```python
import torch

def _softmax(x, axis=-1):
    return torch.softmax(x, dim=axis)

def _gelu(x):
    return torch.nn.functional.gelu(x, approximate='tanh')

def _silu(x):
    return torch.nn.functional.silu(x)

def _sigmoid(x):
    return torch.sigmoid(x)

def _layernorm(x, axis=-1, eps=1e-05):
    m = x.mean(dim=axis, keepdim=True)
    v = x.var(dim=axis, keepdim=True, unbiased=False)
    return (x - m) / torch.sqrt(v + eps)

def _scatter_add(tgt, idx, src, axis=0):
    return tgt.clone().index_add_(axis, idx, src)

def _segment_sum(src, seg, n):
    out = torch.zeros((n,) + src.shape[1:], dtype=src.dtype)
    return out.index_add_(0, seg, src)

def _pad(x, pw):
    flat = tuple((v for pair in reversed(pw) for v in pair))
    return torch.nn.functional.pad(x, flat)
kernel_name = 'interleave_layers__sliding_local_dilated__mixer_gmlp__prompt'

def setup_inputs():

    _w = lambda a: (lambda t: t.to(torch.bfloat16) if t.is_floating_point() else t)(torch.as_tensor(a))

    def _A_setup():
        B, S, D = (1, 2048, 576)
        return {'x': _w((lambda *s: torch.randn(*s, dtype=torch.bfloat16) * 0.05)(B, S, D)), 'wqkv': _w((lambda *s: torch.randn(*s, dtype=torch.bfloat16) * 0.05)(D, 3 * D)), 'wo': _w((lambda *s: torch.randn(*s, dtype=torch.bfloat16) * 0.05)(D, D))}
    _A_in = _A_setup()

    def _B_setup():
        B, S, D, F = (1, 2048, 576, 4608)
        Fh = F // 2
        return {'x': _w((lambda *s: torch.randn(*s, dtype=torch.bfloat16) * 0.05)(B, S, D)), 'w_in': _w((lambda *s: torch.randn(*s, dtype=torch.bfloat16) * 0.2)(D, 2 * Fh)), 'w_sp': _w(0.01 * (lambda *s: torch.randn(*s, dtype=torch.bfloat16) * 0.2)(S, S)), 'b_sp': _w(1.0 + 0.01 * (lambda *s: torch.randn(*s, dtype=torch.bfloat16) * 0.05)(S)), 'w_out': _w((lambda *s: torch.randn(*s, dtype=torch.bfloat16) * 0.05)(Fh, D))}
    _B_in = _B_setup()
    return {'A_x': _A_in['x'], 'A_wqkv': _A_in['wqkv'], 'A_wo': _A_in['wo'], 'B_x': _B_in['x'], 'B_w_in': _B_in['w_in'], 'B_w_sp': _B_in['w_sp'], 'B_b_sp': _B_in['b_sp'], 'B_w_out': _B_in['w_out']}

def reference(A_x, A_wqkv, A_wo, B_x, B_w_in, B_w_sp, B_b_sp, B_w_out):

    def _A_ref(x, wqkv, wo):
        B, S, D = x.shape
        H = 32
        Dh = D // H
        W, dil = (8, 2)
        qkv = (lambda x, *d: x.permute(*d))((x @ wqkv).reshape(B, S, 3, H, Dh), 2, 0, 3, 1, 4)
        q, k, v = (qkv[0], qkv[1], qkv[2])
        scale = Dh ** (-0.5)
        pos = torch.arange(S)
        off = torch.arange(W) * dil
        idx = pos[:, None] - off[None, :]
        mask = idx >= 0
        idx_c = torch.where(mask, idx, 0).reshape(-1)
        kg = k[:, :, idx_c, :].reshape(B, H, S, W, Dh)
        vg = v[:, :, idx_c, :].reshape(B, H, S, W, Dh)
        logits = torch.einsum('bhsd,bhswd->bhsw', q, kg) * scale
        logits = torch.where(mask[None, None, :, :], logits, -1000000000.0)
        attn = _softmax(logits, axis=-1)
        o = torch.einsum('bhsw,bhswd->bhsd', attn, vg)
        return (lambda x, *d: x.permute(*d))(o, 0, 2, 1, 3).reshape(B, S, D) @ wo

    def _B_ref(x, w_in, w_sp, b_sp, w_out):
        B, S, D = x.shape
        F = w_in.shape[-1]
        Fh = F // 2
        z = _gelu(torch.einsum('bsd,df->bsf', x, w_in))
        z1 = z[..., :Fh].clone()
        z2 = _layernorm(z[..., Fh:], axis=-1)
        g = torch.einsum('ts,bsf->btf', w_sp, z2) + b_sp[None, :, None]
        return torch.einsum('bsf,fd->bsd', z1 * g, w_out)
    x = A_x
    x = x + _A_ref(_layernorm(x, axis=-1), A_wqkv, A_wo)
    x = x + _B_ref(_layernorm(x, axis=-1), B_w_in, B_w_sp, B_b_sp, B_w_out)
    x = x + _A_ref(_layernorm(x, axis=-1), A_wqkv, A_wo)
    x = x + _B_ref(_layernorm(x, axis=-1), B_w_in, B_w_sp, B_b_sp, B_w_out)
    return x
```

```asm
; @launch kernel=k0_kernel grid=(352,1,1) block=(256,1,1) lds=36864
; @launch kernel=p1l0_kernel grid=(256,1,1) block=(512,1,1) lds=163840
; @launch kernel=p2l0_kernel grid=(256,1,1) block=(512,1,1) lds=163840
; @launch kernel=p3l0_kernel grid=(256,1,1) block=(512,1,1) lds=163840
; @launch kernel=p5l0_kernel grid=(256,1,1) block=(512,1,1) lds=163840
; @launch kernel=p1l1_kernel grid=(256,1,1) block=(512,1,1) lds=163840
; @launch kernel=p2l1_kernel grid=(256,1,1) block=(512,1,1) lds=163840
; @launch kernel=p3l1_kernel grid=(256,1,1) block=(512,1,1) lds=163840
; @launch kernel=p5l1_kernel grid=(256,1,1) block=(512,1,1) lds=163840
.amdgcn_target "amdgcn-amd-amdhsa--gfx950"
.text
.globl k0_kernel
.p2align 8
.type k0_kernel,@function
k0_kernel:
    s_cmp_ge_u32 s2, 352
    s_cbranch_scc1 L_k0_end
    s_load_dwordx2 s[24:25], s[0:1], 80
    s_load_dwordx16 s[36:51], s[0:1], 0
    v_lshrrev_b32 v2, 6, v0
    v_and_b32 v1, 63, v0
    v_lshlrev_b32 v1, 4, v1
    v_readfirstlane_b32 s20, v2
    v_and_b32 v2, 15, v0
    v_bfe_u32 v3, v0, 4, 2
    v_bfrev_b32 v6, 1
    v_mov_b32 v11, 0x3f803f80
    s_mul_i32 s30, s20, 9216
    s_waitcnt lgkmcnt(0)
    s_mov_b32 s4, s24
    s_mov_b32 s5, s25
    s_mov_b32 s6, 0x10000000
    s_mov_b32 s7, 0x20000
    s_cmp_ge_u32 s2, 2
    s_cbranch_scc1 L_k0_nz
    v_lshlrev_b32 v4, 8, v0
    v_mov_b32 v5, 0
    s_lshl_b32 s26, s2, 16
    s_add_u32 s26, s26, 0x8500000
    buffer_store_dword v5, v4, s[4:7], s26 offen
L_k0_nz:
    s_cmp_lt_u32 s2, 54
    s_cbranch_scc1 L_k0_wq
    s_cmp_lt_u32 s2, 118
    s_cbranch_scc1 L_k0_x
    s_cmp_lt_u32 s2, 136
    s_cbranch_scc1 L_k0_wo
    s_cmp_lt_u32 s2, 280
    s_cbranch_scc1 L_k0_wi
    s_sub_u32 s26, s2, 280
    s_mul_i32 s28, s26, 57
    s_lshr_b32 s28, s28, 9
    s_mul_i32 s27, s28, 9
    s_sub_u32 s27, s26, s27
    s_mov_b32 s8, s50
    s_mov_b32 s9, s51
    s_mov_b32 s10, 0x288000
    s_mov_b32 s11, 0x20000
    s_mul_i32 s29, s28, 331776
    s_lshl_b32 s31, s27, 7
    s_add_u32 s29, s29, s31
    s_mul_i32 s31, s20, 82944
    s_add_u32 s29, s29, s31
    v_bfe_u32 v4, v0, 3, 3
    v_mul_u32_u24 v4, 1152, v4
    v_and_b32 v5, 7, v0
    v_lshl_add_u32 v4, v5, 4, v4
    s_add_u32 m0, s30, 0
    s_add_u32 s31, s29, 0
    buffer_load_dwordx4 v4, s[8:11], s31 offen lds
    s_add_u32 m0, s30, 1024
    s_add_u32 s31, s29, 9216
    buffer_load_dwordx4 v4, s[8:11], s31 offen lds
    s_add_u32 m0, s30, 2048
    s_add_u32 s31, s29, 18432
    buffer_load_dwordx4 v4, s[8:11], s31 offen lds
    s_add_u32 m0, s30, 3072
    s_add_u32 s31, s29, 27648
    buffer_load_dwordx4 v4, s[8:11], s31 offen lds
    s_add_u32 m0, s30, 4096
    s_add_u32 s31, s29, 36864
    buffer_load_dwordx4 v4, s[8:11], s31 offen lds
    s_add_u32 m0, s30, 5120
    s_add_u32 s31, s29, 46080
    buffer_load_dwordx4 v4, s[8:11], s31 offen lds
    s_add_u32 m0, s30, 6144
    s_add_u32 s31, s29, 55296
    buffer_load_dwordx4 v4, s[8:11], s31 offen lds
    s_add_u32 m0, s30, 7168
    s_add_u32 s31, s29, 64512
    buffer_load_dwordx4 v4, s[8:11], s31 offen lds
    s_add_u32 m0, s30, 8192
    s_add_u32 s31, s29, 73728
    buffer_load_dwordx4 v4, s[8:11], s31 offen lds
    v_lshrrev_b32 v7, 2, v2
    v_and_b32 v8, 3, v2
    s_lshl_b32 s31, s20, 5
    v_lshlrev_b32 v9, 7, v7
    v_lshl_add_u32 v9, v8, 3, v9
    v_add_u32 v9, s31, v9
    v_mul_u32_u24 v4, 512, v3
    v_add_u32 v4, v4, v9
    v_mul_u32_u24 v5, 512, v3
    v_add_u32 v5, v5, v9
    s_lshl_b32 s31, s27, 2
    s_add_u32 s31, s31, s20
    v_lshl_add_u32 v7, s31, 2, v7
    v_lshlrev_b32 v8, 4, v8
    v_lshl_add_u32 v8, v3, 8, v8
    v_mul_u32_u24 v9, 57, v7
    v_lshrrev_b32 v9, 10, v9
    v_mul_u32_u24 v10, 18, v9
    v_sub_u32 v10, v7, v10
    v_lshrrev_b32 v12, 3, v10
    v_and_b32 v13, 1, v10
    v_lshl_add_u32 v12, v12, 1, v13
    v_bfe_u32 v14, v10, 1, 2
    v_cmp_gt_u32 vcc, 16, v10
    v_mul_u32_u24 v9, 331776, v9
    v_add_u32 v9, v9, v8
    v_cndmask_b32 v12, 8, v12, vcc
    v_cndmask_b32 v14, v13, v14, vcc
    v_mov_b32 v15, 0x1000
    v_mov_b32 v13, 0x80
    v_cndmask_b32 v15, v13, v15, vcc
    v_lshl_add_u32 v9, v12, 10, v9
    v_lshl_add_u32 v9, v14, 6, v9
    v_add_u32 v10, v9, v15
    s_and_b32 s31, s28, 1
    s_cmp_eq_u32 s31, 1
    s_cselect_b64 vcc, -1, 0
    v_cndmask_b32 v12, v9, v10, vcc
    v_cndmask_b32 v13, v10, v9, vcc
    s_mul_i32 s32, s28, 9
    s_waitcnt vmcnt(0)
    s_barrier
    ds_read_b64_tr_b16 v[16:17], v4 offset:0
    ds_read_b64_tr_b16 v[18:19], v4 offset:2048
    ds_read_b64_tr_b16 v[20:21], v4 offset:4096
    ds_read_b64_tr_b16 v[22:23], v4 offset:6144
    ds_read_b64_tr_b16 v[24:25], v4 offset:8192
    ds_read_b64_tr_b16 v[26:27], v4 offset:10240
    ds_read_b64_tr_b16 v[28:29], v4 offset:12288
    ds_read_b64_tr_b16 v[30:31], v4 offset:14336
    ds_read_b64_tr_b16 v[32:33], v4 offset:18432
    ds_read_b64_tr_b16 v[34:35], v4 offset:20480
    ds_read_b64_tr_b16 v[36:37], v4 offset:22528
    ds_read_b64_tr_b16 v[38:39], v4 offset:24576
    ds_read_b64_tr_b16 v[40:41], v4 offset:26624
    ds_read_b64_tr_b16 v[42:43], v4 offset:28672
    ds_read_b64_tr_b16 v[44:45], v4 offset:30720
    ds_read_b64_tr_b16 v[46:47], v4 offset:32768
    ds_read_b64_tr_b16 v[48:49], v5 offset:16384
    ds_read_b64_tr_b16 v[50:51], v5 offset:34816
    s_waitcnt lgkmcnt(15)
    s_add_u32 s31, s32, 0
    s_lshr_b32 s31, s31, 1
    s_mul_i32 s31, s31, 9216
    s_add_u32 s31, s31, 0x8100000
    buffer_store_dwordx4 v[16:19], v12, s[4:7], s31 offen
    s_waitcnt lgkmcnt(14)
    s_add_u32 s31, s32, 1
    s_lshr_b32 s31, s31, 1
    s_mul_i32 s31, s31, 9216
    s_add_u32 s31, s31, 0x8100000
    buffer_store_dwordx4 v[20:23], v13, s[4:7], s31 offen
    s_waitcnt lgkmcnt(12)
    s_add_u32 s31, s32, 2
    s_lshr_b32 s31, s31, 1
    s_mul_i32 s31, s31, 9216
    s_add_u32 s31, s31, 0x8100000
    buffer_store_dwordx4 v[24:27], v12, s[4:7], s31 offen
    s_waitcnt lgkmcnt(10)
    s_add_u32 s31, s32, 3
    s_lshr_b32 s31, s31, 1
    s_mul_i32 s31, s31, 9216
    s_add_u32 s31, s31, 0x8100000
    buffer_store_dwordx4 v[28:31], v13, s[4:7], s31 offen
    s_waitcnt lgkmcnt(8)
    s_add_u32 s31, s32, 4
    s_lshr_b32 s31, s31, 1
    s_mul_i32 s31, s31, 9216
    s_add_u32 s31, s31, 0x8100000
    buffer_store_dwordx4 v[32:35], v12, s[4:7], s31 offen
    s_waitcnt lgkmcnt(6)
    s_add_u32 s31, s32, 5
    s_lshr_b32 s31, s31, 1
    s_mul_i32 s31, s31, 9216
    s_add_u32 s31, s31, 0x8100000
    buffer_store_dwordx4 v[36:39], v13, s[4:7], s31 offen
    s_waitcnt lgkmcnt(4)
    s_add_u32 s31, s32, 6
    s_lshr_b32 s31, s31, 1
    s_mul_i32 s31, s31, 9216
    s_add_u32 s31, s31, 0x8100000
    buffer_store_dwordx4 v[40:43], v12, s[4:7], s31 offen
    s_waitcnt lgkmcnt(2)
    s_add_u32 s31, s32, 7
    s_lshr_b32 s31, s31, 1
    s_mul_i32 s31, s31, 9216
    s_add_u32 s31, s31, 0x8100000
    buffer_store_dwordx4 v[44:47], v13, s[4:7], s31 offen
    s_waitcnt lgkmcnt(0)
    s_add_u32 s31, s32, 8
    s_lshr_b32 s31, s31, 1
    s_mul_i32 s31, s31, 9216
    s_add_u32 s31, s31, 0x8100000
    buffer_store_dwordx4 v[48:51], v12, s[4:7], s31 offen
    s_endpgm
L_k0_wo:
    s_sub_u32 s26, s2, 118
    s_mul_i32 s28, s26, 57
    s_lshr_b32 s28, s28, 9
    s_mul_i32 s27, s28, 9
    s_sub_u32 s27, s26, s27
    s_mov_b32 s8, s40
    s_mov_b32 s9, s41
    s_mov_b32 s10, 0xa2000
    s_mov_b32 s11, 0x20000
    s_mul_i32 s29, s28, 331776
    s_lshl_b32 s31, s27, 7
    s_add_u32 s29, s29, s31
    s_mul_i32 s31, s20, 82944
    s_add_u32 s29, s29, s31
    v_bfe_u32 v4, v0, 3, 3
    v_mul_u32_u24 v4, 1152, v4
    v_and_b32 v5, 7, v0
    v_lshl_add_u32 v4, v5, 4, v4
    s_add_u32 m0, s30, 0
    s_add_u32 s31, s29, 0
    buffer_load_dwordx4 v4, s[8:11], s31 offen lds
    s_add_u32 m0, s30, 1024
    s_add_u32 s31, s29, 9216
    buffer_load_dwordx4 v4, s[8:11], s31 offen lds
    s_add_u32 m0, s30, 2048
    s_add_u32 s31, s29, 18432
    buffer_load_dwordx4 v4, s[8:11], s31 offen lds
    s_add_u32 m0, s30, 3072
    s_add_u32 s31, s29, 27648
    buffer_load_dwordx4 v4, s[8:11], s31 offen lds
    s_add_u32 m0, s30, 4096
    s_add_u32 s31, s29, 36864
    buffer_load_dwordx4 v4, s[8:11], s31 offen lds
    s_add_u32 m0, s30, 5120
    s_add_u32 s31, s29, 46080
    buffer_load_dwordx4 v4, s[8:11], s31 offen lds
    s_add_u32 m0, s30, 6144
    s_add_u32 s31, s29, 55296
    buffer_load_dwordx4 v4, s[8:11], s31 offen lds
    s_add_u32 m0, s30, 7168
    s_add_u32 s31, s29, 64512
    buffer_load_dwordx4 v4, s[8:11], s31 offen lds
    s_add_u32 m0, s30, 8192
    s_add_u32 s31, s29, 73728
    buffer_load_dwordx4 v4, s[8:11], s31 offen lds
    v_lshrrev_b32 v7, 2, v2
    v_and_b32 v8, 3, v2
    s_lshl_b32 s31, s20, 5
    v_lshlrev_b32 v9, 7, v7
    v_lshl_add_u32 v9, v8, 3, v9
    v_add_u32 v9, s31, v9
    v_mul_u32_u24 v4, 512, v3
    v_add_u32 v4, v4, v9
    v_mul_u32_u24 v5, 9216, v3
    v_add_u32 v5, v5, v9
    s_lshl_b32 s31, s27, 2
    s_add_u32 s31, s31, s20
    v_lshl_add_u32 v7, s31, 2, v7
    v_lshlrev_b32 v8, 4, v8
    v_lshl_add_u32 v8, v3, 8, v8
    v_mul_u32_u24 v9, 57, v7
    v_lshrrev_b32 v9, 10, v9
    v_mul_u32_u24 v10, 18, v9
    v_sub_u32 v10, v7, v10
    v_lshrrev_b32 v12, 3, v10
    v_and_b32 v13, 1, v10
    v_lshl_add_u32 v12, v12, 1, v13
    v_bfe_u32 v14, v10, 1, 2
    v_cmp_gt_u32 vcc, 16, v10
    v_mul_u32_u24 v9, 82944, v9
    v_add_u32 v9, v9, v8
    v_cndmask_b32 v12, 8, v12, vcc
    v_cndmask_b32 v14, v13, v14, vcc
    v_mov_b32 v15, 0x1000
    v_mov_b32 v13, 0x80
    v_cndmask_b32 v15, v13, v15, vcc
    v_lshl_add_u32 v9, v12, 10, v9
    v_lshl_add_u32 v9, v14, 6, v9
    v_add_u32 v10, v9, v15
    s_and_b32 s31, s28, 1
    s_cmp_eq_u32 s31, 1
    s_cselect_b64 vcc, -1, 0
    v_cndmask_b32 v12, v9, v10, vcc
    v_cndmask_b32 v13, v10, v9, vcc
    s_lshl_b32 s32, s28, 3
    s_waitcnt vmcnt(0)
    s_barrier
    ds_read_b64_tr_b16 v[16:17], v4 offset:0
    ds_read_b64_tr_b16 v[18:19], v4 offset:2560
    ds_read_b64_tr_b16 v[20:21], v4 offset:4608
    ds_read_b64_tr_b16 v[22:23], v4 offset:7168
    ds_read_b64_tr_b16 v[24:25], v4 offset:9216
    ds_read_b64_tr_b16 v[26:27], v4 offset:11776
    ds_read_b64_tr_b16 v[28:29], v4 offset:13824
    ds_read_b64_tr_b16 v[30:31], v4 offset:16384
    ds_read_b64_tr_b16 v[32:33], v4 offset:18432
    ds_read_b64_tr_b16 v[34:35], v4 offset:20992
    ds_read_b64_tr_b16 v[36:37], v4 offset:23040
    ds_read_b64_tr_b16 v[38:39], v4 offset:25600
    ds_read_b64_tr_b16 v[40:41], v4 offset:27648
    ds_read_b64_tr_b16 v[42:43], v4 offset:30208
    ds_read_b64_tr_b16 v[44:45], v4 offset:32256
    ds_read_b64_tr_b16 v[46:47], v4 offset:34816
    ds_read_b64_tr_b16 v[48:49], v5 offset:2048
    ds_read_b64_tr_b16 v[50:51], v5 offset:6656
    s_waitcnt lgkmcnt(15)
    s_mul_i32 s31, s28, 36864
    s_add_u32 s31, s31, 0x7a00000
    buffer_store_dwordx4 v[16:19], v9, s[4:7], s31 offen
    s_waitcnt lgkmcnt(14)
    s_mul_i32 s31, s28, 36864
    s_add_u32 s31, s31, 0x7a00000
    buffer_store_dwordx4 v[20:23], v10, s[4:7], s31 offen
    s_waitcnt lgkmcnt(12)
    s_mul_i32 s31, s28, 36864
    s_add_u32 s31, s31, 0x7a02400
    buffer_store_dwordx4 v[24:27], v9, s[4:7], s31 offen
    s_waitcnt lgkmcnt(10)
    s_mul_i32 s31, s28, 36864
    s_add_u32 s31, s31, 0x7a02400
    buffer_store_dwordx4 v[28:31], v10, s[4:7], s31 offen
    s_waitcnt lgkmcnt(8)
    s_mul_i32 s31, s28, 36864
    s_add_u32 s31, s31, 0x7a04800
    buffer_store_dwordx4 v[32:35], v9, s[4:7], s31 offen
    s_waitcnt lgkmcnt(6)
    s_mul_i32 s31, s28, 36864
    s_add_u32 s31, s31, 0x7a04800
    buffer_store_dwordx4 v[36:39], v10, s[4:7], s31 offen
    s_waitcnt lgkmcnt(4)
    s_mul_i32 s31, s28, 36864
    s_add_u32 s31, s31, 0x7a06c00
    buffer_store_dwordx4 v[40:43], v9, s[4:7], s31 offen
    s_waitcnt lgkmcnt(2)
    s_mul_i32 s31, s28, 36864
    s_add_u32 s31, s31, 0x7a06c00
    buffer_store_dwordx4 v[44:47], v10, s[4:7], s31 offen
    s_waitcnt lgkmcnt(0)
    s_mov_b32 s31, 0x7a12000
    buffer_store_dwordx4 v[48:51], v12, s[4:7], s31 offen
    s_endpgm
L_k0_wi:
    s_sub_u32 s26, s2, 136
    s_mul_i32 s28, s26, 57
    s_lshr_b32 s28, s28, 12
    s_mul_i32 s27, s28, 72
    s_sub_u32 s27, s26, s27
    s_mov_b32 s8, s44
    s_mov_b32 s9, s45
    s_mov_b32 s10, 0x510000
    s_mov_b32 s11, 0x20000
    s_mul_i32 s29, s28, 2654208
    s_lshl_b32 s31, s27, 7
    s_add_u32 s29, s29, s31
    s_mul_i32 s31, s20, 663552
    s_add_u32 s29, s29, s31
    v_bfe_u32 v4, v0, 3, 3
    v_mul_u32_u24 v4, 9216, v4
    v_and_b32 v5, 7, v0
    v_lshl_add_u32 v4, v5, 4, v4
    s_add_u32 m0, s30, 0
    s_add_u32 s31, s29, 0
    buffer_load_dwordx4 v4, s[8:11], s31 offen lds
    s_add_u32 m0, s30, 1024
    s_add_u32 s31, s29, 73728
    buffer_load_dwordx4 v4, s[8:11], s31 offen lds
    s_add_u32 m0, s30, 2048
    s_add_u32 s31, s29, 147456
    buffer_load_dwordx4 v4, s[8:11], s31 offen lds
    s_add_u32 m0, s30, 3072
    s_add_u32 s31, s29, 221184
    buffer_load_dwordx4 v4, s[8:11], s31 offen lds
    s_add_u32 m0, s30, 4096
    s_add_u32 s31, s29, 294912
    buffer_load_dwordx4 v4, s[8:11], s31 offen lds
    s_add_u32 m0, s30, 5120
    s_add_u32 s31, s29, 368640
    buffer_load_dwordx4 v4, s[8:11], s31 offen lds
    s_add_u32 m0, s30, 6144
    s_add_u32 s31, s29, 442368
    buffer_load_dwordx4 v4, s[8:11], s31 offen lds
    s_add_u32 m0, s30, 7168
    s_add_u32 s31, s29, 516096
    buffer_load_dwordx4 v4, s[8:11], s31 offen lds
    s_add_u32 m0, s30, 8192
    s_add_u32 s31, s29, 589824
    buffer_load_dwordx4 v4, s[8:11], s31 offen lds
    v_lshrrev_b32 v7, 2, v2
    v_and_b32 v8, 3, v2
    s_lshl_b32 s31, s20, 5
    v_lshlrev_b32 v9, 7, v7
    v_lshl_add_u32 v9, v8, 3, v9
    v_add_u32 v9, s31, v9
    v_mul_u32_u24 v4, 1024, v3
    v_add_u32 v4, v4, v9
    v_mul_u32_u24 v5, 9216, v3
    v_add_u32 v5, v5, v9
    s_lshl_b32 s31, s27, 2
    s_add_u32 s31, s31, s20
    v_lshl_add_u32 v7, s31, 2, v7
    v_lshlrev_b32 v8, 4, v8
    v_lshl_add_u32 v8, v3, 8, v8
    s_cmp_lt_u32 s31, 144
    s_cselect_b32 s33, 1, 0
    s_cselect_b32 s34, 0, 144
    s_sub_u32 s34, s31, s34
    s_mul_i32 s35, s34, 57
    s_lshr_b32 s35, s35, 9
    s_mul_i32 s52, s35, 9
    s_sub_u32 s34, s34, s52
    s_lshl_b32 s52, s35, 1
    s_add_u32 s52, s52, s33
    s_mul_i32 s52, s52, 165888
    s_lshl_b32 s53, s34, 10
    s_add_u32 s52, s52, s53
    s_add_u32 s52, s52, 0x7b00000
    s_mul_i32 s53, s28, 9216
    s_add_u32 s54, s52, s53
    s_lshl_b32 s53, s53, 3
    s_add_u32 s52, s52, s53
    s_lshl_b32 s55, s35, 12
    s_mul_i32 s53, s28, 1152
    s_add_u32 s55, s55, s53
    s_mul_i32 s53, s33, 576
    s_add_u32 s55, s55, s53
    s_lshl_b32 s53, s34, 6
    s_add_u32 s55, s55, s53
    s_add_u32 s55, s55, 0x8410000
    v_cmp_eq_u32 vcc, 0, v3
    v_lshlrev_b32 v10, 2, v2
    s_nop 0
    v_cndmask_b32 v10, v6, v10, vcc
    s_waitcnt vmcnt(0)
    s_barrier
    ds_read_b64_tr_b16 v[16:17], v4 offset:0
    ds_read_b64_tr_b16 v[18:19], v4 offset:512
    ds_read_b64_tr_b16 v[20:21], v4 offset:4096
    ds_read_b64_tr_b16 v[22:23], v4 offset:4608
    ds_read_b64_tr_b16 v[24:25], v4 offset:9216
    ds_read_b64_tr_b16 v[26:27], v4 offset:9728
    ds_read_b64_tr_b16 v[28:29], v4 offset:13312
    ds_read_b64_tr_b16 v[30:31], v4 offset:13824
    ds_read_b64_tr_b16 v[32:33], v4 offset:18432
    ds_read_b64_tr_b16 v[34:35], v4 offset:18944
    ds_read_b64_tr_b16 v[36:37], v4 offset:22528
    ds_read_b64_tr_b16 v[38:39], v4 offset:23040
    ds_read_b64_tr_b16 v[40:41], v4 offset:27648
    ds_read_b64_tr_b16 v[42:43], v4 offset:28160
    ds_read_b64_tr_b16 v[44:45], v4 offset:31744
    ds_read_b64_tr_b16 v[46:47], v4 offset:32256
    ds_read_b64_tr_b16 v[48:49], v5 offset:8192
    ds_read_b64_tr_b16 v[50:51], v5 offset:8704
    s_waitcnt lgkmcnt(15)
    s_add_u32 s31, s52, 0
    buffer_store_dwordx4 v[16:19], v1, s[4:7], s31 offen
    s_waitcnt lgkmcnt(14)
    s_add_u32 s31, s52, 9216
    buffer_store_dwordx4 v[20:23], v1, s[4:7], s31 offen
    s_waitcnt lgkmcnt(12)
    s_add_u32 s31, s52, 18432
    buffer_store_dwordx4 v[24:27], v1, s[4:7], s31 offen
    s_waitcnt lgkmcnt(10)
    s_add_u32 s31, s52, 27648
    buffer_store_dwordx4 v[28:31], v1, s[4:7], s31 offen
    s_waitcnt lgkmcnt(8)
    s_add_u32 s31, s52, 36864
    buffer_store_dwordx4 v[32:35], v1, s[4:7], s31 offen
    s_waitcnt lgkmcnt(6)
    s_add_u32 s31, s52, 46080
    buffer_store_dwordx4 v[36:39], v1, s[4:7], s31 offen
    s_waitcnt lgkmcnt(4)
    s_add_u32 s31, s52, 55296
    buffer_store_dwordx4 v[40:43], v1, s[4:7], s31 offen
    s_waitcnt lgkmcnt(2)
    s_add_u32 s31, s52, 64512
    buffer_store_dwordx4 v[44:47], v1, s[4:7], s31 offen
    s_waitcnt lgkmcnt(0)
    s_add_u32 s31, s54, 147456
    buffer_store_dwordx4 v[48:51], v1, s[4:7], s31 offen
    v_mov_b32 v12, 0
    v_mov_b32 v13, 0
    v_dot2_f32_bf16 v12, v16, v11, v12
    v_dot2_f32_bf16 v13, v17, v11, v13
    v_dot2_f32_bf16 v12, v18, v11, v12
    v_dot2_f32_bf16 v13, v19, v11, v13
    v_dot2_f32_bf16 v12, v20, v11, v12
    v_dot2_f32_bf16 v13, v21, v11, v13
    v_dot2_f32_bf16 v12, v22, v11, v12
    v_dot2_f32_bf16 v13, v23, v11, v13
    v_dot2_f32_bf16 v12, v24, v11, v12
    v_dot2_f32_bf16 v13, v25, v11, v13
    v_dot2_f32_bf16 v12, v26, v11, v12
    v_dot2_f32_bf16 v13, v27, v11, v13
    v_dot2_f32_bf16 v12, v28, v11, v12
    v_dot2_f32_bf16 v13, v29, v11, v13
    v_dot2_f32_bf16 v12, v30, v11, v12
    v_dot2_f32_bf16 v13, v31, v11, v13
    v_dot2_f32_bf16 v12, v32, v11, v12
    v_dot2_f32_bf16 v13, v33, v11, v13
    v_dot2_f32_bf16 v12, v34, v11, v12
    v_dot2_f32_bf16 v13, v35, v11, v13
    v_dot2_f32_bf16 v12, v36, v11, v12
    v_dot2_f32_bf16 v13, v37, v11, v13
    v_dot2_f32_bf16 v12, v38, v11, v12
    v_dot2_f32_bf16 v13, v39, v11, v13
    v_dot2_f32_bf16 v12, v40, v11, v12
    v_dot2_f32_bf16 v13, v41, v11, v13
    v_dot2_f32_bf16 v12, v42, v11, v12
    v_dot2_f32_bf16 v13, v43, v11, v13
    v_dot2_f32_bf16 v12, v44, v11, v12
    v_dot2_f32_bf16 v13, v45, v11, v13
    v_dot2_f32_bf16 v12, v46, v11, v12
    v_dot2_f32_bf16 v13, v47, v11, v13
    v_dot2_f32_bf16 v12, v48, v11, v12
    v_dot2_f32_bf16 v13, v49, v11, v13
    v_dot2_f32_bf16 v12, v50, v11, v12
    v_dot2_f32_bf16 v13, v51, v11, v13
    s_nop 2
    v_add_f32 v12, v12, v13
    v_mov_b32 v13, v12
    s_nop 1
    v_permlane32_swap_b32 v12, v13
    v_add_f32 v12, v12, v13
    v_mov_b32 v13, v12
    s_nop 1
    v_permlane16_swap_b32 v12, v13
    v_add_f32 v12, v12, v13
    buffer_store_dword v12, v10, s[4:7], s55 offen
    s_endpgm
L_k0_wq:
    s_sub_u32 s26, s2, 0
    s_mul_i32 s28, s26, 19
    s_lshr_b32 s28, s28, 9
    s_mul_i32 s27, s28, 27
    s_sub_u32 s27, s26, s27
    s_mov_b32 s8, s38
    s_mov_b32 s9, s39
    s_mov_b32 s10, 0x1e6000
    s_mov_b32 s11, 0x20000
    s_mul_i32 s29, s28, 995328
    s_lshl_b32 s31, s27, 7
    s_add_u32 s29, s29, s31
    s_mul_i32 s31, s20, 248832
    s_add_u32 s29, s29, s31
    v_bfe_u32 v4, v0, 3, 3
    v_mul_u32_u24 v4, 3456, v4
    v_and_b32 v5, 7, v0
    v_lshl_add_u32 v4, v5, 4, v4
    s_add_u32 m0, s30, 0
    s_add_u32 s31, s29, 0
    buffer_load_dwordx4 v4, s[8:11], s31 offen lds
    s_add_u32 m0, s30, 1024
    s_add_u32 s31, s29, 27648
    buffer_load_dwordx4 v4, s[8:11], s31 offen lds
    s_add_u32 m0, s30, 2048
    s_add_u32 s31, s29, 55296
    buffer_load_dwordx4 v4, s[8:11], s31 offen lds
    s_add_u32 m0, s30, 3072
    s_add_u32 s31, s29, 82944
    buffer_load_dwordx4 v4, s[8:11], s31 offen lds
    s_add_u32 m0, s30, 4096
    s_add_u32 s31, s29, 110592
    buffer_load_dwordx4 v4, s[8:11], s31 offen lds
    s_add_u32 m0, s30, 5120
    s_add_u32 s31, s29, 138240
    buffer_load_dwordx4 v4, s[8:11], s31 offen lds
    s_add_u32 m0, s30, 6144
    s_add_u32 s31, s29, 165888
    buffer_load_dwordx4 v4, s[8:11], s31 offen lds
    s_add_u32 m0, s30, 7168
    s_add_u32 s31, s29, 193536
    buffer_load_dwordx4 v4, s[8:11], s31 offen lds
    s_add_u32 m0, s30, 8192
    s_add_u32 s31, s29, 221184
    buffer_load_dwordx4 v4, s[8:11], s31 offen lds
    v_lshrrev_b32 v7, 2, v2
    v_and_b32 v8, 3, v2
    s_lshl_b32 s31, s20, 5
    v_lshlrev_b32 v9, 7, v7
    v_lshl_add_u32 v9, v8, 3, v9
    v_add_u32 v9, s31, v9
    v_mul_u32_u24 v4, 1024, v3
    v_add_u32 v4, v4, v9
    v_mul_u32_u24 v5, 9216, v3
    v_add_u32 v5, v5, v9
    s_lshl_b32 s31, s27, 2
    s_add_u32 s31, s31, s20
    v_lshl_add_u32 v7, s31, 2, v7
    v_lshlrev_b32 v8, 4, v8
    v_lshl_add_u32 v8, v3, 8, v8
    v_mul_u32_u24 v9, 57, v7
    v_lshrrev_b32 v9, 13, v9
    v_mul_u32_u24 v10, 144, v9
    v_sub_u32 v10, v7, v10
    v_mul_u32_u24 v12, 57, v10
    v_lshrrev_b32 v12, 9, v12
    v_mul_u32_u24 v13, 9, v12
    v_sub_u32 v13, v10, v13
    v_cmp_lt_u32 s[52:53], 4, v13
    v_cmp_eq_u32 s[54:55], 4, v13
    v_cmp_eq_u32 s[56:57], 2, v9
    v_lshlrev_b32 v14, 1, v9
    v_add_u32 v15, 1, v14
    v_subrev_u32 v10, 5, v13
    v_cndmask_b32 v14, v14, v15, s[52:53]
    v_cndmask_b32 v13, v13, v10, s[52:53]
    v_cndmask_b32 v14, v14, 6, s[54:55]
    v_cndmask_b32 v13, v13, v9, s[54:55]
    s_and_b64 s[56:57], s[56:57], s[54:55]
    s_mov_b32 s33, 129024
    v_mul_lo_u32 v9, v12, s33
    v_add_u32 v9, v9, v8
    v_lshl_add_u32 v9, v14, 10, v9
    v_lshl_add_u32 v9, v13, 6, v9
    v_add_u32 v15, 64, v9
    v_cndmask_b32 v15, v6, v15, s[56:57]
    v_and_b32 v10, 3, v2
    v_lshlrev_b32 v10, 2, v10
    v_lshl_add_u32 v10, v13, 4, v10
    v_lshl_add_u32 v10, v14, 6, v10
    v_lshl_add_u32 v10, v12, 10, v10
    v_cmp_eq_u32 vcc, 0, v3
    s_lshl_b32 s55, s28, 9
    s_add_u32 s55, s55, 0x8400000
    v_cndmask_b32 v10, v6, v10, vcc
    s_mul_i32 s53, s28, 7168
    s_add_u32 s54, s53, 0x781c000
    s_lshl_b32 s53, s53, 3
    s_add_u32 s52, s53, 0x7800000
    v_mov_b32 v52, 0
    v_mov_b32 v53, 0
    v_mov_b32 v54, 0
    v_mov_b32 v55, 0
    s_cmp_eq_u64 s[56:57], 0
    s_cbranch_scc1 L_k0_np
    s_add_u32 s31, s52, 0
    buffer_store_dwordx4 v[52:55], v15, s[4:7], s31 offen
    s_add_u32 s31, s52, 7168
    buffer_store_dwordx4 v[52:55], v15, s[4:7], s31 offen
    s_add_u32 s31, s52, 14336
    buffer_store_dwordx4 v[52:55], v15, s[4:7], s31 offen
    s_add_u32 s31, s52, 21504
    buffer_store_dwordx4 v[52:55], v15, s[4:7], s31 offen
    s_add_u32 s31, s52, 28672
    buffer_store_dwordx4 v[52:55], v15, s[4:7], s31 offen
    s_add_u32 s31, s52, 35840
    buffer_store_dwordx4 v[52:55], v15, s[4:7], s31 offen
    s_add_u32 s31, s52, 43008
    buffer_store_dwordx4 v[52:55], v15, s[4:7], s31 offen
    s_add_u32 s31, s52, 50176
    buffer_store_dwordx4 v[52:55], v15, s[4:7], s31 offen
    s_mov_b32 s31, s54
    buffer_store_dwordx4 v[52:55], v15, s[4:7], s31 offen
L_k0_np:
    s_waitcnt vmcnt(0)
    s_barrier
    ds_read_b64_tr_b16 v[16:17], v4 offset:0
    ds_read_b64_tr_b16 v[18:19], v4 offset:512
    ds_read_b64_tr_b16 v[20:21], v4 offset:4096
    ds_read_b64_tr_b16 v[22:23], v4 offset:4608
    ds_read_b64_tr_b16 v[24:25], v4 offset:9216
    ds_read_b64_tr_b16 v[26:27], v4 offset:9728
    ds_read_b64_tr_b16 v[28:29], v4 offset:13312
    ds_read_b64_tr_b16 v[30:31], v4 offset:13824
    ds_read_b64_tr_b16 v[32:33], v4 offset:18432
    ds_read_b64_tr_b16 v[34:35], v4 offset:18944
    ds_read_b64_tr_b16 v[36:37], v4 offset:22528
    ds_read_b64_tr_b16 v[38:39], v4 offset:23040
    ds_read_b64_tr_b16 v[40:41], v4 offset:27648
    ds_read_b64_tr_b16 v[42:43], v4 offset:28160
    ds_read_b64_tr_b16 v[44:45], v4 offset:31744
    ds_read_b64_tr_b16 v[46:47], v4 offset:32256
    ds_read_b64_tr_b16 v[48:49], v5 offset:8192
    ds_read_b64_tr_b16 v[50:51], v5 offset:8704
    s_waitcnt lgkmcnt(15)
    s_add_u32 s31, s52, 0
    buffer_store_dwordx4 v[16:19], v9, s[4:7], s31 offen
    s_waitcnt lgkmcnt(14)
    s_add_u32 s31, s52, 7168
    buffer_store_dwordx4 v[20:23], v9, s[4:7], s31 offen
    s_waitcnt lgkmcnt(12)
    s_add_u32 s31, s52, 14336
    buffer_store_dwordx4 v[24:27], v9, s[4:7], s31 offen
    s_waitcnt lgkmcnt(10)
    s_add_u32 s31, s52, 21504
    buffer_store_dwordx4 v[28:31], v9, s[4:7], s31 offen
    s_waitcnt lgkmcnt(8)
    s_add_u32 s31, s52, 28672
    buffer_store_dwordx4 v[32:35], v9, s[4:7], s31 offen
    s_waitcnt lgkmcnt(6)
    s_add_u32 s31, s52, 35840
    buffer_store_dwordx4 v[36:39], v9, s[4:7], s31 offen
    s_waitcnt lgkmcnt(4)
    s_add_u32 s31, s52, 43008
    buffer_store_dwordx4 v[40:43], v9, s[4:7], s31 offen
    s_waitcnt lgkmcnt(2)
    s_add_u32 s31, s52, 50176
    buffer_store_dwordx4 v[44:47], v9, s[4:7], s31 offen
    s_waitcnt lgkmcnt(0)
    s_mov_b32 s31, s54
    buffer_store_dwordx4 v[48:51], v9, s[4:7], s31 offen
    v_mov_b32 v12, 0
    v_mov_b32 v13, 0
    v_dot2_f32_bf16 v12, v16, v11, v12
    v_dot2_f32_bf16 v13, v17, v11, v13
    v_dot2_f32_bf16 v12, v18, v11, v12
    v_dot2_f32_bf16 v13, v19, v11, v13
    v_dot2_f32_bf16 v12, v20, v11, v12
    v_dot2_f32_bf16 v13, v21, v11, v13
    v_dot2_f32_bf16 v12, v22, v11, v12
    v_dot2_f32_bf16 v13, v23, v11, v13
    v_dot2_f32_bf16 v12, v24, v11, v12
    v_dot2_f32_bf16 v13, v25, v11, v13
    v_dot2_f32_bf16 v12, v26, v11, v12
    v_dot2_f32_bf16 v13, v27, v11, v13
    v_dot2_f32_bf16 v12, v28, v11, v12
    v_dot2_f32_bf16 v13, v29, v11, v13
    v_dot2_f32_bf16 v12, v30, v11, v12
    v_dot2_f32_bf16 v13, v31, v11, v13
    v_dot2_f32_bf16 v12, v32, v11, v12
    v_dot2_f32_bf16 v13, v33, v11, v13
    v_dot2_f32_bf16 v12, v34, v11, v12
    v_dot2_f32_bf16 v13, v35, v11, v13
    v_dot2_f32_bf16 v12, v36, v11, v12
    v_dot2_f32_bf16 v13, v37, v11, v13
    v_dot2_f32_bf16 v12, v38, v11, v12
    v_dot2_f32_bf16 v13, v39, v11, v13
    v_dot2_f32_bf16 v12, v40, v11, v12
    v_dot2_f32_bf16 v13, v41, v11, v13
    v_dot2_f32_bf16 v12, v42, v11, v12
    v_dot2_f32_bf16 v13, v43, v11, v13
    v_dot2_f32_bf16 v12, v44, v11, v12
    v_dot2_f32_bf16 v13, v45, v11, v13
    v_dot2_f32_bf16 v12, v46, v11, v12
    v_dot2_f32_bf16 v13, v47, v11, v13
    v_dot2_f32_bf16 v12, v48, v11, v12
    v_dot2_f32_bf16 v13, v49, v11, v13
    v_dot2_f32_bf16 v12, v50, v11, v12
    v_dot2_f32_bf16 v13, v51, v11, v13
    s_nop 2
    v_add_f32 v12, v12, v13
    v_mov_b32 v13, v12
    s_nop 1
    v_permlane32_swap_b32 v12, v13
    v_add_f32 v12, v12, v13
    v_mov_b32 v13, v12
    s_nop 1
    v_permlane16_swap_b32 v12, v13
    v_add_f32 v12, v12, v13
    buffer_store_dword v12, v10, s[4:7], s55 offen
    s_endpgm
L_k0_x:
    s_mov_b32 s8, s36
    s_mov_b32 s9, s37
    s_mov_b32 s10, 0x240000
    s_mov_b32 s11, 0x20000
    s_sub_u32 s26, s2, 54
    s_mul_i32 s29, s26, 36864
    s_add_u32 s29, s29, s30
    s_add_u32 m0, s30, 0
    s_add_u32 s31, s29, 0
    buffer_load_dwordx4 v1, s[8:11], s31 offen lds
    s_add_u32 m0, s30, 1024
    s_add_u32 s31, s29, 1024
    buffer_load_dwordx4 v1, s[8:11], s31 offen lds
    s_add_u32 m0, s30, 2048
    s_add_u32 s31, s29, 2048
    buffer_load_dwordx4 v1, s[8:11], s31 offen lds
    s_add_u32 m0, s30, 3072
    s_add_u32 s31, s29, 3072
    buffer_load_dwordx4 v1, s[8:11], s31 offen lds
    s_add_u32 m0, s30, 4096
    s_add_u32 s31, s29, 4096
    buffer_load_dwordx4 v1, s[8:11], s31 offen lds
    s_add_u32 m0, s30, 5120
    s_add_u32 s31, s29, 5120
    buffer_load_dwordx4 v1, s[8:11], s31 offen lds
    s_add_u32 m0, s30, 6144
    s_add_u32 s31, s29, 6144
    buffer_load_dwordx4 v1, s[8:11], s31 offen lds
    s_add_u32 m0, s30, 7168
    s_add_u32 s31, s29, 7168
    buffer_load_dwordx4 v1, s[8:11], s31 offen lds
    s_add_u32 m0, s30, 8192
    s_add_u32 s31, s29, 8192
    buffer_load_dwordx4 v1, s[8:11], s31 offen lds
    s_lshr_b32 s32, s20, 1
    s_and_b32 s33, s20, 1
    s_mul_i32 s34, s32, 18432
    s_mul_i32 s35, s33, 576
    s_add_u32 s34, s34, s35
    v_mul_u32_u24 v7, 1152, v2
    v_add_u32 v7, s34, v7
    v_lshl_add_u32 v4, v3, 4, v7
    v_mul_u32_u24 v5, 144, v3
    v_add_u32 v5, v5, v7
    s_lshl_b32 s52, s26, 1
    s_add_u32 s52, s52, s32
    s_lshl_b32 s55, s52, 10
    s_lshl_b32 s53, s33, 3
    s_add_u32 s55, s55, s53
    s_add_u32 s55, s55, 0x2400000
    s_mul_i32 s52, s52, 18432
    s_add_u32 s52, s52, 0x0
    s_lshl_b32 s53, s33, 10
    s_add_u32 s54, s52, s53
    s_lshl_b32 s53, s33, 13
    s_add_u32 s52, s52, s53
    s_waitcnt vmcnt(0)
    s_barrier
    ds_read_b128 v[16:19], v4 offset:0
    ds_read_b128 v[20:23], v4 offset:64
    ds_read_b128 v[24:27], v4 offset:144
    ds_read_b128 v[28:31], v4 offset:208
    ds_read_b128 v[32:35], v4 offset:288
    ds_read_b128 v[36:39], v4 offset:352
    ds_read_b128 v[40:43], v4 offset:432
    ds_read_b128 v[44:47], v4 offset:496
    ds_read_b128 v[48:51], v5 offset:128
    s_waitcnt lgkmcnt(8)
    s_add_u32 s31, s52, 0
    buffer_store_dwordx4 v[16:19], v1, s[4:7], s31 offen
    s_waitcnt lgkmcnt(7)
    s_add_u32 s31, s52, 1024
    buffer_store_dwordx4 v[20:23], v1, s[4:7], s31 offen
    s_waitcnt lgkmcnt(6)
    s_add_u32 s31, s52, 2048
    buffer_store_dwordx4 v[24:27], v1, s[4:7], s31 offen
    s_waitcnt lgkmcnt(5)
    s_add_u32 s31, s52, 3072
    buffer_store_dwordx4 v[28:31], v1, s[4:7], s31 offen
    s_waitcnt lgkmcnt(4)
    s_add_u32 s31, s52, 4096
    buffer_store_dwordx4 v[32:35], v1, s[4:7], s31 offen
    s_waitcnt lgkmcnt(3)
    s_add_u32 s31, s52, 5120
    buffer_store_dwordx4 v[36:39], v1, s[4:7], s31 offen
    s_waitcnt lgkmcnt(2)
    s_add_u32 s31, s52, 6144
    buffer_store_dwordx4 v[40:43], v1, s[4:7], s31 offen
    s_waitcnt lgkmcnt(1)
    s_add_u32 s31, s52, 7168
    buffer_store_dwordx4 v[44:47], v1, s[4:7], s31 offen
    s_waitcnt lgkmcnt(0)
    s_add_u32 s31, s54, 16384
    buffer_store_dwordx4 v[48:51], v1, s[4:7], s31 offen
    v_mov_b32 v12, 0
    v_mov_b32 v13, 0
    v_dot2_f32_bf16 v12, v16, v11, v12
    v_dot2_f32_bf16 v13, v16, v16, v13
    v_dot2_f32_bf16 v12, v17, v11, v12
    v_dot2_f32_bf16 v13, v17, v17, v13
    v_dot2_f32_bf16 v12, v18, v11, v12
    v_dot2_f32_bf16 v13, v18, v18, v13
    v_dot2_f32_bf16 v12, v19, v11, v12
    v_dot2_f32_bf16 v13, v19, v19, v13
    v_dot2_f32_bf16 v12, v20, v11, v12
    v_dot2_f32_bf16 v13, v20, v20, v13
    v_dot2_f32_bf16 v12, v21, v11, v12
    v_dot2_f32_bf16 v13, v21, v21, v13
    v_dot2_f32_bf16 v12, v22, v11, v12
    v_dot2_f32_bf16 v13, v22, v22, v13
    v_dot2_f32_bf16 v12, v23, v11, v12
    v_dot2_f32_bf16 v13, v23, v23, v13
    v_dot2_f32_bf16 v12, v24, v11, v12
    v_dot2_f32_bf16 v13, v24, v24, v13
    v_dot2_f32_bf16 v12, v25, v11, v12
    v_dot2_f32_bf16 v13, v25, v25, v13
    v_dot2_f32_bf16 v12, v26, v11, v12
    v_dot2_f32_bf16 v13, v26, v26, v13
    v_dot2_f32_bf16 v12, v27, v11, v12
    v_dot2_f32_bf16 v13, v27, v27, v13
    v_dot2_f32_bf16 v12, v28, v11, v12
    v_dot2_f32_bf16 v13, v28, v28, v13
    v_dot2_f32_bf16 v12, v29, v11, v12
    v_dot2_f32_bf16 v13, v29, v29, v13
    v_dot2_f32_bf16 v12, v30, v11, v12
    v_dot2_f32_bf16 v13, v30, v30, v13
    v_dot2_f32_bf16 v12, v31, v11, v12
    v_dot2_f32_bf16 v13, v31, v31, v13
    v_dot2_f32_bf16 v12, v32, v11, v12
    v_dot2_f32_bf16 v13, v32, v32, v13
    v_dot2_f32_bf16 v12, v33, v11, v12
    v_dot2_f32_bf16 v13, v33, v33, v13
    v_dot2_f32_bf16 v12, v34, v11, v12
    v_dot2_f32_bf16 v13, v34, v34, v13
    v_dot2_f32_bf16 v12, v35, v11, v12
    v_dot2_f32_bf16 v13, v35, v35, v13
    v_dot2_f32_bf16 v12, v36, v11, v12
    v_dot2_f32_bf16 v13, v36, v36, v13
    v_dot2_f32_bf16 v12, v37, v11, v12
    v_dot2_f32_bf16 v13, v37, v37, v13
    v_dot2_f32_bf16 v12, v38, v11, v12
    v_dot2_f32_bf16 v13, v38, v38, v13
    v_dot2_f32_bf16 v12, v39, v11, v12
    v_dot2_f32_bf16 v13, v39, v39, v13
    v_dot2_f32_bf16 v12, v40, v11, v12
    v_dot2_f32_bf16 v13, v40, v40, v13
    v_dot2_f32_bf16 v12, v41, v11, v12
    v_dot2_f32_bf16 v13, v41, v41, v13
    v_dot2_f32_bf16 v12, v42, v11, v12
    v_dot2_f32_bf16 v13, v42, v42, v13
    v_dot2_f32_bf16 v12, v43, v11, v12
    v_dot2_f32_bf16 v13, v43, v43, v13
    v_dot2_f32_bf16 v12, v44, v11, v12
    v_dot2_f32_bf16 v13, v44, v44, v13
    v_dot2_f32_bf16 v12, v45, v11, v12
    v_dot2_f32_bf16 v13, v45, v45, v13
    v_dot2_f32_bf16 v12, v46, v11, v12
    v_dot2_f32_bf16 v13, v46, v46, v13
    v_dot2_f32_bf16 v12, v47, v11, v12
    v_dot2_f32_bf16 v13, v47, v47, v13
    v_dot2_f32_bf16 v12, v48, v11, v12
    v_dot2_f32_bf16 v13, v48, v48, v13
    v_dot2_f32_bf16 v12, v49, v11, v12
    v_dot2_f32_bf16 v13, v49, v49, v13
    v_dot2_f32_bf16 v12, v50, v11, v12
    v_dot2_f32_bf16 v13, v50, v50, v13
    v_dot2_f32_bf16 v12, v51, v11, v12
    v_dot2_f32_bf16 v13, v51, v51, v13
    s_nop 2
    buffer_store_dwordx2 v[12:13], v1, s[4:7], s55 offen
L_k0_end:
    s_endpgm

.globl p1l0_kernel
.p2align 8
.type p1l0_kernel,@function
p1l0_kernel:
    s_mov_b32 s22, 0
L_go_p1:
    s_cmp_ge_u32 s2, 256
    s_cbranch_scc1 L_end_p1
    s_load_dwordx2 s[24:25], s[0:1], 80
    s_load_dwordx4 s[28:31], s[0:1], 40
    s_load_dwordx2 s[26:27], s[0:1], 64
    v_lshrrev_b32 v2, 6, v0
    v_and_b32 v1, 63, v0
    v_lshlrev_b32 v1, 4, v1
    v_readfirstlane_b32 s23, v2
    v_mov_b32 v2, 163832
    v_mov_b32 v3, 0
    ds_write_b32 v2, v3
    s_mul_i32 s21, s22, 0x2800000
    s_and_b32 s20, s23, 3
    s_waitcnt lgkmcnt(0)
    s_mov_b32 s4, s24
    s_mov_b32 s5, s25
    s_mov_b32 s6, 0x10000000
    s_mov_b32 s7, 0x20000
    s_mov_b32 s8, s28
    s_mov_b32 s9, s29
    s_mov_b32 s10, 0x800000
    s_mov_b32 s11, 0x20000
    s_mov_b32 s12, s30
    s_mov_b32 s13, s31
    s_mov_b32 s14, 0x1000
    s_mov_b32 s15, 0x20000
    s_mov_b32 s16, s26
    s_mov_b32 s17, s27
    s_mov_b32 s18, 0x240000
    s_mov_b32 s19, 0x20000
    s_cmp_ge_u32 s23, 4
    s_cbranch_scc1 L_ld_p1
    s_and_b32 s25, s2, 7
    s_lshr_b32 s26, s2, 3
    s_lshl_b32 s23, s25, 1
    s_lshr_b32 s27, s26, 4
    s_add_u32 s23, s23, s27
    s_and_b32 s24, s26, 15
    s_lshl_b32 s30, s23, 3
    s_lshl_b32 s31, s20, 1
    s_add_u32 s31, s30, s31
    s_mul_i32 s29, s31, 18432
    s_add_u32 s29, s29, s21
    s_add_u32 s35, s29, 0x600000
    s_add_u32 s29, s29, 0x0
    s_max_u32 s30, s30, 1
    s_sub_u32 s30, s30, 1
    s_lshl_b32 s30, s30, 10
    s_add_u32 s30, s30, s21
    s_add_u32 s30, s30, 0x2400000
    s_lshl_b32 s32, s31, 10
    s_add_u32 s32, s32, s21
    s_add_u32 s32, s32, 0x2400000
    v_and_b32 v2, 15, v0
    v_bfe_u32 v3, v0, 4, 2
    s_add_u32 s33, s20, 2
    s_add_u32 s34, s20, 4
    s_cmp_ge_u32 s20, 2
    s_cselect_b32 s33, 6, s33
    s_cselect_b32 s34, 6, s34
    s_lshl_b32 s36, s33, 10
    s_lshl_b32 s37, s34, 10
    v_mov_b32 v246, v1
    v_add_u32 v247, 64512, v1
    v_add_u32 v248, 131072, v1
    v_add_u32 v249, s36, v1
    v_add_u32 v250, s36, v247
    v_add_u32 v251, s37, v1
    v_add_u32 v252, s37, v247
    v_add_u32 v253, 18432, v1
    v_mov_b32 v16, 0
    v_mov_b32 v17, 0
    v_mov_b32 v18, 0
    v_mov_b32 v19, 0
    v_mov_b32 v20, 0
    v_mov_b32 v21, 0
    v_mov_b32 v22, 0
    v_mov_b32 v23, 0
    v_mov_b32 v24, 0
    v_mov_b32 v25, 0
    v_mov_b32 v26, 0
    v_mov_b32 v27, 0
    v_mov_b32 v28, 0
    v_mov_b32 v29, 0
    v_mov_b32 v30, 0
    v_mov_b32 v31, 0
    v_mov_b32 v32, 0
    v_mov_b32 v33, 0
    v_mov_b32 v34, 0
    v_mov_b32 v35, 0
    v_mov_b32 v36, 0
    v_mov_b32 v37, 0
    v_mov_b32 v38, 0
    v_mov_b32 v39, 0
    v_mov_b32 v40, 0
    v_mov_b32 v41, 0
    v_mov_b32 v42, 0
    v_mov_b32 v43, 0
    v_mov_b32 v44, 0
    v_mov_b32 v45, 0
    v_mov_b32 v46, 0
    v_mov_b32 v47, 0
    v_mov_b32 v48, 0
    v_mov_b32 v49, 0
    v_mov_b32 v50, 0
    v_mov_b32 v51, 0
    v_mov_b32 v52, 0
    v_mov_b32 v53, 0
    v_mov_b32 v54, 0
    v_mov_b32 v55, 0
    v_mov_b32 v56, 0
    v_mov_b32 v57, 0
    v_mov_b32 v58, 0
    v_mov_b32 v59, 0
    v_mov_b32 v60, 0
    v_mov_b32 v61, 0
    v_mov_b32 v62, 0
    v_mov_b32 v63, 0
    v_mov_b32 v64, 0
    v_mov_b32 v65, 0
    v_mov_b32 v66, 0
    v_mov_b32 v67, 0
    v_mov_b32 v68, 0
    v_mov_b32 v69, 0
    v_mov_b32 v70, 0
    v_mov_b32 v71, 0
    v_mov_b32 v72, 0
    v_mov_b32 v73, 0
    v_mov_b32 v74, 0
    v_mov_b32 v75, 0
    v_mov_b32 v76, 0
    v_mov_b32 v77, 0
    v_mov_b32 v78, 0
    v_mov_b32 v79, 0
    v_mov_b32 v80, 0
    v_mov_b32 v81, 0
    v_mov_b32 v82, 0
    v_mov_b32 v83, 0
    v_mov_b32 v84, 0
    v_mov_b32 v85, 0
    v_mov_b32 v86, 0
    v_mov_b32 v87, 0
    s_add_u32 s38, s29, 0
    s_add_u32 s39, s29, 4096
    s_add_u32 s40, s29, 8192
    s_add_u32 s41, s29, 12288
    s_add_u32 s42, s29, 16384
    buffer_load_dwordx4 v[168:171], v1, s[4:7], s38 offen offset:0
    buffer_load_dwordx4 v[172:175], v253, s[4:7], s38 offen offset:0
    buffer_load_dwordx4 v[4:7], v1, s[4:7], s30 offen
    buffer_load_dwordx4 v[8:11], v1, s[4:7], s32 offen offset:0
    buffer_load_dwordx4 v[12:15], v1, s[4:7], s32 offen offset:1024
    buffer_load_dwordx4 v[176:179], v1, s[4:7], s38 offen offset:1024
    buffer_load_dwordx4 v[180:183], v253, s[4:7], s38 offen offset:1024
    buffer_load_dwordx4 v[184:187], v1, s[4:7], s38 offen offset:2048
    buffer_load_dwordx4 v[188:191], v253, s[4:7], s38 offen offset:2048
    buffer_load_dwordx4 v[192:195], v1, s[4:7], s38 offen offset:3072
    buffer_load_dwordx4 v[196:199], v253, s[4:7], s38 offen offset:3072
    buffer_load_dwordx4 v[200:203], v1, s[4:7], s39 offen offset:0
    buffer_load_dwordx4 v[204:207], v253, s[4:7], s39 offen offset:0
    s_barrier
    ds_read_b128 v[88:91], v246 offset:0
    ds_read_b128 v[92:95], v246 offset:1024
    ds_read_b128 v[96:99], v246 offset:2048
    ds_read_b128 v[100:103], v246 offset:3072
    ds_read_b128 v[104:107], v246 offset:4096
    ds_read_b128 v[108:111], v246 offset:5120
    ds_read_b128 v[112:115], v246 offset:6144
    ds_read_b128 v[116:119], v248 offset:0
    ds_read_b128 v[120:123], v249 offset:0
    ds_read_b128 v[124:127], v251 offset:0
    s_waitcnt vmcnt(11) lgkmcnt(6)
    v_mfma_f32_16x16x32_bf16 v[16:19], v[88:91], v[168:171], v[16:19]
    ds_read_b128 v[128:131], v246 offset:7168
    v_mfma_f32_16x16x32_bf16 v[48:51], v[88:91], v[172:175], v[48:51]
    ds_read_b128 v[132:135], v246 offset:8192
    v_mfma_f32_16x16x32_bf16 v[20:23], v[92:95], v[168:171], v[20:23]
    ds_read_b128 v[136:139], v246 offset:9216
    v_mfma_f32_16x16x32_bf16 v[52:55], v[92:95], v[172:175], v[52:55]
    ds_read_b128 v[140:143], v246 offset:10240
    v_mfma_f32_16x16x32_bf16 v[24:27], v[96:99], v[168:171], v[24:27]
    ds_read_b128 v[144:147], v246 offset:11264
    v_mfma_f32_16x16x32_bf16 v[56:59], v[96:99], v[172:175], v[56:59]
    ds_read_b128 v[148:151], v246 offset:12288
    v_mfma_f32_16x16x32_bf16 v[28:31], v[100:103], v[168:171], v[28:31]
    ds_read_b128 v[152:155], v246 offset:13312
    v_mfma_f32_16x16x32_bf16 v[60:63], v[100:103], v[172:175], v[60:63]
    ds_read_b128 v[156:159], v248 offset:1024
    s_waitcnt lgkmcnt(8)
    v_mfma_f32_16x16x32_bf16 v[36:39], v[168:171], v[104:107], v[36:39]
    ds_read_b128 v[160:163], v249 offset:7168
    v_mfma_f32_16x16x32_bf16 v[68:71], v[172:175], v[104:107], v[68:71]
    ds_read_b128 v[164:167], v251 offset:7168
    v_mfma_f32_16x16x32_bf16 v[40:43], v[168:171], v[108:111], v[40:43]
    buffer_load_dwordx4 v[208:211], v1, s[4:7], s39 offen offset:1024
    v_mfma_f32_16x16x32_bf16 v[72:75], v[172:175], v[108:111], v[72:75]
    v_mfma_f32_16x16x32_bf16 v[32:35], v[112:115], v[168:171], v[32:35]
    buffer_load_dwordx4 v[212:215], v253, s[4:7], s39 offen offset:1024
    v_mfma_f32_16x16x32_bf16 v[64:67], v[112:115], v[172:175], v[64:67]
    v_mfma_f32_16x16x32_bf16 v[44:47], v[168:171], v[112:115], v[44:47]
    buffer_load_dwordx4 v[216:219], v1, s[4:7], s39 offen offset:2048
    v_mfma_f32_16x16x32_bf16 v[76:79], v[172:175], v[112:115], v[76:79]
    v_mfma_f32_16x16x32_bf16 v[80:83], v[120:123], v[116:119], v[80:83]
    buffer_load_dwordx4 v[220:223], v253, s[4:7], s39 offen offset:2048
    v_mfma_f32_16x16x32_bf16 v[84:87], v[116:119], v[124:127], v[84:87]
    s_waitcnt vmcnt(10) lgkmcnt(6)
    s_barrier
    v_mfma_f32_16x16x32_bf16 v[16:19], v[128:131], v[176:179], v[16:19]
    ds_read_b128 v[88:91], v246 offset:14336
    v_mfma_f32_16x16x32_bf16 v[48:51], v[128:131], v[180:183], v[48:51]
    ds_read_b128 v[92:95], v246 offset:15360
    v_mfma_f32_16x16x32_bf16 v[20:23], v[132:135], v[176:179], v[20:23]
    ds_read_b128 v[96:99], v246 offset:16384
    v_mfma_f32_16x16x32_bf16 v[52:55], v[132:135], v[180:183], v[52:55]
    ds_read_b128 v[100:103], v246 offset:17408
    v_mfma_f32_16x16x32_bf16 v[24:27], v[136:139], v[176:179], v[24:27]
    ds_read_b128 v[104:107], v246 offset:18432
    v_mfma_f32_16x16x32_bf16 v[56:59], v[136:139], v[180:183], v[56:59]
    ds_read_b128 v[108:111], v246 offset:19456
    v_mfma_f32_16x16x32_bf16 v[28:31], v[140:143], v[176:179], v[28:31]
    ds_read_b128 v[112:115], v246 offset:20480
    v_mfma_f32_16x16x32_bf16 v[60:63], v[140:143], v[180:183], v[60:63]
    ds_read_b128 v[116:119], v248 offset:2048
    s_waitcnt lgkmcnt(8)
    v_mfma_f32_16x16x32_bf16 v[36:39], v[176:179], v[144:147], v[36:39]
    ds_read_b128 v[120:123], v249 offset:14336
    v_mfma_f32_16x16x32_bf16 v[68:71], v[180:183], v[144:147], v[68:71]
    ds_read_b128 v[124:127], v251 offset:14336
    v_mfma_f32_16x16x32_bf16 v[40:43], v[176:179], v[148:151], v[40:43]
    buffer_load_dwordx4 v[224:227], v1, s[4:7], s39 offen offset:3072
    v_add_f32 v240, v4, v6
    v_mfma_f32_16x16x32_bf16 v[72:75], v[180:183], v[148:151], v[72:75]
    v_add_f32 v241, v5, v7
    v_mfma_f32_16x16x32_bf16 v[32:35], v[152:155], v[176:179], v[32:35]
    buffer_load_dwordx4 v[228:231], v253, s[4:7], s39 offen offset:3072
    v_add_f32 v242, v8, v10
    v_mfma_f32_16x16x32_bf16 v[64:67], v[152:155], v[180:183], v[64:67]
    v_add_f32 v243, v9, v11
    v_mfma_f32_16x16x32_bf16 v[44:47], v[176:179], v[152:155], v[44:47]
    buffer_load_dwordx4 v[232:235], v1, s[4:7], s40 offen offset:0
    v_add_f32 v244, v12, v14
    v_mfma_f32_16x16x32_bf16 v[76:79], v[180:183], v[152:155], v[76:79]
    v_add_f32 v245, v13, v15
    v_mfma_f32_16x16x32_bf16 v[80:83], v[160:163], v[156:159], v[80:83]
    buffer_load_dwordx4 v[236:239], v253, s[4:7], s40 offen offset:0
    v_mov_b32 v4, v240
    v_mfma_f32_16x16x32_bf16 v[84:87], v[156:159], v[164:167], v[84:87]
    v_mov_b32 v5, v241
    s_waitcnt vmcnt(12) lgkmcnt(6)
    v_mfma_f32_16x16x32_bf16 v[16:19], v[88:91], v[184:187], v[16:19]
    ds_read_b128 v[128:131], v246 offset:21504
    v_mfma_f32_16x16x32_bf16 v[48:51], v[88:91], v[188:191], v[48:51]
    ds_read_b128 v[132:135], v246 offset:22528
    v_mfma_f32_16x16x32_bf16 v[20:23], v[92:95], v[184:187], v[20:23]
    ds_read_b128 v[136:139], v246 offset:23552
    v_mfma_f32_16x16x32_bf16 v[52:55], v[92:95], v[188:191], v[52:55]
    ds_read_b128 v[140:143], v246 offset:24576
    v_mfma_f32_16x16x32_bf16 v[24:27], v[96:99], v[184:187], v[24:27]
    ds_read_b128 v[144:147], v246 offset:25600
    v_mfma_f32_16x16x32_bf16 v[56:59], v[96:99], v[188:191], v[56:59]
    ds_read_b128 v[148:151], v246 offset:26624
    v_mfma_f32_16x16x32_bf16 v[28:31], v[100:103], v[184:187], v[28:31]
    ds_read_b128 v[152:155], v246 offset:27648
    v_mfma_f32_16x16x32_bf16 v[60:63], v[100:103], v[188:191], v[60:63]
    ds_read_b128 v[156:159], v248 offset:3072
    s_waitcnt lgkmcnt(8)
    v_mfma_f32_16x16x32_bf16 v[36:39], v[184:187], v[104:107], v[36:39]
    ds_read_b128 v[160:163], v249 offset:21504
    v_mfma_f32_16x16x32_bf16 v[68:71], v[188:191], v[104:107], v[68:71]
    ds_read_b128 v[164:167], v251 offset:21504
    v_mfma_f32_16x16x32_bf16 v[40:43], v[184:187], v[108:111], v[40:43]
    buffer_load_dwordx4 v[168:171], v1, s[4:7], s40 offen offset:1024
    v_mov_b32 v8, v242
    v_mfma_f32_16x16x32_bf16 v[72:75], v[188:191], v[108:111], v[72:75]
    v_mov_b32 v9, v243
    v_mfma_f32_16x16x32_bf16 v[32:35], v[112:115], v[184:187], v[32:35]
    buffer_load_dwordx4 v[172:175], v253, s[4:7], s40 offen offset:1024
    v_mov_b32 v12, v244
    v_mfma_f32_16x16x32_bf16 v[64:67], v[112:115], v[188:191], v[64:67]
    v_mov_b32 v13, v245
    v_mfma_f32_16x16x32_bf16 v[44:47], v[184:187], v[112:115], v[44:47]
    buffer_load_dwordx4 v[176:179], v1, s[4:7], s40 offen offset:2048
    v_permlane32_swap_b32 v240, v4
    v_mfma_f32_16x16x32_bf16 v[76:79], v[188:191], v[112:115], v[76:79]
    v_permlane32_swap_b32 v241, v5
    v_mfma_f32_16x16x32_bf16 v[80:83], v[120:123], v[116:119], v[80:83]
    buffer_load_dwordx4 v[180:183], v253, s[4:7], s40 offen offset:2048
    v_permlane32_swap_b32 v242, v8
    v_mfma_f32_16x16x32_bf16 v[84:87], v[116:119], v[124:127], v[84:87]
    v_permlane32_swap_b32 v243, v9
    s_waitcnt vmcnt(14) lgkmcnt(6)
    s_barrier
    v_mfma_f32_16x16x32_bf16 v[16:19], v[128:131], v[192:195], v[16:19]
    ds_read_b128 v[88:91], v246 offset:28672
    v_mfma_f32_16x16x32_bf16 v[48:51], v[128:131], v[196:199], v[48:51]
    ds_read_b128 v[92:95], v246 offset:29696
    v_mfma_f32_16x16x32_bf16 v[20:23], v[132:135], v[192:195], v[20:23]
    ds_read_b128 v[96:99], v246 offset:30720
    v_mfma_f32_16x16x32_bf16 v[52:55], v[132:135], v[196:199], v[52:55]
    ds_read_b128 v[100:103], v246 offset:31744
    v_mfma_f32_16x16x32_bf16 v[24:27], v[136:139], v[192:195], v[24:27]
    ds_read_b128 v[104:107], v246 offset:32768
    v_mfma_f32_16x16x32_bf16 v[56:59], v[136:139], v[196:199], v[56:59]
    ds_read_b128 v[108:111], v246 offset:33792
    v_mfma_f32_16x16x32_bf16 v[28:31], v[140:143], v[192:195], v[28:31]
    ds_read_b128 v[112:115], v246 offset:34816
    v_mfma_f32_16x16x32_bf16 v[60:63], v[140:143], v[196:199], v[60:63]
    ds_read_b128 v[116:119], v248 offset:4096
    s_waitcnt lgkmcnt(8)
    v_mfma_f32_16x16x32_bf16 v[36:39], v[192:195], v[144:147], v[36:39]
    ds_read_b128 v[120:123], v249 offset:28672
    v_mfma_f32_16x16x32_bf16 v[68:71], v[196:199], v[144:147], v[68:71]
    ds_read_b128 v[124:127], v251 offset:28672
    v_mfma_f32_16x16x32_bf16 v[40:43], v[192:195], v[148:151], v[40:43]
    buffer_load_dwordx4 v[184:187], v1, s[4:7], s40 offen offset:3072
    v_permlane32_swap_b32 v244, v12
    v_mfma_f32_16x16x32_bf16 v[72:75], v[196:199], v[148:151], v[72:75]
    v_permlane32_swap_b32 v245, v13
    v_mfma_f32_16x16x32_bf16 v[32:35], v[152:155], v[192:195], v[32:35]
    buffer_load_dwordx4 v[188:191], v253, s[4:7], s40 offen offset:3072
    v_add_f32 v240, v240, v4
    v_mfma_f32_16x16x32_bf16 v[64:67], v[152:155], v[196:199], v[64:67]
    v_add_f32 v241, v241, v5
    v_mfma_f32_16x16x32_bf16 v[44:47], v[192:195], v[152:155], v[44:47]
    v_add_f32 v242, v242, v8
    v_mfma_f32_16x16x32_bf16 v[76:79], v[196:199], v[152:155], v[76:79]
    v_add_f32 v243, v243, v9
    v_mfma_f32_16x16x32_bf16 v[80:83], v[160:163], v[156:159], v[80:83]
    v_add_f32 v244, v244, v12
    v_mfma_f32_16x16x32_bf16 v[84:87], v[156:159], v[164:167], v[84:87]
    v_add_f32 v245, v245, v13
    s_waitcnt vmcnt(14) lgkmcnt(6)
    v_mfma_f32_16x16x32_bf16 v[16:19], v[88:91], v[200:203], v[16:19]
    ds_read_b128 v[128:131], v246 offset:35840
    v_mfma_f32_16x16x32_bf16 v[48:51], v[88:91], v[204:207], v[48:51]
    ds_read_b128 v[132:135], v246 offset:36864
    v_mfma_f32_16x16x32_bf16 v[20:23], v[92:95], v[200:203], v[20:23]
    ds_read_b128 v[136:139], v246 offset:37888
    v_mfma_f32_16x16x32_bf16 v[52:55], v[92:95], v[204:207], v[52:55]
    ds_read_b128 v[140:143], v246 offset:38912
    v_mfma_f32_16x16x32_bf16 v[24:27], v[96:99], v[200:203], v[24:27]
    ds_read_b128 v[144:147], v246 offset:39936
    v_mfma_f32_16x16x32_bf16 v[56:59], v[96:99], v[204:207], v[56:59]
    ds_read_b128 v[148:151], v246 offset:40960
    v_mfma_f32_16x16x32_bf16 v[28:31], v[100:103], v[200:203], v[28:31]
    ds_read_b128 v[152:155], v246 offset:41984
    v_mfma_f32_16x16x32_bf16 v[60:63], v[100:103], v[204:207], v[60:63]
    ds_read_b128 v[156:159], v248 offset:5120
    s_waitcnt lgkmcnt(8)
    v_mfma_f32_16x16x32_bf16 v[36:39], v[200:203], v[104:107], v[36:39]
    ds_read_b128 v[160:163], v249 offset:35840
    v_mfma_f32_16x16x32_bf16 v[68:71], v[204:207], v[104:107], v[68:71]
    ds_read_b128 v[164:167], v251 offset:35840
    v_mfma_f32_16x16x32_bf16 v[40:43], v[200:203], v[108:111], v[40:43]
    buffer_load_dwordx4 v[192:195], v1, s[4:7], s41 offen offset:0
    v_mov_b32 v4, v240
    v_mfma_f32_16x16x32_bf16 v[72:75], v[204:207], v[108:111], v[72:75]
    v_mov_b32 v5, v241
    v_mfma_f32_16x16x32_bf16 v[32:35], v[112:115], v[200:203], v[32:35]
    buffer_load_dwordx4 v[196:199], v253, s[4:7], s41 offen offset:0
    v_mov_b32 v8, v242
    v_mfma_f32_16x16x32_bf16 v[64:67], v[112:115], v[204:207], v[64:67]
    v_mov_b32 v9, v243
    v_mfma_f32_16x16x32_bf16 v[44:47], v[200:203], v[112:115], v[44:47]
    v_mov_b32 v12, v244
    v_mfma_f32_16x16x32_bf16 v[76:79], v[204:207], v[112:115], v[76:79]
    v_mov_b32 v13, v245
    v_mfma_f32_16x16x32_bf16 v[80:83], v[120:123], v[116:119], v[80:83]
    v_permlane16_swap_b32 v240, v4
    v_mfma_f32_16x16x32_bf16 v[84:87], v[116:119], v[124:127], v[84:87]
    v_permlane16_swap_b32 v241, v5
    s_waitcnt vmcnt(14) lgkmcnt(6)
    s_barrier
    v_mfma_f32_16x16x32_bf16 v[16:19], v[128:131], v[208:211], v[16:19]
    ds_read_b128 v[88:91], v246 offset:43008
    v_mfma_f32_16x16x32_bf16 v[48:51], v[128:131], v[212:215], v[48:51]
    ds_read_b128 v[92:95], v246 offset:44032
    v_mfma_f32_16x16x32_bf16 v[20:23], v[132:135], v[208:211], v[20:23]
    ds_read_b128 v[96:99], v246 offset:45056
    v_mfma_f32_16x16x32_bf16 v[52:55], v[132:135], v[212:215], v[52:55]
    ds_read_b128 v[100:103], v246 offset:46080
    v_mfma_f32_16x16x32_bf16 v[24:27], v[136:139], v[208:211], v[24:27]
    ds_read_b128 v[104:107], v246 offset:47104
    v_mfma_f32_16x16x32_bf16 v[56:59], v[136:139], v[212:215], v[56:59]
    ds_read_b128 v[108:111], v246 offset:48128
    v_mfma_f32_16x16x32_bf16 v[28:31], v[140:143], v[208:211], v[28:31]
    ds_read_b128 v[112:115], v246 offset:49152
    v_mfma_f32_16x16x32_bf16 v[60:63], v[140:143], v[212:215], v[60:63]
    ds_read_b128 v[116:119], v248 offset:6144
    s_waitcnt lgkmcnt(8)
    v_mfma_f32_16x16x32_bf16 v[36:39], v[208:211], v[144:147], v[36:39]
    ds_read_b128 v[120:123], v249 offset:43008
    v_mfma_f32_16x16x32_bf16 v[68:71], v[212:215], v[144:147], v[68:71]
    ds_read_b128 v[124:127], v251 offset:43008
    v_mfma_f32_16x16x32_bf16 v[40:43], v[208:211], v[148:151], v[40:43]
    buffer_load_dwordx4 v[200:203], v1, s[4:7], s41 offen offset:1024
    v_permlane16_swap_b32 v242, v8
    v_mfma_f32_16x16x32_bf16 v[72:75], v[212:215], v[148:151], v[72:75]
    v_permlane16_swap_b32 v243, v9
    v_mfma_f32_16x16x32_bf16 v[32:35], v[152:155], v[208:211], v[32:35]
    buffer_load_dwordx4 v[204:207], v253, s[4:7], s41 offen offset:1024
    v_permlane16_swap_b32 v244, v12
    v_mfma_f32_16x16x32_bf16 v[64:67], v[152:155], v[212:215], v[64:67]
    v_permlane16_swap_b32 v245, v13
    v_mfma_f32_16x16x32_bf16 v[44:47], v[208:211], v[152:155], v[44:47]
    v_add_f32 v240, v240, v4
    v_mfma_f32_16x16x32_bf16 v[76:79], v[212:215], v[152:155], v[76:79]
    v_add_f32 v241, v241, v5
    v_mfma_f32_16x16x32_bf16 v[80:83], v[160:163], v[156:159], v[80:83]
    v_add_f32 v242, v242, v8
    v_mfma_f32_16x16x32_bf16 v[84:87], v[156:159], v[164:167], v[84:87]
    v_add_f32 v243, v243, v9
    s_waitcnt vmcnt(14) lgkmcnt(6)
    v_mfma_f32_16x16x32_bf16 v[16:19], v[88:91], v[216:219], v[16:19]
    ds_read_b128 v[128:131], v246 offset:50176
    v_mfma_f32_16x16x32_bf16 v[48:51], v[88:91], v[220:223], v[48:51]
    ds_read_b128 v[132:135], v246 offset:51200
    v_mfma_f32_16x16x32_bf16 v[20:23], v[92:95], v[216:219], v[20:23]
    ds_read_b128 v[136:139], v246 offset:52224
    v_mfma_f32_16x16x32_bf16 v[52:55], v[92:95], v[220:223], v[52:55]
    ds_read_b128 v[140:143], v246 offset:53248
    v_mfma_f32_16x16x32_bf16 v[24:27], v[96:99], v[216:219], v[24:27]
    ds_read_b128 v[144:147], v246 offset:54272
    v_mfma_f32_16x16x32_bf16 v[56:59], v[96:99], v[220:223], v[56:59]
    ds_read_b128 v[148:151], v246 offset:55296
    v_mfma_f32_16x16x32_bf16 v[28:31], v[100:103], v[216:219], v[28:31]
    ds_read_b128 v[152:155], v246 offset:56320
    v_mfma_f32_16x16x32_bf16 v[60:63], v[100:103], v[220:223], v[60:63]
    ds_read_b128 v[156:159], v248 offset:7168
    s_waitcnt lgkmcnt(8)
    v_mfma_f32_16x16x32_bf16 v[36:39], v[216:219], v[104:107], v[36:39]
    ds_read_b128 v[160:163], v249 offset:50176
    v_mfma_f32_16x16x32_bf16 v[68:71], v[220:223], v[104:107], v[68:71]
    ds_read_b128 v[164:167], v251 offset:50176
    v_mfma_f32_16x16x32_bf16 v[40:43], v[216:219], v[108:111], v[40:43]
    buffer_load_dwordx4 v[208:211], v1, s[4:7], s41 offen offset:2048
    v_add_f32 v244, v244, v12
    v_mfma_f32_16x16x32_bf16 v[72:75], v[220:223], v[108:111], v[72:75]
    v_add_f32 v245, v245, v13
    v_mfma_f32_16x16x32_bf16 v[32:35], v[112:115], v[216:219], v[32:35]
    buffer_load_dwordx4 v[212:215], v253, s[4:7], s41 offen offset:2048
    v_mul_f32 v240, 0x3ae38e39, v240
    v_mfma_f32_16x16x32_bf16 v[64:67], v[112:115], v[220:223], v[64:67]
    v_mul_f32 v241, 0x3ae38e39, v241
    v_mfma_f32_16x16x32_bf16 v[44:47], v[216:219], v[112:115], v[44:47]
    v_mul_f32 v242, 0x3ae38e39, v242
    v_mfma_f32_16x16x32_bf16 v[76:79], v[220:223], v[112:115], v[76:79]
    v_mul_f32 v243, 0x3ae38e39, v243
    v_mfma_f32_16x16x32_bf16 v[80:83], v[120:123], v[116:119], v[80:83]
    v_mul_f32 v244, 0x3ae38e39, v244
    v_mfma_f32_16x16x32_bf16 v[84:87], v[116:119], v[124:127], v[84:87]
    v_mul_f32 v245, 0x3ae38e39, v245
    s_waitcnt vmcnt(14) lgkmcnt(6)
    v_mfma_f32_16x16x32_bf16 v[16:19], v[128:131], v[224:227], v[16:19]
    ds_read_b128 v[88:91], v246 offset:57344
    v_mfma_f32_16x16x32_bf16 v[48:51], v[128:131], v[228:231], v[48:51]
    ds_read_b128 v[92:95], v246 offset:58368
    v_mfma_f32_16x16x32_bf16 v[20:23], v[132:135], v[224:227], v[20:23]
    ds_read_b128 v[96:99], v246 offset:59392
    v_mfma_f32_16x16x32_bf16 v[52:55], v[132:135], v[228:231], v[52:55]
    ds_read_b128 v[100:103], v246 offset:60416
    v_mfma_f32_16x16x32_bf16 v[24:27], v[136:139], v[224:227], v[24:27]
    ds_read_b128 v[104:107], v246 offset:61440
    v_mfma_f32_16x16x32_bf16 v[56:59], v[136:139], v[228:231], v[56:59]
    ds_read_b128 v[108:111], v246 offset:62464
    v_mfma_f32_16x16x32_bf16 v[28:31], v[140:143], v[224:227], v[28:31]
    ds_read_b128 v[112:115], v246 offset:63488
    v_mfma_f32_16x16x32_bf16 v[60:63], v[140:143], v[228:231], v[60:63]
    ds_read_b128 v[116:119], v248 offset:8192
    s_waitcnt lgkmcnt(8)
    v_mfma_f32_16x16x32_bf16 v[36:39], v[224:227], v[144:147], v[36:39]
    ds_read_b128 v[120:123], v249 offset:57344
    v_mfma_f32_16x16x32_bf16 v[68:71], v[228:231], v[144:147], v[68:71]
    ds_read_b128 v[124:127], v251 offset:57344
    v_mfma_f32_16x16x32_bf16 v[40:43], v[224:227], v[148:151], v[40:43]
    buffer_load_dwordx4 v[216:219], v1, s[4:7], s41 offen offset:3072
    v_fma_f32 v241, -v240, v240, v241
    v_mfma_f32_16x16x32_bf16 v[72:75], v[228:231], v[148:151], v[72:75]
    v_fma_f32 v243, -v242, v242, v243
    v_mfma_f32_16x16x32_bf16 v[32:35], v[152:155], v[224:227], v[32:35]
    buffer_load_dwordx4 v[220:223], v253, s[4:7], s41 offen offset:3072
    v_fma_f32 v245, -v244, v244, v245
    v_mfma_f32_16x16x32_bf16 v[64:67], v[152:155], v[228:231], v[64:67]
    v_max_f32 v241, 0, v241
    v_mfma_f32_16x16x32_bf16 v[44:47], v[224:227], v[152:155], v[44:47]
    v_max_f32 v243, 0, v243
    v_mfma_f32_16x16x32_bf16 v[76:79], v[228:231], v[152:155], v[76:79]
    v_max_f32 v245, 0, v245
    v_mfma_f32_16x16x32_bf16 v[80:83], v[160:163], v[156:159], v[80:83]
    v_add_f32 v241, 0x3727c5ac, v241
    v_mfma_f32_16x16x32_bf16 v[84:87], v[156:159], v[164:167], v[84:87]
    v_add_f32 v243, 0x3727c5ac, v243
    s_waitcnt vmcnt(14) lgkmcnt(6)
    s_barrier
    v_mfma_f32_16x16x32_bf16 v[16:19], v[88:91], v[232:235], v[16:19]
    ds_read_b128 v[128:131], v247 offset:0
    v_mfma_f32_16x16x32_bf16 v[48:51], v[88:91], v[236:239], v[48:51]
    ds_read_b128 v[132:135], v247 offset:1024
    v_mfma_f32_16x16x32_bf16 v[20:23], v[92:95], v[232:235], v[20:23]
    ds_read_b128 v[136:139], v247 offset:2048
    v_mfma_f32_16x16x32_bf16 v[52:55], v[92:95], v[236:239], v[52:55]
    ds_read_b128 v[140:143], v247 offset:3072
    v_mfma_f32_16x16x32_bf16 v[24:27], v[96:99], v[232:235], v[24:27]
    ds_read_b128 v[144:147], v247 offset:4096
    v_mfma_f32_16x16x32_bf16 v[56:59], v[96:99], v[236:239], v[56:59]
    ds_read_b128 v[148:151], v247 offset:5120
    v_mfma_f32_16x16x32_bf16 v[28:31], v[100:103], v[232:235], v[28:31]
    ds_read_b128 v[152:155], v247 offset:6144
    v_mfma_f32_16x16x32_bf16 v[60:63], v[100:103], v[236:239], v[60:63]
    ds_read_b128 v[156:159], v248 offset:9216
    s_waitcnt lgkmcnt(8)
    v_mfma_f32_16x16x32_bf16 v[36:39], v[232:235], v[104:107], v[36:39]
    ds_read_b128 v[160:163], v250 offset:0
    v_mfma_f32_16x16x32_bf16 v[68:71], v[236:239], v[104:107], v[68:71]
    ds_read_b128 v[164:167], v252 offset:0
    v_mfma_f32_16x16x32_bf16 v[40:43], v[232:235], v[108:111], v[40:43]
    buffer_load_dwordx4 v[224:227], v1, s[4:7], s42 offen offset:0
    v_add_f32 v245, 0x3727c5ac, v245
    v_mfma_f32_16x16x32_bf16 v[72:75], v[236:239], v[108:111], v[72:75]
    v_rsq_f32 v241, v241
    v_mfma_f32_16x16x32_bf16 v[32:35], v[112:115], v[232:235], v[32:35]
    buffer_load_dwordx4 v[228:231], v253, s[4:7], s42 offen offset:0
    v_rsq_f32 v243, v243
    v_mfma_f32_16x16x32_bf16 v[64:67], v[112:115], v[236:239], v[64:67]
    v_rsq_f32 v245, v245
    v_mfma_f32_16x16x32_bf16 v[44:47], v[232:235], v[112:115], v[44:47]
    s_nop 0
    v_mfma_f32_16x16x32_bf16 v[76:79], v[236:239], v[112:115], v[76:79]
    v_mfma_f32_16x16x32_bf16 v[80:83], v[120:123], v[116:119], v[80:83]
    v_mfma_f32_16x16x32_bf16 v[84:87], v[116:119], v[124:127], v[84:87]
    s_waitcnt vmcnt(14) lgkmcnt(6)
    v_mfma_f32_16x16x32_bf16 v[16:19], v[128:131], v[168:171], v[16:19]
    ds_read_b128 v[88:91], v247 offset:7168
    v_mfma_f32_16x16x32_bf16 v[48:51], v[128:131], v[172:175], v[48:51]
    ds_read_b128 v[92:95], v247 offset:8192
    v_mfma_f32_16x16x32_bf16 v[20:23], v[132:135], v[168:171], v[20:23]
    ds_read_b128 v[96:99], v247 offset:9216
    v_mfma_f32_16x16x32_bf16 v[52:55], v[132:135], v[172:175], v[52:55]
    ds_read_b128 v[100:103], v247 offset:10240
    v_mfma_f32_16x16x32_bf16 v[24:27], v[136:139], v[168:171], v[24:27]
    ds_read_b128 v[104:107], v247 offset:11264
    v_mfma_f32_16x16x32_bf16 v[56:59], v[136:139], v[172:175], v[56:59]
    ds_read_b128 v[108:111], v247 offset:12288
    v_mfma_f32_16x16x32_bf16 v[28:31], v[140:143], v[168:171], v[28:31]
    ds_read_b128 v[112:115], v247 offset:13312
    v_mfma_f32_16x16x32_bf16 v[60:63], v[140:143], v[172:175], v[60:63]
    ds_read_b128 v[116:119], v248 offset:10240
    s_waitcnt lgkmcnt(8)
    v_mfma_f32_16x16x32_bf16 v[36:39], v[168:171], v[144:147], v[36:39]
    ds_read_b128 v[120:123], v250 offset:7168
    v_mfma_f32_16x16x32_bf16 v[68:71], v[172:175], v[144:147], v[68:71]
    ds_read_b128 v[124:127], v252 offset:7168
    v_mfma_f32_16x16x32_bf16 v[40:43], v[168:171], v[148:151], v[40:43]
    buffer_load_dwordx4 v[232:235], v1, s[4:7], s42 offen offset:1024
    v_mfma_f32_16x16x32_bf16 v[72:75], v[172:175], v[148:151], v[72:75]
    v_mfma_f32_16x16x32_bf16 v[32:35], v[152:155], v[168:171], v[32:35]
    buffer_load_dwordx4 v[236:239], v253, s[4:7], s42 offen offset:1024
    v_mfma_f32_16x16x32_bf16 v[64:67], v[152:155], v[172:175], v[64:67]
    v_mfma_f32_16x16x32_bf16 v[44:47], v[168:171], v[152:155], v[44:47]
    v_mfma_f32_16x16x32_bf16 v[76:79], v[172:175], v[152:155], v[76:79]
    v_mfma_f32_16x16x32_bf16 v[80:83], v[160:163], v[156:159], v[80:83]
    v_mfma_f32_16x16x32_bf16 v[84:87], v[156:159], v[164:167], v[84:87]
    s_waitcnt vmcnt(14) lgkmcnt(6)
    s_barrier
    v_mfma_f32_16x16x32_bf16 v[16:19], v[88:91], v[176:179], v[16:19]
    ds_read_b128 v[128:131], v247 offset:14336
    v_mfma_f32_16x16x32_bf16 v[48:51], v[88:91], v[180:183], v[48:51]
    ds_read_b128 v[132:135], v247 offset:15360
    v_mfma_f32_16x16x32_bf16 v[20:23], v[92:95], v[176:179], v[20:23]
    ds_read_b128 v[136:139], v247 offset:16384
    v_mfma_f32_16x16x32_bf16 v[52:55], v[92:95], v[180:183], v[52:55]
    ds_read_b128 v[140:143], v247 offset:17408
    v_mfma_f32_16x16x32_bf16 v[24:27], v[96:99], v[176:179], v[24:27]
    ds_read_b128 v[144:147], v247 offset:18432
    v_mfma_f32_16x16x32_bf16 v[56:59], v[96:99], v[180:183], v[56:59]
    ds_read_b128 v[148:151], v247 offset:19456
    v_mfma_f32_16x16x32_bf16 v[28:31], v[100:103], v[176:179], v[28:31]
    ds_read_b128 v[152:155], v247 offset:20480
    v_mfma_f32_16x16x32_bf16 v[60:63], v[100:103], v[180:183], v[60:63]
    ds_read_b128 v[156:159], v248 offset:11264
    s_waitcnt lgkmcnt(8)
    v_mfma_f32_16x16x32_bf16 v[36:39], v[176:179], v[104:107], v[36:39]
    ds_read_b128 v[160:163], v250 offset:14336
    v_mfma_f32_16x16x32_bf16 v[68:71], v[180:183], v[104:107], v[68:71]
    ds_read_b128 v[164:167], v252 offset:14336
    v_mfma_f32_16x16x32_bf16 v[40:43], v[176:179], v[108:111], v[40:43]
    v_mfma_f32_16x16x32_bf16 v[72:75], v[180:183], v[108:111], v[72:75]
    v_mfma_f32_16x16x32_bf16 v[32:35], v[112:115], v[176:179], v[32:35]
    v_mfma_f32_16x16x32_bf16 v[64:67], v[112:115], v[180:183], v[64:67]
    v_mfma_f32_16x16x32_bf16 v[44:47], v[176:179], v[112:115], v[44:47]
    v_mfma_f32_16x16x32_bf16 v[76:79], v[180:183], v[112:115], v[76:79]
    v_mfma_f32_16x16x32_bf16 v[80:83], v[120:123], v[116:119], v[80:83]
    v_mfma_f32_16x16x32_bf16 v[84:87], v[116:119], v[124:127], v[84:87]
    s_waitcnt vmcnt(12) lgkmcnt(6)
    v_mfma_f32_16x16x32_bf16 v[16:19], v[128:131], v[184:187], v[16:19]
    ds_read_b128 v[88:91], v247 offset:21504
    v_mfma_f32_16x16x32_bf16 v[48:51], v[128:131], v[188:191], v[48:51]
    ds_read_b128 v[92:95], v247 offset:22528
    v_mfma_f32_16x16x32_bf16 v[20:23], v[132:135], v[184:187], v[20:23]
    ds_read_b128 v[96:99], v247 offset:23552
    v_mfma_f32_16x16x32_bf16 v[52:55], v[132:135], v[188:191], v[52:55]
    ds_read_b128 v[100:103], v247 offset:24576
    v_mfma_f32_16x16x32_bf16 v[24:27], v[136:139], v[184:187], v[24:27]
    ds_read_b128 v[104:107], v247 offset:25600
    v_mfma_f32_16x16x32_bf16 v[56:59], v[136:139], v[188:191], v[56:59]
    ds_read_b128 v[108:111], v247 offset:26624
    v_mfma_f32_16x16x32_bf16 v[28:31], v[140:143], v[184:187], v[28:31]
    ds_read_b128 v[112:115], v247 offset:27648
    v_mfma_f32_16x16x32_bf16 v[60:63], v[140:143], v[188:191], v[60:63]
    ds_read_b128 v[116:119], v248 offset:12288
    s_waitcnt lgkmcnt(8)
    v_mfma_f32_16x16x32_bf16 v[36:39], v[184:187], v[144:147], v[36:39]
    ds_read_b128 v[120:123], v250 offset:21504
    v_mfma_f32_16x16x32_bf16 v[68:71], v[188:191], v[144:147], v[68:71]
    ds_read_b128 v[124:127], v252 offset:21504
    v_mfma_f32_16x16x32_bf16 v[40:43], v[184:187], v[148:151], v[40:43]
    v_mfma_f32_16x16x32_bf16 v[72:75], v[188:191], v[148:151], v[72:75]
    v_mfma_f32_16x16x32_bf16 v[32:35], v[152:155], v[184:187], v[32:35]
    v_mfma_f32_16x16x32_bf16 v[64:67], v[152:155], v[188:191], v[64:67]
    v_mfma_f32_16x16x32_bf16 v[44:47], v[184:187], v[152:155], v[44:47]
    v_mfma_f32_16x16x32_bf16 v[76:79], v[188:191], v[152:155], v[76:79]
    v_mfma_f32_16x16x32_bf16 v[80:83], v[160:163], v[156:159], v[80:83]
    v_mfma_f32_16x16x32_bf16 v[84:87], v[156:159], v[164:167], v[84:87]
    s_waitcnt vmcnt(10) lgkmcnt(6)
    s_barrier
    v_mfma_f32_16x16x32_bf16 v[16:19], v[88:91], v[192:195], v[16:19]
    ds_read_b128 v[128:131], v247 offset:28672
    v_mfma_f32_16x16x32_bf16 v[48:51], v[88:91], v[196:199], v[48:51]
    ds_read_b128 v[132:135], v247 offset:29696
    v_mfma_f32_16x16x32_bf16 v[20:23], v[92:95], v[192:195], v[20:23]
    ds_read_b128 v[136:139], v247 offset:30720
    v_mfma_f32_16x16x32_bf16 v[52:55], v[92:95], v[196:199], v[52:55]
    ds_read_b128 v[140:143], v247 offset:31744
    v_mfma_f32_16x16x32_bf16 v[24:27], v[96:99], v[192:195], v[24:27]
    ds_read_b128 v[144:147], v247 offset:32768
    v_mfma_f32_16x16x32_bf16 v[56:59], v[96:99], v[196:199], v[56:59]
    ds_read_b128 v[148:151], v247 offset:33792
    v_mfma_f32_16x16x32_bf16 v[28:31], v[100:103], v[192:195], v[28:31]
    ds_read_b128 v[152:155], v247 offset:34816
    v_mfma_f32_16x16x32_bf16 v[60:63], v[100:103], v[196:199], v[60:63]
    ds_read_b128 v[156:159], v248 offset:13312
    s_waitcnt lgkmcnt(8)
    v_mfma_f32_16x16x32_bf16 v[36:39], v[192:195], v[104:107], v[36:39]
    ds_read_b128 v[160:163], v250 offset:28672
    v_mfma_f32_16x16x32_bf16 v[68:71], v[196:199], v[104:107], v[68:71]
    ds_read_b128 v[164:167], v252 offset:28672
    v_mfma_f32_16x16x32_bf16 v[40:43], v[192:195], v[108:111], v[40:43]
    v_lshlrev_b32 v4, 4, v3
    v_mfma_f32_16x16x32_bf16 v[72:75], v[196:199], v[108:111], v[72:75]
    v_add_u32 v4, 161792, v4
    v_mfma_f32_16x16x32_bf16 v[32:35], v[112:115], v[192:195], v[32:35]
    s_lshl_b32 s36, s33, 6
    v_mfma_f32_16x16x32_bf16 v[64:67], v[112:115], v[196:199], v[64:67]
    v_add_u32 v5, s36, v4
    v_mfma_f32_16x16x32_bf16 v[44:47], v[192:195], v[112:115], v[44:47]
    v_lshlrev_b32 v6, 2, v2
    v_mfma_f32_16x16x32_bf16 v[76:79], v[196:199], v[112:115], v[76:79]
    v_add_u32 v6, 161792, v6
    v_mfma_f32_16x16x32_bf16 v[80:83], v[120:123], v[116:119], v[80:83]
    s_lshl_b32 s37, s34, 6
    v_mfma_f32_16x16x32_bf16 v[84:87], v[116:119], v[124:127], v[84:87]
    v_add_u32 v7, s37, v6
    s_waitcnt vmcnt(8) lgkmcnt(6)
    v_mfma_f32_16x16x32_bf16 v[16:19], v[128:131], v[200:203], v[16:19]
    ds_read_b128 v[88:91], v247 offset:35840
    v_mfma_f32_16x16x32_bf16 v[48:51], v[128:131], v[204:207], v[48:51]
    ds_read_b128 v[92:95], v247 offset:36864
    v_mfma_f32_16x16x32_bf16 v[20:23], v[132:135], v[200:203], v[20:23]
    ds_read_b128 v[96:99], v247 offset:37888
    v_mfma_f32_16x16x32_bf16 v[52:55], v[132:135], v[204:207], v[52:55]
    ds_read_b128 v[100:103], v247 offset:38912
    v_mfma_f32_16x16x32_bf16 v[24:27], v[136:139], v[200:203], v[24:27]
    ds_read_b128 v[104:107], v247 offset:39936
    v_mfma_f32_16x16x32_bf16 v[56:59], v[136:139], v[204:207], v[56:59]
    ds_read_b128 v[108:111], v247 offset:40960
    v_mfma_f32_16x16x32_bf16 v[28:31], v[140:143], v[200:203], v[28:31]
    ds_read_b128 v[112:115], v247 offset:41984
    v_mfma_f32_16x16x32_bf16 v[60:63], v[140:143], v[204:207], v[60:63]
    ds_read_b128 v[116:119], v248 offset:14336
    s_waitcnt lgkmcnt(8)
    v_mfma_f32_16x16x32_bf16 v[36:39], v[200:203], v[144:147], v[36:39]
    ds_read_b128 v[120:123], v250 offset:35840
    v_mfma_f32_16x16x32_bf16 v[68:71], v[204:207], v[144:147], v[68:71]
    ds_read_b128 v[124:127], v252 offset:35840
    v_mfma_f32_16x16x32_bf16 v[40:43], v[200:203], v[148:151], v[40:43]
    v_lshlrev_b32 v8, 4, v3
    v_mfma_f32_16x16x32_bf16 v[72:75], v[204:207], v[148:151], v[72:75]
    v_add_u32 v9, 4, v8
    v_mfma_f32_16x16x32_bf16 v[32:35], v[152:155], v[200:203], v[32:35]
    v_add_u32 v10, 8, v8
    v_mfma_f32_16x16x32_bf16 v[64:67], v[152:155], v[204:207], v[64:67]
    v_add_u32 v11, 12, v8
    v_mfma_f32_16x16x32_bf16 v[44:47], v[200:203], v[152:155], v[44:47]
    v_mfma_f32_16x16x32_bf16 v[76:79], v[204:207], v[152:155], v[76:79]
    v_mfma_f32_16x16x32_bf16 v[80:83], v[160:163], v[156:159], v[80:83]
    v_mfma_f32_16x16x32_bf16 v[84:87], v[156:159], v[164:167], v[84:87]
    s_waitcnt vmcnt(6) lgkmcnt(6)
    v_mfma_f32_16x16x32_bf16 v[16:19], v[88:91], v[208:211], v[16:19]
    ds_read_b128 v[128:131], v247 offset:43008
    v_mfma_f32_16x16x32_bf16 v[48:51], v[88:91], v[212:215], v[48:51]
    ds_read_b128 v[132:135], v247 offset:44032
    v_mfma_f32_16x16x32_bf16 v[20:23], v[92:95], v[208:211], v[20:23]
    ds_read_b128 v[136:139], v247 offset:45056
    v_mfma_f32_16x16x32_bf16 v[52:55], v[92:95], v[212:215], v[52:55]
    ds_read_b128 v[140:143], v247 offset:46080
    v_mfma_f32_16x16x32_bf16 v[24:27], v[96:99], v[208:211], v[24:27]
    ds_read_b128 v[144:147], v247 offset:47104
    v_mfma_f32_16x16x32_bf16 v[56:59], v[96:99], v[212:215], v[56:59]
    ds_read_b128 v[148:151], v247 offset:48128
    v_mfma_f32_16x16x32_bf16 v[28:31], v[100:103], v[208:211], v[28:31]
    ds_read_b128 v[152:155], v247 offset:49152
    v_mfma_f32_16x16x32_bf16 v[60:63], v[100:103], v[212:215], v[60:63]
    ds_read_b128 v[156:159], v248 offset:15360
    s_waitcnt lgkmcnt(8)
    v_mfma_f32_16x16x32_bf16 v[36:39], v[208:211], v[104:107], v[36:39]
    ds_read_b128 v[160:163], v250 offset:43008
    v_mfma_f32_16x16x32_bf16 v[68:71], v[212:215], v[104:107], v[68:71]
    ds_read_b128 v[164:167], v252 offset:43008
    v_mfma_f32_16x16x32_bf16 v[40:43], v[208:211], v[108:111], v[40:43]
    v_mfma_f32_16x16x32_bf16 v[72:75], v[212:215], v[108:111], v[72:75]
    v_mfma_f32_16x16x32_bf16 v[32:35], v[112:115], v[208:211], v[32:35]
    v_mfma_f32_16x16x32_bf16 v[64:67], v[112:115], v[212:215], v[64:67]
    v_mfma_f32_16x16x32_bf16 v[44:47], v[208:211], v[112:115], v[44:47]
    v_mfma_f32_16x16x32_bf16 v[76:79], v[212:215], v[112:115], v[76:79]
    v_mfma_f32_16x16x32_bf16 v[80:83], v[120:123], v[116:119], v[80:83]
    v_mfma_f32_16x16x32_bf16 v[84:87], v[116:119], v[124:127], v[84:87]
    s_waitcnt vmcnt(4) lgkmcnt(6)
    s_barrier
    v_mfma_f32_16x16x32_bf16 v[16:19], v[128:131], v[216:219], v[16:19]
    ds_read_b128 v[88:91], v247 offset:50176
    v_mfma_f32_16x16x32_bf16 v[48:51], v[128:131], v[220:223], v[48:51]
    ds_read_b128 v[92:95], v247 offset:51200
    v_mfma_f32_16x16x32_bf16 v[20:23], v[132:135], v[216:219], v[20:23]
    ds_read_b128 v[96:99], v247 offset:52224
    v_mfma_f32_16x16x32_bf16 v[52:55], v[132:135], v[220:223], v[52:55]
    ds_read_b128 v[100:103], v247 offset:53248
    v_mfma_f32_16x16x32_bf16 v[24:27], v[136:139], v[216:219], v[24:27]
    ds_read_b128 v[104:107], v247 offset:54272
    v_mfma_f32_16x16x32_bf16 v[56:59], v[136:139], v[220:223], v[56:59]
    ds_read_b128 v[108:111], v247 offset:55296
    v_mfma_f32_16x16x32_bf16 v[28:31], v[140:143], v[216:219], v[28:31]
    ds_read_b128 v[112:115], v247 offset:56320
    v_mfma_f32_16x16x32_bf16 v[60:63], v[140:143], v[220:223], v[60:63]
    ds_read_b128 v[116:119], v248 offset:16384
    s_waitcnt lgkmcnt(8)
    v_mfma_f32_16x16x32_bf16 v[36:39], v[216:219], v[144:147], v[36:39]
    ds_read_b128 v[120:123], v250 offset:50176
    v_mfma_f32_16x16x32_bf16 v[68:71], v[220:223], v[144:147], v[68:71]
    ds_read_b128 v[124:127], v252 offset:50176
    v_mfma_f32_16x16x32_bf16 v[40:43], v[216:219], v[148:151], v[40:43]
    v_mfma_f32_16x16x32_bf16 v[72:75], v[220:223], v[148:151], v[72:75]
    v_mfma_f32_16x16x32_bf16 v[32:35], v[152:155], v[216:219], v[32:35]
    v_mfma_f32_16x16x32_bf16 v[64:67], v[152:155], v[220:223], v[64:67]
    v_mfma_f32_16x16x32_bf16 v[44:47], v[216:219], v[152:155], v[44:47]
    v_mfma_f32_16x16x32_bf16 v[76:79], v[220:223], v[152:155], v[76:79]
    v_mfma_f32_16x16x32_bf16 v[80:83], v[160:163], v[156:159], v[80:83]
    v_mfma_f32_16x16x32_bf16 v[84:87], v[156:159], v[164:167], v[84:87]
    s_waitcnt vmcnt(2) lgkmcnt(6)
    v_mfma_f32_16x16x32_bf16 v[16:19], v[88:91], v[224:227], v[16:19]
    ds_read_b128 v[128:131], v247 offset:57344
    v_mfma_f32_16x16x32_bf16 v[48:51], v[88:91], v[228:231], v[48:51]
    ds_read_b128 v[132:135], v247 offset:58368
    v_mfma_f32_16x16x32_bf16 v[20:23], v[92:95], v[224:227], v[20:23]
    ds_read_b128 v[136:139], v247 offset:59392
    v_mfma_f32_16x16x32_bf16 v[52:55], v[92:95], v[228:231], v[52:55]
    ds_read_b128 v[140:143], v247 offset:60416
    v_mfma_f32_16x16x32_bf16 v[24:27], v[96:99], v[224:227], v[24:27]
    ds_read_b128 v[144:147], v247 offset:61440
    v_mfma_f32_16x16x32_bf16 v[56:59], v[96:99], v[228:231], v[56:59]
    ds_read_b128 v[148:151], v247 offset:62464
    v_mfma_f32_16x16x32_bf16 v[28:31], v[100:103], v[224:227], v[28:31]
    ds_read_b128 v[152:155], v247 offset:63488
    v_mfma_f32_16x16x32_bf16 v[60:63], v[100:103], v[228:231], v[60:63]
    ds_read_b128 v[156:159], v248 offset:17408
    s_waitcnt lgkmcnt(8)
    v_mfma_f32_16x16x32_bf16 v[36:39], v[224:227], v[104:107], v[36:39]
    ds_read_b128 v[160:163], v250 offset:57344
    v_mfma_f32_16x16x32_bf16 v[68:71], v[228:231], v[104:107], v[68:71]
    ds_read_b128 v[164:167], v252 offset:57344
    v_mfma_f32_16x16x32_bf16 v[40:43], v[224:227], v[108:111], v[40:43]
    v_mfma_f32_16x16x32_bf16 v[72:75], v[228:231], v[108:111], v[72:75]
    v_mfma_f32_16x16x32_bf16 v[32:35], v[112:115], v[224:227], v[32:35]
    v_mfma_f32_16x16x32_bf16 v[64:67], v[112:115], v[228:231], v[64:67]
    v_mfma_f32_16x16x32_bf16 v[44:47], v[224:227], v[112:115], v[44:47]
    v_mfma_f32_16x16x32_bf16 v[76:79], v[228:231], v[112:115], v[76:79]
    v_mfma_f32_16x16x32_bf16 v[80:83], v[120:123], v[116:119], v[80:83]
    v_mfma_f32_16x16x32_bf16 v[84:87], v[116:119], v[124:127], v[84:87]
    s_waitcnt vmcnt(0) lgkmcnt(0)
    v_mfma_f32_16x16x32_bf16 v[16:19], v[128:131], v[232:235], v[16:19]
    ds_read_b128 v[88:91], v4 offset:128
    ds_read_b128 v[168:171], v4 offset:640
    ds_read_b128 v[92:95], v4 offset:192
    v_mfma_f32_16x16x32_bf16 v[48:51], v[128:131], v[236:239], v[48:51]
    ds_read_b128 v[172:175], v4 offset:704
    ds_read_b128 v[96:99], v4 offset:384
    v_mfma_f32_16x16x32_bf16 v[20:23], v[132:135], v[232:235], v[20:23]
    ds_read_b128 v[176:179], v4 offset:896
    ds_read_b128 v[100:103], v5 offset:0
    ds_read_b128 v[180:183], v5 offset:512
    v_mfma_f32_16x16x32_bf16 v[52:55], v[132:135], v[236:239], v[52:55]
    ds_read_b128 v[104:107], v4 offset:0
    ds_read_b128 v[184:187], v4 offset:512
    v_mfma_f32_16x16x32_bf16 v[24:27], v[136:139], v[232:235], v[24:27]
    ds_read_b128 v[108:111], v4 offset:64
    ds_read_b128 v[188:191], v4 offset:576
    ds_read_b32 v112, v6 offset:256
    v_mfma_f32_16x16x32_bf16 v[56:59], v[136:139], v[236:239], v[56:59]
    ds_read_b32 v116, v6 offset:768
    ds_read_b32 v113, v6 offset:320
    v_mfma_f32_16x16x32_bf16 v[28:31], v[140:143], v[232:235], v[28:31]
    ds_read_b32 v117, v6 offset:832
    ds_read_b32 v114, v6 offset:384
    ds_read_b32 v118, v6 offset:896
    v_mfma_f32_16x16x32_bf16 v[60:63], v[140:143], v[236:239], v[60:63]
    ds_read_b32 v115, v7 offset:0
    ds_read_b32 v119, v7 offset:512
    v_mfma_f32_16x16x32_bf16 v[36:39], v[232:235], v[144:147], v[36:39]
    ds_bpermute_b32 v200, v8, v244
    ds_bpermute_b32 v212, v8, v245
    v_mfma_f32_16x16x32_bf16 v[68:71], v[236:239], v[144:147], v[68:71]
    ds_bpermute_b32 v201, v9, v244
    ds_bpermute_b32 v213, v9, v245
    ds_bpermute_b32 v202, v10, v244
    v_mfma_f32_16x16x32_bf16 v[40:43], v[232:235], v[148:151], v[40:43]
    ds_bpermute_b32 v214, v10, v245
    ds_bpermute_b32 v203, v11, v244
    v_mfma_f32_16x16x32_bf16 v[72:75], v[236:239], v[148:151], v[72:75]
    ds_bpermute_b32 v215, v11, v245
    ds_bpermute_b32 v192, v8, v240
    ds_bpermute_b32 v204, v8, v241
    v_mfma_f32_16x16x32_bf16 v[32:35], v[152:155], v[232:235], v[32:35]
    ds_bpermute_b32 v193, v9, v240
    ds_bpermute_b32 v205, v9, v241
    v_mfma_f32_16x16x32_bf16 v[64:67], v[152:155], v[236:239], v[64:67]
    ds_bpermute_b32 v194, v10, v240
    ds_bpermute_b32 v206, v10, v241
    ds_bpermute_b32 v195, v11, v240
    v_mfma_f32_16x16x32_bf16 v[44:47], v[232:235], v[152:155], v[44:47]
    ds_bpermute_b32 v207, v11, v241
    ds_bpermute_b32 v196, v8, v242
    v_mfma_f32_16x16x32_bf16 v[76:79], v[236:239], v[152:155], v[76:79]
    ds_bpermute_b32 v208, v8, v243
    ds_bpermute_b32 v197, v9, v242
    ds_bpermute_b32 v209, v9, v243
    v_mfma_f32_16x16x32_bf16 v[80:83], v[160:163], v[156:159], v[80:83]
    ds_bpermute_b32 v198, v10, v242
    ds_bpermute_b32 v210, v10, v243
    v_mfma_f32_16x16x32_bf16 v[84:87], v[156:159], v[164:167], v[84:87]
    ds_bpermute_b32 v199, v11, v242
    ds_bpermute_b32 v211, v11, v243
    v_and_b32 v4, 1, v2
    v_lshl_add_u32 v5, v3, 2, v4
    v_add_u32 v6, 2, v5
    v_cmp_eq_u32 s[40:41], 1, v4
    v_cmp_le_u32 s[42:43], v5, v2
    v_cmp_le_u32 s[44:45], v6, v2
    v_cmp_eq_u32 s[46:47], 0, v3
    v_mov_b32 v4, 0xffff
    v_mov_b32 v5, 0xffff0000
    v_cndmask_b32 v4, v4, v5, s[40:41]
    v_cndmask_b32 v12, v4, 0, s[42:43]
    v_cndmask_b32 v13, v4, 0, s[44:45]
    v_cndmask_b32 v14, 0, v4, s[42:43]
    v_cndmask_b32 v15, 0, v4, s[44:45]
    s_cmp_eq_u32 s31, 0
    s_cselect_b64 s[48:49], s[42:43], -1
    s_cselect_b64 s[50:51], s[44:45], -1
    v_lshrrev_b32 v8, 1, v1
    s_mul_i32 s36, s20, 3072
    s_add_u32 s36, s36, 149504
    v_add_u32 v9, s36, v8
    s_lshl_b32 s37, s20, 9
    s_add_u32 s37, s37, 149504
    v_add_u32 v10, s37, v8
    s_waitcnt lgkmcnt(0)
    v_pk_add_f32 v[88:89], v[88:89], v[168:169]
    v_pk_add_f32 v[90:91], v[90:91], v[170:171]
    v_pk_add_f32 v[92:93], v[92:93], v[172:173]
    v_pk_add_f32 v[94:95], v[94:95], v[174:175]
    v_pk_add_f32 v[96:97], v[96:97], v[176:177]
    v_pk_add_f32 v[98:99], v[98:99], v[178:179]
    v_pk_add_f32 v[100:101], v[100:101], v[180:181]
    v_pk_add_f32 v[102:103], v[102:103], v[182:183]
    v_pk_add_f32 v[104:105], v[104:105], v[184:185]
    v_pk_add_f32 v[106:107], v[106:107], v[186:187]
    v_pk_add_f32 v[108:109], v[108:109], v[188:189]
    v_pk_add_f32 v[110:111], v[110:111], v[190:191]
    v_pk_add_f32 v[112:113], v[112:113], v[116:117]
    v_pk_add_f32 v[114:115], v[114:115], v[118:119]
    v_pk_fma_f32 v[56:57], v[244:245], v[88:89], v[56:57] op_sel_hi:[0,1,1] neg_lo:[1,0,0] neg_hi:[1,0,0]
    v_pk_fma_f32 v[58:59], v[244:245], v[90:91], v[58:59] op_sel_hi:[0,1,1] neg_lo:[1,0,0] neg_hi:[1,0,0]
    v_pk_fma_f32 v[60:61], v[244:245], v[92:93], v[60:61] op_sel_hi:[0,1,1] neg_lo:[1,0,0] neg_hi:[1,0,0]
    v_pk_fma_f32 v[62:63], v[244:245], v[94:95], v[62:63] op_sel_hi:[0,1,1] neg_lo:[1,0,0] neg_hi:[1,0,0]
    v_pk_fma_f32 v[64:65], v[244:245], v[96:97], v[64:65] op_sel_hi:[0,1,1] neg_lo:[1,0,0] neg_hi:[1,0,0]
    v_pk_fma_f32 v[66:67], v[244:245], v[98:99], v[66:67] op_sel_hi:[0,1,1] neg_lo:[1,0,0] neg_hi:[1,0,0]
    v_pk_fma_f32 v[68:69], v[200:201], v[112:113], v[68:69] op_sel:[0,0,0] op_sel_hi:[1,0,1] neg_lo:[1,0,0] neg_hi:[1,0,0]
    v_pk_fma_f32 v[70:71], v[202:203], v[112:113], v[70:71] op_sel:[0,0,0] op_sel_hi:[1,0,1] neg_lo:[1,0,0] neg_hi:[1,0,0]
    v_pk_fma_f32 v[72:73], v[200:201], v[112:113], v[72:73] op_sel:[0,1,0] op_sel_hi:[1,1,1] neg_lo:[1,0,0] neg_hi:[1,0,0]
    v_pk_fma_f32 v[74:75], v[202:203], v[112:113], v[74:75] op_sel:[0,1,0] op_sel_hi:[1,1,1] neg_lo:[1,0,0] neg_hi:[1,0,0]
    v_pk_fma_f32 v[76:77], v[200:201], v[114:115], v[76:77] op_sel:[0,0,0] op_sel_hi:[1,0,1] neg_lo:[1,0,0] neg_hi:[1,0,0]
    v_pk_fma_f32 v[78:79], v[202:203], v[114:115], v[78:79] op_sel:[0,0,0] op_sel_hi:[1,0,1] neg_lo:[1,0,0] neg_hi:[1,0,0]
    v_pk_fma_f32 v[80:81], v[240:241], v[100:101], v[80:81] op_sel_hi:[0,1,1] neg_lo:[1,0,0] neg_hi:[1,0,0]
    v_pk_fma_f32 v[82:83], v[240:241], v[102:103], v[82:83] op_sel_hi:[0,1,1] neg_lo:[1,0,0] neg_hi:[1,0,0]
    v_pk_fma_f32 v[84:85], v[192:193], v[114:115], v[84:85] op_sel:[0,1,0] op_sel_hi:[1,1,1] neg_lo:[1,0,0] neg_hi:[1,0,0]
    v_pk_fma_f32 v[86:87], v[194:195], v[114:115], v[86:87] op_sel:[0,1,0] op_sel_hi:[1,1,1] neg_lo:[1,0,0] neg_hi:[1,0,0]
    v_pk_mul_f32 v[56:57], v[56:57], v[244:245] op_sel:[0,1] op_sel_hi:[1,1]
    v_pk_mul_f32 v[58:59], v[58:59], v[244:245] op_sel:[0,1] op_sel_hi:[1,1]
    v_pk_mul_f32 v[60:61], v[60:61], v[244:245] op_sel:[0,1] op_sel_hi:[1,1]
    v_pk_mul_f32 v[62:63], v[62:63], v[244:245] op_sel:[0,1] op_sel_hi:[1,1]
    v_pk_mul_f32 v[64:65], v[64:65], v[244:245] op_sel:[0,1] op_sel_hi:[1,1]
    v_pk_mul_f32 v[66:67], v[66:67], v[244:245] op_sel:[0,1] op_sel_hi:[1,1]
    v_pk_mul_f32 v[68:69], v[68:69], v[212:213]
    v_pk_mul_f32 v[70:71], v[70:71], v[214:215]
    v_pk_mul_f32 v[72:73], v[72:73], v[212:213]
    v_pk_mul_f32 v[74:75], v[74:75], v[214:215]
    v_pk_mul_f32 v[76:77], v[76:77], v[212:213]
    v_pk_mul_f32 v[78:79], v[78:79], v[214:215]
    v_pk_mul_f32 v[80:81], v[80:81], v[240:241] op_sel:[0,1] op_sel_hi:[1,1]
    v_pk_mul_f32 v[82:83], v[82:83], v[240:241] op_sel:[0,1] op_sel_hi:[1,1]
    v_pk_mul_f32 v[84:85], v[84:85], v[204:205]
    v_pk_mul_f32 v[86:87], v[86:87], v[206:207]
    v_cvt_pk_bf16_f32 v144, v56, v57
    v_cvt_pk_bf16_f32 v145, v58, v59
    v_cvt_pk_bf16_f32 v148, v60, v61
    v_cvt_pk_bf16_f32 v149, v62, v63
    v_cvt_pk_bf16_f32 v190, v64, v65
    v_cvt_pk_bf16_f32 v191, v66, v67
    v_cvt_pk_bf16_f32 v172, v68, v69
    v_cvt_pk_bf16_f32 v173, v70, v71
    v_cvt_pk_bf16_f32 v178, v72, v73
    v_cvt_pk_bf16_f32 v179, v74, v75
    v_cvt_pk_bf16_f32 v184, v76, v77
    v_cvt_pk_bf16_f32 v185, v78, v79
    v_cvt_pk_bf16_f32 v216, v80, v81
    v_cvt_pk_bf16_f32 v217, v82, v83
    v_cvt_pk_bf16_f32 v218, v84, v85
    v_cvt_pk_bf16_f32 v219, v86, v87
    s_cmp_eq_u32 s20, 3
    s_cbranch_scc1 L_a_nw
    ds_write_b64 v9, v[144:145] offset:3072
    ds_write_b64 v9, v[148:149] offset:3584
    ds_write_b64 v9, v[190:191] offset:4096
    ds_write_b64 v9, v[172:173] offset:4608
    ds_write_b64 v9, v[178:179] offset:5120
    ds_write_b64 v9, v[184:185] offset:5632
    ds_write_b64 v10, v[216:217]
    ds_write_b64 v10, v[218:219] offset:1536
L_a_nw:
    v_pk_fma_f32 v[24:25], v[242:243], v[88:89], v[24:25] op_sel_hi:[0,1,1] neg_lo:[1,0,0] neg_hi:[1,0,0]
    v_pk_fma_f32 v[26:27], v[242:243], v[90:91], v[26:27] op_sel_hi:[0,1,1] neg_lo:[1,0,0] neg_hi:[1,0,0]
    v_pk_fma_f32 v[28:29], v[242:243], v[92:93], v[28:29] op_sel_hi:[0,1,1] neg_lo:[1,0,0] neg_hi:[1,0,0]
    v_pk_fma_f32 v[30:31], v[242:243], v[94:95], v[30:31] op_sel_hi:[0,1,1] neg_lo:[1,0,0] neg_hi:[1,0,0]
    v_pk_fma_f32 v[32:33], v[242:243], v[96:97], v[32:33] op_sel_hi:[0,1,1] neg_lo:[1,0,0] neg_hi:[1,0,0]
    v_pk_fma_f32 v[34:35], v[242:243], v[98:99], v[34:35] op_sel_hi:[0,1,1] neg_lo:[1,0,0] neg_hi:[1,0,0]
    v_pk_fma_f32 v[36:37], v[196:197], v[112:113], v[36:37] op_sel:[0,0,0] op_sel_hi:[1,0,1] neg_lo:[1,0,0] neg_hi:[1,0,0]
    v_pk_fma_f32 v[38:39], v[198:199], v[112:113], v[38:39] op_sel:[0,0,0] op_sel_hi:[1,0,1] neg_lo:[1,0,0] neg_hi:[1,0,0]
    v_pk_fma_f32 v[40:41], v[196:197], v[112:113], v[40:41] op_sel:[0,1,0] op_sel_hi:[1,1,1] neg_lo:[1,0,0] neg_hi:[1,0,0]
    v_pk_fma_f32 v[42:43], v[198:199], v[112:113], v[42:43] op_sel:[0,1,0] op_sel_hi:[1,1,1] neg_lo:[1,0,0] neg_hi:[1,0,0]
    v_pk_fma_f32 v[44:45], v[196:197], v[114:115], v[44:45] op_sel:[0,0,0] op_sel_hi:[1,0,1] neg_lo:[1,0,0] neg_hi:[1,0,0]
    v_pk_fma_f32 v[46:47], v[198:199], v[114:115], v[46:47] op_sel:[0,0,0] op_sel_hi:[1,0,1] neg_lo:[1,0,0] neg_hi:[1,0,0]
    v_pk_mul_f32 v[24:25], v[24:25], v[242:243] op_sel:[0,1] op_sel_hi:[1,1]
    v_pk_mul_f32 v[26:27], v[26:27], v[242:243] op_sel:[0,1] op_sel_hi:[1,1]
    v_pk_mul_f32 v[28:29], v[28:29], v[242:243] op_sel:[0,1] op_sel_hi:[1,1]
    v_pk_mul_f32 v[30:31], v[30:31], v[242:243] op_sel:[0,1] op_sel_hi:[1,1]
    v_pk_mul_f32 v[32:33], v[32:33], v[242:243] op_sel:[0,1] op_sel_hi:[1,1]
    v_pk_mul_f32 v[34:35], v[34:35], v[242:243] op_sel:[0,1] op_sel_hi:[1,1]
    v_pk_mul_f32 v[36:37], v[36:37], v[208:209]
    v_pk_mul_f32 v[38:39], v[38:39], v[210:211]
    v_pk_mul_f32 v[40:41], v[40:41], v[208:209]
    v_pk_mul_f32 v[42:43], v[42:43], v[210:211]
    v_pk_mul_f32 v[44:45], v[44:45], v[208:209]
    v_pk_mul_f32 v[46:47], v[46:47], v[210:211]
    v_cvt_pk_bf16_f32 v136, v24, v25
    v_cvt_pk_bf16_f32 v137, v26, v27
    v_cvt_pk_bf16_f32 v140, v28, v29
    v_cvt_pk_bf16_f32 v141, v30, v31
    v_cvt_pk_bf16_f32 v188, v32, v33
    v_cvt_pk_bf16_f32 v189, v34, v35
    v_cvt_pk_bf16_f32 v170, v36, v37
    v_cvt_pk_bf16_f32 v171, v38, v39
    v_cvt_pk_bf16_f32 v176, v40, v41
    v_cvt_pk_bf16_f32 v177, v42, v43
    v_cvt_pk_bf16_f32 v182, v44, v45
    v_cvt_pk_bf16_f32 v183, v46, v47
    s_waitcnt lgkmcnt(0)
    s_barrier
    ds_read_b64 v[128:129], v9 offset:0
    ds_read_b64 v[132:133], v9 offset:512
    ds_read_b64 v[186:187], v9 offset:1024
    ds_read_b64 v[168:169], v9 offset:1536
    ds_read_b64 v[174:175], v9 offset:2048
    ds_read_b64 v[180:181], v9 offset:2560
    v_pk_fma_f32 v[16:17], v[242:243], v[104:105], v[16:17] op_sel_hi:[0,1,1] neg_lo:[1,0,0] neg_hi:[1,0,0]
    v_pk_fma_f32 v[18:19], v[242:243], v[106:107], v[18:19] op_sel_hi:[0,1,1] neg_lo:[1,0,0] neg_hi:[1,0,0]
    v_pk_fma_f32 v[20:21], v[242:243], v[108:109], v[20:21] op_sel_hi:[0,1,1] neg_lo:[1,0,0] neg_hi:[1,0,0]
    v_pk_fma_f32 v[22:23], v[242:243], v[110:111], v[22:23] op_sel_hi:[0,1,1] neg_lo:[1,0,0] neg_hi:[1,0,0]
    v_pk_fma_f32 v[48:49], v[244:245], v[104:105], v[48:49] op_sel_hi:[0,1,1] neg_lo:[1,0,0] neg_hi:[1,0,0]
    v_pk_fma_f32 v[50:51], v[244:245], v[106:107], v[50:51] op_sel_hi:[0,1,1] neg_lo:[1,0,0] neg_hi:[1,0,0]
    v_pk_fma_f32 v[52:53], v[244:245], v[108:109], v[52:53] op_sel_hi:[0,1,1] neg_lo:[1,0,0] neg_hi:[1,0,0]
    v_pk_fma_f32 v[54:55], v[244:245], v[110:111], v[54:55] op_sel_hi:[0,1,1] neg_lo:[1,0,0] neg_hi:[1,0,0]
    v_pk_mul_f32 v[16:17], v[16:17], v[242:243] op_sel:[0,1] op_sel_hi:[1,1]
    v_pk_mul_f32 v[18:19], v[18:19], v[242:243] op_sel:[0,1] op_sel_hi:[1,1]
    v_pk_mul_f32 v[20:21], v[20:21], v[242:243] op_sel:[0,1] op_sel_hi:[1,1]
    v_pk_mul_f32 v[22:23], v[22:23], v[242:243] op_sel:[0,1] op_sel_hi:[1,1]
    v_pk_mul_f32 v[48:49], v[48:49], v[244:245] op_sel:[0,1] op_sel_hi:[1,1]
    v_pk_mul_f32 v[50:51], v[50:51], v[244:245] op_sel:[0,1] op_sel_hi:[1,1]
    v_pk_mul_f32 v[52:53], v[52:53], v[244:245] op_sel:[0,1] op_sel_hi:[1,1]
    v_pk_mul_f32 v[54:55], v[54:55], v[244:245] op_sel:[0,1] op_sel_hi:[1,1]
    v_cvt_pk_bf16_f32 v152, v16, v17
    v_cvt_pk_bf16_f32 v153, v18, v19
    v_cvt_pk_bf16_f32 v156, v20, v21
    v_cvt_pk_bf16_f32 v157, v22, v23
    v_cvt_pk_bf16_f32 v160, v48, v49
    v_cvt_pk_bf16_f32 v161, v50, v51
    v_cvt_pk_bf16_f32 v164, v52, v53
    v_cvt_pk_bf16_f32 v165, v54, v55
    v_cndmask_b32 v154, 0, v188, s[46:47]
    v_mov_b32 v155, 0
    v_cndmask_b32 v158, 0, v189, s[46:47]
    v_mov_b32 v159, 0
    v_cndmask_b32 v162, 0, v190, s[46:47]
    v_mov_b32 v163, 0
    v_cndmask_b32 v166, 0, v191, s[46:47]
    v_mov_b32 v167, 0
    v_mov_b32 v131, 0
    v_mov_b32 v135, 0
    v_mov_b32 v139, 0
    v_mov_b32 v143, 0
    v_mov_b32 v147, 0
    v_mov_b32 v151, 0
    s_waitcnt lgkmcnt(0)
    v_permlane16_swap_b32 v188, v138
    v_permlane16_swap_b32 v189, v142
    v_permlane16_swap_b32 v190, v146
    v_permlane16_swap_b32 v191, v150
    v_permlane16_swap_b32 v186, v130
    v_permlane16_swap_b32 v187, v134
    v_cndmask_b32 v138, 0, v138, s[46:47]
    v_cndmask_b32 v142, 0, v142, s[46:47]
    v_cndmask_b32 v146, 0, v146, s[46:47]
    v_cndmask_b32 v150, 0, v150, s[46:47]
    v_cndmask_b32 v130, 0, v130, s[46:47]
    v_cndmask_b32 v134, 0, v134, s[46:47]
    s_nop 1
    v_mfma_f32_16x16x32_bf16 v[20:23], v[144:147], v[160:163], 0
    v_mfma_f32_16x16x32_bf16 v[16:19], v[136:139], v[160:163], 0
    v_mfma_f32_16x16x32_bf16 v[28:31], v[148:151], v[164:167], 0
    v_mfma_f32_16x16x32_bf16 v[24:27], v[140:143], v[164:167], 0
    v_mfma_f32_16x16x32_bf16 v[36:39], v[136:139], v[152:155], 0
    v_mfma_f32_16x16x32_bf16 v[32:35], v[128:131], v[152:155], 0
    v_mfma_f32_16x16x32_bf16 v[44:47], v[140:143], v[156:159], 0
    v_mfma_f32_16x16x32_bf16 v[40:43], v[132:135], v[156:159], 0
    s_lshl_b32 s36, s24, 10
    v_add_u32 v4, s36, v1
    v_add_u32 v5, 18432, v4
    s_lshr_b32 s36, s24, 3
    s_lshl_b32 s36, s36, 10
    s_bfe_u32 s37, s24, 0x20001
    s_lshl_b32 s37, s37, 8
    s_add_u32 s36, s36, s37
    s_and_b32 s37, s24, 1
    s_lshl_b32 s37, s37, 3
    s_add_u32 s36, s36, s37
    s_add_u32 s36, s36, 16384
    v_cmp_eq_u32 vcc, 2, v3
    v_lshl_add_u32 v6, v2, 4, s36
    v_bfrev_b32 v7, 1
    v_cndmask_b32 v6, v7, v6, vcc
    v_add_u32 v7, 18432, v6
    v_mov_b32 v8, 0xf149f2ca
    s_mov_b32 s52, 0x3eae1a93
    v_cndmask_b32 v20, v20, v21, s[40:41]
    v_cndmask_b32 v16, v16, v17, s[40:41]
    v_cndmask_b32 v48, v16, v20, s[42:43]
    v_cndmask_b32 v22, v22, v23, s[40:41]
    v_cndmask_b32 v18, v18, v19, s[40:41]
    v_cndmask_b32 v49, v18, v22, s[44:45]
    v_max_f32 v56, v48, v49
    v_cndmask_b32 v28, v28, v29, s[40:41]
    v_cndmask_b32 v24, v24, v25, s[40:41]
    v_cndmask_b32 v50, v24, v28, s[42:43]
    v_cndmask_b32 v30, v30, v31, s[40:41]
    v_cndmask_b32 v26, v26, v27, s[40:41]
    v_cndmask_b32 v51, v26, v30, s[44:45]
    v_max_f32 v57, v50, v51
    v_cndmask_b32 v36, v36, v37, s[40:41]
    v_cndmask_b32 v32, v32, v33, s[40:41]
    v_cndmask_b32 v52, v32, v36, s[42:43]
    v_cndmask_b32 v52, v8, v52, s[48:49]
    v_cndmask_b32 v38, v38, v39, s[40:41]
    v_cndmask_b32 v34, v34, v35, s[40:41]
    v_cndmask_b32 v53, v34, v38, s[44:45]
    v_cndmask_b32 v53, v8, v53, s[50:51]
    v_max_f32 v58, v52, v53
    v_cndmask_b32 v44, v44, v45, s[40:41]
    v_cndmask_b32 v40, v40, v41, s[40:41]
    v_cndmask_b32 v54, v40, v44, s[42:43]
    v_cndmask_b32 v54, v8, v54, s[48:49]
    v_cndmask_b32 v46, v46, v47, s[40:41]
    v_cndmask_b32 v42, v42, v43, s[40:41]
    v_cndmask_b32 v55, v42, v46, s[44:45]
    v_cndmask_b32 v55, v8, v55, s[50:51]
    v_max_f32 v59, v54, v55
    v_mov_b32 v60, v56
    v_mov_b32 v61, v57
    v_mov_b32 v62, v58
    v_mov_b32 v63, v59
    v_permlane32_swap_b32 v56, v60
    v_permlane32_swap_b32 v57, v61
    v_permlane32_swap_b32 v58, v62
    v_permlane32_swap_b32 v59, v63
    v_max_f32 v56, v56, v60
    v_max_f32 v57, v57, v61
    v_max_f32 v58, v58, v62
    v_max_f32 v59, v59, v63
    v_mov_b32 v60, v56
    v_mov_b32 v61, v57
    v_mov_b32 v62, v58
    v_mov_b32 v63, v59
    v_permlane16_swap_b32 v56, v60
    v_permlane16_swap_b32 v57, v61
    v_permlane16_swap_b32 v58, v62
    v_permlane16_swap_b32 v59, v63
    v_max_f32 v56, v56, v60
    v_max_f32 v57, v57, v61
    v_max_f32 v58, v58, v62
    v_max_f32 v59, v59, v63
    v_mul_f32 v56, s52, v56
    v_mul_f32 v57, s52, v57
    v_mul_f32 v58, s52, v58
    v_mul_f32 v59, s52, v59
    v_fma_f32 v48, v48, s52, -v56
    v_fma_f32 v49, v49, s52, -v56
    v_fma_f32 v50, v50, s52, -v57
    v_fma_f32 v51, v51, s52, -v57
    v_fma_f32 v52, v52, s52, -v58
    v_fma_f32 v53, v53, s52, -v58
    v_fma_f32 v54, v54, s52, -v59
    v_fma_f32 v55, v55, s52, -v59
    v_exp_f32 v48, v48
    v_exp_f32 v49, v49
    v_exp_f32 v50, v50
    v_exp_f32 v51, v51
    v_exp_f32 v52, v52
    v_exp_f32 v53, v53
    v_exp_f32 v54, v54
    v_exp_f32 v55, v55
    v_add_f32 v56, v48, v49
    v_add_f32 v57, v50, v51
    v_add_f32 v58, v52, v53
    v_add_f32 v59, v54, v55
    v_mov_b32 v60, v56
    v_mov_b32 v61, v57
    v_mov_b32 v62, v58
    v_mov_b32 v63, v59
    v_permlane32_swap_b32 v56, v60
    v_permlane32_swap_b32 v57, v61
    v_permlane32_swap_b32 v58, v62
    v_permlane32_swap_b32 v59, v63
    v_add_f32 v56, v56, v60
    v_add_f32 v57, v57, v61
    v_add_f32 v58, v58, v62
    v_add_f32 v59, v59, v63
    v_mov_b32 v60, v56
    v_mov_b32 v61, v57
    v_mov_b32 v62, v58
    v_mov_b32 v63, v59
    v_permlane16_swap_b32 v56, v60
    v_permlane16_swap_b32 v57, v61
    v_permlane16_swap_b32 v58, v62
    v_permlane16_swap_b32 v59, v63
    v_add_f32 v56, v56, v60
    v_add_f32 v57, v57, v61
    v_add_f32 v58, v58, v62
    v_add_f32 v59, v59, v63
    v_rcp_f32 v56, v56
    v_rcp_f32 v57, v57
    v_rcp_f32 v58, v58
    v_rcp_f32 v59, v59
    v_mul_f32 v48, v48, v56
    v_mul_f32 v49, v49, v56
    v_mul_f32 v50, v50, v57
    v_mul_f32 v51, v51, v57
    v_mul_f32 v52, v52, v58
    v_mul_f32 v53, v53, v58
    v_mul_f32 v54, v54, v59
    v_mul_f32 v55, v55, v59
    v_cvt_pk_bf16_f32 v48, v48, v48
    v_cvt_pk_bf16_f32 v49, v49, v49
    v_cvt_pk_bf16_f32 v50, v50, v50
    v_cvt_pk_bf16_f32 v51, v51, v51
    v_cvt_pk_bf16_f32 v52, v52, v52
    v_cvt_pk_bf16_f32 v53, v53, v53
    v_cvt_pk_bf16_f32 v54, v54, v54
    v_cvt_pk_bf16_f32 v55, v55, v55
    v_and_b32 v64, v48, v12
    v_and_b32 v65, v49, v13
    v_and_b32 v66, v48, v14
    v_and_b32 v67, v49, v15
    v_and_b32 v68, v50, v12
    v_and_b32 v69, v51, v13
    v_and_b32 v70, v50, v14
    v_and_b32 v71, v51, v15
    v_and_b32 v72, v52, v12
    v_and_b32 v73, v53, v13
    v_and_b32 v74, v52, v14
    v_and_b32 v75, v53, v15
    v_and_b32 v76, v54, v12
    v_and_b32 v77, v55, v13
    v_and_b32 v78, v54, v14
    v_and_b32 v79, v55, v15
    s_nop 1
    v_mfma_f32_16x16x32_bf16 v[16:19], v[170:173], v[64:67], 0
    v_mfma_f32_16x16x32_bf16 v[20:23], v[182:185], v[64:67], 0
    v_mfma_f32_16x16x32_bf16 v[24:27], v[176:179], v[68:71], 0
    v_mfma_f32_16x16x32_bf16 v[28:31], v[182:185], v[68:71], 0
    v_mfma_f32_16x16x32_bf16 v[32:35], v[168:171], v[72:75], 0
    v_mfma_f32_16x16x32_bf16 v[36:39], v[180:183], v[72:75], 0
    v_mfma_f32_16x16x32_bf16 v[40:43], v[174:177], v[76:79], 0
    v_mfma_f32_16x16x32_bf16 v[44:47], v[180:183], v[76:79], 0
    s_nop 3
    v_cvt_pk_bf16_f32 v216, v16, v17
    v_cvt_pk_bf16_f32 v217, v18, v19
    v_cvt_pk_bf16_f32 v220, v20, v21
    v_cvt_pk_bf16_f32 v218, v24, v25
    v_cvt_pk_bf16_f32 v219, v26, v27
    v_cvt_pk_bf16_f32 v221, v30, v31
    buffer_store_dwordx4 v[216:219], v5, s[4:7], s35 offen
    buffer_store_dwordx2 v[220:221], v7, s[4:7], s35 offen
    s_nop 0
    v_cvt_pk_bf16_f32 v224, v32, v33
    v_cvt_pk_bf16_f32 v225, v34, v35
    v_cvt_pk_bf16_f32 v228, v36, v37
    v_cvt_pk_bf16_f32 v226, v40, v41
    v_cvt_pk_bf16_f32 v227, v42, v43
    v_cvt_pk_bf16_f32 v229, v46, v47
    buffer_store_dwordx4 v[224:227], v4, s[4:7], s35 offen
    buffer_store_dwordx2 v[228:229], v6, s[4:7], s35 offen
    s_endpgm
L_ld_p1:
    s_and_b32 s25, s2, 7
    s_lshr_b32 s26, s2, 3
    s_lshl_b32 s23, s25, 1
    s_lshr_b32 s27, s26, 4
    s_add_u32 s23, s23, s27
    s_and_b32 s24, s26, 15
    s_mul_i32 s29, s24, 129024
    s_lshl_b32 s30, s20, 12
    s_add_u32 s29, s29, s30
    s_add_u32 s29, s29, 0x7800000
    s_lshl_b32 s31, s23, 3
    s_max_u32 s31, s31, 1
    s_sub_u32 s31, s31, 1
    s_mul_i32 s31, s31, 18432
    s_add_u32 s31, s31, s21
    s_add_u32 s31, s31, 0x0
    s_lshl_b32 s32, s20, 10
    s_and_b32 s33, s32, 1024
    s_add_u32 m0, s32, 131072
    s_add_u32 s34, s31, s32
    s_add_u32 s34, s34, 0
    buffer_load_dwordx4 v1, s[4:7], s34 offen  lds
    s_add_u32 m0, s30, 0
    s_add_u32 s34, s29, 0
    buffer_load_dwordx4 v1, s[4:7], s34 offen offset:0 lds
    buffer_load_dwordx4 v1, s[4:7], s34 offen offset:1024 lds
    buffer_load_dwordx4 v1, s[4:7], s34 offen offset:2048 lds
    buffer_load_dwordx4 v1, s[4:7], s34 offen offset:3072 lds
    s_add_u32 m0, s30, 16384
    s_add_u32 s34, s29, 16384
    buffer_load_dwordx4 v1, s[4:7], s34 offen offset:0 lds
    buffer_load_dwordx4 v1, s[4:7], s34 offen offset:1024 lds
    buffer_load_dwordx4 v1, s[4:7], s34 offen offset:2048 lds
    buffer_load_dwordx4 v1, s[4:7], s34 offen offset:3072 lds
    s_waitcnt vmcnt(4)
    s_barrier
    s_add_u32 m0, s32, 135168
    s_add_u32 s34, s31, s32
    s_add_u32 s34, s34, 4096
    buffer_load_dwordx4 v1, s[4:7], s34 offen  lds
    s_add_u32 m0, s30, 32768
    s_add_u32 s34, s29, 32768
    buffer_load_dwordx4 v1, s[4:7], s34 offen offset:0 lds
    buffer_load_dwordx4 v1, s[4:7], s34 offen offset:1024 lds
    buffer_load_dwordx4 v1, s[4:7], s34 offen offset:2048 lds
    buffer_load_dwordx4 v1, s[4:7], s34 offen offset:3072 lds
    s_add_u32 m0, s30, 49152
    s_add_u32 s34, s29, 49152
    buffer_load_dwordx4 v1, s[4:7], s34 offen offset:0 lds
    buffer_load_dwordx4 v1, s[4:7], s34 offen offset:1024 lds
    buffer_load_dwordx4 v1, s[4:7], s34 offen offset:2048 lds
    buffer_load_dwordx4 v1, s[4:7], s34 offen offset:3072 lds
    s_add_u32 m0, s32, 139264
    s_add_u32 s34, s31, s32
    s_add_u32 s34, s34, 8192
    buffer_load_dwordx4 v1, s[4:7], s34 offen  lds
    s_waitcnt vmcnt(10)
    s_barrier
    s_add_u32 m0, s30, 65536
    s_add_u32 s34, s29, 65536
    buffer_load_dwordx4 v1, s[4:7], s34 offen offset:0 lds
    buffer_load_dwordx4 v1, s[4:7], s34 offen offset:1024 lds
    buffer_load_dwordx4 v1, s[4:7], s34 offen offset:2048 lds
    buffer_load_dwordx4 v1, s[4:7], s34 offen offset:3072 lds
    s_waitcnt vmcnt(9)
    s_barrier
    s_add_u32 m0, s30, 81920
    s_add_u32 s34, s29, 81920
    buffer_load_dwordx4 v1, s[4:7], s34 offen offset:0 lds
    buffer_load_dwordx4 v1, s[4:7], s34 offen offset:1024 lds
    buffer_load_dwordx4 v1, s[4:7], s34 offen offset:2048 lds
    buffer_load_dwordx4 v1, s[4:7], s34 offen offset:3072 lds
    s_add_u32 m0, s32, 143360
    s_add_u32 s34, s31, s32
    s_add_u32 s34, s34, 12288
    buffer_load_dwordx4 v1, s[4:7], s34 offen  lds
    s_waitcnt vmcnt(9)
    s_barrier
    s_add_u32 m0, s30, 98304
    s_add_u32 s34, s29, 98304
    buffer_load_dwordx4 v1, s[4:7], s34 offen offset:0 lds
    buffer_load_dwordx4 v1, s[4:7], s34 offen offset:1024 lds
    buffer_load_dwordx4 v1, s[4:7], s34 offen offset:2048 lds
    buffer_load_dwordx4 v1, s[4:7], s34 offen offset:3072 lds
    s_waitcnt vmcnt(9)
    s_barrier
    s_add_u32 m0, s33, 147456
    s_add_u32 s34, s31, s33
    s_add_u32 s34, s34, 16384
    buffer_load_dwordx4 v1, s[4:7], s34 offen  lds
    s_add_u32 m0, s30, 114688
    s_add_u32 s34, s29, 114688
    buffer_load_dwordx4 v1, s[4:7], s34 offen offset:0 lds
    buffer_load_dwordx4 v1, s[4:7], s34 offen offset:1024 lds
    buffer_load_dwordx4 v1, s[4:7], s34 offen offset:2048 lds
    buffer_load_dwordx4 v1, s[4:7], s34 offen offset:3072 lds
    s_mov_b32 m0, 161792
    s_lshl_b32 s34, s24, 10
    s_add_u32 s34, s34, 0x8400000
    buffer_load_dwordx4 v1, s[4:7], s34 offen lds
    s_waitcnt vmcnt(10)
    s_barrier
    s_waitcnt vmcnt(6)
    s_barrier
    s_waitcnt vmcnt(0)
    s_barrier
L_end_p1:
    s_endpgm

.globl p2l0_kernel
.p2align 8
.type p2l0_kernel,@function
p2l0_kernel:
    s_mov_b32 s22, 0
L_go_p2:
    s_cmp_ge_u32 s2, 256
    s_cbranch_scc1 L_end_p2
    s_load_dwordx2 s[24:25], s[0:1], 80
    s_load_dwordx4 s[28:31], s[0:1], 40
    s_load_dwordx2 s[26:27], s[0:1], 64
    v_lshrrev_b32 v2, 6, v0
    v_and_b32 v1, 63, v0
    v_lshlrev_b32 v1, 4, v1
    v_readfirstlane_b32 s23, v2
    v_mov_b32 v2, 163832
    v_mov_b32 v3, 0
    ds_write_b32 v2, v3
    s_mul_i32 s21, s22, 0x2800000
    s_and_b32 s20, s23, 3
    s_waitcnt lgkmcnt(0)
    s_mov_b32 s4, s24
    s_mov_b32 s5, s25
    s_mov_b32 s6, 0x10000000
    s_mov_b32 s7, 0x20000
    s_mov_b32 s8, s28
    s_mov_b32 s9, s29
    s_mov_b32 s10, 0x800000
    s_mov_b32 s11, 0x20000
    s_mov_b32 s12, s30
    s_mov_b32 s13, s31
    s_mov_b32 s14, 0x1000
    s_mov_b32 s15, 0x20000
    s_mov_b32 s16, s26
    s_mov_b32 s17, s27
    s_mov_b32 s18, 0x240000
    s_mov_b32 s19, 0x20000
    s_cmp_ge_u32 s23, 4
    s_cbranch_scc1 L_ld_p2
    s_and_b32 s25, s2, 7
    s_lshr_b32 s26, s2, 3
    s_lshl_b32 s23, s25, 2
    s_lshr_b32 s27, s26, 3
    s_add_u32 s23, s23, s27
    s_and_b32 s24, s26, 7
    s_add_u32 s28, s23, s24
    s_and_b32 s28, s28, 3
    s_lshl_b32 s30, s23, 2
    s_add_u32 s30, s30, s20
    s_mul_i32 s29, s30, 18432
    s_add_u32 s29, s29, s21
    s_add_u32 s29, s29, 0x600000
    s_mul_i32 s34, s30, 18432
    s_add_u32 s34, s34, s21
    s_add_u32 s34, s34, 0x0
    s_lshl_b32 s35, s24, 11
    s_lshr_b32 s36, s24, 2
    s_lshl_b32 s36, s36, 10
    s_and_b32 s37, s24, 3
    s_lshl_b32 s37, s37, 8
    s_add_u32 s36, s36, s37
    s_add_u32 s36, s36, 16384
    v_and_b32 v2, 15, v0
    v_bfe_u32 v3, v0, 4, 2
    v_add_u32 v4, s35, v1
    v_lshlrev_b32 v5, 4, v2
    v_lshl_add_u32 v5, v3, 3, v5
    v_add_u32 v5, s36, v5
    v_cmp_gt_u32 s[40:41], 2, v3
    v_bfrev_b32 v6, 1
    v_add_u32 v12, 0, v1
    v_add_u32 v13, 36864, v1
    v_add_u32 v14, 73728, v1
    v_add_u32 v15, 110592, v1
    v_cndmask_b32 v5, v6, v5, s[40:41]
    v_mov_b32 v16, 0
    v_mov_b32 v17, 0
    v_mov_b32 v18, 0
    v_mov_b32 v19, 0
    v_mov_b32 v20, 0
    v_mov_b32 v21, 0
    v_mov_b32 v22, 0
    v_mov_b32 v23, 0
    v_mov_b32 v24, 0
    v_mov_b32 v25, 0
    v_mov_b32 v26, 0
    v_mov_b32 v27, 0
    v_mov_b32 v28, 0
    v_mov_b32 v29, 0
    v_mov_b32 v30, 0
    v_mov_b32 v31, 0
    v_mov_b32 v32, 0
    v_mov_b32 v33, 0
    v_mov_b32 v34, 0
    v_mov_b32 v35, 0
    v_mov_b32 v36, 0
    v_mov_b32 v37, 0
    v_mov_b32 v38, 0
    v_mov_b32 v39, 0
    s_and_b32 s37, s20, 1
    v_bfe_u32 v7, v2, 2, 1
    v_lshrrev_b32 v8, 3, v2
    v_lshlrev_b32 v8, 2, v8
    v_and_b32 v9, 3, v2
    v_add_u32 v8, v8, v9
    s_lshl_b32 s37, s37, 3
    v_add_u32 v8, s37, v8
    s_mov_b32 s32, 0
    s_lshl_b32 s32, s32, 13
    s_add_u32 s32, s32, s29
    s_add_u32 s33, s32, 4096
    buffer_load_dwordx4 v[112:115], v1, s[4:7], s32 offen offset:0
    buffer_load_dwordx4 v[116:119], v1, s[4:7], s32 offen offset:1024
    buffer_load_dwordx4 v[120:123], v1, s[4:7], s32 offen offset:2048
    buffer_load_dwordx4 v[124:127], v1, s[4:7], s32 offen offset:3072
    buffer_load_dwordx4 v[128:131], v1, s[4:7], s33 offen offset:0
    buffer_load_dwordx4 v[132:135], v1, s[4:7], s33 offen offset:1024
    buffer_load_dwordx4 v[136:139], v1, s[4:7], s33 offen offset:2048
    buffer_load_dwordx4 v[140:143], v1, s[4:7], s33 offen offset:3072
    s_mov_b32 s32, 1
    s_lshl_b32 s32, s32, 13
    s_add_u32 s32, s32, s29
    s_add_u32 s33, s32, 4096
    buffer_load_dwordx4 v[144:147], v1, s[4:7], s32 offen offset:0
    buffer_load_dwordx4 v[148:151], v1, s[4:7], s32 offen offset:1024
    buffer_load_dwordx4 v[152:155], v1, s[4:7], s32 offen offset:2048
    buffer_load_dwordx4 v[156:159], v1, s[4:7], s32 offen offset:3072
    buffer_load_dwordx4 v[160:163], v1, s[4:7], s33 offen offset:0
    buffer_load_dwordx4 v[164:167], v1, s[4:7], s33 offen offset:1024
    buffer_load_dwordx4 v[168:171], v1, s[4:7], s33 offen offset:2048
    buffer_load_dwordx4 v[172:175], v1, s[4:7], s33 offen offset:3072
    s_barrier
    ds_read_b128 v[40:43], v12 offset:0
    ds_read_b128 v[44:47], v12 offset:1024
    ds_read_b128 v[48:51], v12 offset:2048
    ds_read_b128 v[52:55], v12 offset:3072
    ds_read_b128 v[72:75], v12 offset:8192
    ds_read_b128 v[56:59], v12 offset:4096
    ds_read_b128 v[60:63], v12 offset:5120
    ds_read_b128 v[64:67], v12 offset:6144
    ds_read_b128 v[68:71], v12 offset:7168
    s_waitcnt vmcnt(14) lgkmcnt(4)
    v_mfma_f32_16x16x32_bf16 v[16:19], v[40:43], v[112:115], v[16:19]
    ds_read_b128 v[76:79], v12 offset:9216
    s_mov_b32 s32, 2
    s_lshl_b32 s32, s32, 13
    s_add_u32 s32, s32, s29
    s_add_u32 s33, s32, 4096
    v_mfma_f32_16x16x32_bf16 v[20:23], v[44:47], v[112:115], v[20:23]
    ds_read_b128 v[80:83], v12 offset:10240
    v_mfma_f32_16x16x32_bf16 v[24:27], v[48:51], v[112:115], v[24:27]
    ds_read_b128 v[84:87], v12 offset:11264
    buffer_load_dwordx4 v[176:179], v1, s[4:7], s32 offen offset:0
    v_mfma_f32_16x16x32_bf16 v[28:31], v[52:55], v[112:115], v[28:31]
    ds_read_b128 v[88:91], v12 offset:12288
    v_mfma_f32_16x16x32_bf16 v[32:35], v[72:75], v[112:115], v[32:35]
    ds_read_b128 v[108:111], v12 offset:17408
    s_waitcnt lgkmcnt(5)
    v_mfma_f32_16x16x32_bf16 v[16:19], v[56:59], v[116:119], v[16:19]
    ds_read_b128 v[92:95], v12 offset:13312
    v_mfma_f32_16x16x32_bf16 v[20:23], v[60:63], v[116:119], v[20:23]
    ds_read_b128 v[96:99], v12 offset:14336
    buffer_load_dwordx4 v[180:183], v1, s[4:7], s32 offen offset:1024
    v_mfma_f32_16x16x32_bf16 v[24:27], v[64:67], v[116:119], v[24:27]
    ds_read_b128 v[100:103], v12 offset:15360
    v_mfma_f32_16x16x32_bf16 v[28:31], v[68:71], v[116:119], v[28:31]
    ds_read_b128 v[104:107], v12 offset:16384
    v_mfma_f32_16x16x32_bf16 v[36:39], v[72:75], v[116:119], v[36:39]
    s_waitcnt vmcnt(14) lgkmcnt(4)
    v_mfma_f32_16x16x32_bf16 v[16:19], v[76:79], v[120:123], v[16:19]
    ds_read_b128 v[40:43], v12 offset:18432
    v_mfma_f32_16x16x32_bf16 v[20:23], v[80:83], v[120:123], v[20:23]
    ds_read_b128 v[44:47], v12 offset:19456
    v_mfma_f32_16x16x32_bf16 v[24:27], v[84:87], v[120:123], v[24:27]
    ds_read_b128 v[48:51], v12 offset:20480
    v_mfma_f32_16x16x32_bf16 v[28:31], v[88:91], v[120:123], v[28:31]
    ds_read_b128 v[52:55], v12 offset:21504
    buffer_load_dwordx4 v[208:211], v4, s[4:7], s34 offen offset:0
    v_mfma_f32_16x16x32_bf16 v[32:35], v[108:111], v[120:123], v[32:35]
    ds_read_b128 v[72:75], v12 offset:26624
    s_waitcnt lgkmcnt(5)
    v_mfma_f32_16x16x32_bf16 v[16:19], v[92:95], v[124:127], v[16:19]
    ds_read_b128 v[56:59], v12 offset:22528
    buffer_load_dwordx4 v[212:215], v4, s[4:7], s34 offen offset:1024
    v_mfma_f32_16x16x32_bf16 v[20:23], v[96:99], v[124:127], v[20:23]
    ds_read_b128 v[60:63], v12 offset:23552
    v_mfma_f32_16x16x32_bf16 v[24:27], v[100:103], v[124:127], v[24:27]
    ds_read_b128 v[64:67], v12 offset:24576
    buffer_load_dwordx2 v[216:217], v5, s[4:7], s34 offen
    v_mfma_f32_16x16x32_bf16 v[28:31], v[104:107], v[124:127], v[28:31]
    ds_read_b128 v[68:71], v12 offset:25600
    v_mfma_f32_16x16x32_bf16 v[36:39], v[108:111], v[124:127], v[36:39]
    s_waitcnt vmcnt(15) lgkmcnt(4)
    v_mfma_f32_16x16x32_bf16 v[16:19], v[40:43], v[128:131], v[16:19]
    ds_read_b128 v[76:79], v12 offset:27648
    v_mfma_f32_16x16x32_bf16 v[20:23], v[44:47], v[128:131], v[20:23]
    ds_read_b128 v[80:83], v12 offset:28672
    v_mfma_f32_16x16x32_bf16 v[24:27], v[48:51], v[128:131], v[24:27]
    ds_read_b128 v[84:87], v12 offset:29696
    v_mfma_f32_16x16x32_bf16 v[28:31], v[52:55], v[128:131], v[28:31]
    ds_read_b128 v[88:91], v12 offset:30720
    v_mfma_f32_16x16x32_bf16 v[32:35], v[72:75], v[128:131], v[32:35]
    ds_read_b128 v[108:111], v12 offset:35840
    s_waitcnt lgkmcnt(5)
    v_mfma_f32_16x16x32_bf16 v[16:19], v[56:59], v[132:135], v[16:19]
    ds_read_b128 v[92:95], v12 offset:31744
    v_mfma_f32_16x16x32_bf16 v[20:23], v[60:63], v[132:135], v[20:23]
    ds_read_b128 v[96:99], v12 offset:32768
    v_mfma_f32_16x16x32_bf16 v[24:27], v[64:67], v[132:135], v[24:27]
    ds_read_b128 v[100:103], v12 offset:33792
    v_mfma_f32_16x16x32_bf16 v[28:31], v[68:71], v[132:135], v[28:31]
    ds_read_b128 v[104:107], v12 offset:34816
    v_mfma_f32_16x16x32_bf16 v[36:39], v[72:75], v[132:135], v[36:39]
    s_waitcnt vmcnt(13) lgkmcnt(0)
    s_barrier
    v_mfma_f32_16x16x32_bf16 v[16:19], v[76:79], v[136:139], v[16:19]
    ds_read_b128 v[40:43], v13 offset:0
    v_mfma_f32_16x16x32_bf16 v[20:23], v[80:83], v[136:139], v[20:23]
    ds_read_b128 v[44:47], v13 offset:1024
    v_mfma_f32_16x16x32_bf16 v[24:27], v[84:87], v[136:139], v[24:27]
    ds_read_b128 v[48:51], v13 offset:2048
    v_mfma_f32_16x16x32_bf16 v[28:31], v[88:91], v[136:139], v[28:31]
    ds_read_b128 v[52:55], v13 offset:3072
    v_mfma_f32_16x16x32_bf16 v[32:35], v[108:111], v[136:139], v[32:35]
    ds_read_b128 v[72:75], v13 offset:8192
    v_mfma_f32_16x16x32_bf16 v[16:19], v[92:95], v[140:143], v[16:19]
    ds_read_b128 v[56:59], v13 offset:4096
    v_mfma_f32_16x16x32_bf16 v[20:23], v[96:99], v[140:143], v[20:23]
    ds_read_b128 v[60:63], v13 offset:5120
    v_mfma_f32_16x16x32_bf16 v[24:27], v[100:103], v[140:143], v[24:27]
    ds_read_b128 v[64:67], v13 offset:6144
    v_mfma_f32_16x16x32_bf16 v[28:31], v[104:107], v[140:143], v[28:31]
    ds_read_b128 v[68:71], v13 offset:7168
    v_mfma_f32_16x16x32_bf16 v[36:39], v[108:111], v[140:143], v[36:39]
    s_waitcnt vmcnt(11) lgkmcnt(4)
    v_mfma_f32_16x16x32_bf16 v[16:19], v[40:43], v[144:147], v[16:19]
    ds_read_b128 v[76:79], v13 offset:9216
    v_mfma_f32_16x16x32_bf16 v[20:23], v[44:47], v[144:147], v[20:23]
    ds_read_b128 v[80:83], v13 offset:10240
    v_mfma_f32_16x16x32_bf16 v[24:27], v[48:51], v[144:147], v[24:27]
    ds_read_b128 v[84:87], v13 offset:11264
    v_mfma_f32_16x16x32_bf16 v[28:31], v[52:55], v[144:147], v[28:31]
    ds_read_b128 v[88:91], v13 offset:12288
    v_mfma_f32_16x16x32_bf16 v[32:35], v[72:75], v[144:147], v[32:35]
    ds_read_b128 v[108:111], v13 offset:17408
    s_waitcnt lgkmcnt(5)
    v_mfma_f32_16x16x32_bf16 v[16:19], v[56:59], v[148:151], v[16:19]
    ds_read_b128 v[92:95], v13 offset:13312
    v_mfma_f32_16x16x32_bf16 v[20:23], v[60:63], v[148:151], v[20:23]
    ds_read_b128 v[96:99], v13 offset:14336
    v_mfma_f32_16x16x32_bf16 v[24:27], v[64:67], v[148:151], v[24:27]
    ds_read_b128 v[100:103], v13 offset:15360
    v_mfma_f32_16x16x32_bf16 v[28:31], v[68:71], v[148:151], v[28:31]
    ds_read_b128 v[104:107], v13 offset:16384
    v_mfma_f32_16x16x32_bf16 v[36:39], v[72:75], v[148:151], v[36:39]
    s_waitcnt vmcnt(9) lgkmcnt(4)
    v_mfma_f32_16x16x32_bf16 v[16:19], v[76:79], v[152:155], v[16:19]
    ds_read_b128 v[40:43], v13 offset:18432
    v_mfma_f32_16x16x32_bf16 v[20:23], v[80:83], v[152:155], v[20:23]
    ds_read_b128 v[44:47], v13 offset:19456
    v_mfma_f32_16x16x32_bf16 v[24:27], v[84:87], v[152:155], v[24:27]
    ds_read_b128 v[48:51], v13 offset:20480
    v_mfma_f32_16x16x32_bf16 v[28:31], v[88:91], v[152:155], v[28:31]
    ds_read_b128 v[52:55], v13 offset:21504
    v_mfma_f32_16x16x32_bf16 v[32:35], v[108:111], v[152:155], v[32:35]
    ds_read_b128 v[72:75], v13 offset:26624
    s_waitcnt lgkmcnt(5)
    v_mfma_f32_16x16x32_bf16 v[16:19], v[92:95], v[156:159], v[16:19]
    ds_read_b128 v[56:59], v13 offset:22528
    v_mfma_f32_16x16x32_bf16 v[20:23], v[96:99], v[156:159], v[20:23]
    ds_read_b128 v[60:63], v13 offset:23552
    v_mfma_f32_16x16x32_bf16 v[24:27], v[100:103], v[156:159], v[24:27]
    ds_read_b128 v[64:67], v13 offset:24576
    v_mfma_f32_16x16x32_bf16 v[28:31], v[104:107], v[156:159], v[28:31]
    ds_read_b128 v[68:71], v13 offset:25600
    v_mfma_f32_16x16x32_bf16 v[36:39], v[108:111], v[156:159], v[36:39]
    s_waitcnt vmcnt(7) lgkmcnt(4)
    v_mfma_f32_16x16x32_bf16 v[16:19], v[40:43], v[160:163], v[16:19]
    ds_read_b128 v[76:79], v13 offset:27648
    v_mfma_f32_16x16x32_bf16 v[20:23], v[44:47], v[160:163], v[20:23]
    ds_read_b128 v[80:83], v13 offset:28672
    v_mfma_f32_16x16x32_bf16 v[24:27], v[48:51], v[160:163], v[24:27]
    ds_read_b128 v[84:87], v13 offset:29696
    v_mfma_f32_16x16x32_bf16 v[28:31], v[52:55], v[160:163], v[28:31]
    ds_read_b128 v[88:91], v13 offset:30720
    v_mfma_f32_16x16x32_bf16 v[32:35], v[72:75], v[160:163], v[32:35]
    ds_read_b128 v[108:111], v13 offset:35840
    s_waitcnt lgkmcnt(5)
    v_mfma_f32_16x16x32_bf16 v[16:19], v[56:59], v[164:167], v[16:19]
    ds_read_b128 v[92:95], v13 offset:31744
    v_mfma_f32_16x16x32_bf16 v[20:23], v[60:63], v[164:167], v[20:23]
    ds_read_b128 v[96:99], v13 offset:32768
    v_mfma_f32_16x16x32_bf16 v[24:27], v[64:67], v[164:167], v[24:27]
    ds_read_b128 v[100:103], v13 offset:33792
    v_mfma_f32_16x16x32_bf16 v[28:31], v[68:71], v[164:167], v[28:31]
    ds_read_b128 v[104:107], v13 offset:34816
    v_mfma_f32_16x16x32_bf16 v[36:39], v[72:75], v[164:167], v[36:39]
    s_waitcnt vmcnt(5) lgkmcnt(0)
    s_barrier
    v_mfma_f32_16x16x32_bf16 v[16:19], v[76:79], v[168:171], v[16:19]
    ds_read_b128 v[40:43], v14 offset:0
    v_mfma_f32_16x16x32_bf16 v[20:23], v[80:83], v[168:171], v[20:23]
    ds_read_b128 v[44:47], v14 offset:1024
    v_mfma_f32_16x16x32_bf16 v[24:27], v[84:87], v[168:171], v[24:27]
    ds_read_b128 v[48:51], v14 offset:2048
    v_mfma_f32_16x16x32_bf16 v[28:31], v[88:91], v[168:171], v[28:31]
    ds_read_b128 v[52:55], v14 offset:3072
    v_mfma_f32_16x16x32_bf16 v[32:35], v[108:111], v[168:171], v[32:35]
    ds_read_b128 v[72:75], v14 offset:8192
    v_mfma_f32_16x16x32_bf16 v[16:19], v[92:95], v[172:175], v[16:19]
    ds_read_b128 v[56:59], v14 offset:4096
    v_mfma_f32_16x16x32_bf16 v[20:23], v[96:99], v[172:175], v[20:23]
    ds_read_b128 v[60:63], v14 offset:5120
    v_mfma_f32_16x16x32_bf16 v[24:27], v[100:103], v[172:175], v[24:27]
    ds_read_b128 v[64:67], v14 offset:6144
    v_mfma_f32_16x16x32_bf16 v[28:31], v[104:107], v[172:175], v[28:31]
    ds_read_b128 v[68:71], v14 offset:7168
    v_mfma_f32_16x16x32_bf16 v[36:39], v[108:111], v[172:175], v[36:39]
    s_waitcnt vmcnt(3) lgkmcnt(0)
    v_mfma_f32_16x16x32_bf16 v[16:19], v[40:43], v[176:179], v[16:19]
    v_mfma_f32_16x16x32_bf16 v[20:23], v[44:47], v[176:179], v[20:23]
    v_mfma_f32_16x16x32_bf16 v[24:27], v[48:51], v[176:179], v[24:27]
    v_mfma_f32_16x16x32_bf16 v[28:31], v[52:55], v[176:179], v[28:31]
    v_mfma_f32_16x16x32_bf16 v[32:35], v[72:75], v[176:179], v[32:35]
    v_mfma_f32_16x16x32_bf16 v[16:19], v[56:59], v[180:183], v[16:19]
    v_mfma_f32_16x16x32_bf16 v[20:23], v[60:63], v[180:183], v[20:23]
    v_mfma_f32_16x16x32_bf16 v[24:27], v[64:67], v[180:183], v[24:27]
    v_mfma_f32_16x16x32_bf16 v[28:31], v[68:71], v[180:183], v[28:31]
    v_mfma_f32_16x16x32_bf16 v[36:39], v[72:75], v[180:183], v[36:39]
    s_and_b32 s30, s30, 0xfffe
    s_mov_b32 s38, s21
    s_mul_i32 s34, s30, 18432
    s_add_u32 s34, s34, s38
    s_add_u32 s34, s34, 0x300000
    s_lshl_b32 s39, s30, 10
    s_add_u32 s39, s39, s38
    s_add_u32 s39, s39, 0x2420000
    v_mul_u32_u24 v9, 18432, v7
    v_lshl_add_u32 v9, v8, 4, v9
    v_lshl_add_u32 v4, v3, 8, v9
    v_add_u32 v4, s35, v4
    v_lshl_add_u32 v5, v3, 3, v9
    v_add_u32 v5, s36, v5
    v_cndmask_b32 v5, v6, v5, s[40:41]
    s_lshr_b32 s42, s24, 1
    s_lshl_b32 s42, s42, 8
    s_and_b32 s43, s24, 1
    s_lshl_b32 s43, s43, 3
    s_add_u32 s42, s42, s43
    v_lshlrev_b32 v10, 10, v7
    v_lshl_add_u32 v10, v8, 4, v10
    v_add_u32 v10, s42, v10
    v_cmp_eq_u32 vcc, 0, v3
    v_mov_b32 v11, 0x3f803f80
    s_nop 0
    v_cndmask_b32 v10, v6, v10, vcc
    s_waitcnt vmcnt(0)
    v_permlane32_swap_b32 v36, v220
    v_permlane32_swap_b32 v37, v221
    v_permlane32_swap_b32 v38, v222
    v_permlane32_swap_b32 v39, v223
    v_lshlrev_b32 v224, 16, v208
    v_and_b32 v225, 0xffff0000, v208
    v_lshlrev_b32 v226, 16, v209
    v_and_b32 v227, 0xffff0000, v209
    v_lshlrev_b32 v228, 16, v210
    v_and_b32 v229, 0xffff0000, v210
    v_lshlrev_b32 v230, 16, v211
    v_and_b32 v231, 0xffff0000, v211
    v_lshlrev_b32 v232, 16, v212
    v_and_b32 v233, 0xffff0000, v212
    v_lshlrev_b32 v234, 16, v213
    v_and_b32 v235, 0xffff0000, v213
    v_lshlrev_b32 v236, 16, v214
    v_and_b32 v237, 0xffff0000, v214
    v_lshlrev_b32 v238, 16, v215
    v_and_b32 v239, 0xffff0000, v215
    v_lshlrev_b32 v240, 16, v216
    v_and_b32 v241, 0xffff0000, v216
    v_lshlrev_b32 v242, 16, v217
    v_and_b32 v243, 0xffff0000, v217
    v_pk_add_f32 v[32:33], v[32:33], v[220:221]
    v_pk_add_f32 v[34:35], v[34:35], v[222:223]
    v_pk_add_f32 v[16:17], v[16:17], v[224:225]
    v_pk_add_f32 v[18:19], v[18:19], v[226:227]
    v_pk_add_f32 v[20:21], v[20:21], v[228:229]
    v_pk_add_f32 v[22:23], v[22:23], v[230:231]
    v_pk_add_f32 v[24:25], v[24:25], v[232:233]
    v_pk_add_f32 v[26:27], v[26:27], v[234:235]
    v_pk_add_f32 v[28:29], v[28:29], v[236:237]
    v_pk_add_f32 v[30:31], v[30:31], v[238:239]
    v_pk_add_f32 v[32:33], v[32:33], v[240:241]
    v_pk_add_f32 v[34:35], v[34:35], v[242:243]
    v_cvt_pk_bf16_f32 v208, v16, v17
    v_cvt_pk_bf16_f32 v209, v18, v19
    v_cvt_pk_bf16_f32 v210, v20, v21
    v_cvt_pk_bf16_f32 v211, v22, v23
    v_cvt_pk_bf16_f32 v212, v24, v25
    v_cvt_pk_bf16_f32 v213, v26, v27
    v_cvt_pk_bf16_f32 v214, v28, v29
    v_cvt_pk_bf16_f32 v215, v30, v31
    v_cvt_pk_bf16_f32 v216, v32, v33
    v_cvt_pk_bf16_f32 v217, v34, v35
    buffer_store_dwordx4 v[208:211], v4, s[4:7], s34 offen offset:0
    buffer_store_dwordx4 v[212:215], v4, s[4:7], s34 offen offset:1024
    buffer_store_dwordx2 v[216:217], v5, s[4:7], s34 offen
    v_cndmask_b32 v222, 0, v216, s[40:41]
    v_cndmask_b32 v223, 0, v217, s[40:41]
    v_mov_b32 v220, 0
    v_mov_b32 v221, 0
    v_dot2_f32_bf16 v220, v208, v11, v220
    v_dot2_f32_bf16 v221, v208, v208, v221
    v_dot2_f32_bf16 v220, v209, v11, v220
    v_dot2_f32_bf16 v221, v209, v209, v221
    v_dot2_f32_bf16 v220, v210, v11, v220
    v_dot2_f32_bf16 v221, v210, v210, v221
    v_dot2_f32_bf16 v220, v211, v11, v220
    v_dot2_f32_bf16 v221, v211, v211, v221
    v_dot2_f32_bf16 v220, v212, v11, v220
    v_dot2_f32_bf16 v221, v212, v212, v221
    v_dot2_f32_bf16 v220, v213, v11, v220
    v_dot2_f32_bf16 v221, v213, v213, v221
    v_dot2_f32_bf16 v220, v214, v11, v220
    v_dot2_f32_bf16 v221, v214, v214, v221
    v_dot2_f32_bf16 v220, v215, v11, v220
    v_dot2_f32_bf16 v221, v215, v215, v221
    v_dot2_f32_bf16 v220, v222, v11, v220
    v_dot2_f32_bf16 v221, v222, v222, v221
    v_dot2_f32_bf16 v220, v223, v11, v220
    v_dot2_f32_bf16 v221, v223, v223, v221
    s_nop 2
    v_mov_b32 v222, v220
    v_mov_b32 v223, v221
    s_nop 1
    v_permlane32_swap_b32 v220, v222
    v_permlane32_swap_b32 v221, v223
    v_add_f32 v220, v220, v222
    v_add_f32 v221, v221, v223
    v_mov_b32 v222, v220
    v_mov_b32 v223, v221
    s_nop 1
    v_permlane16_swap_b32 v220, v222
    v_permlane16_swap_b32 v221, v223
    v_add_f32 v220, v220, v222
    v_add_f32 v221, v221, v223
    buffer_store_dwordx2 v[220:221], v10, s[4:7], s39 offen
    s_endpgm
L_ld_p2:
    s_and_b32 s25, s2, 7
    s_lshr_b32 s26, s2, 3
    s_lshl_b32 s23, s25, 2
    s_lshr_b32 s27, s26, 3
    s_add_u32 s23, s23, s27
    s_and_b32 s24, s26, 7
    s_add_u32 s28, s23, s24
    s_and_b32 s28, s28, 3
    s_mul_i32 s29, s24, 82944
    s_add_u32 s29, s29, 0x7a00000
    s_mul_i32 s30, s20, 9216
    s_mul_i32 s31, s20, 3072
    s_mov_b32 s32, 0
    s_mul_i32 s32, s32, 36864
    s_add_u32 s32, s32, s29
    s_add_u32 s32, s32, s30
    s_add_u32 m0, s30, 0
    s_add_u32 s33, s32, 0
    buffer_load_dwordx4 v1, s[4:7], s33 offen offset:0 lds
    buffer_load_dwordx4 v1, s[4:7], s33 offen offset:1024 lds
    buffer_load_dwordx4 v1, s[4:7], s33 offen offset:2048 lds
    buffer_load_dwordx4 v1, s[4:7], s33 offen offset:3072 lds
    s_add_u32 m0, s30, 4096
    s_add_u32 s33, s32, 4096
    buffer_load_dwordx4 v1, s[4:7], s33 offen offset:0 lds
    buffer_load_dwordx4 v1, s[4:7], s33 offen offset:1024 lds
    buffer_load_dwordx4 v1, s[4:7], s33 offen offset:2048 lds
    buffer_load_dwordx4 v1, s[4:7], s33 offen offset:3072 lds
    s_add_u32 m0, s30, 8192
    s_add_u32 s33, s32, 8192
    buffer_load_dwordx4 v1, s[4:7], s33 offen offset:0 lds
    s_mov_b32 s32, 1
    s_mul_i32 s32, s32, 36864
    s_add_u32 s32, s32, s29
    s_add_u32 s32, s32, s30
    s_add_u32 m0, s30, 36864
    s_add_u32 s33, s32, 0
    buffer_load_dwordx4 v1, s[4:7], s33 offen offset:0 lds
    buffer_load_dwordx4 v1, s[4:7], s33 offen offset:1024 lds
    buffer_load_dwordx4 v1, s[4:7], s33 offen offset:2048 lds
    buffer_load_dwordx4 v1, s[4:7], s33 offen offset:3072 lds
    s_add_u32 m0, s30, 40960
    s_add_u32 s33, s32, 4096
    buffer_load_dwordx4 v1, s[4:7], s33 offen offset:0 lds
    buffer_load_dwordx4 v1, s[4:7], s33 offen offset:1024 lds
    buffer_load_dwordx4 v1, s[4:7], s33 offen offset:2048 lds
    buffer_load_dwordx4 v1, s[4:7], s33 offen offset:3072 lds
    s_add_u32 m0, s30, 45056
    s_add_u32 s33, s32, 8192
    buffer_load_dwordx4 v1, s[4:7], s33 offen offset:0 lds
    s_waitcnt vmcnt(9)
    s_barrier
    s_add_u32 m0, s31, 73728
    s_add_u32 s33, s29, s31
    s_add_u32 s33, s33, 73728
    buffer_load_dwordx4 v1, s[4:7], s33 offen offset:0 lds
    buffer_load_dwordx4 v1, s[4:7], s33 offen offset:1024 lds
    buffer_load_dwordx4 v1, s[4:7], s33 offen offset:2048 lds
    s_waitcnt vmcnt(3)
    s_barrier
    s_waitcnt vmcnt(0)
    s_barrier
L_end_p2:
    s_endpgm

.globl p3l0_kernel
.p2align 8
.type p3l0_kernel,@function
p3l0_kernel:
    s_mov_b32 s22, 0
L_go_p3:
    s_cmp_ge_u32 s2, 256
    s_cbranch_scc1 L_end_p3
    s_load_dwordx2 s[24:25], s[0:1], 80
    s_load_dwordx4 s[28:31], s[0:1], 40
    s_load_dwordx2 s[26:27], s[0:1], 64
    v_lshrrev_b32 v2, 6, v0
    v_and_b32 v1, 63, v0
    v_lshlrev_b32 v1, 4, v1
    v_readfirstlane_b32 s23, v2
    v_mov_b32 v2, 163832
    v_mov_b32 v3, 0
    ds_write_b32 v2, v3
    s_mul_i32 s21, s22, 0x2800000
    s_and_b32 s20, s23, 3
    s_waitcnt lgkmcnt(0)
    s_mov_b32 s4, s24
    s_mov_b32 s5, s25
    s_mov_b32 s6, 0x10000000
    s_mov_b32 s7, 0x20000
    s_mov_b32 s8, s28
    s_mov_b32 s9, s29
    s_mov_b32 s10, 0x800000
    s_mov_b32 s11, 0x20000
    s_mov_b32 s12, s30
    s_mov_b32 s13, s31
    s_mov_b32 s14, 0x1000
    s_mov_b32 s15, 0x20000
    s_mov_b32 s16, s26
    s_mov_b32 s17, s27
    s_mov_b32 s18, 0x240000
    s_mov_b32 s19, 0x20000
    s_cmp_ge_u32 s23, 4
    s_cbranch_scc1 L_ld_p3
    s_and_b32 s25, s2, 7
    s_lshr_b32 s26, s2, 3
    s_and_b32 s23, s25, 1
    s_lshl_b32 s23, s23, 3
    s_and_b32 s27, s26, 7
    s_add_u32 s23, s23, s27
    s_lshr_b32 s24, s25, 1
    s_lshl_b32 s24, s24, 2
    s_lshr_b32 s27, s26, 3
    s_add_u32 s24, s24, s27
    s_add_u32 s28, s23, s24
    s_and_b32 s28, s28, 3
    s_lshl_b32 s30, s20, 12
    s_lshl_b32 s31, s23, 3
    s_lshl_b32 s33, s20, 1
    s_add_u32 s31, s31, s33
    s_lshl_b32 s32, s31, 10
    s_add_u32 s32, s32, s21
    s_add_u32 s32, s32, 0x2420000
    v_add_u32 v2, 36864, v1
    s_add_u32 s33, s30, 73728
    v_add_u32 v3, s33, v1
    s_lshr_b32 s34, s31, 1
    s_lshl_b32 s35, s34, 12
    s_add_u32 s35, s35, s21
    s_add_u32 s35, s35, 0x2440000
    s_lshl_b32 s36, s24, 8
    s_add_u32 s36, s36, s35
    s_lshl_b32 s37, s22, 8
    s_add_u32 s37, s37, s34
    s_lshl_b32 s37, s37, 8
    s_add_u32 s37, s37, 0x8504000
    s_lshl_b32 s38, s24, 6
    s_add_u32 s38, s38, s34
    s_mul_i32 s38, s38, 9216
    s_add_u32 s38, s38, s21
    s_add_u32 s38, s38, 0x1200000
    buffer_load_dwordx4 v[8:11], v1, s[4:7], s32 offen offset:0
    buffer_load_dwordx4 v[12:15], v1, s[4:7], s32 offen offset:1024
    s_barrier
    ds_read_b128 v[160:163], v3 offset:0
    ds_read_b128 v[164:167], v3 offset:2048
    ds_read_b128 v[168:171], v1 offset:0
    ds_read_b128 v[172:175], v1 offset:1024
    ds_read_b128 v[176:179], v1 offset:2048
    ds_read_b128 v[180:183], v1 offset:3072
    ds_read_b128 v[184:187], v1 offset:4096
    ds_read_b128 v[188:191], v1 offset:5120
    ds_read_b128 v[192:195], v1 offset:6144
    ds_read_b128 v[196:199], v1 offset:7168
    ds_read_b128 v[200:203], v1 offset:8192
    s_waitcnt lgkmcnt(5)
    v_mfma_f32_16x16x32_bf16 v[16:19], v[160:163], v[168:171], 0
    ds_read_b128 v[204:207], v3 offset:1024
    v_mfma_f32_16x16x32_bf16 v[20:23], v[164:167], v[168:171], 0
    ds_read_b128 v[208:211], v3 offset:3072
    v_mfma_f32_16x16x32_bf16 v[24:27], v[160:163], v[172:175], 0
    ds_read_b128 v[212:215], v1 offset:9216
    v_mfma_f32_16x16x32_bf16 v[28:31], v[164:167], v[172:175], 0
    ds_read_b128 v[216:219], v1 offset:10240
    v_mfma_f32_16x16x32_bf16 v[32:35], v[160:163], v[176:179], 0
    ds_read_b128 v[220:223], v1 offset:11264
    v_mfma_f32_16x16x32_bf16 v[36:39], v[164:167], v[176:179], 0
    ds_read_b128 v[224:227], v1 offset:12288
    v_mfma_f32_16x16x32_bf16 v[40:43], v[160:163], v[180:183], 0
    ds_read_b128 v[228:231], v1 offset:13312
    v_mfma_f32_16x16x32_bf16 v[44:47], v[164:167], v[180:183], 0
    ds_read_b128 v[232:235], v1 offset:14336
    s_waitcnt lgkmcnt(8)
    v_mfma_f32_16x16x32_bf16 v[48:51], v[160:163], v[184:187], 0
    ds_read_b128 v[236:239], v1 offset:15360
    v_mfma_f32_16x16x32_bf16 v[52:55], v[164:167], v[184:187], 0
    ds_read_b128 v[240:243], v1 offset:16384
    v_mfma_f32_16x16x32_bf16 v[56:59], v[160:163], v[188:191], 0
    ds_read_b128 v[244:247], v1 offset:17408
    v_mfma_f32_16x16x32_bf16 v[60:63], v[164:167], v[188:191], 0
    v_mfma_f32_16x16x32_bf16 v[64:67], v[160:163], v[192:195], 0
    v_mfma_f32_16x16x32_bf16 v[68:71], v[164:167], v[192:195], 0
    v_mfma_f32_16x16x32_bf16 v[72:75], v[160:163], v[196:199], 0
    v_mfma_f32_16x16x32_bf16 v[76:79], v[164:167], v[196:199], 0
    v_mfma_f32_16x16x32_bf16 v[80:83], v[160:163], v[200:203], 0
    v_mfma_f32_16x16x32_bf16 v[84:87], v[164:167], v[200:203], 0
    s_waitcnt lgkmcnt(0)
    s_barrier
    v_mfma_f32_16x16x32_bf16 v[16:19], v[204:207], v[212:215], v[16:19]
    ds_read_b128 v[160:163], v3 offset:16384
    v_mfma_f32_16x16x32_bf16 v[20:23], v[208:211], v[212:215], v[20:23]
    ds_read_b128 v[164:167], v3 offset:18432
    v_mfma_f32_16x16x32_bf16 v[24:27], v[204:207], v[216:219], v[24:27]
    ds_read_b128 v[168:171], v1 offset:18432
    v_mfma_f32_16x16x32_bf16 v[28:31], v[208:211], v[216:219], v[28:31]
    ds_read_b128 v[172:175], v1 offset:19456
    v_mfma_f32_16x16x32_bf16 v[32:35], v[204:207], v[220:223], v[32:35]
    ds_read_b128 v[176:179], v1 offset:20480
    v_mfma_f32_16x16x32_bf16 v[36:39], v[208:211], v[220:223], v[36:39]
    ds_read_b128 v[180:183], v1 offset:21504
    v_mfma_f32_16x16x32_bf16 v[40:43], v[204:207], v[224:227], v[40:43]
    ds_read_b128 v[184:187], v1 offset:22528
    v_mfma_f32_16x16x32_bf16 v[44:47], v[208:211], v[224:227], v[44:47]
    ds_read_b128 v[188:191], v1 offset:23552
    v_mfma_f32_16x16x32_bf16 v[48:51], v[204:207], v[228:231], v[48:51]
    ds_read_b128 v[192:195], v1 offset:24576
    v_mfma_f32_16x16x32_bf16 v[52:55], v[208:211], v[228:231], v[52:55]
    ds_read_b128 v[196:199], v1 offset:25600
    v_mfma_f32_16x16x32_bf16 v[56:59], v[204:207], v[232:235], v[56:59]
    ds_read_b128 v[200:203], v1 offset:26624
    v_mfma_f32_16x16x32_bf16 v[60:63], v[208:211], v[232:235], v[60:63]
    v_mfma_f32_16x16x32_bf16 v[64:67], v[204:207], v[236:239], v[64:67]
    v_mfma_f32_16x16x32_bf16 v[68:71], v[208:211], v[236:239], v[68:71]
    v_mfma_f32_16x16x32_bf16 v[72:75], v[204:207], v[240:243], v[72:75]
    v_mfma_f32_16x16x32_bf16 v[76:79], v[208:211], v[240:243], v[76:79]
    v_mfma_f32_16x16x32_bf16 v[80:83], v[204:207], v[244:247], v[80:83]
    v_mfma_f32_16x16x32_bf16 v[84:87], v[208:211], v[244:247], v[84:87]
    s_waitcnt lgkmcnt(5)
    v_mfma_f32_16x16x32_bf16 v[16:19], v[160:163], v[168:171], v[16:19]
    ds_read_b128 v[204:207], v3 offset:17408
    v_mfma_f32_16x16x32_bf16 v[20:23], v[164:167], v[168:171], v[20:23]
    ds_read_b128 v[208:211], v3 offset:19456
    v_mfma_f32_16x16x32_bf16 v[24:27], v[160:163], v[172:175], v[24:27]
    ds_read_b128 v[212:215], v1 offset:27648
    v_mfma_f32_16x16x32_bf16 v[28:31], v[164:167], v[172:175], v[28:31]
    ds_read_b128 v[216:219], v1 offset:28672
    v_mfma_f32_16x16x32_bf16 v[32:35], v[160:163], v[176:179], v[32:35]
    ds_read_b128 v[220:223], v1 offset:29696
    v_mfma_f32_16x16x32_bf16 v[36:39], v[164:167], v[176:179], v[36:39]
    ds_read_b128 v[224:227], v1 offset:30720
    v_mfma_f32_16x16x32_bf16 v[40:43], v[160:163], v[180:183], v[40:43]
    ds_read_b128 v[228:231], v1 offset:31744
    v_mfma_f32_16x16x32_bf16 v[44:47], v[164:167], v[180:183], v[44:47]
    ds_read_b128 v[232:235], v1 offset:32768
    s_waitcnt lgkmcnt(8)
    v_mfma_f32_16x16x32_bf16 v[48:51], v[160:163], v[184:187], v[48:51]
    ds_read_b128 v[236:239], v1 offset:33792
    v_mfma_f32_16x16x32_bf16 v[52:55], v[164:167], v[184:187], v[52:55]
    ds_read_b128 v[240:243], v1 offset:34816
    v_mfma_f32_16x16x32_bf16 v[56:59], v[160:163], v[188:191], v[56:59]
    ds_read_b128 v[244:247], v1 offset:35840
    v_mfma_f32_16x16x32_bf16 v[60:63], v[164:167], v[188:191], v[60:63]
    s_waitcnt vmcnt(0)
    v_mfma_f32_16x16x32_bf16 v[64:67], v[160:163], v[192:195], v[64:67]
    v_add_f32 v248, v8, v10
    v_mfma_f32_16x16x32_bf16 v[68:71], v[164:167], v[192:195], v[68:71]
    v_add_f32 v249, v9, v11
    v_mfma_f32_16x16x32_bf16 v[72:75], v[160:163], v[196:199], v[72:75]
    v_add_f32 v250, v12, v14
    v_mfma_f32_16x16x32_bf16 v[76:79], v[164:167], v[196:199], v[76:79]
    v_add_f32 v251, v13, v15
    v_mfma_f32_16x16x32_bf16 v[80:83], v[160:163], v[200:203], v[80:83]
    v_mov_b32 v8, v248
    v_mfma_f32_16x16x32_bf16 v[84:87], v[164:167], v[200:203], v[84:87]
    v_mov_b32 v9, v249
    s_waitcnt lgkmcnt(0)
    s_barrier
    v_mfma_f32_16x16x32_bf16 v[16:19], v[204:207], v[212:215], v[16:19]
    ds_read_b128 v[160:163], v3 offset:32768
    v_mfma_f32_16x16x32_bf16 v[20:23], v[208:211], v[212:215], v[20:23]
    ds_read_b128 v[164:167], v3 offset:34816
    v_mfma_f32_16x16x32_bf16 v[24:27], v[204:207], v[216:219], v[24:27]
    ds_read_b128 v[168:171], v2 offset:0
    v_mfma_f32_16x16x32_bf16 v[28:31], v[208:211], v[216:219], v[28:31]
    ds_read_b128 v[172:175], v2 offset:1024
    v_mfma_f32_16x16x32_bf16 v[32:35], v[204:207], v[220:223], v[32:35]
    ds_read_b128 v[176:179], v2 offset:2048
    v_mfma_f32_16x16x32_bf16 v[36:39], v[208:211], v[220:223], v[36:39]
    ds_read_b128 v[180:183], v2 offset:3072
    v_mfma_f32_16x16x32_bf16 v[40:43], v[204:207], v[224:227], v[40:43]
    ds_read_b128 v[184:187], v2 offset:4096
    v_mfma_f32_16x16x32_bf16 v[44:47], v[208:211], v[224:227], v[44:47]
    ds_read_b128 v[188:191], v2 offset:5120
    v_mfma_f32_16x16x32_bf16 v[48:51], v[204:207], v[228:231], v[48:51]
    ds_read_b128 v[192:195], v2 offset:6144
    v_mfma_f32_16x16x32_bf16 v[52:55], v[208:211], v[228:231], v[52:55]
    ds_read_b128 v[196:199], v2 offset:7168
    v_mfma_f32_16x16x32_bf16 v[56:59], v[204:207], v[232:235], v[56:59]
    ds_read_b128 v[200:203], v2 offset:8192
    v_mfma_f32_16x16x32_bf16 v[60:63], v[208:211], v[232:235], v[60:63]
    v_mov_b32 v12, v250
    v_mfma_f32_16x16x32_bf16 v[64:67], v[204:207], v[236:239], v[64:67]
    v_mov_b32 v13, v251
    v_mfma_f32_16x16x32_bf16 v[68:71], v[208:211], v[236:239], v[68:71]
    v_permlane32_swap_b32 v248, v8
    v_mfma_f32_16x16x32_bf16 v[72:75], v[204:207], v[240:243], v[72:75]
    v_permlane32_swap_b32 v249, v9
    v_mfma_f32_16x16x32_bf16 v[76:79], v[208:211], v[240:243], v[76:79]
    v_permlane32_swap_b32 v250, v12
    v_mfma_f32_16x16x32_bf16 v[80:83], v[204:207], v[244:247], v[80:83]
    v_permlane32_swap_b32 v251, v13
    v_mfma_f32_16x16x32_bf16 v[84:87], v[208:211], v[244:247], v[84:87]
    v_add_f32 v248, v248, v8
    s_waitcnt lgkmcnt(5)
    v_mfma_f32_16x16x32_bf16 v[16:19], v[160:163], v[168:171], v[16:19]
    ds_read_b128 v[204:207], v3 offset:33792
    v_mfma_f32_16x16x32_bf16 v[20:23], v[164:167], v[168:171], v[20:23]
    ds_read_b128 v[208:211], v3 offset:35840
    v_mfma_f32_16x16x32_bf16 v[24:27], v[160:163], v[172:175], v[24:27]
    ds_read_b128 v[212:215], v2 offset:9216
    v_mfma_f32_16x16x32_bf16 v[28:31], v[164:167], v[172:175], v[28:31]
    ds_read_b128 v[216:219], v2 offset:10240
    v_mfma_f32_16x16x32_bf16 v[32:35], v[160:163], v[176:179], v[32:35]
    ds_read_b128 v[220:223], v2 offset:11264
    v_mfma_f32_16x16x32_bf16 v[36:39], v[164:167], v[176:179], v[36:39]
    ds_read_b128 v[224:227], v2 offset:12288
    v_mfma_f32_16x16x32_bf16 v[40:43], v[160:163], v[180:183], v[40:43]
    ds_read_b128 v[228:231], v2 offset:13312
    v_mfma_f32_16x16x32_bf16 v[44:47], v[164:167], v[180:183], v[44:47]
    ds_read_b128 v[232:235], v2 offset:14336
    s_waitcnt lgkmcnt(8)
    v_mfma_f32_16x16x32_bf16 v[48:51], v[160:163], v[184:187], v[48:51]
    ds_read_b128 v[236:239], v2 offset:15360
    v_mfma_f32_16x16x32_bf16 v[52:55], v[164:167], v[184:187], v[52:55]
    ds_read_b128 v[240:243], v2 offset:16384
    v_mfma_f32_16x16x32_bf16 v[56:59], v[160:163], v[188:191], v[56:59]
    ds_read_b128 v[244:247], v2 offset:17408
    v_mfma_f32_16x16x32_bf16 v[60:63], v[164:167], v[188:191], v[60:63]
    v_add_f32 v249, v249, v9
    v_mfma_f32_16x16x32_bf16 v[64:67], v[160:163], v[192:195], v[64:67]
    v_add_f32 v250, v250, v12
    v_mfma_f32_16x16x32_bf16 v[68:71], v[164:167], v[192:195], v[68:71]
    v_add_f32 v251, v251, v13
    v_mfma_f32_16x16x32_bf16 v[72:75], v[160:163], v[196:199], v[72:75]
    v_mov_b32 v8, v248
    v_mfma_f32_16x16x32_bf16 v[76:79], v[164:167], v[196:199], v[76:79]
    v_mov_b32 v9, v249
    v_mfma_f32_16x16x32_bf16 v[80:83], v[160:163], v[200:203], v[80:83]
    v_mov_b32 v12, v250
    v_mfma_f32_16x16x32_bf16 v[84:87], v[164:167], v[200:203], v[84:87]
    v_mov_b32 v13, v251
    s_waitcnt lgkmcnt(0)
    s_barrier
    v_mfma_f32_16x16x32_bf16 v[16:19], v[204:207], v[212:215], v[16:19]
    ds_read_b128 v[160:163], v3 offset:49152
    v_mfma_f32_16x16x32_bf16 v[20:23], v[208:211], v[212:215], v[20:23]
    ds_read_b128 v[164:167], v3 offset:51200
    v_mfma_f32_16x16x32_bf16 v[24:27], v[204:207], v[216:219], v[24:27]
    ds_read_b128 v[168:171], v2 offset:18432
    v_mfma_f32_16x16x32_bf16 v[28:31], v[208:211], v[216:219], v[28:31]
    ds_read_b128 v[172:175], v2 offset:19456
    v_mfma_f32_16x16x32_bf16 v[32:35], v[204:207], v[220:223], v[32:35]
    ds_read_b128 v[176:179], v2 offset:20480
    v_mfma_f32_16x16x32_bf16 v[36:39], v[208:211], v[220:223], v[36:39]
    ds_read_b128 v[180:183], v2 offset:21504
    v_mfma_f32_16x16x32_bf16 v[40:43], v[204:207], v[224:227], v[40:43]
    ds_read_b128 v[184:187], v2 offset:22528
    v_mfma_f32_16x16x32_bf16 v[44:47], v[208:211], v[224:227], v[44:47]
    ds_read_b128 v[188:191], v2 offset:23552
    v_mfma_f32_16x16x32_bf16 v[48:51], v[204:207], v[228:231], v[48:51]
    ds_read_b128 v[192:195], v2 offset:24576
    v_mfma_f32_16x16x32_bf16 v[52:55], v[208:211], v[228:231], v[52:55]
    ds_read_b128 v[196:199], v2 offset:25600
    v_mfma_f32_16x16x32_bf16 v[56:59], v[204:207], v[232:235], v[56:59]
    ds_read_b128 v[200:203], v2 offset:26624
    v_mfma_f32_16x16x32_bf16 v[60:63], v[208:211], v[232:235], v[60:63]
    v_permlane16_swap_b32 v248, v8
    v_mfma_f32_16x16x32_bf16 v[64:67], v[204:207], v[236:239], v[64:67]
    v_permlane16_swap_b32 v249, v9
    v_mfma_f32_16x16x32_bf16 v[68:71], v[208:211], v[236:239], v[68:71]
    v_permlane16_swap_b32 v250, v12
    v_mfma_f32_16x16x32_bf16 v[72:75], v[204:207], v[240:243], v[72:75]
    v_permlane16_swap_b32 v251, v13
    v_mfma_f32_16x16x32_bf16 v[76:79], v[208:211], v[240:243], v[76:79]
    v_add_f32 v248, v248, v8
    v_mfma_f32_16x16x32_bf16 v[80:83], v[204:207], v[244:247], v[80:83]
    v_add_f32 v249, v249, v9
    v_mfma_f32_16x16x32_bf16 v[84:87], v[208:211], v[244:247], v[84:87]
    v_add_f32 v250, v250, v12
    s_waitcnt lgkmcnt(5)
    v_mfma_f32_16x16x32_bf16 v[16:19], v[160:163], v[168:171], v[16:19]
    ds_read_b128 v[204:207], v3 offset:50176
    v_mfma_f32_16x16x32_bf16 v[20:23], v[164:167], v[168:171], v[20:23]
    ds_read_b128 v[208:211], v3 offset:52224
    v_mfma_f32_16x16x32_bf16 v[24:27], v[160:163], v[172:175], v[24:27]
    ds_read_b128 v[212:215], v2 offset:27648
    v_mfma_f32_16x16x32_bf16 v[28:31], v[164:167], v[172:175], v[28:31]
    ds_read_b128 v[216:219], v2 offset:28672
    v_mfma_f32_16x16x32_bf16 v[32:35], v[160:163], v[176:179], v[32:35]
    ds_read_b128 v[220:223], v2 offset:29696
    v_mfma_f32_16x16x32_bf16 v[36:39], v[164:167], v[176:179], v[36:39]
    ds_read_b128 v[224:227], v2 offset:30720
    v_mfma_f32_16x16x32_bf16 v[40:43], v[160:163], v[180:183], v[40:43]
    ds_read_b128 v[228:231], v2 offset:31744
    v_mfma_f32_16x16x32_bf16 v[44:47], v[164:167], v[180:183], v[44:47]
    ds_read_b128 v[232:235], v2 offset:32768
    s_waitcnt lgkmcnt(8)
    v_mfma_f32_16x16x32_bf16 v[48:51], v[160:163], v[184:187], v[48:51]
    ds_read_b128 v[236:239], v2 offset:33792
    v_mfma_f32_16x16x32_bf16 v[52:55], v[164:167], v[184:187], v[52:55]
    ds_read_b128 v[240:243], v2 offset:34816
    v_mfma_f32_16x16x32_bf16 v[56:59], v[160:163], v[188:191], v[56:59]
    ds_read_b128 v[244:247], v2 offset:35840
    v_mfma_f32_16x16x32_bf16 v[60:63], v[164:167], v[188:191], v[60:63]
    v_add_f32 v251, v251, v13
    v_mfma_f32_16x16x32_bf16 v[64:67], v[160:163], v[192:195], v[64:67]
    v_mul_f32 v248, 0x3ae38e39, v248
    v_mfma_f32_16x16x32_bf16 v[68:71], v[164:167], v[192:195], v[68:71]
    v_mul_f32 v249, 0x3ae38e39, v249
    v_mfma_f32_16x16x32_bf16 v[72:75], v[160:163], v[196:199], v[72:75]
    v_mul_f32 v250, 0x3ae38e39, v250
    v_mfma_f32_16x16x32_bf16 v[76:79], v[164:167], v[196:199], v[76:79]
    v_mul_f32 v251, 0x3ae38e39, v251
    v_mfma_f32_16x16x32_bf16 v[80:83], v[160:163], v[200:203], v[80:83]
    v_fma_f32 v249, -v248, v248, v249
    v_mfma_f32_16x16x32_bf16 v[84:87], v[164:167], v[200:203], v[84:87]
    v_fma_f32 v251, -v250, v250, v251
    s_waitcnt lgkmcnt(0)
    s_barrier
    v_mfma_f32_16x16x32_bf16 v[16:19], v[204:207], v[212:215], v[16:19]
    ds_read_b128 v[160:163], v3 offset:0
    v_mfma_f32_16x16x32_bf16 v[20:23], v[208:211], v[212:215], v[20:23]
    ds_read_b128 v[164:167], v3 offset:2048
    v_mfma_f32_16x16x32_bf16 v[24:27], v[204:207], v[216:219], v[24:27]
    ds_read_b128 v[168:171], v1 offset:0
    v_mfma_f32_16x16x32_bf16 v[28:31], v[208:211], v[216:219], v[28:31]
    ds_read_b128 v[172:175], v1 offset:1024
    v_mfma_f32_16x16x32_bf16 v[32:35], v[204:207], v[220:223], v[32:35]
    ds_read_b128 v[176:179], v1 offset:2048
    v_mfma_f32_16x16x32_bf16 v[36:39], v[208:211], v[220:223], v[36:39]
    ds_read_b128 v[180:183], v1 offset:3072
    v_mfma_f32_16x16x32_bf16 v[40:43], v[204:207], v[224:227], v[40:43]
    ds_read_b128 v[184:187], v1 offset:4096
    v_mfma_f32_16x16x32_bf16 v[44:47], v[208:211], v[224:227], v[44:47]
    ds_read_b128 v[188:191], v1 offset:5120
    v_mfma_f32_16x16x32_bf16 v[48:51], v[204:207], v[228:231], v[48:51]
    ds_read_b128 v[192:195], v1 offset:6144
    v_mfma_f32_16x16x32_bf16 v[52:55], v[208:211], v[228:231], v[52:55]
    ds_read_b128 v[196:199], v1 offset:7168
    v_mfma_f32_16x16x32_bf16 v[56:59], v[204:207], v[232:235], v[56:59]
    ds_read_b128 v[200:203], v1 offset:8192
    v_mfma_f32_16x16x32_bf16 v[60:63], v[208:211], v[232:235], v[60:63]
    v_max_f32 v249, 0, v249
    v_mfma_f32_16x16x32_bf16 v[64:67], v[204:207], v[236:239], v[64:67]
    v_max_f32 v251, 0, v251
    v_mfma_f32_16x16x32_bf16 v[68:71], v[208:211], v[236:239], v[68:71]
    v_add_f32 v249, 0x3727c5ac, v249
    v_mfma_f32_16x16x32_bf16 v[72:75], v[204:207], v[240:243], v[72:75]
    v_add_f32 v251, 0x3727c5ac, v251
    v_mfma_f32_16x16x32_bf16 v[76:79], v[208:211], v[240:243], v[76:79]
    v_rsq_f32 v249, v249
    v_mfma_f32_16x16x32_bf16 v[80:83], v[204:207], v[244:247], v[80:83]
    v_rsq_f32 v251, v251
    v_mfma_f32_16x16x32_bf16 v[84:87], v[208:211], v[244:247], v[84:87]
    s_nop 0
    s_waitcnt lgkmcnt(5)
    v_mfma_f32_16x16x32_bf16 v[16:19], v[160:163], v[168:171], v[16:19]
    ds_read_b128 v[204:207], v3 offset:1024
    v_mfma_f32_16x16x32_bf16 v[20:23], v[164:167], v[168:171], v[20:23]
    ds_read_b128 v[208:211], v3 offset:3072
    v_mfma_f32_16x16x32_bf16 v[24:27], v[160:163], v[172:175], v[24:27]
    ds_read_b128 v[212:215], v1 offset:9216
    v_mfma_f32_16x16x32_bf16 v[28:31], v[164:167], v[172:175], v[28:31]
    ds_read_b128 v[216:219], v1 offset:10240
    v_mfma_f32_16x16x32_bf16 v[32:35], v[160:163], v[176:179], v[32:35]
    ds_read_b128 v[220:223], v1 offset:11264
    v_mfma_f32_16x16x32_bf16 v[36:39], v[164:167], v[176:179], v[36:39]
    ds_read_b128 v[224:227], v1 offset:12288
    v_mfma_f32_16x16x32_bf16 v[40:43], v[160:163], v[180:183], v[40:43]
    ds_read_b128 v[228:231], v1 offset:13312
    v_mfma_f32_16x16x32_bf16 v[44:47], v[164:167], v[180:183], v[44:47]
    ds_read_b128 v[232:235], v1 offset:14336
    s_waitcnt lgkmcnt(8)
    v_mfma_f32_16x16x32_bf16 v[48:51], v[160:163], v[184:187], v[48:51]
    ds_read_b128 v[236:239], v1 offset:15360
    v_mfma_f32_16x16x32_bf16 v[52:55], v[164:167], v[184:187], v[52:55]
    ds_read_b128 v[240:243], v1 offset:16384
    v_mfma_f32_16x16x32_bf16 v[56:59], v[160:163], v[188:191], v[56:59]
    ds_read_b128 v[244:247], v1 offset:17408
    v_mfma_f32_16x16x32_bf16 v[60:63], v[164:167], v[188:191], v[60:63]
    v_bfe_u32 v5, v0, 4, 2
    v_mfma_f32_16x16x32_bf16 v[64:67], v[160:163], v[192:195], v[64:67]
    v_and_b32 v6, 15, v0
    v_mfma_f32_16x16x32_bf16 v[68:71], v[164:167], v[192:195], v[68:71]
    v_lshlrev_b32 v8, 4, v5
    v_mfma_f32_16x16x32_bf16 v[72:75], v[160:163], v[196:199], v[72:75]
    v_add_u32 v9, 4, v8
    v_mfma_f32_16x16x32_bf16 v[76:79], v[164:167], v[196:199], v[76:79]
    v_add_u32 v10, 8, v8
    v_mfma_f32_16x16x32_bf16 v[80:83], v[160:163], v[200:203], v[80:83]
    v_add_u32 v11, 12, v8
    v_mfma_f32_16x16x32_bf16 v[84:87], v[164:167], v[200:203], v[84:87]
    v_lshlrev_b32 v7, 2, v6
    s_waitcnt lgkmcnt(0)
    s_barrier
    v_mfma_f32_16x16x32_bf16 v[16:19], v[204:207], v[212:215], v[16:19]
    ds_read_b128 v[160:163], v3 offset:16384
    v_mfma_f32_16x16x32_bf16 v[20:23], v[208:211], v[212:215], v[20:23]
    ds_read_b128 v[164:167], v3 offset:18432
    v_mfma_f32_16x16x32_bf16 v[24:27], v[204:207], v[216:219], v[24:27]
    ds_read_b128 v[168:171], v1 offset:18432
    v_mfma_f32_16x16x32_bf16 v[28:31], v[208:211], v[216:219], v[28:31]
    ds_read_b128 v[172:175], v1 offset:19456
    v_mfma_f32_16x16x32_bf16 v[32:35], v[204:207], v[220:223], v[32:35]
    ds_read_b128 v[176:179], v1 offset:20480
    v_mfma_f32_16x16x32_bf16 v[36:39], v[208:211], v[220:223], v[36:39]
    ds_read_b128 v[180:183], v1 offset:21504
    v_mfma_f32_16x16x32_bf16 v[40:43], v[204:207], v[224:227], v[40:43]
    ds_read_b128 v[184:187], v1 offset:22528
    v_mfma_f32_16x16x32_bf16 v[44:47], v[208:211], v[224:227], v[44:47]
    ds_read_b128 v[188:191], v1 offset:23552
    v_mfma_f32_16x16x32_bf16 v[48:51], v[204:207], v[228:231], v[48:51]
    ds_read_b128 v[192:195], v1 offset:24576
    v_mfma_f32_16x16x32_bf16 v[52:55], v[208:211], v[228:231], v[52:55]
    ds_read_b128 v[196:199], v1 offset:25600
    v_mfma_f32_16x16x32_bf16 v[56:59], v[204:207], v[232:235], v[56:59]
    ds_read_b128 v[200:203], v1 offset:26624
    v_mfma_f32_16x16x32_bf16 v[60:63], v[208:211], v[232:235], v[60:63]
    v_add_u32 v7, 139264, v7
    v_mfma_f32_16x16x32_bf16 v[64:67], v[204:207], v[236:239], v[64:67]
    v_mfma_f32_16x16x32_bf16 v[68:71], v[208:211], v[236:239], v[68:71]
    v_mfma_f32_16x16x32_bf16 v[72:75], v[204:207], v[240:243], v[72:75]
    v_mfma_f32_16x16x32_bf16 v[76:79], v[208:211], v[240:243], v[76:79]
    v_mfma_f32_16x16x32_bf16 v[80:83], v[204:207], v[244:247], v[80:83]
    v_mfma_f32_16x16x32_bf16 v[84:87], v[208:211], v[244:247], v[84:87]
    s_waitcnt lgkmcnt(5)
    v_mfma_f32_16x16x32_bf16 v[16:19], v[160:163], v[168:171], v[16:19]
    ds_read_b128 v[204:207], v3 offset:17408
    v_mfma_f32_16x16x32_bf16 v[20:23], v[164:167], v[168:171], v[20:23]
    ds_read_b128 v[208:211], v3 offset:19456
    v_mfma_f32_16x16x32_bf16 v[24:27], v[160:163], v[172:175], v[24:27]
    ds_read_b128 v[212:215], v1 offset:27648
    v_mfma_f32_16x16x32_bf16 v[28:31], v[164:167], v[172:175], v[28:31]
    ds_read_b128 v[216:219], v1 offset:28672
    v_mfma_f32_16x16x32_bf16 v[32:35], v[160:163], v[176:179], v[32:35]
    ds_read_b128 v[220:223], v1 offset:29696
    v_mfma_f32_16x16x32_bf16 v[36:39], v[164:167], v[176:179], v[36:39]
    ds_read_b128 v[224:227], v1 offset:30720
    v_mfma_f32_16x16x32_bf16 v[40:43], v[160:163], v[180:183], v[40:43]
    ds_read_b128 v[228:231], v1 offset:31744
    v_mfma_f32_16x16x32_bf16 v[44:47], v[164:167], v[180:183], v[44:47]
    ds_read_b128 v[232:235], v1 offset:32768
    s_waitcnt lgkmcnt(8)
    v_mfma_f32_16x16x32_bf16 v[48:51], v[160:163], v[184:187], v[48:51]
    ds_read_b128 v[236:239], v1 offset:33792
    v_mfma_f32_16x16x32_bf16 v[52:55], v[164:167], v[184:187], v[52:55]
    ds_read_b128 v[240:243], v1 offset:34816
    v_mfma_f32_16x16x32_bf16 v[56:59], v[160:163], v[188:191], v[56:59]
    ds_read_b128 v[244:247], v1 offset:35840
    v_mfma_f32_16x16x32_bf16 v[60:63], v[164:167], v[188:191], v[60:63]
    v_mfma_f32_16x16x32_bf16 v[64:67], v[160:163], v[192:195], v[64:67]
    v_mfma_f32_16x16x32_bf16 v[68:71], v[164:167], v[192:195], v[68:71]
    v_mfma_f32_16x16x32_bf16 v[72:75], v[160:163], v[196:199], v[72:75]
    v_mfma_f32_16x16x32_bf16 v[76:79], v[164:167], v[196:199], v[76:79]
    v_mfma_f32_16x16x32_bf16 v[80:83], v[160:163], v[200:203], v[80:83]
    v_mfma_f32_16x16x32_bf16 v[84:87], v[164:167], v[200:203], v[84:87]
    s_waitcnt lgkmcnt(0)
    s_barrier
    v_mfma_f32_16x16x32_bf16 v[16:19], v[204:207], v[212:215], v[16:19]
    ds_read_b128 v[160:163], v3 offset:32768
    v_mfma_f32_16x16x32_bf16 v[20:23], v[208:211], v[212:215], v[20:23]
    ds_read_b128 v[164:167], v3 offset:34816
    v_mfma_f32_16x16x32_bf16 v[24:27], v[204:207], v[216:219], v[24:27]
    ds_read_b128 v[168:171], v2 offset:0
    v_mfma_f32_16x16x32_bf16 v[28:31], v[208:211], v[216:219], v[28:31]
    ds_read_b128 v[172:175], v2 offset:1024
    v_mfma_f32_16x16x32_bf16 v[32:35], v[204:207], v[220:223], v[32:35]
    ds_read_b128 v[176:179], v2 offset:2048
    v_mfma_f32_16x16x32_bf16 v[36:39], v[208:211], v[220:223], v[36:39]
    ds_read_b128 v[180:183], v2 offset:3072
    v_mfma_f32_16x16x32_bf16 v[40:43], v[204:207], v[224:227], v[40:43]
    ds_read_b128 v[184:187], v2 offset:4096
    v_mfma_f32_16x16x32_bf16 v[44:47], v[208:211], v[224:227], v[44:47]
    ds_read_b128 v[188:191], v2 offset:5120
    v_mfma_f32_16x16x32_bf16 v[48:51], v[204:207], v[228:231], v[48:51]
    ds_read_b128 v[192:195], v2 offset:6144
    v_mfma_f32_16x16x32_bf16 v[52:55], v[208:211], v[228:231], v[52:55]
    ds_read_b128 v[196:199], v2 offset:7168
    v_mfma_f32_16x16x32_bf16 v[56:59], v[204:207], v[232:235], v[56:59]
    ds_read_b128 v[200:203], v2 offset:8192
    v_mfma_f32_16x16x32_bf16 v[60:63], v[208:211], v[232:235], v[60:63]
    v_mfma_f32_16x16x32_bf16 v[64:67], v[204:207], v[236:239], v[64:67]
    v_mfma_f32_16x16x32_bf16 v[68:71], v[208:211], v[236:239], v[68:71]
    v_mfma_f32_16x16x32_bf16 v[72:75], v[204:207], v[240:243], v[72:75]
    v_mfma_f32_16x16x32_bf16 v[76:79], v[208:211], v[240:243], v[76:79]
    v_mfma_f32_16x16x32_bf16 v[80:83], v[204:207], v[244:247], v[80:83]
    v_mfma_f32_16x16x32_bf16 v[84:87], v[208:211], v[244:247], v[84:87]
    s_waitcnt lgkmcnt(5)
    v_mfma_f32_16x16x32_bf16 v[16:19], v[160:163], v[168:171], v[16:19]
    ds_read_b128 v[204:207], v3 offset:33792
    v_mfma_f32_16x16x32_bf16 v[20:23], v[164:167], v[168:171], v[20:23]
    ds_read_b128 v[208:211], v3 offset:35840
    v_mfma_f32_16x16x32_bf16 v[24:27], v[160:163], v[172:175], v[24:27]
    ds_read_b128 v[212:215], v2 offset:9216
    v_mfma_f32_16x16x32_bf16 v[28:31], v[164:167], v[172:175], v[28:31]
    ds_read_b128 v[216:219], v2 offset:10240
    v_mfma_f32_16x16x32_bf16 v[32:35], v[160:163], v[176:179], v[32:35]
    ds_read_b128 v[220:223], v2 offset:11264
    v_mfma_f32_16x16x32_bf16 v[36:39], v[164:167], v[176:179], v[36:39]
    ds_read_b128 v[224:227], v2 offset:12288
    v_mfma_f32_16x16x32_bf16 v[40:43], v[160:163], v[180:183], v[40:43]
    ds_read_b128 v[228:231], v2 offset:13312
    v_mfma_f32_16x16x32_bf16 v[44:47], v[164:167], v[180:183], v[44:47]
    ds_read_b128 v[232:235], v2 offset:14336
    s_waitcnt lgkmcnt(8)
    v_mfma_f32_16x16x32_bf16 v[48:51], v[160:163], v[184:187], v[48:51]
    ds_read_b128 v[236:239], v2 offset:15360
    v_mfma_f32_16x16x32_bf16 v[52:55], v[164:167], v[184:187], v[52:55]
    ds_read_b128 v[240:243], v2 offset:16384
    v_mfma_f32_16x16x32_bf16 v[56:59], v[160:163], v[188:191], v[56:59]
    ds_read_b128 v[244:247], v2 offset:17408
    v_mfma_f32_16x16x32_bf16 v[60:63], v[164:167], v[188:191], v[60:63]
    v_mfma_f32_16x16x32_bf16 v[64:67], v[160:163], v[192:195], v[64:67]
    v_mfma_f32_16x16x32_bf16 v[68:71], v[164:167], v[192:195], v[68:71]
    v_mfma_f32_16x16x32_bf16 v[72:75], v[160:163], v[196:199], v[72:75]
    v_mfma_f32_16x16x32_bf16 v[76:79], v[164:167], v[196:199], v[76:79]
    v_mfma_f32_16x16x32_bf16 v[80:83], v[160:163], v[200:203], v[80:83]
    v_mfma_f32_16x16x32_bf16 v[84:87], v[164:167], v[200:203], v[84:87]
    s_waitcnt lgkmcnt(0)
    s_barrier
    v_mfma_f32_16x16x32_bf16 v[16:19], v[204:207], v[212:215], v[16:19]
    ds_read_b128 v[160:163], v3 offset:49152
    v_mfma_f32_16x16x32_bf16 v[20:23], v[208:211], v[212:215], v[20:23]
    ds_read_b128 v[164:167], v3 offset:51200
    v_mfma_f32_16x16x32_bf16 v[24:27], v[204:207], v[216:219], v[24:27]
    ds_read_b128 v[168:171], v2 offset:18432
    v_mfma_f32_16x16x32_bf16 v[28:31], v[208:211], v[216:219], v[28:31]
    ds_read_b128 v[172:175], v2 offset:19456
    v_mfma_f32_16x16x32_bf16 v[32:35], v[204:207], v[220:223], v[32:35]
    ds_read_b128 v[176:179], v2 offset:20480
    v_mfma_f32_16x16x32_bf16 v[36:39], v[208:211], v[220:223], v[36:39]
    ds_read_b128 v[180:183], v2 offset:21504
    v_mfma_f32_16x16x32_bf16 v[40:43], v[204:207], v[224:227], v[40:43]
    ds_read_b128 v[184:187], v2 offset:22528
    v_mfma_f32_16x16x32_bf16 v[44:47], v[208:211], v[224:227], v[44:47]
    ds_read_b128 v[188:191], v2 offset:23552
    v_mfma_f32_16x16x32_bf16 v[48:51], v[204:207], v[228:231], v[48:51]
    ds_read_b128 v[192:195], v2 offset:24576
    v_mfma_f32_16x16x32_bf16 v[52:55], v[208:211], v[228:231], v[52:55]
    ds_read_b128 v[196:199], v2 offset:25600
    v_mfma_f32_16x16x32_bf16 v[56:59], v[204:207], v[232:235], v[56:59]
    ds_read_b128 v[200:203], v2 offset:26624
    v_mfma_f32_16x16x32_bf16 v[60:63], v[208:211], v[232:235], v[60:63]
    v_mfma_f32_16x16x32_bf16 v[64:67], v[204:207], v[236:239], v[64:67]
    v_mfma_f32_16x16x32_bf16 v[68:71], v[208:211], v[236:239], v[68:71]
    v_mfma_f32_16x16x32_bf16 v[72:75], v[204:207], v[240:243], v[72:75]
    v_mfma_f32_16x16x32_bf16 v[76:79], v[208:211], v[240:243], v[76:79]
    v_mfma_f32_16x16x32_bf16 v[80:83], v[204:207], v[244:247], v[80:83]
    v_mfma_f32_16x16x32_bf16 v[84:87], v[208:211], v[244:247], v[84:87]
    s_waitcnt lgkmcnt(5)
    v_mfma_f32_16x16x32_bf16 v[16:19], v[160:163], v[168:171], v[16:19]
    ds_read_b128 v[204:207], v3 offset:50176
    v_mfma_f32_16x16x32_bf16 v[20:23], v[164:167], v[168:171], v[20:23]
    ds_read_b128 v[208:211], v3 offset:52224
    v_mfma_f32_16x16x32_bf16 v[24:27], v[160:163], v[172:175], v[24:27]
    ds_read_b128 v[212:215], v2 offset:27648
    v_mfma_f32_16x16x32_bf16 v[28:31], v[164:167], v[172:175], v[28:31]
    ds_read_b128 v[216:219], v2 offset:28672
    v_mfma_f32_16x16x32_bf16 v[32:35], v[160:163], v[176:179], v[32:35]
    ds_read_b128 v[220:223], v2 offset:29696
    v_mfma_f32_16x16x32_bf16 v[36:39], v[164:167], v[176:179], v[36:39]
    ds_read_b128 v[224:227], v2 offset:30720
    v_mfma_f32_16x16x32_bf16 v[40:43], v[160:163], v[180:183], v[40:43]
    ds_read_b128 v[228:231], v2 offset:31744
    v_mfma_f32_16x16x32_bf16 v[44:47], v[164:167], v[180:183], v[44:47]
    ds_read_b128 v[232:235], v2 offset:32768
    s_waitcnt lgkmcnt(8)
    v_mfma_f32_16x16x32_bf16 v[48:51], v[160:163], v[184:187], v[48:51]
    ds_read_b128 v[236:239], v2 offset:33792
    v_mfma_f32_16x16x32_bf16 v[52:55], v[164:167], v[184:187], v[52:55]
    ds_read_b128 v[240:243], v2 offset:34816
    v_mfma_f32_16x16x32_bf16 v[56:59], v[160:163], v[188:191], v[56:59]
    ds_read_b128 v[244:247], v2 offset:35840
    v_mfma_f32_16x16x32_bf16 v[60:63], v[164:167], v[188:191], v[60:63]
    v_mfma_f32_16x16x32_bf16 v[64:67], v[160:163], v[192:195], v[64:67]
    v_mfma_f32_16x16x32_bf16 v[68:71], v[164:167], v[192:195], v[68:71]
    v_mfma_f32_16x16x32_bf16 v[72:75], v[160:163], v[196:199], v[72:75]
    v_mfma_f32_16x16x32_bf16 v[76:79], v[164:167], v[196:199], v[76:79]
    v_mfma_f32_16x16x32_bf16 v[80:83], v[160:163], v[200:203], v[80:83]
    v_mfma_f32_16x16x32_bf16 v[84:87], v[164:167], v[200:203], v[84:87]
    s_waitcnt lgkmcnt(0)
    s_barrier
    v_mfma_f32_16x16x32_bf16 v[16:19], v[204:207], v[212:215], v[16:19]
    ds_read_b128 v[160:163], v3 offset:0
    v_mfma_f32_16x16x32_bf16 v[20:23], v[208:211], v[212:215], v[20:23]
    ds_read_b128 v[164:167], v3 offset:2048
    v_mfma_f32_16x16x32_bf16 v[24:27], v[204:207], v[216:219], v[24:27]
    ds_read_b128 v[168:171], v1 offset:0
    v_mfma_f32_16x16x32_bf16 v[28:31], v[208:211], v[216:219], v[28:31]
    ds_read_b128 v[172:175], v1 offset:1024
    v_mfma_f32_16x16x32_bf16 v[32:35], v[204:207], v[220:223], v[32:35]
    ds_read_b128 v[176:179], v1 offset:2048
    v_mfma_f32_16x16x32_bf16 v[36:39], v[208:211], v[220:223], v[36:39]
    ds_read_b128 v[180:183], v1 offset:3072
    v_mfma_f32_16x16x32_bf16 v[40:43], v[204:207], v[224:227], v[40:43]
    ds_read_b128 v[184:187], v1 offset:4096
    v_mfma_f32_16x16x32_bf16 v[44:47], v[208:211], v[224:227], v[44:47]
    ds_read_b128 v[188:191], v1 offset:5120
    v_mfma_f32_16x16x32_bf16 v[48:51], v[204:207], v[228:231], v[48:51]
    ds_read_b128 v[192:195], v1 offset:6144
    v_mfma_f32_16x16x32_bf16 v[52:55], v[208:211], v[228:231], v[52:55]
    ds_read_b128 v[196:199], v1 offset:7168
    v_mfma_f32_16x16x32_bf16 v[56:59], v[204:207], v[232:235], v[56:59]
    ds_read_b128 v[200:203], v1 offset:8192
    v_mfma_f32_16x16x32_bf16 v[60:63], v[208:211], v[232:235], v[60:63]
    v_mfma_f32_16x16x32_bf16 v[64:67], v[204:207], v[236:239], v[64:67]
    v_mfma_f32_16x16x32_bf16 v[68:71], v[208:211], v[236:239], v[68:71]
    v_mfma_f32_16x16x32_bf16 v[72:75], v[204:207], v[240:243], v[72:75]
    v_mfma_f32_16x16x32_bf16 v[76:79], v[208:211], v[240:243], v[76:79]
    v_mfma_f32_16x16x32_bf16 v[80:83], v[204:207], v[244:247], v[80:83]
    v_mfma_f32_16x16x32_bf16 v[84:87], v[208:211], v[244:247], v[84:87]
    s_waitcnt lgkmcnt(5)
    v_mfma_f32_16x16x32_bf16 v[16:19], v[160:163], v[168:171], v[16:19]
    ds_read_b128 v[204:207], v3 offset:1024
    v_mfma_f32_16x16x32_bf16 v[20:23], v[164:167], v[168:171], v[20:23]
    ds_read_b128 v[208:211], v3 offset:3072
    v_mfma_f32_16x16x32_bf16 v[24:27], v[160:163], v[172:175], v[24:27]
    ds_read_b128 v[212:215], v1 offset:9216
    v_mfma_f32_16x16x32_bf16 v[28:31], v[164:167], v[172:175], v[28:31]
    ds_read_b128 v[216:219], v1 offset:10240
    v_mfma_f32_16x16x32_bf16 v[32:35], v[160:163], v[176:179], v[32:35]
    ds_read_b128 v[220:223], v1 offset:11264
    v_mfma_f32_16x16x32_bf16 v[36:39], v[164:167], v[176:179], v[36:39]
    ds_read_b128 v[224:227], v1 offset:12288
    v_mfma_f32_16x16x32_bf16 v[40:43], v[160:163], v[180:183], v[40:43]
    ds_read_b128 v[228:231], v1 offset:13312
    v_mfma_f32_16x16x32_bf16 v[44:47], v[164:167], v[180:183], v[44:47]
    ds_read_b128 v[232:235], v1 offset:14336
    s_waitcnt lgkmcnt(8)
    v_mfma_f32_16x16x32_bf16 v[48:51], v[160:163], v[184:187], v[48:51]
    ds_read_b128 v[236:239], v1 offset:15360
    v_mfma_f32_16x16x32_bf16 v[52:55], v[164:167], v[184:187], v[52:55]
    ds_read_b128 v[240:243], v1 offset:16384
    v_mfma_f32_16x16x32_bf16 v[56:59], v[160:163], v[188:191], v[56:59]
    ds_read_b128 v[244:247], v1 offset:17408
    v_mfma_f32_16x16x32_bf16 v[60:63], v[164:167], v[188:191], v[60:63]
    v_mfma_f32_16x16x32_bf16 v[64:67], v[160:163], v[192:195], v[64:67]
    v_mfma_f32_16x16x32_bf16 v[68:71], v[164:167], v[192:195], v[68:71]
    v_mfma_f32_16x16x32_bf16 v[72:75], v[160:163], v[196:199], v[72:75]
    v_mfma_f32_16x16x32_bf16 v[76:79], v[164:167], v[196:199], v[76:79]
    v_mfma_f32_16x16x32_bf16 v[80:83], v[160:163], v[200:203], v[80:83]
    v_mfma_f32_16x16x32_bf16 v[84:87], v[164:167], v[200:203], v[84:87]
    s_waitcnt lgkmcnt(0)
    s_barrier
    v_mfma_f32_16x16x32_bf16 v[16:19], v[204:207], v[212:215], v[16:19]
    ds_read_b128 v[160:163], v3 offset:16384
    ds_bpermute_b32 v96, v8, v249
    ds_bpermute_b32 v88, v8, v248
    v_mfma_f32_16x16x32_bf16 v[20:23], v[208:211], v[212:215], v[20:23]
    ds_read_b128 v[164:167], v3 offset:18432
    ds_bpermute_b32 v97, v9, v249
    ds_bpermute_b32 v89, v9, v248
    v_mfma_f32_16x16x32_bf16 v[24:27], v[204:207], v[216:219], v[24:27]
    ds_read_b128 v[168:171], v1 offset:18432
    ds_bpermute_b32 v98, v10, v249
    ds_bpermute_b32 v90, v10, v248
    v_mfma_f32_16x16x32_bf16 v[28:31], v[208:211], v[216:219], v[28:31]
    ds_read_b128 v[172:175], v1 offset:19456
    ds_bpermute_b32 v99, v11, v249
    ds_bpermute_b32 v91, v11, v248
    v_mfma_f32_16x16x32_bf16 v[32:35], v[204:207], v[220:223], v[32:35]
    ds_read_b128 v[176:179], v1 offset:20480
    ds_bpermute_b32 v100, v8, v251
    ds_bpermute_b32 v92, v8, v250
    v_mfma_f32_16x16x32_bf16 v[36:39], v[208:211], v[220:223], v[36:39]
    ds_read_b128 v[180:183], v1 offset:21504
    ds_bpermute_b32 v101, v9, v251
    ds_bpermute_b32 v93, v9, v250
    v_mfma_f32_16x16x32_bf16 v[40:43], v[204:207], v[224:227], v[40:43]
    ds_read_b128 v[184:187], v1 offset:22528
    ds_bpermute_b32 v102, v10, v251
    ds_bpermute_b32 v94, v10, v250
    v_mfma_f32_16x16x32_bf16 v[44:47], v[208:211], v[224:227], v[44:47]
    ds_read_b128 v[188:191], v1 offset:23552
    ds_bpermute_b32 v103, v11, v251
    ds_bpermute_b32 v95, v11, v250
    v_mfma_f32_16x16x32_bf16 v[48:51], v[204:207], v[228:231], v[48:51]
    ds_read_b128 v[192:195], v1 offset:24576
    ds_read_b32 v128, v7 offset:0
    v_mfma_f32_16x16x32_bf16 v[52:55], v[208:211], v[228:231], v[52:55]
    ds_read_b128 v[196:199], v1 offset:25600
    ds_read_b32 v138, v7 offset:1152
    ds_read_b32 v129, v7 offset:64
    v_mfma_f32_16x16x32_bf16 v[56:59], v[204:207], v[232:235], v[56:59]
    ds_read_b128 v[200:203], v1 offset:26624
    ds_read_b32 v139, v7 offset:1216
    ds_read_b32 v130, v7 offset:128
    v_mfma_f32_16x16x32_bf16 v[60:63], v[208:211], v[232:235], v[60:63]
    ds_read_b32 v140, v7 offset:1280
    ds_read_b32 v131, v7 offset:192
    v_mfma_f32_16x16x32_bf16 v[64:67], v[204:207], v[236:239], v[64:67]
    ds_read_b32 v141, v7 offset:1344
    ds_read_b32 v132, v7 offset:256
    v_mfma_f32_16x16x32_bf16 v[68:71], v[208:211], v[236:239], v[68:71]
    ds_read_b32 v142, v7 offset:1408
    ds_read_b32 v133, v7 offset:320
    v_mfma_f32_16x16x32_bf16 v[72:75], v[204:207], v[240:243], v[72:75]
    ds_read_b32 v143, v7 offset:1472
    ds_read_b32 v134, v7 offset:384
    v_mfma_f32_16x16x32_bf16 v[76:79], v[208:211], v[240:243], v[76:79]
    ds_read_b32 v144, v7 offset:1536
    ds_read_b32 v135, v7 offset:448
    v_mfma_f32_16x16x32_bf16 v[80:83], v[204:207], v[244:247], v[80:83]
    ds_read_b32 v145, v7 offset:1600
    ds_read_b32 v136, v7 offset:512
    v_mfma_f32_16x16x32_bf16 v[84:87], v[208:211], v[244:247], v[84:87]
    ds_read_b32 v146, v7 offset:1664
    s_mov_b32 s40, 0xc0135761
    s_mov_b32 s42, 0x3d372713
    v_mov_b64 v[204:205], 0
    v_mov_b64 v[206:207], 0
    v_mov_b64 v[208:209], 0
    v_mov_b64 v[210:211], 0
    v_mov_b64 v[212:213], 0
    v_mov_b64 v[214:215], 0
    v_mov_b64 v[216:217], 0
    v_mov_b64 v[218:219], 0
    s_waitcnt lgkmcnt(0)
    v_rcp_f32 v120, v96
    v_rcp_f32 v121, v97
    v_rcp_f32 v122, v98
    v_rcp_f32 v123, v99
    v_rcp_f32 v124, v100
    v_rcp_f32 v125, v101
    v_rcp_f32 v126, v102
    v_rcp_f32 v127, v103
    v_pk_mul_f32 v[104:105], v[96:97], s[40:41] op_sel_hi:[1,0]
    v_pk_mul_f32 v[106:107], v[98:99], s[40:41] op_sel_hi:[1,0]
    v_pk_mul_f32 v[108:109], v[100:101], s[40:41] op_sel_hi:[1,0]
    v_pk_mul_f32 v[110:111], v[102:103], s[40:41] op_sel_hi:[1,0]
    v_pk_mul_f32 v[112:113], v[96:97], v[96:97]
    v_pk_mul_f32 v[114:115], v[98:99], v[98:99]
    v_pk_mul_f32 v[116:117], v[100:101], v[100:101]
    v_pk_mul_f32 v[118:119], v[102:103], v[102:103]
    v_pk_mul_f32 v[112:113], v[112:113], s[42:43] op_sel_hi:[1,0]
    v_pk_mul_f32 v[114:115], v[114:115], s[42:43] op_sel_hi:[1,0]
    v_pk_mul_f32 v[116:117], v[116:117], s[42:43] op_sel_hi:[1,0]
    v_pk_mul_f32 v[118:119], v[118:119], s[42:43] op_sel_hi:[1,0]
    v_pk_mul_f32 v[112:113], v[112:113], v[104:105]
    v_pk_mul_f32 v[114:115], v[114:115], v[106:107]
    v_pk_mul_f32 v[116:117], v[116:117], v[108:109]
    v_pk_mul_f32 v[118:119], v[118:119], v[110:111]
    v_pk_add_f32 v[128:129], v[128:129], v[138:139]
    v_pk_add_f32 v[130:131], v[130:131], v[140:141]
    v_pk_add_f32 v[132:133], v[132:133], v[142:143]
    v_pk_add_f32 v[134:135], v[134:135], v[144:145]
    v_pk_add_f32 v[136:137], v[136:137], v[146:147]
    v_pk_fma_f32 v[16:17], v[88:89], v[128:129], v[16:17] op_sel:[0,0,0] op_sel_hi:[1,0,1] neg_lo:[1,0,0] neg_hi:[1,0,0]
    v_pk_fma_f32 v[18:19], v[90:91], v[128:129], v[18:19] op_sel:[0,0,0] op_sel_hi:[1,0,1] neg_lo:[1,0,0] neg_hi:[1,0,0]
    v_pk_fma_f32 v[20:21], v[92:93], v[128:129], v[20:21] op_sel:[0,0,0] op_sel_hi:[1,0,1] neg_lo:[1,0,0] neg_hi:[1,0,0]
    v_pk_fma_f32 v[22:23], v[94:95], v[128:129], v[22:23] op_sel:[0,0,0] op_sel_hi:[1,0,1] neg_lo:[1,0,0] neg_hi:[1,0,0]
    v_pk_mul_f32 v[220:221], v[16:17], v[16:17]
    v_pk_mul_f32 v[222:223], v[18:19], v[18:19]
    v_pk_mul_f32 v[224:225], v[20:21], v[20:21]
    v_pk_mul_f32 v[226:227], v[22:23], v[22:23]
    v_pk_fma_f32 v[220:221], v[220:221], v[112:113], v[104:105]
    v_pk_fma_f32 v[222:223], v[222:223], v[114:115], v[106:107]
    v_pk_fma_f32 v[224:225], v[224:225], v[116:117], v[108:109]
    v_pk_fma_f32 v[226:227], v[226:227], v[118:119], v[110:111]
    v_pk_mul_f32 v[220:221], v[220:221], v[16:17]
    v_pk_mul_f32 v[222:223], v[222:223], v[18:19]
    v_pk_mul_f32 v[224:225], v[224:225], v[20:21]
    v_pk_mul_f32 v[226:227], v[226:227], v[22:23]
    v_exp_f32 v220, v220
    v_exp_f32 v221, v221
    v_exp_f32 v222, v222
    v_exp_f32 v223, v223
    v_exp_f32 v224, v224
    v_exp_f32 v225, v225
    v_exp_f32 v226, v226
    v_exp_f32 v227, v227
    v_pk_fma_f32 v[220:221], v[220:221], v[120:121], v[120:121]
    v_pk_fma_f32 v[222:223], v[222:223], v[122:123], v[122:123]
    v_pk_fma_f32 v[224:225], v[224:225], v[124:125], v[124:125]
    v_pk_fma_f32 v[226:227], v[226:227], v[126:127], v[126:127]
    v_rcp_f32 v220, v220
    v_rcp_f32 v221, v221
    v_rcp_f32 v222, v222
    v_rcp_f32 v223, v223
    v_rcp_f32 v224, v224
    v_rcp_f32 v225, v225
    v_rcp_f32 v226, v226
    v_rcp_f32 v227, v227
    v_pk_mul_f32 v[16:17], v[16:17], v[220:221]
    v_pk_mul_f32 v[18:19], v[18:19], v[222:223]
    v_pk_mul_f32 v[20:21], v[20:21], v[224:225]
    v_pk_mul_f32 v[22:23], v[22:23], v[226:227]
    v_pk_add_f32 v[204:205], v[204:205], v[16:17]
    v_pk_fma_f32 v[206:207], v[16:17], v[16:17], v[206:207]
    v_pk_add_f32 v[208:209], v[208:209], v[18:19]
    v_pk_fma_f32 v[210:211], v[18:19], v[18:19], v[210:211]
    v_pk_add_f32 v[212:213], v[212:213], v[20:21]
    v_pk_fma_f32 v[214:215], v[20:21], v[20:21], v[214:215]
    v_pk_add_f32 v[216:217], v[216:217], v[22:23]
    v_pk_fma_f32 v[218:219], v[22:23], v[22:23], v[218:219]
    v_pk_fma_f32 v[24:25], v[88:89], v[128:129], v[24:25] op_sel:[0,1,0] op_sel_hi:[1,1,1] neg_lo:[1,0,0] neg_hi:[1,0,0]
    v_pk_fma_f32 v[26:27], v[90:91], v[128:129], v[26:27] op_sel:[0,1,0] op_sel_hi:[1,1,1] neg_lo:[1,0,0] neg_hi:[1,0,0]
    v_pk_fma_f32 v[28:29], v[92:93], v[128:129], v[28:29] op_sel:[0,1,0] op_sel_hi:[1,1,1] neg_lo:[1,0,0] neg_hi:[1,0,0]
    v_pk_fma_f32 v[30:31], v[94:95], v[128:129], v[30:31] op_sel:[0,1,0] op_sel_hi:[1,1,1] neg_lo:[1,0,0] neg_hi:[1,0,0]
    v_pk_mul_f32 v[228:229], v[24:25], v[24:25]
    v_pk_mul_f32 v[230:231], v[26:27], v[26:27]
    v_pk_mul_f32 v[232:233], v[28:29], v[28:29]
    v_pk_mul_f32 v[234:235], v[30:31], v[30:31]
    v_pk_fma_f32 v[228:229], v[228:229], v[112:113], v[104:105]
    v_pk_fma_f32 v[230:231], v[230:231], v[114:115], v[106:107]
    v_pk_fma_f32 v[232:233], v[232:233], v[116:117], v[108:109]
    v_pk_fma_f32 v[234:235], v[234:235], v[118:119], v[110:111]
    v_pk_mul_f32 v[228:229], v[228:229], v[24:25]
    v_pk_mul_f32 v[230:231], v[230:231], v[26:27]
    v_pk_mul_f32 v[232:233], v[232:233], v[28:29]
    v_pk_mul_f32 v[234:235], v[234:235], v[30:31]
    v_exp_f32 v228, v228
    v_exp_f32 v229, v229
    v_exp_f32 v230, v230
    v_exp_f32 v231, v231
    v_exp_f32 v232, v232
    v_exp_f32 v233, v233
    v_exp_f32 v234, v234
    v_exp_f32 v235, v235
    v_pk_fma_f32 v[228:229], v[228:229], v[120:121], v[120:121]
    v_pk_fma_f32 v[230:231], v[230:231], v[122:123], v[122:123]
    v_pk_fma_f32 v[232:233], v[232:233], v[124:125], v[124:125]
    v_pk_fma_f32 v[234:235], v[234:235], v[126:127], v[126:127]
    v_rcp_f32 v228, v228
    v_rcp_f32 v229, v229
    v_rcp_f32 v230, v230
    v_rcp_f32 v231, v231
    v_rcp_f32 v232, v232
    v_rcp_f32 v233, v233
    v_rcp_f32 v234, v234
    v_rcp_f32 v235, v235
    v_pk_mul_f32 v[24:25], v[24:25], v[228:229]
    v_pk_mul_f32 v[26:27], v[26:27], v[230:231]
    v_pk_mul_f32 v[28:29], v[28:29], v[232:233]
    v_pk_mul_f32 v[30:31], v[30:31], v[234:235]
    v_pk_add_f32 v[204:205], v[204:205], v[24:25]
    v_pk_fma_f32 v[206:207], v[24:25], v[24:25], v[206:207]
    v_pk_add_f32 v[208:209], v[208:209], v[26:27]
    v_pk_fma_f32 v[210:211], v[26:27], v[26:27], v[210:211]
    v_pk_add_f32 v[212:213], v[212:213], v[28:29]
    v_pk_fma_f32 v[214:215], v[28:29], v[28:29], v[214:215]
    v_pk_add_f32 v[216:217], v[216:217], v[30:31]
    v_pk_fma_f32 v[218:219], v[30:31], v[30:31], v[218:219]
    v_pk_fma_f32 v[32:33], v[88:89], v[130:131], v[32:33] op_sel:[0,0,0] op_sel_hi:[1,0,1] neg_lo:[1,0,0] neg_hi:[1,0,0]
    v_pk_fma_f32 v[34:35], v[90:91], v[130:131], v[34:35] op_sel:[0,0,0] op_sel_hi:[1,0,1] neg_lo:[1,0,0] neg_hi:[1,0,0]
    v_pk_fma_f32 v[36:37], v[92:93], v[130:131], v[36:37] op_sel:[0,0,0] op_sel_hi:[1,0,1] neg_lo:[1,0,0] neg_hi:[1,0,0]
    v_pk_fma_f32 v[38:39], v[94:95], v[130:131], v[38:39] op_sel:[0,0,0] op_sel_hi:[1,0,1] neg_lo:[1,0,0] neg_hi:[1,0,0]
    v_pk_mul_f32 v[220:221], v[32:33], v[32:33]
    v_pk_mul_f32 v[222:223], v[34:35], v[34:35]
    v_pk_mul_f32 v[224:225], v[36:37], v[36:37]
    v_pk_mul_f32 v[226:227], v[38:39], v[38:39]
    v_pk_fma_f32 v[220:221], v[220:221], v[112:113], v[104:105]
    v_pk_fma_f32 v[222:223], v[222:223], v[114:115], v[106:107]
    v_pk_fma_f32 v[224:225], v[224:225], v[116:117], v[108:109]
    v_pk_fma_f32 v[226:227], v[226:227], v[118:119], v[110:111]
    v_pk_mul_f32 v[220:221], v[220:221], v[32:33]
    v_pk_mul_f32 v[222:223], v[222:223], v[34:35]
    v_pk_mul_f32 v[224:225], v[224:225], v[36:37]
    v_pk_mul_f32 v[226:227], v[226:227], v[38:39]
    v_exp_f32 v220, v220
    v_exp_f32 v221, v221
    v_exp_f32 v222, v222
    v_exp_f32 v223, v223
    v_exp_f32 v224, v224
    v_exp_f32 v225, v225
    v_exp_f32 v226, v226
    v_exp_f32 v227, v227
    v_pk_fma_f32 v[220:221], v[220:221], v[120:121], v[120:121]
    v_pk_fma_f32 v[222:223], v[222:223], v[122:123], v[122:123]
    v_pk_fma_f32 v[224:225], v[224:225], v[124:125], v[124:125]
    v_pk_fma_f32 v[226:227], v[226:227], v[126:127], v[126:127]
    v_rcp_f32 v220, v220
    v_rcp_f32 v221, v221
    v_rcp_f32 v222, v222
    v_rcp_f32 v223, v223
    v_rcp_f32 v224, v224
    v_rcp_f32 v225, v225
    v_rcp_f32 v226, v226
    v_rcp_f32 v227, v227
    v_pk_mul_f32 v[32:33], v[32:33], v[220:221]
    v_pk_mul_f32 v[34:35], v[34:35], v[222:223]
    v_pk_mul_f32 v[36:37], v[36:37], v[224:225]
    v_pk_mul_f32 v[38:39], v[38:39], v[226:227]
    v_pk_add_f32 v[204:205], v[204:205], v[32:33]
    v_pk_fma_f32 v[206:207], v[32:33], v[32:33], v[206:207]
    v_pk_add_f32 v[208:209], v[208:209], v[34:35]
    v_pk_fma_f32 v[210:211], v[34:35], v[34:35], v[210:211]
    v_pk_add_f32 v[212:213], v[212:213], v[36:37]
    v_pk_fma_f32 v[214:215], v[36:37], v[36:37], v[214:215]
    v_pk_add_f32 v[216:217], v[216:217], v[38:39]
    v_pk_fma_f32 v[218:219], v[38:39], v[38:39], v[218:219]
    v_pk_fma_f32 v[40:41], v[88:89], v[130:131], v[40:41] op_sel:[0,1,0] op_sel_hi:[1,1,1] neg_lo:[1,0,0] neg_hi:[1,0,0]
    v_pk_fma_f32 v[42:43], v[90:91], v[130:131], v[42:43] op_sel:[0,1,0] op_sel_hi:[1,1,1] neg_lo:[1,0,0] neg_hi:[1,0,0]
    v_pk_fma_f32 v[44:45], v[92:93], v[130:131], v[44:45] op_sel:[0,1,0] op_sel_hi:[1,1,1] neg_lo:[1,0,0] neg_hi:[1,0,0]
    v_pk_fma_f32 v[46:47], v[94:95], v[130:131], v[46:47] op_sel:[0,1,0] op_sel_hi:[1,1,1] neg_lo:[1,0,0] neg_hi:[1,0,0]
    v_pk_mul_f32 v[228:229], v[40:41], v[40:41]
    v_pk_mul_f32 v[230:231], v[42:43], v[42:43]
    v_pk_mul_f32 v[232:233], v[44:45], v[44:45]
    v_pk_mul_f32 v[234:235], v[46:47], v[46:47]
    v_pk_fma_f32 v[228:229], v[228:229], v[112:113], v[104:105]
    v_pk_fma_f32 v[230:231], v[230:231], v[114:115], v[106:107]
    v_pk_fma_f32 v[232:233], v[232:233], v[116:117], v[108:109]
    v_pk_fma_f32 v[234:235], v[234:235], v[118:119], v[110:111]
    v_pk_mul_f32 v[228:229], v[228:229], v[40:41]
    v_pk_mul_f32 v[230:231], v[230:231], v[42:43]
    v_pk_mul_f32 v[232:233], v[232:233], v[44:45]
    v_pk_mul_f32 v[234:235], v[234:235], v[46:47]
    v_exp_f32 v228, v228
    v_exp_f32 v229, v229
    v_exp_f32 v230, v230
    v_exp_f32 v231, v231
    v_exp_f32 v232, v232
    v_exp_f32 v233, v233
    v_exp_f32 v234, v234
    v_exp_f32 v235, v235
    v_pk_fma_f32 v[228:229], v[228:229], v[120:121], v[120:121]
    v_pk_fma_f32 v[230:231], v[230:231], v[122:123], v[122:123]
    v_pk_fma_f32 v[232:233], v[232:233], v[124:125], v[124:125]
    v_pk_fma_f32 v[234:235], v[234:235], v[126:127], v[126:127]
    v_rcp_f32 v228, v228
    v_rcp_f32 v229, v229
    v_rcp_f32 v230, v230
    v_rcp_f32 v231, v231
    v_rcp_f32 v232, v232
    v_rcp_f32 v233, v233
    v_rcp_f32 v234, v234
    v_rcp_f32 v235, v235
    v_pk_mul_f32 v[40:41], v[40:41], v[228:229]
    v_pk_mul_f32 v[42:43], v[42:43], v[230:231]
    v_pk_mul_f32 v[44:45], v[44:45], v[232:233]
    v_pk_mul_f32 v[46:47], v[46:47], v[234:235]
    v_pk_add_f32 v[204:205], v[204:205], v[40:41]
    v_pk_fma_f32 v[206:207], v[40:41], v[40:41], v[206:207]
    v_pk_add_f32 v[208:209], v[208:209], v[42:43]
    v_pk_fma_f32 v[210:211], v[42:43], v[42:43], v[210:211]
    v_pk_add_f32 v[212:213], v[212:213], v[44:45]
    v_pk_fma_f32 v[214:215], v[44:45], v[44:45], v[214:215]
    v_pk_add_f32 v[216:217], v[216:217], v[46:47]
    v_pk_fma_f32 v[218:219], v[46:47], v[46:47], v[218:219]
    v_pk_fma_f32 v[48:49], v[88:89], v[132:133], v[48:49] op_sel:[0,0,0] op_sel_hi:[1,0,1] neg_lo:[1,0,0] neg_hi:[1,0,0]
    v_pk_fma_f32 v[50:51], v[90:91], v[132:133], v[50:51] op_sel:[0,0,0] op_sel_hi:[1,0,1] neg_lo:[1,0,0] neg_hi:[1,0,0]
    v_pk_fma_f32 v[52:53], v[92:93], v[132:133], v[52:53] op_sel:[0,0,0] op_sel_hi:[1,0,1] neg_lo:[1,0,0] neg_hi:[1,0,0]
    v_pk_fma_f32 v[54:55], v[94:95], v[132:133], v[54:55] op_sel:[0,0,0] op_sel_hi:[1,0,1] neg_lo:[1,0,0] neg_hi:[1,0,0]
    v_pk_mul_f32 v[220:221], v[48:49], v[48:49]
    v_pk_mul_f32 v[222:223], v[50:51], v[50:51]
    v_pk_mul_f32 v[224:225], v[52:53], v[52:53]
    v_pk_mul_f32 v[226:227], v[54:55], v[54:55]
    v_pk_fma_f32 v[220:221], v[220:221], v[112:113], v[104:105]
    v_pk_fma_f32 v[222:223], v[222:223], v[114:115], v[106:107]
    v_pk_fma_f32 v[224:225], v[224:225], v[116:117], v[108:109]
    v_pk_fma_f32 v[226:227], v[226:227], v[118:119], v[110:111]
    v_pk_mul_f32 v[220:221], v[220:221], v[48:49]
    v_pk_mul_f32 v[222:223], v[222:223], v[50:51]
    v_pk_mul_f32 v[224:225], v[224:225], v[52:53]
    v_pk_mul_f32 v[226:227], v[226:227], v[54:55]
    v_exp_f32 v220, v220
    v_exp_f32 v221, v221
    v_exp_f32 v222, v222
    v_exp_f32 v223, v223
    v_exp_f32 v224, v224
    v_exp_f32 v225, v225
    v_exp_f32 v226, v226
    v_exp_f32 v227, v227
    v_pk_fma_f32 v[220:221], v[220:221], v[120:121], v[120:121]
    v_pk_fma_f32 v[222:223], v[222:223], v[122:123], v[122:123]
    v_pk_fma_f32 v[224:225], v[224:225], v[124:125], v[124:125]
    v_pk_fma_f32 v[226:227], v[226:227], v[126:127], v[126:127]
    v_rcp_f32 v220, v220
    v_rcp_f32 v221, v221
    v_rcp_f32 v222, v222
    v_rcp_f32 v223, v223
    v_rcp_f32 v224, v224
    v_rcp_f32 v225, v225
    v_rcp_f32 v226, v226
    v_rcp_f32 v227, v227
    v_pk_mul_f32 v[48:49], v[48:49], v[220:221]
    v_pk_mul_f32 v[50:51], v[50:51], v[222:223]
    v_pk_mul_f32 v[52:53], v[52:53], v[224:225]
    v_pk_mul_f32 v[54:55], v[54:55], v[226:227]
    v_pk_add_f32 v[204:205], v[204:205], v[48:49]
    v_pk_fma_f32 v[206:207], v[48:49], v[48:49], v[206:207]
    v_pk_add_f32 v[208:209], v[208:209], v[50:51]
    v_pk_fma_f32 v[210:211], v[50:51], v[50:51], v[210:211]
    v_pk_add_f32 v[212:213], v[212:213], v[52:53]
    v_pk_fma_f32 v[214:215], v[52:53], v[52:53], v[214:215]
    v_pk_add_f32 v[216:217], v[216:217], v[54:55]
    v_pk_fma_f32 v[218:219], v[54:55], v[54:55], v[218:219]
    v_pk_fma_f32 v[56:57], v[88:89], v[132:133], v[56:57] op_sel:[0,1,0] op_sel_hi:[1,1,1] neg_lo:[1,0,0] neg_hi:[1,0,0]
    v_pk_fma_f32 v[58:59], v[90:91], v[132:133], v[58:59] op_sel:[0,1,0] op_sel_hi:[1,1,1] neg_lo:[1,0,0] neg_hi:[1,0,0]
    v_pk_fma_f32 v[60:61], v[92:93], v[132:133], v[60:61] op_sel:[0,1,0] op_sel_hi:[1,1,1] neg_lo:[1,0,0] neg_hi:[1,0,0]
    v_pk_fma_f32 v[62:63], v[94:95], v[132:133], v[62:63] op_sel:[0,1,0] op_sel_hi:[1,1,1] neg_lo:[1,0,0] neg_hi:[1,0,0]
    v_pk_mul_f32 v[228:229], v[56:57], v[56:57]
    v_pk_mul_f32 v[230:231], v[58:59], v[58:59]
    v_pk_mul_f32 v[232:233], v[60:61], v[60:61]
    v_pk_mul_f32 v[234:235], v[62:63], v[62:63]
    v_pk_fma_f32 v[228:229], v[228:229], v[112:113], v[104:105]
    v_pk_fma_f32 v[230:231], v[230:231], v[114:115], v[106:107]
    v_pk_fma_f32 v[232:233], v[232:233], v[116:117], v[108:109]
    v_pk_fma_f32 v[234:235], v[234:235], v[118:119], v[110:111]
    v_pk_mul_f32 v[228:229], v[228:229], v[56:57]
    v_pk_mul_f32 v[230:231], v[230:231], v[58:59]
    v_pk_mul_f32 v[232:233], v[232:233], v[60:61]
    v_pk_mul_f32 v[234:235], v[234:235], v[62:63]
    v_exp_f32 v228, v228
    v_exp_f32 v229, v229
    v_exp_f32 v230, v230
    v_exp_f32 v231, v231
    v_exp_f32 v232, v232
    v_exp_f32 v233, v233
    v_exp_f32 v234, v234
    v_exp_f32 v235, v235
    v_pk_fma_f32 v[228:229], v[228:229], v[120:121], v[120:121]
    v_pk_fma_f32 v[230:231], v[230:231], v[122:123], v[122:123]
    v_pk_fma_f32 v[232:233], v[232:233], v[124:125], v[124:125]
    v_pk_fma_f32 v[234:235], v[234:235], v[126:127], v[126:127]
    v_rcp_f32 v228, v228
    v_rcp_f32 v229, v229
    v_rcp_f32 v230, v230
    v_rcp_f32 v231, v231
    v_rcp_f32 v232, v232
    v_rcp_f32 v233, v233
    v_rcp_f32 v234, v234
    v_rcp_f32 v235, v235
    v_pk_mul_f32 v[56:57], v[56:57], v[228:229]
    v_pk_mul_f32 v[58:59], v[58:59], v[230:231]
    v_pk_mul_f32 v[60:61], v[60:61], v[232:233]
    v_pk_mul_f32 v[62:63], v[62:63], v[234:235]
    v_pk_add_f32 v[204:205], v[204:205], v[56:57]
    v_pk_fma_f32 v[206:207], v[56:57], v[56:57], v[206:207]
    v_pk_add_f32 v[208:209], v[208:209], v[58:59]
    v_pk_fma_f32 v[210:211], v[58:59], v[58:59], v[210:211]
    v_pk_add_f32 v[212:213], v[212:213], v[60:61]
    v_pk_fma_f32 v[214:215], v[60:61], v[60:61], v[214:215]
    v_pk_add_f32 v[216:217], v[216:217], v[62:63]
    v_pk_fma_f32 v[218:219], v[62:63], v[62:63], v[218:219]
    v_pk_fma_f32 v[64:65], v[88:89], v[134:135], v[64:65] op_sel:[0,0,0] op_sel_hi:[1,0,1] neg_lo:[1,0,0] neg_hi:[1,0,0]
    v_pk_fma_f32 v[66:67], v[90:91], v[134:135], v[66:67] op_sel:[0,0,0] op_sel_hi:[1,0,1] neg_lo:[1,0,0] neg_hi:[1,0,0]
    v_pk_fma_f32 v[68:69], v[92:93], v[134:135], v[68:69] op_sel:[0,0,0] op_sel_hi:[1,0,1] neg_lo:[1,0,0] neg_hi:[1,0,0]
    v_pk_fma_f32 v[70:71], v[94:95], v[134:135], v[70:71] op_sel:[0,0,0] op_sel_hi:[1,0,1] neg_lo:[1,0,0] neg_hi:[1,0,0]
    v_pk_mul_f32 v[220:221], v[64:65], v[64:65]
    v_pk_mul_f32 v[222:223], v[66:67], v[66:67]
    v_pk_mul_f32 v[224:225], v[68:69], v[68:69]
    v_pk_mul_f32 v[226:227], v[70:71], v[70:71]
    v_pk_fma_f32 v[220:221], v[220:221], v[112:113], v[104:105]
    v_pk_fma_f32 v[222:223], v[222:223], v[114:115], v[106:107]
    v_pk_fma_f32 v[224:225], v[224:225], v[116:117], v[108:109]
    v_pk_fma_f32 v[226:227], v[226:227], v[118:119], v[110:111]
    v_pk_mul_f32 v[220:221], v[220:221], v[64:65]
    v_pk_mul_f32 v[222:223], v[222:223], v[66:67]
    v_pk_mul_f32 v[224:225], v[224:225], v[68:69]
    v_pk_mul_f32 v[226:227], v[226:227], v[70:71]
    v_exp_f32 v220, v220
    v_exp_f32 v221, v221
    v_exp_f32 v222, v222
    v_exp_f32 v223, v223
    v_exp_f32 v224, v224
    v_exp_f32 v225, v225
    v_exp_f32 v226, v226
    v_exp_f32 v227, v227
    v_pk_fma_f32 v[220:221], v[220:221], v[120:121], v[120:121]
    v_pk_fma_f32 v[222:223], v[222:223], v[122:123], v[122:123]
    v_pk_fma_f32 v[224:225], v[224:225], v[124:125], v[124:125]
    v_pk_fma_f32 v[226:227], v[226:227], v[126:127], v[126:127]
    v_rcp_f32 v220, v220
    v_rcp_f32 v221, v221
    v_rcp_f32 v222, v222
    v_rcp_f32 v223, v223
    v_rcp_f32 v224, v224
    v_rcp_f32 v225, v225
    v_rcp_f32 v226, v226
    v_rcp_f32 v227, v227
    v_pk_mul_f32 v[64:65], v[64:65], v[220:221]
    v_pk_mul_f32 v[66:67], v[66:67], v[222:223]
    v_pk_mul_f32 v[68:69], v[68:69], v[224:225]
    v_pk_mul_f32 v[70:71], v[70:71], v[226:227]
    v_pk_add_f32 v[204:205], v[204:205], v[64:65]
    v_pk_fma_f32 v[206:207], v[64:65], v[64:65], v[206:207]
    v_pk_add_f32 v[208:209], v[208:209], v[66:67]
    v_pk_fma_f32 v[210:211], v[66:67], v[66:67], v[210:211]
    v_pk_add_f32 v[212:213], v[212:213], v[68:69]
    v_pk_fma_f32 v[214:215], v[68:69], v[68:69], v[214:215]
    v_pk_add_f32 v[216:217], v[216:217], v[70:71]
    v_pk_fma_f32 v[218:219], v[70:71], v[70:71], v[218:219]
    v_pk_fma_f32 v[72:73], v[88:89], v[134:135], v[72:73] op_sel:[0,1,0] op_sel_hi:[1,1,1] neg_lo:[1,0,0] neg_hi:[1,0,0]
    v_pk_fma_f32 v[74:75], v[90:91], v[134:135], v[74:75] op_sel:[0,1,0] op_sel_hi:[1,1,1] neg_lo:[1,0,0] neg_hi:[1,0,0]
    v_pk_fma_f32 v[76:77], v[92:93], v[134:135], v[76:77] op_sel:[0,1,0] op_sel_hi:[1,1,1] neg_lo:[1,0,0] neg_hi:[1,0,0]
    v_pk_fma_f32 v[78:79], v[94:95], v[134:135], v[78:79] op_sel:[0,1,0] op_sel_hi:[1,1,1] neg_lo:[1,0,0] neg_hi:[1,0,0]
    v_pk_mul_f32 v[228:229], v[72:73], v[72:73]
    v_pk_mul_f32 v[230:231], v[74:75], v[74:75]
    v_pk_mul_f32 v[232:233], v[76:77], v[76:77]
    v_pk_mul_f32 v[234:235], v[78:79], v[78:79]
    v_pk_fma_f32 v[228:229], v[228:229], v[112:113], v[104:105]
    v_pk_fma_f32 v[230:231], v[230:231], v[114:115], v[106:107]
    v_pk_fma_f32 v[232:233], v[232:233], v[116:117], v[108:109]
    v_pk_fma_f32 v[234:235], v[234:235], v[118:119], v[110:111]
    v_pk_mul_f32 v[228:229], v[228:229], v[72:73]
    v_pk_mul_f32 v[230:231], v[230:231], v[74:75]
    v_pk_mul_f32 v[232:233], v[232:233], v[76:77]
    v_pk_mul_f32 v[234:235], v[234:235], v[78:79]
    v_exp_f32 v228, v228
    v_exp_f32 v229, v229
    v_exp_f32 v230, v230
    v_exp_f32 v231, v231
    v_exp_f32 v232, v232
    v_exp_f32 v233, v233
    v_exp_f32 v234, v234
    v_exp_f32 v235, v235
    v_pk_fma_f32 v[228:229], v[228:229], v[120:121], v[120:121]
    v_pk_fma_f32 v[230:231], v[230:231], v[122:123], v[122:123]
    v_pk_fma_f32 v[232:233], v[232:233], v[124:125], v[124:125]
    v_pk_fma_f32 v[234:235], v[234:235], v[126:127], v[126:127]
    v_rcp_f32 v228, v228
    v_rcp_f32 v229, v229
    v_rcp_f32 v230, v230
    v_rcp_f32 v231, v231
    v_rcp_f32 v232, v232
    v_rcp_f32 v233, v233
    v_rcp_f32 v234, v234
    v_rcp_f32 v235, v235
    v_pk_mul_f32 v[72:73], v[72:73], v[228:229]
    v_pk_mul_f32 v[74:75], v[74:75], v[230:231]
    v_pk_mul_f32 v[76:77], v[76:77], v[232:233]
    v_pk_mul_f32 v[78:79], v[78:79], v[234:235]
    v_pk_add_f32 v[204:205], v[204:205], v[72:73]
    v_pk_fma_f32 v[206:207], v[72:73], v[72:73], v[206:207]
    v_pk_add_f32 v[208:209], v[208:209], v[74:75]
    v_pk_fma_f32 v[210:211], v[74:75], v[74:75], v[210:211]
    v_pk_add_f32 v[212:213], v[212:213], v[76:77]
    v_pk_fma_f32 v[214:215], v[76:77], v[76:77], v[214:215]
    v_pk_add_f32 v[216:217], v[216:217], v[78:79]
    v_pk_fma_f32 v[218:219], v[78:79], v[78:79], v[218:219]
    v_pk_fma_f32 v[80:81], v[88:89], v[136:137], v[80:81] op_sel:[0,0,0] op_sel_hi:[1,0,1] neg_lo:[1,0,0] neg_hi:[1,0,0]
    v_pk_fma_f32 v[82:83], v[90:91], v[136:137], v[82:83] op_sel:[0,0,0] op_sel_hi:[1,0,1] neg_lo:[1,0,0] neg_hi:[1,0,0]
    v_pk_fma_f32 v[84:85], v[92:93], v[136:137], v[84:85] op_sel:[0,0,0] op_sel_hi:[1,0,1] neg_lo:[1,0,0] neg_hi:[1,0,0]
    v_pk_fma_f32 v[86:87], v[94:95], v[136:137], v[86:87] op_sel:[0,0,0] op_sel_hi:[1,0,1] neg_lo:[1,0,0] neg_hi:[1,0,0]
    v_pk_mul_f32 v[220:221], v[80:81], v[80:81]
    v_pk_mul_f32 v[222:223], v[82:83], v[82:83]
    v_pk_mul_f32 v[224:225], v[84:85], v[84:85]
    v_pk_mul_f32 v[226:227], v[86:87], v[86:87]
    v_pk_fma_f32 v[220:221], v[220:221], v[112:113], v[104:105]
    v_pk_fma_f32 v[222:223], v[222:223], v[114:115], v[106:107]
    v_pk_fma_f32 v[224:225], v[224:225], v[116:117], v[108:109]
    v_pk_fma_f32 v[226:227], v[226:227], v[118:119], v[110:111]
    v_pk_mul_f32 v[220:221], v[220:221], v[80:81]
    v_pk_mul_f32 v[222:223], v[222:223], v[82:83]
    v_pk_mul_f32 v[224:225], v[224:225], v[84:85]
    v_pk_mul_f32 v[226:227], v[226:227], v[86:87]
    v_exp_f32 v220, v220
    v_exp_f32 v221, v221
    v_exp_f32 v222, v222
    v_exp_f32 v223, v223
    v_exp_f32 v224, v224
    v_exp_f32 v225, v225
    v_exp_f32 v226, v226
    v_exp_f32 v227, v227
    v_pk_fma_f32 v[220:221], v[220:221], v[120:121], v[120:121]
    v_pk_fma_f32 v[222:223], v[222:223], v[122:123], v[122:123]
    v_pk_fma_f32 v[224:225], v[224:225], v[124:125], v[124:125]
    v_pk_fma_f32 v[226:227], v[226:227], v[126:127], v[126:127]
    v_rcp_f32 v220, v220
    v_rcp_f32 v221, v221
    v_rcp_f32 v222, v222
    v_rcp_f32 v223, v223
    v_rcp_f32 v224, v224
    v_rcp_f32 v225, v225
    v_rcp_f32 v226, v226
    v_rcp_f32 v227, v227
    v_pk_mul_f32 v[80:81], v[80:81], v[220:221]
    v_pk_mul_f32 v[82:83], v[82:83], v[222:223]
    v_pk_mul_f32 v[84:85], v[84:85], v[224:225]
    v_pk_mul_f32 v[86:87], v[86:87], v[226:227]
    v_pk_add_f32 v[204:205], v[204:205], v[80:81]
    v_pk_fma_f32 v[206:207], v[80:81], v[80:81], v[206:207]
    v_pk_add_f32 v[208:209], v[208:209], v[82:83]
    v_pk_fma_f32 v[210:211], v[82:83], v[82:83], v[210:211]
    v_pk_add_f32 v[212:213], v[212:213], v[84:85]
    v_pk_fma_f32 v[214:215], v[84:85], v[84:85], v[214:215]
    v_pk_add_f32 v[216:217], v[216:217], v[86:87]
    v_pk_fma_f32 v[218:219], v[86:87], v[86:87], v[218:219]
    v_lshrrev_b32 v8, 2, v6
    v_lshlrev_b32 v8, 4, v8
    v_lshl_add_u32 v8, v5, 6, v8
    v_and_b32 v9, 3, v6
    v_cmp_eq_u32 vcc, 0, v9
    v_bfrev_b32 v10, 1
    v_lshl_add_u32 v255, v9, 8, v8
    v_cndmask_b32 v8, v10, v8, vcc
    v_cmp_eq_u32 vcc, 0, v1
    v_add_f32_dpp v204, v204, v204 row_mirror row_mask:0xf bank_mask:0x3
    v_add_f32_dpp v205, v205, v205 row_mirror row_mask:0xf bank_mask:0x3
    v_add_f32_dpp v206, v206, v206 row_mirror row_mask:0xf bank_mask:0x3
    v_add_f32_dpp v207, v207, v207 row_mirror row_mask:0xf bank_mask:0x3
    v_add_f32_dpp v208, v208, v208 row_mirror row_mask:0xf bank_mask:0x3
    v_add_f32_dpp v209, v209, v209 row_mirror row_mask:0xf bank_mask:0x3
    v_add_f32_dpp v210, v210, v210 row_mirror row_mask:0xf bank_mask:0x3
    v_add_f32_dpp v211, v211, v211 row_mirror row_mask:0xf bank_mask:0x3
    v_add_f32_dpp v204, v212, v212 row_mirror row_mask:0xf bank_mask:0xc
    v_add_f32_dpp v205, v213, v213 row_mirror row_mask:0xf bank_mask:0xc
    v_add_f32_dpp v206, v214, v214 row_mirror row_mask:0xf bank_mask:0xc
    v_add_f32_dpp v207, v215, v215 row_mirror row_mask:0xf bank_mask:0xc
    v_add_f32_dpp v208, v216, v216 row_mirror row_mask:0xf bank_mask:0xc
    v_add_f32_dpp v209, v217, v217 row_mirror row_mask:0xf bank_mask:0xc
    v_add_f32_dpp v210, v218, v218 row_mirror row_mask:0xf bank_mask:0xc
    v_add_f32_dpp v211, v219, v219 row_mirror row_mask:0xf bank_mask:0xc
    v_add_f32_dpp v204, v204, v204 row_half_mirror row_mask:0xf bank_mask:0x5
    v_add_f32_dpp v205, v205, v205 row_half_mirror row_mask:0xf bank_mask:0x5
    v_add_f32_dpp v206, v206, v206 row_half_mirror row_mask:0xf bank_mask:0x5
    v_add_f32_dpp v207, v207, v207 row_half_mirror row_mask:0xf bank_mask:0x5
    v_add_f32_dpp v204, v208, v208 row_half_mirror row_mask:0xf bank_mask:0xa
    v_add_f32_dpp v205, v209, v209 row_half_mirror row_mask:0xf bank_mask:0xa
    v_add_f32_dpp v206, v210, v210 row_half_mirror row_mask:0xf bank_mask:0xa
    v_add_f32_dpp v207, v211, v211 row_half_mirror row_mask:0xf bank_mask:0xa
    v_add_f32_dpp v204, v204, v204 quad_perm:[1,0,3,2] row_mask:0xf bank_mask:0xf
    v_add_f32_dpp v205, v205, v205 quad_perm:[1,0,3,2] row_mask:0xf bank_mask:0xf
    v_add_f32_dpp v206, v206, v206 quad_perm:[1,0,3,2] row_mask:0xf bank_mask:0xf
    v_add_f32_dpp v207, v207, v207 quad_perm:[1,0,3,2] row_mask:0xf bank_mask:0xf
    v_add_f32_dpp v12, v204, v204 quad_perm:[2,3,0,1] row_mask:0xf bank_mask:0xf
    v_add_f32_dpp v13, v205, v205 quad_perm:[2,3,0,1] row_mask:0xf bank_mask:0xf
    v_add_f32_dpp v14, v206, v206 quad_perm:[2,3,0,1] row_mask:0xf bank_mask:0xf
    v_add_f32_dpp v15, v207, v207 quad_perm:[2,3,0,1] row_mask:0xf bank_mask:0xf
    v_cndmask_b32 v253, v10, v1, vcc
    v_mov_b32 v252, 1
    v_mov_b32 v254, 0
    buffer_store_dwordx4 v[12:15], v8, s[4:7], s36 offen sc1
    s_waitcnt lgkmcnt(5)
    v_mfma_f32_16x16x32_bf16 v[88:91], v[168:171], v[160:163], 0
    ds_read_b128 v[204:207], v3 offset:17408
    v_mfma_f32_16x16x32_bf16 v[92:95], v[168:171], v[164:167], 0
    ds_read_b128 v[208:211], v3 offset:19456
    v_mfma_f32_16x16x32_bf16 v[96:99], v[172:175], v[160:163], 0
    ds_read_b128 v[212:215], v1 offset:27648
    v_mfma_f32_16x16x32_bf16 v[100:103], v[172:175], v[164:167], 0
    ds_read_b128 v[216:219], v1 offset:28672
    v_mfma_f32_16x16x32_bf16 v[104:107], v[176:179], v[160:163], 0
    ds_read_b128 v[220:223], v1 offset:29696
    v_mfma_f32_16x16x32_bf16 v[108:111], v[176:179], v[164:167], 0
    ds_read_b128 v[224:227], v1 offset:30720
    v_mfma_f32_16x16x32_bf16 v[112:115], v[180:183], v[160:163], 0
    ds_read_b128 v[228:231], v1 offset:31744
    v_mfma_f32_16x16x32_bf16 v[116:119], v[180:183], v[164:167], 0
    ds_read_b128 v[232:235], v1 offset:32768
    s_waitcnt lgkmcnt(8)
    v_mfma_f32_16x16x32_bf16 v[120:123], v[184:187], v[160:163], 0
    ds_read_b128 v[236:239], v1 offset:33792
    v_mfma_f32_16x16x32_bf16 v[124:127], v[184:187], v[164:167], 0
    ds_read_b128 v[240:243], v1 offset:34816
    v_mfma_f32_16x16x32_bf16 v[128:131], v[188:191], v[160:163], 0
    ds_read_b128 v[244:247], v1 offset:35840
    v_mfma_f32_16x16x32_bf16 v[132:135], v[188:191], v[164:167], 0
    v_mfma_f32_16x16x32_bf16 v[136:139], v[192:195], v[160:163], 0
    v_mfma_f32_16x16x32_bf16 v[140:143], v[192:195], v[164:167], 0
    v_mfma_f32_16x16x32_bf16 v[144:147], v[196:199], v[160:163], 0
    v_mfma_f32_16x16x32_bf16 v[148:151], v[196:199], v[164:167], 0
    v_mfma_f32_16x16x32_bf16 v[152:155], v[200:203], v[160:163], 0
    v_mfma_f32_16x16x32_bf16 v[156:159], v[200:203], v[164:167], 0
    s_waitcnt lgkmcnt(0)
    s_barrier
    v_mfma_f32_16x16x32_bf16 v[88:91], v[212:215], v[204:207], v[88:91]
    ds_read_b128 v[160:163], v3 offset:32768
    v_mfma_f32_16x16x32_bf16 v[92:95], v[212:215], v[208:211], v[92:95]
    ds_read_b128 v[164:167], v3 offset:34816
    v_mfma_f32_16x16x32_bf16 v[96:99], v[216:219], v[204:207], v[96:99]
    ds_read_b128 v[168:171], v2 offset:0
    v_mfma_f32_16x16x32_bf16 v[100:103], v[216:219], v[208:211], v[100:103]
    ds_read_b128 v[172:175], v2 offset:1024
    v_mfma_f32_16x16x32_bf16 v[104:107], v[220:223], v[204:207], v[104:107]
    ds_read_b128 v[176:179], v2 offset:2048
    v_mfma_f32_16x16x32_bf16 v[108:111], v[220:223], v[208:211], v[108:111]
    ds_read_b128 v[180:183], v2 offset:3072
    v_mfma_f32_16x16x32_bf16 v[112:115], v[224:227], v[204:207], v[112:115]
    ds_read_b128 v[184:187], v2 offset:4096
    v_mfma_f32_16x16x32_bf16 v[116:119], v[224:227], v[208:211], v[116:119]
    ds_read_b128 v[188:191], v2 offset:5120
    v_mfma_f32_16x16x32_bf16 v[120:123], v[228:231], v[204:207], v[120:123]
    ds_read_b128 v[192:195], v2 offset:6144
    v_mfma_f32_16x16x32_bf16 v[124:127], v[228:231], v[208:211], v[124:127]
    ds_read_b128 v[196:199], v2 offset:7168
    v_mfma_f32_16x16x32_bf16 v[128:131], v[232:235], v[204:207], v[128:131]
    ds_read_b128 v[200:203], v2 offset:8192
    v_mfma_f32_16x16x32_bf16 v[132:135], v[232:235], v[208:211], v[132:135]
    v_mfma_f32_16x16x32_bf16 v[136:139], v[236:239], v[204:207], v[136:139]
    v_mfma_f32_16x16x32_bf16 v[140:143], v[236:239], v[208:211], v[140:143]
    v_mfma_f32_16x16x32_bf16 v[144:147], v[240:243], v[204:207], v[144:147]
    v_mfma_f32_16x16x32_bf16 v[148:151], v[240:243], v[208:211], v[148:151]
    v_mfma_f32_16x16x32_bf16 v[152:155], v[244:247], v[204:207], v[152:155]
    v_mfma_f32_16x16x32_bf16 v[156:159], v[244:247], v[208:211], v[156:159]
    s_waitcnt lgkmcnt(5)
    v_mfma_f32_16x16x32_bf16 v[88:91], v[168:171], v[160:163], v[88:91]
    ds_read_b128 v[204:207], v3 offset:33792
    v_mfma_f32_16x16x32_bf16 v[92:95], v[168:171], v[164:167], v[92:95]
    ds_read_b128 v[208:211], v3 offset:35840
    v_mfma_f32_16x16x32_bf16 v[96:99], v[172:175], v[160:163], v[96:99]
    ds_read_b128 v[212:215], v2 offset:9216
    v_mfma_f32_16x16x32_bf16 v[100:103], v[172:175], v[164:167], v[100:103]
    ds_read_b128 v[216:219], v2 offset:10240
    v_mfma_f32_16x16x32_bf16 v[104:107], v[176:179], v[160:163], v[104:107]
    ds_read_b128 v[220:223], v2 offset:11264
    v_mfma_f32_16x16x32_bf16 v[108:111], v[176:179], v[164:167], v[108:111]
    ds_read_b128 v[224:227], v2 offset:12288
    v_mfma_f32_16x16x32_bf16 v[112:115], v[180:183], v[160:163], v[112:115]
    ds_read_b128 v[228:231], v2 offset:13312
    v_mfma_f32_16x16x32_bf16 v[116:119], v[180:183], v[164:167], v[116:119]
    ds_read_b128 v[232:235], v2 offset:14336
    s_waitcnt lgkmcnt(8)
    v_mfma_f32_16x16x32_bf16 v[120:123], v[184:187], v[160:163], v[120:123]
    ds_read_b128 v[236:239], v2 offset:15360
    v_mfma_f32_16x16x32_bf16 v[124:127], v[184:187], v[164:167], v[124:127]
    ds_read_b128 v[240:243], v2 offset:16384
    v_mfma_f32_16x16x32_bf16 v[128:131], v[188:191], v[160:163], v[128:131]
    ds_read_b128 v[244:247], v2 offset:17408
    v_mfma_f32_16x16x32_bf16 v[132:135], v[188:191], v[164:167], v[132:135]
    v_mfma_f32_16x16x32_bf16 v[136:139], v[192:195], v[160:163], v[136:139]
    v_mfma_f32_16x16x32_bf16 v[140:143], v[192:195], v[164:167], v[140:143]
    v_mfma_f32_16x16x32_bf16 v[144:147], v[196:199], v[160:163], v[144:147]
    v_mfma_f32_16x16x32_bf16 v[148:151], v[196:199], v[164:167], v[148:151]
    v_mfma_f32_16x16x32_bf16 v[152:155], v[200:203], v[160:163], v[152:155]
    v_mfma_f32_16x16x32_bf16 v[156:159], v[200:203], v[164:167], v[156:159]
    s_waitcnt lgkmcnt(0)
    s_barrier
    v_mfma_f32_16x16x32_bf16 v[88:91], v[212:215], v[204:207], v[88:91]
    ds_read_b128 v[160:163], v3 offset:49152
    v_mfma_f32_16x16x32_bf16 v[92:95], v[212:215], v[208:211], v[92:95]
    ds_read_b128 v[164:167], v3 offset:51200
    v_mfma_f32_16x16x32_bf16 v[96:99], v[216:219], v[204:207], v[96:99]
    ds_read_b128 v[168:171], v2 offset:18432
    v_mfma_f32_16x16x32_bf16 v[100:103], v[216:219], v[208:211], v[100:103]
    ds_read_b128 v[172:175], v2 offset:19456
    v_mfma_f32_16x16x32_bf16 v[104:107], v[220:223], v[204:207], v[104:107]
    ds_read_b128 v[176:179], v2 offset:20480
    v_mfma_f32_16x16x32_bf16 v[108:111], v[220:223], v[208:211], v[108:111]
    ds_read_b128 v[180:183], v2 offset:21504
    v_mfma_f32_16x16x32_bf16 v[112:115], v[224:227], v[204:207], v[112:115]
    ds_read_b128 v[184:187], v2 offset:22528
    v_mfma_f32_16x16x32_bf16 v[116:119], v[224:227], v[208:211], v[116:119]
    ds_read_b128 v[188:191], v2 offset:23552
    v_mfma_f32_16x16x32_bf16 v[120:123], v[228:231], v[204:207], v[120:123]
    ds_read_b128 v[192:195], v2 offset:24576
    v_mfma_f32_16x16x32_bf16 v[124:127], v[228:231], v[208:211], v[124:127]
    ds_read_b128 v[196:199], v2 offset:25600
    v_mfma_f32_16x16x32_bf16 v[128:131], v[232:235], v[204:207], v[128:131]
    ds_read_b128 v[200:203], v2 offset:26624
    v_mfma_f32_16x16x32_bf16 v[132:135], v[232:235], v[208:211], v[132:135]
    v_mfma_f32_16x16x32_bf16 v[136:139], v[236:239], v[204:207], v[136:139]
    s_waitcnt vmcnt(0)
    buffer_atomic_add v252, v253, s[4:7], s37 offen sc1
    v_mfma_f32_16x16x32_bf16 v[140:143], v[236:239], v[208:211], v[140:143]
    v_mfma_f32_16x16x32_bf16 v[144:147], v[240:243], v[204:207], v[144:147]
    v_mfma_f32_16x16x32_bf16 v[148:151], v[240:243], v[208:211], v[148:151]
    v_mfma_f32_16x16x32_bf16 v[152:155], v[244:247], v[204:207], v[152:155]
    v_mfma_f32_16x16x32_bf16 v[156:159], v[244:247], v[208:211], v[156:159]
    s_waitcnt lgkmcnt(5)
    v_mfma_f32_16x16x32_bf16 v[88:91], v[168:171], v[160:163], v[88:91]
    ds_read_b128 v[204:207], v3 offset:50176
    v_mfma_f32_16x16x32_bf16 v[92:95], v[168:171], v[164:167], v[92:95]
    ds_read_b128 v[208:211], v3 offset:52224
    v_mfma_f32_16x16x32_bf16 v[96:99], v[172:175], v[160:163], v[96:99]
    ds_read_b128 v[212:215], v2 offset:27648
    v_mfma_f32_16x16x32_bf16 v[100:103], v[172:175], v[164:167], v[100:103]
    ds_read_b128 v[216:219], v2 offset:28672
    v_mfma_f32_16x16x32_bf16 v[104:107], v[176:179], v[160:163], v[104:107]
    ds_read_b128 v[220:223], v2 offset:29696
    v_mfma_f32_16x16x32_bf16 v[108:111], v[176:179], v[164:167], v[108:111]
    ds_read_b128 v[224:227], v2 offset:30720
    v_mfma_f32_16x16x32_bf16 v[112:115], v[180:183], v[160:163], v[112:115]
    ds_read_b128 v[228:231], v2 offset:31744
    v_mfma_f32_16x16x32_bf16 v[116:119], v[180:183], v[164:167], v[116:119]
    ds_read_b128 v[232:235], v2 offset:32768
    s_waitcnt lgkmcnt(8)
    v_mfma_f32_16x16x32_bf16 v[120:123], v[184:187], v[160:163], v[120:123]
    ds_read_b128 v[236:239], v2 offset:33792
    v_mfma_f32_16x16x32_bf16 v[124:127], v[184:187], v[164:167], v[124:127]
    ds_read_b128 v[240:243], v2 offset:34816
    v_mfma_f32_16x16x32_bf16 v[128:131], v[188:191], v[160:163], v[128:131]
    ds_read_b128 v[244:247], v2 offset:35840
    v_mfma_f32_16x16x32_bf16 v[132:135], v[188:191], v[164:167], v[132:135]
    v_mfma_f32_16x16x32_bf16 v[136:139], v[192:195], v[160:163], v[136:139]
    v_mfma_f32_16x16x32_bf16 v[140:143], v[192:195], v[164:167], v[140:143]
    v_mfma_f32_16x16x32_bf16 v[144:147], v[196:199], v[160:163], v[144:147]
    v_mfma_f32_16x16x32_bf16 v[148:151], v[196:199], v[164:167], v[148:151]
    v_mfma_f32_16x16x32_bf16 v[152:155], v[200:203], v[160:163], v[152:155]
    v_mfma_f32_16x16x32_bf16 v[156:159], v[200:203], v[164:167], v[156:159]
    s_waitcnt lgkmcnt(0)
    s_barrier
    v_mfma_f32_16x16x32_bf16 v[88:91], v[212:215], v[204:207], v[88:91]
    ds_read_b128 v[160:163], v3 offset:0
    v_mfma_f32_16x16x32_bf16 v[92:95], v[212:215], v[208:211], v[92:95]
    ds_read_b128 v[164:167], v3 offset:2048
    v_mfma_f32_16x16x32_bf16 v[96:99], v[216:219], v[204:207], v[96:99]
    ds_read_b128 v[168:171], v1 offset:0
    v_mfma_f32_16x16x32_bf16 v[100:103], v[216:219], v[208:211], v[100:103]
    ds_read_b128 v[172:175], v1 offset:1024
    v_mfma_f32_16x16x32_bf16 v[104:107], v[220:223], v[204:207], v[104:107]
    ds_read_b128 v[176:179], v1 offset:2048
    v_mfma_f32_16x16x32_bf16 v[108:111], v[220:223], v[208:211], v[108:111]
    ds_read_b128 v[180:183], v1 offset:3072
    v_mfma_f32_16x16x32_bf16 v[112:115], v[224:227], v[204:207], v[112:115]
    ds_read_b128 v[184:187], v1 offset:4096
    v_mfma_f32_16x16x32_bf16 v[116:119], v[224:227], v[208:211], v[116:119]
    ds_read_b128 v[188:191], v1 offset:5120
    v_mfma_f32_16x16x32_bf16 v[120:123], v[228:231], v[204:207], v[120:123]
    ds_read_b128 v[192:195], v1 offset:6144
    v_mfma_f32_16x16x32_bf16 v[124:127], v[228:231], v[208:211], v[124:127]
    ds_read_b128 v[196:199], v1 offset:7168
    v_mfma_f32_16x16x32_bf16 v[128:131], v[232:235], v[204:207], v[128:131]
    ds_read_b128 v[200:203], v1 offset:8192
    v_mfma_f32_16x16x32_bf16 v[132:135], v[232:235], v[208:211], v[132:135]
    v_mfma_f32_16x16x32_bf16 v[136:139], v[236:239], v[204:207], v[136:139]
    v_mfma_f32_16x16x32_bf16 v[140:143], v[236:239], v[208:211], v[140:143]
    v_mfma_f32_16x16x32_bf16 v[144:147], v[240:243], v[204:207], v[144:147]
    v_mfma_f32_16x16x32_bf16 v[148:151], v[240:243], v[208:211], v[148:151]
    v_mfma_f32_16x16x32_bf16 v[152:155], v[244:247], v[204:207], v[152:155]
    v_mfma_f32_16x16x32_bf16 v[156:159], v[244:247], v[208:211], v[156:159]
    s_waitcnt lgkmcnt(5)
    v_mfma_f32_16x16x32_bf16 v[88:91], v[168:171], v[160:163], v[88:91]
    ds_read_b128 v[204:207], v3 offset:1024
    v_mfma_f32_16x16x32_bf16 v[92:95], v[168:171], v[164:167], v[92:95]
    ds_read_b128 v[208:211], v3 offset:3072
    v_mfma_f32_16x16x32_bf16 v[96:99], v[172:175], v[160:163], v[96:99]
    ds_read_b128 v[212:215], v1 offset:9216
    v_mfma_f32_16x16x32_bf16 v[100:103], v[172:175], v[164:167], v[100:103]
    ds_read_b128 v[216:219], v1 offset:10240
    v_mfma_f32_16x16x32_bf16 v[104:107], v[176:179], v[160:163], v[104:107]
    ds_read_b128 v[220:223], v1 offset:11264
    v_mfma_f32_16x16x32_bf16 v[108:111], v[176:179], v[164:167], v[108:111]
    ds_read_b128 v[224:227], v1 offset:12288
    v_mfma_f32_16x16x32_bf16 v[112:115], v[180:183], v[160:163], v[112:115]
    ds_read_b128 v[228:231], v1 offset:13312
    v_mfma_f32_16x16x32_bf16 v[116:119], v[180:183], v[164:167], v[116:119]
    ds_read_b128 v[232:235], v1 offset:14336
    s_waitcnt lgkmcnt(8)
    v_mfma_f32_16x16x32_bf16 v[120:123], v[184:187], v[160:163], v[120:123]
    ds_read_b128 v[236:239], v1 offset:15360
    v_mfma_f32_16x16x32_bf16 v[124:127], v[184:187], v[164:167], v[124:127]
    ds_read_b128 v[240:243], v1 offset:16384
    v_mfma_f32_16x16x32_bf16 v[128:131], v[188:191], v[160:163], v[128:131]
    ds_read_b128 v[244:247], v1 offset:17408
    v_mfma_f32_16x16x32_bf16 v[132:135], v[188:191], v[164:167], v[132:135]
    v_mfma_f32_16x16x32_bf16 v[136:139], v[192:195], v[160:163], v[136:139]
    v_mfma_f32_16x16x32_bf16 v[140:143], v[192:195], v[164:167], v[140:143]
    v_mfma_f32_16x16x32_bf16 v[144:147], v[196:199], v[160:163], v[144:147]
    v_mfma_f32_16x16x32_bf16 v[148:151], v[196:199], v[164:167], v[148:151]
    v_mfma_f32_16x16x32_bf16 v[152:155], v[200:203], v[160:163], v[152:155]
    v_mfma_f32_16x16x32_bf16 v[156:159], v[200:203], v[164:167], v[156:159]
    s_waitcnt lgkmcnt(0)
    s_barrier
    v_mfma_f32_16x16x32_bf16 v[88:91], v[212:215], v[204:207], v[88:91]
    ds_read_b128 v[160:163], v3 offset:16384
    v_mfma_f32_16x16x32_bf16 v[92:95], v[212:215], v[208:211], v[92:95]
    ds_read_b128 v[164:167], v3 offset:18432
    v_mfma_f32_16x16x32_bf16 v[96:99], v[216:219], v[204:207], v[96:99]
    ds_read_b128 v[168:171], v1 offset:18432
    v_mfma_f32_16x16x32_bf16 v[100:103], v[216:219], v[208:211], v[100:103]
    ds_read_b128 v[172:175], v1 offset:19456
    v_mfma_f32_16x16x32_bf16 v[104:107], v[220:223], v[204:207], v[104:107]
    ds_read_b128 v[176:179], v1 offset:20480
    v_mfma_f32_16x16x32_bf16 v[108:111], v[220:223], v[208:211], v[108:111]
    ds_read_b128 v[180:183], v1 offset:21504
    v_mfma_f32_16x16x32_bf16 v[112:115], v[224:227], v[204:207], v[112:115]
    ds_read_b128 v[184:187], v1 offset:22528
    v_mfma_f32_16x16x32_bf16 v[116:119], v[224:227], v[208:211], v[116:119]
    ds_read_b128 v[188:191], v1 offset:23552
    v_mfma_f32_16x16x32_bf16 v[120:123], v[228:231], v[204:207], v[120:123]
    ds_read_b128 v[192:195], v1 offset:24576
    v_mfma_f32_16x16x32_bf16 v[124:127], v[228:231], v[208:211], v[124:127]
    ds_read_b128 v[196:199], v1 offset:25600
    v_mfma_f32_16x16x32_bf16 v[128:131], v[232:235], v[204:207], v[128:131]
    ds_read_b128 v[200:203], v1 offset:26624
    v_mfma_f32_16x16x32_bf16 v[132:135], v[232:235], v[208:211], v[132:135]
    v_mfma_f32_16x16x32_bf16 v[136:139], v[236:239], v[204:207], v[136:139]
    v_mfma_f32_16x16x32_bf16 v[140:143], v[236:239], v[208:211], v[140:143]
    v_mfma_f32_16x16x32_bf16 v[144:147], v[240:243], v[204:207], v[144:147]
    v_mfma_f32_16x16x32_bf16 v[148:151], v[240:243], v[208:211], v[148:151]
    v_mfma_f32_16x16x32_bf16 v[152:155], v[244:247], v[204:207], v[152:155]
    v_mfma_f32_16x16x32_bf16 v[156:159], v[244:247], v[208:211], v[156:159]
    s_waitcnt lgkmcnt(5)
    v_mfma_f32_16x16x32_bf16 v[88:91], v[168:171], v[160:163], v[88:91]
    ds_read_b128 v[204:207], v3 offset:17408
    v_mfma_f32_16x16x32_bf16 v[92:95], v[168:171], v[164:167], v[92:95]
    ds_read_b128 v[208:211], v3 offset:19456
    v_mfma_f32_16x16x32_bf16 v[96:99], v[172:175], v[160:163], v[96:99]
    ds_read_b128 v[212:215], v1 offset:27648
    v_mfma_f32_16x16x32_bf16 v[100:103], v[172:175], v[164:167], v[100:103]
    ds_read_b128 v[216:219], v1 offset:28672
    v_mfma_f32_16x16x32_bf16 v[104:107], v[176:179], v[160:163], v[104:107]
    ds_read_b128 v[220:223], v1 offset:29696
    v_mfma_f32_16x16x32_bf16 v[108:111], v[176:179], v[164:167], v[108:111]
    ds_read_b128 v[224:227], v1 offset:30720
    v_mfma_f32_16x16x32_bf16 v[112:115], v[180:183], v[160:163], v[112:115]
    ds_read_b128 v[228:231], v1 offset:31744
    v_mfma_f32_16x16x32_bf16 v[116:119], v[180:183], v[164:167], v[116:119]
    ds_read_b128 v[232:235], v1 offset:32768
    s_waitcnt lgkmcnt(8)
    v_mfma_f32_16x16x32_bf16 v[120:123], v[184:187], v[160:163], v[120:123]
    ds_read_b128 v[236:239], v1 offset:33792
    v_mfma_f32_16x16x32_bf16 v[124:127], v[184:187], v[164:167], v[124:127]
    ds_read_b128 v[240:243], v1 offset:34816
    v_mfma_f32_16x16x32_bf16 v[128:131], v[188:191], v[160:163], v[128:131]
    ds_read_b128 v[244:247], v1 offset:35840
    v_mfma_f32_16x16x32_bf16 v[132:135], v[188:191], v[164:167], v[132:135]
    v_mfma_f32_16x16x32_bf16 v[136:139], v[192:195], v[160:163], v[136:139]
    v_mfma_f32_16x16x32_bf16 v[140:143], v[192:195], v[164:167], v[140:143]
    v_mfma_f32_16x16x32_bf16 v[144:147], v[196:199], v[160:163], v[144:147]
    v_mfma_f32_16x16x32_bf16 v[148:151], v[196:199], v[164:167], v[148:151]
    v_mfma_f32_16x16x32_bf16 v[152:155], v[200:203], v[160:163], v[152:155]
    v_mfma_f32_16x16x32_bf16 v[156:159], v[200:203], v[164:167], v[156:159]
    s_waitcnt lgkmcnt(0)
    s_barrier
    v_mfma_f32_16x16x32_bf16 v[88:91], v[212:215], v[204:207], v[88:91]
    ds_read_b128 v[160:163], v3 offset:32768
    v_mfma_f32_16x16x32_bf16 v[92:95], v[212:215], v[208:211], v[92:95]
    ds_read_b128 v[164:167], v3 offset:34816
    v_mfma_f32_16x16x32_bf16 v[96:99], v[216:219], v[204:207], v[96:99]
    ds_read_b128 v[168:171], v2 offset:0
    v_mfma_f32_16x16x32_bf16 v[100:103], v[216:219], v[208:211], v[100:103]
    ds_read_b128 v[172:175], v2 offset:1024
    v_mfma_f32_16x16x32_bf16 v[104:107], v[220:223], v[204:207], v[104:107]
    ds_read_b128 v[176:179], v2 offset:2048
    v_mfma_f32_16x16x32_bf16 v[108:111], v[220:223], v[208:211], v[108:111]
    ds_read_b128 v[180:183], v2 offset:3072
    v_mfma_f32_16x16x32_bf16 v[112:115], v[224:227], v[204:207], v[112:115]
    ds_read_b128 v[184:187], v2 offset:4096
    v_mfma_f32_16x16x32_bf16 v[116:119], v[224:227], v[208:211], v[116:119]
    ds_read_b128 v[188:191], v2 offset:5120
    v_mfma_f32_16x16x32_bf16 v[120:123], v[228:231], v[204:207], v[120:123]
    ds_read_b128 v[192:195], v2 offset:6144
    v_mfma_f32_16x16x32_bf16 v[124:127], v[228:231], v[208:211], v[124:127]
    ds_read_b128 v[196:199], v2 offset:7168
    v_mfma_f32_16x16x32_bf16 v[128:131], v[232:235], v[204:207], v[128:131]
    ds_read_b128 v[200:203], v2 offset:8192
    v_mfma_f32_16x16x32_bf16 v[132:135], v[232:235], v[208:211], v[132:135]
    v_mfma_f32_16x16x32_bf16 v[136:139], v[236:239], v[204:207], v[136:139]
    v_mfma_f32_16x16x32_bf16 v[140:143], v[236:239], v[208:211], v[140:143]
    v_mfma_f32_16x16x32_bf16 v[144:147], v[240:243], v[204:207], v[144:147]
    v_mfma_f32_16x16x32_bf16 v[148:151], v[240:243], v[208:211], v[148:151]
    v_mfma_f32_16x16x32_bf16 v[152:155], v[244:247], v[204:207], v[152:155]
    v_mfma_f32_16x16x32_bf16 v[156:159], v[244:247], v[208:211], v[156:159]
    s_waitcnt lgkmcnt(5)
    v_mfma_f32_16x16x32_bf16 v[88:91], v[168:171], v[160:163], v[88:91]
    ds_read_b128 v[204:207], v3 offset:33792
    v_mfma_f32_16x16x32_bf16 v[92:95], v[168:171], v[164:167], v[92:95]
    ds_read_b128 v[208:211], v3 offset:35840
    v_mfma_f32_16x16x32_bf16 v[96:99], v[172:175], v[160:163], v[96:99]
    ds_read_b128 v[212:215], v2 offset:9216
    v_mfma_f32_16x16x32_bf16 v[100:103], v[172:175], v[164:167], v[100:103]
    ds_read_b128 v[216:219], v2 offset:10240
    v_mfma_f32_16x16x32_bf16 v[104:107], v[176:179], v[160:163], v[104:107]
    ds_read_b128 v[220:223], v2 offset:11264
    v_mfma_f32_16x16x32_bf16 v[108:111], v[176:179], v[164:167], v[108:111]
    ds_read_b128 v[224:227], v2 offset:12288
    v_mfma_f32_16x16x32_bf16 v[112:115], v[180:183], v[160:163], v[112:115]
    ds_read_b128 v[228:231], v2 offset:13312
    v_mfma_f32_16x16x32_bf16 v[116:119], v[180:183], v[164:167], v[116:119]
    ds_read_b128 v[232:235], v2 offset:14336
    s_waitcnt lgkmcnt(8)
    v_mfma_f32_16x16x32_bf16 v[120:123], v[184:187], v[160:163], v[120:123]
    ds_read_b128 v[236:239], v2 offset:15360
    v_mfma_f32_16x16x32_bf16 v[124:127], v[184:187], v[164:167], v[124:127]
    ds_read_b128 v[240:243], v2 offset:16384
    v_mfma_f32_16x16x32_bf16 v[128:131], v[188:191], v[160:163], v[128:131]
    ds_read_b128 v[244:247], v2 offset:17408
    v_mfma_f32_16x16x32_bf16 v[132:135], v[188:191], v[164:167], v[132:135]
    v_mfma_f32_16x16x32_bf16 v[136:139], v[192:195], v[160:163], v[136:139]
    v_mfma_f32_16x16x32_bf16 v[140:143], v[192:195], v[164:167], v[140:143]
    v_mfma_f32_16x16x32_bf16 v[144:147], v[196:199], v[160:163], v[144:147]
    v_mfma_f32_16x16x32_bf16 v[148:151], v[196:199], v[164:167], v[148:151]
    v_mfma_f32_16x16x32_bf16 v[152:155], v[200:203], v[160:163], v[152:155]
    v_mfma_f32_16x16x32_bf16 v[156:159], v[200:203], v[164:167], v[156:159]
    s_waitcnt lgkmcnt(0)
    s_barrier
    v_mfma_f32_16x16x32_bf16 v[88:91], v[212:215], v[204:207], v[88:91]
    ds_read_b128 v[160:163], v3 offset:49152
    v_mfma_f32_16x16x32_bf16 v[92:95], v[212:215], v[208:211], v[92:95]
    ds_read_b128 v[164:167], v3 offset:51200
    v_mfma_f32_16x16x32_bf16 v[96:99], v[216:219], v[204:207], v[96:99]
    ds_read_b128 v[168:171], v2 offset:18432
    v_mfma_f32_16x16x32_bf16 v[100:103], v[216:219], v[208:211], v[100:103]
    ds_read_b128 v[172:175], v2 offset:19456
    v_mfma_f32_16x16x32_bf16 v[104:107], v[220:223], v[204:207], v[104:107]
    ds_read_b128 v[176:179], v2 offset:20480
    v_mfma_f32_16x16x32_bf16 v[108:111], v[220:223], v[208:211], v[108:111]
    ds_read_b128 v[180:183], v2 offset:21504
    v_mfma_f32_16x16x32_bf16 v[112:115], v[224:227], v[204:207], v[112:115]
    ds_read_b128 v[184:187], v2 offset:22528
    v_mfma_f32_16x16x32_bf16 v[116:119], v[224:227], v[208:211], v[116:119]
    ds_read_b128 v[188:191], v2 offset:23552
    v_mfma_f32_16x16x32_bf16 v[120:123], v[228:231], v[204:207], v[120:123]
    ds_read_b128 v[192:195], v2 offset:24576
    v_mfma_f32_16x16x32_bf16 v[124:127], v[228:231], v[208:211], v[124:127]
    ds_read_b128 v[196:199], v2 offset:25600
    v_mfma_f32_16x16x32_bf16 v[128:131], v[232:235], v[204:207], v[128:131]
    ds_read_b128 v[200:203], v2 offset:26624
    v_mfma_f32_16x16x32_bf16 v[132:135], v[232:235], v[208:211], v[132:135]
    v_mfma_f32_16x16x32_bf16 v[136:139], v[236:239], v[204:207], v[136:139]
    buffer_load_dword v4, v254, s[4:7], s37 offen sc1
    v_mfma_f32_16x16x32_bf16 v[140:143], v[236:239], v[208:211], v[140:143]
    v_mfma_f32_16x16x32_bf16 v[144:147], v[240:243], v[204:207], v[144:147]
    v_mfma_f32_16x16x32_bf16 v[148:151], v[240:243], v[208:211], v[148:151]
    v_mfma_f32_16x16x32_bf16 v[152:155], v[244:247], v[204:207], v[152:155]
    v_mfma_f32_16x16x32_bf16 v[156:159], v[244:247], v[208:211], v[156:159]
    s_waitcnt lgkmcnt(5)
    v_mfma_f32_16x16x32_bf16 v[88:91], v[168:171], v[160:163], v[88:91]
    ds_read_b128 v[204:207], v3 offset:50176
    v_mfma_f32_16x16x32_bf16 v[92:95], v[168:171], v[164:167], v[92:95]
    ds_read_b128 v[208:211], v3 offset:52224
    v_mfma_f32_16x16x32_bf16 v[96:99], v[172:175], v[160:163], v[96:99]
    ds_read_b128 v[212:215], v2 offset:27648
    v_mfma_f32_16x16x32_bf16 v[100:103], v[172:175], v[164:167], v[100:103]
    ds_read_b128 v[216:219], v2 offset:28672
    v_mfma_f32_16x16x32_bf16 v[104:107], v[176:179], v[160:163], v[104:107]
    ds_read_b128 v[220:223], v2 offset:29696
    v_mfma_f32_16x16x32_bf16 v[108:111], v[176:179], v[164:167], v[108:111]
    ds_read_b128 v[224:227], v2 offset:30720
    v_mfma_f32_16x16x32_bf16 v[112:115], v[180:183], v[160:163], v[112:115]
    ds_read_b128 v[228:231], v2 offset:31744
    v_mfma_f32_16x16x32_bf16 v[116:119], v[180:183], v[164:167], v[116:119]
    ds_read_b128 v[232:235], v2 offset:32768
    s_waitcnt lgkmcnt(8)
    v_mfma_f32_16x16x32_bf16 v[120:123], v[184:187], v[160:163], v[120:123]
    ds_read_b128 v[236:239], v2 offset:33792
    v_mfma_f32_16x16x32_bf16 v[124:127], v[184:187], v[164:167], v[124:127]
    ds_read_b128 v[240:243], v2 offset:34816
    v_mfma_f32_16x16x32_bf16 v[128:131], v[188:191], v[160:163], v[128:131]
    ds_read_b128 v[244:247], v2 offset:35840
    v_mfma_f32_16x16x32_bf16 v[132:135], v[188:191], v[164:167], v[132:135]
    v_mfma_f32_16x16x32_bf16 v[136:139], v[192:195], v[160:163], v[136:139]
    v_mfma_f32_16x16x32_bf16 v[140:143], v[192:195], v[164:167], v[140:143]
    v_mfma_f32_16x16x32_bf16 v[144:147], v[196:199], v[160:163], v[144:147]
    v_mfma_f32_16x16x32_bf16 v[148:151], v[196:199], v[164:167], v[148:151]
    v_mfma_f32_16x16x32_bf16 v[152:155], v[200:203], v[160:163], v[152:155]
    v_mfma_f32_16x16x32_bf16 v[156:159], v[200:203], v[164:167], v[156:159]
    s_waitcnt lgkmcnt(0)
    s_barrier
    v_mfma_f32_16x16x32_bf16 v[88:91], v[212:215], v[204:207], v[88:91]
    ds_read_b128 v[160:163], v3 offset:0
    v_mfma_f32_16x16x32_bf16 v[92:95], v[212:215], v[208:211], v[92:95]
    ds_read_b128 v[164:167], v3 offset:2048
    v_mfma_f32_16x16x32_bf16 v[96:99], v[216:219], v[204:207], v[96:99]
    ds_read_b128 v[168:171], v1 offset:0
    v_mfma_f32_16x16x32_bf16 v[100:103], v[216:219], v[208:211], v[100:103]
    ds_read_b128 v[172:175], v1 offset:1024
    v_mfma_f32_16x16x32_bf16 v[104:107], v[220:223], v[204:207], v[104:107]
    ds_read_b128 v[176:179], v1 offset:2048
    v_mfma_f32_16x16x32_bf16 v[108:111], v[220:223], v[208:211], v[108:111]
    ds_read_b128 v[180:183], v1 offset:3072
    v_mfma_f32_16x16x32_bf16 v[112:115], v[224:227], v[204:207], v[112:115]
    ds_read_b128 v[184:187], v1 offset:4096
    v_mfma_f32_16x16x32_bf16 v[116:119], v[224:227], v[208:211], v[116:119]
    ds_read_b128 v[188:191], v1 offset:5120
    v_mfma_f32_16x16x32_bf16 v[120:123], v[228:231], v[204:207], v[120:123]
    ds_read_b128 v[192:195], v1 offset:6144
    v_mfma_f32_16x16x32_bf16 v[124:127], v[228:231], v[208:211], v[124:127]
    ds_read_b128 v[196:199], v1 offset:7168
    v_mfma_f32_16x16x32_bf16 v[128:131], v[232:235], v[204:207], v[128:131]
    ds_read_b128 v[200:203], v1 offset:8192
    v_mfma_f32_16x16x32_bf16 v[132:135], v[232:235], v[208:211], v[132:135]
    s_waitcnt vmcnt(0)
    v_cmp_gt_u32 vcc, 16, v4
    v_mfma_f32_16x16x32_bf16 v[136:139], v[236:239], v[204:207], v[136:139]
    v_mfma_f32_16x16x32_bf16 v[140:143], v[236:239], v[208:211], v[140:143]
    s_cbranch_vccnz L_g_slow
L_g_back:
    buffer_load_dwordx4 v[4:7], v255, s[4:7], s35 offen offset:0 sc1
    v_mfma_f32_16x16x32_bf16 v[144:147], v[240:243], v[204:207], v[144:147]
    buffer_load_dwordx4 v[8:11], v255, s[4:7], s35 offen offset:1024 sc1
    v_mfma_f32_16x16x32_bf16 v[148:151], v[240:243], v[208:211], v[148:151]
    buffer_load_dwordx4 v[12:15], v255, s[4:7], s35 offen offset:2048 sc1
    v_mfma_f32_16x16x32_bf16 v[152:155], v[244:247], v[204:207], v[152:155]
    buffer_load_dwordx4 v[252:255], v255, s[4:7], s35 offen offset:3072 sc1
    v_mfma_f32_16x16x32_bf16 v[156:159], v[244:247], v[208:211], v[156:159]
    s_waitcnt lgkmcnt(5)
    v_mfma_f32_16x16x32_bf16 v[88:91], v[168:171], v[160:163], v[88:91]
    ds_read_b128 v[204:207], v3 offset:1024
    v_mfma_f32_16x16x32_bf16 v[92:95], v[168:171], v[164:167], v[92:95]
    ds_read_b128 v[208:211], v3 offset:3072
    v_mfma_f32_16x16x32_bf16 v[96:99], v[172:175], v[160:163], v[96:99]
    ds_read_b128 v[212:215], v1 offset:9216
    v_mfma_f32_16x16x32_bf16 v[100:103], v[172:175], v[164:167], v[100:103]
    ds_read_b128 v[216:219], v1 offset:10240
    v_mfma_f32_16x16x32_bf16 v[104:107], v[176:179], v[160:163], v[104:107]
    ds_read_b128 v[220:223], v1 offset:11264
    v_mfma_f32_16x16x32_bf16 v[108:111], v[176:179], v[164:167], v[108:111]
    ds_read_b128 v[224:227], v1 offset:12288
    v_mfma_f32_16x16x32_bf16 v[112:115], v[180:183], v[160:163], v[112:115]
    ds_read_b128 v[228:231], v1 offset:13312
    v_mfma_f32_16x16x32_bf16 v[116:119], v[180:183], v[164:167], v[116:119]
    ds_read_b128 v[232:235], v1 offset:14336
    s_waitcnt lgkmcnt(8)
    v_mfma_f32_16x16x32_bf16 v[120:123], v[184:187], v[160:163], v[120:123]
    ds_read_b128 v[236:239], v1 offset:15360
    v_mfma_f32_16x16x32_bf16 v[124:127], v[184:187], v[164:167], v[124:127]
    ds_read_b128 v[240:243], v1 offset:16384
    v_mfma_f32_16x16x32_bf16 v[128:131], v[188:191], v[160:163], v[128:131]
    ds_read_b128 v[244:247], v1 offset:17408
    v_mfma_f32_16x16x32_bf16 v[132:135], v[188:191], v[164:167], v[132:135]
    v_mfma_f32_16x16x32_bf16 v[136:139], v[192:195], v[160:163], v[136:139]
    v_mfma_f32_16x16x32_bf16 v[140:143], v[192:195], v[164:167], v[140:143]
    v_mfma_f32_16x16x32_bf16 v[144:147], v[196:199], v[160:163], v[144:147]
    v_mfma_f32_16x16x32_bf16 v[148:151], v[196:199], v[164:167], v[148:151]
    v_mfma_f32_16x16x32_bf16 v[152:155], v[200:203], v[160:163], v[152:155]
    v_mfma_f32_16x16x32_bf16 v[156:159], v[200:203], v[164:167], v[156:159]
    s_waitcnt lgkmcnt(0)
    s_barrier
    v_mfma_f32_16x16x32_bf16 v[88:91], v[212:215], v[204:207], v[88:91]
    ds_read_b128 v[160:163], v3 offset:16384
    v_mfma_f32_16x16x32_bf16 v[92:95], v[212:215], v[208:211], v[92:95]
    ds_read_b128 v[164:167], v3 offset:18432
    v_mfma_f32_16x16x32_bf16 v[96:99], v[216:219], v[204:207], v[96:99]
    ds_read_b128 v[168:171], v1 offset:18432
    v_mfma_f32_16x16x32_bf16 v[100:103], v[216:219], v[208:211], v[100:103]
    ds_read_b128 v[172:175], v1 offset:19456
    v_mfma_f32_16x16x32_bf16 v[104:107], v[220:223], v[204:207], v[104:107]
    ds_read_b128 v[176:179], v1 offset:20480
    v_mfma_f32_16x16x32_bf16 v[108:111], v[220:223], v[208:211], v[108:111]
    ds_read_b128 v[180:183], v1 offset:21504
    v_mfma_f32_16x16x32_bf16 v[112:115], v[224:227], v[204:207], v[112:115]
    ds_read_b128 v[184:187], v1 offset:22528
    v_mfma_f32_16x16x32_bf16 v[116:119], v[224:227], v[208:211], v[116:119]
    ds_read_b128 v[188:191], v1 offset:23552
    v_mfma_f32_16x16x32_bf16 v[120:123], v[228:231], v[204:207], v[120:123]
    ds_read_b128 v[192:195], v1 offset:24576
    v_mfma_f32_16x16x32_bf16 v[124:127], v[228:231], v[208:211], v[124:127]
    ds_read_b128 v[196:199], v1 offset:25600
    v_mfma_f32_16x16x32_bf16 v[128:131], v[232:235], v[204:207], v[128:131]
    ds_read_b128 v[200:203], v1 offset:26624
    v_mfma_f32_16x16x32_bf16 v[132:135], v[232:235], v[208:211], v[132:135]
    v_mfma_f32_16x16x32_bf16 v[136:139], v[236:239], v[204:207], v[136:139]
    v_mfma_f32_16x16x32_bf16 v[140:143], v[236:239], v[208:211], v[140:143]
    v_mfma_f32_16x16x32_bf16 v[144:147], v[240:243], v[204:207], v[144:147]
    v_mfma_f32_16x16x32_bf16 v[148:151], v[240:243], v[208:211], v[148:151]
    v_mfma_f32_16x16x32_bf16 v[152:155], v[244:247], v[204:207], v[152:155]
    v_mfma_f32_16x16x32_bf16 v[156:159], v[244:247], v[208:211], v[156:159]
    s_waitcnt lgkmcnt(5)
    v_mfma_f32_16x16x32_bf16 v[88:91], v[168:171], v[160:163], v[88:91]
    ds_read_b128 v[204:207], v3 offset:17408
    v_mfma_f32_16x16x32_bf16 v[92:95], v[168:171], v[164:167], v[92:95]
    ds_read_b128 v[208:211], v3 offset:19456
    v_mfma_f32_16x16x32_bf16 v[96:99], v[172:175], v[160:163], v[96:99]
    ds_read_b128 v[212:215], v1 offset:27648
    v_mfma_f32_16x16x32_bf16 v[100:103], v[172:175], v[164:167], v[100:103]
    ds_read_b128 v[216:219], v1 offset:28672
    v_mfma_f32_16x16x32_bf16 v[104:107], v[176:179], v[160:163], v[104:107]
    ds_read_b128 v[220:223], v1 offset:29696
    v_mfma_f32_16x16x32_bf16 v[108:111], v[176:179], v[164:167], v[108:111]
    ds_read_b128 v[224:227], v1 offset:30720
    v_mfma_f32_16x16x32_bf16 v[112:115], v[180:183], v[160:163], v[112:115]
    ds_read_b128 v[228:231], v1 offset:31744
    v_mfma_f32_16x16x32_bf16 v[116:119], v[180:183], v[164:167], v[116:119]
    ds_read_b128 v[232:235], v1 offset:32768
    s_waitcnt lgkmcnt(8)
    v_mfma_f32_16x16x32_bf16 v[120:123], v[184:187], v[160:163], v[120:123]
    ds_read_b128 v[236:239], v1 offset:33792
    v_mfma_f32_16x16x32_bf16 v[124:127], v[184:187], v[164:167], v[124:127]
    ds_read_b128 v[240:243], v1 offset:34816
    v_mfma_f32_16x16x32_bf16 v[128:131], v[188:191], v[160:163], v[128:131]
    ds_read_b128 v[244:247], v1 offset:35840
    v_mfma_f32_16x16x32_bf16 v[132:135], v[188:191], v[164:167], v[132:135]
    v_mfma_f32_16x16x32_bf16 v[136:139], v[192:195], v[160:163], v[136:139]
    v_mfma_f32_16x16x32_bf16 v[140:143], v[192:195], v[164:167], v[140:143]
    v_mfma_f32_16x16x32_bf16 v[144:147], v[196:199], v[160:163], v[144:147]
    v_mfma_f32_16x16x32_bf16 v[148:151], v[196:199], v[164:167], v[148:151]
    v_mfma_f32_16x16x32_bf16 v[152:155], v[200:203], v[160:163], v[152:155]
    v_mfma_f32_16x16x32_bf16 v[156:159], v[200:203], v[164:167], v[156:159]
    s_waitcnt lgkmcnt(0)
    s_barrier
    v_mfma_f32_16x16x32_bf16 v[88:91], v[212:215], v[204:207], v[88:91]
    v_mfma_f32_16x16x32_bf16 v[92:95], v[212:215], v[208:211], v[92:95]
    v_mfma_f32_16x16x32_bf16 v[96:99], v[216:219], v[204:207], v[96:99]
    v_mfma_f32_16x16x32_bf16 v[100:103], v[216:219], v[208:211], v[100:103]
    v_mfma_f32_16x16x32_bf16 v[104:107], v[220:223], v[204:207], v[104:107]
    v_mfma_f32_16x16x32_bf16 v[108:111], v[220:223], v[208:211], v[108:111]
    v_mfma_f32_16x16x32_bf16 v[112:115], v[224:227], v[204:207], v[112:115]
    v_mfma_f32_16x16x32_bf16 v[116:119], v[224:227], v[208:211], v[116:119]
    v_mfma_f32_16x16x32_bf16 v[120:123], v[228:231], v[204:207], v[120:123]
    v_mfma_f32_16x16x32_bf16 v[124:127], v[228:231], v[208:211], v[124:127]
    v_mfma_f32_16x16x32_bf16 v[128:131], v[232:235], v[204:207], v[128:131]
    v_mfma_f32_16x16x32_bf16 v[132:135], v[232:235], v[208:211], v[132:135]
    v_mfma_f32_16x16x32_bf16 v[136:139], v[236:239], v[204:207], v[136:139]
    v_mfma_f32_16x16x32_bf16 v[140:143], v[236:239], v[208:211], v[140:143]
    v_mfma_f32_16x16x32_bf16 v[144:147], v[240:243], v[204:207], v[144:147]
    v_mfma_f32_16x16x32_bf16 v[148:151], v[240:243], v[208:211], v[148:151]
    v_mfma_f32_16x16x32_bf16 v[152:155], v[244:247], v[204:207], v[152:155]
    v_mfma_f32_16x16x32_bf16 v[156:159], v[244:247], v[208:211], v[156:159]
    s_waitcnt vmcnt(0)
    v_pk_add_f32 v[4:5], v[4:5], v[8:9]
    v_pk_add_f32 v[6:7], v[6:7], v[10:11]
    v_pk_add_f32 v[12:13], v[12:13], v[252:253]
    v_pk_add_f32 v[14:15], v[14:15], v[254:255]
    v_pk_add_f32 v[4:5], v[4:5], v[12:13]
    v_pk_add_f32 v[6:7], v[6:7], v[14:15]
    v_bfe_u32 v8, v0, 2, 2
    v_and_b32 v9, 3, v0
    v_lshl_add_u32 v8, v8, 3, v9
    s_lshl_b32 s33, s31, 5
    v_lshl_add_u32 v8, v8, 1, s33
    buffer_load_ushort v252, v8, s[12:15], 0 offen
    buffer_load_ushort v254, v8, s[12:15], 0 offen offset:8
    v_add_f32_dpp v4, v4, v4 quad_perm:[1,0,3,2] row_mask:0xf bank_mask:0xf
    v_add_f32_dpp v5, v5, v5 quad_perm:[1,0,3,2] row_mask:0xf bank_mask:0xf
    v_add_f32_dpp v6, v6, v6 quad_perm:[1,0,3,2] row_mask:0xf bank_mask:0xf
    v_add_f32_dpp v7, v7, v7 quad_perm:[1,0,3,2] row_mask:0xf bank_mask:0xf
    v_add_f32_dpp v4, v4, v4 quad_perm:[2,3,0,1] row_mask:0xf bank_mask:0xf
    v_add_f32_dpp v5, v5, v5 quad_perm:[2,3,0,1] row_mask:0xf bank_mask:0xf
    v_add_f32_dpp v6, v6, v6 quad_perm:[2,3,0,1] row_mask:0xf bank_mask:0xf
    v_add_f32_dpp v7, v7, v7 quad_perm:[2,3,0,1] row_mask:0xf bank_mask:0xf
    s_mov_b32 s44, 0x39e38e39
    v_pk_mul_f32 v[4:5], v[4:5], s[44:45] op_sel_hi:[1,0]
    v_pk_mul_f32 v[6:7], v[6:7], s[44:45] op_sel_hi:[1,0]
    v_pk_fma_f32 v[6:7], v[4:5], v[4:5], v[6:7] neg_lo:[1,0,0] neg_hi:[1,0,0]
    v_max_f32 v6, 0, v6
    v_max_f32 v7, 0, v7
    v_add_f32 v6, 0x3727c5ac, v6
    v_add_f32 v7, 0x3727c5ac, v7
    v_rsq_f32 v6, v6
    v_rsq_f32 v7, v7
    s_nop 0
    v_pk_mul_f32 v[4:5], v[4:5], v[6:7] neg_lo:[1,0] neg_hi:[1,0]
    s_add_u32 s39, s38, 4096
    s_add_u32 s46, s38, 8192
    v_mov_b32_dpp v160, v6 row_newbcast:0 row_mask:0xf bank_mask:0xf
    v_mov_b32_dpp v161, v7 row_newbcast:0 row_mask:0xf bank_mask:0xf
    v_mov_b32_dpp v162, v6 row_newbcast:4 row_mask:0xf bank_mask:0xf
    v_mov_b32_dpp v163, v7 row_newbcast:4 row_mask:0xf bank_mask:0xf
    v_mov_b32_dpp v164, v6 row_newbcast:8 row_mask:0xf bank_mask:0xf
    v_mov_b32_dpp v165, v7 row_newbcast:8 row_mask:0xf bank_mask:0xf
    v_mov_b32_dpp v166, v6 row_newbcast:12 row_mask:0xf bank_mask:0xf
    v_mov_b32_dpp v167, v7 row_newbcast:12 row_mask:0xf bank_mask:0xf
    v_mov_b32_dpp v168, v4 row_newbcast:0 row_mask:0xf bank_mask:0xf
    v_mov_b32_dpp v169, v5 row_newbcast:0 row_mask:0xf bank_mask:0xf
    v_mov_b32_dpp v170, v4 row_newbcast:4 row_mask:0xf bank_mask:0xf
    v_mov_b32_dpp v171, v5 row_newbcast:4 row_mask:0xf bank_mask:0xf
    v_mov_b32_dpp v172, v4 row_newbcast:8 row_mask:0xf bank_mask:0xf
    v_mov_b32_dpp v173, v5 row_newbcast:8 row_mask:0xf bank_mask:0xf
    v_mov_b32_dpp v174, v4 row_newbcast:12 row_mask:0xf bank_mask:0xf
    v_mov_b32_dpp v175, v5 row_newbcast:12 row_mask:0xf bank_mask:0xf
    v_bfe_u32 v5, v0, 4, 2
    v_lshlrev_b32 v5, 4, v5
    v_add_u32 v5, 139840, v5
    ds_read_b128 v[176:179], v5 offset:0
    ds_read_b128 v[212:215], v5 offset:1152
    ds_read_b128 v[180:183], v5 offset:64
    ds_read_b128 v[216:219], v5 offset:1216
    ds_read_b128 v[184:187], v5 offset:128
    ds_read_b128 v[220:223], v5 offset:1280
    ds_read_b128 v[188:191], v5 offset:192
    ds_read_b128 v[224:227], v5 offset:1344
    ds_read_b128 v[192:195], v5 offset:256
    ds_read_b128 v[228:231], v5 offset:1408
    ds_read_b128 v[196:199], v5 offset:320
    ds_read_b128 v[232:235], v5 offset:1472
    ds_read_b128 v[200:203], v5 offset:384
    ds_read_b128 v[236:239], v5 offset:1536
    ds_read_b128 v[204:207], v5 offset:448
    ds_read_b128 v[240:243], v5 offset:1600
    ds_read_b128 v[208:211], v5 offset:512
    ds_read_b128 v[244:247], v5 offset:1664
    v_pk_fma_f32 v[16:17], v[16:17], v[160:161], v[168:169]
    v_pk_fma_f32 v[18:19], v[18:19], v[162:163], v[170:171]
    v_pk_fma_f32 v[20:21], v[20:21], v[164:165], v[172:173]
    v_pk_fma_f32 v[22:23], v[22:23], v[166:167], v[174:175]
    v_cvt_pk_bf16_f32 v16, v16, v17
    v_cvt_pk_bf16_f32 v17, v18, v19
    v_cvt_pk_bf16_f32 v18, v20, v21
    v_cvt_pk_bf16_f32 v19, v22, v23
    buffer_store_dwordx4 v[16:19], v1, s[4:7], s38 offen offset:0 sc1
    v_pk_fma_f32 v[24:25], v[24:25], v[160:161], v[168:169]
    v_pk_fma_f32 v[26:27], v[26:27], v[162:163], v[170:171]
    v_pk_fma_f32 v[28:29], v[28:29], v[164:165], v[172:173]
    v_pk_fma_f32 v[30:31], v[30:31], v[166:167], v[174:175]
    v_cvt_pk_bf16_f32 v24, v24, v25
    v_cvt_pk_bf16_f32 v25, v26, v27
    v_cvt_pk_bf16_f32 v26, v28, v29
    v_cvt_pk_bf16_f32 v27, v30, v31
    buffer_store_dwordx4 v[24:27], v1, s[4:7], s38 offen offset:1024 sc1
    v_pk_fma_f32 v[32:33], v[32:33], v[160:161], v[168:169]
    v_pk_fma_f32 v[34:35], v[34:35], v[162:163], v[170:171]
    v_pk_fma_f32 v[36:37], v[36:37], v[164:165], v[172:173]
    v_pk_fma_f32 v[38:39], v[38:39], v[166:167], v[174:175]
    v_cvt_pk_bf16_f32 v32, v32, v33
    v_cvt_pk_bf16_f32 v33, v34, v35
    v_cvt_pk_bf16_f32 v34, v36, v37
    v_cvt_pk_bf16_f32 v35, v38, v39
    buffer_store_dwordx4 v[32:35], v1, s[4:7], s38 offen offset:2048 sc1
    v_pk_fma_f32 v[40:41], v[40:41], v[160:161], v[168:169]
    v_pk_fma_f32 v[42:43], v[42:43], v[162:163], v[170:171]
    v_pk_fma_f32 v[44:45], v[44:45], v[164:165], v[172:173]
    v_pk_fma_f32 v[46:47], v[46:47], v[166:167], v[174:175]
    v_cvt_pk_bf16_f32 v40, v40, v41
    v_cvt_pk_bf16_f32 v41, v42, v43
    v_cvt_pk_bf16_f32 v42, v44, v45
    v_cvt_pk_bf16_f32 v43, v46, v47
    buffer_store_dwordx4 v[40:43], v1, s[4:7], s38 offen offset:3072 sc1
    v_pk_fma_f32 v[48:49], v[48:49], v[160:161], v[168:169]
    v_pk_fma_f32 v[50:51], v[50:51], v[162:163], v[170:171]
    v_pk_fma_f32 v[52:53], v[52:53], v[164:165], v[172:173]
    v_pk_fma_f32 v[54:55], v[54:55], v[166:167], v[174:175]
    v_cvt_pk_bf16_f32 v48, v48, v49
    v_cvt_pk_bf16_f32 v49, v50, v51
    v_cvt_pk_bf16_f32 v50, v52, v53
    v_cvt_pk_bf16_f32 v51, v54, v55
    buffer_store_dwordx4 v[48:51], v1, s[4:7], s39 offen offset:0 sc1
    v_pk_fma_f32 v[56:57], v[56:57], v[160:161], v[168:169]
    v_pk_fma_f32 v[58:59], v[58:59], v[162:163], v[170:171]
    v_pk_fma_f32 v[60:61], v[60:61], v[164:165], v[172:173]
    v_pk_fma_f32 v[62:63], v[62:63], v[166:167], v[174:175]
    v_cvt_pk_bf16_f32 v56, v56, v57
    v_cvt_pk_bf16_f32 v57, v58, v59
    v_cvt_pk_bf16_f32 v58, v60, v61
    v_cvt_pk_bf16_f32 v59, v62, v63
    buffer_store_dwordx4 v[56:59], v1, s[4:7], s39 offen offset:1024 sc1
    v_pk_fma_f32 v[64:65], v[64:65], v[160:161], v[168:169]
    v_pk_fma_f32 v[66:67], v[66:67], v[162:163], v[170:171]
    v_pk_fma_f32 v[68:69], v[68:69], v[164:165], v[172:173]
    v_pk_fma_f32 v[70:71], v[70:71], v[166:167], v[174:175]
    v_cvt_pk_bf16_f32 v64, v64, v65
    v_cvt_pk_bf16_f32 v65, v66, v67
    v_cvt_pk_bf16_f32 v66, v68, v69
    v_cvt_pk_bf16_f32 v67, v70, v71
    buffer_store_dwordx4 v[64:67], v1, s[4:7], s39 offen offset:2048 sc1
    v_pk_fma_f32 v[72:73], v[72:73], v[160:161], v[168:169]
    v_pk_fma_f32 v[74:75], v[74:75], v[162:163], v[170:171]
    v_pk_fma_f32 v[76:77], v[76:77], v[164:165], v[172:173]
    v_pk_fma_f32 v[78:79], v[78:79], v[166:167], v[174:175]
    v_cvt_pk_bf16_f32 v72, v72, v73
    v_cvt_pk_bf16_f32 v73, v74, v75
    v_cvt_pk_bf16_f32 v74, v76, v77
    v_cvt_pk_bf16_f32 v75, v78, v79
    buffer_store_dwordx4 v[72:75], v1, s[4:7], s39 offen offset:3072 sc1
    v_pk_fma_f32 v[80:81], v[80:81], v[160:161], v[168:169]
    v_pk_fma_f32 v[82:83], v[82:83], v[162:163], v[170:171]
    v_pk_fma_f32 v[84:85], v[84:85], v[164:165], v[172:173]
    v_pk_fma_f32 v[86:87], v[86:87], v[166:167], v[174:175]
    v_cvt_pk_bf16_f32 v80, v80, v81
    v_cvt_pk_bf16_f32 v81, v82, v83
    v_cvt_pk_bf16_f32 v82, v84, v85
    v_cvt_pk_bf16_f32 v83, v86, v87
    buffer_store_dwordx4 v[80:83], v1, s[4:7], s46 offen offset:0 sc1
    v_mul_f32 v4, s40, v249
    v_mul_f32 v5, v249, v249
    v_mul_f32 v6, s40, v251
    v_mul_f32 v7, v251, v251
    v_mul_f32 v5, s42, v5
    v_rcp_f32 v249, v249
    v_mul_f32 v7, s42, v7
    v_rcp_f32 v251, v251
    v_mul_f32 v5, v5, v4
    v_mul_f32 v7, v7, v6
    s_waitcnt lgkmcnt(0)
    v_pk_add_f32 v[176:177], v[176:177], v[212:213]
    v_pk_add_f32 v[178:179], v[178:179], v[214:215]
    v_pk_add_f32 v[180:181], v[180:181], v[216:217]
    v_pk_add_f32 v[182:183], v[182:183], v[218:219]
    v_pk_add_f32 v[184:185], v[184:185], v[220:221]
    v_pk_add_f32 v[186:187], v[186:187], v[222:223]
    v_pk_add_f32 v[188:189], v[188:189], v[224:225]
    v_pk_add_f32 v[190:191], v[190:191], v[226:227]
    v_pk_add_f32 v[192:193], v[192:193], v[228:229]
    v_pk_add_f32 v[194:195], v[194:195], v[230:231]
    v_pk_add_f32 v[196:197], v[196:197], v[232:233]
    v_pk_add_f32 v[198:199], v[198:199], v[234:235]
    v_pk_add_f32 v[200:201], v[200:201], v[236:237]
    v_pk_add_f32 v[202:203], v[202:203], v[238:239]
    v_pk_add_f32 v[204:205], v[204:205], v[240:241]
    v_pk_add_f32 v[206:207], v[206:207], v[242:243]
    v_pk_add_f32 v[208:209], v[208:209], v[244:245]
    v_pk_add_f32 v[210:211], v[210:211], v[246:247]
    s_lshl_b32 s45, s22, 8
    s_add_u32 s45, s45, s24
    s_lshl_b32 s45, s45, 8
    s_add_u32 s45, s45, 0x8508000
    v_pk_fma_f32 v[88:89], v[248:249], v[176:177], v[88:89] op_sel_hi:[0,1,1] neg_lo:[1,0,0] neg_hi:[1,0,0]
    v_pk_fma_f32 v[90:91], v[248:249], v[178:179], v[90:91] op_sel_hi:[0,1,1] neg_lo:[1,0,0] neg_hi:[1,0,0]
    v_pk_fma_f32 v[92:93], v[250:251], v[176:177], v[92:93] op_sel_hi:[0,1,1] neg_lo:[1,0,0] neg_hi:[1,0,0]
    v_pk_fma_f32 v[94:95], v[250:251], v[178:179], v[94:95] op_sel_hi:[0,1,1] neg_lo:[1,0,0] neg_hi:[1,0,0]
    v_pk_mul_f32 v[160:161], v[88:89], v[88:89]
    v_pk_mul_f32 v[162:163], v[90:91], v[90:91]
    v_pk_mul_f32 v[164:165], v[92:93], v[92:93]
    v_pk_mul_f32 v[166:167], v[94:95], v[94:95]
    v_pk_fma_f32 v[160:161], v[160:161], v[4:5], v[4:5] op_sel:[0,1,0] op_sel_hi:[1,1,0]
    v_pk_fma_f32 v[162:163], v[162:163], v[4:5], v[4:5] op_sel:[0,1,0] op_sel_hi:[1,1,0]
    v_pk_fma_f32 v[164:165], v[164:165], v[6:7], v[6:7] op_sel:[0,1,0] op_sel_hi:[1,1,0]
    v_pk_fma_f32 v[166:167], v[166:167], v[6:7], v[6:7] op_sel:[0,1,0] op_sel_hi:[1,1,0]
    v_pk_mul_f32 v[160:161], v[160:161], v[88:89]
    v_pk_mul_f32 v[162:163], v[162:163], v[90:91]
    v_pk_mul_f32 v[164:165], v[164:165], v[92:93]
    v_pk_mul_f32 v[166:167], v[166:167], v[94:95]
    v_exp_f32 v160, v160
    v_exp_f32 v161, v161
    v_exp_f32 v162, v162
    v_exp_f32 v163, v163
    v_exp_f32 v164, v164
    v_exp_f32 v165, v165
    v_exp_f32 v166, v166
    v_exp_f32 v167, v167
    v_pk_fma_f32 v[160:161], v[160:161], v[248:249], v[248:249] op_sel:[0,1,1] op_sel_hi:[1,1,1]
    v_pk_fma_f32 v[162:163], v[162:163], v[248:249], v[248:249] op_sel:[0,1,1] op_sel_hi:[1,1,1]
    v_pk_fma_f32 v[164:165], v[164:165], v[250:251], v[250:251] op_sel:[0,1,1] op_sel_hi:[1,1,1]
    v_pk_fma_f32 v[166:167], v[166:167], v[250:251], v[250:251] op_sel:[0,1,1] op_sel_hi:[1,1,1]
    v_rcp_f32 v160, v160
    v_rcp_f32 v161, v161
    v_rcp_f32 v162, v162
    v_rcp_f32 v163, v163
    v_rcp_f32 v164, v164
    v_rcp_f32 v165, v165
    v_rcp_f32 v166, v166
    v_rcp_f32 v167, v167
    v_pk_mul_f32 v[88:89], v[88:89], v[160:161]
    v_pk_mul_f32 v[90:91], v[90:91], v[162:163]
    v_pk_mul_f32 v[92:93], v[92:93], v[164:165]
    v_pk_mul_f32 v[94:95], v[94:95], v[166:167]
    v_pk_fma_f32 v[96:97], v[248:249], v[180:181], v[96:97] op_sel_hi:[0,1,1] neg_lo:[1,0,0] neg_hi:[1,0,0]
    v_pk_fma_f32 v[98:99], v[248:249], v[182:183], v[98:99] op_sel_hi:[0,1,1] neg_lo:[1,0,0] neg_hi:[1,0,0]
    v_pk_fma_f32 v[100:101], v[250:251], v[180:181], v[100:101] op_sel_hi:[0,1,1] neg_lo:[1,0,0] neg_hi:[1,0,0]
    v_pk_fma_f32 v[102:103], v[250:251], v[182:183], v[102:103] op_sel_hi:[0,1,1] neg_lo:[1,0,0] neg_hi:[1,0,0]
    v_pk_mul_f32 v[168:169], v[96:97], v[96:97]
    v_pk_mul_f32 v[170:171], v[98:99], v[98:99]
    v_pk_mul_f32 v[172:173], v[100:101], v[100:101]
    v_pk_mul_f32 v[174:175], v[102:103], v[102:103]
    v_pk_fma_f32 v[168:169], v[168:169], v[4:5], v[4:5] op_sel:[0,1,0] op_sel_hi:[1,1,0]
    v_pk_fma_f32 v[170:171], v[170:171], v[4:5], v[4:5] op_sel:[0,1,0] op_sel_hi:[1,1,0]
    v_pk_fma_f32 v[172:173], v[172:173], v[6:7], v[6:7] op_sel:[0,1,0] op_sel_hi:[1,1,0]
    v_pk_fma_f32 v[174:175], v[174:175], v[6:7], v[6:7] op_sel:[0,1,0] op_sel_hi:[1,1,0]
    v_pk_mul_f32 v[168:169], v[168:169], v[96:97]
    v_pk_mul_f32 v[170:171], v[170:171], v[98:99]
    v_pk_mul_f32 v[172:173], v[172:173], v[100:101]
    v_pk_mul_f32 v[174:175], v[174:175], v[102:103]
    v_exp_f32 v168, v168
    v_exp_f32 v169, v169
    v_exp_f32 v170, v170
    v_exp_f32 v171, v171
    v_exp_f32 v172, v172
    v_exp_f32 v173, v173
    v_exp_f32 v174, v174
    v_exp_f32 v175, v175
    v_pk_fma_f32 v[168:169], v[168:169], v[248:249], v[248:249] op_sel:[0,1,1] op_sel_hi:[1,1,1]
    v_pk_fma_f32 v[170:171], v[170:171], v[248:249], v[248:249] op_sel:[0,1,1] op_sel_hi:[1,1,1]
    v_pk_fma_f32 v[172:173], v[172:173], v[250:251], v[250:251] op_sel:[0,1,1] op_sel_hi:[1,1,1]
    v_pk_fma_f32 v[174:175], v[174:175], v[250:251], v[250:251] op_sel:[0,1,1] op_sel_hi:[1,1,1]
    v_rcp_f32 v168, v168
    v_rcp_f32 v169, v169
    v_rcp_f32 v170, v170
    v_rcp_f32 v171, v171
    v_rcp_f32 v172, v172
    v_rcp_f32 v173, v173
    v_rcp_f32 v174, v174
    v_rcp_f32 v175, v175
    v_pk_mul_f32 v[96:97], v[96:97], v[168:169]
    v_pk_mul_f32 v[98:99], v[98:99], v[170:171]
    v_pk_mul_f32 v[100:101], v[100:101], v[172:173]
    v_pk_mul_f32 v[102:103], v[102:103], v[174:175]
    v_pk_fma_f32 v[104:105], v[248:249], v[184:185], v[104:105] op_sel_hi:[0,1,1] neg_lo:[1,0,0] neg_hi:[1,0,0]
    v_pk_fma_f32 v[106:107], v[248:249], v[186:187], v[106:107] op_sel_hi:[0,1,1] neg_lo:[1,0,0] neg_hi:[1,0,0]
    v_pk_fma_f32 v[108:109], v[250:251], v[184:185], v[108:109] op_sel_hi:[0,1,1] neg_lo:[1,0,0] neg_hi:[1,0,0]
    v_pk_fma_f32 v[110:111], v[250:251], v[186:187], v[110:111] op_sel_hi:[0,1,1] neg_lo:[1,0,0] neg_hi:[1,0,0]
    v_pk_mul_f32 v[160:161], v[104:105], v[104:105]
    v_pk_mul_f32 v[162:163], v[106:107], v[106:107]
    v_pk_mul_f32 v[164:165], v[108:109], v[108:109]
    v_pk_mul_f32 v[166:167], v[110:111], v[110:111]
    v_pk_fma_f32 v[160:161], v[160:161], v[4:5], v[4:5] op_sel:[0,1,0] op_sel_hi:[1,1,0]
    v_pk_fma_f32 v[162:163], v[162:163], v[4:5], v[4:5] op_sel:[0,1,0] op_sel_hi:[1,1,0]
    v_pk_fma_f32 v[164:165], v[164:165], v[6:7], v[6:7] op_sel:[0,1,0] op_sel_hi:[1,1,0]
    v_pk_fma_f32 v[166:167], v[166:167], v[6:7], v[6:7] op_sel:[0,1,0] op_sel_hi:[1,1,0]
    v_pk_mul_f32 v[160:161], v[160:161], v[104:105]
    v_pk_mul_f32 v[162:163], v[162:163], v[106:107]
    v_pk_mul_f32 v[164:165], v[164:165], v[108:109]
    v_pk_mul_f32 v[166:167], v[166:167], v[110:111]
    v_exp_f32 v160, v160
    v_exp_f32 v161, v161
    v_exp_f32 v162, v162
    v_exp_f32 v163, v163
    v_exp_f32 v164, v164
    v_exp_f32 v165, v165
    v_exp_f32 v166, v166
    v_exp_f32 v167, v167
    v_pk_fma_f32 v[160:161], v[160:161], v[248:249], v[248:249] op_sel:[0,1,1] op_sel_hi:[1,1,1]
    v_pk_fma_f32 v[162:163], v[162:163], v[248:249], v[248:249] op_sel:[0,1,1] op_sel_hi:[1,1,1]
    v_pk_fma_f32 v[164:165], v[164:165], v[250:251], v[250:251] op_sel:[0,1,1] op_sel_hi:[1,1,1]
    v_pk_fma_f32 v[166:167], v[166:167], v[250:251], v[250:251] op_sel:[0,1,1] op_sel_hi:[1,1,1]
    v_rcp_f32 v160, v160
    v_rcp_f32 v161, v161
    v_rcp_f32 v162, v162
    v_rcp_f32 v163, v163
    v_rcp_f32 v164, v164
    v_rcp_f32 v165, v165
    v_rcp_f32 v166, v166
    v_rcp_f32 v167, v167
    v_pk_mul_f32 v[104:105], v[104:105], v[160:161]
    v_pk_mul_f32 v[106:107], v[106:107], v[162:163]
    v_pk_mul_f32 v[108:109], v[108:109], v[164:165]
    v_pk_mul_f32 v[110:111], v[110:111], v[166:167]
    v_pk_fma_f32 v[112:113], v[248:249], v[188:189], v[112:113] op_sel_hi:[0,1,1] neg_lo:[1,0,0] neg_hi:[1,0,0]
    v_pk_fma_f32 v[114:115], v[248:249], v[190:191], v[114:115] op_sel_hi:[0,1,1] neg_lo:[1,0,0] neg_hi:[1,0,0]
    v_pk_fma_f32 v[116:117], v[250:251], v[188:189], v[116:117] op_sel_hi:[0,1,1] neg_lo:[1,0,0] neg_hi:[1,0,0]
    v_pk_fma_f32 v[118:119], v[250:251], v[190:191], v[118:119] op_sel_hi:[0,1,1] neg_lo:[1,0,0] neg_hi:[1,0,0]
    v_pk_mul_f32 v[168:169], v[112:113], v[112:113]
    v_pk_mul_f32 v[170:171], v[114:115], v[114:115]
    v_pk_mul_f32 v[172:173], v[116:117], v[116:117]
    v_pk_mul_f32 v[174:175], v[118:119], v[118:119]
    v_pk_fma_f32 v[168:169], v[168:169], v[4:5], v[4:5] op_sel:[0,1,0] op_sel_hi:[1,1,0]
    v_pk_fma_f32 v[170:171], v[170:171], v[4:5], v[4:5] op_sel:[0,1,0] op_sel_hi:[1,1,0]
    v_pk_fma_f32 v[172:173], v[172:173], v[6:7], v[6:7] op_sel:[0,1,0] op_sel_hi:[1,1,0]
    v_pk_fma_f32 v[174:175], v[174:175], v[6:7], v[6:7] op_sel:[0,1,0] op_sel_hi:[1,1,0]
    v_pk_mul_f32 v[168:169], v[168:169], v[112:113]
    v_pk_mul_f32 v[170:171], v[170:171], v[114:115]
    v_pk_mul_f32 v[172:173], v[172:173], v[116:117]
    v_pk_mul_f32 v[174:175], v[174:175], v[118:119]
    v_exp_f32 v168, v168
    v_exp_f32 v169, v169
    v_exp_f32 v170, v170
    v_exp_f32 v171, v171
    v_exp_f32 v172, v172
    v_exp_f32 v173, v173
    v_exp_f32 v174, v174
    v_exp_f32 v175, v175
    v_pk_fma_f32 v[168:169], v[168:169], v[248:249], v[248:249] op_sel:[0,1,1] op_sel_hi:[1,1,1]
    v_pk_fma_f32 v[170:171], v[170:171], v[248:249], v[248:249] op_sel:[0,1,1] op_sel_hi:[1,1,1]
    v_pk_fma_f32 v[172:173], v[172:173], v[250:251], v[250:251] op_sel:[0,1,1] op_sel_hi:[1,1,1]
    v_pk_fma_f32 v[174:175], v[174:175], v[250:251], v[250:251] op_sel:[0,1,1] op_sel_hi:[1,1,1]
    v_rcp_f32 v168, v168
    v_rcp_f32 v169, v169
    v_rcp_f32 v170, v170
    v_rcp_f32 v171, v171
    v_rcp_f32 v172, v172
    v_rcp_f32 v173, v173
    v_rcp_f32 v174, v174
    v_rcp_f32 v175, v175
    v_pk_mul_f32 v[112:113], v[112:113], v[168:169]
    v_pk_mul_f32 v[114:115], v[114:115], v[170:171]
    v_pk_mul_f32 v[116:117], v[116:117], v[172:173]
    v_pk_mul_f32 v[118:119], v[118:119], v[174:175]
    v_pk_fma_f32 v[120:121], v[248:249], v[192:193], v[120:121] op_sel_hi:[0,1,1] neg_lo:[1,0,0] neg_hi:[1,0,0]
    v_pk_fma_f32 v[122:123], v[248:249], v[194:195], v[122:123] op_sel_hi:[0,1,1] neg_lo:[1,0,0] neg_hi:[1,0,0]
    v_pk_fma_f32 v[124:125], v[250:251], v[192:193], v[124:125] op_sel_hi:[0,1,1] neg_lo:[1,0,0] neg_hi:[1,0,0]
    v_pk_fma_f32 v[126:127], v[250:251], v[194:195], v[126:127] op_sel_hi:[0,1,1] neg_lo:[1,0,0] neg_hi:[1,0,0]
    v_pk_mul_f32 v[160:161], v[120:121], v[120:121]
    v_pk_mul_f32 v[162:163], v[122:123], v[122:123]
    v_pk_mul_f32 v[164:165], v[124:125], v[124:125]
    v_pk_mul_f32 v[166:167], v[126:127], v[126:127]
    v_pk_fma_f32 v[160:161], v[160:161], v[4:5], v[4:5] op_sel:[0,1,0] op_sel_hi:[1,1,0]
    v_pk_fma_f32 v[162:163], v[162:163], v[4:5], v[4:5] op_sel:[0,1,0] op_sel_hi:[1,1,0]
    v_pk_fma_f32 v[164:165], v[164:165], v[6:7], v[6:7] op_sel:[0,1,0] op_sel_hi:[1,1,0]
    v_pk_fma_f32 v[166:167], v[166:167], v[6:7], v[6:7] op_sel:[0,1,0] op_sel_hi:[1,1,0]
    v_pk_mul_f32 v[160:161], v[160:161], v[120:121]
    v_pk_mul_f32 v[162:163], v[162:163], v[122:123]
    v_pk_mul_f32 v[164:165], v[164:165], v[124:125]
    v_pk_mul_f32 v[166:167], v[166:167], v[126:127]
    v_exp_f32 v160, v160
    v_exp_f32 v161, v161
    v_exp_f32 v162, v162
    v_exp_f32 v163, v163
    v_exp_f32 v164, v164
    v_exp_f32 v165, v165
    v_exp_f32 v166, v166
    v_exp_f32 v167, v167
    v_pk_fma_f32 v[160:161], v[160:161], v[248:249], v[248:249] op_sel:[0,1,1] op_sel_hi:[1,1,1]
    v_pk_fma_f32 v[162:163], v[162:163], v[248:249], v[248:249] op_sel:[0,1,1] op_sel_hi:[1,1,1]
    v_pk_fma_f32 v[164:165], v[164:165], v[250:251], v[250:251] op_sel:[0,1,1] op_sel_hi:[1,1,1]
    v_pk_fma_f32 v[166:167], v[166:167], v[250:251], v[250:251] op_sel:[0,1,1] op_sel_hi:[1,1,1]
    v_rcp_f32 v160, v160
    v_rcp_f32 v161, v161
    v_rcp_f32 v162, v162
    v_rcp_f32 v163, v163
    v_rcp_f32 v164, v164
    v_rcp_f32 v165, v165
    v_rcp_f32 v166, v166
    v_rcp_f32 v167, v167
    v_pk_mul_f32 v[120:121], v[120:121], v[160:161]
    v_pk_mul_f32 v[122:123], v[122:123], v[162:163]
    v_pk_mul_f32 v[124:125], v[124:125], v[164:165]
    v_pk_mul_f32 v[126:127], v[126:127], v[166:167]
    s_waitcnt vmcnt(0)
    v_mov_b32 v8, 1
    v_mov_b32 v9, 163832
    v_mov_b32 v10, 0
    s_mov_b64 exec, 1
    ds_add_rtn_u32 v11, v9, v8
    s_waitcnt lgkmcnt(0)
    v_and_b32 v11, 3, v11
    v_cmp_eq_u32 vcc, 3, v11
    s_nop 0
    s_cbranch_vccz L_sk_z2s
    buffer_atomic_add v8, v10, s[4:7], s45 offen sc1
L_sk_z2s:
    s_mov_b64 exec, -1
    v_pk_fma_f32 v[128:129], v[248:249], v[196:197], v[128:129] op_sel_hi:[0,1,1] neg_lo:[1,0,0] neg_hi:[1,0,0]
    v_pk_fma_f32 v[130:131], v[248:249], v[198:199], v[130:131] op_sel_hi:[0,1,1] neg_lo:[1,0,0] neg_hi:[1,0,0]
    v_pk_fma_f32 v[132:133], v[250:251], v[196:197], v[132:133] op_sel_hi:[0,1,1] neg_lo:[1,0,0] neg_hi:[1,0,0]
    v_pk_fma_f32 v[134:135], v[250:251], v[198:199], v[134:135] op_sel_hi:[0,1,1] neg_lo:[1,0,0] neg_hi:[1,0,0]
    v_pk_mul_f32 v[168:169], v[128:129], v[128:129]
    v_pk_mul_f32 v[170:171], v[130:131], v[130:131]
    v_pk_mul_f32 v[172:173], v[132:133], v[132:133]
    v_pk_mul_f32 v[174:175], v[134:135], v[134:135]
    v_pk_fma_f32 v[168:169], v[168:169], v[4:5], v[4:5] op_sel:[0,1,0] op_sel_hi:[1,1,0]
    v_pk_fma_f32 v[170:171], v[170:171], v[4:5], v[4:5] op_sel:[0,1,0] op_sel_hi:[1,1,0]
    v_pk_fma_f32 v[172:173], v[172:173], v[6:7], v[6:7] op_sel:[0,1,0] op_sel_hi:[1,1,0]
    v_pk_fma_f32 v[174:175], v[174:175], v[6:7], v[6:7] op_sel:[0,1,0] op_sel_hi:[1,1,0]
    v_pk_mul_f32 v[168:169], v[168:169], v[128:129]
    v_pk_mul_f32 v[170:171], v[170:171], v[130:131]
    v_pk_mul_f32 v[172:173], v[172:173], v[132:133]
    v_pk_mul_f32 v[174:175], v[174:175], v[134:135]
    v_exp_f32 v168, v168
    v_exp_f32 v169, v169
    v_exp_f32 v170, v170
    v_exp_f32 v171, v171
    v_exp_f32 v172, v172
    v_exp_f32 v173, v173
    v_exp_f32 v174, v174
    v_exp_f32 v175, v175
    v_pk_fma_f32 v[168:169], v[168:169], v[248:249], v[248:249] op_sel:[0,1,1] op_sel_hi:[1,1,1]
    v_pk_fma_f32 v[170:171], v[170:171], v[248:249], v[248:249] op_sel:[0,1,1] op_sel_hi:[1,1,1]
    v_pk_fma_f32 v[172:173], v[172:173], v[250:251], v[250:251] op_sel:[0,1,1] op_sel_hi:[1,1,1]
    v_pk_fma_f32 v[174:175], v[174:175], v[250:251], v[250:251] op_sel:[0,1,1] op_sel_hi:[1,1,1]
    v_rcp_f32 v168, v168
    v_rcp_f32 v169, v169
    v_rcp_f32 v170, v170
    v_rcp_f32 v171, v171
    v_rcp_f32 v172, v172
    v_rcp_f32 v173, v173
    v_rcp_f32 v174, v174
    v_rcp_f32 v175, v175
    v_pk_mul_f32 v[128:129], v[128:129], v[168:169]
    v_pk_mul_f32 v[130:131], v[130:131], v[170:171]
    v_pk_mul_f32 v[132:133], v[132:133], v[172:173]
    v_pk_mul_f32 v[134:135], v[134:135], v[174:175]
    v_pk_fma_f32 v[136:137], v[248:249], v[200:201], v[136:137] op_sel_hi:[0,1,1] neg_lo:[1,0,0] neg_hi:[1,0,0]
    v_pk_fma_f32 v[138:139], v[248:249], v[202:203], v[138:139] op_sel_hi:[0,1,1] neg_lo:[1,0,0] neg_hi:[1,0,0]
    v_pk_fma_f32 v[140:141], v[250:251], v[200:201], v[140:141] op_sel_hi:[0,1,1] neg_lo:[1,0,0] neg_hi:[1,0,0]
    v_pk_fma_f32 v[142:143], v[250:251], v[202:203], v[142:143] op_sel_hi:[0,1,1] neg_lo:[1,0,0] neg_hi:[1,0,0]
    v_pk_mul_f32 v[160:161], v[136:137], v[136:137]
    v_pk_mul_f32 v[162:163], v[138:139], v[138:139]
    v_pk_mul_f32 v[164:165], v[140:141], v[140:141]
    v_pk_mul_f32 v[166:167], v[142:143], v[142:143]
    v_pk_fma_f32 v[160:161], v[160:161], v[4:5], v[4:5] op_sel:[0,1,0] op_sel_hi:[1,1,0]
    v_pk_fma_f32 v[162:163], v[162:163], v[4:5], v[4:5] op_sel:[0,1,0] op_sel_hi:[1,1,0]
    v_pk_fma_f32 v[164:165], v[164:165], v[6:7], v[6:7] op_sel:[0,1,0] op_sel_hi:[1,1,0]
    v_pk_fma_f32 v[166:167], v[166:167], v[6:7], v[6:7] op_sel:[0,1,0] op_sel_hi:[1,1,0]
    v_pk_mul_f32 v[160:161], v[160:161], v[136:137]
    v_pk_mul_f32 v[162:163], v[162:163], v[138:139]
    v_pk_mul_f32 v[164:165], v[164:165], v[140:141]
    v_pk_mul_f32 v[166:167], v[166:167], v[142:143]
    v_exp_f32 v160, v160
    v_exp_f32 v161, v161
    v_exp_f32 v162, v162
    v_exp_f32 v163, v163
    v_exp_f32 v164, v164
    v_exp_f32 v165, v165
    v_exp_f32 v166, v166
    v_exp_f32 v167, v167
    v_pk_fma_f32 v[160:161], v[160:161], v[248:249], v[248:249] op_sel:[0,1,1] op_sel_hi:[1,1,1]
    v_pk_fma_f32 v[162:163], v[162:163], v[248:249], v[248:249] op_sel:[0,1,1] op_sel_hi:[1,1,1]
    v_pk_fma_f32 v[164:165], v[164:165], v[250:251], v[250:251] op_sel:[0,1,1] op_sel_hi:[1,1,1]
    v_pk_fma_f32 v[166:167], v[166:167], v[250:251], v[250:251] op_sel:[0,1,1] op_sel_hi:[1,1,1]
    v_rcp_f32 v160, v160
    v_rcp_f32 v161, v161
    v_rcp_f32 v162, v162
    v_rcp_f32 v163, v163
    v_rcp_f32 v164, v164
    v_rcp_f32 v165, v165
    v_rcp_f32 v166, v166
    v_rcp_f32 v167, v167
    v_pk_mul_f32 v[136:137], v[136:137], v[160:161]
    v_pk_mul_f32 v[138:139], v[138:139], v[162:163]
    v_pk_mul_f32 v[140:141], v[140:141], v[164:165]
    v_pk_mul_f32 v[142:143], v[142:143], v[166:167]
    v_pk_fma_f32 v[144:145], v[248:249], v[204:205], v[144:145] op_sel_hi:[0,1,1] neg_lo:[1,0,0] neg_hi:[1,0,0]
    v_pk_fma_f32 v[146:147], v[248:249], v[206:207], v[146:147] op_sel_hi:[0,1,1] neg_lo:[1,0,0] neg_hi:[1,0,0]
    v_pk_fma_f32 v[148:149], v[250:251], v[204:205], v[148:149] op_sel_hi:[0,1,1] neg_lo:[1,0,0] neg_hi:[1,0,0]
    v_pk_fma_f32 v[150:151], v[250:251], v[206:207], v[150:151] op_sel_hi:[0,1,1] neg_lo:[1,0,0] neg_hi:[1,0,0]
    v_pk_mul_f32 v[168:169], v[144:145], v[144:145]
    v_pk_mul_f32 v[170:171], v[146:147], v[146:147]
    v_pk_mul_f32 v[172:173], v[148:149], v[148:149]
    v_pk_mul_f32 v[174:175], v[150:151], v[150:151]
    v_pk_fma_f32 v[168:169], v[168:169], v[4:5], v[4:5] op_sel:[0,1,0] op_sel_hi:[1,1,0]
    v_pk_fma_f32 v[170:171], v[170:171], v[4:5], v[4:5] op_sel:[0,1,0] op_sel_hi:[1,1,0]
    v_pk_fma_f32 v[172:173], v[172:173], v[6:7], v[6:7] op_sel:[0,1,0] op_sel_hi:[1,1,0]
    v_pk_fma_f32 v[174:175], v[174:175], v[6:7], v[6:7] op_sel:[0,1,0] op_sel_hi:[1,1,0]
    v_pk_mul_f32 v[168:169], v[168:169], v[144:145]
    v_pk_mul_f32 v[170:171], v[170:171], v[146:147]
    v_pk_mul_f32 v[172:173], v[172:173], v[148:149]
    v_pk_mul_f32 v[174:175], v[174:175], v[150:151]
    v_exp_f32 v168, v168
    v_exp_f32 v169, v169
    v_exp_f32 v170, v170
    v_exp_f32 v171, v171
    v_exp_f32 v172, v172
    v_exp_f32 v173, v173
    v_exp_f32 v174, v174
    v_exp_f32 v175, v175
    v_pk_fma_f32 v[168:169], v[168:169], v[248:249], v[248:249] op_sel:[0,1,1] op_sel_hi:[1,1,1]
    v_pk_fma_f32 v[170:171], v[170:171], v[248:249], v[248:249] op_sel:[0,1,1] op_sel_hi:[1,1,1]
    v_pk_fma_f32 v[172:173], v[172:173], v[250:251], v[250:251] op_sel:[0,1,1] op_sel_hi:[1,1,1]
    v_pk_fma_f32 v[174:175], v[174:175], v[250:251], v[250:251] op_sel:[0,1,1] op_sel_hi:[1,1,1]
    v_rcp_f32 v168, v168
    v_rcp_f32 v169, v169
    v_rcp_f32 v170, v170
    v_rcp_f32 v171, v171
    v_rcp_f32 v172, v172
    v_rcp_f32 v173, v173
    v_rcp_f32 v174, v174
    v_rcp_f32 v175, v175
    v_pk_mul_f32 v[144:145], v[144:145], v[168:169]
    v_pk_mul_f32 v[146:147], v[146:147], v[170:171]
    v_pk_mul_f32 v[148:149], v[148:149], v[172:173]
    v_pk_mul_f32 v[150:151], v[150:151], v[174:175]
    v_pk_fma_f32 v[152:153], v[248:249], v[208:209], v[152:153] op_sel_hi:[0,1,1] neg_lo:[1,0,0] neg_hi:[1,0,0]
    v_pk_fma_f32 v[154:155], v[248:249], v[210:211], v[154:155] op_sel_hi:[0,1,1] neg_lo:[1,0,0] neg_hi:[1,0,0]
    v_pk_fma_f32 v[156:157], v[250:251], v[208:209], v[156:157] op_sel_hi:[0,1,1] neg_lo:[1,0,0] neg_hi:[1,0,0]
    v_pk_fma_f32 v[158:159], v[250:251], v[210:211], v[158:159] op_sel_hi:[0,1,1] neg_lo:[1,0,0] neg_hi:[1,0,0]
    v_pk_mul_f32 v[160:161], v[152:153], v[152:153]
    v_pk_mul_f32 v[162:163], v[154:155], v[154:155]
    v_pk_mul_f32 v[164:165], v[156:157], v[156:157]
    v_pk_mul_f32 v[166:167], v[158:159], v[158:159]
    v_pk_fma_f32 v[160:161], v[160:161], v[4:5], v[4:5] op_sel:[0,1,0] op_sel_hi:[1,1,0]
    v_pk_fma_f32 v[162:163], v[162:163], v[4:5], v[4:5] op_sel:[0,1,0] op_sel_hi:[1,1,0]
    v_pk_fma_f32 v[164:165], v[164:165], v[6:7], v[6:7] op_sel:[0,1,0] op_sel_hi:[1,1,0]
    v_pk_fma_f32 v[166:167], v[166:167], v[6:7], v[6:7] op_sel:[0,1,0] op_sel_hi:[1,1,0]
    v_pk_mul_f32 v[160:161], v[160:161], v[152:153]
    v_pk_mul_f32 v[162:163], v[162:163], v[154:155]
    v_pk_mul_f32 v[164:165], v[164:165], v[156:157]
    v_pk_mul_f32 v[166:167], v[166:167], v[158:159]
    v_exp_f32 v160, v160
    v_exp_f32 v161, v161
    v_exp_f32 v162, v162
    v_exp_f32 v163, v163
    v_exp_f32 v164, v164
    v_exp_f32 v165, v165
    v_exp_f32 v166, v166
    v_exp_f32 v167, v167
    v_pk_fma_f32 v[160:161], v[160:161], v[248:249], v[248:249] op_sel:[0,1,1] op_sel_hi:[1,1,1]
    v_pk_fma_f32 v[162:163], v[162:163], v[248:249], v[248:249] op_sel:[0,1,1] op_sel_hi:[1,1,1]
    v_pk_fma_f32 v[164:165], v[164:165], v[250:251], v[250:251] op_sel:[0,1,1] op_sel_hi:[1,1,1]
    v_pk_fma_f32 v[166:167], v[166:167], v[250:251], v[250:251] op_sel:[0,1,1] op_sel_hi:[1,1,1]
    v_rcp_f32 v160, v160
    v_rcp_f32 v161, v161
    v_rcp_f32 v162, v162
    v_rcp_f32 v163, v163
    v_rcp_f32 v164, v164
    v_rcp_f32 v165, v165
    v_rcp_f32 v166, v166
    v_rcp_f32 v167, v167
    v_pk_mul_f32 v[152:153], v[152:153], v[160:161]
    v_pk_mul_f32 v[154:155], v[154:155], v[162:163]
    v_pk_mul_f32 v[156:157], v[156:157], v[164:165]
    v_pk_mul_f32 v[158:159], v[158:159], v[166:167]
    v_lshlrev_b32 v252, 16, v252
    v_lshlrev_b32 v254, 16, v254
    v_mov_b32 v253, v252
    v_mov_b32 v255, v254
    v_and_b32 v6, 15, v0
    v_lshrrev_b32 v3, 1, v6
    v_bfe_u32 v4, v0, 4, 2
    v_xor_b32 v3, v3, v4
    v_lshlrev_b32 v3, 4, v3
    v_lshl_add_u32 v3, v6, 7, v3
    s_add_u32 s33, s30, 73728
    v_add_u32 v3, s33, v3
    v_xor_b32 v4, 64, v3
    v_mov_b64 v[16:17], v[252:253]
    v_mov_b64 v[18:19], v[252:253]
    v_mov_b64 v[20:21], v[254:255]
    v_mov_b64 v[22:23], v[254:255]
    v_mov_b64 v[24:25], v[252:253]
    v_mov_b64 v[26:27], v[252:253]
    v_mov_b64 v[28:29], v[254:255]
    v_mov_b64 v[30:31], v[254:255]
    v_mov_b64 v[32:33], v[252:253]
    v_mov_b64 v[34:35], v[252:253]
    v_mov_b64 v[36:37], v[254:255]
    v_mov_b64 v[38:39], v[254:255]
    v_mov_b64 v[40:41], v[252:253]
    v_mov_b64 v[42:43], v[252:253]
    v_mov_b64 v[44:45], v[254:255]
    v_mov_b64 v[46:47], v[254:255]
    v_mov_b64 v[48:49], v[252:253]
    v_mov_b64 v[50:51], v[252:253]
    v_mov_b64 v[52:53], v[254:255]
    v_mov_b64 v[54:55], v[254:255]
    v_mov_b64 v[56:57], v[252:253]
    v_mov_b64 v[58:59], v[252:253]
    v_mov_b64 v[60:61], v[254:255]
    v_mov_b64 v[62:63], v[254:255]
    v_mov_b64 v[64:65], v[252:253]
    v_mov_b64 v[66:67], v[252:253]
    v_mov_b64 v[68:69], v[254:255]
    v_mov_b64 v[70:71], v[254:255]
    v_mov_b64 v[72:73], v[252:253]
    v_mov_b64 v[74:75], v[252:253]
    v_mov_b64 v[76:77], v[254:255]
    v_mov_b64 v[78:79], v[254:255]
    v_mov_b64 v[80:81], v[252:253]
    v_mov_b64 v[82:83], v[252:253]
    v_mov_b64 v[84:85], v[254:255]
    v_mov_b64 v[86:87], v[254:255]
    s_mul_i32 s36, s31, 73728
    s_lshr_b32 s33, s24, 1
    s_mul_i32 s33, s33, 9216
    s_add_u32 s36, s36, s33
    s_add_u32 s36, s36, s21
    s_and_b32 s33, s24, 1
    s_lshl_b32 s34, s33, 12
    s_lshl_b32 s35, s33, 3
    s_add_u32 s35, s35, 8192
    v_add_u32 v14, s34, v1
    v_add_u32 v15, s35, v1
    s_add_u32 s39, s36, 0x1b00000
    s_add_u32 s40, s36, 0x1b12000
    s_mov_b32 s41, 7
    s_barrier
    ds_read_b128 v[160:163], v3 offset:32768
    ds_read_b128 v[164:167], v3 offset:34816
    ds_read_b128 v[168:171], v2 offset:0
    ds_read_b128 v[172:175], v2 offset:1024
    ds_read_b128 v[176:179], v2 offset:2048
    ds_read_b128 v[180:183], v2 offset:3072
    ds_read_b128 v[184:187], v2 offset:4096
    ds_read_b128 v[188:191], v2 offset:5120
    ds_read_b128 v[192:195], v2 offset:6144
    ds_read_b128 v[196:199], v2 offset:7168
    ds_read_b128 v[200:203], v2 offset:8192
    .p2align 6
L_g_loop:
    s_waitcnt lgkmcnt(5)
    v_mfma_f32_16x16x32_bf16 v[16:19], v[168:171], v[160:163], v[16:19]
    ds_read_b128 v[204:207], v4 offset:32768
    v_mfma_f32_16x16x32_bf16 v[20:23], v[168:171], v[164:167], v[20:23]
    ds_read_b128 v[208:211], v4 offset:34816
    v_mfma_f32_16x16x32_bf16 v[24:27], v[172:175], v[160:163], v[24:27]
    ds_read_b128 v[212:215], v2 offset:9216
    v_mfma_f32_16x16x32_bf16 v[28:31], v[172:175], v[164:167], v[28:31]
    ds_read_b128 v[216:219], v2 offset:10240
    v_mfma_f32_16x16x32_bf16 v[32:35], v[176:179], v[160:163], v[32:35]
    ds_read_b128 v[220:223], v2 offset:11264
    v_mfma_f32_16x16x32_bf16 v[36:39], v[176:179], v[164:167], v[36:39]
    ds_read_b128 v[224:227], v2 offset:12288
    v_mfma_f32_16x16x32_bf16 v[40:43], v[180:183], v[160:163], v[40:43]
    ds_read_b128 v[228:231], v2 offset:13312
    v_mfma_f32_16x16x32_bf16 v[44:47], v[180:183], v[164:167], v[44:47]
    ds_read_b128 v[232:235], v2 offset:14336
    s_waitcnt lgkmcnt(8)
    v_mfma_f32_16x16x32_bf16 v[48:51], v[184:187], v[160:163], v[48:51]
    ds_read_b128 v[236:239], v2 offset:15360
    v_mfma_f32_16x16x32_bf16 v[52:55], v[184:187], v[164:167], v[52:55]
    ds_read_b128 v[240:243], v2 offset:16384
    v_mfma_f32_16x16x32_bf16 v[56:59], v[188:191], v[160:163], v[56:59]
    ds_read_b128 v[244:247], v2 offset:17408
    v_mfma_f32_16x16x32_bf16 v[60:63], v[188:191], v[164:167], v[60:63]
    v_mfma_f32_16x16x32_bf16 v[64:67], v[192:195], v[160:163], v[64:67]
    v_mfma_f32_16x16x32_bf16 v[68:71], v[192:195], v[164:167], v[68:71]
    v_mfma_f32_16x16x32_bf16 v[72:75], v[196:199], v[160:163], v[72:75]
    v_mfma_f32_16x16x32_bf16 v[76:79], v[196:199], v[164:167], v[76:79]
    v_mfma_f32_16x16x32_bf16 v[80:83], v[200:203], v[160:163], v[80:83]
    v_mfma_f32_16x16x32_bf16 v[84:87], v[200:203], v[164:167], v[84:87]
    s_waitcnt lgkmcnt(0)
    s_barrier
    v_mfma_f32_16x16x32_bf16 v[16:19], v[212:215], v[204:207], v[16:19]
    ds_read_b128 v[160:163], v3 offset:49152
    v_mfma_f32_16x16x32_bf16 v[20:23], v[212:215], v[208:211], v[20:23]
    ds_read_b128 v[164:167], v3 offset:51200
    v_mfma_f32_16x16x32_bf16 v[24:27], v[216:219], v[204:207], v[24:27]
    ds_read_b128 v[168:171], v2 offset:18432
    v_mfma_f32_16x16x32_bf16 v[28:31], v[216:219], v[208:211], v[28:31]
    ds_read_b128 v[172:175], v2 offset:19456
    v_mfma_f32_16x16x32_bf16 v[32:35], v[220:223], v[204:207], v[32:35]
    ds_read_b128 v[176:179], v2 offset:20480
    v_mfma_f32_16x16x32_bf16 v[36:39], v[220:223], v[208:211], v[36:39]
    ds_read_b128 v[180:183], v2 offset:21504
    v_mfma_f32_16x16x32_bf16 v[40:43], v[224:227], v[204:207], v[40:43]
    ds_read_b128 v[184:187], v2 offset:22528
    v_mfma_f32_16x16x32_bf16 v[44:47], v[224:227], v[208:211], v[44:47]
    ds_read_b128 v[188:191], v2 offset:23552
    v_mfma_f32_16x16x32_bf16 v[48:51], v[228:231], v[204:207], v[48:51]
    ds_read_b128 v[192:195], v2 offset:24576
    v_mfma_f32_16x16x32_bf16 v[52:55], v[228:231], v[208:211], v[52:55]
    ds_read_b128 v[196:199], v2 offset:25600
    v_mfma_f32_16x16x32_bf16 v[56:59], v[232:235], v[204:207], v[56:59]
    ds_read_b128 v[200:203], v2 offset:26624
    v_mfma_f32_16x16x32_bf16 v[60:63], v[232:235], v[208:211], v[60:63]
    v_mfma_f32_16x16x32_bf16 v[64:67], v[236:239], v[204:207], v[64:67]
    v_mfma_f32_16x16x32_bf16 v[68:71], v[236:239], v[208:211], v[68:71]
    v_mfma_f32_16x16x32_bf16 v[72:75], v[240:243], v[204:207], v[72:75]
    v_mfma_f32_16x16x32_bf16 v[76:79], v[240:243], v[208:211], v[76:79]
    v_mfma_f32_16x16x32_bf16 v[80:83], v[244:247], v[204:207], v[80:83]
    v_mfma_f32_16x16x32_bf16 v[84:87], v[244:247], v[208:211], v[84:87]
    s_waitcnt lgkmcnt(5)
    v_mfma_f32_16x16x32_bf16 v[16:19], v[168:171], v[160:163], v[16:19]
    ds_read_b128 v[204:207], v4 offset:49152
    v_mfma_f32_16x16x32_bf16 v[20:23], v[168:171], v[164:167], v[20:23]
    ds_read_b128 v[208:211], v4 offset:51200
    v_mfma_f32_16x16x32_bf16 v[24:27], v[172:175], v[160:163], v[24:27]
    ds_read_b128 v[212:215], v2 offset:27648
    v_mfma_f32_16x16x32_bf16 v[28:31], v[172:175], v[164:167], v[28:31]
    ds_read_b128 v[216:219], v2 offset:28672
    v_mfma_f32_16x16x32_bf16 v[32:35], v[176:179], v[160:163], v[32:35]
    ds_read_b128 v[220:223], v2 offset:29696
    v_mfma_f32_16x16x32_bf16 v[36:39], v[176:179], v[164:167], v[36:39]
    ds_read_b128 v[224:227], v2 offset:30720
    v_mfma_f32_16x16x32_bf16 v[40:43], v[180:183], v[160:163], v[40:43]
    ds_read_b128 v[228:231], v2 offset:31744
    v_mfma_f32_16x16x32_bf16 v[44:47], v[180:183], v[164:167], v[44:47]
    ds_read_b128 v[232:235], v2 offset:32768
    s_waitcnt lgkmcnt(8)
    v_mfma_f32_16x16x32_bf16 v[48:51], v[184:187], v[160:163], v[48:51]
    ds_read_b128 v[236:239], v2 offset:33792
    v_mfma_f32_16x16x32_bf16 v[52:55], v[184:187], v[164:167], v[52:55]
    ds_read_b128 v[240:243], v2 offset:34816
    v_mfma_f32_16x16x32_bf16 v[56:59], v[188:191], v[160:163], v[56:59]
    ds_read_b128 v[244:247], v2 offset:35840
    v_mfma_f32_16x16x32_bf16 v[60:63], v[188:191], v[164:167], v[60:63]
    v_mfma_f32_16x16x32_bf16 v[64:67], v[192:195], v[160:163], v[64:67]
    v_mfma_f32_16x16x32_bf16 v[68:71], v[192:195], v[164:167], v[68:71]
    v_mfma_f32_16x16x32_bf16 v[72:75], v[196:199], v[160:163], v[72:75]
    v_mfma_f32_16x16x32_bf16 v[76:79], v[196:199], v[164:167], v[76:79]
    v_mfma_f32_16x16x32_bf16 v[80:83], v[200:203], v[160:163], v[80:83]
    v_mfma_f32_16x16x32_bf16 v[84:87], v[200:203], v[164:167], v[84:87]
    s_waitcnt lgkmcnt(0)
    s_barrier
    v_mfma_f32_16x16x32_bf16 v[16:19], v[212:215], v[204:207], v[16:19]
    ds_read_b128 v[160:163], v3 offset:0
    v_mfma_f32_16x16x32_bf16 v[20:23], v[212:215], v[208:211], v[20:23]
    ds_read_b128 v[164:167], v3 offset:2048
    v_mfma_f32_16x16x32_bf16 v[24:27], v[216:219], v[204:207], v[24:27]
    ds_read_b128 v[168:171], v1 offset:0
    v_mfma_f32_16x16x32_bf16 v[28:31], v[216:219], v[208:211], v[28:31]
    ds_read_b128 v[172:175], v1 offset:1024
    v_mfma_f32_16x16x32_bf16 v[32:35], v[220:223], v[204:207], v[32:35]
    ds_read_b128 v[176:179], v1 offset:2048
    v_mfma_f32_16x16x32_bf16 v[36:39], v[220:223], v[208:211], v[36:39]
    ds_read_b128 v[180:183], v1 offset:3072
    v_mfma_f32_16x16x32_bf16 v[40:43], v[224:227], v[204:207], v[40:43]
    ds_read_b128 v[184:187], v1 offset:4096
    v_mfma_f32_16x16x32_bf16 v[44:47], v[224:227], v[208:211], v[44:47]
    ds_read_b128 v[188:191], v1 offset:5120
    v_mfma_f32_16x16x32_bf16 v[48:51], v[228:231], v[204:207], v[48:51]
    ds_read_b128 v[192:195], v1 offset:6144
    v_mfma_f32_16x16x32_bf16 v[52:55], v[228:231], v[208:211], v[52:55]
    ds_read_b128 v[196:199], v1 offset:7168
    v_mfma_f32_16x16x32_bf16 v[56:59], v[232:235], v[204:207], v[56:59]
    ds_read_b128 v[200:203], v1 offset:8192
    v_mfma_f32_16x16x32_bf16 v[60:63], v[232:235], v[208:211], v[60:63]
    v_mfma_f32_16x16x32_bf16 v[64:67], v[236:239], v[204:207], v[64:67]
    v_mfma_f32_16x16x32_bf16 v[68:71], v[236:239], v[208:211], v[68:71]
    v_mfma_f32_16x16x32_bf16 v[72:75], v[240:243], v[204:207], v[72:75]
    v_mfma_f32_16x16x32_bf16 v[76:79], v[240:243], v[208:211], v[76:79]
    v_mfma_f32_16x16x32_bf16 v[80:83], v[244:247], v[204:207], v[80:83]
    v_mfma_f32_16x16x32_bf16 v[84:87], v[244:247], v[208:211], v[84:87]
    s_waitcnt lgkmcnt(5)
    v_mfma_f32_16x16x32_bf16 v[16:19], v[168:171], v[160:163], v[16:19]
    ds_read_b128 v[204:207], v4 offset:0
    v_mfma_f32_16x16x32_bf16 v[20:23], v[168:171], v[164:167], v[20:23]
    ds_read_b128 v[208:211], v4 offset:2048
    v_mfma_f32_16x16x32_bf16 v[24:27], v[172:175], v[160:163], v[24:27]
    ds_read_b128 v[212:215], v1 offset:9216
    v_mfma_f32_16x16x32_bf16 v[28:31], v[172:175], v[164:167], v[28:31]
    ds_read_b128 v[216:219], v1 offset:10240
    v_mfma_f32_16x16x32_bf16 v[32:35], v[176:179], v[160:163], v[32:35]
    ds_read_b128 v[220:223], v1 offset:11264
    v_mfma_f32_16x16x32_bf16 v[36:39], v[176:179], v[164:167], v[36:39]
    ds_read_b128 v[224:227], v1 offset:12288
    v_mfma_f32_16x16x32_bf16 v[40:43], v[180:183], v[160:163], v[40:43]
    ds_read_b128 v[228:231], v1 offset:13312
    v_mfma_f32_16x16x32_bf16 v[44:47], v[180:183], v[164:167], v[44:47]
    ds_read_b128 v[232:235], v1 offset:14336
    s_waitcnt lgkmcnt(8)
    v_mfma_f32_16x16x32_bf16 v[48:51], v[184:187], v[160:163], v[48:51]
    ds_read_b128 v[236:239], v1 offset:15360
    v_mfma_f32_16x16x32_bf16 v[52:55], v[184:187], v[164:167], v[52:55]
    ds_read_b128 v[240:243], v1 offset:16384
    v_mfma_f32_16x16x32_bf16 v[56:59], v[188:191], v[160:163], v[56:59]
    ds_read_b128 v[244:247], v1 offset:17408
    v_mfma_f32_16x16x32_bf16 v[60:63], v[188:191], v[164:167], v[60:63]
    v_mfma_f32_16x16x32_bf16 v[64:67], v[192:195], v[160:163], v[64:67]
    v_mfma_f32_16x16x32_bf16 v[68:71], v[192:195], v[164:167], v[68:71]
    v_mfma_f32_16x16x32_bf16 v[72:75], v[196:199], v[160:163], v[72:75]
    v_mfma_f32_16x16x32_bf16 v[76:79], v[196:199], v[164:167], v[76:79]
    v_mfma_f32_16x16x32_bf16 v[80:83], v[200:203], v[160:163], v[80:83]
    v_mfma_f32_16x16x32_bf16 v[84:87], v[200:203], v[164:167], v[84:87]
    s_waitcnt lgkmcnt(0)
    s_barrier
    v_mfma_f32_16x16x32_bf16 v[16:19], v[212:215], v[204:207], v[16:19]
    ds_read_b128 v[160:163], v3 offset:16384
    v_mfma_f32_16x16x32_bf16 v[20:23], v[212:215], v[208:211], v[20:23]
    ds_read_b128 v[164:167], v3 offset:18432
    v_mfma_f32_16x16x32_bf16 v[24:27], v[216:219], v[204:207], v[24:27]
    ds_read_b128 v[168:171], v1 offset:18432
    v_mfma_f32_16x16x32_bf16 v[28:31], v[216:219], v[208:211], v[28:31]
    ds_read_b128 v[172:175], v1 offset:19456
    v_mfma_f32_16x16x32_bf16 v[32:35], v[220:223], v[204:207], v[32:35]
    ds_read_b128 v[176:179], v1 offset:20480
    v_mfma_f32_16x16x32_bf16 v[36:39], v[220:223], v[208:211], v[36:39]
    ds_read_b128 v[180:183], v1 offset:21504
    v_mfma_f32_16x16x32_bf16 v[40:43], v[224:227], v[204:207], v[40:43]
    ds_read_b128 v[184:187], v1 offset:22528
    v_mfma_f32_16x16x32_bf16 v[44:47], v[224:227], v[208:211], v[44:47]
    ds_read_b128 v[188:191], v1 offset:23552
    v_mfma_f32_16x16x32_bf16 v[48:51], v[228:231], v[204:207], v[48:51]
    ds_read_b128 v[192:195], v1 offset:24576
    v_mfma_f32_16x16x32_bf16 v[52:55], v[228:231], v[208:211], v[52:55]
    ds_read_b128 v[196:199], v1 offset:25600
    v_mfma_f32_16x16x32_bf16 v[56:59], v[232:235], v[204:207], v[56:59]
    ds_read_b128 v[200:203], v1 offset:26624
    v_mfma_f32_16x16x32_bf16 v[60:63], v[232:235], v[208:211], v[60:63]
    v_mfma_f32_16x16x32_bf16 v[64:67], v[236:239], v[204:207], v[64:67]
    v_mfma_f32_16x16x32_bf16 v[68:71], v[236:239], v[208:211], v[68:71]
    v_mfma_f32_16x16x32_bf16 v[72:75], v[240:243], v[204:207], v[72:75]
    v_mfma_f32_16x16x32_bf16 v[76:79], v[240:243], v[208:211], v[76:79]
    v_mfma_f32_16x16x32_bf16 v[80:83], v[244:247], v[204:207], v[80:83]
    v_mfma_f32_16x16x32_bf16 v[84:87], v[244:247], v[208:211], v[84:87]
    s_waitcnt lgkmcnt(5)
    v_mfma_f32_16x16x32_bf16 v[16:19], v[168:171], v[160:163], v[16:19]
    ds_read_b128 v[204:207], v4 offset:16384
    v_mfma_f32_16x16x32_bf16 v[20:23], v[168:171], v[164:167], v[20:23]
    ds_read_b128 v[208:211], v4 offset:18432
    v_mfma_f32_16x16x32_bf16 v[24:27], v[172:175], v[160:163], v[24:27]
    ds_read_b128 v[212:215], v1 offset:27648
    v_mfma_f32_16x16x32_bf16 v[28:31], v[172:175], v[164:167], v[28:31]
    ds_read_b128 v[216:219], v1 offset:28672
    v_mfma_f32_16x16x32_bf16 v[32:35], v[176:179], v[160:163], v[32:35]
    ds_read_b128 v[220:223], v1 offset:29696
    v_mfma_f32_16x16x32_bf16 v[36:39], v[176:179], v[164:167], v[36:39]
    ds_read_b128 v[224:227], v1 offset:30720
    v_mfma_f32_16x16x32_bf16 v[40:43], v[180:183], v[160:163], v[40:43]
    ds_read_b128 v[228:231], v1 offset:31744
    v_mfma_f32_16x16x32_bf16 v[44:47], v[180:183], v[164:167], v[44:47]
    ds_read_b128 v[232:235], v1 offset:32768
    s_waitcnt lgkmcnt(8)
    v_mfma_f32_16x16x32_bf16 v[48:51], v[184:187], v[160:163], v[48:51]
    ds_read_b128 v[236:239], v1 offset:33792
    v_mfma_f32_16x16x32_bf16 v[52:55], v[184:187], v[164:167], v[52:55]
    ds_read_b128 v[240:243], v1 offset:34816
    v_mfma_f32_16x16x32_bf16 v[56:59], v[188:191], v[160:163], v[56:59]
    ds_read_b128 v[244:247], v1 offset:35840
    v_mfma_f32_16x16x32_bf16 v[60:63], v[188:191], v[164:167], v[60:63]
    v_mfma_f32_16x16x32_bf16 v[64:67], v[192:195], v[160:163], v[64:67]
    v_mfma_f32_16x16x32_bf16 v[68:71], v[192:195], v[164:167], v[68:71]
    v_mfma_f32_16x16x32_bf16 v[72:75], v[196:199], v[160:163], v[72:75]
    v_mfma_f32_16x16x32_bf16 v[76:79], v[196:199], v[164:167], v[76:79]
    v_mfma_f32_16x16x32_bf16 v[80:83], v[200:203], v[160:163], v[80:83]
    v_mfma_f32_16x16x32_bf16 v[84:87], v[200:203], v[164:167], v[84:87]
    s_waitcnt lgkmcnt(0)
    s_barrier
    v_mfma_f32_16x16x32_bf16 v[16:19], v[212:215], v[204:207], v[16:19]
    ds_read_b128 v[160:163], v3 offset:32768
    v_mfma_f32_16x16x32_bf16 v[20:23], v[212:215], v[208:211], v[20:23]
    ds_read_b128 v[164:167], v3 offset:34816
    v_mfma_f32_16x16x32_bf16 v[24:27], v[216:219], v[204:207], v[24:27]
    ds_read_b128 v[168:171], v2 offset:0
    v_mfma_f32_16x16x32_bf16 v[28:31], v[216:219], v[208:211], v[28:31]
    ds_read_b128 v[172:175], v2 offset:1024
    v_mfma_f32_16x16x32_bf16 v[32:35], v[220:223], v[204:207], v[32:35]
    ds_read_b128 v[176:179], v2 offset:2048
    v_mfma_f32_16x16x32_bf16 v[36:39], v[220:223], v[208:211], v[36:39]
    ds_read_b128 v[180:183], v2 offset:3072
    v_mfma_f32_16x16x32_bf16 v[40:43], v[224:227], v[204:207], v[40:43]
    ds_read_b128 v[184:187], v2 offset:4096
    v_mfma_f32_16x16x32_bf16 v[44:47], v[224:227], v[208:211], v[44:47]
    ds_read_b128 v[188:191], v2 offset:5120
    v_mfma_f32_16x16x32_bf16 v[48:51], v[228:231], v[204:207], v[48:51]
    ds_read_b128 v[192:195], v2 offset:6144
    v_mfma_f32_16x16x32_bf16 v[52:55], v[228:231], v[208:211], v[52:55]
    ds_read_b128 v[196:199], v2 offset:7168
    v_mfma_f32_16x16x32_bf16 v[56:59], v[232:235], v[204:207], v[56:59]
    ds_read_b128 v[200:203], v2 offset:8192
    v_mfma_f32_16x16x32_bf16 v[60:63], v[232:235], v[208:211], v[60:63]
    v_mfma_f32_16x16x32_bf16 v[64:67], v[236:239], v[204:207], v[64:67]
    v_mfma_f32_16x16x32_bf16 v[68:71], v[236:239], v[208:211], v[68:71]
    v_mfma_f32_16x16x32_bf16 v[72:75], v[240:243], v[204:207], v[72:75]
    v_mfma_f32_16x16x32_bf16 v[76:79], v[240:243], v[208:211], v[76:79]
    v_mfma_f32_16x16x32_bf16 v[80:83], v[244:247], v[204:207], v[80:83]
    s_sub_u32 s41, s41, 1
    v_mfma_f32_16x16x32_bf16 v[84:87], v[244:247], v[208:211], v[84:87]
    s_cmp_lg_u32 s41, 0
    s_cbranch_scc1 L_g_loop
    s_waitcnt lgkmcnt(5)
    v_mfma_f32_16x16x32_bf16 v[16:19], v[168:171], v[160:163], v[16:19]
    ds_read_b128 v[204:207], v4 offset:32768
    v_mfma_f32_16x16x32_bf16 v[20:23], v[168:171], v[164:167], v[20:23]
    ds_read_b128 v[208:211], v4 offset:34816
    v_mfma_f32_16x16x32_bf16 v[24:27], v[172:175], v[160:163], v[24:27]
    ds_read_b128 v[212:215], v2 offset:9216
    v_mfma_f32_16x16x32_bf16 v[28:31], v[172:175], v[164:167], v[28:31]
    ds_read_b128 v[216:219], v2 offset:10240
    v_mfma_f32_16x16x32_bf16 v[32:35], v[176:179], v[160:163], v[32:35]
    ds_read_b128 v[220:223], v2 offset:11264
    v_mfma_f32_16x16x32_bf16 v[36:39], v[176:179], v[164:167], v[36:39]
    ds_read_b128 v[224:227], v2 offset:12288
    v_mfma_f32_16x16x32_bf16 v[40:43], v[180:183], v[160:163], v[40:43]
    ds_read_b128 v[228:231], v2 offset:13312
    v_mfma_f32_16x16x32_bf16 v[44:47], v[180:183], v[164:167], v[44:47]
    ds_read_b128 v[232:235], v2 offset:14336
    s_waitcnt lgkmcnt(8)
    v_mfma_f32_16x16x32_bf16 v[48:51], v[184:187], v[160:163], v[48:51]
    ds_read_b128 v[236:239], v2 offset:15360
    v_mfma_f32_16x16x32_bf16 v[52:55], v[184:187], v[164:167], v[52:55]
    ds_read_b128 v[240:243], v2 offset:16384
    v_mfma_f32_16x16x32_bf16 v[56:59], v[188:191], v[160:163], v[56:59]
    ds_read_b128 v[244:247], v2 offset:17408
    v_mfma_f32_16x16x32_bf16 v[60:63], v[188:191], v[164:167], v[60:63]
    v_mfma_f32_16x16x32_bf16 v[64:67], v[192:195], v[160:163], v[64:67]
    v_mfma_f32_16x16x32_bf16 v[68:71], v[192:195], v[164:167], v[68:71]
    v_mfma_f32_16x16x32_bf16 v[72:75], v[196:199], v[160:163], v[72:75]
    v_mfma_f32_16x16x32_bf16 v[76:79], v[196:199], v[164:167], v[76:79]
    v_mfma_f32_16x16x32_bf16 v[80:83], v[200:203], v[160:163], v[80:83]
    v_mfma_f32_16x16x32_bf16 v[84:87], v[200:203], v[164:167], v[84:87]
    s_waitcnt lgkmcnt(0)
    s_barrier
    v_mfma_f32_16x16x32_bf16 v[16:19], v[212:215], v[204:207], v[16:19]
    ds_read_b128 v[160:163], v3 offset:49152
    v_mfma_f32_16x16x32_bf16 v[20:23], v[212:215], v[208:211], v[20:23]
    ds_read_b128 v[164:167], v3 offset:51200
    v_mfma_f32_16x16x32_bf16 v[24:27], v[216:219], v[204:207], v[24:27]
    ds_read_b128 v[168:171], v2 offset:18432
    v_mfma_f32_16x16x32_bf16 v[28:31], v[216:219], v[208:211], v[28:31]
    ds_read_b128 v[172:175], v2 offset:19456
    v_mfma_f32_16x16x32_bf16 v[32:35], v[220:223], v[204:207], v[32:35]
    ds_read_b128 v[176:179], v2 offset:20480
    v_mfma_f32_16x16x32_bf16 v[36:39], v[220:223], v[208:211], v[36:39]
    ds_read_b128 v[180:183], v2 offset:21504
    v_mfma_f32_16x16x32_bf16 v[40:43], v[224:227], v[204:207], v[40:43]
    ds_read_b128 v[184:187], v2 offset:22528
    v_mfma_f32_16x16x32_bf16 v[44:47], v[224:227], v[208:211], v[44:47]
    ds_read_b128 v[188:191], v2 offset:23552
    v_mfma_f32_16x16x32_bf16 v[48:51], v[228:231], v[204:207], v[48:51]
    ds_read_b128 v[192:195], v2 offset:24576
    v_mfma_f32_16x16x32_bf16 v[52:55], v[228:231], v[208:211], v[52:55]
    ds_read_b128 v[196:199], v2 offset:25600
    v_mfma_f32_16x16x32_bf16 v[56:59], v[232:235], v[204:207], v[56:59]
    ds_read_b128 v[200:203], v2 offset:26624
    v_mfma_f32_16x16x32_bf16 v[60:63], v[232:235], v[208:211], v[60:63]
    v_mfma_f32_16x16x32_bf16 v[64:67], v[236:239], v[204:207], v[64:67]
    v_mfma_f32_16x16x32_bf16 v[68:71], v[236:239], v[208:211], v[68:71]
    v_mfma_f32_16x16x32_bf16 v[72:75], v[240:243], v[204:207], v[72:75]
    v_mfma_f32_16x16x32_bf16 v[76:79], v[240:243], v[208:211], v[76:79]
    v_mfma_f32_16x16x32_bf16 v[80:83], v[244:247], v[204:207], v[80:83]
    v_mfma_f32_16x16x32_bf16 v[84:87], v[244:247], v[208:211], v[84:87]
    s_waitcnt lgkmcnt(5)
    v_mfma_f32_16x16x32_bf16 v[16:19], v[168:171], v[160:163], v[16:19]
    ds_read_b128 v[204:207], v4 offset:49152
    v_mfma_f32_16x16x32_bf16 v[20:23], v[168:171], v[164:167], v[20:23]
    ds_read_b128 v[208:211], v4 offset:51200
    v_mfma_f32_16x16x32_bf16 v[24:27], v[172:175], v[160:163], v[24:27]
    ds_read_b128 v[212:215], v2 offset:27648
    v_mfma_f32_16x16x32_bf16 v[28:31], v[172:175], v[164:167], v[28:31]
    ds_read_b128 v[216:219], v2 offset:28672
    v_mfma_f32_16x16x32_bf16 v[32:35], v[176:179], v[160:163], v[32:35]
    ds_read_b128 v[220:223], v2 offset:29696
    v_mfma_f32_16x16x32_bf16 v[36:39], v[176:179], v[164:167], v[36:39]
    ds_read_b128 v[224:227], v2 offset:30720
    v_mfma_f32_16x16x32_bf16 v[40:43], v[180:183], v[160:163], v[40:43]
    ds_read_b128 v[228:231], v2 offset:31744
    v_mfma_f32_16x16x32_bf16 v[44:47], v[180:183], v[164:167], v[44:47]
    ds_read_b128 v[232:235], v2 offset:32768
    s_waitcnt lgkmcnt(8)
    v_mfma_f32_16x16x32_bf16 v[48:51], v[184:187], v[160:163], v[48:51]
    ds_read_b128 v[236:239], v2 offset:33792
    v_mfma_f32_16x16x32_bf16 v[52:55], v[184:187], v[164:167], v[52:55]
    ds_read_b128 v[240:243], v2 offset:34816
    v_mfma_f32_16x16x32_bf16 v[56:59], v[188:191], v[160:163], v[56:59]
    ds_read_b128 v[244:247], v2 offset:35840
    v_mfma_f32_16x16x32_bf16 v[60:63], v[188:191], v[164:167], v[60:63]
    v_mfma_f32_16x16x32_bf16 v[64:67], v[192:195], v[160:163], v[64:67]
    v_mfma_f32_16x16x32_bf16 v[68:71], v[192:195], v[164:167], v[68:71]
    v_mfma_f32_16x16x32_bf16 v[72:75], v[196:199], v[160:163], v[72:75]
    v_mfma_f32_16x16x32_bf16 v[76:79], v[196:199], v[164:167], v[76:79]
    v_mfma_f32_16x16x32_bf16 v[80:83], v[200:203], v[160:163], v[80:83]
    v_mfma_f32_16x16x32_bf16 v[84:87], v[200:203], v[164:167], v[84:87]
    s_waitcnt lgkmcnt(0)
    s_barrier
    v_mfma_f32_16x16x32_bf16 v[16:19], v[212:215], v[204:207], v[16:19]
    ds_read_b128 v[160:163], v3 offset:0
    v_mfma_f32_16x16x32_bf16 v[20:23], v[212:215], v[208:211], v[20:23]
    ds_read_b128 v[164:167], v3 offset:2048
    v_mfma_f32_16x16x32_bf16 v[24:27], v[216:219], v[204:207], v[24:27]
    ds_read_b128 v[168:171], v1 offset:0
    v_mfma_f32_16x16x32_bf16 v[28:31], v[216:219], v[208:211], v[28:31]
    ds_read_b128 v[172:175], v1 offset:1024
    v_mfma_f32_16x16x32_bf16 v[32:35], v[220:223], v[204:207], v[32:35]
    ds_read_b128 v[176:179], v1 offset:2048
    v_mfma_f32_16x16x32_bf16 v[36:39], v[220:223], v[208:211], v[36:39]
    ds_read_b128 v[180:183], v1 offset:3072
    v_mfma_f32_16x16x32_bf16 v[40:43], v[224:227], v[204:207], v[40:43]
    ds_read_b128 v[184:187], v1 offset:4096
    v_mfma_f32_16x16x32_bf16 v[44:47], v[224:227], v[208:211], v[44:47]
    ds_read_b128 v[188:191], v1 offset:5120
    v_mfma_f32_16x16x32_bf16 v[48:51], v[228:231], v[204:207], v[48:51]
    ds_read_b128 v[192:195], v1 offset:6144
    v_mfma_f32_16x16x32_bf16 v[52:55], v[228:231], v[208:211], v[52:55]
    ds_read_b128 v[196:199], v1 offset:7168
    v_mfma_f32_16x16x32_bf16 v[56:59], v[232:235], v[204:207], v[56:59]
    ds_read_b128 v[200:203], v1 offset:8192
    v_mfma_f32_16x16x32_bf16 v[60:63], v[232:235], v[208:211], v[60:63]
    v_mfma_f32_16x16x32_bf16 v[64:67], v[236:239], v[204:207], v[64:67]
    v_mfma_f32_16x16x32_bf16 v[68:71], v[236:239], v[208:211], v[68:71]
    v_mfma_f32_16x16x32_bf16 v[72:75], v[240:243], v[204:207], v[72:75]
    v_mfma_f32_16x16x32_bf16 v[76:79], v[240:243], v[208:211], v[76:79]
    v_mfma_f32_16x16x32_bf16 v[80:83], v[244:247], v[204:207], v[80:83]
    v_mfma_f32_16x16x32_bf16 v[84:87], v[244:247], v[208:211], v[84:87]
    s_waitcnt lgkmcnt(5)
    v_mfma_f32_16x16x32_bf16 v[16:19], v[168:171], v[160:163], v[16:19]
    ds_read_b128 v[204:207], v4 offset:0
    v_mfma_f32_16x16x32_bf16 v[20:23], v[168:171], v[164:167], v[20:23]
    ds_read_b128 v[208:211], v4 offset:2048
    v_mfma_f32_16x16x32_bf16 v[24:27], v[172:175], v[160:163], v[24:27]
    ds_read_b128 v[212:215], v1 offset:9216
    v_mfma_f32_16x16x32_bf16 v[28:31], v[172:175], v[164:167], v[28:31]
    ds_read_b128 v[216:219], v1 offset:10240
    v_mfma_f32_16x16x32_bf16 v[32:35], v[176:179], v[160:163], v[32:35]
    ds_read_b128 v[220:223], v1 offset:11264
    v_mfma_f32_16x16x32_bf16 v[36:39], v[176:179], v[164:167], v[36:39]
    ds_read_b128 v[224:227], v1 offset:12288
    v_mfma_f32_16x16x32_bf16 v[40:43], v[180:183], v[160:163], v[40:43]
    ds_read_b128 v[228:231], v1 offset:13312
    v_mfma_f32_16x16x32_bf16 v[44:47], v[180:183], v[164:167], v[44:47]
    ds_read_b128 v[232:235], v1 offset:14336
    s_waitcnt lgkmcnt(8)
    v_mfma_f32_16x16x32_bf16 v[48:51], v[184:187], v[160:163], v[48:51]
    ds_read_b128 v[236:239], v1 offset:15360
    v_mfma_f32_16x16x32_bf16 v[52:55], v[184:187], v[164:167], v[52:55]
    ds_read_b128 v[240:243], v1 offset:16384
    v_mfma_f32_16x16x32_bf16 v[56:59], v[188:191], v[160:163], v[56:59]
    ds_read_b128 v[244:247], v1 offset:17408
    v_mfma_f32_16x16x32_bf16 v[60:63], v[188:191], v[164:167], v[60:63]
    v_mfma_f32_16x16x32_bf16 v[64:67], v[192:195], v[160:163], v[64:67]
    v_mfma_f32_16x16x32_bf16 v[68:71], v[192:195], v[164:167], v[68:71]
    v_mfma_f32_16x16x32_bf16 v[72:75], v[196:199], v[160:163], v[72:75]
    v_mfma_f32_16x16x32_bf16 v[76:79], v[196:199], v[164:167], v[76:79]
    v_mfma_f32_16x16x32_bf16 v[80:83], v[200:203], v[160:163], v[80:83]
    v_mfma_f32_16x16x32_bf16 v[84:87], v[200:203], v[164:167], v[84:87]
    s_waitcnt lgkmcnt(0)
    s_barrier
    v_mfma_f32_16x16x32_bf16 v[16:19], v[212:215], v[204:207], v[16:19]
    ds_read_b128 v[160:163], v3 offset:16384
    v_mfma_f32_16x16x32_bf16 v[20:23], v[212:215], v[208:211], v[20:23]
    ds_read_b128 v[164:167], v3 offset:18432
    v_mfma_f32_16x16x32_bf16 v[24:27], v[216:219], v[204:207], v[24:27]
    ds_read_b128 v[168:171], v1 offset:18432
    v_mfma_f32_16x16x32_bf16 v[28:31], v[216:219], v[208:211], v[28:31]
    ds_read_b128 v[172:175], v1 offset:19456
    v_mfma_f32_16x16x32_bf16 v[32:35], v[220:223], v[204:207], v[32:35]
    ds_read_b128 v[176:179], v1 offset:20480
    v_mfma_f32_16x16x32_bf16 v[36:39], v[220:223], v[208:211], v[36:39]
    ds_read_b128 v[180:183], v1 offset:21504
    v_mfma_f32_16x16x32_bf16 v[40:43], v[224:227], v[204:207], v[40:43]
    ds_read_b128 v[184:187], v1 offset:22528
    v_mfma_f32_16x16x32_bf16 v[44:47], v[224:227], v[208:211], v[44:47]
    ds_read_b128 v[188:191], v1 offset:23552
    v_mfma_f32_16x16x32_bf16 v[48:51], v[228:231], v[204:207], v[48:51]
    ds_read_b128 v[192:195], v1 offset:24576
    v_mfma_f32_16x16x32_bf16 v[52:55], v[228:231], v[208:211], v[52:55]
    ds_read_b128 v[196:199], v1 offset:25600
    v_mfma_f32_16x16x32_bf16 v[56:59], v[232:235], v[204:207], v[56:59]
    ds_read_b128 v[200:203], v1 offset:26624
    v_mfma_f32_16x16x32_bf16 v[60:63], v[232:235], v[208:211], v[60:63]
    v_mfma_f32_16x16x32_bf16 v[64:67], v[236:239], v[204:207], v[64:67]
    v_mfma_f32_16x16x32_bf16 v[68:71], v[236:239], v[208:211], v[68:71]
    v_mfma_f32_16x16x32_bf16 v[72:75], v[240:243], v[204:207], v[72:75]
    v_mfma_f32_16x16x32_bf16 v[76:79], v[240:243], v[208:211], v[76:79]
    v_mfma_f32_16x16x32_bf16 v[80:83], v[244:247], v[204:207], v[80:83]
    v_mfma_f32_16x16x32_bf16 v[84:87], v[244:247], v[208:211], v[84:87]
    s_waitcnt lgkmcnt(5)
    v_mfma_f32_16x16x32_bf16 v[16:19], v[168:171], v[160:163], v[16:19]
    ds_read_b128 v[204:207], v4 offset:16384
    v_mfma_f32_16x16x32_bf16 v[20:23], v[168:171], v[164:167], v[20:23]
    ds_read_b128 v[208:211], v4 offset:18432
    v_mfma_f32_16x16x32_bf16 v[24:27], v[172:175], v[160:163], v[24:27]
    ds_read_b128 v[212:215], v1 offset:27648
    v_mfma_f32_16x16x32_bf16 v[28:31], v[172:175], v[164:167], v[28:31]
    ds_read_b128 v[216:219], v1 offset:28672
    v_mfma_f32_16x16x32_bf16 v[32:35], v[176:179], v[160:163], v[32:35]
    ds_read_b128 v[220:223], v1 offset:29696
    v_mfma_f32_16x16x32_bf16 v[36:39], v[176:179], v[164:167], v[36:39]
    ds_read_b128 v[224:227], v1 offset:30720
    v_mfma_f32_16x16x32_bf16 v[40:43], v[180:183], v[160:163], v[40:43]
    ds_read_b128 v[228:231], v1 offset:31744
    v_mfma_f32_16x16x32_bf16 v[44:47], v[180:183], v[164:167], v[44:47]
    ds_read_b128 v[232:235], v1 offset:32768
    s_waitcnt lgkmcnt(8)
    v_mfma_f32_16x16x32_bf16 v[48:51], v[184:187], v[160:163], v[48:51]
    ds_read_b128 v[236:239], v1 offset:33792
    v_mfma_f32_16x16x32_bf16 v[52:55], v[184:187], v[164:167], v[52:55]
    ds_read_b128 v[240:243], v1 offset:34816
    v_mfma_f32_16x16x32_bf16 v[56:59], v[188:191], v[160:163], v[56:59]
    ds_read_b128 v[244:247], v1 offset:35840
    v_mfma_f32_16x16x32_bf16 v[60:63], v[188:191], v[164:167], v[60:63]
    v_mfma_f32_16x16x32_bf16 v[64:67], v[192:195], v[160:163], v[64:67]
    v_mfma_f32_16x16x32_bf16 v[68:71], v[192:195], v[164:167], v[68:71]
    v_mfma_f32_16x16x32_bf16 v[72:75], v[196:199], v[160:163], v[72:75]
    v_mfma_f32_16x16x32_bf16 v[76:79], v[196:199], v[164:167], v[76:79]
    v_mfma_f32_16x16x32_bf16 v[80:83], v[200:203], v[160:163], v[80:83]
    v_mfma_f32_16x16x32_bf16 v[84:87], v[200:203], v[164:167], v[84:87]
    s_waitcnt lgkmcnt(0)
    v_mfma_f32_16x16x32_bf16 v[16:19], v[212:215], v[204:207], v[16:19]
    v_mfma_f32_16x16x32_bf16 v[20:23], v[212:215], v[208:211], v[20:23]
    v_mfma_f32_16x16x32_bf16 v[24:27], v[216:219], v[204:207], v[24:27]
    v_mfma_f32_16x16x32_bf16 v[28:31], v[216:219], v[208:211], v[28:31]
    v_mfma_f32_16x16x32_bf16 v[32:35], v[220:223], v[204:207], v[32:35]
    v_mfma_f32_16x16x32_bf16 v[36:39], v[220:223], v[208:211], v[36:39]
    v_mfma_f32_16x16x32_bf16 v[40:43], v[224:227], v[204:207], v[40:43]
    v_mfma_f32_16x16x32_bf16 v[44:47], v[224:227], v[208:211], v[44:47]
    v_mfma_f32_16x16x32_bf16 v[48:51], v[228:231], v[204:207], v[48:51]
    v_mfma_f32_16x16x32_bf16 v[52:55], v[228:231], v[208:211], v[52:55]
    v_mfma_f32_16x16x32_bf16 v[56:59], v[232:235], v[204:207], v[56:59]
    v_mfma_f32_16x16x32_bf16 v[60:63], v[232:235], v[208:211], v[60:63]
    v_mfma_f32_16x16x32_bf16 v[64:67], v[236:239], v[204:207], v[64:67]
    v_mfma_f32_16x16x32_bf16 v[68:71], v[236:239], v[208:211], v[68:71]
    v_mfma_f32_16x16x32_bf16 v[72:75], v[240:243], v[204:207], v[72:75]
    v_mfma_f32_16x16x32_bf16 v[76:79], v[240:243], v[208:211], v[76:79]
    v_mfma_f32_16x16x32_bf16 v[80:83], v[244:247], v[204:207], v[80:83]
    v_mfma_f32_16x16x32_bf16 v[84:87], v[244:247], v[208:211], v[84:87]
    s_nop 3
    v_pk_mul_f32 v[16:17], v[16:17], v[88:89]
    v_pk_mul_f32 v[18:19], v[18:19], v[90:91]
    v_pk_mul_f32 v[24:25], v[24:25], v[96:97]
    v_pk_mul_f32 v[26:27], v[26:27], v[98:99]
    v_cvt_pk_bf16_f32 v160, v16, v17
    v_cvt_pk_bf16_f32 v161, v18, v19
    v_cvt_pk_bf16_f32 v162, v24, v25
    v_cvt_pk_bf16_f32 v163, v26, v27
    buffer_store_dwordx4 v[160:163], v14, s[4:7], s39 offen offset:0
    v_pk_mul_f32 v[20:21], v[20:21], v[92:93]
    v_pk_mul_f32 v[22:23], v[22:23], v[94:95]
    v_pk_mul_f32 v[28:29], v[28:29], v[100:101]
    v_pk_mul_f32 v[30:31], v[30:31], v[102:103]
    v_cvt_pk_bf16_f32 v164, v20, v21
    v_cvt_pk_bf16_f32 v165, v22, v23
    v_cvt_pk_bf16_f32 v166, v28, v29
    v_cvt_pk_bf16_f32 v167, v30, v31
    buffer_store_dwordx4 v[164:167], v14, s[4:7], s40 offen offset:0
    v_pk_mul_f32 v[32:33], v[32:33], v[104:105]
    v_pk_mul_f32 v[34:35], v[34:35], v[106:107]
    v_pk_mul_f32 v[40:41], v[40:41], v[112:113]
    v_pk_mul_f32 v[42:43], v[42:43], v[114:115]
    v_cvt_pk_bf16_f32 v168, v32, v33
    v_cvt_pk_bf16_f32 v169, v34, v35
    v_cvt_pk_bf16_f32 v170, v40, v41
    v_cvt_pk_bf16_f32 v171, v42, v43
    buffer_store_dwordx4 v[168:171], v14, s[4:7], s39 offen offset:1024
    v_pk_mul_f32 v[36:37], v[36:37], v[108:109]
    v_pk_mul_f32 v[38:39], v[38:39], v[110:111]
    v_pk_mul_f32 v[44:45], v[44:45], v[116:117]
    v_pk_mul_f32 v[46:47], v[46:47], v[118:119]
    v_cvt_pk_bf16_f32 v172, v36, v37
    v_cvt_pk_bf16_f32 v173, v38, v39
    v_cvt_pk_bf16_f32 v174, v44, v45
    v_cvt_pk_bf16_f32 v175, v46, v47
    buffer_store_dwordx4 v[172:175], v14, s[4:7], s40 offen offset:1024
    v_pk_mul_f32 v[48:49], v[48:49], v[120:121]
    v_pk_mul_f32 v[50:51], v[50:51], v[122:123]
    v_pk_mul_f32 v[56:57], v[56:57], v[128:129]
    v_pk_mul_f32 v[58:59], v[58:59], v[130:131]
    v_cvt_pk_bf16_f32 v176, v48, v49
    v_cvt_pk_bf16_f32 v177, v50, v51
    v_cvt_pk_bf16_f32 v178, v56, v57
    v_cvt_pk_bf16_f32 v179, v58, v59
    buffer_store_dwordx4 v[176:179], v14, s[4:7], s39 offen offset:2048
    v_pk_mul_f32 v[52:53], v[52:53], v[124:125]
    v_pk_mul_f32 v[54:55], v[54:55], v[126:127]
    v_pk_mul_f32 v[60:61], v[60:61], v[132:133]
    v_pk_mul_f32 v[62:63], v[62:63], v[134:135]
    v_cvt_pk_bf16_f32 v180, v52, v53
    v_cvt_pk_bf16_f32 v181, v54, v55
    v_cvt_pk_bf16_f32 v182, v60, v61
    v_cvt_pk_bf16_f32 v183, v62, v63
    buffer_store_dwordx4 v[180:183], v14, s[4:7], s40 offen offset:2048
    v_pk_mul_f32 v[64:65], v[64:65], v[136:137]
    v_pk_mul_f32 v[66:67], v[66:67], v[138:139]
    v_pk_mul_f32 v[72:73], v[72:73], v[144:145]
    v_pk_mul_f32 v[74:75], v[74:75], v[146:147]
    v_cvt_pk_bf16_f32 v184, v64, v65
    v_cvt_pk_bf16_f32 v185, v66, v67
    v_cvt_pk_bf16_f32 v186, v72, v73
    v_cvt_pk_bf16_f32 v187, v74, v75
    buffer_store_dwordx4 v[184:187], v14, s[4:7], s39 offen offset:3072
    v_pk_mul_f32 v[68:69], v[68:69], v[140:141]
    v_pk_mul_f32 v[70:71], v[70:71], v[142:143]
    v_pk_mul_f32 v[76:77], v[76:77], v[148:149]
    v_pk_mul_f32 v[78:79], v[78:79], v[150:151]
    v_cvt_pk_bf16_f32 v188, v68, v69
    v_cvt_pk_bf16_f32 v189, v70, v71
    v_cvt_pk_bf16_f32 v190, v76, v77
    v_cvt_pk_bf16_f32 v191, v78, v79
    buffer_store_dwordx4 v[188:191], v14, s[4:7], s40 offen offset:3072
    v_pk_mul_f32 v[80:81], v[80:81], v[152:153]
    v_pk_mul_f32 v[82:83], v[82:83], v[154:155]
    v_cvt_pk_bf16_f32 v192, v80, v81
    v_cvt_pk_bf16_f32 v193, v82, v83
    buffer_store_dwordx2 v[192:193], v15, s[4:7], s39 offen
    v_pk_mul_f32 v[84:85], v[84:85], v[156:157]
    v_pk_mul_f32 v[86:87], v[86:87], v[158:159]
    v_cvt_pk_bf16_f32 v196, v84, v85
    v_cvt_pk_bf16_f32 v197, v86, v87
    buffer_store_dwordx2 v[196:197], v15, s[4:7], s40 offen
    s_endpgm
L_g_slow:
    s_mov_b32 s60, 65536
L_poll_zs:
    buffer_load_dword v4, v254, s[4:7], s37 offen sc1
    s_waitcnt vmcnt(0)
    v_cmp_gt_u32 vcc, 16, v4
    s_sub_u32 s60, s60, 1
    s_cbranch_scc1 L_pd_zs
    s_cbranch_vccz L_pd_zs
    s_sleep 4
    s_branch L_poll_zs
L_pd_zs:
    s_branch L_g_back
L_ld_p3:
    s_and_b32 s25, s2, 7
    s_lshr_b32 s26, s2, 3
    s_and_b32 s23, s25, 1
    s_lshl_b32 s23, s23, 3
    s_and_b32 s27, s26, 7
    s_add_u32 s23, s23, s27
    s_lshr_b32 s24, s25, 1
    s_lshl_b32 s24, s24, 2
    s_lshr_b32 s27, s26, 3
    s_add_u32 s24, s24, s27
    s_add_u32 s28, s23, s24
    s_and_b32 s28, s28, 3
    s_lshl_b32 s30, s20, 12
    s_lshr_b32 s33, s20, 1
    s_mul_i32 s31, s33, 18432
    s_and_b32 s33, s20, 1
    s_lshl_b32 s33, s33, 10
    s_add_u32 s33, s33, 16384
    s_add_u32 s31, s31, s33
    s_sub_u32 s49, s33, s30
    s_mul_i32 s34, s24, 331776
    s_add_u32 s34, s34, s30
    s_add_u32 s34, s34, 0x7b00000
    s_lshl_b32 s35, s23, 3
    s_lshl_b32 s33, s20, 1
    s_add_u32 s35, s35, s33
    s_mul_i32 s35, s35, 18432
    s_add_u32 s35, s35, s21
    s_add_u32 s35, s35, 0x300000
    s_mul_i32 s36, s24, 589824
    s_add_u32 s36, s36, s30
    s_add_u32 s36, s36, s21
    s_add_u32 s36, s36, 0x1200000
    v_add_u32 v2, 16384, v1
    s_cmp_eq_u32 s28, 0
    s_cselect_b32 s48, 4, 0
    s_mul_i32 s50, s48, 18432
    s_add_u32 s50, s50, s34
    s_add_u32 m0, s30, 0
    s_mov_b32 s53, s50
    buffer_load_dwordx4 v1, s[4:7], s50 offen offset:0  lds
    buffer_load_dwordx4 v1, s[4:7], s50 offen offset:1024  lds
    buffer_load_dwordx4 v1, s[4:7], s50 offen offset:2048  lds
    buffer_load_dwordx4 v1, s[4:7], s50 offen offset:3072  lds
    s_cmp_eq_u32 s28, 0
    s_cselect_b32 s48, 4, 0
    s_lshl_b32 s51, s48, 11
    s_add_u32 m0, s30, 73728
    s_add_u32 s51, s51, s35
    buffer_load_dwordx4 v1, s[4:7], s51 offen offset:0  lds
    buffer_load_dwordx4 v1, s[4:7], s51 offen offset:1024  lds
    buffer_load_dwordx4 v2, s[4:7], s51 offen offset:2048  lds
    buffer_load_dwordx4 v2, s[4:7], s51 offen offset:3072  lds
    s_cmp_eq_u32 s28, 1
    s_cselect_b32 s48, 5, 1
    s_mul_i32 s50, s48, 18432
    s_add_u32 s50, s50, s34
    s_cmp_ge_u32 s20, 2
    s_cselect_b32 s52, s50, s53
    s_add_u32 m0, s31, 0
    s_add_u32 s52, s52, s49
    buffer_load_dwordx4 v1, s[4:7], s52 offen  lds
    s_add_u32 m0, s30, 18432
    s_mov_b32 s53, s50
    buffer_load_dwordx4 v1, s[4:7], s50 offen offset:0  lds
    buffer_load_dwordx4 v1, s[4:7], s50 offen offset:1024  lds
    buffer_load_dwordx4 v1, s[4:7], s50 offen offset:2048  lds
    buffer_load_dwordx4 v1, s[4:7], s50 offen offset:3072  lds
    s_cmp_eq_u32 s28, 1
    s_cselect_b32 s48, 5, 1
    s_lshl_b32 s51, s48, 11
    s_add_u32 m0, s30, 90112
    s_add_u32 s51, s51, s35
    buffer_load_dwordx4 v1, s[4:7], s51 offen offset:0  lds
    buffer_load_dwordx4 v1, s[4:7], s51 offen offset:1024  lds
    buffer_load_dwordx4 v2, s[4:7], s51 offen offset:2048  lds
    buffer_load_dwordx4 v2, s[4:7], s51 offen offset:3072  lds
    s_waitcnt vmcnt(8)
    s_barrier
    s_cmp_eq_u32 s28, 2
    s_cselect_b32 s48, 6, 2
    s_mul_i32 s50, s48, 18432
    s_add_u32 s50, s50, s34
    s_add_u32 m0, s30, 36864
    s_mov_b32 s53, s50
    buffer_load_dwordx4 v1, s[4:7], s50 offen offset:0  lds
    buffer_load_dwordx4 v1, s[4:7], s50 offen offset:1024  lds
    buffer_load_dwordx4 v1, s[4:7], s50 offen offset:2048  lds
    buffer_load_dwordx4 v1, s[4:7], s50 offen offset:3072  lds
    s_cmp_eq_u32 s28, 2
    s_cselect_b32 s48, 6, 2
    s_lshl_b32 s51, s48, 11
    s_add_u32 m0, s30, 106496
    s_add_u32 s51, s51, s35
    buffer_load_dwordx4 v1, s[4:7], s51 offen offset:0  lds
    buffer_load_dwordx4 v1, s[4:7], s51 offen offset:1024  lds
    buffer_load_dwordx4 v2, s[4:7], s51 offen offset:2048  lds
    buffer_load_dwordx4 v2, s[4:7], s51 offen offset:3072  lds
    s_cmp_eq_u32 s28, 3
    s_cselect_b32 s48, 7, 3
    s_mul_i32 s50, s48, 18432
    s_add_u32 s50, s50, s34
    s_cmp_ge_u32 s20, 2
    s_cselect_b32 s52, s50, s53
    s_add_u32 m0, s31, 36864
    s_add_u32 s52, s52, s49
    buffer_load_dwordx4 v1, s[4:7], s52 offen  lds
    s_add_u32 m0, s30, 55296
    s_mov_b32 s53, s50
    buffer_load_dwordx4 v1, s[4:7], s50 offen offset:0  lds
    buffer_load_dwordx4 v1, s[4:7], s50 offen offset:1024  lds
    buffer_load_dwordx4 v1, s[4:7], s50 offen offset:2048  lds
    buffer_load_dwordx4 v1, s[4:7], s50 offen offset:3072  lds
    s_cmp_eq_u32 s28, 3
    s_cselect_b32 s48, 7, 3
    s_lshl_b32 s51, s48, 11
    s_add_u32 m0, s30, 122880
    s_add_u32 s51, s51, s35
    buffer_load_dwordx4 v1, s[4:7], s51 offen offset:0  lds
    buffer_load_dwordx4 v1, s[4:7], s51 offen offset:1024  lds
    buffer_load_dwordx4 v2, s[4:7], s51 offen offset:2048  lds
    buffer_load_dwordx4 v2, s[4:7], s51 offen offset:3072  lds
    s_lshl_b32 s33, s20, 10
    s_add_u32 m0, s33, 139264
    s_lshl_b32 s51, s24, 12
    s_add_u32 s51, s51, s33
    s_add_u32 s51, s51, 0x8410000
    buffer_load_dwordx4 v1, s[4:7], s51 offen lds
    s_lshl_b32 s33, s23, 7
    s_lshl_b32 s37, s20, 5
    s_add_u32 s33, s33, s37
    v_bfe_u32 v8, v0, 5, 1
    v_bfe_u32 v9, v0, 3, 2
    v_lshl_add_u32 v8, v8, 3, v9
    v_add_u32 v8, s33, v8
    v_lshlrev_b32 v8, 12, v8
    v_bfe_u32 v9, v0, 4, 2
    v_and_b32 v10, 7, v0
    v_xor_b32 v9, v9, v10
    v_lshl_add_u32 v8, v9, 4, v8
    v_xor_b32 v9, 64, v8
    v_add_u32 v9, 64512, v9
    v_add_u32 v10, 14336, v8
    v_add_u32 v11, 14336, v9
    s_cmp_eq_u32 s28, 0
    s_cselect_b32 s44, 4, 0
    s_cmp_eq_u32 s28, 1
    s_cselect_b32 s45, 5, 1
    s_cmp_eq_u32 s28, 2
    s_cselect_b32 s46, 6, 2
    s_cmp_eq_u32 s28, 3
    s_cselect_b32 s47, 7, 3
    s_lshl_b32 s54, s22, 8
    s_add_u32 s54, s54, s24
    s_lshl_b32 s54, s54, 8
    s_add_u32 s54, s54, 0x8508000
    v_mov_b32 v3, 0
    s_waitcnt vmcnt(18)
    s_barrier
    s_cmp_eq_u32 s28, 0
    s_cselect_b32 s48, 8, 4
    s_mul_i32 s50, s48, 18432
    s_add_u32 s50, s50, s34
    s_add_u32 m0, s30, 0
    s_mov_b32 s53, s50
    buffer_load_dwordx4 v1, s[4:7], s50 offen offset:0  lds
    buffer_load_dwordx4 v1, s[4:7], s50 offen offset:1024  lds
    buffer_load_dwordx4 v1, s[4:7], s50 offen offset:2048  lds
    buffer_load_dwordx4 v1, s[4:7], s50 offen offset:3072  lds
    s_cmp_eq_u32 s28, 0
    s_cselect_b32 s48, 8, 4
    s_lshl_b32 s51, s48, 11
    s_add_u32 m0, s30, 73728
    s_add_u32 s51, s51, s35
    buffer_load_dwordx4 v1, s[4:7], s51 offen offset:0  lds
    buffer_load_dwordx4 v1, s[4:7], s51 offen offset:1024  lds
    buffer_load_dwordx4 v2, s[4:7], s51 offen offset:2048  lds
    buffer_load_dwordx4 v2, s[4:7], s51 offen offset:3072  lds
    s_waitcnt vmcnt(17)
    s_barrier
    s_cmp_eq_u32 s28, 1
    s_cselect_b32 s48, 1, 5
    s_mul_i32 s50, s48, 18432
    s_add_u32 s50, s50, s34
    s_cmp_ge_u32 s20, 2
    s_cselect_b32 s52, s50, s53
    s_add_u32 m0, s31, 0
    s_add_u32 s52, s52, s49
    buffer_load_dwordx4 v1, s[4:7], s52 offen  lds
    s_add_u32 m0, s30, 18432
    s_mov_b32 s53, s50
    buffer_load_dwordx4 v1, s[4:7], s50 offen offset:0  lds
    buffer_load_dwordx4 v1, s[4:7], s50 offen offset:1024  lds
    buffer_load_dwordx4 v1, s[4:7], s50 offen offset:2048  lds
    buffer_load_dwordx4 v1, s[4:7], s50 offen offset:3072  lds
    s_cmp_eq_u32 s28, 1
    s_cselect_b32 s48, 1, 5
    s_lshl_b32 s51, s48, 11
    s_add_u32 m0, s30, 90112
    s_add_u32 s51, s51, s35
    buffer_load_dwordx4 v1, s[4:7], s51 offen offset:0  lds
    buffer_load_dwordx4 v1, s[4:7], s51 offen offset:1024  lds
    buffer_load_dwordx4 v2, s[4:7], s51 offen offset:2048  lds
    buffer_load_dwordx4 v2, s[4:7], s51 offen offset:3072  lds
    s_waitcnt vmcnt(18)
    s_barrier
    s_cmp_eq_u32 s28, 2
    s_cselect_b32 s48, 2, 6
    s_mul_i32 s50, s48, 18432
    s_add_u32 s50, s50, s34
    s_add_u32 m0, s30, 36864
    s_mov_b32 s53, s50
    buffer_load_dwordx4 v1, s[4:7], s50 offen offset:0  lds
    buffer_load_dwordx4 v1, s[4:7], s50 offen offset:1024  lds
    buffer_load_dwordx4 v1, s[4:7], s50 offen offset:2048  lds
    buffer_load_dwordx4 v1, s[4:7], s50 offen offset:3072  lds
    s_cmp_eq_u32 s28, 2
    s_cselect_b32 s48, 2, 6
    s_lshl_b32 s51, s48, 11
    s_add_u32 m0, s30, 106496
    s_add_u32 s51, s51, s35
    buffer_load_dwordx4 v1, s[4:7], s51 offen offset:0  lds
    buffer_load_dwordx4 v1, s[4:7], s51 offen offset:1024  lds
    buffer_load_dwordx4 v2, s[4:7], s51 offen offset:2048  lds
    buffer_load_dwordx4 v2, s[4:7], s51 offen offset:3072  lds
    s_waitcnt vmcnt(16)
    s_barrier
    s_cmp_eq_u32 s28, 3
    s_cselect_b32 s48, 3, 7
    s_mul_i32 s50, s48, 18432
    s_add_u32 s50, s50, s34
    s_cmp_ge_u32 s20, 2
    s_cselect_b32 s52, s50, s53
    s_add_u32 m0, s31, 36864
    s_add_u32 s52, s52, s49
    buffer_load_dwordx4 v1, s[4:7], s52 offen  lds
    s_add_u32 m0, s30, 55296
    s_mov_b32 s53, s50
    buffer_load_dwordx4 v1, s[4:7], s50 offen offset:0  lds
    buffer_load_dwordx4 v1, s[4:7], s50 offen offset:1024  lds
    buffer_load_dwordx4 v1, s[4:7], s50 offen offset:2048  lds
    buffer_load_dwordx4 v1, s[4:7], s50 offen offset:3072  lds
    s_cmp_eq_u32 s28, 3
    s_cselect_b32 s48, 3, 7
    s_lshl_b32 s51, s48, 11
    s_add_u32 m0, s30, 122880
    s_add_u32 s51, s51, s35
    buffer_load_dwordx4 v1, s[4:7], s51 offen offset:0  lds
    buffer_load_dwordx4 v1, s[4:7], s51 offen offset:1024  lds
    buffer_load_dwordx4 v2, s[4:7], s51 offen offset:2048  lds
    buffer_load_dwordx4 v2, s[4:7], s51 offen offset:3072  lds
    s_waitcnt vmcnt(17)
    s_barrier
    s_cmp_eq_u32 s28, 0
    s_cselect_b32 s48, 0, 8
    s_mul_i32 s50, s48, 18432
    s_add_u32 s50, s50, s34
    s_add_u32 m0, s30, 0
    s_mov_b32 s53, s50
    buffer_load_dwordx4 v1, s[4:7], s50 offen offset:0  lds
    buffer_load_dwordx4 v1, s[4:7], s50 offen offset:1024  lds
    buffer_load_dwordx4 v1, s[4:7], s50 offen offset:2048  lds
    buffer_load_dwordx4 v1, s[4:7], s50 offen offset:3072  lds
    s_cmp_eq_u32 s28, 0
    s_cselect_b32 s48, 0, 8
    s_lshl_b32 s51, s48, 11
    s_add_u32 m0, s30, 73728
    s_add_u32 s51, s51, s35
    buffer_load_dwordx4 v1, s[4:7], s51 offen offset:0  lds
    buffer_load_dwordx4 v1, s[4:7], s51 offen offset:1024  lds
    buffer_load_dwordx4 v2, s[4:7], s51 offen offset:2048  lds
    buffer_load_dwordx4 v2, s[4:7], s51 offen offset:3072  lds
    s_waitcnt vmcnt(16)
    s_barrier
    s_cmp_eq_u32 s28, 0
    s_cselect_b32 s48, 4, 0
    s_mul_i32 s50, s48, 18432
    s_add_u32 s50, s50, s34
    s_add_u32 s50, s50, 165888
    s_cmp_ge_u32 s20, 2
    s_cselect_b32 s52, s50, s53
    s_add_u32 m0, s31, 0
    s_add_u32 s52, s52, s49
    buffer_load_dwordx4 v1, s[4:7], s52 offen  lds
    s_add_u32 m0, s30, 18432
    s_mov_b32 s53, s50
    buffer_load_dwordx4 v1, s[4:7], s50 offen offset:0  lds
    buffer_load_dwordx4 v1, s[4:7], s50 offen offset:1024  lds
    buffer_load_dwordx4 v1, s[4:7], s50 offen offset:2048  lds
    buffer_load_dwordx4 v1, s[4:7], s50 offen offset:3072  lds
    s_cmp_eq_u32 s28, 0
    s_cselect_b32 s48, 4, 0
    s_lshl_b32 s51, s48, 11
    s_add_u32 m0, s30, 90112
    s_add_u32 s51, s51, s35
    buffer_load_dwordx4 v1, s[4:7], s51 offen offset:0  lds
    buffer_load_dwordx4 v1, s[4:7], s51 offen offset:1024  lds
    buffer_load_dwordx4 v2, s[4:7], s51 offen offset:2048  lds
    buffer_load_dwordx4 v2, s[4:7], s51 offen offset:3072  lds
    s_waitcnt vmcnt(17)
    s_barrier
    s_cmp_eq_u32 s28, 1
    s_cselect_b32 s48, 5, 1
    s_mul_i32 s50, s48, 18432
    s_add_u32 s50, s50, s34
    s_add_u32 s50, s50, 165888
    s_add_u32 m0, s30, 36864
    s_mov_b32 s53, s50
    buffer_load_dwordx4 v1, s[4:7], s50 offen offset:0  lds
    buffer_load_dwordx4 v1, s[4:7], s50 offen offset:1024  lds
    buffer_load_dwordx4 v1, s[4:7], s50 offen offset:2048  lds
    buffer_load_dwordx4 v1, s[4:7], s50 offen offset:3072  lds
    s_cmp_eq_u32 s28, 1
    s_cselect_b32 s48, 5, 1
    s_lshl_b32 s51, s48, 11
    s_add_u32 m0, s30, 106496
    s_add_u32 s51, s51, s35
    buffer_load_dwordx4 v1, s[4:7], s51 offen offset:0  lds
    buffer_load_dwordx4 v1, s[4:7], s51 offen offset:1024  lds
    buffer_load_dwordx4 v2, s[4:7], s51 offen offset:2048  lds
    buffer_load_dwordx4 v2, s[4:7], s51 offen offset:3072  lds
    s_waitcnt vmcnt(16)
    s_barrier
    s_cmp_eq_u32 s28, 2
    s_cselect_b32 s48, 6, 2
    s_mul_i32 s50, s48, 18432
    s_add_u32 s50, s50, s34
    s_add_u32 s50, s50, 165888
    s_cmp_ge_u32 s20, 2
    s_cselect_b32 s52, s50, s53
    s_add_u32 m0, s31, 36864
    s_add_u32 s52, s52, s49
    buffer_load_dwordx4 v1, s[4:7], s52 offen  lds
    s_add_u32 m0, s30, 55296
    s_mov_b32 s53, s50
    buffer_load_dwordx4 v1, s[4:7], s50 offen offset:0  lds
    buffer_load_dwordx4 v1, s[4:7], s50 offen offset:1024  lds
    buffer_load_dwordx4 v1, s[4:7], s50 offen offset:2048  lds
    buffer_load_dwordx4 v1, s[4:7], s50 offen offset:3072  lds
    s_cmp_eq_u32 s28, 2
    s_cselect_b32 s48, 6, 2
    s_lshl_b32 s51, s48, 11
    s_add_u32 m0, s30, 122880
    s_add_u32 s51, s51, s35
    buffer_load_dwordx4 v1, s[4:7], s51 offen offset:0  lds
    buffer_load_dwordx4 v1, s[4:7], s51 offen offset:1024  lds
    buffer_load_dwordx4 v2, s[4:7], s51 offen offset:2048  lds
    buffer_load_dwordx4 v2, s[4:7], s51 offen offset:3072  lds
    s_waitcnt vmcnt(17)
    s_barrier
    s_cmp_eq_u32 s28, 3
    s_cselect_b32 s48, 7, 3
    s_mul_i32 s50, s48, 18432
    s_add_u32 s50, s50, s34
    s_add_u32 s50, s50, 165888
    s_add_u32 m0, s30, 0
    s_mov_b32 s53, s50
    buffer_load_dwordx4 v1, s[4:7], s50 offen offset:0  lds
    buffer_load_dwordx4 v1, s[4:7], s50 offen offset:1024  lds
    buffer_load_dwordx4 v1, s[4:7], s50 offen offset:2048  lds
    buffer_load_dwordx4 v1, s[4:7], s50 offen offset:3072  lds
    s_cmp_eq_u32 s28, 3
    s_cselect_b32 s48, 7, 3
    s_lshl_b32 s51, s48, 11
    s_add_u32 m0, s30, 73728
    s_add_u32 s51, s51, s35
    buffer_load_dwordx4 v1, s[4:7], s51 offen offset:0  lds
    buffer_load_dwordx4 v1, s[4:7], s51 offen offset:1024  lds
    buffer_load_dwordx4 v2, s[4:7], s51 offen offset:2048  lds
    buffer_load_dwordx4 v2, s[4:7], s51 offen offset:3072  lds
    s_waitcnt vmcnt(16)
    s_barrier
    s_cmp_eq_u32 s28, 0
    s_cselect_b32 s48, 8, 4
    s_mul_i32 s50, s48, 18432
    s_add_u32 s50, s50, s34
    s_add_u32 s50, s50, 165888
    s_cmp_ge_u32 s20, 2
    s_cselect_b32 s52, s50, s53
    s_add_u32 m0, s31, 0
    s_add_u32 s52, s52, s49
    buffer_load_dwordx4 v1, s[4:7], s52 offen  lds
    s_add_u32 m0, s30, 18432
    s_mov_b32 s53, s50
    buffer_load_dwordx4 v1, s[4:7], s50 offen offset:0  lds
    buffer_load_dwordx4 v1, s[4:7], s50 offen offset:1024  lds
    buffer_load_dwordx4 v1, s[4:7], s50 offen offset:2048  lds
    buffer_load_dwordx4 v1, s[4:7], s50 offen offset:3072  lds
    s_cmp_eq_u32 s28, 0
    s_cselect_b32 s48, 8, 4
    s_lshl_b32 s51, s48, 11
    s_add_u32 m0, s30, 90112
    s_add_u32 s51, s51, s35
    buffer_load_dwordx4 v1, s[4:7], s51 offen offset:0  lds
    buffer_load_dwordx4 v1, s[4:7], s51 offen offset:1024  lds
    buffer_load_dwordx4 v2, s[4:7], s51 offen offset:2048  lds
    buffer_load_dwordx4 v2, s[4:7], s51 offen offset:3072  lds
    s_waitcnt vmcnt(17)
    s_barrier
    s_cmp_eq_u32 s28, 1
    s_cselect_b32 s48, 1, 5
    s_mul_i32 s50, s48, 18432
    s_add_u32 s50, s50, s34
    s_add_u32 s50, s50, 165888
    s_add_u32 m0, s30, 36864
    s_mov_b32 s53, s50
    buffer_load_dwordx4 v1, s[4:7], s50 offen offset:0  lds
    buffer_load_dwordx4 v1, s[4:7], s50 offen offset:1024  lds
    buffer_load_dwordx4 v1, s[4:7], s50 offen offset:2048  lds
    buffer_load_dwordx4 v1, s[4:7], s50 offen offset:3072  lds
    s_cmp_eq_u32 s28, 1
    s_cselect_b32 s48, 1, 5
    s_lshl_b32 s51, s48, 11
    s_add_u32 m0, s30, 106496
    s_add_u32 s51, s51, s35
    buffer_load_dwordx4 v1, s[4:7], s51 offen offset:0  lds
    buffer_load_dwordx4 v1, s[4:7], s51 offen offset:1024  lds
    buffer_load_dwordx4 v2, s[4:7], s51 offen offset:2048  lds
    buffer_load_dwordx4 v2, s[4:7], s51 offen offset:3072  lds
    s_waitcnt vmcnt(16)
    s_barrier
    s_cmp_eq_u32 s28, 2
    s_cselect_b32 s48, 2, 6
    s_mul_i32 s50, s48, 18432
    s_add_u32 s50, s50, s34
    s_add_u32 s50, s50, 165888
    s_cmp_ge_u32 s20, 2
    s_cselect_b32 s52, s50, s53
    s_add_u32 m0, s31, 36864
    s_add_u32 s52, s52, s49
    buffer_load_dwordx4 v1, s[4:7], s52 offen  lds
    s_add_u32 m0, s30, 55296
    s_mov_b32 s53, s50
    buffer_load_dwordx4 v1, s[4:7], s50 offen offset:0  lds
    buffer_load_dwordx4 v1, s[4:7], s50 offen offset:1024  lds
    buffer_load_dwordx4 v1, s[4:7], s50 offen offset:2048  lds
    buffer_load_dwordx4 v1, s[4:7], s50 offen offset:3072  lds
    s_cmp_eq_u32 s28, 2
    s_cselect_b32 s48, 2, 6
    s_lshl_b32 s51, s48, 11
    s_add_u32 m0, s30, 122880
    s_add_u32 s51, s51, s35
    buffer_load_dwordx4 v1, s[4:7], s51 offen offset:0  lds
    buffer_load_dwordx4 v1, s[4:7], s51 offen offset:1024  lds
    buffer_load_dwordx4 v2, s[4:7], s51 offen offset:2048  lds
    buffer_load_dwordx4 v2, s[4:7], s51 offen offset:3072  lds
    s_waitcnt vmcnt(17)
    s_barrier
    s_cmp_eq_u32 s28, 3
    s_cselect_b32 s48, 3, 7
    s_mul_i32 s50, s48, 18432
    s_add_u32 s50, s50, s34
    s_add_u32 s50, s50, 165888
    s_add_u32 m0, s30, 0
    s_mov_b32 s53, s50
    buffer_load_dwordx4 v1, s[4:7], s50 offen offset:0  lds
    buffer_load_dwordx4 v1, s[4:7], s50 offen offset:1024  lds
    buffer_load_dwordx4 v1, s[4:7], s50 offen offset:2048  lds
    buffer_load_dwordx4 v1, s[4:7], s50 offen offset:3072  lds
    s_cmp_eq_u32 s28, 3
    s_cselect_b32 s48, 3, 7
    s_lshl_b32 s51, s48, 11
    s_add_u32 m0, s30, 73728
    s_add_u32 s51, s51, s35
    buffer_load_dwordx4 v1, s[4:7], s51 offen offset:0  lds
    buffer_load_dwordx4 v1, s[4:7], s51 offen offset:1024  lds
    buffer_load_dwordx4 v2, s[4:7], s51 offen offset:2048  lds
    buffer_load_dwordx4 v2, s[4:7], s51 offen offset:3072  lds
    s_waitcnt vmcnt(16)
    s_barrier
    s_cmp_eq_u32 s28, 0
    s_cselect_b32 s48, 0, 8
    s_mul_i32 s50, s48, 18432
    s_add_u32 s50, s50, s34
    s_add_u32 s50, s50, 165888
    s_cmp_ge_u32 s20, 2
    s_cselect_b32 s52, s50, s53
    s_add_u32 m0, s31, 0
    s_add_u32 s52, s52, s49
    buffer_load_dwordx4 v1, s[4:7], s52 offen  lds
    s_add_u32 m0, s30, 18432
    s_mov_b32 s53, s50
    buffer_load_dwordx4 v1, s[4:7], s50 offen offset:0  lds
    buffer_load_dwordx4 v1, s[4:7], s50 offen offset:1024  lds
    buffer_load_dwordx4 v1, s[4:7], s50 offen offset:2048  lds
    buffer_load_dwordx4 v1, s[4:7], s50 offen offset:3072  lds
    s_cmp_eq_u32 s28, 0
    s_cselect_b32 s48, 0, 8
    s_lshl_b32 s51, s48, 11
    s_add_u32 m0, s30, 90112
    s_add_u32 s51, s51, s35
    buffer_load_dwordx4 v1, s[4:7], s51 offen offset:0  lds
    buffer_load_dwordx4 v1, s[4:7], s51 offen offset:1024  lds
    buffer_load_dwordx4 v2, s[4:7], s51 offen offset:2048  lds
    buffer_load_dwordx4 v2, s[4:7], s51 offen offset:3072  lds
    s_waitcnt vmcnt(17)
    s_barrier
    s_add_u32 m0, s30, 106496
    s_lshl_b32 s51, s44, 7
    buffer_load_dwordx4 v8, s[8:11], s51 offen offset:0 lds
    buffer_load_dwordx4 v9, s[8:11], s51 offen offset:1024 lds
    buffer_load_dwordx4 v10, s[8:11], s51 offen offset:2048 lds
    buffer_load_dwordx4 v11, s[8:11], s51 offen offset:3072 lds
    s_waitcnt vmcnt(12)
    s_barrier
    s_add_u32 m0, s30, 122880
    s_lshl_b32 s51, s45, 7
    buffer_load_dwordx4 v8, s[8:11], s51 offen offset:0 lds
    buffer_load_dwordx4 v9, s[8:11], s51 offen offset:1024 lds
    buffer_load_dwordx4 v10, s[8:11], s51 offen offset:2048 lds
    buffer_load_dwordx4 v11, s[8:11], s51 offen offset:3072 lds
    s_waitcnt vmcnt(8)
    s_barrier
    s_add_u32 m0, s30, 73728
    s_lshl_b32 s51, s46, 7
    buffer_load_dwordx4 v8, s[8:11], s51 offen offset:0 lds
    buffer_load_dwordx4 v9, s[8:11], s51 offen offset:1024 lds
    buffer_load_dwordx4 v10, s[8:11], s51 offen offset:2048 lds
    buffer_load_dwordx4 v11, s[8:11], s51 offen offset:3072 lds
    s_barrier
    s_add_u32 m0, s30, 90112
    s_lshl_b32 s51, s47, 7
    buffer_load_dwordx4 v8, s[8:11], s51 offen offset:0 lds
    buffer_load_dwordx4 v9, s[8:11], s51 offen offset:1024 lds
    buffer_load_dwordx4 v10, s[8:11], s51 offen offset:2048 lds
    buffer_load_dwordx4 v11, s[8:11], s51 offen offset:3072 lds
    s_mov_b32 s60, 65536
L_poll_z2:
    buffer_load_dword v4, v3, s[4:7], s54 offen sc1
    s_waitcnt vmcnt(0)
    v_cmp_gt_u32 vcc, 16, v4
    s_sub_u32 s60, s60, 1
    s_cbranch_scc1 L_pd_z2
    s_cbranch_vccz L_pd_z2
    s_sleep 8
    s_branch L_poll_z2
L_pd_z2:
    s_mul_i32 s50, s44, 18432
    s_add_u32 s50, s50, s36
    s_add_u32 m0, s30, 36864
    s_mov_b32 s53, s50
    buffer_load_dwordx4 v1, s[4:7], s50 offen offset:0 sc1 lds
    buffer_load_dwordx4 v1, s[4:7], s50 offen offset:1024 sc1 lds
    buffer_load_dwordx4 v1, s[4:7], s50 offen offset:2048 sc1 lds
    buffer_load_dwordx4 v1, s[4:7], s50 offen offset:3072 sc1 lds
    s_add_u32 s44, s44, 4
    s_and_b32 s44, s44, 31
    s_mul_i32 s50, s45, 18432
    s_add_u32 s50, s50, s36
    s_cmp_ge_u32 s20, 2
    s_cselect_b32 s52, s50, s53
    s_add_u32 m0, s31, 36864
    s_add_u32 s52, s52, s49
    buffer_load_dwordx4 v1, s[4:7], s52 offen sc1 lds
    s_add_u32 m0, s30, 55296
    s_mov_b32 s53, s50
    buffer_load_dwordx4 v1, s[4:7], s50 offen offset:0 sc1 lds
    buffer_load_dwordx4 v1, s[4:7], s50 offen offset:1024 sc1 lds
    buffer_load_dwordx4 v1, s[4:7], s50 offen offset:2048 sc1 lds
    buffer_load_dwordx4 v1, s[4:7], s50 offen offset:3072 sc1 lds
    s_add_u32 s45, s45, 4
    s_and_b32 s45, s45, 31
    s_mul_i32 s50, s46, 18432
    s_add_u32 s50, s50, s36
    s_add_u32 m0, s30, 0
    s_mov_b32 s53, s50
    buffer_load_dwordx4 v1, s[4:7], s50 offen offset:0 sc1 lds
    buffer_load_dwordx4 v1, s[4:7], s50 offen offset:1024 sc1 lds
    buffer_load_dwordx4 v1, s[4:7], s50 offen offset:2048 sc1 lds
    buffer_load_dwordx4 v1, s[4:7], s50 offen offset:3072 sc1 lds
    s_add_u32 s46, s46, 4
    s_and_b32 s46, s46, 31
    s_mul_i32 s50, s47, 18432
    s_add_u32 s50, s50, s36
    s_cmp_ge_u32 s20, 2
    s_cselect_b32 s52, s50, s53
    s_add_u32 m0, s31, 0
    s_add_u32 s52, s52, s49
    buffer_load_dwordx4 v1, s[4:7], s52 offen sc1 lds
    s_add_u32 m0, s30, 18432
    s_mov_b32 s53, s50
    buffer_load_dwordx4 v1, s[4:7], s50 offen offset:0 sc1 lds
    buffer_load_dwordx4 v1, s[4:7], s50 offen offset:1024 sc1 lds
    buffer_load_dwordx4 v1, s[4:7], s50 offen offset:2048 sc1 lds
    buffer_load_dwordx4 v1, s[4:7], s50 offen offset:3072 sc1 lds
    s_add_u32 s47, s47, 4
    s_and_b32 s47, s47, 31
    s_waitcnt vmcnt(13)
    s_barrier
    s_waitcnt vmcnt(9)
    s_barrier
    s_mul_i32 s50, s44, 18432
    s_add_u32 s50, s50, s36
    s_add_u32 m0, s30, 36864
    s_mov_b32 s53, s50
    buffer_load_dwordx4 v1, s[4:7], s50 offen offset:0 sc1 lds
    buffer_load_dwordx4 v1, s[4:7], s50 offen offset:1024 sc1 lds
    buffer_load_dwordx4 v1, s[4:7], s50 offen offset:2048 sc1 lds
    buffer_load_dwordx4 v1, s[4:7], s50 offen offset:3072 sc1 lds
    s_add_u32 m0, s30, 106496
    s_lshl_b32 s51, s44, 7
    buffer_load_dwordx4 v8, s[8:11], s51 offen offset:0 lds
    buffer_load_dwordx4 v9, s[8:11], s51 offen offset:1024 lds
    buffer_load_dwordx4 v10, s[8:11], s51 offen offset:2048 lds
    buffer_load_dwordx4 v11, s[8:11], s51 offen offset:3072 lds
    s_add_u32 s44, s44, 4
    s_and_b32 s44, s44, 31
    s_waitcnt vmcnt(12)
    s_barrier
    s_mul_i32 s50, s45, 18432
    s_add_u32 s50, s50, s36
    s_cmp_ge_u32 s20, 2
    s_cselect_b32 s52, s50, s53
    s_add_u32 m0, s31, 36864
    s_add_u32 s52, s52, s49
    buffer_load_dwordx4 v1, s[4:7], s52 offen sc1 lds
    s_add_u32 m0, s30, 55296
    s_mov_b32 s53, s50
    buffer_load_dwordx4 v1, s[4:7], s50 offen offset:0 sc1 lds
    buffer_load_dwordx4 v1, s[4:7], s50 offen offset:1024 sc1 lds
    buffer_load_dwordx4 v1, s[4:7], s50 offen offset:2048 sc1 lds
    buffer_load_dwordx4 v1, s[4:7], s50 offen offset:3072 sc1 lds
    s_add_u32 m0, s30, 122880
    s_lshl_b32 s51, s45, 7
    buffer_load_dwordx4 v8, s[8:11], s51 offen offset:0 lds
    buffer_load_dwordx4 v9, s[8:11], s51 offen offset:1024 lds
    buffer_load_dwordx4 v10, s[8:11], s51 offen offset:2048 lds
    buffer_load_dwordx4 v11, s[8:11], s51 offen offset:3072 lds
    s_add_u32 s45, s45, 4
    s_and_b32 s45, s45, 31
    s_waitcnt vmcnt(17)
    s_barrier
    s_mul_i32 s50, s46, 18432
    s_add_u32 s50, s50, s36
    s_add_u32 m0, s30, 0
    s_mov_b32 s53, s50
    buffer_load_dwordx4 v1, s[4:7], s50 offen offset:0 sc1 lds
    buffer_load_dwordx4 v1, s[4:7], s50 offen offset:1024 sc1 lds
    buffer_load_dwordx4 v1, s[4:7], s50 offen offset:2048 sc1 lds
    buffer_load_dwordx4 v1, s[4:7], s50 offen offset:3072 sc1 lds
    s_add_u32 m0, s30, 73728
    s_lshl_b32 s51, s46, 7
    buffer_load_dwordx4 v8, s[8:11], s51 offen offset:0 lds
    buffer_load_dwordx4 v9, s[8:11], s51 offen offset:1024 lds
    buffer_load_dwordx4 v10, s[8:11], s51 offen offset:2048 lds
    buffer_load_dwordx4 v11, s[8:11], s51 offen offset:3072 lds
    s_add_u32 s46, s46, 4
    s_and_b32 s46, s46, 31
    s_waitcnt vmcnt(16)
    s_barrier
    s_mul_i32 s50, s47, 18432
    s_add_u32 s50, s50, s36
    s_cmp_ge_u32 s20, 2
    s_cselect_b32 s52, s50, s53
    s_add_u32 m0, s31, 0
    s_add_u32 s52, s52, s49
    buffer_load_dwordx4 v1, s[4:7], s52 offen sc1 lds
    s_add_u32 m0, s30, 18432
    s_mov_b32 s53, s50
    buffer_load_dwordx4 v1, s[4:7], s50 offen offset:0 sc1 lds
    buffer_load_dwordx4 v1, s[4:7], s50 offen offset:1024 sc1 lds
    buffer_load_dwordx4 v1, s[4:7], s50 offen offset:2048 sc1 lds
    buffer_load_dwordx4 v1, s[4:7], s50 offen offset:3072 sc1 lds
    s_add_u32 m0, s30, 90112
    s_lshl_b32 s51, s47, 7
    buffer_load_dwordx4 v8, s[8:11], s51 offen offset:0 lds
    buffer_load_dwordx4 v9, s[8:11], s51 offen offset:1024 lds
    buffer_load_dwordx4 v10, s[8:11], s51 offen offset:2048 lds
    buffer_load_dwordx4 v11, s[8:11], s51 offen offset:3072 lds
    s_add_u32 s47, s47, 4
    s_and_b32 s47, s47, 31
    s_mov_b32 s41, 6
L_g_ll:
    s_waitcnt vmcnt(17)
    s_barrier
    s_mul_i32 s50, s44, 18432
    s_add_u32 s50, s50, s36
    s_add_u32 m0, s30, 36864
    s_mov_b32 s53, s50
    buffer_load_dwordx4 v1, s[4:7], s50 offen offset:0 sc1 lds
    buffer_load_dwordx4 v1, s[4:7], s50 offen offset:1024 sc1 lds
    buffer_load_dwordx4 v1, s[4:7], s50 offen offset:2048 sc1 lds
    buffer_load_dwordx4 v1, s[4:7], s50 offen offset:3072 sc1 lds
    s_add_u32 m0, s30, 106496
    s_lshl_b32 s51, s44, 7
    buffer_load_dwordx4 v8, s[8:11], s51 offen offset:0 lds
    buffer_load_dwordx4 v9, s[8:11], s51 offen offset:1024 lds
    buffer_load_dwordx4 v10, s[8:11], s51 offen offset:2048 lds
    buffer_load_dwordx4 v11, s[8:11], s51 offen offset:3072 lds
    s_add_u32 s44, s44, 4
    s_and_b32 s44, s44, 31
    s_waitcnt vmcnt(16)
    s_barrier
    s_mul_i32 s50, s45, 18432
    s_add_u32 s50, s50, s36
    s_cmp_ge_u32 s20, 2
    s_cselect_b32 s52, s50, s53
    s_add_u32 m0, s31, 36864
    s_add_u32 s52, s52, s49
    buffer_load_dwordx4 v1, s[4:7], s52 offen sc1 lds
    s_add_u32 m0, s30, 55296
    s_mov_b32 s53, s50
    buffer_load_dwordx4 v1, s[4:7], s50 offen offset:0 sc1 lds
    buffer_load_dwordx4 v1, s[4:7], s50 offen offset:1024 sc1 lds
    buffer_load_dwordx4 v1, s[4:7], s50 offen offset:2048 sc1 lds
    buffer_load_dwordx4 v1, s[4:7], s50 offen offset:3072 sc1 lds
    s_add_u32 m0, s30, 122880
    s_lshl_b32 s51, s45, 7
    buffer_load_dwordx4 v8, s[8:11], s51 offen offset:0 lds
    buffer_load_dwordx4 v9, s[8:11], s51 offen offset:1024 lds
    buffer_load_dwordx4 v10, s[8:11], s51 offen offset:2048 lds
    buffer_load_dwordx4 v11, s[8:11], s51 offen offset:3072 lds
    s_add_u32 s45, s45, 4
    s_and_b32 s45, s45, 31
    s_waitcnt vmcnt(17)
    s_barrier
    s_mul_i32 s50, s46, 18432
    s_add_u32 s50, s50, s36
    s_add_u32 m0, s30, 0
    s_mov_b32 s53, s50
    buffer_load_dwordx4 v1, s[4:7], s50 offen offset:0 sc1 lds
    buffer_load_dwordx4 v1, s[4:7], s50 offen offset:1024 sc1 lds
    buffer_load_dwordx4 v1, s[4:7], s50 offen offset:2048 sc1 lds
    buffer_load_dwordx4 v1, s[4:7], s50 offen offset:3072 sc1 lds
    s_add_u32 m0, s30, 73728
    s_lshl_b32 s51, s46, 7
    buffer_load_dwordx4 v8, s[8:11], s51 offen offset:0 lds
    buffer_load_dwordx4 v9, s[8:11], s51 offen offset:1024 lds
    buffer_load_dwordx4 v10, s[8:11], s51 offen offset:2048 lds
    buffer_load_dwordx4 v11, s[8:11], s51 offen offset:3072 lds
    s_add_u32 s46, s46, 4
    s_and_b32 s46, s46, 31
    s_waitcnt vmcnt(16)
    s_barrier
    s_mul_i32 s50, s47, 18432
    s_add_u32 s50, s50, s36
    s_cmp_ge_u32 s20, 2
    s_cselect_b32 s52, s50, s53
    s_add_u32 m0, s31, 0
    s_add_u32 s52, s52, s49
    buffer_load_dwordx4 v1, s[4:7], s52 offen sc1 lds
    s_add_u32 m0, s30, 18432
    s_mov_b32 s53, s50
    buffer_load_dwordx4 v1, s[4:7], s50 offen offset:0 sc1 lds
    buffer_load_dwordx4 v1, s[4:7], s50 offen offset:1024 sc1 lds
    buffer_load_dwordx4 v1, s[4:7], s50 offen offset:2048 sc1 lds
    buffer_load_dwordx4 v1, s[4:7], s50 offen offset:3072 sc1 lds
    s_add_u32 m0, s30, 90112
    s_lshl_b32 s51, s47, 7
    buffer_load_dwordx4 v8, s[8:11], s51 offen offset:0 lds
    buffer_load_dwordx4 v9, s[8:11], s51 offen offset:1024 lds
    buffer_load_dwordx4 v10, s[8:11], s51 offen offset:2048 lds
    buffer_load_dwordx4 v11, s[8:11], s51 offen offset:3072 lds
    s_add_u32 s47, s47, 4
    s_and_b32 s47, s47, 31
    s_sub_u32 s41, s41, 1
    s_cmp_lg_u32 s41, 0
    s_cbranch_scc1 L_g_ll
    s_waitcnt vmcnt(17)
    s_barrier
    s_waitcnt vmcnt(8)
    s_barrier
    s_waitcnt vmcnt(0)
    s_barrier
L_end_p3:
    s_endpgm

.globl p5l0_kernel
.p2align 8
.type p5l0_kernel,@function
p5l0_kernel:
    s_mov_b32 s22, 0
L_go_p5:
    s_cmp_ge_u32 s2, 256
    s_cbranch_scc1 L_end_p5
    s_load_dwordx2 s[24:25], s[0:1], 80
    s_load_dwordx4 s[28:31], s[0:1], 40
    s_load_dwordx2 s[26:27], s[0:1], 64
    v_lshrrev_b32 v2, 6, v0
    v_and_b32 v1, 63, v0
    v_lshlrev_b32 v1, 4, v1
    v_readfirstlane_b32 s23, v2
    v_mov_b32 v2, 163832
    v_mov_b32 v3, 0
    ds_write_b32 v2, v3
    s_mul_i32 s21, s22, 0x2800000
    s_and_b32 s20, s23, 3
    s_waitcnt lgkmcnt(0)
    s_mov_b32 s4, s24
    s_mov_b32 s5, s25
    s_mov_b32 s6, 0x10000000
    s_mov_b32 s7, 0x20000
    s_mov_b32 s8, s28
    s_mov_b32 s9, s29
    s_mov_b32 s10, 0x800000
    s_mov_b32 s11, 0x20000
    s_mov_b32 s12, s30
    s_mov_b32 s13, s31
    s_mov_b32 s14, 0x1000
    s_mov_b32 s15, 0x20000
    s_mov_b32 s16, s26
    s_mov_b32 s17, s27
    s_mov_b32 s18, 0x240000
    s_mov_b32 s19, 0x20000
    s_cmp_ge_u32 s23, 4
    s_cbranch_scc1 L_ld_p5
    s_and_b32 s25, s2, 7
    s_lshr_b32 s26, s2, 3
    s_lshl_b32 s23, s25, 2
    s_lshr_b32 s27, s26, 3
    s_add_u32 s23, s23, s27
    s_and_b32 s24, s26, 7
    s_add_u32 s28, s23, s24
    s_and_b32 s28, s28, 3
    s_lshl_b32 s30, s23, 2
    s_add_u32 s30, s30, s20
    s_mul_i32 s29, s30, 73728
    s_add_u32 s29, s29, s21
    s_add_u32 s29, s29, 0x1b00000
    s_mul_i32 s34, s30, 18432
    s_add_u32 s34, s34, s21
    s_add_u32 s34, s34, 0x300000
    s_lshl_b32 s35, s24, 11
    s_lshr_b32 s36, s24, 2
    s_lshl_b32 s36, s36, 10
    s_and_b32 s37, s24, 3
    s_lshl_b32 s37, s37, 8
    s_add_u32 s36, s36, s37
    s_add_u32 s36, s36, 16384
    v_and_b32 v2, 15, v0
    v_bfe_u32 v3, v0, 4, 2
    v_add_u32 v4, s35, v1
    v_lshlrev_b32 v5, 4, v2
    v_lshl_add_u32 v5, v3, 3, v5
    v_add_u32 v5, s36, v5
    v_cmp_gt_u32 s[40:41], 2, v3
    v_bfrev_b32 v6, 1
    v_add_u32 v12, 0, v1
    v_add_u32 v13, 36864, v1
    v_add_u32 v14, 73728, v1
    v_add_u32 v15, 110592, v1
    v_cndmask_b32 v5, v6, v5, s[40:41]
    v_mov_b32 v16, 0
    v_mov_b32 v17, 0
    v_mov_b32 v18, 0
    v_mov_b32 v19, 0
    v_mov_b32 v20, 0
    v_mov_b32 v21, 0
    v_mov_b32 v22, 0
    v_mov_b32 v23, 0
    v_mov_b32 v24, 0
    v_mov_b32 v25, 0
    v_mov_b32 v26, 0
    v_mov_b32 v27, 0
    v_mov_b32 v28, 0
    v_mov_b32 v29, 0
    v_mov_b32 v30, 0
    v_mov_b32 v31, 0
    v_mov_b32 v32, 0
    v_mov_b32 v33, 0
    v_mov_b32 v34, 0
    v_mov_b32 v35, 0
    v_mov_b32 v36, 0
    v_mov_b32 v37, 0
    v_mov_b32 v38, 0
    v_mov_b32 v39, 0
    s_and_b32 s37, s20, 1
    v_lshrrev_b32 v7, 3, v2
    v_bfe_u32 v8, v2, 2, 1
    v_lshlrev_b32 v8, 3, v8
    v_and_b32 v9, 3, v2
    v_add_u32 v8, v8, v9
    s_lshl_b32 s37, s37, 2
    v_add_u32 v8, s37, v8
    s_cmp_eq_u32 s28, 0
    s_cselect_b32 s32, 4, 0
    s_lshl_b32 s32, s32, 13
    s_add_u32 s32, s32, s29
    s_add_u32 s33, s32, 4096
    buffer_load_dwordx4 v[112:115], v1, s[4:7], s32 offen offset:0
    buffer_load_dwordx4 v[116:119], v1, s[4:7], s32 offen offset:1024
    buffer_load_dwordx4 v[120:123], v1, s[4:7], s32 offen offset:2048
    buffer_load_dwordx4 v[124:127], v1, s[4:7], s32 offen offset:3072
    buffer_load_dwordx4 v[128:131], v1, s[4:7], s33 offen offset:0
    buffer_load_dwordx4 v[132:135], v1, s[4:7], s33 offen offset:1024
    buffer_load_dwordx4 v[136:139], v1, s[4:7], s33 offen offset:2048
    buffer_load_dwordx4 v[140:143], v1, s[4:7], s33 offen offset:3072
    s_cmp_eq_u32 s28, 1
    s_cselect_b32 s32, 5, 1
    s_lshl_b32 s32, s32, 13
    s_add_u32 s32, s32, s29
    s_add_u32 s33, s32, 4096
    buffer_load_dwordx4 v[144:147], v1, s[4:7], s32 offen offset:0
    buffer_load_dwordx4 v[148:151], v1, s[4:7], s32 offen offset:1024
    buffer_load_dwordx4 v[152:155], v1, s[4:7], s32 offen offset:2048
    buffer_load_dwordx4 v[156:159], v1, s[4:7], s32 offen offset:3072
    buffer_load_dwordx4 v[160:163], v1, s[4:7], s33 offen offset:0
    buffer_load_dwordx4 v[164:167], v1, s[4:7], s33 offen offset:1024
    buffer_load_dwordx4 v[168:171], v1, s[4:7], s33 offen offset:2048
    buffer_load_dwordx4 v[172:175], v1, s[4:7], s33 offen offset:3072
    s_barrier
    ds_read_b128 v[40:43], v12 offset:0
    ds_read_b128 v[44:47], v12 offset:1024
    ds_read_b128 v[48:51], v12 offset:2048
    ds_read_b128 v[52:55], v12 offset:3072
    ds_read_b128 v[72:75], v12 offset:8192
    ds_read_b128 v[56:59], v12 offset:4096
    ds_read_b128 v[60:63], v12 offset:5120
    ds_read_b128 v[64:67], v12 offset:6144
    ds_read_b128 v[68:71], v12 offset:7168
    s_waitcnt vmcnt(14) lgkmcnt(4)
    v_mfma_f32_16x16x32_bf16 v[16:19], v[40:43], v[112:115], v[16:19]
    ds_read_b128 v[76:79], v12 offset:9216
    s_cmp_eq_u32 s28, 2
    s_cselect_b32 s32, 6, 2
    s_lshl_b32 s32, s32, 13
    s_add_u32 s32, s32, s29
    s_add_u32 s33, s32, 4096
    v_mfma_f32_16x16x32_bf16 v[20:23], v[44:47], v[112:115], v[20:23]
    ds_read_b128 v[80:83], v12 offset:10240
    v_mfma_f32_16x16x32_bf16 v[24:27], v[48:51], v[112:115], v[24:27]
    ds_read_b128 v[84:87], v12 offset:11264
    buffer_load_dwordx4 v[176:179], v1, s[4:7], s32 offen offset:0
    v_mfma_f32_16x16x32_bf16 v[28:31], v[52:55], v[112:115], v[28:31]
    ds_read_b128 v[88:91], v12 offset:12288
    v_mfma_f32_16x16x32_bf16 v[32:35], v[72:75], v[112:115], v[32:35]
    ds_read_b128 v[108:111], v12 offset:17408
    s_waitcnt lgkmcnt(5)
    v_mfma_f32_16x16x32_bf16 v[16:19], v[56:59], v[116:119], v[16:19]
    ds_read_b128 v[92:95], v12 offset:13312
    v_mfma_f32_16x16x32_bf16 v[20:23], v[60:63], v[116:119], v[20:23]
    ds_read_b128 v[96:99], v12 offset:14336
    buffer_load_dwordx4 v[180:183], v1, s[4:7], s32 offen offset:1024
    v_mfma_f32_16x16x32_bf16 v[24:27], v[64:67], v[116:119], v[24:27]
    ds_read_b128 v[100:103], v12 offset:15360
    v_mfma_f32_16x16x32_bf16 v[28:31], v[68:71], v[116:119], v[28:31]
    ds_read_b128 v[104:107], v12 offset:16384
    v_mfma_f32_16x16x32_bf16 v[36:39], v[72:75], v[116:119], v[36:39]
    s_waitcnt vmcnt(14) lgkmcnt(4)
    v_mfma_f32_16x16x32_bf16 v[16:19], v[76:79], v[120:123], v[16:19]
    ds_read_b128 v[40:43], v12 offset:18432
    v_mfma_f32_16x16x32_bf16 v[20:23], v[80:83], v[120:123], v[20:23]
    ds_read_b128 v[44:47], v12 offset:19456
    v_mfma_f32_16x16x32_bf16 v[24:27], v[84:87], v[120:123], v[24:27]
    ds_read_b128 v[48:51], v12 offset:20480
    buffer_load_dwordx4 v[184:187], v1, s[4:7], s32 offen offset:2048
    v_mfma_f32_16x16x32_bf16 v[28:31], v[88:91], v[120:123], v[28:31]
    ds_read_b128 v[52:55], v12 offset:21504
    v_mfma_f32_16x16x32_bf16 v[32:35], v[108:111], v[120:123], v[32:35]
    ds_read_b128 v[72:75], v12 offset:26624
    s_waitcnt lgkmcnt(5)
    v_mfma_f32_16x16x32_bf16 v[16:19], v[92:95], v[124:127], v[16:19]
    ds_read_b128 v[56:59], v12 offset:22528
    v_mfma_f32_16x16x32_bf16 v[20:23], v[96:99], v[124:127], v[20:23]
    ds_read_b128 v[60:63], v12 offset:23552
    buffer_load_dwordx4 v[188:191], v1, s[4:7], s32 offen offset:3072
    v_mfma_f32_16x16x32_bf16 v[24:27], v[100:103], v[124:127], v[24:27]
    ds_read_b128 v[64:67], v12 offset:24576
    v_mfma_f32_16x16x32_bf16 v[28:31], v[104:107], v[124:127], v[28:31]
    ds_read_b128 v[68:71], v12 offset:25600
    v_mfma_f32_16x16x32_bf16 v[36:39], v[108:111], v[124:127], v[36:39]
    s_waitcnt vmcnt(14) lgkmcnt(4)
    v_mfma_f32_16x16x32_bf16 v[16:19], v[40:43], v[128:131], v[16:19]
    ds_read_b128 v[76:79], v12 offset:27648
    v_mfma_f32_16x16x32_bf16 v[20:23], v[44:47], v[128:131], v[20:23]
    ds_read_b128 v[80:83], v12 offset:28672
    v_mfma_f32_16x16x32_bf16 v[24:27], v[48:51], v[128:131], v[24:27]
    ds_read_b128 v[84:87], v12 offset:29696
    buffer_load_dwordx4 v[192:195], v1, s[4:7], s33 offen offset:0
    v_mfma_f32_16x16x32_bf16 v[28:31], v[52:55], v[128:131], v[28:31]
    ds_read_b128 v[88:91], v12 offset:30720
    v_mfma_f32_16x16x32_bf16 v[32:35], v[72:75], v[128:131], v[32:35]
    ds_read_b128 v[108:111], v12 offset:35840
    s_waitcnt lgkmcnt(5)
    v_mfma_f32_16x16x32_bf16 v[16:19], v[56:59], v[132:135], v[16:19]
    ds_read_b128 v[92:95], v12 offset:31744
    v_mfma_f32_16x16x32_bf16 v[20:23], v[60:63], v[132:135], v[20:23]
    ds_read_b128 v[96:99], v12 offset:32768
    buffer_load_dwordx4 v[196:199], v1, s[4:7], s33 offen offset:1024
    v_mfma_f32_16x16x32_bf16 v[24:27], v[64:67], v[132:135], v[24:27]
    ds_read_b128 v[100:103], v12 offset:33792
    v_mfma_f32_16x16x32_bf16 v[28:31], v[68:71], v[132:135], v[28:31]
    ds_read_b128 v[104:107], v12 offset:34816
    v_mfma_f32_16x16x32_bf16 v[36:39], v[72:75], v[132:135], v[36:39]
    s_waitcnt vmcnt(14) lgkmcnt(0)
    s_barrier
    v_mfma_f32_16x16x32_bf16 v[16:19], v[76:79], v[136:139], v[16:19]
    ds_read_b128 v[40:43], v13 offset:0
    v_mfma_f32_16x16x32_bf16 v[20:23], v[80:83], v[136:139], v[20:23]
    ds_read_b128 v[44:47], v13 offset:1024
    v_mfma_f32_16x16x32_bf16 v[24:27], v[84:87], v[136:139], v[24:27]
    ds_read_b128 v[48:51], v13 offset:2048
    buffer_load_dwordx4 v[200:203], v1, s[4:7], s33 offen offset:2048
    v_mfma_f32_16x16x32_bf16 v[28:31], v[88:91], v[136:139], v[28:31]
    ds_read_b128 v[52:55], v13 offset:3072
    v_mfma_f32_16x16x32_bf16 v[32:35], v[108:111], v[136:139], v[32:35]
    ds_read_b128 v[72:75], v13 offset:8192
    v_mfma_f32_16x16x32_bf16 v[16:19], v[92:95], v[140:143], v[16:19]
    ds_read_b128 v[56:59], v13 offset:4096
    v_mfma_f32_16x16x32_bf16 v[20:23], v[96:99], v[140:143], v[20:23]
    ds_read_b128 v[60:63], v13 offset:5120
    buffer_load_dwordx4 v[204:207], v1, s[4:7], s33 offen offset:3072
    v_mfma_f32_16x16x32_bf16 v[24:27], v[100:103], v[140:143], v[24:27]
    ds_read_b128 v[64:67], v13 offset:6144
    v_mfma_f32_16x16x32_bf16 v[28:31], v[104:107], v[140:143], v[28:31]
    ds_read_b128 v[68:71], v13 offset:7168
    v_mfma_f32_16x16x32_bf16 v[36:39], v[108:111], v[140:143], v[36:39]
    s_waitcnt vmcnt(14) lgkmcnt(4)
    v_mfma_f32_16x16x32_bf16 v[16:19], v[40:43], v[144:147], v[16:19]
    ds_read_b128 v[76:79], v13 offset:9216
    s_cmp_eq_u32 s28, 3
    s_cselect_b32 s32, 7, 3
    s_lshl_b32 s32, s32, 13
    s_add_u32 s32, s32, s29
    s_add_u32 s33, s32, 4096
    v_mfma_f32_16x16x32_bf16 v[20:23], v[44:47], v[144:147], v[20:23]
    ds_read_b128 v[80:83], v13 offset:10240
    v_mfma_f32_16x16x32_bf16 v[24:27], v[48:51], v[144:147], v[24:27]
    ds_read_b128 v[84:87], v13 offset:11264
    buffer_load_dwordx4 v[112:115], v1, s[4:7], s32 offen offset:0
    v_mfma_f32_16x16x32_bf16 v[28:31], v[52:55], v[144:147], v[28:31]
    ds_read_b128 v[88:91], v13 offset:12288
    v_mfma_f32_16x16x32_bf16 v[32:35], v[72:75], v[144:147], v[32:35]
    ds_read_b128 v[108:111], v13 offset:17408
    s_waitcnt lgkmcnt(5)
    v_mfma_f32_16x16x32_bf16 v[16:19], v[56:59], v[148:151], v[16:19]
    ds_read_b128 v[92:95], v13 offset:13312
    v_mfma_f32_16x16x32_bf16 v[20:23], v[60:63], v[148:151], v[20:23]
    ds_read_b128 v[96:99], v13 offset:14336
    buffer_load_dwordx4 v[116:119], v1, s[4:7], s32 offen offset:1024
    v_mfma_f32_16x16x32_bf16 v[24:27], v[64:67], v[148:151], v[24:27]
    ds_read_b128 v[100:103], v13 offset:15360
    v_mfma_f32_16x16x32_bf16 v[28:31], v[68:71], v[148:151], v[28:31]
    ds_read_b128 v[104:107], v13 offset:16384
    v_mfma_f32_16x16x32_bf16 v[36:39], v[72:75], v[148:151], v[36:39]
    s_waitcnt vmcnt(14) lgkmcnt(4)
    v_mfma_f32_16x16x32_bf16 v[16:19], v[76:79], v[152:155], v[16:19]
    ds_read_b128 v[40:43], v13 offset:18432
    v_mfma_f32_16x16x32_bf16 v[20:23], v[80:83], v[152:155], v[20:23]
    ds_read_b128 v[44:47], v13 offset:19456
    v_mfma_f32_16x16x32_bf16 v[24:27], v[84:87], v[152:155], v[24:27]
    ds_read_b128 v[48:51], v13 offset:20480
    buffer_load_dwordx4 v[120:123], v1, s[4:7], s32 offen offset:2048
    v_mfma_f32_16x16x32_bf16 v[28:31], v[88:91], v[152:155], v[28:31]
    ds_read_b128 v[52:55], v13 offset:21504
    v_mfma_f32_16x16x32_bf16 v[32:35], v[108:111], v[152:155], v[32:35]
    ds_read_b128 v[72:75], v13 offset:26624
    s_waitcnt lgkmcnt(5)
    v_mfma_f32_16x16x32_bf16 v[16:19], v[92:95], v[156:159], v[16:19]
    ds_read_b128 v[56:59], v13 offset:22528
    v_mfma_f32_16x16x32_bf16 v[20:23], v[96:99], v[156:159], v[20:23]
    ds_read_b128 v[60:63], v13 offset:23552
    buffer_load_dwordx4 v[124:127], v1, s[4:7], s32 offen offset:3072
    v_mfma_f32_16x16x32_bf16 v[24:27], v[100:103], v[156:159], v[24:27]
    ds_read_b128 v[64:67], v13 offset:24576
    v_mfma_f32_16x16x32_bf16 v[28:31], v[104:107], v[156:159], v[28:31]
    ds_read_b128 v[68:71], v13 offset:25600
    v_mfma_f32_16x16x32_bf16 v[36:39], v[108:111], v[156:159], v[36:39]
    s_waitcnt vmcnt(14) lgkmcnt(4)
    v_mfma_f32_16x16x32_bf16 v[16:19], v[40:43], v[160:163], v[16:19]
    ds_read_b128 v[76:79], v13 offset:27648
    v_mfma_f32_16x16x32_bf16 v[20:23], v[44:47], v[160:163], v[20:23]
    ds_read_b128 v[80:83], v13 offset:28672
    v_mfma_f32_16x16x32_bf16 v[24:27], v[48:51], v[160:163], v[24:27]
    ds_read_b128 v[84:87], v13 offset:29696
    buffer_load_dwordx4 v[128:131], v1, s[4:7], s33 offen offset:0
    v_mfma_f32_16x16x32_bf16 v[28:31], v[52:55], v[160:163], v[28:31]
    ds_read_b128 v[88:91], v13 offset:30720
    v_mfma_f32_16x16x32_bf16 v[32:35], v[72:75], v[160:163], v[32:35]
    ds_read_b128 v[108:111], v13 offset:35840
    s_waitcnt lgkmcnt(5)
    v_mfma_f32_16x16x32_bf16 v[16:19], v[56:59], v[164:167], v[16:19]
    ds_read_b128 v[92:95], v13 offset:31744
    v_mfma_f32_16x16x32_bf16 v[20:23], v[60:63], v[164:167], v[20:23]
    ds_read_b128 v[96:99], v13 offset:32768
    buffer_load_dwordx4 v[132:135], v1, s[4:7], s33 offen offset:1024
    v_mfma_f32_16x16x32_bf16 v[24:27], v[64:67], v[164:167], v[24:27]
    ds_read_b128 v[100:103], v13 offset:33792
    v_mfma_f32_16x16x32_bf16 v[28:31], v[68:71], v[164:167], v[28:31]
    ds_read_b128 v[104:107], v13 offset:34816
    v_mfma_f32_16x16x32_bf16 v[36:39], v[72:75], v[164:167], v[36:39]
    s_waitcnt vmcnt(14) lgkmcnt(0)
    s_barrier
    v_mfma_f32_16x16x32_bf16 v[16:19], v[76:79], v[168:171], v[16:19]
    ds_read_b128 v[40:43], v14 offset:0
    v_mfma_f32_16x16x32_bf16 v[20:23], v[80:83], v[168:171], v[20:23]
    ds_read_b128 v[44:47], v14 offset:1024
    v_mfma_f32_16x16x32_bf16 v[24:27], v[84:87], v[168:171], v[24:27]
    ds_read_b128 v[48:51], v14 offset:2048
    buffer_load_dwordx4 v[136:139], v1, s[4:7], s33 offen offset:2048
    v_mfma_f32_16x16x32_bf16 v[28:31], v[88:91], v[168:171], v[28:31]
    ds_read_b128 v[52:55], v14 offset:3072
    v_mfma_f32_16x16x32_bf16 v[32:35], v[108:111], v[168:171], v[32:35]
    ds_read_b128 v[72:75], v14 offset:8192
    v_mfma_f32_16x16x32_bf16 v[16:19], v[92:95], v[172:175], v[16:19]
    ds_read_b128 v[56:59], v14 offset:4096
    v_mfma_f32_16x16x32_bf16 v[20:23], v[96:99], v[172:175], v[20:23]
    ds_read_b128 v[60:63], v14 offset:5120
    buffer_load_dwordx4 v[140:143], v1, s[4:7], s33 offen offset:3072
    v_mfma_f32_16x16x32_bf16 v[24:27], v[100:103], v[172:175], v[24:27]
    ds_read_b128 v[64:67], v14 offset:6144
    v_mfma_f32_16x16x32_bf16 v[28:31], v[104:107], v[172:175], v[28:31]
    ds_read_b128 v[68:71], v14 offset:7168
    v_mfma_f32_16x16x32_bf16 v[36:39], v[108:111], v[172:175], v[36:39]
    s_waitcnt vmcnt(14) lgkmcnt(4)
    v_mfma_f32_16x16x32_bf16 v[16:19], v[40:43], v[176:179], v[16:19]
    ds_read_b128 v[76:79], v14 offset:9216
    s_cmp_eq_u32 s28, 0
    s_cselect_b32 s32, 8, 4
    s_lshl_b32 s32, s32, 13
    s_add_u32 s32, s32, s29
    s_add_u32 s33, s32, 4096
    v_mfma_f32_16x16x32_bf16 v[20:23], v[44:47], v[176:179], v[20:23]
    ds_read_b128 v[80:83], v14 offset:10240
    v_mfma_f32_16x16x32_bf16 v[24:27], v[48:51], v[176:179], v[24:27]
    ds_read_b128 v[84:87], v14 offset:11264
    buffer_load_dwordx4 v[144:147], v1, s[4:7], s32 offen offset:0
    v_mfma_f32_16x16x32_bf16 v[28:31], v[52:55], v[176:179], v[28:31]
    ds_read_b128 v[88:91], v14 offset:12288
    v_mfma_f32_16x16x32_bf16 v[32:35], v[72:75], v[176:179], v[32:35]
    ds_read_b128 v[108:111], v14 offset:17408
    s_waitcnt lgkmcnt(5)
    v_mfma_f32_16x16x32_bf16 v[16:19], v[56:59], v[180:183], v[16:19]
    ds_read_b128 v[92:95], v14 offset:13312
    v_mfma_f32_16x16x32_bf16 v[20:23], v[60:63], v[180:183], v[20:23]
    ds_read_b128 v[96:99], v14 offset:14336
    buffer_load_dwordx4 v[148:151], v1, s[4:7], s32 offen offset:1024
    v_mfma_f32_16x16x32_bf16 v[24:27], v[64:67], v[180:183], v[24:27]
    ds_read_b128 v[100:103], v14 offset:15360
    v_mfma_f32_16x16x32_bf16 v[28:31], v[68:71], v[180:183], v[28:31]
    ds_read_b128 v[104:107], v14 offset:16384
    v_mfma_f32_16x16x32_bf16 v[36:39], v[72:75], v[180:183], v[36:39]
    s_waitcnt vmcnt(14) lgkmcnt(4)
    v_mfma_f32_16x16x32_bf16 v[16:19], v[76:79], v[184:187], v[16:19]
    ds_read_b128 v[40:43], v14 offset:18432
    v_mfma_f32_16x16x32_bf16 v[20:23], v[80:83], v[184:187], v[20:23]
    ds_read_b128 v[44:47], v14 offset:19456
    v_mfma_f32_16x16x32_bf16 v[24:27], v[84:87], v[184:187], v[24:27]
    ds_read_b128 v[48:51], v14 offset:20480
    buffer_load_dwordx4 v[152:155], v1, s[4:7], s32 offen offset:2048
    v_mfma_f32_16x16x32_bf16 v[28:31], v[88:91], v[184:187], v[28:31]
    ds_read_b128 v[52:55], v14 offset:21504
    v_mfma_f32_16x16x32_bf16 v[32:35], v[108:111], v[184:187], v[32:35]
    ds_read_b128 v[72:75], v14 offset:26624
    s_waitcnt lgkmcnt(5)
    v_mfma_f32_16x16x32_bf16 v[16:19], v[92:95], v[188:191], v[16:19]
    ds_read_b128 v[56:59], v14 offset:22528
    v_mfma_f32_16x16x32_bf16 v[20:23], v[96:99], v[188:191], v[20:23]
    ds_read_b128 v[60:63], v14 offset:23552
    buffer_load_dwordx4 v[156:159], v1, s[4:7], s32 offen offset:3072
    v_mfma_f32_16x16x32_bf16 v[24:27], v[100:103], v[188:191], v[24:27]
    ds_read_b128 v[64:67], v14 offset:24576
    v_mfma_f32_16x16x32_bf16 v[28:31], v[104:107], v[188:191], v[28:31]
    ds_read_b128 v[68:71], v14 offset:25600
    v_mfma_f32_16x16x32_bf16 v[36:39], v[108:111], v[188:191], v[36:39]
    s_waitcnt vmcnt(14) lgkmcnt(4)
    v_mfma_f32_16x16x32_bf16 v[16:19], v[40:43], v[192:195], v[16:19]
    ds_read_b128 v[76:79], v14 offset:27648
    v_mfma_f32_16x16x32_bf16 v[20:23], v[44:47], v[192:195], v[20:23]
    ds_read_b128 v[80:83], v14 offset:28672
    v_mfma_f32_16x16x32_bf16 v[24:27], v[48:51], v[192:195], v[24:27]
    ds_read_b128 v[84:87], v14 offset:29696
    buffer_load_dwordx4 v[160:163], v1, s[4:7], s33 offen offset:0
    v_mfma_f32_16x16x32_bf16 v[28:31], v[52:55], v[192:195], v[28:31]
    ds_read_b128 v[88:91], v14 offset:30720
    v_mfma_f32_16x16x32_bf16 v[32:35], v[72:75], v[192:195], v[32:35]
    ds_read_b128 v[108:111], v14 offset:35840
    s_waitcnt lgkmcnt(5)
    v_mfma_f32_16x16x32_bf16 v[16:19], v[56:59], v[196:199], v[16:19]
    ds_read_b128 v[92:95], v14 offset:31744
    v_mfma_f32_16x16x32_bf16 v[20:23], v[60:63], v[196:199], v[20:23]
    ds_read_b128 v[96:99], v14 offset:32768
    buffer_load_dwordx4 v[164:167], v1, s[4:7], s33 offen offset:1024
    v_mfma_f32_16x16x32_bf16 v[24:27], v[64:67], v[196:199], v[24:27]
    ds_read_b128 v[100:103], v14 offset:33792
    v_mfma_f32_16x16x32_bf16 v[28:31], v[68:71], v[196:199], v[28:31]
    ds_read_b128 v[104:107], v14 offset:34816
    v_mfma_f32_16x16x32_bf16 v[36:39], v[72:75], v[196:199], v[36:39]
    s_waitcnt vmcnt(14) lgkmcnt(0)
    s_barrier
    v_mfma_f32_16x16x32_bf16 v[16:19], v[76:79], v[200:203], v[16:19]
    ds_read_b128 v[40:43], v15 offset:0
    v_mfma_f32_16x16x32_bf16 v[20:23], v[80:83], v[200:203], v[20:23]
    ds_read_b128 v[44:47], v15 offset:1024
    v_mfma_f32_16x16x32_bf16 v[24:27], v[84:87], v[200:203], v[24:27]
    ds_read_b128 v[48:51], v15 offset:2048
    buffer_load_dwordx4 v[168:171], v1, s[4:7], s33 offen offset:2048
    v_mfma_f32_16x16x32_bf16 v[28:31], v[88:91], v[200:203], v[28:31]
    ds_read_b128 v[52:55], v15 offset:3072
    v_mfma_f32_16x16x32_bf16 v[32:35], v[108:111], v[200:203], v[32:35]
    ds_read_b128 v[72:75], v15 offset:8192
    v_mfma_f32_16x16x32_bf16 v[16:19], v[92:95], v[204:207], v[16:19]
    ds_read_b128 v[56:59], v15 offset:4096
    v_mfma_f32_16x16x32_bf16 v[20:23], v[96:99], v[204:207], v[20:23]
    ds_read_b128 v[60:63], v15 offset:5120
    buffer_load_dwordx4 v[172:175], v1, s[4:7], s33 offen offset:3072
    v_mfma_f32_16x16x32_bf16 v[24:27], v[100:103], v[204:207], v[24:27]
    ds_read_b128 v[64:67], v15 offset:6144
    v_mfma_f32_16x16x32_bf16 v[28:31], v[104:107], v[204:207], v[28:31]
    ds_read_b128 v[68:71], v15 offset:7168
    v_mfma_f32_16x16x32_bf16 v[36:39], v[108:111], v[204:207], v[36:39]
    s_waitcnt vmcnt(14) lgkmcnt(4)
    v_mfma_f32_16x16x32_bf16 v[16:19], v[40:43], v[112:115], v[16:19]
    ds_read_b128 v[76:79], v15 offset:9216
    s_cmp_eq_u32 s28, 1
    s_cselect_b32 s32, 1, 5
    s_lshl_b32 s32, s32, 13
    s_add_u32 s32, s32, s29
    s_add_u32 s33, s32, 4096
    v_mfma_f32_16x16x32_bf16 v[20:23], v[44:47], v[112:115], v[20:23]
    ds_read_b128 v[80:83], v15 offset:10240
    v_mfma_f32_16x16x32_bf16 v[24:27], v[48:51], v[112:115], v[24:27]
    ds_read_b128 v[84:87], v15 offset:11264
    buffer_load_dwordx4 v[176:179], v1, s[4:7], s32 offen offset:0
    v_mfma_f32_16x16x32_bf16 v[28:31], v[52:55], v[112:115], v[28:31]
    ds_read_b128 v[88:91], v15 offset:12288
    v_mfma_f32_16x16x32_bf16 v[32:35], v[72:75], v[112:115], v[32:35]
    ds_read_b128 v[108:111], v15 offset:17408
    s_waitcnt lgkmcnt(5)
    v_mfma_f32_16x16x32_bf16 v[16:19], v[56:59], v[116:119], v[16:19]
    ds_read_b128 v[92:95], v15 offset:13312
    v_mfma_f32_16x16x32_bf16 v[20:23], v[60:63], v[116:119], v[20:23]
    ds_read_b128 v[96:99], v15 offset:14336
    buffer_load_dwordx4 v[180:183], v1, s[4:7], s32 offen offset:1024
    v_mfma_f32_16x16x32_bf16 v[24:27], v[64:67], v[116:119], v[24:27]
    ds_read_b128 v[100:103], v15 offset:15360
    v_mfma_f32_16x16x32_bf16 v[28:31], v[68:71], v[116:119], v[28:31]
    ds_read_b128 v[104:107], v15 offset:16384
    v_mfma_f32_16x16x32_bf16 v[36:39], v[72:75], v[116:119], v[36:39]
    s_waitcnt vmcnt(14) lgkmcnt(4)
    v_mfma_f32_16x16x32_bf16 v[16:19], v[76:79], v[120:123], v[16:19]
    ds_read_b128 v[40:43], v15 offset:18432
    v_mfma_f32_16x16x32_bf16 v[20:23], v[80:83], v[120:123], v[20:23]
    ds_read_b128 v[44:47], v15 offset:19456
    v_mfma_f32_16x16x32_bf16 v[24:27], v[84:87], v[120:123], v[24:27]
    ds_read_b128 v[48:51], v15 offset:20480
    buffer_load_dwordx4 v[184:187], v1, s[4:7], s32 offen offset:2048
    v_mfma_f32_16x16x32_bf16 v[28:31], v[88:91], v[120:123], v[28:31]
    ds_read_b128 v[52:55], v15 offset:21504
    v_mfma_f32_16x16x32_bf16 v[32:35], v[108:111], v[120:123], v[32:35]
    ds_read_b128 v[72:75], v15 offset:26624
    s_waitcnt lgkmcnt(5)
    v_mfma_f32_16x16x32_bf16 v[16:19], v[92:95], v[124:127], v[16:19]
    ds_read_b128 v[56:59], v15 offset:22528
    v_mfma_f32_16x16x32_bf16 v[20:23], v[96:99], v[124:127], v[20:23]
    ds_read_b128 v[60:63], v15 offset:23552
    buffer_load_dwordx4 v[188:191], v1, s[4:7], s32 offen offset:3072
    v_mfma_f32_16x16x32_bf16 v[24:27], v[100:103], v[124:127], v[24:27]
    ds_read_b128 v[64:67], v15 offset:24576
    v_mfma_f32_16x16x32_bf16 v[28:31], v[104:107], v[124:127], v[28:31]
    ds_read_b128 v[68:71], v15 offset:25600
    v_mfma_f32_16x16x32_bf16 v[36:39], v[108:111], v[124:127], v[36:39]
    s_waitcnt vmcnt(14) lgkmcnt(4)
    v_mfma_f32_16x16x32_bf16 v[16:19], v[40:43], v[128:131], v[16:19]
    ds_read_b128 v[76:79], v15 offset:27648
    v_mfma_f32_16x16x32_bf16 v[20:23], v[44:47], v[128:131], v[20:23]
    ds_read_b128 v[80:83], v15 offset:28672
    v_mfma_f32_16x16x32_bf16 v[24:27], v[48:51], v[128:131], v[24:27]
    ds_read_b128 v[84:87], v15 offset:29696
    buffer_load_dwordx4 v[192:195], v1, s[4:7], s33 offen offset:0
    v_mfma_f32_16x16x32_bf16 v[28:31], v[52:55], v[128:131], v[28:31]
    ds_read_b128 v[88:91], v15 offset:30720
    v_mfma_f32_16x16x32_bf16 v[32:35], v[72:75], v[128:131], v[32:35]
    ds_read_b128 v[108:111], v15 offset:35840
    s_waitcnt lgkmcnt(5)
    v_mfma_f32_16x16x32_bf16 v[16:19], v[56:59], v[132:135], v[16:19]
    ds_read_b128 v[92:95], v15 offset:31744
    v_mfma_f32_16x16x32_bf16 v[20:23], v[60:63], v[132:135], v[20:23]
    ds_read_b128 v[96:99], v15 offset:32768
    buffer_load_dwordx4 v[196:199], v1, s[4:7], s33 offen offset:1024
    v_mfma_f32_16x16x32_bf16 v[24:27], v[64:67], v[132:135], v[24:27]
    ds_read_b128 v[100:103], v15 offset:33792
    v_mfma_f32_16x16x32_bf16 v[28:31], v[68:71], v[132:135], v[28:31]
    ds_read_b128 v[104:107], v15 offset:34816
    v_mfma_f32_16x16x32_bf16 v[36:39], v[72:75], v[132:135], v[36:39]
    s_waitcnt vmcnt(14) lgkmcnt(0)
    s_barrier
    v_mfma_f32_16x16x32_bf16 v[16:19], v[76:79], v[136:139], v[16:19]
    ds_read_b128 v[40:43], v12 offset:0
    v_mfma_f32_16x16x32_bf16 v[20:23], v[80:83], v[136:139], v[20:23]
    ds_read_b128 v[44:47], v12 offset:1024
    v_mfma_f32_16x16x32_bf16 v[24:27], v[84:87], v[136:139], v[24:27]
    ds_read_b128 v[48:51], v12 offset:2048
    buffer_load_dwordx4 v[200:203], v1, s[4:7], s33 offen offset:2048
    v_mfma_f32_16x16x32_bf16 v[28:31], v[88:91], v[136:139], v[28:31]
    ds_read_b128 v[52:55], v12 offset:3072
    v_mfma_f32_16x16x32_bf16 v[32:35], v[108:111], v[136:139], v[32:35]
    ds_read_b128 v[72:75], v12 offset:8192
    v_mfma_f32_16x16x32_bf16 v[16:19], v[92:95], v[140:143], v[16:19]
    ds_read_b128 v[56:59], v12 offset:4096
    v_mfma_f32_16x16x32_bf16 v[20:23], v[96:99], v[140:143], v[20:23]
    ds_read_b128 v[60:63], v12 offset:5120
    buffer_load_dwordx4 v[204:207], v1, s[4:7], s33 offen offset:3072
    v_mfma_f32_16x16x32_bf16 v[24:27], v[100:103], v[140:143], v[24:27]
    ds_read_b128 v[64:67], v12 offset:6144
    v_mfma_f32_16x16x32_bf16 v[28:31], v[104:107], v[140:143], v[28:31]
    ds_read_b128 v[68:71], v12 offset:7168
    v_mfma_f32_16x16x32_bf16 v[36:39], v[108:111], v[140:143], v[36:39]
    s_waitcnt vmcnt(14) lgkmcnt(4)
    v_mfma_f32_16x16x32_bf16 v[16:19], v[40:43], v[144:147], v[16:19]
    ds_read_b128 v[76:79], v12 offset:9216
    s_cmp_eq_u32 s28, 2
    s_cselect_b32 s32, 2, 6
    s_lshl_b32 s32, s32, 13
    s_add_u32 s32, s32, s29
    s_add_u32 s33, s32, 4096
    v_mfma_f32_16x16x32_bf16 v[20:23], v[44:47], v[144:147], v[20:23]
    ds_read_b128 v[80:83], v12 offset:10240
    v_mfma_f32_16x16x32_bf16 v[24:27], v[48:51], v[144:147], v[24:27]
    ds_read_b128 v[84:87], v12 offset:11264
    buffer_load_dwordx4 v[112:115], v1, s[4:7], s32 offen offset:0
    v_mfma_f32_16x16x32_bf16 v[28:31], v[52:55], v[144:147], v[28:31]
    ds_read_b128 v[88:91], v12 offset:12288
    v_mfma_f32_16x16x32_bf16 v[32:35], v[72:75], v[144:147], v[32:35]
    ds_read_b128 v[108:111], v12 offset:17408
    s_waitcnt lgkmcnt(5)
    v_mfma_f32_16x16x32_bf16 v[16:19], v[56:59], v[148:151], v[16:19]
    ds_read_b128 v[92:95], v12 offset:13312
    v_mfma_f32_16x16x32_bf16 v[20:23], v[60:63], v[148:151], v[20:23]
    ds_read_b128 v[96:99], v12 offset:14336
    buffer_load_dwordx4 v[116:119], v1, s[4:7], s32 offen offset:1024
    v_mfma_f32_16x16x32_bf16 v[24:27], v[64:67], v[148:151], v[24:27]
    ds_read_b128 v[100:103], v12 offset:15360
    v_mfma_f32_16x16x32_bf16 v[28:31], v[68:71], v[148:151], v[28:31]
    ds_read_b128 v[104:107], v12 offset:16384
    v_mfma_f32_16x16x32_bf16 v[36:39], v[72:75], v[148:151], v[36:39]
    s_waitcnt vmcnt(14) lgkmcnt(4)
    v_mfma_f32_16x16x32_bf16 v[16:19], v[76:79], v[152:155], v[16:19]
    ds_read_b128 v[40:43], v12 offset:18432
    v_mfma_f32_16x16x32_bf16 v[20:23], v[80:83], v[152:155], v[20:23]
    ds_read_b128 v[44:47], v12 offset:19456
    v_mfma_f32_16x16x32_bf16 v[24:27], v[84:87], v[152:155], v[24:27]
    ds_read_b128 v[48:51], v12 offset:20480
    buffer_load_dwordx4 v[120:123], v1, s[4:7], s32 offen offset:2048
    v_mfma_f32_16x16x32_bf16 v[28:31], v[88:91], v[152:155], v[28:31]
    ds_read_b128 v[52:55], v12 offset:21504
    v_mfma_f32_16x16x32_bf16 v[32:35], v[108:111], v[152:155], v[32:35]
    ds_read_b128 v[72:75], v12 offset:26624
    s_waitcnt lgkmcnt(5)
    v_mfma_f32_16x16x32_bf16 v[16:19], v[92:95], v[156:159], v[16:19]
    ds_read_b128 v[56:59], v12 offset:22528
    v_mfma_f32_16x16x32_bf16 v[20:23], v[96:99], v[156:159], v[20:23]
    ds_read_b128 v[60:63], v12 offset:23552
    buffer_load_dwordx4 v[124:127], v1, s[4:7], s32 offen offset:3072
    v_mfma_f32_16x16x32_bf16 v[24:27], v[100:103], v[156:159], v[24:27]
    ds_read_b128 v[64:67], v12 offset:24576
    v_mfma_f32_16x16x32_bf16 v[28:31], v[104:107], v[156:159], v[28:31]
    ds_read_b128 v[68:71], v12 offset:25600
    v_mfma_f32_16x16x32_bf16 v[36:39], v[108:111], v[156:159], v[36:39]
    s_waitcnt vmcnt(14) lgkmcnt(4)
    v_mfma_f32_16x16x32_bf16 v[16:19], v[40:43], v[160:163], v[16:19]
    ds_read_b128 v[76:79], v12 offset:27648
    v_mfma_f32_16x16x32_bf16 v[20:23], v[44:47], v[160:163], v[20:23]
    ds_read_b128 v[80:83], v12 offset:28672
    v_mfma_f32_16x16x32_bf16 v[24:27], v[48:51], v[160:163], v[24:27]
    ds_read_b128 v[84:87], v12 offset:29696
    buffer_load_dwordx4 v[128:131], v1, s[4:7], s33 offen offset:0
    v_mfma_f32_16x16x32_bf16 v[28:31], v[52:55], v[160:163], v[28:31]
    ds_read_b128 v[88:91], v12 offset:30720
    v_mfma_f32_16x16x32_bf16 v[32:35], v[72:75], v[160:163], v[32:35]
    ds_read_b128 v[108:111], v12 offset:35840
    s_waitcnt lgkmcnt(5)
    v_mfma_f32_16x16x32_bf16 v[16:19], v[56:59], v[164:167], v[16:19]
    ds_read_b128 v[92:95], v12 offset:31744
    v_mfma_f32_16x16x32_bf16 v[20:23], v[60:63], v[164:167], v[20:23]
    ds_read_b128 v[96:99], v12 offset:32768
    buffer_load_dwordx4 v[132:135], v1, s[4:7], s33 offen offset:1024
    v_mfma_f32_16x16x32_bf16 v[24:27], v[64:67], v[164:167], v[24:27]
    ds_read_b128 v[100:103], v12 offset:33792
    v_mfma_f32_16x16x32_bf16 v[28:31], v[68:71], v[164:167], v[28:31]
    ds_read_b128 v[104:107], v12 offset:34816
    v_mfma_f32_16x16x32_bf16 v[36:39], v[72:75], v[164:167], v[36:39]
    s_waitcnt vmcnt(14) lgkmcnt(0)
    s_barrier
    v_mfma_f32_16x16x32_bf16 v[16:19], v[76:79], v[168:171], v[16:19]
    ds_read_b128 v[40:43], v13 offset:0
    v_mfma_f32_16x16x32_bf16 v[20:23], v[80:83], v[168:171], v[20:23]
    ds_read_b128 v[44:47], v13 offset:1024
    v_mfma_f32_16x16x32_bf16 v[24:27], v[84:87], v[168:171], v[24:27]
    ds_read_b128 v[48:51], v13 offset:2048
    buffer_load_dwordx4 v[136:139], v1, s[4:7], s33 offen offset:2048
    v_mfma_f32_16x16x32_bf16 v[28:31], v[88:91], v[168:171], v[28:31]
    ds_read_b128 v[52:55], v13 offset:3072
    v_mfma_f32_16x16x32_bf16 v[32:35], v[108:111], v[168:171], v[32:35]
    ds_read_b128 v[72:75], v13 offset:8192
    v_mfma_f32_16x16x32_bf16 v[16:19], v[92:95], v[172:175], v[16:19]
    ds_read_b128 v[56:59], v13 offset:4096
    v_mfma_f32_16x16x32_bf16 v[20:23], v[96:99], v[172:175], v[20:23]
    ds_read_b128 v[60:63], v13 offset:5120
    buffer_load_dwordx4 v[140:143], v1, s[4:7], s33 offen offset:3072
    v_mfma_f32_16x16x32_bf16 v[24:27], v[100:103], v[172:175], v[24:27]
    ds_read_b128 v[64:67], v13 offset:6144
    v_mfma_f32_16x16x32_bf16 v[28:31], v[104:107], v[172:175], v[28:31]
    ds_read_b128 v[68:71], v13 offset:7168
    v_mfma_f32_16x16x32_bf16 v[36:39], v[108:111], v[172:175], v[36:39]
    s_waitcnt vmcnt(14) lgkmcnt(4)
    v_mfma_f32_16x16x32_bf16 v[16:19], v[40:43], v[176:179], v[16:19]
    ds_read_b128 v[76:79], v13 offset:9216
    s_cmp_eq_u32 s28, 3
    s_cselect_b32 s32, 3, 7
    s_lshl_b32 s32, s32, 13
    s_add_u32 s32, s32, s29
    s_add_u32 s33, s32, 4096
    v_mfma_f32_16x16x32_bf16 v[20:23], v[44:47], v[176:179], v[20:23]
    ds_read_b128 v[80:83], v13 offset:10240
    v_mfma_f32_16x16x32_bf16 v[24:27], v[48:51], v[176:179], v[24:27]
    ds_read_b128 v[84:87], v13 offset:11264
    buffer_load_dwordx4 v[144:147], v1, s[4:7], s32 offen offset:0
    v_mfma_f32_16x16x32_bf16 v[28:31], v[52:55], v[176:179], v[28:31]
    ds_read_b128 v[88:91], v13 offset:12288
    v_mfma_f32_16x16x32_bf16 v[32:35], v[72:75], v[176:179], v[32:35]
    ds_read_b128 v[108:111], v13 offset:17408
    s_waitcnt lgkmcnt(5)
    v_mfma_f32_16x16x32_bf16 v[16:19], v[56:59], v[180:183], v[16:19]
    ds_read_b128 v[92:95], v13 offset:13312
    v_mfma_f32_16x16x32_bf16 v[20:23], v[60:63], v[180:183], v[20:23]
    ds_read_b128 v[96:99], v13 offset:14336
    buffer_load_dwordx4 v[148:151], v1, s[4:7], s32 offen offset:1024
    v_mfma_f32_16x16x32_bf16 v[24:27], v[64:67], v[180:183], v[24:27]
    ds_read_b128 v[100:103], v13 offset:15360
    v_mfma_f32_16x16x32_bf16 v[28:31], v[68:71], v[180:183], v[28:31]
    ds_read_b128 v[104:107], v13 offset:16384
    v_mfma_f32_16x16x32_bf16 v[36:39], v[72:75], v[180:183], v[36:39]
    s_waitcnt vmcnt(14) lgkmcnt(4)
    v_mfma_f32_16x16x32_bf16 v[16:19], v[76:79], v[184:187], v[16:19]
    ds_read_b128 v[40:43], v13 offset:18432
    v_mfma_f32_16x16x32_bf16 v[20:23], v[80:83], v[184:187], v[20:23]
    ds_read_b128 v[44:47], v13 offset:19456
    v_mfma_f32_16x16x32_bf16 v[24:27], v[84:87], v[184:187], v[24:27]
    ds_read_b128 v[48:51], v13 offset:20480
    buffer_load_dwordx4 v[152:155], v1, s[4:7], s32 offen offset:2048
    v_mfma_f32_16x16x32_bf16 v[28:31], v[88:91], v[184:187], v[28:31]
    ds_read_b128 v[52:55], v13 offset:21504
    v_mfma_f32_16x16x32_bf16 v[32:35], v[108:111], v[184:187], v[32:35]
    ds_read_b128 v[72:75], v13 offset:26624
    s_waitcnt lgkmcnt(5)
    v_mfma_f32_16x16x32_bf16 v[16:19], v[92:95], v[188:191], v[16:19]
    ds_read_b128 v[56:59], v13 offset:22528
    v_mfma_f32_16x16x32_bf16 v[20:23], v[96:99], v[188:191], v[20:23]
    ds_read_b128 v[60:63], v13 offset:23552
    buffer_load_dwordx4 v[156:159], v1, s[4:7], s32 offen offset:3072
    v_mfma_f32_16x16x32_bf16 v[24:27], v[100:103], v[188:191], v[24:27]
    ds_read_b128 v[64:67], v13 offset:24576
    v_mfma_f32_16x16x32_bf16 v[28:31], v[104:107], v[188:191], v[28:31]
    ds_read_b128 v[68:71], v13 offset:25600
    v_mfma_f32_16x16x32_bf16 v[36:39], v[108:111], v[188:191], v[36:39]
    s_waitcnt vmcnt(14) lgkmcnt(4)
    v_mfma_f32_16x16x32_bf16 v[16:19], v[40:43], v[192:195], v[16:19]
    ds_read_b128 v[76:79], v13 offset:27648
    v_mfma_f32_16x16x32_bf16 v[20:23], v[44:47], v[192:195], v[20:23]
    ds_read_b128 v[80:83], v13 offset:28672
    v_mfma_f32_16x16x32_bf16 v[24:27], v[48:51], v[192:195], v[24:27]
    ds_read_b128 v[84:87], v13 offset:29696
    buffer_load_dwordx4 v[160:163], v1, s[4:7], s33 offen offset:0
    v_mfma_f32_16x16x32_bf16 v[28:31], v[52:55], v[192:195], v[28:31]
    ds_read_b128 v[88:91], v13 offset:30720
    v_mfma_f32_16x16x32_bf16 v[32:35], v[72:75], v[192:195], v[32:35]
    ds_read_b128 v[108:111], v13 offset:35840
    s_waitcnt lgkmcnt(5)
    v_mfma_f32_16x16x32_bf16 v[16:19], v[56:59], v[196:199], v[16:19]
    ds_read_b128 v[92:95], v13 offset:31744
    v_mfma_f32_16x16x32_bf16 v[20:23], v[60:63], v[196:199], v[20:23]
    ds_read_b128 v[96:99], v13 offset:32768
    buffer_load_dwordx4 v[164:167], v1, s[4:7], s33 offen offset:1024
    v_mfma_f32_16x16x32_bf16 v[24:27], v[64:67], v[196:199], v[24:27]
    ds_read_b128 v[100:103], v13 offset:33792
    v_mfma_f32_16x16x32_bf16 v[28:31], v[68:71], v[196:199], v[28:31]
    ds_read_b128 v[104:107], v13 offset:34816
    v_mfma_f32_16x16x32_bf16 v[36:39], v[72:75], v[196:199], v[36:39]
    s_waitcnt vmcnt(14) lgkmcnt(0)
    s_barrier
    v_mfma_f32_16x16x32_bf16 v[16:19], v[76:79], v[200:203], v[16:19]
    ds_read_b128 v[40:43], v14 offset:0
    v_mfma_f32_16x16x32_bf16 v[20:23], v[80:83], v[200:203], v[20:23]
    ds_read_b128 v[44:47], v14 offset:1024
    v_mfma_f32_16x16x32_bf16 v[24:27], v[84:87], v[200:203], v[24:27]
    ds_read_b128 v[48:51], v14 offset:2048
    buffer_load_dwordx4 v[168:171], v1, s[4:7], s33 offen offset:2048
    v_mfma_f32_16x16x32_bf16 v[28:31], v[88:91], v[200:203], v[28:31]
    ds_read_b128 v[52:55], v14 offset:3072
    v_mfma_f32_16x16x32_bf16 v[32:35], v[108:111], v[200:203], v[32:35]
    ds_read_b128 v[72:75], v14 offset:8192
    v_mfma_f32_16x16x32_bf16 v[16:19], v[92:95], v[204:207], v[16:19]
    ds_read_b128 v[56:59], v14 offset:4096
    v_mfma_f32_16x16x32_bf16 v[20:23], v[96:99], v[204:207], v[20:23]
    ds_read_b128 v[60:63], v14 offset:5120
    buffer_load_dwordx4 v[172:175], v1, s[4:7], s33 offen offset:3072
    v_mfma_f32_16x16x32_bf16 v[24:27], v[100:103], v[204:207], v[24:27]
    ds_read_b128 v[64:67], v14 offset:6144
    v_mfma_f32_16x16x32_bf16 v[28:31], v[104:107], v[204:207], v[28:31]
    ds_read_b128 v[68:71], v14 offset:7168
    v_mfma_f32_16x16x32_bf16 v[36:39], v[108:111], v[204:207], v[36:39]
    s_waitcnt vmcnt(14) lgkmcnt(4)
    v_mfma_f32_16x16x32_bf16 v[16:19], v[40:43], v[112:115], v[16:19]
    ds_read_b128 v[76:79], v14 offset:9216
    s_cmp_eq_u32 s28, 0
    s_cselect_b32 s32, 0, 8
    s_lshl_b32 s32, s32, 13
    s_add_u32 s32, s32, s29
    s_add_u32 s33, s32, 4096
    v_mfma_f32_16x16x32_bf16 v[20:23], v[44:47], v[112:115], v[20:23]
    ds_read_b128 v[80:83], v14 offset:10240
    v_mfma_f32_16x16x32_bf16 v[24:27], v[48:51], v[112:115], v[24:27]
    ds_read_b128 v[84:87], v14 offset:11264
    buffer_load_dwordx4 v[176:179], v1, s[4:7], s32 offen offset:0
    v_mfma_f32_16x16x32_bf16 v[28:31], v[52:55], v[112:115], v[28:31]
    ds_read_b128 v[88:91], v14 offset:12288
    v_mfma_f32_16x16x32_bf16 v[32:35], v[72:75], v[112:115], v[32:35]
    ds_read_b128 v[108:111], v14 offset:17408
    s_waitcnt lgkmcnt(5)
    v_mfma_f32_16x16x32_bf16 v[16:19], v[56:59], v[116:119], v[16:19]
    ds_read_b128 v[92:95], v14 offset:13312
    v_mfma_f32_16x16x32_bf16 v[20:23], v[60:63], v[116:119], v[20:23]
    ds_read_b128 v[96:99], v14 offset:14336
    buffer_load_dwordx4 v[180:183], v1, s[4:7], s32 offen offset:1024
    v_mfma_f32_16x16x32_bf16 v[24:27], v[64:67], v[116:119], v[24:27]
    ds_read_b128 v[100:103], v14 offset:15360
    v_mfma_f32_16x16x32_bf16 v[28:31], v[68:71], v[116:119], v[28:31]
    ds_read_b128 v[104:107], v14 offset:16384
    v_mfma_f32_16x16x32_bf16 v[36:39], v[72:75], v[116:119], v[36:39]
    s_waitcnt vmcnt(14) lgkmcnt(4)
    v_mfma_f32_16x16x32_bf16 v[16:19], v[76:79], v[120:123], v[16:19]
    ds_read_b128 v[40:43], v14 offset:18432
    v_mfma_f32_16x16x32_bf16 v[20:23], v[80:83], v[120:123], v[20:23]
    ds_read_b128 v[44:47], v14 offset:19456
    v_mfma_f32_16x16x32_bf16 v[24:27], v[84:87], v[120:123], v[24:27]
    ds_read_b128 v[48:51], v14 offset:20480
    buffer_load_dwordx4 v[184:187], v1, s[4:7], s32 offen offset:2048
    v_mfma_f32_16x16x32_bf16 v[28:31], v[88:91], v[120:123], v[28:31]
    ds_read_b128 v[52:55], v14 offset:21504
    v_mfma_f32_16x16x32_bf16 v[32:35], v[108:111], v[120:123], v[32:35]
    ds_read_b128 v[72:75], v14 offset:26624
    s_waitcnt lgkmcnt(5)
    v_mfma_f32_16x16x32_bf16 v[16:19], v[92:95], v[124:127], v[16:19]
    ds_read_b128 v[56:59], v14 offset:22528
    v_mfma_f32_16x16x32_bf16 v[20:23], v[96:99], v[124:127], v[20:23]
    ds_read_b128 v[60:63], v14 offset:23552
    buffer_load_dwordx4 v[188:191], v1, s[4:7], s32 offen offset:3072
    v_mfma_f32_16x16x32_bf16 v[24:27], v[100:103], v[124:127], v[24:27]
    ds_read_b128 v[64:67], v14 offset:24576
    v_mfma_f32_16x16x32_bf16 v[28:31], v[104:107], v[124:127], v[28:31]
    ds_read_b128 v[68:71], v14 offset:25600
    v_mfma_f32_16x16x32_bf16 v[36:39], v[108:111], v[124:127], v[36:39]
    s_waitcnt vmcnt(14) lgkmcnt(4)
    v_mfma_f32_16x16x32_bf16 v[16:19], v[40:43], v[128:131], v[16:19]
    ds_read_b128 v[76:79], v14 offset:27648
    v_mfma_f32_16x16x32_bf16 v[20:23], v[44:47], v[128:131], v[20:23]
    ds_read_b128 v[80:83], v14 offset:28672
    v_mfma_f32_16x16x32_bf16 v[24:27], v[48:51], v[128:131], v[24:27]
    ds_read_b128 v[84:87], v14 offset:29696
    buffer_load_dwordx4 v[192:195], v1, s[4:7], s33 offen offset:0
    v_mfma_f32_16x16x32_bf16 v[28:31], v[52:55], v[128:131], v[28:31]
    ds_read_b128 v[88:91], v14 offset:30720
    v_mfma_f32_16x16x32_bf16 v[32:35], v[72:75], v[128:131], v[32:35]
    ds_read_b128 v[108:111], v14 offset:35840
    s_waitcnt lgkmcnt(5)
    v_mfma_f32_16x16x32_bf16 v[16:19], v[56:59], v[132:135], v[16:19]
    ds_read_b128 v[92:95], v14 offset:31744
    v_mfma_f32_16x16x32_bf16 v[20:23], v[60:63], v[132:135], v[20:23]
    ds_read_b128 v[96:99], v14 offset:32768
    buffer_load_dwordx4 v[196:199], v1, s[4:7], s33 offen offset:1024
    v_mfma_f32_16x16x32_bf16 v[24:27], v[64:67], v[132:135], v[24:27]
    ds_read_b128 v[100:103], v14 offset:33792
    v_mfma_f32_16x16x32_bf16 v[28:31], v[68:71], v[132:135], v[28:31]
    ds_read_b128 v[104:107], v14 offset:34816
    v_mfma_f32_16x16x32_bf16 v[36:39], v[72:75], v[132:135], v[36:39]
    s_waitcnt vmcnt(14) lgkmcnt(0)
    s_barrier
    v_mfma_f32_16x16x32_bf16 v[16:19], v[76:79], v[136:139], v[16:19]
    ds_read_b128 v[40:43], v15 offset:0
    v_mfma_f32_16x16x32_bf16 v[20:23], v[80:83], v[136:139], v[20:23]
    ds_read_b128 v[44:47], v15 offset:1024
    v_mfma_f32_16x16x32_bf16 v[24:27], v[84:87], v[136:139], v[24:27]
    ds_read_b128 v[48:51], v15 offset:2048
    buffer_load_dwordx4 v[200:203], v1, s[4:7], s33 offen offset:2048
    v_mfma_f32_16x16x32_bf16 v[28:31], v[88:91], v[136:139], v[28:31]
    ds_read_b128 v[52:55], v15 offset:3072
    v_mfma_f32_16x16x32_bf16 v[32:35], v[108:111], v[136:139], v[32:35]
    ds_read_b128 v[72:75], v15 offset:8192
    v_mfma_f32_16x16x32_bf16 v[16:19], v[92:95], v[140:143], v[16:19]
    ds_read_b128 v[56:59], v15 offset:4096
    v_mfma_f32_16x16x32_bf16 v[20:23], v[96:99], v[140:143], v[20:23]
    ds_read_b128 v[60:63], v15 offset:5120
    buffer_load_dwordx4 v[204:207], v1, s[4:7], s33 offen offset:3072
    v_mfma_f32_16x16x32_bf16 v[24:27], v[100:103], v[140:143], v[24:27]
    ds_read_b128 v[64:67], v15 offset:6144
    v_mfma_f32_16x16x32_bf16 v[28:31], v[104:107], v[140:143], v[28:31]
    ds_read_b128 v[68:71], v15 offset:7168
    v_mfma_f32_16x16x32_bf16 v[36:39], v[108:111], v[140:143], v[36:39]
    s_waitcnt vmcnt(14) lgkmcnt(4)
    v_mfma_f32_16x16x32_bf16 v[16:19], v[40:43], v[144:147], v[16:19]
    ds_read_b128 v[76:79], v15 offset:9216
    v_mfma_f32_16x16x32_bf16 v[20:23], v[44:47], v[144:147], v[20:23]
    ds_read_b128 v[80:83], v15 offset:10240
    v_mfma_f32_16x16x32_bf16 v[24:27], v[48:51], v[144:147], v[24:27]
    ds_read_b128 v[84:87], v15 offset:11264
    v_mfma_f32_16x16x32_bf16 v[28:31], v[52:55], v[144:147], v[28:31]
    ds_read_b128 v[88:91], v15 offset:12288
    buffer_load_dwordx4 v[208:211], v4, s[4:7], s34 offen offset:0
    v_mfma_f32_16x16x32_bf16 v[32:35], v[72:75], v[144:147], v[32:35]
    ds_read_b128 v[108:111], v15 offset:17408
    s_waitcnt lgkmcnt(5)
    v_mfma_f32_16x16x32_bf16 v[16:19], v[56:59], v[148:151], v[16:19]
    ds_read_b128 v[92:95], v15 offset:13312
    buffer_load_dwordx4 v[212:215], v4, s[4:7], s34 offen offset:1024
    v_mfma_f32_16x16x32_bf16 v[20:23], v[60:63], v[148:151], v[20:23]
    ds_read_b128 v[96:99], v15 offset:14336
    v_mfma_f32_16x16x32_bf16 v[24:27], v[64:67], v[148:151], v[24:27]
    ds_read_b128 v[100:103], v15 offset:15360
    buffer_load_dwordx2 v[216:217], v5, s[4:7], s34 offen
    v_mfma_f32_16x16x32_bf16 v[28:31], v[68:71], v[148:151], v[28:31]
    ds_read_b128 v[104:107], v15 offset:16384
    v_mfma_f32_16x16x32_bf16 v[36:39], v[72:75], v[148:151], v[36:39]
    s_waitcnt vmcnt(15) lgkmcnt(4)
    v_mfma_f32_16x16x32_bf16 v[16:19], v[76:79], v[152:155], v[16:19]
    ds_read_b128 v[40:43], v15 offset:18432
    v_mfma_f32_16x16x32_bf16 v[20:23], v[80:83], v[152:155], v[20:23]
    ds_read_b128 v[44:47], v15 offset:19456
    v_mfma_f32_16x16x32_bf16 v[24:27], v[84:87], v[152:155], v[24:27]
    ds_read_b128 v[48:51], v15 offset:20480
    v_mfma_f32_16x16x32_bf16 v[28:31], v[88:91], v[152:155], v[28:31]
    ds_read_b128 v[52:55], v15 offset:21504
    v_mfma_f32_16x16x32_bf16 v[32:35], v[108:111], v[152:155], v[32:35]
    ds_read_b128 v[72:75], v15 offset:26624
    s_waitcnt lgkmcnt(5)
    v_mfma_f32_16x16x32_bf16 v[16:19], v[92:95], v[156:159], v[16:19]
    ds_read_b128 v[56:59], v15 offset:22528
    v_mfma_f32_16x16x32_bf16 v[20:23], v[96:99], v[156:159], v[20:23]
    ds_read_b128 v[60:63], v15 offset:23552
    v_mfma_f32_16x16x32_bf16 v[24:27], v[100:103], v[156:159], v[24:27]
    ds_read_b128 v[64:67], v15 offset:24576
    v_mfma_f32_16x16x32_bf16 v[28:31], v[104:107], v[156:159], v[28:31]
    ds_read_b128 v[68:71], v15 offset:25600
    v_mfma_f32_16x16x32_bf16 v[36:39], v[108:111], v[156:159], v[36:39]
    s_waitcnt vmcnt(13) lgkmcnt(4)
    v_mfma_f32_16x16x32_bf16 v[16:19], v[40:43], v[160:163], v[16:19]
    ds_read_b128 v[76:79], v15 offset:27648
    v_mfma_f32_16x16x32_bf16 v[20:23], v[44:47], v[160:163], v[20:23]
    ds_read_b128 v[80:83], v15 offset:28672
    v_mfma_f32_16x16x32_bf16 v[24:27], v[48:51], v[160:163], v[24:27]
    ds_read_b128 v[84:87], v15 offset:29696
    v_mfma_f32_16x16x32_bf16 v[28:31], v[52:55], v[160:163], v[28:31]
    ds_read_b128 v[88:91], v15 offset:30720
    v_mfma_f32_16x16x32_bf16 v[32:35], v[72:75], v[160:163], v[32:35]
    ds_read_b128 v[108:111], v15 offset:35840
    s_waitcnt lgkmcnt(5)
    v_mfma_f32_16x16x32_bf16 v[16:19], v[56:59], v[164:167], v[16:19]
    ds_read_b128 v[92:95], v15 offset:31744
    v_mfma_f32_16x16x32_bf16 v[20:23], v[60:63], v[164:167], v[20:23]
    ds_read_b128 v[96:99], v15 offset:32768
    v_mfma_f32_16x16x32_bf16 v[24:27], v[64:67], v[164:167], v[24:27]
    ds_read_b128 v[100:103], v15 offset:33792
    v_mfma_f32_16x16x32_bf16 v[28:31], v[68:71], v[164:167], v[28:31]
    ds_read_b128 v[104:107], v15 offset:34816
    v_mfma_f32_16x16x32_bf16 v[36:39], v[72:75], v[164:167], v[36:39]
    s_waitcnt vmcnt(11) lgkmcnt(0)
    s_barrier
    v_mfma_f32_16x16x32_bf16 v[16:19], v[76:79], v[168:171], v[16:19]
    ds_read_b128 v[40:43], v12 offset:0
    v_mfma_f32_16x16x32_bf16 v[20:23], v[80:83], v[168:171], v[20:23]
    ds_read_b128 v[44:47], v12 offset:1024
    v_mfma_f32_16x16x32_bf16 v[24:27], v[84:87], v[168:171], v[24:27]
    ds_read_b128 v[48:51], v12 offset:2048
    v_mfma_f32_16x16x32_bf16 v[28:31], v[88:91], v[168:171], v[28:31]
    ds_read_b128 v[52:55], v12 offset:3072
    v_mfma_f32_16x16x32_bf16 v[32:35], v[108:111], v[168:171], v[32:35]
    ds_read_b128 v[72:75], v12 offset:8192
    v_mfma_f32_16x16x32_bf16 v[16:19], v[92:95], v[172:175], v[16:19]
    ds_read_b128 v[56:59], v12 offset:4096
    v_mfma_f32_16x16x32_bf16 v[20:23], v[96:99], v[172:175], v[20:23]
    ds_read_b128 v[60:63], v12 offset:5120
    v_mfma_f32_16x16x32_bf16 v[24:27], v[100:103], v[172:175], v[24:27]
    ds_read_b128 v[64:67], v12 offset:6144
    v_mfma_f32_16x16x32_bf16 v[28:31], v[104:107], v[172:175], v[28:31]
    ds_read_b128 v[68:71], v12 offset:7168
    v_mfma_f32_16x16x32_bf16 v[36:39], v[108:111], v[172:175], v[36:39]
    s_waitcnt vmcnt(9) lgkmcnt(4)
    v_mfma_f32_16x16x32_bf16 v[16:19], v[40:43], v[176:179], v[16:19]
    ds_read_b128 v[76:79], v12 offset:9216
    v_mfma_f32_16x16x32_bf16 v[20:23], v[44:47], v[176:179], v[20:23]
    ds_read_b128 v[80:83], v12 offset:10240
    v_mfma_f32_16x16x32_bf16 v[24:27], v[48:51], v[176:179], v[24:27]
    ds_read_b128 v[84:87], v12 offset:11264
    v_mfma_f32_16x16x32_bf16 v[28:31], v[52:55], v[176:179], v[28:31]
    ds_read_b128 v[88:91], v12 offset:12288
    v_mfma_f32_16x16x32_bf16 v[32:35], v[72:75], v[176:179], v[32:35]
    ds_read_b128 v[108:111], v12 offset:17408
    s_waitcnt lgkmcnt(5)
    v_mfma_f32_16x16x32_bf16 v[16:19], v[56:59], v[180:183], v[16:19]
    ds_read_b128 v[92:95], v12 offset:13312
    v_mfma_f32_16x16x32_bf16 v[20:23], v[60:63], v[180:183], v[20:23]
    ds_read_b128 v[96:99], v12 offset:14336
    v_mfma_f32_16x16x32_bf16 v[24:27], v[64:67], v[180:183], v[24:27]
    ds_read_b128 v[100:103], v12 offset:15360
    v_mfma_f32_16x16x32_bf16 v[28:31], v[68:71], v[180:183], v[28:31]
    ds_read_b128 v[104:107], v12 offset:16384
    v_mfma_f32_16x16x32_bf16 v[36:39], v[72:75], v[180:183], v[36:39]
    s_waitcnt vmcnt(7) lgkmcnt(4)
    v_mfma_f32_16x16x32_bf16 v[16:19], v[76:79], v[184:187], v[16:19]
    ds_read_b128 v[40:43], v12 offset:18432
    v_mfma_f32_16x16x32_bf16 v[20:23], v[80:83], v[184:187], v[20:23]
    ds_read_b128 v[44:47], v12 offset:19456
    v_mfma_f32_16x16x32_bf16 v[24:27], v[84:87], v[184:187], v[24:27]
    ds_read_b128 v[48:51], v12 offset:20480
    v_mfma_f32_16x16x32_bf16 v[28:31], v[88:91], v[184:187], v[28:31]
    ds_read_b128 v[52:55], v12 offset:21504
    v_mfma_f32_16x16x32_bf16 v[32:35], v[108:111], v[184:187], v[32:35]
    ds_read_b128 v[72:75], v12 offset:26624
    s_waitcnt lgkmcnt(5)
    v_mfma_f32_16x16x32_bf16 v[16:19], v[92:95], v[188:191], v[16:19]
    ds_read_b128 v[56:59], v12 offset:22528
    v_mfma_f32_16x16x32_bf16 v[20:23], v[96:99], v[188:191], v[20:23]
    ds_read_b128 v[60:63], v12 offset:23552
    v_mfma_f32_16x16x32_bf16 v[24:27], v[100:103], v[188:191], v[24:27]
    ds_read_b128 v[64:67], v12 offset:24576
    v_mfma_f32_16x16x32_bf16 v[28:31], v[104:107], v[188:191], v[28:31]
    ds_read_b128 v[68:71], v12 offset:25600
    v_mfma_f32_16x16x32_bf16 v[36:39], v[108:111], v[188:191], v[36:39]
    s_waitcnt vmcnt(5) lgkmcnt(4)
    v_mfma_f32_16x16x32_bf16 v[16:19], v[40:43], v[192:195], v[16:19]
    ds_read_b128 v[76:79], v12 offset:27648
    v_mfma_f32_16x16x32_bf16 v[20:23], v[44:47], v[192:195], v[20:23]
    ds_read_b128 v[80:83], v12 offset:28672
    v_mfma_f32_16x16x32_bf16 v[24:27], v[48:51], v[192:195], v[24:27]
    ds_read_b128 v[84:87], v12 offset:29696
    v_mfma_f32_16x16x32_bf16 v[28:31], v[52:55], v[192:195], v[28:31]
    ds_read_b128 v[88:91], v12 offset:30720
    v_mfma_f32_16x16x32_bf16 v[32:35], v[72:75], v[192:195], v[32:35]
    ds_read_b128 v[108:111], v12 offset:35840
    s_waitcnt lgkmcnt(5)
    v_mfma_f32_16x16x32_bf16 v[16:19], v[56:59], v[196:199], v[16:19]
    ds_read_b128 v[92:95], v12 offset:31744
    v_mfma_f32_16x16x32_bf16 v[20:23], v[60:63], v[196:199], v[20:23]
    ds_read_b128 v[96:99], v12 offset:32768
    v_mfma_f32_16x16x32_bf16 v[24:27], v[64:67], v[196:199], v[24:27]
    ds_read_b128 v[100:103], v12 offset:33792
    v_mfma_f32_16x16x32_bf16 v[28:31], v[68:71], v[196:199], v[28:31]
    ds_read_b128 v[104:107], v12 offset:34816
    v_mfma_f32_16x16x32_bf16 v[36:39], v[72:75], v[196:199], v[36:39]
    s_waitcnt vmcnt(3) lgkmcnt(0)
    v_mfma_f32_16x16x32_bf16 v[16:19], v[76:79], v[200:203], v[16:19]
    v_mfma_f32_16x16x32_bf16 v[20:23], v[80:83], v[200:203], v[20:23]
    v_mfma_f32_16x16x32_bf16 v[24:27], v[84:87], v[200:203], v[24:27]
    v_mfma_f32_16x16x32_bf16 v[28:31], v[88:91], v[200:203], v[28:31]
    v_mfma_f32_16x16x32_bf16 v[32:35], v[108:111], v[200:203], v[32:35]
    v_mfma_f32_16x16x32_bf16 v[16:19], v[92:95], v[204:207], v[16:19]
    v_mfma_f32_16x16x32_bf16 v[20:23], v[96:99], v[204:207], v[20:23]
    v_mfma_f32_16x16x32_bf16 v[24:27], v[100:103], v[204:207], v[24:27]
    v_mfma_f32_16x16x32_bf16 v[28:31], v[104:107], v[204:207], v[28:31]
    v_mfma_f32_16x16x32_bf16 v[36:39], v[108:111], v[204:207], v[36:39]
    s_and_b32 s30, s30, 0xfffe
    s_add_u32 s38, s21, 0x2800000
    s_mul_i32 s34, s30, 18432
    s_add_u32 s34, s34, s38
    s_add_u32 s34, s34, 0x0
    s_lshl_b32 s39, s30, 10
    s_add_u32 s39, s39, s38
    s_add_u32 s39, s39, 0x2400000
    v_mul_u32_u24 v9, 18432, v7
    v_lshl_add_u32 v9, v8, 4, v9
    v_lshl_add_u32 v4, v3, 8, v9
    v_add_u32 v4, s35, v4
    v_lshl_add_u32 v5, v3, 3, v9
    v_add_u32 v5, s36, v5
    v_cndmask_b32 v5, v6, v5, s[40:41]
    s_lshr_b32 s42, s24, 1
    s_lshl_b32 s42, s42, 8
    s_and_b32 s43, s24, 1
    s_lshl_b32 s43, s43, 3
    s_add_u32 s42, s42, s43
    v_lshlrev_b32 v10, 10, v7
    v_lshl_add_u32 v10, v8, 4, v10
    v_add_u32 v10, s42, v10
    v_cmp_eq_u32 vcc, 0, v3
    v_mov_b32 v11, 0x3f803f80
    s_nop 0
    v_cndmask_b32 v10, v6, v10, vcc
    s_waitcnt vmcnt(0)
    v_permlane32_swap_b32 v36, v220
    v_permlane32_swap_b32 v37, v221
    v_permlane32_swap_b32 v38, v222
    v_permlane32_swap_b32 v39, v223
    v_lshlrev_b32 v224, 16, v208
    v_and_b32 v225, 0xffff0000, v208
    v_lshlrev_b32 v226, 16, v209
    v_and_b32 v227, 0xffff0000, v209
    v_lshlrev_b32 v228, 16, v210
    v_and_b32 v229, 0xffff0000, v210
    v_lshlrev_b32 v230, 16, v211
    v_and_b32 v231, 0xffff0000, v211
    v_lshlrev_b32 v232, 16, v212
    v_and_b32 v233, 0xffff0000, v212
    v_lshlrev_b32 v234, 16, v213
    v_and_b32 v235, 0xffff0000, v213
    v_lshlrev_b32 v236, 16, v214
    v_and_b32 v237, 0xffff0000, v214
    v_lshlrev_b32 v238, 16, v215
    v_and_b32 v239, 0xffff0000, v215
    v_lshlrev_b32 v240, 16, v216
    v_and_b32 v241, 0xffff0000, v216
    v_lshlrev_b32 v242, 16, v217
    v_and_b32 v243, 0xffff0000, v217
    v_pk_add_f32 v[32:33], v[32:33], v[220:221]
    v_pk_add_f32 v[34:35], v[34:35], v[222:223]
    v_pk_add_f32 v[16:17], v[16:17], v[224:225]
    v_pk_add_f32 v[18:19], v[18:19], v[226:227]
    v_pk_add_f32 v[20:21], v[20:21], v[228:229]
    v_pk_add_f32 v[22:23], v[22:23], v[230:231]
    v_pk_add_f32 v[24:25], v[24:25], v[232:233]
    v_pk_add_f32 v[26:27], v[26:27], v[234:235]
    v_pk_add_f32 v[28:29], v[28:29], v[236:237]
    v_pk_add_f32 v[30:31], v[30:31], v[238:239]
    v_pk_add_f32 v[32:33], v[32:33], v[240:241]
    v_pk_add_f32 v[34:35], v[34:35], v[242:243]
    v_cvt_pk_bf16_f32 v208, v16, v17
    v_cvt_pk_bf16_f32 v209, v18, v19
    v_cvt_pk_bf16_f32 v210, v20, v21
    v_cvt_pk_bf16_f32 v211, v22, v23
    v_cvt_pk_bf16_f32 v212, v24, v25
    v_cvt_pk_bf16_f32 v213, v26, v27
    v_cvt_pk_bf16_f32 v214, v28, v29
    v_cvt_pk_bf16_f32 v215, v30, v31
    v_cvt_pk_bf16_f32 v216, v32, v33
    v_cvt_pk_bf16_f32 v217, v34, v35
    s_cmp_eq_u32 s22, 1
    s_cbranch_scc1 L_fin_p5
    buffer_store_dwordx4 v[208:211], v4, s[4:7], s34 offen offset:0
    buffer_store_dwordx4 v[212:215], v4, s[4:7], s34 offen offset:1024
    buffer_store_dwordx2 v[216:217], v5, s[4:7], s34 offen
    v_cndmask_b32 v222, 0, v216, s[40:41]
    v_cndmask_b32 v223, 0, v217, s[40:41]
    v_mov_b32 v220, 0
    v_mov_b32 v221, 0
    v_dot2_f32_bf16 v220, v208, v11, v220
    v_dot2_f32_bf16 v221, v208, v208, v221
    v_dot2_f32_bf16 v220, v209, v11, v220
    v_dot2_f32_bf16 v221, v209, v209, v221
    v_dot2_f32_bf16 v220, v210, v11, v220
    v_dot2_f32_bf16 v221, v210, v210, v221
    v_dot2_f32_bf16 v220, v211, v11, v220
    v_dot2_f32_bf16 v221, v211, v211, v221
    v_dot2_f32_bf16 v220, v212, v11, v220
    v_dot2_f32_bf16 v221, v212, v212, v221
    v_dot2_f32_bf16 v220, v213, v11, v220
    v_dot2_f32_bf16 v221, v213, v213, v221
    v_dot2_f32_bf16 v220, v214, v11, v220
    v_dot2_f32_bf16 v221, v214, v214, v221
    v_dot2_f32_bf16 v220, v215, v11, v220
    v_dot2_f32_bf16 v221, v215, v215, v221
    v_dot2_f32_bf16 v220, v222, v11, v220
    v_dot2_f32_bf16 v221, v222, v222, v221
    v_dot2_f32_bf16 v220, v223, v11, v220
    v_dot2_f32_bf16 v221, v223, v223, v221
    s_nop 2
    v_mov_b32 v222, v220
    v_mov_b32 v223, v221
    s_nop 1
    v_permlane32_swap_b32 v220, v222
    v_permlane32_swap_b32 v221, v223
    v_add_f32 v220, v220, v222
    v_add_f32 v221, v221, v223
    v_mov_b32 v222, v220
    v_mov_b32 v223, v221
    s_nop 1
    v_permlane16_swap_b32 v220, v222
    v_permlane16_swap_b32 v221, v223
    v_add_f32 v220, v220, v222
    v_add_f32 v221, v221, v223
    buffer_store_dwordx2 v[220:221], v10, s[4:7], s39 offen
    s_branch L_fin_p5_e
L_fin_p5:
    v_lshl_add_u32 v9, v7, 4, v8
    v_mul_u32_u24 v9, 1152, v9
    s_mul_i32 s34, s30, 18432
    s_mul_i32 s42, s24, 144
    s_add_u32 s34, s34, s42
    v_lshl_add_u32 v4, v3, 4, v9
    v_lshl_add_u32 v5, v3, 3, v9
    v_cndmask_b32 v5, v6, v5, s[40:41]
    buffer_store_dwordx4 v[208:211], v4, s[16:19], s34 offen offset:0
    buffer_store_dwordx4 v[212:215], v4, s[16:19], s34 offen offset:64
    buffer_store_dwordx2 v[216:217], v5, s[16:19], s34 offen offset:128
L_fin_p5_e:
    s_endpgm
L_ld_p5:
    s_and_b32 s25, s2, 7
    s_lshr_b32 s26, s2, 3
    s_lshl_b32 s23, s25, 2
    s_lshr_b32 s27, s26, 3
    s_add_u32 s23, s23, s27
    s_and_b32 s24, s26, 7
    s_add_u32 s28, s23, s24
    s_and_b32 s28, s28, 3
    s_mul_i32 s29, s24, 331776
    s_add_u32 s29, s29, 0x8100000
    s_mul_i32 s30, s20, 9216
    s_mul_i32 s31, s20, 3072
    s_cmp_eq_u32 s28, 0
    s_cselect_b32 s32, 4, 0
    s_mul_i32 s32, s32, 36864
    s_add_u32 s32, s32, s29
    s_add_u32 s32, s32, s30
    s_add_u32 m0, s30, 0
    s_add_u32 s33, s32, 0
    buffer_load_dwordx4 v1, s[4:7], s33 offen offset:0 lds
    buffer_load_dwordx4 v1, s[4:7], s33 offen offset:1024 lds
    buffer_load_dwordx4 v1, s[4:7], s33 offen offset:2048 lds
    buffer_load_dwordx4 v1, s[4:7], s33 offen offset:3072 lds
    s_add_u32 m0, s30, 4096
    s_add_u32 s33, s32, 4096
    buffer_load_dwordx4 v1, s[4:7], s33 offen offset:0 lds
    buffer_load_dwordx4 v1, s[4:7], s33 offen offset:1024 lds
    buffer_load_dwordx4 v1, s[4:7], s33 offen offset:2048 lds
    buffer_load_dwordx4 v1, s[4:7], s33 offen offset:3072 lds
    s_add_u32 m0, s30, 8192
    s_add_u32 s33, s32, 8192
    buffer_load_dwordx4 v1, s[4:7], s33 offen offset:0 lds
    s_cmp_eq_u32 s28, 1
    s_cselect_b32 s32, 5, 1
    s_mul_i32 s32, s32, 36864
    s_add_u32 s32, s32, s29
    s_add_u32 s32, s32, s30
    s_add_u32 m0, s30, 36864
    s_add_u32 s33, s32, 0
    buffer_load_dwordx4 v1, s[4:7], s33 offen offset:0 lds
    buffer_load_dwordx4 v1, s[4:7], s33 offen offset:1024 lds
    buffer_load_dwordx4 v1, s[4:7], s33 offen offset:2048 lds
    buffer_load_dwordx4 v1, s[4:7], s33 offen offset:3072 lds
    s_add_u32 m0, s30, 40960
    s_add_u32 s33, s32, 4096
    buffer_load_dwordx4 v1, s[4:7], s33 offen offset:0 lds
    buffer_load_dwordx4 v1, s[4:7], s33 offen offset:1024 lds
    buffer_load_dwordx4 v1, s[4:7], s33 offen offset:2048 lds
    buffer_load_dwordx4 v1, s[4:7], s33 offen offset:3072 lds
    s_add_u32 m0, s30, 45056
    s_add_u32 s33, s32, 8192
    buffer_load_dwordx4 v1, s[4:7], s33 offen offset:0 lds
    s_waitcnt vmcnt(9)
    s_barrier
    s_cmp_eq_u32 s28, 2
    s_cselect_b32 s32, 6, 2
    s_mul_i32 s32, s32, 36864
    s_add_u32 s32, s32, s29
    s_add_u32 s32, s32, s30
    s_add_u32 m0, s30, 73728
    s_add_u32 s33, s32, 0
    buffer_load_dwordx4 v1, s[4:7], s33 offen offset:0 lds
    buffer_load_dwordx4 v1, s[4:7], s33 offen offset:1024 lds
    buffer_load_dwordx4 v1, s[4:7], s33 offen offset:2048 lds
    buffer_load_dwordx4 v1, s[4:7], s33 offen offset:3072 lds
    s_add_u32 m0, s30, 77824
    s_add_u32 s33, s32, 4096
    buffer_load_dwordx4 v1, s[4:7], s33 offen offset:0 lds
    buffer_load_dwordx4 v1, s[4:7], s33 offen offset:1024 lds
    buffer_load_dwordx4 v1, s[4:7], s33 offen offset:2048 lds
    buffer_load_dwordx4 v1, s[4:7], s33 offen offset:3072 lds
    s_add_u32 m0, s30, 81920
    s_add_u32 s33, s32, 8192
    buffer_load_dwordx4 v1, s[4:7], s33 offen offset:0 lds
    s_cmp_eq_u32 s28, 3
    s_cselect_b32 s32, 7, 3
    s_mul_i32 s32, s32, 36864
    s_add_u32 s32, s32, s29
    s_add_u32 s32, s32, s30
    s_add_u32 m0, s30, 110592
    s_add_u32 s33, s32, 0
    buffer_load_dwordx4 v1, s[4:7], s33 offen offset:0 lds
    buffer_load_dwordx4 v1, s[4:7], s33 offen offset:1024 lds
    buffer_load_dwordx4 v1, s[4:7], s33 offen offset:2048 lds
    buffer_load_dwordx4 v1, s[4:7], s33 offen offset:3072 lds
    s_add_u32 m0, s30, 114688
    s_add_u32 s33, s32, 4096
    buffer_load_dwordx4 v1, s[4:7], s33 offen offset:0 lds
    buffer_load_dwordx4 v1, s[4:7], s33 offen offset:1024 lds
    buffer_load_dwordx4 v1, s[4:7], s33 offen offset:2048 lds
    buffer_load_dwordx4 v1, s[4:7], s33 offen offset:3072 lds
    s_add_u32 m0, s30, 118784
    s_add_u32 s33, s32, 8192
    buffer_load_dwordx4 v1, s[4:7], s33 offen offset:0 lds
    s_waitcnt vmcnt(18)
    s_barrier
    s_cmp_eq_u32 s28, 0
    s_cselect_b32 s32, 8, 4
    s_mul_i32 s32, s32, 36864
    s_add_u32 s32, s32, s29
    s_add_u32 s32, s32, s30
    s_add_u32 m0, s30, 0
    s_add_u32 s33, s32, 0
    buffer_load_dwordx4 v1, s[4:7], s33 offen offset:0 lds
    buffer_load_dwordx4 v1, s[4:7], s33 offen offset:1024 lds
    buffer_load_dwordx4 v1, s[4:7], s33 offen offset:2048 lds
    buffer_load_dwordx4 v1, s[4:7], s33 offen offset:3072 lds
    s_add_u32 m0, s30, 4096
    s_add_u32 s33, s32, 4096
    buffer_load_dwordx4 v1, s[4:7], s33 offen offset:0 lds
    buffer_load_dwordx4 v1, s[4:7], s33 offen offset:1024 lds
    buffer_load_dwordx4 v1, s[4:7], s33 offen offset:2048 lds
    buffer_load_dwordx4 v1, s[4:7], s33 offen offset:3072 lds
    s_add_u32 m0, s30, 8192
    s_add_u32 s33, s32, 8192
    buffer_load_dwordx4 v1, s[4:7], s33 offen offset:0 lds
    s_waitcnt vmcnt(18)
    s_barrier
    s_cmp_eq_u32 s28, 1
    s_cselect_b32 s32, 1, 5
    s_mul_i32 s32, s32, 36864
    s_add_u32 s32, s32, s29
    s_add_u32 s32, s32, s30
    s_add_u32 m0, s30, 36864
    s_add_u32 s33, s32, 0
    buffer_load_dwordx4 v1, s[4:7], s33 offen offset:0 lds
    buffer_load_dwordx4 v1, s[4:7], s33 offen offset:1024 lds
    buffer_load_dwordx4 v1, s[4:7], s33 offen offset:2048 lds
    buffer_load_dwordx4 v1, s[4:7], s33 offen offset:3072 lds
    s_add_u32 m0, s30, 40960
    s_add_u32 s33, s32, 4096
    buffer_load_dwordx4 v1, s[4:7], s33 offen offset:0 lds
    buffer_load_dwordx4 v1, s[4:7], s33 offen offset:1024 lds
    buffer_load_dwordx4 v1, s[4:7], s33 offen offset:2048 lds
    buffer_load_dwordx4 v1, s[4:7], s33 offen offset:3072 lds
    s_add_u32 m0, s30, 45056
    s_add_u32 s33, s32, 8192
    buffer_load_dwordx4 v1, s[4:7], s33 offen offset:0 lds
    s_waitcnt vmcnt(18)
    s_barrier
    s_cmp_eq_u32 s28, 2
    s_cselect_b32 s32, 2, 6
    s_mul_i32 s32, s32, 36864
    s_add_u32 s32, s32, s29
    s_add_u32 s32, s32, s30
    s_add_u32 m0, s30, 73728
    s_add_u32 s33, s32, 0
    buffer_load_dwordx4 v1, s[4:7], s33 offen offset:0 lds
    buffer_load_dwordx4 v1, s[4:7], s33 offen offset:1024 lds
    buffer_load_dwordx4 v1, s[4:7], s33 offen offset:2048 lds
    buffer_load_dwordx4 v1, s[4:7], s33 offen offset:3072 lds
    s_add_u32 m0, s30, 77824
    s_add_u32 s33, s32, 4096
    buffer_load_dwordx4 v1, s[4:7], s33 offen offset:0 lds
    buffer_load_dwordx4 v1, s[4:7], s33 offen offset:1024 lds
    buffer_load_dwordx4 v1, s[4:7], s33 offen offset:2048 lds
    buffer_load_dwordx4 v1, s[4:7], s33 offen offset:3072 lds
    s_add_u32 m0, s30, 81920
    s_add_u32 s33, s32, 8192
    buffer_load_dwordx4 v1, s[4:7], s33 offen offset:0 lds
    s_waitcnt vmcnt(18)
    s_barrier
    s_cmp_eq_u32 s28, 3
    s_cselect_b32 s32, 3, 7
    s_mul_i32 s32, s32, 36864
    s_add_u32 s32, s32, s29
    s_add_u32 s32, s32, s30
    s_add_u32 m0, s30, 110592
    s_add_u32 s33, s32, 0
    buffer_load_dwordx4 v1, s[4:7], s33 offen offset:0 lds
    buffer_load_dwordx4 v1, s[4:7], s33 offen offset:1024 lds
    buffer_load_dwordx4 v1, s[4:7], s33 offen offset:2048 lds
    buffer_load_dwordx4 v1, s[4:7], s33 offen offset:3072 lds
    s_add_u32 m0, s30, 114688
    s_add_u32 s33, s32, 4096
    buffer_load_dwordx4 v1, s[4:7], s33 offen offset:0 lds
    buffer_load_dwordx4 v1, s[4:7], s33 offen offset:1024 lds
    buffer_load_dwordx4 v1, s[4:7], s33 offen offset:2048 lds
    buffer_load_dwordx4 v1, s[4:7], s33 offen offset:3072 lds
    s_add_u32 m0, s30, 118784
    s_add_u32 s33, s32, 8192
    buffer_load_dwordx4 v1, s[4:7], s33 offen offset:0 lds
    s_waitcnt vmcnt(18)
    s_barrier
    s_cmp_eq_u32 s28, 0
    s_cselect_b32 s32, 0, 8
    s_mul_i32 s32, s32, 36864
    s_add_u32 s32, s32, s29
    s_add_u32 s32, s32, s30
    s_add_u32 m0, s30, 0
    s_add_u32 s33, s32, 0
    buffer_load_dwordx4 v1, s[4:7], s33 offen offset:0 lds
    buffer_load_dwordx4 v1, s[4:7], s33 offen offset:1024 lds
    buffer_load_dwordx4 v1, s[4:7], s33 offen offset:2048 lds
    buffer_load_dwordx4 v1, s[4:7], s33 offen offset:3072 lds
    s_add_u32 m0, s30, 4096
    s_add_u32 s33, s32, 4096
    buffer_load_dwordx4 v1, s[4:7], s33 offen offset:0 lds
    buffer_load_dwordx4 v1, s[4:7], s33 offen offset:1024 lds
    buffer_load_dwordx4 v1, s[4:7], s33 offen offset:2048 lds
    buffer_load_dwordx4 v1, s[4:7], s33 offen offset:3072 lds
    s_add_u32 m0, s30, 8192
    s_add_u32 s33, s32, 8192
    buffer_load_dwordx4 v1, s[4:7], s33 offen offset:0 lds
    s_waitcnt vmcnt(18)
    s_barrier
    s_waitcnt vmcnt(9)
    s_barrier
    s_waitcnt vmcnt(0)
    s_barrier
L_end_p5:
    s_endpgm

.globl p1l1_kernel
.p2align 8
.type p1l1_kernel,@function
p1l1_kernel:
    s_mov_b32 s22, 1
    s_branch L_go_p1

.globl p2l1_kernel
.p2align 8
.type p2l1_kernel,@function
p2l1_kernel:
    s_mov_b32 s22, 1
    s_branch L_go_p2

.globl p3l1_kernel
.p2align 8
.type p3l1_kernel,@function
p3l1_kernel:
    s_mov_b32 s22, 1
    s_branch L_go_p3

.globl p5l1_kernel
.p2align 8
.type p5l1_kernel,@function
p5l1_kernel:
    s_mov_b32 s22, 1
    s_branch L_go_p5

.section .rodata,"a"
.p2align 6
.amdhsa_kernel k0_kernel
  .amdhsa_next_free_vgpr 64
  .amdhsa_next_free_sgpr 102
  .amdhsa_accum_offset 64
  .amdhsa_group_segment_fixed_size 0
  .amdhsa_kernarg_size 88
  .amdhsa_user_sgpr_count 2
  .amdhsa_user_sgpr_kernarg_segment_ptr 1
  .amdhsa_system_sgpr_workgroup_id_x 1
  .amdhsa_float_denorm_mode_32 3
.end_amdhsa_kernel

.p2align 6
.amdhsa_kernel p1l0_kernel
  .amdhsa_next_free_vgpr 256
  .amdhsa_next_free_sgpr 102
  .amdhsa_accum_offset 256
  .amdhsa_group_segment_fixed_size 0
  .amdhsa_kernarg_size 88
  .amdhsa_user_sgpr_count 2
  .amdhsa_user_sgpr_kernarg_segment_ptr 1
  .amdhsa_system_sgpr_workgroup_id_x 1
  .amdhsa_float_denorm_mode_32 3
.end_amdhsa_kernel

.p2align 6
.amdhsa_kernel p2l0_kernel
  .amdhsa_next_free_vgpr 256
  .amdhsa_next_free_sgpr 102
  .amdhsa_accum_offset 256
  .amdhsa_group_segment_fixed_size 0
  .amdhsa_kernarg_size 88
  .amdhsa_user_sgpr_count 2
  .amdhsa_user_sgpr_kernarg_segment_ptr 1
  .amdhsa_system_sgpr_workgroup_id_x 1
  .amdhsa_float_denorm_mode_32 3
.end_amdhsa_kernel

.p2align 6
.amdhsa_kernel p3l0_kernel
  .amdhsa_next_free_vgpr 256
  .amdhsa_next_free_sgpr 102
  .amdhsa_accum_offset 256
  .amdhsa_group_segment_fixed_size 0
  .amdhsa_kernarg_size 88
  .amdhsa_user_sgpr_count 2
  .amdhsa_user_sgpr_kernarg_segment_ptr 1
  .amdhsa_system_sgpr_workgroup_id_x 1
  .amdhsa_float_denorm_mode_32 3
.end_amdhsa_kernel

.p2align 6
.amdhsa_kernel p5l0_kernel
  .amdhsa_next_free_vgpr 256
  .amdhsa_next_free_sgpr 102
  .amdhsa_accum_offset 256
  .amdhsa_group_segment_fixed_size 0
  .amdhsa_kernarg_size 88
  .amdhsa_user_sgpr_count 2
  .amdhsa_user_sgpr_kernarg_segment_ptr 1
  .amdhsa_system_sgpr_workgroup_id_x 1
  .amdhsa_float_denorm_mode_32 3
.end_amdhsa_kernel

.p2align 6
.amdhsa_kernel p1l1_kernel
  .amdhsa_next_free_vgpr 256
  .amdhsa_next_free_sgpr 102
  .amdhsa_accum_offset 256
  .amdhsa_group_segment_fixed_size 0
  .amdhsa_kernarg_size 88
  .amdhsa_user_sgpr_count 2
  .amdhsa_user_sgpr_kernarg_segment_ptr 1
  .amdhsa_system_sgpr_workgroup_id_x 1
  .amdhsa_float_denorm_mode_32 3
.end_amdhsa_kernel

.p2align 6
.amdhsa_kernel p2l1_kernel
  .amdhsa_next_free_vgpr 256
  .amdhsa_next_free_sgpr 102
  .amdhsa_accum_offset 256
  .amdhsa_group_segment_fixed_size 0
  .amdhsa_kernarg_size 88
  .amdhsa_user_sgpr_count 2
  .amdhsa_user_sgpr_kernarg_segment_ptr 1
  .amdhsa_system_sgpr_workgroup_id_x 1
  .amdhsa_float_denorm_mode_32 3
.end_amdhsa_kernel

.p2align 6
.amdhsa_kernel p3l1_kernel
  .amdhsa_next_free_vgpr 256
  .amdhsa_next_free_sgpr 102
  .amdhsa_accum_offset 256
  .amdhsa_group_segment_fixed_size 0
  .amdhsa_kernarg_size 88
  .amdhsa_user_sgpr_count 2
  .amdhsa_user_sgpr_kernarg_segment_ptr 1
  .amdhsa_system_sgpr_workgroup_id_x 1
  .amdhsa_float_denorm_mode_32 3
.end_amdhsa_kernel

.p2align 6
.amdhsa_kernel p5l1_kernel
  .amdhsa_next_free_vgpr 256
  .amdhsa_next_free_sgpr 102
  .amdhsa_accum_offset 256
  .amdhsa_group_segment_fixed_size 0
  .amdhsa_kernarg_size 88
  .amdhsa_user_sgpr_count 2
  .amdhsa_user_sgpr_kernarg_segment_ptr 1
  .amdhsa_system_sgpr_workgroup_id_x 1
  .amdhsa_float_denorm_mode_32 3
.end_amdhsa_kernel
```

```asm
; @launch kernel=k0_kernel grid=(352,1,1) block=(256,1,1) lds=36864
; @launch kernel=mega_kernel grid=(256,1,1) block=(512,1,1) lds=163840
.amdgcn_target "amdgcn-amd-amdhsa--gfx950"
.text
.globl k0_kernel
.p2align 8
.type k0_kernel,@function
k0_kernel:
    s_cmp_ge_u32 s2, 352
    s_cbranch_scc1 L_k0_end
    s_load_dwordx2 s[24:25], s[0:1], 80
    s_load_dwordx16 s[36:51], s[0:1], 0
    v_lshrrev_b32 v2, 6, v0
    v_and_b32 v1, 63, v0
    v_lshlrev_b32 v1, 4, v1
    v_readfirstlane_b32 s20, v2
    v_and_b32 v2, 15, v0
    v_bfe_u32 v3, v0, 4, 2
    v_bfrev_b32 v6, 1
    v_mov_b32 v11, 0x3f803f80
    s_mul_i32 s30, s20, 9216
    s_waitcnt lgkmcnt(0)
    s_mov_b32 s4, s24
    s_mov_b32 s5, s25
    s_mov_b32 s6, 0x10000000
    s_mov_b32 s7, 0x20000
    s_cmp_ge_u32 s2, 2
    s_cbranch_scc1 L_k0_nz
    v_lshlrev_b32 v4, 8, v0
    v_mov_b32 v5, 0
    s_lshl_b32 s26, s2, 16
    s_add_u32 s26, s26, 0x8500000
    buffer_store_dword v5, v4, s[4:7], s26 offen
L_k0_nz:
    s_cmp_lt_u32 s2, 54
    s_cbranch_scc1 L_k0_wq
    s_cmp_lt_u32 s2, 118
    s_cbranch_scc1 L_k0_x
    s_cmp_lt_u32 s2, 136
    s_cbranch_scc1 L_k0_wo
    s_cmp_lt_u32 s2, 280
    s_cbranch_scc1 L_k0_wi
    s_sub_u32 s26, s2, 280
    s_mul_i32 s28, s26, 57
    s_lshr_b32 s28, s28, 9
    s_mul_i32 s27, s28, 9
    s_sub_u32 s27, s26, s27
    s_mov_b32 s8, s50
    s_mov_b32 s9, s51
    s_mov_b32 s10, 0x288000
    s_mov_b32 s11, 0x20000
    s_mul_i32 s29, s28, 331776
    s_lshl_b32 s31, s27, 7
    s_add_u32 s29, s29, s31
    s_mul_i32 s31, s20, 82944
    s_add_u32 s29, s29, s31
    v_bfe_u32 v4, v0, 3, 3
    v_mul_u32_u24 v4, 1152, v4
    v_and_b32 v5, 7, v0
    v_lshl_add_u32 v4, v5, 4, v4
    s_add_u32 m0, s30, 0
    s_add_u32 s31, s29, 0
    buffer_load_dwordx4 v4, s[8:11], s31 offen lds
    s_add_u32 m0, s30, 1024
    s_add_u32 s31, s29, 9216
    buffer_load_dwordx4 v4, s[8:11], s31 offen lds
    s_add_u32 m0, s30, 2048
    s_add_u32 s31, s29, 18432
    buffer_load_dwordx4 v4, s[8:11], s31 offen lds
    s_add_u32 m0, s30, 3072
    s_add_u32 s31, s29, 27648
    buffer_load_dwordx4 v4, s[8:11], s31 offen lds
    s_add_u32 m0, s30, 4096
    s_add_u32 s31, s29, 36864
    buffer_load_dwordx4 v4, s[8:11], s31 offen lds
    s_add_u32 m0, s30, 5120
    s_add_u32 s31, s29, 46080
    buffer_load_dwordx4 v4, s[8:11], s31 offen lds
    s_add_u32 m0, s30, 6144
    s_add_u32 s31, s29, 55296
    buffer_load_dwordx4 v4, s[8:11], s31 offen lds
    s_add_u32 m0, s30, 7168
    s_add_u32 s31, s29, 64512
    buffer_load_dwordx4 v4, s[8:11], s31 offen lds
    s_add_u32 m0, s30, 8192
    s_add_u32 s31, s29, 73728
    buffer_load_dwordx4 v4, s[8:11], s31 offen lds
    v_lshrrev_b32 v7, 2, v2
    v_and_b32 v8, 3, v2
    s_lshl_b32 s31, s20, 5
    v_lshlrev_b32 v9, 7, v7
    v_lshl_add_u32 v9, v8, 3, v9
    v_add_u32 v9, s31, v9
    v_mul_u32_u24 v4, 512, v3
    v_add_u32 v4, v4, v9
    v_mul_u32_u24 v5, 512, v3
    v_add_u32 v5, v5, v9
    s_lshl_b32 s31, s27, 2
    s_add_u32 s31, s31, s20
    v_lshl_add_u32 v7, s31, 2, v7
    v_lshlrev_b32 v8, 4, v8
    v_lshl_add_u32 v8, v3, 8, v8
    v_mul_u32_u24 v9, 57, v7
    v_lshrrev_b32 v9, 10, v9
    v_mul_u32_u24 v10, 18, v9
    v_sub_u32 v10, v7, v10
    v_lshrrev_b32 v12, 3, v10
    v_and_b32 v13, 1, v10
    v_lshl_add_u32 v12, v12, 1, v13
    v_bfe_u32 v14, v10, 1, 2
    v_cmp_gt_u32 vcc, 16, v10
    v_mul_u32_u24 v9, 331776, v9
    v_add_u32 v9, v9, v8
    v_cndmask_b32 v12, 8, v12, vcc
    v_cndmask_b32 v14, v13, v14, vcc
    v_mov_b32 v15, 0x1000
    v_mov_b32 v13, 0x80
    v_cndmask_b32 v15, v13, v15, vcc
    v_lshl_add_u32 v9, v12, 10, v9
    v_lshl_add_u32 v9, v14, 6, v9
    v_add_u32 v10, v9, v15
    s_and_b32 s31, s28, 1
    s_cmp_eq_u32 s31, 1
    s_cselect_b64 vcc, -1, 0
    v_cndmask_b32 v12, v9, v10, vcc
    v_cndmask_b32 v13, v10, v9, vcc
    s_mul_i32 s32, s28, 9
    s_waitcnt vmcnt(0)
    s_barrier
    ds_read_b64_tr_b16 v[16:17], v4 offset:0
    ds_read_b64_tr_b16 v[18:19], v4 offset:2048
    ds_read_b64_tr_b16 v[20:21], v4 offset:4096
    ds_read_b64_tr_b16 v[22:23], v4 offset:6144
    ds_read_b64_tr_b16 v[24:25], v4 offset:8192
    ds_read_b64_tr_b16 v[26:27], v4 offset:10240
    ds_read_b64_tr_b16 v[28:29], v4 offset:12288
    ds_read_b64_tr_b16 v[30:31], v4 offset:14336
    ds_read_b64_tr_b16 v[32:33], v4 offset:18432
    ds_read_b64_tr_b16 v[34:35], v4 offset:20480
    ds_read_b64_tr_b16 v[36:37], v4 offset:22528
    ds_read_b64_tr_b16 v[38:39], v4 offset:24576
    ds_read_b64_tr_b16 v[40:41], v4 offset:26624
    ds_read_b64_tr_b16 v[42:43], v4 offset:28672
    ds_read_b64_tr_b16 v[44:45], v4 offset:30720
    ds_read_b64_tr_b16 v[46:47], v4 offset:32768
    ds_read_b64_tr_b16 v[48:49], v5 offset:16384
    ds_read_b64_tr_b16 v[50:51], v5 offset:34816
    s_waitcnt lgkmcnt(15)
    s_add_u32 s31, s32, 0
    s_lshr_b32 s31, s31, 1
    s_mul_i32 s31, s31, 9216
    s_add_u32 s31, s31, 0x8100000
    buffer_store_dwordx4 v[16:19], v12, s[4:7], s31 offen
    s_waitcnt lgkmcnt(14)
    s_add_u32 s31, s32, 1
    s_lshr_b32 s31, s31, 1
    s_mul_i32 s31, s31, 9216
    s_add_u32 s31, s31, 0x8100000
    buffer_store_dwordx4 v[20:23], v13, s[4:7], s31 offen
    s_waitcnt lgkmcnt(12)
    s_add_u32 s31, s32, 2
    s_lshr_b32 s31, s31, 1
    s_mul_i32 s31, s31, 9216
    s_add_u32 s31, s31, 0x8100000
    buffer_store_dwordx4 v[24:27], v12, s[4:7], s31 offen
    s_waitcnt lgkmcnt(10)
    s_add_u32 s31, s32, 3
    s_lshr_b32 s31, s31, 1
    s_mul_i32 s31, s31, 9216
    s_add_u32 s31, s31, 0x8100000
    buffer_store_dwordx4 v[28:31], v13, s[4:7], s31 offen
    s_waitcnt lgkmcnt(8)
    s_add_u32 s31, s32, 4
    s_lshr_b32 s31, s31, 1
    s_mul_i32 s31, s31, 9216
    s_add_u32 s31, s31, 0x8100000
    buffer_store_dwordx4 v[32:35], v12, s[4:7], s31 offen
    s_waitcnt lgkmcnt(6)
    s_add_u32 s31, s32, 5
    s_lshr_b32 s31, s31, 1
    s_mul_i32 s31, s31, 9216
    s_add_u32 s31, s31, 0x8100000
    buffer_store_dwordx4 v[36:39], v13, s[4:7], s31 offen
    s_waitcnt lgkmcnt(4)
    s_add_u32 s31, s32, 6
    s_lshr_b32 s31, s31, 1
    s_mul_i32 s31, s31, 9216
    s_add_u32 s31, s31, 0x8100000
    buffer_store_dwordx4 v[40:43], v12, s[4:7], s31 offen
    s_waitcnt lgkmcnt(2)
    s_add_u32 s31, s32, 7
    s_lshr_b32 s31, s31, 1
    s_mul_i32 s31, s31, 9216
    s_add_u32 s31, s31, 0x8100000
    buffer_store_dwordx4 v[44:47], v13, s[4:7], s31 offen
    s_waitcnt lgkmcnt(0)
    s_add_u32 s31, s32, 8
    s_lshr_b32 s31, s31, 1
    s_mul_i32 s31, s31, 9216
    s_add_u32 s31, s31, 0x8100000
    buffer_store_dwordx4 v[48:51], v12, s[4:7], s31 offen
    s_endpgm
L_k0_wo:
    s_sub_u32 s26, s2, 118
    s_mul_i32 s28, s26, 57
    s_lshr_b32 s28, s28, 9
    s_mul_i32 s27, s28, 9
    s_sub_u32 s27, s26, s27
    s_mov_b32 s8, s40
    s_mov_b32 s9, s41
    s_mov_b32 s10, 0xa2000
    s_mov_b32 s11, 0x20000
    s_mul_i32 s29, s28, 331776
    s_lshl_b32 s31, s27, 7
    s_add_u32 s29, s29, s31
    s_mul_i32 s31, s20, 82944
    s_add_u32 s29, s29, s31
    v_bfe_u32 v4, v0, 3, 3
    v_mul_u32_u24 v4, 1152, v4
    v_and_b32 v5, 7, v0
    v_lshl_add_u32 v4, v5, 4, v4
    s_add_u32 m0, s30, 0
    s_add_u32 s31, s29, 0
    buffer_load_dwordx4 v4, s[8:11], s31 offen lds
    s_add_u32 m0, s30, 1024
    s_add_u32 s31, s29, 9216
    buffer_load_dwordx4 v4, s[8:11], s31 offen lds
    s_add_u32 m0, s30, 2048
    s_add_u32 s31, s29, 18432
    buffer_load_dwordx4 v4, s[8:11], s31 offen lds
    s_add_u32 m0, s30, 3072
    s_add_u32 s31, s29, 27648
    buffer_load_dwordx4 v4, s[8:11], s31 offen lds
    s_add_u32 m0, s30, 4096
    s_add_u32 s31, s29, 36864
    buffer_load_dwordx4 v4, s[8:11], s31 offen lds
    s_add_u32 m0, s30, 5120
    s_add_u32 s31, s29, 46080
    buffer_load_dwordx4 v4, s[8:11], s31 offen lds
    s_add_u32 m0, s30, 6144
    s_add_u32 s31, s29, 55296
    buffer_load_dwordx4 v4, s[8:11], s31 offen lds
    s_add_u32 m0, s30, 7168
    s_add_u32 s31, s29, 64512
    buffer_load_dwordx4 v4, s[8:11], s31 offen lds
    s_add_u32 m0, s30, 8192
    s_add_u32 s31, s29, 73728
    buffer_load_dwordx4 v4, s[8:11], s31 offen lds
    v_lshrrev_b32 v7, 2, v2
    v_and_b32 v8, 3, v2
    s_lshl_b32 s31, s20, 5
    v_lshlrev_b32 v9, 7, v7
    v_lshl_add_u32 v9, v8, 3, v9
    v_add_u32 v9, s31, v9
    v_mul_u32_u24 v4, 512, v3
    v_add_u32 v4, v4, v9
    v_mul_u32_u24 v5, 9216, v3
    v_add_u32 v5, v5, v9
    s_lshl_b32 s31, s27, 2
    s_add_u32 s31, s31, s20
    v_lshl_add_u32 v7, s31, 2, v7
    v_lshlrev_b32 v8, 4, v8
    v_lshl_add_u32 v8, v3, 8, v8
    v_mul_u32_u24 v9, 57, v7
    v_lshrrev_b32 v9, 10, v9
    v_mul_u32_u24 v10, 18, v9
    v_sub_u32 v10, v7, v10
    v_lshrrev_b32 v12, 3, v10
    v_and_b32 v13, 1, v10
    v_lshl_add_u32 v12, v12, 1, v13
    v_bfe_u32 v14, v10, 1, 2
    v_cmp_gt_u32 vcc, 16, v10
    v_mul_u32_u24 v9, 82944, v9
    v_add_u32 v9, v9, v8
    v_cndmask_b32 v12, 8, v12, vcc
    v_cndmask_b32 v14, v13, v14, vcc
    v_mov_b32 v15, 0x1000
    v_mov_b32 v13, 0x80
    v_cndmask_b32 v15, v13, v15, vcc
    v_lshl_add_u32 v9, v12, 10, v9
    v_lshl_add_u32 v9, v14, 6, v9
    v_add_u32 v10, v9, v15
    s_and_b32 s31, s28, 1
    s_cmp_eq_u32 s31, 1
    s_cselect_b64 vcc, -1, 0
    v_cndmask_b32 v12, v9, v10, vcc
    v_cndmask_b32 v13, v10, v9, vcc
    s_lshl_b32 s32, s28, 3
    s_waitcnt vmcnt(0)
    s_barrier
    ds_read_b64_tr_b16 v[16:17], v4 offset:0
    ds_read_b64_tr_b16 v[18:19], v4 offset:2560
    ds_read_b64_tr_b16 v[20:21], v4 offset:4608
    ds_read_b64_tr_b16 v[22:23], v4 offset:7168
    ds_read_b64_tr_b16 v[24:25], v4 offset:9216
    ds_read_b64_tr_b16 v[26:27], v4 offset:11776
    ds_read_b64_tr_b16 v[28:29], v4 offset:13824
    ds_read_b64_tr_b16 v[30:31], v4 offset:16384
    ds_read_b64_tr_b16 v[32:33], v4 offset:18432
    ds_read_b64_tr_b16 v[34:35], v4 offset:20992
    ds_read_b64_tr_b16 v[36:37], v4 offset:23040
    ds_read_b64_tr_b16 v[38:39], v4 offset:25600
    ds_read_b64_tr_b16 v[40:41], v4 offset:27648
    ds_read_b64_tr_b16 v[42:43], v4 offset:30208
    ds_read_b64_tr_b16 v[44:45], v4 offset:32256
    ds_read_b64_tr_b16 v[46:47], v4 offset:34816
    ds_read_b64_tr_b16 v[48:49], v5 offset:2048
    ds_read_b64_tr_b16 v[50:51], v5 offset:6656
    s_waitcnt lgkmcnt(15)
    s_mul_i32 s31, s28, 36864
    s_add_u32 s31, s31, 0x7a00000
    buffer_store_dwordx4 v[16:19], v9, s[4:7], s31 offen
    s_waitcnt lgkmcnt(14)
    s_mul_i32 s31, s28, 36864
    s_add_u32 s31, s31, 0x7a00000
    buffer_store_dwordx4 v[20:23], v10, s[4:7], s31 offen
    s_waitcnt lgkmcnt(12)
    s_mul_i32 s31, s28, 36864
    s_add_u32 s31, s31, 0x7a02400
    buffer_store_dwordx4 v[24:27], v9, s[4:7], s31 offen
    s_waitcnt lgkmcnt(10)
    s_mul_i32 s31, s28, 36864
    s_add_u32 s31, s31, 0x7a02400
    buffer_store_dwordx4 v[28:31], v10, s[4:7], s31 offen
    s_waitcnt lgkmcnt(8)
    s_mul_i32 s31, s28, 36864
    s_add_u32 s31, s31, 0x7a04800
    buffer_store_dwordx4 v[32:35], v9, s[4:7], s31 offen
    s_waitcnt lgkmcnt(6)
    s_mul_i32 s31, s28, 36864
    s_add_u32 s31, s31, 0x7a04800
    buffer_store_dwordx4 v[36:39], v10, s[4:7], s31 offen
    s_waitcnt lgkmcnt(4)
    s_mul_i32 s31, s28, 36864
    s_add_u32 s31, s31, 0x7a06c00
    buffer_store_dwordx4 v[40:43], v9, s[4:7], s31 offen
    s_waitcnt lgkmcnt(2)
    s_mul_i32 s31, s28, 36864
    s_add_u32 s31, s31, 0x7a06c00
    buffer_store_dwordx4 v[44:47], v10, s[4:7], s31 offen
    s_waitcnt lgkmcnt(0)
    s_mov_b32 s31, 0x7a12000
    buffer_store_dwordx4 v[48:51], v12, s[4:7], s31 offen
    s_endpgm
L_k0_wi:
    s_sub_u32 s26, s2, 136
    s_mul_i32 s28, s26, 57
    s_lshr_b32 s28, s28, 12
    s_mul_i32 s27, s28, 72
    s_sub_u32 s27, s26, s27
    s_mov_b32 s8, s44
    s_mov_b32 s9, s45
    s_mov_b32 s10, 0x510000
    s_mov_b32 s11, 0x20000
    s_mul_i32 s29, s28, 2654208
    s_lshl_b32 s31, s27, 7
    s_add_u32 s29, s29, s31
    s_mul_i32 s31, s20, 663552
    s_add_u32 s29, s29, s31
    v_bfe_u32 v4, v0, 3, 3
    v_mul_u32_u24 v4, 9216, v4
    v_and_b32 v5, 7, v0
    v_lshl_add_u32 v4, v5, 4, v4
    s_add_u32 m0, s30, 0
    s_add_u32 s31, s29, 0
    buffer_load_dwordx4 v4, s[8:11], s31 offen lds
    s_add_u32 m0, s30, 1024
    s_add_u32 s31, s29, 73728
    buffer_load_dwordx4 v4, s[8:11], s31 offen lds
    s_add_u32 m0, s30, 2048
    s_add_u32 s31, s29, 147456
    buffer_load_dwordx4 v4, s[8:11], s31 offen lds
    s_add_u32 m0, s30, 3072
    s_add_u32 s31, s29, 221184
    buffer_load_dwordx4 v4, s[8:11], s31 offen lds
    s_add_u32 m0, s30, 4096
    s_add_u32 s31, s29, 294912
    buffer_load_dwordx4 v4, s[8:11], s31 offen lds
    s_add_u32 m0, s30, 5120
    s_add_u32 s31, s29, 368640
    buffer_load_dwordx4 v4, s[8:11], s31 offen lds
    s_add_u32 m0, s30, 6144
    s_add_u32 s31, s29, 442368
    buffer_load_dwordx4 v4, s[8:11], s31 offen lds
    s_add_u32 m0, s30, 7168
    s_add_u32 s31, s29, 516096
    buffer_load_dwordx4 v4, s[8:11], s31 offen lds
    s_add_u32 m0, s30, 8192
    s_add_u32 s31, s29, 589824
    buffer_load_dwordx4 v4, s[8:11], s31 offen lds
    v_lshrrev_b32 v7, 2, v2
    v_and_b32 v8, 3, v2
    s_lshl_b32 s31, s20, 5
    v_lshlrev_b32 v9, 7, v7
    v_lshl_add_u32 v9, v8, 3, v9
    v_add_u32 v9, s31, v9
    v_mul_u32_u24 v4, 1024, v3
    v_add_u32 v4, v4, v9
    v_mul_u32_u24 v5, 9216, v3
    v_add_u32 v5, v5, v9
    s_lshl_b32 s31, s27, 2
    s_add_u32 s31, s31, s20
    v_lshl_add_u32 v7, s31, 2, v7
    v_lshlrev_b32 v8, 4, v8
    v_lshl_add_u32 v8, v3, 8, v8
    s_cmp_lt_u32 s31, 144
    s_cselect_b32 s33, 1, 0
    s_cselect_b32 s34, 0, 144
    s_sub_u32 s34, s31, s34
    s_mul_i32 s35, s34, 57
    s_lshr_b32 s35, s35, 9
    s_mul_i32 s52, s35, 9
    s_sub_u32 s34, s34, s52
    s_lshl_b32 s52, s35, 1
    s_add_u32 s52, s52, s33
    s_mul_i32 s52, s52, 165888
    s_lshl_b32 s53, s34, 10
    s_add_u32 s52, s52, s53
    s_add_u32 s52, s52, 0x7b00000
    s_mul_i32 s53, s28, 9216
    s_add_u32 s54, s52, s53
    s_lshl_b32 s53, s53, 3
    s_add_u32 s52, s52, s53
    s_lshl_b32 s55, s35, 12
    s_mul_i32 s53, s28, 1152
    s_add_u32 s55, s55, s53
    s_mul_i32 s53, s33, 576
    s_add_u32 s55, s55, s53
    s_lshl_b32 s53, s34, 6
    s_add_u32 s55, s55, s53
    s_add_u32 s55, s55, 0x8410000
    v_cmp_eq_u32 vcc, 0, v3
    v_lshlrev_b32 v10, 2, v2
    s_nop 0
    v_cndmask_b32 v10, v6, v10, vcc
    s_waitcnt vmcnt(0)
    s_barrier
    ds_read_b64_tr_b16 v[16:17], v4 offset:0
    ds_read_b64_tr_b16 v[18:19], v4 offset:512
    ds_read_b64_tr_b16 v[20:21], v4 offset:4096
    ds_read_b64_tr_b16 v[22:23], v4 offset:4608
    ds_read_b64_tr_b16 v[24:25], v4 offset:9216
    ds_read_b64_tr_b16 v[26:27], v4 offset:9728
    ds_read_b64_tr_b16 v[28:29], v4 offset:13312
    ds_read_b64_tr_b16 v[30:31], v4 offset:13824
    ds_read_b64_tr_b16 v[32:33], v4 offset:18432
    ds_read_b64_tr_b16 v[34:35], v4 offset:18944
    ds_read_b64_tr_b16 v[36:37], v4 offset:22528
    ds_read_b64_tr_b16 v[38:39], v4 offset:23040
    ds_read_b64_tr_b16 v[40:41], v4 offset:27648
    ds_read_b64_tr_b16 v[42:43], v4 offset:28160
    ds_read_b64_tr_b16 v[44:45], v4 offset:31744
    ds_read_b64_tr_b16 v[46:47], v4 offset:32256
    ds_read_b64_tr_b16 v[48:49], v5 offset:8192
    ds_read_b64_tr_b16 v[50:51], v5 offset:8704
    s_waitcnt lgkmcnt(15)
    s_add_u32 s31, s52, 0
    buffer_store_dwordx4 v[16:19], v1, s[4:7], s31 offen
    s_waitcnt lgkmcnt(14)
    s_add_u32 s31, s52, 9216
    buffer_store_dwordx4 v[20:23], v1, s[4:7], s31 offen
    s_waitcnt lgkmcnt(12)
    s_add_u32 s31, s52, 18432
    buffer_store_dwordx4 v[24:27], v1, s[4:7], s31 offen
    s_waitcnt lgkmcnt(10)
    s_add_u32 s31, s52, 27648
    buffer_store_dwordx4 v[28:31], v1, s[4:7], s31 offen
    s_waitcnt lgkmcnt(8)
    s_add_u32 s31, s52, 36864
    buffer_store_dwordx4 v[32:35], v1, s[4:7], s31 offen
    s_waitcnt lgkmcnt(6)
    s_add_u32 s31, s52, 46080
    buffer_store_dwordx4 v[36:39], v1, s[4:7], s31 offen
    s_waitcnt lgkmcnt(4)
    s_add_u32 s31, s52, 55296
    buffer_store_dwordx4 v[40:43], v1, s[4:7], s31 offen
    s_waitcnt lgkmcnt(2)
    s_add_u32 s31, s52, 64512
    buffer_store_dwordx4 v[44:47], v1, s[4:7], s31 offen
    s_waitcnt lgkmcnt(0)
    s_add_u32 s31, s54, 147456
    buffer_store_dwordx4 v[48:51], v1, s[4:7], s31 offen
    v_mov_b32 v12, 0
    v_mov_b32 v13, 0
    v_dot2_f32_bf16 v12, v16, v11, v12
    v_dot2_f32_bf16 v13, v17, v11, v13
    v_dot2_f32_bf16 v12, v18, v11, v12
    v_dot2_f32_bf16 v13, v19, v11, v13
    v_dot2_f32_bf16 v12, v20, v11, v12
    v_dot2_f32_bf16 v13, v21, v11, v13
    v_dot2_f32_bf16 v12, v22, v11, v12
    v_dot2_f32_bf16 v13, v23, v11, v13
    v_dot2_f32_bf16 v12, v24, v11, v12
    v_dot2_f32_bf16 v13, v25, v11, v13
    v_dot2_f32_bf16 v12, v26, v11, v12
    v_dot2_f32_bf16 v13, v27, v11, v13
    v_dot2_f32_bf16 v12, v28, v11, v12
    v_dot2_f32_bf16 v13, v29, v11, v13
    v_dot2_f32_bf16 v12, v30, v11, v12
    v_dot2_f32_bf16 v13, v31, v11, v13
    v_dot2_f32_bf16 v12, v32, v11, v12
    v_dot2_f32_bf16 v13, v33, v11, v13
    v_dot2_f32_bf16 v12, v34, v11, v12
    v_dot2_f32_bf16 v13, v35, v11, v13
    v_dot2_f32_bf16 v12, v36, v11, v12
    v_dot2_f32_bf16 v13, v37, v11, v13
    v_dot2_f32_bf16 v12, v38, v11, v12
    v_dot2_f32_bf16 v13, v39, v11, v13
    v_dot2_f32_bf16 v12, v40, v11, v12
    v_dot2_f32_bf16 v13, v41, v11, v13
    v_dot2_f32_bf16 v12, v42, v11, v12
    v_dot2_f32_bf16 v13, v43, v11, v13
    v_dot2_f32_bf16 v12, v44, v11, v12
    v_dot2_f32_bf16 v13, v45, v11, v13
    v_dot2_f32_bf16 v12, v46, v11, v12
    v_dot2_f32_bf16 v13, v47, v11, v13
    v_dot2_f32_bf16 v12, v48, v11, v12
    v_dot2_f32_bf16 v13, v49, v11, v13
    v_dot2_f32_bf16 v12, v50, v11, v12
    v_dot2_f32_bf16 v13, v51, v11, v13
    s_nop 2
    v_add_f32 v12, v12, v13
    v_mov_b32 v13, v12
    s_nop 1
    v_permlane32_swap_b32 v12, v13
    v_add_f32 v12, v12, v13
    v_mov_b32 v13, v12
    s_nop 1
    v_permlane16_swap_b32 v12, v13
    v_add_f32 v12, v12, v13
    buffer_store_dword v12, v10, s[4:7], s55 offen
    s_endpgm
L_k0_wq:
    s_sub_u32 s26, s2, 0
    s_mul_i32 s28, s26, 19
    s_lshr_b32 s28, s28, 9
    s_mul_i32 s27, s28, 27
    s_sub_u32 s27, s26, s27
    s_mov_b32 s8, s38
    s_mov_b32 s9, s39
    s_mov_b32 s10, 0x1e6000
    s_mov_b32 s11, 0x20000
    s_mul_i32 s29, s28, 995328
    s_lshl_b32 s31, s27, 7
    s_add_u32 s29, s29, s31
    s_mul_i32 s31, s20, 248832
    s_add_u32 s29, s29, s31
    v_bfe_u32 v4, v0, 3, 3
    v_mul_u32_u24 v4, 3456, v4
    v_and_b32 v5, 7, v0
    v_lshl_add_u32 v4, v5, 4, v4
    s_add_u32 m0, s30, 0
    s_add_u32 s31, s29, 0
    buffer_load_dwordx4 v4, s[8:11], s31 offen lds
    s_add_u32 m0, s30, 1024
    s_add_u32 s31, s29, 27648
    buffer_load_dwordx4 v4, s[8:11], s31 offen lds
    s_add_u32 m0, s30, 2048
    s_add_u32 s31, s29, 55296
    buffer_load_dwordx4 v4, s[8:11], s31 offen lds
    s_add_u32 m0, s30, 3072
    s_add_u32 s31, s29, 82944
    buffer_load_dwordx4 v4, s[8:11], s31 offen lds
    s_add_u32 m0, s30, 4096
    s_add_u32 s31, s29, 110592
    buffer_load_dwordx4 v4, s[8:11], s31 offen lds
    s_add_u32 m0, s30, 5120
    s_add_u32 s31, s29, 138240
    buffer_load_dwordx4 v4, s[8:11], s31 offen lds
    s_add_u32 m0, s30, 6144
    s_add_u32 s31, s29, 165888
    buffer_load_dwordx4 v4, s[8:11], s31 offen lds
    s_add_u32 m0, s30, 7168
    s_add_u32 s31, s29, 193536
    buffer_load_dwordx4 v4, s[8:11], s31 offen lds
    s_add_u32 m0, s30, 8192
    s_add_u32 s31, s29, 221184
    buffer_load_dwordx4 v4, s[8:11], s31 offen lds
    v_lshrrev_b32 v7, 2, v2
    v_and_b32 v8, 3, v2
    s_lshl_b32 s31, s20, 5
    v_lshlrev_b32 v9, 7, v7
    v_lshl_add_u32 v9, v8, 3, v9
    v_add_u32 v9, s31, v9
    v_mul_u32_u24 v4, 1024, v3
    v_add_u32 v4, v4, v9
    v_mul_u32_u24 v5, 9216, v3
    v_add_u32 v5, v5, v9
    s_lshl_b32 s31, s27, 2
    s_add_u32 s31, s31, s20
    v_lshl_add_u32 v7, s31, 2, v7
    v_lshlrev_b32 v8, 4, v8
    v_lshl_add_u32 v8, v3, 8, v8
    v_mul_u32_u24 v9, 57, v7
    v_lshrrev_b32 v9, 13, v9
    v_mul_u32_u24 v10, 144, v9
    v_sub_u32 v10, v7, v10
    v_mul_u32_u24 v12, 57, v10
    v_lshrrev_b32 v12, 9, v12
    v_mul_u32_u24 v13, 9, v12
    v_sub_u32 v13, v10, v13
    v_cmp_lt_u32 s[52:53], 4, v13
    v_cmp_eq_u32 s[54:55], 4, v13
    v_cmp_eq_u32 s[56:57], 2, v9
    v_lshlrev_b32 v14, 1, v9
    v_add_u32 v15, 1, v14
    v_subrev_u32 v10, 5, v13
    v_cndmask_b32 v14, v14, v15, s[52:53]
    v_cndmask_b32 v13, v13, v10, s[52:53]
    v_cndmask_b32 v14, v14, 6, s[54:55]
    v_cndmask_b32 v13, v13, v9, s[54:55]
    s_and_b64 s[56:57], s[56:57], s[54:55]
    s_mov_b32 s33, 129024
    v_mul_lo_u32 v9, v12, s33
    v_add_u32 v9, v9, v8
    v_lshl_add_u32 v9, v14, 10, v9
    v_lshl_add_u32 v9, v13, 6, v9
    v_add_u32 v15, 64, v9
    v_cndmask_b32 v15, v6, v15, s[56:57]
    v_and_b32 v10, 3, v2
    v_lshlrev_b32 v10, 2, v10
    v_lshl_add_u32 v10, v13, 4, v10
    v_lshl_add_u32 v10, v14, 6, v10
    v_lshl_add_u32 v10, v12, 10, v10
    v_cmp_eq_u32 vcc, 0, v3
    s_lshl_b32 s55, s28, 9
    s_add_u32 s55, s55, 0x8400000
    v_cndmask_b32 v10, v6, v10, vcc
    s_mul_i32 s53, s28, 7168
    s_add_u32 s54, s53, 0x781c000
    s_lshl_b32 s53, s53, 3
    s_add_u32 s52, s53, 0x7800000
    v_mov_b32 v52, 0
    v_mov_b32 v53, 0
    v_mov_b32 v54, 0
    v_mov_b32 v55, 0
    s_cmp_eq_u64 s[56:57], 0
    s_cbranch_scc1 L_k0_np
    s_add_u32 s31, s52, 0
    buffer_store_dwordx4 v[52:55], v15, s[4:7], s31 offen
    s_add_u32 s31, s52, 7168
    buffer_store_dwordx4 v[52:55], v15, s[4:7], s31 offen
    s_add_u32 s31, s52, 14336
    buffer_store_dwordx4 v[52:55], v15, s[4:7], s31 offen
    s_add_u32 s31, s52, 21504
    buffer_store_dwordx4 v[52:55], v15, s[4:7], s31 offen
    s_add_u32 s31, s52, 28672
    buffer_store_dwordx4 v[52:55], v15, s[4:7], s31 offen
    s_add_u32 s31, s52, 35840
    buffer_store_dwordx4 v[52:55], v15, s[4:7], s31 offen
    s_add_u32 s31, s52, 43008
    buffer_store_dwordx4 v[52:55], v15, s[4:7], s31 offen
    s_add_u32 s31, s52, 50176
    buffer_store_dwordx4 v[52:55], v15, s[4:7], s31 offen
    s_mov_b32 s31, s54
    buffer_store_dwordx4 v[52:55], v15, s[4:7], s31 offen
L_k0_np:
    s_waitcnt vmcnt(0)
    s_barrier
    ds_read_b64_tr_b16 v[16:17], v4 offset:0
    ds_read_b64_tr_b16 v[18:19], v4 offset:512
    ds_read_b64_tr_b16 v[20:21], v4 offset:4096
    ds_read_b64_tr_b16 v[22:23], v4 offset:4608
    ds_read_b64_tr_b16 v[24:25], v4 offset:9216
    ds_read_b64_tr_b16 v[26:27], v4 offset:9728
    ds_read_b64_tr_b16 v[28:29], v4 offset:13312
    ds_read_b64_tr_b16 v[30:31], v4 offset:13824
    ds_read_b64_tr_b16 v[32:33], v4 offset:18432
    ds_read_b64_tr_b16 v[34:35], v4 offset:18944
    ds_read_b64_tr_b16 v[36:37], v4 offset:22528
    ds_read_b64_tr_b16 v[38:39], v4 offset:23040
    ds_read_b64_tr_b16 v[40:41], v4 offset:27648
    ds_read_b64_tr_b16 v[42:43], v4 offset:28160
    ds_read_b64_tr_b16 v[44:45], v4 offset:31744
    ds_read_b64_tr_b16 v[46:47], v4 offset:32256
    ds_read_b64_tr_b16 v[48:49], v5 offset:8192
    ds_read_b64_tr_b16 v[50:51], v5 offset:8704
    s_waitcnt lgkmcnt(15)
    s_add_u32 s31, s52, 0
    buffer_store_dwordx4 v[16:19], v9, s[4:7], s31 offen
    s_waitcnt lgkmcnt(14)
    s_add_u32 s31, s52, 7168
    buffer_store_dwordx4 v[20:23], v9, s[4:7], s31 offen
    s_waitcnt lgkmcnt(12)
    s_add_u32 s31, s52, 14336
    buffer_store_dwordx4 v[24:27], v9, s[4:7], s31 offen
    s_waitcnt lgkmcnt(10)
    s_add_u32 s31, s52, 21504
    buffer_store_dwordx4 v[28:31], v9, s[4:7], s31 offen
    s_waitcnt lgkmcnt(8)
    s_add_u32 s31, s52, 28672
    buffer_store_dwordx4 v[32:35], v9, s[4:7], s31 offen
    s_waitcnt lgkmcnt(6)
    s_add_u32 s31, s52, 35840
    buffer_store_dwordx4 v[36:39], v9, s[4:7], s31 offen
    s_waitcnt lgkmcnt(4)
    s_add_u32 s31, s52, 43008
    buffer_store_dwordx4 v[40:43], v9, s[4:7], s31 offen
    s_waitcnt lgkmcnt(2)
    s_add_u32 s31, s52, 50176
    buffer_store_dwordx4 v[44:47], v9, s[4:7], s31 offen
    s_waitcnt lgkmcnt(0)
    s_mov_b32 s31, s54
    buffer_store_dwordx4 v[48:51], v9, s[4:7], s31 offen
    v_mov_b32 v12, 0
    v_mov_b32 v13, 0
    v_dot2_f32_bf16 v12, v16, v11, v12
    v_dot2_f32_bf16 v13, v17, v11, v13
    v_dot2_f32_bf16 v12, v18, v11, v12
    v_dot2_f32_bf16 v13, v19, v11, v13
    v_dot2_f32_bf16 v12, v20, v11, v12
    v_dot2_f32_bf16 v13, v21, v11, v13
    v_dot2_f32_bf16 v12, v22, v11, v12
    v_dot2_f32_bf16 v13, v23, v11, v13
    v_dot2_f32_bf16 v12, v24, v11, v12
    v_dot2_f32_bf16 v13, v25, v11, v13
    v_dot2_f32_bf16 v12, v26, v11, v12
    v_dot2_f32_bf16 v13, v27, v11, v13
    v_dot2_f32_bf16 v12, v28, v11, v12
    v_dot2_f32_bf16 v13, v29, v11, v13
    v_dot2_f32_bf16 v12, v30, v11, v12
    v_dot2_f32_bf16 v13, v31, v11, v13
    v_dot2_f32_bf16 v12, v32, v11, v12
    v_dot2_f32_bf16 v13, v33, v11, v13
    v_dot2_f32_bf16 v12, v34, v11, v12
    v_dot2_f32_bf16 v13, v35, v11, v13
    v_dot2_f32_bf16 v12, v36, v11, v12
    v_dot2_f32_bf16 v13, v37, v11, v13
    v_dot2_f32_bf16 v12, v38, v11, v12
    v_dot2_f32_bf16 v13, v39, v11, v13
    v_dot2_f32_bf16 v12, v40, v11, v12
    v_dot2_f32_bf16 v13, v41, v11, v13
    v_dot2_f32_bf16 v12, v42, v11, v12
    v_dot2_f32_bf16 v13, v43, v11, v13
    v_dot2_f32_bf16 v12, v44, v11, v12
    v_dot2_f32_bf16 v13, v45, v11, v13
    v_dot2_f32_bf16 v12, v46, v11, v12
    v_dot2_f32_bf16 v13, v47, v11, v13
    v_dot2_f32_bf16 v12, v48, v11, v12
    v_dot2_f32_bf16 v13, v49, v11, v13
    v_dot2_f32_bf16 v12, v50, v11, v12
    v_dot2_f32_bf16 v13, v51, v11, v13
    s_nop 2
    v_add_f32 v12, v12, v13
    v_mov_b32 v13, v12
    s_nop 1
    v_permlane32_swap_b32 v12, v13
    v_add_f32 v12, v12, v13
    v_mov_b32 v13, v12
    s_nop 1
    v_permlane16_swap_b32 v12, v13
    v_add_f32 v12, v12, v13
    buffer_store_dword v12, v10, s[4:7], s55 offen
    s_endpgm
L_k0_x:
    s_mov_b32 s8, s36
    s_mov_b32 s9, s37
    s_mov_b32 s10, 0x240000
    s_mov_b32 s11, 0x20000
    s_sub_u32 s26, s2, 54
    s_mul_i32 s29, s26, 36864
    s_add_u32 s29, s29, s30
    s_add_u32 m0, s30, 0
    s_add_u32 s31, s29, 0
    buffer_load_dwordx4 v1, s[8:11], s31 offen lds
    s_add_u32 m0, s30, 1024
    s_add_u32 s31, s29, 1024
    buffer_load_dwordx4 v1, s[8:11], s31 offen lds
    s_add_u32 m0, s30, 2048
    s_add_u32 s31, s29, 2048
    buffer_load_dwordx4 v1, s[8:11], s31 offen lds
    s_add_u32 m0, s30, 3072
    s_add_u32 s31, s29, 3072
    buffer_load_dwordx4 v1, s[8:11], s31 offen lds
    s_add_u32 m0, s30, 4096
    s_add_u32 s31, s29, 4096
    buffer_load_dwordx4 v1, s[8:11], s31 offen lds
    s_add_u32 m0, s30, 5120
    s_add_u32 s31, s29, 5120
    buffer_load_dwordx4 v1, s[8:11], s31 offen lds
    s_add_u32 m0, s30, 6144
    s_add_u32 s31, s29, 6144
    buffer_load_dwordx4 v1, s[8:11], s31 offen lds
    s_add_u32 m0, s30, 7168
    s_add_u32 s31, s29, 7168
    buffer_load_dwordx4 v1, s[8:11], s31 offen lds
    s_add_u32 m0, s30, 8192
    s_add_u32 s31, s29, 8192
    buffer_load_dwordx4 v1, s[8:11], s31 offen lds
    s_lshr_b32 s32, s20, 1
    s_and_b32 s33, s20, 1
    s_mul_i32 s34, s32, 18432
    s_mul_i32 s35, s33, 576
    s_add_u32 s34, s34, s35
    v_mul_u32_u24 v7, 1152, v2
    v_add_u32 v7, s34, v7
    v_lshl_add_u32 v4, v3, 4, v7
    v_mul_u32_u24 v5, 144, v3
    v_add_u32 v5, v5, v7
    s_lshl_b32 s52, s26, 1
    s_add_u32 s52, s52, s32
    s_lshl_b32 s55, s52, 10
    s_lshl_b32 s53, s33, 3
    s_add_u32 s55, s55, s53
    s_add_u32 s55, s55, 0x2400000
    s_mul_i32 s52, s52, 18432
    s_add_u32 s52, s52, 0x0
    s_lshl_b32 s53, s33, 10
    s_add_u32 s54, s52, s53
    s_lshl_b32 s53, s33, 13
    s_add_u32 s52, s52, s53
    s_waitcnt vmcnt(0)
    s_barrier
    ds_read_b128 v[16:19], v4 offset:0
    ds_read_b128 v[20:23], v4 offset:64
    ds_read_b128 v[24:27], v4 offset:144
    ds_read_b128 v[28:31], v4 offset:208
    ds_read_b128 v[32:35], v4 offset:288
    ds_read_b128 v[36:39], v4 offset:352
    ds_read_b128 v[40:43], v4 offset:432
    ds_read_b128 v[44:47], v4 offset:496
    ds_read_b128 v[48:51], v5 offset:128
    s_waitcnt lgkmcnt(8)
    s_add_u32 s31, s52, 0
    buffer_store_dwordx4 v[16:19], v1, s[4:7], s31 offen
    s_waitcnt lgkmcnt(7)
    s_add_u32 s31, s52, 1024
    buffer_store_dwordx4 v[20:23], v1, s[4:7], s31 offen
    s_waitcnt lgkmcnt(6)
    s_add_u32 s31, s52, 2048
    buffer_store_dwordx4 v[24:27], v1, s[4:7], s31 offen
    s_waitcnt lgkmcnt(5)
    s_add_u32 s31, s52, 3072
    buffer_store_dwordx4 v[28:31], v1, s[4:7], s31 offen
    s_waitcnt lgkmcnt(4)
    s_add_u32 s31, s52, 4096
    buffer_store_dwordx4 v[32:35], v1, s[4:7], s31 offen
    s_waitcnt lgkmcnt(3)
    s_add_u32 s31, s52, 5120
    buffer_store_dwordx4 v[36:39], v1, s[4:7], s31 offen
    s_waitcnt lgkmcnt(2)
    s_add_u32 s31, s52, 6144
    buffer_store_dwordx4 v[40:43], v1, s[4:7], s31 offen
    s_waitcnt lgkmcnt(1)
    s_add_u32 s31, s52, 7168
    buffer_store_dwordx4 v[44:47], v1, s[4:7], s31 offen
    s_waitcnt lgkmcnt(0)
    s_add_u32 s31, s54, 16384
    buffer_store_dwordx4 v[48:51], v1, s[4:7], s31 offen
    v_mov_b32 v12, 0
    v_mov_b32 v13, 0
    v_dot2_f32_bf16 v12, v16, v11, v12
    v_dot2_f32_bf16 v13, v16, v16, v13
    v_dot2_f32_bf16 v12, v17, v11, v12
    v_dot2_f32_bf16 v13, v17, v17, v13
    v_dot2_f32_bf16 v12, v18, v11, v12
    v_dot2_f32_bf16 v13, v18, v18, v13
    v_dot2_f32_bf16 v12, v19, v11, v12
    v_dot2_f32_bf16 v13, v19, v19, v13
    v_dot2_f32_bf16 v12, v20, v11, v12
    v_dot2_f32_bf16 v13, v20, v20, v13
    v_dot2_f32_bf16 v12, v21, v11, v12
    v_dot2_f32_bf16 v13, v21, v21, v13
    v_dot2_f32_bf16 v12, v22, v11, v12
    v_dot2_f32_bf16 v13, v22, v22, v13
    v_dot2_f32_bf16 v12, v23, v11, v12
    v_dot2_f32_bf16 v13, v23, v23, v13
    v_dot2_f32_bf16 v12, v24, v11, v12
    v_dot2_f32_bf16 v13, v24, v24, v13
    v_dot2_f32_bf16 v12, v25, v11, v12
    v_dot2_f32_bf16 v13, v25, v25, v13
    v_dot2_f32_bf16 v12, v26, v11, v12
    v_dot2_f32_bf16 v13, v26, v26, v13
    v_dot2_f32_bf16 v12, v27, v11, v12
    v_dot2_f32_bf16 v13, v27, v27, v13
    v_dot2_f32_bf16 v12, v28, v11, v12
    v_dot2_f32_bf16 v13, v28, v28, v13
    v_dot2_f32_bf16 v12, v29, v11, v12
    v_dot2_f32_bf16 v13, v29, v29, v13
    v_dot2_f32_bf16 v12, v30, v11, v12
    v_dot2_f32_bf16 v13, v30, v30, v13
    v_dot2_f32_bf16 v12, v31, v11, v12
    v_dot2_f32_bf16 v13, v31, v31, v13
    v_dot2_f32_bf16 v12, v32, v11, v12
    v_dot2_f32_bf16 v13, v32, v32, v13
    v_dot2_f32_bf16 v12, v33, v11, v12
    v_dot2_f32_bf16 v13, v33, v33, v13
    v_dot2_f32_bf16 v12, v34, v11, v12
    v_dot2_f32_bf16 v13, v34, v34, v13
    v_dot2_f32_bf16 v12, v35, v11, v12
    v_dot2_f32_bf16 v13, v35, v35, v13
    v_dot2_f32_bf16 v12, v36, v11, v12
    v_dot2_f32_bf16 v13, v36, v36, v13
    v_dot2_f32_bf16 v12, v37, v11, v12
    v_dot2_f32_bf16 v13, v37, v37, v13
    v_dot2_f32_bf16 v12, v38, v11, v12
    v_dot2_f32_bf16 v13, v38, v38, v13
    v_dot2_f32_bf16 v12, v39, v11, v12
    v_dot2_f32_bf16 v13, v39, v39, v13
    v_dot2_f32_bf16 v12, v40, v11, v12
    v_dot2_f32_bf16 v13, v40, v40, v13
    v_dot2_f32_bf16 v12, v41, v11, v12
    v_dot2_f32_bf16 v13, v41, v41, v13
    v_dot2_f32_bf16 v12, v42, v11, v12
    v_dot2_f32_bf16 v13, v42, v42, v13
    v_dot2_f32_bf16 v12, v43, v11, v12
    v_dot2_f32_bf16 v13, v43, v43, v13
    v_dot2_f32_bf16 v12, v44, v11, v12
    v_dot2_f32_bf16 v13, v44, v44, v13
    v_dot2_f32_bf16 v12, v45, v11, v12
    v_dot2_f32_bf16 v13, v45, v45, v13
    v_dot2_f32_bf16 v12, v46, v11, v12
    v_dot2_f32_bf16 v13, v46, v46, v13
    v_dot2_f32_bf16 v12, v47, v11, v12
    v_dot2_f32_bf16 v13, v47, v47, v13
    v_dot2_f32_bf16 v12, v48, v11, v12
    v_dot2_f32_bf16 v13, v48, v48, v13
    v_dot2_f32_bf16 v12, v49, v11, v12
    v_dot2_f32_bf16 v13, v49, v49, v13
    v_dot2_f32_bf16 v12, v50, v11, v12
    v_dot2_f32_bf16 v13, v50, v50, v13
    v_dot2_f32_bf16 v12, v51, v11, v12
    v_dot2_f32_bf16 v13, v51, v51, v13
    s_nop 2
    buffer_store_dwordx2 v[12:13], v1, s[4:7], s55 offen
L_k0_end:
    s_endpgm

.globl mega_kernel
.p2align 8
.type mega_kernel,@function
mega_kernel:
    s_mov_b32 s22, 0
    s_cmp_ge_u32 s2, 256
    s_cbranch_scc1 L_end_m
    s_load_dwordx2 s[24:25], s[0:1], 80
    s_load_dwordx4 s[28:31], s[0:1], 40
    s_load_dwordx2 s[26:27], s[0:1], 64
    v_lshrrev_b32 v2, 6, v0
    v_and_b32 v1, 63, v0
    v_lshlrev_b32 v1, 4, v1
    v_readfirstlane_b32 s23, v2
    v_mov_b32 v2, 163832
    v_mov_b32 v3, 0
    ds_write_b32 v2, v3
    s_mul_i32 s21, s22, 0x2800000
    s_and_b32 s20, s23, 3
    s_waitcnt lgkmcnt(0)
    s_mov_b32 s4, s24
    s_mov_b32 s5, s25
    s_mov_b32 s6, 0x10000000
    s_mov_b32 s7, 0x20000
    s_mov_b32 s8, s28
    s_mov_b32 s9, s29
    s_mov_b32 s10, 0x800000
    s_mov_b32 s11, 0x20000
    s_mov_b32 s12, s30
    s_mov_b32 s13, s31
    s_mov_b32 s14, 0x1000
    s_mov_b32 s15, 0x20000
    s_mov_b32 s16, s26
    s_mov_b32 s17, s27
    s_mov_b32 s18, 0x240000
    s_mov_b32 s19, 0x20000
    s_cmp_ge_u32 s23, 4
    s_cbranch_scc1 L_ld_m
L_m_cl:
    s_and_b32 s25, s2, 7
    s_lshr_b32 s26, s2, 3
    s_lshl_b32 s23, s25, 1
    s_lshr_b32 s27, s26, 4
    s_add_u32 s23, s23, s27
    s_and_b32 s24, s26, 15
    s_lshl_b32 s30, s23, 3
    s_lshl_b32 s31, s20, 1
    s_add_u32 s31, s30, s31
    s_mul_i32 s29, s31, 18432
    s_add_u32 s29, s29, s21
    s_add_u32 s35, s29, 0x600000
    s_add_u32 s29, s29, 0x0
    s_max_u32 s30, s30, 1
    s_sub_u32 s30, s30, 1
    s_lshl_b32 s30, s30, 10
    s_add_u32 s30, s30, s21
    s_add_u32 s30, s30, 0x2400000
    s_lshl_b32 s32, s31, 10
    s_add_u32 s32, s32, s21
    s_add_u32 s32, s32, 0x2400000
    v_and_b32 v2, 15, v0
    v_bfe_u32 v3, v0, 4, 2
    s_add_u32 s33, s20, 2
    s_add_u32 s34, s20, 4
    s_cmp_ge_u32 s20, 2
    s_cselect_b32 s33, 6, s33
    s_cselect_b32 s34, 6, s34
    s_lshl_b32 s36, s33, 10
    s_lshl_b32 s37, s34, 10
    v_mov_b32 v246, v1
    v_add_u32 v247, 64512, v1
    v_add_u32 v248, 131072, v1
    v_add_u32 v249, s36, v1
    v_add_u32 v250, s36, v247
    v_add_u32 v251, s37, v1
    v_add_u32 v252, s37, v247
    v_add_u32 v253, 18432, v1
    v_mov_b32 v16, 0
    v_mov_b32 v17, 0
    v_mov_b32 v18, 0
    v_mov_b32 v19, 0
    v_mov_b32 v20, 0
    v_mov_b32 v21, 0
    v_mov_b32 v22, 0
    v_mov_b32 v23, 0
    v_mov_b32 v24, 0
    v_mov_b32 v25, 0
    v_mov_b32 v26, 0
    v_mov_b32 v27, 0
    v_mov_b32 v28, 0
    v_mov_b32 v29, 0
    v_mov_b32 v30, 0
    v_mov_b32 v31, 0
    v_mov_b32 v32, 0
    v_mov_b32 v33, 0
    v_mov_b32 v34, 0
    v_mov_b32 v35, 0
    v_mov_b32 v36, 0
    v_mov_b32 v37, 0
    v_mov_b32 v38, 0
    v_mov_b32 v39, 0
    v_mov_b32 v40, 0
    v_mov_b32 v41, 0
    v_mov_b32 v42, 0
    v_mov_b32 v43, 0
    v_mov_b32 v44, 0
    v_mov_b32 v45, 0
    v_mov_b32 v46, 0
    v_mov_b32 v47, 0
    v_mov_b32 v48, 0
    v_mov_b32 v49, 0
    v_mov_b32 v50, 0
    v_mov_b32 v51, 0
    v_mov_b32 v52, 0
    v_mov_b32 v53, 0
    v_mov_b32 v54, 0
    v_mov_b32 v55, 0
    v_mov_b32 v56, 0
    v_mov_b32 v57, 0
    v_mov_b32 v58, 0
    v_mov_b32 v59, 0
    v_mov_b32 v60, 0
    v_mov_b32 v61, 0
    v_mov_b32 v62, 0
    v_mov_b32 v63, 0
    v_mov_b32 v64, 0
    v_mov_b32 v65, 0
    v_mov_b32 v66, 0
    v_mov_b32 v67, 0
    v_mov_b32 v68, 0
    v_mov_b32 v69, 0
    v_mov_b32 v70, 0
    v_mov_b32 v71, 0
    v_mov_b32 v72, 0
    v_mov_b32 v73, 0
    v_mov_b32 v74, 0
    v_mov_b32 v75, 0
    v_mov_b32 v76, 0
    v_mov_b32 v77, 0
    v_mov_b32 v78, 0
    v_mov_b32 v79, 0
    v_mov_b32 v80, 0
    v_mov_b32 v81, 0
    v_mov_b32 v82, 0
    v_mov_b32 v83, 0
    v_mov_b32 v84, 0
    v_mov_b32 v85, 0
    v_mov_b32 v86, 0
    v_mov_b32 v87, 0
    s_cmp_eq_u32 s22, 0
    s_cbranch_scc1 L_m_nodep
    s_max_u32 s44, s23, 1
    s_sub_u32 s44, s44, 1
    s_min_u32 s47, s23, 1
    s_lshl_b32 s47, s47, 8
    s_lshl_b32 s46, s22, 8
    s_add_u32 s46, s46, s44
    s_lshl_b32 s46, s46, 8
    s_add_u32 s46, s46, 0x850c000
    s_sub_u32 s46, s46, 65536
    s_waitcnt vmcnt(0)
    v_mov_b32 v4, 1
    v_mov_b32 v5, 163832
    v_mov_b32 v6, 0
    v_writelane_b32 v6, s47, 1
    s_mov_b64 exec, 1
    ds_add_rtn_u32 v7, v5, v4
    s_waitcnt lgkmcnt(0)
    v_and_b32 v7, 3, v7
    v_cmp_eq_u32 vcc, 3, v7
    s_nop 0
    s_cbranch_vccz L_sk_d1
    buffer_atomic_add v4, v6, s[4:7], s45 offen sc1
    s_mov_b64 exec, 3
    s_mov_b32 s60, 65536
L_poll_d1:
    buffer_load_dword v7, v6, s[4:7], s46 offen sc1
    s_waitcnt vmcnt(0)
    v_cmp_gt_u32 vcc, 16, v7
    s_sub_u32 s60, s60, 1
    s_cbranch_scc1 L_pd_d1
    s_cbranch_vccz L_pd_d1
    s_sleep 4
    s_branch L_poll_d1
L_pd_d1:
L_sk_d1:
    s_mov_b64 exec, -1
L_m_nodep:
    s_barrier
    s_add_u32 s38, s29, 0
    s_add_u32 s39, s29, 4096
    s_add_u32 s40, s29, 8192
    s_add_u32 s41, s29, 12288
    s_add_u32 s42, s29, 16384
    buffer_load_dwordx4 v[168:171], v1, s[4:7], s38 offen offset:0 sc1
    buffer_load_dwordx4 v[172:175], v253, s[4:7], s38 offen offset:0 sc1
    buffer_load_dwordx4 v[4:7], v1, s[4:7], s30 offen sc1
    buffer_load_dwordx4 v[8:11], v1, s[4:7], s32 offen offset:0 sc1
    buffer_load_dwordx4 v[12:15], v1, s[4:7], s32 offen offset:1024 sc1
    buffer_load_dwordx4 v[176:179], v1, s[4:7], s38 offen offset:1024 sc1
    buffer_load_dwordx4 v[180:183], v253, s[4:7], s38 offen offset:1024 sc1
    buffer_load_dwordx4 v[184:187], v1, s[4:7], s38 offen offset:2048 sc1
    buffer_load_dwordx4 v[188:191], v253, s[4:7], s38 offen offset:2048 sc1
    buffer_load_dwordx4 v[192:195], v1, s[4:7], s38 offen offset:3072 sc1
    buffer_load_dwordx4 v[196:199], v253, s[4:7], s38 offen offset:3072 sc1
    buffer_load_dwordx4 v[200:203], v1, s[4:7], s39 offen offset:0 sc1
    buffer_load_dwordx4 v[204:207], v253, s[4:7], s39 offen offset:0 sc1
    s_barrier
    ds_read_b128 v[88:91], v246 offset:0
    ds_read_b128 v[92:95], v246 offset:1024
    ds_read_b128 v[96:99], v246 offset:2048
    ds_read_b128 v[100:103], v246 offset:3072
    ds_read_b128 v[104:107], v246 offset:4096
    ds_read_b128 v[108:111], v246 offset:5120
    ds_read_b128 v[112:115], v246 offset:6144
    ds_read_b128 v[116:119], v248 offset:0
    ds_read_b128 v[120:123], v249 offset:0
    ds_read_b128 v[124:127], v251 offset:0
    s_waitcnt vmcnt(11) lgkmcnt(6)
    v_mfma_f32_16x16x32_bf16 v[16:19], v[88:91], v[168:171], v[16:19]
    ds_read_b128 v[128:131], v246 offset:7168
    v_mfma_f32_16x16x32_bf16 v[48:51], v[88:91], v[172:175], v[48:51]
    ds_read_b128 v[132:135], v246 offset:8192
    v_mfma_f32_16x16x32_bf16 v[20:23], v[92:95], v[168:171], v[20:23]
    ds_read_b128 v[136:139], v246 offset:9216
    v_mfma_f32_16x16x32_bf16 v[52:55], v[92:95], v[172:175], v[52:55]
    ds_read_b128 v[140:143], v246 offset:10240
    v_mfma_f32_16x16x32_bf16 v[24:27], v[96:99], v[168:171], v[24:27]
    ds_read_b128 v[144:147], v246 offset:11264
    v_mfma_f32_16x16x32_bf16 v[56:59], v[96:99], v[172:175], v[56:59]
    ds_read_b128 v[148:151], v246 offset:12288
    v_mfma_f32_16x16x32_bf16 v[28:31], v[100:103], v[168:171], v[28:31]
    ds_read_b128 v[152:155], v246 offset:13312
    v_mfma_f32_16x16x32_bf16 v[60:63], v[100:103], v[172:175], v[60:63]
    ds_read_b128 v[156:159], v248 offset:1024
    s_waitcnt lgkmcnt(8)
    v_mfma_f32_16x16x32_bf16 v[36:39], v[168:171], v[104:107], v[36:39]
    ds_read_b128 v[160:163], v249 offset:7168
    v_mfma_f32_16x16x32_bf16 v[68:71], v[172:175], v[104:107], v[68:71]
    ds_read_b128 v[164:167], v251 offset:7168
    v_mfma_f32_16x16x32_bf16 v[40:43], v[168:171], v[108:111], v[40:43]
    buffer_load_dwordx4 v[208:211], v1, s[4:7], s39 offen offset:1024 sc1
    v_mfma_f32_16x16x32_bf16 v[72:75], v[172:175], v[108:111], v[72:75]
    v_mfma_f32_16x16x32_bf16 v[32:35], v[112:115], v[168:171], v[32:35]
    buffer_load_dwordx4 v[212:215], v253, s[4:7], s39 offen offset:1024 sc1
    v_mfma_f32_16x16x32_bf16 v[64:67], v[112:115], v[172:175], v[64:67]
    v_mfma_f32_16x16x32_bf16 v[44:47], v[168:171], v[112:115], v[44:47]
    buffer_load_dwordx4 v[216:219], v1, s[4:7], s39 offen offset:2048 sc1
    v_mfma_f32_16x16x32_bf16 v[76:79], v[172:175], v[112:115], v[76:79]
    v_mfma_f32_16x16x32_bf16 v[80:83], v[120:123], v[116:119], v[80:83]
    buffer_load_dwordx4 v[220:223], v253, s[4:7], s39 offen offset:2048 sc1
    v_mfma_f32_16x16x32_bf16 v[84:87], v[116:119], v[124:127], v[84:87]
    s_waitcnt vmcnt(10) lgkmcnt(6)
    s_barrier
    v_mfma_f32_16x16x32_bf16 v[16:19], v[128:131], v[176:179], v[16:19]
    ds_read_b128 v[88:91], v246 offset:14336
    v_mfma_f32_16x16x32_bf16 v[48:51], v[128:131], v[180:183], v[48:51]
    ds_read_b128 v[92:95], v246 offset:15360
    v_mfma_f32_16x16x32_bf16 v[20:23], v[132:135], v[176:179], v[20:23]
    ds_read_b128 v[96:99], v246 offset:16384
    v_mfma_f32_16x16x32_bf16 v[52:55], v[132:135], v[180:183], v[52:55]
    ds_read_b128 v[100:103], v246 offset:17408
    v_mfma_f32_16x16x32_bf16 v[24:27], v[136:139], v[176:179], v[24:27]
    ds_read_b128 v[104:107], v246 offset:18432
    v_mfma_f32_16x16x32_bf16 v[56:59], v[136:139], v[180:183], v[56:59]
    ds_read_b128 v[108:111], v246 offset:19456
    v_mfma_f32_16x16x32_bf16 v[28:31], v[140:143], v[176:179], v[28:31]
    ds_read_b128 v[112:115], v246 offset:20480
    v_mfma_f32_16x16x32_bf16 v[60:63], v[140:143], v[180:183], v[60:63]
    ds_read_b128 v[116:119], v248 offset:2048
    s_waitcnt lgkmcnt(8)
    v_mfma_f32_16x16x32_bf16 v[36:39], v[176:179], v[144:147], v[36:39]
    ds_read_b128 v[120:123], v249 offset:14336
    v_mfma_f32_16x16x32_bf16 v[68:71], v[180:183], v[144:147], v[68:71]
    ds_read_b128 v[124:127], v251 offset:14336
    v_mfma_f32_16x16x32_bf16 v[40:43], v[176:179], v[148:151], v[40:43]
    buffer_load_dwordx4 v[224:227], v1, s[4:7], s39 offen offset:3072 sc1
    v_add_f32 v240, v4, v6
    v_mfma_f32_16x16x32_bf16 v[72:75], v[180:183], v[148:151], v[72:75]
    v_add_f32 v241, v5, v7
    v_mfma_f32_16x16x32_bf16 v[32:35], v[152:155], v[176:179], v[32:35]
    buffer_load_dwordx4 v[228:231], v253, s[4:7], s39 offen offset:3072 sc1
    v_add_f32 v242, v8, v10
    v_mfma_f32_16x16x32_bf16 v[64:67], v[152:155], v[180:183], v[64:67]
    v_add_f32 v243, v9, v11
    v_mfma_f32_16x16x32_bf16 v[44:47], v[176:179], v[152:155], v[44:47]
    buffer_load_dwordx4 v[232:235], v1, s[4:7], s40 offen offset:0 sc1
    v_add_f32 v244, v12, v14
    v_mfma_f32_16x16x32_bf16 v[76:79], v[180:183], v[152:155], v[76:79]
    v_add_f32 v245, v13, v15
    v_mfma_f32_16x16x32_bf16 v[80:83], v[160:163], v[156:159], v[80:83]
    buffer_load_dwordx4 v[236:239], v253, s[4:7], s40 offen offset:0 sc1
    v_mov_b32 v4, v240
    v_mfma_f32_16x16x32_bf16 v[84:87], v[156:159], v[164:167], v[84:87]
    v_mov_b32 v5, v241
    s_waitcnt vmcnt(12) lgkmcnt(6)
    v_mfma_f32_16x16x32_bf16 v[16:19], v[88:91], v[184:187], v[16:19]
    ds_read_b128 v[128:131], v246 offset:21504
    v_mfma_f32_16x16x32_bf16 v[48:51], v[88:91], v[188:191], v[48:51]
    ds_read_b128 v[132:135], v246 offset:22528
    v_mfma_f32_16x16x32_bf16 v[20:23], v[92:95], v[184:187], v[20:23]
    ds_read_b128 v[136:139], v246 offset:23552
    v_mfma_f32_16x16x32_bf16 v[52:55], v[92:95], v[188:191], v[52:55]
    ds_read_b128 v[140:143], v246 offset:24576
    v_mfma_f32_16x16x32_bf16 v[24:27], v[96:99], v[184:187], v[24:27]
    ds_read_b128 v[144:147], v246 offset:25600
    v_mfma_f32_16x16x32_bf16 v[56:59], v[96:99], v[188:191], v[56:59]
    ds_read_b128 v[148:151], v246 offset:26624
    v_mfma_f32_16x16x32_bf16 v[28:31], v[100:103], v[184:187], v[28:31]
    ds_read_b128 v[152:155], v246 offset:27648
    v_mfma_f32_16x16x32_bf16 v[60:63], v[100:103], v[188:191], v[60:63]
    ds_read_b128 v[156:159], v248 offset:3072
    s_waitcnt lgkmcnt(8)
    v_mfma_f32_16x16x32_bf16 v[36:39], v[184:187], v[104:107], v[36:39]
    ds_read_b128 v[160:163], v249 offset:21504
    v_mfma_f32_16x16x32_bf16 v[68:71], v[188:191], v[104:107], v[68:71]
    ds_read_b128 v[164:167], v251 offset:21504
    v_mfma_f32_16x16x32_bf16 v[40:43], v[184:187], v[108:111], v[40:43]
    buffer_load_dwordx4 v[168:171], v1, s[4:7], s40 offen offset:1024 sc1
    v_mov_b32 v8, v242
    v_mfma_f32_16x16x32_bf16 v[72:75], v[188:191], v[108:111], v[72:75]
    v_mov_b32 v9, v243
    v_mfma_f32_16x16x32_bf16 v[32:35], v[112:115], v[184:187], v[32:35]
    buffer_load_dwordx4 v[172:175], v253, s[4:7], s40 offen offset:1024 sc1
    v_mov_b32 v12, v244
    v_mfma_f32_16x16x32_bf16 v[64:67], v[112:115], v[188:191], v[64:67]
    v_mov_b32 v13, v245
    v_mfma_f32_16x16x32_bf16 v[44:47], v[184:187], v[112:115], v[44:47]
    buffer_load_dwordx4 v[176:179], v1, s[4:7], s40 offen offset:2048 sc1
    v_permlane32_swap_b32 v240, v4
    v_mfma_f32_16x16x32_bf16 v[76:79], v[188:191], v[112:115], v[76:79]
    v_permlane32_swap_b32 v241, v5
    v_mfma_f32_16x16x32_bf16 v[80:83], v[120:123], v[116:119], v[80:83]
    buffer_load_dwordx4 v[180:183], v253, s[4:7], s40 offen offset:2048 sc1
    v_permlane32_swap_b32 v242, v8
    v_mfma_f32_16x16x32_bf16 v[84:87], v[116:119], v[124:127], v[84:87]
    v_permlane32_swap_b32 v243, v9
    s_waitcnt vmcnt(14) lgkmcnt(6)
    s_barrier
    v_mfma_f32_16x16x32_bf16 v[16:19], v[128:131], v[192:195], v[16:19]
    ds_read_b128 v[88:91], v246 offset:28672
    v_mfma_f32_16x16x32_bf16 v[48:51], v[128:131], v[196:199], v[48:51]
    ds_read_b128 v[92:95], v246 offset:29696
    v_mfma_f32_16x16x32_bf16 v[20:23], v[132:135], v[192:195], v[20:23]
    ds_read_b128 v[96:99], v246 offset:30720
    v_mfma_f32_16x16x32_bf16 v[52:55], v[132:135], v[196:199], v[52:55]
    ds_read_b128 v[100:103], v246 offset:31744
    v_mfma_f32_16x16x32_bf16 v[24:27], v[136:139], v[192:195], v[24:27]
    ds_read_b128 v[104:107], v246 offset:32768
    v_mfma_f32_16x16x32_bf16 v[56:59], v[136:139], v[196:199], v[56:59]
    ds_read_b128 v[108:111], v246 offset:33792
    v_mfma_f32_16x16x32_bf16 v[28:31], v[140:143], v[192:195], v[28:31]
    ds_read_b128 v[112:115], v246 offset:34816
    v_mfma_f32_16x16x32_bf16 v[60:63], v[140:143], v[196:199], v[60:63]
    ds_read_b128 v[116:119], v248 offset:4096
    s_waitcnt lgkmcnt(8)
    v_mfma_f32_16x16x32_bf16 v[36:39], v[192:195], v[144:147], v[36:39]
    ds_read_b128 v[120:123], v249 offset:28672
    v_mfma_f32_16x16x32_bf16 v[68:71], v[196:199], v[144:147], v[68:71]
    ds_read_b128 v[124:127], v251 offset:28672
    v_mfma_f32_16x16x32_bf16 v[40:43], v[192:195], v[148:151], v[40:43]
    buffer_load_dwordx4 v[184:187], v1, s[4:7], s40 offen offset:3072 sc1
    v_permlane32_swap_b32 v244, v12
    v_mfma_f32_16x16x32_bf16 v[72:75], v[196:199], v[148:151], v[72:75]
    v_permlane32_swap_b32 v245, v13
    v_mfma_f32_16x16x32_bf16 v[32:35], v[152:155], v[192:195], v[32:35]
    buffer_load_dwordx4 v[188:191], v253, s[4:7], s40 offen offset:3072 sc1
    v_add_f32 v240, v240, v4
    v_mfma_f32_16x16x32_bf16 v[64:67], v[152:155], v[196:199], v[64:67]
    v_add_f32 v241, v241, v5
    v_mfma_f32_16x16x32_bf16 v[44:47], v[192:195], v[152:155], v[44:47]
    v_add_f32 v242, v242, v8
    v_mfma_f32_16x16x32_bf16 v[76:79], v[196:199], v[152:155], v[76:79]
    v_add_f32 v243, v243, v9
    v_mfma_f32_16x16x32_bf16 v[80:83], v[160:163], v[156:159], v[80:83]
    v_add_f32 v244, v244, v12
    v_mfma_f32_16x16x32_bf16 v[84:87], v[156:159], v[164:167], v[84:87]
    v_add_f32 v245, v245, v13
    s_waitcnt vmcnt(14) lgkmcnt(6)
    v_mfma_f32_16x16x32_bf16 v[16:19], v[88:91], v[200:203], v[16:19]
    ds_read_b128 v[128:131], v246 offset:35840
    v_mfma_f32_16x16x32_bf16 v[48:51], v[88:91], v[204:207], v[48:51]
    ds_read_b128 v[132:135], v246 offset:36864
    v_mfma_f32_16x16x32_bf16 v[20:23], v[92:95], v[200:203], v[20:23]
    ds_read_b128 v[136:139], v246 offset:37888
    v_mfma_f32_16x16x32_bf16 v[52:55], v[92:95], v[204:207], v[52:55]
    ds_read_b128 v[140:143], v246 offset:38912
    v_mfma_f32_16x16x32_bf16 v[24:27], v[96:99], v[200:203], v[24:27]
    ds_read_b128 v[144:147], v246 offset:39936
    v_mfma_f32_16x16x32_bf16 v[56:59], v[96:99], v[204:207], v[56:59]
    ds_read_b128 v[148:151], v246 offset:40960
    v_mfma_f32_16x16x32_bf16 v[28:31], v[100:103], v[200:203], v[28:31]
    ds_read_b128 v[152:155], v246 offset:41984
    v_mfma_f32_16x16x32_bf16 v[60:63], v[100:103], v[204:207], v[60:63]
    ds_read_b128 v[156:159], v248 offset:5120
    s_waitcnt lgkmcnt(8)
    v_mfma_f32_16x16x32_bf16 v[36:39], v[200:203], v[104:107], v[36:39]
    ds_read_b128 v[160:163], v249 offset:35840
    v_mfma_f32_16x16x32_bf16 v[68:71], v[204:207], v[104:107], v[68:71]
    ds_read_b128 v[164:167], v251 offset:35840
    v_mfma_f32_16x16x32_bf16 v[40:43], v[200:203], v[108:111], v[40:43]
    buffer_load_dwordx4 v[192:195], v1, s[4:7], s41 offen offset:0 sc1
    v_mov_b32 v4, v240
    v_mfma_f32_16x16x32_bf16 v[72:75], v[204:207], v[108:111], v[72:75]
    v_mov_b32 v5, v241
    v_mfma_f32_16x16x32_bf16 v[32:35], v[112:115], v[200:203], v[32:35]
    buffer_load_dwordx4 v[196:199], v253, s[4:7], s41 offen offset:0 sc1
    v_mov_b32 v8, v242
    v_mfma_f32_16x16x32_bf16 v[64:67], v[112:115], v[204:207], v[64:67]
    v_mov_b32 v9, v243
    v_mfma_f32_16x16x32_bf16 v[44:47], v[200:203], v[112:115], v[44:47]
    v_mov_b32 v12, v244
    v_mfma_f32_16x16x32_bf16 v[76:79], v[204:207], v[112:115], v[76:79]
    v_mov_b32 v13, v245
    v_mfma_f32_16x16x32_bf16 v[80:83], v[120:123], v[116:119], v[80:83]
    v_permlane16_swap_b32 v240, v4
    v_mfma_f32_16x16x32_bf16 v[84:87], v[116:119], v[124:127], v[84:87]
    v_permlane16_swap_b32 v241, v5
    s_waitcnt vmcnt(14) lgkmcnt(6)
    s_barrier
    v_mfma_f32_16x16x32_bf16 v[16:19], v[128:131], v[208:211], v[16:19]
    ds_read_b128 v[88:91], v246 offset:43008
    v_mfma_f32_16x16x32_bf16 v[48:51], v[128:131], v[212:215], v[48:51]
    ds_read_b128 v[92:95], v246 offset:44032
    v_mfma_f32_16x16x32_bf16 v[20:23], v[132:135], v[208:211], v[20:23]
    ds_read_b128 v[96:99], v246 offset:45056
    v_mfma_f32_16x16x32_bf16 v[52:55], v[132:135], v[212:215], v[52:55]
    ds_read_b128 v[100:103], v246 offset:46080
    v_mfma_f32_16x16x32_bf16 v[24:27], v[136:139], v[208:211], v[24:27]
    ds_read_b128 v[104:107], v246 offset:47104
    v_mfma_f32_16x16x32_bf16 v[56:59], v[136:139], v[212:215], v[56:59]
    ds_read_b128 v[108:111], v246 offset:48128
    v_mfma_f32_16x16x32_bf16 v[28:31], v[140:143], v[208:211], v[28:31]
    ds_read_b128 v[112:115], v246 offset:49152
    v_mfma_f32_16x16x32_bf16 v[60:63], v[140:143], v[212:215], v[60:63]
    ds_read_b128 v[116:119], v248 offset:6144
    s_waitcnt lgkmcnt(8)
    v_mfma_f32_16x16x32_bf16 v[36:39], v[208:211], v[144:147], v[36:39]
    ds_read_b128 v[120:123], v249 offset:43008
    v_mfma_f32_16x16x32_bf16 v[68:71], v[212:215], v[144:147], v[68:71]
    ds_read_b128 v[124:127], v251 offset:43008
    v_mfma_f32_16x16x32_bf16 v[40:43], v[208:211], v[148:151], v[40:43]
    buffer_load_dwordx4 v[200:203], v1, s[4:7], s41 offen offset:1024 sc1
    v_permlane16_swap_b32 v242, v8
    v_mfma_f32_16x16x32_bf16 v[72:75], v[212:215], v[148:151], v[72:75]
    v_permlane16_swap_b32 v243, v9
    v_mfma_f32_16x16x32_bf16 v[32:35], v[152:155], v[208:211], v[32:35]
    buffer_load_dwordx4 v[204:207], v253, s[4:7], s41 offen offset:1024 sc1
    v_permlane16_swap_b32 v244, v12
    v_mfma_f32_16x16x32_bf16 v[64:67], v[152:155], v[212:215], v[64:67]
    v_permlane16_swap_b32 v245, v13
    v_mfma_f32_16x16x32_bf16 v[44:47], v[208:211], v[152:155], v[44:47]
    v_add_f32 v240, v240, v4
    v_mfma_f32_16x16x32_bf16 v[76:79], v[212:215], v[152:155], v[76:79]
    v_add_f32 v241, v241, v5
    v_mfma_f32_16x16x32_bf16 v[80:83], v[160:163], v[156:159], v[80:83]
    v_add_f32 v242, v242, v8
    v_mfma_f32_16x16x32_bf16 v[84:87], v[156:159], v[164:167], v[84:87]
    v_add_f32 v243, v243, v9
    s_waitcnt vmcnt(14) lgkmcnt(6)
    v_mfma_f32_16x16x32_bf16 v[16:19], v[88:91], v[216:219], v[16:19]
    ds_read_b128 v[128:131], v246 offset:50176
    v_mfma_f32_16x16x32_bf16 v[48:51], v[88:91], v[220:223], v[48:51]
    ds_read_b128 v[132:135], v246 offset:51200
    v_mfma_f32_16x16x32_bf16 v[20:23], v[92:95], v[216:219], v[20:23]
    ds_read_b128 v[136:139], v246 offset:52224
    v_mfma_f32_16x16x32_bf16 v[52:55], v[92:95], v[220:223], v[52:55]
    ds_read_b128 v[140:143], v246 offset:53248
    v_mfma_f32_16x16x32_bf16 v[24:27], v[96:99], v[216:219], v[24:27]
    ds_read_b128 v[144:147], v246 offset:54272
    v_mfma_f32_16x16x32_bf16 v[56:59], v[96:99], v[220:223], v[56:59]
    ds_read_b128 v[148:151], v246 offset:55296
    v_mfma_f32_16x16x32_bf16 v[28:31], v[100:103], v[216:219], v[28:31]
    ds_read_b128 v[152:155], v246 offset:56320
    v_mfma_f32_16x16x32_bf16 v[60:63], v[100:103], v[220:223], v[60:63]
    ds_read_b128 v[156:159], v248 offset:7168
    s_waitcnt lgkmcnt(8)
    v_mfma_f32_16x16x32_bf16 v[36:39], v[216:219], v[104:107], v[36:39]
    ds_read_b128 v[160:163], v249 offset:50176
    v_mfma_f32_16x16x32_bf16 v[68:71], v[220:223], v[104:107], v[68:71]
    ds_read_b128 v[164:167], v251 offset:50176
    v_mfma_f32_16x16x32_bf16 v[40:43], v[216:219], v[108:111], v[40:43]
    buffer_load_dwordx4 v[208:211], v1, s[4:7], s41 offen offset:2048 sc1
    v_add_f32 v244, v244, v12
    v_mfma_f32_16x16x32_bf16 v[72:75], v[220:223], v[108:111], v[72:75]
    v_add_f32 v245, v245, v13
    v_mfma_f32_16x16x32_bf16 v[32:35], v[112:115], v[216:219], v[32:35]
    buffer_load_dwordx4 v[212:215], v253, s[4:7], s41 offen offset:2048 sc1
    v_mul_f32 v240, 0x3ae38e39, v240
    v_mfma_f32_16x16x32_bf16 v[64:67], v[112:115], v[220:223], v[64:67]
    v_mul_f32 v241, 0x3ae38e39, v241
    v_mfma_f32_16x16x32_bf16 v[44:47], v[216:219], v[112:115], v[44:47]
    v_mul_f32 v242, 0x3ae38e39, v242
    v_mfma_f32_16x16x32_bf16 v[76:79], v[220:223], v[112:115], v[76:79]
    v_mul_f32 v243, 0x3ae38e39, v243
    v_mfma_f32_16x16x32_bf16 v[80:83], v[120:123], v[116:119], v[80:83]
    v_mul_f32 v244, 0x3ae38e39, v244
    v_mfma_f32_16x16x32_bf16 v[84:87], v[116:119], v[124:127], v[84:87]
    v_mul_f32 v245, 0x3ae38e39, v245
    s_waitcnt vmcnt(14) lgkmcnt(6)
    v_mfma_f32_16x16x32_bf16 v[16:19], v[128:131], v[224:227], v[16:19]
    ds_read_b128 v[88:91], v246 offset:57344
    v_mfma_f32_16x16x32_bf16 v[48:51], v[128:131], v[228:231], v[48:51]
    ds_read_b128 v[92:95], v246 offset:58368
    v_mfma_f32_16x16x32_bf16 v[20:23], v[132:135], v[224:227], v[20:23]
    ds_read_b128 v[96:99], v246 offset:59392
    v_mfma_f32_16x16x32_bf16 v[52:55], v[132:135], v[228:231], v[52:55]
    ds_read_b128 v[100:103], v246 offset:60416
    v_mfma_f32_16x16x32_bf16 v[24:27], v[136:139], v[224:227], v[24:27]
    ds_read_b128 v[104:107], v246 offset:61440
    v_mfma_f32_16x16x32_bf16 v[56:59], v[136:139], v[228:231], v[56:59]
    ds_read_b128 v[108:111], v246 offset:62464
    v_mfma_f32_16x16x32_bf16 v[28:31], v[140:143], v[224:227], v[28:31]
    ds_read_b128 v[112:115], v246 offset:63488
    v_mfma_f32_16x16x32_bf16 v[60:63], v[140:143], v[228:231], v[60:63]
    ds_read_b128 v[116:119], v248 offset:8192
    s_waitcnt lgkmcnt(8)
    v_mfma_f32_16x16x32_bf16 v[36:39], v[224:227], v[144:147], v[36:39]
    ds_read_b128 v[120:123], v249 offset:57344
    v_mfma_f32_16x16x32_bf16 v[68:71], v[228:231], v[144:147], v[68:71]
    ds_read_b128 v[124:127], v251 offset:57344
    v_mfma_f32_16x16x32_bf16 v[40:43], v[224:227], v[148:151], v[40:43]
    buffer_load_dwordx4 v[216:219], v1, s[4:7], s41 offen offset:3072 sc1
    v_fma_f32 v241, -v240, v240, v241
    v_mfma_f32_16x16x32_bf16 v[72:75], v[228:231], v[148:151], v[72:75]
    v_fma_f32 v243, -v242, v242, v243
    v_mfma_f32_16x16x32_bf16 v[32:35], v[152:155], v[224:227], v[32:35]
    buffer_load_dwordx4 v[220:223], v253, s[4:7], s41 offen offset:3072 sc1
    v_fma_f32 v245, -v244, v244, v245
    v_mfma_f32_16x16x32_bf16 v[64:67], v[152:155], v[228:231], v[64:67]
    v_max_f32 v241, 0, v241
    v_mfma_f32_16x16x32_bf16 v[44:47], v[224:227], v[152:155], v[44:47]
    v_max_f32 v243, 0, v243
    v_mfma_f32_16x16x32_bf16 v[76:79], v[228:231], v[152:155], v[76:79]
    v_max_f32 v245, 0, v245
    v_mfma_f32_16x16x32_bf16 v[80:83], v[160:163], v[156:159], v[80:83]
    v_add_f32 v241, 0x3727c5ac, v241
    v_mfma_f32_16x16x32_bf16 v[84:87], v[156:159], v[164:167], v[84:87]
    v_add_f32 v243, 0x3727c5ac, v243
    s_waitcnt vmcnt(14) lgkmcnt(6)
    s_barrier
    v_mfma_f32_16x16x32_bf16 v[16:19], v[88:91], v[232:235], v[16:19]
    ds_read_b128 v[128:131], v247 offset:0
    v_mfma_f32_16x16x32_bf16 v[48:51], v[88:91], v[236:239], v[48:51]
    ds_read_b128 v[132:135], v247 offset:1024
    v_mfma_f32_16x16x32_bf16 v[20:23], v[92:95], v[232:235], v[20:23]
    ds_read_b128 v[136:139], v247 offset:2048
    v_mfma_f32_16x16x32_bf16 v[52:55], v[92:95], v[236:239], v[52:55]
    ds_read_b128 v[140:143], v247 offset:3072
    v_mfma_f32_16x16x32_bf16 v[24:27], v[96:99], v[232:235], v[24:27]
    ds_read_b128 v[144:147], v247 offset:4096
    v_mfma_f32_16x16x32_bf16 v[56:59], v[96:99], v[236:239], v[56:59]
    ds_read_b128 v[148:151], v247 offset:5120
    v_mfma_f32_16x16x32_bf16 v[28:31], v[100:103], v[232:235], v[28:31]
    ds_read_b128 v[152:155], v247 offset:6144
    v_mfma_f32_16x16x32_bf16 v[60:63], v[100:103], v[236:239], v[60:63]
    ds_read_b128 v[156:159], v248 offset:9216
    s_waitcnt lgkmcnt(8)
    v_mfma_f32_16x16x32_bf16 v[36:39], v[232:235], v[104:107], v[36:39]
    ds_read_b128 v[160:163], v250 offset:0
    v_mfma_f32_16x16x32_bf16 v[68:71], v[236:239], v[104:107], v[68:71]
    ds_read_b128 v[164:167], v252 offset:0
    v_mfma_f32_16x16x32_bf16 v[40:43], v[232:235], v[108:111], v[40:43]
    buffer_load_dwordx4 v[224:227], v1, s[4:7], s42 offen offset:0 sc1
    v_add_f32 v245, 0x3727c5ac, v245
    v_mfma_f32_16x16x32_bf16 v[72:75], v[236:239], v[108:111], v[72:75]
    v_rsq_f32 v241, v241
    v_mfma_f32_16x16x32_bf16 v[32:35], v[112:115], v[232:235], v[32:35]
    buffer_load_dwordx4 v[228:231], v253, s[4:7], s42 offen offset:0 sc1
    v_rsq_f32 v243, v243
    v_mfma_f32_16x16x32_bf16 v[64:67], v[112:115], v[236:239], v[64:67]
    v_rsq_f32 v245, v245
    v_mfma_f32_16x16x32_bf16 v[44:47], v[232:235], v[112:115], v[44:47]
    s_nop 0
    v_mfma_f32_16x16x32_bf16 v[76:79], v[236:239], v[112:115], v[76:79]
    v_mfma_f32_16x16x32_bf16 v[80:83], v[120:123], v[116:119], v[80:83]
    v_mfma_f32_16x16x32_bf16 v[84:87], v[116:119], v[124:127], v[84:87]
    s_waitcnt vmcnt(14) lgkmcnt(6)
    v_mfma_f32_16x16x32_bf16 v[16:19], v[128:131], v[168:171], v[16:19]
    ds_read_b128 v[88:91], v247 offset:7168
    v_mfma_f32_16x16x32_bf16 v[48:51], v[128:131], v[172:175], v[48:51]
    ds_read_b128 v[92:95], v247 offset:8192
    v_mfma_f32_16x16x32_bf16 v[20:23], v[132:135], v[168:171], v[20:23]
    ds_read_b128 v[96:99], v247 offset:9216
    v_mfma_f32_16x16x32_bf16 v[52:55], v[132:135], v[172:175], v[52:55]
    ds_read_b128 v[100:103], v247 offset:10240
    v_mfma_f32_16x16x32_bf16 v[24:27], v[136:139], v[168:171], v[24:27]
    ds_read_b128 v[104:107], v247 offset:11264
    v_mfma_f32_16x16x32_bf16 v[56:59], v[136:139], v[172:175], v[56:59]
    ds_read_b128 v[108:111], v247 offset:12288
    v_mfma_f32_16x16x32_bf16 v[28:31], v[140:143], v[168:171], v[28:31]
    ds_read_b128 v[112:115], v247 offset:13312
    v_mfma_f32_16x16x32_bf16 v[60:63], v[140:143], v[172:175], v[60:63]
    ds_read_b128 v[116:119], v248 offset:10240
    s_waitcnt lgkmcnt(8)
    v_mfma_f32_16x16x32_bf16 v[36:39], v[168:171], v[144:147], v[36:39]
    ds_read_b128 v[120:123], v250 offset:7168
    v_mfma_f32_16x16x32_bf16 v[68:71], v[172:175], v[144:147], v[68:71]
    ds_read_b128 v[124:127], v252 offset:7168
    v_mfma_f32_16x16x32_bf16 v[40:43], v[168:171], v[148:151], v[40:43]
    buffer_load_dwordx4 v[232:235], v1, s[4:7], s42 offen offset:1024 sc1
    v_mfma_f32_16x16x32_bf16 v[72:75], v[172:175], v[148:151], v[72:75]
    v_mfma_f32_16x16x32_bf16 v[32:35], v[152:155], v[168:171], v[32:35]
    buffer_load_dwordx4 v[236:239], v253, s[4:7], s42 offen offset:1024 sc1
    v_mfma_f32_16x16x32_bf16 v[64:67], v[152:155], v[172:175], v[64:67]
    v_mfma_f32_16x16x32_bf16 v[44:47], v[168:171], v[152:155], v[44:47]
    v_mfma_f32_16x16x32_bf16 v[76:79], v[172:175], v[152:155], v[76:79]
    v_mfma_f32_16x16x32_bf16 v[80:83], v[160:163], v[156:159], v[80:83]
    v_mfma_f32_16x16x32_bf16 v[84:87], v[156:159], v[164:167], v[84:87]
    s_waitcnt vmcnt(14) lgkmcnt(6)
    s_barrier
    v_mfma_f32_16x16x32_bf16 v[16:19], v[88:91], v[176:179], v[16:19]
    ds_read_b128 v[128:131], v247 offset:14336
    v_mfma_f32_16x16x32_bf16 v[48:51], v[88:91], v[180:183], v[48:51]
    ds_read_b128 v[132:135], v247 offset:15360
    v_mfma_f32_16x16x32_bf16 v[20:23], v[92:95], v[176:179], v[20:23]
    ds_read_b128 v[136:139], v247 offset:16384
    v_mfma_f32_16x16x32_bf16 v[52:55], v[92:95], v[180:183], v[52:55]
    ds_read_b128 v[140:143], v247 offset:17408
    v_mfma_f32_16x16x32_bf16 v[24:27], v[96:99], v[176:179], v[24:27]
    ds_read_b128 v[144:147], v247 offset:18432
    v_mfma_f32_16x16x32_bf16 v[56:59], v[96:99], v[180:183], v[56:59]
    ds_read_b128 v[148:151], v247 offset:19456
    v_mfma_f32_16x16x32_bf16 v[28:31], v[100:103], v[176:179], v[28:31]
    ds_read_b128 v[152:155], v247 offset:20480
    v_mfma_f32_16x16x32_bf16 v[60:63], v[100:103], v[180:183], v[60:63]
    ds_read_b128 v[156:159], v248 offset:11264
    s_waitcnt lgkmcnt(8)
    v_mfma_f32_16x16x32_bf16 v[36:39], v[176:179], v[104:107], v[36:39]
    ds_read_b128 v[160:163], v250 offset:14336
    v_mfma_f32_16x16x32_bf16 v[68:71], v[180:183], v[104:107], v[68:71]
    ds_read_b128 v[164:167], v252 offset:14336
    v_mfma_f32_16x16x32_bf16 v[40:43], v[176:179], v[108:111], v[40:43]
    v_mfma_f32_16x16x32_bf16 v[72:75], v[180:183], v[108:111], v[72:75]
    v_mfma_f32_16x16x32_bf16 v[32:35], v[112:115], v[176:179], v[32:35]
    v_mfma_f32_16x16x32_bf16 v[64:67], v[112:115], v[180:183], v[64:67]
    v_mfma_f32_16x16x32_bf16 v[44:47], v[176:179], v[112:115], v[44:47]
    v_mfma_f32_16x16x32_bf16 v[76:79], v[180:183], v[112:115], v[76:79]
    v_mfma_f32_16x16x32_bf16 v[80:83], v[120:123], v[116:119], v[80:83]
    v_mfma_f32_16x16x32_bf16 v[84:87], v[116:119], v[124:127], v[84:87]
    s_waitcnt vmcnt(12) lgkmcnt(6)
    v_mfma_f32_16x16x32_bf16 v[16:19], v[128:131], v[184:187], v[16:19]
    ds_read_b128 v[88:91], v247 offset:21504
    v_mfma_f32_16x16x32_bf16 v[48:51], v[128:131], v[188:191], v[48:51]
    ds_read_b128 v[92:95], v247 offset:22528
    v_mfma_f32_16x16x32_bf16 v[20:23], v[132:135], v[184:187], v[20:23]
    ds_read_b128 v[96:99], v247 offset:23552
    v_mfma_f32_16x16x32_bf16 v[52:55], v[132:135], v[188:191], v[52:55]
    ds_read_b128 v[100:103], v247 offset:24576
    v_mfma_f32_16x16x32_bf16 v[24:27], v[136:139], v[184:187], v[24:27]
    ds_read_b128 v[104:107], v247 offset:25600
    v_mfma_f32_16x16x32_bf16 v[56:59], v[136:139], v[188:191], v[56:59]
    ds_read_b128 v[108:111], v247 offset:26624
    v_mfma_f32_16x16x32_bf16 v[28:31], v[140:143], v[184:187], v[28:31]
    ds_read_b128 v[112:115], v247 offset:27648
    v_mfma_f32_16x16x32_bf16 v[60:63], v[140:143], v[188:191], v[60:63]
    ds_read_b128 v[116:119], v248 offset:12288
    s_waitcnt lgkmcnt(8)
    v_mfma_f32_16x16x32_bf16 v[36:39], v[184:187], v[144:147], v[36:39]
    ds_read_b128 v[120:123], v250 offset:21504
    v_mfma_f32_16x16x32_bf16 v[68:71], v[188:191], v[144:147], v[68:71]
    ds_read_b128 v[124:127], v252 offset:21504
    v_mfma_f32_16x16x32_bf16 v[40:43], v[184:187], v[148:151], v[40:43]
    v_mfma_f32_16x16x32_bf16 v[72:75], v[188:191], v[148:151], v[72:75]
    v_mfma_f32_16x16x32_bf16 v[32:35], v[152:155], v[184:187], v[32:35]
    v_mfma_f32_16x16x32_bf16 v[64:67], v[152:155], v[188:191], v[64:67]
    v_mfma_f32_16x16x32_bf16 v[44:47], v[184:187], v[152:155], v[44:47]
    v_mfma_f32_16x16x32_bf16 v[76:79], v[188:191], v[152:155], v[76:79]
    v_mfma_f32_16x16x32_bf16 v[80:83], v[160:163], v[156:159], v[80:83]
    v_mfma_f32_16x16x32_bf16 v[84:87], v[156:159], v[164:167], v[84:87]
    s_waitcnt vmcnt(10) lgkmcnt(6)
    s_barrier
    v_mfma_f32_16x16x32_bf16 v[16:19], v[88:91], v[192:195], v[16:19]
    ds_read_b128 v[128:131], v247 offset:28672
    v_mfma_f32_16x16x32_bf16 v[48:51], v[88:91], v[196:199], v[48:51]
    ds_read_b128 v[132:135], v247 offset:29696
    v_mfma_f32_16x16x32_bf16 v[20:23], v[92:95], v[192:195], v[20:23]
    ds_read_b128 v[136:139], v247 offset:30720
    v_mfma_f32_16x16x32_bf16 v[52:55], v[92:95], v[196:199], v[52:55]
    ds_read_b128 v[140:143], v247 offset:31744
    v_mfma_f32_16x16x32_bf16 v[24:27], v[96:99], v[192:195], v[24:27]
    ds_read_b128 v[144:147], v247 offset:32768
    v_mfma_f32_16x16x32_bf16 v[56:59], v[96:99], v[196:199], v[56:59]
    ds_read_b128 v[148:151], v247 offset:33792
    v_mfma_f32_16x16x32_bf16 v[28:31], v[100:103], v[192:195], v[28:31]
    ds_read_b128 v[152:155], v247 offset:34816
    v_mfma_f32_16x16x32_bf16 v[60:63], v[100:103], v[196:199], v[60:63]
    ds_read_b128 v[156:159], v248 offset:13312
    s_waitcnt lgkmcnt(8)
    v_mfma_f32_16x16x32_bf16 v[36:39], v[192:195], v[104:107], v[36:39]
    ds_read_b128 v[160:163], v250 offset:28672
    v_mfma_f32_16x16x32_bf16 v[68:71], v[196:199], v[104:107], v[68:71]
    ds_read_b128 v[164:167], v252 offset:28672
    v_mfma_f32_16x16x32_bf16 v[40:43], v[192:195], v[108:111], v[40:43]
    v_lshlrev_b32 v4, 4, v3
    v_mfma_f32_16x16x32_bf16 v[72:75], v[196:199], v[108:111], v[72:75]
    v_add_u32 v4, 161792, v4
    v_mfma_f32_16x16x32_bf16 v[32:35], v[112:115], v[192:195], v[32:35]
    s_lshl_b32 s36, s33, 6
    v_mfma_f32_16x16x32_bf16 v[64:67], v[112:115], v[196:199], v[64:67]
    v_add_u32 v5, s36, v4
    v_mfma_f32_16x16x32_bf16 v[44:47], v[192:195], v[112:115], v[44:47]
    v_lshlrev_b32 v6, 2, v2
    v_mfma_f32_16x16x32_bf16 v[76:79], v[196:199], v[112:115], v[76:79]
    v_add_u32 v6, 161792, v6
    v_mfma_f32_16x16x32_bf16 v[80:83], v[120:123], v[116:119], v[80:83]
    s_lshl_b32 s37, s34, 6
    v_mfma_f32_16x16x32_bf16 v[84:87], v[116:119], v[124:127], v[84:87]
    v_add_u32 v7, s37, v6
    s_waitcnt vmcnt(8) lgkmcnt(6)
    v_mfma_f32_16x16x32_bf16 v[16:19], v[128:131], v[200:203], v[16:19]
    ds_read_b128 v[88:91], v247 offset:35840
    v_mfma_f32_16x16x32_bf16 v[48:51], v[128:131], v[204:207], v[48:51]
    ds_read_b128 v[92:95], v247 offset:36864
    v_mfma_f32_16x16x32_bf16 v[20:23], v[132:135], v[200:203], v[20:23]
    ds_read_b128 v[96:99], v247 offset:37888
    v_mfma_f32_16x16x32_bf16 v[52:55], v[132:135], v[204:207], v[52:55]
    ds_read_b128 v[100:103], v247 offset:38912
    v_mfma_f32_16x16x32_bf16 v[24:27], v[136:139], v[200:203], v[24:27]
    ds_read_b128 v[104:107], v247 offset:39936
    v_mfma_f32_16x16x32_bf16 v[56:59], v[136:139], v[204:207], v[56:59]
    ds_read_b128 v[108:111], v247 offset:40960
    v_mfma_f32_16x16x32_bf16 v[28:31], v[140:143], v[200:203], v[28:31]
    ds_read_b128 v[112:115], v247 offset:41984
    v_mfma_f32_16x16x32_bf16 v[60:63], v[140:143], v[204:207], v[60:63]
    ds_read_b128 v[116:119], v248 offset:14336
    s_waitcnt lgkmcnt(8)
    v_mfma_f32_16x16x32_bf16 v[36:39], v[200:203], v[144:147], v[36:39]
    ds_read_b128 v[120:123], v250 offset:35840
    v_mfma_f32_16x16x32_bf16 v[68:71], v[204:207], v[144:147], v[68:71]
    ds_read_b128 v[124:127], v252 offset:35840
    v_mfma_f32_16x16x32_bf16 v[40:43], v[200:203], v[148:151], v[40:43]
    v_lshlrev_b32 v8, 4, v3
    v_mfma_f32_16x16x32_bf16 v[72:75], v[204:207], v[148:151], v[72:75]
    v_add_u32 v9, 4, v8
    v_mfma_f32_16x16x32_bf16 v[32:35], v[152:155], v[200:203], v[32:35]
    v_add_u32 v10, 8, v8
    v_mfma_f32_16x16x32_bf16 v[64:67], v[152:155], v[204:207], v[64:67]
    v_add_u32 v11, 12, v8
    v_mfma_f32_16x16x32_bf16 v[44:47], v[200:203], v[152:155], v[44:47]
    v_mfma_f32_16x16x32_bf16 v[76:79], v[204:207], v[152:155], v[76:79]
    v_mfma_f32_16x16x32_bf16 v[80:83], v[160:163], v[156:159], v[80:83]
    v_mfma_f32_16x16x32_bf16 v[84:87], v[156:159], v[164:167], v[84:87]
    s_waitcnt vmcnt(6) lgkmcnt(6)
    v_mfma_f32_16x16x32_bf16 v[16:19], v[88:91], v[208:211], v[16:19]
    ds_read_b128 v[128:131], v247 offset:43008
    v_mfma_f32_16x16x32_bf16 v[48:51], v[88:91], v[212:215], v[48:51]
    ds_read_b128 v[132:135], v247 offset:44032
    v_mfma_f32_16x16x32_bf16 v[20:23], v[92:95], v[208:211], v[20:23]
    ds_read_b128 v[136:139], v247 offset:45056
    v_mfma_f32_16x16x32_bf16 v[52:55], v[92:95], v[212:215], v[52:55]
    ds_read_b128 v[140:143], v247 offset:46080
    v_mfma_f32_16x16x32_bf16 v[24:27], v[96:99], v[208:211], v[24:27]
    ds_read_b128 v[144:147], v247 offset:47104
    v_mfma_f32_16x16x32_bf16 v[56:59], v[96:99], v[212:215], v[56:59]
    ds_read_b128 v[148:151], v247 offset:48128
    v_mfma_f32_16x16x32_bf16 v[28:31], v[100:103], v[208:211], v[28:31]
    ds_read_b128 v[152:155], v247 offset:49152
    v_mfma_f32_16x16x32_bf16 v[60:63], v[100:103], v[212:215], v[60:63]
    ds_read_b128 v[156:159], v248 offset:15360
    s_waitcnt lgkmcnt(8)
    v_mfma_f32_16x16x32_bf16 v[36:39], v[208:211], v[104:107], v[36:39]
    ds_read_b128 v[160:163], v250 offset:43008
    v_mfma_f32_16x16x32_bf16 v[68:71], v[212:215], v[104:107], v[68:71]
    ds_read_b128 v[164:167], v252 offset:43008
    v_mfma_f32_16x16x32_bf16 v[40:43], v[208:211], v[108:111], v[40:43]
    v_mfma_f32_16x16x32_bf16 v[72:75], v[212:215], v[108:111], v[72:75]
    v_mfma_f32_16x16x32_bf16 v[32:35], v[112:115], v[208:211], v[32:35]
    v_mfma_f32_16x16x32_bf16 v[64:67], v[112:115], v[212:215], v[64:67]
    v_mfma_f32_16x16x32_bf16 v[44:47], v[208:211], v[112:115], v[44:47]
    v_mfma_f32_16x16x32_bf16 v[76:79], v[212:215], v[112:115], v[76:79]
    v_mfma_f32_16x16x32_bf16 v[80:83], v[120:123], v[116:119], v[80:83]
    v_mfma_f32_16x16x32_bf16 v[84:87], v[116:119], v[124:127], v[84:87]
    s_waitcnt vmcnt(4) lgkmcnt(6)
    s_barrier
    v_mfma_f32_16x16x32_bf16 v[16:19], v[128:131], v[216:219], v[16:19]
    ds_read_b128 v[88:91], v247 offset:50176
    v_mfma_f32_16x16x32_bf16 v[48:51], v[128:131], v[220:223], v[48:51]
    ds_read_b128 v[92:95], v247 offset:51200
    v_mfma_f32_16x16x32_bf16 v[20:23], v[132:135], v[216:219], v[20:23]
    ds_read_b128 v[96:99], v247 offset:52224
    v_mfma_f32_16x16x32_bf16 v[52:55], v[132:135], v[220:223], v[52:55]
    ds_read_b128 v[100:103], v247 offset:53248
    v_mfma_f32_16x16x32_bf16 v[24:27], v[136:139], v[216:219], v[24:27]
    ds_read_b128 v[104:107], v247 offset:54272
    v_mfma_f32_16x16x32_bf16 v[56:59], v[136:139], v[220:223], v[56:59]
    ds_read_b128 v[108:111], v247 offset:55296
    v_mfma_f32_16x16x32_bf16 v[28:31], v[140:143], v[216:219], v[28:31]
    ds_read_b128 v[112:115], v247 offset:56320
    v_mfma_f32_16x16x32_bf16 v[60:63], v[140:143], v[220:223], v[60:63]
    ds_read_b128 v[116:119], v248 offset:16384
    s_waitcnt lgkmcnt(8)
    v_mfma_f32_16x16x32_bf16 v[36:39], v[216:219], v[144:147], v[36:39]
    ds_read_b128 v[120:123], v250 offset:50176
    v_mfma_f32_16x16x32_bf16 v[68:71], v[220:223], v[144:147], v[68:71]
    ds_read_b128 v[124:127], v252 offset:50176
    v_mfma_f32_16x16x32_bf16 v[40:43], v[216:219], v[148:151], v[40:43]
    v_mfma_f32_16x16x32_bf16 v[72:75], v[220:223], v[148:151], v[72:75]
    v_mfma_f32_16x16x32_bf16 v[32:35], v[152:155], v[216:219], v[32:35]
    v_mfma_f32_16x16x32_bf16 v[64:67], v[152:155], v[220:223], v[64:67]
    v_mfma_f32_16x16x32_bf16 v[44:47], v[216:219], v[152:155], v[44:47]
    v_mfma_f32_16x16x32_bf16 v[76:79], v[220:223], v[152:155], v[76:79]
    v_mfma_f32_16x16x32_bf16 v[80:83], v[160:163], v[156:159], v[80:83]
    v_mfma_f32_16x16x32_bf16 v[84:87], v[156:159], v[164:167], v[84:87]
    s_waitcnt vmcnt(2) lgkmcnt(6)
    v_mfma_f32_16x16x32_bf16 v[16:19], v[88:91], v[224:227], v[16:19]
    ds_read_b128 v[128:131], v247 offset:57344
    v_mfma_f32_16x16x32_bf16 v[48:51], v[88:91], v[228:231], v[48:51]
    ds_read_b128 v[132:135], v247 offset:58368
    v_mfma_f32_16x16x32_bf16 v[20:23], v[92:95], v[224:227], v[20:23]
    ds_read_b128 v[136:139], v247 offset:59392
    v_mfma_f32_16x16x32_bf16 v[52:55], v[92:95], v[228:231], v[52:55]
    ds_read_b128 v[140:143], v247 offset:60416
    v_mfma_f32_16x16x32_bf16 v[24:27], v[96:99], v[224:227], v[24:27]
    ds_read_b128 v[144:147], v247 offset:61440
    v_mfma_f32_16x16x32_bf16 v[56:59], v[96:99], v[228:231], v[56:59]
    ds_read_b128 v[148:151], v247 offset:62464
    v_mfma_f32_16x16x32_bf16 v[28:31], v[100:103], v[224:227], v[28:31]
    ds_read_b128 v[152:155], v247 offset:63488
    v_mfma_f32_16x16x32_bf16 v[60:63], v[100:103], v[228:231], v[60:63]
    ds_read_b128 v[156:159], v248 offset:17408
    s_waitcnt lgkmcnt(8)
    v_mfma_f32_16x16x32_bf16 v[36:39], v[224:227], v[104:107], v[36:39]
    ds_read_b128 v[160:163], v250 offset:57344
    v_mfma_f32_16x16x32_bf16 v[68:71], v[228:231], v[104:107], v[68:71]
    ds_read_b128 v[164:167], v252 offset:57344
    v_mfma_f32_16x16x32_bf16 v[40:43], v[224:227], v[108:111], v[40:43]
    v_mfma_f32_16x16x32_bf16 v[72:75], v[228:231], v[108:111], v[72:75]
    v_mfma_f32_16x16x32_bf16 v[32:35], v[112:115], v[224:227], v[32:35]
    v_mfma_f32_16x16x32_bf16 v[64:67], v[112:115], v[228:231], v[64:67]
    v_mfma_f32_16x16x32_bf16 v[44:47], v[224:227], v[112:115], v[44:47]
    v_mfma_f32_16x16x32_bf16 v[76:79], v[228:231], v[112:115], v[76:79]
    v_mfma_f32_16x16x32_bf16 v[80:83], v[120:123], v[116:119], v[80:83]
    v_mfma_f32_16x16x32_bf16 v[84:87], v[116:119], v[124:127], v[84:87]
    s_waitcnt vmcnt(0) lgkmcnt(0)
    v_mfma_f32_16x16x32_bf16 v[16:19], v[128:131], v[232:235], v[16:19]
    ds_read_b128 v[88:91], v4 offset:128
    ds_read_b128 v[168:171], v4 offset:640
    ds_read_b128 v[92:95], v4 offset:192
    v_mfma_f32_16x16x32_bf16 v[48:51], v[128:131], v[236:239], v[48:51]
    ds_read_b128 v[172:175], v4 offset:704
    ds_read_b128 v[96:99], v4 offset:384
    v_mfma_f32_16x16x32_bf16 v[20:23], v[132:135], v[232:235], v[20:23]
    ds_read_b128 v[176:179], v4 offset:896
    ds_read_b128 v[100:103], v5 offset:0
    ds_read_b128 v[180:183], v5 offset:512
    v_mfma_f32_16x16x32_bf16 v[52:55], v[132:135], v[236:239], v[52:55]
    ds_read_b128 v[104:107], v4 offset:0
    ds_read_b128 v[184:187], v4 offset:512
    v_mfma_f32_16x16x32_bf16 v[24:27], v[136:139], v[232:235], v[24:27]
    ds_read_b128 v[108:111], v4 offset:64
    ds_read_b128 v[188:191], v4 offset:576
    ds_read_b32 v112, v6 offset:256
    v_mfma_f32_16x16x32_bf16 v[56:59], v[136:139], v[236:239], v[56:59]
    ds_read_b32 v116, v6 offset:768
    ds_read_b32 v113, v6 offset:320
    v_mfma_f32_16x16x32_bf16 v[28:31], v[140:143], v[232:235], v[28:31]
    ds_read_b32 v117, v6 offset:832
    ds_read_b32 v114, v6 offset:384
    ds_read_b32 v118, v6 offset:896
    v_mfma_f32_16x16x32_bf16 v[60:63], v[140:143], v[236:239], v[60:63]
    ds_read_b32 v115, v7 offset:0
    ds_read_b32 v119, v7 offset:512
    v_mfma_f32_16x16x32_bf16 v[36:39], v[232:235], v[144:147], v[36:39]
    ds_bpermute_b32 v200, v8, v244
    ds_bpermute_b32 v212, v8, v245
    v_mfma_f32_16x16x32_bf16 v[68:71], v[236:239], v[144:147], v[68:71]
    ds_bpermute_b32 v201, v9, v244
    ds_bpermute_b32 v213, v9, v245
    ds_bpermute_b32 v202, v10, v244
    v_mfma_f32_16x16x32_bf16 v[40:43], v[232:235], v[148:151], v[40:43]
    ds_bpermute_b32 v214, v10, v245
    ds_bpermute_b32 v203, v11, v244
    v_mfma_f32_16x16x32_bf16 v[72:75], v[236:239], v[148:151], v[72:75]
    ds_bpermute_b32 v215, v11, v245
    ds_bpermute_b32 v192, v8, v240
    ds_bpermute_b32 v204, v8, v241
    v_mfma_f32_16x16x32_bf16 v[32:35], v[152:155], v[232:235], v[32:35]
    ds_bpermute_b32 v193, v9, v240
    ds_bpermute_b32 v205, v9, v241
    v_mfma_f32_16x16x32_bf16 v[64:67], v[152:155], v[236:239], v[64:67]
    ds_bpermute_b32 v194, v10, v240
    ds_bpermute_b32 v206, v10, v241
    ds_bpermute_b32 v195, v11, v240
    v_mfma_f32_16x16x32_bf16 v[44:47], v[232:235], v[152:155], v[44:47]
    ds_bpermute_b32 v207, v11, v241
    ds_bpermute_b32 v196, v8, v242
    v_mfma_f32_16x16x32_bf16 v[76:79], v[236:239], v[152:155], v[76:79]
    ds_bpermute_b32 v208, v8, v243
    ds_bpermute_b32 v197, v9, v242
    ds_bpermute_b32 v209, v9, v243
    v_mfma_f32_16x16x32_bf16 v[80:83], v[160:163], v[156:159], v[80:83]
    ds_bpermute_b32 v198, v10, v242
    ds_bpermute_b32 v210, v10, v243
    v_mfma_f32_16x16x32_bf16 v[84:87], v[156:159], v[164:167], v[84:87]
    ds_bpermute_b32 v199, v11, v242
    ds_bpermute_b32 v211, v11, v243
    v_and_b32 v4, 1, v2
    v_lshl_add_u32 v5, v3, 2, v4
    v_add_u32 v6, 2, v5
    v_cmp_eq_u32 s[40:41], 1, v4
    v_cmp_le_u32 s[42:43], v5, v2
    v_cmp_le_u32 s[44:45], v6, v2
    v_cmp_eq_u32 s[46:47], 0, v3
    v_mov_b32 v4, 0xffff
    v_mov_b32 v5, 0xffff0000
    v_cndmask_b32 v4, v4, v5, s[40:41]
    v_cndmask_b32 v12, v4, 0, s[42:43]
    v_cndmask_b32 v13, v4, 0, s[44:45]
    v_cndmask_b32 v14, 0, v4, s[42:43]
    v_cndmask_b32 v15, 0, v4, s[44:45]
    s_cmp_eq_u32 s31, 0
    s_cselect_b64 s[48:49], s[42:43], -1
    s_cselect_b64 s[50:51], s[44:45], -1
    v_lshrrev_b32 v8, 1, v1
    s_mul_i32 s36, s20, 3072
    s_add_u32 s36, s36, 149504
    v_add_u32 v9, s36, v8
    s_lshl_b32 s37, s20, 9
    s_add_u32 s37, s37, 149504
    v_add_u32 v10, s37, v8
    s_waitcnt lgkmcnt(0)
    v_pk_add_f32 v[88:89], v[88:89], v[168:169]
    v_pk_add_f32 v[90:91], v[90:91], v[170:171]
    v_pk_add_f32 v[92:93], v[92:93], v[172:173]
    v_pk_add_f32 v[94:95], v[94:95], v[174:175]
    v_pk_add_f32 v[96:97], v[96:97], v[176:177]
    v_pk_add_f32 v[98:99], v[98:99], v[178:179]
    v_pk_add_f32 v[100:101], v[100:101], v[180:181]
    v_pk_add_f32 v[102:103], v[102:103], v[182:183]
    v_pk_add_f32 v[104:105], v[104:105], v[184:185]
    v_pk_add_f32 v[106:107], v[106:107], v[186:187]
    v_pk_add_f32 v[108:109], v[108:109], v[188:189]
    v_pk_add_f32 v[110:111], v[110:111], v[190:191]
    v_pk_add_f32 v[112:113], v[112:113], v[116:117]
    v_pk_add_f32 v[114:115], v[114:115], v[118:119]
    v_pk_fma_f32 v[56:57], v[244:245], v[88:89], v[56:57] op_sel_hi:[0,1,1] neg_lo:[1,0,0] neg_hi:[1,0,0]
    v_pk_fma_f32 v[58:59], v[244:245], v[90:91], v[58:59] op_sel_hi:[0,1,1] neg_lo:[1,0,0] neg_hi:[1,0,0]
    v_pk_fma_f32 v[60:61], v[244:245], v[92:93], v[60:61] op_sel_hi:[0,1,1] neg_lo:[1,0,0] neg_hi:[1,0,0]
    v_pk_fma_f32 v[62:63], v[244:245], v[94:95], v[62:63] op_sel_hi:[0,1,1] neg_lo:[1,0,0] neg_hi:[1,0,0]
    v_pk_fma_f32 v[64:65], v[244:245], v[96:97], v[64:65] op_sel_hi:[0,1,1] neg_lo:[1,0,0] neg_hi:[1,0,0]
    v_pk_fma_f32 v[66:67], v[244:245], v[98:99], v[66:67] op_sel_hi:[0,1,1] neg_lo:[1,0,0] neg_hi:[1,0,0]
    v_pk_fma_f32 v[68:69], v[200:201], v[112:113], v[68:69] op_sel:[0,0,0] op_sel_hi:[1,0,1] neg_lo:[1,0,0] neg_hi:[1,0,0]
    v_pk_fma_f32 v[70:71], v[202:203], v[112:113], v[70:71] op_sel:[0,0,0] op_sel_hi:[1,0,1] neg_lo:[1,0,0] neg_hi:[1,0,0]
    v_pk_fma_f32 v[72:73], v[200:201], v[112:113], v[72:73] op_sel:[0,1,0] op_sel_hi:[1,1,1] neg_lo:[1,0,0] neg_hi:[1,0,0]
    v_pk_fma_f32 v[74:75], v[202:203], v[112:113], v[74:75] op_sel:[0,1,0] op_sel_hi:[1,1,1] neg_lo:[1,0,0] neg_hi:[1,0,0]
    v_pk_fma_f32 v[76:77], v[200:201], v[114:115], v[76:77] op_sel:[0,0,0] op_sel_hi:[1,0,1] neg_lo:[1,0,0] neg_hi:[1,0,0]
    v_pk_fma_f32 v[78:79], v[202:203], v[114:115], v[78:79] op_sel:[0,0,0] op_sel_hi:[1,0,1] neg_lo:[1,0,0] neg_hi:[1,0,0]
    v_pk_fma_f32 v[80:81], v[240:241], v[100:101], v[80:81] op_sel_hi:[0,1,1] neg_lo:[1,0,0] neg_hi:[1,0,0]
    v_pk_fma_f32 v[82:83], v[240:241], v[102:103], v[82:83] op_sel_hi:[0,1,1] neg_lo:[1,0,0] neg_hi:[1,0,0]
    v_pk_fma_f32 v[84:85], v[192:193], v[114:115], v[84:85] op_sel:[0,1,0] op_sel_hi:[1,1,1] neg_lo:[1,0,0] neg_hi:[1,0,0]
    v_pk_fma_f32 v[86:87], v[194:195], v[114:115], v[86:87] op_sel:[0,1,0] op_sel_hi:[1,1,1] neg_lo:[1,0,0] neg_hi:[1,0,0]
    v_pk_mul_f32 v[56:57], v[56:57], v[244:245] op_sel:[0,1] op_sel_hi:[1,1]
    v_pk_mul_f32 v[58:59], v[58:59], v[244:245] op_sel:[0,1] op_sel_hi:[1,1]
    v_pk_mul_f32 v[60:61], v[60:61], v[244:245] op_sel:[0,1] op_sel_hi:[1,1]
    v_pk_mul_f32 v[62:63], v[62:63], v[244:245] op_sel:[0,1] op_sel_hi:[1,1]
    v_pk_mul_f32 v[64:65], v[64:65], v[244:245] op_sel:[0,1] op_sel_hi:[1,1]
    v_pk_mul_f32 v[66:67], v[66:67], v[244:245] op_sel:[0,1] op_sel_hi:[1,1]
    v_pk_mul_f32 v[68:69], v[68:69], v[212:213]
    v_pk_mul_f32 v[70:71], v[70:71], v[214:215]
    v_pk_mul_f32 v[72:73], v[72:73], v[212:213]
    v_pk_mul_f32 v[74:75], v[74:75], v[214:215]
    v_pk_mul_f32 v[76:77], v[76:77], v[212:213]
    v_pk_mul_f32 v[78:79], v[78:79], v[214:215]
    v_pk_mul_f32 v[80:81], v[80:81], v[240:241] op_sel:[0,1] op_sel_hi:[1,1]
    v_pk_mul_f32 v[82:83], v[82:83], v[240:241] op_sel:[0,1] op_sel_hi:[1,1]
    v_pk_mul_f32 v[84:85], v[84:85], v[204:205]
    v_pk_mul_f32 v[86:87], v[86:87], v[206:207]
    v_cvt_pk_bf16_f32 v144, v56, v57
    v_cvt_pk_bf16_f32 v145, v58, v59
    v_cvt_pk_bf16_f32 v148, v60, v61
    v_cvt_pk_bf16_f32 v149, v62, v63
    v_cvt_pk_bf16_f32 v190, v64, v65
    v_cvt_pk_bf16_f32 v191, v66, v67
    v_cvt_pk_bf16_f32 v172, v68, v69
    v_cvt_pk_bf16_f32 v173, v70, v71
    v_cvt_pk_bf16_f32 v178, v72, v73
    v_cvt_pk_bf16_f32 v179, v74, v75
    v_cvt_pk_bf16_f32 v184, v76, v77
    v_cvt_pk_bf16_f32 v185, v78, v79
    v_cvt_pk_bf16_f32 v216, v80, v81
    v_cvt_pk_bf16_f32 v217, v82, v83
    v_cvt_pk_bf16_f32 v218, v84, v85
    v_cvt_pk_bf16_f32 v219, v86, v87
    s_cmp_eq_u32 s20, 3
    s_cbranch_scc1 L_a_nw
    ds_write_b64 v9, v[144:145] offset:3072
    ds_write_b64 v9, v[148:149] offset:3584
    ds_write_b64 v9, v[190:191] offset:4096
    ds_write_b64 v9, v[172:173] offset:4608
    ds_write_b64 v9, v[178:179] offset:5120
    ds_write_b64 v9, v[184:185] offset:5632
    ds_write_b64 v10, v[216:217]
    ds_write_b64 v10, v[218:219] offset:1536
L_a_nw:
    v_pk_fma_f32 v[24:25], v[242:243], v[88:89], v[24:25] op_sel_hi:[0,1,1] neg_lo:[1,0,0] neg_hi:[1,0,0]
    v_pk_fma_f32 v[26:27], v[242:243], v[90:91], v[26:27] op_sel_hi:[0,1,1] neg_lo:[1,0,0] neg_hi:[1,0,0]
    v_pk_fma_f32 v[28:29], v[242:243], v[92:93], v[28:29] op_sel_hi:[0,1,1] neg_lo:[1,0,0] neg_hi:[1,0,0]
    v_pk_fma_f32 v[30:31], v[242:243], v[94:95], v[30:31] op_sel_hi:[0,1,1] neg_lo:[1,0,0] neg_hi:[1,0,0]
    v_pk_fma_f32 v[32:33], v[242:243], v[96:97], v[32:33] op_sel_hi:[0,1,1] neg_lo:[1,0,0] neg_hi:[1,0,0]
    v_pk_fma_f32 v[34:35], v[242:243], v[98:99], v[34:35] op_sel_hi:[0,1,1] neg_lo:[1,0,0] neg_hi:[1,0,0]
    v_pk_fma_f32 v[36:37], v[196:197], v[112:113], v[36:37] op_sel:[0,0,0] op_sel_hi:[1,0,1] neg_lo:[1,0,0] neg_hi:[1,0,0]
    v_pk_fma_f32 v[38:39], v[198:199], v[112:113], v[38:39] op_sel:[0,0,0] op_sel_hi:[1,0,1] neg_lo:[1,0,0] neg_hi:[1,0,0]
    v_pk_fma_f32 v[40:41], v[196:197], v[112:113], v[40:41] op_sel:[0,1,0] op_sel_hi:[1,1,1] neg_lo:[1,0,0] neg_hi:[1,0,0]
    v_pk_fma_f32 v[42:43], v[198:199], v[112:113], v[42:43] op_sel:[0,1,0] op_sel_hi:[1,1,1] neg_lo:[1,0,0] neg_hi:[1,0,0]
    v_pk_fma_f32 v[44:45], v[196:197], v[114:115], v[44:45] op_sel:[0,0,0] op_sel_hi:[1,0,1] neg_lo:[1,0,0] neg_hi:[1,0,0]
    v_pk_fma_f32 v[46:47], v[198:199], v[114:115], v[46:47] op_sel:[0,0,0] op_sel_hi:[1,0,1] neg_lo:[1,0,0] neg_hi:[1,0,0]
    v_pk_mul_f32 v[24:25], v[24:25], v[242:243] op_sel:[0,1] op_sel_hi:[1,1]
    v_pk_mul_f32 v[26:27], v[26:27], v[242:243] op_sel:[0,1] op_sel_hi:[1,1]
    v_pk_mul_f32 v[28:29], v[28:29], v[242:243] op_sel:[0,1] op_sel_hi:[1,1]
    v_pk_mul_f32 v[30:31], v[30:31], v[242:243] op_sel:[0,1] op_sel_hi:[1,1]
    v_pk_mul_f32 v[32:33], v[32:33], v[242:243] op_sel:[0,1] op_sel_hi:[1,1]
    v_pk_mul_f32 v[34:35], v[34:35], v[242:243] op_sel:[0,1] op_sel_hi:[1,1]
    v_pk_mul_f32 v[36:37], v[36:37], v[208:209]
    v_pk_mul_f32 v[38:39], v[38:39], v[210:211]
    v_pk_mul_f32 v[40:41], v[40:41], v[208:209]
    v_pk_mul_f32 v[42:43], v[42:43], v[210:211]
    v_pk_mul_f32 v[44:45], v[44:45], v[208:209]
    v_pk_mul_f32 v[46:47], v[46:47], v[210:211]
    v_cvt_pk_bf16_f32 v136, v24, v25
    v_cvt_pk_bf16_f32 v137, v26, v27
    v_cvt_pk_bf16_f32 v140, v28, v29
    v_cvt_pk_bf16_f32 v141, v30, v31
    v_cvt_pk_bf16_f32 v188, v32, v33
    v_cvt_pk_bf16_f32 v189, v34, v35
    v_cvt_pk_bf16_f32 v170, v36, v37
    v_cvt_pk_bf16_f32 v171, v38, v39
    v_cvt_pk_bf16_f32 v176, v40, v41
    v_cvt_pk_bf16_f32 v177, v42, v43
    v_cvt_pk_bf16_f32 v182, v44, v45
    v_cvt_pk_bf16_f32 v183, v46, v47
    s_waitcnt lgkmcnt(0)
    s_barrier
    ds_read_b64 v[128:129], v9 offset:0
    ds_read_b64 v[132:133], v9 offset:512
    ds_read_b64 v[186:187], v9 offset:1024
    ds_read_b64 v[168:169], v9 offset:1536
    ds_read_b64 v[174:175], v9 offset:2048
    ds_read_b64 v[180:181], v9 offset:2560
    v_pk_fma_f32 v[16:17], v[242:243], v[104:105], v[16:17] op_sel_hi:[0,1,1] neg_lo:[1,0,0] neg_hi:[1,0,0]
    v_pk_fma_f32 v[18:19], v[242:243], v[106:107], v[18:19] op_sel_hi:[0,1,1] neg_lo:[1,0,0] neg_hi:[1,0,0]
    v_pk_fma_f32 v[20:21], v[242:243], v[108:109], v[20:21] op_sel_hi:[0,1,1] neg_lo:[1,0,0] neg_hi:[1,0,0]
    v_pk_fma_f32 v[22:23], v[242:243], v[110:111], v[22:23] op_sel_hi:[0,1,1] neg_lo:[1,0,0] neg_hi:[1,0,0]
    v_pk_fma_f32 v[48:49], v[244:245], v[104:105], v[48:49] op_sel_hi:[0,1,1] neg_lo:[1,0,0] neg_hi:[1,0,0]
    v_pk_fma_f32 v[50:51], v[244:245], v[106:107], v[50:51] op_sel_hi:[0,1,1] neg_lo:[1,0,0] neg_hi:[1,0,0]
    v_pk_fma_f32 v[52:53], v[244:245], v[108:109], v[52:53] op_sel_hi:[0,1,1] neg_lo:[1,0,0] neg_hi:[1,0,0]
    v_pk_fma_f32 v[54:55], v[244:245], v[110:111], v[54:55] op_sel_hi:[0,1,1] neg_lo:[1,0,0] neg_hi:[1,0,0]
    v_pk_mul_f32 v[16:17], v[16:17], v[242:243] op_sel:[0,1] op_sel_hi:[1,1]
    v_pk_mul_f32 v[18:19], v[18:19], v[242:243] op_sel:[0,1] op_sel_hi:[1,1]
    v_pk_mul_f32 v[20:21], v[20:21], v[242:243] op_sel:[0,1] op_sel_hi:[1,1]
    v_pk_mul_f32 v[22:23], v[22:23], v[242:243] op_sel:[0,1] op_sel_hi:[1,1]
    v_pk_mul_f32 v[48:49], v[48:49], v[244:245] op_sel:[0,1] op_sel_hi:[1,1]
    v_pk_mul_f32 v[50:51], v[50:51], v[244:245] op_sel:[0,1] op_sel_hi:[1,1]
    v_pk_mul_f32 v[52:53], v[52:53], v[244:245] op_sel:[0,1] op_sel_hi:[1,1]
    v_pk_mul_f32 v[54:55], v[54:55], v[244:245] op_sel:[0,1] op_sel_hi:[1,1]
    v_cvt_pk_bf16_f32 v152, v16, v17
    v_cvt_pk_bf16_f32 v153, v18, v19
    v_cvt_pk_bf16_f32 v156, v20, v21
    v_cvt_pk_bf16_f32 v157, v22, v23
    v_cvt_pk_bf16_f32 v160, v48, v49
    v_cvt_pk_bf16_f32 v161, v50, v51
    v_cvt_pk_bf16_f32 v164, v52, v53
    v_cvt_pk_bf16_f32 v165, v54, v55
    v_cndmask_b32 v154, 0, v188, s[46:47]
    v_mov_b32 v155, 0
    v_cndmask_b32 v158, 0, v189, s[46:47]
    v_mov_b32 v159, 0
    v_cndmask_b32 v162, 0, v190, s[46:47]
    v_mov_b32 v163, 0
    v_cndmask_b32 v166, 0, v191, s[46:47]
    v_mov_b32 v167, 0
    v_mov_b32 v131, 0
    v_mov_b32 v135, 0
    v_mov_b32 v139, 0
    v_mov_b32 v143, 0
    v_mov_b32 v147, 0
    v_mov_b32 v151, 0
    s_waitcnt lgkmcnt(0)
    v_permlane16_swap_b32 v188, v138
    v_permlane16_swap_b32 v189, v142
    v_permlane16_swap_b32 v190, v146
    v_permlane16_swap_b32 v191, v150
    v_permlane16_swap_b32 v186, v130
    v_permlane16_swap_b32 v187, v134
    v_cndmask_b32 v138, 0, v138, s[46:47]
    v_cndmask_b32 v142, 0, v142, s[46:47]
    v_cndmask_b32 v146, 0, v146, s[46:47]
    v_cndmask_b32 v150, 0, v150, s[46:47]
    v_cndmask_b32 v130, 0, v130, s[46:47]
    v_cndmask_b32 v134, 0, v134, s[46:47]
    s_nop 1
    v_mfma_f32_16x16x32_bf16 v[20:23], v[144:147], v[160:163], 0
    v_mfma_f32_16x16x32_bf16 v[16:19], v[136:139], v[160:163], 0
    v_mfma_f32_16x16x32_bf16 v[28:31], v[148:151], v[164:167], 0
    v_mfma_f32_16x16x32_bf16 v[24:27], v[140:143], v[164:167], 0
    v_mfma_f32_16x16x32_bf16 v[36:39], v[136:139], v[152:155], 0
    v_mfma_f32_16x16x32_bf16 v[32:35], v[128:131], v[152:155], 0
    v_mfma_f32_16x16x32_bf16 v[44:47], v[140:143], v[156:159], 0
    v_mfma_f32_16x16x32_bf16 v[40:43], v[132:135], v[156:159], 0
    s_lshl_b32 s36, s24, 10
    v_add_u32 v4, s36, v1
    v_add_u32 v5, 18432, v4
    s_lshr_b32 s36, s24, 3
    s_lshl_b32 s36, s36, 10
    s_bfe_u32 s37, s24, 0x20001
    s_lshl_b32 s37, s37, 8
    s_add_u32 s36, s36, s37
    s_and_b32 s37, s24, 1
    s_lshl_b32 s37, s37, 3
    s_add_u32 s36, s36, s37
    s_add_u32 s36, s36, 16384
    v_cmp_eq_u32 vcc, 2, v3
    v_lshl_add_u32 v6, v2, 4, s36
    v_bfrev_b32 v7, 1
    v_cndmask_b32 v6, v7, v6, vcc
    v_add_u32 v7, 18432, v6
    v_mov_b32 v8, 0xf149f2ca
    s_mov_b32 s52, 0x3eae1a93
    v_cndmask_b32 v20, v20, v21, s[40:41]
    v_cndmask_b32 v16, v16, v17, s[40:41]
    v_cndmask_b32 v48, v16, v20, s[42:43]
    v_cndmask_b32 v22, v22, v23, s[40:41]
    v_cndmask_b32 v18, v18, v19, s[40:41]
    v_cndmask_b32 v49, v18, v22, s[44:45]
    v_max_f32 v56, v48, v49
    v_cndmask_b32 v28, v28, v29, s[40:41]
    v_cndmask_b32 v24, v24, v25, s[40:41]
    v_cndmask_b32 v50, v24, v28, s[42:43]
    v_cndmask_b32 v30, v30, v31, s[40:41]
    v_cndmask_b32 v26, v26, v27, s[40:41]
    v_cndmask_b32 v51, v26, v30, s[44:45]
    v_max_f32 v57, v50, v51
    v_cndmask_b32 v36, v36, v37, s[40:41]
    v_cndmask_b32 v32, v32, v33, s[40:41]
    v_cndmask_b32 v52, v32, v36, s[42:43]
    v_cndmask_b32 v52, v8, v52, s[48:49]
    v_cndmask_b32 v38, v38, v39, s[40:41]
    v_cndmask_b32 v34, v34, v35, s[40:41]
    v_cndmask_b32 v53, v34, v38, s[44:45]
    v_cndmask_b32 v53, v8, v53, s[50:51]
    v_max_f32 v58, v52, v53
    v_cndmask_b32 v44, v44, v45, s[40:41]
    v_cndmask_b32 v40, v40, v41, s[40:41]
    v_cndmask_b32 v54, v40, v44, s[42:43]
    v_cndmask_b32 v54, v8, v54, s[48:49]
    v_cndmask_b32 v46, v46, v47, s[40:41]
    v_cndmask_b32 v42, v42, v43, s[40:41]
    v_cndmask_b32 v55, v42, v46, s[44:45]
    v_cndmask_b32 v55, v8, v55, s[50:51]
    v_max_f32 v59, v54, v55
    v_mov_b32 v60, v56
    v_mov_b32 v61, v57
    v_mov_b32 v62, v58
    v_mov_b32 v63, v59
    v_permlane32_swap_b32 v56, v60
    v_permlane32_swap_b32 v57, v61
    v_permlane32_swap_b32 v58, v62
    v_permlane32_swap_b32 v59, v63
    v_max_f32 v56, v56, v60
    v_max_f32 v57, v57, v61
    v_max_f32 v58, v58, v62
    v_max_f32 v59, v59, v63
    v_mov_b32 v60, v56
    v_mov_b32 v61, v57
    v_mov_b32 v62, v58
    v_mov_b32 v63, v59
    v_permlane16_swap_b32 v56, v60
    v_permlane16_swap_b32 v57, v61
    v_permlane16_swap_b32 v58, v62
    v_permlane16_swap_b32 v59, v63
    v_max_f32 v56, v56, v60
    v_max_f32 v57, v57, v61
    v_max_f32 v58, v58, v62
    v_max_f32 v59, v59, v63
    v_mul_f32 v56, s52, v56
    v_mul_f32 v57, s52, v57
    v_mul_f32 v58, s52, v58
    v_mul_f32 v59, s52, v59
    v_fma_f32 v48, v48, s52, -v56
    v_fma_f32 v49, v49, s52, -v56
    v_fma_f32 v50, v50, s52, -v57
    v_fma_f32 v51, v51, s52, -v57
    v_fma_f32 v52, v52, s52, -v58
    v_fma_f32 v53, v53, s52, -v58
    v_fma_f32 v54, v54, s52, -v59
    v_fma_f32 v55, v55, s52, -v59
    v_exp_f32 v48, v48
    v_exp_f32 v49, v49
    v_exp_f32 v50, v50
    v_exp_f32 v51, v51
    v_exp_f32 v52, v52
    v_exp_f32 v53, v53
    v_exp_f32 v54, v54
    v_exp_f32 v55, v55
    v_add_f32 v56, v48, v49
    v_add_f32 v57, v50, v51
    v_add_f32 v58, v52, v53
    v_add_f32 v59, v54, v55
    v_mov_b32 v60, v56
    v_mov_b32 v61, v57
    v_mov_b32 v62, v58
    v_mov_b32 v63, v59
    v_permlane32_swap_b32 v56, v60
    v_permlane32_swap_b32 v57, v61
    v_permlane32_swap_b32 v58, v62
    v_permlane32_swap_b32 v59, v63
    v_add_f32 v56, v56, v60
    v_add_f32 v57, v57, v61
    v_add_f32 v58, v58, v62
    v_add_f32 v59, v59, v63
    v_mov_b32 v60, v56
    v_mov_b32 v61, v57
    v_mov_b32 v62, v58
    v_mov_b32 v63, v59
    v_permlane16_swap_b32 v56, v60
    v_permlane16_swap_b32 v57, v61
    v_permlane16_swap_b32 v58, v62
    v_permlane16_swap_b32 v59, v63
    v_add_f32 v56, v56, v60
    v_add_f32 v57, v57, v61
    v_add_f32 v58, v58, v62
    v_add_f32 v59, v59, v63
    v_rcp_f32 v56, v56
    v_rcp_f32 v57, v57
    v_rcp_f32 v58, v58
    v_rcp_f32 v59, v59
    v_mul_f32 v48, v48, v56
    v_mul_f32 v49, v49, v56
    v_mul_f32 v50, v50, v57
    v_mul_f32 v51, v51, v57
    v_mul_f32 v52, v52, v58
    v_mul_f32 v53, v53, v58
    v_mul_f32 v54, v54, v59
    v_mul_f32 v55, v55, v59
    v_cvt_pk_bf16_f32 v48, v48, v48
    v_cvt_pk_bf16_f32 v49, v49, v49
    v_cvt_pk_bf16_f32 v50, v50, v50
    v_cvt_pk_bf16_f32 v51, v51, v51
    v_cvt_pk_bf16_f32 v52, v52, v52
    v_cvt_pk_bf16_f32 v53, v53, v53
    v_cvt_pk_bf16_f32 v54, v54, v54
    v_cvt_pk_bf16_f32 v55, v55, v55
    v_and_b32 v64, v48, v12
    v_and_b32 v65, v49, v13
    v_and_b32 v66, v48, v14
    v_and_b32 v67, v49, v15
    v_and_b32 v68, v50, v12
    v_and_b32 v69, v51, v13
    v_and_b32 v70, v50, v14
    v_and_b32 v71, v51, v15
    v_and_b32 v72, v52, v12
    v_and_b32 v73, v53, v13
    v_and_b32 v74, v52, v14
    v_and_b32 v75, v53, v15
    v_and_b32 v76, v54, v12
    v_and_b32 v77, v55, v13
    v_and_b32 v78, v54, v14
    v_and_b32 v79, v55, v15
    s_nop 1
    v_mfma_f32_16x16x32_bf16 v[16:19], v[170:173], v[64:67], 0
    v_mfma_f32_16x16x32_bf16 v[20:23], v[182:185], v[64:67], 0
    v_mfma_f32_16x16x32_bf16 v[24:27], v[176:179], v[68:71], 0
    v_mfma_f32_16x16x32_bf16 v[28:31], v[182:185], v[68:71], 0
    v_mfma_f32_16x16x32_bf16 v[32:35], v[168:171], v[72:75], 0
    v_mfma_f32_16x16x32_bf16 v[36:39], v[180:183], v[72:75], 0
    v_mfma_f32_16x16x32_bf16 v[40:43], v[174:177], v[76:79], 0
    v_mfma_f32_16x16x32_bf16 v[44:47], v[180:183], v[76:79], 0
    s_nop 3
    v_cvt_pk_bf16_f32 v216, v16, v17
    v_cvt_pk_bf16_f32 v217, v18, v19
    v_cvt_pk_bf16_f32 v220, v20, v21
    v_cvt_pk_bf16_f32 v218, v24, v25
    v_cvt_pk_bf16_f32 v219, v26, v27
    v_cvt_pk_bf16_f32 v221, v30, v31
    buffer_store_dwordx4 v[216:219], v5, s[4:7], s35 offen sc1
    buffer_store_dwordx2 v[220:221], v7, s[4:7], s35 offen sc1
    s_nop 0
    v_cvt_pk_bf16_f32 v224, v32, v33
    v_cvt_pk_bf16_f32 v225, v34, v35
    v_cvt_pk_bf16_f32 v228, v36, v37
    v_cvt_pk_bf16_f32 v226, v40, v41
    v_cvt_pk_bf16_f32 v227, v42, v43
    v_cvt_pk_bf16_f32 v229, v46, v47
    buffer_store_dwordx4 v[224:227], v4, s[4:7], s35 offen sc1
    buffer_store_dwordx2 v[228:229], v6, s[4:7], s35 offen sc1
    s_lshl_b32 s45, s22, 8
    s_add_u32 s45, s45, s23
    s_lshl_b32 s45, s45, 8
    s_add_u32 s45, s45, 0x8500000
    s_and_b32 s25, s2, 7
    s_lshr_b32 s26, s2, 3
    s_lshl_b32 s23, s25, 2
    s_lshr_b32 s27, s26, 3
    s_add_u32 s23, s23, s27
    s_and_b32 s24, s26, 7
    s_add_u32 s28, s23, s24
    s_and_b32 s28, s28, 3
    s_lshl_b32 s30, s23, 2
    s_add_u32 s30, s30, s20
    s_mul_i32 s29, s30, 18432
    s_add_u32 s29, s29, s21
    s_add_u32 s29, s29, 0x600000
    s_mul_i32 s34, s30, 18432
    s_add_u32 s34, s34, s21
    s_add_u32 s34, s34, 0x0
    s_lshl_b32 s35, s24, 11
    s_lshr_b32 s36, s24, 2
    s_lshl_b32 s36, s36, 10
    s_and_b32 s37, s24, 3
    s_lshl_b32 s37, s37, 8
    s_add_u32 s36, s36, s37
    s_add_u32 s36, s36, 16384
    v_and_b32 v2, 15, v0
    v_bfe_u32 v3, v0, 4, 2
    v_add_u32 v4, s35, v1
    v_lshlrev_b32 v5, 4, v2
    v_lshl_add_u32 v5, v3, 3, v5
    v_add_u32 v5, s36, v5
    v_cmp_gt_u32 s[40:41], 2, v3
    v_bfrev_b32 v6, 1
    v_add_u32 v12, 0, v1
    v_add_u32 v13, 36864, v1
    v_add_u32 v14, 73728, v1
    v_add_u32 v15, 110592, v1
    v_cndmask_b32 v5, v6, v5, s[40:41]
    v_mov_b32 v16, 0
    v_mov_b32 v17, 0
    v_mov_b32 v18, 0
    v_mov_b32 v19, 0
    v_mov_b32 v20, 0
    v_mov_b32 v21, 0
    v_mov_b32 v22, 0
    v_mov_b32 v23, 0
    v_mov_b32 v24, 0
    v_mov_b32 v25, 0
    v_mov_b32 v26, 0
    v_mov_b32 v27, 0
    v_mov_b32 v28, 0
    v_mov_b32 v29, 0
    v_mov_b32 v30, 0
    v_mov_b32 v31, 0
    v_mov_b32 v32, 0
    v_mov_b32 v33, 0
    v_mov_b32 v34, 0
    v_mov_b32 v35, 0
    v_mov_b32 v36, 0
    v_mov_b32 v37, 0
    v_mov_b32 v38, 0
    v_mov_b32 v39, 0
    s_and_b32 s37, s20, 1
    v_bfe_u32 v7, v2, 2, 1
    v_lshrrev_b32 v8, 3, v2
    v_lshlrev_b32 v8, 2, v8
    v_and_b32 v9, 3, v2
    v_add_u32 v8, v8, v9
    s_lshl_b32 s37, s37, 3
    v_add_u32 v8, s37, v8
    s_lshr_b32 s44, s23, 1
    s_lshl_b32 s46, s22, 8
    s_add_u32 s46, s46, s44
    s_lshl_b32 s46, s46, 8
    s_add_u32 s46, s46, 0x8500000
    s_waitcnt vmcnt(0)
    v_mov_b32 v220, 1
    v_mov_b32 v221, 163832
    v_mov_b32 v222, 0
    s_mov_b64 exec, 1
    ds_add_rtn_u32 v223, v221, v220
    s_waitcnt lgkmcnt(0)
    v_and_b32 v223, 3, v223
    v_cmp_eq_u32 vcc, 3, v223
    s_nop 0
    s_cbranch_vccz L_sk_d2
    buffer_atomic_add v220, v222, s[4:7], s45 offen sc1
    s_mov_b32 s60, 65536
L_poll_d2:
    buffer_load_dword v223, v222, s[4:7], s46 offen sc1
    s_waitcnt vmcnt(0)
    v_cmp_gt_u32 vcc, 16, v223
    s_sub_u32 s60, s60, 1
    s_cbranch_scc1 L_pd_d2
    s_cbranch_vccz L_pd_d2
    s_sleep 4
    s_branch L_poll_d2
L_pd_d2:
L_sk_d2:
    s_mov_b64 exec, -1
    s_barrier
    s_mov_b32 s32, 0
    s_lshl_b32 s32, s32, 13
    s_add_u32 s32, s32, s29
    s_add_u32 s33, s32, 4096
    buffer_load_dwordx4 v[112:115], v1, s[4:7], s32 offen offset:0 sc1
    buffer_load_dwordx4 v[116:119], v1, s[4:7], s32 offen offset:1024 sc1
    buffer_load_dwordx4 v[120:123], v1, s[4:7], s32 offen offset:2048 sc1
    buffer_load_dwordx4 v[124:127], v1, s[4:7], s32 offen offset:3072 sc1
    buffer_load_dwordx4 v[128:131], v1, s[4:7], s33 offen offset:0 sc1
    buffer_load_dwordx4 v[132:135], v1, s[4:7], s33 offen offset:1024 sc1
    buffer_load_dwordx4 v[136:139], v1, s[4:7], s33 offen offset:2048 sc1
    buffer_load_dwordx4 v[140:143], v1, s[4:7], s33 offen offset:3072 sc1
    s_mov_b32 s32, 1
    s_lshl_b32 s32, s32, 13
    s_add_u32 s32, s32, s29
    s_add_u32 s33, s32, 4096
    buffer_load_dwordx4 v[144:147], v1, s[4:7], s32 offen offset:0 sc1
    buffer_load_dwordx4 v[148:151], v1, s[4:7], s32 offen offset:1024 sc1
    buffer_load_dwordx4 v[152:155], v1, s[4:7], s32 offen offset:2048 sc1
    buffer_load_dwordx4 v[156:159], v1, s[4:7], s32 offen offset:3072 sc1
    buffer_load_dwordx4 v[160:163], v1, s[4:7], s33 offen offset:0 sc1
    buffer_load_dwordx4 v[164:167], v1, s[4:7], s33 offen offset:1024 sc1
    buffer_load_dwordx4 v[168:171], v1, s[4:7], s33 offen offset:2048 sc1
    buffer_load_dwordx4 v[172:175], v1, s[4:7], s33 offen offset:3072 sc1
    ds_read_b128 v[40:43], v12 offset:0
    ds_read_b128 v[44:47], v12 offset:1024
    ds_read_b128 v[48:51], v12 offset:2048
    ds_read_b128 v[52:55], v12 offset:3072
    ds_read_b128 v[72:75], v12 offset:8192
    ds_read_b128 v[56:59], v12 offset:4096
    ds_read_b128 v[60:63], v12 offset:5120
    ds_read_b128 v[64:67], v12 offset:6144
    ds_read_b128 v[68:71], v12 offset:7168
    s_waitcnt vmcnt(14) lgkmcnt(4)
    v_mfma_f32_16x16x32_bf16 v[16:19], v[40:43], v[112:115], v[16:19]
    ds_read_b128 v[76:79], v12 offset:9216
    s_mov_b32 s32, 2
    s_lshl_b32 s32, s32, 13
    s_add_u32 s32, s32, s29
    s_add_u32 s33, s32, 4096
    v_mfma_f32_16x16x32_bf16 v[20:23], v[44:47], v[112:115], v[20:23]
    ds_read_b128 v[80:83], v12 offset:10240
    v_mfma_f32_16x16x32_bf16 v[24:27], v[48:51], v[112:115], v[24:27]
    ds_read_b128 v[84:87], v12 offset:11264
    buffer_load_dwordx4 v[176:179], v1, s[4:7], s32 offen offset:0 sc1
    v_mfma_f32_16x16x32_bf16 v[28:31], v[52:55], v[112:115], v[28:31]
    ds_read_b128 v[88:91], v12 offset:12288
    v_mfma_f32_16x16x32_bf16 v[32:35], v[72:75], v[112:115], v[32:35]
    ds_read_b128 v[108:111], v12 offset:17408
    s_waitcnt lgkmcnt(5)
    v_mfma_f32_16x16x32_bf16 v[16:19], v[56:59], v[116:119], v[16:19]
    ds_read_b128 v[92:95], v12 offset:13312
    v_mfma_f32_16x16x32_bf16 v[20:23], v[60:63], v[116:119], v[20:23]
    ds_read_b128 v[96:99], v12 offset:14336
    buffer_load_dwordx4 v[180:183], v1, s[4:7], s32 offen offset:1024 sc1
    v_mfma_f32_16x16x32_bf16 v[24:27], v[64:67], v[116:119], v[24:27]
    ds_read_b128 v[100:103], v12 offset:15360
    v_mfma_f32_16x16x32_bf16 v[28:31], v[68:71], v[116:119], v[28:31]
    ds_read_b128 v[104:107], v12 offset:16384
    v_mfma_f32_16x16x32_bf16 v[36:39], v[72:75], v[116:119], v[36:39]
    s_waitcnt vmcnt(14) lgkmcnt(4)
    v_mfma_f32_16x16x32_bf16 v[16:19], v[76:79], v[120:123], v[16:19]
    ds_read_b128 v[40:43], v12 offset:18432
    v_mfma_f32_16x16x32_bf16 v[20:23], v[80:83], v[120:123], v[20:23]
    ds_read_b128 v[44:47], v12 offset:19456
    v_mfma_f32_16x16x32_bf16 v[24:27], v[84:87], v[120:123], v[24:27]
    ds_read_b128 v[48:51], v12 offset:20480
    v_mfma_f32_16x16x32_bf16 v[28:31], v[88:91], v[120:123], v[28:31]
    ds_read_b128 v[52:55], v12 offset:21504
    buffer_load_dwordx4 v[208:211], v4, s[4:7], s34 offen offset:0 sc1
    v_mfma_f32_16x16x32_bf16 v[32:35], v[108:111], v[120:123], v[32:35]
    ds_read_b128 v[72:75], v12 offset:26624
    s_waitcnt lgkmcnt(5)
    v_mfma_f32_16x16x32_bf16 v[16:19], v[92:95], v[124:127], v[16:19]
    ds_read_b128 v[56:59], v12 offset:22528
    buffer_load_dwordx4 v[212:215], v4, s[4:7], s34 offen offset:1024 sc1
    v_mfma_f32_16x16x32_bf16 v[20:23], v[96:99], v[124:127], v[20:23]
    ds_read_b128 v[60:63], v12 offset:23552
    v_mfma_f32_16x16x32_bf16 v[24:27], v[100:103], v[124:127], v[24:27]
    ds_read_b128 v[64:67], v12 offset:24576
    buffer_load_dwordx2 v[216:217], v5, s[4:7], s34 offen sc1
    v_mfma_f32_16x16x32_bf16 v[28:31], v[104:107], v[124:127], v[28:31]
    ds_read_b128 v[68:71], v12 offset:25600
    v_mfma_f32_16x16x32_bf16 v[36:39], v[108:111], v[124:127], v[36:39]
    s_waitcnt vmcnt(15) lgkmcnt(4)
    v_mfma_f32_16x16x32_bf16 v[16:19], v[40:43], v[128:131], v[16:19]
    ds_read_b128 v[76:79], v12 offset:27648
    v_mfma_f32_16x16x32_bf16 v[20:23], v[44:47], v[128:131], v[20:23]
    ds_read_b128 v[80:83], v12 offset:28672
    v_mfma_f32_16x16x32_bf16 v[24:27], v[48:51], v[128:131], v[24:27]
    ds_read_b128 v[84:87], v12 offset:29696
    v_mfma_f32_16x16x32_bf16 v[28:31], v[52:55], v[128:131], v[28:31]
    ds_read_b128 v[88:91], v12 offset:30720
    v_mfma_f32_16x16x32_bf16 v[32:35], v[72:75], v[128:131], v[32:35]
    ds_read_b128 v[108:111], v12 offset:35840
    s_waitcnt lgkmcnt(5)
    v_mfma_f32_16x16x32_bf16 v[16:19], v[56:59], v[132:135], v[16:19]
    ds_read_b128 v[92:95], v12 offset:31744
    v_mfma_f32_16x16x32_bf16 v[20:23], v[60:63], v[132:135], v[20:23]
    ds_read_b128 v[96:99], v12 offset:32768
    v_mfma_f32_16x16x32_bf16 v[24:27], v[64:67], v[132:135], v[24:27]
    ds_read_b128 v[100:103], v12 offset:33792
    v_mfma_f32_16x16x32_bf16 v[28:31], v[68:71], v[132:135], v[28:31]
    ds_read_b128 v[104:107], v12 offset:34816
    v_mfma_f32_16x16x32_bf16 v[36:39], v[72:75], v[132:135], v[36:39]
    s_waitcnt vmcnt(13) lgkmcnt(0)
    s_barrier
    v_mfma_f32_16x16x32_bf16 v[16:19], v[76:79], v[136:139], v[16:19]
    ds_read_b128 v[40:43], v13 offset:0
    v_mfma_f32_16x16x32_bf16 v[20:23], v[80:83], v[136:139], v[20:23]
    ds_read_b128 v[44:47], v13 offset:1024
    v_mfma_f32_16x16x32_bf16 v[24:27], v[84:87], v[136:139], v[24:27]
    ds_read_b128 v[48:51], v13 offset:2048
    v_mfma_f32_16x16x32_bf16 v[28:31], v[88:91], v[136:139], v[28:31]
    ds_read_b128 v[52:55], v13 offset:3072
    v_mfma_f32_16x16x32_bf16 v[32:35], v[108:111], v[136:139], v[32:35]
    ds_read_b128 v[72:75], v13 offset:8192
    v_mfma_f32_16x16x32_bf16 v[16:19], v[92:95], v[140:143], v[16:19]
    ds_read_b128 v[56:59], v13 offset:4096
    v_mfma_f32_16x16x32_bf16 v[20:23], v[96:99], v[140:143], v[20:23]
    ds_read_b128 v[60:63], v13 offset:5120
    v_mfma_f32_16x16x32_bf16 v[24:27], v[100:103], v[140:143], v[24:27]
    ds_read_b128 v[64:67], v13 offset:6144
    v_mfma_f32_16x16x32_bf16 v[28:31], v[104:107], v[140:143], v[28:31]
    ds_read_b128 v[68:71], v13 offset:7168
    v_mfma_f32_16x16x32_bf16 v[36:39], v[108:111], v[140:143], v[36:39]
    s_waitcnt vmcnt(11) lgkmcnt(4)
    v_mfma_f32_16x16x32_bf16 v[16:19], v[40:43], v[144:147], v[16:19]
    ds_read_b128 v[76:79], v13 offset:9216
    v_mfma_f32_16x16x32_bf16 v[20:23], v[44:47], v[144:147], v[20:23]
    ds_read_b128 v[80:83], v13 offset:10240
    v_mfma_f32_16x16x32_bf16 v[24:27], v[48:51], v[144:147], v[24:27]
    ds_read_b128 v[84:87], v13 offset:11264
    v_mfma_f32_16x16x32_bf16 v[28:31], v[52:55], v[144:147], v[28:31]
    ds_read_b128 v[88:91], v13 offset:12288
    v_mfma_f32_16x16x32_bf16 v[32:35], v[72:75], v[144:147], v[32:35]
    ds_read_b128 v[108:111], v13 offset:17408
    s_waitcnt lgkmcnt(5)
    v_mfma_f32_16x16x32_bf16 v[16:19], v[56:59], v[148:151], v[16:19]
    ds_read_b128 v[92:95], v13 offset:13312
    v_mfma_f32_16x16x32_bf16 v[20:23], v[60:63], v[148:151], v[20:23]
    ds_read_b128 v[96:99], v13 offset:14336
    v_mfma_f32_16x16x32_bf16 v[24:27], v[64:67], v[148:151], v[24:27]
    ds_read_b128 v[100:103], v13 offset:15360
    v_mfma_f32_16x16x32_bf16 v[28:31], v[68:71], v[148:151], v[28:31]
    ds_read_b128 v[104:107], v13 offset:16384
    v_mfma_f32_16x16x32_bf16 v[36:39], v[72:75], v[148:151], v[36:39]
    s_waitcnt vmcnt(9) lgkmcnt(4)
    v_mfma_f32_16x16x32_bf16 v[16:19], v[76:79], v[152:155], v[16:19]
    ds_read_b128 v[40:43], v13 offset:18432
    v_mfma_f32_16x16x32_bf16 v[20:23], v[80:83], v[152:155], v[20:23]
    ds_read_b128 v[44:47], v13 offset:19456
    v_mfma_f32_16x16x32_bf16 v[24:27], v[84:87], v[152:155], v[24:27]
    ds_read_b128 v[48:51], v13 offset:20480
    v_mfma_f32_16x16x32_bf16 v[28:31], v[88:91], v[152:155], v[28:31]
    ds_read_b128 v[52:55], v13 offset:21504
    v_mfma_f32_16x16x32_bf16 v[32:35], v[108:111], v[152:155], v[32:35]
    ds_read_b128 v[72:75], v13 offset:26624
    s_waitcnt lgkmcnt(5)
    v_mfma_f32_16x16x32_bf16 v[16:19], v[92:95], v[156:159], v[16:19]
    ds_read_b128 v[56:59], v13 offset:22528
    v_mfma_f32_16x16x32_bf16 v[20:23], v[96:99], v[156:159], v[20:23]
    ds_read_b128 v[60:63], v13 offset:23552
    v_mfma_f32_16x16x32_bf16 v[24:27], v[100:103], v[156:159], v[24:27]
    ds_read_b128 v[64:67], v13 offset:24576
    v_mfma_f32_16x16x32_bf16 v[28:31], v[104:107], v[156:159], v[28:31]
    ds_read_b128 v[68:71], v13 offset:25600
    v_mfma_f32_16x16x32_bf16 v[36:39], v[108:111], v[156:159], v[36:39]
    s_waitcnt vmcnt(7) lgkmcnt(4)
    v_mfma_f32_16x16x32_bf16 v[16:19], v[40:43], v[160:163], v[16:19]
    ds_read_b128 v[76:79], v13 offset:27648
    v_mfma_f32_16x16x32_bf16 v[20:23], v[44:47], v[160:163], v[20:23]
    ds_read_b128 v[80:83], v13 offset:28672
    v_mfma_f32_16x16x32_bf16 v[24:27], v[48:51], v[160:163], v[24:27]
    ds_read_b128 v[84:87], v13 offset:29696
    v_mfma_f32_16x16x32_bf16 v[28:31], v[52:55], v[160:163], v[28:31]
    ds_read_b128 v[88:91], v13 offset:30720
    v_mfma_f32_16x16x32_bf16 v[32:35], v[72:75], v[160:163], v[32:35]
    ds_read_b128 v[108:111], v13 offset:35840
    s_waitcnt lgkmcnt(5)
    v_mfma_f32_16x16x32_bf16 v[16:19], v[56:59], v[164:167], v[16:19]
    ds_read_b128 v[92:95], v13 offset:31744
    v_mfma_f32_16x16x32_bf16 v[20:23], v[60:63], v[164:167], v[20:23]
    ds_read_b128 v[96:99], v13 offset:32768
    v_mfma_f32_16x16x32_bf16 v[24:27], v[64:67], v[164:167], v[24:27]
    ds_read_b128 v[100:103], v13 offset:33792
    v_mfma_f32_16x16x32_bf16 v[28:31], v[68:71], v[164:167], v[28:31]
    ds_read_b128 v[104:107], v13 offset:34816
    v_mfma_f32_16x16x32_bf16 v[36:39], v[72:75], v[164:167], v[36:39]
    s_waitcnt vmcnt(5) lgkmcnt(0)
    s_barrier
    v_mfma_f32_16x16x32_bf16 v[16:19], v[76:79], v[168:171], v[16:19]
    ds_read_b128 v[40:43], v14 offset:0
    v_mfma_f32_16x16x32_bf16 v[20:23], v[80:83], v[168:171], v[20:23]
    ds_read_b128 v[44:47], v14 offset:1024
    v_mfma_f32_16x16x32_bf16 v[24:27], v[84:87], v[168:171], v[24:27]
    ds_read_b128 v[48:51], v14 offset:2048
    v_mfma_f32_16x16x32_bf16 v[28:31], v[88:91], v[168:171], v[28:31]
    ds_read_b128 v[52:55], v14 offset:3072
    v_mfma_f32_16x16x32_bf16 v[32:35], v[108:111], v[168:171], v[32:35]
    ds_read_b128 v[72:75], v14 offset:8192
    v_mfma_f32_16x16x32_bf16 v[16:19], v[92:95], v[172:175], v[16:19]
    ds_read_b128 v[56:59], v14 offset:4096
    v_mfma_f32_16x16x32_bf16 v[20:23], v[96:99], v[172:175], v[20:23]
    ds_read_b128 v[60:63], v14 offset:5120
    v_mfma_f32_16x16x32_bf16 v[24:27], v[100:103], v[172:175], v[24:27]
    ds_read_b128 v[64:67], v14 offset:6144
    v_mfma_f32_16x16x32_bf16 v[28:31], v[104:107], v[172:175], v[28:31]
    ds_read_b128 v[68:71], v14 offset:7168
    v_mfma_f32_16x16x32_bf16 v[36:39], v[108:111], v[172:175], v[36:39]
    s_waitcnt vmcnt(3) lgkmcnt(0)
    s_barrier
    v_mfma_f32_16x16x32_bf16 v[16:19], v[40:43], v[176:179], v[16:19]
    v_mfma_f32_16x16x32_bf16 v[20:23], v[44:47], v[176:179], v[20:23]
    v_mfma_f32_16x16x32_bf16 v[24:27], v[48:51], v[176:179], v[24:27]
    v_mfma_f32_16x16x32_bf16 v[28:31], v[52:55], v[176:179], v[28:31]
    v_mfma_f32_16x16x32_bf16 v[32:35], v[72:75], v[176:179], v[32:35]
    v_mfma_f32_16x16x32_bf16 v[16:19], v[56:59], v[180:183], v[16:19]
    v_mfma_f32_16x16x32_bf16 v[20:23], v[60:63], v[180:183], v[20:23]
    v_mfma_f32_16x16x32_bf16 v[24:27], v[64:67], v[180:183], v[24:27]
    v_mfma_f32_16x16x32_bf16 v[28:31], v[68:71], v[180:183], v[28:31]
    v_mfma_f32_16x16x32_bf16 v[36:39], v[72:75], v[180:183], v[36:39]
    s_and_b32 s30, s30, 0xfffe
    s_mov_b32 s38, s21
    s_mul_i32 s34, s30, 18432
    s_add_u32 s34, s34, s38
    s_add_u32 s34, s34, 0x300000
    s_lshl_b32 s39, s30, 10
    s_add_u32 s39, s39, s38
    s_add_u32 s39, s39, 0x2420000
    v_mul_u32_u24 v9, 18432, v7
    v_lshl_add_u32 v9, v8, 4, v9
    v_lshl_add_u32 v4, v3, 8, v9
    v_add_u32 v4, s35, v4
    v_lshl_add_u32 v5, v3, 3, v9
    v_add_u32 v5, s36, v5
    v_cndmask_b32 v5, v6, v5, s[40:41]
    s_lshr_b32 s42, s24, 1
    s_lshl_b32 s42, s42, 8
    s_and_b32 s43, s24, 1
    s_lshl_b32 s43, s43, 3
    s_add_u32 s42, s42, s43
    v_lshlrev_b32 v10, 10, v7
    v_lshl_add_u32 v10, v8, 4, v10
    v_add_u32 v10, s42, v10
    v_cmp_eq_u32 vcc, 0, v3
    v_mov_b32 v11, 0x3f803f80
    s_nop 0
    v_cndmask_b32 v10, v6, v10, vcc
    s_waitcnt vmcnt(0)
    v_permlane32_swap_b32 v36, v220
    v_permlane32_swap_b32 v37, v221
    v_permlane32_swap_b32 v38, v222
    v_permlane32_swap_b32 v39, v223
    v_lshlrev_b32 v224, 16, v208
    v_and_b32 v225, 0xffff0000, v208
    v_lshlrev_b32 v226, 16, v209
    v_and_b32 v227, 0xffff0000, v209
    v_lshlrev_b32 v228, 16, v210
    v_and_b32 v229, 0xffff0000, v210
    v_lshlrev_b32 v230, 16, v211
    v_and_b32 v231, 0xffff0000, v211
    v_lshlrev_b32 v232, 16, v212
    v_and_b32 v233, 0xffff0000, v212
    v_lshlrev_b32 v234, 16, v213
    v_and_b32 v235, 0xffff0000, v213
    v_lshlrev_b32 v236, 16, v214
    v_and_b32 v237, 0xffff0000, v214
    v_lshlrev_b32 v238, 16, v215
    v_and_b32 v239, 0xffff0000, v215
    v_lshlrev_b32 v240, 16, v216
    v_and_b32 v241, 0xffff0000, v216
    v_lshlrev_b32 v242, 16, v217
    v_and_b32 v243, 0xffff0000, v217
    v_pk_add_f32 v[32:33], v[32:33], v[220:221]
    v_pk_add_f32 v[34:35], v[34:35], v[222:223]
    v_pk_add_f32 v[16:17], v[16:17], v[224:225]
    v_pk_add_f32 v[18:19], v[18:19], v[226:227]
    v_pk_add_f32 v[20:21], v[20:21], v[228:229]
    v_pk_add_f32 v[22:23], v[22:23], v[230:231]
    v_pk_add_f32 v[24:25], v[24:25], v[232:233]
    v_pk_add_f32 v[26:27], v[26:27], v[234:235]
    v_pk_add_f32 v[28:29], v[28:29], v[236:237]
    v_pk_add_f32 v[30:31], v[30:31], v[238:239]
    v_pk_add_f32 v[32:33], v[32:33], v[240:241]
    v_pk_add_f32 v[34:35], v[34:35], v[242:243]
    v_cvt_pk_bf16_f32 v208, v16, v17
    v_cvt_pk_bf16_f32 v209, v18, v19
    v_cvt_pk_bf16_f32 v210, v20, v21
    v_cvt_pk_bf16_f32 v211, v22, v23
    v_cvt_pk_bf16_f32 v212, v24, v25
    v_cvt_pk_bf16_f32 v213, v26, v27
    v_cvt_pk_bf16_f32 v214, v28, v29
    v_cvt_pk_bf16_f32 v215, v30, v31
    v_cvt_pk_bf16_f32 v216, v32, v33
    v_cvt_pk_bf16_f32 v217, v34, v35
    buffer_store_dwordx4 v[208:211], v4, s[4:7], s34 offen offset:0 sc1
    buffer_store_dwordx4 v[212:215], v4, s[4:7], s34 offen offset:1024 sc1
    buffer_store_dwordx2 v[216:217], v5, s[4:7], s34 offen sc1
    v_cndmask_b32 v222, 0, v216, s[40:41]
    v_cndmask_b32 v223, 0, v217, s[40:41]
    v_mov_b32 v220, 0
    v_mov_b32 v221, 0
    v_dot2_f32_bf16 v220, v208, v11, v220
    v_dot2_f32_bf16 v221, v208, v208, v221
    v_dot2_f32_bf16 v220, v209, v11, v220
    v_dot2_f32_bf16 v221, v209, v209, v221
    v_dot2_f32_bf16 v220, v210, v11, v220
    v_dot2_f32_bf16 v221, v210, v210, v221
    v_dot2_f32_bf16 v220, v211, v11, v220
    v_dot2_f32_bf16 v221, v211, v211, v221
    v_dot2_f32_bf16 v220, v212, v11, v220
    v_dot2_f32_bf16 v221, v212, v212, v221
    v_dot2_f32_bf16 v220, v213, v11, v220
    v_dot2_f32_bf16 v221, v213, v213, v221
    v_dot2_f32_bf16 v220, v214, v11, v220
    v_dot2_f32_bf16 v221, v214, v214, v221
    v_dot2_f32_bf16 v220, v215, v11, v220
    v_dot2_f32_bf16 v221, v215, v215, v221
    v_dot2_f32_bf16 v220, v222, v11, v220
    v_dot2_f32_bf16 v221, v222, v222, v221
    v_dot2_f32_bf16 v220, v223, v11, v220
    v_dot2_f32_bf16 v221, v223, v223, v221
    s_nop 2
    v_mov_b32 v222, v220
    v_mov_b32 v223, v221
    s_nop 1
    v_permlane32_swap_b32 v220, v222
    v_permlane32_swap_b32 v221, v223
    v_add_f32 v220, v220, v222
    v_add_f32 v221, v221, v223
    v_mov_b32 v222, v220
    v_mov_b32 v223, v221
    s_nop 1
    v_permlane16_swap_b32 v220, v222
    v_permlane16_swap_b32 v221, v223
    v_add_f32 v220, v220, v222
    v_add_f32 v221, v221, v223
    buffer_store_dwordx2 v[220:221], v10, s[4:7], s39 offen sc1
    s_lshr_b32 s44, s23, 1
    s_lshl_b32 s45, s22, 8
    s_add_u32 s45, s45, s44
    s_lshl_b32 s45, s45, 8
    s_add_u32 s45, s45, 0x8502000
    s_and_b32 s25, s2, 7
    s_lshr_b32 s26, s2, 3
    s_and_b32 s23, s25, 1
    s_lshl_b32 s23, s23, 3
    s_and_b32 s27, s26, 7
    s_add_u32 s23, s23, s27
    s_lshr_b32 s24, s25, 1
    s_lshl_b32 s24, s24, 2
    s_lshr_b32 s27, s26, 3
    s_add_u32 s24, s24, s27
    s_add_u32 s28, s23, s24
    s_and_b32 s28, s28, 3
    s_lshl_b32 s30, s20, 12
    s_lshl_b32 s31, s23, 3
    s_lshl_b32 s33, s20, 1
    s_add_u32 s31, s31, s33
    s_lshl_b32 s32, s31, 10
    s_add_u32 s32, s32, s21
    s_add_u32 s32, s32, 0x2420000
    v_add_u32 v2, 36864, v1
    s_add_u32 s33, s30, 73728
    v_add_u32 v3, s33, v1
    s_lshr_b32 s34, s31, 1
    s_lshl_b32 s35, s34, 12
    s_add_u32 s35, s35, s21
    s_add_u32 s35, s35, 0x2440000
    s_lshl_b32 s36, s24, 8
    s_add_u32 s36, s36, s35
    s_lshl_b32 s37, s22, 8
    s_add_u32 s37, s37, s34
    s_lshl_b32 s37, s37, 8
    s_add_u32 s37, s37, 0x8504000
    s_lshl_b32 s38, s24, 6
    s_add_u32 s38, s38, s34
    s_mul_i32 s38, s38, 9216
    s_add_u32 s38, s38, s21
    s_add_u32 s38, s38, 0x1200000
    s_mov_b32 s44, s23
    s_lshl_b32 s46, s22, 8
    s_add_u32 s46, s46, s44
    s_lshl_b32 s46, s46, 8
    s_add_u32 s46, s46, 0x8502000
    s_waitcnt vmcnt(0)
    v_mov_b32 v4, 1
    v_mov_b32 v5, 163832
    v_mov_b32 v6, 0
    s_mov_b64 exec, 1
    ds_add_rtn_u32 v7, v5, v4
    s_waitcnt lgkmcnt(0)
    v_and_b32 v7, 3, v7
    v_cmp_eq_u32 vcc, 3, v7
    s_nop 0
    s_cbranch_vccz L_sk_d3
    buffer_atomic_add v4, v6, s[4:7], s45 offen sc1
    s_mov_b32 s60, 65536
L_poll_d3:
    buffer_load_dword v7, v6, s[4:7], s46 offen sc1
    s_waitcnt vmcnt(0)
    v_cmp_gt_u32 vcc, 16, v7
    s_sub_u32 s60, s60, 1
    s_cbranch_scc1 L_pd_d3
    s_cbranch_vccz L_pd_d3
    s_sleep 4
    s_branch L_poll_d3
L_pd_d3:
L_sk_d3:
    s_mov_b64 exec, -1
    s_barrier
    buffer_load_dwordx4 v[8:11], v1, s[4:7], s32 offen offset:0 sc1
    buffer_load_dwordx4 v[12:15], v1, s[4:7], s32 offen offset:1024 sc1
    s_barrier
    ds_read_b128 v[160:163], v3 offset:0
    ds_read_b128 v[164:167], v3 offset:2048
    ds_read_b128 v[168:171], v1 offset:0
    ds_read_b128 v[172:175], v1 offset:1024
    ds_read_b128 v[176:179], v1 offset:2048
    ds_read_b128 v[180:183], v1 offset:3072
    ds_read_b128 v[184:187], v1 offset:4096
    ds_read_b128 v[188:191], v1 offset:5120
    ds_read_b128 v[192:195], v1 offset:6144
    ds_read_b128 v[196:199], v1 offset:7168
    ds_read_b128 v[200:203], v1 offset:8192
    s_waitcnt lgkmcnt(5)
    v_mfma_f32_16x16x32_bf16 v[16:19], v[160:163], v[168:171], 0
    ds_read_b128 v[204:207], v3 offset:1024
    v_mfma_f32_16x16x32_bf16 v[20:23], v[164:167], v[168:171], 0
    ds_read_b128 v[208:211], v3 offset:3072
    v_mfma_f32_16x16x32_bf16 v[24:27], v[160:163], v[172:175], 0
    ds_read_b128 v[212:215], v1 offset:9216
    v_mfma_f32_16x16x32_bf16 v[28:31], v[164:167], v[172:175], 0
    ds_read_b128 v[216:219], v1 offset:10240
    v_mfma_f32_16x16x32_bf16 v[32:35], v[160:163], v[176:179], 0
    ds_read_b128 v[220:223], v1 offset:11264
    v_mfma_f32_16x16x32_bf16 v[36:39], v[164:167], v[176:179], 0
    ds_read_b128 v[224:227], v1 offset:12288
    v_mfma_f32_16x16x32_bf16 v[40:43], v[160:163], v[180:183], 0
    ds_read_b128 v[228:231], v1 offset:13312
    v_mfma_f32_16x16x32_bf16 v[44:47], v[164:167], v[180:183], 0
    ds_read_b128 v[232:235], v1 offset:14336
    s_waitcnt lgkmcnt(8)
    v_mfma_f32_16x16x32_bf16 v[48:51], v[160:163], v[184:187], 0
    ds_read_b128 v[236:239], v1 offset:15360
    v_mfma_f32_16x16x32_bf16 v[52:55], v[164:167], v[184:187], 0
    ds_read_b128 v[240:243], v1 offset:16384
    v_mfma_f32_16x16x32_bf16 v[56:59], v[160:163], v[188:191], 0
    ds_read_b128 v[244:247], v1 offset:17408
    v_mfma_f32_16x16x32_bf16 v[60:63], v[164:167], v[188:191], 0
    v_mfma_f32_16x16x32_bf16 v[64:67], v[160:163], v[192:195], 0
    v_mfma_f32_16x16x32_bf16 v[68:71], v[164:167], v[192:195], 0
    v_mfma_f32_16x16x32_bf16 v[72:75], v[160:163], v[196:199], 0
    v_mfma_f32_16x16x32_bf16 v[76:79], v[164:167], v[196:199], 0
    v_mfma_f32_16x16x32_bf16 v[80:83], v[160:163], v[200:203], 0
    v_mfma_f32_16x16x32_bf16 v[84:87], v[164:167], v[200:203], 0
    s_waitcnt lgkmcnt(0)
    s_barrier
    v_mfma_f32_16x16x32_bf16 v[16:19], v[204:207], v[212:215], v[16:19]
    ds_read_b128 v[160:163], v3 offset:16384
    v_mfma_f32_16x16x32_bf16 v[20:23], v[208:211], v[212:215], v[20:23]
    ds_read_b128 v[164:167], v3 offset:18432
    v_mfma_f32_16x16x32_bf16 v[24:27], v[204:207], v[216:219], v[24:27]
    ds_read_b128 v[168:171], v1 offset:18432
    v_mfma_f32_16x16x32_bf16 v[28:31], v[208:211], v[216:219], v[28:31]
    ds_read_b128 v[172:175], v1 offset:19456
    v_mfma_f32_16x16x32_bf16 v[32:35], v[204:207], v[220:223], v[32:35]
    ds_read_b128 v[176:179], v1 offset:20480
    v_mfma_f32_16x16x32_bf16 v[36:39], v[208:211], v[220:223], v[36:39]
    ds_read_b128 v[180:183], v1 offset:21504
    v_mfma_f32_16x16x32_bf16 v[40:43], v[204:207], v[224:227], v[40:43]
    ds_read_b128 v[184:187], v1 offset:22528
    v_mfma_f32_16x16x32_bf16 v[44:47], v[208:211], v[224:227], v[44:47]
    ds_read_b128 v[188:191], v1 offset:23552
    v_mfma_f32_16x16x32_bf16 v[48:51], v[204:207], v[228:231], v[48:51]
    ds_read_b128 v[192:195], v1 offset:24576
    v_mfma_f32_16x16x32_bf16 v[52:55], v[208:211], v[228:231], v[52:55]
    ds_read_b128 v[196:199], v1 offset:25600
    v_mfma_f32_16x16x32_bf16 v[56:59], v[204:207], v[232:235], v[56:59]
    ds_read_b128 v[200:203], v1 offset:26624
    v_mfma_f32_16x16x32_bf16 v[60:63], v[208:211], v[232:235], v[60:63]
    v_mfma_f32_16x16x32_bf16 v[64:67], v[204:207], v[236:239], v[64:67]
    v_mfma_f32_16x16x32_bf16 v[68:71], v[208:211], v[236:239], v[68:71]
    v_mfma_f32_16x16x32_bf16 v[72:75], v[204:207], v[240:243], v[72:75]
    v_mfma_f32_16x16x32_bf16 v[76:79], v[208:211], v[240:243], v[76:79]
    v_mfma_f32_16x16x32_bf16 v[80:83], v[204:207], v[244:247], v[80:83]
    v_mfma_f32_16x16x32_bf16 v[84:87], v[208:211], v[244:247], v[84:87]
    s_waitcnt lgkmcnt(5)
    v_mfma_f32_16x16x32_bf16 v[16:19], v[160:163], v[168:171], v[16:19]
    ds_read_b128 v[204:207], v3 offset:17408
    v_mfma_f32_16x16x32_bf16 v[20:23], v[164:167], v[168:171], v[20:23]
    ds_read_b128 v[208:211], v3 offset:19456
    v_mfma_f32_16x16x32_bf16 v[24:27], v[160:163], v[172:175], v[24:27]
    ds_read_b128 v[212:215], v1 offset:27648
    v_mfma_f32_16x16x32_bf16 v[28:31], v[164:167], v[172:175], v[28:31]
    ds_read_b128 v[216:219], v1 offset:28672
    v_mfma_f32_16x16x32_bf16 v[32:35], v[160:163], v[176:179], v[32:35]
    ds_read_b128 v[220:223], v1 offset:29696
    v_mfma_f32_16x16x32_bf16 v[36:39], v[164:167], v[176:179], v[36:39]
    ds_read_b128 v[224:227], v1 offset:30720
    v_mfma_f32_16x16x32_bf16 v[40:43], v[160:163], v[180:183], v[40:43]
    ds_read_b128 v[228:231], v1 offset:31744
    v_mfma_f32_16x16x32_bf16 v[44:47], v[164:167], v[180:183], v[44:47]
    ds_read_b128 v[232:235], v1 offset:32768
    s_waitcnt lgkmcnt(8)
    v_mfma_f32_16x16x32_bf16 v[48:51], v[160:163], v[184:187], v[48:51]
    ds_read_b128 v[236:239], v1 offset:33792
    v_mfma_f32_16x16x32_bf16 v[52:55], v[164:167], v[184:187], v[52:55]
    ds_read_b128 v[240:243], v1 offset:34816
    v_mfma_f32_16x16x32_bf16 v[56:59], v[160:163], v[188:191], v[56:59]
    ds_read_b128 v[244:247], v1 offset:35840
    v_mfma_f32_16x16x32_bf16 v[60:63], v[164:167], v[188:191], v[60:63]
    s_waitcnt vmcnt(0)
    v_mfma_f32_16x16x32_bf16 v[64:67], v[160:163], v[192:195], v[64:67]
    v_add_f32 v248, v8, v10
    v_mfma_f32_16x16x32_bf16 v[68:71], v[164:167], v[192:195], v[68:71]
    v_add_f32 v249, v9, v11
    v_mfma_f32_16x16x32_bf16 v[72:75], v[160:163], v[196:199], v[72:75]
    v_add_f32 v250, v12, v14
    v_mfma_f32_16x16x32_bf16 v[76:79], v[164:167], v[196:199], v[76:79]
    v_add_f32 v251, v13, v15
    v_mfma_f32_16x16x32_bf16 v[80:83], v[160:163], v[200:203], v[80:83]
    v_mov_b32 v8, v248
    v_mfma_f32_16x16x32_bf16 v[84:87], v[164:167], v[200:203], v[84:87]
    v_mov_b32 v9, v249
    s_waitcnt lgkmcnt(0)
    s_barrier
    v_mfma_f32_16x16x32_bf16 v[16:19], v[204:207], v[212:215], v[16:19]
    ds_read_b128 v[160:163], v3 offset:32768
    v_mfma_f32_16x16x32_bf16 v[20:23], v[208:211], v[212:215], v[20:23]
    ds_read_b128 v[164:167], v3 offset:34816
    v_mfma_f32_16x16x32_bf16 v[24:27], v[204:207], v[216:219], v[24:27]
    ds_read_b128 v[168:171], v2 offset:0
    v_mfma_f32_16x16x32_bf16 v[28:31], v[208:211], v[216:219], v[28:31]
    ds_read_b128 v[172:175], v2 offset:1024
    v_mfma_f32_16x16x32_bf16 v[32:35], v[204:207], v[220:223], v[32:35]
    ds_read_b128 v[176:179], v2 offset:2048
    v_mfma_f32_16x16x32_bf16 v[36:39], v[208:211], v[220:223], v[36:39]
    ds_read_b128 v[180:183], v2 offset:3072
    v_mfma_f32_16x16x32_bf16 v[40:43], v[204:207], v[224:227], v[40:43]
    ds_read_b128 v[184:187], v2 offset:4096
    v_mfma_f32_16x16x32_bf16 v[44:47], v[208:211], v[224:227], v[44:47]
    ds_read_b128 v[188:191], v2 offset:5120
    v_mfma_f32_16x16x32_bf16 v[48:51], v[204:207], v[228:231], v[48:51]
    ds_read_b128 v[192:195], v2 offset:6144
    v_mfma_f32_16x16x32_bf16 v[52:55], v[208:211], v[228:231], v[52:55]
    ds_read_b128 v[196:199], v2 offset:7168
    v_mfma_f32_16x16x32_bf16 v[56:59], v[204:207], v[232:235], v[56:59]
    ds_read_b128 v[200:203], v2 offset:8192
    v_mfma_f32_16x16x32_bf16 v[60:63], v[208:211], v[232:235], v[60:63]
    v_mov_b32 v12, v250
    v_mfma_f32_16x16x32_bf16 v[64:67], v[204:207], v[236:239], v[64:67]
    v_mov_b32 v13, v251
    v_mfma_f32_16x16x32_bf16 v[68:71], v[208:211], v[236:239], v[68:71]
    v_permlane32_swap_b32 v248, v8
    v_mfma_f32_16x16x32_bf16 v[72:75], v[204:207], v[240:243], v[72:75]
    v_permlane32_swap_b32 v249, v9
    v_mfma_f32_16x16x32_bf16 v[76:79], v[208:211], v[240:243], v[76:79]
    v_permlane32_swap_b32 v250, v12
    v_mfma_f32_16x16x32_bf16 v[80:83], v[204:207], v[244:247], v[80:83]
    v_permlane32_swap_b32 v251, v13
    v_mfma_f32_16x16x32_bf16 v[84:87], v[208:211], v[244:247], v[84:87]
    v_add_f32 v248, v248, v8
    s_waitcnt lgkmcnt(5)
    v_mfma_f32_16x16x32_bf16 v[16:19], v[160:163], v[168:171], v[16:19]
    ds_read_b128 v[204:207], v3 offset:33792
    v_mfma_f32_16x16x32_bf16 v[20:23], v[164:167], v[168:171], v[20:23]
    ds_read_b128 v[208:211], v3 offset:35840
    v_mfma_f32_16x16x32_bf16 v[24:27], v[160:163], v[172:175], v[24:27]
    ds_read_b128 v[212:215], v2 offset:9216
    v_mfma_f32_16x16x32_bf16 v[28:31], v[164:167], v[172:175], v[28:31]
    ds_read_b128 v[216:219], v2 offset:10240
    v_mfma_f32_16x16x32_bf16 v[32:35], v[160:163], v[176:179], v[32:35]
    ds_read_b128 v[220:223], v2 offset:11264
    v_mfma_f32_16x16x32_bf16 v[36:39], v[164:167], v[176:179], v[36:39]
    ds_read_b128 v[224:227], v2 offset:12288
    v_mfma_f32_16x16x32_bf16 v[40:43], v[160:163], v[180:183], v[40:43]
    ds_read_b128 v[228:231], v2 offset:13312
    v_mfma_f32_16x16x32_bf16 v[44:47], v[164:167], v[180:183], v[44:47]
    ds_read_b128 v[232:235], v2 offset:14336
    s_waitcnt lgkmcnt(8)
    v_mfma_f32_16x16x32_bf16 v[48:51], v[160:163], v[184:187], v[48:51]
    ds_read_b128 v[236:239], v2 offset:15360
    v_mfma_f32_16x16x32_bf16 v[52:55], v[164:167], v[184:187], v[52:55]
    ds_read_b128 v[240:243], v2 offset:16384
    v_mfma_f32_16x16x32_bf16 v[56:59], v[160:163], v[188:191], v[56:59]
    ds_read_b128 v[244:247], v2 offset:17408
    v_mfma_f32_16x16x32_bf16 v[60:63], v[164:167], v[188:191], v[60:63]
    v_add_f32 v249, v249, v9
    v_mfma_f32_16x16x32_bf16 v[64:67], v[160:163], v[192:195], v[64:67]
    v_add_f32 v250, v250, v12
    v_mfma_f32_16x16x32_bf16 v[68:71], v[164:167], v[192:195], v[68:71]
    v_add_f32 v251, v251, v13
    v_mfma_f32_16x16x32_bf16 v[72:75], v[160:163], v[196:199], v[72:75]
    v_mov_b32 v8, v248
    v_mfma_f32_16x16x32_bf16 v[76:79], v[164:167], v[196:199], v[76:79]
    v_mov_b32 v9, v249
    v_mfma_f32_16x16x32_bf16 v[80:83], v[160:163], v[200:203], v[80:83]
    v_mov_b32 v12, v250
    v_mfma_f32_16x16x32_bf16 v[84:87], v[164:167], v[200:203], v[84:87]
    v_mov_b32 v13, v251
    s_waitcnt lgkmcnt(0)
    s_barrier
    v_mfma_f32_16x16x32_bf16 v[16:19], v[204:207], v[212:215], v[16:19]
    ds_read_b128 v[160:163], v3 offset:49152
    v_mfma_f32_16x16x32_bf16 v[20:23], v[208:211], v[212:215], v[20:23]
    ds_read_b128 v[164:167], v3 offset:51200
    v_mfma_f32_16x16x32_bf16 v[24:27], v[204:207], v[216:219], v[24:27]
    ds_read_b128 v[168:171], v2 offset:18432
    v_mfma_f32_16x16x32_bf16 v[28:31], v[208:211], v[216:219], v[28:31]
    ds_read_b128 v[172:175], v2 offset:19456
    v_mfma_f32_16x16x32_bf16 v[32:35], v[204:207], v[220:223], v[32:35]
    ds_read_b128 v[176:179], v2 offset:20480
    v_mfma_f32_16x16x32_bf16 v[36:39], v[208:211], v[220:223], v[36:39]
    ds_read_b128 v[180:183], v2 offset:21504
    v_mfma_f32_16x16x32_bf16 v[40:43], v[204:207], v[224:227], v[40:43]
    ds_read_b128 v[184:187], v2 offset:22528
    v_mfma_f32_16x16x32_bf16 v[44:47], v[208:211], v[224:227], v[44:47]
    ds_read_b128 v[188:191], v2 offset:23552
    v_mfma_f32_16x16x32_bf16 v[48:51], v[204:207], v[228:231], v[48:51]
    ds_read_b128 v[192:195], v2 offset:24576
    v_mfma_f32_16x16x32_bf16 v[52:55], v[208:211], v[228:231], v[52:55]
    ds_read_b128 v[196:199], v2 offset:25600
    v_mfma_f32_16x16x32_bf16 v[56:59], v[204:207], v[232:235], v[56:59]
    ds_read_b128 v[200:203], v2 offset:26624
    v_mfma_f32_16x16x32_bf16 v[60:63], v[208:211], v[232:235], v[60:63]
    v_permlane16_swap_b32 v248, v8
    v_mfma_f32_16x16x32_bf16 v[64:67], v[204:207], v[236:239], v[64:67]
    v_permlane16_swap_b32 v249, v9
    v_mfma_f32_16x16x32_bf16 v[68:71], v[208:211], v[236:239], v[68:71]
    v_permlane16_swap_b32 v250, v12
    v_mfma_f32_16x16x32_bf16 v[72:75], v[204:207], v[240:243], v[72:75]
    v_permlane16_swap_b32 v251, v13
    v_mfma_f32_16x16x32_bf16 v[76:79], v[208:211], v[240:243], v[76:79]
    v_add_f32 v248, v248, v8
    v_mfma_f32_16x16x32_bf16 v[80:83], v[204:207], v[244:247], v[80:83]
    v_add_f32 v249, v249, v9
    v_mfma_f32_16x16x32_bf16 v[84:87], v[208:211], v[244:247], v[84:87]
    v_add_f32 v250, v250, v12
    s_waitcnt lgkmcnt(5)
    v_mfma_f32_16x16x32_bf16 v[16:19], v[160:163], v[168:171], v[16:19]
    ds_read_b128 v[204:207], v3 offset:50176
    v_mfma_f32_16x16x32_bf16 v[20:23], v[164:167], v[168:171], v[20:23]
    ds_read_b128 v[208:211], v3 offset:52224
    v_mfma_f32_16x16x32_bf16 v[24:27], v[160:163], v[172:175], v[24:27]
    ds_read_b128 v[212:215], v2 offset:27648
    v_mfma_f32_16x16x32_bf16 v[28:31], v[164:167], v[172:175], v[28:31]
    ds_read_b128 v[216:219], v2 offset:28672
    v_mfma_f32_16x16x32_bf16 v[32:35], v[160:163], v[176:179], v[32:35]
    ds_read_b128 v[220:223], v2 offset:29696
    v_mfma_f32_16x16x32_bf16 v[36:39], v[164:167], v[176:179], v[36:39]
    ds_read_b128 v[224:227], v2 offset:30720
    v_mfma_f32_16x16x32_bf16 v[40:43], v[160:163], v[180:183], v[40:43]
    ds_read_b128 v[228:231], v2 offset:31744
    v_mfma_f32_16x16x32_bf16 v[44:47], v[164:167], v[180:183], v[44:47]
    ds_read_b128 v[232:235], v2 offset:32768
    s_waitcnt lgkmcnt(8)
    v_mfma_f32_16x16x32_bf16 v[48:51], v[160:163], v[184:187], v[48:51]
    ds_read_b128 v[236:239], v2 offset:33792
    v_mfma_f32_16x16x32_bf16 v[52:55], v[164:167], v[184:187], v[52:55]
    ds_read_b128 v[240:243], v2 offset:34816
    v_mfma_f32_16x16x32_bf16 v[56:59], v[160:163], v[188:191], v[56:59]
    ds_read_b128 v[244:247], v2 offset:35840
    v_mfma_f32_16x16x32_bf16 v[60:63], v[164:167], v[188:191], v[60:63]
    v_add_f32 v251, v251, v13
    v_mfma_f32_16x16x32_bf16 v[64:67], v[160:163], v[192:195], v[64:67]
    v_mul_f32 v248, 0x3ae38e39, v248
    v_mfma_f32_16x16x32_bf16 v[68:71], v[164:167], v[192:195], v[68:71]
    v_mul_f32 v249, 0x3ae38e39, v249
    v_mfma_f32_16x16x32_bf16 v[72:75], v[160:163], v[196:199], v[72:75]
    v_mul_f32 v250, 0x3ae38e39, v250
    v_mfma_f32_16x16x32_bf16 v[76:79], v[164:167], v[196:199], v[76:79]
    v_mul_f32 v251, 0x3ae38e39, v251
    v_mfma_f32_16x16x32_bf16 v[80:83], v[160:163], v[200:203], v[80:83]
    v_fma_f32 v249, -v248, v248, v249
    v_mfma_f32_16x16x32_bf16 v[84:87], v[164:167], v[200:203], v[84:87]
    v_fma_f32 v251, -v250, v250, v251
    s_waitcnt lgkmcnt(0)
    s_barrier
    v_mfma_f32_16x16x32_bf16 v[16:19], v[204:207], v[212:215], v[16:19]
    ds_read_b128 v[160:163], v3 offset:0
    v_mfma_f32_16x16x32_bf16 v[20:23], v[208:211], v[212:215], v[20:23]
    ds_read_b128 v[164:167], v3 offset:2048
    v_mfma_f32_16x16x32_bf16 v[24:27], v[204:207], v[216:219], v[24:27]
    ds_read_b128 v[168:171], v1 offset:0
    v_mfma_f32_16x16x32_bf16 v[28:31], v[208:211], v[216:219], v[28:31]
    ds_read_b128 v[172:175], v1 offset:1024
    v_mfma_f32_16x16x32_bf16 v[32:35], v[204:207], v[220:223], v[32:35]
    ds_read_b128 v[176:179], v1 offset:2048
    v_mfma_f32_16x16x32_bf16 v[36:39], v[208:211], v[220:223], v[36:39]
    ds_read_b128 v[180:183], v1 offset:3072
    v_mfma_f32_16x16x32_bf16 v[40:43], v[204:207], v[224:227], v[40:43]
    ds_read_b128 v[184:187], v1 offset:4096
    v_mfma_f32_16x16x32_bf16 v[44:47], v[208:211], v[224:227], v[44:47]
    ds_read_b128 v[188:191], v1 offset:5120
    v_mfma_f32_16x16x32_bf16 v[48:51], v[204:207], v[228:231], v[48:51]
    ds_read_b128 v[192:195], v1 offset:6144
    v_mfma_f32_16x16x32_bf16 v[52:55], v[208:211], v[228:231], v[52:55]
    ds_read_b128 v[196:199], v1 offset:7168
    v_mfma_f32_16x16x32_bf16 v[56:59], v[204:207], v[232:235], v[56:59]
    ds_read_b128 v[200:203], v1 offset:8192
    v_mfma_f32_16x16x32_bf16 v[60:63], v[208:211], v[232:235], v[60:63]
    v_max_f32 v249, 0, v249
    v_mfma_f32_16x16x32_bf16 v[64:67], v[204:207], v[236:239], v[64:67]
    v_max_f32 v251, 0, v251
    v_mfma_f32_16x16x32_bf16 v[68:71], v[208:211], v[236:239], v[68:71]
    v_add_f32 v249, 0x3727c5ac, v249
    v_mfma_f32_16x16x32_bf16 v[72:75], v[204:207], v[240:243], v[72:75]
    v_add_f32 v251, 0x3727c5ac, v251
    v_mfma_f32_16x16x32_bf16 v[76:79], v[208:211], v[240:243], v[76:79]
    v_rsq_f32 v249, v249
    v_mfma_f32_16x16x32_bf16 v[80:83], v[204:207], v[244:247], v[80:83]
    v_rsq_f32 v251, v251
    v_mfma_f32_16x16x32_bf16 v[84:87], v[208:211], v[244:247], v[84:87]
    s_nop 0
    s_waitcnt lgkmcnt(5)
    v_mfma_f32_16x16x32_bf16 v[16:19], v[160:163], v[168:171], v[16:19]
    ds_read_b128 v[204:207], v3 offset:1024
    v_mfma_f32_16x16x32_bf16 v[20:23], v[164:167], v[168:171], v[20:23]
    ds_read_b128 v[208:211], v3 offset:3072
    v_mfma_f32_16x16x32_bf16 v[24:27], v[160:163], v[172:175], v[24:27]
    ds_read_b128 v[212:215], v1 offset:9216
    v_mfma_f32_16x16x32_bf16 v[28:31], v[164:167], v[172:175], v[28:31]
    ds_read_b128 v[216:219], v1 offset:10240
    v_mfma_f32_16x16x32_bf16 v[32:35], v[160:163], v[176:179], v[32:35]
    ds_read_b128 v[220:223], v1 offset:11264
    v_mfma_f32_16x16x32_bf16 v[36:39], v[164:167], v[176:179], v[36:39]
    ds_read_b128 v[224:227], v1 offset:12288
    v_mfma_f32_16x16x32_bf16 v[40:43], v[160:163], v[180:183], v[40:43]
    ds_read_b128 v[228:231], v1 offset:13312
    v_mfma_f32_16x16x32_bf16 v[44:47], v[164:167], v[180:183], v[44:47]
    ds_read_b128 v[232:235], v1 offset:14336
    s_waitcnt lgkmcnt(8)
    v_mfma_f32_16x16x32_bf16 v[48:51], v[160:163], v[184:187], v[48:51]
    ds_read_b128 v[236:239], v1 offset:15360
    v_mfma_f32_16x16x32_bf16 v[52:55], v[164:167], v[184:187], v[52:55]
    ds_read_b128 v[240:243], v1 offset:16384
    v_mfma_f32_16x16x32_bf16 v[56:59], v[160:163], v[188:191], v[56:59]
    ds_read_b128 v[244:247], v1 offset:17408
    v_mfma_f32_16x16x32_bf16 v[60:63], v[164:167], v[188:191], v[60:63]
    v_bfe_u32 v5, v0, 4, 2
    v_mfma_f32_16x16x32_bf16 v[64:67], v[160:163], v[192:195], v[64:67]
    v_and_b32 v6, 15, v0
    v_mfma_f32_16x16x32_bf16 v[68:71], v[164:167], v[192:195], v[68:71]
    v_lshlrev_b32 v8, 4, v5
    v_mfma_f32_16x16x32_bf16 v[72:75], v[160:163], v[196:199], v[72:75]
    v_add_u32 v9, 4, v8
    v_mfma_f32_16x16x32_bf16 v[76:79], v[164:167], v[196:199], v[76:79]
    v_add_u32 v10, 8, v8
    v_mfma_f32_16x16x32_bf16 v[80:83], v[160:163], v[200:203], v[80:83]
    v_add_u32 v11, 12, v8
    v_mfma_f32_16x16x32_bf16 v[84:87], v[164:167], v[200:203], v[84:87]
    v_lshlrev_b32 v7, 2, v6
    s_waitcnt lgkmcnt(0)
    s_barrier
    v_mfma_f32_16x16x32_bf16 v[16:19], v[204:207], v[212:215], v[16:19]
    ds_read_b128 v[160:163], v3 offset:16384
    v_mfma_f32_16x16x32_bf16 v[20:23], v[208:211], v[212:215], v[20:23]
    ds_read_b128 v[164:167], v3 offset:18432
    v_mfma_f32_16x16x32_bf16 v[24:27], v[204:207], v[216:219], v[24:27]
    ds_read_b128 v[168:171], v1 offset:18432
    v_mfma_f32_16x16x32_bf16 v[28:31], v[208:211], v[216:219], v[28:31]
    ds_read_b128 v[172:175], v1 offset:19456
    v_mfma_f32_16x16x32_bf16 v[32:35], v[204:207], v[220:223], v[32:35]
    ds_read_b128 v[176:179], v1 offset:20480
    v_mfma_f32_16x16x32_bf16 v[36:39], v[208:211], v[220:223], v[36:39]
    ds_read_b128 v[180:183], v1 offset:21504
    v_mfma_f32_16x16x32_bf16 v[40:43], v[204:207], v[224:227], v[40:43]
    ds_read_b128 v[184:187], v1 offset:22528
    v_mfma_f32_16x16x32_bf16 v[44:47], v[208:211], v[224:227], v[44:47]
    ds_read_b128 v[188:191], v1 offset:23552
    v_mfma_f32_16x16x32_bf16 v[48:51], v[204:207], v[228:231], v[48:51]
    ds_read_b128 v[192:195], v1 offset:24576
    v_mfma_f32_16x16x32_bf16 v[52:55], v[208:211], v[228:231], v[52:55]
    ds_read_b128 v[196:199], v1 offset:25600
    v_mfma_f32_16x16x32_bf16 v[56:59], v[204:207], v[232:235], v[56:59]
    ds_read_b128 v[200:203], v1 offset:26624
    v_mfma_f32_16x16x32_bf16 v[60:63], v[208:211], v[232:235], v[60:63]
    v_add_u32 v7, 139264, v7
    v_mfma_f32_16x16x32_bf16 v[64:67], v[204:207], v[236:239], v[64:67]
    v_mfma_f32_16x16x32_bf16 v[68:71], v[208:211], v[236:239], v[68:71]
    v_mfma_f32_16x16x32_bf16 v[72:75], v[204:207], v[240:243], v[72:75]
    v_mfma_f32_16x16x32_bf16 v[76:79], v[208:211], v[240:243], v[76:79]
    v_mfma_f32_16x16x32_bf16 v[80:83], v[204:207], v[244:247], v[80:83]
    v_mfma_f32_16x16x32_bf16 v[84:87], v[208:211], v[244:247], v[84:87]
    s_waitcnt lgkmcnt(5)
    v_mfma_f32_16x16x32_bf16 v[16:19], v[160:163], v[168:171], v[16:19]
    ds_read_b128 v[204:207], v3 offset:17408
    v_mfma_f32_16x16x32_bf16 v[20:23], v[164:167], v[168:171], v[20:23]
    ds_read_b128 v[208:211], v3 offset:19456
    v_mfma_f32_16x16x32_bf16 v[24:27], v[160:163], v[172:175], v[24:27]
    ds_read_b128 v[212:215], v1 offset:27648
    v_mfma_f32_16x16x32_bf16 v[28:31], v[164:167], v[172:175], v[28:31]
    ds_read_b128 v[216:219], v1 offset:28672
    v_mfma_f32_16x16x32_bf16 v[32:35], v[160:163], v[176:179], v[32:35]
    ds_read_b128 v[220:223], v1 offset:29696
    v_mfma_f32_16x16x32_bf16 v[36:39], v[164:167], v[176:179], v[36:39]
    ds_read_b128 v[224:227], v1 offset:30720
    v_mfma_f32_16x16x32_bf16 v[40:43], v[160:163], v[180:183], v[40:43]
    ds_read_b128 v[228:231], v1 offset:31744
    v_mfma_f32_16x16x32_bf16 v[44:47], v[164:167], v[180:183], v[44:47]
    ds_read_b128 v[232:235], v1 offset:32768
    s_waitcnt lgkmcnt(8)
    v_mfma_f32_16x16x32_bf16 v[48:51], v[160:163], v[184:187], v[48:51]
    ds_read_b128 v[236:239], v1 offset:33792
    v_mfma_f32_16x16x32_bf16 v[52:55], v[164:167], v[184:187], v[52:55]
    ds_read_b128 v[240:243], v1 offset:34816
    v_mfma_f32_16x16x32_bf16 v[56:59], v[160:163], v[188:191], v[56:59]
    ds_read_b128 v[244:247], v1 offset:35840
    v_mfma_f32_16x16x32_bf16 v[60:63], v[164:167], v[188:191], v[60:63]
    v_mfma_f32_16x16x32_bf16 v[64:67], v[160:163], v[192:195], v[64:67]
    v_mfma_f32_16x16x32_bf16 v[68:71], v[164:167], v[192:195], v[68:71]
    v_mfma_f32_16x16x32_bf16 v[72:75], v[160:163], v[196:199], v[72:75]
    v_mfma_f32_16x16x32_bf16 v[76:79], v[164:167], v[196:199], v[76:79]
    v_mfma_f32_16x16x32_bf16 v[80:83], v[160:163], v[200:203], v[80:83]
    v_mfma_f32_16x16x32_bf16 v[84:87], v[164:167], v[200:203], v[84:87]
    s_waitcnt lgkmcnt(0)
    s_barrier
    v_mfma_f32_16x16x32_bf16 v[16:19], v[204:207], v[212:215], v[16:19]
    ds_read_b128 v[160:163], v3 offset:32768
    v_mfma_f32_16x16x32_bf16 v[20:23], v[208:211], v[212:215], v[20:23]
    ds_read_b128 v[164:167], v3 offset:34816
    v_mfma_f32_16x16x32_bf16 v[24:27], v[204:207], v[216:219], v[24:27]
    ds_read_b128 v[168:171], v2 offset:0
    v_mfma_f32_16x16x32_bf16 v[28:31], v[208:211], v[216:219], v[28:31]
    ds_read_b128 v[172:175], v2 offset:1024
    v_mfma_f32_16x16x32_bf16 v[32:35], v[204:207], v[220:223], v[32:35]
    ds_read_b128 v[176:179], v2 offset:2048
    v_mfma_f32_16x16x32_bf16 v[36:39], v[208:211], v[220:223], v[36:39]
    ds_read_b128 v[180:183], v2 offset:3072
    v_mfma_f32_16x16x32_bf16 v[40:43], v[204:207], v[224:227], v[40:43]
    ds_read_b128 v[184:187], v2 offset:4096
    v_mfma_f32_16x16x32_bf16 v[44:47], v[208:211], v[224:227], v[44:47]
    ds_read_b128 v[188:191], v2 offset:5120
    v_mfma_f32_16x16x32_bf16 v[48:51], v[204:207], v[228:231], v[48:51]
    ds_read_b128 v[192:195], v2 offset:6144
    v_mfma_f32_16x16x32_bf16 v[52:55], v[208:211], v[228:231], v[52:55]
    ds_read_b128 v[196:199], v2 offset:7168
    v_mfma_f32_16x16x32_bf16 v[56:59], v[204:207], v[232:235], v[56:59]
    ds_read_b128 v[200:203], v2 offset:8192
    v_mfma_f32_16x16x32_bf16 v[60:63], v[208:211], v[232:235], v[60:63]
    v_mfma_f32_16x16x32_bf16 v[64:67], v[204:207], v[236:239], v[64:67]
    v_mfma_f32_16x16x32_bf16 v[68:71], v[208:211], v[236:239], v[68:71]
    v_mfma_f32_16x16x32_bf16 v[72:75], v[204:207], v[240:243], v[72:75]
    v_mfma_f32_16x16x32_bf16 v[76:79], v[208:211], v[240:243], v[76:79]
    v_mfma_f32_16x16x32_bf16 v[80:83], v[204:207], v[244:247], v[80:83]
    v_mfma_f32_16x16x32_bf16 v[84:87], v[208:211], v[244:247], v[84:87]
    s_waitcnt lgkmcnt(5)
    v_mfma_f32_16x16x32_bf16 v[16:19], v[160:163], v[168:171], v[16:19]
    ds_read_b128 v[204:207], v3 offset:33792
    v_mfma_f32_16x16x32_bf16 v[20:23], v[164:167], v[168:171], v[20:23]
    ds_read_b128 v[208:211], v3 offset:35840
    v_mfma_f32_16x16x32_bf16 v[24:27], v[160:163], v[172:175], v[24:27]
    ds_read_b128 v[212:215], v2 offset:9216
    v_mfma_f32_16x16x32_bf16 v[28:31], v[164:167], v[172:175], v[28:31]
    ds_read_b128 v[216:219], v2 offset:10240
    v_mfma_f32_16x16x32_bf16 v[32:35], v[160:163], v[176:179], v[32:35]
    ds_read_b128 v[220:223], v2 offset:11264
    v_mfma_f32_16x16x32_bf16 v[36:39], v[164:167], v[176:179], v[36:39]
    ds_read_b128 v[224:227], v2 offset:12288
    v_mfma_f32_16x16x32_bf16 v[40:43], v[160:163], v[180:183], v[40:43]
    ds_read_b128 v[228:231], v2 offset:13312
    v_mfma_f32_16x16x32_bf16 v[44:47], v[164:167], v[180:183], v[44:47]
    ds_read_b128 v[232:235], v2 offset:14336
    s_waitcnt lgkmcnt(8)
    v_mfma_f32_16x16x32_bf16 v[48:51], v[160:163], v[184:187], v[48:51]
    ds_read_b128 v[236:239], v2 offset:15360
    v_mfma_f32_16x16x32_bf16 v[52:55], v[164:167], v[184:187], v[52:55]
    ds_read_b128 v[240:243], v2 offset:16384
    v_mfma_f32_16x16x32_bf16 v[56:59], v[160:163], v[188:191], v[56:59]
    ds_read_b128 v[244:247], v2 offset:17408
    v_mfma_f32_16x16x32_bf16 v[60:63], v[164:167], v[188:191], v[60:63]
    v_mfma_f32_16x16x32_bf16 v[64:67], v[160:163], v[192:195], v[64:67]
    v_mfma_f32_16x16x32_bf16 v[68:71], v[164:167], v[192:195], v[68:71]
    v_mfma_f32_16x16x32_bf16 v[72:75], v[160:163], v[196:199], v[72:75]
    v_mfma_f32_16x16x32_bf16 v[76:79], v[164:167], v[196:199], v[76:79]
    v_mfma_f32_16x16x32_bf16 v[80:83], v[160:163], v[200:203], v[80:83]
    v_mfma_f32_16x16x32_bf16 v[84:87], v[164:167], v[200:203], v[84:87]
    s_waitcnt lgkmcnt(0)
    s_barrier
    v_mfma_f32_16x16x32_bf16 v[16:19], v[204:207], v[212:215], v[16:19]
    ds_read_b128 v[160:163], v3 offset:49152
    v_mfma_f32_16x16x32_bf16 v[20:23], v[208:211], v[212:215], v[20:23]
    ds_read_b128 v[164:167], v3 offset:51200
    v_mfma_f32_16x16x32_bf16 v[24:27], v[204:207], v[216:219], v[24:27]
    ds_read_b128 v[168:171], v2 offset:18432
    v_mfma_f32_16x16x32_bf16 v[28:31], v[208:211], v[216:219], v[28:31]
    ds_read_b128 v[172:175], v2 offset:19456
    v_mfma_f32_16x16x32_bf16 v[32:35], v[204:207], v[220:223], v[32:35]
    ds_read_b128 v[176:179], v2 offset:20480
    v_mfma_f32_16x16x32_bf16 v[36:39], v[208:211], v[220:223], v[36:39]
    ds_read_b128 v[180:183], v2 offset:21504
    v_mfma_f32_16x16x32_bf16 v[40:43], v[204:207], v[224:227], v[40:43]
    ds_read_b128 v[184:187], v2 offset:22528
    v_mfma_f32_16x16x32_bf16 v[44:47], v[208:211], v[224:227], v[44:47]
    ds_read_b128 v[188:191], v2 offset:23552
    v_mfma_f32_16x16x32_bf16 v[48:51], v[204:207], v[228:231], v[48:51]
    ds_read_b128 v[192:195], v2 offset:24576
    v_mfma_f32_16x16x32_bf16 v[52:55], v[208:211], v[228:231], v[52:55]
    ds_read_b128 v[196:199], v2 offset:25600
    v_mfma_f32_16x16x32_bf16 v[56:59], v[204:207], v[232:235], v[56:59]
    ds_read_b128 v[200:203], v2 offset:26624
    v_mfma_f32_16x16x32_bf16 v[60:63], v[208:211], v[232:235], v[60:63]
    v_mfma_f32_16x16x32_bf16 v[64:67], v[204:207], v[236:239], v[64:67]
    v_mfma_f32_16x16x32_bf16 v[68:71], v[208:211], v[236:239], v[68:71]
    v_mfma_f32_16x16x32_bf16 v[72:75], v[204:207], v[240:243], v[72:75]
    v_mfma_f32_16x16x32_bf16 v[76:79], v[208:211], v[240:243], v[76:79]
    v_mfma_f32_16x16x32_bf16 v[80:83], v[204:207], v[244:247], v[80:83]
    v_mfma_f32_16x16x32_bf16 v[84:87], v[208:211], v[244:247], v[84:87]
    s_waitcnt lgkmcnt(5)
    v_mfma_f32_16x16x32_bf16 v[16:19], v[160:163], v[168:171], v[16:19]
    ds_read_b128 v[204:207], v3 offset:50176
    v_mfma_f32_16x16x32_bf16 v[20:23], v[164:167], v[168:171], v[20:23]
    ds_read_b128 v[208:211], v3 offset:52224
    v_mfma_f32_16x16x32_bf16 v[24:27], v[160:163], v[172:175], v[24:27]
    ds_read_b128 v[212:215], v2 offset:27648
    v_mfma_f32_16x16x32_bf16 v[28:31], v[164:167], v[172:175], v[28:31]
    ds_read_b128 v[216:219], v2 offset:28672
    v_mfma_f32_16x16x32_bf16 v[32:35], v[160:163], v[176:179], v[32:35]
    ds_read_b128 v[220:223], v2 offset:29696
    v_mfma_f32_16x16x32_bf16 v[36:39], v[164:167], v[176:179], v[36:39]
    ds_read_b128 v[224:227], v2 offset:30720
    v_mfma_f32_16x16x32_bf16 v[40:43], v[160:163], v[180:183], v[40:43]
    ds_read_b128 v[228:231], v2 offset:31744
    v_mfma_f32_16x16x32_bf16 v[44:47], v[164:167], v[180:183], v[44:47]
    ds_read_b128 v[232:235], v2 offset:32768
    s_waitcnt lgkmcnt(8)
    v_mfma_f32_16x16x32_bf16 v[48:51], v[160:163], v[184:187], v[48:51]
    ds_read_b128 v[236:239], v2 offset:33792
    v_mfma_f32_16x16x32_bf16 v[52:55], v[164:167], v[184:187], v[52:55]
    ds_read_b128 v[240:243], v2 offset:34816
    v_mfma_f32_16x16x32_bf16 v[56:59], v[160:163], v[188:191], v[56:59]
    ds_read_b128 v[244:247], v2 offset:35840
    v_mfma_f32_16x16x32_bf16 v[60:63], v[164:167], v[188:191], v[60:63]
    v_mfma_f32_16x16x32_bf16 v[64:67], v[160:163], v[192:195], v[64:67]
    v_mfma_f32_16x16x32_bf16 v[68:71], v[164:167], v[192:195], v[68:71]
    v_mfma_f32_16x16x32_bf16 v[72:75], v[160:163], v[196:199], v[72:75]
    v_mfma_f32_16x16x32_bf16 v[76:79], v[164:167], v[196:199], v[76:79]
    v_mfma_f32_16x16x32_bf16 v[80:83], v[160:163], v[200:203], v[80:83]
    v_mfma_f32_16x16x32_bf16 v[84:87], v[164:167], v[200:203], v[84:87]
    s_waitcnt lgkmcnt(0)
    s_barrier
    v_mfma_f32_16x16x32_bf16 v[16:19], v[204:207], v[212:215], v[16:19]
    ds_read_b128 v[160:163], v3 offset:0
    v_mfma_f32_16x16x32_bf16 v[20:23], v[208:211], v[212:215], v[20:23]
    ds_read_b128 v[164:167], v3 offset:2048
    v_mfma_f32_16x16x32_bf16 v[24:27], v[204:207], v[216:219], v[24:27]
    ds_read_b128 v[168:171], v1 offset:0
    v_mfma_f32_16x16x32_bf16 v[28:31], v[208:211], v[216:219], v[28:31]
    ds_read_b128 v[172:175], v1 offset:1024
    v_mfma_f32_16x16x32_bf16 v[32:35], v[204:207], v[220:223], v[32:35]
    ds_read_b128 v[176:179], v1 offset:2048
    v_mfma_f32_16x16x32_bf16 v[36:39], v[208:211], v[220:223], v[36:39]
    ds_read_b128 v[180:183], v1 offset:3072
    v_mfma_f32_16x16x32_bf16 v[40:43], v[204:207], v[224:227], v[40:43]
    ds_read_b128 v[184:187], v1 offset:4096
    v_mfma_f32_16x16x32_bf16 v[44:47], v[208:211], v[224:227], v[44:47]
    ds_read_b128 v[188:191], v1 offset:5120
    v_mfma_f32_16x16x32_bf16 v[48:51], v[204:207], v[228:231], v[48:51]
    ds_read_b128 v[192:195], v1 offset:6144
    v_mfma_f32_16x16x32_bf16 v[52:55], v[208:211], v[228:231], v[52:55]
    ds_read_b128 v[196:199], v1 offset:7168
    v_mfma_f32_16x16x32_bf16 v[56:59], v[204:207], v[232:235], v[56:59]
    ds_read_b128 v[200:203], v1 offset:8192
    v_mfma_f32_16x16x32_bf16 v[60:63], v[208:211], v[232:235], v[60:63]
    v_mfma_f32_16x16x32_bf16 v[64:67], v[204:207], v[236:239], v[64:67]
    v_mfma_f32_16x16x32_bf16 v[68:71], v[208:211], v[236:239], v[68:71]
    v_mfma_f32_16x16x32_bf16 v[72:75], v[204:207], v[240:243], v[72:75]
    v_mfma_f32_16x16x32_bf16 v[76:79], v[208:211], v[240:243], v[76:79]
    v_mfma_f32_16x16x32_bf16 v[80:83], v[204:207], v[244:247], v[80:83]
    v_mfma_f32_16x16x32_bf16 v[84:87], v[208:211], v[244:247], v[84:87]
    s_waitcnt lgkmcnt(5)
    v_mfma_f32_16x16x32_bf16 v[16:19], v[160:163], v[168:171], v[16:19]
    ds_read_b128 v[204:207], v3 offset:1024
    v_mfma_f32_16x16x32_bf16 v[20:23], v[164:167], v[168:171], v[20:23]
    ds_read_b128 v[208:211], v3 offset:3072
    v_mfma_f32_16x16x32_bf16 v[24:27], v[160:163], v[172:175], v[24:27]
    ds_read_b128 v[212:215], v1 offset:9216
    v_mfma_f32_16x16x32_bf16 v[28:31], v[164:167], v[172:175], v[28:31]
    ds_read_b128 v[216:219], v1 offset:10240
    v_mfma_f32_16x16x32_bf16 v[32:35], v[160:163], v[176:179], v[32:35]
    ds_read_b128 v[220:223], v1 offset:11264
    v_mfma_f32_16x16x32_bf16 v[36:39], v[164:167], v[176:179], v[36:39]
    ds_read_b128 v[224:227], v1 offset:12288
    v_mfma_f32_16x16x32_bf16 v[40:43], v[160:163], v[180:183], v[40:43]
    ds_read_b128 v[228:231], v1 offset:13312
    v_mfma_f32_16x16x32_bf16 v[44:47], v[164:167], v[180:183], v[44:47]
    ds_read_b128 v[232:235], v1 offset:14336
    s_waitcnt lgkmcnt(8)
    v_mfma_f32_16x16x32_bf16 v[48:51], v[160:163], v[184:187], v[48:51]
    ds_read_b128 v[236:239], v1 offset:15360
    v_mfma_f32_16x16x32_bf16 v[52:55], v[164:167], v[184:187], v[52:55]
    ds_read_b128 v[240:243], v1 offset:16384
    v_mfma_f32_16x16x32_bf16 v[56:59], v[160:163], v[188:191], v[56:59]
    ds_read_b128 v[244:247], v1 offset:17408
    v_mfma_f32_16x16x32_bf16 v[60:63], v[164:167], v[188:191], v[60:63]
    v_mfma_f32_16x16x32_bf16 v[64:67], v[160:163], v[192:195], v[64:67]
    v_mfma_f32_16x16x32_bf16 v[68:71], v[164:167], v[192:195], v[68:71]
    v_mfma_f32_16x16x32_bf16 v[72:75], v[160:163], v[196:199], v[72:75]
    v_mfma_f32_16x16x32_bf16 v[76:79], v[164:167], v[196:199], v[76:79]
    v_mfma_f32_16x16x32_bf16 v[80:83], v[160:163], v[200:203], v[80:83]
    v_mfma_f32_16x16x32_bf16 v[84:87], v[164:167], v[200:203], v[84:87]
    s_waitcnt lgkmcnt(0)
    s_barrier
    v_mfma_f32_16x16x32_bf16 v[16:19], v[204:207], v[212:215], v[16:19]
    ds_read_b128 v[160:163], v3 offset:16384
    ds_bpermute_b32 v96, v8, v249
    ds_bpermute_b32 v88, v8, v248
    v_mfma_f32_16x16x32_bf16 v[20:23], v[208:211], v[212:215], v[20:23]
    ds_read_b128 v[164:167], v3 offset:18432
    ds_bpermute_b32 v97, v9, v249
    ds_bpermute_b32 v89, v9, v248
    v_mfma_f32_16x16x32_bf16 v[24:27], v[204:207], v[216:219], v[24:27]
    ds_read_b128 v[168:171], v1 offset:18432
    ds_bpermute_b32 v98, v10, v249
    ds_bpermute_b32 v90, v10, v248
    v_mfma_f32_16x16x32_bf16 v[28:31], v[208:211], v[216:219], v[28:31]
    ds_read_b128 v[172:175], v1 offset:19456
    ds_bpermute_b32 v99, v11, v249
    ds_bpermute_b32 v91, v11, v248
    v_mfma_f32_16x16x32_bf16 v[32:35], v[204:207], v[220:223], v[32:35]
    ds_read_b128 v[176:179], v1 offset:20480
    ds_bpermute_b32 v100, v8, v251
    ds_bpermute_b32 v92, v8, v250
    v_mfma_f32_16x16x32_bf16 v[36:39], v[208:211], v[220:223], v[36:39]
    ds_read_b128 v[180:183], v1 offset:21504
    ds_bpermute_b32 v101, v9, v251
    ds_bpermute_b32 v93, v9, v250
    v_mfma_f32_16x16x32_bf16 v[40:43], v[204:207], v[224:227], v[40:43]
    ds_read_b128 v[184:187], v1 offset:22528
    ds_bpermute_b32 v102, v10, v251
    ds_bpermute_b32 v94, v10, v250
    v_mfma_f32_16x16x32_bf16 v[44:47], v[208:211], v[224:227], v[44:47]
    ds_read_b128 v[188:191], v1 offset:23552
    ds_bpermute_b32 v103, v11, v251
    ds_bpermute_b32 v95, v11, v250
    v_mfma_f32_16x16x32_bf16 v[48:51], v[204:207], v[228:231], v[48:51]
    ds_read_b128 v[192:195], v1 offset:24576
    ds_read_b32 v128, v7 offset:0
    v_mfma_f32_16x16x32_bf16 v[52:55], v[208:211], v[228:231], v[52:55]
    ds_read_b128 v[196:199], v1 offset:25600
    ds_read_b32 v138, v7 offset:1152
    ds_read_b32 v129, v7 offset:64
    v_mfma_f32_16x16x32_bf16 v[56:59], v[204:207], v[232:235], v[56:59]
    ds_read_b128 v[200:203], v1 offset:26624
    ds_read_b32 v139, v7 offset:1216
    ds_read_b32 v130, v7 offset:128
    v_mfma_f32_16x16x32_bf16 v[60:63], v[208:211], v[232:235], v[60:63]
    ds_read_b32 v140, v7 offset:1280
    ds_read_b32 v131, v7 offset:192
    v_mfma_f32_16x16x32_bf16 v[64:67], v[204:207], v[236:239], v[64:67]
    ds_read_b32 v141, v7 offset:1344
    ds_read_b32 v132, v7 offset:256
    v_mfma_f32_16x16x32_bf16 v[68:71], v[208:211], v[236:239], v[68:71]
    ds_read_b32 v142, v7 offset:1408
    ds_read_b32 v133, v7 offset:320
    v_mfma_f32_16x16x32_bf16 v[72:75], v[204:207], v[240:243], v[72:75]
    ds_read_b32 v143, v7 offset:1472
    ds_read_b32 v134, v7 offset:384
    v_mfma_f32_16x16x32_bf16 v[76:79], v[208:211], v[240:243], v[76:79]
    ds_read_b32 v144, v7 offset:1536
    ds_read_b32 v135, v7 offset:448
    v_mfma_f32_16x16x32_bf16 v[80:83], v[204:207], v[244:247], v[80:83]
    ds_read_b32 v145, v7 offset:1600
    ds_read_b32 v136, v7 offset:512
    v_mfma_f32_16x16x32_bf16 v[84:87], v[208:211], v[244:247], v[84:87]
    ds_read_b32 v146, v7 offset:1664
    s_mov_b32 s40, 0xc0135761
    s_mov_b32 s42, 0x3d372713
    v_mov_b64 v[204:205], 0
    v_mov_b64 v[206:207], 0
    v_mov_b64 v[208:209], 0
    v_mov_b64 v[210:211], 0
    v_mov_b64 v[212:213], 0
    v_mov_b64 v[214:215], 0
    v_mov_b64 v[216:217], 0
    v_mov_b64 v[218:219], 0
    s_waitcnt lgkmcnt(0)
    v_rcp_f32 v120, v96
    v_rcp_f32 v121, v97
    v_rcp_f32 v122, v98
    v_rcp_f32 v123, v99
    v_rcp_f32 v124, v100
    v_rcp_f32 v125, v101
    v_rcp_f32 v126, v102
    v_rcp_f32 v127, v103
    v_pk_mul_f32 v[104:105], v[96:97], s[40:41] op_sel_hi:[1,0]
    v_pk_mul_f32 v[106:107], v[98:99], s[40:41] op_sel_hi:[1,0]
    v_pk_mul_f32 v[108:109], v[100:101], s[40:41] op_sel_hi:[1,0]
    v_pk_mul_f32 v[110:111], v[102:103], s[40:41] op_sel_hi:[1,0]
    v_pk_mul_f32 v[112:113], v[96:97], v[96:97]
    v_pk_mul_f32 v[114:115], v[98:99], v[98:99]
    v_pk_mul_f32 v[116:117], v[100:101], v[100:101]
    v_pk_mul_f32 v[118:119], v[102:103], v[102:103]
    v_pk_mul_f32 v[112:113], v[112:113], s[42:43] op_sel_hi:[1,0]
    v_pk_mul_f32 v[114:115], v[114:115], s[42:43] op_sel_hi:[1,0]
    v_pk_mul_f32 v[116:117], v[116:117], s[42:43] op_sel_hi:[1,0]
    v_pk_mul_f32 v[118:119], v[118:119], s[42:43] op_sel_hi:[1,0]
    v_pk_mul_f32 v[112:113], v[112:113], v[104:105]
    v_pk_mul_f32 v[114:115], v[114:115], v[106:107]
    v_pk_mul_f32 v[116:117], v[116:117], v[108:109]
    v_pk_mul_f32 v[118:119], v[118:119], v[110:111]
    v_pk_add_f32 v[128:129], v[128:129], v[138:139]
    v_pk_add_f32 v[130:131], v[130:131], v[140:141]
    v_pk_add_f32 v[132:133], v[132:133], v[142:143]
    v_pk_add_f32 v[134:135], v[134:135], v[144:145]
    v_pk_add_f32 v[136:137], v[136:137], v[146:147]
    v_pk_fma_f32 v[16:17], v[88:89], v[128:129], v[16:17] op_sel:[0,0,0] op_sel_hi:[1,0,1] neg_lo:[1,0,0] neg_hi:[1,0,0]
    v_pk_fma_f32 v[18:19], v[90:91], v[128:129], v[18:19] op_sel:[0,0,0] op_sel_hi:[1,0,1] neg_lo:[1,0,0] neg_hi:[1,0,0]
    v_pk_fma_f32 v[20:21], v[92:93], v[128:129], v[20:21] op_sel:[0,0,0] op_sel_hi:[1,0,1] neg_lo:[1,0,0] neg_hi:[1,0,0]
    v_pk_fma_f32 v[22:23], v[94:95], v[128:129], v[22:23] op_sel:[0,0,0] op_sel_hi:[1,0,1] neg_lo:[1,0,0] neg_hi:[1,0,0]
    v_pk_mul_f32 v[220:221], v[16:17], v[16:17]
    v_pk_mul_f32 v[222:223], v[18:19], v[18:19]
    v_pk_mul_f32 v[224:225], v[20:21], v[20:21]
    v_pk_mul_f32 v[226:227], v[22:23], v[22:23]
    v_pk_fma_f32 v[220:221], v[220:221], v[112:113], v[104:105]
    v_pk_fma_f32 v[222:223], v[222:223], v[114:115], v[106:107]
    v_pk_fma_f32 v[224:225], v[224:225], v[116:117], v[108:109]
    v_pk_fma_f32 v[226:227], v[226:227], v[118:119], v[110:111]
    v_pk_mul_f32 v[220:221], v[220:221], v[16:17]
    v_pk_mul_f32 v[222:223], v[222:223], v[18:19]
    v_pk_mul_f32 v[224:225], v[224:225], v[20:21]
    v_pk_mul_f32 v[226:227], v[226:227], v[22:23]
    v_exp_f32 v220, v220
    v_exp_f32 v221, v221
    v_exp_f32 v222, v222
    v_exp_f32 v223, v223
    v_exp_f32 v224, v224
    v_exp_f32 v225, v225
    v_exp_f32 v226, v226
    v_exp_f32 v227, v227
    v_pk_fma_f32 v[220:221], v[220:221], v[120:121], v[120:121]
    v_pk_fma_f32 v[222:223], v[222:223], v[122:123], v[122:123]
    v_pk_fma_f32 v[224:225], v[224:225], v[124:125], v[124:125]
    v_pk_fma_f32 v[226:227], v[226:227], v[126:127], v[126:127]
    v_rcp_f32 v220, v220
    v_rcp_f32 v221, v221
    v_rcp_f32 v222, v222
    v_rcp_f32 v223, v223
    v_rcp_f32 v224, v224
    v_rcp_f32 v225, v225
    v_rcp_f32 v226, v226
    v_rcp_f32 v227, v227
    v_pk_mul_f32 v[16:17], v[16:17], v[220:221]
    v_pk_mul_f32 v[18:19], v[18:19], v[222:223]
    v_pk_mul_f32 v[20:21], v[20:21], v[224:225]
    v_pk_mul_f32 v[22:23], v[22:23], v[226:227]
    v_pk_add_f32 v[204:205], v[204:205], v[16:17]
    v_pk_fma_f32 v[206:207], v[16:17], v[16:17], v[206:207]
    v_pk_add_f32 v[208:209], v[208:209], v[18:19]
    v_pk_fma_f32 v[210:211], v[18:19], v[18:19], v[210:211]
    v_pk_add_f32 v[212:213], v[212:213], v[20:21]
    v_pk_fma_f32 v[214:215], v[20:21], v[20:21], v[214:215]
    v_pk_add_f32 v[216:217], v[216:217], v[22:23]
    v_pk_fma_f32 v[218:219], v[22:23], v[22:23], v[218:219]
    v_pk_fma_f32 v[24:25], v[88:89], v[128:129], v[24:25] op_sel:[0,1,0] op_sel_hi:[1,1,1] neg_lo:[1,0,0] neg_hi:[1,0,0]
    v_pk_fma_f32 v[26:27], v[90:91], v[128:129], v[26:27] op_sel:[0,1,0] op_sel_hi:[1,1,1] neg_lo:[1,0,0] neg_hi:[1,0,0]
    v_pk_fma_f32 v[28:29], v[92:93], v[128:129], v[28:29] op_sel:[0,1,0] op_sel_hi:[1,1,1] neg_lo:[1,0,0] neg_hi:[1,0,0]
    v_pk_fma_f32 v[30:31], v[94:95], v[128:129], v[30:31] op_sel:[0,1,0] op_sel_hi:[1,1,1] neg_lo:[1,0,0] neg_hi:[1,0,0]
    v_pk_mul_f32 v[228:229], v[24:25], v[24:25]
    v_pk_mul_f32 v[230:231], v[26:27], v[26:27]
    v_pk_mul_f32 v[232:233], v[28:29], v[28:29]
    v_pk_mul_f32 v[234:235], v[30:31], v[30:31]
    v_pk_fma_f32 v[228:229], v[228:229], v[112:113], v[104:105]
    v_pk_fma_f32 v[230:231], v[230:231], v[114:115], v[106:107]
    v_pk_fma_f32 v[232:233], v[232:233], v[116:117], v[108:109]
    v_pk_fma_f32 v[234:235], v[234:235], v[118:119], v[110:111]
    v_pk_mul_f32 v[228:229], v[228:229], v[24:25]
    v_pk_mul_f32 v[230:231], v[230:231], v[26:27]
    v_pk_mul_f32 v[232:233], v[232:233], v[28:29]
    v_pk_mul_f32 v[234:235], v[234:235], v[30:31]
    v_exp_f32 v228, v228
    v_exp_f32 v229, v229
    v_exp_f32 v230, v230
    v_exp_f32 v231, v231
    v_exp_f32 v232, v232
    v_exp_f32 v233, v233
    v_exp_f32 v234, v234
    v_exp_f32 v235, v235
    v_pk_fma_f32 v[228:229], v[228:229], v[120:121], v[120:121]
    v_pk_fma_f32 v[230:231], v[230:231], v[122:123], v[122:123]
    v_pk_fma_f32 v[232:233], v[232:233], v[124:125], v[124:125]
    v_pk_fma_f32 v[234:235], v[234:235], v[126:127], v[126:127]
    v_rcp_f32 v228, v228
    v_rcp_f32 v229, v229
    v_rcp_f32 v230, v230
    v_rcp_f32 v231, v231
    v_rcp_f32 v232, v232
    v_rcp_f32 v233, v233
    v_rcp_f32 v234, v234
    v_rcp_f32 v235, v235
    v_pk_mul_f32 v[24:25], v[24:25], v[228:229]
    v_pk_mul_f32 v[26:27], v[26:27], v[230:231]
    v_pk_mul_f32 v[28:29], v[28:29], v[232:233]
    v_pk_mul_f32 v[30:31], v[30:31], v[234:235]
    v_pk_add_f32 v[204:205], v[204:205], v[24:25]
    v_pk_fma_f32 v[206:207], v[24:25], v[24:25], v[206:207]
    v_pk_add_f32 v[208:209], v[208:209], v[26:27]
    v_pk_fma_f32 v[210:211], v[26:27], v[26:27], v[210:211]
    v_pk_add_f32 v[212:213], v[212:213], v[28:29]
    v_pk_fma_f32 v[214:215], v[28:29], v[28:29], v[214:215]
    v_pk_add_f32 v[216:217], v[216:217], v[30:31]
    v_pk_fma_f32 v[218:219], v[30:31], v[30:31], v[218:219]
    v_pk_fma_f32 v[32:33], v[88:89], v[130:131], v[32:33] op_sel:[0,0,0] op_sel_hi:[1,0,1] neg_lo:[1,0,0] neg_hi:[1,0,0]
    v_pk_fma_f32 v[34:35], v[90:91], v[130:131], v[34:35] op_sel:[0,0,0] op_sel_hi:[1,0,1] neg_lo:[1,0,0] neg_hi:[1,0,0]
    v_pk_fma_f32 v[36:37], v[92:93], v[130:131], v[36:37] op_sel:[0,0,0] op_sel_hi:[1,0,1] neg_lo:[1,0,0] neg_hi:[1,0,0]
    v_pk_fma_f32 v[38:39], v[94:95], v[130:131], v[38:39] op_sel:[0,0,0] op_sel_hi:[1,0,1] neg_lo:[1,0,0] neg_hi:[1,0,0]
    v_pk_mul_f32 v[220:221], v[32:33], v[32:33]
    v_pk_mul_f32 v[222:223], v[34:35], v[34:35]
    v_pk_mul_f32 v[224:225], v[36:37], v[36:37]
    v_pk_mul_f32 v[226:227], v[38:39], v[38:39]
    v_pk_fma_f32 v[220:221], v[220:221], v[112:113], v[104:105]
    v_pk_fma_f32 v[222:223], v[222:223], v[114:115], v[106:107]
    v_pk_fma_f32 v[224:225], v[224:225], v[116:117], v[108:109]
    v_pk_fma_f32 v[226:227], v[226:227], v[118:119], v[110:111]
    v_pk_mul_f32 v[220:221], v[220:221], v[32:33]
    v_pk_mul_f32 v[222:223], v[222:223], v[34:35]
    v_pk_mul_f32 v[224:225], v[224:225], v[36:37]
    v_pk_mul_f32 v[226:227], v[226:227], v[38:39]
    v_exp_f32 v220, v220
    v_exp_f32 v221, v221
    v_exp_f32 v222, v222
    v_exp_f32 v223, v223
    v_exp_f32 v224, v224
    v_exp_f32 v225, v225
    v_exp_f32 v226, v226
    v_exp_f32 v227, v227
    v_pk_fma_f32 v[220:221], v[220:221], v[120:121], v[120:121]
    v_pk_fma_f32 v[222:223], v[222:223], v[122:123], v[122:123]
    v_pk_fma_f32 v[224:225], v[224:225], v[124:125], v[124:125]
    v_pk_fma_f32 v[226:227], v[226:227], v[126:127], v[126:127]
    v_rcp_f32 v220, v220
    v_rcp_f32 v221, v221
    v_rcp_f32 v222, v222
    v_rcp_f32 v223, v223
    v_rcp_f32 v224, v224
    v_rcp_f32 v225, v225
    v_rcp_f32 v226, v226
    v_rcp_f32 v227, v227
    v_pk_mul_f32 v[32:33], v[32:33], v[220:221]
    v_pk_mul_f32 v[34:35], v[34:35], v[222:223]
    v_pk_mul_f32 v[36:37], v[36:37], v[224:225]
    v_pk_mul_f32 v[38:39], v[38:39], v[226:227]
    v_pk_add_f32 v[204:205], v[204:205], v[32:33]
    v_pk_fma_f32 v[206:207], v[32:33], v[32:33], v[206:207]
    v_pk_add_f32 v[208:209], v[208:209], v[34:35]
    v_pk_fma_f32 v[210:211], v[34:35], v[34:35], v[210:211]
    v_pk_add_f32 v[212:213], v[212:213], v[36:37]
    v_pk_fma_f32 v[214:215], v[36:37], v[36:37], v[214:215]
    v_pk_add_f32 v[216:217], v[216:217], v[38:39]
    v_pk_fma_f32 v[218:219], v[38:39], v[38:39], v[218:219]
    v_pk_fma_f32 v[40:41], v[88:89], v[130:131], v[40:41] op_sel:[0,1,0] op_sel_hi:[1,1,1] neg_lo:[1,0,0] neg_hi:[1,0,0]
    v_pk_fma_f32 v[42:43], v[90:91], v[130:131], v[42:43] op_sel:[0,1,0] op_sel_hi:[1,1,1] neg_lo:[1,0,0] neg_hi:[1,0,0]
    v_pk_fma_f32 v[44:45], v[92:93], v[130:131], v[44:45] op_sel:[0,1,0] op_sel_hi:[1,1,1] neg_lo:[1,0,0] neg_hi:[1,0,0]
    v_pk_fma_f32 v[46:47], v[94:95], v[130:131], v[46:47] op_sel:[0,1,0] op_sel_hi:[1,1,1] neg_lo:[1,0,0] neg_hi:[1,0,0]
    v_pk_mul_f32 v[228:229], v[40:41], v[40:41]
    v_pk_mul_f32 v[230:231], v[42:43], v[42:43]
    v_pk_mul_f32 v[232:233], v[44:45], v[44:45]
    v_pk_mul_f32 v[234:235], v[46:47], v[46:47]
    v_pk_fma_f32 v[228:229], v[228:229], v[112:113], v[104:105]
    v_pk_fma_f32 v[230:231], v[230:231], v[114:115], v[106:107]
    v_pk_fma_f32 v[232:233], v[232:233], v[116:117], v[108:109]
    v_pk_fma_f32 v[234:235], v[234:235], v[118:119], v[110:111]
    v_pk_mul_f32 v[228:229], v[228:229], v[40:41]
    v_pk_mul_f32 v[230:231], v[230:231], v[42:43]
    v_pk_mul_f32 v[232:233], v[232:233], v[44:45]
    v_pk_mul_f32 v[234:235], v[234:235], v[46:47]
    v_exp_f32 v228, v228
    v_exp_f32 v229, v229
    v_exp_f32 v230, v230
    v_exp_f32 v231, v231
    v_exp_f32 v232, v232
    v_exp_f32 v233, v233
    v_exp_f32 v234, v234
    v_exp_f32 v235, v235
    v_pk_fma_f32 v[228:229], v[228:229], v[120:121], v[120:121]
    v_pk_fma_f32 v[230:231], v[230:231], v[122:123], v[122:123]
    v_pk_fma_f32 v[232:233], v[232:233], v[124:125], v[124:125]
    v_pk_fma_f32 v[234:235], v[234:235], v[126:127], v[126:127]
    v_rcp_f32 v228, v228
    v_rcp_f32 v229, v229
    v_rcp_f32 v230, v230
    v_rcp_f32 v231, v231
    v_rcp_f32 v232, v232
    v_rcp_f32 v233, v233
    v_rcp_f32 v234, v234
    v_rcp_f32 v235, v235
    v_pk_mul_f32 v[40:41], v[40:41], v[228:229]
    v_pk_mul_f32 v[42:43], v[42:43], v[230:231]
    v_pk_mul_f32 v[44:45], v[44:45], v[232:233]
    v_pk_mul_f32 v[46:47], v[46:47], v[234:235]
    v_pk_add_f32 v[204:205], v[204:205], v[40:41]
    v_pk_fma_f32 v[206:207], v[40:41], v[40:41], v[206:207]
    v_pk_add_f32 v[208:209], v[208:209], v[42:43]
    v_pk_fma_f32 v[210:211], v[42:43], v[42:43], v[210:211]
    v_pk_add_f32 v[212:213], v[212:213], v[44:45]
    v_pk_fma_f32 v[214:215], v[44:45], v[44:45], v[214:215]
    v_pk_add_f32 v[216:217], v[216:217], v[46:47]
    v_pk_fma_f32 v[218:219], v[46:47], v[46:47], v[218:219]
    v_pk_fma_f32 v[48:49], v[88:89], v[132:133], v[48:49] op_sel:[0,0,0] op_sel_hi:[1,0,1] neg_lo:[1,0,0] neg_hi:[1,0,0]
    v_pk_fma_f32 v[50:51], v[90:91], v[132:133], v[50:51] op_sel:[0,0,0] op_sel_hi:[1,0,1] neg_lo:[1,0,0] neg_hi:[1,0,0]
    v_pk_fma_f32 v[52:53], v[92:93], v[132:133], v[52:53] op_sel:[0,0,0] op_sel_hi:[1,0,1] neg_lo:[1,0,0] neg_hi:[1,0,0]
    v_pk_fma_f32 v[54:55], v[94:95], v[132:133], v[54:55] op_sel:[0,0,0] op_sel_hi:[1,0,1] neg_lo:[1,0,0] neg_hi:[1,0,0]
    v_pk_mul_f32 v[220:221], v[48:49], v[48:49]
    v_pk_mul_f32 v[222:223], v[50:51], v[50:51]
    v_pk_mul_f32 v[224:225], v[52:53], v[52:53]
    v_pk_mul_f32 v[226:227], v[54:55], v[54:55]
    v_pk_fma_f32 v[220:221], v[220:221], v[112:113], v[104:105]
    v_pk_fma_f32 v[222:223], v[222:223], v[114:115], v[106:107]
    v_pk_fma_f32 v[224:225], v[224:225], v[116:117], v[108:109]
    v_pk_fma_f32 v[226:227], v[226:227], v[118:119], v[110:111]
    v_pk_mul_f32 v[220:221], v[220:221], v[48:49]
    v_pk_mul_f32 v[222:223], v[222:223], v[50:51]
    v_pk_mul_f32 v[224:225], v[224:225], v[52:53]
    v_pk_mul_f32 v[226:227], v[226:227], v[54:55]
    v_exp_f32 v220, v220
    v_exp_f32 v221, v221
    v_exp_f32 v222, v222
    v_exp_f32 v223, v223
    v_exp_f32 v224, v224
    v_exp_f32 v225, v225
    v_exp_f32 v226, v226
    v_exp_f32 v227, v227
    v_pk_fma_f32 v[220:221], v[220:221], v[120:121], v[120:121]
    v_pk_fma_f32 v[222:223], v[222:223], v[122:123], v[122:123]
    v_pk_fma_f32 v[224:225], v[224:225], v[124:125], v[124:125]
    v_pk_fma_f32 v[226:227], v[226:227], v[126:127], v[126:127]
    v_rcp_f32 v220, v220
    v_rcp_f32 v221, v221
    v_rcp_f32 v222, v222
    v_rcp_f32 v223, v223
    v_rcp_f32 v224, v224
    v_rcp_f32 v225, v225
    v_rcp_f32 v226, v226
    v_rcp_f32 v227, v227
    v_pk_mul_f32 v[48:49], v[48:49], v[220:221]
    v_pk_mul_f32 v[50:51], v[50:51], v[222:223]
    v_pk_mul_f32 v[52:53], v[52:53], v[224:225]
    v_pk_mul_f32 v[54:55], v[54:55], v[226:227]
    v_pk_add_f32 v[204:205], v[204:205], v[48:49]
    v_pk_fma_f32 v[206:207], v[48:49], v[48:49], v[206:207]
    v_pk_add_f32 v[208:209], v[208:209], v[50:51]
    v_pk_fma_f32 v[210:211], v[50:51], v[50:51], v[210:211]
    v_pk_add_f32 v[212:213], v[212:213], v[52:53]
    v_pk_fma_f32 v[214:215], v[52:53], v[52:53], v[214:215]
    v_pk_add_f32 v[216:217], v[216:217], v[54:55]
    v_pk_fma_f32 v[218:219], v[54:55], v[54:55], v[218:219]
    v_pk_fma_f32 v[56:57], v[88:89], v[132:133], v[56:57] op_sel:[0,1,0] op_sel_hi:[1,1,1] neg_lo:[1,0,0] neg_hi:[1,0,0]
    v_pk_fma_f32 v[58:59], v[90:91], v[132:133], v[58:59] op_sel:[0,1,0] op_sel_hi:[1,1,1] neg_lo:[1,0,0] neg_hi:[1,0,0]
    v_pk_fma_f32 v[60:61], v[92:93], v[132:133], v[60:61] op_sel:[0,1,0] op_sel_hi:[1,1,1] neg_lo:[1,0,0] neg_hi:[1,0,0]
    v_pk_fma_f32 v[62:63], v[94:95], v[132:133], v[62:63] op_sel:[0,1,0] op_sel_hi:[1,1,1] neg_lo:[1,0,0] neg_hi:[1,0,0]
    v_pk_mul_f32 v[228:229], v[56:57], v[56:57]
    v_pk_mul_f32 v[230:231], v[58:59], v[58:59]
    v_pk_mul_f32 v[232:233], v[60:61], v[60:61]
    v_pk_mul_f32 v[234:235], v[62:63], v[62:63]
    v_pk_fma_f32 v[228:229], v[228:229], v[112:113], v[104:105]
    v_pk_fma_f32 v[230:231], v[230:231], v[114:115], v[106:107]
    v_pk_fma_f32 v[232:233], v[232:233], v[116:117], v[108:109]
    v_pk_fma_f32 v[234:235], v[234:235], v[118:119], v[110:111]
    v_pk_mul_f32 v[228:229], v[228:229], v[56:57]
    v_pk_mul_f32 v[230:231], v[230:231], v[58:59]
    v_pk_mul_f32 v[232:233], v[232:233], v[60:61]
    v_pk_mul_f32 v[234:235], v[234:235], v[62:63]
    v_exp_f32 v228, v228
    v_exp_f32 v229, v229
    v_exp_f32 v230, v230
    v_exp_f32 v231, v231
    v_exp_f32 v232, v232
    v_exp_f32 v233, v233
    v_exp_f32 v234, v234
    v_exp_f32 v235, v235
    v_pk_fma_f32 v[228:229], v[228:229], v[120:121], v[120:121]
    v_pk_fma_f32 v[230:231], v[230:231], v[122:123], v[122:123]
    v_pk_fma_f32 v[232:233], v[232:233], v[124:125], v[124:125]
    v_pk_fma_f32 v[234:235], v[234:235], v[126:127], v[126:127]
    v_rcp_f32 v228, v228
    v_rcp_f32 v229, v229
    v_rcp_f32 v230, v230
    v_rcp_f32 v231, v231
    v_rcp_f32 v232, v232
    v_rcp_f32 v233, v233
    v_rcp_f32 v234, v234
    v_rcp_f32 v235, v235
    v_pk_mul_f32 v[56:57], v[56:57], v[228:229]
    v_pk_mul_f32 v[58:59], v[58:59], v[230:231]
    v_pk_mul_f32 v[60:61], v[60:61], v[232:233]
    v_pk_mul_f32 v[62:63], v[62:63], v[234:235]
    v_pk_add_f32 v[204:205], v[204:205], v[56:57]
    v_pk_fma_f32 v[206:207], v[56:57], v[56:57], v[206:207]
    v_pk_add_f32 v[208:209], v[208:209], v[58:59]
    v_pk_fma_f32 v[210:211], v[58:59], v[58:59], v[210:211]
    v_pk_add_f32 v[212:213], v[212:213], v[60:61]
    v_pk_fma_f32 v[214:215], v[60:61], v[60:61], v[214:215]
    v_pk_add_f32 v[216:217], v[216:217], v[62:63]
    v_pk_fma_f32 v[218:219], v[62:63], v[62:63], v[218:219]
    v_pk_fma_f32 v[64:65], v[88:89], v[134:135], v[64:65] op_sel:[0,0,0] op_sel_hi:[1,0,1] neg_lo:[1,0,0] neg_hi:[1,0,0]
    v_pk_fma_f32 v[66:67], v[90:91], v[134:135], v[66:67] op_sel:[0,0,0] op_sel_hi:[1,0,1] neg_lo:[1,0,0] neg_hi:[1,0,0]
    v_pk_fma_f32 v[68:69], v[92:93], v[134:135], v[68:69] op_sel:[0,0,0] op_sel_hi:[1,0,1] neg_lo:[1,0,0] neg_hi:[1,0,0]
    v_pk_fma_f32 v[70:71], v[94:95], v[134:135], v[70:71] op_sel:[0,0,0] op_sel_hi:[1,0,1] neg_lo:[1,0,0] neg_hi:[1,0,0]
    v_pk_mul_f32 v[220:221], v[64:65], v[64:65]
    v_pk_mul_f32 v[222:223], v[66:67], v[66:67]
    v_pk_mul_f32 v[224:225], v[68:69], v[68:69]
    v_pk_mul_f32 v[226:227], v[70:71], v[70:71]
    v_pk_fma_f32 v[220:221], v[220:221], v[112:113], v[104:105]
    v_pk_fma_f32 v[222:223], v[222:223], v[114:115], v[106:107]
    v_pk_fma_f32 v[224:225], v[224:225], v[116:117], v[108:109]
    v_pk_fma_f32 v[226:227], v[226:227], v[118:119], v[110:111]
    v_pk_mul_f32 v[220:221], v[220:221], v[64:65]
    v_pk_mul_f32 v[222:223], v[222:223], v[66:67]
    v_pk_mul_f32 v[224:225], v[224:225], v[68:69]
    v_pk_mul_f32 v[226:227], v[226:227], v[70:71]
    v_exp_f32 v220, v220
    v_exp_f32 v221, v221
    v_exp_f32 v222, v222
    v_exp_f32 v223, v223
    v_exp_f32 v224, v224
    v_exp_f32 v225, v225
    v_exp_f32 v226, v226
    v_exp_f32 v227, v227
    v_pk_fma_f32 v[220:221], v[220:221], v[120:121], v[120:121]
    v_pk_fma_f32 v[222:223], v[222:223], v[122:123], v[122:123]
    v_pk_fma_f32 v[224:225], v[224:225], v[124:125], v[124:125]
    v_pk_fma_f32 v[226:227], v[226:227], v[126:127], v[126:127]
    v_rcp_f32 v220, v220
    v_rcp_f32 v221, v221
    v_rcp_f32 v222, v222
    v_rcp_f32 v223, v223
    v_rcp_f32 v224, v224
    v_rcp_f32 v225, v225
    v_rcp_f32 v226, v226
    v_rcp_f32 v227, v227
    v_pk_mul_f32 v[64:65], v[64:65], v[220:221]
    v_pk_mul_f32 v[66:67], v[66:67], v[222:223]
    v_pk_mul_f32 v[68:69], v[68:69], v[224:225]
    v_pk_mul_f32 v[70:71], v[70:71], v[226:227]
    v_pk_add_f32 v[204:205], v[204:205], v[64:65]
    v_pk_fma_f32 v[206:207], v[64:65], v[64:65], v[206:207]
    v_pk_add_f32 v[208:209], v[208:209], v[66:67]
    v_pk_fma_f32 v[210:211], v[66:67], v[66:67], v[210:211]
    v_pk_add_f32 v[212:213], v[212:213], v[68:69]
    v_pk_fma_f32 v[214:215], v[68:69], v[68:69], v[214:215]
    v_pk_add_f32 v[216:217], v[216:217], v[70:71]
    v_pk_fma_f32 v[218:219], v[70:71], v[70:71], v[218:219]
    v_pk_fma_f32 v[72:73], v[88:89], v[134:135], v[72:73] op_sel:[0,1,0] op_sel_hi:[1,1,1] neg_lo:[1,0,0] neg_hi:[1,0,0]
    v_pk_fma_f32 v[74:75], v[90:91], v[134:135], v[74:75] op_sel:[0,1,0] op_sel_hi:[1,1,1] neg_lo:[1,0,0] neg_hi:[1,0,0]
    v_pk_fma_f32 v[76:77], v[92:93], v[134:135], v[76:77] op_sel:[0,1,0] op_sel_hi:[1,1,1] neg_lo:[1,0,0] neg_hi:[1,0,0]
    v_pk_fma_f32 v[78:79], v[94:95], v[134:135], v[78:79] op_sel:[0,1,0] op_sel_hi:[1,1,1] neg_lo:[1,0,0] neg_hi:[1,0,0]
    v_pk_mul_f32 v[228:229], v[72:73], v[72:73]
    v_pk_mul_f32 v[230:231], v[74:75], v[74:75]
    v_pk_mul_f32 v[232:233], v[76:77], v[76:77]
    v_pk_mul_f32 v[234:235], v[78:79], v[78:79]
    v_pk_fma_f32 v[228:229], v[228:229], v[112:113], v[104:105]
    v_pk_fma_f32 v[230:231], v[230:231], v[114:115], v[106:107]
    v_pk_fma_f32 v[232:233], v[232:233], v[116:117], v[108:109]
    v_pk_fma_f32 v[234:235], v[234:235], v[118:119], v[110:111]
    v_pk_mul_f32 v[228:229], v[228:229], v[72:73]
    v_pk_mul_f32 v[230:231], v[230:231], v[74:75]
    v_pk_mul_f32 v[232:233], v[232:233], v[76:77]
    v_pk_mul_f32 v[234:235], v[234:235], v[78:79]
    v_exp_f32 v228, v228
    v_exp_f32 v229, v229
    v_exp_f32 v230, v230
    v_exp_f32 v231, v231
    v_exp_f32 v232, v232
    v_exp_f32 v233, v233
    v_exp_f32 v234, v234
    v_exp_f32 v235, v235
    v_pk_fma_f32 v[228:229], v[228:229], v[120:121], v[120:121]
    v_pk_fma_f32 v[230:231], v[230:231], v[122:123], v[122:123]
    v_pk_fma_f32 v[232:233], v[232:233], v[124:125], v[124:125]
    v_pk_fma_f32 v[234:235], v[234:235], v[126:127], v[126:127]
    v_rcp_f32 v228, v228
    v_rcp_f32 v229, v229
    v_rcp_f32 v230, v230
    v_rcp_f32 v231, v231
    v_rcp_f32 v232, v232
    v_rcp_f32 v233, v233
    v_rcp_f32 v234, v234
    v_rcp_f32 v235, v235
    v_pk_mul_f32 v[72:73], v[72:73], v[228:229]
    v_pk_mul_f32 v[74:75], v[74:75], v[230:231]
    v_pk_mul_f32 v[76:77], v[76:77], v[232:233]
    v_pk_mul_f32 v[78:79], v[78:79], v[234:235]
    v_pk_add_f32 v[204:205], v[204:205], v[72:73]
    v_pk_fma_f32 v[206:207], v[72:73], v[72:73], v[206:207]
    v_pk_add_f32 v[208:209], v[208:209], v[74:75]
    v_pk_fma_f32 v[210:211], v[74:75], v[74:75], v[210:211]
    v_pk_add_f32 v[212:213], v[212:213], v[76:77]
    v_pk_fma_f32 v[214:215], v[76:77], v[76:77], v[214:215]
    v_pk_add_f32 v[216:217], v[216:217], v[78:79]
    v_pk_fma_f32 v[218:219], v[78:79], v[78:79], v[218:219]
    v_pk_fma_f32 v[80:81], v[88:89], v[136:137], v[80:81] op_sel:[0,0,0] op_sel_hi:[1,0,1] neg_lo:[1,0,0] neg_hi:[1,0,0]
    v_pk_fma_f32 v[82:83], v[90:91], v[136:137], v[82:83] op_sel:[0,0,0] op_sel_hi:[1,0,1] neg_lo:[1,0,0] neg_hi:[1,0,0]
    v_pk_fma_f32 v[84:85], v[92:93], v[136:137], v[84:85] op_sel:[0,0,0] op_sel_hi:[1,0,1] neg_lo:[1,0,0] neg_hi:[1,0,0]
    v_pk_fma_f32 v[86:87], v[94:95], v[136:137], v[86:87] op_sel:[0,0,0] op_sel_hi:[1,0,1] neg_lo:[1,0,0] neg_hi:[1,0,0]
    v_pk_mul_f32 v[220:221], v[80:81], v[80:81]
    v_pk_mul_f32 v[222:223], v[82:83], v[82:83]
    v_pk_mul_f32 v[224:225], v[84:85], v[84:85]
    v_pk_mul_f32 v[226:227], v[86:87], v[86:87]
    v_pk_fma_f32 v[220:221], v[220:221], v[112:113], v[104:105]
    v_pk_fma_f32 v[222:223], v[222:223], v[114:115], v[106:107]
    v_pk_fma_f32 v[224:225], v[224:225], v[116:117], v[108:109]
    v_pk_fma_f32 v[226:227], v[226:227], v[118:119], v[110:111]
    v_pk_mul_f32 v[220:221], v[220:221], v[80:81]
    v_pk_mul_f32 v[222:223], v[222:223], v[82:83]
    v_pk_mul_f32 v[224:225], v[224:225], v[84:85]
    v_pk_mul_f32 v[226:227], v[226:227], v[86:87]
    v_exp_f32 v220, v220
    v_exp_f32 v221, v221
    v_exp_f32 v222, v222
    v_exp_f32 v223, v223
    v_exp_f32 v224, v224
    v_exp_f32 v225, v225
    v_exp_f32 v226, v226
    v_exp_f32 v227, v227
    v_pk_fma_f32 v[220:221], v[220:221], v[120:121], v[120:121]
    v_pk_fma_f32 v[222:223], v[222:223], v[122:123], v[122:123]
    v_pk_fma_f32 v[224:225], v[224:225], v[124:125], v[124:125]
    v_pk_fma_f32 v[226:227], v[226:227], v[126:127], v[126:127]
    v_rcp_f32 v220, v220
    v_rcp_f32 v221, v221
    v_rcp_f32 v222, v222
    v_rcp_f32 v223, v223
    v_rcp_f32 v224, v224
    v_rcp_f32 v225, v225
    v_rcp_f32 v226, v226
    v_rcp_f32 v227, v227
    v_pk_mul_f32 v[80:81], v[80:81], v[220:221]
    v_pk_mul_f32 v[82:83], v[82:83], v[222:223]
    v_pk_mul_f32 v[84:85], v[84:85], v[224:225]
    v_pk_mul_f32 v[86:87], v[86:87], v[226:227]
    v_pk_add_f32 v[204:205], v[204:205], v[80:81]
    v_pk_fma_f32 v[206:207], v[80:81], v[80:81], v[206:207]
    v_pk_add_f32 v[208:209], v[208:209], v[82:83]
    v_pk_fma_f32 v[210:211], v[82:83], v[82:83], v[210:211]
    v_pk_add_f32 v[212:213], v[212:213], v[84:85]
    v_pk_fma_f32 v[214:215], v[84:85], v[84:85], v[214:215]
    v_pk_add_f32 v[216:217], v[216:217], v[86:87]
    v_pk_fma_f32 v[218:219], v[86:87], v[86:87], v[218:219]
    v_lshrrev_b32 v8, 2, v6
    v_lshlrev_b32 v8, 4, v8
    v_lshl_add_u32 v8, v5, 6, v8
    v_and_b32 v9, 3, v6
    v_cmp_eq_u32 vcc, 0, v9
    v_bfrev_b32 v10, 1
    v_lshl_add_u32 v255, v9, 8, v8
    v_cndmask_b32 v8, v10, v8, vcc
    v_cmp_eq_u32 vcc, 0, v1
    v_add_f32_dpp v204, v204, v204 row_mirror row_mask:0xf bank_mask:0x3
    v_add_f32_dpp v205, v205, v205 row_mirror row_mask:0xf bank_mask:0x3
    v_add_f32_dpp v206, v206, v206 row_mirror row_mask:0xf bank_mask:0x3
    v_add_f32_dpp v207, v207, v207 row_mirror row_mask:0xf bank_mask:0x3
    v_add_f32_dpp v208, v208, v208 row_mirror row_mask:0xf bank_mask:0x3
    v_add_f32_dpp v209, v209, v209 row_mirror row_mask:0xf bank_mask:0x3
    v_add_f32_dpp v210, v210, v210 row_mirror row_mask:0xf bank_mask:0x3
    v_add_f32_dpp v211, v211, v211 row_mirror row_mask:0xf bank_mask:0x3
    v_add_f32_dpp v204, v212, v212 row_mirror row_mask:0xf bank_mask:0xc
    v_add_f32_dpp v205, v213, v213 row_mirror row_mask:0xf bank_mask:0xc
    v_add_f32_dpp v206, v214, v214 row_mirror row_mask:0xf bank_mask:0xc
    v_add_f32_dpp v207, v215, v215 row_mirror row_mask:0xf bank_mask:0xc
    v_add_f32_dpp v208, v216, v216 row_mirror row_mask:0xf bank_mask:0xc
    v_add_f32_dpp v209, v217, v217 row_mirror row_mask:0xf bank_mask:0xc
    v_add_f32_dpp v210, v218, v218 row_mirror row_mask:0xf bank_mask:0xc
    v_add_f32_dpp v211, v219, v219 row_mirror row_mask:0xf bank_mask:0xc
    v_add_f32_dpp v204, v204, v204 row_half_mirror row_mask:0xf bank_mask:0x5
    v_add_f32_dpp v205, v205, v205 row_half_mirror row_mask:0xf bank_mask:0x5
    v_add_f32_dpp v206, v206, v206 row_half_mirror row_mask:0xf bank_mask:0x5
    v_add_f32_dpp v207, v207, v207 row_half_mirror row_mask:0xf bank_mask:0x5
    v_add_f32_dpp v204, v208, v208 row_half_mirror row_mask:0xf bank_mask:0xa
    v_add_f32_dpp v205, v209, v209 row_half_mirror row_mask:0xf bank_mask:0xa
    v_add_f32_dpp v206, v210, v210 row_half_mirror row_mask:0xf bank_mask:0xa
    v_add_f32_dpp v207, v211, v211 row_half_mirror row_mask:0xf bank_mask:0xa
    v_add_f32_dpp v204, v204, v204 quad_perm:[1,0,3,2] row_mask:0xf bank_mask:0xf
    v_add_f32_dpp v205, v205, v205 quad_perm:[1,0,3,2] row_mask:0xf bank_mask:0xf
    v_add_f32_dpp v206, v206, v206 quad_perm:[1,0,3,2] row_mask:0xf bank_mask:0xf
    v_add_f32_dpp v207, v207, v207 quad_perm:[1,0,3,2] row_mask:0xf bank_mask:0xf
    v_add_f32_dpp v12, v204, v204 quad_perm:[2,3,0,1] row_mask:0xf bank_mask:0xf
    v_add_f32_dpp v13, v205, v205 quad_perm:[2,3,0,1] row_mask:0xf bank_mask:0xf
    v_add_f32_dpp v14, v206, v206 quad_perm:[2,3,0,1] row_mask:0xf bank_mask:0xf
    v_add_f32_dpp v15, v207, v207 quad_perm:[2,3,0,1] row_mask:0xf bank_mask:0xf
    v_cndmask_b32 v253, v10, v1, vcc
    v_mov_b32 v252, 1
    v_mov_b32 v254, 0
    buffer_store_dwordx4 v[12:15], v8, s[4:7], s36 offen sc1
    s_waitcnt lgkmcnt(5)
    v_mfma_f32_16x16x32_bf16 v[88:91], v[168:171], v[160:163], 0
    ds_read_b128 v[204:207], v3 offset:17408
    v_mfma_f32_16x16x32_bf16 v[92:95], v[168:171], v[164:167], 0
    ds_read_b128 v[208:211], v3 offset:19456
    v_mfma_f32_16x16x32_bf16 v[96:99], v[172:175], v[160:163], 0
    ds_read_b128 v[212:215], v1 offset:27648
    v_mfma_f32_16x16x32_bf16 v[100:103], v[172:175], v[164:167], 0
    ds_read_b128 v[216:219], v1 offset:28672
    v_mfma_f32_16x16x32_bf16 v[104:107], v[176:179], v[160:163], 0
    ds_read_b128 v[220:223], v1 offset:29696
    v_mfma_f32_16x16x32_bf16 v[108:111], v[176:179], v[164:167], 0
    ds_read_b128 v[224:227], v1 offset:30720
    v_mfma_f32_16x16x32_bf16 v[112:115], v[180:183], v[160:163], 0
    ds_read_b128 v[228:231], v1 offset:31744
    v_mfma_f32_16x16x32_bf16 v[116:119], v[180:183], v[164:167], 0
    ds_read_b128 v[232:235], v1 offset:32768
    s_waitcnt lgkmcnt(8)
    v_mfma_f32_16x16x32_bf16 v[120:123], v[184:187], v[160:163], 0
    ds_read_b128 v[236:239], v1 offset:33792
    v_mfma_f32_16x16x32_bf16 v[124:127], v[184:187], v[164:167], 0
    ds_read_b128 v[240:243], v1 offset:34816
    v_mfma_f32_16x16x32_bf16 v[128:131], v[188:191], v[160:163], 0
    ds_read_b128 v[244:247], v1 offset:35840
    v_mfma_f32_16x16x32_bf16 v[132:135], v[188:191], v[164:167], 0
    v_mfma_f32_16x16x32_bf16 v[136:139], v[192:195], v[160:163], 0
    v_mfma_f32_16x16x32_bf16 v[140:143], v[192:195], v[164:167], 0
    v_mfma_f32_16x16x32_bf16 v[144:147], v[196:199], v[160:163], 0
    v_mfma_f32_16x16x32_bf16 v[148:151], v[196:199], v[164:167], 0
    v_mfma_f32_16x16x32_bf16 v[152:155], v[200:203], v[160:163], 0
    v_mfma_f32_16x16x32_bf16 v[156:159], v[200:203], v[164:167], 0
    s_waitcnt lgkmcnt(0)
    s_barrier
    v_mfma_f32_16x16x32_bf16 v[88:91], v[212:215], v[204:207], v[88:91]
    ds_read_b128 v[160:163], v3 offset:32768
    v_mfma_f32_16x16x32_bf16 v[92:95], v[212:215], v[208:211], v[92:95]
    ds_read_b128 v[164:167], v3 offset:34816
    v_mfma_f32_16x16x32_bf16 v[96:99], v[216:219], v[204:207], v[96:99]
    ds_read_b128 v[168:171], v2 offset:0
    v_mfma_f32_16x16x32_bf16 v[100:103], v[216:219], v[208:211], v[100:103]
    ds_read_b128 v[172:175], v2 offset:1024
    v_mfma_f32_16x16x32_bf16 v[104:107], v[220:223], v[204:207], v[104:107]
    ds_read_b128 v[176:179], v2 offset:2048
    v_mfma_f32_16x16x32_bf16 v[108:111], v[220:223], v[208:211], v[108:111]
    ds_read_b128 v[180:183], v2 offset:3072
    v_mfma_f32_16x16x32_bf16 v[112:115], v[224:227], v[204:207], v[112:115]
    ds_read_b128 v[184:187], v2 offset:4096
    v_mfma_f32_16x16x32_bf16 v[116:119], v[224:227], v[208:211], v[116:119]
    ds_read_b128 v[188:191], v2 offset:5120
    v_mfma_f32_16x16x32_bf16 v[120:123], v[228:231], v[204:207], v[120:123]
    ds_read_b128 v[192:195], v2 offset:6144
    v_mfma_f32_16x16x32_bf16 v[124:127], v[228:231], v[208:211], v[124:127]
    ds_read_b128 v[196:199], v2 offset:7168
    v_mfma_f32_16x16x32_bf16 v[128:131], v[232:235], v[204:207], v[128:131]
    ds_read_b128 v[200:203], v2 offset:8192
    v_mfma_f32_16x16x32_bf16 v[132:135], v[232:235], v[208:211], v[132:135]
    v_mfma_f32_16x16x32_bf16 v[136:139], v[236:239], v[204:207], v[136:139]
    v_mfma_f32_16x16x32_bf16 v[140:143], v[236:239], v[208:211], v[140:143]
    v_mfma_f32_16x16x32_bf16 v[144:147], v[240:243], v[204:207], v[144:147]
    v_mfma_f32_16x16x32_bf16 v[148:151], v[240:243], v[208:211], v[148:151]
    v_mfma_f32_16x16x32_bf16 v[152:155], v[244:247], v[204:207], v[152:155]
    v_mfma_f32_16x16x32_bf16 v[156:159], v[244:247], v[208:211], v[156:159]
    s_waitcnt lgkmcnt(5)
    v_mfma_f32_16x16x32_bf16 v[88:91], v[168:171], v[160:163], v[88:91]
    ds_read_b128 v[204:207], v3 offset:33792
    v_mfma_f32_16x16x32_bf16 v[92:95], v[168:171], v[164:167], v[92:95]
    ds_read_b128 v[208:211], v3 offset:35840
    v_mfma_f32_16x16x32_bf16 v[96:99], v[172:175], v[160:163], v[96:99]
    ds_read_b128 v[212:215], v2 offset:9216
    v_mfma_f32_16x16x32_bf16 v[100:103], v[172:175], v[164:167], v[100:103]
    ds_read_b128 v[216:219], v2 offset:10240
    v_mfma_f32_16x16x32_bf16 v[104:107], v[176:179], v[160:163], v[104:107]
    ds_read_b128 v[220:223], v2 offset:11264
    v_mfma_f32_16x16x32_bf16 v[108:111], v[176:179], v[164:167], v[108:111]
    ds_read_b128 v[224:227], v2 offset:12288
    v_mfma_f32_16x16x32_bf16 v[112:115], v[180:183], v[160:163], v[112:115]
    ds_read_b128 v[228:231], v2 offset:13312
    v_mfma_f32_16x16x32_bf16 v[116:119], v[180:183], v[164:167], v[116:119]
    ds_read_b128 v[232:235], v2 offset:14336
    s_waitcnt lgkmcnt(8)
    v_mfma_f32_16x16x32_bf16 v[120:123], v[184:187], v[160:163], v[120:123]
    ds_read_b128 v[236:239], v2 offset:15360
    v_mfma_f32_16x16x32_bf16 v[124:127], v[184:187], v[164:167], v[124:127]
    ds_read_b128 v[240:243], v2 offset:16384
    v_mfma_f32_16x16x32_bf16 v[128:131], v[188:191], v[160:163], v[128:131]
    ds_read_b128 v[244:247], v2 offset:17408
    v_mfma_f32_16x16x32_bf16 v[132:135], v[188:191], v[164:167], v[132:135]
    v_mfma_f32_16x16x32_bf16 v[136:139], v[192:195], v[160:163], v[136:139]
    v_mfma_f32_16x16x32_bf16 v[140:143], v[192:195], v[164:167], v[140:143]
    v_mfma_f32_16x16x32_bf16 v[144:147], v[196:199], v[160:163], v[144:147]
    v_mfma_f32_16x16x32_bf16 v[148:151], v[196:199], v[164:167], v[148:151]
    v_mfma_f32_16x16x32_bf16 v[152:155], v[200:203], v[160:163], v[152:155]
    v_mfma_f32_16x16x32_bf16 v[156:159], v[200:203], v[164:167], v[156:159]
    s_waitcnt lgkmcnt(0)
    s_barrier
    v_mfma_f32_16x16x32_bf16 v[88:91], v[212:215], v[204:207], v[88:91]
    ds_read_b128 v[160:163], v3 offset:49152
    v_mfma_f32_16x16x32_bf16 v[92:95], v[212:215], v[208:211], v[92:95]
    ds_read_b128 v[164:167], v3 offset:51200
    v_mfma_f32_16x16x32_bf16 v[96:99], v[216:219], v[204:207], v[96:99]
    ds_read_b128 v[168:171], v2 offset:18432
    v_mfma_f32_16x16x32_bf16 v[100:103], v[216:219], v[208:211], v[100:103]
    ds_read_b128 v[172:175], v2 offset:19456
    v_mfma_f32_16x16x32_bf16 v[104:107], v[220:223], v[204:207], v[104:107]
    ds_read_b128 v[176:179], v2 offset:20480
    v_mfma_f32_16x16x32_bf16 v[108:111], v[220:223], v[208:211], v[108:111]
    ds_read_b128 v[180:183], v2 offset:21504
    v_mfma_f32_16x16x32_bf16 v[112:115], v[224:227], v[204:207], v[112:115]
    ds_read_b128 v[184:187], v2 offset:22528
    v_mfma_f32_16x16x32_bf16 v[116:119], v[224:227], v[208:211], v[116:119]
    ds_read_b128 v[188:191], v2 offset:23552
    v_mfma_f32_16x16x32_bf16 v[120:123], v[228:231], v[204:207], v[120:123]
    ds_read_b128 v[192:195], v2 offset:24576
    v_mfma_f32_16x16x32_bf16 v[124:127], v[228:231], v[208:211], v[124:127]
    ds_read_b128 v[196:199], v2 offset:25600
    v_mfma_f32_16x16x32_bf16 v[128:131], v[232:235], v[204:207], v[128:131]
    ds_read_b128 v[200:203], v2 offset:26624
    v_mfma_f32_16x16x32_bf16 v[132:135], v[232:235], v[208:211], v[132:135]
    v_mfma_f32_16x16x32_bf16 v[136:139], v[236:239], v[204:207], v[136:139]
    s_waitcnt vmcnt(0)
    buffer_atomic_add v252, v253, s[4:7], s37 offen sc1
    v_mfma_f32_16x16x32_bf16 v[140:143], v[236:239], v[208:211], v[140:143]
    v_mfma_f32_16x16x32_bf16 v[144:147], v[240:243], v[204:207], v[144:147]
    v_mfma_f32_16x16x32_bf16 v[148:151], v[240:243], v[208:211], v[148:151]
    v_mfma_f32_16x16x32_bf16 v[152:155], v[244:247], v[204:207], v[152:155]
    v_mfma_f32_16x16x32_bf16 v[156:159], v[244:247], v[208:211], v[156:159]
    s_waitcnt lgkmcnt(5)
    v_mfma_f32_16x16x32_bf16 v[88:91], v[168:171], v[160:163], v[88:91]
    ds_read_b128 v[204:207], v3 offset:50176
    v_mfma_f32_16x16x32_bf16 v[92:95], v[168:171], v[164:167], v[92:95]
    ds_read_b128 v[208:211], v3 offset:52224
    v_mfma_f32_16x16x32_bf16 v[96:99], v[172:175], v[160:163], v[96:99]
    ds_read_b128 v[212:215], v2 offset:27648
    v_mfma_f32_16x16x32_bf16 v[100:103], v[172:175], v[164:167], v[100:103]
    ds_read_b128 v[216:219], v2 offset:28672
    v_mfma_f32_16x16x32_bf16 v[104:107], v[176:179], v[160:163], v[104:107]
    ds_read_b128 v[220:223], v2 offset:29696
    v_mfma_f32_16x16x32_bf16 v[108:111], v[176:179], v[164:167], v[108:111]
    ds_read_b128 v[224:227], v2 offset:30720
    v_mfma_f32_16x16x32_bf16 v[112:115], v[180:183], v[160:163], v[112:115]
    ds_read_b128 v[228:231], v2 offset:31744
    v_mfma_f32_16x16x32_bf16 v[116:119], v[180:183], v[164:167], v[116:119]
    ds_read_b128 v[232:235], v2 offset:32768
    s_waitcnt lgkmcnt(8)
    v_mfma_f32_16x16x32_bf16 v[120:123], v[184:187], v[160:163], v[120:123]
    ds_read_b128 v[236:239], v2 offset:33792
    v_mfma_f32_16x16x32_bf16 v[124:127], v[184:187], v[164:167], v[124:127]
    ds_read_b128 v[240:243], v2 offset:34816
    v_mfma_f32_16x16x32_bf16 v[128:131], v[188:191], v[160:163], v[128:131]
    ds_read_b128 v[244:247], v2 offset:35840
    v_mfma_f32_16x16x32_bf16 v[132:135], v[188:191], v[164:167], v[132:135]
    v_mfma_f32_16x16x32_bf16 v[136:139], v[192:195], v[160:163], v[136:139]
    v_mfma_f32_16x16x32_bf16 v[140:143], v[192:195], v[164:167], v[140:143]
    v_mfma_f32_16x16x32_bf16 v[144:147], v[196:199], v[160:163], v[144:147]
    v_mfma_f32_16x16x32_bf16 v[148:151], v[196:199], v[164:167], v[148:151]
    v_mfma_f32_16x16x32_bf16 v[152:155], v[200:203], v[160:163], v[152:155]
    v_mfma_f32_16x16x32_bf16 v[156:159], v[200:203], v[164:167], v[156:159]
    s_waitcnt lgkmcnt(0)
    s_barrier
    v_mfma_f32_16x16x32_bf16 v[88:91], v[212:215], v[204:207], v[88:91]
    ds_read_b128 v[160:163], v3 offset:0
    v_mfma_f32_16x16x32_bf16 v[92:95], v[212:215], v[208:211], v[92:95]
    ds_read_b128 v[164:167], v3 offset:2048
    v_mfma_f32_16x16x32_bf16 v[96:99], v[216:219], v[204:207], v[96:99]
    ds_read_b128 v[168:171], v1 offset:0
    v_mfma_f32_16x16x32_bf16 v[100:103], v[216:219], v[208:211], v[100:103]
    ds_read_b128 v[172:175], v1 offset:1024
    v_mfma_f32_16x16x32_bf16 v[104:107], v[220:223], v[204:207], v[104:107]
    ds_read_b128 v[176:179], v1 offset:2048
    v_mfma_f32_16x16x32_bf16 v[108:111], v[220:223], v[208:211], v[108:111]
    ds_read_b128 v[180:183], v1 offset:3072
    v_mfma_f32_16x16x32_bf16 v[112:115], v[224:227], v[204:207], v[112:115]
    ds_read_b128 v[184:187], v1 offset:4096
    v_mfma_f32_16x16x32_bf16 v[116:119], v[224:227], v[208:211], v[116:119]
    ds_read_b128 v[188:191], v1 offset:5120
    v_mfma_f32_16x16x32_bf16 v[120:123], v[228:231], v[204:207], v[120:123]
    ds_read_b128 v[192:195], v1 offset:6144
    v_mfma_f32_16x16x32_bf16 v[124:127], v[228:231], v[208:211], v[124:127]
    ds_read_b128 v[196:199], v1 offset:7168
    v_mfma_f32_16x16x32_bf16 v[128:131], v[232:235], v[204:207], v[128:131]
    ds_read_b128 v[200:203], v1 offset:8192
    v_mfma_f32_16x16x32_bf16 v[132:135], v[232:235], v[208:211], v[132:135]
    v_mfma_f32_16x16x32_bf16 v[136:139], v[236:239], v[204:207], v[136:139]
    v_mfma_f32_16x16x32_bf16 v[140:143], v[236:239], v[208:211], v[140:143]
    v_mfma_f32_16x16x32_bf16 v[144:147], v[240:243], v[204:207], v[144:147]
    v_mfma_f32_16x16x32_bf16 v[148:151], v[240:243], v[208:211], v[148:151]
    v_mfma_f32_16x16x32_bf16 v[152:155], v[244:247], v[204:207], v[152:155]
    v_mfma_f32_16x16x32_bf16 v[156:159], v[244:247], v[208:211], v[156:159]
    s_waitcnt lgkmcnt(5)
    v_mfma_f32_16x16x32_bf16 v[88:91], v[168:171], v[160:163], v[88:91]
    ds_read_b128 v[204:207], v3 offset:1024
    v_mfma_f32_16x16x32_bf16 v[92:95], v[168:171], v[164:167], v[92:95]
    ds_read_b128 v[208:211], v3 offset:3072
    v_mfma_f32_16x16x32_bf16 v[96:99], v[172:175], v[160:163], v[96:99]
    ds_read_b128 v[212:215], v1 offset:9216
    v_mfma_f32_16x16x32_bf16 v[100:103], v[172:175], v[164:167], v[100:103]
    ds_read_b128 v[216:219], v1 offset:10240
    v_mfma_f32_16x16x32_bf16 v[104:107], v[176:179], v[160:163], v[104:107]
    ds_read_b128 v[220:223], v1 offset:11264
    v_mfma_f32_16x16x32_bf16 v[108:111], v[176:179], v[164:167], v[108:111]
    ds_read_b128 v[224:227], v1 offset:12288
    v_mfma_f32_16x16x32_bf16 v[112:115], v[180:183], v[160:163], v[112:115]
    ds_read_b128 v[228:231], v1 offset:13312
    v_mfma_f32_16x16x32_bf16 v[116:119], v[180:183], v[164:167], v[116:119]
    ds_read_b128 v[232:235], v1 offset:14336
    s_waitcnt lgkmcnt(8)
    v_mfma_f32_16x16x32_bf16 v[120:123], v[184:187], v[160:163], v[120:123]
    ds_read_b128 v[236:239], v1 offset:15360
    v_mfma_f32_16x16x32_bf16 v[124:127], v[184:187], v[164:167], v[124:127]
    ds_read_b128 v[240:243], v1 offset:16384
    v_mfma_f32_16x16x32_bf16 v[128:131], v[188:191], v[160:163], v[128:131]
    ds_read_b128 v[244:247], v1 offset:17408
    v_mfma_f32_16x16x32_bf16 v[132:135], v[188:191], v[164:167], v[132:135]
    v_mfma_f32_16x16x32_bf16 v[136:139], v[192:195], v[160:163], v[136:139]
    v_mfma_f32_16x16x32_bf16 v[140:143], v[192:195], v[164:167], v[140:143]
    v_mfma_f32_16x16x32_bf16 v[144:147], v[196:199], v[160:163], v[144:147]
    v_mfma_f32_16x16x32_bf16 v[148:151], v[196:199], v[164:167], v[148:151]
    v_mfma_f32_16x16x32_bf16 v[152:155], v[200:203], v[160:163], v[152:155]
    v_mfma_f32_16x16x32_bf16 v[156:159], v[200:203], v[164:167], v[156:159]
    s_waitcnt lgkmcnt(0)
    s_barrier
    v_mfma_f32_16x16x32_bf16 v[88:91], v[212:215], v[204:207], v[88:91]
    ds_read_b128 v[160:163], v3 offset:16384
    v_mfma_f32_16x16x32_bf16 v[92:95], v[212:215], v[208:211], v[92:95]
    ds_read_b128 v[164:167], v3 offset:18432
    v_mfma_f32_16x16x32_bf16 v[96:99], v[216:219], v[204:207], v[96:99]
    ds_read_b128 v[168:171], v1 offset:18432
    v_mfma_f32_16x16x32_bf16 v[100:103], v[216:219], v[208:211], v[100:103]
    ds_read_b128 v[172:175], v1 offset:19456
    v_mfma_f32_16x16x32_bf16 v[104:107], v[220:223], v[204:207], v[104:107]
    ds_read_b128 v[176:179], v1 offset:20480
    v_mfma_f32_16x16x32_bf16 v[108:111], v[220:223], v[208:211], v[108:111]
    ds_read_b128 v[180:183], v1 offset:21504
    v_mfma_f32_16x16x32_bf16 v[112:115], v[224:227], v[204:207], v[112:115]
    ds_read_b128 v[184:187], v1 offset:22528
    v_mfma_f32_16x16x32_bf16 v[116:119], v[224:227], v[208:211], v[116:119]
    ds_read_b128 v[188:191], v1 offset:23552
    v_mfma_f32_16x16x32_bf16 v[120:123], v[228:231], v[204:207], v[120:123]
    ds_read_b128 v[192:195], v1 offset:24576
    v_mfma_f32_16x16x32_bf16 v[124:127], v[228:231], v[208:211], v[124:127]
    ds_read_b128 v[196:199], v1 offset:25600
    v_mfma_f32_16x16x32_bf16 v[128:131], v[232:235], v[204:207], v[128:131]
    ds_read_b128 v[200:203], v1 offset:26624
    v_mfma_f32_16x16x32_bf16 v[132:135], v[232:235], v[208:211], v[132:135]
    v_mfma_f32_16x16x32_bf16 v[136:139], v[236:239], v[204:207], v[136:139]
    v_mfma_f32_16x16x32_bf16 v[140:143], v[236:239], v[208:211], v[140:143]
    v_mfma_f32_16x16x32_bf16 v[144:147], v[240:243], v[204:207], v[144:147]
    v_mfma_f32_16x16x32_bf16 v[148:151], v[240:243], v[208:211], v[148:151]
    v_mfma_f32_16x16x32_bf16 v[152:155], v[244:247], v[204:207], v[152:155]
    v_mfma_f32_16x16x32_bf16 v[156:159], v[244:247], v[208:211], v[156:159]
    s_waitcnt lgkmcnt(5)
    v_mfma_f32_16x16x32_bf16 v[88:91], v[168:171], v[160:163], v[88:91]
    ds_read_b128 v[204:207], v3 offset:17408
    v_mfma_f32_16x16x32_bf16 v[92:95], v[168:171], v[164:167], v[92:95]
    ds_read_b128 v[208:211], v3 offset:19456
    v_mfma_f32_16x16x32_bf16 v[96:99], v[172:175], v[160:163], v[96:99]
    ds_read_b128 v[212:215], v1 offset:27648
    v_mfma_f32_16x16x32_bf16 v[100:103], v[172:175], v[164:167], v[100:103]
    ds_read_b128 v[216:219], v1 offset:28672
    v_mfma_f32_16x16x32_bf16 v[104:107], v[176:179], v[160:163], v[104:107]
    ds_read_b128 v[220:223], v1 offset:29696
    v_mfma_f32_16x16x32_bf16 v[108:111], v[176:179], v[164:167], v[108:111]
    ds_read_b128 v[224:227], v1 offset:30720
    v_mfma_f32_16x16x32_bf16 v[112:115], v[180:183], v[160:163], v[112:115]
    ds_read_b128 v[228:231], v1 offset:31744
    v_mfma_f32_16x16x32_bf16 v[116:119], v[180:183], v[164:167], v[116:119]
    ds_read_b128 v[232:235], v1 offset:32768
    s_waitcnt lgkmcnt(8)
    v_mfma_f32_16x16x32_bf16 v[120:123], v[184:187], v[160:163], v[120:123]
    ds_read_b128 v[236:239], v1 offset:33792
    v_mfma_f32_16x16x32_bf16 v[124:127], v[184:187], v[164:167], v[124:127]
    ds_read_b128 v[240:243], v1 offset:34816
    v_mfma_f32_16x16x32_bf16 v[128:131], v[188:191], v[160:163], v[128:131]
    ds_read_b128 v[244:247], v1 offset:35840
    v_mfma_f32_16x16x32_bf16 v[132:135], v[188:191], v[164:167], v[132:135]
    v_mfma_f32_16x16x32_bf16 v[136:139], v[192:195], v[160:163], v[136:139]
    v_mfma_f32_16x16x32_bf16 v[140:143], v[192:195], v[164:167], v[140:143]
    v_mfma_f32_16x16x32_bf16 v[144:147], v[196:199], v[160:163], v[144:147]
    v_mfma_f32_16x16x32_bf16 v[148:151], v[196:199], v[164:167], v[148:151]
    v_mfma_f32_16x16x32_bf16 v[152:155], v[200:203], v[160:163], v[152:155]
    v_mfma_f32_16x16x32_bf16 v[156:159], v[200:203], v[164:167], v[156:159]
    s_waitcnt lgkmcnt(0)
    s_barrier
    v_mfma_f32_16x16x32_bf16 v[88:91], v[212:215], v[204:207], v[88:91]
    ds_read_b128 v[160:163], v3 offset:32768
    v_mfma_f32_16x16x32_bf16 v[92:95], v[212:215], v[208:211], v[92:95]
    ds_read_b128 v[164:167], v3 offset:34816
    v_mfma_f32_16x16x32_bf16 v[96:99], v[216:219], v[204:207], v[96:99]
    ds_read_b128 v[168:171], v2 offset:0
    v_mfma_f32_16x16x32_bf16 v[100:103], v[216:219], v[208:211], v[100:103]
    ds_read_b128 v[172:175], v2 offset:1024
    v_mfma_f32_16x16x32_bf16 v[104:107], v[220:223], v[204:207], v[104:107]
    ds_read_b128 v[176:179], v2 offset:2048
    v_mfma_f32_16x16x32_bf16 v[108:111], v[220:223], v[208:211], v[108:111]
    ds_read_b128 v[180:183], v2 offset:3072
    v_mfma_f32_16x16x32_bf16 v[112:115], v[224:227], v[204:207], v[112:115]
    ds_read_b128 v[184:187], v2 offset:4096
    v_mfma_f32_16x16x32_bf16 v[116:119], v[224:227], v[208:211], v[116:119]
    ds_read_b128 v[188:191], v2 offset:5120
    v_mfma_f32_16x16x32_bf16 v[120:123], v[228:231], v[204:207], v[120:123]
    ds_read_b128 v[192:195], v2 offset:6144
    v_mfma_f32_16x16x32_bf16 v[124:127], v[228:231], v[208:211], v[124:127]
    ds_read_b128 v[196:199], v2 offset:7168
    v_mfma_f32_16x16x32_bf16 v[128:131], v[232:235], v[204:207], v[128:131]
    ds_read_b128 v[200:203], v2 offset:8192
    v_mfma_f32_16x16x32_bf16 v[132:135], v[232:235], v[208:211], v[132:135]
    v_mfma_f32_16x16x32_bf16 v[136:139], v[236:239], v[204:207], v[136:139]
    v_mfma_f32_16x16x32_bf16 v[140:143], v[236:239], v[208:211], v[140:143]
    v_mfma_f32_16x16x32_bf16 v[144:147], v[240:243], v[204:207], v[144:147]
    v_mfma_f32_16x16x32_bf16 v[148:151], v[240:243], v[208:211], v[148:151]
    v_mfma_f32_16x16x32_bf16 v[152:155], v[244:247], v[204:207], v[152:155]
    v_mfma_f32_16x16x32_bf16 v[156:159], v[244:247], v[208:211], v[156:159]
    s_waitcnt lgkmcnt(5)
    v_mfma_f32_16x16x32_bf16 v[88:91], v[168:171], v[160:163], v[88:91]
    ds_read_b128 v[204:207], v3 offset:33792
    v_mfma_f32_16x16x32_bf16 v[92:95], v[168:171], v[164:167], v[92:95]
    ds_read_b128 v[208:211], v3 offset:35840
    v_mfma_f32_16x16x32_bf16 v[96:99], v[172:175], v[160:163], v[96:99]
    ds_read_b128 v[212:215], v2 offset:9216
    v_mfma_f32_16x16x32_bf16 v[100:103], v[172:175], v[164:167], v[100:103]
    ds_read_b128 v[216:219], v2 offset:10240
    v_mfma_f32_16x16x32_bf16 v[104:107], v[176:179], v[160:163], v[104:107]
    ds_read_b128 v[220:223], v2 offset:11264
    v_mfma_f32_16x16x32_bf16 v[108:111], v[176:179], v[164:167], v[108:111]
    ds_read_b128 v[224:227], v2 offset:12288
    v_mfma_f32_16x16x32_bf16 v[112:115], v[180:183], v[160:163], v[112:115]
    ds_read_b128 v[228:231], v2 offset:13312
    v_mfma_f32_16x16x32_bf16 v[116:119], v[180:183], v[164:167], v[116:119]
    ds_read_b128 v[232:235], v2 offset:14336
    s_waitcnt lgkmcnt(8)
    v_mfma_f32_16x16x32_bf16 v[120:123], v[184:187], v[160:163], v[120:123]
    ds_read_b128 v[236:239], v2 offset:15360
    v_mfma_f32_16x16x32_bf16 v[124:127], v[184:187], v[164:167], v[124:127]
    ds_read_b128 v[240:243], v2 offset:16384
    v_mfma_f32_16x16x32_bf16 v[128:131], v[188:191], v[160:163], v[128:131]
    ds_read_b128 v[244:247], v2 offset:17408
    v_mfma_f32_16x16x32_bf16 v[132:135], v[188:191], v[164:167], v[132:135]
    v_mfma_f32_16x16x32_bf16 v[136:139], v[192:195], v[160:163], v[136:139]
    v_mfma_f32_16x16x32_bf16 v[140:143], v[192:195], v[164:167], v[140:143]
    v_mfma_f32_16x16x32_bf16 v[144:147], v[196:199], v[160:163], v[144:147]
    v_mfma_f32_16x16x32_bf16 v[148:151], v[196:199], v[164:167], v[148:151]
    v_mfma_f32_16x16x32_bf16 v[152:155], v[200:203], v[160:163], v[152:155]
    v_mfma_f32_16x16x32_bf16 v[156:159], v[200:203], v[164:167], v[156:159]
    s_waitcnt lgkmcnt(0)
    s_barrier
    v_mfma_f32_16x16x32_bf16 v[88:91], v[212:215], v[204:207], v[88:91]
    ds_read_b128 v[160:163], v3 offset:49152
    v_mfma_f32_16x16x32_bf16 v[92:95], v[212:215], v[208:211], v[92:95]
    ds_read_b128 v[164:167], v3 offset:51200
    v_mfma_f32_16x16x32_bf16 v[96:99], v[216:219], v[204:207], v[96:99]
    ds_read_b128 v[168:171], v2 offset:18432
    v_mfma_f32_16x16x32_bf16 v[100:103], v[216:219], v[208:211], v[100:103]
    ds_read_b128 v[172:175], v2 offset:19456
    v_mfma_f32_16x16x32_bf16 v[104:107], v[220:223], v[204:207], v[104:107]
    ds_read_b128 v[176:179], v2 offset:20480
    v_mfma_f32_16x16x32_bf16 v[108:111], v[220:223], v[208:211], v[108:111]
    ds_read_b128 v[180:183], v2 offset:21504
    v_mfma_f32_16x16x32_bf16 v[112:115], v[224:227], v[204:207], v[112:115]
    ds_read_b128 v[184:187], v2 offset:22528
    v_mfma_f32_16x16x32_bf16 v[116:119], v[224:227], v[208:211], v[116:119]
    ds_read_b128 v[188:191], v2 offset:23552
    v_mfma_f32_16x16x32_bf16 v[120:123], v[228:231], v[204:207], v[120:123]
    ds_read_b128 v[192:195], v2 offset:24576
    v_mfma_f32_16x16x32_bf16 v[124:127], v[228:231], v[208:211], v[124:127]
    ds_read_b128 v[196:199], v2 offset:25600
    v_mfma_f32_16x16x32_bf16 v[128:131], v[232:235], v[204:207], v[128:131]
    ds_read_b128 v[200:203], v2 offset:26624
    v_mfma_f32_16x16x32_bf16 v[132:135], v[232:235], v[208:211], v[132:135]
    v_mfma_f32_16x16x32_bf16 v[136:139], v[236:239], v[204:207], v[136:139]
    buffer_load_dword v4, v254, s[4:7], s37 offen sc1
    v_mfma_f32_16x16x32_bf16 v[140:143], v[236:239], v[208:211], v[140:143]
    v_mfma_f32_16x16x32_bf16 v[144:147], v[240:243], v[204:207], v[144:147]
    v_mfma_f32_16x16x32_bf16 v[148:151], v[240:243], v[208:211], v[148:151]
    v_mfma_f32_16x16x32_bf16 v[152:155], v[244:247], v[204:207], v[152:155]
    v_mfma_f32_16x16x32_bf16 v[156:159], v[244:247], v[208:211], v[156:159]
    s_waitcnt lgkmcnt(5)
    v_mfma_f32_16x16x32_bf16 v[88:91], v[168:171], v[160:163], v[88:91]
    ds_read_b128 v[204:207], v3 offset:50176
    v_mfma_f32_16x16x32_bf16 v[92:95], v[168:171], v[164:167], v[92:95]
    ds_read_b128 v[208:211], v3 offset:52224
    v_mfma_f32_16x16x32_bf16 v[96:99], v[172:175], v[160:163], v[96:99]
    ds_read_b128 v[212:215], v2 offset:27648
    v_mfma_f32_16x16x32_bf16 v[100:103], v[172:175], v[164:167], v[100:103]
    ds_read_b128 v[216:219], v2 offset:28672
    v_mfma_f32_16x16x32_bf16 v[104:107], v[176:179], v[160:163], v[104:107]
    ds_read_b128 v[220:223], v2 offset:29696
    v_mfma_f32_16x16x32_bf16 v[108:111], v[176:179], v[164:167], v[108:111]
    ds_read_b128 v[224:227], v2 offset:30720
    v_mfma_f32_16x16x32_bf16 v[112:115], v[180:183], v[160:163], v[112:115]
    ds_read_b128 v[228:231], v2 offset:31744
    v_mfma_f32_16x16x32_bf16 v[116:119], v[180:183], v[164:167], v[116:119]
    ds_read_b128 v[232:235], v2 offset:32768
    s_waitcnt lgkmcnt(8)
    v_mfma_f32_16x16x32_bf16 v[120:123], v[184:187], v[160:163], v[120:123]
    ds_read_b128 v[236:239], v2 offset:33792
    v_mfma_f32_16x16x32_bf16 v[124:127], v[184:187], v[164:167], v[124:127]
    ds_read_b128 v[240:243], v2 offset:34816
    v_mfma_f32_16x16x32_bf16 v[128:131], v[188:191], v[160:163], v[128:131]
    ds_read_b128 v[244:247], v2 offset:35840
    v_mfma_f32_16x16x32_bf16 v[132:135], v[188:191], v[164:167], v[132:135]
    v_mfma_f32_16x16x32_bf16 v[136:139], v[192:195], v[160:163], v[136:139]
    v_mfma_f32_16x16x32_bf16 v[140:143], v[192:195], v[164:167], v[140:143]
    v_mfma_f32_16x16x32_bf16 v[144:147], v[196:199], v[160:163], v[144:147]
    v_mfma_f32_16x16x32_bf16 v[148:151], v[196:199], v[164:167], v[148:151]
    v_mfma_f32_16x16x32_bf16 v[152:155], v[200:203], v[160:163], v[152:155]
    v_mfma_f32_16x16x32_bf16 v[156:159], v[200:203], v[164:167], v[156:159]
    s_waitcnt lgkmcnt(0)
    s_barrier
    v_mfma_f32_16x16x32_bf16 v[88:91], v[212:215], v[204:207], v[88:91]
    ds_read_b128 v[160:163], v3 offset:0
    v_mfma_f32_16x16x32_bf16 v[92:95], v[212:215], v[208:211], v[92:95]
    ds_read_b128 v[164:167], v3 offset:2048
    v_mfma_f32_16x16x32_bf16 v[96:99], v[216:219], v[204:207], v[96:99]
    ds_read_b128 v[168:171], v1 offset:0
    v_mfma_f32_16x16x32_bf16 v[100:103], v[216:219], v[208:211], v[100:103]
    ds_read_b128 v[172:175], v1 offset:1024
    v_mfma_f32_16x16x32_bf16 v[104:107], v[220:223], v[204:207], v[104:107]
    ds_read_b128 v[176:179], v1 offset:2048
    v_mfma_f32_16x16x32_bf16 v[108:111], v[220:223], v[208:211], v[108:111]
    ds_read_b128 v[180:183], v1 offset:3072
    v_mfma_f32_16x16x32_bf16 v[112:115], v[224:227], v[204:207], v[112:115]
    ds_read_b128 v[184:187], v1 offset:4096
    v_mfma_f32_16x16x32_bf16 v[116:119], v[224:227], v[208:211], v[116:119]
    ds_read_b128 v[188:191], v1 offset:5120
    v_mfma_f32_16x16x32_bf16 v[120:123], v[228:231], v[204:207], v[120:123]
    ds_read_b128 v[192:195], v1 offset:6144
    v_mfma_f32_16x16x32_bf16 v[124:127], v[228:231], v[208:211], v[124:127]
    ds_read_b128 v[196:199], v1 offset:7168
    v_mfma_f32_16x16x32_bf16 v[128:131], v[232:235], v[204:207], v[128:131]
    ds_read_b128 v[200:203], v1 offset:8192
    v_mfma_f32_16x16x32_bf16 v[132:135], v[232:235], v[208:211], v[132:135]
    s_waitcnt vmcnt(0)
    v_cmp_gt_u32 vcc, 16, v4
    v_mfma_f32_16x16x32_bf16 v[136:139], v[236:239], v[204:207], v[136:139]
    v_mfma_f32_16x16x32_bf16 v[140:143], v[236:239], v[208:211], v[140:143]
    s_cbranch_vccnz L_g_slow
L_g_back:
    buffer_load_dwordx4 v[4:7], v255, s[4:7], s35 offen offset:0 sc1
    v_mfma_f32_16x16x32_bf16 v[144:147], v[240:243], v[204:207], v[144:147]
    buffer_load_dwordx4 v[8:11], v255, s[4:7], s35 offen offset:1024 sc1
    v_mfma_f32_16x16x32_bf16 v[148:151], v[240:243], v[208:211], v[148:151]
    buffer_load_dwordx4 v[12:15], v255, s[4:7], s35 offen offset:2048 sc1
    v_mfma_f32_16x16x32_bf16 v[152:155], v[244:247], v[204:207], v[152:155]
    buffer_load_dwordx4 v[252:255], v255, s[4:7], s35 offen offset:3072 sc1
    v_mfma_f32_16x16x32_bf16 v[156:159], v[244:247], v[208:211], v[156:159]
    s_waitcnt lgkmcnt(5)
    v_mfma_f32_16x16x32_bf16 v[88:91], v[168:171], v[160:163], v[88:91]
    ds_read_b128 v[204:207], v3 offset:1024
    v_mfma_f32_16x16x32_bf16 v[92:95], v[168:171], v[164:167], v[92:95]
    ds_read_b128 v[208:211], v3 offset:3072
    v_mfma_f32_16x16x32_bf16 v[96:99], v[172:175], v[160:163], v[96:99]
    ds_read_b128 v[212:215], v1 offset:9216
    v_mfma_f32_16x16x32_bf16 v[100:103], v[172:175], v[164:167], v[100:103]
    ds_read_b128 v[216:219], v1 offset:10240
    v_mfma_f32_16x16x32_bf16 v[104:107], v[176:179], v[160:163], v[104:107]
    ds_read_b128 v[220:223], v1 offset:11264
    v_mfma_f32_16x16x32_bf16 v[108:111], v[176:179], v[164:167], v[108:111]
    ds_read_b128 v[224:227], v1 offset:12288
    v_mfma_f32_16x16x32_bf16 v[112:115], v[180:183], v[160:163], v[112:115]
    ds_read_b128 v[228:231], v1 offset:13312
    v_mfma_f32_16x16x32_bf16 v[116:119], v[180:183], v[164:167], v[116:119]
    ds_read_b128 v[232:235], v1 offset:14336
    s_waitcnt lgkmcnt(8)
    v_mfma_f32_16x16x32_bf16 v[120:123], v[184:187], v[160:163], v[120:123]
    ds_read_b128 v[236:239], v1 offset:15360
    v_mfma_f32_16x16x32_bf16 v[124:127], v[184:187], v[164:167], v[124:127]
    ds_read_b128 v[240:243], v1 offset:16384
    v_mfma_f32_16x16x32_bf16 v[128:131], v[188:191], v[160:163], v[128:131]
    ds_read_b128 v[244:247], v1 offset:17408
    v_mfma_f32_16x16x32_bf16 v[132:135], v[188:191], v[164:167], v[132:135]
    v_mfma_f32_16x16x32_bf16 v[136:139], v[192:195], v[160:163], v[136:139]
    v_mfma_f32_16x16x32_bf16 v[140:143], v[192:195], v[164:167], v[140:143]
    v_mfma_f32_16x16x32_bf16 v[144:147], v[196:199], v[160:163], v[144:147]
    v_mfma_f32_16x16x32_bf16 v[148:151], v[196:199], v[164:167], v[148:151]
    v_mfma_f32_16x16x32_bf16 v[152:155], v[200:203], v[160:163], v[152:155]
    v_mfma_f32_16x16x32_bf16 v[156:159], v[200:203], v[164:167], v[156:159]
    s_waitcnt lgkmcnt(0)
    s_barrier
    v_mfma_f32_16x16x32_bf16 v[88:91], v[212:215], v[204:207], v[88:91]
    ds_read_b128 v[160:163], v3 offset:16384
    v_mfma_f32_16x16x32_bf16 v[92:95], v[212:215], v[208:211], v[92:95]
    ds_read_b128 v[164:167], v3 offset:18432
    v_mfma_f32_16x16x32_bf16 v[96:99], v[216:219], v[204:207], v[96:99]
    ds_read_b128 v[168:171], v1 offset:18432
    v_mfma_f32_16x16x32_bf16 v[100:103], v[216:219], v[208:211], v[100:103]
    ds_read_b128 v[172:175], v1 offset:19456
    v_mfma_f32_16x16x32_bf16 v[104:107], v[220:223], v[204:207], v[104:107]
    ds_read_b128 v[176:179], v1 offset:20480
    v_mfma_f32_16x16x32_bf16 v[108:111], v[220:223], v[208:211], v[108:111]
    ds_read_b128 v[180:183], v1 offset:21504
    v_mfma_f32_16x16x32_bf16 v[112:115], v[224:227], v[204:207], v[112:115]
    ds_read_b128 v[184:187], v1 offset:22528
    v_mfma_f32_16x16x32_bf16 v[116:119], v[224:227], v[208:211], v[116:119]
    ds_read_b128 v[188:191], v1 offset:23552
    v_mfma_f32_16x16x32_bf16 v[120:123], v[228:231], v[204:207], v[120:123]
    ds_read_b128 v[192:195], v1 offset:24576
    v_mfma_f32_16x16x32_bf16 v[124:127], v[228:231], v[208:211], v[124:127]
    ds_read_b128 v[196:199], v1 offset:25600
    v_mfma_f32_16x16x32_bf16 v[128:131], v[232:235], v[204:207], v[128:131]
    ds_read_b128 v[200:203], v1 offset:26624
    v_mfma_f32_16x16x32_bf16 v[132:135], v[232:235], v[208:211], v[132:135]
    v_mfma_f32_16x16x32_bf16 v[136:139], v[236:239], v[204:207], v[136:139]
    v_mfma_f32_16x16x32_bf16 v[140:143], v[236:239], v[208:211], v[140:143]
    v_mfma_f32_16x16x32_bf16 v[144:147], v[240:243], v[204:207], v[144:147]
    v_mfma_f32_16x16x32_bf16 v[148:151], v[240:243], v[208:211], v[148:151]
    v_mfma_f32_16x16x32_bf16 v[152:155], v[244:247], v[204:207], v[152:155]
    v_mfma_f32_16x16x32_bf16 v[156:159], v[244:247], v[208:211], v[156:159]
    s_waitcnt lgkmcnt(5)
    v_mfma_f32_16x16x32_bf16 v[88:91], v[168:171], v[160:163], v[88:91]
    ds_read_b128 v[204:207], v3 offset:17408
    v_mfma_f32_16x16x32_bf16 v[92:95], v[168:171], v[164:167], v[92:95]
    ds_read_b128 v[208:211], v3 offset:19456
    v_mfma_f32_16x16x32_bf16 v[96:99], v[172:175], v[160:163], v[96:99]
    ds_read_b128 v[212:215], v1 offset:27648
    v_mfma_f32_16x16x32_bf16 v[100:103], v[172:175], v[164:167], v[100:103]
    ds_read_b128 v[216:219], v1 offset:28672
    v_mfma_f32_16x16x32_bf16 v[104:107], v[176:179], v[160:163], v[104:107]
    ds_read_b128 v[220:223], v1 offset:29696
    v_mfma_f32_16x16x32_bf16 v[108:111], v[176:179], v[164:167], v[108:111]
    ds_read_b128 v[224:227], v1 offset:30720
    v_mfma_f32_16x16x32_bf16 v[112:115], v[180:183], v[160:163], v[112:115]
    ds_read_b128 v[228:231], v1 offset:31744
    v_mfma_f32_16x16x32_bf16 v[116:119], v[180:183], v[164:167], v[116:119]
    ds_read_b128 v[232:235], v1 offset:32768
    s_waitcnt lgkmcnt(8)
    v_mfma_f32_16x16x32_bf16 v[120:123], v[184:187], v[160:163], v[120:123]
    ds_read_b128 v[236:239], v1 offset:33792
    v_mfma_f32_16x16x32_bf16 v[124:127], v[184:187], v[164:167], v[124:127]
    ds_read_b128 v[240:243], v1 offset:34816
    v_mfma_f32_16x16x32_bf16 v[128:131], v[188:191], v[160:163], v[128:131]
    ds_read_b128 v[244:247], v1 offset:35840
    v_mfma_f32_16x16x32_bf16 v[132:135], v[188:191], v[164:167], v[132:135]
    v_mfma_f32_16x16x32_bf16 v[136:139], v[192:195], v[160:163], v[136:139]
    v_mfma_f32_16x16x32_bf16 v[140:143], v[192:195], v[164:167], v[140:143]
    v_mfma_f32_16x16x32_bf16 v[144:147], v[196:199], v[160:163], v[144:147]
    v_mfma_f32_16x16x32_bf16 v[148:151], v[196:199], v[164:167], v[148:151]
    v_mfma_f32_16x16x32_bf16 v[152:155], v[200:203], v[160:163], v[152:155]
    v_mfma_f32_16x16x32_bf16 v[156:159], v[200:203], v[164:167], v[156:159]
    s_waitcnt lgkmcnt(0)
    s_barrier
    v_mfma_f32_16x16x32_bf16 v[88:91], v[212:215], v[204:207], v[88:91]
    v_mfma_f32_16x16x32_bf16 v[92:95], v[212:215], v[208:211], v[92:95]
    v_mfma_f32_16x16x32_bf16 v[96:99], v[216:219], v[204:207], v[96:99]
    v_mfma_f32_16x16x32_bf16 v[100:103], v[216:219], v[208:211], v[100:103]
    v_mfma_f32_16x16x32_bf16 v[104:107], v[220:223], v[204:207], v[104:107]
    v_mfma_f32_16x16x32_bf16 v[108:111], v[220:223], v[208:211], v[108:111]
    v_mfma_f32_16x16x32_bf16 v[112:115], v[224:227], v[204:207], v[112:115]
    v_mfma_f32_16x16x32_bf16 v[116:119], v[224:227], v[208:211], v[116:119]
    v_mfma_f32_16x16x32_bf16 v[120:123], v[228:231], v[204:207], v[120:123]
    v_mfma_f32_16x16x32_bf16 v[124:127], v[228:231], v[208:211], v[124:127]
    v_mfma_f32_16x16x32_bf16 v[128:131], v[232:235], v[204:207], v[128:131]
    v_mfma_f32_16x16x32_bf16 v[132:135], v[232:235], v[208:211], v[132:135]
    v_mfma_f32_16x16x32_bf16 v[136:139], v[236:239], v[204:207], v[136:139]
    v_mfma_f32_16x16x32_bf16 v[140:143], v[236:239], v[208:211], v[140:143]
    v_mfma_f32_16x16x32_bf16 v[144:147], v[240:243], v[204:207], v[144:147]
    v_mfma_f32_16x16x32_bf16 v[148:151], v[240:243], v[208:211], v[148:151]
    v_mfma_f32_16x16x32_bf16 v[152:155], v[244:247], v[204:207], v[152:155]
    v_mfma_f32_16x16x32_bf16 v[156:159], v[244:247], v[208:211], v[156:159]
    s_waitcnt vmcnt(0)
    v_pk_add_f32 v[4:5], v[4:5], v[8:9]
    v_pk_add_f32 v[6:7], v[6:7], v[10:11]
    v_pk_add_f32 v[12:13], v[12:13], v[252:253]
    v_pk_add_f32 v[14:15], v[14:15], v[254:255]
    v_pk_add_f32 v[4:5], v[4:5], v[12:13]
    v_pk_add_f32 v[6:7], v[6:7], v[14:15]
    v_bfe_u32 v8, v0, 2, 2
    v_and_b32 v9, 3, v0
    v_lshl_add_u32 v8, v8, 3, v9
    s_lshl_b32 s33, s31, 5
    v_lshl_add_u32 v8, v8, 1, s33
    buffer_load_ushort v252, v8, s[12:15], 0 offen
    buffer_load_ushort v254, v8, s[12:15], 0 offen offset:8
    v_add_f32_dpp v4, v4, v4 quad_perm:[1,0,3,2] row_mask:0xf bank_mask:0xf
    v_add_f32_dpp v5, v5, v5 quad_perm:[1,0,3,2] row_mask:0xf bank_mask:0xf
    v_add_f32_dpp v6, v6, v6 quad_perm:[1,0,3,2] row_mask:0xf bank_mask:0xf
    v_add_f32_dpp v7, v7, v7 quad_perm:[1,0,3,2] row_mask:0xf bank_mask:0xf
    v_add_f32_dpp v4, v4, v4 quad_perm:[2,3,0,1] row_mask:0xf bank_mask:0xf
    v_add_f32_dpp v5, v5, v5 quad_perm:[2,3,0,1] row_mask:0xf bank_mask:0xf
    v_add_f32_dpp v6, v6, v6 quad_perm:[2,3,0,1] row_mask:0xf bank_mask:0xf
    v_add_f32_dpp v7, v7, v7 quad_perm:[2,3,0,1] row_mask:0xf bank_mask:0xf
    s_mov_b32 s44, 0x39e38e39
    v_pk_mul_f32 v[4:5], v[4:5], s[44:45] op_sel_hi:[1,0]
    v_pk_mul_f32 v[6:7], v[6:7], s[44:45] op_sel_hi:[1,0]
    v_pk_fma_f32 v[6:7], v[4:5], v[4:5], v[6:7] neg_lo:[1,0,0] neg_hi:[1,0,0]
    v_max_f32 v6, 0, v6
    v_max_f32 v7, 0, v7
    v_add_f32 v6, 0x3727c5ac, v6
    v_add_f32 v7, 0x3727c5ac, v7
    v_rsq_f32 v6, v6
    v_rsq_f32 v7, v7
    s_nop 0
    v_pk_mul_f32 v[4:5], v[4:5], v[6:7] neg_lo:[1,0] neg_hi:[1,0]
    s_add_u32 s39, s38, 4096
    s_add_u32 s46, s38, 8192
    v_mov_b32_dpp v160, v6 row_newbcast:0 row_mask:0xf bank_mask:0xf
    v_mov_b32_dpp v161, v7 row_newbcast:0 row_mask:0xf bank_mask:0xf
    v_mov_b32_dpp v162, v6 row_newbcast:4 row_mask:0xf bank_mask:0xf
    v_mov_b32_dpp v163, v7 row_newbcast:4 row_mask:0xf bank_mask:0xf
    v_mov_b32_dpp v164, v6 row_newbcast:8 row_mask:0xf bank_mask:0xf
    v_mov_b32_dpp v165, v7 row_newbcast:8 row_mask:0xf bank_mask:0xf
    v_mov_b32_dpp v166, v6 row_newbcast:12 row_mask:0xf bank_mask:0xf
    v_mov_b32_dpp v167, v7 row_newbcast:12 row_mask:0xf bank_mask:0xf
    v_mov_b32_dpp v168, v4 row_newbcast:0 row_mask:0xf bank_mask:0xf
    v_mov_b32_dpp v169, v5 row_newbcast:0 row_mask:0xf bank_mask:0xf
    v_mov_b32_dpp v170, v4 row_newbcast:4 row_mask:0xf bank_mask:0xf
    v_mov_b32_dpp v171, v5 row_newbcast:4 row_mask:0xf bank_mask:0xf
    v_mov_b32_dpp v172, v4 row_newbcast:8 row_mask:0xf bank_mask:0xf
    v_mov_b32_dpp v173, v5 row_newbcast:8 row_mask:0xf bank_mask:0xf
    v_mov_b32_dpp v174, v4 row_newbcast:12 row_mask:0xf bank_mask:0xf
    v_mov_b32_dpp v175, v5 row_newbcast:12 row_mask:0xf bank_mask:0xf
    v_bfe_u32 v5, v0, 4, 2
    v_lshlrev_b32 v5, 4, v5
    v_add_u32 v5, 139840, v5
    ds_read_b128 v[176:179], v5 offset:0
    ds_read_b128 v[212:215], v5 offset:1152
    ds_read_b128 v[180:183], v5 offset:64
    ds_read_b128 v[216:219], v5 offset:1216
    ds_read_b128 v[184:187], v5 offset:128
    ds_read_b128 v[220:223], v5 offset:1280
    ds_read_b128 v[188:191], v5 offset:192
    ds_read_b128 v[224:227], v5 offset:1344
    ds_read_b128 v[192:195], v5 offset:256
    ds_read_b128 v[228:231], v5 offset:1408
    ds_read_b128 v[196:199], v5 offset:320
    ds_read_b128 v[232:235], v5 offset:1472
    ds_read_b128 v[200:203], v5 offset:384
    ds_read_b128 v[236:239], v5 offset:1536
    ds_read_b128 v[204:207], v5 offset:448
    ds_read_b128 v[240:243], v5 offset:1600
    ds_read_b128 v[208:211], v5 offset:512
    ds_read_b128 v[244:247], v5 offset:1664
    v_pk_fma_f32 v[16:17], v[16:17], v[160:161], v[168:169]
    v_pk_fma_f32 v[18:19], v[18:19], v[162:163], v[170:171]
    v_pk_fma_f32 v[20:21], v[20:21], v[164:165], v[172:173]
    v_pk_fma_f32 v[22:23], v[22:23], v[166:167], v[174:175]
    v_cvt_pk_bf16_f32 v16, v16, v17
    v_cvt_pk_bf16_f32 v17, v18, v19
    v_cvt_pk_bf16_f32 v18, v20, v21
    v_cvt_pk_bf16_f32 v19, v22, v23
    buffer_store_dwordx4 v[16:19], v1, s[4:7], s38 offen offset:0 sc1
    v_pk_fma_f32 v[24:25], v[24:25], v[160:161], v[168:169]
    v_pk_fma_f32 v[26:27], v[26:27], v[162:163], v[170:171]
    v_pk_fma_f32 v[28:29], v[28:29], v[164:165], v[172:173]
    v_pk_fma_f32 v[30:31], v[30:31], v[166:167], v[174:175]
    v_cvt_pk_bf16_f32 v24, v24, v25
    v_cvt_pk_bf16_f32 v25, v26, v27
    v_cvt_pk_bf16_f32 v26, v28, v29
    v_cvt_pk_bf16_f32 v27, v30, v31
    buffer_store_dwordx4 v[24:27], v1, s[4:7], s38 offen offset:1024 sc1
    v_pk_fma_f32 v[32:33], v[32:33], v[160:161], v[168:169]
    v_pk_fma_f32 v[34:35], v[34:35], v[162:163], v[170:171]
    v_pk_fma_f32 v[36:37], v[36:37], v[164:165], v[172:173]
    v_pk_fma_f32 v[38:39], v[38:39], v[166:167], v[174:175]
    v_cvt_pk_bf16_f32 v32, v32, v33
    v_cvt_pk_bf16_f32 v33, v34, v35
    v_cvt_pk_bf16_f32 v34, v36, v37
    v_cvt_pk_bf16_f32 v35, v38, v39
    buffer_store_dwordx4 v[32:35], v1, s[4:7], s38 offen offset:2048 sc1
    v_pk_fma_f32 v[40:41], v[40:41], v[160:161], v[168:169]
    v_pk_fma_f32 v[42:43], v[42:43], v[162:163], v[170:171]
    v_pk_fma_f32 v[44:45], v[44:45], v[164:165], v[172:173]
    v_pk_fma_f32 v[46:47], v[46:47], v[166:167], v[174:175]
    v_cvt_pk_bf16_f32 v40, v40, v41
    v_cvt_pk_bf16_f32 v41, v42, v43
    v_cvt_pk_bf16_f32 v42, v44, v45
    v_cvt_pk_bf16_f32 v43, v46, v47
    buffer_store_dwordx4 v[40:43], v1, s[4:7], s38 offen offset:3072 sc1
    v_pk_fma_f32 v[48:49], v[48:49], v[160:161], v[168:169]
    v_pk_fma_f32 v[50:51], v[50:51], v[162:163], v[170:171]
    v_pk_fma_f32 v[52:53], v[52:53], v[164:165], v[172:173]
    v_pk_fma_f32 v[54:55], v[54:55], v[166:167], v[174:175]
    v_cvt_pk_bf16_f32 v48, v48, v49
    v_cvt_pk_bf16_f32 v49, v50, v51
    v_cvt_pk_bf16_f32 v50, v52, v53
    v_cvt_pk_bf16_f32 v51, v54, v55
    buffer_store_dwordx4 v[48:51], v1, s[4:7], s39 offen offset:0 sc1
    v_pk_fma_f32 v[56:57], v[56:57], v[160:161], v[168:169]
    v_pk_fma_f32 v[58:59], v[58:59], v[162:163], v[170:171]
    v_pk_fma_f32 v[60:61], v[60:61], v[164:165], v[172:173]
    v_pk_fma_f32 v[62:63], v[62:63], v[166:167], v[174:175]
    v_cvt_pk_bf16_f32 v56, v56, v57
    v_cvt_pk_bf16_f32 v57, v58, v59
    v_cvt_pk_bf16_f32 v58, v60, v61
    v_cvt_pk_bf16_f32 v59, v62, v63
    buffer_store_dwordx4 v[56:59], v1, s[4:7], s39 offen offset:1024 sc1
    v_pk_fma_f32 v[64:65], v[64:65], v[160:161], v[168:169]
    v_pk_fma_f32 v[66:67], v[66:67], v[162:163], v[170:171]
    v_pk_fma_f32 v[68:69], v[68:69], v[164:165], v[172:173]
    v_pk_fma_f32 v[70:71], v[70:71], v[166:167], v[174:175]
    v_cvt_pk_bf16_f32 v64, v64, v65
    v_cvt_pk_bf16_f32 v65, v66, v67
    v_cvt_pk_bf16_f32 v66, v68, v69
    v_cvt_pk_bf16_f32 v67, v70, v71
    buffer_store_dwordx4 v[64:67], v1, s[4:7], s39 offen offset:2048 sc1
    v_pk_fma_f32 v[72:73], v[72:73], v[160:161], v[168:169]
    v_pk_fma_f32 v[74:75], v[74:75], v[162:163], v[170:171]
    v_pk_fma_f32 v[76:77], v[76:77], v[164:165], v[172:173]
    v_pk_fma_f32 v[78:79], v[78:79], v[166:167], v[174:175]
    v_cvt_pk_bf16_f32 v72, v72, v73
    v_cvt_pk_bf16_f32 v73, v74, v75
    v_cvt_pk_bf16_f32 v74, v76, v77
    v_cvt_pk_bf16_f32 v75, v78, v79
    buffer_store_dwordx4 v[72:75], v1, s[4:7], s39 offen offset:3072 sc1
    v_pk_fma_f32 v[80:81], v[80:81], v[160:161], v[168:169]
    v_pk_fma_f32 v[82:83], v[82:83], v[162:163], v[170:171]
    v_pk_fma_f32 v[84:85], v[84:85], v[164:165], v[172:173]
    v_pk_fma_f32 v[86:87], v[86:87], v[166:167], v[174:175]
    v_cvt_pk_bf16_f32 v80, v80, v81
    v_cvt_pk_bf16_f32 v81, v82, v83
    v_cvt_pk_bf16_f32 v82, v84, v85
    v_cvt_pk_bf16_f32 v83, v86, v87
    buffer_store_dwordx4 v[80:83], v1, s[4:7], s46 offen offset:0 sc1
    v_mul_f32 v4, s40, v249
    v_mul_f32 v5, v249, v249
    v_mul_f32 v6, s40, v251
    v_mul_f32 v7, v251, v251
    v_mul_f32 v5, s42, v5
    v_rcp_f32 v249, v249
    v_mul_f32 v7, s42, v7
    v_rcp_f32 v251, v251
    v_mul_f32 v5, v5, v4
    v_mul_f32 v7, v7, v6
    s_waitcnt lgkmcnt(0)
    v_pk_add_f32 v[176:177], v[176:177], v[212:213]
    v_pk_add_f32 v[178:179], v[178:179], v[214:215]
    v_pk_add_f32 v[180:181], v[180:181], v[216:217]
    v_pk_add_f32 v[182:183], v[182:183], v[218:219]
    v_pk_add_f32 v[184:185], v[184:185], v[220:221]
    v_pk_add_f32 v[186:187], v[186:187], v[222:223]
    v_pk_add_f32 v[188:189], v[188:189], v[224:225]
    v_pk_add_f32 v[190:191], v[190:191], v[226:227]
    v_pk_add_f32 v[192:193], v[192:193], v[228:229]
    v_pk_add_f32 v[194:195], v[194:195], v[230:231]
    v_pk_add_f32 v[196:197], v[196:197], v[232:233]
    v_pk_add_f32 v[198:199], v[198:199], v[234:235]
    v_pk_add_f32 v[200:201], v[200:201], v[236:237]
    v_pk_add_f32 v[202:203], v[202:203], v[238:239]
    v_pk_add_f32 v[204:205], v[204:205], v[240:241]
    v_pk_add_f32 v[206:207], v[206:207], v[242:243]
    v_pk_add_f32 v[208:209], v[208:209], v[244:245]
    v_pk_add_f32 v[210:211], v[210:211], v[246:247]
    s_lshl_b32 s45, s22, 8
    s_add_u32 s45, s45, s24
    s_lshl_b32 s45, s45, 8
    s_add_u32 s45, s45, 0x8508000
    v_pk_fma_f32 v[88:89], v[248:249], v[176:177], v[88:89] op_sel_hi:[0,1,1] neg_lo:[1,0,0] neg_hi:[1,0,0]
    v_pk_fma_f32 v[90:91], v[248:249], v[178:179], v[90:91] op_sel_hi:[0,1,1] neg_lo:[1,0,0] neg_hi:[1,0,0]
    v_pk_fma_f32 v[92:93], v[250:251], v[176:177], v[92:93] op_sel_hi:[0,1,1] neg_lo:[1,0,0] neg_hi:[1,0,0]
    v_pk_fma_f32 v[94:95], v[250:251], v[178:179], v[94:95] op_sel_hi:[0,1,1] neg_lo:[1,0,0] neg_hi:[1,0,0]
    v_pk_mul_f32 v[160:161], v[88:89], v[88:89]
    v_pk_mul_f32 v[162:163], v[90:91], v[90:91]
    v_pk_mul_f32 v[164:165], v[92:93], v[92:93]
    v_pk_mul_f32 v[166:167], v[94:95], v[94:95]
    v_pk_fma_f32 v[160:161], v[160:161], v[4:5], v[4:5] op_sel:[0,1,0] op_sel_hi:[1,1,0]
    v_pk_fma_f32 v[162:163], v[162:163], v[4:5], v[4:5] op_sel:[0,1,0] op_sel_hi:[1,1,0]
    v_pk_fma_f32 v[164:165], v[164:165], v[6:7], v[6:7] op_sel:[0,1,0] op_sel_hi:[1,1,0]
    v_pk_fma_f32 v[166:167], v[166:167], v[6:7], v[6:7] op_sel:[0,1,0] op_sel_hi:[1,1,0]
    v_pk_mul_f32 v[160:161], v[160:161], v[88:89]
    v_pk_mul_f32 v[162:163], v[162:163], v[90:91]
    v_pk_mul_f32 v[164:165], v[164:165], v[92:93]
    v_pk_mul_f32 v[166:167], v[166:167], v[94:95]
    v_exp_f32 v160, v160
    v_exp_f32 v161, v161
    v_exp_f32 v162, v162
    v_exp_f32 v163, v163
    v_exp_f32 v164, v164
    v_exp_f32 v165, v165
    v_exp_f32 v166, v166
    v_exp_f32 v167, v167
    v_pk_fma_f32 v[160:161], v[160:161], v[248:249], v[248:249] op_sel:[0,1,1] op_sel_hi:[1,1,1]
    v_pk_fma_f32 v[162:163], v[162:163], v[248:249], v[248:249] op_sel:[0,1,1] op_sel_hi:[1,1,1]
    v_pk_fma_f32 v[164:165], v[164:165], v[250:251], v[250:251] op_sel:[0,1,1] op_sel_hi:[1,1,1]
    v_pk_fma_f32 v[166:167], v[166:167], v[250:251], v[250:251] op_sel:[0,1,1] op_sel_hi:[1,1,1]
    v_rcp_f32 v160, v160
    v_rcp_f32 v161, v161
    v_rcp_f32 v162, v162
    v_rcp_f32 v163, v163
    v_rcp_f32 v164, v164
    v_rcp_f32 v165, v165
    v_rcp_f32 v166, v166
    v_rcp_f32 v167, v167
    v_pk_mul_f32 v[88:89], v[88:89], v[160:161]
    v_pk_mul_f32 v[90:91], v[90:91], v[162:163]
    v_pk_mul_f32 v[92:93], v[92:93], v[164:165]
    v_pk_mul_f32 v[94:95], v[94:95], v[166:167]
    v_pk_fma_f32 v[96:97], v[248:249], v[180:181], v[96:97] op_sel_hi:[0,1,1] neg_lo:[1,0,0] neg_hi:[1,0,0]
    v_pk_fma_f32 v[98:99], v[248:249], v[182:183], v[98:99] op_sel_hi:[0,1,1] neg_lo:[1,0,0] neg_hi:[1,0,0]
    v_pk_fma_f32 v[100:101], v[250:251], v[180:181], v[100:101] op_sel_hi:[0,1,1] neg_lo:[1,0,0] neg_hi:[1,0,0]
    v_pk_fma_f32 v[102:103], v[250:251], v[182:183], v[102:103] op_sel_hi:[0,1,1] neg_lo:[1,0,0] neg_hi:[1,0,0]
    v_pk_mul_f32 v[168:169], v[96:97], v[96:97]
    v_pk_mul_f32 v[170:171], v[98:99], v[98:99]
    v_pk_mul_f32 v[172:173], v[100:101], v[100:101]
    v_pk_mul_f32 v[174:175], v[102:103], v[102:103]
    v_pk_fma_f32 v[168:169], v[168:169], v[4:5], v[4:5] op_sel:[0,1,0] op_sel_hi:[1,1,0]
    v_pk_fma_f32 v[170:171], v[170:171], v[4:5], v[4:5] op_sel:[0,1,0] op_sel_hi:[1,1,0]
    v_pk_fma_f32 v[172:173], v[172:173], v[6:7], v[6:7] op_sel:[0,1,0] op_sel_hi:[1,1,0]
    v_pk_fma_f32 v[174:175], v[174:175], v[6:7], v[6:7] op_sel:[0,1,0] op_sel_hi:[1,1,0]
    v_pk_mul_f32 v[168:169], v[168:169], v[96:97]
    v_pk_mul_f32 v[170:171], v[170:171], v[98:99]
    v_pk_mul_f32 v[172:173], v[172:173], v[100:101]
    v_pk_mul_f32 v[174:175], v[174:175], v[102:103]
    v_exp_f32 v168, v168
    v_exp_f32 v169, v169
    v_exp_f32 v170, v170
    v_exp_f32 v171, v171
    v_exp_f32 v172, v172
    v_exp_f32 v173, v173
    v_exp_f32 v174, v174
    v_exp_f32 v175, v175
    v_pk_fma_f32 v[168:169], v[168:169], v[248:249], v[248:249] op_sel:[0,1,1] op_sel_hi:[1,1,1]
    v_pk_fma_f32 v[170:171], v[170:171], v[248:249], v[248:249] op_sel:[0,1,1] op_sel_hi:[1,1,1]
    v_pk_fma_f32 v[172:173], v[172:173], v[250:251], v[250:251] op_sel:[0,1,1] op_sel_hi:[1,1,1]
    v_pk_fma_f32 v[174:175], v[174:175], v[250:251], v[250:251] op_sel:[0,1,1] op_sel_hi:[1,1,1]
    v_rcp_f32 v168, v168
    v_rcp_f32 v169, v169
    v_rcp_f32 v170, v170
    v_rcp_f32 v171, v171
    v_rcp_f32 v172, v172
    v_rcp_f32 v173, v173
    v_rcp_f32 v174, v174
    v_rcp_f32 v175, v175
    v_pk_mul_f32 v[96:97], v[96:97], v[168:169]
    v_pk_mul_f32 v[98:99], v[98:99], v[170:171]
    v_pk_mul_f32 v[100:101], v[100:101], v[172:173]
    v_pk_mul_f32 v[102:103], v[102:103], v[174:175]
    v_pk_fma_f32 v[104:105], v[248:249], v[184:185], v[104:105] op_sel_hi:[0,1,1] neg_lo:[1,0,0] neg_hi:[1,0,0]
    v_pk_fma_f32 v[106:107], v[248:249], v[186:187], v[106:107] op_sel_hi:[0,1,1] neg_lo:[1,0,0] neg_hi:[1,0,0]
    v_pk_fma_f32 v[108:109], v[250:251], v[184:185], v[108:109] op_sel_hi:[0,1,1] neg_lo:[1,0,0] neg_hi:[1,0,0]
    v_pk_fma_f32 v[110:111], v[250:251], v[186:187], v[110:111] op_sel_hi:[0,1,1] neg_lo:[1,0,0] neg_hi:[1,0,0]
    v_pk_mul_f32 v[160:161], v[104:105], v[104:105]
    v_pk_mul_f32 v[162:163], v[106:107], v[106:107]
    v_pk_mul_f32 v[164:165], v[108:109], v[108:109]
    v_pk_mul_f32 v[166:167], v[110:111], v[110:111]
    v_pk_fma_f32 v[160:161], v[160:161], v[4:5], v[4:5] op_sel:[0,1,0] op_sel_hi:[1,1,0]
    v_pk_fma_f32 v[162:163], v[162:163], v[4:5], v[4:5] op_sel:[0,1,0] op_sel_hi:[1,1,0]
    v_pk_fma_f32 v[164:165], v[164:165], v[6:7], v[6:7] op_sel:[0,1,0] op_sel_hi:[1,1,0]
    v_pk_fma_f32 v[166:167], v[166:167], v[6:7], v[6:7] op_sel:[0,1,0] op_sel_hi:[1,1,0]
    v_pk_mul_f32 v[160:161], v[160:161], v[104:105]
    v_pk_mul_f32 v[162:163], v[162:163], v[106:107]
    v_pk_mul_f32 v[164:165], v[164:165], v[108:109]
    v_pk_mul_f32 v[166:167], v[166:167], v[110:111]
    v_exp_f32 v160, v160
    v_exp_f32 v161, v161
    v_exp_f32 v162, v162
    v_exp_f32 v163, v163
    v_exp_f32 v164, v164
    v_exp_f32 v165, v165
    v_exp_f32 v166, v166
    v_exp_f32 v167, v167
    v_pk_fma_f32 v[160:161], v[160:161], v[248:249], v[248:249] op_sel:[0,1,1] op_sel_hi:[1,1,1]
    v_pk_fma_f32 v[162:163], v[162:163], v[248:249], v[248:249] op_sel:[0,1,1] op_sel_hi:[1,1,1]
    v_pk_fma_f32 v[164:165], v[164:165], v[250:251], v[250:251] op_sel:[0,1,1] op_sel_hi:[1,1,1]
    v_pk_fma_f32 v[166:167], v[166:167], v[250:251], v[250:251] op_sel:[0,1,1] op_sel_hi:[1,1,1]
    v_rcp_f32 v160, v160
    v_rcp_f32 v161, v161
    v_rcp_f32 v162, v162
    v_rcp_f32 v163, v163
    v_rcp_f32 v164, v164
    v_rcp_f32 v165, v165
    v_rcp_f32 v166, v166
    v_rcp_f32 v167, v167
    v_pk_mul_f32 v[104:105], v[104:105], v[160:161]
    v_pk_mul_f32 v[106:107], v[106:107], v[162:163]
    v_pk_mul_f32 v[108:109], v[108:109], v[164:165]
    v_pk_mul_f32 v[110:111], v[110:111], v[166:167]
    v_pk_fma_f32 v[112:113], v[248:249], v[188:189], v[112:113] op_sel_hi:[0,1,1] neg_lo:[1,0,0] neg_hi:[1,0,0]
    v_pk_fma_f32 v[114:115], v[248:249], v[190:191], v[114:115] op_sel_hi:[0,1,1] neg_lo:[1,0,0] neg_hi:[1,0,0]
    v_pk_fma_f32 v[116:117], v[250:251], v[188:189], v[116:117] op_sel_hi:[0,1,1] neg_lo:[1,0,0] neg_hi:[1,0,0]
    v_pk_fma_f32 v[118:119], v[250:251], v[190:191], v[118:119] op_sel_hi:[0,1,1] neg_lo:[1,0,0] neg_hi:[1,0,0]
    v_pk_mul_f32 v[168:169], v[112:113], v[112:113]
    v_pk_mul_f32 v[170:171], v[114:115], v[114:115]
    v_pk_mul_f32 v[172:173], v[116:117], v[116:117]
    v_pk_mul_f32 v[174:175], v[118:119], v[118:119]
    v_pk_fma_f32 v[168:169], v[168:169], v[4:5], v[4:5] op_sel:[0,1,0] op_sel_hi:[1,1,0]
    v_pk_fma_f32 v[170:171], v[170:171], v[4:5], v[4:5] op_sel:[0,1,0] op_sel_hi:[1,1,0]
    v_pk_fma_f32 v[172:173], v[172:173], v[6:7], v[6:7] op_sel:[0,1,0] op_sel_hi:[1,1,0]
    v_pk_fma_f32 v[174:175], v[174:175], v[6:7], v[6:7] op_sel:[0,1,0] op_sel_hi:[1,1,0]
    v_pk_mul_f32 v[168:169], v[168:169], v[112:113]
    v_pk_mul_f32 v[170:171], v[170:171], v[114:115]
    v_pk_mul_f32 v[172:173], v[172:173], v[116:117]
    v_pk_mul_f32 v[174:175], v[174:175], v[118:119]
    v_exp_f32 v168, v168
    v_exp_f32 v169, v169
    v_exp_f32 v170, v170
    v_exp_f32 v171, v171
    v_exp_f32 v172, v172
    v_exp_f32 v173, v173
    v_exp_f32 v174, v174
    v_exp_f32 v175, v175
    v_pk_fma_f32 v[168:169], v[168:169], v[248:249], v[248:249] op_sel:[0,1,1] op_sel_hi:[1,1,1]
    v_pk_fma_f32 v[170:171], v[170:171], v[248:249], v[248:249] op_sel:[0,1,1] op_sel_hi:[1,1,1]
    v_pk_fma_f32 v[172:173], v[172:173], v[250:251], v[250:251] op_sel:[0,1,1] op_sel_hi:[1,1,1]
    v_pk_fma_f32 v[174:175], v[174:175], v[250:251], v[250:251] op_sel:[0,1,1] op_sel_hi:[1,1,1]
    v_rcp_f32 v168, v168
    v_rcp_f32 v169, v169
    v_rcp_f32 v170, v170
    v_rcp_f32 v171, v171
    v_rcp_f32 v172, v172
    v_rcp_f32 v173, v173
    v_rcp_f32 v174, v174
    v_rcp_f32 v175, v175
    v_pk_mul_f32 v[112:113], v[112:113], v[168:169]
    v_pk_mul_f32 v[114:115], v[114:115], v[170:171]
    v_pk_mul_f32 v[116:117], v[116:117], v[172:173]
    v_pk_mul_f32 v[118:119], v[118:119], v[174:175]
    v_pk_fma_f32 v[120:121], v[248:249], v[192:193], v[120:121] op_sel_hi:[0,1,1] neg_lo:[1,0,0] neg_hi:[1,0,0]
    v_pk_fma_f32 v[122:123], v[248:249], v[194:195], v[122:123] op_sel_hi:[0,1,1] neg_lo:[1,0,0] neg_hi:[1,0,0]
    v_pk_fma_f32 v[124:125], v[250:251], v[192:193], v[124:125] op_sel_hi:[0,1,1] neg_lo:[1,0,0] neg_hi:[1,0,0]
    v_pk_fma_f32 v[126:127], v[250:251], v[194:195], v[126:127] op_sel_hi:[0,1,1] neg_lo:[1,0,0] neg_hi:[1,0,0]
    v_pk_mul_f32 v[160:161], v[120:121], v[120:121]
    v_pk_mul_f32 v[162:163], v[122:123], v[122:123]
    v_pk_mul_f32 v[164:165], v[124:125], v[124:125]
    v_pk_mul_f32 v[166:167], v[126:127], v[126:127]
    v_pk_fma_f32 v[160:161], v[160:161], v[4:5], v[4:5] op_sel:[0,1,0] op_sel_hi:[1,1,0]
    v_pk_fma_f32 v[162:163], v[162:163], v[4:5], v[4:5] op_sel:[0,1,0] op_sel_hi:[1,1,0]
    v_pk_fma_f32 v[164:165], v[164:165], v[6:7], v[6:7] op_sel:[0,1,0] op_sel_hi:[1,1,0]
    v_pk_fma_f32 v[166:167], v[166:167], v[6:7], v[6:7] op_sel:[0,1,0] op_sel_hi:[1,1,0]
    v_pk_mul_f32 v[160:161], v[160:161], v[120:121]
    v_pk_mul_f32 v[162:163], v[162:163], v[122:123]
    v_pk_mul_f32 v[164:165], v[164:165], v[124:125]
    v_pk_mul_f32 v[166:167], v[166:167], v[126:127]
    v_exp_f32 v160, v160
    v_exp_f32 v161, v161
    v_exp_f32 v162, v162
    v_exp_f32 v163, v163
    v_exp_f32 v164, v164
    v_exp_f32 v165, v165
    v_exp_f32 v166, v166
    v_exp_f32 v167, v167
    v_pk_fma_f32 v[160:161], v[160:161], v[248:249], v[248:249] op_sel:[0,1,1] op_sel_hi:[1,1,1]
    v_pk_fma_f32 v[162:163], v[162:163], v[248:249], v[248:249] op_sel:[0,1,1] op_sel_hi:[1,1,1]
    v_pk_fma_f32 v[164:165], v[164:165], v[250:251], v[250:251] op_sel:[0,1,1] op_sel_hi:[1,1,1]
    v_pk_fma_f32 v[166:167], v[166:167], v[250:251], v[250:251] op_sel:[0,1,1] op_sel_hi:[1,1,1]
    v_rcp_f32 v160, v160
    v_rcp_f32 v161, v161
    v_rcp_f32 v162, v162
    v_rcp_f32 v163, v163
    v_rcp_f32 v164, v164
    v_rcp_f32 v165, v165
    v_rcp_f32 v166, v166
    v_rcp_f32 v167, v167
    v_pk_mul_f32 v[120:121], v[120:121], v[160:161]
    v_pk_mul_f32 v[122:123], v[122:123], v[162:163]
    v_pk_mul_f32 v[124:125], v[124:125], v[164:165]
    v_pk_mul_f32 v[126:127], v[126:127], v[166:167]
    s_waitcnt vmcnt(0)
    v_mov_b32 v8, 1
    v_mov_b32 v9, 163832
    v_mov_b32 v10, 0
    s_mov_b64 exec, 1
    ds_add_rtn_u32 v11, v9, v8
    s_waitcnt lgkmcnt(0)
    v_and_b32 v11, 3, v11
    v_cmp_eq_u32 vcc, 3, v11
    s_nop 0
    s_cbranch_vccz L_sk_z2s
    buffer_atomic_add v8, v10, s[4:7], s45 offen sc1
L_sk_z2s:
    s_mov_b64 exec, -1
    v_pk_fma_f32 v[128:129], v[248:249], v[196:197], v[128:129] op_sel_hi:[0,1,1] neg_lo:[1,0,0] neg_hi:[1,0,0]
    v_pk_fma_f32 v[130:131], v[248:249], v[198:199], v[130:131] op_sel_hi:[0,1,1] neg_lo:[1,0,0] neg_hi:[1,0,0]
    v_pk_fma_f32 v[132:133], v[250:251], v[196:197], v[132:133] op_sel_hi:[0,1,1] neg_lo:[1,0,0] neg_hi:[1,0,0]
    v_pk_fma_f32 v[134:135], v[250:251], v[198:199], v[134:135] op_sel_hi:[0,1,1] neg_lo:[1,0,0] neg_hi:[1,0,0]
    v_pk_mul_f32 v[168:169], v[128:129], v[128:129]
    v_pk_mul_f32 v[170:171], v[130:131], v[130:131]
    v_pk_mul_f32 v[172:173], v[132:133], v[132:133]
    v_pk_mul_f32 v[174:175], v[134:135], v[134:135]
    v_pk_fma_f32 v[168:169], v[168:169], v[4:5], v[4:5] op_sel:[0,1,0] op_sel_hi:[1,1,0]
    v_pk_fma_f32 v[170:171], v[170:171], v[4:5], v[4:5] op_sel:[0,1,0] op_sel_hi:[1,1,0]
    v_pk_fma_f32 v[172:173], v[172:173], v[6:7], v[6:7] op_sel:[0,1,0] op_sel_hi:[1,1,0]
    v_pk_fma_f32 v[174:175], v[174:175], v[6:7], v[6:7] op_sel:[0,1,0] op_sel_hi:[1,1,0]
    v_pk_mul_f32 v[168:169], v[168:169], v[128:129]
    v_pk_mul_f32 v[170:171], v[170:171], v[130:131]
    v_pk_mul_f32 v[172:173], v[172:173], v[132:133]
    v_pk_mul_f32 v[174:175], v[174:175], v[134:135]
    v_exp_f32 v168, v168
    v_exp_f32 v169, v169
    v_exp_f32 v170, v170
    v_exp_f32 v171, v171
    v_exp_f32 v172, v172
    v_exp_f32 v173, v173
    v_exp_f32 v174, v174
    v_exp_f32 v175, v175
    v_pk_fma_f32 v[168:169], v[168:169], v[248:249], v[248:249] op_sel:[0,1,1] op_sel_hi:[1,1,1]
    v_pk_fma_f32 v[170:171], v[170:171], v[248:249], v[248:249] op_sel:[0,1,1] op_sel_hi:[1,1,1]
    v_pk_fma_f32 v[172:173], v[172:173], v[250:251], v[250:251] op_sel:[0,1,1] op_sel_hi:[1,1,1]
    v_pk_fma_f32 v[174:175], v[174:175], v[250:251], v[250:251] op_sel:[0,1,1] op_sel_hi:[1,1,1]
    v_rcp_f32 v168, v168
    v_rcp_f32 v169, v169
    v_rcp_f32 v170, v170
    v_rcp_f32 v171, v171
    v_rcp_f32 v172, v172
    v_rcp_f32 v173, v173
    v_rcp_f32 v174, v174
    v_rcp_f32 v175, v175
    v_pk_mul_f32 v[128:129], v[128:129], v[168:169]
    v_pk_mul_f32 v[130:131], v[130:131], v[170:171]
    v_pk_mul_f32 v[132:133], v[132:133], v[172:173]
    v_pk_mul_f32 v[134:135], v[134:135], v[174:175]
    v_pk_fma_f32 v[136:137], v[248:249], v[200:201], v[136:137] op_sel_hi:[0,1,1] neg_lo:[1,0,0] neg_hi:[1,0,0]
    v_pk_fma_f32 v[138:139], v[248:249], v[202:203], v[138:139] op_sel_hi:[0,1,1] neg_lo:[1,0,0] neg_hi:[1,0,0]
    v_pk_fma_f32 v[140:141], v[250:251], v[200:201], v[140:141] op_sel_hi:[0,1,1] neg_lo:[1,0,0] neg_hi:[1,0,0]
    v_pk_fma_f32 v[142:143], v[250:251], v[202:203], v[142:143] op_sel_hi:[0,1,1] neg_lo:[1,0,0] neg_hi:[1,0,0]
    v_pk_mul_f32 v[160:161], v[136:137], v[136:137]
    v_pk_mul_f32 v[162:163], v[138:139], v[138:139]
    v_pk_mul_f32 v[164:165], v[140:141], v[140:141]
    v_pk_mul_f32 v[166:167], v[142:143], v[142:143]
    v_pk_fma_f32 v[160:161], v[160:161], v[4:5], v[4:5] op_sel:[0,1,0] op_sel_hi:[1,1,0]
    v_pk_fma_f32 v[162:163], v[162:163], v[4:5], v[4:5] op_sel:[0,1,0] op_sel_hi:[1,1,0]
    v_pk_fma_f32 v[164:165], v[164:165], v[6:7], v[6:7] op_sel:[0,1,0] op_sel_hi:[1,1,0]
    v_pk_fma_f32 v[166:167], v[166:167], v[6:7], v[6:7] op_sel:[0,1,0] op_sel_hi:[1,1,0]
    v_pk_mul_f32 v[160:161], v[160:161], v[136:137]
    v_pk_mul_f32 v[162:163], v[162:163], v[138:139]
    v_pk_mul_f32 v[164:165], v[164:165], v[140:141]
    v_pk_mul_f32 v[166:167], v[166:167], v[142:143]
    v_exp_f32 v160, v160
    v_exp_f32 v161, v161
    v_exp_f32 v162, v162
    v_exp_f32 v163, v163
    v_exp_f32 v164, v164
    v_exp_f32 v165, v165
    v_exp_f32 v166, v166
    v_exp_f32 v167, v167
    v_pk_fma_f32 v[160:161], v[160:161], v[248:249], v[248:249] op_sel:[0,1,1] op_sel_hi:[1,1,1]
    v_pk_fma_f32 v[162:163], v[162:163], v[248:249], v[248:249] op_sel:[0,1,1] op_sel_hi:[1,1,1]
    v_pk_fma_f32 v[164:165], v[164:165], v[250:251], v[250:251] op_sel:[0,1,1] op_sel_hi:[1,1,1]
    v_pk_fma_f32 v[166:167], v[166:167], v[250:251], v[250:251] op_sel:[0,1,1] op_sel_hi:[1,1,1]
    v_rcp_f32 v160, v160
    v_rcp_f32 v161, v161
    v_rcp_f32 v162, v162
    v_rcp_f32 v163, v163
    v_rcp_f32 v164, v164
    v_rcp_f32 v165, v165
    v_rcp_f32 v166, v166
    v_rcp_f32 v167, v167
    v_pk_mul_f32 v[136:137], v[136:137], v[160:161]
    v_pk_mul_f32 v[138:139], v[138:139], v[162:163]
    v_pk_mul_f32 v[140:141], v[140:141], v[164:165]
    v_pk_mul_f32 v[142:143], v[142:143], v[166:167]
    v_pk_fma_f32 v[144:145], v[248:249], v[204:205], v[144:145] op_sel_hi:[0,1,1] neg_lo:[1,0,0] neg_hi:[1,0,0]
    v_pk_fma_f32 v[146:147], v[248:249], v[206:207], v[146:147] op_sel_hi:[0,1,1] neg_lo:[1,0,0] neg_hi:[1,0,0]
    v_pk_fma_f32 v[148:149], v[250:251], v[204:205], v[148:149] op_sel_hi:[0,1,1] neg_lo:[1,0,0] neg_hi:[1,0,0]
    v_pk_fma_f32 v[150:151], v[250:251], v[206:207], v[150:151] op_sel_hi:[0,1,1] neg_lo:[1,0,0] neg_hi:[1,0,0]
    v_pk_mul_f32 v[168:169], v[144:145], v[144:145]
    v_pk_mul_f32 v[170:171], v[146:147], v[146:147]
    v_pk_mul_f32 v[172:173], v[148:149], v[148:149]
    v_pk_mul_f32 v[174:175], v[150:151], v[150:151]
    v_pk_fma_f32 v[168:169], v[168:169], v[4:5], v[4:5] op_sel:[0,1,0] op_sel_hi:[1,1,0]
    v_pk_fma_f32 v[170:171], v[170:171], v[4:5], v[4:5] op_sel:[0,1,0] op_sel_hi:[1,1,0]
    v_pk_fma_f32 v[172:173], v[172:173], v[6:7], v[6:7] op_sel:[0,1,0] op_sel_hi:[1,1,0]
    v_pk_fma_f32 v[174:175], v[174:175], v[6:7], v[6:7] op_sel:[0,1,0] op_sel_hi:[1,1,0]
    v_pk_mul_f32 v[168:169], v[168:169], v[144:145]
    v_pk_mul_f32 v[170:171], v[170:171], v[146:147]
    v_pk_mul_f32 v[172:173], v[172:173], v[148:149]
    v_pk_mul_f32 v[174:175], v[174:175], v[150:151]
    v_exp_f32 v168, v168
    v_exp_f32 v169, v169
    v_exp_f32 v170, v170
    v_exp_f32 v171, v171
    v_exp_f32 v172, v172
    v_exp_f32 v173, v173
    v_exp_f32 v174, v174
    v_exp_f32 v175, v175
    v_pk_fma_f32 v[168:169], v[168:169], v[248:249], v[248:249] op_sel:[0,1,1] op_sel_hi:[1,1,1]
    v_pk_fma_f32 v[170:171], v[170:171], v[248:249], v[248:249] op_sel:[0,1,1] op_sel_hi:[1,1,1]
    v_pk_fma_f32 v[172:173], v[172:173], v[250:251], v[250:251] op_sel:[0,1,1] op_sel_hi:[1,1,1]
    v_pk_fma_f32 v[174:175], v[174:175], v[250:251], v[250:251] op_sel:[0,1,1] op_sel_hi:[1,1,1]
    v_rcp_f32 v168, v168
    v_rcp_f32 v169, v169
    v_rcp_f32 v170, v170
    v_rcp_f32 v171, v171
    v_rcp_f32 v172, v172
    v_rcp_f32 v173, v173
    v_rcp_f32 v174, v174
    v_rcp_f32 v175, v175
    v_pk_mul_f32 v[144:145], v[144:145], v[168:169]
    v_pk_mul_f32 v[146:147], v[146:147], v[170:171]
    v_pk_mul_f32 v[148:149], v[148:149], v[172:173]
    v_pk_mul_f32 v[150:151], v[150:151], v[174:175]
    v_pk_fma_f32 v[152:153], v[248:249], v[208:209], v[152:153] op_sel_hi:[0,1,1] neg_lo:[1,0,0] neg_hi:[1,0,0]
    v_pk_fma_f32 v[154:155], v[248:249], v[210:211], v[154:155] op_sel_hi:[0,1,1] neg_lo:[1,0,0] neg_hi:[1,0,0]
    v_pk_fma_f32 v[156:157], v[250:251], v[208:209], v[156:157] op_sel_hi:[0,1,1] neg_lo:[1,0,0] neg_hi:[1,0,0]
    v_pk_fma_f32 v[158:159], v[250:251], v[210:211], v[158:159] op_sel_hi:[0,1,1] neg_lo:[1,0,0] neg_hi:[1,0,0]
    v_pk_mul_f32 v[160:161], v[152:153], v[152:153]
    v_pk_mul_f32 v[162:163], v[154:155], v[154:155]
    v_pk_mul_f32 v[164:165], v[156:157], v[156:157]
    v_pk_mul_f32 v[166:167], v[158:159], v[158:159]
    v_pk_fma_f32 v[160:161], v[160:161], v[4:5], v[4:5] op_sel:[0,1,0] op_sel_hi:[1,1,0]
    v_pk_fma_f32 v[162:163], v[162:163], v[4:5], v[4:5] op_sel:[0,1,0] op_sel_hi:[1,1,0]
    v_pk_fma_f32 v[164:165], v[164:165], v[6:7], v[6:7] op_sel:[0,1,0] op_sel_hi:[1,1,0]
    v_pk_fma_f32 v[166:167], v[166:167], v[6:7], v[6:7] op_sel:[0,1,0] op_sel_hi:[1,1,0]
    v_pk_mul_f32 v[160:161], v[160:161], v[152:153]
    v_pk_mul_f32 v[162:163], v[162:163], v[154:155]
    v_pk_mul_f32 v[164:165], v[164:165], v[156:157]
    v_pk_mul_f32 v[166:167], v[166:167], v[158:159]
    v_exp_f32 v160, v160
    v_exp_f32 v161, v161
    v_exp_f32 v162, v162
    v_exp_f32 v163, v163
    v_exp_f32 v164, v164
    v_exp_f32 v165, v165
    v_exp_f32 v166, v166
    v_exp_f32 v167, v167
    v_pk_fma_f32 v[160:161], v[160:161], v[248:249], v[248:249] op_sel:[0,1,1] op_sel_hi:[1,1,1]
    v_pk_fma_f32 v[162:163], v[162:163], v[248:249], v[248:249] op_sel:[0,1,1] op_sel_hi:[1,1,1]
    v_pk_fma_f32 v[164:165], v[164:165], v[250:251], v[250:251] op_sel:[0,1,1] op_sel_hi:[1,1,1]
    v_pk_fma_f32 v[166:167], v[166:167], v[250:251], v[250:251] op_sel:[0,1,1] op_sel_hi:[1,1,1]
    v_rcp_f32 v160, v160
    v_rcp_f32 v161, v161
    v_rcp_f32 v162, v162
    v_rcp_f32 v163, v163
    v_rcp_f32 v164, v164
    v_rcp_f32 v165, v165
    v_rcp_f32 v166, v166
    v_rcp_f32 v167, v167
    v_pk_mul_f32 v[152:153], v[152:153], v[160:161]
    v_pk_mul_f32 v[154:155], v[154:155], v[162:163]
    v_pk_mul_f32 v[156:157], v[156:157], v[164:165]
    v_pk_mul_f32 v[158:159], v[158:159], v[166:167]
    v_lshlrev_b32 v252, 16, v252
    v_lshlrev_b32 v254, 16, v254
    v_mov_b32 v253, v252
    v_mov_b32 v255, v254
    v_and_b32 v6, 15, v0
    v_lshrrev_b32 v3, 1, v6
    v_bfe_u32 v4, v0, 4, 2
    v_xor_b32 v3, v3, v4
    v_lshlrev_b32 v3, 4, v3
    v_lshl_add_u32 v3, v6, 7, v3
    s_add_u32 s33, s30, 73728
    v_add_u32 v3, s33, v3
    v_xor_b32 v4, 64, v3
    v_mov_b64 v[16:17], v[252:253]
    v_mov_b64 v[18:19], v[252:253]
    v_mov_b64 v[20:21], v[254:255]
    v_mov_b64 v[22:23], v[254:255]
    v_mov_b64 v[24:25], v[252:253]
    v_mov_b64 v[26:27], v[252:253]
    v_mov_b64 v[28:29], v[254:255]
    v_mov_b64 v[30:31], v[254:255]
    v_mov_b64 v[32:33], v[252:253]
    v_mov_b64 v[34:35], v[252:253]
    v_mov_b64 v[36:37], v[254:255]
    v_mov_b64 v[38:39], v[254:255]
    v_mov_b64 v[40:41], v[252:253]
    v_mov_b64 v[42:43], v[252:253]
    v_mov_b64 v[44:45], v[254:255]
    v_mov_b64 v[46:47], v[254:255]
    v_mov_b64 v[48:49], v[252:253]
    v_mov_b64 v[50:51], v[252:253]
    v_mov_b64 v[52:53], v[254:255]
    v_mov_b64 v[54:55], v[254:255]
    v_mov_b64 v[56:57], v[252:253]
    v_mov_b64 v[58:59], v[252:253]
    v_mov_b64 v[60:61], v[254:255]
    v_mov_b64 v[62:63], v[254:255]
    v_mov_b64 v[64:65], v[252:253]
    v_mov_b64 v[66:67], v[252:253]
    v_mov_b64 v[68:69], v[254:255]
    v_mov_b64 v[70:71], v[254:255]
    v_mov_b64 v[72:73], v[252:253]
    v_mov_b64 v[74:75], v[252:253]
    v_mov_b64 v[76:77], v[254:255]
    v_mov_b64 v[78:79], v[254:255]
    v_mov_b64 v[80:81], v[252:253]
    v_mov_b64 v[82:83], v[252:253]
    v_mov_b64 v[84:85], v[254:255]
    v_mov_b64 v[86:87], v[254:255]
    s_mul_i32 s36, s31, 73728
    s_lshr_b32 s33, s24, 1
    s_mul_i32 s33, s33, 9216
    s_add_u32 s36, s36, s33
    s_add_u32 s36, s36, s21
    s_and_b32 s33, s24, 1
    s_lshl_b32 s34, s33, 12
    s_lshl_b32 s35, s33, 3
    s_add_u32 s35, s35, 8192
    v_add_u32 v14, s34, v1
    v_add_u32 v15, s35, v1
    s_add_u32 s39, s36, 0x1b00000
    s_add_u32 s40, s36, 0x1b12000
    s_mov_b32 s41, 7
    s_barrier
    ds_read_b128 v[160:163], v3 offset:32768
    ds_read_b128 v[164:167], v3 offset:34816
    ds_read_b128 v[168:171], v2 offset:0
    ds_read_b128 v[172:175], v2 offset:1024
    ds_read_b128 v[176:179], v2 offset:2048
    ds_read_b128 v[180:183], v2 offset:3072
    ds_read_b128 v[184:187], v2 offset:4096
    ds_read_b128 v[188:191], v2 offset:5120
    ds_read_b128 v[192:195], v2 offset:6144
    ds_read_b128 v[196:199], v2 offset:7168
    ds_read_b128 v[200:203], v2 offset:8192
    .p2align 6
L_g_loop:
    s_waitcnt lgkmcnt(5)
    v_mfma_f32_16x16x32_bf16 v[16:19], v[168:171], v[160:163], v[16:19]
    ds_read_b128 v[204:207], v4 offset:32768
    v_mfma_f32_16x16x32_bf16 v[20:23], v[168:171], v[164:167], v[20:23]
    ds_read_b128 v[208:211], v4 offset:34816
    v_mfma_f32_16x16x32_bf16 v[24:27], v[172:175], v[160:163], v[24:27]
    ds_read_b128 v[212:215], v2 offset:9216
    v_mfma_f32_16x16x32_bf16 v[28:31], v[172:175], v[164:167], v[28:31]
    ds_read_b128 v[216:219], v2 offset:10240
    v_mfma_f32_16x16x32_bf16 v[32:35], v[176:179], v[160:163], v[32:35]
    ds_read_b128 v[220:223], v2 offset:11264
    v_mfma_f32_16x16x32_bf16 v[36:39], v[176:179], v[164:167], v[36:39]
    ds_read_b128 v[224:227], v2 offset:12288
    v_mfma_f32_16x16x32_bf16 v[40:43], v[180:183], v[160:163], v[40:43]
    ds_read_b128 v[228:231], v2 offset:13312
    v_mfma_f32_16x16x32_bf16 v[44:47], v[180:183], v[164:167], v[44:47]
    ds_read_b128 v[232:235], v2 offset:14336
    s_waitcnt lgkmcnt(8)
    v_mfma_f32_16x16x32_bf16 v[48:51], v[184:187], v[160:163], v[48:51]
    ds_read_b128 v[236:239], v2 offset:15360
    v_mfma_f32_16x16x32_bf16 v[52:55], v[184:187], v[164:167], v[52:55]
    ds_read_b128 v[240:243], v2 offset:16384
    v_mfma_f32_16x16x32_bf16 v[56:59], v[188:191], v[160:163], v[56:59]
    ds_read_b128 v[244:247], v2 offset:17408
    v_mfma_f32_16x16x32_bf16 v[60:63], v[188:191], v[164:167], v[60:63]
    v_mfma_f32_16x16x32_bf16 v[64:67], v[192:195], v[160:163], v[64:67]
    v_mfma_f32_16x16x32_bf16 v[68:71], v[192:195], v[164:167], v[68:71]
    v_mfma_f32_16x16x32_bf16 v[72:75], v[196:199], v[160:163], v[72:75]
    v_mfma_f32_16x16x32_bf16 v[76:79], v[196:199], v[164:167], v[76:79]
    v_mfma_f32_16x16x32_bf16 v[80:83], v[200:203], v[160:163], v[80:83]
    v_mfma_f32_16x16x32_bf16 v[84:87], v[200:203], v[164:167], v[84:87]
    s_waitcnt lgkmcnt(0)
    s_barrier
    v_mfma_f32_16x16x32_bf16 v[16:19], v[212:215], v[204:207], v[16:19]
    ds_read_b128 v[160:163], v3 offset:49152
    v_mfma_f32_16x16x32_bf16 v[20:23], v[212:215], v[208:211], v[20:23]
    ds_read_b128 v[164:167], v3 offset:51200
    v_mfma_f32_16x16x32_bf16 v[24:27], v[216:219], v[204:207], v[24:27]
    ds_read_b128 v[168:171], v2 offset:18432
    v_mfma_f32_16x16x32_bf16 v[28:31], v[216:219], v[208:211], v[28:31]
    ds_read_b128 v[172:175], v2 offset:19456
    v_mfma_f32_16x16x32_bf16 v[32:35], v[220:223], v[204:207], v[32:35]
    ds_read_b128 v[176:179], v2 offset:20480
    v_mfma_f32_16x16x32_bf16 v[36:39], v[220:223], v[208:211], v[36:39]
    ds_read_b128 v[180:183], v2 offset:21504
    v_mfma_f32_16x16x32_bf16 v[40:43], v[224:227], v[204:207], v[40:43]
    ds_read_b128 v[184:187], v2 offset:22528
    v_mfma_f32_16x16x32_bf16 v[44:47], v[224:227], v[208:211], v[44:47]
    ds_read_b128 v[188:191], v2 offset:23552
    v_mfma_f32_16x16x32_bf16 v[48:51], v[228:231], v[204:207], v[48:51]
    ds_read_b128 v[192:195], v2 offset:24576
    v_mfma_f32_16x16x32_bf16 v[52:55], v[228:231], v[208:211], v[52:55]
    ds_read_b128 v[196:199], v2 offset:25600
    v_mfma_f32_16x16x32_bf16 v[56:59], v[232:235], v[204:207], v[56:59]
    ds_read_b128 v[200:203], v2 offset:26624
    v_mfma_f32_16x16x32_bf16 v[60:63], v[232:235], v[208:211], v[60:63]
    v_mfma_f32_16x16x32_bf16 v[64:67], v[236:239], v[204:207], v[64:67]
    v_mfma_f32_16x16x32_bf16 v[68:71], v[236:239], v[208:211], v[68:71]
    v_mfma_f32_16x16x32_bf16 v[72:75], v[240:243], v[204:207], v[72:75]
    v_mfma_f32_16x16x32_bf16 v[76:79], v[240:243], v[208:211], v[76:79]
    v_mfma_f32_16x16x32_bf16 v[80:83], v[244:247], v[204:207], v[80:83]
    v_mfma_f32_16x16x32_bf16 v[84:87], v[244:247], v[208:211], v[84:87]
    s_waitcnt lgkmcnt(5)
    v_mfma_f32_16x16x32_bf16 v[16:19], v[168:171], v[160:163], v[16:19]
    ds_read_b128 v[204:207], v4 offset:49152
    v_mfma_f32_16x16x32_bf16 v[20:23], v[168:171], v[164:167], v[20:23]
    ds_read_b128 v[208:211], v4 offset:51200
    v_mfma_f32_16x16x32_bf16 v[24:27], v[172:175], v[160:163], v[24:27]
    ds_read_b128 v[212:215], v2 offset:27648
    v_mfma_f32_16x16x32_bf16 v[28:31], v[172:175], v[164:167], v[28:31]
    ds_read_b128 v[216:219], v2 offset:28672
    v_mfma_f32_16x16x32_bf16 v[32:35], v[176:179], v[160:163], v[32:35]
    ds_read_b128 v[220:223], v2 offset:29696
    v_mfma_f32_16x16x32_bf16 v[36:39], v[176:179], v[164:167], v[36:39]
    ds_read_b128 v[224:227], v2 offset:30720
    v_mfma_f32_16x16x32_bf16 v[40:43], v[180:183], v[160:163], v[40:43]
    ds_read_b128 v[228:231], v2 offset:31744
    v_mfma_f32_16x16x32_bf16 v[44:47], v[180:183], v[164:167], v[44:47]
    ds_read_b128 v[232:235], v2 offset:32768
    s_waitcnt lgkmcnt(8)
    v_mfma_f32_16x16x32_bf16 v[48:51], v[184:187], v[160:163], v[48:51]
    ds_read_b128 v[236:239], v2 offset:33792
    v_mfma_f32_16x16x32_bf16 v[52:55], v[184:187], v[164:167], v[52:55]
    ds_read_b128 v[240:243], v2 offset:34816
    v_mfma_f32_16x16x32_bf16 v[56:59], v[188:191], v[160:163], v[56:59]
    ds_read_b128 v[244:247], v2 offset:35840
    v_mfma_f32_16x16x32_bf16 v[60:63], v[188:191], v[164:167], v[60:63]
    v_mfma_f32_16x16x32_bf16 v[64:67], v[192:195], v[160:163], v[64:67]
    v_mfma_f32_16x16x32_bf16 v[68:71], v[192:195], v[164:167], v[68:71]
    v_mfma_f32_16x16x32_bf16 v[72:75], v[196:199], v[160:163], v[72:75]
    v_mfma_f32_16x16x32_bf16 v[76:79], v[196:199], v[164:167], v[76:79]
    v_mfma_f32_16x16x32_bf16 v[80:83], v[200:203], v[160:163], v[80:83]
    v_mfma_f32_16x16x32_bf16 v[84:87], v[200:203], v[164:167], v[84:87]
    s_waitcnt lgkmcnt(0)
    s_barrier
    v_mfma_f32_16x16x32_bf16 v[16:19], v[212:215], v[204:207], v[16:19]
    ds_read_b128 v[160:163], v3 offset:0
    v_mfma_f32_16x16x32_bf16 v[20:23], v[212:215], v[208:211], v[20:23]
    ds_read_b128 v[164:167], v3 offset:2048
    v_mfma_f32_16x16x32_bf16 v[24:27], v[216:219], v[204:207], v[24:27]
    ds_read_b128 v[168:171], v1 offset:0
    v_mfma_f32_16x16x32_bf16 v[28:31], v[216:219], v[208:211], v[28:31]
    ds_read_b128 v[172:175], v1 offset:1024
    v_mfma_f32_16x16x32_bf16 v[32:35], v[220:223], v[204:207], v[32:35]
    ds_read_b128 v[176:179], v1 offset:2048
    v_mfma_f32_16x16x32_bf16 v[36:39], v[220:223], v[208:211], v[36:39]
    ds_read_b128 v[180:183], v1 offset:3072
    v_mfma_f32_16x16x32_bf16 v[40:43], v[224:227], v[204:207], v[40:43]
    ds_read_b128 v[184:187], v1 offset:4096
    v_mfma_f32_16x16x32_bf16 v[44:47], v[224:227], v[208:211], v[44:47]
    ds_read_b128 v[188:191], v1 offset:5120
    v_mfma_f32_16x16x32_bf16 v[48:51], v[228:231], v[204:207], v[48:51]
    ds_read_b128 v[192:195], v1 offset:6144
    v_mfma_f32_16x16x32_bf16 v[52:55], v[228:231], v[208:211], v[52:55]
    ds_read_b128 v[196:199], v1 offset:7168
    v_mfma_f32_16x16x32_bf16 v[56:59], v[232:235], v[204:207], v[56:59]
    ds_read_b128 v[200:203], v1 offset:8192
    v_mfma_f32_16x16x32_bf16 v[60:63], v[232:235], v[208:211], v[60:63]
    v_mfma_f32_16x16x32_bf16 v[64:67], v[236:239], v[204:207], v[64:67]
    v_mfma_f32_16x16x32_bf16 v[68:71], v[236:239], v[208:211], v[68:71]
    v_mfma_f32_16x16x32_bf16 v[72:75], v[240:243], v[204:207], v[72:75]
    v_mfma_f32_16x16x32_bf16 v[76:79], v[240:243], v[208:211], v[76:79]
    v_mfma_f32_16x16x32_bf16 v[80:83], v[244:247], v[204:207], v[80:83]
    v_mfma_f32_16x16x32_bf16 v[84:87], v[244:247], v[208:211], v[84:87]
    s_waitcnt lgkmcnt(5)
    v_mfma_f32_16x16x32_bf16 v[16:19], v[168:171], v[160:163], v[16:19]
    ds_read_b128 v[204:207], v4 offset:0
    v_mfma_f32_16x16x32_bf16 v[20:23], v[168:171], v[164:167], v[20:23]
    ds_read_b128 v[208:211], v4 offset:2048
    v_mfma_f32_16x16x32_bf16 v[24:27], v[172:175], v[160:163], v[24:27]
    ds_read_b128 v[212:215], v1 offset:9216
    v_mfma_f32_16x16x32_bf16 v[28:31], v[172:175], v[164:167], v[28:31]
    ds_read_b128 v[216:219], v1 offset:10240
    v_mfma_f32_16x16x32_bf16 v[32:35], v[176:179], v[160:163], v[32:35]
    ds_read_b128 v[220:223], v1 offset:11264
    v_mfma_f32_16x16x32_bf16 v[36:39], v[176:179], v[164:167], v[36:39]
    ds_read_b128 v[224:227], v1 offset:12288
    v_mfma_f32_16x16x32_bf16 v[40:43], v[180:183], v[160:163], v[40:43]
    ds_read_b128 v[228:231], v1 offset:13312
    v_mfma_f32_16x16x32_bf16 v[44:47], v[180:183], v[164:167], v[44:47]
    ds_read_b128 v[232:235], v1 offset:14336
    s_waitcnt lgkmcnt(8)
    v_mfma_f32_16x16x32_bf16 v[48:51], v[184:187], v[160:163], v[48:51]
    ds_read_b128 v[236:239], v1 offset:15360
    v_mfma_f32_16x16x32_bf16 v[52:55], v[184:187], v[164:167], v[52:55]
    ds_read_b128 v[240:243], v1 offset:16384
    v_mfma_f32_16x16x32_bf16 v[56:59], v[188:191], v[160:163], v[56:59]
    ds_read_b128 v[244:247], v1 offset:17408
    v_mfma_f32_16x16x32_bf16 v[60:63], v[188:191], v[164:167], v[60:63]
    v_mfma_f32_16x16x32_bf16 v[64:67], v[192:195], v[160:163], v[64:67]
    v_mfma_f32_16x16x32_bf16 v[68:71], v[192:195], v[164:167], v[68:71]
    v_mfma_f32_16x16x32_bf16 v[72:75], v[196:199], v[160:163], v[72:75]
    v_mfma_f32_16x16x32_bf16 v[76:79], v[196:199], v[164:167], v[76:79]
    v_mfma_f32_16x16x32_bf16 v[80:83], v[200:203], v[160:163], v[80:83]
    v_mfma_f32_16x16x32_bf16 v[84:87], v[200:203], v[164:167], v[84:87]
    s_waitcnt lgkmcnt(0)
    s_barrier
    v_mfma_f32_16x16x32_bf16 v[16:19], v[212:215], v[204:207], v[16:19]
    ds_read_b128 v[160:163], v3 offset:16384
    v_mfma_f32_16x16x32_bf16 v[20:23], v[212:215], v[208:211], v[20:23]
    ds_read_b128 v[164:167], v3 offset:18432
    v_mfma_f32_16x16x32_bf16 v[24:27], v[216:219], v[204:207], v[24:27]
    ds_read_b128 v[168:171], v1 offset:18432
    v_mfma_f32_16x16x32_bf16 v[28:31], v[216:219], v[208:211], v[28:31]
    ds_read_b128 v[172:175], v1 offset:19456
    v_mfma_f32_16x16x32_bf16 v[32:35], v[220:223], v[204:207], v[32:35]
    ds_read_b128 v[176:179], v1 offset:20480
    v_mfma_f32_16x16x32_bf16 v[36:39], v[220:223], v[208:211], v[36:39]
    ds_read_b128 v[180:183], v1 offset:21504
    v_mfma_f32_16x16x32_bf16 v[40:43], v[224:227], v[204:207], v[40:43]
    ds_read_b128 v[184:187], v1 offset:22528
    v_mfma_f32_16x16x32_bf16 v[44:47], v[224:227], v[208:211], v[44:47]
    ds_read_b128 v[188:191], v1 offset:23552
    v_mfma_f32_16x16x32_bf16 v[48:51], v[228:231], v[204:207], v[48:51]
    ds_read_b128 v[192:195], v1 offset:24576
    v_mfma_f32_16x16x32_bf16 v[52:55], v[228:231], v[208:211], v[52:55]
    ds_read_b128 v[196:199], v1 offset:25600
    v_mfma_f32_16x16x32_bf16 v[56:59], v[232:235], v[204:207], v[56:59]
    ds_read_b128 v[200:203], v1 offset:26624
    v_mfma_f32_16x16x32_bf16 v[60:63], v[232:235], v[208:211], v[60:63]
    v_mfma_f32_16x16x32_bf16 v[64:67], v[236:239], v[204:207], v[64:67]
    v_mfma_f32_16x16x32_bf16 v[68:71], v[236:239], v[208:211], v[68:71]
    v_mfma_f32_16x16x32_bf16 v[72:75], v[240:243], v[204:207], v[72:75]
    v_mfma_f32_16x16x32_bf16 v[76:79], v[240:243], v[208:211], v[76:79]
    v_mfma_f32_16x16x32_bf16 v[80:83], v[244:247], v[204:207], v[80:83]
    v_mfma_f32_16x16x32_bf16 v[84:87], v[244:247], v[208:211], v[84:87]
    s_waitcnt lgkmcnt(5)
    v_mfma_f32_16x16x32_bf16 v[16:19], v[168:171], v[160:163], v[16:19]
    ds_read_b128 v[204:207], v4 offset:16384
    v_mfma_f32_16x16x32_bf16 v[20:23], v[168:171], v[164:167], v[20:23]
    ds_read_b128 v[208:211], v4 offset:18432
    v_mfma_f32_16x16x32_bf16 v[24:27], v[172:175], v[160:163], v[24:27]
    ds_read_b128 v[212:215], v1 offset:27648
    v_mfma_f32_16x16x32_bf16 v[28:31], v[172:175], v[164:167], v[28:31]
    ds_read_b128 v[216:219], v1 offset:28672
    v_mfma_f32_16x16x32_bf16 v[32:35], v[176:179], v[160:163], v[32:35]
    ds_read_b128 v[220:223], v1 offset:29696
    v_mfma_f32_16x16x32_bf16 v[36:39], v[176:179], v[164:167], v[36:39]
    ds_read_b128 v[224:227], v1 offset:30720
    v_mfma_f32_16x16x32_bf16 v[40:43], v[180:183], v[160:163], v[40:43]
    ds_read_b128 v[228:231], v1 offset:31744
    v_mfma_f32_16x16x32_bf16 v[44:47], v[180:183], v[164:167], v[44:47]
    ds_read_b128 v[232:235], v1 offset:32768
    s_waitcnt lgkmcnt(8)
    v_mfma_f32_16x16x32_bf16 v[48:51], v[184:187], v[160:163], v[48:51]
    ds_read_b128 v[236:239], v1 offset:33792
    v_mfma_f32_16x16x32_bf16 v[52:55], v[184:187], v[164:167], v[52:55]
    ds_read_b128 v[240:243], v1 offset:34816
    v_mfma_f32_16x16x32_bf16 v[56:59], v[188:191], v[160:163], v[56:59]
    ds_read_b128 v[244:247], v1 offset:35840
    v_mfma_f32_16x16x32_bf16 v[60:63], v[188:191], v[164:167], v[60:63]
    v_mfma_f32_16x16x32_bf16 v[64:67], v[192:195], v[160:163], v[64:67]
    v_mfma_f32_16x16x32_bf16 v[68:71], v[192:195], v[164:167], v[68:71]
    v_mfma_f32_16x16x32_bf16 v[72:75], v[196:199], v[160:163], v[72:75]
    v_mfma_f32_16x16x32_bf16 v[76:79], v[196:199], v[164:167], v[76:79]
    v_mfma_f32_16x16x32_bf16 v[80:83], v[200:203], v[160:163], v[80:83]
    v_mfma_f32_16x16x32_bf16 v[84:87], v[200:203], v[164:167], v[84:87]
    s_waitcnt lgkmcnt(0)
    s_barrier
    v_mfma_f32_16x16x32_bf16 v[16:19], v[212:215], v[204:207], v[16:19]
    ds_read_b128 v[160:163], v3 offset:32768
    v_mfma_f32_16x16x32_bf16 v[20:23], v[212:215], v[208:211], v[20:23]
    ds_read_b128 v[164:167], v3 offset:34816
    v_mfma_f32_16x16x32_bf16 v[24:27], v[216:219], v[204:207], v[24:27]
    ds_read_b128 v[168:171], v2 offset:0
    v_mfma_f32_16x16x32_bf16 v[28:31], v[216:219], v[208:211], v[28:31]
    ds_read_b128 v[172:175], v2 offset:1024
    v_mfma_f32_16x16x32_bf16 v[32:35], v[220:223], v[204:207], v[32:35]
    ds_read_b128 v[176:179], v2 offset:2048
    v_mfma_f32_16x16x32_bf16 v[36:39], v[220:223], v[208:211], v[36:39]
    ds_read_b128 v[180:183], v2 offset:3072
    v_mfma_f32_16x16x32_bf16 v[40:43], v[224:227], v[204:207], v[40:43]
    ds_read_b128 v[184:187], v2 offset:4096
    v_mfma_f32_16x16x32_bf16 v[44:47], v[224:227], v[208:211], v[44:47]
    ds_read_b128 v[188:191], v2 offset:5120
    v_mfma_f32_16x16x32_bf16 v[48:51], v[228:231], v[204:207], v[48:51]
    ds_read_b128 v[192:195], v2 offset:6144
    v_mfma_f32_16x16x32_bf16 v[52:55], v[228:231], v[208:211], v[52:55]
    ds_read_b128 v[196:199], v2 offset:7168
    v_mfma_f32_16x16x32_bf16 v[56:59], v[232:235], v[204:207], v[56:59]
    ds_read_b128 v[200:203], v2 offset:8192
    v_mfma_f32_16x16x32_bf16 v[60:63], v[232:235], v[208:211], v[60:63]
    v_mfma_f32_16x16x32_bf16 v[64:67], v[236:239], v[204:207], v[64:67]
    v_mfma_f32_16x16x32_bf16 v[68:71], v[236:239], v[208:211], v[68:71]
    v_mfma_f32_16x16x32_bf16 v[72:75], v[240:243], v[204:207], v[72:75]
    v_mfma_f32_16x16x32_bf16 v[76:79], v[240:243], v[208:211], v[76:79]
    v_mfma_f32_16x16x32_bf16 v[80:83], v[244:247], v[204:207], v[80:83]
    s_sub_u32 s41, s41, 1
    v_mfma_f32_16x16x32_bf16 v[84:87], v[244:247], v[208:211], v[84:87]
    s_cmp_lg_u32 s41, 0
    s_cbranch_scc1 L_g_loop
    s_waitcnt lgkmcnt(5)
    v_mfma_f32_16x16x32_bf16 v[16:19], v[168:171], v[160:163], v[16:19]
    ds_read_b128 v[204:207], v4 offset:32768
    v_mfma_f32_16x16x32_bf16 v[20:23], v[168:171], v[164:167], v[20:23]
    ds_read_b128 v[208:211], v4 offset:34816
    v_mfma_f32_16x16x32_bf16 v[24:27], v[172:175], v[160:163], v[24:27]
    ds_read_b128 v[212:215], v2 offset:9216
    v_mfma_f32_16x16x32_bf16 v[28:31], v[172:175], v[164:167], v[28:31]
    ds_read_b128 v[216:219], v2 offset:10240
    v_mfma_f32_16x16x32_bf16 v[32:35], v[176:179], v[160:163], v[32:35]
    ds_read_b128 v[220:223], v2 offset:11264
    v_mfma_f32_16x16x32_bf16 v[36:39], v[176:179], v[164:167], v[36:39]
    ds_read_b128 v[224:227], v2 offset:12288
    v_mfma_f32_16x16x32_bf16 v[40:43], v[180:183], v[160:163], v[40:43]
    ds_read_b128 v[228:231], v2 offset:13312
    v_mfma_f32_16x16x32_bf16 v[44:47], v[180:183], v[164:167], v[44:47]
    ds_read_b128 v[232:235], v2 offset:14336
    s_waitcnt lgkmcnt(8)
    v_mfma_f32_16x16x32_bf16 v[48:51], v[184:187], v[160:163], v[48:51]
    ds_read_b128 v[236:239], v2 offset:15360
    v_mfma_f32_16x16x32_bf16 v[52:55], v[184:187], v[164:167], v[52:55]
    ds_read_b128 v[240:243], v2 offset:16384
    v_mfma_f32_16x16x32_bf16 v[56:59], v[188:191], v[160:163], v[56:59]
    ds_read_b128 v[244:247], v2 offset:17408
    v_mfma_f32_16x16x32_bf16 v[60:63], v[188:191], v[164:167], v[60:63]
    v_mfma_f32_16x16x32_bf16 v[64:67], v[192:195], v[160:163], v[64:67]
    v_mfma_f32_16x16x32_bf16 v[68:71], v[192:195], v[164:167], v[68:71]
    v_mfma_f32_16x16x32_bf16 v[72:75], v[196:199], v[160:163], v[72:75]
    v_mfma_f32_16x16x32_bf16 v[76:79], v[196:199], v[164:167], v[76:79]
    v_mfma_f32_16x16x32_bf16 v[80:83], v[200:203], v[160:163], v[80:83]
    v_mfma_f32_16x16x32_bf16 v[84:87], v[200:203], v[164:167], v[84:87]
    s_waitcnt lgkmcnt(0)
    s_barrier
    v_mfma_f32_16x16x32_bf16 v[16:19], v[212:215], v[204:207], v[16:19]
    ds_read_b128 v[160:163], v3 offset:49152
    v_mfma_f32_16x16x32_bf16 v[20:23], v[212:215], v[208:211], v[20:23]
    ds_read_b128 v[164:167], v3 offset:51200
    v_mfma_f32_16x16x32_bf16 v[24:27], v[216:219], v[204:207], v[24:27]
    ds_read_b128 v[168:171], v2 offset:18432
    v_mfma_f32_16x16x32_bf16 v[28:31], v[216:219], v[208:211], v[28:31]
    ds_read_b128 v[172:175], v2 offset:19456
    v_mfma_f32_16x16x32_bf16 v[32:35], v[220:223], v[204:207], v[32:35]
    ds_read_b128 v[176:179], v2 offset:20480
    v_mfma_f32_16x16x32_bf16 v[36:39], v[220:223], v[208:211], v[36:39]
    ds_read_b128 v[180:183], v2 offset:21504
    v_mfma_f32_16x16x32_bf16 v[40:43], v[224:227], v[204:207], v[40:43]
    ds_read_b128 v[184:187], v2 offset:22528
    v_mfma_f32_16x16x32_bf16 v[44:47], v[224:227], v[208:211], v[44:47]
    ds_read_b128 v[188:191], v2 offset:23552
    v_mfma_f32_16x16x32_bf16 v[48:51], v[228:231], v[204:207], v[48:51]
    ds_read_b128 v[192:195], v2 offset:24576
    v_mfma_f32_16x16x32_bf16 v[52:55], v[228:231], v[208:211], v[52:55]
    ds_read_b128 v[196:199], v2 offset:25600
    v_mfma_f32_16x16x32_bf16 v[56:59], v[232:235], v[204:207], v[56:59]
    ds_read_b128 v[200:203], v2 offset:26624
    v_mfma_f32_16x16x32_bf16 v[60:63], v[232:235], v[208:211], v[60:63]
    v_mfma_f32_16x16x32_bf16 v[64:67], v[236:239], v[204:207], v[64:67]
    v_mfma_f32_16x16x32_bf16 v[68:71], v[236:239], v[208:211], v[68:71]
    v_mfma_f32_16x16x32_bf16 v[72:75], v[240:243], v[204:207], v[72:75]
    v_mfma_f32_16x16x32_bf16 v[76:79], v[240:243], v[208:211], v[76:79]
    v_mfma_f32_16x16x32_bf16 v[80:83], v[244:247], v[204:207], v[80:83]
    v_mfma_f32_16x16x32_bf16 v[84:87], v[244:247], v[208:211], v[84:87]
    s_waitcnt lgkmcnt(5)
    v_mfma_f32_16x16x32_bf16 v[16:19], v[168:171], v[160:163], v[16:19]
    ds_read_b128 v[204:207], v4 offset:49152
    v_mfma_f32_16x16x32_bf16 v[20:23], v[168:171], v[164:167], v[20:23]
    ds_read_b128 v[208:211], v4 offset:51200
    v_mfma_f32_16x16x32_bf16 v[24:27], v[172:175], v[160:163], v[24:27]
    ds_read_b128 v[212:215], v2 offset:27648
    v_mfma_f32_16x16x32_bf16 v[28:31], v[172:175], v[164:167], v[28:31]
    ds_read_b128 v[216:219], v2 offset:28672
    v_mfma_f32_16x16x32_bf16 v[32:35], v[176:179], v[160:163], v[32:35]
    ds_read_b128 v[220:223], v2 offset:29696
    v_mfma_f32_16x16x32_bf16 v[36:39], v[176:179], v[164:167], v[36:39]
    ds_read_b128 v[224:227], v2 offset:30720
    v_mfma_f32_16x16x32_bf16 v[40:43], v[180:183], v[160:163], v[40:43]
    ds_read_b128 v[228:231], v2 offset:31744
    v_mfma_f32_16x16x32_bf16 v[44:47], v[180:183], v[164:167], v[44:47]
    ds_read_b128 v[232:235], v2 offset:32768
    s_waitcnt lgkmcnt(8)
    v_mfma_f32_16x16x32_bf16 v[48:51], v[184:187], v[160:163], v[48:51]
    ds_read_b128 v[236:239], v2 offset:33792
    v_mfma_f32_16x16x32_bf16 v[52:55], v[184:187], v[164:167], v[52:55]
    ds_read_b128 v[240:243], v2 offset:34816
    v_mfma_f32_16x16x32_bf16 v[56:59], v[188:191], v[160:163], v[56:59]
    ds_read_b128 v[244:247], v2 offset:35840
    v_mfma_f32_16x16x32_bf16 v[60:63], v[188:191], v[164:167], v[60:63]
    v_mfma_f32_16x16x32_bf16 v[64:67], v[192:195], v[160:163], v[64:67]
    v_mfma_f32_16x16x32_bf16 v[68:71], v[192:195], v[164:167], v[68:71]
    v_mfma_f32_16x16x32_bf16 v[72:75], v[196:199], v[160:163], v[72:75]
    v_mfma_f32_16x16x32_bf16 v[76:79], v[196:199], v[164:167], v[76:79]
    v_mfma_f32_16x16x32_bf16 v[80:83], v[200:203], v[160:163], v[80:83]
    v_mfma_f32_16x16x32_bf16 v[84:87], v[200:203], v[164:167], v[84:87]
    s_waitcnt lgkmcnt(0)
    s_barrier
    v_mfma_f32_16x16x32_bf16 v[16:19], v[212:215], v[204:207], v[16:19]
    ds_read_b128 v[160:163], v3 offset:0
    v_mfma_f32_16x16x32_bf16 v[20:23], v[212:215], v[208:211], v[20:23]
    ds_read_b128 v[164:167], v3 offset:2048
    v_mfma_f32_16x16x32_bf16 v[24:27], v[216:219], v[204:207], v[24:27]
    ds_read_b128 v[168:171], v1 offset:0
    v_mfma_f32_16x16x32_bf16 v[28:31], v[216:219], v[208:211], v[28:31]
    ds_read_b128 v[172:175], v1 offset:1024
    v_mfma_f32_16x16x32_bf16 v[32:35], v[220:223], v[204:207], v[32:35]
    ds_read_b128 v[176:179], v1 offset:2048
    v_mfma_f32_16x16x32_bf16 v[36:39], v[220:223], v[208:211], v[36:39]
    ds_read_b128 v[180:183], v1 offset:3072
    v_mfma_f32_16x16x32_bf16 v[40:43], v[224:227], v[204:207], v[40:43]
    ds_read_b128 v[184:187], v1 offset:4096
    v_mfma_f32_16x16x32_bf16 v[44:47], v[224:227], v[208:211], v[44:47]
    ds_read_b128 v[188:191], v1 offset:5120
    v_mfma_f32_16x16x32_bf16 v[48:51], v[228:231], v[204:207], v[48:51]
    ds_read_b128 v[192:195], v1 offset:6144
    v_mfma_f32_16x16x32_bf16 v[52:55], v[228:231], v[208:211], v[52:55]
    ds_read_b128 v[196:199], v1 offset:7168
    v_mfma_f32_16x16x32_bf16 v[56:59], v[232:235], v[204:207], v[56:59]
    ds_read_b128 v[200:203], v1 offset:8192
    v_mfma_f32_16x16x32_bf16 v[60:63], v[232:235], v[208:211], v[60:63]
    v_mfma_f32_16x16x32_bf16 v[64:67], v[236:239], v[204:207], v[64:67]
    v_mfma_f32_16x16x32_bf16 v[68:71], v[236:239], v[208:211], v[68:71]
    v_mfma_f32_16x16x32_bf16 v[72:75], v[240:243], v[204:207], v[72:75]
    v_mfma_f32_16x16x32_bf16 v[76:79], v[240:243], v[208:211], v[76:79]
    v_mfma_f32_16x16x32_bf16 v[80:83], v[244:247], v[204:207], v[80:83]
    v_mfma_f32_16x16x32_bf16 v[84:87], v[244:247], v[208:211], v[84:87]
    s_waitcnt lgkmcnt(5)
    v_mfma_f32_16x16x32_bf16 v[16:19], v[168:171], v[160:163], v[16:19]
    ds_read_b128 v[204:207], v4 offset:0
    v_mfma_f32_16x16x32_bf16 v[20:23], v[168:171], v[164:167], v[20:23]
    ds_read_b128 v[208:211], v4 offset:2048
    v_mfma_f32_16x16x32_bf16 v[24:27], v[172:175], v[160:163], v[24:27]
    ds_read_b128 v[212:215], v1 offset:9216
    v_mfma_f32_16x16x32_bf16 v[28:31], v[172:175], v[164:167], v[28:31]
    ds_read_b128 v[216:219], v1 offset:10240
    v_mfma_f32_16x16x32_bf16 v[32:35], v[176:179], v[160:163], v[32:35]
    ds_read_b128 v[220:223], v1 offset:11264
    v_mfma_f32_16x16x32_bf16 v[36:39], v[176:179], v[164:167], v[36:39]
    ds_read_b128 v[224:227], v1 offset:12288
    v_mfma_f32_16x16x32_bf16 v[40:43], v[180:183], v[160:163], v[40:43]
    ds_read_b128 v[228:231], v1 offset:13312
    v_mfma_f32_16x16x32_bf16 v[44:47], v[180:183], v[164:167], v[44:47]
    ds_read_b128 v[232:235], v1 offset:14336
    s_waitcnt lgkmcnt(8)
    v_mfma_f32_16x16x32_bf16 v[48:51], v[184:187], v[160:163], v[48:51]
    ds_read_b128 v[236:239], v1 offset:15360
    v_mfma_f32_16x16x32_bf16 v[52:55], v[184:187], v[164:167], v[52:55]
    ds_read_b128 v[240:243], v1 offset:16384
    v_mfma_f32_16x16x32_bf16 v[56:59], v[188:191], v[160:163], v[56:59]
    ds_read_b128 v[244:247], v1 offset:17408
    v_mfma_f32_16x16x32_bf16 v[60:63], v[188:191], v[164:167], v[60:63]
    v_mfma_f32_16x16x32_bf16 v[64:67], v[192:195], v[160:163], v[64:67]
    v_mfma_f32_16x16x32_bf16 v[68:71], v[192:195], v[164:167], v[68:71]
    v_mfma_f32_16x16x32_bf16 v[72:75], v[196:199], v[160:163], v[72:75]
    v_mfma_f32_16x16x32_bf16 v[76:79], v[196:199], v[164:167], v[76:79]
    v_mfma_f32_16x16x32_bf16 v[80:83], v[200:203], v[160:163], v[80:83]
    v_mfma_f32_16x16x32_bf16 v[84:87], v[200:203], v[164:167], v[84:87]
    s_waitcnt lgkmcnt(0)
    s_barrier
    v_mfma_f32_16x16x32_bf16 v[16:19], v[212:215], v[204:207], v[16:19]
    ds_read_b128 v[160:163], v3 offset:16384
    v_mfma_f32_16x16x32_bf16 v[20:23], v[212:215], v[208:211], v[20:23]
    ds_read_b128 v[164:167], v3 offset:18432
    v_mfma_f32_16x16x32_bf16 v[24:27], v[216:219], v[204:207], v[24:27]
    ds_read_b128 v[168:171], v1 offset:18432
    v_mfma_f32_16x16x32_bf16 v[28:31], v[216:219], v[208:211], v[28:31]
    ds_read_b128 v[172:175], v1 offset:19456
    v_mfma_f32_16x16x32_bf16 v[32:35], v[220:223], v[204:207], v[32:35]
    ds_read_b128 v[176:179], v1 offset:20480
    v_mfma_f32_16x16x32_bf16 v[36:39], v[220:223], v[208:211], v[36:39]
    ds_read_b128 v[180:183], v1 offset:21504
    v_mfma_f32_16x16x32_bf16 v[40:43], v[224:227], v[204:207], v[40:43]
    ds_read_b128 v[184:187], v1 offset:22528
    v_mfma_f32_16x16x32_bf16 v[44:47], v[224:227], v[208:211], v[44:47]
    ds_read_b128 v[188:191], v1 offset:23552
    v_mfma_f32_16x16x32_bf16 v[48:51], v[228:231], v[204:207], v[48:51]
    ds_read_b128 v[192:195], v1 offset:24576
    v_mfma_f32_16x16x32_bf16 v[52:55], v[228:231], v[208:211], v[52:55]
    ds_read_b128 v[196:199], v1 offset:25600
    v_mfma_f32_16x16x32_bf16 v[56:59], v[232:235], v[204:207], v[56:59]
    ds_read_b128 v[200:203], v1 offset:26624
    v_mfma_f32_16x16x32_bf16 v[60:63], v[232:235], v[208:211], v[60:63]
    v_mfma_f32_16x16x32_bf16 v[64:67], v[236:239], v[204:207], v[64:67]
    v_mfma_f32_16x16x32_bf16 v[68:71], v[236:239], v[208:211], v[68:71]
    v_mfma_f32_16x16x32_bf16 v[72:75], v[240:243], v[204:207], v[72:75]
    v_mfma_f32_16x16x32_bf16 v[76:79], v[240:243], v[208:211], v[76:79]
    v_mfma_f32_16x16x32_bf16 v[80:83], v[244:247], v[204:207], v[80:83]
    v_mfma_f32_16x16x32_bf16 v[84:87], v[244:247], v[208:211], v[84:87]
    s_waitcnt lgkmcnt(5)
    v_mfma_f32_16x16x32_bf16 v[16:19], v[168:171], v[160:163], v[16:19]
    ds_read_b128 v[204:207], v4 offset:16384
    v_mfma_f32_16x16x32_bf16 v[20:23], v[168:171], v[164:167], v[20:23]
    ds_read_b128 v[208:211], v4 offset:18432
    v_mfma_f32_16x16x32_bf16 v[24:27], v[172:175], v[160:163], v[24:27]
    ds_read_b128 v[212:215], v1 offset:27648
    v_mfma_f32_16x16x32_bf16 v[28:31], v[172:175], v[164:167], v[28:31]
    ds_read_b128 v[216:219], v1 offset:28672
    v_mfma_f32_16x16x32_bf16 v[32:35], v[176:179], v[160:163], v[32:35]
    ds_read_b128 v[220:223], v1 offset:29696
    v_mfma_f32_16x16x32_bf16 v[36:39], v[176:179], v[164:167], v[36:39]
    ds_read_b128 v[224:227], v1 offset:30720
    v_mfma_f32_16x16x32_bf16 v[40:43], v[180:183], v[160:163], v[40:43]
    ds_read_b128 v[228:231], v1 offset:31744
    v_mfma_f32_16x16x32_bf16 v[44:47], v[180:183], v[164:167], v[44:47]
    ds_read_b128 v[232:235], v1 offset:32768
    s_waitcnt lgkmcnt(8)
    v_mfma_f32_16x16x32_bf16 v[48:51], v[184:187], v[160:163], v[48:51]
    ds_read_b128 v[236:239], v1 offset:33792
    v_mfma_f32_16x16x32_bf16 v[52:55], v[184:187], v[164:167], v[52:55]
    ds_read_b128 v[240:243], v1 offset:34816
    v_mfma_f32_16x16x32_bf16 v[56:59], v[188:191], v[160:163], v[56:59]
    ds_read_b128 v[244:247], v1 offset:35840
    v_mfma_f32_16x16x32_bf16 v[60:63], v[188:191], v[164:167], v[60:63]
    v_mfma_f32_16x16x32_bf16 v[64:67], v[192:195], v[160:163], v[64:67]
    v_mfma_f32_16x16x32_bf16 v[68:71], v[192:195], v[164:167], v[68:71]
    v_mfma_f32_16x16x32_bf16 v[72:75], v[196:199], v[160:163], v[72:75]
    v_mfma_f32_16x16x32_bf16 v[76:79], v[196:199], v[164:167], v[76:79]
    v_mfma_f32_16x16x32_bf16 v[80:83], v[200:203], v[160:163], v[80:83]
    v_mfma_f32_16x16x32_bf16 v[84:87], v[200:203], v[164:167], v[84:87]
    s_waitcnt lgkmcnt(0)
    s_barrier
    v_mfma_f32_16x16x32_bf16 v[16:19], v[212:215], v[204:207], v[16:19]
    v_mfma_f32_16x16x32_bf16 v[20:23], v[212:215], v[208:211], v[20:23]
    v_mfma_f32_16x16x32_bf16 v[24:27], v[216:219], v[204:207], v[24:27]
    v_mfma_f32_16x16x32_bf16 v[28:31], v[216:219], v[208:211], v[28:31]
    v_mfma_f32_16x16x32_bf16 v[32:35], v[220:223], v[204:207], v[32:35]
    v_mfma_f32_16x16x32_bf16 v[36:39], v[220:223], v[208:211], v[36:39]
    v_mfma_f32_16x16x32_bf16 v[40:43], v[224:227], v[204:207], v[40:43]
    v_mfma_f32_16x16x32_bf16 v[44:47], v[224:227], v[208:211], v[44:47]
    v_mfma_f32_16x16x32_bf16 v[48:51], v[228:231], v[204:207], v[48:51]
    v_mfma_f32_16x16x32_bf16 v[52:55], v[228:231], v[208:211], v[52:55]
    v_mfma_f32_16x16x32_bf16 v[56:59], v[232:235], v[204:207], v[56:59]
    v_mfma_f32_16x16x32_bf16 v[60:63], v[232:235], v[208:211], v[60:63]
    v_mfma_f32_16x16x32_bf16 v[64:67], v[236:239], v[204:207], v[64:67]
    v_mfma_f32_16x16x32_bf16 v[68:71], v[236:239], v[208:211], v[68:71]
    v_mfma_f32_16x16x32_bf16 v[72:75], v[240:243], v[204:207], v[72:75]
    v_mfma_f32_16x16x32_bf16 v[76:79], v[240:243], v[208:211], v[76:79]
    v_mfma_f32_16x16x32_bf16 v[80:83], v[244:247], v[204:207], v[80:83]
    v_mfma_f32_16x16x32_bf16 v[84:87], v[244:247], v[208:211], v[84:87]
    s_nop 3
    v_pk_mul_f32 v[16:17], v[16:17], v[88:89]
    v_pk_mul_f32 v[18:19], v[18:19], v[90:91]
    v_pk_mul_f32 v[24:25], v[24:25], v[96:97]
    v_pk_mul_f32 v[26:27], v[26:27], v[98:99]
    v_cvt_pk_bf16_f32 v160, v16, v17
    v_cvt_pk_bf16_f32 v161, v18, v19
    v_cvt_pk_bf16_f32 v162, v24, v25
    v_cvt_pk_bf16_f32 v163, v26, v27
    buffer_store_dwordx4 v[160:163], v14, s[4:7], s39 offen offset:0 sc1
    v_pk_mul_f32 v[20:21], v[20:21], v[92:93]
    v_pk_mul_f32 v[22:23], v[22:23], v[94:95]
    v_pk_mul_f32 v[28:29], v[28:29], v[100:101]
    v_pk_mul_f32 v[30:31], v[30:31], v[102:103]
    v_cvt_pk_bf16_f32 v164, v20, v21
    v_cvt_pk_bf16_f32 v165, v22, v23
    v_cvt_pk_bf16_f32 v166, v28, v29
    v_cvt_pk_bf16_f32 v167, v30, v31
    buffer_store_dwordx4 v[164:167], v14, s[4:7], s40 offen offset:0 sc1
    v_pk_mul_f32 v[32:33], v[32:33], v[104:105]
    v_pk_mul_f32 v[34:35], v[34:35], v[106:107]
    v_pk_mul_f32 v[40:41], v[40:41], v[112:113]
    v_pk_mul_f32 v[42:43], v[42:43], v[114:115]
    v_cvt_pk_bf16_f32 v168, v32, v33
    v_cvt_pk_bf16_f32 v169, v34, v35
    v_cvt_pk_bf16_f32 v170, v40, v41
    v_cvt_pk_bf16_f32 v171, v42, v43
    buffer_store_dwordx4 v[168:171], v14, s[4:7], s39 offen offset:1024 sc1
    v_pk_mul_f32 v[36:37], v[36:37], v[108:109]
    v_pk_mul_f32 v[38:39], v[38:39], v[110:111]
    v_pk_mul_f32 v[44:45], v[44:45], v[116:117]
    v_pk_mul_f32 v[46:47], v[46:47], v[118:119]
    v_cvt_pk_bf16_f32 v172, v36, v37
    v_cvt_pk_bf16_f32 v173, v38, v39
    v_cvt_pk_bf16_f32 v174, v44, v45
    v_cvt_pk_bf16_f32 v175, v46, v47
    buffer_store_dwordx4 v[172:175], v14, s[4:7], s40 offen offset:1024 sc1
    v_pk_mul_f32 v[48:49], v[48:49], v[120:121]
    v_pk_mul_f32 v[50:51], v[50:51], v[122:123]
    v_pk_mul_f32 v[56:57], v[56:57], v[128:129]
    v_pk_mul_f32 v[58:59], v[58:59], v[130:131]
    v_cvt_pk_bf16_f32 v176, v48, v49
    v_cvt_pk_bf16_f32 v177, v50, v51
    v_cvt_pk_bf16_f32 v178, v56, v57
    v_cvt_pk_bf16_f32 v179, v58, v59
    buffer_store_dwordx4 v[176:179], v14, s[4:7], s39 offen offset:2048 sc1
    v_pk_mul_f32 v[52:53], v[52:53], v[124:125]
    v_pk_mul_f32 v[54:55], v[54:55], v[126:127]
    v_pk_mul_f32 v[60:61], v[60:61], v[132:133]
    v_pk_mul_f32 v[62:63], v[62:63], v[134:135]
    v_cvt_pk_bf16_f32 v180, v52, v53
    v_cvt_pk_bf16_f32 v181, v54, v55
    v_cvt_pk_bf16_f32 v182, v60, v61
    v_cvt_pk_bf16_f32 v183, v62, v63
    buffer_store_dwordx4 v[180:183], v14, s[4:7], s40 offen offset:2048 sc1
    v_pk_mul_f32 v[64:65], v[64:65], v[136:137]
    v_pk_mul_f32 v[66:67], v[66:67], v[138:139]
    v_pk_mul_f32 v[72:73], v[72:73], v[144:145]
    v_pk_mul_f32 v[74:75], v[74:75], v[146:147]
    v_cvt_pk_bf16_f32 v184, v64, v65
    v_cvt_pk_bf16_f32 v185, v66, v67
    v_cvt_pk_bf16_f32 v186, v72, v73
    v_cvt_pk_bf16_f32 v187, v74, v75
    buffer_store_dwordx4 v[184:187], v14, s[4:7], s39 offen offset:3072 sc1
    v_pk_mul_f32 v[68:69], v[68:69], v[140:141]
    v_pk_mul_f32 v[70:71], v[70:71], v[142:143]
    v_pk_mul_f32 v[76:77], v[76:77], v[148:149]
    v_pk_mul_f32 v[78:79], v[78:79], v[150:151]
    v_cvt_pk_bf16_f32 v188, v68, v69
    v_cvt_pk_bf16_f32 v189, v70, v71
    v_cvt_pk_bf16_f32 v190, v76, v77
    v_cvt_pk_bf16_f32 v191, v78, v79
    buffer_store_dwordx4 v[188:191], v14, s[4:7], s40 offen offset:3072 sc1
    v_pk_mul_f32 v[80:81], v[80:81], v[152:153]
    v_pk_mul_f32 v[82:83], v[82:83], v[154:155]
    v_cvt_pk_bf16_f32 v192, v80, v81
    v_cvt_pk_bf16_f32 v193, v82, v83
    buffer_store_dwordx2 v[192:193], v15, s[4:7], s39 offen sc1
    v_pk_mul_f32 v[84:85], v[84:85], v[156:157]
    v_pk_mul_f32 v[86:87], v[86:87], v[158:159]
    v_cvt_pk_bf16_f32 v196, v84, v85
    v_cvt_pk_bf16_f32 v197, v86, v87
    buffer_store_dwordx2 v[196:197], v15, s[4:7], s40 offen sc1
    s_lshl_b32 s45, s22, 8
    s_add_u32 s45, s45, s23
    s_lshl_b32 s45, s45, 8
    s_add_u32 s45, s45, 0x850a000
    s_and_b32 s25, s2, 7
    s_lshr_b32 s26, s2, 3
    s_lshl_b32 s23, s25, 2
    s_lshr_b32 s27, s26, 3
    s_add_u32 s23, s23, s27
    s_and_b32 s24, s26, 7
    s_add_u32 s28, s23, s24
    s_and_b32 s28, s28, 3
    s_lshl_b32 s30, s23, 2
    s_add_u32 s30, s30, s20
    s_mul_i32 s29, s30, 73728
    s_add_u32 s29, s29, s21
    s_add_u32 s29, s29, 0x1b00000
    s_mul_i32 s34, s30, 18432
    s_add_u32 s34, s34, s21
    s_add_u32 s34, s34, 0x300000
    s_lshl_b32 s35, s24, 11
    s_lshr_b32 s36, s24, 2
    s_lshl_b32 s36, s36, 10
    s_and_b32 s37, s24, 3
    s_lshl_b32 s37, s37, 8
    s_add_u32 s36, s36, s37
    s_add_u32 s36, s36, 16384
    v_and_b32 v2, 15, v0
    v_bfe_u32 v3, v0, 4, 2
    v_add_u32 v4, s35, v1
    v_lshlrev_b32 v5, 4, v2
    v_lshl_add_u32 v5, v3, 3, v5
    v_add_u32 v5, s36, v5
    v_cmp_gt_u32 s[40:41], 2, v3
    v_bfrev_b32 v6, 1
    v_add_u32 v12, 0, v1
    v_add_u32 v13, 36864, v1
    v_add_u32 v14, 73728, v1
    v_add_u32 v15, 110592, v1
    v_cndmask_b32 v5, v6, v5, s[40:41]
    v_mov_b32 v16, 0
    v_mov_b32 v17, 0
    v_mov_b32 v18, 0
    v_mov_b32 v19, 0
    v_mov_b32 v20, 0
    v_mov_b32 v21, 0
    v_mov_b32 v22, 0
    v_mov_b32 v23, 0
    v_mov_b32 v24, 0
    v_mov_b32 v25, 0
    v_mov_b32 v26, 0
    v_mov_b32 v27, 0
    v_mov_b32 v28, 0
    v_mov_b32 v29, 0
    v_mov_b32 v30, 0
    v_mov_b32 v31, 0
    v_mov_b32 v32, 0
    v_mov_b32 v33, 0
    v_mov_b32 v34, 0
    v_mov_b32 v35, 0
    v_mov_b32 v36, 0
    v_mov_b32 v37, 0
    v_mov_b32 v38, 0
    v_mov_b32 v39, 0
    s_and_b32 s37, s20, 1
    v_lshrrev_b32 v7, 3, v2
    v_bfe_u32 v8, v2, 2, 1
    v_lshlrev_b32 v8, 3, v8
    v_and_b32 v9, 3, v2
    v_add_u32 v8, v8, v9
    s_lshl_b32 s37, s37, 2
    v_add_u32 v8, s37, v8
    s_lshr_b32 s44, s23, 1
    s_lshl_b32 s46, s22, 8
    s_add_u32 s46, s46, s44
    s_lshl_b32 s46, s46, 8
    s_add_u32 s46, s46, 0x850a000
    s_waitcnt vmcnt(0)
    v_mov_b32 v220, 1
    v_mov_b32 v221, 163832
    v_mov_b32 v222, 0
    s_mov_b64 exec, 1
    ds_add_rtn_u32 v223, v221, v220
    s_waitcnt lgkmcnt(0)
    v_and_b32 v223, 3, v223
    v_cmp_eq_u32 vcc, 3, v223
    s_nop 0
    s_cbranch_vccz L_sk_d5
    buffer_atomic_add v220, v222, s[4:7], s45 offen sc1
    s_mov_b32 s60, 65536
L_poll_d5:
    buffer_load_dword v223, v222, s[4:7], s46 offen sc1
    s_waitcnt vmcnt(0)
    v_cmp_gt_u32 vcc, 16, v223
    s_sub_u32 s60, s60, 1
    s_cbranch_scc1 L_pd_d5
    s_cbranch_vccz L_pd_d5
    s_sleep 4
    s_branch L_poll_d5
L_pd_d5:
L_sk_d5:
    s_mov_b64 exec, -1
    s_barrier
    s_cmp_eq_u32 s28, 0
    s_cselect_b32 s32, 4, 0
    s_lshl_b32 s32, s32, 13
    s_add_u32 s32, s32, s29
    s_add_u32 s33, s32, 4096
    buffer_load_dwordx4 v[112:115], v1, s[4:7], s32 offen offset:0 sc1
    buffer_load_dwordx4 v[116:119], v1, s[4:7], s32 offen offset:1024 sc1
    buffer_load_dwordx4 v[120:123], v1, s[4:7], s32 offen offset:2048 sc1
    buffer_load_dwordx4 v[124:127], v1, s[4:7], s32 offen offset:3072 sc1
    buffer_load_dwordx4 v[128:131], v1, s[4:7], s33 offen offset:0 sc1
    buffer_load_dwordx4 v[132:135], v1, s[4:7], s33 offen offset:1024 sc1
    buffer_load_dwordx4 v[136:139], v1, s[4:7], s33 offen offset:2048 sc1
    buffer_load_dwordx4 v[140:143], v1, s[4:7], s33 offen offset:3072 sc1
    s_cmp_eq_u32 s28, 1
    s_cselect_b32 s32, 5, 1
    s_lshl_b32 s32, s32, 13
    s_add_u32 s32, s32, s29
    s_add_u32 s33, s32, 4096
    buffer_load_dwordx4 v[144:147], v1, s[4:7], s32 offen offset:0 sc1
    buffer_load_dwordx4 v[148:151], v1, s[4:7], s32 offen offset:1024 sc1
    buffer_load_dwordx4 v[152:155], v1, s[4:7], s32 offen offset:2048 sc1
    buffer_load_dwordx4 v[156:159], v1, s[4:7], s32 offen offset:3072 sc1
    buffer_load_dwordx4 v[160:163], v1, s[4:7], s33 offen offset:0 sc1
    buffer_load_dwordx4 v[164:167], v1, s[4:7], s33 offen offset:1024 sc1
    buffer_load_dwordx4 v[168:171], v1, s[4:7], s33 offen offset:2048 sc1
    buffer_load_dwordx4 v[172:175], v1, s[4:7], s33 offen offset:3072 sc1
    ds_read_b128 v[40:43], v12 offset:0
    ds_read_b128 v[44:47], v12 offset:1024
    ds_read_b128 v[48:51], v12 offset:2048
    ds_read_b128 v[52:55], v12 offset:3072
    ds_read_b128 v[72:75], v12 offset:8192
    ds_read_b128 v[56:59], v12 offset:4096
    ds_read_b128 v[60:63], v12 offset:5120
    ds_read_b128 v[64:67], v12 offset:6144
    ds_read_b128 v[68:71], v12 offset:7168
    s_waitcnt vmcnt(14) lgkmcnt(4)
    v_mfma_f32_16x16x32_bf16 v[16:19], v[40:43], v[112:115], v[16:19]
    ds_read_b128 v[76:79], v12 offset:9216
    s_cmp_eq_u32 s28, 2
    s_cselect_b32 s32, 6, 2
    s_lshl_b32 s32, s32, 13
    s_add_u32 s32, s32, s29
    s_add_u32 s33, s32, 4096
    v_mfma_f32_16x16x32_bf16 v[20:23], v[44:47], v[112:115], v[20:23]
    ds_read_b128 v[80:83], v12 offset:10240
    v_mfma_f32_16x16x32_bf16 v[24:27], v[48:51], v[112:115], v[24:27]
    ds_read_b128 v[84:87], v12 offset:11264
    buffer_load_dwordx4 v[176:179], v1, s[4:7], s32 offen offset:0 sc1
    v_mfma_f32_16x16x32_bf16 v[28:31], v[52:55], v[112:115], v[28:31]
    ds_read_b128 v[88:91], v12 offset:12288
    v_mfma_f32_16x16x32_bf16 v[32:35], v[72:75], v[112:115], v[32:35]
    ds_read_b128 v[108:111], v12 offset:17408
    s_waitcnt lgkmcnt(5)
    v_mfma_f32_16x16x32_bf16 v[16:19], v[56:59], v[116:119], v[16:19]
    ds_read_b128 v[92:95], v12 offset:13312
    v_mfma_f32_16x16x32_bf16 v[20:23], v[60:63], v[116:119], v[20:23]
    ds_read_b128 v[96:99], v12 offset:14336
    buffer_load_dwordx4 v[180:183], v1, s[4:7], s32 offen offset:1024 sc1
    v_mfma_f32_16x16x32_bf16 v[24:27], v[64:67], v[116:119], v[24:27]
    ds_read_b128 v[100:103], v12 offset:15360
    v_mfma_f32_16x16x32_bf16 v[28:31], v[68:71], v[116:119], v[28:31]
    ds_read_b128 v[104:107], v12 offset:16384
    v_mfma_f32_16x16x32_bf16 v[36:39], v[72:75], v[116:119], v[36:39]
    s_waitcnt vmcnt(14) lgkmcnt(4)
    v_mfma_f32_16x16x32_bf16 v[16:19], v[76:79], v[120:123], v[16:19]
    ds_read_b128 v[40:43], v12 offset:18432
    v_mfma_f32_16x16x32_bf16 v[20:23], v[80:83], v[120:123], v[20:23]
    ds_read_b128 v[44:47], v12 offset:19456
    v_mfma_f32_16x16x32_bf16 v[24:27], v[84:87], v[120:123], v[24:27]
    ds_read_b128 v[48:51], v12 offset:20480
    buffer_load_dwordx4 v[184:187], v1, s[4:7], s32 offen offset:2048 sc1
    v_mfma_f32_16x16x32_bf16 v[28:31], v[88:91], v[120:123], v[28:31]
    ds_read_b128 v[52:55], v12 offset:21504
    v_mfma_f32_16x16x32_bf16 v[32:35], v[108:111], v[120:123], v[32:35]
    ds_read_b128 v[72:75], v12 offset:26624
    s_waitcnt lgkmcnt(5)
    v_mfma_f32_16x16x32_bf16 v[16:19], v[92:95], v[124:127], v[16:19]
    ds_read_b128 v[56:59], v12 offset:22528
    v_mfma_f32_16x16x32_bf16 v[20:23], v[96:99], v[124:127], v[20:23]
    ds_read_b128 v[60:63], v12 offset:23552
    buffer_load_dwordx4 v[188:191], v1, s[4:7], s32 offen offset:3072 sc1
    v_mfma_f32_16x16x32_bf16 v[24:27], v[100:103], v[124:127], v[24:27]
    ds_read_b128 v[64:67], v12 offset:24576
    v_mfma_f32_16x16x32_bf16 v[28:31], v[104:107], v[124:127], v[28:31]
    ds_read_b128 v[68:71], v12 offset:25600
    v_mfma_f32_16x16x32_bf16 v[36:39], v[108:111], v[124:127], v[36:39]
    s_waitcnt vmcnt(14) lgkmcnt(4)
    v_mfma_f32_16x16x32_bf16 v[16:19], v[40:43], v[128:131], v[16:19]
    ds_read_b128 v[76:79], v12 offset:27648
    v_mfma_f32_16x16x32_bf16 v[20:23], v[44:47], v[128:131], v[20:23]
    ds_read_b128 v[80:83], v12 offset:28672
    v_mfma_f32_16x16x32_bf16 v[24:27], v[48:51], v[128:131], v[24:27]
    ds_read_b128 v[84:87], v12 offset:29696
    buffer_load_dwordx4 v[192:195], v1, s[4:7], s33 offen offset:0 sc1
    v_mfma_f32_16x16x32_bf16 v[28:31], v[52:55], v[128:131], v[28:31]
    ds_read_b128 v[88:91], v12 offset:30720
    v_mfma_f32_16x16x32_bf16 v[32:35], v[72:75], v[128:131], v[32:35]
    ds_read_b128 v[108:111], v12 offset:35840
    s_waitcnt lgkmcnt(5)
    v_mfma_f32_16x16x32_bf16 v[16:19], v[56:59], v[132:135], v[16:19]
    ds_read_b128 v[92:95], v12 offset:31744
    v_mfma_f32_16x16x32_bf16 v[20:23], v[60:63], v[132:135], v[20:23]
    ds_read_b128 v[96:99], v12 offset:32768
    buffer_load_dwordx4 v[196:199], v1, s[4:7], s33 offen offset:1024 sc1
    v_mfma_f32_16x16x32_bf16 v[24:27], v[64:67], v[132:135], v[24:27]
    ds_read_b128 v[100:103], v12 offset:33792
    v_mfma_f32_16x16x32_bf16 v[28:31], v[68:71], v[132:135], v[28:31]
    ds_read_b128 v[104:107], v12 offset:34816
    v_mfma_f32_16x16x32_bf16 v[36:39], v[72:75], v[132:135], v[36:39]
    s_waitcnt vmcnt(14) lgkmcnt(0)
    s_barrier
    v_mfma_f32_16x16x32_bf16 v[16:19], v[76:79], v[136:139], v[16:19]
    ds_read_b128 v[40:43], v13 offset:0
    v_mfma_f32_16x16x32_bf16 v[20:23], v[80:83], v[136:139], v[20:23]
    ds_read_b128 v[44:47], v13 offset:1024
    v_mfma_f32_16x16x32_bf16 v[24:27], v[84:87], v[136:139], v[24:27]
    ds_read_b128 v[48:51], v13 offset:2048
    buffer_load_dwordx4 v[200:203], v1, s[4:7], s33 offen offset:2048 sc1
    v_mfma_f32_16x16x32_bf16 v[28:31], v[88:91], v[136:139], v[28:31]
    ds_read_b128 v[52:55], v13 offset:3072
    v_mfma_f32_16x16x32_bf16 v[32:35], v[108:111], v[136:139], v[32:35]
    ds_read_b128 v[72:75], v13 offset:8192
    v_mfma_f32_16x16x32_bf16 v[16:19], v[92:95], v[140:143], v[16:19]
    ds_read_b128 v[56:59], v13 offset:4096
    v_mfma_f32_16x16x32_bf16 v[20:23], v[96:99], v[140:143], v[20:23]
    ds_read_b128 v[60:63], v13 offset:5120
    buffer_load_dwordx4 v[204:207], v1, s[4:7], s33 offen offset:3072 sc1
    v_mfma_f32_16x16x32_bf16 v[24:27], v[100:103], v[140:143], v[24:27]
    ds_read_b128 v[64:67], v13 offset:6144
    v_mfma_f32_16x16x32_bf16 v[28:31], v[104:107], v[140:143], v[28:31]
    ds_read_b128 v[68:71], v13 offset:7168
    v_mfma_f32_16x16x32_bf16 v[36:39], v[108:111], v[140:143], v[36:39]
    s_waitcnt vmcnt(14) lgkmcnt(4)
    v_mfma_f32_16x16x32_bf16 v[16:19], v[40:43], v[144:147], v[16:19]
    ds_read_b128 v[76:79], v13 offset:9216
    s_cmp_eq_u32 s28, 3
    s_cselect_b32 s32, 7, 3
    s_lshl_b32 s32, s32, 13
    s_add_u32 s32, s32, s29
    s_add_u32 s33, s32, 4096
    v_mfma_f32_16x16x32_bf16 v[20:23], v[44:47], v[144:147], v[20:23]
    ds_read_b128 v[80:83], v13 offset:10240
    v_mfma_f32_16x16x32_bf16 v[24:27], v[48:51], v[144:147], v[24:27]
    ds_read_b128 v[84:87], v13 offset:11264
    buffer_load_dwordx4 v[112:115], v1, s[4:7], s32 offen offset:0 sc1
    v_mfma_f32_16x16x32_bf16 v[28:31], v[52:55], v[144:147], v[28:31]
    ds_read_b128 v[88:91], v13 offset:12288
    v_mfma_f32_16x16x32_bf16 v[32:35], v[72:75], v[144:147], v[32:35]
    ds_read_b128 v[108:111], v13 offset:17408
    s_waitcnt lgkmcnt(5)
    v_mfma_f32_16x16x32_bf16 v[16:19], v[56:59], v[148:151], v[16:19]
    ds_read_b128 v[92:95], v13 offset:13312
    v_mfma_f32_16x16x32_bf16 v[20:23], v[60:63], v[148:151], v[20:23]
    ds_read_b128 v[96:99], v13 offset:14336
    buffer_load_dwordx4 v[116:119], v1, s[4:7], s32 offen offset:1024 sc1
    v_mfma_f32_16x16x32_bf16 v[24:27], v[64:67], v[148:151], v[24:27]
    ds_read_b128 v[100:103], v13 offset:15360
    v_mfma_f32_16x16x32_bf16 v[28:31], v[68:71], v[148:151], v[28:31]
    ds_read_b128 v[104:107], v13 offset:16384
    v_mfma_f32_16x16x32_bf16 v[36:39], v[72:75], v[148:151], v[36:39]
    s_waitcnt vmcnt(14) lgkmcnt(4)
    v_mfma_f32_16x16x32_bf16 v[16:19], v[76:79], v[152:155], v[16:19]
    ds_read_b128 v[40:43], v13 offset:18432
    v_mfma_f32_16x16x32_bf16 v[20:23], v[80:83], v[152:155], v[20:23]
    ds_read_b128 v[44:47], v13 offset:19456
    v_mfma_f32_16x16x32_bf16 v[24:27], v[84:87], v[152:155], v[24:27]
    ds_read_b128 v[48:51], v13 offset:20480
    buffer_load_dwordx4 v[120:123], v1, s[4:7], s32 offen offset:2048 sc1
    v_mfma_f32_16x16x32_bf16 v[28:31], v[88:91], v[152:155], v[28:31]
    ds_read_b128 v[52:55], v13 offset:21504
    v_mfma_f32_16x16x32_bf16 v[32:35], v[108:111], v[152:155], v[32:35]
    ds_read_b128 v[72:75], v13 offset:26624
    s_waitcnt lgkmcnt(5)
    v_mfma_f32_16x16x32_bf16 v[16:19], v[92:95], v[156:159], v[16:19]
    ds_read_b128 v[56:59], v13 offset:22528
    v_mfma_f32_16x16x32_bf16 v[20:23], v[96:99], v[156:159], v[20:23]
    ds_read_b128 v[60:63], v13 offset:23552
    buffer_load_dwordx4 v[124:127], v1, s[4:7], s32 offen offset:3072 sc1
    v_mfma_f32_16x16x32_bf16 v[24:27], v[100:103], v[156:159], v[24:27]
    ds_read_b128 v[64:67], v13 offset:24576
    v_mfma_f32_16x16x32_bf16 v[28:31], v[104:107], v[156:159], v[28:31]
    ds_read_b128 v[68:71], v13 offset:25600
    v_mfma_f32_16x16x32_bf16 v[36:39], v[108:111], v[156:159], v[36:39]
    s_waitcnt vmcnt(14) lgkmcnt(4)
    v_mfma_f32_16x16x32_bf16 v[16:19], v[40:43], v[160:163], v[16:19]
    ds_read_b128 v[76:79], v13 offset:27648
    v_mfma_f32_16x16x32_bf16 v[20:23], v[44:47], v[160:163], v[20:23]
    ds_read_b128 v[80:83], v13 offset:28672
    v_mfma_f32_16x16x32_bf16 v[24:27], v[48:51], v[160:163], v[24:27]
    ds_read_b128 v[84:87], v13 offset:29696
    buffer_load_dwordx4 v[128:131], v1, s[4:7], s33 offen offset:0 sc1
    v_mfma_f32_16x16x32_bf16 v[28:31], v[52:55], v[160:163], v[28:31]
    ds_read_b128 v[88:91], v13 offset:30720
    v_mfma_f32_16x16x32_bf16 v[32:35], v[72:75], v[160:163], v[32:35]
    ds_read_b128 v[108:111], v13 offset:35840
    s_waitcnt lgkmcnt(5)
    v_mfma_f32_16x16x32_bf16 v[16:19], v[56:59], v[164:167], v[16:19]
    ds_read_b128 v[92:95], v13 offset:31744
    v_mfma_f32_16x16x32_bf16 v[20:23], v[60:63], v[164:167], v[20:23]
    ds_read_b128 v[96:99], v13 offset:32768
    buffer_load_dwordx4 v[132:135], v1, s[4:7], s33 offen offset:1024 sc1
    v_mfma_f32_16x16x32_bf16 v[24:27], v[64:67], v[164:167], v[24:27]
    ds_read_b128 v[100:103], v13 offset:33792
    v_mfma_f32_16x16x32_bf16 v[28:31], v[68:71], v[164:167], v[28:31]
    ds_read_b128 v[104:107], v13 offset:34816
    v_mfma_f32_16x16x32_bf16 v[36:39], v[72:75], v[164:167], v[36:39]
    s_waitcnt vmcnt(14) lgkmcnt(0)
    s_barrier
    v_mfma_f32_16x16x32_bf16 v[16:19], v[76:79], v[168:171], v[16:19]
    ds_read_b128 v[40:43], v14 offset:0
    v_mfma_f32_16x16x32_bf16 v[20:23], v[80:83], v[168:171], v[20:23]
    ds_read_b128 v[44:47], v14 offset:1024
    v_mfma_f32_16x16x32_bf16 v[24:27], v[84:87], v[168:171], v[24:27]
    ds_read_b128 v[48:51], v14 offset:2048
    buffer_load_dwordx4 v[136:139], v1, s[4:7], s33 offen offset:2048 sc1
    v_mfma_f32_16x16x32_bf16 v[28:31], v[88:91], v[168:171], v[28:31]
    ds_read_b128 v[52:55], v14 offset:3072
    v_mfma_f32_16x16x32_bf16 v[32:35], v[108:111], v[168:171], v[32:35]
    ds_read_b128 v[72:75], v14 offset:8192
    v_mfma_f32_16x16x32_bf16 v[16:19], v[92:95], v[172:175], v[16:19]
    ds_read_b128 v[56:59], v14 offset:4096
    v_mfma_f32_16x16x32_bf16 v[20:23], v[96:99], v[172:175], v[20:23]
    ds_read_b128 v[60:63], v14 offset:5120
    buffer_load_dwordx4 v[140:143], v1, s[4:7], s33 offen offset:3072 sc1
    v_mfma_f32_16x16x32_bf16 v[24:27], v[100:103], v[172:175], v[24:27]
    ds_read_b128 v[64:67], v14 offset:6144
    v_mfma_f32_16x16x32_bf16 v[28:31], v[104:107], v[172:175], v[28:31]
    ds_read_b128 v[68:71], v14 offset:7168
    v_mfma_f32_16x16x32_bf16 v[36:39], v[108:111], v[172:175], v[36:39]
    s_waitcnt vmcnt(14) lgkmcnt(4)
    v_mfma_f32_16x16x32_bf16 v[16:19], v[40:43], v[176:179], v[16:19]
    ds_read_b128 v[76:79], v14 offset:9216
    s_cmp_eq_u32 s28, 0
    s_cselect_b32 s32, 8, 4
    s_lshl_b32 s32, s32, 13
    s_add_u32 s32, s32, s29
    s_add_u32 s33, s32, 4096
    v_mfma_f32_16x16x32_bf16 v[20:23], v[44:47], v[176:179], v[20:23]
    ds_read_b128 v[80:83], v14 offset:10240
    v_mfma_f32_16x16x32_bf16 v[24:27], v[48:51], v[176:179], v[24:27]
    ds_read_b128 v[84:87], v14 offset:11264
    buffer_load_dwordx4 v[144:147], v1, s[4:7], s32 offen offset:0 sc1
    v_mfma_f32_16x16x32_bf16 v[28:31], v[52:55], v[176:179], v[28:31]
    ds_read_b128 v[88:91], v14 offset:12288
    v_mfma_f32_16x16x32_bf16 v[32:35], v[72:75], v[176:179], v[32:35]
    ds_read_b128 v[108:111], v14 offset:17408
    s_waitcnt lgkmcnt(5)
    v_mfma_f32_16x16x32_bf16 v[16:19], v[56:59], v[180:183], v[16:19]
    ds_read_b128 v[92:95], v14 offset:13312
    v_mfma_f32_16x16x32_bf16 v[20:23], v[60:63], v[180:183], v[20:23]
    ds_read_b128 v[96:99], v14 offset:14336
    buffer_load_dwordx4 v[148:151], v1, s[4:7], s32 offen offset:1024 sc1
    v_mfma_f32_16x16x32_bf16 v[24:27], v[64:67], v[180:183], v[24:27]
    ds_read_b128 v[100:103], v14 offset:15360
    v_mfma_f32_16x16x32_bf16 v[28:31], v[68:71], v[180:183], v[28:31]
    ds_read_b128 v[104:107], v14 offset:16384
    v_mfma_f32_16x16x32_bf16 v[36:39], v[72:75], v[180:183], v[36:39]
    s_waitcnt vmcnt(14) lgkmcnt(4)
    v_mfma_f32_16x16x32_bf16 v[16:19], v[76:79], v[184:187], v[16:19]
    ds_read_b128 v[40:43], v14 offset:18432
    v_mfma_f32_16x16x32_bf16 v[20:23], v[80:83], v[184:187], v[20:23]
    ds_read_b128 v[44:47], v14 offset:19456
    v_mfma_f32_16x16x32_bf16 v[24:27], v[84:87], v[184:187], v[24:27]
    ds_read_b128 v[48:51], v14 offset:20480
    buffer_load_dwordx4 v[152:155], v1, s[4:7], s32 offen offset:2048 sc1
    v_mfma_f32_16x16x32_bf16 v[28:31], v[88:91], v[184:187], v[28:31]
    ds_read_b128 v[52:55], v14 offset:21504
    v_mfma_f32_16x16x32_bf16 v[32:35], v[108:111], v[184:187], v[32:35]
    ds_read_b128 v[72:75], v14 offset:26624
    s_waitcnt lgkmcnt(5)
    v_mfma_f32_16x16x32_bf16 v[16:19], v[92:95], v[188:191], v[16:19]
    ds_read_b128 v[56:59], v14 offset:22528
    v_mfma_f32_16x16x32_bf16 v[20:23], v[96:99], v[188:191], v[20:23]
    ds_read_b128 v[60:63], v14 offset:23552
    buffer_load_dwordx4 v[156:159], v1, s[4:7], s32 offen offset:3072 sc1
    v_mfma_f32_16x16x32_bf16 v[24:27], v[100:103], v[188:191], v[24:27]
    ds_read_b128 v[64:67], v14 offset:24576
    v_mfma_f32_16x16x32_bf16 v[28:31], v[104:107], v[188:191], v[28:31]
    ds_read_b128 v[68:71], v14 offset:25600
    v_mfma_f32_16x16x32_bf16 v[36:39], v[108:111], v[188:191], v[36:39]
    s_waitcnt vmcnt(14) lgkmcnt(4)
    v_mfma_f32_16x16x32_bf16 v[16:19], v[40:43], v[192:195], v[16:19]
    ds_read_b128 v[76:79], v14 offset:27648
    v_mfma_f32_16x16x32_bf16 v[20:23], v[44:47], v[192:195], v[20:23]
    ds_read_b128 v[80:83], v14 offset:28672
    v_mfma_f32_16x16x32_bf16 v[24:27], v[48:51], v[192:195], v[24:27]
    ds_read_b128 v[84:87], v14 offset:29696
    buffer_load_dwordx4 v[160:163], v1, s[4:7], s33 offen offset:0 sc1
    v_mfma_f32_16x16x32_bf16 v[28:31], v[52:55], v[192:195], v[28:31]
    ds_read_b128 v[88:91], v14 offset:30720
    v_mfma_f32_16x16x32_bf16 v[32:35], v[72:75], v[192:195], v[32:35]
    ds_read_b128 v[108:111], v14 offset:35840
    s_waitcnt lgkmcnt(5)
    v_mfma_f32_16x16x32_bf16 v[16:19], v[56:59], v[196:199], v[16:19]
    ds_read_b128 v[92:95], v14 offset:31744
    v_mfma_f32_16x16x32_bf16 v[20:23], v[60:63], v[196:199], v[20:23]
    ds_read_b128 v[96:99], v14 offset:32768
    buffer_load_dwordx4 v[164:167], v1, s[4:7], s33 offen offset:1024 sc1
    v_mfma_f32_16x16x32_bf16 v[24:27], v[64:67], v[196:199], v[24:27]
    ds_read_b128 v[100:103], v14 offset:33792
    v_mfma_f32_16x16x32_bf16 v[28:31], v[68:71], v[196:199], v[28:31]
    ds_read_b128 v[104:107], v14 offset:34816
    v_mfma_f32_16x16x32_bf16 v[36:39], v[72:75], v[196:199], v[36:39]
    s_waitcnt vmcnt(14) lgkmcnt(0)
    s_barrier
    v_mfma_f32_16x16x32_bf16 v[16:19], v[76:79], v[200:203], v[16:19]
    ds_read_b128 v[40:43], v15 offset:0
    v_mfma_f32_16x16x32_bf16 v[20:23], v[80:83], v[200:203], v[20:23]
    ds_read_b128 v[44:47], v15 offset:1024
    v_mfma_f32_16x16x32_bf16 v[24:27], v[84:87], v[200:203], v[24:27]
    ds_read_b128 v[48:51], v15 offset:2048
    buffer_load_dwordx4 v[168:171], v1, s[4:7], s33 offen offset:2048 sc1
    v_mfma_f32_16x16x32_bf16 v[28:31], v[88:91], v[200:203], v[28:31]
    ds_read_b128 v[52:55], v15 offset:3072
    v_mfma_f32_16x16x32_bf16 v[32:35], v[108:111], v[200:203], v[32:35]
    ds_read_b128 v[72:75], v15 offset:8192
    v_mfma_f32_16x16x32_bf16 v[16:19], v[92:95], v[204:207], v[16:19]
    ds_read_b128 v[56:59], v15 offset:4096
    v_mfma_f32_16x16x32_bf16 v[20:23], v[96:99], v[204:207], v[20:23]
    ds_read_b128 v[60:63], v15 offset:5120
    buffer_load_dwordx4 v[172:175], v1, s[4:7], s33 offen offset:3072 sc1
    v_mfma_f32_16x16x32_bf16 v[24:27], v[100:103], v[204:207], v[24:27]
    ds_read_b128 v[64:67], v15 offset:6144
    v_mfma_f32_16x16x32_bf16 v[28:31], v[104:107], v[204:207], v[28:31]
    ds_read_b128 v[68:71], v15 offset:7168
    v_mfma_f32_16x16x32_bf16 v[36:39], v[108:111], v[204:207], v[36:39]
    s_waitcnt vmcnt(14) lgkmcnt(4)
    v_mfma_f32_16x16x32_bf16 v[16:19], v[40:43], v[112:115], v[16:19]
    ds_read_b128 v[76:79], v15 offset:9216
    s_cmp_eq_u32 s28, 1
    s_cselect_b32 s32, 1, 5
    s_lshl_b32 s32, s32, 13
    s_add_u32 s32, s32, s29
    s_add_u32 s33, s32, 4096
    v_mfma_f32_16x16x32_bf16 v[20:23], v[44:47], v[112:115], v[20:23]
    ds_read_b128 v[80:83], v15 offset:10240
    v_mfma_f32_16x16x32_bf16 v[24:27], v[48:51], v[112:115], v[24:27]
    ds_read_b128 v[84:87], v15 offset:11264
    buffer_load_dwordx4 v[176:179], v1, s[4:7], s32 offen offset:0 sc1
    v_mfma_f32_16x16x32_bf16 v[28:31], v[52:55], v[112:115], v[28:31]
    ds_read_b128 v[88:91], v15 offset:12288
    v_mfma_f32_16x16x32_bf16 v[32:35], v[72:75], v[112:115], v[32:35]
    ds_read_b128 v[108:111], v15 offset:17408
    s_waitcnt lgkmcnt(5)
    v_mfma_f32_16x16x32_bf16 v[16:19], v[56:59], v[116:119], v[16:19]
    ds_read_b128 v[92:95], v15 offset:13312
    v_mfma_f32_16x16x32_bf16 v[20:23], v[60:63], v[116:119], v[20:23]
    ds_read_b128 v[96:99], v15 offset:14336
    buffer_load_dwordx4 v[180:183], v1, s[4:7], s32 offen offset:1024 sc1
    v_mfma_f32_16x16x32_bf16 v[24:27], v[64:67], v[116:119], v[24:27]
    ds_read_b128 v[100:103], v15 offset:15360
    v_mfma_f32_16x16x32_bf16 v[28:31], v[68:71], v[116:119], v[28:31]
    ds_read_b128 v[104:107], v15 offset:16384
    v_mfma_f32_16x16x32_bf16 v[36:39], v[72:75], v[116:119], v[36:39]
    s_waitcnt vmcnt(14) lgkmcnt(4)
    v_mfma_f32_16x16x32_bf16 v[16:19], v[76:79], v[120:123], v[16:19]
    ds_read_b128 v[40:43], v15 offset:18432
    v_mfma_f32_16x16x32_bf16 v[20:23], v[80:83], v[120:123], v[20:23]
    ds_read_b128 v[44:47], v15 offset:19456
    v_mfma_f32_16x16x32_bf16 v[24:27], v[84:87], v[120:123], v[24:27]
    ds_read_b128 v[48:51], v15 offset:20480
    buffer_load_dwordx4 v[184:187], v1, s[4:7], s32 offen offset:2048 sc1
    v_mfma_f32_16x16x32_bf16 v[28:31], v[88:91], v[120:123], v[28:31]
    ds_read_b128 v[52:55], v15 offset:21504
    v_mfma_f32_16x16x32_bf16 v[32:35], v[108:111], v[120:123], v[32:35]
    ds_read_b128 v[72:75], v15 offset:26624
    s_waitcnt lgkmcnt(5)
    v_mfma_f32_16x16x32_bf16 v[16:19], v[92:95], v[124:127], v[16:19]
    ds_read_b128 v[56:59], v15 offset:22528
    v_mfma_f32_16x16x32_bf16 v[20:23], v[96:99], v[124:127], v[20:23]
    ds_read_b128 v[60:63], v15 offset:23552
    buffer_load_dwordx4 v[188:191], v1, s[4:7], s32 offen offset:3072 sc1
    v_mfma_f32_16x16x32_bf16 v[24:27], v[100:103], v[124:127], v[24:27]
    ds_read_b128 v[64:67], v15 offset:24576
    v_mfma_f32_16x16x32_bf16 v[28:31], v[104:107], v[124:127], v[28:31]
    ds_read_b128 v[68:71], v15 offset:25600
    v_mfma_f32_16x16x32_bf16 v[36:39], v[108:111], v[124:127], v[36:39]
    s_waitcnt vmcnt(14) lgkmcnt(4)
    v_mfma_f32_16x16x32_bf16 v[16:19], v[40:43], v[128:131], v[16:19]
    ds_read_b128 v[76:79], v15 offset:27648
    v_mfma_f32_16x16x32_bf16 v[20:23], v[44:47], v[128:131], v[20:23]
    ds_read_b128 v[80:83], v15 offset:28672
    v_mfma_f32_16x16x32_bf16 v[24:27], v[48:51], v[128:131], v[24:27]
    ds_read_b128 v[84:87], v15 offset:29696
    buffer_load_dwordx4 v[192:195], v1, s[4:7], s33 offen offset:0 sc1
    v_mfma_f32_16x16x32_bf16 v[28:31], v[52:55], v[128:131], v[28:31]
    ds_read_b128 v[88:91], v15 offset:30720
    v_mfma_f32_16x16x32_bf16 v[32:35], v[72:75], v[128:131], v[32:35]
    ds_read_b128 v[108:111], v15 offset:35840
    s_waitcnt lgkmcnt(5)
    v_mfma_f32_16x16x32_bf16 v[16:19], v[56:59], v[132:135], v[16:19]
    ds_read_b128 v[92:95], v15 offset:31744
    v_mfma_f32_16x16x32_bf16 v[20:23], v[60:63], v[132:135], v[20:23]
    ds_read_b128 v[96:99], v15 offset:32768
    buffer_load_dwordx4 v[196:199], v1, s[4:7], s33 offen offset:1024 sc1
    v_mfma_f32_16x16x32_bf16 v[24:27], v[64:67], v[132:135], v[24:27]
    ds_read_b128 v[100:103], v15 offset:33792
    v_mfma_f32_16x16x32_bf16 v[28:31], v[68:71], v[132:135], v[28:31]
    ds_read_b128 v[104:107], v15 offset:34816
    v_mfma_f32_16x16x32_bf16 v[36:39], v[72:75], v[132:135], v[36:39]
    s_waitcnt vmcnt(14) lgkmcnt(0)
    s_barrier
    v_mfma_f32_16x16x32_bf16 v[16:19], v[76:79], v[136:139], v[16:19]
    ds_read_b128 v[40:43], v12 offset:0
    v_mfma_f32_16x16x32_bf16 v[20:23], v[80:83], v[136:139], v[20:23]
    ds_read_b128 v[44:47], v12 offset:1024
    v_mfma_f32_16x16x32_bf16 v[24:27], v[84:87], v[136:139], v[24:27]
    ds_read_b128 v[48:51], v12 offset:2048
    buffer_load_dwordx4 v[200:203], v1, s[4:7], s33 offen offset:2048 sc1
    v_mfma_f32_16x16x32_bf16 v[28:31], v[88:91], v[136:139], v[28:31]
    ds_read_b128 v[52:55], v12 offset:3072
    v_mfma_f32_16x16x32_bf16 v[32:35], v[108:111], v[136:139], v[32:35]
    ds_read_b128 v[72:75], v12 offset:8192
    v_mfma_f32_16x16x32_bf16 v[16:19], v[92:95], v[140:143], v[16:19]
    ds_read_b128 v[56:59], v12 offset:4096
    v_mfma_f32_16x16x32_bf16 v[20:23], v[96:99], v[140:143], v[20:23]
    ds_read_b128 v[60:63], v12 offset:5120
    buffer_load_dwordx4 v[204:207], v1, s[4:7], s33 offen offset:3072 sc1
    v_mfma_f32_16x16x32_bf16 v[24:27], v[100:103], v[140:143], v[24:27]
    ds_read_b128 v[64:67], v12 offset:6144
    v_mfma_f32_16x16x32_bf16 v[28:31], v[104:107], v[140:143], v[28:31]
    ds_read_b128 v[68:71], v12 offset:7168
    v_mfma_f32_16x16x32_bf16 v[36:39], v[108:111], v[140:143], v[36:39]
    s_waitcnt vmcnt(14) lgkmcnt(4)
    v_mfma_f32_16x16x32_bf16 v[16:19], v[40:43], v[144:147], v[16:19]
    ds_read_b128 v[76:79], v12 offset:9216
    s_cmp_eq_u32 s28, 2
    s_cselect_b32 s32, 2, 6
    s_lshl_b32 s32, s32, 13
    s_add_u32 s32, s32, s29
    s_add_u32 s33, s32, 4096
    v_mfma_f32_16x16x32_bf16 v[20:23], v[44:47], v[144:147], v[20:23]
    ds_read_b128 v[80:83], v12 offset:10240
    v_mfma_f32_16x16x32_bf16 v[24:27], v[48:51], v[144:147], v[24:27]
    ds_read_b128 v[84:87], v12 offset:11264
    buffer_load_dwordx4 v[112:115], v1, s[4:7], s32 offen offset:0 sc1
    v_mfma_f32_16x16x32_bf16 v[28:31], v[52:55], v[144:147], v[28:31]
    ds_read_b128 v[88:91], v12 offset:12288
    v_mfma_f32_16x16x32_bf16 v[32:35], v[72:75], v[144:147], v[32:35]
    ds_read_b128 v[108:111], v12 offset:17408
    s_waitcnt lgkmcnt(5)
    v_mfma_f32_16x16x32_bf16 v[16:19], v[56:59], v[148:151], v[16:19]
    ds_read_b128 v[92:95], v12 offset:13312
    v_mfma_f32_16x16x32_bf16 v[20:23], v[60:63], v[148:151], v[20:23]
    ds_read_b128 v[96:99], v12 offset:14336
    buffer_load_dwordx4 v[116:119], v1, s[4:7], s32 offen offset:1024 sc1
    v_mfma_f32_16x16x32_bf16 v[24:27], v[64:67], v[148:151], v[24:27]
    ds_read_b128 v[100:103], v12 offset:15360
    v_mfma_f32_16x16x32_bf16 v[28:31], v[68:71], v[148:151], v[28:31]
    ds_read_b128 v[104:107], v12 offset:16384
    v_mfma_f32_16x16x32_bf16 v[36:39], v[72:75], v[148:151], v[36:39]
    s_waitcnt vmcnt(14) lgkmcnt(4)
    v_mfma_f32_16x16x32_bf16 v[16:19], v[76:79], v[152:155], v[16:19]
    ds_read_b128 v[40:43], v12 offset:18432
    v_mfma_f32_16x16x32_bf16 v[20:23], v[80:83], v[152:155], v[20:23]
    ds_read_b128 v[44:47], v12 offset:19456
    v_mfma_f32_16x16x32_bf16 v[24:27], v[84:87], v[152:155], v[24:27]
    ds_read_b128 v[48:51], v12 offset:20480
    buffer_load_dwordx4 v[120:123], v1, s[4:7], s32 offen offset:2048 sc1
    v_mfma_f32_16x16x32_bf16 v[28:31], v[88:91], v[152:155], v[28:31]
    ds_read_b128 v[52:55], v12 offset:21504
    v_mfma_f32_16x16x32_bf16 v[32:35], v[108:111], v[152:155], v[32:35]
    ds_read_b128 v[72:75], v12 offset:26624
    s_waitcnt lgkmcnt(5)
    v_mfma_f32_16x16x32_bf16 v[16:19], v[92:95], v[156:159], v[16:19]
    ds_read_b128 v[56:59], v12 offset:22528
    v_mfma_f32_16x16x32_bf16 v[20:23], v[96:99], v[156:159], v[20:23]
    ds_read_b128 v[60:63], v12 offset:23552
    buffer_load_dwordx4 v[124:127], v1, s[4:7], s32 offen offset:3072 sc1
    v_mfma_f32_16x16x32_bf16 v[24:27], v[100:103], v[156:159], v[24:27]
    ds_read_b128 v[64:67], v12 offset:24576
    v_mfma_f32_16x16x32_bf16 v[28:31], v[104:107], v[156:159], v[28:31]
    ds_read_b128 v[68:71], v12 offset:25600
    v_mfma_f32_16x16x32_bf16 v[36:39], v[108:111], v[156:159], v[36:39]
    s_waitcnt vmcnt(14) lgkmcnt(4)
    v_mfma_f32_16x16x32_bf16 v[16:19], v[40:43], v[160:163], v[16:19]
    ds_read_b128 v[76:79], v12 offset:27648
    v_mfma_f32_16x16x32_bf16 v[20:23], v[44:47], v[160:163], v[20:23]
    ds_read_b128 v[80:83], v12 offset:28672
    v_mfma_f32_16x16x32_bf16 v[24:27], v[48:51], v[160:163], v[24:27]
    ds_read_b128 v[84:87], v12 offset:29696
    buffer_load_dwordx4 v[128:131], v1, s[4:7], s33 offen offset:0 sc1
    v_mfma_f32_16x16x32_bf16 v[28:31], v[52:55], v[160:163], v[28:31]
    ds_read_b128 v[88:91], v12 offset:30720
    v_mfma_f32_16x16x32_bf16 v[32:35], v[72:75], v[160:163], v[32:35]
    ds_read_b128 v[108:111], v12 offset:35840
    s_waitcnt lgkmcnt(5)
    v_mfma_f32_16x16x32_bf16 v[16:19], v[56:59], v[164:167], v[16:19]
    ds_read_b128 v[92:95], v12 offset:31744
    v_mfma_f32_16x16x32_bf16 v[20:23], v[60:63], v[164:167], v[20:23]
    ds_read_b128 v[96:99], v12 offset:32768
    buffer_load_dwordx4 v[132:135], v1, s[4:7], s33 offen offset:1024 sc1
    v_mfma_f32_16x16x32_bf16 v[24:27], v[64:67], v[164:167], v[24:27]
    ds_read_b128 v[100:103], v12 offset:33792
    v_mfma_f32_16x16x32_bf16 v[28:31], v[68:71], v[164:167], v[28:31]
    ds_read_b128 v[104:107], v12 offset:34816
    v_mfma_f32_16x16x32_bf16 v[36:39], v[72:75], v[164:167], v[36:39]
    s_waitcnt vmcnt(14) lgkmcnt(0)
    s_barrier
    v_mfma_f32_16x16x32_bf16 v[16:19], v[76:79], v[168:171], v[16:19]
    ds_read_b128 v[40:43], v13 offset:0
    v_mfma_f32_16x16x32_bf16 v[20:23], v[80:83], v[168:171], v[20:23]
    ds_read_b128 v[44:47], v13 offset:1024
    v_mfma_f32_16x16x32_bf16 v[24:27], v[84:87], v[168:171], v[24:27]
    ds_read_b128 v[48:51], v13 offset:2048
    buffer_load_dwordx4 v[136:139], v1, s[4:7], s33 offen offset:2048 sc1
    v_mfma_f32_16x16x32_bf16 v[28:31], v[88:91], v[168:171], v[28:31]
    ds_read_b128 v[52:55], v13 offset:3072
    v_mfma_f32_16x16x32_bf16 v[32:35], v[108:111], v[168:171], v[32:35]
    ds_read_b128 v[72:75], v13 offset:8192
    v_mfma_f32_16x16x32_bf16 v[16:19], v[92:95], v[172:175], v[16:19]
    ds_read_b128 v[56:59], v13 offset:4096
    v_mfma_f32_16x16x32_bf16 v[20:23], v[96:99], v[172:175], v[20:23]
    ds_read_b128 v[60:63], v13 offset:5120
    buffer_load_dwordx4 v[140:143], v1, s[4:7], s33 offen offset:3072 sc1
    v_mfma_f32_16x16x32_bf16 v[24:27], v[100:103], v[172:175], v[24:27]
    ds_read_b128 v[64:67], v13 offset:6144
    v_mfma_f32_16x16x32_bf16 v[28:31], v[104:107], v[172:175], v[28:31]
    ds_read_b128 v[68:71], v13 offset:7168
    v_mfma_f32_16x16x32_bf16 v[36:39], v[108:111], v[172:175], v[36:39]
    s_waitcnt vmcnt(14) lgkmcnt(4)
    v_mfma_f32_16x16x32_bf16 v[16:19], v[40:43], v[176:179], v[16:19]
    ds_read_b128 v[76:79], v13 offset:9216
    s_cmp_eq_u32 s28, 3
    s_cselect_b32 s32, 3, 7
    s_lshl_b32 s32, s32, 13
    s_add_u32 s32, s32, s29
    s_add_u32 s33, s32, 4096
    v_mfma_f32_16x16x32_bf16 v[20:23], v[44:47], v[176:179], v[20:23]
    ds_read_b128 v[80:83], v13 offset:10240
    v_mfma_f32_16x16x32_bf16 v[24:27], v[48:51], v[176:179], v[24:27]
    ds_read_b128 v[84:87], v13 offset:11264
    buffer_load_dwordx4 v[144:147], v1, s[4:7], s32 offen offset:0 sc1
    v_mfma_f32_16x16x32_bf16 v[28:31], v[52:55], v[176:179], v[28:31]
    ds_read_b128 v[88:91], v13 offset:12288
    v_mfma_f32_16x16x32_bf16 v[32:35], v[72:75], v[176:179], v[32:35]
    ds_read_b128 v[108:111], v13 offset:17408
    s_waitcnt lgkmcnt(5)
    v_mfma_f32_16x16x32_bf16 v[16:19], v[56:59], v[180:183], v[16:19]
    ds_read_b128 v[92:95], v13 offset:13312
    v_mfma_f32_16x16x32_bf16 v[20:23], v[60:63], v[180:183], v[20:23]
    ds_read_b128 v[96:99], v13 offset:14336
    buffer_load_dwordx4 v[148:151], v1, s[4:7], s32 offen offset:1024 sc1
    v_mfma_f32_16x16x32_bf16 v[24:27], v[64:67], v[180:183], v[24:27]
    ds_read_b128 v[100:103], v13 offset:15360
    v_mfma_f32_16x16x32_bf16 v[28:31], v[68:71], v[180:183], v[28:31]
    ds_read_b128 v[104:107], v13 offset:16384
    v_mfma_f32_16x16x32_bf16 v[36:39], v[72:75], v[180:183], v[36:39]
    s_waitcnt vmcnt(14) lgkmcnt(4)
    v_mfma_f32_16x16x32_bf16 v[16:19], v[76:79], v[184:187], v[16:19]
    ds_read_b128 v[40:43], v13 offset:18432
    v_mfma_f32_16x16x32_bf16 v[20:23], v[80:83], v[184:187], v[20:23]
    ds_read_b128 v[44:47], v13 offset:19456
    v_mfma_f32_16x16x32_bf16 v[24:27], v[84:87], v[184:187], v[24:27]
    ds_read_b128 v[48:51], v13 offset:20480
    buffer_load_dwordx4 v[152:155], v1, s[4:7], s32 offen offset:2048 sc1
    v_mfma_f32_16x16x32_bf16 v[28:31], v[88:91], v[184:187], v[28:31]
    ds_read_b128 v[52:55], v13 offset:21504
    v_mfma_f32_16x16x32_bf16 v[32:35], v[108:111], v[184:187], v[32:35]
    ds_read_b128 v[72:75], v13 offset:26624
    s_waitcnt lgkmcnt(5)
    v_mfma_f32_16x16x32_bf16 v[16:19], v[92:95], v[188:191], v[16:19]
    ds_read_b128 v[56:59], v13 offset:22528
    v_mfma_f32_16x16x32_bf16 v[20:23], v[96:99], v[188:191], v[20:23]
    ds_read_b128 v[60:63], v13 offset:23552
    buffer_load_dwordx4 v[156:159], v1, s[4:7], s32 offen offset:3072 sc1
    v_mfma_f32_16x16x32_bf16 v[24:27], v[100:103], v[188:191], v[24:27]
    ds_read_b128 v[64:67], v13 offset:24576
    v_mfma_f32_16x16x32_bf16 v[28:31], v[104:107], v[188:191], v[28:31]
    ds_read_b128 v[68:71], v13 offset:25600
    v_mfma_f32_16x16x32_bf16 v[36:39], v[108:111], v[188:191], v[36:39]
    s_waitcnt vmcnt(14) lgkmcnt(4)
    v_mfma_f32_16x16x32_bf16 v[16:19], v[40:43], v[192:195], v[16:19]
    ds_read_b128 v[76:79], v13 offset:27648
    v_mfma_f32_16x16x32_bf16 v[20:23], v[44:47], v[192:195], v[20:23]
    ds_read_b128 v[80:83], v13 offset:28672
    v_mfma_f32_16x16x32_bf16 v[24:27], v[48:51], v[192:195], v[24:27]
    ds_read_b128 v[84:87], v13 offset:29696
    buffer_load_dwordx4 v[160:163], v1, s[4:7], s33 offen offset:0 sc1
    v_mfma_f32_16x16x32_bf16 v[28:31], v[52:55], v[192:195], v[28:31]
    ds_read_b128 v[88:91], v13 offset:30720
    v_mfma_f32_16x16x32_bf16 v[32:35], v[72:75], v[192:195], v[32:35]
    ds_read_b128 v[108:111], v13 offset:35840
    s_waitcnt lgkmcnt(5)
    v_mfma_f32_16x16x32_bf16 v[16:19], v[56:59], v[196:199], v[16:19]
    ds_read_b128 v[92:95], v13 offset:31744
    v_mfma_f32_16x16x32_bf16 v[20:23], v[60:63], v[196:199], v[20:23]
    ds_read_b128 v[96:99], v13 offset:32768
    buffer_load_dwordx4 v[164:167], v1, s[4:7], s33 offen offset:1024 sc1
    v_mfma_f32_16x16x32_bf16 v[24:27], v[64:67], v[196:199], v[24:27]
    ds_read_b128 v[100:103], v13 offset:33792
    v_mfma_f32_16x16x32_bf16 v[28:31], v[68:71], v[196:199], v[28:31]
    ds_read_b128 v[104:107], v13 offset:34816
    v_mfma_f32_16x16x32_bf16 v[36:39], v[72:75], v[196:199], v[36:39]
    s_waitcnt vmcnt(14) lgkmcnt(0)
    s_barrier
    v_mfma_f32_16x16x32_bf16 v[16:19], v[76:79], v[200:203], v[16:19]
    ds_read_b128 v[40:43], v14 offset:0
    v_mfma_f32_16x16x32_bf16 v[20:23], v[80:83], v[200:203], v[20:23]
    ds_read_b128 v[44:47], v14 offset:1024
    v_mfma_f32_16x16x32_bf16 v[24:27], v[84:87], v[200:203], v[24:27]
    ds_read_b128 v[48:51], v14 offset:2048
    buffer_load_dwordx4 v[168:171], v1, s[4:7], s33 offen offset:2048 sc1
    v_mfma_f32_16x16x32_bf16 v[28:31], v[88:91], v[200:203], v[28:31]
    ds_read_b128 v[52:55], v14 offset:3072
    v_mfma_f32_16x16x32_bf16 v[32:35], v[108:111], v[200:203], v[32:35]
    ds_read_b128 v[72:75], v14 offset:8192
    v_mfma_f32_16x16x32_bf16 v[16:19], v[92:95], v[204:207], v[16:19]
    ds_read_b128 v[56:59], v14 offset:4096
    v_mfma_f32_16x16x32_bf16 v[20:23], v[96:99], v[204:207], v[20:23]
    ds_read_b128 v[60:63], v14 offset:5120
    buffer_load_dwordx4 v[172:175], v1, s[4:7], s33 offen offset:3072 sc1
    v_mfma_f32_16x16x32_bf16 v[24:27], v[100:103], v[204:207], v[24:27]
    ds_read_b128 v[64:67], v14 offset:6144
    v_mfma_f32_16x16x32_bf16 v[28:31], v[104:107], v[204:207], v[28:31]
    ds_read_b128 v[68:71], v14 offset:7168
    v_mfma_f32_16x16x32_bf16 v[36:39], v[108:111], v[204:207], v[36:39]
    s_waitcnt vmcnt(14) lgkmcnt(4)
    v_mfma_f32_16x16x32_bf16 v[16:19], v[40:43], v[112:115], v[16:19]
    ds_read_b128 v[76:79], v14 offset:9216
    s_cmp_eq_u32 s28, 0
    s_cselect_b32 s32, 0, 8
    s_lshl_b32 s32, s32, 13
    s_add_u32 s32, s32, s29
    s_add_u32 s33, s32, 4096
    v_mfma_f32_16x16x32_bf16 v[20:23], v[44:47], v[112:115], v[20:23]
    ds_read_b128 v[80:83], v14 offset:10240
    v_mfma_f32_16x16x32_bf16 v[24:27], v[48:51], v[112:115], v[24:27]
    ds_read_b128 v[84:87], v14 offset:11264
    buffer_load_dwordx4 v[176:179], v1, s[4:7], s32 offen offset:0 sc1
    v_mfma_f32_16x16x32_bf16 v[28:31], v[52:55], v[112:115], v[28:31]
    ds_read_b128 v[88:91], v14 offset:12288
    v_mfma_f32_16x16x32_bf16 v[32:35], v[72:75], v[112:115], v[32:35]
    ds_read_b128 v[108:111], v14 offset:17408
    s_waitcnt lgkmcnt(5)
    v_mfma_f32_16x16x32_bf16 v[16:19], v[56:59], v[116:119], v[16:19]
    ds_read_b128 v[92:95], v14 offset:13312
    v_mfma_f32_16x16x32_bf16 v[20:23], v[60:63], v[116:119], v[20:23]
    ds_read_b128 v[96:99], v14 offset:14336
    buffer_load_dwordx4 v[180:183], v1, s[4:7], s32 offen offset:1024 sc1
    v_mfma_f32_16x16x32_bf16 v[24:27], v[64:67], v[116:119], v[24:27]
    ds_read_b128 v[100:103], v14 offset:15360
    v_mfma_f32_16x16x32_bf16 v[28:31], v[68:71], v[116:119], v[28:31]
    ds_read_b128 v[104:107], v14 offset:16384
    v_mfma_f32_16x16x32_bf16 v[36:39], v[72:75], v[116:119], v[36:39]
    s_waitcnt vmcnt(14) lgkmcnt(4)
    v_mfma_f32_16x16x32_bf16 v[16:19], v[76:79], v[120:123], v[16:19]
    ds_read_b128 v[40:43], v14 offset:18432
    v_mfma_f32_16x16x32_bf16 v[20:23], v[80:83], v[120:123], v[20:23]
    ds_read_b128 v[44:47], v14 offset:19456
    v_mfma_f32_16x16x32_bf16 v[24:27], v[84:87], v[120:123], v[24:27]
    ds_read_b128 v[48:51], v14 offset:20480
    buffer_load_dwordx4 v[184:187], v1, s[4:7], s32 offen offset:2048 sc1
    v_mfma_f32_16x16x32_bf16 v[28:31], v[88:91], v[120:123], v[28:31]
    ds_read_b128 v[52:55], v14 offset:21504
    v_mfma_f32_16x16x32_bf16 v[32:35], v[108:111], v[120:123], v[32:35]
    ds_read_b128 v[72:75], v14 offset:26624
    s_waitcnt lgkmcnt(5)
    v_mfma_f32_16x16x32_bf16 v[16:19], v[92:95], v[124:127], v[16:19]
    ds_read_b128 v[56:59], v14 offset:22528
    v_mfma_f32_16x16x32_bf16 v[20:23], v[96:99], v[124:127], v[20:23]
    ds_read_b128 v[60:63], v14 offset:23552
    buffer_load_dwordx4 v[188:191], v1, s[4:7], s32 offen offset:3072 sc1
    v_mfma_f32_16x16x32_bf16 v[24:27], v[100:103], v[124:127], v[24:27]
    ds_read_b128 v[64:67], v14 offset:24576
    v_mfma_f32_16x16x32_bf16 v[28:31], v[104:107], v[124:127], v[28:31]
    ds_read_b128 v[68:71], v14 offset:25600
    v_mfma_f32_16x16x32_bf16 v[36:39], v[108:111], v[124:127], v[36:39]
    s_waitcnt vmcnt(14) lgkmcnt(4)
    v_mfma_f32_16x16x32_bf16 v[16:19], v[40:43], v[128:131], v[16:19]
    ds_read_b128 v[76:79], v14 offset:27648
    v_mfma_f32_16x16x32_bf16 v[20:23], v[44:47], v[128:131], v[20:23]
    ds_read_b128 v[80:83], v14 offset:28672
    v_mfma_f32_16x16x32_bf16 v[24:27], v[48:51], v[128:131], v[24:27]
    ds_read_b128 v[84:87], v14 offset:29696
    buffer_load_dwordx4 v[192:195], v1, s[4:7], s33 offen offset:0 sc1
    v_mfma_f32_16x16x32_bf16 v[28:31], v[52:55], v[128:131], v[28:31]
    ds_read_b128 v[88:91], v14 offset:30720
    v_mfma_f32_16x16x32_bf16 v[32:35], v[72:75], v[128:131], v[32:35]
    ds_read_b128 v[108:111], v14 offset:35840
    s_waitcnt lgkmcnt(5)
    v_mfma_f32_16x16x32_bf16 v[16:19], v[56:59], v[132:135], v[16:19]
    ds_read_b128 v[92:95], v14 offset:31744
    v_mfma_f32_16x16x32_bf16 v[20:23], v[60:63], v[132:135], v[20:23]
    ds_read_b128 v[96:99], v14 offset:32768
    buffer_load_dwordx4 v[196:199], v1, s[4:7], s33 offen offset:1024 sc1
    v_mfma_f32_16x16x32_bf16 v[24:27], v[64:67], v[132:135], v[24:27]
    ds_read_b128 v[100:103], v14 offset:33792
    v_mfma_f32_16x16x32_bf16 v[28:31], v[68:71], v[132:135], v[28:31]
    ds_read_b128 v[104:107], v14 offset:34816
    v_mfma_f32_16x16x32_bf16 v[36:39], v[72:75], v[132:135], v[36:39]
    s_waitcnt vmcnt(14) lgkmcnt(0)
    s_barrier
    v_mfma_f32_16x16x32_bf16 v[16:19], v[76:79], v[136:139], v[16:19]
    ds_read_b128 v[40:43], v15 offset:0
    v_mfma_f32_16x16x32_bf16 v[20:23], v[80:83], v[136:139], v[20:23]
    ds_read_b128 v[44:47], v15 offset:1024
    v_mfma_f32_16x16x32_bf16 v[24:27], v[84:87], v[136:139], v[24:27]
    ds_read_b128 v[48:51], v15 offset:2048
    buffer_load_dwordx4 v[200:203], v1, s[4:7], s33 offen offset:2048 sc1
    v_mfma_f32_16x16x32_bf16 v[28:31], v[88:91], v[136:139], v[28:31]
    ds_read_b128 v[52:55], v15 offset:3072
    v_mfma_f32_16x16x32_bf16 v[32:35], v[108:111], v[136:139], v[32:35]
    ds_read_b128 v[72:75], v15 offset:8192
    v_mfma_f32_16x16x32_bf16 v[16:19], v[92:95], v[140:143], v[16:19]
    ds_read_b128 v[56:59], v15 offset:4096
    v_mfma_f32_16x16x32_bf16 v[20:23], v[96:99], v[140:143], v[20:23]
    ds_read_b128 v[60:63], v15 offset:5120
    buffer_load_dwordx4 v[204:207], v1, s[4:7], s33 offen offset:3072 sc1
    v_mfma_f32_16x16x32_bf16 v[24:27], v[100:103], v[140:143], v[24:27]
    ds_read_b128 v[64:67], v15 offset:6144
    v_mfma_f32_16x16x32_bf16 v[28:31], v[104:107], v[140:143], v[28:31]
    ds_read_b128 v[68:71], v15 offset:7168
    v_mfma_f32_16x16x32_bf16 v[36:39], v[108:111], v[140:143], v[36:39]
    s_waitcnt vmcnt(14) lgkmcnt(4)
    v_mfma_f32_16x16x32_bf16 v[16:19], v[40:43], v[144:147], v[16:19]
    ds_read_b128 v[76:79], v15 offset:9216
    v_mfma_f32_16x16x32_bf16 v[20:23], v[44:47], v[144:147], v[20:23]
    ds_read_b128 v[80:83], v15 offset:10240
    v_mfma_f32_16x16x32_bf16 v[24:27], v[48:51], v[144:147], v[24:27]
    ds_read_b128 v[84:87], v15 offset:11264
    v_mfma_f32_16x16x32_bf16 v[28:31], v[52:55], v[144:147], v[28:31]
    ds_read_b128 v[88:91], v15 offset:12288
    buffer_load_dwordx4 v[208:211], v4, s[4:7], s34 offen offset:0 sc1
    v_mfma_f32_16x16x32_bf16 v[32:35], v[72:75], v[144:147], v[32:35]
    ds_read_b128 v[108:111], v15 offset:17408
    s_waitcnt lgkmcnt(5)
    v_mfma_f32_16x16x32_bf16 v[16:19], v[56:59], v[148:151], v[16:19]
    ds_read_b128 v[92:95], v15 offset:13312
    buffer_load_dwordx4 v[212:215], v4, s[4:7], s34 offen offset:1024 sc1
    v_mfma_f32_16x16x32_bf16 v[20:23], v[60:63], v[148:151], v[20:23]
    ds_read_b128 v[96:99], v15 offset:14336
    v_mfma_f32_16x16x32_bf16 v[24:27], v[64:67], v[148:151], v[24:27]
    ds_read_b128 v[100:103], v15 offset:15360
    buffer_load_dwordx2 v[216:217], v5, s[4:7], s34 offen sc1
    v_mfma_f32_16x16x32_bf16 v[28:31], v[68:71], v[148:151], v[28:31]
    ds_read_b128 v[104:107], v15 offset:16384
    v_mfma_f32_16x16x32_bf16 v[36:39], v[72:75], v[148:151], v[36:39]
    s_waitcnt vmcnt(15) lgkmcnt(4)
    v_mfma_f32_16x16x32_bf16 v[16:19], v[76:79], v[152:155], v[16:19]
    ds_read_b128 v[40:43], v15 offset:18432
    v_mfma_f32_16x16x32_bf16 v[20:23], v[80:83], v[152:155], v[20:23]
    ds_read_b128 v[44:47], v15 offset:19456
    v_mfma_f32_16x16x32_bf16 v[24:27], v[84:87], v[152:155], v[24:27]
    ds_read_b128 v[48:51], v15 offset:20480
    v_mfma_f32_16x16x32_bf16 v[28:31], v[88:91], v[152:155], v[28:31]
    ds_read_b128 v[52:55], v15 offset:21504
    v_mfma_f32_16x16x32_bf16 v[32:35], v[108:111], v[152:155], v[32:35]
    ds_read_b128 v[72:75], v15 offset:26624
    s_waitcnt lgkmcnt(5)
    v_mfma_f32_16x16x32_bf16 v[16:19], v[92:95], v[156:159], v[16:19]
    ds_read_b128 v[56:59], v15 offset:22528
    v_mfma_f32_16x16x32_bf16 v[20:23], v[96:99], v[156:159], v[20:23]
    ds_read_b128 v[60:63], v15 offset:23552
    v_mfma_f32_16x16x32_bf16 v[24:27], v[100:103], v[156:159], v[24:27]
    ds_read_b128 v[64:67], v15 offset:24576
    v_mfma_f32_16x16x32_bf16 v[28:31], v[104:107], v[156:159], v[28:31]
    ds_read_b128 v[68:71], v15 offset:25600
    v_mfma_f32_16x16x32_bf16 v[36:39], v[108:111], v[156:159], v[36:39]
    s_waitcnt vmcnt(13) lgkmcnt(4)
    v_mfma_f32_16x16x32_bf16 v[16:19], v[40:43], v[160:163], v[16:19]
    ds_read_b128 v[76:79], v15 offset:27648
    v_mfma_f32_16x16x32_bf16 v[20:23], v[44:47], v[160:163], v[20:23]
    ds_read_b128 v[80:83], v15 offset:28672
    v_mfma_f32_16x16x32_bf16 v[24:27], v[48:51], v[160:163], v[24:27]
    ds_read_b128 v[84:87], v15 offset:29696
    v_mfma_f32_16x16x32_bf16 v[28:31], v[52:55], v[160:163], v[28:31]
    ds_read_b128 v[88:91], v15 offset:30720
    v_mfma_f32_16x16x32_bf16 v[32:35], v[72:75], v[160:163], v[32:35]
    ds_read_b128 v[108:111], v15 offset:35840
    s_waitcnt lgkmcnt(5)
    v_mfma_f32_16x16x32_bf16 v[16:19], v[56:59], v[164:167], v[16:19]
    ds_read_b128 v[92:95], v15 offset:31744
    v_mfma_f32_16x16x32_bf16 v[20:23], v[60:63], v[164:167], v[20:23]
    ds_read_b128 v[96:99], v15 offset:32768
    v_mfma_f32_16x16x32_bf16 v[24:27], v[64:67], v[164:167], v[24:27]
    ds_read_b128 v[100:103], v15 offset:33792
    v_mfma_f32_16x16x32_bf16 v[28:31], v[68:71], v[164:167], v[28:31]
    ds_read_b128 v[104:107], v15 offset:34816
    v_mfma_f32_16x16x32_bf16 v[36:39], v[72:75], v[164:167], v[36:39]
    s_waitcnt vmcnt(11) lgkmcnt(0)
    s_barrier
    v_mfma_f32_16x16x32_bf16 v[16:19], v[76:79], v[168:171], v[16:19]
    ds_read_b128 v[40:43], v12 offset:0
    v_mfma_f32_16x16x32_bf16 v[20:23], v[80:83], v[168:171], v[20:23]
    ds_read_b128 v[44:47], v12 offset:1024
    v_mfma_f32_16x16x32_bf16 v[24:27], v[84:87], v[168:171], v[24:27]
    ds_read_b128 v[48:51], v12 offset:2048
    v_mfma_f32_16x16x32_bf16 v[28:31], v[88:91], v[168:171], v[28:31]
    ds_read_b128 v[52:55], v12 offset:3072
    v_mfma_f32_16x16x32_bf16 v[32:35], v[108:111], v[168:171], v[32:35]
    ds_read_b128 v[72:75], v12 offset:8192
    v_mfma_f32_16x16x32_bf16 v[16:19], v[92:95], v[172:175], v[16:19]
    ds_read_b128 v[56:59], v12 offset:4096
    v_mfma_f32_16x16x32_bf16 v[20:23], v[96:99], v[172:175], v[20:23]
    ds_read_b128 v[60:63], v12 offset:5120
    v_mfma_f32_16x16x32_bf16 v[24:27], v[100:103], v[172:175], v[24:27]
    ds_read_b128 v[64:67], v12 offset:6144
    v_mfma_f32_16x16x32_bf16 v[28:31], v[104:107], v[172:175], v[28:31]
    ds_read_b128 v[68:71], v12 offset:7168
    v_mfma_f32_16x16x32_bf16 v[36:39], v[108:111], v[172:175], v[36:39]
    s_waitcnt vmcnt(9) lgkmcnt(4)
    v_mfma_f32_16x16x32_bf16 v[16:19], v[40:43], v[176:179], v[16:19]
    ds_read_b128 v[76:79], v12 offset:9216
    v_mfma_f32_16x16x32_bf16 v[20:23], v[44:47], v[176:179], v[20:23]
    ds_read_b128 v[80:83], v12 offset:10240
    v_mfma_f32_16x16x32_bf16 v[24:27], v[48:51], v[176:179], v[24:27]
    ds_read_b128 v[84:87], v12 offset:11264
    v_mfma_f32_16x16x32_bf16 v[28:31], v[52:55], v[176:179], v[28:31]
    ds_read_b128 v[88:91], v12 offset:12288
    v_mfma_f32_16x16x32_bf16 v[32:35], v[72:75], v[176:179], v[32:35]
    ds_read_b128 v[108:111], v12 offset:17408
    s_waitcnt lgkmcnt(5)
    v_mfma_f32_16x16x32_bf16 v[16:19], v[56:59], v[180:183], v[16:19]
    ds_read_b128 v[92:95], v12 offset:13312
    v_mfma_f32_16x16x32_bf16 v[20:23], v[60:63], v[180:183], v[20:23]
    ds_read_b128 v[96:99], v12 offset:14336
    v_mfma_f32_16x16x32_bf16 v[24:27], v[64:67], v[180:183], v[24:27]
    ds_read_b128 v[100:103], v12 offset:15360
    v_mfma_f32_16x16x32_bf16 v[28:31], v[68:71], v[180:183], v[28:31]
    ds_read_b128 v[104:107], v12 offset:16384
    v_mfma_f32_16x16x32_bf16 v[36:39], v[72:75], v[180:183], v[36:39]
    s_waitcnt vmcnt(7) lgkmcnt(4)
    v_mfma_f32_16x16x32_bf16 v[16:19], v[76:79], v[184:187], v[16:19]
    ds_read_b128 v[40:43], v12 offset:18432
    v_mfma_f32_16x16x32_bf16 v[20:23], v[80:83], v[184:187], v[20:23]
    ds_read_b128 v[44:47], v12 offset:19456
    v_mfma_f32_16x16x32_bf16 v[24:27], v[84:87], v[184:187], v[24:27]
    ds_read_b128 v[48:51], v12 offset:20480
    v_mfma_f32_16x16x32_bf16 v[28:31], v[88:91], v[184:187], v[28:31]
    ds_read_b128 v[52:55], v12 offset:21504
    v_mfma_f32_16x16x32_bf16 v[32:35], v[108:111], v[184:187], v[32:35]
    ds_read_b128 v[72:75], v12 offset:26624
    s_waitcnt lgkmcnt(5)
    v_mfma_f32_16x16x32_bf16 v[16:19], v[92:95], v[188:191], v[16:19]
    ds_read_b128 v[56:59], v12 offset:22528
    v_mfma_f32_16x16x32_bf16 v[20:23], v[96:99], v[188:191], v[20:23]
    ds_read_b128 v[60:63], v12 offset:23552
    v_mfma_f32_16x16x32_bf16 v[24:27], v[100:103], v[188:191], v[24:27]
    ds_read_b128 v[64:67], v12 offset:24576
    v_mfma_f32_16x16x32_bf16 v[28:31], v[104:107], v[188:191], v[28:31]
    ds_read_b128 v[68:71], v12 offset:25600
    v_mfma_f32_16x16x32_bf16 v[36:39], v[108:111], v[188:191], v[36:39]
    s_waitcnt vmcnt(5) lgkmcnt(4)
    v_mfma_f32_16x16x32_bf16 v[16:19], v[40:43], v[192:195], v[16:19]
    ds_read_b128 v[76:79], v12 offset:27648
    v_mfma_f32_16x16x32_bf16 v[20:23], v[44:47], v[192:195], v[20:23]
    ds_read_b128 v[80:83], v12 offset:28672
    v_mfma_f32_16x16x32_bf16 v[24:27], v[48:51], v[192:195], v[24:27]
    ds_read_b128 v[84:87], v12 offset:29696
    v_mfma_f32_16x16x32_bf16 v[28:31], v[52:55], v[192:195], v[28:31]
    ds_read_b128 v[88:91], v12 offset:30720
    v_mfma_f32_16x16x32_bf16 v[32:35], v[72:75], v[192:195], v[32:35]
    ds_read_b128 v[108:111], v12 offset:35840
    s_waitcnt lgkmcnt(5)
    v_mfma_f32_16x16x32_bf16 v[16:19], v[56:59], v[196:199], v[16:19]
    ds_read_b128 v[92:95], v12 offset:31744
    v_mfma_f32_16x16x32_bf16 v[20:23], v[60:63], v[196:199], v[20:23]
    ds_read_b128 v[96:99], v12 offset:32768
    v_mfma_f32_16x16x32_bf16 v[24:27], v[64:67], v[196:199], v[24:27]
    ds_read_b128 v[100:103], v12 offset:33792
    v_mfma_f32_16x16x32_bf16 v[28:31], v[68:71], v[196:199], v[28:31]
    ds_read_b128 v[104:107], v12 offset:34816
    v_mfma_f32_16x16x32_bf16 v[36:39], v[72:75], v[196:199], v[36:39]
    s_waitcnt vmcnt(3) lgkmcnt(0)
    s_barrier
    v_mfma_f32_16x16x32_bf16 v[16:19], v[76:79], v[200:203], v[16:19]
    v_mfma_f32_16x16x32_bf16 v[20:23], v[80:83], v[200:203], v[20:23]
    v_mfma_f32_16x16x32_bf16 v[24:27], v[84:87], v[200:203], v[24:27]
    v_mfma_f32_16x16x32_bf16 v[28:31], v[88:91], v[200:203], v[28:31]
    v_mfma_f32_16x16x32_bf16 v[32:35], v[108:111], v[200:203], v[32:35]
    v_mfma_f32_16x16x32_bf16 v[16:19], v[92:95], v[204:207], v[16:19]
    v_mfma_f32_16x16x32_bf16 v[20:23], v[96:99], v[204:207], v[20:23]
    v_mfma_f32_16x16x32_bf16 v[24:27], v[100:103], v[204:207], v[24:27]
    v_mfma_f32_16x16x32_bf16 v[28:31], v[104:107], v[204:207], v[28:31]
    v_mfma_f32_16x16x32_bf16 v[36:39], v[108:111], v[204:207], v[36:39]
    s_and_b32 s30, s30, 0xfffe
    s_add_u32 s38, s21, 0x2800000
    s_mul_i32 s34, s30, 18432
    s_add_u32 s34, s34, s38
    s_add_u32 s34, s34, 0x0
    s_lshl_b32 s39, s30, 10
    s_add_u32 s39, s39, s38
    s_add_u32 s39, s39, 0x2400000
    v_mul_u32_u24 v9, 18432, v7
    v_lshl_add_u32 v9, v8, 4, v9
    v_lshl_add_u32 v4, v3, 8, v9
    v_add_u32 v4, s35, v4
    v_lshl_add_u32 v5, v3, 3, v9
    v_add_u32 v5, s36, v5
    v_cndmask_b32 v5, v6, v5, s[40:41]
    s_lshr_b32 s42, s24, 1
    s_lshl_b32 s42, s42, 8
    s_and_b32 s43, s24, 1
    s_lshl_b32 s43, s43, 3
    s_add_u32 s42, s42, s43
    v_lshlrev_b32 v10, 10, v7
    v_lshl_add_u32 v10, v8, 4, v10
    v_add_u32 v10, s42, v10
    v_cmp_eq_u32 vcc, 0, v3
    v_mov_b32 v11, 0x3f803f80
    s_nop 0
    v_cndmask_b32 v10, v6, v10, vcc
    s_waitcnt vmcnt(0)
    v_permlane32_swap_b32 v36, v220
    v_permlane32_swap_b32 v37, v221
    v_permlane32_swap_b32 v38, v222
    v_permlane32_swap_b32 v39, v223
    v_lshlrev_b32 v224, 16, v208
    v_and_b32 v225, 0xffff0000, v208
    v_lshlrev_b32 v226, 16, v209
    v_and_b32 v227, 0xffff0000, v209
    v_lshlrev_b32 v228, 16, v210
    v_and_b32 v229, 0xffff0000, v210
    v_lshlrev_b32 v230, 16, v211
    v_and_b32 v231, 0xffff0000, v211
    v_lshlrev_b32 v232, 16, v212
    v_and_b32 v233, 0xffff0000, v212
    v_lshlrev_b32 v234, 16, v213
    v_and_b32 v235, 0xffff0000, v213
    v_lshlrev_b32 v236, 16, v214
    v_and_b32 v237, 0xffff0000, v214
    v_lshlrev_b32 v238, 16, v215
    v_and_b32 v239, 0xffff0000, v215
    v_lshlrev_b32 v240, 16, v216
    v_and_b32 v241, 0xffff0000, v216
    v_lshlrev_b32 v242, 16, v217
    v_and_b32 v243, 0xffff0000, v217
    v_pk_add_f32 v[32:33], v[32:33], v[220:221]
    v_pk_add_f32 v[34:35], v[34:35], v[222:223]
    v_pk_add_f32 v[16:17], v[16:17], v[224:225]
    v_pk_add_f32 v[18:19], v[18:19], v[226:227]
    v_pk_add_f32 v[20:21], v[20:21], v[228:229]
    v_pk_add_f32 v[22:23], v[22:23], v[230:231]
    v_pk_add_f32 v[24:25], v[24:25], v[232:233]
    v_pk_add_f32 v[26:27], v[26:27], v[234:235]
    v_pk_add_f32 v[28:29], v[28:29], v[236:237]
    v_pk_add_f32 v[30:31], v[30:31], v[238:239]
    v_pk_add_f32 v[32:33], v[32:33], v[240:241]
    v_pk_add_f32 v[34:35], v[34:35], v[242:243]
    v_cvt_pk_bf16_f32 v208, v16, v17
    v_cvt_pk_bf16_f32 v209, v18, v19
    v_cvt_pk_bf16_f32 v210, v20, v21
    v_cvt_pk_bf16_f32 v211, v22, v23
    v_cvt_pk_bf16_f32 v212, v24, v25
    v_cvt_pk_bf16_f32 v213, v26, v27
    v_cvt_pk_bf16_f32 v214, v28, v29
    v_cvt_pk_bf16_f32 v215, v30, v31
    v_cvt_pk_bf16_f32 v216, v32, v33
    v_cvt_pk_bf16_f32 v217, v34, v35
    s_cmp_eq_u32 s22, 1
    s_cbranch_scc1 L_fin_p5
    buffer_store_dwordx4 v[208:211], v4, s[4:7], s34 offen offset:0 sc1
    buffer_store_dwordx4 v[212:215], v4, s[4:7], s34 offen offset:1024 sc1
    buffer_store_dwordx2 v[216:217], v5, s[4:7], s34 offen sc1
    v_cndmask_b32 v222, 0, v216, s[40:41]
    v_cndmask_b32 v223, 0, v217, s[40:41]
    v_mov_b32 v220, 0
    v_mov_b32 v221, 0
    v_dot2_f32_bf16 v220, v208, v11, v220
    v_dot2_f32_bf16 v221, v208, v208, v221
    v_dot2_f32_bf16 v220, v209, v11, v220
    v_dot2_f32_bf16 v221, v209, v209, v221
    v_dot2_f32_bf16 v220, v210, v11, v220
    v_dot2_f32_bf16 v221, v210, v210, v221
    v_dot2_f32_bf16 v220, v211, v11, v220
    v_dot2_f32_bf16 v221, v211, v211, v221
    v_dot2_f32_bf16 v220, v212, v11, v220
    v_dot2_f32_bf16 v221, v212, v212, v221
    v_dot2_f32_bf16 v220, v213, v11, v220
    v_dot2_f32_bf16 v221, v213, v213, v221
    v_dot2_f32_bf16 v220, v214, v11, v220
    v_dot2_f32_bf16 v221, v214, v214, v221
    v_dot2_f32_bf16 v220, v215, v11, v220
    v_dot2_f32_bf16 v221, v215, v215, v221
    v_dot2_f32_bf16 v220, v222, v11, v220
    v_dot2_f32_bf16 v221, v222, v222, v221
    v_dot2_f32_bf16 v220, v223, v11, v220
    v_dot2_f32_bf16 v221, v223, v223, v221
    s_nop 2
    v_mov_b32 v222, v220
    v_mov_b32 v223, v221
    s_nop 1
    v_permlane32_swap_b32 v220, v222
    v_permlane32_swap_b32 v221, v223
    v_add_f32 v220, v220, v222
    v_add_f32 v221, v221, v223
    v_mov_b32 v222, v220
    v_mov_b32 v223, v221
    s_nop 1
    v_permlane16_swap_b32 v220, v222
    v_permlane16_swap_b32 v221, v223
    v_add_f32 v220, v220, v222
    v_add_f32 v221, v221, v223
    buffer_store_dwordx2 v[220:221], v10, s[4:7], s39 offen sc1
    s_branch L_fin_p5_e
L_fin_p5:
    v_lshl_add_u32 v9, v7, 4, v8
    v_mul_u32_u24 v9, 1152, v9
    s_mul_i32 s34, s30, 18432
    s_mul_i32 s42, s24, 144
    s_add_u32 s34, s34, s42
    v_lshl_add_u32 v4, v3, 4, v9
    v_lshl_add_u32 v5, v3, 3, v9
    v_cndmask_b32 v5, v6, v5, s[40:41]
    buffer_store_dwordx4 v[208:211], v4, s[16:19], s34 offen offset:0
    buffer_store_dwordx4 v[212:215], v4, s[16:19], s34 offen offset:64
    buffer_store_dwordx2 v[216:217], v5, s[16:19], s34 offen offset:128
L_fin_p5_e:
    s_lshr_b32 s44, s23, 1
    s_lshl_b32 s45, s22, 8
    s_add_u32 s45, s45, s44
    s_lshl_b32 s45, s45, 8
    s_add_u32 s45, s45, 0x850c000
    s_cmp_eq_u32 s22, 1
    s_cbranch_scc1 L_end_m
    s_mov_b32 s22, 1
    s_mov_b32 s21, 0x2800000
    s_branch L_m_cl
L_g_slow:
    s_mov_b32 s60, 65536
L_poll_zs:
    buffer_load_dword v4, v254, s[4:7], s37 offen sc1
    s_waitcnt vmcnt(0)
    v_cmp_gt_u32 vcc, 16, v4
    s_sub_u32 s60, s60, 1
    s_cbranch_scc1 L_pd_zs
    s_cbranch_vccz L_pd_zs
    s_sleep 4
    s_branch L_poll_zs
L_pd_zs:
    s_branch L_g_back
L_ld_m:
    s_and_b32 s25, s2, 7
    s_lshr_b32 s26, s2, 3
    s_lshl_b32 s23, s25, 1
    s_lshr_b32 s27, s26, 4
    s_add_u32 s23, s23, s27
    s_and_b32 s24, s26, 15
    s_mul_i32 s29, s24, 129024
    s_lshl_b32 s30, s20, 12
    s_add_u32 s29, s29, s30
    s_add_u32 s29, s29, 0x7800000
    s_lshl_b32 s31, s23, 3
    s_max_u32 s31, s31, 1
    s_sub_u32 s31, s31, 1
    s_mul_i32 s31, s31, 18432
    s_add_u32 s31, s31, s21
    s_add_u32 s31, s31, 0x0
    s_lshl_b32 s32, s20, 10
    s_and_b32 s33, s32, 1024
    s_barrier
    s_add_u32 m0, s32, 131072
    s_add_u32 s34, s31, s32
    s_add_u32 s34, s34, 0
    buffer_load_dwordx4 v1, s[4:7], s34 offen sc1 lds
    s_add_u32 m0, s30, 0
    s_add_u32 s34, s29, 0
    buffer_load_dwordx4 v1, s[4:7], s34 offen offset:0 lds
    buffer_load_dwordx4 v1, s[4:7], s34 offen offset:1024 lds
    buffer_load_dwordx4 v1, s[4:7], s34 offen offset:2048 lds
    buffer_load_dwordx4 v1, s[4:7], s34 offen offset:3072 lds
    s_add_u32 m0, s30, 16384
    s_add_u32 s34, s29, 16384
    buffer_load_dwordx4 v1, s[4:7], s34 offen offset:0 lds
    buffer_load_dwordx4 v1, s[4:7], s34 offen offset:1024 lds
    buffer_load_dwordx4 v1, s[4:7], s34 offen offset:2048 lds
    buffer_load_dwordx4 v1, s[4:7], s34 offen offset:3072 lds
    s_waitcnt vmcnt(4)
    s_barrier
    s_add_u32 m0, s32, 135168
    s_add_u32 s34, s31, s32
    s_add_u32 s34, s34, 4096
    buffer_load_dwordx4 v1, s[4:7], s34 offen sc1 lds
    s_add_u32 m0, s30, 32768
    s_add_u32 s34, s29, 32768
    buffer_load_dwordx4 v1, s[4:7], s34 offen offset:0 lds
    buffer_load_dwordx4 v1, s[4:7], s34 offen offset:1024 lds
    buffer_load_dwordx4 v1, s[4:7], s34 offen offset:2048 lds
    buffer_load_dwordx4 v1, s[4:7], s34 offen offset:3072 lds
    s_add_u32 m0, s30, 49152
    s_add_u32 s34, s29, 49152
    buffer_load_dwordx4 v1, s[4:7], s34 offen offset:0 lds
    buffer_load_dwordx4 v1, s[4:7], s34 offen offset:1024 lds
    buffer_load_dwordx4 v1, s[4:7], s34 offen offset:2048 lds
    buffer_load_dwordx4 v1, s[4:7], s34 offen offset:3072 lds
    s_add_u32 m0, s32, 139264
    s_add_u32 s34, s31, s32
    s_add_u32 s34, s34, 8192
    buffer_load_dwordx4 v1, s[4:7], s34 offen sc1 lds
    s_waitcnt vmcnt(10)
    s_barrier
    s_add_u32 m0, s30, 65536
    s_add_u32 s34, s29, 65536
    buffer_load_dwordx4 v1, s[4:7], s34 offen offset:0 lds
    buffer_load_dwordx4 v1, s[4:7], s34 offen offset:1024 lds
    buffer_load_dwordx4 v1, s[4:7], s34 offen offset:2048 lds
    buffer_load_dwordx4 v1, s[4:7], s34 offen offset:3072 lds
    s_waitcnt vmcnt(9)
    s_barrier
    s_add_u32 m0, s30, 81920
    s_add_u32 s34, s29, 81920
    buffer_load_dwordx4 v1, s[4:7], s34 offen offset:0 lds
    buffer_load_dwordx4 v1, s[4:7], s34 offen offset:1024 lds
    buffer_load_dwordx4 v1, s[4:7], s34 offen offset:2048 lds
    buffer_load_dwordx4 v1, s[4:7], s34 offen offset:3072 lds
    s_add_u32 m0, s32, 143360
    s_add_u32 s34, s31, s32
    s_add_u32 s34, s34, 12288
    buffer_load_dwordx4 v1, s[4:7], s34 offen sc1 lds
    s_waitcnt vmcnt(9)
    s_barrier
    s_add_u32 m0, s30, 98304
    s_add_u32 s34, s29, 98304
    buffer_load_dwordx4 v1, s[4:7], s34 offen offset:0 lds
    buffer_load_dwordx4 v1, s[4:7], s34 offen offset:1024 lds
    buffer_load_dwordx4 v1, s[4:7], s34 offen offset:2048 lds
    buffer_load_dwordx4 v1, s[4:7], s34 offen offset:3072 lds
    s_waitcnt vmcnt(9)
    s_barrier
    s_add_u32 m0, s33, 147456
    s_add_u32 s34, s31, s33
    s_add_u32 s34, s34, 16384
    buffer_load_dwordx4 v1, s[4:7], s34 offen sc1 lds
    s_add_u32 m0, s30, 114688
    s_add_u32 s34, s29, 114688
    buffer_load_dwordx4 v1, s[4:7], s34 offen offset:0 lds
    buffer_load_dwordx4 v1, s[4:7], s34 offen offset:1024 lds
    buffer_load_dwordx4 v1, s[4:7], s34 offen offset:2048 lds
    buffer_load_dwordx4 v1, s[4:7], s34 offen offset:3072 lds
    s_mov_b32 m0, 161792
    s_lshl_b32 s34, s24, 10
    s_add_u32 s34, s34, 0x8400000
    buffer_load_dwordx4 v1, s[4:7], s34 offen lds
    s_waitcnt vmcnt(10)
    s_barrier
    s_waitcnt vmcnt(6)
    s_barrier
    s_waitcnt vmcnt(0)
    s_barrier
    s_barrier
L_m_ll:
    s_and_b32 s25, s2, 7
    s_lshr_b32 s26, s2, 3
    s_lshl_b32 s23, s25, 2
    s_lshr_b32 s27, s26, 3
    s_add_u32 s23, s23, s27
    s_and_b32 s24, s26, 7
    s_add_u32 s28, s23, s24
    s_and_b32 s28, s28, 3
    s_mul_i32 s29, s24, 82944
    s_add_u32 s29, s29, 0x7a00000
    s_mul_i32 s30, s20, 9216
    s_mul_i32 s31, s20, 3072
    s_mov_b32 s32, 0
    s_mul_i32 s32, s32, 36864
    s_add_u32 s32, s32, s29
    s_add_u32 s32, s32, s30
    s_add_u32 m0, s30, 0
    s_add_u32 s33, s32, 0
    buffer_load_dwordx4 v1, s[4:7], s33 offen offset:0 lds
    buffer_load_dwordx4 v1, s[4:7], s33 offen offset:1024 lds
    buffer_load_dwordx4 v1, s[4:7], s33 offen offset:2048 lds
    buffer_load_dwordx4 v1, s[4:7], s33 offen offset:3072 lds
    s_add_u32 m0, s30, 4096
    s_add_u32 s33, s32, 4096
    buffer_load_dwordx4 v1, s[4:7], s33 offen offset:0 lds
    buffer_load_dwordx4 v1, s[4:7], s33 offen offset:1024 lds
    buffer_load_dwordx4 v1, s[4:7], s33 offen offset:2048 lds
    buffer_load_dwordx4 v1, s[4:7], s33 offen offset:3072 lds
    s_add_u32 m0, s30, 8192
    s_add_u32 s33, s32, 8192
    buffer_load_dwordx4 v1, s[4:7], s33 offen offset:0 lds
    s_mov_b32 s32, 1
    s_mul_i32 s32, s32, 36864
    s_add_u32 s32, s32, s29
    s_add_u32 s32, s32, s30
    s_add_u32 m0, s30, 36864
    s_add_u32 s33, s32, 0
    buffer_load_dwordx4 v1, s[4:7], s33 offen offset:0 lds
    buffer_load_dwordx4 v1, s[4:7], s33 offen offset:1024 lds
    buffer_load_dwordx4 v1, s[4:7], s33 offen offset:2048 lds
    buffer_load_dwordx4 v1, s[4:7], s33 offen offset:3072 lds
    s_add_u32 m0, s30, 40960
    s_add_u32 s33, s32, 4096
    buffer_load_dwordx4 v1, s[4:7], s33 offen offset:0 lds
    buffer_load_dwordx4 v1, s[4:7], s33 offen offset:1024 lds
    buffer_load_dwordx4 v1, s[4:7], s33 offen offset:2048 lds
    buffer_load_dwordx4 v1, s[4:7], s33 offen offset:3072 lds
    s_add_u32 m0, s30, 45056
    s_add_u32 s33, s32, 8192
    buffer_load_dwordx4 v1, s[4:7], s33 offen offset:0 lds
    s_add_u32 m0, s31, 73728
    s_add_u32 s33, s29, s31
    s_add_u32 s33, s33, 73728
    buffer_load_dwordx4 v1, s[4:7], s33 offen offset:0 lds
    buffer_load_dwordx4 v1, s[4:7], s33 offen offset:1024 lds
    buffer_load_dwordx4 v1, s[4:7], s33 offen offset:2048 lds
    s_waitcnt vmcnt(12)
    s_barrier
    s_waitcnt vmcnt(3)
    s_barrier
    s_waitcnt vmcnt(0)
    s_barrier
    s_barrier
    s_and_b32 s25, s2, 7
    s_lshr_b32 s26, s2, 3
    s_and_b32 s23, s25, 1
    s_lshl_b32 s23, s23, 3
    s_and_b32 s27, s26, 7
    s_add_u32 s23, s23, s27
    s_lshr_b32 s24, s25, 1
    s_lshl_b32 s24, s24, 2
    s_lshr_b32 s27, s26, 3
    s_add_u32 s24, s24, s27
    s_add_u32 s28, s23, s24
    s_and_b32 s28, s28, 3
    s_lshl_b32 s30, s20, 12
    s_lshr_b32 s33, s20, 1
    s_mul_i32 s31, s33, 18432
    s_and_b32 s33, s20, 1
    s_lshl_b32 s33, s33, 10
    s_add_u32 s33, s33, 16384
    s_add_u32 s31, s31, s33
    s_sub_u32 s49, s33, s30
    s_mul_i32 s34, s24, 331776
    s_add_u32 s34, s34, s30
    s_add_u32 s34, s34, 0x7b00000
    s_lshl_b32 s35, s23, 3
    s_lshl_b32 s33, s20, 1
    s_add_u32 s35, s35, s33
    s_mul_i32 s35, s35, 18432
    s_add_u32 s35, s35, s21
    s_add_u32 s35, s35, 0x300000
    s_mul_i32 s36, s24, 589824
    s_add_u32 s36, s36, s30
    s_add_u32 s36, s36, s21
    s_add_u32 s36, s36, 0x1200000
    v_add_u32 v2, 16384, v1
    s_cmp_eq_u32 s28, 0
    s_cselect_b32 s48, 4, 0
    s_mul_i32 s50, s48, 18432
    s_add_u32 s50, s50, s34
    s_add_u32 m0, s30, 0
    s_mov_b32 s53, s50
    buffer_load_dwordx4 v1, s[4:7], s50 offen offset:0  lds
    buffer_load_dwordx4 v1, s[4:7], s50 offen offset:1024  lds
    buffer_load_dwordx4 v1, s[4:7], s50 offen offset:2048  lds
    buffer_load_dwordx4 v1, s[4:7], s50 offen offset:3072  lds
    s_cmp_eq_u32 s28, 1
    s_cselect_b32 s48, 5, 1
    s_mul_i32 s50, s48, 18432
    s_add_u32 s50, s50, s34
    s_cmp_ge_u32 s20, 2
    s_cselect_b32 s52, s50, s53
    s_add_u32 m0, s31, 0
    s_add_u32 s52, s52, s49
    buffer_load_dwordx4 v1, s[4:7], s52 offen  lds
    s_add_u32 m0, s30, 18432
    s_mov_b32 s53, s50
    buffer_load_dwordx4 v1, s[4:7], s50 offen offset:0  lds
    buffer_load_dwordx4 v1, s[4:7], s50 offen offset:1024  lds
    buffer_load_dwordx4 v1, s[4:7], s50 offen offset:2048  lds
    buffer_load_dwordx4 v1, s[4:7], s50 offen offset:3072  lds
    s_cmp_eq_u32 s28, 2
    s_cselect_b32 s48, 6, 2
    s_mul_i32 s50, s48, 18432
    s_add_u32 s50, s50, s34
    s_add_u32 m0, s30, 36864
    s_mov_b32 s53, s50
    buffer_load_dwordx4 v1, s[4:7], s50 offen offset:0  lds
    buffer_load_dwordx4 v1, s[4:7], s50 offen offset:1024  lds
    buffer_load_dwordx4 v1, s[4:7], s50 offen offset:2048  lds
    buffer_load_dwordx4 v1, s[4:7], s50 offen offset:3072  lds
    s_cmp_eq_u32 s28, 3
    s_cselect_b32 s48, 7, 3
    s_mul_i32 s50, s48, 18432
    s_add_u32 s50, s50, s34
    s_cmp_ge_u32 s20, 2
    s_cselect_b32 s52, s50, s53
    s_add_u32 m0, s31, 36864
    s_add_u32 s52, s52, s49
    buffer_load_dwordx4 v1, s[4:7], s52 offen  lds
    s_add_u32 m0, s30, 55296
    s_mov_b32 s53, s50
    buffer_load_dwordx4 v1, s[4:7], s50 offen offset:0  lds
    buffer_load_dwordx4 v1, s[4:7], s50 offen offset:1024  lds
    buffer_load_dwordx4 v1, s[4:7], s50 offen offset:2048  lds
    buffer_load_dwordx4 v1, s[4:7], s50 offen offset:3072  lds
    s_lshl_b32 s33, s20, 10
    s_add_u32 m0, s33, 139264
    s_lshl_b32 s51, s24, 12
    s_add_u32 s51, s51, s33
    s_add_u32 s51, s51, 0x8410000
    buffer_load_dwordx4 v1, s[4:7], s51 offen lds
    s_barrier
    s_cmp_eq_u32 s28, 0
    s_cselect_b32 s48, 4, 0
    s_lshl_b32 s51, s48, 11
    s_add_u32 m0, s30, 73728
    s_add_u32 s51, s51, s35
    buffer_load_dwordx4 v1, s[4:7], s51 offen offset:0 sc1 lds
    buffer_load_dwordx4 v1, s[4:7], s51 offen offset:1024 sc1 lds
    buffer_load_dwordx4 v2, s[4:7], s51 offen offset:2048 sc1 lds
    buffer_load_dwordx4 v2, s[4:7], s51 offen offset:3072 sc1 lds
    s_cmp_eq_u32 s28, 1
    s_cselect_b32 s48, 5, 1
    s_lshl_b32 s51, s48, 11
    s_add_u32 m0, s30, 90112
    s_add_u32 s51, s51, s35
    buffer_load_dwordx4 v1, s[4:7], s51 offen offset:0 sc1 lds
    buffer_load_dwordx4 v1, s[4:7], s51 offen offset:1024 sc1 lds
    buffer_load_dwordx4 v2, s[4:7], s51 offen offset:2048 sc1 lds
    buffer_load_dwordx4 v2, s[4:7], s51 offen offset:3072 sc1 lds
    s_waitcnt vmcnt(4)
    s_barrier
    s_cmp_eq_u32 s28, 2
    s_cselect_b32 s48, 6, 2
    s_lshl_b32 s51, s48, 11
    s_add_u32 m0, s30, 106496
    s_add_u32 s51, s51, s35
    buffer_load_dwordx4 v1, s[4:7], s51 offen offset:0 sc1 lds
    buffer_load_dwordx4 v1, s[4:7], s51 offen offset:1024 sc1 lds
    buffer_load_dwordx4 v2, s[4:7], s51 offen offset:2048 sc1 lds
    buffer_load_dwordx4 v2, s[4:7], s51 offen offset:3072 sc1 lds
    s_cmp_eq_u32 s28, 3
    s_cselect_b32 s48, 7, 3
    s_lshl_b32 s51, s48, 11
    s_add_u32 m0, s30, 122880
    s_add_u32 s51, s51, s35
    buffer_load_dwordx4 v1, s[4:7], s51 offen offset:0 sc1 lds
    buffer_load_dwordx4 v1, s[4:7], s51 offen offset:1024 sc1 lds
    buffer_load_dwordx4 v2, s[4:7], s51 offen offset:2048 sc1 lds
    buffer_load_dwordx4 v2, s[4:7], s51 offen offset:3072 sc1 lds
    s_lshl_b32 s33, s23, 7
    s_lshl_b32 s37, s20, 5
    s_add_u32 s33, s33, s37
    v_bfe_u32 v8, v0, 5, 1
    v_bfe_u32 v9, v0, 3, 2
    v_lshl_add_u32 v8, v8, 3, v9
    v_add_u32 v8, s33, v8
    v_lshlrev_b32 v8, 12, v8
    v_bfe_u32 v9, v0, 4, 2
    v_and_b32 v10, 7, v0
    v_xor_b32 v9, v9, v10
    v_lshl_add_u32 v8, v9, 4, v8
    v_xor_b32 v9, 64, v8
    v_add_u32 v9, 64512, v9
    v_add_u32 v10, 14336, v8
    v_add_u32 v11, 14336, v9
    s_cmp_eq_u32 s28, 0
    s_cselect_b32 s44, 4, 0
    s_cmp_eq_u32 s28, 1
    s_cselect_b32 s45, 5, 1
    s_cmp_eq_u32 s28, 2
    s_cselect_b32 s46, 6, 2
    s_cmp_eq_u32 s28, 3
    s_cselect_b32 s47, 7, 3
    s_lshl_b32 s54, s22, 8
    s_add_u32 s54, s54, s24
    s_lshl_b32 s54, s54, 8
    s_add_u32 s54, s54, 0x8508000
    v_mov_b32 v3, 0
    s_waitcnt vmcnt(8)
    s_barrier
    s_cmp_eq_u32 s28, 0
    s_cselect_b32 s48, 8, 4
    s_mul_i32 s50, s48, 18432
    s_add_u32 s50, s50, s34
    s_add_u32 m0, s30, 0
    s_mov_b32 s53, s50
    buffer_load_dwordx4 v1, s[4:7], s50 offen offset:0  lds
    buffer_load_dwordx4 v1, s[4:7], s50 offen offset:1024  lds
    buffer_load_dwordx4 v1, s[4:7], s50 offen offset:2048  lds
    buffer_load_dwordx4 v1, s[4:7], s50 offen offset:3072  lds
    s_cmp_eq_u32 s28, 0
    s_cselect_b32 s48, 8, 4
    s_lshl_b32 s51, s48, 11
    s_add_u32 m0, s30, 73728
    s_add_u32 s51, s51, s35
    buffer_load_dwordx4 v1, s[4:7], s51 offen offset:0 sc1 lds
    buffer_load_dwordx4 v1, s[4:7], s51 offen offset:1024 sc1 lds
    buffer_load_dwordx4 v2, s[4:7], s51 offen offset:2048 sc1 lds
    buffer_load_dwordx4 v2, s[4:7], s51 offen offset:3072 sc1 lds
    s_waitcnt vmcnt(12)
    s_barrier
    s_cmp_eq_u32 s28, 1
    s_cselect_b32 s48, 1, 5
    s_mul_i32 s50, s48, 18432
    s_add_u32 s50, s50, s34
    s_cmp_ge_u32 s20, 2
    s_cselect_b32 s52, s50, s53
    s_add_u32 m0, s31, 0
    s_add_u32 s52, s52, s49
    buffer_load_dwordx4 v1, s[4:7], s52 offen  lds
    s_add_u32 m0, s30, 18432
    s_mov_b32 s53, s50
    buffer_load_dwordx4 v1, s[4:7], s50 offen offset:0  lds
    buffer_load_dwordx4 v1, s[4:7], s50 offen offset:1024  lds
    buffer_load_dwordx4 v1, s[4:7], s50 offen offset:2048  lds
    buffer_load_dwordx4 v1, s[4:7], s50 offen offset:3072  lds
    s_cmp_eq_u32 s28, 1
    s_cselect_b32 s48, 1, 5
    s_lshl_b32 s51, s48, 11
    s_add_u32 m0, s30, 90112
    s_add_u32 s51, s51, s35
    buffer_load_dwordx4 v1, s[4:7], s51 offen offset:0 sc1 lds
    buffer_load_dwordx4 v1, s[4:7], s51 offen offset:1024 sc1 lds
    buffer_load_dwordx4 v2, s[4:7], s51 offen offset:2048 sc1 lds
    buffer_load_dwordx4 v2, s[4:7], s51 offen offset:3072 sc1 lds
    s_waitcnt vmcnt(17)
    s_barrier
    s_cmp_eq_u32 s28, 2
    s_cselect_b32 s48, 2, 6
    s_mul_i32 s50, s48, 18432
    s_add_u32 s50, s50, s34
    s_add_u32 m0, s30, 36864
    s_mov_b32 s53, s50
    buffer_load_dwordx4 v1, s[4:7], s50 offen offset:0  lds
    buffer_load_dwordx4 v1, s[4:7], s50 offen offset:1024  lds
    buffer_load_dwordx4 v1, s[4:7], s50 offen offset:2048  lds
    buffer_load_dwordx4 v1, s[4:7], s50 offen offset:3072  lds
    s_cmp_eq_u32 s28, 2
    s_cselect_b32 s48, 2, 6
    s_lshl_b32 s51, s48, 11
    s_add_u32 m0, s30, 106496
    s_add_u32 s51, s51, s35
    buffer_load_dwordx4 v1, s[4:7], s51 offen offset:0 sc1 lds
    buffer_load_dwordx4 v1, s[4:7], s51 offen offset:1024 sc1 lds
    buffer_load_dwordx4 v2, s[4:7], s51 offen offset:2048 sc1 lds
    buffer_load_dwordx4 v2, s[4:7], s51 offen offset:3072 sc1 lds
    s_waitcnt vmcnt(16)
    s_barrier
    s_cmp_eq_u32 s28, 3
    s_cselect_b32 s48, 3, 7
    s_mul_i32 s50, s48, 18432
    s_add_u32 s50, s50, s34
    s_cmp_ge_u32 s20, 2
    s_cselect_b32 s52, s50, s53
    s_add_u32 m0, s31, 36864
    s_add_u32 s52, s52, s49
    buffer_load_dwordx4 v1, s[4:7], s52 offen  lds
    s_add_u32 m0, s30, 55296
    s_mov_b32 s53, s50
    buffer_load_dwordx4 v1, s[4:7], s50 offen offset:0  lds
    buffer_load_dwordx4 v1, s[4:7], s50 offen offset:1024  lds
    buffer_load_dwordx4 v1, s[4:7], s50 offen offset:2048  lds
    buffer_load_dwordx4 v1, s[4:7], s50 offen offset:3072  lds
    s_cmp_eq_u32 s28, 3
    s_cselect_b32 s48, 3, 7
    s_lshl_b32 s51, s48, 11
    s_add_u32 m0, s30, 122880
    s_add_u32 s51, s51, s35
    buffer_load_dwordx4 v1, s[4:7], s51 offen offset:0 sc1 lds
    buffer_load_dwordx4 v1, s[4:7], s51 offen offset:1024 sc1 lds
    buffer_load_dwordx4 v2, s[4:7], s51 offen offset:2048 sc1 lds
    buffer_load_dwordx4 v2, s[4:7], s51 offen offset:3072 sc1 lds
    s_waitcnt vmcnt(17)
    s_barrier
    s_cmp_eq_u32 s28, 0
    s_cselect_b32 s48, 0, 8
    s_mul_i32 s50, s48, 18432
    s_add_u32 s50, s50, s34
    s_add_u32 m0, s30, 0
    s_mov_b32 s53, s50
    buffer_load_dwordx4 v1, s[4:7], s50 offen offset:0  lds
    buffer_load_dwordx4 v1, s[4:7], s50 offen offset:1024  lds
    buffer_load_dwordx4 v1, s[4:7], s50 offen offset:2048  lds
    buffer_load_dwordx4 v1, s[4:7], s50 offen offset:3072  lds
    s_cmp_eq_u32 s28, 0
    s_cselect_b32 s48, 0, 8
    s_lshl_b32 s51, s48, 11
    s_add_u32 m0, s30, 73728
    s_add_u32 s51, s51, s35
    buffer_load_dwordx4 v1, s[4:7], s51 offen offset:0 sc1 lds
    buffer_load_dwordx4 v1, s[4:7], s51 offen offset:1024 sc1 lds
    buffer_load_dwordx4 v2, s[4:7], s51 offen offset:2048 sc1 lds
    buffer_load_dwordx4 v2, s[4:7], s51 offen offset:3072 sc1 lds
    s_waitcnt vmcnt(16)
    s_barrier
    s_cmp_eq_u32 s28, 0
    s_cselect_b32 s48, 4, 0
    s_mul_i32 s50, s48, 18432
    s_add_u32 s50, s50, s34
    s_add_u32 s50, s50, 165888
    s_cmp_ge_u32 s20, 2
    s_cselect_b32 s52, s50, s53
    s_add_u32 m0, s31, 0
    s_add_u32 s52, s52, s49
    buffer_load_dwordx4 v1, s[4:7], s52 offen  lds
    s_add_u32 m0, s30, 18432
    s_mov_b32 s53, s50
    buffer_load_dwordx4 v1, s[4:7], s50 offen offset:0  lds
    buffer_load_dwordx4 v1, s[4:7], s50 offen offset:1024  lds
    buffer_load_dwordx4 v1, s[4:7], s50 offen offset:2048  lds
    buffer_load_dwordx4 v1, s[4:7], s50 offen offset:3072  lds
    s_cmp_eq_u32 s28, 0
    s_cselect_b32 s48, 4, 0
    s_lshl_b32 s51, s48, 11
    s_add_u32 m0, s30, 90112
    s_add_u32 s51, s51, s35
    buffer_load_dwordx4 v1, s[4:7], s51 offen offset:0 sc1 lds
    buffer_load_dwordx4 v1, s[4:7], s51 offen offset:1024 sc1 lds
    buffer_load_dwordx4 v2, s[4:7], s51 offen offset:2048 sc1 lds
    buffer_load_dwordx4 v2, s[4:7], s51 offen offset:3072 sc1 lds
    s_waitcnt vmcnt(17)
    s_barrier
    s_cmp_eq_u32 s28, 1
    s_cselect_b32 s48, 5, 1
    s_mul_i32 s50, s48, 18432
    s_add_u32 s50, s50, s34
    s_add_u32 s50, s50, 165888
    s_add_u32 m0, s30, 36864
    s_mov_b32 s53, s50
    buffer_load_dwordx4 v1, s[4:7], s50 offen offset:0  lds
    buffer_load_dwordx4 v1, s[4:7], s50 offen offset:1024  lds
    buffer_load_dwordx4 v1, s[4:7], s50 offen offset:2048  lds
    buffer_load_dwordx4 v1, s[4:7], s50 offen offset:3072  lds
    s_cmp_eq_u32 s28, 1
    s_cselect_b32 s48, 5, 1
    s_lshl_b32 s51, s48, 11
    s_add_u32 m0, s30, 106496
    s_add_u32 s51, s51, s35
    buffer_load_dwordx4 v1, s[4:7], s51 offen offset:0 sc1 lds
    buffer_load_dwordx4 v1, s[4:7], s51 offen offset:1024 sc1 lds
    buffer_load_dwordx4 v2, s[4:7], s51 offen offset:2048 sc1 lds
    buffer_load_dwordx4 v2, s[4:7], s51 offen offset:3072 sc1 lds
    s_waitcnt vmcnt(16)
    s_barrier
    s_cmp_eq_u32 s28, 2
    s_cselect_b32 s48, 6, 2
    s_mul_i32 s50, s48, 18432
    s_add_u32 s50, s50, s34
    s_add_u32 s50, s50, 165888
    s_cmp_ge_u32 s20, 2
    s_cselect_b32 s52, s50, s53
    s_add_u32 m0, s31, 36864
    s_add_u32 s52, s52, s49
    buffer_load_dwordx4 v1, s[4:7], s52 offen  lds
    s_add_u32 m0, s30, 55296
    s_mov_b32 s53, s50
    buffer_load_dwordx4 v1, s[4:7], s50 offen offset:0  lds
    buffer_load_dwordx4 v1, s[4:7], s50 offen offset:1024  lds
    buffer_load_dwordx4 v1, s[4:7], s50 offen offset:2048  lds
    buffer_load_dwordx4 v1, s[4:7], s50 offen offset:3072  lds
    s_cmp_eq_u32 s28, 2
    s_cselect_b32 s48, 6, 2
    s_lshl_b32 s51, s48, 11
    s_add_u32 m0, s30, 122880
    s_add_u32 s51, s51, s35
    buffer_load_dwordx4 v1, s[4:7], s51 offen offset:0 sc1 lds
    buffer_load_dwordx4 v1, s[4:7], s51 offen offset:1024 sc1 lds
    buffer_load_dwordx4 v2, s[4:7], s51 offen offset:2048 sc1 lds
    buffer_load_dwordx4 v2, s[4:7], s51 offen offset:3072 sc1 lds
    s_waitcnt vmcnt(17)
    s_barrier
    s_cmp_eq_u32 s28, 3
    s_cselect_b32 s48, 7, 3
    s_mul_i32 s50, s48, 18432
    s_add_u32 s50, s50, s34
    s_add_u32 s50, s50, 165888
    s_add_u32 m0, s30, 0
    s_mov_b32 s53, s50
    buffer_load_dwordx4 v1, s[4:7], s50 offen offset:0  lds
    buffer_load_dwordx4 v1, s[4:7], s50 offen offset:1024  lds
    buffer_load_dwordx4 v1, s[4:7], s50 offen offset:2048  lds
    buffer_load_dwordx4 v1, s[4:7], s50 offen offset:3072  lds
    s_cmp_eq_u32 s28, 3
    s_cselect_b32 s48, 7, 3
    s_lshl_b32 s51, s48, 11
    s_add_u32 m0, s30, 73728
    s_add_u32 s51, s51, s35
    buffer_load_dwordx4 v1, s[4:7], s51 offen offset:0 sc1 lds
    buffer_load_dwordx4 v1, s[4:7], s51 offen offset:1024 sc1 lds
    buffer_load_dwordx4 v2, s[4:7], s51 offen offset:2048 sc1 lds
    buffer_load_dwordx4 v2, s[4:7], s51 offen offset:3072 sc1 lds
    s_waitcnt vmcnt(16)
    s_barrier
    s_cmp_eq_u32 s28, 0
    s_cselect_b32 s48, 8, 4
    s_mul_i32 s50, s48, 18432
    s_add_u32 s50, s50, s34
    s_add_u32 s50, s50, 165888
    s_cmp_ge_u32 s20, 2
    s_cselect_b32 s52, s50, s53
    s_add_u32 m0, s31, 0
    s_add_u32 s52, s52, s49
    buffer_load_dwordx4 v1, s[4:7], s52 offen  lds
    s_add_u32 m0, s30, 18432
    s_mov_b32 s53, s50
    buffer_load_dwordx4 v1, s[4:7], s50 offen offset:0  lds
    buffer_load_dwordx4 v1, s[4:7], s50 offen offset:1024  lds
    buffer_load_dwordx4 v1, s[4:7], s50 offen offset:2048  lds
    buffer_load_dwordx4 v1, s[4:7], s50 offen offset:3072  lds
    s_cmp_eq_u32 s28, 0
    s_cselect_b32 s48, 8, 4
    s_lshl_b32 s51, s48, 11
    s_add_u32 m0, s30, 90112
    s_add_u32 s51, s51, s35
    buffer_load_dwordx4 v1, s[4:7], s51 offen offset:0 sc1 lds
    buffer_load_dwordx4 v1, s[4:7], s51 offen offset:1024 sc1 lds
    buffer_load_dwordx4 v2, s[4:7], s51 offen offset:2048 sc1 lds
    buffer_load_dwordx4 v2, s[4:7], s51 offen offset:3072 sc1 lds
    s_waitcnt vmcnt(17)
    s_barrier
    s_cmp_eq_u32 s28, 1
    s_cselect_b32 s48, 1, 5
    s_mul_i32 s50, s48, 18432
    s_add_u32 s50, s50, s34
    s_add_u32 s50, s50, 165888
    s_add_u32 m0, s30, 36864
    s_mov_b32 s53, s50
    buffer_load_dwordx4 v1, s[4:7], s50 offen offset:0  lds
    buffer_load_dwordx4 v1, s[4:7], s50 offen offset:1024  lds
    buffer_load_dwordx4 v1, s[4:7], s50 offen offset:2048  lds
    buffer_load_dwordx4 v1, s[4:7], s50 offen offset:3072  lds
    s_cmp_eq_u32 s28, 1
    s_cselect_b32 s48, 1, 5
    s_lshl_b32 s51, s48, 11
    s_add_u32 m0, s30, 106496
    s_add_u32 s51, s51, s35
    buffer_load_dwordx4 v1, s[4:7], s51 offen offset:0 sc1 lds
    buffer_load_dwordx4 v1, s[4:7], s51 offen offset:1024 sc1 lds
    buffer_load_dwordx4 v2, s[4:7], s51 offen offset:2048 sc1 lds
    buffer_load_dwordx4 v2, s[4:7], s51 offen offset:3072 sc1 lds
    s_waitcnt vmcnt(16)
    s_barrier
    s_cmp_eq_u32 s28, 2
    s_cselect_b32 s48, 2, 6
    s_mul_i32 s50, s48, 18432
    s_add_u32 s50, s50, s34
    s_add_u32 s50, s50, 165888
    s_cmp_ge_u32 s20, 2
    s_cselect_b32 s52, s50, s53
    s_add_u32 m0, s31, 36864
    s_add_u32 s52, s52, s49
    buffer_load_dwordx4 v1, s[4:7], s52 offen  lds
    s_add_u32 m0, s30, 55296
    s_mov_b32 s53, s50
    buffer_load_dwordx4 v1, s[4:7], s50 offen offset:0  lds
    buffer_load_dwordx4 v1, s[4:7], s50 offen offset:1024  lds
    buffer_load_dwordx4 v1, s[4:7], s50 offen offset:2048  lds
    buffer_load_dwordx4 v1, s[4:7], s50 offen offset:3072  lds
    s_cmp_eq_u32 s28, 2
    s_cselect_b32 s48, 2, 6
    s_lshl_b32 s51, s48, 11
    s_add_u32 m0, s30, 122880
    s_add_u32 s51, s51, s35
    buffer_load_dwordx4 v1, s[4:7], s51 offen offset:0 sc1 lds
    buffer_load_dwordx4 v1, s[4:7], s51 offen offset:1024 sc1 lds
    buffer_load_dwordx4 v2, s[4:7], s51 offen offset:2048 sc1 lds
    buffer_load_dwordx4 v2, s[4:7], s51 offen offset:3072 sc1 lds
    s_waitcnt vmcnt(17)
    s_barrier
    s_cmp_eq_u32 s28, 3
    s_cselect_b32 s48, 3, 7
    s_mul_i32 s50, s48, 18432
    s_add_u32 s50, s50, s34
    s_add_u32 s50, s50, 165888
    s_add_u32 m0, s30, 0
    s_mov_b32 s53, s50
    buffer_load_dwordx4 v1, s[4:7], s50 offen offset:0  lds
    buffer_load_dwordx4 v1, s[4:7], s50 offen offset:1024  lds
    buffer_load_dwordx4 v1, s[4:7], s50 offen offset:2048  lds
    buffer_load_dwordx4 v1, s[4:7], s50 offen offset:3072  lds
    s_cmp_eq_u32 s28, 3
    s_cselect_b32 s48, 3, 7
    s_lshl_b32 s51, s48, 11
    s_add_u32 m0, s30, 73728
    s_add_u32 s51, s51, s35
    buffer_load_dwordx4 v1, s[4:7], s51 offen offset:0 sc1 lds
    buffer_load_dwordx4 v1, s[4:7], s51 offen offset:1024 sc1 lds
    buffer_load_dwordx4 v2, s[4:7], s51 offen offset:2048 sc1 lds
    buffer_load_dwordx4 v2, s[4:7], s51 offen offset:3072 sc1 lds
    s_waitcnt vmcnt(16)
    s_barrier
    s_cmp_eq_u32 s28, 0
    s_cselect_b32 s48, 0, 8
    s_mul_i32 s50, s48, 18432
    s_add_u32 s50, s50, s34
    s_add_u32 s50, s50, 165888
    s_cmp_ge_u32 s20, 2
    s_cselect_b32 s52, s50, s53
    s_add_u32 m0, s31, 0
    s_add_u32 s52, s52, s49
    buffer_load_dwordx4 v1, s[4:7], s52 offen  lds
    s_add_u32 m0, s30, 18432
    s_mov_b32 s53, s50
    buffer_load_dwordx4 v1, s[4:7], s50 offen offset:0  lds
    buffer_load_dwordx4 v1, s[4:7], s50 offen offset:1024  lds
    buffer_load_dwordx4 v1, s[4:7], s50 offen offset:2048  lds
    buffer_load_dwordx4 v1, s[4:7], s50 offen offset:3072  lds
    s_cmp_eq_u32 s28, 0
    s_cselect_b32 s48, 0, 8
    s_lshl_b32 s51, s48, 11
    s_add_u32 m0, s30, 90112
    s_add_u32 s51, s51, s35
    buffer_load_dwordx4 v1, s[4:7], s51 offen offset:0 sc1 lds
    buffer_load_dwordx4 v1, s[4:7], s51 offen offset:1024 sc1 lds
    buffer_load_dwordx4 v2, s[4:7], s51 offen offset:2048 sc1 lds
    buffer_load_dwordx4 v2, s[4:7], s51 offen offset:3072 sc1 lds
    s_waitcnt vmcnt(17)
    s_barrier
    s_add_u32 m0, s30, 106496
    s_lshl_b32 s51, s44, 7
    buffer_load_dwordx4 v8, s[8:11], s51 offen offset:0 lds
    buffer_load_dwordx4 v9, s[8:11], s51 offen offset:1024 lds
    buffer_load_dwordx4 v10, s[8:11], s51 offen offset:2048 lds
    buffer_load_dwordx4 v11, s[8:11], s51 offen offset:3072 lds
    s_waitcnt vmcnt(12)
    s_barrier
    s_add_u32 m0, s30, 122880
    s_lshl_b32 s51, s45, 7
    buffer_load_dwordx4 v8, s[8:11], s51 offen offset:0 lds
    buffer_load_dwordx4 v9, s[8:11], s51 offen offset:1024 lds
    buffer_load_dwordx4 v10, s[8:11], s51 offen offset:2048 lds
    buffer_load_dwordx4 v11, s[8:11], s51 offen offset:3072 lds
    s_waitcnt vmcnt(8)
    s_barrier
    s_add_u32 m0, s30, 73728
    s_lshl_b32 s51, s46, 7
    buffer_load_dwordx4 v8, s[8:11], s51 offen offset:0 lds
    buffer_load_dwordx4 v9, s[8:11], s51 offen offset:1024 lds
    buffer_load_dwordx4 v10, s[8:11], s51 offen offset:2048 lds
    buffer_load_dwordx4 v11, s[8:11], s51 offen offset:3072 lds
    s_barrier
    s_add_u32 m0, s30, 90112
    s_lshl_b32 s51, s47, 7
    buffer_load_dwordx4 v8, s[8:11], s51 offen offset:0 lds
    buffer_load_dwordx4 v9, s[8:11], s51 offen offset:1024 lds
    buffer_load_dwordx4 v10, s[8:11], s51 offen offset:2048 lds
    buffer_load_dwordx4 v11, s[8:11], s51 offen offset:3072 lds
    s_mov_b32 s60, 65536
L_poll_z2:
    buffer_load_dword v4, v3, s[4:7], s54 offen sc1
    s_waitcnt vmcnt(0)
    v_cmp_gt_u32 vcc, 16, v4
    s_sub_u32 s60, s60, 1
    s_cbranch_scc1 L_pd_z2
    s_cbranch_vccz L_pd_z2
    s_sleep 8
    s_branch L_poll_z2
L_pd_z2:
    s_mul_i32 s50, s44, 18432
    s_add_u32 s50, s50, s36
    s_add_u32 m0, s30, 36864
    s_mov_b32 s53, s50
    buffer_load_dwordx4 v1, s[4:7], s50 offen offset:0 sc1 lds
    buffer_load_dwordx4 v1, s[4:7], s50 offen offset:1024 sc1 lds
    buffer_load_dwordx4 v1, s[4:7], s50 offen offset:2048 sc1 lds
    buffer_load_dwordx4 v1, s[4:7], s50 offen offset:3072 sc1 lds
    s_add_u32 s44, s44, 4
    s_and_b32 s44, s44, 31
    s_mul_i32 s50, s45, 18432
    s_add_u32 s50, s50, s36
    s_cmp_ge_u32 s20, 2
    s_cselect_b32 s52, s50, s53
    s_add_u32 m0, s31, 36864
    s_add_u32 s52, s52, s49
    buffer_load_dwordx4 v1, s[4:7], s52 offen sc1 lds
    s_add_u32 m0, s30, 55296
    s_mov_b32 s53, s50
    buffer_load_dwordx4 v1, s[4:7], s50 offen offset:0 sc1 lds
    buffer_load_dwordx4 v1, s[4:7], s50 offen offset:1024 sc1 lds
    buffer_load_dwordx4 v1, s[4:7], s50 offen offset:2048 sc1 lds
    buffer_load_dwordx4 v1, s[4:7], s50 offen offset:3072 sc1 lds
    s_add_u32 s45, s45, 4
    s_and_b32 s45, s45, 31
    s_mul_i32 s50, s46, 18432
    s_add_u32 s50, s50, s36
    s_add_u32 m0, s30, 0
    s_mov_b32 s53, s50
    buffer_load_dwordx4 v1, s[4:7], s50 offen offset:0 sc1 lds
    buffer_load_dwordx4 v1, s[4:7], s50 offen offset:1024 sc1 lds
    buffer_load_dwordx4 v1, s[4:7], s50 offen offset:2048 sc1 lds
    buffer_load_dwordx4 v1, s[4:7], s50 offen offset:3072 sc1 lds
    s_add_u32 s46, s46, 4
    s_and_b32 s46, s46, 31
    s_mul_i32 s50, s47, 18432
    s_add_u32 s50, s50, s36
    s_cmp_ge_u32 s20, 2
    s_cselect_b32 s52, s50, s53
    s_add_u32 m0, s31, 0
    s_add_u32 s52, s52, s49
    buffer_load_dwordx4 v1, s[4:7], s52 offen sc1 lds
    s_add_u32 m0, s30, 18432
    s_mov_b32 s53, s50
    buffer_load_dwordx4 v1, s[4:7], s50 offen offset:0 sc1 lds
    buffer_load_dwordx4 v1, s[4:7], s50 offen offset:1024 sc1 lds
    buffer_load_dwordx4 v1, s[4:7], s50 offen offset:2048 sc1 lds
    buffer_load_dwordx4 v1, s[4:7], s50 offen offset:3072 sc1 lds
    s_add_u32 s47, s47, 4
    s_and_b32 s47, s47, 31
    s_waitcnt vmcnt(13)
    s_barrier
    s_waitcnt vmcnt(9)
    s_barrier
    s_mul_i32 s50, s44, 18432
    s_add_u32 s50, s50, s36
    s_add_u32 m0, s30, 36864
    s_mov_b32 s53, s50
    buffer_load_dwordx4 v1, s[4:7], s50 offen offset:0 sc1 lds
    buffer_load_dwordx4 v1, s[4:7], s50 offen offset:1024 sc1 lds
    buffer_load_dwordx4 v1, s[4:7], s50 offen offset:2048 sc1 lds
    buffer_load_dwordx4 v1, s[4:7], s50 offen offset:3072 sc1 lds
    s_add_u32 m0, s30, 106496
    s_lshl_b32 s51, s44, 7
    buffer_load_dwordx4 v8, s[8:11], s51 offen offset:0 lds
    buffer_load_dwordx4 v9, s[8:11], s51 offen offset:1024 lds
    buffer_load_dwordx4 v10, s[8:11], s51 offen offset:2048 lds
    buffer_load_dwordx4 v11, s[8:11], s51 offen offset:3072 lds
    s_add_u32 s44, s44, 4
    s_and_b32 s44, s44, 31
    s_waitcnt vmcnt(12)
    s_barrier
    s_mul_i32 s50, s45, 18432
    s_add_u32 s50, s50, s36
    s_cmp_ge_u32 s20, 2
    s_cselect_b32 s52, s50, s53
    s_add_u32 m0, s31, 36864
    s_add_u32 s52, s52, s49
    buffer_load_dwordx4 v1, s[4:7], s52 offen sc1 lds
    s_add_u32 m0, s30, 55296
    s_mov_b32 s53, s50
    buffer_load_dwordx4 v1, s[4:7], s50 offen offset:0 sc1 lds
    buffer_load_dwordx4 v1, s[4:7], s50 offen offset:1024 sc1 lds
    buffer_load_dwordx4 v1, s[4:7], s50 offen offset:2048 sc1 lds
    buffer_load_dwordx4 v1, s[4:7], s50 offen offset:3072 sc1 lds
    s_add_u32 m0, s30, 122880
    s_lshl_b32 s51, s45, 7
    buffer_load_dwordx4 v8, s[8:11], s51 offen offset:0 lds
    buffer_load_dwordx4 v9, s[8:11], s51 offen offset:1024 lds
    buffer_load_dwordx4 v10, s[8:11], s51 offen offset:2048 lds
    buffer_load_dwordx4 v11, s[8:11], s51 offen offset:3072 lds
    s_add_u32 s45, s45, 4
    s_and_b32 s45, s45, 31
    s_waitcnt vmcnt(17)
    s_barrier
    s_mul_i32 s50, s46, 18432
    s_add_u32 s50, s50, s36
    s_add_u32 m0, s30, 0
    s_mov_b32 s53, s50
    buffer_load_dwordx4 v1, s[4:7], s50 offen offset:0 sc1 lds
    buffer_load_dwordx4 v1, s[4:7], s50 offen offset:1024 sc1 lds
    buffer_load_dwordx4 v1, s[4:7], s50 offen offset:2048 sc1 lds
    buffer_load_dwordx4 v1, s[4:7], s50 offen offset:3072 sc1 lds
    s_add_u32 m0, s30, 73728
    s_lshl_b32 s51, s46, 7
    buffer_load_dwordx4 v8, s[8:11], s51 offen offset:0 lds
    buffer_load_dwordx4 v9, s[8:11], s51 offen offset:1024 lds
    buffer_load_dwordx4 v10, s[8:11], s51 offen offset:2048 lds
    buffer_load_dwordx4 v11, s[8:11], s51 offen offset:3072 lds
    s_add_u32 s46, s46, 4
    s_and_b32 s46, s46, 31
    s_waitcnt vmcnt(16)
    s_barrier
    s_mul_i32 s50, s47, 18432
    s_add_u32 s50, s50, s36
    s_cmp_ge_u32 s20, 2
    s_cselect_b32 s52, s50, s53
    s_add_u32 m0, s31, 0
    s_add_u32 s52, s52, s49
    buffer_load_dwordx4 v1, s[4:7], s52 offen sc1 lds
    s_add_u32 m0, s30, 18432
    s_mov_b32 s53, s50
    buffer_load_dwordx4 v1, s[4:7], s50 offen offset:0 sc1 lds
    buffer_load_dwordx4 v1, s[4:7], s50 offen offset:1024 sc1 lds
    buffer_load_dwordx4 v1, s[4:7], s50 offen offset:2048 sc1 lds
    buffer_load_dwordx4 v1, s[4:7], s50 offen offset:3072 sc1 lds
    s_add_u32 m0, s30, 90112
    s_lshl_b32 s51, s47, 7
    buffer_load_dwordx4 v8, s[8:11], s51 offen offset:0 lds
    buffer_load_dwordx4 v9, s[8:11], s51 offen offset:1024 lds
    buffer_load_dwordx4 v10, s[8:11], s51 offen offset:2048 lds
    buffer_load_dwordx4 v11, s[8:11], s51 offen offset:3072 lds
    s_add_u32 s47, s47, 4
    s_and_b32 s47, s47, 31
    s_mov_b32 s41, 6
L_g_ll:
    s_waitcnt vmcnt(17)
    s_barrier
    s_mul_i32 s50, s44, 18432
    s_add_u32 s50, s50, s36
    s_add_u32 m0, s30, 36864
    s_mov_b32 s53, s50
    buffer_load_dwordx4 v1, s[4:7], s50 offen offset:0 sc1 lds
    buffer_load_dwordx4 v1, s[4:7], s50 offen offset:1024 sc1 lds
    buffer_load_dwordx4 v1, s[4:7], s50 offen offset:2048 sc1 lds
    buffer_load_dwordx4 v1, s[4:7], s50 offen offset:3072 sc1 lds
    s_add_u32 m0, s30, 106496
    s_lshl_b32 s51, s44, 7
    buffer_load_dwordx4 v8, s[8:11], s51 offen offset:0 lds
    buffer_load_dwordx4 v9, s[8:11], s51 offen offset:1024 lds
    buffer_load_dwordx4 v10, s[8:11], s51 offen offset:2048 lds
    buffer_load_dwordx4 v11, s[8:11], s51 offen offset:3072 lds
    s_add_u32 s44, s44, 4
    s_and_b32 s44, s44, 31
    s_waitcnt vmcnt(16)
    s_barrier
    s_mul_i32 s50, s45, 18432
    s_add_u32 s50, s50, s36
    s_cmp_ge_u32 s20, 2
    s_cselect_b32 s52, s50, s53
    s_add_u32 m0, s31, 36864
    s_add_u32 s52, s52, s49
    buffer_load_dwordx4 v1, s[4:7], s52 offen sc1 lds
    s_add_u32 m0, s30, 55296
    s_mov_b32 s53, s50
    buffer_load_dwordx4 v1, s[4:7], s50 offen offset:0 sc1 lds
    buffer_load_dwordx4 v1, s[4:7], s50 offen offset:1024 sc1 lds
    buffer_load_dwordx4 v1, s[4:7], s50 offen offset:2048 sc1 lds
    buffer_load_dwordx4 v1, s[4:7], s50 offen offset:3072 sc1 lds
    s_add_u32 m0, s30, 122880
    s_lshl_b32 s51, s45, 7
    buffer_load_dwordx4 v8, s[8:11], s51 offen offset:0 lds
    buffer_load_dwordx4 v9, s[8:11], s51 offen offset:1024 lds
    buffer_load_dwordx4 v10, s[8:11], s51 offen offset:2048 lds
    buffer_load_dwordx4 v11, s[8:11], s51 offen offset:3072 lds
    s_add_u32 s45, s45, 4
    s_and_b32 s45, s45, 31
    s_waitcnt vmcnt(17)
    s_barrier
    s_mul_i32 s50, s46, 18432
    s_add_u32 s50, s50, s36
    s_add_u32 m0, s30, 0
    s_mov_b32 s53, s50
    buffer_load_dwordx4 v1, s[4:7], s50 offen offset:0 sc1 lds
    buffer_load_dwordx4 v1, s[4:7], s50 offen offset:1024 sc1 lds
    buffer_load_dwordx4 v1, s[4:7], s50 offen offset:2048 sc1 lds
    buffer_load_dwordx4 v1, s[4:7], s50 offen offset:3072 sc1 lds
    s_add_u32 m0, s30, 73728
    s_lshl_b32 s51, s46, 7
    buffer_load_dwordx4 v8, s[8:11], s51 offen offset:0 lds
    buffer_load_dwordx4 v9, s[8:11], s51 offen offset:1024 lds
    buffer_load_dwordx4 v10, s[8:11], s51 offen offset:2048 lds
    buffer_load_dwordx4 v11, s[8:11], s51 offen offset:3072 lds
    s_add_u32 s46, s46, 4
    s_and_b32 s46, s46, 31
    s_waitcnt vmcnt(16)
    s_barrier
    s_mul_i32 s50, s47, 18432
    s_add_u32 s50, s50, s36
    s_cmp_ge_u32 s20, 2
    s_cselect_b32 s52, s50, s53
    s_add_u32 m0, s31, 0
    s_add_u32 s52, s52, s49
    buffer_load_dwordx4 v1, s[4:7], s52 offen sc1 lds
    s_add_u32 m0, s30, 18432
    s_mov_b32 s53, s50
    buffer_load_dwordx4 v1, s[4:7], s50 offen offset:0 sc1 lds
    buffer_load_dwordx4 v1, s[4:7], s50 offen offset:1024 sc1 lds
    buffer_load_dwordx4 v1, s[4:7], s50 offen offset:2048 sc1 lds
    buffer_load_dwordx4 v1, s[4:7], s50 offen offset:3072 sc1 lds
    s_add_u32 m0, s30, 90112
    s_lshl_b32 s51, s47, 7
    buffer_load_dwordx4 v8, s[8:11], s51 offen offset:0 lds
    buffer_load_dwordx4 v9, s[8:11], s51 offen offset:1024 lds
    buffer_load_dwordx4 v10, s[8:11], s51 offen offset:2048 lds
    buffer_load_dwordx4 v11, s[8:11], s51 offen offset:3072 lds
    s_add_u32 s47, s47, 4
    s_and_b32 s47, s47, 31
    s_sub_u32 s41, s41, 1
    s_cmp_lg_u32 s41, 0
    s_cbranch_scc1 L_g_ll
    s_waitcnt vmcnt(17)
    s_barrier
    s_waitcnt vmcnt(8)
    s_barrier
    s_waitcnt vmcnt(0)
    s_barrier
    s_barrier
    s_and_b32 s25, s2, 7
    s_lshr_b32 s26, s2, 3
    s_lshl_b32 s23, s25, 2
    s_lshr_b32 s27, s26, 3
    s_add_u32 s23, s23, s27
    s_and_b32 s24, s26, 7
    s_add_u32 s28, s23, s24
    s_and_b32 s28, s28, 3
    s_mul_i32 s29, s24, 331776
    s_add_u32 s29, s29, 0x8100000
    s_mul_i32 s30, s20, 9216
    s_mul_i32 s31, s20, 3072
    s_cmp_eq_u32 s28, 0
    s_cselect_b32 s32, 4, 0
    s_mul_i32 s32, s32, 36864
    s_add_u32 s32, s32, s29
    s_add_u32 s32, s32, s30
    s_add_u32 m0, s30, 0
    s_add_u32 s33, s32, 0
    buffer_load_dwordx4 v1, s[4:7], s33 offen offset:0 lds
    buffer_load_dwordx4 v1, s[4:7], s33 offen offset:1024 lds
    buffer_load_dwordx4 v1, s[4:7], s33 offen offset:2048 lds
    buffer_load_dwordx4 v1, s[4:7], s33 offen offset:3072 lds
    s_add_u32 m0, s30, 4096
    s_add_u32 s33, s32, 4096
    buffer_load_dwordx4 v1, s[4:7], s33 offen offset:0 lds
    buffer_load_dwordx4 v1, s[4:7], s33 offen offset:1024 lds
    buffer_load_dwordx4 v1, s[4:7], s33 offen offset:2048 lds
    buffer_load_dwordx4 v1, s[4:7], s33 offen offset:3072 lds
    s_add_u32 m0, s30, 8192
    s_add_u32 s33, s32, 8192
    buffer_load_dwordx4 v1, s[4:7], s33 offen offset:0 lds
    s_cmp_eq_u32 s28, 1
    s_cselect_b32 s32, 5, 1
    s_mul_i32 s32, s32, 36864
    s_add_u32 s32, s32, s29
    s_add_u32 s32, s32, s30
    s_add_u32 m0, s30, 36864
    s_add_u32 s33, s32, 0
    buffer_load_dwordx4 v1, s[4:7], s33 offen offset:0 lds
    buffer_load_dwordx4 v1, s[4:7], s33 offen offset:1024 lds
    buffer_load_dwordx4 v1, s[4:7], s33 offen offset:2048 lds
    buffer_load_dwordx4 v1, s[4:7], s33 offen offset:3072 lds
    s_add_u32 m0, s30, 40960
    s_add_u32 s33, s32, 4096
    buffer_load_dwordx4 v1, s[4:7], s33 offen offset:0 lds
    buffer_load_dwordx4 v1, s[4:7], s33 offen offset:1024 lds
    buffer_load_dwordx4 v1, s[4:7], s33 offen offset:2048 lds
    buffer_load_dwordx4 v1, s[4:7], s33 offen offset:3072 lds
    s_add_u32 m0, s30, 45056
    s_add_u32 s33, s32, 8192
    buffer_load_dwordx4 v1, s[4:7], s33 offen offset:0 lds
    s_cmp_eq_u32 s28, 2
    s_cselect_b32 s32, 6, 2
    s_mul_i32 s32, s32, 36864
    s_add_u32 s32, s32, s29
    s_add_u32 s32, s32, s30
    s_add_u32 m0, s30, 73728
    s_add_u32 s33, s32, 0
    buffer_load_dwordx4 v1, s[4:7], s33 offen offset:0 lds
    buffer_load_dwordx4 v1, s[4:7], s33 offen offset:1024 lds
    buffer_load_dwordx4 v1, s[4:7], s33 offen offset:2048 lds
    buffer_load_dwordx4 v1, s[4:7], s33 offen offset:3072 lds
    s_add_u32 m0, s30, 77824
    s_add_u32 s33, s32, 4096
    buffer_load_dwordx4 v1, s[4:7], s33 offen offset:0 lds
    buffer_load_dwordx4 v1, s[4:7], s33 offen offset:1024 lds
    buffer_load_dwordx4 v1, s[4:7], s33 offen offset:2048 lds
    buffer_load_dwordx4 v1, s[4:7], s33 offen offset:3072 lds
    s_add_u32 m0, s30, 81920
    s_add_u32 s33, s32, 8192
    buffer_load_dwordx4 v1, s[4:7], s33 offen offset:0 lds
    s_cmp_eq_u32 s28, 3
    s_cselect_b32 s32, 7, 3
    s_mul_i32 s32, s32, 36864
    s_add_u32 s32, s32, s29
    s_add_u32 s32, s32, s30
    s_add_u32 m0, s30, 110592
    s_add_u32 s33, s32, 0
    buffer_load_dwordx4 v1, s[4:7], s33 offen offset:0 lds
    buffer_load_dwordx4 v1, s[4:7], s33 offen offset:1024 lds
    buffer_load_dwordx4 v1, s[4:7], s33 offen offset:2048 lds
    buffer_load_dwordx4 v1, s[4:7], s33 offen offset:3072 lds
    s_add_u32 m0, s30, 114688
    s_add_u32 s33, s32, 4096
    buffer_load_dwordx4 v1, s[4:7], s33 offen offset:0 lds
    buffer_load_dwordx4 v1, s[4:7], s33 offen offset:1024 lds
    buffer_load_dwordx4 v1, s[4:7], s33 offen offset:2048 lds
    buffer_load_dwordx4 v1, s[4:7], s33 offen offset:3072 lds
    s_add_u32 m0, s30, 118784
    s_add_u32 s33, s32, 8192
    buffer_load_dwordx4 v1, s[4:7], s33 offen offset:0 lds
    s_waitcnt vmcnt(27)
    s_barrier
    s_waitcnt vmcnt(18)
    s_barrier
    s_cmp_eq_u32 s28, 0
    s_cselect_b32 s32, 8, 4
    s_mul_i32 s32, s32, 36864
    s_add_u32 s32, s32, s29
    s_add_u32 s32, s32, s30
    s_add_u32 m0, s30, 0
    s_add_u32 s33, s32, 0
    buffer_load_dwordx4 v1, s[4:7], s33 offen offset:0 lds
    buffer_load_dwordx4 v1, s[4:7], s33 offen offset:1024 lds
    buffer_load_dwordx4 v1, s[4:7], s33 offen offset:2048 lds
    buffer_load_dwordx4 v1, s[4:7], s33 offen offset:3072 lds
    s_add_u32 m0, s30, 4096
    s_add_u32 s33, s32, 4096
    buffer_load_dwordx4 v1, s[4:7], s33 offen offset:0 lds
    buffer_load_dwordx4 v1, s[4:7], s33 offen offset:1024 lds
    buffer_load_dwordx4 v1, s[4:7], s33 offen offset:2048 lds
    buffer_load_dwordx4 v1, s[4:7], s33 offen offset:3072 lds
    s_add_u32 m0, s30, 8192
    s_add_u32 s33, s32, 8192
    buffer_load_dwordx4 v1, s[4:7], s33 offen offset:0 lds
    s_waitcnt vmcnt(18)
    s_barrier
    s_cmp_eq_u32 s28, 1
    s_cselect_b32 s32, 1, 5
    s_mul_i32 s32, s32, 36864
    s_add_u32 s32, s32, s29
    s_add_u32 s32, s32, s30
    s_add_u32 m0, s30, 36864
    s_add_u32 s33, s32, 0
    buffer_load_dwordx4 v1, s[4:7], s33 offen offset:0 lds
    buffer_load_dwordx4 v1, s[4:7], s33 offen offset:1024 lds
    buffer_load_dwordx4 v1, s[4:7], s33 offen offset:2048 lds
    buffer_load_dwordx4 v1, s[4:7], s33 offen offset:3072 lds
    s_add_u32 m0, s30, 40960
    s_add_u32 s33, s32, 4096
    buffer_load_dwordx4 v1, s[4:7], s33 offen offset:0 lds
    buffer_load_dwordx4 v1, s[4:7], s33 offen offset:1024 lds
    buffer_load_dwordx4 v1, s[4:7], s33 offen offset:2048 lds
    buffer_load_dwordx4 v1, s[4:7], s33 offen offset:3072 lds
    s_add_u32 m0, s30, 45056
    s_add_u32 s33, s32, 8192
    buffer_load_dwordx4 v1, s[4:7], s33 offen offset:0 lds
    s_waitcnt vmcnt(18)
    s_barrier
    s_cmp_eq_u32 s28, 2
    s_cselect_b32 s32, 2, 6
    s_mul_i32 s32, s32, 36864
    s_add_u32 s32, s32, s29
    s_add_u32 s32, s32, s30
    s_add_u32 m0, s30, 73728
    s_add_u32 s33, s32, 0
    buffer_load_dwordx4 v1, s[4:7], s33 offen offset:0 lds
    buffer_load_dwordx4 v1, s[4:7], s33 offen offset:1024 lds
    buffer_load_dwordx4 v1, s[4:7], s33 offen offset:2048 lds
    buffer_load_dwordx4 v1, s[4:7], s33 offen offset:3072 lds
    s_add_u32 m0, s30, 77824
    s_add_u32 s33, s32, 4096
    buffer_load_dwordx4 v1, s[4:7], s33 offen offset:0 lds
    buffer_load_dwordx4 v1, s[4:7], s33 offen offset:1024 lds
    buffer_load_dwordx4 v1, s[4:7], s33 offen offset:2048 lds
    buffer_load_dwordx4 v1, s[4:7], s33 offen offset:3072 lds
    s_add_u32 m0, s30, 81920
    s_add_u32 s33, s32, 8192
    buffer_load_dwordx4 v1, s[4:7], s33 offen offset:0 lds
    s_waitcnt vmcnt(18)
    s_barrier
    s_cmp_eq_u32 s28, 3
    s_cselect_b32 s32, 3, 7
    s_mul_i32 s32, s32, 36864
    s_add_u32 s32, s32, s29
    s_add_u32 s32, s32, s30
    s_add_u32 m0, s30, 110592
    s_add_u32 s33, s32, 0
    buffer_load_dwordx4 v1, s[4:7], s33 offen offset:0 lds
    buffer_load_dwordx4 v1, s[4:7], s33 offen offset:1024 lds
    buffer_load_dwordx4 v1, s[4:7], s33 offen offset:2048 lds
    buffer_load_dwordx4 v1, s[4:7], s33 offen offset:3072 lds
    s_add_u32 m0, s30, 114688
    s_add_u32 s33, s32, 4096
    buffer_load_dwordx4 v1, s[4:7], s33 offen offset:0 lds
    buffer_load_dwordx4 v1, s[4:7], s33 offen offset:1024 lds
    buffer_load_dwordx4 v1, s[4:7], s33 offen offset:2048 lds
    buffer_load_dwordx4 v1, s[4:7], s33 offen offset:3072 lds
    s_add_u32 m0, s30, 118784
    s_add_u32 s33, s32, 8192
    buffer_load_dwordx4 v1, s[4:7], s33 offen offset:0 lds
    s_waitcnt vmcnt(18)
    s_barrier
    s_cmp_eq_u32 s28, 0
    s_cselect_b32 s32, 0, 8
    s_mul_i32 s32, s32, 36864
    s_add_u32 s32, s32, s29
    s_add_u32 s32, s32, s30
    s_add_u32 m0, s30, 0
    s_add_u32 s33, s32, 0
    buffer_load_dwordx4 v1, s[4:7], s33 offen offset:0 lds
    buffer_load_dwordx4 v1, s[4:7], s33 offen offset:1024 lds
    buffer_load_dwordx4 v1, s[4:7], s33 offen offset:2048 lds
    buffer_load_dwordx4 v1, s[4:7], s33 offen offset:3072 lds
    s_add_u32 m0, s30, 4096
    s_add_u32 s33, s32, 4096
    buffer_load_dwordx4 v1, s[4:7], s33 offen offset:0 lds
    buffer_load_dwordx4 v1, s[4:7], s33 offen offset:1024 lds
    buffer_load_dwordx4 v1, s[4:7], s33 offen offset:2048 lds
    buffer_load_dwordx4 v1, s[4:7], s33 offen offset:3072 lds
    s_add_u32 m0, s30, 8192
    s_add_u32 s33, s32, 8192
    buffer_load_dwordx4 v1, s[4:7], s33 offen offset:0 lds
    s_waitcnt vmcnt(18)
    s_barrier
    s_waitcnt vmcnt(9)
    s_barrier
    s_waitcnt vmcnt(0)
    s_barrier
    s_barrier
    s_cmp_eq_u32 s22, 1
    s_cbranch_scc1 L_end_m
    s_mov_b32 s22, 1
    s_mov_b32 s21, 0x2800000
    s_and_b32 s25, s2, 7
    s_lshr_b32 s26, s2, 3
    s_lshl_b32 s23, s25, 1
    s_lshr_b32 s27, s26, 4
    s_add_u32 s23, s23, s27
    s_and_b32 s24, s26, 15
    s_mul_i32 s29, s24, 129024
    s_lshl_b32 s30, s20, 12
    s_add_u32 s29, s29, s30
    s_add_u32 s29, s29, 0x7800000
    s_lshl_b32 s31, s23, 3
    s_max_u32 s31, s31, 1
    s_sub_u32 s31, s31, 1
    s_mul_i32 s31, s31, 18432
    s_add_u32 s31, s31, s21
    s_add_u32 s31, s31, 0x0
    s_lshl_b32 s32, s20, 10
    s_and_b32 s33, s32, 1024
    s_add_u32 m0, s30, 0
    s_add_u32 s34, s29, 0
    buffer_load_dwordx4 v1, s[4:7], s34 offen offset:0 lds
    buffer_load_dwordx4 v1, s[4:7], s34 offen offset:1024 lds
    buffer_load_dwordx4 v1, s[4:7], s34 offen offset:2048 lds
    buffer_load_dwordx4 v1, s[4:7], s34 offen offset:3072 lds
    s_add_u32 m0, s30, 16384
    s_add_u32 s34, s29, 16384
    buffer_load_dwordx4 v1, s[4:7], s34 offen offset:0 lds
    buffer_load_dwordx4 v1, s[4:7], s34 offen offset:1024 lds
    buffer_load_dwordx4 v1, s[4:7], s34 offen offset:2048 lds
    buffer_load_dwordx4 v1, s[4:7], s34 offen offset:3072 lds
    s_add_u32 m0, s30, 32768
    s_add_u32 s34, s29, 32768
    buffer_load_dwordx4 v1, s[4:7], s34 offen offset:0 lds
    buffer_load_dwordx4 v1, s[4:7], s34 offen offset:1024 lds
    buffer_load_dwordx4 v1, s[4:7], s34 offen offset:2048 lds
    buffer_load_dwordx4 v1, s[4:7], s34 offen offset:3072 lds
    s_add_u32 m0, s30, 49152
    s_add_u32 s34, s29, 49152
    buffer_load_dwordx4 v1, s[4:7], s34 offen offset:0 lds
    buffer_load_dwordx4 v1, s[4:7], s34 offen offset:1024 lds
    buffer_load_dwordx4 v1, s[4:7], s34 offen offset:2048 lds
    buffer_load_dwordx4 v1, s[4:7], s34 offen offset:3072 lds
    s_add_u32 m0, s30, 65536
    s_add_u32 s34, s29, 65536
    buffer_load_dwordx4 v1, s[4:7], s34 offen offset:0 lds
    buffer_load_dwordx4 v1, s[4:7], s34 offen offset:1024 lds
    buffer_load_dwordx4 v1, s[4:7], s34 offen offset:2048 lds
    buffer_load_dwordx4 v1, s[4:7], s34 offen offset:3072 lds
    s_add_u32 m0, s30, 81920
    s_add_u32 s34, s29, 81920
    buffer_load_dwordx4 v1, s[4:7], s34 offen offset:0 lds
    buffer_load_dwordx4 v1, s[4:7], s34 offen offset:1024 lds
    buffer_load_dwordx4 v1, s[4:7], s34 offen offset:2048 lds
    buffer_load_dwordx4 v1, s[4:7], s34 offen offset:3072 lds
    s_add_u32 m0, s30, 98304
    s_add_u32 s34, s29, 98304
    buffer_load_dwordx4 v1, s[4:7], s34 offen offset:0 lds
    buffer_load_dwordx4 v1, s[4:7], s34 offen offset:1024 lds
    buffer_load_dwordx4 v1, s[4:7], s34 offen offset:2048 lds
    buffer_load_dwordx4 v1, s[4:7], s34 offen offset:3072 lds
    s_add_u32 m0, s30, 114688
    s_add_u32 s34, s29, 114688
    buffer_load_dwordx4 v1, s[4:7], s34 offen offset:0 lds
    buffer_load_dwordx4 v1, s[4:7], s34 offen offset:1024 lds
    buffer_load_dwordx4 v1, s[4:7], s34 offen offset:2048 lds
    buffer_load_dwordx4 v1, s[4:7], s34 offen offset:3072 lds
    s_mov_b32 m0, 161792
    s_lshl_b32 s34, s24, 10
    s_add_u32 s34, s34, 0x8400000
    buffer_load_dwordx4 v1, s[4:7], s34 offen lds
    s_barrier
    s_add_u32 m0, s32, 131072
    s_add_u32 s34, s31, s32
    s_add_u32 s34, s34, 0
    buffer_load_dwordx4 v1, s[4:7], s34 offen sc1 lds
    s_waitcnt vmcnt(0)
    s_barrier
    s_add_u32 m0, s32, 135168
    s_add_u32 s34, s31, s32
    s_add_u32 s34, s34, 4096
    buffer_load_dwordx4 v1, s[4:7], s34 offen sc1 lds
    s_add_u32 m0, s32, 139264
    s_add_u32 s34, s31, s32
    s_add_u32 s34, s34, 8192
    buffer_load_dwordx4 v1, s[4:7], s34 offen sc1 lds
    s_waitcnt vmcnt(2)
    s_barrier
    s_waitcnt vmcnt(1)
    s_barrier
    s_add_u32 m0, s32, 143360
    s_add_u32 s34, s31, s32
    s_add_u32 s34, s34, 12288
    buffer_load_dwordx4 v1, s[4:7], s34 offen sc1 lds
    s_waitcnt vmcnt(1)
    s_barrier
    s_waitcnt vmcnt(1)
    s_barrier
    s_add_u32 m0, s33, 147456
    s_add_u32 s34, s31, s33
    s_add_u32 s34, s34, 16384
    buffer_load_dwordx4 v1, s[4:7], s34 offen sc1 lds
    s_waitcnt vmcnt(1)
    s_barrier
    s_waitcnt vmcnt(1)
    s_barrier
    s_waitcnt vmcnt(0)
    s_barrier
    s_barrier
    s_branch L_m_ll
L_end_m:
    s_endpgm

.section .rodata,"a"
.p2align 6
.amdhsa_kernel k0_kernel
  .amdhsa_next_free_vgpr 64
  .amdhsa_next_free_sgpr 102
  .amdhsa_accum_offset 64
  .amdhsa_group_segment_fixed_size 0
  .amdhsa_kernarg_size 88
  .amdhsa_user_sgpr_count 2
  .amdhsa_user_sgpr_kernarg_segment_ptr 1
  .amdhsa_system_sgpr_workgroup_id_x 1
  .amdhsa_float_denorm_mode_32 3
.end_amdhsa_kernel

.p2align 6
.amdhsa_kernel mega_kernel
  .amdhsa_next_free_vgpr 256
  .amdhsa_next_free_sgpr 102
  .amdhsa_accum_offset 256
  .amdhsa_group_segment_fixed_size 0
  .amdhsa_kernarg_size 88
  .amdhsa_user_sgpr_count 2
  .amdhsa_user_sgpr_kernarg_segment_ptr 1
  .amdhsa_system_sgpr_workgroup_id_x 1
  .amdhsa_float_denorm_mode_32 3
.end_amdhsa_kernel
```

```asm
; @launch grid=(256,1,1) block=(512,1,1) lds=163840
.amdgcn_target "amdgcn-amd-amdhsa--gfx950"
.text
.globl interleave_layers__sliding_local_dilated__mixer_gmlp__prompt_kernel
.p2align 8
.type interleave_layers__sliding_local_dilated__mixer_gmlp__prompt_kernel,@function
interleave_layers__sliding_local_dilated__mixer_gmlp__prompt_kernel:
    s_cmp_ge_u32 s2, 256
    s_cbranch_scc1 L_end_m
    s_load_dwordx16 s[36:51], s[0:1], 0
    s_load_dwordx4 s[56:59], s[0:1], 64
    s_load_dwordx2 s[24:25], s[0:1], 80
    v_lshrrev_b32 v2, 6, v0
    v_and_b32 v1, 63, v0
    v_lshlrev_b32 v1, 4, v1
    v_readfirstlane_b32 s23, v2
    s_mov_b32 s22, 0
    s_mov_b32 s21, 0
    s_and_b32 s20, s23, 3
    s_waitcnt lgkmcnt(0)
    s_mov_b32 s4, s24
    s_mov_b32 s5, s25
    s_mov_b32 s6, 0x10000000
    s_mov_b32 s7, 0x20000
    s_mov_b32 s8, s46
    s_mov_b32 s9, s47
    s_mov_b32 s10, 0x800000
    s_mov_b32 s11, 0x20000
    s_mov_b32 s12, s48
    s_mov_b32 s13, s49
    s_mov_b32 s14, 0x1000
    s_mov_b32 s15, 0x20000
    s_mov_b32 s16, s56
    s_mov_b32 s17, s57
    s_mov_b32 s18, 0x240000
    s_mov_b32 s19, 0x20000
    s_cmp_ge_u32 s23, 4
    s_cbranch_scc1 L_ld_m
    v_bfe_u32 v2, v1, 4, 4
    v_lshrrev_b32 v3, 8, v1
    v_bfrev_b32 v6, 1
    v_mov_b32 v11, 0x3f803f80
    s_lshl_b32 s30, s20, 12
    s_and_b32 s29, s20, 1
    s_cmp_lt_u32 s2, 128
    s_cbranch_scc1 L_p0_x
    s_cmp_lt_u32 s2, 236
    s_cbranch_scc1 L_p0_wq
    s_cmp_lt_u32 s2, 254
    s_cbranch_scc1 L_p0_wo
    s_mov_b32 s46, 0
    s_mov_b32 s47, 0
    s_mov_b32 s27, 0
    s_mov_b32 s28, 0
    s_barrier
    s_cmp_lg_u32 s2, 254
    s_cbranch_scc1 L_p0_nz
    s_cmp_lg_u32 s20, 0
    s_cbranch_scc1 L_p0_nz
    v_lshlrev_b32 v4, 4, v1
    v_mov_b32 v5, 0
    s_mov_b32 s31, 0x4500000
    buffer_store_dword v5, v4, s[4:7], s31 offen sc1
    s_mov_b32 s31, 0x4504000
    buffer_store_dword v5, v4, s[4:7], s31 offen sc1
    s_mov_b32 s31, 0x4508000
    buffer_store_dword v5, v4, s[4:7], s31 offen sc1
    s_mov_b32 s31, 0x450c000
    buffer_store_dword v5, v4, s[4:7], s31 offen sc1
    s_mov_b32 s31, 0x4510000
    buffer_store_dword v5, v4, s[4:7], s31 offen sc1
    s_mov_b32 s31, 0x4514000
    buffer_store_dword v5, v4, s[4:7], s31 offen sc1
    s_waitcnt vmcnt(0)
    s_mov_b32 s31, 1
    s_atomic_add s31, s[58:59], 0
L_p0_nz:
    s_barrier
    s_branch L_p0_cd
L_p0_wo:
    s_mul_i32 s30, s20, 9216
    s_sub_u32 s26, s2, 236
    s_mul_i32 s28, s26, 57
    s_lshr_b32 s28, s28, 9
    s_mul_i32 s27, s28, 9
    s_sub_u32 s27, s26, s27
    s_mov_b32 s32, s40
    s_mov_b32 s33, s41
    s_mov_b32 s34, 0xa2000
    s_mov_b32 s35, 0x20000
    s_mul_i32 s29, s28, 331776
    s_lshl_b32 s31, s27, 7
    s_add_u32 s29, s29, s31
    s_mul_i32 s31, s20, 82944
    s_add_u32 s29, s29, s31
    v_lshrrev_b32 v4, 7, v1
    v_mul_u32_u24 v4, 1152, v4
    v_and_b32 v5, 0x70, v1
    v_add_u32 v4, v4, v5
    s_add_u32 m0, s30, 0
    s_add_u32 s31, s29, 0
    buffer_load_dwordx4 v4, s[32:35], s31 offen nt lds
    s_add_u32 m0, s30, 1024
    s_add_u32 s31, s29, 9216
    buffer_load_dwordx4 v4, s[32:35], s31 offen nt lds
    s_add_u32 m0, s30, 2048
    s_add_u32 s31, s29, 18432
    buffer_load_dwordx4 v4, s[32:35], s31 offen nt lds
    s_add_u32 m0, s30, 3072
    s_add_u32 s31, s29, 27648
    buffer_load_dwordx4 v4, s[32:35], s31 offen nt lds
    s_add_u32 m0, s30, 4096
    s_add_u32 s31, s29, 36864
    buffer_load_dwordx4 v4, s[32:35], s31 offen nt lds
    s_add_u32 m0, s30, 5120
    s_add_u32 s31, s29, 46080
    buffer_load_dwordx4 v4, s[32:35], s31 offen nt lds
    s_add_u32 m0, s30, 6144
    s_add_u32 s31, s29, 55296
    buffer_load_dwordx4 v4, s[32:35], s31 offen nt lds
    s_add_u32 m0, s30, 7168
    s_add_u32 s31, s29, 64512
    buffer_load_dwordx4 v4, s[32:35], s31 offen nt lds
    s_add_u32 m0, s30, 8192
    s_add_u32 s31, s29, 73728
    buffer_load_dwordx4 v4, s[32:35], s31 offen nt lds
    s_barrier
    v_lshrrev_b32 v7, 2, v2
    v_and_b32 v8, 3, v2
    s_lshl_b32 s31, s20, 5
    s_add_u32 s31, s31, 0
    v_lshlrev_b32 v9, 7, v7
    v_lshl_add_u32 v9, v8, 3, v9
    v_add_u32 v9, s31, v9
    v_mul_u32_u24 v4, 512, v3
    v_add_u32 v4, v4, v9
    v_mul_u32_u24 v5, 9216, v3
    v_add_u32 v5, v5, v9
    s_lshl_b32 s31, s27, 2
    s_add_u32 s31, s31, s20
    v_lshl_add_u32 v7, s31, 2, v7
    v_lshlrev_b32 v8, 4, v8
    v_lshl_add_u32 v8, v3, 8, v8
    v_mul_u32_u24 v9, 57, v7
    v_lshrrev_b32 v9, 10, v9
    v_mul_u32_u24 v10, 18, v9
    v_sub_u32 v10, v7, v10
    v_lshrrev_b32 v12, 3, v10
    v_and_b32 v13, 1, v10
    v_lshl_add_u32 v12, v12, 1, v13
    v_bfe_u32 v14, v10, 1, 2
    v_cmp_gt_u32 vcc, 16, v10
    v_mul_u32_u24 v9, 82944, v9
    v_add_u32 v9, v9, v8
    v_cndmask_b32 v12, 8, v12, vcc
    v_cndmask_b32 v14, v13, v14, vcc
    v_mov_b32 v15, 0x1000
    v_mov_b32 v13, 0x80
    v_cndmask_b32 v15, v13, v15, vcc
    v_lshl_add_u32 v9, v12, 10, v9
    v_lshl_add_u32 v9, v14, 6, v9
    v_add_u32 v10, v9, v15
    s_and_b32 s31, s28, 1
    s_cmp_eq_u32 s31, 1
    s_cselect_b64 vcc, -1, 0
    v_cndmask_b32 v14, v9, v10, vcc
    s_mul_i32 s31, s28, 36864
    s_add_u32 s37, s31, 0x3a00000
    s_add_u32 s38, s31, 0x3a00000
    s_add_u32 s39, s31, 0x3a02400
    s_add_u32 s40, s31, 0x3a02400
    s_add_u32 s41, s31, 0x3a04800
    s_add_u32 s42, s31, 0x3a04800
    s_add_u32 s43, s31, 0x3a06c00
    s_add_u32 s47, s31, 0x3a06c00
    s_lshr_b32 s31, s28, 1
    s_mul_i32 s31, s31, 9216
    s_add_u32 s48, s31, 0x3a12000
    s_waitcnt vmcnt(0)
    s_barrier
    ds_read_b64_tr_b16 v[16:17], v4 offset:0
    ds_read_b64_tr_b16 v[18:19], v4 offset:2560
    ds_read_b64_tr_b16 v[20:21], v4 offset:4608
    ds_read_b64_tr_b16 v[22:23], v4 offset:7168
    ds_read_b64_tr_b16 v[24:25], v4 offset:9216
    ds_read_b64_tr_b16 v[26:27], v4 offset:11776
    ds_read_b64_tr_b16 v[28:29], v4 offset:13824
    ds_read_b64_tr_b16 v[30:31], v4 offset:16384
    ds_read_b64_tr_b16 v[32:33], v4 offset:18432
    ds_read_b64_tr_b16 v[34:35], v4 offset:20992
    ds_read_b64_tr_b16 v[36:37], v4 offset:23040
    ds_read_b64_tr_b16 v[38:39], v4 offset:25600
    ds_read_b64_tr_b16 v[40:41], v4 offset:27648
    ds_read_b64_tr_b16 v[42:43], v4 offset:30208
    ds_read_b64_tr_b16 v[44:45], v4 offset:32256
    ds_read_b64_tr_b16 v[46:47], v4 offset:34816
    ds_read_b64_tr_b16 v[48:49], v5 offset:2048
    ds_read_b64_tr_b16 v[50:51], v5 offset:6656
    s_waitcnt lgkmcnt(15)
    s_mov_b32 s31, s37
    buffer_store_dwordx4 v[16:19], v9, s[4:7], s31 offen sc1
    s_waitcnt lgkmcnt(14)
    s_mov_b32 s31, s38
    buffer_store_dwordx4 v[20:23], v10, s[4:7], s31 offen sc1
    s_waitcnt lgkmcnt(12)
    s_mov_b32 s31, s39
    buffer_store_dwordx4 v[24:27], v9, s[4:7], s31 offen sc1
    s_waitcnt lgkmcnt(10)
    s_mov_b32 s31, s40
    buffer_store_dwordx4 v[28:31], v10, s[4:7], s31 offen sc1
    s_waitcnt lgkmcnt(8)
    s_mov_b32 s31, s41
    buffer_store_dwordx4 v[32:35], v9, s[4:7], s31 offen sc1
    s_waitcnt lgkmcnt(6)
    s_mov_b32 s31, s42
    buffer_store_dwordx4 v[36:39], v10, s[4:7], s31 offen sc1
    s_waitcnt lgkmcnt(4)
    s_mov_b32 s31, s43
    buffer_store_dwordx4 v[40:43], v9, s[4:7], s31 offen sc1
    s_waitcnt lgkmcnt(2)
    s_mov_b32 s31, s47
    buffer_store_dwordx4 v[44:47], v10, s[4:7], s31 offen sc1
    s_waitcnt lgkmcnt(0)
    s_mov_b32 s31, s48
    buffer_store_dwordx4 v[48:51], v14, s[4:7], s31 offen sc1
    s_mov_b32 s46, 1
    s_mov_b32 s47, 0
    s_mov_b32 s27, 32
    s_mov_b32 s28, 0
    s_branch L_p0_cd
L_p0_wq:
    s_mov_b32 s32, s38
    s_mov_b32 s33, s39
    s_mov_b32 s34, 0x1e6000
    s_mov_b32 s35, 0x20000
    s_sub_u32 s23, s2, 128
    s_mul_i32 s25, s23, 19
    s_lshr_b32 s25, s25, 10
    s_mul_i32 s24, s25, 54
    s_sub_u32 s24, s23, s24
    s_mul_i32 s26, s25, 995328
    s_lshl_b32 s31, s24, 6
    s_add_u32 s26, s26, s31
    v_lshrrev_b32 v4, 6, v1
    v_mul_u32_u24 v4, 3456, v4
    v_and_b32 v5, 48, v1
    v_add_u32 v4, v4, v5
    s_mul_i32 s31, s20, 221184
    s_add_u32 s27, s26, s31
    s_add_u32 m0, s30, 0
    s_add_u32 s31, s27, 0
    buffer_load_dwordx4 v4, s[32:35], s31 offen nt lds
    s_add_u32 m0, s30, 1024
    s_add_u32 s31, s27, 55296
    buffer_load_dwordx4 v4, s[32:35], s31 offen nt lds
    s_add_u32 m0, s30, 2048
    s_add_u32 s31, s27, 110592
    buffer_load_dwordx4 v4, s[32:35], s31 offen nt lds
    s_add_u32 m0, s30, 3072
    s_add_u32 s31, s27, 165888
    buffer_load_dwordx4 v4, s[32:35], s31 offen nt lds
    s_lshl_b32 s31, s29, 10
    s_add_u32 m0, s31, 16384
    s_mul_i32 s31, s29, 55296
    s_add_u32 s31, s31, s26
    s_add_u32 s31, s31, 884736
    buffer_load_dwordx4 v4, s[32:35], s31 offen nt lds
    s_barrier
    v_lshrrev_b32 v7, 2, v2
    v_and_b32 v8, 3, v2
    s_lshl_b32 s31, s29, 5
    v_lshlrev_b32 v9, 6, v7
    v_lshl_add_u32 v9, v8, 3, v9
    v_add_u32 v9, s31, v9
    v_lshl_add_u32 v4, v3, 9, v9
    v_mul_u32_u24 v5, 4608, v3
    v_add_u32 v5, v5, v9
    s_lshl_b32 s31, s24, 1
    s_add_u32 s31, s31, s29
    v_lshl_add_u32 v7, s31, 2, v7
    v_lshlrev_b32 v8, 4, v8
    v_lshl_add_u32 v8, v3, 8, v8
    v_mul_u32_u24 v9, 57, v7
    v_lshrrev_b32 v9, 13, v9
    v_mul_u32_u24 v10, 144, v9
    v_sub_u32 v10, v7, v10
    v_mul_u32_u24 v12, 57, v10
    v_lshrrev_b32 v12, 9, v12
    v_mul_u32_u24 v13, 9, v12
    v_sub_u32 v13, v10, v13
    v_cmp_lt_u32 s[36:37], 4, v13
    v_cmp_eq_u32 s[38:39], 4, v13
    v_cmp_eq_u32 s[40:41], 2, v9
    v_lshlrev_b32 v14, 1, v9
    v_add_u32 v15, 1, v14
    v_subrev_u32 v10, 5, v13
    v_cndmask_b32 v14, v14, v15, s[36:37]
    v_cndmask_b32 v13, v13, v10, s[36:37]
    v_cndmask_b32 v14, v14, 6, s[38:39]
    v_cndmask_b32 v13, v13, v9, s[38:39]
    s_and_b64 s[40:41], s[40:41], s[38:39]
    s_mov_b32 s31, 129024
    v_mul_lo_u32 v9, v12, s31
    v_add_u32 v9, v9, v8
    v_lshl_add_u32 v9, v14, 10, v9
    v_lshl_add_u32 v9, v13, 6, v9
    v_add_u32 v15, 64, v9
    v_cndmask_b32 v15, v6, v15, s[40:41]
    v_and_b32 v10, 3, v2
    v_lshlrev_b32 v10, 2, v10
    v_lshl_add_u32 v10, v13, 4, v10
    v_lshl_add_u32 v10, v14, 6, v10
    v_lshl_add_u32 v10, v12, 10, v10
    v_cmp_eq_u32 vcc, 0, v3
    s_lshl_b32 s45, s25, 9
    s_add_u32 s45, s45, 0x4400000
    v_cndmask_b32 v10, v6, v10, vcc
    s_mul_i32 s43, s25, 7168
    s_add_u32 s44, s43, 0x381c000
    s_lshl_b32 s43, s43, 3
    s_add_u32 s42, s43, 0x3800000
    s_mul_i32 s26, s24, 57
    s_lshr_b32 s26, s26, 9
    s_mul_i32 s27, s26, 9
    s_sub_u32 s27, s24, s27
    s_cmp_lt_u32 s26, 2
    s_cselect_b32 s31, 2, 1
    s_cmp_ge_u32 s27, 1
    s_cselect_b32 s46, s31, 0
    s_cmp_le_u32 s27, 7
    s_cselect_b32 s47, s31, 0
    s_and_b32 s26, s26, 1
    s_lshl_b32 s26, s26, 3
    s_min_u32 s28, s27, 7
    s_add_u32 s28, s28, s26
    s_max_u32 s27, s27, 1
    s_sub_u32 s27, s27, 1
    s_add_u32 s27, s27, s26
    s_waitcnt vmcnt(0)
    s_barrier
    ds_read_b64_tr_b16 v[16:17], v4 offset:0
    ds_read_b64_tr_b16 v[18:19], v4 offset:256
    ds_read_b64_tr_b16 v[20:21], v4 offset:2048
    ds_read_b64_tr_b16 v[22:23], v4 offset:2304
    ds_read_b64_tr_b16 v[24:25], v4 offset:4608
    ds_read_b64_tr_b16 v[26:27], v4 offset:4864
    ds_read_b64_tr_b16 v[28:29], v4 offset:6656
    ds_read_b64_tr_b16 v[30:31], v4 offset:6912
    ds_read_b64_tr_b16 v[32:33], v4 offset:9216
    ds_read_b64_tr_b16 v[34:35], v4 offset:9472
    ds_read_b64_tr_b16 v[36:37], v4 offset:11264
    ds_read_b64_tr_b16 v[38:39], v4 offset:11520
    ds_read_b64_tr_b16 v[40:41], v4 offset:13824
    ds_read_b64_tr_b16 v[42:43], v4 offset:14080
    ds_read_b64_tr_b16 v[44:45], v4 offset:15872
    ds_read_b64_tr_b16 v[46:47], v4 offset:16128
    ds_read_b64_tr_b16 v[48:49], v5 offset:4096
    ds_read_b64_tr_b16 v[50:51], v5 offset:4352
    s_cmp_ge_u32 s20, 2
    s_cbranch_scc1 L_p0_cs
    s_waitcnt lgkmcnt(15)
    s_add_u32 s31, s42, 0
    buffer_store_dwordx4 v[16:19], v9, s[4:7], s31 offen sc1
    s_waitcnt lgkmcnt(14)
    s_add_u32 s31, s42, 7168
    buffer_store_dwordx4 v[20:23], v9, s[4:7], s31 offen sc1
    s_waitcnt lgkmcnt(12)
    s_add_u32 s31, s42, 14336
    buffer_store_dwordx4 v[24:27], v9, s[4:7], s31 offen sc1
    s_waitcnt lgkmcnt(10)
    s_add_u32 s31, s42, 21504
    buffer_store_dwordx4 v[28:31], v9, s[4:7], s31 offen sc1
    s_waitcnt lgkmcnt(8)
    s_add_u32 s31, s42, 28672
    buffer_store_dwordx4 v[32:35], v9, s[4:7], s31 offen sc1
    s_waitcnt lgkmcnt(6)
    s_add_u32 s31, s42, 35840
    buffer_store_dwordx4 v[36:39], v9, s[4:7], s31 offen sc1
    s_waitcnt lgkmcnt(4)
    s_add_u32 s31, s42, 43008
    buffer_store_dwordx4 v[40:43], v9, s[4:7], s31 offen sc1
    s_waitcnt lgkmcnt(2)
    s_add_u32 s31, s42, 50176
    buffer_store_dwordx4 v[44:47], v9, s[4:7], s31 offen sc1
    s_waitcnt lgkmcnt(0)
    s_mov_b32 s31, s44
    buffer_store_dwordx4 v[48:51], v9, s[4:7], s31 offen sc1
    s_branch L_p0_cd
L_p0_cs:
    v_mov_b32 v52, 0
    v_mov_b32 v53, 0
    v_mov_b32 v54, 0
    v_mov_b32 v55, 0
    s_cmp_eq_u64 s[40:41], 0
    s_cbranch_scc1 L_p0_np
    s_add_u32 s31, s42, 0
    buffer_store_dwordx4 v[52:55], v15, s[4:7], s31 offen sc1
    s_add_u32 s31, s42, 7168
    buffer_store_dwordx4 v[52:55], v15, s[4:7], s31 offen sc1
    s_add_u32 s31, s42, 14336
    buffer_store_dwordx4 v[52:55], v15, s[4:7], s31 offen sc1
    s_add_u32 s31, s42, 21504
    buffer_store_dwordx4 v[52:55], v15, s[4:7], s31 offen sc1
    s_add_u32 s31, s42, 28672
    buffer_store_dwordx4 v[52:55], v15, s[4:7], s31 offen sc1
    s_add_u32 s31, s42, 35840
    buffer_store_dwordx4 v[52:55], v15, s[4:7], s31 offen sc1
    s_add_u32 s31, s42, 43008
    buffer_store_dwordx4 v[52:55], v15, s[4:7], s31 offen sc1
    s_add_u32 s31, s42, 50176
    buffer_store_dwordx4 v[52:55], v15, s[4:7], s31 offen sc1
    s_mov_b32 s31, s44
    buffer_store_dwordx4 v[52:55], v15, s[4:7], s31 offen sc1
L_p0_np:
    s_waitcnt lgkmcnt(0)
    v_dot2_f32_bf16 v12, v16, v11, 0
    v_dot2_f32_bf16 v13, v17, v11, 0
    v_dot2_f32_bf16 v12, v18, v11, v12
    v_dot2_f32_bf16 v13, v19, v11, v13
    v_dot2_f32_bf16 v12, v20, v11, v12
    v_dot2_f32_bf16 v13, v21, v11, v13
    v_dot2_f32_bf16 v12, v22, v11, v12
    v_dot2_f32_bf16 v13, v23, v11, v13
    v_dot2_f32_bf16 v12, v24, v11, v12
    v_dot2_f32_bf16 v13, v25, v11, v13
    v_dot2_f32_bf16 v12, v26, v11, v12
    v_dot2_f32_bf16 v13, v27, v11, v13
    v_dot2_f32_bf16 v12, v28, v11, v12
    v_dot2_f32_bf16 v13, v29, v11, v13
    v_dot2_f32_bf16 v12, v30, v11, v12
    v_dot2_f32_bf16 v13, v31, v11, v13
    v_dot2_f32_bf16 v12, v32, v11, v12
    v_dot2_f32_bf16 v13, v33, v11, v13
    v_dot2_f32_bf16 v12, v34, v11, v12
    v_dot2_f32_bf16 v13, v35, v11, v13
    v_dot2_f32_bf16 v12, v36, v11, v12
    v_dot2_f32_bf16 v13, v37, v11, v13
    v_dot2_f32_bf16 v12, v38, v11, v12
    v_dot2_f32_bf16 v13, v39, v11, v13
    v_dot2_f32_bf16 v12, v40, v11, v12
    v_dot2_f32_bf16 v13, v41, v11, v13
    v_dot2_f32_bf16 v12, v42, v11, v12
    v_dot2_f32_bf16 v13, v43, v11, v13
    v_dot2_f32_bf16 v12, v44, v11, v12
    v_dot2_f32_bf16 v13, v45, v11, v13
    v_dot2_f32_bf16 v12, v46, v11, v12
    v_dot2_f32_bf16 v13, v47, v11, v13
    v_dot2_f32_bf16 v12, v48, v11, v12
    v_dot2_f32_bf16 v13, v49, v11, v13
    v_dot2_f32_bf16 v12, v50, v11, v12
    v_dot2_f32_bf16 v13, v51, v11, v13
    s_nop 2
    v_add_f32 v12, v12, v13
    v_mov_b32 v13, v12
    s_nop 1
    v_permlane32_swap_b32 v12, v13
    v_add_f32 v12, v12, v13
    v_mov_b32 v13, v12
    s_nop 1
    v_permlane16_swap_b32 v12, v13
    v_add_f32 v12, v12, v13
    buffer_store_dword v12, v10, s[4:7], s45 offen sc1
    s_branch L_p0_cd
L_p0_x:
    s_mov_b32 s32, s36
    s_mov_b32 s33, s37
    s_mov_b32 s34, 0x240000
    s_mov_b32 s35, 0x20000
    s_mul_i32 s26, s2, 18432
    s_mov_b32 m0, s30
    s_add_u32 s31, s26, s30
    buffer_load_dwordx4 v1, s[32:35], s31 offen offset:0 nt lds
    buffer_load_dwordx4 v1, s[32:35], s31 offen offset:1024 nt lds
    buffer_load_dwordx4 v1, s[32:35], s31 offen offset:2048 nt lds
    buffer_load_dwordx4 v1, s[32:35], s31 offen offset:3072 nt lds
    s_lshl_b32 s27, s29, 10
    s_add_u32 s27, s27, 16384
    s_mov_b32 m0, s27
    s_add_u32 s31, s26, s27
    buffer_load_dwordx4 v1, s[32:35], s31 offen nt lds
    s_barrier
    s_mul_i32 s31, s20, 288
    v_mul_u32_u24 v7, 1152, v2
    v_lshl_add_u32 v4, v3, 4, v7
    v_add_u32 v4, s31, v4
    s_mul_i32 s31, s29, 576
    v_mul_u32_u24 v5, 144, v3
    v_add3_u32 v5, v5, v7, s31
    s_add_u32 s26, s26, 0x0
    s_add_u32 s42, s26, s30
    s_add_u32 s44, s26, s27
    s_lshl_b32 s45, s2, 10
    s_lshl_b32 s31, s20, 8
    s_add_u32 s45, s45, s31
    s_add_u32 s45, s45, 0x1b00000
    v_cmp_gt_u32 vcc, 2, v3
    v_lshrrev_b32 v10, 1, v1
    s_mov_b32 s46, 2
    s_mov_b32 s47, 0
    v_cndmask_b32 v10, v6, v10, vcc
    s_lshr_b32 s27, s2, 3
    s_add_u32 s27, s27, 48
    s_mov_b32 s28, 0
    s_waitcnt vmcnt(0)
    s_barrier
    ds_read_b128 v[16:19], v4 offset:0
    ds_read_b128 v[20:23], v4 offset:64
    ds_read_b128 v[24:27], v4 offset:144
    ds_read_b128 v[28:31], v4 offset:208
    ds_read_b128 v[32:35], v5 offset:128
    s_waitcnt lgkmcnt(4)
    buffer_store_dwordx4 v[16:19], v1, s[4:7], s42 offen offset:0 sc1
    s_waitcnt lgkmcnt(3)
    buffer_store_dwordx4 v[20:23], v1, s[4:7], s42 offen offset:1024 sc1
    s_waitcnt lgkmcnt(2)
    buffer_store_dwordx4 v[24:27], v1, s[4:7], s42 offen offset:2048 sc1
    s_waitcnt lgkmcnt(1)
    buffer_store_dwordx4 v[28:31], v1, s[4:7], s42 offen offset:3072 sc1
    v_dot2_f32_bf16 v12, v16, v11, 0
    v_dot2_f32_bf16 v13, v16, v16, 0
    v_dot2_f32_bf16 v12, v17, v11, v12
    v_dot2_f32_bf16 v13, v17, v17, v13
    v_dot2_f32_bf16 v12, v18, v11, v12
    v_dot2_f32_bf16 v13, v18, v18, v13
    v_dot2_f32_bf16 v12, v19, v11, v12
    v_dot2_f32_bf16 v13, v19, v19, v13
    v_dot2_f32_bf16 v12, v20, v11, v12
    v_dot2_f32_bf16 v13, v20, v20, v13
    v_dot2_f32_bf16 v12, v21, v11, v12
    v_dot2_f32_bf16 v13, v21, v21, v13
    v_dot2_f32_bf16 v12, v22, v11, v12
    v_dot2_f32_bf16 v13, v22, v22, v13
    v_dot2_f32_bf16 v12, v23, v11, v12
    v_dot2_f32_bf16 v13, v23, v23, v13
    v_dot2_f32_bf16 v12, v24, v11, v12
    v_dot2_f32_bf16 v13, v24, v24, v13
    v_dot2_f32_bf16 v12, v25, v11, v12
    v_dot2_f32_bf16 v13, v25, v25, v13
    v_dot2_f32_bf16 v12, v26, v11, v12
    v_dot2_f32_bf16 v13, v26, v26, v13
    v_dot2_f32_bf16 v12, v27, v11, v12
    v_dot2_f32_bf16 v13, v27, v27, v13
    v_dot2_f32_bf16 v12, v28, v11, v12
    v_dot2_f32_bf16 v13, v28, v28, v13
    v_dot2_f32_bf16 v12, v29, v11, v12
    v_dot2_f32_bf16 v13, v29, v29, v13
    v_dot2_f32_bf16 v12, v30, v11, v12
    v_dot2_f32_bf16 v13, v30, v30, v13
    v_dot2_f32_bf16 v12, v31, v11, v12
    v_dot2_f32_bf16 v13, v31, v31, v13
    s_waitcnt lgkmcnt(0)
    s_cmp_ge_u32 s20, 2
    s_cbranch_scc1 L_p0_xs
    buffer_store_dwordx4 v[32:35], v1, s[4:7], s44 offen sc1
    v_dot2_f32_bf16 v12, v32, v11, v12
    v_dot2_f32_bf16 v13, v32, v32, v13
    v_dot2_f32_bf16 v12, v33, v11, v12
    v_dot2_f32_bf16 v13, v33, v33, v13
    v_dot2_f32_bf16 v12, v34, v11, v12
    v_dot2_f32_bf16 v13, v34, v34, v13
    v_dot2_f32_bf16 v12, v35, v11, v12
    v_dot2_f32_bf16 v13, v35, v35, v13
L_p0_xs:
    s_nop 2
    v_mov_b32 v14, v12
    v_mov_b32 v15, v13
    s_nop 1
    v_permlane32_swap_b32 v12, v14
    v_permlane32_swap_b32 v13, v15
    v_add_f32 v12, v12, v14
    v_add_f32 v13, v13, v15
    buffer_store_dwordx2 v[12:13], v10, s[4:7], s45 offen sc1
L_p0_cd:
    s_barrier
    s_lshl_b32 s50, s22, 7
    s_add_u32 s50, s50, s27
    s_lshl_b32 s50, s50, 8
    s_add_u32 s50, s50, 0x4500000
    s_add_u32 s50, s50, s4
    s_addc_u32 s51, s5, 0
    s_lshl_b32 s48, s22, 7
    s_add_u32 s48, s48, s28
    s_lshl_b32 s48, s48, 8
    s_add_u32 s48, s48, 0x4500000
    s_add_u32 s48, s48, s4
    s_addc_u32 s49, s5, 0
    s_cmp_lg_u32 s20, 0
    s_cbranch_scc1 L_pd_dbg
    s_mov_b32 s32, s58
    s_mov_b32 s33, s59
    s_mov_b32 s34, 0x100
    s_mov_b32 s35, 0x20000
    v_mov_b32 v4, 0
    s_mov_b32 s60, 65536
L_poll_dbg:
    buffer_load_dword v5, v4, s[32:35], 0 offen sc1
    s_waitcnt vmcnt(0)
    v_cmp_gt_u32 vcc, 1, v5
    s_sub_u32 s60, s60, 1
    s_cbranch_scc1 L_pd_dbg
    s_cbranch_vccz L_pd_dbg
    s_sleep 4
    s_branch L_poll_dbg
L_pd_dbg:
L_m_cl:
    s_and_b32 s25, s2, 7
    s_lshr_b32 s26, s2, 3
    s_lshr_b32 s23, s25, 1
    s_lshl_b32 s23, s23, 2
    s_lshr_b32 s27, s26, 3
    s_add_u32 s23, s23, s27
    s_and_b32 s24, s25, 1
    s_lshl_b32 s24, s24, 3
    s_and_b32 s27, s26, 7
    s_add_u32 s24, s24, s27
    s_lshl_b32 s30, s23, 3
    s_lshl_b32 s31, s20, 1
    s_add_u32 s31, s30, s31
    s_mul_i32 s29, s31, 18432
    s_add_u32 s29, s29, s21
    s_add_u32 s35, s29, 0x600000
    s_add_u32 s29, s29, 0x0
    s_max_u32 s30, s30, 1
    s_sub_u32 s30, s30, 1
    s_lshl_b32 s30, s30, 10
    s_add_u32 s30, s30, s21
    s_add_u32 s30, s30, 0x1b00000
    s_lshl_b32 s32, s31, 10
    s_add_u32 s32, s32, s21
    s_add_u32 s32, s32, 0x1b00000
    v_bfe_u32 v2, v1, 4, 4
    v_lshrrev_b32 v3, 8, v1
    s_add_u32 s33, s20, 2
    s_add_u32 s34, s20, 4
    s_cmp_ge_u32 s20, 2
    s_cselect_b32 s33, 6, s33
    s_cselect_b32 s34, 6, s34
    s_lshl_b32 s36, s33, 10
    s_lshl_b32 s37, s34, 10
    v_add_u32 v247, 64512, v1
    v_add_u32 v248, 131072, v1
    v_add_u32 v249, s36, v1
    v_add_u32 v250, s36, v247
    v_add_u32 v251, s37, v1
    v_add_u32 v252, s37, v247
    v_add_u32 v253, 18432, v1
    v_lshrrev_b32 v0, 1, v1
    s_add_u32 s38, s29, 0
    s_add_u32 s39, s29, 4096
    s_add_u32 s40, s29, 8192
    s_add_u32 s41, s29, 12288
    s_add_u32 s42, s29, 16384
    s_max_u32 s44, s23, 1
    s_sub_u32 s44, s44, 1
    s_lshl_b32 s52, s22, 7
    s_add_u32 s52, s52, s23
    s_lshl_b32 s52, s52, 8
    s_add_u32 s52, s52, 0x4503000
    s_add_u32 s52, s52, s4
    s_addc_u32 s53, s5, 0
    s_lshl_b32 s54, s22, 7
    s_add_u32 s54, s54, s44
    s_lshl_b32 s54, s54, 8
    s_add_u32 s54, s54, 0x4503000
    s_add_u32 s54, s54, s4
    s_addc_u32 s55, s5, 0
    s_lshl_b32 s44, s24, 8
    s_add_u32 s44, s44, 0x4500000
    s_add_u32 s44, s44, s4
    s_addc_u32 s45, s5, 0
    s_waitcnt vmcnt(0)
    s_barrier
    s_cmp_lg_u32 s20, 0
    s_cbranch_scc1 L_ns_d1
    s_atomic_add s46, s[50:51], 0
    s_cmp_eq_u32 s47, 0
    s_cbranch_scc1 L_ns_d1
    s_atomic_add s47, s[48:49], 0
L_ns_d1:
    s_barrier
    s_cmp_lg_u32 s20, 0
    s_cbranch_scc1 L_pd_d1
    s_mov_b32 s60, 65536
L_poll_d1:
    s_mov_b32 s57, 0
    s_atomic_add s57, s[52:53], 0 glc
    s_mov_b32 s58, 0
    s_atomic_add s58, s[54:55], 0 glc
    s_mov_b32 s59, 0
    s_atomic_add s59, s[44:45], 0 glc
    s_waitcnt lgkmcnt(0)
    s_min_u32 s57, s57, s58
    s_min_u32 s57, s57, s59
    s_cmp_ge_u32 s57, 16
    s_cbranch_scc1 L_pd_d1
    s_sub_u32 s60, s60, 1
    s_cbranch_scc1 L_pd_d1
    s_sleep 2
    s_branch L_poll_d1
L_pd_d1:
    s_barrier
    buffer_load_dwordx4 v[168:171], v1, s[4:7], s38 offen offset:0 sc1
    buffer_load_dwordx4 v[172:175], v253, s[4:7], s38 offen offset:0 sc1
    buffer_load_dwordx2 v[4:5], v0, s[4:7], s30 offen offset:0 sc1
    buffer_load_dwordx2 v[6:7], v0, s[4:7], s30 offen offset:512 sc1
    buffer_load_dwordx2 v[8:9], v0, s[4:7], s32 offen offset:0 sc1
    buffer_load_dwordx2 v[10:11], v0, s[4:7], s32 offen offset:512 sc1
    buffer_load_dwordx2 v[12:13], v0, s[4:7], s32 offen offset:1024 sc1
    buffer_load_dwordx2 v[14:15], v0, s[4:7], s32 offen offset:1536 sc1
    buffer_load_dwordx4 v[176:179], v1, s[4:7], s38 offen offset:1024 sc1
    buffer_load_dwordx4 v[180:183], v253, s[4:7], s38 offen offset:1024 sc1
    buffer_load_dwordx4 v[184:187], v1, s[4:7], s38 offen offset:2048 sc1
    buffer_load_dwordx4 v[188:191], v253, s[4:7], s38 offen offset:2048 sc1
    buffer_load_dwordx4 v[192:195], v1, s[4:7], s38 offen offset:3072 sc1
    buffer_load_dwordx4 v[196:199], v253, s[4:7], s38 offen offset:3072 sc1
    s_lshl_b32 s50, s22, 7
    s_add_u32 s50, s50, s23
    s_lshl_b32 s50, s50, 8
    s_add_u32 s50, s50, 0x4508000
    s_add_u32 s50, s50, s4
    s_addc_u32 s51, s5, 0
    s_barrier
    ds_read_b128 v[88:91], v1 offset:0
    ds_read_b128 v[92:95], v1 offset:1024
    ds_read_b128 v[96:99], v1 offset:2048
    ds_read_b128 v[100:103], v1 offset:3072
    ds_read_b128 v[104:107], v1 offset:4096
    ds_read_b128 v[108:111], v1 offset:5120
    ds_read_b128 v[112:115], v1 offset:6144
    ds_read_b128 v[116:119], v248 offset:0
    ds_read_b128 v[120:123], v249 offset:0
    ds_read_b128 v[124:127], v251 offset:0
    s_waitcnt vmcnt(12) lgkmcnt(6)
    v_mfma_f32_16x16x32_bf16 v[16:19], v[88:91], v[168:171], 0
    ds_read_b128 v[128:131], v1 offset:7168
    v_mfma_f32_16x16x32_bf16 v[48:51], v[88:91], v[172:175], 0
    ds_read_b128 v[132:135], v1 offset:8192
    v_mfma_f32_16x16x32_bf16 v[20:23], v[92:95], v[168:171], 0
    ds_read_b128 v[136:139], v1 offset:9216
    v_mfma_f32_16x16x32_bf16 v[52:55], v[92:95], v[172:175], 0
    ds_read_b128 v[140:143], v1 offset:10240
    v_mfma_f32_16x16x32_bf16 v[24:27], v[96:99], v[168:171], 0
    ds_read_b128 v[144:147], v1 offset:11264
    v_mfma_f32_16x16x32_bf16 v[56:59], v[96:99], v[172:175], 0
    ds_read_b128 v[148:151], v1 offset:12288
    v_mfma_f32_16x16x32_bf16 v[28:31], v[100:103], v[168:171], 0
    ds_read_b128 v[152:155], v1 offset:13312
    v_mfma_f32_16x16x32_bf16 v[60:63], v[100:103], v[172:175], 0
    ds_read_b128 v[156:159], v248 offset:1024
    s_waitcnt lgkmcnt(8)
    v_mfma_f32_16x16x32_bf16 v[36:39], v[168:171], v[104:107], 0
    ds_read_b128 v[160:163], v249 offset:7168
    v_mfma_f32_16x16x32_bf16 v[68:71], v[172:175], v[104:107], 0
    ds_read_b128 v[164:167], v251 offset:7168
    v_mfma_f32_16x16x32_bf16 v[40:43], v[168:171], v[108:111], 0
    buffer_load_dwordx4 v[200:203], v1, s[4:7], s39 offen offset:0 sc1
    v_mfma_f32_16x16x32_bf16 v[72:75], v[172:175], v[108:111], 0
    v_mfma_f32_16x16x32_bf16 v[32:35], v[112:115], v[168:171], 0
    buffer_load_dwordx4 v[204:207], v253, s[4:7], s39 offen offset:0 sc1
    v_mfma_f32_16x16x32_bf16 v[64:67], v[112:115], v[172:175], 0
    v_mfma_f32_16x16x32_bf16 v[44:47], v[168:171], v[112:115], 0
    buffer_load_dwordx4 v[208:211], v1, s[4:7], s39 offen offset:1024 sc1
    v_mfma_f32_16x16x32_bf16 v[76:79], v[172:175], v[112:115], 0
    v_mfma_f32_16x16x32_bf16 v[80:83], v[120:123], v[116:119], 0
    buffer_load_dwordx4 v[212:215], v253, s[4:7], s39 offen offset:1024 sc1
    v_mfma_f32_16x16x32_bf16 v[84:87], v[116:119], v[124:127], 0
    s_waitcnt vmcnt(8) lgkmcnt(6)
    s_barrier
    v_mfma_f32_16x16x32_bf16 v[16:19], v[128:131], v[176:179], v[16:19]
    ds_read_b128 v[88:91], v1 offset:14336
    v_mfma_f32_16x16x32_bf16 v[48:51], v[128:131], v[180:183], v[48:51]
    ds_read_b128 v[92:95], v1 offset:15360
    v_mfma_f32_16x16x32_bf16 v[20:23], v[132:135], v[176:179], v[20:23]
    ds_read_b128 v[96:99], v1 offset:16384
    v_mfma_f32_16x16x32_bf16 v[52:55], v[132:135], v[180:183], v[52:55]
    ds_read_b128 v[100:103], v1 offset:17408
    v_mfma_f32_16x16x32_bf16 v[24:27], v[136:139], v[176:179], v[24:27]
    ds_read_b128 v[104:107], v1 offset:18432
    v_mfma_f32_16x16x32_bf16 v[56:59], v[136:139], v[180:183], v[56:59]
    ds_read_b128 v[108:111], v1 offset:19456
    v_mfma_f32_16x16x32_bf16 v[28:31], v[140:143], v[176:179], v[28:31]
    ds_read_b128 v[112:115], v1 offset:20480
    v_mfma_f32_16x16x32_bf16 v[60:63], v[140:143], v[180:183], v[60:63]
    ds_read_b128 v[116:119], v248 offset:2048
    s_waitcnt lgkmcnt(8)
    v_mfma_f32_16x16x32_bf16 v[36:39], v[176:179], v[144:147], v[36:39]
    ds_read_b128 v[120:123], v249 offset:14336
    v_add_f32 v240, v4, v6
    v_mfma_f32_16x16x32_bf16 v[68:71], v[180:183], v[144:147], v[68:71]
    ds_read_b128 v[124:127], v251 offset:14336
    v_add_f32 v241, v5, v7
    v_mfma_f32_16x16x32_bf16 v[40:43], v[176:179], v[148:151], v[40:43]
    buffer_load_dwordx4 v[216:219], v1, s[4:7], s39 offen offset:2048 sc1
    v_add_f32 v242, v8, v10
    v_mfma_f32_16x16x32_bf16 v[72:75], v[180:183], v[148:151], v[72:75]
    v_add_f32 v243, v9, v11
    v_mfma_f32_16x16x32_bf16 v[32:35], v[152:155], v[176:179], v[32:35]
    buffer_load_dwordx4 v[220:223], v253, s[4:7], s39 offen offset:2048 sc1
    v_add_f32 v244, v12, v14
    v_mfma_f32_16x16x32_bf16 v[64:67], v[152:155], v[180:183], v[64:67]
    v_add_f32 v245, v13, v15
    v_mfma_f32_16x16x32_bf16 v[44:47], v[176:179], v[152:155], v[44:47]
    buffer_load_dwordx4 v[224:227], v1, s[4:7], s39 offen offset:3072 sc1
    v_mov_b32 v4, v240
    v_mfma_f32_16x16x32_bf16 v[76:79], v[180:183], v[152:155], v[76:79]
    v_mov_b32 v5, v241
    v_mfma_f32_16x16x32_bf16 v[80:83], v[160:163], v[156:159], v[80:83]
    buffer_load_dwordx4 v[228:231], v253, s[4:7], s39 offen offset:3072 sc1
    v_mov_b32 v8, v242
    v_mfma_f32_16x16x32_bf16 v[84:87], v[156:159], v[164:167], v[84:87]
    v_mov_b32 v9, v243
    s_waitcnt vmcnt(10) lgkmcnt(6)
    v_mfma_f32_16x16x32_bf16 v[16:19], v[88:91], v[184:187], v[16:19]
    ds_read_b128 v[128:131], v1 offset:21504
    v_mfma_f32_16x16x32_bf16 v[48:51], v[88:91], v[188:191], v[48:51]
    ds_read_b128 v[132:135], v1 offset:22528
    v_mfma_f32_16x16x32_bf16 v[20:23], v[92:95], v[184:187], v[20:23]
    ds_read_b128 v[136:139], v1 offset:23552
    v_mfma_f32_16x16x32_bf16 v[52:55], v[92:95], v[188:191], v[52:55]
    ds_read_b128 v[140:143], v1 offset:24576
    v_mfma_f32_16x16x32_bf16 v[24:27], v[96:99], v[184:187], v[24:27]
    ds_read_b128 v[144:147], v1 offset:25600
    v_mfma_f32_16x16x32_bf16 v[56:59], v[96:99], v[188:191], v[56:59]
    ds_read_b128 v[148:151], v1 offset:26624
    v_mfma_f32_16x16x32_bf16 v[28:31], v[100:103], v[184:187], v[28:31]
    ds_read_b128 v[152:155], v1 offset:27648
    v_mfma_f32_16x16x32_bf16 v[60:63], v[100:103], v[188:191], v[60:63]
    ds_read_b128 v[156:159], v248 offset:3072
    s_waitcnt lgkmcnt(8)
    v_mfma_f32_16x16x32_bf16 v[36:39], v[184:187], v[104:107], v[36:39]
    ds_read_b128 v[160:163], v249 offset:21504
    v_mov_b32 v12, v244
    v_mfma_f32_16x16x32_bf16 v[68:71], v[188:191], v[104:107], v[68:71]
    ds_read_b128 v[164:167], v251 offset:21504
    v_mov_b32 v13, v245
    v_mfma_f32_16x16x32_bf16 v[40:43], v[184:187], v[108:111], v[40:43]
    buffer_load_dwordx4 v[232:235], v1, s[4:7], s40 offen offset:0 sc1
    v_permlane32_swap_b32 v240, v4
    v_mfma_f32_16x16x32_bf16 v[72:75], v[188:191], v[108:111], v[72:75]
    v_permlane32_swap_b32 v241, v5
    v_mfma_f32_16x16x32_bf16 v[32:35], v[112:115], v[184:187], v[32:35]
    buffer_load_dwordx4 v[236:239], v253, s[4:7], s40 offen offset:0 sc1
    v_permlane32_swap_b32 v242, v8
    v_mfma_f32_16x16x32_bf16 v[64:67], v[112:115], v[188:191], v[64:67]
    v_permlane32_swap_b32 v243, v9
    v_mfma_f32_16x16x32_bf16 v[44:47], v[184:187], v[112:115], v[44:47]
    buffer_load_dwordx4 v[168:171], v1, s[4:7], s40 offen offset:1024 sc1
    v_permlane32_swap_b32 v244, v12
    v_mfma_f32_16x16x32_bf16 v[76:79], v[188:191], v[112:115], v[76:79]
    v_permlane32_swap_b32 v245, v13
    v_mfma_f32_16x16x32_bf16 v[80:83], v[120:123], v[116:119], v[80:83]
    buffer_load_dwordx4 v[172:175], v253, s[4:7], s40 offen offset:1024 sc1
    v_add_f32 v240, v240, v4
    v_mfma_f32_16x16x32_bf16 v[84:87], v[116:119], v[124:127], v[84:87]
    v_add_f32 v241, v241, v5
    s_waitcnt vmcnt(12) lgkmcnt(6)
    s_barrier
    v_mfma_f32_16x16x32_bf16 v[16:19], v[128:131], v[192:195], v[16:19]
    ds_read_b128 v[88:91], v1 offset:28672
    v_mfma_f32_16x16x32_bf16 v[48:51], v[128:131], v[196:199], v[48:51]
    ds_read_b128 v[92:95], v1 offset:29696
    v_mfma_f32_16x16x32_bf16 v[20:23], v[132:135], v[192:195], v[20:23]
    ds_read_b128 v[96:99], v1 offset:30720
    v_mfma_f32_16x16x32_bf16 v[52:55], v[132:135], v[196:199], v[52:55]
    ds_read_b128 v[100:103], v1 offset:31744
    v_mfma_f32_16x16x32_bf16 v[24:27], v[136:139], v[192:195], v[24:27]
    ds_read_b128 v[104:107], v1 offset:32768
    v_mfma_f32_16x16x32_bf16 v[56:59], v[136:139], v[196:199], v[56:59]
    ds_read_b128 v[108:111], v1 offset:33792
    v_mfma_f32_16x16x32_bf16 v[28:31], v[140:143], v[192:195], v[28:31]
    ds_read_b128 v[112:115], v1 offset:34816
    v_mfma_f32_16x16x32_bf16 v[60:63], v[140:143], v[196:199], v[60:63]
    ds_read_b128 v[116:119], v248 offset:4096
    s_waitcnt lgkmcnt(8)
    v_mfma_f32_16x16x32_bf16 v[36:39], v[192:195], v[144:147], v[36:39]
    ds_read_b128 v[120:123], v249 offset:28672
    v_add_f32 v242, v242, v8
    v_mfma_f32_16x16x32_bf16 v[68:71], v[196:199], v[144:147], v[68:71]
    ds_read_b128 v[124:127], v251 offset:28672
    v_add_f32 v243, v243, v9
    v_mfma_f32_16x16x32_bf16 v[40:43], v[192:195], v[148:151], v[40:43]
    buffer_load_dwordx4 v[176:179], v1, s[4:7], s40 offen offset:2048 sc1
    v_add_f32 v244, v244, v12
    v_mfma_f32_16x16x32_bf16 v[72:75], v[196:199], v[148:151], v[72:75]
    v_add_f32 v245, v245, v13
    v_mfma_f32_16x16x32_bf16 v[32:35], v[152:155], v[192:195], v[32:35]
    buffer_load_dwordx4 v[180:183], v253, s[4:7], s40 offen offset:2048 sc1
    v_mov_b32 v4, v240
    v_mfma_f32_16x16x32_bf16 v[64:67], v[152:155], v[196:199], v[64:67]
    v_mov_b32 v5, v241
    v_mfma_f32_16x16x32_bf16 v[44:47], v[192:195], v[152:155], v[44:47]
    buffer_load_dwordx4 v[184:187], v1, s[4:7], s40 offen offset:3072 sc1
    v_mov_b32 v8, v242
    v_mfma_f32_16x16x32_bf16 v[76:79], v[196:199], v[152:155], v[76:79]
    v_mov_b32 v9, v243
    v_mfma_f32_16x16x32_bf16 v[80:83], v[160:163], v[156:159], v[80:83]
    buffer_load_dwordx4 v[188:191], v253, s[4:7], s40 offen offset:3072 sc1
    v_mov_b32 v12, v244
    v_mfma_f32_16x16x32_bf16 v[84:87], v[156:159], v[164:167], v[84:87]
    v_mov_b32 v13, v245
    s_waitcnt vmcnt(14) lgkmcnt(6)
    v_mfma_f32_16x16x32_bf16 v[16:19], v[88:91], v[200:203], v[16:19]
    ds_read_b128 v[128:131], v1 offset:35840
    v_mfma_f32_16x16x32_bf16 v[48:51], v[88:91], v[204:207], v[48:51]
    ds_read_b128 v[132:135], v1 offset:36864
    v_mfma_f32_16x16x32_bf16 v[20:23], v[92:95], v[200:203], v[20:23]
    ds_read_b128 v[136:139], v1 offset:37888
    v_mfma_f32_16x16x32_bf16 v[52:55], v[92:95], v[204:207], v[52:55]
    ds_read_b128 v[140:143], v1 offset:38912
    v_mfma_f32_16x16x32_bf16 v[24:27], v[96:99], v[200:203], v[24:27]
    ds_read_b128 v[144:147], v1 offset:39936
    v_mfma_f32_16x16x32_bf16 v[56:59], v[96:99], v[204:207], v[56:59]
    ds_read_b128 v[148:151], v1 offset:40960
    v_mfma_f32_16x16x32_bf16 v[28:31], v[100:103], v[200:203], v[28:31]
    ds_read_b128 v[152:155], v1 offset:41984
    v_mfma_f32_16x16x32_bf16 v[60:63], v[100:103], v[204:207], v[60:63]
    ds_read_b128 v[156:159], v248 offset:5120
    s_waitcnt lgkmcnt(8)
    v_mfma_f32_16x16x32_bf16 v[36:39], v[200:203], v[104:107], v[36:39]
    ds_read_b128 v[160:163], v249 offset:35840
    v_permlane16_swap_b32 v240, v4
    v_mfma_f32_16x16x32_bf16 v[68:71], v[204:207], v[104:107], v[68:71]
    ds_read_b128 v[164:167], v251 offset:35840
    v_permlane16_swap_b32 v241, v5
    v_mfma_f32_16x16x32_bf16 v[40:43], v[200:203], v[108:111], v[40:43]
    buffer_load_dwordx4 v[192:195], v1, s[4:7], s41 offen offset:0 sc1
    v_permlane16_swap_b32 v242, v8
    v_mfma_f32_16x16x32_bf16 v[72:75], v[204:207], v[108:111], v[72:75]
    v_permlane16_swap_b32 v243, v9
    v_mfma_f32_16x16x32_bf16 v[32:35], v[112:115], v[200:203], v[32:35]
    buffer_load_dwordx4 v[196:199], v253, s[4:7], s41 offen offset:0 sc1
    v_permlane16_swap_b32 v244, v12
    v_mfma_f32_16x16x32_bf16 v[64:67], v[112:115], v[204:207], v[64:67]
    v_permlane16_swap_b32 v245, v13
    v_mfma_f32_16x16x32_bf16 v[44:47], v[200:203], v[112:115], v[44:47]
    v_add_f32 v240, v240, v4
    v_mfma_f32_16x16x32_bf16 v[76:79], v[204:207], v[112:115], v[76:79]
    v_add_f32 v241, v241, v5
    v_mfma_f32_16x16x32_bf16 v[80:83], v[120:123], v[116:119], v[80:83]
    v_add_f32 v242, v242, v8
    v_mfma_f32_16x16x32_bf16 v[84:87], v[116:119], v[124:127], v[84:87]
    v_add_f32 v243, v243, v9
    s_waitcnt vmcnt(14) lgkmcnt(6)
    s_barrier
    v_mfma_f32_16x16x32_bf16 v[16:19], v[128:131], v[208:211], v[16:19]
    ds_read_b128 v[88:91], v1 offset:43008
    v_mfma_f32_16x16x32_bf16 v[48:51], v[128:131], v[212:215], v[48:51]
    ds_read_b128 v[92:95], v1 offset:44032
    v_mfma_f32_16x16x32_bf16 v[20:23], v[132:135], v[208:211], v[20:23]
    ds_read_b128 v[96:99], v1 offset:45056
    v_mfma_f32_16x16x32_bf16 v[52:55], v[132:135], v[212:215], v[52:55]
    ds_read_b128 v[100:103], v1 offset:46080
    v_mfma_f32_16x16x32_bf16 v[24:27], v[136:139], v[208:211], v[24:27]
    ds_read_b128 v[104:107], v1 offset:47104
    v_mfma_f32_16x16x32_bf16 v[56:59], v[136:139], v[212:215], v[56:59]
    ds_read_b128 v[108:111], v1 offset:48128
    v_mfma_f32_16x16x32_bf16 v[28:31], v[140:143], v[208:211], v[28:31]
    ds_read_b128 v[112:115], v1 offset:49152
    v_mfma_f32_16x16x32_bf16 v[60:63], v[140:143], v[212:215], v[60:63]
    ds_read_b128 v[116:119], v248 offset:6144
    s_waitcnt lgkmcnt(8)
    v_mfma_f32_16x16x32_bf16 v[36:39], v[208:211], v[144:147], v[36:39]
    ds_read_b128 v[120:123], v249 offset:43008
    v_add_f32 v244, v244, v12
    v_mfma_f32_16x16x32_bf16 v[68:71], v[212:215], v[144:147], v[68:71]
    ds_read_b128 v[124:127], v251 offset:43008
    v_add_f32 v245, v245, v13
    v_mfma_f32_16x16x32_bf16 v[40:43], v[208:211], v[148:151], v[40:43]
    buffer_load_dwordx4 v[200:203], v1, s[4:7], s41 offen offset:1024 sc1
    v_mul_f32 v240, 0x3ae38e39, v240
    v_mfma_f32_16x16x32_bf16 v[72:75], v[212:215], v[148:151], v[72:75]
    v_mul_f32 v241, 0x3ae38e39, v241
    v_mfma_f32_16x16x32_bf16 v[32:35], v[152:155], v[208:211], v[32:35]
    buffer_load_dwordx4 v[204:207], v253, s[4:7], s41 offen offset:1024 sc1
    v_mul_f32 v242, 0x3ae38e39, v242
    v_mfma_f32_16x16x32_bf16 v[64:67], v[152:155], v[212:215], v[64:67]
    v_mul_f32 v243, 0x3ae38e39, v243
    v_mfma_f32_16x16x32_bf16 v[44:47], v[208:211], v[152:155], v[44:47]
    v_mul_f32 v244, 0x3ae38e39, v244
    v_mfma_f32_16x16x32_bf16 v[76:79], v[212:215], v[152:155], v[76:79]
    v_mul_f32 v245, 0x3ae38e39, v245
    v_mfma_f32_16x16x32_bf16 v[80:83], v[160:163], v[156:159], v[80:83]
    v_fma_f32 v241, -v240, v240, v241
    v_mfma_f32_16x16x32_bf16 v[84:87], v[156:159], v[164:167], v[84:87]
    v_fma_f32 v243, -v242, v242, v243
    s_waitcnt vmcnt(14) lgkmcnt(6)
    v_mfma_f32_16x16x32_bf16 v[16:19], v[88:91], v[216:219], v[16:19]
    ds_read_b128 v[128:131], v1 offset:50176
    v_mfma_f32_16x16x32_bf16 v[48:51], v[88:91], v[220:223], v[48:51]
    ds_read_b128 v[132:135], v1 offset:51200
    v_mfma_f32_16x16x32_bf16 v[20:23], v[92:95], v[216:219], v[20:23]
    ds_read_b128 v[136:139], v1 offset:52224
    v_mfma_f32_16x16x32_bf16 v[52:55], v[92:95], v[220:223], v[52:55]
    ds_read_b128 v[140:143], v1 offset:53248
    v_mfma_f32_16x16x32_bf16 v[24:27], v[96:99], v[216:219], v[24:27]
    ds_read_b128 v[144:147], v1 offset:54272
    v_mfma_f32_16x16x32_bf16 v[56:59], v[96:99], v[220:223], v[56:59]
    ds_read_b128 v[148:151], v1 offset:55296
    v_mfma_f32_16x16x32_bf16 v[28:31], v[100:103], v[216:219], v[28:31]
    ds_read_b128 v[152:155], v1 offset:56320
    v_mfma_f32_16x16x32_bf16 v[60:63], v[100:103], v[220:223], v[60:63]
    ds_read_b128 v[156:159], v248 offset:7168
    s_waitcnt lgkmcnt(8)
    v_mfma_f32_16x16x32_bf16 v[36:39], v[216:219], v[104:107], v[36:39]
    ds_read_b128 v[160:163], v249 offset:50176
    v_fma_f32 v245, -v244, v244, v245
    v_mfma_f32_16x16x32_bf16 v[68:71], v[220:223], v[104:107], v[68:71]
    ds_read_b128 v[164:167], v251 offset:50176
    v_max_f32 v241, 0, v241
    v_mfma_f32_16x16x32_bf16 v[40:43], v[216:219], v[108:111], v[40:43]
    buffer_load_dwordx4 v[208:211], v1, s[4:7], s41 offen offset:2048 sc1
    v_max_f32 v243, 0, v243
    v_mfma_f32_16x16x32_bf16 v[72:75], v[220:223], v[108:111], v[72:75]
    v_max_f32 v245, 0, v245
    v_mfma_f32_16x16x32_bf16 v[32:35], v[112:115], v[216:219], v[32:35]
    buffer_load_dwordx4 v[212:215], v253, s[4:7], s41 offen offset:2048 sc1
    v_add_f32 v241, 0x3727c5ac, v241
    v_mfma_f32_16x16x32_bf16 v[64:67], v[112:115], v[220:223], v[64:67]
    v_add_f32 v243, 0x3727c5ac, v243
    v_mfma_f32_16x16x32_bf16 v[44:47], v[216:219], v[112:115], v[44:47]
    v_add_f32 v245, 0x3727c5ac, v245
    v_mfma_f32_16x16x32_bf16 v[76:79], v[220:223], v[112:115], v[76:79]
    v_rsq_f32 v241, v241
    v_mfma_f32_16x16x32_bf16 v[80:83], v[120:123], v[116:119], v[80:83]
    v_rsq_f32 v243, v243
    v_mfma_f32_16x16x32_bf16 v[84:87], v[116:119], v[124:127], v[84:87]
    v_rsq_f32 v245, v245
    s_waitcnt vmcnt(14) lgkmcnt(6)
    v_mfma_f32_16x16x32_bf16 v[16:19], v[128:131], v[224:227], v[16:19]
    ds_read_b128 v[88:91], v1 offset:57344
    v_mfma_f32_16x16x32_bf16 v[48:51], v[128:131], v[228:231], v[48:51]
    ds_read_b128 v[92:95], v1 offset:58368
    v_mfma_f32_16x16x32_bf16 v[20:23], v[132:135], v[224:227], v[20:23]
    ds_read_b128 v[96:99], v1 offset:59392
    v_mfma_f32_16x16x32_bf16 v[52:55], v[132:135], v[228:231], v[52:55]
    ds_read_b128 v[100:103], v1 offset:60416
    v_mfma_f32_16x16x32_bf16 v[24:27], v[136:139], v[224:227], v[24:27]
    ds_read_b128 v[104:107], v1 offset:61440
    v_mfma_f32_16x16x32_bf16 v[56:59], v[136:139], v[228:231], v[56:59]
    ds_read_b128 v[108:111], v1 offset:62464
    v_mfma_f32_16x16x32_bf16 v[28:31], v[140:143], v[224:227], v[28:31]
    ds_read_b128 v[112:115], v1 offset:63488
    v_mfma_f32_16x16x32_bf16 v[60:63], v[140:143], v[228:231], v[60:63]
    ds_read_b128 v[116:119], v248 offset:8192
    s_waitcnt lgkmcnt(8)
    v_mfma_f32_16x16x32_bf16 v[36:39], v[224:227], v[144:147], v[36:39]
    ds_read_b128 v[120:123], v249 offset:57344
    s_nop 0
    v_mfma_f32_16x16x32_bf16 v[68:71], v[228:231], v[144:147], v[68:71]
    ds_read_b128 v[124:127], v251 offset:57344
    v_lshlrev_b32 v9, 4, v3
    v_mfma_f32_16x16x32_bf16 v[40:43], v[224:227], v[148:151], v[40:43]
    buffer_load_dwordx4 v[216:219], v1, s[4:7], s41 offen offset:3072 sc1
    v_add_u32 v4, 161792, v9
    v_mfma_f32_16x16x32_bf16 v[72:75], v[228:231], v[148:151], v[72:75]
    s_lshl_b32 s36, s33, 6
    v_mfma_f32_16x16x32_bf16 v[32:35], v[152:155], v[224:227], v[32:35]
    buffer_load_dwordx4 v[220:223], v253, s[4:7], s41 offen offset:3072 sc1
    v_add_u32 v5, s36, v4
    v_mfma_f32_16x16x32_bf16 v[64:67], v[152:155], v[228:231], v[64:67]
    v_lshlrev_b32 v8, 2, v2
    v_mfma_f32_16x16x32_bf16 v[44:47], v[224:227], v[152:155], v[44:47]
    v_add_u32 v6, 161792, v8
    v_mfma_f32_16x16x32_bf16 v[76:79], v[228:231], v[152:155], v[76:79]
    s_lshl_b32 s37, s34, 6
    v_mfma_f32_16x16x32_bf16 v[80:83], v[160:163], v[156:159], v[80:83]
    v_add_u32 v7, s37, v6
    v_mfma_f32_16x16x32_bf16 v[84:87], v[156:159], v[164:167], v[84:87]
    s_mul_i32 s36, s20, 3072
    s_waitcnt vmcnt(14) lgkmcnt(6)
    s_barrier
    v_mfma_f32_16x16x32_bf16 v[16:19], v[88:91], v[232:235], v[16:19]
    ds_read_b128 v[128:131], v247 offset:0
    v_mfma_f32_16x16x32_bf16 v[48:51], v[88:91], v[236:239], v[48:51]
    ds_read_b128 v[132:135], v247 offset:1024
    v_mfma_f32_16x16x32_bf16 v[20:23], v[92:95], v[232:235], v[20:23]
    ds_read_b128 v[136:139], v247 offset:2048
    v_mfma_f32_16x16x32_bf16 v[52:55], v[92:95], v[236:239], v[52:55]
    ds_read_b128 v[140:143], v247 offset:3072
    v_mfma_f32_16x16x32_bf16 v[24:27], v[96:99], v[232:235], v[24:27]
    ds_read_b128 v[144:147], v247 offset:4096
    v_mfma_f32_16x16x32_bf16 v[56:59], v[96:99], v[236:239], v[56:59]
    ds_read_b128 v[148:151], v247 offset:5120
    v_mfma_f32_16x16x32_bf16 v[28:31], v[100:103], v[232:235], v[28:31]
    ds_read_b128 v[152:155], v247 offset:6144
    v_mfma_f32_16x16x32_bf16 v[60:63], v[100:103], v[236:239], v[60:63]
    ds_read_b128 v[156:159], v248 offset:9216
    s_waitcnt lgkmcnt(8)
    v_mfma_f32_16x16x32_bf16 v[36:39], v[232:235], v[104:107], v[36:39]
    ds_read_b128 v[160:163], v250 offset:0
    s_add_u32 s36, s36, 153600
    v_mfma_f32_16x16x32_bf16 v[68:71], v[236:239], v[104:107], v[68:71]
    ds_read_b128 v[164:167], v252 offset:0
    v_add_u32 v8, s36, v8
    v_mfma_f32_16x16x32_bf16 v[40:43], v[232:235], v[108:111], v[40:43]
    buffer_load_dwordx4 v[224:227], v1, s[4:7], s42 offen offset:0 sc1
    v_add_u32 v9, s36, v9
    v_mfma_f32_16x16x32_bf16 v[72:75], v[236:239], v[108:111], v[72:75]
    v_add_u32 v10, 256, v6
    v_mfma_f32_16x16x32_bf16 v[32:35], v[112:115], v[232:235], v[32:35]
    buffer_load_dwordx4 v[228:231], v253, s[4:7], s42 offen offset:0 sc1
    v_add_u32 v11, 320, v6
    v_mfma_f32_16x16x32_bf16 v[64:67], v[112:115], v[236:239], v[64:67]
    v_add_u32 v12, 384, v6
    v_mfma_f32_16x16x32_bf16 v[44:47], v[232:235], v[112:115], v[44:47]
    v_mfma_f32_16x16x32_bf16 v[76:79], v[236:239], v[112:115], v[76:79]
    v_mfma_f32_16x16x32_bf16 v[80:83], v[120:123], v[116:119], v[80:83]
    v_mfma_f32_16x16x32_bf16 v[84:87], v[116:119], v[124:127], v[84:87]
    s_waitcnt vmcnt(14) lgkmcnt(6)
    v_mfma_f32_16x16x32_bf16 v[16:19], v[128:131], v[168:171], v[16:19]
    ds_write2_b32 v8, v240, v241 offset0:0 offset1:16
    ds_write2_b32 v8, v242, v243 offset0:32 offset1:48
    ds_write2_b32 v8, v244, v245 offset0:64 offset1:80
    ds_read_b128 v[88:91], v247 offset:7168
    v_mfma_f32_16x16x32_bf16 v[48:51], v[128:131], v[172:175], v[48:51]
    ds_read_b128 v[92:95], v247 offset:8192
    v_mfma_f32_16x16x32_bf16 v[20:23], v[132:135], v[168:171], v[20:23]
    ds_read_b128 v[96:99], v247 offset:9216
    v_mfma_f32_16x16x32_bf16 v[52:55], v[132:135], v[172:175], v[52:55]
    ds_read_b128 v[100:103], v247 offset:10240
    v_mfma_f32_16x16x32_bf16 v[24:27], v[136:139], v[168:171], v[24:27]
    ds_read_b128 v[104:107], v247 offset:11264
    v_mfma_f32_16x16x32_bf16 v[56:59], v[136:139], v[172:175], v[56:59]
    ds_read_b128 v[108:111], v247 offset:12288
    v_mfma_f32_16x16x32_bf16 v[28:31], v[140:143], v[168:171], v[28:31]
    ds_read_b128 v[112:115], v247 offset:13312
    v_mfma_f32_16x16x32_bf16 v[60:63], v[140:143], v[172:175], v[60:63]
    ds_read_b128 v[116:119], v248 offset:10240
    s_waitcnt lgkmcnt(8)
    v_mfma_f32_16x16x32_bf16 v[36:39], v[168:171], v[144:147], v[36:39]
    ds_read_b128 v[120:123], v250 offset:7168
    v_mfma_f32_16x16x32_bf16 v[68:71], v[172:175], v[144:147], v[68:71]
    ds_read_b128 v[124:127], v252 offset:7168
    v_mfma_f32_16x16x32_bf16 v[40:43], v[168:171], v[148:151], v[40:43]
    buffer_load_dwordx4 v[232:235], v1, s[4:7], s42 offen offset:1024 sc1
    v_mfma_f32_16x16x32_bf16 v[72:75], v[172:175], v[148:151], v[72:75]
    v_mfma_f32_16x16x32_bf16 v[32:35], v[152:155], v[168:171], v[32:35]
    buffer_load_dwordx4 v[236:239], v253, s[4:7], s42 offen offset:1024 sc1
    v_mfma_f32_16x16x32_bf16 v[64:67], v[152:155], v[172:175], v[64:67]
    v_mfma_f32_16x16x32_bf16 v[44:47], v[168:171], v[152:155], v[44:47]
    v_mfma_f32_16x16x32_bf16 v[76:79], v[172:175], v[152:155], v[76:79]
    v_mfma_f32_16x16x32_bf16 v[80:83], v[160:163], v[156:159], v[80:83]
    v_mfma_f32_16x16x32_bf16 v[84:87], v[156:159], v[164:167], v[84:87]
    s_waitcnt vmcnt(14) lgkmcnt(6)
    s_barrier
    v_mfma_f32_16x16x32_bf16 v[16:19], v[88:91], v[176:179], v[16:19]
    ds_read_b128 v[168:171], v4 offset:128
    ds_read_b128 v[172:175], v4 offset:192
    ds_read_b128 v[128:131], v247 offset:14336
    v_mfma_f32_16x16x32_bf16 v[48:51], v[88:91], v[180:183], v[48:51]
    ds_read_b128 v[132:135], v247 offset:15360
    v_mfma_f32_16x16x32_bf16 v[20:23], v[92:95], v[176:179], v[20:23]
    ds_read_b128 v[136:139], v247 offset:16384
    v_mfma_f32_16x16x32_bf16 v[52:55], v[92:95], v[180:183], v[52:55]
    ds_read_b128 v[140:143], v247 offset:17408
    v_mfma_f32_16x16x32_bf16 v[24:27], v[96:99], v[176:179], v[24:27]
    ds_read_b128 v[144:147], v247 offset:18432
    v_mfma_f32_16x16x32_bf16 v[56:59], v[96:99], v[180:183], v[56:59]
    ds_read_b128 v[148:151], v247 offset:19456
    v_mfma_f32_16x16x32_bf16 v[28:31], v[100:103], v[176:179], v[28:31]
    ds_read_b128 v[152:155], v247 offset:20480
    v_mfma_f32_16x16x32_bf16 v[60:63], v[100:103], v[180:183], v[60:63]
    ds_read_b128 v[156:159], v248 offset:11264
    s_waitcnt lgkmcnt(8)
    v_mfma_f32_16x16x32_bf16 v[36:39], v[176:179], v[104:107], v[36:39]
    ds_read_b128 v[160:163], v250 offset:14336
    v_mfma_f32_16x16x32_bf16 v[68:71], v[180:183], v[104:107], v[68:71]
    ds_read_b128 v[164:167], v252 offset:14336
    v_mfma_f32_16x16x32_bf16 v[40:43], v[176:179], v[108:111], v[40:43]
    v_mfma_f32_16x16x32_bf16 v[72:75], v[180:183], v[108:111], v[72:75]
    v_mfma_f32_16x16x32_bf16 v[32:35], v[112:115], v[176:179], v[32:35]
    v_mfma_f32_16x16x32_bf16 v[64:67], v[112:115], v[180:183], v[64:67]
    v_mfma_f32_16x16x32_bf16 v[44:47], v[176:179], v[112:115], v[44:47]
    v_mfma_f32_16x16x32_bf16 v[76:79], v[180:183], v[112:115], v[76:79]
    v_mfma_f32_16x16x32_bf16 v[80:83], v[120:123], v[116:119], v[80:83]
    v_mfma_f32_16x16x32_bf16 v[84:87], v[116:119], v[124:127], v[84:87]
    s_waitcnt vmcnt(12) lgkmcnt(6)
    v_mfma_f32_16x16x32_bf16 v[16:19], v[128:131], v[184:187], v[16:19]
    ds_read_b128 v[176:179], v4 offset:384
    ds_read_b128 v[180:183], v5 offset:0
    ds_read_b128 v[88:91], v247 offset:21504
    v_mfma_f32_16x16x32_bf16 v[48:51], v[128:131], v[188:191], v[48:51]
    ds_read_b128 v[92:95], v247 offset:22528
    v_mfma_f32_16x16x32_bf16 v[20:23], v[132:135], v[184:187], v[20:23]
    ds_read_b128 v[96:99], v247 offset:23552
    v_mfma_f32_16x16x32_bf16 v[52:55], v[132:135], v[188:191], v[52:55]
    ds_read_b128 v[100:103], v247 offset:24576
    v_mfma_f32_16x16x32_bf16 v[24:27], v[136:139], v[184:187], v[24:27]
    ds_read_b128 v[104:107], v247 offset:25600
    v_mfma_f32_16x16x32_bf16 v[56:59], v[136:139], v[188:191], v[56:59]
    ds_read_b128 v[108:111], v247 offset:26624
    v_mfma_f32_16x16x32_bf16 v[28:31], v[140:143], v[184:187], v[28:31]
    ds_read_b128 v[112:115], v247 offset:27648
    v_mfma_f32_16x16x32_bf16 v[60:63], v[140:143], v[188:191], v[60:63]
    ds_read_b128 v[116:119], v248 offset:12288
    s_waitcnt lgkmcnt(8)
    v_mfma_f32_16x16x32_bf16 v[36:39], v[184:187], v[144:147], v[36:39]
    ds_read_b128 v[120:123], v250 offset:21504
    v_mfma_f32_16x16x32_bf16 v[68:71], v[188:191], v[144:147], v[68:71]
    ds_read_b128 v[124:127], v252 offset:21504
    v_mfma_f32_16x16x32_bf16 v[40:43], v[184:187], v[148:151], v[40:43]
    v_mfma_f32_16x16x32_bf16 v[72:75], v[188:191], v[148:151], v[72:75]
    v_mfma_f32_16x16x32_bf16 v[32:35], v[152:155], v[184:187], v[32:35]
    v_mfma_f32_16x16x32_bf16 v[64:67], v[152:155], v[188:191], v[64:67]
    v_mfma_f32_16x16x32_bf16 v[44:47], v[184:187], v[152:155], v[44:47]
    v_mfma_f32_16x16x32_bf16 v[76:79], v[188:191], v[152:155], v[76:79]
    v_mfma_f32_16x16x32_bf16 v[80:83], v[160:163], v[156:159], v[80:83]
    v_mfma_f32_16x16x32_bf16 v[84:87], v[156:159], v[164:167], v[84:87]
    s_waitcnt vmcnt(10) lgkmcnt(6)
    s_barrier
    v_mfma_f32_16x16x32_bf16 v[16:19], v[88:91], v[192:195], v[16:19]
    ds_read_b128 v[184:187], v4 offset:0
    ds_read_b128 v[188:191], v4 offset:64
    ds_read_b128 v[128:131], v247 offset:28672
    v_mfma_f32_16x16x32_bf16 v[48:51], v[88:91], v[196:199], v[48:51]
    ds_read_b128 v[132:135], v247 offset:29696
    v_mfma_f32_16x16x32_bf16 v[20:23], v[92:95], v[192:195], v[20:23]
    ds_read_b128 v[136:139], v247 offset:30720
    v_mfma_f32_16x16x32_bf16 v[52:55], v[92:95], v[196:199], v[52:55]
    ds_read_b128 v[140:143], v247 offset:31744
    v_mfma_f32_16x16x32_bf16 v[24:27], v[96:99], v[192:195], v[24:27]
    ds_read_b128 v[144:147], v247 offset:32768
    v_mfma_f32_16x16x32_bf16 v[56:59], v[96:99], v[196:199], v[56:59]
    ds_read_b128 v[148:151], v247 offset:33792
    v_mfma_f32_16x16x32_bf16 v[28:31], v[100:103], v[192:195], v[28:31]
    ds_read_b128 v[152:155], v247 offset:34816
    v_mfma_f32_16x16x32_bf16 v[60:63], v[100:103], v[196:199], v[60:63]
    ds_read_b128 v[156:159], v248 offset:13312
    s_waitcnt lgkmcnt(8)
    v_mfma_f32_16x16x32_bf16 v[36:39], v[192:195], v[104:107], v[36:39]
    ds_read_b128 v[160:163], v250 offset:28672
    v_mfma_f32_16x16x32_bf16 v[68:71], v[196:199], v[104:107], v[68:71]
    ds_read_b128 v[164:167], v252 offset:28672
    v_mfma_f32_16x16x32_bf16 v[40:43], v[192:195], v[108:111], v[40:43]
    v_mfma_f32_16x16x32_bf16 v[72:75], v[196:199], v[108:111], v[72:75]
    v_mfma_f32_16x16x32_bf16 v[32:35], v[112:115], v[192:195], v[32:35]
    v_mfma_f32_16x16x32_bf16 v[64:67], v[112:115], v[196:199], v[64:67]
    v_mfma_f32_16x16x32_bf16 v[44:47], v[192:195], v[112:115], v[44:47]
    v_mfma_f32_16x16x32_bf16 v[76:79], v[196:199], v[112:115], v[76:79]
    v_mfma_f32_16x16x32_bf16 v[80:83], v[120:123], v[116:119], v[80:83]
    v_mfma_f32_16x16x32_bf16 v[84:87], v[116:119], v[124:127], v[84:87]
    s_waitcnt vmcnt(8) lgkmcnt(6)
    v_mfma_f32_16x16x32_bf16 v[16:19], v[128:131], v[200:203], v[16:19]
    ds_read_b128 v[192:195], v4 offset:640
    ds_read_b128 v[196:199], v4 offset:704
    ds_read_b128 v[88:91], v247 offset:35840
    v_mfma_f32_16x16x32_bf16 v[48:51], v[128:131], v[204:207], v[48:51]
    ds_read_b128 v[92:95], v247 offset:36864
    v_mfma_f32_16x16x32_bf16 v[20:23], v[132:135], v[200:203], v[20:23]
    ds_read_b128 v[96:99], v247 offset:37888
    v_mfma_f32_16x16x32_bf16 v[52:55], v[132:135], v[204:207], v[52:55]
    ds_read_b128 v[100:103], v247 offset:38912
    v_mfma_f32_16x16x32_bf16 v[24:27], v[136:139], v[200:203], v[24:27]
    ds_read_b128 v[104:107], v247 offset:39936
    v_mfma_f32_16x16x32_bf16 v[56:59], v[136:139], v[204:207], v[56:59]
    ds_read_b128 v[108:111], v247 offset:40960
    v_mfma_f32_16x16x32_bf16 v[28:31], v[140:143], v[200:203], v[28:31]
    ds_read_b128 v[112:115], v247 offset:41984
    v_mfma_f32_16x16x32_bf16 v[60:63], v[140:143], v[204:207], v[60:63]
    ds_read_b128 v[116:119], v248 offset:14336
    s_waitcnt lgkmcnt(8)
    v_mfma_f32_16x16x32_bf16 v[36:39], v[200:203], v[144:147], v[36:39]
    ds_read_b128 v[120:123], v250 offset:35840
    v_mfma_f32_16x16x32_bf16 v[68:71], v[204:207], v[144:147], v[68:71]
    ds_read_b128 v[124:127], v252 offset:35840
    v_mfma_f32_16x16x32_bf16 v[40:43], v[200:203], v[148:151], v[40:43]
    v_mfma_f32_16x16x32_bf16 v[72:75], v[204:207], v[148:151], v[72:75]
    v_mfma_f32_16x16x32_bf16 v[32:35], v[152:155], v[200:203], v[32:35]
    v_mfma_f32_16x16x32_bf16 v[64:67], v[152:155], v[204:207], v[64:67]
    v_mfma_f32_16x16x32_bf16 v[44:47], v[200:203], v[152:155], v[44:47]
    v_mfma_f32_16x16x32_bf16 v[76:79], v[204:207], v[152:155], v[76:79]
    v_mfma_f32_16x16x32_bf16 v[80:83], v[160:163], v[156:159], v[80:83]
    v_mfma_f32_16x16x32_bf16 v[84:87], v[156:159], v[164:167], v[84:87]
    s_waitcnt vmcnt(6) lgkmcnt(6)
    v_mfma_f32_16x16x32_bf16 v[16:19], v[88:91], v[208:211], v[16:19]
    ds_read_b128 v[200:203], v4 offset:896
    ds_read_b128 v[204:207], v5 offset:512
    ds_read_b128 v[128:131], v247 offset:43008
    v_mfma_f32_16x16x32_bf16 v[48:51], v[88:91], v[212:215], v[48:51]
    ds_read_b128 v[132:135], v247 offset:44032
    v_mfma_f32_16x16x32_bf16 v[20:23], v[92:95], v[208:211], v[20:23]
    ds_read_b128 v[136:139], v247 offset:45056
    v_mfma_f32_16x16x32_bf16 v[52:55], v[92:95], v[212:215], v[52:55]
    ds_read_b128 v[140:143], v247 offset:46080
    v_mfma_f32_16x16x32_bf16 v[24:27], v[96:99], v[208:211], v[24:27]
    ds_read_b128 v[144:147], v247 offset:47104
    v_mfma_f32_16x16x32_bf16 v[56:59], v[96:99], v[212:215], v[56:59]
    ds_read_b128 v[148:151], v247 offset:48128
    v_mfma_f32_16x16x32_bf16 v[28:31], v[100:103], v[208:211], v[28:31]
    ds_read_b128 v[152:155], v247 offset:49152
    v_mfma_f32_16x16x32_bf16 v[60:63], v[100:103], v[212:215], v[60:63]
    ds_read_b128 v[156:159], v248 offset:15360
    s_waitcnt lgkmcnt(8)
    v_mfma_f32_16x16x32_bf16 v[36:39], v[208:211], v[104:107], v[36:39]
    ds_read_b128 v[160:163], v250 offset:43008
    v_mfma_f32_16x16x32_bf16 v[68:71], v[212:215], v[104:107], v[68:71]
    ds_read_b128 v[164:167], v252 offset:43008
    v_mfma_f32_16x16x32_bf16 v[40:43], v[208:211], v[108:111], v[40:43]
    v_mfma_f32_16x16x32_bf16 v[72:75], v[212:215], v[108:111], v[72:75]
    v_mfma_f32_16x16x32_bf16 v[32:35], v[112:115], v[208:211], v[32:35]
    v_mfma_f32_16x16x32_bf16 v[64:67], v[112:115], v[212:215], v[64:67]
    v_mfma_f32_16x16x32_bf16 v[44:47], v[208:211], v[112:115], v[44:47]
    v_mfma_f32_16x16x32_bf16 v[76:79], v[212:215], v[112:115], v[76:79]
    v_mfma_f32_16x16x32_bf16 v[80:83], v[120:123], v[116:119], v[80:83]
    v_mfma_f32_16x16x32_bf16 v[84:87], v[116:119], v[124:127], v[84:87]
    s_waitcnt vmcnt(4) lgkmcnt(6)
    s_barrier
    v_mfma_f32_16x16x32_bf16 v[16:19], v[128:131], v[216:219], v[16:19]
    ds_read_b128 v[208:211], v4 offset:512
    ds_read_b128 v[212:215], v4 offset:576
    ds_read_b128 v[88:91], v247 offset:50176
    v_mfma_f32_16x16x32_bf16 v[48:51], v[128:131], v[220:223], v[48:51]
    ds_read_b128 v[92:95], v247 offset:51200
    v_mfma_f32_16x16x32_bf16 v[20:23], v[132:135], v[216:219], v[20:23]
    ds_read_b128 v[96:99], v247 offset:52224
    v_mfma_f32_16x16x32_bf16 v[52:55], v[132:135], v[220:223], v[52:55]
    ds_read_b128 v[100:103], v247 offset:53248
    v_mfma_f32_16x16x32_bf16 v[24:27], v[136:139], v[216:219], v[24:27]
    ds_read_b128 v[104:107], v247 offset:54272
    v_mfma_f32_16x16x32_bf16 v[56:59], v[136:139], v[220:223], v[56:59]
    ds_read_b128 v[108:111], v247 offset:55296
    v_mfma_f32_16x16x32_bf16 v[28:31], v[140:143], v[216:219], v[28:31]
    ds_read_b128 v[112:115], v247 offset:56320
    v_mfma_f32_16x16x32_bf16 v[60:63], v[140:143], v[220:223], v[60:63]
    ds_read_b128 v[116:119], v248 offset:16384
    s_waitcnt lgkmcnt(8)
    v_mfma_f32_16x16x32_bf16 v[36:39], v[216:219], v[144:147], v[36:39]
    ds_read_b128 v[120:123], v250 offset:50176
    v_mfma_f32_16x16x32_bf16 v[68:71], v[220:223], v[144:147], v[68:71]
    ds_read_b128 v[124:127], v252 offset:50176
    v_mfma_f32_16x16x32_bf16 v[40:43], v[216:219], v[148:151], v[40:43]
    v_mfma_f32_16x16x32_bf16 v[72:75], v[220:223], v[148:151], v[72:75]
    v_mfma_f32_16x16x32_bf16 v[32:35], v[152:155], v[216:219], v[32:35]
    v_mfma_f32_16x16x32_bf16 v[64:67], v[152:155], v[220:223], v[64:67]
    v_mfma_f32_16x16x32_bf16 v[44:47], v[216:219], v[152:155], v[44:47]
    v_mfma_f32_16x16x32_bf16 v[76:79], v[220:223], v[152:155], v[76:79]
    v_mfma_f32_16x16x32_bf16 v[80:83], v[160:163], v[156:159], v[80:83]
    v_mfma_f32_16x16x32_bf16 v[84:87], v[156:159], v[164:167], v[84:87]
    s_waitcnt vmcnt(2) lgkmcnt(6)
    v_mfma_f32_16x16x32_bf16 v[16:19], v[88:91], v[224:227], v[16:19]
    ds_read2st64_b32 v[216:217], v10 offset0:0 offset1:2
    ds_read2st64_b32 v[218:219], v11 offset0:0 offset1:2
    ds_read2st64_b32 v[220:221], v12 offset0:0 offset1:2
    ds_read2st64_b32 v[222:223], v7 offset0:0 offset1:2
    ds_read_b128 v[128:131], v247 offset:57344
    v_mfma_f32_16x16x32_bf16 v[48:51], v[88:91], v[228:231], v[48:51]
    ds_read_b128 v[132:135], v247 offset:58368
    v_mfma_f32_16x16x32_bf16 v[20:23], v[92:95], v[224:227], v[20:23]
    ds_read_b128 v[136:139], v247 offset:59392
    v_mfma_f32_16x16x32_bf16 v[52:55], v[92:95], v[228:231], v[52:55]
    ds_read_b128 v[140:143], v247 offset:60416
    v_mfma_f32_16x16x32_bf16 v[24:27], v[96:99], v[224:227], v[24:27]
    ds_read_b128 v[144:147], v247 offset:61440
    v_mfma_f32_16x16x32_bf16 v[56:59], v[96:99], v[228:231], v[56:59]
    ds_read_b128 v[148:151], v247 offset:62464
    v_mfma_f32_16x16x32_bf16 v[28:31], v[100:103], v[224:227], v[28:31]
    ds_read_b128 v[152:155], v247 offset:63488
    v_mfma_f32_16x16x32_bf16 v[60:63], v[100:103], v[228:231], v[60:63]
    ds_read_b128 v[156:159], v248 offset:17408
    s_waitcnt lgkmcnt(8)
    v_mfma_f32_16x16x32_bf16 v[36:39], v[224:227], v[104:107], v[36:39]
    ds_read_b128 v[160:163], v250 offset:57344
    v_mfma_f32_16x16x32_bf16 v[68:71], v[228:231], v[104:107], v[68:71]
    ds_read_b128 v[164:167], v252 offset:57344
    v_mfma_f32_16x16x32_bf16 v[40:43], v[224:227], v[108:111], v[40:43]
    v_add_f32 v168, v168, v192
    v_add_f32 v169, v169, v193
    v_mfma_f32_16x16x32_bf16 v[72:75], v[228:231], v[108:111], v[72:75]
    v_add_f32 v170, v170, v194
    v_add_f32 v171, v171, v195
    v_mfma_f32_16x16x32_bf16 v[32:35], v[112:115], v[224:227], v[32:35]
    v_add_f32 v172, v172, v196
    v_add_f32 v173, v173, v197
    v_mfma_f32_16x16x32_bf16 v[64:67], v[112:115], v[228:231], v[64:67]
    v_add_f32 v174, v174, v198
    v_add_f32 v175, v175, v199
    v_mfma_f32_16x16x32_bf16 v[44:47], v[224:227], v[112:115], v[44:47]
    v_add_f32 v176, v176, v200
    v_add_f32 v177, v177, v201
    v_mfma_f32_16x16x32_bf16 v[76:79], v[228:231], v[112:115], v[76:79]
    v_add_f32 v178, v178, v202
    v_add_f32 v179, v179, v203
    v_mfma_f32_16x16x32_bf16 v[80:83], v[120:123], v[116:119], v[80:83]
    v_add_f32 v180, v180, v204
    v_add_f32 v181, v181, v205
    v_mfma_f32_16x16x32_bf16 v[84:87], v[116:119], v[124:127], v[84:87]
    v_add_f32 v182, v182, v206
    v_add_f32 v183, v183, v207
    s_waitcnt vmcnt(0) lgkmcnt(6)
    v_mfma_f32_16x16x32_bf16 v[16:19], v[128:131], v[232:235], v[16:19]
    ds_read_b128 v[96:99], v9 offset:256
    v_mfma_f32_16x16x32_bf16 v[48:51], v[128:131], v[236:239], v[48:51]
    ds_read_b128 v[108:111], v9 offset:320
    v_mfma_f32_16x16x32_bf16 v[20:23], v[132:135], v[232:235], v[20:23]
    ds_read_b128 v[88:91], v9 offset:0
    v_mfma_f32_16x16x32_bf16 v[52:55], v[132:135], v[236:239], v[52:55]
    ds_read_b128 v[100:103], v9 offset:64
    v_mfma_f32_16x16x32_bf16 v[24:27], v[136:139], v[232:235], v[24:27]
    ds_read_b128 v[92:95], v9 offset:128
    v_mfma_f32_16x16x32_bf16 v[56:59], v[136:139], v[236:239], v[56:59]
    ds_read_b128 v[104:107], v9 offset:192
    v_mfma_f32_16x16x32_bf16 v[28:31], v[140:143], v[232:235], v[28:31]
    v_add_f32 v184, v184, v208
    v_add_f32 v185, v185, v209
    v_mfma_f32_16x16x32_bf16 v[60:63], v[140:143], v[236:239], v[60:63]
    s_waitcnt lgkmcnt(6)
    v_add_f32 v186, v186, v210
    v_mfma_f32_16x16x32_bf16 v[36:39], v[232:235], v[144:147], v[36:39]
    v_add_f32 v187, v187, v211
    v_add_f32 v188, v188, v212
    v_mfma_f32_16x16x32_bf16 v[68:71], v[236:239], v[144:147], v[68:71]
    v_add_f32 v189, v189, v213
    v_add_f32 v190, v190, v214
    v_mfma_f32_16x16x32_bf16 v[40:43], v[232:235], v[148:151], v[40:43]
    v_add_f32 v191, v191, v215
    v_add_f32 v216, v216, v217
    v_mfma_f32_16x16x32_bf16 v[72:75], v[236:239], v[148:151], v[72:75]
    v_add_f32 v217, v218, v219
    v_add_f32 v218, v220, v221
    v_mfma_f32_16x16x32_bf16 v[32:35], v[152:155], v[232:235], v[32:35]
    v_add_f32 v219, v222, v223
    v_mfma_f32_16x16x32_bf16 v[64:67], v[152:155], v[236:239], v[64:67]
    v_mfma_f32_16x16x32_bf16 v[44:47], v[232:235], v[152:155], v[44:47]
    v_mfma_f32_16x16x32_bf16 v[76:79], v[236:239], v[152:155], v[76:79]
    v_mfma_f32_16x16x32_bf16 v[80:83], v[160:163], v[156:159], v[80:83]
    v_mfma_f32_16x16x32_bf16 v[84:87], v[156:159], v[164:167], v[84:87]
    v_and_b32 v4, 1, v2
    v_lshl_add_u32 v5, v3, 2, v4
    v_add_u32 v6, 2, v5
    v_cmp_eq_u32 s[40:41], 1, v4
    v_cmp_le_u32 s[42:43], v5, v2
    v_cmp_le_u32 s[44:45], v6, v2
    v_cmp_eq_u32 s[46:47], 0, v3
    v_mov_b32 v4, 0xffff
    v_mov_b32 v5, 0xffff0000
    v_cndmask_b32 v4, v4, v5, s[40:41]
    v_cndmask_b32 v12, v4, 0, s[42:43]
    v_cndmask_b32 v13, v4, 0, s[44:45]
    v_cndmask_b32 v14, 0, v4, s[42:43]
    v_cndmask_b32 v15, 0, v4, s[44:45]
    s_cmp_eq_u32 s31, 0
    s_cselect_b64 s[48:49], s[42:43], -1
    s_cselect_b64 s[38:39], s[44:45], -1
    v_lshrrev_b32 v8, 1, v1
    s_mul_i32 s36, s20, 3072
    s_add_u32 s36, s36, 149504
    v_add_u32 v9, s36, v8
    s_lshl_b32 s37, s20, 9
    s_add_u32 s37, s37, 149504
    v_add_u32 v10, s37, v8
    s_waitcnt lgkmcnt(0)
    v_pk_fma_f32 v[56:57], v[244:245], v[168:169], v[56:57] op_sel_hi:[0,1,1] neg_lo:[1,0,0] neg_hi:[1,0,0]
    v_pk_fma_f32 v[58:59], v[244:245], v[170:171], v[58:59] op_sel_hi:[0,1,1] neg_lo:[1,0,0] neg_hi:[1,0,0]
    v_pk_fma_f32 v[60:61], v[244:245], v[172:173], v[60:61] op_sel_hi:[0,1,1] neg_lo:[1,0,0] neg_hi:[1,0,0]
    v_pk_fma_f32 v[62:63], v[244:245], v[174:175], v[62:63] op_sel_hi:[0,1,1] neg_lo:[1,0,0] neg_hi:[1,0,0]
    v_pk_fma_f32 v[64:65], v[244:245], v[176:177], v[64:65] op_sel_hi:[0,1,1] neg_lo:[1,0,0] neg_hi:[1,0,0]
    v_pk_fma_f32 v[66:67], v[244:245], v[178:179], v[66:67] op_sel_hi:[0,1,1] neg_lo:[1,0,0] neg_hi:[1,0,0]
    v_pk_fma_f32 v[68:69], v[96:97], v[216:217], v[68:69] op_sel:[0,0,0] op_sel_hi:[1,0,1] neg_lo:[1,0,0] neg_hi:[1,0,0]
    v_pk_fma_f32 v[70:71], v[98:99], v[216:217], v[70:71] op_sel:[0,0,0] op_sel_hi:[1,0,1] neg_lo:[1,0,0] neg_hi:[1,0,0]
    v_pk_fma_f32 v[72:73], v[96:97], v[216:217], v[72:73] op_sel:[0,1,0] op_sel_hi:[1,1,1] neg_lo:[1,0,0] neg_hi:[1,0,0]
    v_pk_fma_f32 v[74:75], v[98:99], v[216:217], v[74:75] op_sel:[0,1,0] op_sel_hi:[1,1,1] neg_lo:[1,0,0] neg_hi:[1,0,0]
    v_pk_fma_f32 v[76:77], v[96:97], v[218:219], v[76:77] op_sel:[0,0,0] op_sel_hi:[1,0,1] neg_lo:[1,0,0] neg_hi:[1,0,0]
    v_pk_fma_f32 v[78:79], v[98:99], v[218:219], v[78:79] op_sel:[0,0,0] op_sel_hi:[1,0,1] neg_lo:[1,0,0] neg_hi:[1,0,0]
    v_pk_fma_f32 v[80:81], v[240:241], v[180:181], v[80:81] op_sel_hi:[0,1,1] neg_lo:[1,0,0] neg_hi:[1,0,0]
    v_pk_fma_f32 v[82:83], v[240:241], v[182:183], v[82:83] op_sel_hi:[0,1,1] neg_lo:[1,0,0] neg_hi:[1,0,0]
    v_pk_fma_f32 v[84:85], v[88:89], v[218:219], v[84:85] op_sel:[0,1,0] op_sel_hi:[1,1,1] neg_lo:[1,0,0] neg_hi:[1,0,0]
    v_pk_fma_f32 v[86:87], v[90:91], v[218:219], v[86:87] op_sel:[0,1,0] op_sel_hi:[1,1,1] neg_lo:[1,0,0] neg_hi:[1,0,0]
    v_pk_mul_f32 v[56:57], v[56:57], v[244:245] op_sel:[0,1] op_sel_hi:[1,1]
    v_pk_mul_f32 v[58:59], v[58:59], v[244:245] op_sel:[0,1] op_sel_hi:[1,1]
    v_pk_mul_f32 v[60:61], v[60:61], v[244:245] op_sel:[0,1] op_sel_hi:[1,1]
    v_pk_mul_f32 v[62:63], v[62:63], v[244:245] op_sel:[0,1] op_sel_hi:[1,1]
    v_pk_mul_f32 v[64:65], v[64:65], v[244:245] op_sel:[0,1] op_sel_hi:[1,1]
    v_pk_mul_f32 v[66:67], v[66:67], v[244:245] op_sel:[0,1] op_sel_hi:[1,1]
    v_pk_mul_f32 v[68:69], v[68:69], v[108:109]
    v_pk_mul_f32 v[70:71], v[70:71], v[110:111]
    v_pk_mul_f32 v[72:73], v[72:73], v[108:109]
    v_pk_mul_f32 v[74:75], v[74:75], v[110:111]
    v_pk_mul_f32 v[76:77], v[76:77], v[108:109]
    v_pk_mul_f32 v[78:79], v[78:79], v[110:111]
    v_pk_mul_f32 v[80:81], v[80:81], v[240:241] op_sel:[0,1] op_sel_hi:[1,1]
    v_pk_mul_f32 v[82:83], v[82:83], v[240:241] op_sel:[0,1] op_sel_hi:[1,1]
    v_pk_mul_f32 v[84:85], v[84:85], v[100:101]
    v_pk_mul_f32 v[86:87], v[86:87], v[102:103]
    v_cvt_pk_bf16_f32 v144, v56, v57
    v_cvt_pk_bf16_f32 v145, v58, v59
    v_cvt_pk_bf16_f32 v148, v60, v61
    v_cvt_pk_bf16_f32 v149, v62, v63
    v_cvt_pk_bf16_f32 v214, v64, v65
    v_cvt_pk_bf16_f32 v215, v66, v67
    v_cvt_pk_bf16_f32 v196, v68, v69
    v_cvt_pk_bf16_f32 v197, v70, v71
    v_cvt_pk_bf16_f32 v202, v72, v73
    v_cvt_pk_bf16_f32 v203, v74, v75
    v_cvt_pk_bf16_f32 v208, v76, v77
    v_cvt_pk_bf16_f32 v209, v78, v79
    v_cvt_pk_bf16_f32 v224, v80, v81
    v_cvt_pk_bf16_f32 v225, v82, v83
    v_cvt_pk_bf16_f32 v226, v84, v85
    v_cvt_pk_bf16_f32 v227, v86, v87
    s_cmp_eq_u32 s20, 3
    s_cbranch_scc1 L_a_nw
    ds_write_b64 v9, v[144:145] offset:3072
    ds_write_b64 v9, v[148:149] offset:3584
    ds_write_b64 v9, v[214:215] offset:4096
    ds_write_b64 v9, v[196:197] offset:4608
    ds_write_b64 v9, v[202:203] offset:5120
    ds_write_b64 v9, v[208:209] offset:5632
    ds_write_b64 v10, v[224:225]
    ds_write_b64 v10, v[226:227] offset:1536
L_a_nw:
    v_pk_fma_f32 v[24:25], v[242:243], v[168:169], v[24:25] op_sel_hi:[0,1,1] neg_lo:[1,0,0] neg_hi:[1,0,0]
    v_pk_fma_f32 v[26:27], v[242:243], v[170:171], v[26:27] op_sel_hi:[0,1,1] neg_lo:[1,0,0] neg_hi:[1,0,0]
    v_pk_fma_f32 v[28:29], v[242:243], v[172:173], v[28:29] op_sel_hi:[0,1,1] neg_lo:[1,0,0] neg_hi:[1,0,0]
    v_pk_fma_f32 v[30:31], v[242:243], v[174:175], v[30:31] op_sel_hi:[0,1,1] neg_lo:[1,0,0] neg_hi:[1,0,0]
    v_pk_fma_f32 v[32:33], v[242:243], v[176:177], v[32:33] op_sel_hi:[0,1,1] neg_lo:[1,0,0] neg_hi:[1,0,0]
    v_pk_fma_f32 v[34:35], v[242:243], v[178:179], v[34:35] op_sel_hi:[0,1,1] neg_lo:[1,0,0] neg_hi:[1,0,0]
    v_pk_fma_f32 v[36:37], v[92:93], v[216:217], v[36:37] op_sel:[0,0,0] op_sel_hi:[1,0,1] neg_lo:[1,0,0] neg_hi:[1,0,0]
    v_pk_fma_f32 v[38:39], v[94:95], v[216:217], v[38:39] op_sel:[0,0,0] op_sel_hi:[1,0,1] neg_lo:[1,0,0] neg_hi:[1,0,0]
    v_pk_fma_f32 v[40:41], v[92:93], v[216:217], v[40:41] op_sel:[0,1,0] op_sel_hi:[1,1,1] neg_lo:[1,0,0] neg_hi:[1,0,0]
    v_pk_fma_f32 v[42:43], v[94:95], v[216:217], v[42:43] op_sel:[0,1,0] op_sel_hi:[1,1,1] neg_lo:[1,0,0] neg_hi:[1,0,0]
    v_pk_fma_f32 v[44:45], v[92:93], v[218:219], v[44:45] op_sel:[0,0,0] op_sel_hi:[1,0,1] neg_lo:[1,0,0] neg_hi:[1,0,0]
    v_pk_fma_f32 v[46:47], v[94:95], v[218:219], v[46:47] op_sel:[0,0,0] op_sel_hi:[1,0,1] neg_lo:[1,0,0] neg_hi:[1,0,0]
    v_pk_mul_f32 v[24:25], v[24:25], v[242:243] op_sel:[0,1] op_sel_hi:[1,1]
    v_pk_mul_f32 v[26:27], v[26:27], v[242:243] op_sel:[0,1] op_sel_hi:[1,1]
    v_pk_mul_f32 v[28:29], v[28:29], v[242:243] op_sel:[0,1] op_sel_hi:[1,1]
    v_pk_mul_f32 v[30:31], v[30:31], v[242:243] op_sel:[0,1] op_sel_hi:[1,1]
    v_pk_mul_f32 v[32:33], v[32:33], v[242:243] op_sel:[0,1] op_sel_hi:[1,1]
    v_pk_mul_f32 v[34:35], v[34:35], v[242:243] op_sel:[0,1] op_sel_hi:[1,1]
    v_pk_mul_f32 v[36:37], v[36:37], v[104:105]
    v_pk_mul_f32 v[38:39], v[38:39], v[106:107]
    v_pk_mul_f32 v[40:41], v[40:41], v[104:105]
    v_pk_mul_f32 v[42:43], v[42:43], v[106:107]
    v_pk_mul_f32 v[44:45], v[44:45], v[104:105]
    v_pk_mul_f32 v[46:47], v[46:47], v[106:107]
    v_cvt_pk_bf16_f32 v136, v24, v25
    v_cvt_pk_bf16_f32 v137, v26, v27
    v_cvt_pk_bf16_f32 v140, v28, v29
    v_cvt_pk_bf16_f32 v141, v30, v31
    v_cvt_pk_bf16_f32 v212, v32, v33
    v_cvt_pk_bf16_f32 v213, v34, v35
    v_cvt_pk_bf16_f32 v194, v36, v37
    v_cvt_pk_bf16_f32 v195, v38, v39
    v_cvt_pk_bf16_f32 v200, v40, v41
    v_cvt_pk_bf16_f32 v201, v42, v43
    v_cvt_pk_bf16_f32 v206, v44, v45
    v_cvt_pk_bf16_f32 v207, v46, v47
    s_waitcnt lgkmcnt(0)
    s_barrier
    ds_read_b64 v[128:129], v9 offset:0
    ds_read_b64 v[132:133], v9 offset:512
    ds_read_b64 v[210:211], v9 offset:1024
    ds_read_b64 v[192:193], v9 offset:1536
    ds_read_b64 v[198:199], v9 offset:2048
    ds_read_b64 v[204:205], v9 offset:2560
    v_pk_fma_f32 v[16:17], v[242:243], v[184:185], v[16:17] op_sel_hi:[0,1,1] neg_lo:[1,0,0] neg_hi:[1,0,0]
    v_pk_fma_f32 v[18:19], v[242:243], v[186:187], v[18:19] op_sel_hi:[0,1,1] neg_lo:[1,0,0] neg_hi:[1,0,0]
    v_pk_fma_f32 v[20:21], v[242:243], v[188:189], v[20:21] op_sel_hi:[0,1,1] neg_lo:[1,0,0] neg_hi:[1,0,0]
    v_pk_fma_f32 v[22:23], v[242:243], v[190:191], v[22:23] op_sel_hi:[0,1,1] neg_lo:[1,0,0] neg_hi:[1,0,0]
    v_pk_fma_f32 v[48:49], v[244:245], v[184:185], v[48:49] op_sel_hi:[0,1,1] neg_lo:[1,0,0] neg_hi:[1,0,0]
    v_pk_fma_f32 v[50:51], v[244:245], v[186:187], v[50:51] op_sel_hi:[0,1,1] neg_lo:[1,0,0] neg_hi:[1,0,0]
    v_pk_fma_f32 v[52:53], v[244:245], v[188:189], v[52:53] op_sel_hi:[0,1,1] neg_lo:[1,0,0] neg_hi:[1,0,0]
    v_pk_fma_f32 v[54:55], v[244:245], v[190:191], v[54:55] op_sel_hi:[0,1,1] neg_lo:[1,0,0] neg_hi:[1,0,0]
    v_pk_mul_f32 v[16:17], v[16:17], v[242:243] op_sel:[0,1] op_sel_hi:[1,1]
    v_pk_mul_f32 v[18:19], v[18:19], v[242:243] op_sel:[0,1] op_sel_hi:[1,1]
    v_pk_mul_f32 v[20:21], v[20:21], v[242:243] op_sel:[0,1] op_sel_hi:[1,1]
    v_pk_mul_f32 v[22:23], v[22:23], v[242:243] op_sel:[0,1] op_sel_hi:[1,1]
    v_pk_mul_f32 v[48:49], v[48:49], v[244:245] op_sel:[0,1] op_sel_hi:[1,1]
    v_pk_mul_f32 v[50:51], v[50:51], v[244:245] op_sel:[0,1] op_sel_hi:[1,1]
    v_pk_mul_f32 v[52:53], v[52:53], v[244:245] op_sel:[0,1] op_sel_hi:[1,1]
    v_pk_mul_f32 v[54:55], v[54:55], v[244:245] op_sel:[0,1] op_sel_hi:[1,1]
    v_cvt_pk_bf16_f32 v152, v16, v17
    v_cvt_pk_bf16_f32 v153, v18, v19
    v_cvt_pk_bf16_f32 v156, v20, v21
    v_cvt_pk_bf16_f32 v157, v22, v23
    v_cvt_pk_bf16_f32 v160, v48, v49
    v_cvt_pk_bf16_f32 v161, v50, v51
    v_cvt_pk_bf16_f32 v164, v52, v53
    v_cvt_pk_bf16_f32 v165, v54, v55
    v_cndmask_b32 v154, 0, v212, s[46:47]
    v_mov_b32 v155, 0
    v_cndmask_b32 v158, 0, v213, s[46:47]
    v_mov_b32 v159, 0
    v_cndmask_b32 v162, 0, v214, s[46:47]
    v_mov_b32 v163, 0
    v_cndmask_b32 v166, 0, v215, s[46:47]
    v_mov_b32 v167, 0
    v_mov_b32 v131, 0
    v_mov_b32 v135, 0
    v_mov_b32 v139, 0
    v_mov_b32 v143, 0
    v_mov_b32 v147, 0
    v_mov_b32 v151, 0
    s_waitcnt lgkmcnt(0)
    v_permlane16_swap_b32 v212, v138
    v_permlane16_swap_b32 v213, v142
    v_permlane16_swap_b32 v214, v146
    v_permlane16_swap_b32 v215, v150
    v_permlane16_swap_b32 v210, v130
    v_permlane16_swap_b32 v211, v134
    v_cndmask_b32 v138, 0, v138, s[46:47]
    v_cndmask_b32 v142, 0, v142, s[46:47]
    v_cndmask_b32 v146, 0, v146, s[46:47]
    v_cndmask_b32 v150, 0, v150, s[46:47]
    v_cndmask_b32 v130, 0, v130, s[46:47]
    v_cndmask_b32 v134, 0, v134, s[46:47]
    s_nop 1
    v_mfma_f32_16x16x32_bf16 v[20:23], v[144:147], v[160:163], 0
    v_mfma_f32_16x16x32_bf16 v[16:19], v[136:139], v[160:163], 0
    v_mfma_f32_16x16x32_bf16 v[28:31], v[148:151], v[164:167], 0
    v_mfma_f32_16x16x32_bf16 v[24:27], v[140:143], v[164:167], 0
    v_mfma_f32_16x16x32_bf16 v[36:39], v[136:139], v[152:155], 0
    v_mfma_f32_16x16x32_bf16 v[32:35], v[128:131], v[152:155], 0
    v_mfma_f32_16x16x32_bf16 v[44:47], v[140:143], v[156:159], 0
    v_mfma_f32_16x16x32_bf16 v[40:43], v[132:135], v[156:159], 0
    s_lshl_b32 s36, s24, 10
    v_add_u32 v4, s36, v1
    v_add_u32 v5, 18432, v4
    s_lshl_b32 s36, s24, 7
    s_add_u32 s36, s36, 16384
    v_cmp_eq_u32 vcc, 2, v3
    v_lshl_add_u32 v6, v2, 3, s36
    v_bfrev_b32 v7, 1
    v_cndmask_b32 v6, v7, v6, vcc
    v_add_u32 v7, 18432, v6
    v_mov_b32 v8, 0xf149f2ca
    s_mov_b32 s33, 0x3eae1a93
    v_cndmask_b32 v20, v20, v21, s[40:41]
    v_cndmask_b32 v16, v16, v17, s[40:41]
    v_cndmask_b32 v48, v16, v20, s[42:43]
    v_cndmask_b32 v22, v22, v23, s[40:41]
    v_cndmask_b32 v18, v18, v19, s[40:41]
    v_cndmask_b32 v49, v18, v22, s[44:45]
    v_max_f32 v56, v48, v49
    v_cndmask_b32 v28, v28, v29, s[40:41]
    v_cndmask_b32 v24, v24, v25, s[40:41]
    v_cndmask_b32 v50, v24, v28, s[42:43]
    v_cndmask_b32 v30, v30, v31, s[40:41]
    v_cndmask_b32 v26, v26, v27, s[40:41]
    v_cndmask_b32 v51, v26, v30, s[44:45]
    v_max_f32 v57, v50, v51
    v_cndmask_b32 v36, v36, v37, s[40:41]
    v_cndmask_b32 v32, v32, v33, s[40:41]
    v_cndmask_b32 v52, v32, v36, s[42:43]
    v_cndmask_b32 v52, v8, v52, s[48:49]
    v_cndmask_b32 v38, v38, v39, s[40:41]
    v_cndmask_b32 v34, v34, v35, s[40:41]
    v_cndmask_b32 v53, v34, v38, s[44:45]
    v_cndmask_b32 v53, v8, v53, s[38:39]
    v_max_f32 v58, v52, v53
    v_cndmask_b32 v44, v44, v45, s[40:41]
    v_cndmask_b32 v40, v40, v41, s[40:41]
    v_cndmask_b32 v54, v40, v44, s[42:43]
    v_cndmask_b32 v54, v8, v54, s[48:49]
    v_cndmask_b32 v46, v46, v47, s[40:41]
    v_cndmask_b32 v42, v42, v43, s[40:41]
    v_cndmask_b32 v55, v42, v46, s[44:45]
    v_cndmask_b32 v55, v8, v55, s[38:39]
    v_max_f32 v59, v54, v55
    v_mov_b32 v60, v56
    v_mov_b32 v61, v57
    v_mov_b32 v62, v58
    v_mov_b32 v63, v59
    v_permlane32_swap_b32 v56, v60
    v_permlane32_swap_b32 v57, v61
    v_permlane32_swap_b32 v58, v62
    v_permlane32_swap_b32 v59, v63
    v_max_f32 v56, v56, v60
    v_max_f32 v57, v57, v61
    v_max_f32 v58, v58, v62
    v_max_f32 v59, v59, v63
    v_mov_b32 v60, v56
    v_mov_b32 v61, v57
    v_mov_b32 v62, v58
    v_mov_b32 v63, v59
    v_permlane16_swap_b32 v56, v60
    v_permlane16_swap_b32 v57, v61
    v_permlane16_swap_b32 v58, v62
    v_permlane16_swap_b32 v59, v63
    v_max_f32 v56, v56, v60
    v_max_f32 v57, v57, v61
    v_max_f32 v58, v58, v62
    v_max_f32 v59, v59, v63
    v_mul_f32 v56, s33, v56
    v_mul_f32 v57, s33, v57
    v_mul_f32 v58, s33, v58
    v_mul_f32 v59, s33, v59
    v_fma_f32 v48, v48, s33, -v56
    v_fma_f32 v49, v49, s33, -v56
    v_fma_f32 v50, v50, s33, -v57
    v_fma_f32 v51, v51, s33, -v57
    v_fma_f32 v52, v52, s33, -v58
    v_fma_f32 v53, v53, s33, -v58
    v_fma_f32 v54, v54, s33, -v59
    v_fma_f32 v55, v55, s33, -v59
    v_exp_f32 v48, v48
    v_exp_f32 v49, v49
    v_exp_f32 v50, v50
    v_exp_f32 v51, v51
    v_exp_f32 v52, v52
    v_exp_f32 v53, v53
    v_exp_f32 v54, v54
    v_exp_f32 v55, v55
    v_add_f32 v56, v48, v49
    v_add_f32 v57, v50, v51
    v_add_f32 v58, v52, v53
    v_add_f32 v59, v54, v55
    v_mov_b32 v60, v56
    v_mov_b32 v61, v57
    v_mov_b32 v62, v58
    v_mov_b32 v63, v59
    v_permlane32_swap_b32 v56, v60
    v_permlane32_swap_b32 v57, v61
    v_permlane32_swap_b32 v58, v62
    v_permlane32_swap_b32 v59, v63
    v_add_f32 v56, v56, v60
    v_add_f32 v57, v57, v61
    v_add_f32 v58, v58, v62
    v_add_f32 v59, v59, v63
    v_mov_b32 v60, v56
    v_mov_b32 v61, v57
    v_mov_b32 v62, v58
    v_mov_b32 v63, v59
    v_permlane16_swap_b32 v56, v60
    v_permlane16_swap_b32 v57, v61
    v_permlane16_swap_b32 v58, v62
    v_permlane16_swap_b32 v59, v63
    v_add_f32 v56, v56, v60
    v_add_f32 v57, v57, v61
    v_add_f32 v58, v58, v62
    v_add_f32 v59, v59, v63
    v_rcp_f32 v56, v56
    v_rcp_f32 v57, v57
    v_rcp_f32 v58, v58
    v_rcp_f32 v59, v59
    v_mul_f32 v48, v48, v56
    v_mul_f32 v49, v49, v56
    v_mul_f32 v50, v50, v57
    v_mul_f32 v51, v51, v57
    v_mul_f32 v52, v52, v58
    v_mul_f32 v53, v53, v58
    v_mul_f32 v54, v54, v59
    v_mul_f32 v55, v55, v59
    v_cvt_pk_bf16_f32 v48, v48, v48
    v_cvt_pk_bf16_f32 v49, v49, v49
    v_cvt_pk_bf16_f32 v50, v50, v50
    v_cvt_pk_bf16_f32 v51, v51, v51
    v_cvt_pk_bf16_f32 v52, v52, v52
    v_cvt_pk_bf16_f32 v53, v53, v53
    v_cvt_pk_bf16_f32 v54, v54, v54
    v_cvt_pk_bf16_f32 v55, v55, v55
    v_and_b32 v64, v48, v12
    v_and_b32 v65, v49, v13
    v_and_b32 v66, v48, v14
    v_and_b32 v67, v49, v15
    v_and_b32 v68, v50, v12
    v_and_b32 v69, v51, v13
    v_and_b32 v70, v50, v14
    v_and_b32 v71, v51, v15
    v_and_b32 v72, v52, v12
    v_and_b32 v73, v53, v13
    v_and_b32 v74, v52, v14
    v_and_b32 v75, v53, v15
    v_and_b32 v76, v54, v12
    v_and_b32 v77, v55, v13
    v_and_b32 v78, v54, v14
    v_and_b32 v79, v55, v15
    s_nop 1
    v_mfma_f32_16x16x32_bf16 v[16:19], v[194:197], v[64:67], 0
    v_mfma_f32_16x16x32_bf16 v[20:23], v[206:209], v[64:67], 0
    v_mfma_f32_16x16x32_bf16 v[24:27], v[200:203], v[68:71], 0
    v_mfma_f32_16x16x32_bf16 v[28:31], v[206:209], v[68:71], 0
    v_mfma_f32_16x16x32_bf16 v[32:35], v[192:195], v[72:75], 0
    v_mfma_f32_16x16x32_bf16 v[36:39], v[204:207], v[72:75], 0
    v_mfma_f32_16x16x32_bf16 v[40:43], v[198:201], v[76:79], 0
    v_mfma_f32_16x16x32_bf16 v[44:47], v[204:207], v[76:79], 0
    s_nop 3
    v_cvt_pk_bf16_f32 v224, v16, v17
    v_cvt_pk_bf16_f32 v225, v18, v19
    v_cvt_pk_bf16_f32 v228, v20, v21
    v_cvt_pk_bf16_f32 v226, v24, v25
    v_cvt_pk_bf16_f32 v227, v26, v27
    v_cvt_pk_bf16_f32 v229, v30, v31
    buffer_store_dwordx4 v[224:227], v5, s[4:7], s35 offen sc1
    buffer_store_dwordx2 v[228:229], v7, s[4:7], s35 offen sc1
    s_nop 0
    v_cvt_pk_bf16_f32 v232, v32, v33
    v_cvt_pk_bf16_f32 v233, v34, v35
    v_cvt_pk_bf16_f32 v236, v36, v37
    v_cvt_pk_bf16_f32 v234, v40, v41
    v_cvt_pk_bf16_f32 v235, v42, v43
    v_cvt_pk_bf16_f32 v237, v46, v47
    buffer_store_dwordx4 v[232:235], v4, s[4:7], s35 offen sc1
    buffer_store_dwordx2 v[236:237], v6, s[4:7], s35 offen sc1
    s_and_b32 s25, s2, 7
    s_lshr_b32 s26, s2, 3
    s_lshl_b32 s23, s25, 2
    s_lshr_b32 s27, s26, 3
    s_add_u32 s23, s23, s27
    s_and_b32 s24, s26, 7
    s_add_u32 s25, s23, s24
    s_and_b32 s25, s25, 3
    s_lshl_b32 s30, s23, 2
    s_add_u32 s30, s30, s20
    s_mul_i32 s29, s30, 18432
    s_add_u32 s29, s29, s21
    s_add_u32 s29, s29, 0x600000
    s_mul_i32 s34, s30, 18432
    s_add_u32 s34, s34, s21
    s_add_u32 s34, s34, 0x0
    s_lshl_b32 s35, s24, 11
    s_lshr_b32 s36, s24, 2
    s_lshl_b32 s36, s36, 10
    s_and_b32 s37, s24, 3
    s_lshl_b32 s37, s37, 8
    s_add_u32 s36, s36, s37
    s_add_u32 s36, s36, 16384
    v_bfe_u32 v2, v1, 4, 4
    v_lshrrev_b32 v3, 8, v1
    v_add_u32 v4, s35, v1
    v_lshlrev_b32 v5, 4, v2
    v_lshl_add_u32 v5, v3, 3, v5
    v_add_u32 v5, s36, v5
    v_cmp_gt_u32 s[40:41], 2, v3
    v_bfrev_b32 v6, 1
    v_add_u32 v12, 0, v1
    v_add_u32 v13, 36864, v1
    v_add_u32 v14, 73728, v1
    v_add_u32 v15, 110592, v1
    v_cndmask_b32 v5, v6, v5, s[40:41]
    buffer_load_dwordx4 v[208:211], v4, s[4:7], s34 offen offset:0 sc1
    buffer_load_dwordx4 v[212:215], v4, s[4:7], s34 offen offset:1024 sc1
    buffer_load_dwordx2 v[216:217], v5, s[4:7], s34 offen sc1
    s_add_u32 s34, s34, 0x300000
    s_lshl_b32 s39, s30, 10
    s_add_u32 s39, s39, s21
    s_lshl_b32 s42, s24, 7
    s_add_u32 s39, s39, s42
    s_add_u32 s39, s39, 0x1b20000
    v_cmp_eq_u32 vcc, 0, v3
    v_lshlrev_b32 v10, 3, v2
    v_mov_b32 v11, 0x3f803f80
    v_lshl_add_u32 v7, v3, 8, v10
    v_cndmask_b32 v10, v6, v10, vcc
    s_lshr_b32 s44, s23, 1
    s_lshl_b32 s52, s22, 7
    s_add_u32 s52, s52, s44
    s_lshl_b32 s52, s52, 8
    s_add_u32 s52, s52, 0x4508000
    s_add_u32 s52, s52, s4
    s_addc_u32 s53, s5, 0
    s_waitcnt vmcnt(0)
    s_barrier
    s_cmp_lg_u32 s20, 0
    s_cbranch_scc1 L_ns_d2
    s_mov_b32 s56, 1
    s_atomic_add s56, s[50:51], 0
L_ns_d2:
    v_lshlrev_b32 v16, 16, v208
    v_and_b32 v17, 0xffff0000, v208
    v_lshlrev_b32 v18, 16, v209
    v_and_b32 v19, 0xffff0000, v209
    v_lshlrev_b32 v20, 16, v210
    v_and_b32 v21, 0xffff0000, v210
    v_lshlrev_b32 v22, 16, v211
    v_and_b32 v23, 0xffff0000, v211
    v_lshlrev_b32 v24, 16, v212
    v_and_b32 v25, 0xffff0000, v212
    v_lshlrev_b32 v26, 16, v213
    v_and_b32 v27, 0xffff0000, v213
    v_lshlrev_b32 v28, 16, v214
    v_and_b32 v29, 0xffff0000, v214
    v_lshlrev_b32 v30, 16, v215
    v_and_b32 v31, 0xffff0000, v215
    v_lshlrev_b32 v32, 16, v216
    v_and_b32 v33, 0xffff0000, v216
    v_lshlrev_b32 v34, 16, v217
    v_and_b32 v35, 0xffff0000, v217
    s_cmp_lg_u32 s20, 0
    s_cbranch_scc1 L_pd_d2
    s_mov_b32 s60, 65536
L_poll_d2:
    s_mov_b32 s57, 0
    s_atomic_add s57, s[52:53], 0 glc
    s_waitcnt lgkmcnt(0)
    s_cmp_ge_u32 s57, 16
    s_cbranch_scc1 L_pd_d2
    s_sub_u32 s60, s60, 1
    s_cbranch_scc1 L_pd_d2
    s_sleep 2
    s_branch L_poll_d2
L_pd_d2:
    s_barrier
    s_mov_b32 s32, 0
    s_lshl_b32 s32, s32, 13
    s_add_u32 s32, s32, s29
    s_add_u32 s33, s32, 4096
    buffer_load_dwordx4 v[112:115], v1, s[4:7], s32 offen offset:0 sc1
    buffer_load_dwordx4 v[116:119], v1, s[4:7], s32 offen offset:1024 sc1
    buffer_load_dwordx4 v[120:123], v1, s[4:7], s32 offen offset:2048 sc1
    buffer_load_dwordx4 v[124:127], v1, s[4:7], s32 offen offset:3072 sc1
    buffer_load_dwordx4 v[128:131], v1, s[4:7], s33 offen offset:0 sc1
    buffer_load_dwordx4 v[132:135], v1, s[4:7], s33 offen offset:1024 sc1
    buffer_load_dwordx4 v[136:139], v1, s[4:7], s33 offen offset:2048 sc1
    buffer_load_dwordx4 v[140:143], v1, s[4:7], s33 offen offset:3072 sc1
    ds_read_b128 v[40:43], v12 offset:18432
    ds_read_b128 v[44:47], v12 offset:19456
    ds_read_b128 v[48:51], v12 offset:20480
    ds_read_b128 v[52:55], v12 offset:21504
    ds_read_b128 v[72:75], v12 offset:26624
    ds_read_b128 v[56:59], v12 offset:22528
    ds_read_b128 v[60:63], v12 offset:23552
    ds_read_b128 v[64:67], v12 offset:24576
    ds_read_b128 v[68:71], v12 offset:25600
    s_mov_b32 s32, 1
    s_lshl_b32 s32, s32, 13
    s_add_u32 s32, s32, s29
    s_add_u32 s33, s32, 4096
    buffer_load_dwordx4 v[144:147], v1, s[4:7], s32 offen offset:0 sc1
    buffer_load_dwordx4 v[148:151], v1, s[4:7], s32 offen offset:1024 sc1
    buffer_load_dwordx4 v[152:155], v1, s[4:7], s32 offen offset:2048 sc1
    buffer_load_dwordx4 v[156:159], v1, s[4:7], s32 offen offset:3072 sc1
    buffer_load_dwordx4 v[160:163], v1, s[4:7], s33 offen offset:0 sc1
    buffer_load_dwordx4 v[164:167], v1, s[4:7], s33 offen offset:1024 sc1
    buffer_load_dwordx4 v[168:171], v1, s[4:7], s33 offen offset:2048 sc1
    buffer_load_dwordx4 v[172:175], v1, s[4:7], s33 offen offset:3072 sc1
    s_mov_b32 s32, 2
    s_lshl_b32 s32, s32, 13
    s_add_u32 s32, s32, s29
    s_add_u32 s33, s32, 4096
    buffer_load_dwordx2 v[176:177], v7, s[4:7], s32 offen offset:0 sc1
    buffer_load_dwordx2 v[178:179], v7, s[4:7], s32 offen offset:128 sc1
    buffer_load_dwordx2 v[180:181], v7, s[4:7], s32 offen offset:1024 sc1
    buffer_load_dwordx2 v[182:183], v7, s[4:7], s32 offen offset:1152 sc1
    s_lshl_b32 s42, s23, 3
    s_add_u32 s42, s42, s24
    s_lshl_b32 s42, s42, 2
    s_add_u32 s42, s42, s20
    s_lshl_b32 s42, s42, 8
    s_add_u32 s42, s42, s21
    s_add_u32 s42, s42, 0x1b40000
    v_mov_b32 v220, -1.0
    v_lshrrev_b32 v221, 2, v1
    buffer_store_dword v220, v221, s[4:7], s42 offen sc1
    s_lshl_b32 s50, s22, 7
    s_add_u32 s50, s50, s44
    s_lshl_b32 s50, s50, 8
    s_add_u32 s50, s50, 0x4509000
    s_add_u32 s50, s50, s4
    s_addc_u32 s51, s5, 0
    s_waitcnt vmcnt(19) lgkmcnt(4)
    v_mfma_f32_16x16x32_bf16 v[16:19], v[40:43], v[112:115], v[16:19]
    ds_read_b128 v[76:79], v12 offset:27648
    v_mfma_f32_16x16x32_bf16 v[20:23], v[44:47], v[112:115], v[20:23]
    ds_read_b128 v[80:83], v12 offset:28672
    v_mfma_f32_16x16x32_bf16 v[24:27], v[48:51], v[112:115], v[24:27]
    ds_read_b128 v[84:87], v12 offset:29696
    v_mfma_f32_16x16x32_bf16 v[28:31], v[52:55], v[112:115], v[28:31]
    ds_read_b128 v[88:91], v12 offset:30720
    v_mfma_f32_16x16x32_bf16 v[32:35], v[72:75], v[112:115], v[32:35]
    ds_read_b128 v[108:111], v12 offset:35840
    s_waitcnt lgkmcnt(5)
    v_mfma_f32_16x16x32_bf16 v[16:19], v[56:59], v[116:119], v[16:19]
    ds_read_b128 v[92:95], v12 offset:31744
    v_mfma_f32_16x16x32_bf16 v[20:23], v[60:63], v[116:119], v[20:23]
    ds_read_b128 v[96:99], v12 offset:32768
    v_mfma_f32_16x16x32_bf16 v[24:27], v[64:67], v[116:119], v[24:27]
    ds_read_b128 v[100:103], v12 offset:33792
    v_mfma_f32_16x16x32_bf16 v[28:31], v[68:71], v[116:119], v[28:31]
    ds_read_b128 v[104:107], v12 offset:34816
    v_mfma_f32_16x16x32_bf16 v[36:39], v[72:75], v[116:119], 0
    s_waitcnt vmcnt(17) lgkmcnt(4)
    v_mfma_f32_16x16x32_bf16 v[16:19], v[76:79], v[120:123], v[16:19]
    ds_read_b128 v[40:43], v13 offset:18432
    v_mfma_f32_16x16x32_bf16 v[20:23], v[80:83], v[120:123], v[20:23]
    ds_read_b128 v[44:47], v13 offset:19456
    v_mfma_f32_16x16x32_bf16 v[24:27], v[84:87], v[120:123], v[24:27]
    ds_read_b128 v[48:51], v13 offset:20480
    v_mfma_f32_16x16x32_bf16 v[28:31], v[88:91], v[120:123], v[28:31]
    ds_read_b128 v[52:55], v13 offset:21504
    v_mfma_f32_16x16x32_bf16 v[32:35], v[108:111], v[120:123], v[32:35]
    ds_read_b128 v[72:75], v13 offset:26624
    s_waitcnt lgkmcnt(5)
    v_mfma_f32_16x16x32_bf16 v[16:19], v[92:95], v[124:127], v[16:19]
    ds_read_b128 v[56:59], v13 offset:22528
    v_mfma_f32_16x16x32_bf16 v[20:23], v[96:99], v[124:127], v[20:23]
    ds_read_b128 v[60:63], v13 offset:23552
    v_mfma_f32_16x16x32_bf16 v[24:27], v[100:103], v[124:127], v[24:27]
    ds_read_b128 v[64:67], v13 offset:24576
    v_mfma_f32_16x16x32_bf16 v[28:31], v[104:107], v[124:127], v[28:31]
    ds_read_b128 v[68:71], v13 offset:25600
    v_mfma_f32_16x16x32_bf16 v[36:39], v[108:111], v[124:127], v[36:39]
    s_waitcnt vmcnt(15) lgkmcnt(4)
    v_mfma_f32_16x16x32_bf16 v[16:19], v[40:43], v[128:131], v[16:19]
    ds_read_b128 v[76:79], v13 offset:27648
    v_mfma_f32_16x16x32_bf16 v[20:23], v[44:47], v[128:131], v[20:23]
    ds_read_b128 v[80:83], v13 offset:28672
    v_mfma_f32_16x16x32_bf16 v[24:27], v[48:51], v[128:131], v[24:27]
    ds_read_b128 v[84:87], v13 offset:29696
    v_mfma_f32_16x16x32_bf16 v[28:31], v[52:55], v[128:131], v[28:31]
    ds_read_b128 v[88:91], v13 offset:30720
    v_mfma_f32_16x16x32_bf16 v[32:35], v[72:75], v[128:131], v[32:35]
    ds_read_b128 v[108:111], v13 offset:35840
    s_waitcnt lgkmcnt(5)
    v_mfma_f32_16x16x32_bf16 v[16:19], v[56:59], v[132:135], v[16:19]
    ds_read_b128 v[92:95], v13 offset:31744
    v_mfma_f32_16x16x32_bf16 v[20:23], v[60:63], v[132:135], v[20:23]
    ds_read_b128 v[96:99], v13 offset:32768
    v_mfma_f32_16x16x32_bf16 v[24:27], v[64:67], v[132:135], v[24:27]
    ds_read_b128 v[100:103], v13 offset:33792
    v_mfma_f32_16x16x32_bf16 v[28:31], v[68:71], v[132:135], v[28:31]
    ds_read_b128 v[104:107], v13 offset:34816
    v_mfma_f32_16x16x32_bf16 v[36:39], v[72:75], v[132:135], v[36:39]
    s_waitcnt vmcnt(13) lgkmcnt(4)
    v_mfma_f32_16x16x32_bf16 v[16:19], v[76:79], v[136:139], v[16:19]
    ds_read_b128 v[40:43], v14 offset:18432
    v_mfma_f32_16x16x32_bf16 v[20:23], v[80:83], v[136:139], v[20:23]
    ds_read_b128 v[44:47], v14 offset:19456
    v_mfma_f32_16x16x32_bf16 v[24:27], v[84:87], v[136:139], v[24:27]
    ds_read_b128 v[48:51], v14 offset:20480
    v_mfma_f32_16x16x32_bf16 v[28:31], v[88:91], v[136:139], v[28:31]
    ds_read_b128 v[52:55], v14 offset:21504
    v_mfma_f32_16x16x32_bf16 v[32:35], v[108:111], v[136:139], v[32:35]
    ds_read_b128 v[72:75], v14 offset:26624
    s_waitcnt lgkmcnt(5)
    v_mfma_f32_16x16x32_bf16 v[16:19], v[92:95], v[140:143], v[16:19]
    ds_read_b128 v[56:59], v14 offset:22528
    v_mfma_f32_16x16x32_bf16 v[20:23], v[96:99], v[140:143], v[20:23]
    ds_read_b128 v[60:63], v14 offset:23552
    v_mfma_f32_16x16x32_bf16 v[24:27], v[100:103], v[140:143], v[24:27]
    ds_read_b128 v[64:67], v14 offset:24576
    v_mfma_f32_16x16x32_bf16 v[28:31], v[104:107], v[140:143], v[28:31]
    ds_read_b128 v[68:71], v14 offset:25600
    v_mfma_f32_16x16x32_bf16 v[36:39], v[108:111], v[140:143], v[36:39]
    s_waitcnt vmcnt(11) lgkmcnt(4)
    v_mfma_f32_16x16x32_bf16 v[16:19], v[40:43], v[144:147], v[16:19]
    ds_read_b128 v[76:79], v14 offset:27648
    v_mfma_f32_16x16x32_bf16 v[20:23], v[44:47], v[144:147], v[20:23]
    ds_read_b128 v[80:83], v14 offset:28672
    v_mfma_f32_16x16x32_bf16 v[24:27], v[48:51], v[144:147], v[24:27]
    ds_read_b128 v[84:87], v14 offset:29696
    v_mfma_f32_16x16x32_bf16 v[28:31], v[52:55], v[144:147], v[28:31]
    ds_read_b128 v[88:91], v14 offset:30720
    v_mfma_f32_16x16x32_bf16 v[32:35], v[72:75], v[144:147], v[32:35]
    ds_read_b128 v[108:111], v14 offset:35840
    s_waitcnt lgkmcnt(5)
    v_mfma_f32_16x16x32_bf16 v[16:19], v[56:59], v[148:151], v[16:19]
    ds_read_b128 v[92:95], v14 offset:31744
    v_mfma_f32_16x16x32_bf16 v[20:23], v[60:63], v[148:151], v[20:23]
    ds_read_b128 v[96:99], v14 offset:32768
    v_mfma_f32_16x16x32_bf16 v[24:27], v[64:67], v[148:151], v[24:27]
    ds_read_b128 v[100:103], v14 offset:33792
    v_mfma_f32_16x16x32_bf16 v[28:31], v[68:71], v[148:151], v[28:31]
    ds_read_b128 v[104:107], v14 offset:34816
    v_mfma_f32_16x16x32_bf16 v[36:39], v[72:75], v[148:151], v[36:39]
    s_waitcnt vmcnt(9) lgkmcnt(4)
    v_mfma_f32_16x16x32_bf16 v[16:19], v[76:79], v[152:155], v[16:19]
    ds_read_b128 v[40:43], v15 offset:18432
    v_mfma_f32_16x16x32_bf16 v[20:23], v[80:83], v[152:155], v[20:23]
    ds_read_b128 v[44:47], v15 offset:19456
    v_mfma_f32_16x16x32_bf16 v[24:27], v[84:87], v[152:155], v[24:27]
    ds_read_b128 v[48:51], v15 offset:20480
    v_mfma_f32_16x16x32_bf16 v[28:31], v[88:91], v[152:155], v[28:31]
    ds_read_b128 v[52:55], v15 offset:21504
    v_mfma_f32_16x16x32_bf16 v[32:35], v[108:111], v[152:155], v[32:35]
    ds_read_b128 v[72:75], v15 offset:26624
    s_waitcnt lgkmcnt(5)
    v_mfma_f32_16x16x32_bf16 v[16:19], v[92:95], v[156:159], v[16:19]
    ds_read_b128 v[56:59], v15 offset:22528
    v_mfma_f32_16x16x32_bf16 v[20:23], v[96:99], v[156:159], v[20:23]
    ds_read_b128 v[60:63], v15 offset:23552
    v_mfma_f32_16x16x32_bf16 v[24:27], v[100:103], v[156:159], v[24:27]
    ds_read_b128 v[64:67], v15 offset:24576
    v_mfma_f32_16x16x32_bf16 v[28:31], v[104:107], v[156:159], v[28:31]
    ds_read_b128 v[68:71], v15 offset:25600
    v_mfma_f32_16x16x32_bf16 v[36:39], v[108:111], v[156:159], v[36:39]
    s_waitcnt vmcnt(7) lgkmcnt(4)
    v_mfma_f32_16x16x32_bf16 v[16:19], v[40:43], v[160:163], v[16:19]
    ds_read_b128 v[76:79], v15 offset:27648
    v_mfma_f32_16x16x32_bf16 v[20:23], v[44:47], v[160:163], v[20:23]
    ds_read_b128 v[80:83], v15 offset:28672
    v_mfma_f32_16x16x32_bf16 v[24:27], v[48:51], v[160:163], v[24:27]
    ds_read_b128 v[84:87], v15 offset:29696
    v_mfma_f32_16x16x32_bf16 v[28:31], v[52:55], v[160:163], v[28:31]
    ds_read_b128 v[88:91], v15 offset:30720
    v_mfma_f32_16x16x32_bf16 v[32:35], v[72:75], v[160:163], v[32:35]
    ds_read_b128 v[108:111], v15 offset:35840
    s_waitcnt lgkmcnt(5)
    v_mfma_f32_16x16x32_bf16 v[16:19], v[56:59], v[164:167], v[16:19]
    ds_read_b128 v[92:95], v15 offset:31744
    v_mfma_f32_16x16x32_bf16 v[20:23], v[60:63], v[164:167], v[20:23]
    ds_read_b128 v[96:99], v15 offset:32768
    v_mfma_f32_16x16x32_bf16 v[24:27], v[64:67], v[164:167], v[24:27]
    ds_read_b128 v[100:103], v15 offset:33792
    v_mfma_f32_16x16x32_bf16 v[28:31], v[68:71], v[164:167], v[28:31]
    ds_read_b128 v[104:107], v15 offset:34816
    v_mfma_f32_16x16x32_bf16 v[36:39], v[72:75], v[164:167], v[36:39]
    s_waitcnt vmcnt(5) lgkmcnt(4)
    v_mfma_f32_16x16x32_bf16 v[16:19], v[76:79], v[168:171], v[16:19]
    ds_read_b128 v[40:43], v15 offset:36864
    v_mfma_f32_16x16x32_bf16 v[20:23], v[80:83], v[168:171], v[20:23]
    ds_read_b128 v[44:47], v15 offset:37888
    v_mfma_f32_16x16x32_bf16 v[24:27], v[84:87], v[168:171], v[24:27]
    ds_read_b128 v[48:51], v15 offset:38912
    v_mfma_f32_16x16x32_bf16 v[28:31], v[88:91], v[168:171], v[28:31]
    ds_read_b128 v[52:55], v15 offset:39936
    v_mfma_f32_16x16x32_bf16 v[32:35], v[108:111], v[168:171], v[32:35]
    ds_read_b128 v[72:75], v15 offset:45056
    s_waitcnt lgkmcnt(5)
    v_mfma_f32_16x16x32_bf16 v[16:19], v[92:95], v[172:175], v[16:19]
    ds_read_b128 v[56:59], v15 offset:40960
    v_mfma_f32_16x16x32_bf16 v[20:23], v[96:99], v[172:175], v[20:23]
    ds_read_b128 v[60:63], v15 offset:41984
    v_mfma_f32_16x16x32_bf16 v[24:27], v[100:103], v[172:175], v[24:27]
    ds_read_b128 v[64:67], v15 offset:43008
    v_mfma_f32_16x16x32_bf16 v[28:31], v[104:107], v[172:175], v[28:31]
    ds_read_b128 v[68:71], v15 offset:44032
    v_mfma_f32_16x16x32_bf16 v[36:39], v[108:111], v[172:175], v[36:39]
    s_waitcnt vmcnt(1) lgkmcnt(4)
    v_mfma_f32_16x16x32_bf16 v[16:19], v[40:43], v[176:179], v[16:19]
    v_mfma_f32_16x16x32_bf16 v[20:23], v[44:47], v[176:179], v[20:23]
    v_mfma_f32_16x16x32_bf16 v[24:27], v[48:51], v[176:179], v[24:27]
    v_mfma_f32_16x16x32_bf16 v[28:31], v[52:55], v[176:179], v[28:31]
    v_mfma_f32_16x16x32_bf16 v[32:35], v[72:75], v[176:179], v[32:35]
    s_waitcnt lgkmcnt(0)
    v_mfma_f32_16x16x32_bf16 v[16:19], v[56:59], v[180:183], v[16:19]
    v_mfma_f32_16x16x32_bf16 v[20:23], v[60:63], v[180:183], v[20:23]
    v_mfma_f32_16x16x32_bf16 v[24:27], v[64:67], v[180:183], v[24:27]
    v_mfma_f32_16x16x32_bf16 v[28:31], v[68:71], v[180:183], v[28:31]
    v_mfma_f32_16x16x32_bf16 v[36:39], v[72:75], v[180:183], v[36:39]
    s_nop 3
    v_cvt_pk_bf16_f32 v208, v16, v17
    v_cvt_pk_bf16_f32 v209, v18, v19
    v_cvt_pk_bf16_f32 v210, v20, v21
    v_cvt_pk_bf16_f32 v211, v22, v23
    v_cvt_pk_bf16_f32 v212, v24, v25
    v_cvt_pk_bf16_f32 v213, v26, v27
    v_cvt_pk_bf16_f32 v214, v28, v29
    v_cvt_pk_bf16_f32 v215, v30, v31
    buffer_store_dwordx4 v[208:211], v4, s[4:7], s34 offen offset:0 sc1
    buffer_store_dwordx4 v[212:215], v4, s[4:7], s34 offen offset:1024 sc1
    v_permlane32_swap_b32 v36, v220
    v_permlane32_swap_b32 v37, v221
    v_permlane32_swap_b32 v38, v222
    v_permlane32_swap_b32 v39, v223
    v_pk_add_f32 v[32:33], v[32:33], v[220:221]
    v_pk_add_f32 v[34:35], v[34:35], v[222:223]
    v_cvt_pk_bf16_f32 v216, v32, v33
    v_cvt_pk_bf16_f32 v217, v34, v35
    buffer_store_dwordx2 v[216:217], v5, s[4:7], s34 offen sc1
    v_cndmask_b32 v222, 0, v216, s[40:41]
    v_cndmask_b32 v223, 0, v217, s[40:41]
    v_dot2_f32_bf16 v220, v208, v11, 0
    v_dot2_f32_bf16 v221, v208, v208, 0
    v_dot2_f32_bf16 v220, v209, v11, v220
    v_dot2_f32_bf16 v221, v209, v209, v221
    v_dot2_f32_bf16 v220, v210, v11, v220
    v_dot2_f32_bf16 v221, v210, v210, v221
    v_dot2_f32_bf16 v220, v211, v11, v220
    v_dot2_f32_bf16 v221, v211, v211, v221
    v_dot2_f32_bf16 v220, v212, v11, v220
    v_dot2_f32_bf16 v221, v212, v212, v221
    v_dot2_f32_bf16 v220, v213, v11, v220
    v_dot2_f32_bf16 v221, v213, v213, v221
    v_dot2_f32_bf16 v220, v214, v11, v220
    v_dot2_f32_bf16 v221, v214, v214, v221
    v_dot2_f32_bf16 v220, v215, v11, v220
    v_dot2_f32_bf16 v221, v215, v215, v221
    v_dot2_f32_bf16 v220, v222, v11, v220
    v_dot2_f32_bf16 v221, v222, v222, v221
    v_dot2_f32_bf16 v220, v223, v11, v220
    v_dot2_f32_bf16 v221, v223, v223, v221
    s_nop 2
    v_mov_b32 v222, v220
    v_mov_b32 v223, v221
    s_nop 1
    v_permlane32_swap_b32 v220, v222
    v_permlane32_swap_b32 v221, v223
    v_add_f32 v220, v220, v222
    v_add_f32 v221, v221, v223
    v_mov_b32 v222, v220
    v_mov_b32 v223, v221
    s_nop 1
    v_permlane16_swap_b32 v220, v222
    v_permlane16_swap_b32 v221, v223
    v_add_f32 v220, v220, v222
    v_add_f32 v221, v221, v223
    buffer_store_dwordx2 v[220:221], v10, s[4:7], s39 offen sc1
    s_and_b32 s25, s2, 7
    s_lshr_b32 s26, s2, 3
    s_and_b32 s23, s25, 1
    s_lshl_b32 s23, s23, 3
    s_and_b32 s27, s26, 7
    s_add_u32 s23, s23, s27
    s_lshr_b32 s24, s25, 1
    s_lshl_b32 s24, s24, 2
    s_lshr_b32 s27, s26, 3
    s_add_u32 s24, s24, s27
    s_add_u32 s28, s23, s24
    s_and_b32 s28, s28, 3
    s_lshl_b32 s30, s20, 12
    s_lshl_b32 s31, s23, 3
    s_lshl_b32 s33, s20, 1
    s_add_u32 s31, s31, s33
    s_lshl_b32 s32, s31, 10
    s_add_u32 s32, s32, s21
    s_add_u32 s32, s32, 0x1b20000
    v_add_u32 v2, 73728, v1
    s_add_u32 s33, s30, 18432
    v_add_u32 v3, s33, v1
    v_add_u32 v0, s33, v2
    s_lshr_b32 s34, s31, 1
    s_lshl_b32 s35, s34, 12
    s_add_u32 s35, s35, s21
    s_add_u32 s35, s35, 0x1b40000
    s_lshl_b32 s36, s24, 8
    s_add_u32 s36, s36, s35
    s_lshl_b32 s38, s24, 6
    s_add_u32 s38, s38, s34
    s_mul_i32 s38, s38, 9216
    s_add_u32 s38, s38, s21
    s_add_u32 s38, s38, 0x900000
    s_add_u32 s39, s38, 4096
    s_add_u32 s46, s38, 8192
    s_mov_b32 s40, 0xc0135761
    s_mov_b32 s42, 0x3d372713
    s_mov_b32 s44, 0x39e38e39
    s_mov_b32 s45, 0x3727c5ac
    v_lshrrev_b32 v4, 1, v1
    s_lshl_b32 s52, s22, 7
    s_add_u32 s52, s52, s23
    s_lshl_b32 s52, s52, 8
    s_add_u32 s52, s52, 0x4509000
    s_add_u32 s52, s52, s4
    s_addc_u32 s53, s5, 0
    s_waitcnt vmcnt(0)
    s_barrier
    s_cmp_lg_u32 s20, 0
    s_cbranch_scc1 L_ns_d3
    s_mov_b32 s56, 1
    s_atomic_add s56, s[50:51], 0
L_ns_d3:
    s_cmp_lg_u32 s20, 0
    s_cbranch_scc1 L_pd_d3
    s_mov_b32 s60, 65536
L_poll_d3:
    s_mov_b32 s57, 0
    s_atomic_add s57, s[52:53], 0 glc
    s_waitcnt lgkmcnt(0)
    s_cmp_ge_u32 s57, 16
    s_cbranch_scc1 L_pd_d3
    s_sub_u32 s60, s60, 1
    s_cbranch_scc1 L_pd_d3
    s_sleep 2
    s_branch L_poll_d3
L_pd_d3:
    s_barrier
    buffer_load_dwordx2 v[8:9], v4, s[4:7], s32 offen offset:0 sc1
    buffer_load_dwordx2 v[10:11], v4, s[4:7], s32 offen offset:512 sc1
    buffer_load_dwordx2 v[12:13], v4, s[4:7], s32 offen offset:1024 sc1
    buffer_load_dwordx2 v[14:15], v4, s[4:7], s32 offen offset:1536 sc1
    s_lshl_b32 s50, s22, 7
    s_add_u32 s50, s50, s23
    s_lshl_b32 s50, s50, 8
    s_add_u32 s50, s50, 0x450a000
    s_add_u32 s50, s50, s4
    s_addc_u32 s51, s5, 0
    s_barrier
    ds_read_b128 v[160:163], v3 offset:0
    ds_read_b128 v[164:167], v3 offset:2048
    ds_read_b128 v[168:171], v1 offset:0
    ds_read_b128 v[172:175], v1 offset:1024
    ds_read_b128 v[176:179], v1 offset:2048
    ds_read_b128 v[180:183], v1 offset:3072
    ds_read_b128 v[184:187], v1 offset:4096
    ds_read_b128 v[188:191], v1 offset:5120
    ds_read_b128 v[192:195], v1 offset:6144
    ds_read_b128 v[196:199], v1 offset:7168
    ds_read_b128 v[200:203], v1 offset:8192
    s_waitcnt lgkmcnt(5)
    v_mfma_f32_16x16x32_bf16 v[16:19], v[160:163], v[168:171], 0
    ds_read_b128 v[204:207], v3 offset:1024
    v_mfma_f32_16x16x32_bf16 v[20:23], v[164:167], v[168:171], 0
    ds_read_b128 v[208:211], v3 offset:3072
    v_mfma_f32_16x16x32_bf16 v[24:27], v[160:163], v[172:175], 0
    ds_read_b128 v[212:215], v1 offset:9216
    v_mfma_f32_16x16x32_bf16 v[28:31], v[164:167], v[172:175], 0
    ds_read_b128 v[216:219], v1 offset:10240
    v_mfma_f32_16x16x32_bf16 v[32:35], v[160:163], v[176:179], 0
    ds_read_b128 v[220:223], v1 offset:11264
    v_mfma_f32_16x16x32_bf16 v[36:39], v[164:167], v[176:179], 0
    ds_read_b128 v[224:227], v1 offset:12288
    v_mfma_f32_16x16x32_bf16 v[40:43], v[160:163], v[180:183], 0
    ds_read_b128 v[228:231], v1 offset:13312
    v_mfma_f32_16x16x32_bf16 v[44:47], v[164:167], v[180:183], 0
    ds_read_b128 v[232:235], v1 offset:14336
    s_waitcnt lgkmcnt(8)
    v_mfma_f32_16x16x32_bf16 v[48:51], v[160:163], v[184:187], 0
    ds_read_b128 v[236:239], v1 offset:15360
    v_mfma_f32_16x16x32_bf16 v[52:55], v[164:167], v[184:187], 0
    ds_read_b128 v[240:243], v1 offset:16384
    v_mfma_f32_16x16x32_bf16 v[56:59], v[160:163], v[188:191], 0
    ds_read_b128 v[244:247], v1 offset:17408
    v_mfma_f32_16x16x32_bf16 v[60:63], v[164:167], v[188:191], 0
    v_mfma_f32_16x16x32_bf16 v[64:67], v[160:163], v[192:195], 0
    v_mfma_f32_16x16x32_bf16 v[68:71], v[164:167], v[192:195], 0
    v_mfma_f32_16x16x32_bf16 v[72:75], v[160:163], v[196:199], 0
    v_mfma_f32_16x16x32_bf16 v[76:79], v[164:167], v[196:199], 0
    v_mfma_f32_16x16x32_bf16 v[80:83], v[160:163], v[200:203], 0
    v_mfma_f32_16x16x32_bf16 v[84:87], v[164:167], v[200:203], 0
    s_waitcnt lgkmcnt(0)
    s_barrier
    v_mfma_f32_16x16x32_bf16 v[16:19], v[204:207], v[212:215], v[16:19]
    ds_read_b128 v[160:163], v3 offset:36864
    v_mfma_f32_16x16x32_bf16 v[20:23], v[208:211], v[212:215], v[20:23]
    ds_read_b128 v[164:167], v3 offset:38912
    v_mfma_f32_16x16x32_bf16 v[24:27], v[204:207], v[216:219], v[24:27]
    ds_read_b128 v[168:171], v1 offset:36864
    v_mfma_f32_16x16x32_bf16 v[28:31], v[208:211], v[216:219], v[28:31]
    ds_read_b128 v[172:175], v1 offset:37888
    v_mfma_f32_16x16x32_bf16 v[32:35], v[204:207], v[220:223], v[32:35]
    ds_read_b128 v[176:179], v1 offset:38912
    v_mfma_f32_16x16x32_bf16 v[36:39], v[208:211], v[220:223], v[36:39]
    ds_read_b128 v[180:183], v1 offset:39936
    v_mfma_f32_16x16x32_bf16 v[40:43], v[204:207], v[224:227], v[40:43]
    ds_read_b128 v[184:187], v1 offset:40960
    v_mfma_f32_16x16x32_bf16 v[44:47], v[208:211], v[224:227], v[44:47]
    ds_read_b128 v[188:191], v1 offset:41984
    v_mfma_f32_16x16x32_bf16 v[48:51], v[204:207], v[228:231], v[48:51]
    ds_read_b128 v[192:195], v1 offset:43008
    v_mfma_f32_16x16x32_bf16 v[52:55], v[208:211], v[228:231], v[52:55]
    ds_read_b128 v[196:199], v1 offset:44032
    v_lshrrev_b32 v5, 8, v1
    v_mfma_f32_16x16x32_bf16 v[56:59], v[204:207], v[232:235], v[56:59]
    ds_read_b128 v[200:203], v1 offset:45056
    v_bfe_u32 v6, v1, 4, 4
    v_mfma_f32_16x16x32_bf16 v[60:63], v[208:211], v[232:235], v[60:63]
    v_lshlrev_b32 v7, 2, v6
    v_mfma_f32_16x16x32_bf16 v[64:67], v[204:207], v[236:239], v[64:67]
    s_lshl_b32 s33, s20, 8
    v_mfma_f32_16x16x32_bf16 v[68:71], v[208:211], v[236:239], v[68:71]
    s_add_u32 s33, s33, 147456
    v_mfma_f32_16x16x32_bf16 v[72:75], v[204:207], v[240:243], v[72:75]
    v_add_u32 v4, s33, v7
    v_mfma_f32_16x16x32_bf16 v[76:79], v[208:211], v[240:243], v[76:79]
    v_lshl_add_u32 v252, v5, 4, s33
    v_mfma_f32_16x16x32_bf16 v[80:83], v[204:207], v[244:247], v[80:83]
    v_add_u32 v7, 159744, v7
    v_mfma_f32_16x16x32_bf16 v[84:87], v[208:211], v[244:247], v[84:87]
    v_add_u32 v253, 1152, v7
    s_waitcnt vmcnt(0)
    s_waitcnt lgkmcnt(5)
    v_mfma_f32_16x16x32_bf16 v[16:19], v[160:163], v[168:171], v[16:19]
    ds_read2_b32 v[128:129], v7 offset0:0 offset1:16
    ds_read2_b32 v[130:131], v7 offset0:32 offset1:48
    ds_read_b128 v[204:207], v3 offset:37888
    v_mfma_f32_16x16x32_bf16 v[20:23], v[164:167], v[168:171], v[20:23]
    ds_read_b128 v[208:211], v3 offset:39936
    v_mfma_f32_16x16x32_bf16 v[24:27], v[160:163], v[172:175], v[24:27]
    ds_read_b128 v[212:215], v1 offset:46080
    v_mfma_f32_16x16x32_bf16 v[28:31], v[164:167], v[172:175], v[28:31]
    ds_read_b128 v[216:219], v1 offset:47104
    v_mfma_f32_16x16x32_bf16 v[32:35], v[160:163], v[176:179], v[32:35]
    ds_read_b128 v[220:223], v1 offset:48128
    v_mfma_f32_16x16x32_bf16 v[36:39], v[164:167], v[176:179], v[36:39]
    ds_read_b128 v[224:227], v1 offset:49152
    v_mfma_f32_16x16x32_bf16 v[40:43], v[160:163], v[180:183], v[40:43]
    ds_read_b128 v[228:231], v1 offset:50176
    v_mfma_f32_16x16x32_bf16 v[44:47], v[164:167], v[180:183], v[44:47]
    ds_read_b128 v[232:235], v1 offset:51200
    s_waitcnt lgkmcnt(8)
    v_mfma_f32_16x16x32_bf16 v[48:51], v[160:163], v[184:187], v[48:51]
    ds_read_b128 v[236:239], v1 offset:52224
    v_mfma_f32_16x16x32_bf16 v[52:55], v[164:167], v[184:187], v[52:55]
    ds_read_b128 v[240:243], v1 offset:53248
    v_add_f32 v248, v8, v10
    v_mfma_f32_16x16x32_bf16 v[56:59], v[160:163], v[188:191], v[56:59]
    ds_read_b128 v[244:247], v1 offset:54272
    v_add_f32 v249, v9, v11
    v_mfma_f32_16x16x32_bf16 v[60:63], v[164:167], v[188:191], v[60:63]
    v_add_f32 v250, v12, v14
    v_mfma_f32_16x16x32_bf16 v[64:67], v[160:163], v[192:195], v[64:67]
    v_add_f32 v251, v13, v15
    v_mfma_f32_16x16x32_bf16 v[68:71], v[164:167], v[192:195], v[68:71]
    v_mov_b32 v8, v248
    v_mfma_f32_16x16x32_bf16 v[72:75], v[160:163], v[196:199], v[72:75]
    v_mov_b32 v9, v249
    v_mfma_f32_16x16x32_bf16 v[76:79], v[164:167], v[196:199], v[76:79]
    v_mov_b32 v12, v250
    v_mfma_f32_16x16x32_bf16 v[80:83], v[160:163], v[200:203], v[80:83]
    v_mov_b32 v13, v251
    v_mfma_f32_16x16x32_bf16 v[84:87], v[164:167], v[200:203], v[84:87]
    v_permlane32_swap_b32 v248, v8
    v_permlane32_swap_b32 v249, v9
    s_waitcnt lgkmcnt(0)
    s_barrier
    v_mfma_f32_16x16x32_bf16 v[16:19], v[204:207], v[212:215], v[16:19]
    ds_read2_b32 v[132:133], v7 offset0:64 offset1:80
    ds_read2_b32 v[134:135], v7 offset0:96 offset1:112
    ds_read_b128 v[160:163], v0 offset:0
    v_mfma_f32_16x16x32_bf16 v[20:23], v[208:211], v[212:215], v[20:23]
    ds_read_b128 v[164:167], v0 offset:2048
    v_mfma_f32_16x16x32_bf16 v[24:27], v[204:207], v[216:219], v[24:27]
    ds_read_b128 v[168:171], v2 offset:0
    v_mfma_f32_16x16x32_bf16 v[28:31], v[208:211], v[216:219], v[28:31]
    ds_read_b128 v[172:175], v2 offset:1024
    v_mfma_f32_16x16x32_bf16 v[32:35], v[204:207], v[220:223], v[32:35]
    ds_read_b128 v[176:179], v2 offset:2048
    v_mfma_f32_16x16x32_bf16 v[36:39], v[208:211], v[220:223], v[36:39]
    ds_read_b128 v[180:183], v2 offset:3072
    v_mfma_f32_16x16x32_bf16 v[40:43], v[204:207], v[224:227], v[40:43]
    ds_read_b128 v[184:187], v2 offset:4096
    v_mfma_f32_16x16x32_bf16 v[44:47], v[208:211], v[224:227], v[44:47]
    ds_read_b128 v[188:191], v2 offset:5120
    v_mfma_f32_16x16x32_bf16 v[48:51], v[204:207], v[228:231], v[48:51]
    ds_read_b128 v[192:195], v2 offset:6144
    v_mfma_f32_16x16x32_bf16 v[52:55], v[208:211], v[228:231], v[52:55]
    ds_read_b128 v[196:199], v2 offset:7168
    v_permlane32_swap_b32 v250, v12
    v_mfma_f32_16x16x32_bf16 v[56:59], v[204:207], v[232:235], v[56:59]
    ds_read_b128 v[200:203], v2 offset:8192
    v_permlane32_swap_b32 v251, v13
    v_mfma_f32_16x16x32_bf16 v[60:63], v[208:211], v[232:235], v[60:63]
    v_add_f32 v248, v248, v8
    v_mfma_f32_16x16x32_bf16 v[64:67], v[204:207], v[236:239], v[64:67]
    v_add_f32 v249, v249, v9
    v_mfma_f32_16x16x32_bf16 v[68:71], v[208:211], v[236:239], v[68:71]
    v_add_f32 v250, v250, v12
    v_mfma_f32_16x16x32_bf16 v[72:75], v[204:207], v[240:243], v[72:75]
    v_add_f32 v251, v251, v13
    v_mfma_f32_16x16x32_bf16 v[76:79], v[208:211], v[240:243], v[76:79]
    v_mov_b32 v8, v248
    v_mfma_f32_16x16x32_bf16 v[80:83], v[204:207], v[244:247], v[80:83]
    v_mov_b32 v9, v249
    v_mfma_f32_16x16x32_bf16 v[84:87], v[208:211], v[244:247], v[84:87]
    v_mov_b32 v12, v250
    v_mov_b32 v13, v251
    s_waitcnt lgkmcnt(5)
    v_mfma_f32_16x16x32_bf16 v[16:19], v[160:163], v[168:171], v[16:19]
    ds_read2_b32 v[136:137], v7 offset0:128 offset1:144
    ds_read2_b32 v[138:139], v253 offset0:0 offset1:16
    ds_read_b128 v[204:207], v0 offset:1024
    v_mfma_f32_16x16x32_bf16 v[20:23], v[164:167], v[168:171], v[20:23]
    ds_read_b128 v[208:211], v0 offset:3072
    v_mfma_f32_16x16x32_bf16 v[24:27], v[160:163], v[172:175], v[24:27]
    ds_read_b128 v[212:215], v2 offset:9216
    v_mfma_f32_16x16x32_bf16 v[28:31], v[164:167], v[172:175], v[28:31]
    ds_read_b128 v[216:219], v2 offset:10240
    v_mfma_f32_16x16x32_bf16 v[32:35], v[160:163], v[176:179], v[32:35]
    ds_read_b128 v[220:223], v2 offset:11264
    v_mfma_f32_16x16x32_bf16 v[36:39], v[164:167], v[176:179], v[36:39]
    ds_read_b128 v[224:227], v2 offset:12288
    v_mfma_f32_16x16x32_bf16 v[40:43], v[160:163], v[180:183], v[40:43]
    ds_read_b128 v[228:231], v2 offset:13312
    v_mfma_f32_16x16x32_bf16 v[44:47], v[164:167], v[180:183], v[44:47]
    ds_read_b128 v[232:235], v2 offset:14336
    s_waitcnt lgkmcnt(8)
    v_mfma_f32_16x16x32_bf16 v[48:51], v[160:163], v[184:187], v[48:51]
    ds_read_b128 v[236:239], v2 offset:15360
    v_mfma_f32_16x16x32_bf16 v[52:55], v[164:167], v[184:187], v[52:55]
    ds_read_b128 v[240:243], v2 offset:16384
    v_permlane16_swap_b32 v248, v8
    v_mfma_f32_16x16x32_bf16 v[56:59], v[160:163], v[188:191], v[56:59]
    ds_read_b128 v[244:247], v2 offset:17408
    v_permlane16_swap_b32 v249, v9
    v_mfma_f32_16x16x32_bf16 v[60:63], v[164:167], v[188:191], v[60:63]
    v_permlane16_swap_b32 v250, v12
    v_mfma_f32_16x16x32_bf16 v[64:67], v[160:163], v[192:195], v[64:67]
    v_permlane16_swap_b32 v251, v13
    v_mfma_f32_16x16x32_bf16 v[68:71], v[164:167], v[192:195], v[68:71]
    v_add_f32 v248, v248, v8
    v_mfma_f32_16x16x32_bf16 v[72:75], v[160:163], v[196:199], v[72:75]
    v_add_f32 v249, v249, v9
    v_mfma_f32_16x16x32_bf16 v[76:79], v[164:167], v[196:199], v[76:79]
    v_add_f32 v250, v250, v12
    v_mfma_f32_16x16x32_bf16 v[80:83], v[160:163], v[200:203], v[80:83]
    v_add_f32 v251, v251, v13
    v_mfma_f32_16x16x32_bf16 v[84:87], v[164:167], v[200:203], v[84:87]
    v_mul_f32 v248, 0x3ae38e39, v248
    v_mul_f32 v249, 0x3ae38e39, v249
    s_waitcnt lgkmcnt(0)
    s_barrier
    v_mfma_f32_16x16x32_bf16 v[16:19], v[204:207], v[212:215], v[16:19]
    ds_read2_b32 v[140:141], v253 offset0:32 offset1:48
    ds_read2_b32 v[142:143], v253 offset0:64 offset1:80
    ds_read_b128 v[160:163], v0 offset:36864
    v_mfma_f32_16x16x32_bf16 v[20:23], v[208:211], v[212:215], v[20:23]
    ds_read_b128 v[164:167], v0 offset:38912
    v_mfma_f32_16x16x32_bf16 v[24:27], v[204:207], v[216:219], v[24:27]
    ds_read_b128 v[168:171], v2 offset:36864
    v_mfma_f32_16x16x32_bf16 v[28:31], v[208:211], v[216:219], v[28:31]
    ds_read_b128 v[172:175], v2 offset:37888
    v_mfma_f32_16x16x32_bf16 v[32:35], v[204:207], v[220:223], v[32:35]
    ds_read_b128 v[176:179], v2 offset:38912
    v_mfma_f32_16x16x32_bf16 v[36:39], v[208:211], v[220:223], v[36:39]
    ds_read_b128 v[180:183], v2 offset:39936
    v_mfma_f32_16x16x32_bf16 v[40:43], v[204:207], v[224:227], v[40:43]
    ds_read_b128 v[184:187], v2 offset:40960
    v_mfma_f32_16x16x32_bf16 v[44:47], v[208:211], v[224:227], v[44:47]
    ds_read_b128 v[188:191], v2 offset:41984
    v_mfma_f32_16x16x32_bf16 v[48:51], v[204:207], v[228:231], v[48:51]
    ds_read_b128 v[192:195], v2 offset:43008
    v_mfma_f32_16x16x32_bf16 v[52:55], v[208:211], v[228:231], v[52:55]
    ds_read_b128 v[196:199], v2 offset:44032
    v_mul_f32 v250, 0x3ae38e39, v250
    v_mfma_f32_16x16x32_bf16 v[56:59], v[204:207], v[232:235], v[56:59]
    ds_read_b128 v[200:203], v2 offset:45056
    v_mul_f32 v251, 0x3ae38e39, v251
    v_mfma_f32_16x16x32_bf16 v[60:63], v[208:211], v[232:235], v[60:63]
    v_fma_f32 v249, -v248, v248, v249
    v_mfma_f32_16x16x32_bf16 v[64:67], v[204:207], v[236:239], v[64:67]
    v_fma_f32 v251, -v250, v250, v251
    v_mfma_f32_16x16x32_bf16 v[68:71], v[208:211], v[236:239], v[68:71]
    v_max_f32 v249, 0, v249
    v_mfma_f32_16x16x32_bf16 v[72:75], v[204:207], v[240:243], v[72:75]
    v_max_f32 v251, 0, v251
    v_mfma_f32_16x16x32_bf16 v[76:79], v[208:211], v[240:243], v[76:79]
    v_add_f32 v249, 0x3727c5ac, v249
    v_mfma_f32_16x16x32_bf16 v[80:83], v[204:207], v[244:247], v[80:83]
    v_add_f32 v251, 0x3727c5ac, v251
    v_mfma_f32_16x16x32_bf16 v[84:87], v[208:211], v[244:247], v[84:87]
    v_rsq_f32 v249, v249
    v_rsq_f32 v251, v251
    s_waitcnt lgkmcnt(5)
    v_mfma_f32_16x16x32_bf16 v[16:19], v[160:163], v[168:171], v[16:19]
    ds_read2_b32 v[144:145], v253 offset0:96 offset1:112
    ds_read2_b32 v[146:147], v253 offset0:128 offset1:144
    ds_read_b128 v[204:207], v0 offset:37888
    v_mfma_f32_16x16x32_bf16 v[20:23], v[164:167], v[168:171], v[20:23]
    ds_read_b128 v[208:211], v0 offset:39936
    v_mfma_f32_16x16x32_bf16 v[24:27], v[160:163], v[172:175], v[24:27]
    ds_read_b128 v[212:215], v2 offset:46080
    v_mfma_f32_16x16x32_bf16 v[28:31], v[164:167], v[172:175], v[28:31]
    ds_read_b128 v[216:219], v2 offset:47104
    v_mfma_f32_16x16x32_bf16 v[32:35], v[160:163], v[176:179], v[32:35]
    ds_read_b128 v[220:223], v2 offset:48128
    v_mfma_f32_16x16x32_bf16 v[36:39], v[164:167], v[176:179], v[36:39]
    ds_read_b128 v[224:227], v2 offset:49152
    v_mfma_f32_16x16x32_bf16 v[40:43], v[160:163], v[180:183], v[40:43]
    ds_read_b128 v[228:231], v2 offset:50176
    v_mfma_f32_16x16x32_bf16 v[44:47], v[164:167], v[180:183], v[44:47]
    ds_read_b128 v[232:235], v2 offset:51200
    s_waitcnt lgkmcnt(8)
    v_mfma_f32_16x16x32_bf16 v[48:51], v[160:163], v[184:187], v[48:51]
    ds_read_b128 v[236:239], v2 offset:52224
    v_mfma_f32_16x16x32_bf16 v[52:55], v[164:167], v[184:187], v[52:55]
    ds_read_b128 v[240:243], v2 offset:53248
    s_nop 0
    v_mfma_f32_16x16x32_bf16 v[56:59], v[160:163], v[188:191], v[56:59]
    ds_read_b128 v[244:247], v2 offset:54272
    v_mfma_f32_16x16x32_bf16 v[60:63], v[164:167], v[188:191], v[60:63]
    v_mfma_f32_16x16x32_bf16 v[64:67], v[160:163], v[192:195], v[64:67]
    v_mfma_f32_16x16x32_bf16 v[68:71], v[164:167], v[192:195], v[68:71]
    v_mfma_f32_16x16x32_bf16 v[72:75], v[160:163], v[196:199], v[72:75]
    v_mfma_f32_16x16x32_bf16 v[76:79], v[164:167], v[196:199], v[76:79]
    v_mfma_f32_16x16x32_bf16 v[80:83], v[160:163], v[200:203], v[80:83]
    v_mfma_f32_16x16x32_bf16 v[84:87], v[164:167], v[200:203], v[84:87]
    s_waitcnt lgkmcnt(0)
    s_barrier
    v_mfma_f32_16x16x32_bf16 v[16:19], v[204:207], v[212:215], v[16:19]
    ds_read_b128 v[160:163], v3 offset:0
    v_mfma_f32_16x16x32_bf16 v[20:23], v[208:211], v[212:215], v[20:23]
    ds_read_b128 v[164:167], v3 offset:2048
    v_mfma_f32_16x16x32_bf16 v[24:27], v[204:207], v[216:219], v[24:27]
    ds_read_b128 v[168:171], v1 offset:0
    v_mfma_f32_16x16x32_bf16 v[28:31], v[208:211], v[216:219], v[28:31]
    ds_read_b128 v[172:175], v1 offset:1024
    v_mfma_f32_16x16x32_bf16 v[32:35], v[204:207], v[220:223], v[32:35]
    ds_read_b128 v[176:179], v1 offset:2048
    v_mfma_f32_16x16x32_bf16 v[36:39], v[208:211], v[220:223], v[36:39]
    ds_read_b128 v[180:183], v1 offset:3072
    v_mfma_f32_16x16x32_bf16 v[40:43], v[204:207], v[224:227], v[40:43]
    ds_read_b128 v[184:187], v1 offset:4096
    v_mfma_f32_16x16x32_bf16 v[44:47], v[208:211], v[224:227], v[44:47]
    ds_read_b128 v[188:191], v1 offset:5120
    v_mfma_f32_16x16x32_bf16 v[48:51], v[204:207], v[228:231], v[48:51]
    ds_read_b128 v[192:195], v1 offset:6144
    v_mfma_f32_16x16x32_bf16 v[52:55], v[208:211], v[228:231], v[52:55]
    ds_read_b128 v[196:199], v1 offset:7168
    v_mfma_f32_16x16x32_bf16 v[56:59], v[204:207], v[232:235], v[56:59]
    ds_read_b128 v[200:203], v1 offset:8192
    v_mfma_f32_16x16x32_bf16 v[60:63], v[208:211], v[232:235], v[60:63]
    v_mfma_f32_16x16x32_bf16 v[64:67], v[204:207], v[236:239], v[64:67]
    v_mfma_f32_16x16x32_bf16 v[68:71], v[208:211], v[236:239], v[68:71]
    v_mfma_f32_16x16x32_bf16 v[72:75], v[204:207], v[240:243], v[72:75]
    v_mfma_f32_16x16x32_bf16 v[76:79], v[208:211], v[240:243], v[76:79]
    v_mfma_f32_16x16x32_bf16 v[80:83], v[204:207], v[244:247], v[80:83]
    v_mfma_f32_16x16x32_bf16 v[84:87], v[208:211], v[244:247], v[84:87]
    s_waitcnt lgkmcnt(5)
    v_mfma_f32_16x16x32_bf16 v[16:19], v[160:163], v[168:171], v[16:19]
    ds_write2_b32 v4, v248, v249 offset0:0 offset1:32
    ds_write2_b32 v4, v250, v251 offset0:16 offset1:48
    ds_read_b128 v[204:207], v3 offset:1024
    v_mfma_f32_16x16x32_bf16 v[20:23], v[164:167], v[168:171], v[20:23]
    ds_read_b128 v[208:211], v3 offset:3072
    v_mfma_f32_16x16x32_bf16 v[24:27], v[160:163], v[172:175], v[24:27]
    ds_read_b128 v[212:215], v1 offset:9216
    v_mfma_f32_16x16x32_bf16 v[28:31], v[164:167], v[172:175], v[28:31]
    ds_read_b128 v[216:219], v1 offset:10240
    v_mfma_f32_16x16x32_bf16 v[32:35], v[160:163], v[176:179], v[32:35]
    ds_read_b128 v[220:223], v1 offset:11264
    v_mfma_f32_16x16x32_bf16 v[36:39], v[164:167], v[176:179], v[36:39]
    ds_read_b128 v[224:227], v1 offset:12288
    v_mfma_f32_16x16x32_bf16 v[40:43], v[160:163], v[180:183], v[40:43]
    ds_read_b128 v[228:231], v1 offset:13312
    v_mfma_f32_16x16x32_bf16 v[44:47], v[164:167], v[180:183], v[44:47]
    ds_read_b128 v[232:235], v1 offset:14336
    s_waitcnt lgkmcnt(8)
    v_mfma_f32_16x16x32_bf16 v[48:51], v[160:163], v[184:187], v[48:51]
    ds_read_b128 v[236:239], v1 offset:15360
    v_mfma_f32_16x16x32_bf16 v[52:55], v[164:167], v[184:187], v[52:55]
    ds_read_b128 v[240:243], v1 offset:16384
    v_mfma_f32_16x16x32_bf16 v[56:59], v[160:163], v[188:191], v[56:59]
    ds_read_b128 v[244:247], v1 offset:17408
    v_mfma_f32_16x16x32_bf16 v[60:63], v[164:167], v[188:191], v[60:63]
    v_mfma_f32_16x16x32_bf16 v[64:67], v[160:163], v[192:195], v[64:67]
    v_mfma_f32_16x16x32_bf16 v[68:71], v[164:167], v[192:195], v[68:71]
    v_mfma_f32_16x16x32_bf16 v[72:75], v[160:163], v[196:199], v[72:75]
    v_mfma_f32_16x16x32_bf16 v[76:79], v[164:167], v[196:199], v[76:79]
    v_mfma_f32_16x16x32_bf16 v[80:83], v[160:163], v[200:203], v[80:83]
    v_mfma_f32_16x16x32_bf16 v[84:87], v[164:167], v[200:203], v[84:87]
    s_waitcnt lgkmcnt(0)
    s_barrier
    v_mfma_f32_16x16x32_bf16 v[16:19], v[204:207], v[212:215], v[16:19]
    ds_read_b128 v[88:91], v252 offset:0
    ds_read_b128 v[92:95], v252 offset:64
    ds_read_b128 v[96:99], v252 offset:128
    ds_read_b128 v[100:103], v252 offset:192
    ds_read_b128 v[160:163], v3 offset:36864
    v_mfma_f32_16x16x32_bf16 v[20:23], v[208:211], v[212:215], v[20:23]
    ds_read_b128 v[164:167], v3 offset:38912
    v_mfma_f32_16x16x32_bf16 v[24:27], v[204:207], v[216:219], v[24:27]
    ds_read_b128 v[168:171], v1 offset:36864
    v_mfma_f32_16x16x32_bf16 v[28:31], v[208:211], v[216:219], v[28:31]
    ds_read_b128 v[172:175], v1 offset:37888
    v_mfma_f32_16x16x32_bf16 v[32:35], v[204:207], v[220:223], v[32:35]
    ds_read_b128 v[176:179], v1 offset:38912
    v_mfma_f32_16x16x32_bf16 v[36:39], v[208:211], v[220:223], v[36:39]
    ds_read_b128 v[180:183], v1 offset:39936
    v_mfma_f32_16x16x32_bf16 v[40:43], v[204:207], v[224:227], v[40:43]
    ds_read_b128 v[184:187], v1 offset:40960
    v_mfma_f32_16x16x32_bf16 v[44:47], v[208:211], v[224:227], v[44:47]
    ds_read_b128 v[188:191], v1 offset:41984
    v_mfma_f32_16x16x32_bf16 v[48:51], v[204:207], v[228:231], v[48:51]
    ds_read_b128 v[192:195], v1 offset:43008
    v_mfma_f32_16x16x32_bf16 v[52:55], v[208:211], v[228:231], v[52:55]
    ds_read_b128 v[196:199], v1 offset:44032
    v_mfma_f32_16x16x32_bf16 v[56:59], v[204:207], v[232:235], v[56:59]
    ds_read_b128 v[200:203], v1 offset:45056
    v_mfma_f32_16x16x32_bf16 v[60:63], v[208:211], v[232:235], v[60:63]
    v_mfma_f32_16x16x32_bf16 v[64:67], v[204:207], v[236:239], v[64:67]
    v_mfma_f32_16x16x32_bf16 v[68:71], v[208:211], v[236:239], v[68:71]
    v_mfma_f32_16x16x32_bf16 v[72:75], v[204:207], v[240:243], v[72:75]
    v_mfma_f32_16x16x32_bf16 v[76:79], v[208:211], v[240:243], v[76:79]
    v_mfma_f32_16x16x32_bf16 v[80:83], v[204:207], v[244:247], v[80:83]
    v_mfma_f32_16x16x32_bf16 v[84:87], v[208:211], v[244:247], v[84:87]
    s_waitcnt lgkmcnt(5)
    v_mfma_f32_16x16x32_bf16 v[16:19], v[160:163], v[168:171], v[16:19]
    ds_read_b128 v[204:207], v3 offset:37888
    v_mfma_f32_16x16x32_bf16 v[20:23], v[164:167], v[168:171], v[20:23]
    ds_read_b128 v[208:211], v3 offset:39936
    v_mfma_f32_16x16x32_bf16 v[24:27], v[160:163], v[172:175], v[24:27]
    ds_read_b128 v[212:215], v1 offset:46080
    v_mfma_f32_16x16x32_bf16 v[28:31], v[164:167], v[172:175], v[28:31]
    ds_read_b128 v[216:219], v1 offset:47104
    v_mfma_f32_16x16x32_bf16 v[32:35], v[160:163], v[176:179], v[32:35]
    ds_read_b128 v[220:223], v1 offset:48128
    v_mfma_f32_16x16x32_bf16 v[36:39], v[164:167], v[176:179], v[36:39]
    ds_read_b128 v[224:227], v1 offset:49152
    v_mfma_f32_16x16x32_bf16 v[40:43], v[160:163], v[180:183], v[40:43]
    ds_read_b128 v[228:231], v1 offset:50176
    v_mfma_f32_16x16x32_bf16 v[44:47], v[164:167], v[180:183], v[44:47]
    ds_read_b128 v[232:235], v1 offset:51200
    s_waitcnt lgkmcnt(8)
    v_mfma_f32_16x16x32_bf16 v[48:51], v[160:163], v[184:187], v[48:51]
    ds_read_b128 v[236:239], v1 offset:52224
    v_mfma_f32_16x16x32_bf16 v[52:55], v[164:167], v[184:187], v[52:55]
    ds_read_b128 v[240:243], v1 offset:53248
    v_rcp_f32 v120, v96
    v_mfma_f32_16x16x32_bf16 v[56:59], v[160:163], v[188:191], v[56:59]
    ds_read_b128 v[244:247], v1 offset:54272
    v_mul_f32 v104, s40, v96
    v_mfma_f32_16x16x32_bf16 v[60:63], v[164:167], v[188:191], v[60:63]
    v_mul_f32 v112, v96, v96
    v_mfma_f32_16x16x32_bf16 v[64:67], v[160:163], v[192:195], v[64:67]
    v_rcp_f32 v121, v97
    v_mfma_f32_16x16x32_bf16 v[68:71], v[164:167], v[192:195], v[68:71]
    v_mul_f32 v105, s40, v97
    v_mfma_f32_16x16x32_bf16 v[72:75], v[160:163], v[196:199], v[72:75]
    v_mul_f32 v113, v97, v97
    v_mfma_f32_16x16x32_bf16 v[76:79], v[164:167], v[196:199], v[76:79]
    v_rcp_f32 v122, v98
    v_mfma_f32_16x16x32_bf16 v[80:83], v[160:163], v[200:203], v[80:83]
    v_mul_f32 v106, s40, v98
    v_mfma_f32_16x16x32_bf16 v[84:87], v[164:167], v[200:203], v[84:87]
    v_mul_f32 v114, v98, v98
    v_rcp_f32 v123, v99
    s_waitcnt lgkmcnt(0)
    s_barrier
    v_mfma_f32_16x16x32_bf16 v[16:19], v[204:207], v[212:215], v[16:19]
    ds_read_b128 v[160:163], v0 offset:0
    v_mfma_f32_16x16x32_bf16 v[20:23], v[208:211], v[212:215], v[20:23]
    ds_read_b128 v[164:167], v0 offset:2048
    v_mfma_f32_16x16x32_bf16 v[24:27], v[204:207], v[216:219], v[24:27]
    ds_read_b128 v[168:171], v2 offset:0
    v_mfma_f32_16x16x32_bf16 v[28:31], v[208:211], v[216:219], v[28:31]
    ds_read_b128 v[172:175], v2 offset:1024
    v_mfma_f32_16x16x32_bf16 v[32:35], v[204:207], v[220:223], v[32:35]
    ds_read_b128 v[176:179], v2 offset:2048
    v_mfma_f32_16x16x32_bf16 v[36:39], v[208:211], v[220:223], v[36:39]
    ds_read_b128 v[180:183], v2 offset:3072
    v_mfma_f32_16x16x32_bf16 v[40:43], v[204:207], v[224:227], v[40:43]
    ds_read_b128 v[184:187], v2 offset:4096
    v_mfma_f32_16x16x32_bf16 v[44:47], v[208:211], v[224:227], v[44:47]
    ds_read_b128 v[188:191], v2 offset:5120
    v_mfma_f32_16x16x32_bf16 v[48:51], v[204:207], v[228:231], v[48:51]
    ds_read_b128 v[192:195], v2 offset:6144
    v_mfma_f32_16x16x32_bf16 v[52:55], v[208:211], v[228:231], v[52:55]
    ds_read_b128 v[196:199], v2 offset:7168
    v_mul_f32 v107, s40, v99
    v_mfma_f32_16x16x32_bf16 v[56:59], v[204:207], v[232:235], v[56:59]
    ds_read_b128 v[200:203], v2 offset:8192
    v_mul_f32 v115, v99, v99
    v_mfma_f32_16x16x32_bf16 v[60:63], v[208:211], v[232:235], v[60:63]
    v_rcp_f32 v124, v100
    v_mfma_f32_16x16x32_bf16 v[64:67], v[204:207], v[236:239], v[64:67]
    v_mul_f32 v108, s40, v100
    v_mfma_f32_16x16x32_bf16 v[68:71], v[208:211], v[236:239], v[68:71]
    v_mul_f32 v116, v100, v100
    v_mfma_f32_16x16x32_bf16 v[72:75], v[204:207], v[240:243], v[72:75]
    v_rcp_f32 v125, v101
    v_mfma_f32_16x16x32_bf16 v[76:79], v[208:211], v[240:243], v[76:79]
    v_mul_f32 v109, s40, v101
    v_mfma_f32_16x16x32_bf16 v[80:83], v[204:207], v[244:247], v[80:83]
    v_mul_f32 v117, v101, v101
    v_mfma_f32_16x16x32_bf16 v[84:87], v[208:211], v[244:247], v[84:87]
    v_rcp_f32 v126, v102
    v_mul_f32 v110, s40, v102
    s_waitcnt lgkmcnt(5)
    v_mfma_f32_16x16x32_bf16 v[16:19], v[160:163], v[168:171], v[16:19]
    ds_read_b128 v[204:207], v0 offset:1024
    v_mfma_f32_16x16x32_bf16 v[20:23], v[164:167], v[168:171], v[20:23]
    ds_read_b128 v[208:211], v0 offset:3072
    v_mfma_f32_16x16x32_bf16 v[24:27], v[160:163], v[172:175], v[24:27]
    ds_read_b128 v[212:215], v2 offset:9216
    v_mfma_f32_16x16x32_bf16 v[28:31], v[164:167], v[172:175], v[28:31]
    ds_read_b128 v[216:219], v2 offset:10240
    v_mfma_f32_16x16x32_bf16 v[32:35], v[160:163], v[176:179], v[32:35]
    ds_read_b128 v[220:223], v2 offset:11264
    v_mfma_f32_16x16x32_bf16 v[36:39], v[164:167], v[176:179], v[36:39]
    ds_read_b128 v[224:227], v2 offset:12288
    v_mfma_f32_16x16x32_bf16 v[40:43], v[160:163], v[180:183], v[40:43]
    ds_read_b128 v[228:231], v2 offset:13312
    v_mfma_f32_16x16x32_bf16 v[44:47], v[164:167], v[180:183], v[44:47]
    ds_read_b128 v[232:235], v2 offset:14336
    s_waitcnt lgkmcnt(8)
    v_mfma_f32_16x16x32_bf16 v[48:51], v[160:163], v[184:187], v[48:51]
    ds_read_b128 v[236:239], v2 offset:15360
    v_mfma_f32_16x16x32_bf16 v[52:55], v[164:167], v[184:187], v[52:55]
    ds_read_b128 v[240:243], v2 offset:16384
    v_mul_f32 v118, v102, v102
    v_mfma_f32_16x16x32_bf16 v[56:59], v[160:163], v[188:191], v[56:59]
    ds_read_b128 v[244:247], v2 offset:17408
    v_rcp_f32 v127, v103
    v_mfma_f32_16x16x32_bf16 v[60:63], v[164:167], v[188:191], v[60:63]
    v_mul_f32 v111, s40, v103
    v_mfma_f32_16x16x32_bf16 v[64:67], v[160:163], v[192:195], v[64:67]
    v_mul_f32 v119, v103, v103
    v_mfma_f32_16x16x32_bf16 v[68:71], v[164:167], v[192:195], v[68:71]
    v_mul_f32 v112, s42, v112
    v_mfma_f32_16x16x32_bf16 v[72:75], v[160:163], v[196:199], v[72:75]
    v_mul_f32 v113, s42, v113
    v_mfma_f32_16x16x32_bf16 v[76:79], v[164:167], v[196:199], v[76:79]
    v_mul_f32 v114, s42, v114
    v_mfma_f32_16x16x32_bf16 v[80:83], v[160:163], v[200:203], v[80:83]
    v_mul_f32 v115, s42, v115
    v_mfma_f32_16x16x32_bf16 v[84:87], v[164:167], v[200:203], v[84:87]
    v_mul_f32 v116, s42, v116
    v_mul_f32 v117, s42, v117
    s_waitcnt lgkmcnt(0)
    s_barrier
    v_mfma_f32_16x16x32_bf16 v[16:19], v[204:207], v[212:215], v[16:19]
    ds_read_b128 v[160:163], v0 offset:36864
    v_mfma_f32_16x16x32_bf16 v[20:23], v[208:211], v[212:215], v[20:23]
    ds_read_b128 v[164:167], v0 offset:38912
    v_mfma_f32_16x16x32_bf16 v[24:27], v[204:207], v[216:219], v[24:27]
    ds_read_b128 v[168:171], v2 offset:36864
    v_mfma_f32_16x16x32_bf16 v[28:31], v[208:211], v[216:219], v[28:31]
    ds_read_b128 v[172:175], v2 offset:37888
    v_mfma_f32_16x16x32_bf16 v[32:35], v[204:207], v[220:223], v[32:35]
    ds_read_b128 v[176:179], v2 offset:38912
    v_mfma_f32_16x16x32_bf16 v[36:39], v[208:211], v[220:223], v[36:39]
    ds_read_b128 v[180:183], v2 offset:39936
    v_mfma_f32_16x16x32_bf16 v[40:43], v[204:207], v[224:227], v[40:43]
    ds_read_b128 v[184:187], v2 offset:40960
    v_mfma_f32_16x16x32_bf16 v[44:47], v[208:211], v[224:227], v[44:47]
    ds_read_b128 v[188:191], v2 offset:41984
    v_mfma_f32_16x16x32_bf16 v[48:51], v[204:207], v[228:231], v[48:51]
    ds_read_b128 v[192:195], v2 offset:43008
    v_mfma_f32_16x16x32_bf16 v[52:55], v[208:211], v[228:231], v[52:55]
    ds_read_b128 v[196:199], v2 offset:44032
    v_mul_f32 v118, s42, v118
    v_mfma_f32_16x16x32_bf16 v[56:59], v[204:207], v[232:235], v[56:59]
    ds_read_b128 v[200:203], v2 offset:45056
    v_mul_f32 v119, s42, v119
    v_mfma_f32_16x16x32_bf16 v[60:63], v[208:211], v[232:235], v[60:63]
    v_mul_f32 v112, v112, v104
    v_mfma_f32_16x16x32_bf16 v[64:67], v[204:207], v[236:239], v[64:67]
    v_mul_f32 v113, v113, v105
    v_mfma_f32_16x16x32_bf16 v[68:71], v[208:211], v[236:239], v[68:71]
    v_mul_f32 v114, v114, v106
    v_mfma_f32_16x16x32_bf16 v[72:75], v[204:207], v[240:243], v[72:75]
    v_mul_f32 v115, v115, v107
    v_mfma_f32_16x16x32_bf16 v[76:79], v[208:211], v[240:243], v[76:79]
    v_mul_f32 v116, v116, v108
    v_mfma_f32_16x16x32_bf16 v[80:83], v[204:207], v[244:247], v[80:83]
    v_mul_f32 v117, v117, v109
    v_mfma_f32_16x16x32_bf16 v[84:87], v[208:211], v[244:247], v[84:87]
    v_mul_f32 v118, v118, v110
    v_mul_f32 v119, v119, v111
    s_waitcnt lgkmcnt(5)
    v_mfma_f32_16x16x32_bf16 v[16:19], v[160:163], v[168:171], v[16:19]
    ds_read_b128 v[204:207], v0 offset:37888
    v_mfma_f32_16x16x32_bf16 v[20:23], v[164:167], v[168:171], v[20:23]
    ds_read_b128 v[208:211], v0 offset:39936
    v_mfma_f32_16x16x32_bf16 v[24:27], v[160:163], v[172:175], v[24:27]
    ds_read_b128 v[212:215], v2 offset:46080
    v_mfma_f32_16x16x32_bf16 v[28:31], v[164:167], v[172:175], v[28:31]
    ds_read_b128 v[216:219], v2 offset:47104
    v_mfma_f32_16x16x32_bf16 v[32:35], v[160:163], v[176:179], v[32:35]
    ds_read_b128 v[220:223], v2 offset:48128
    v_mfma_f32_16x16x32_bf16 v[36:39], v[164:167], v[176:179], v[36:39]
    ds_read_b128 v[224:227], v2 offset:49152
    v_mfma_f32_16x16x32_bf16 v[40:43], v[160:163], v[180:183], v[40:43]
    ds_read_b128 v[228:231], v2 offset:50176
    v_mfma_f32_16x16x32_bf16 v[44:47], v[164:167], v[180:183], v[44:47]
    ds_read_b128 v[232:235], v2 offset:51200
    s_waitcnt lgkmcnt(8)
    v_mfma_f32_16x16x32_bf16 v[48:51], v[160:163], v[184:187], v[48:51]
    ds_read_b128 v[236:239], v2 offset:52224
    v_mfma_f32_16x16x32_bf16 v[52:55], v[164:167], v[184:187], v[52:55]
    ds_read_b128 v[240:243], v2 offset:53248
    v_add_f32 v128, v128, v138
    v_mfma_f32_16x16x32_bf16 v[56:59], v[160:163], v[188:191], v[56:59]
    ds_read_b128 v[244:247], v2 offset:54272
    v_add_f32 v129, v129, v139
    v_mfma_f32_16x16x32_bf16 v[60:63], v[164:167], v[188:191], v[60:63]
    v_add_f32 v130, v130, v140
    v_mfma_f32_16x16x32_bf16 v[64:67], v[160:163], v[192:195], v[64:67]
    v_add_f32 v131, v131, v141
    v_mfma_f32_16x16x32_bf16 v[68:71], v[164:167], v[192:195], v[68:71]
    v_add_f32 v132, v132, v142
    v_mfma_f32_16x16x32_bf16 v[72:75], v[160:163], v[196:199], v[72:75]
    v_add_f32 v133, v133, v143
    v_mfma_f32_16x16x32_bf16 v[76:79], v[164:167], v[196:199], v[76:79]
    v_add_f32 v134, v134, v144
    v_mfma_f32_16x16x32_bf16 v[80:83], v[160:163], v[200:203], v[80:83]
    v_add_f32 v135, v135, v145
    v_mfma_f32_16x16x32_bf16 v[84:87], v[164:167], v[200:203], v[84:87]
    v_add_f32 v136, v136, v146
    v_lshrrev_b32 v8, 2, v6
    s_waitcnt lgkmcnt(0)
    s_barrier
    v_mfma_f32_16x16x32_bf16 v[16:19], v[204:207], v[212:215], v[16:19]
    ds_read_b128 v[160:163], v3 offset:0
    v_mfma_f32_16x16x32_bf16 v[20:23], v[208:211], v[212:215], v[20:23]
    ds_read_b128 v[164:167], v3 offset:2048
    v_mfma_f32_16x16x32_bf16 v[24:27], v[204:207], v[216:219], v[24:27]
    ds_read_b128 v[168:171], v1 offset:0
    v_mfma_f32_16x16x32_bf16 v[28:31], v[208:211], v[216:219], v[28:31]
    ds_read_b128 v[172:175], v1 offset:1024
    v_mfma_f32_16x16x32_bf16 v[32:35], v[204:207], v[220:223], v[32:35]
    ds_read_b128 v[176:179], v1 offset:2048
    v_mfma_f32_16x16x32_bf16 v[36:39], v[208:211], v[220:223], v[36:39]
    ds_read_b128 v[180:183], v1 offset:3072
    v_mfma_f32_16x16x32_bf16 v[40:43], v[204:207], v[224:227], v[40:43]
    ds_read_b128 v[184:187], v1 offset:4096
    v_mfma_f32_16x16x32_bf16 v[44:47], v[208:211], v[224:227], v[44:47]
    ds_read_b128 v[188:191], v1 offset:5120
    v_mfma_f32_16x16x32_bf16 v[48:51], v[204:207], v[228:231], v[48:51]
    ds_read_b128 v[192:195], v1 offset:6144
    v_mfma_f32_16x16x32_bf16 v[52:55], v[208:211], v[228:231], v[52:55]
    ds_read_b128 v[196:199], v1 offset:7168
    v_lshlrev_b32 v8, 4, v8
    v_mfma_f32_16x16x32_bf16 v[56:59], v[204:207], v[232:235], v[56:59]
    ds_read_b128 v[200:203], v1 offset:8192
    v_lshl_add_u32 v8, v5, 6, v8
    v_mfma_f32_16x16x32_bf16 v[60:63], v[208:211], v[232:235], v[60:63]
    v_and_b32 v9, 3, v6
    v_mfma_f32_16x16x32_bf16 v[64:67], v[204:207], v[236:239], v[64:67]
    v_cmp_eq_u32 vcc, 0, v9
    v_mfma_f32_16x16x32_bf16 v[68:71], v[208:211], v[236:239], v[68:71]
    v_bfrev_b32 v10, 1
    v_mfma_f32_16x16x32_bf16 v[72:75], v[204:207], v[240:243], v[72:75]
    v_lshl_add_u32 v255, v9, 8, v8
    v_mfma_f32_16x16x32_bf16 v[76:79], v[208:211], v[240:243], v[76:79]
    v_cndmask_b32 v8, v10, v8, vcc
    v_mfma_f32_16x16x32_bf16 v[80:83], v[204:207], v[244:247], v[80:83]
    v_mfma_f32_16x16x32_bf16 v[84:87], v[208:211], v[244:247], v[84:87]
    s_waitcnt lgkmcnt(5)
    v_mfma_f32_16x16x32_bf16 v[16:19], v[160:163], v[168:171], v[16:19]
    ds_read_b128 v[204:207], v3 offset:1024
    v_mfma_f32_16x16x32_bf16 v[20:23], v[164:167], v[168:171], v[20:23]
    ds_read_b128 v[208:211], v3 offset:3072
    v_mfma_f32_16x16x32_bf16 v[24:27], v[160:163], v[172:175], v[24:27]
    ds_read_b128 v[212:215], v1 offset:9216
    v_mfma_f32_16x16x32_bf16 v[28:31], v[164:167], v[172:175], v[28:31]
    ds_read_b128 v[216:219], v1 offset:10240
    v_mfma_f32_16x16x32_bf16 v[32:35], v[160:163], v[176:179], v[32:35]
    ds_read_b128 v[220:223], v1 offset:11264
    v_mfma_f32_16x16x32_bf16 v[36:39], v[164:167], v[176:179], v[36:39]
    ds_read_b128 v[224:227], v1 offset:12288
    v_mfma_f32_16x16x32_bf16 v[40:43], v[160:163], v[180:183], v[40:43]
    ds_read_b128 v[228:231], v1 offset:13312
    v_mfma_f32_16x16x32_bf16 v[44:47], v[164:167], v[180:183], v[44:47]
    ds_read_b128 v[232:235], v1 offset:14336
    s_waitcnt lgkmcnt(8)
    v_mfma_f32_16x16x32_bf16 v[48:51], v[160:163], v[184:187], v[48:51]
    ds_read_b128 v[236:239], v1 offset:15360
    v_mfma_f32_16x16x32_bf16 v[52:55], v[164:167], v[184:187], v[52:55]
    ds_read_b128 v[240:243], v1 offset:16384
    v_mfma_f32_16x16x32_bf16 v[56:59], v[160:163], v[188:191], v[56:59]
    ds_read_b128 v[244:247], v1 offset:17408
    v_mfma_f32_16x16x32_bf16 v[60:63], v[164:167], v[188:191], v[60:63]
    v_mfma_f32_16x16x32_bf16 v[64:67], v[160:163], v[192:195], v[64:67]
    v_mfma_f32_16x16x32_bf16 v[68:71], v[164:167], v[192:195], v[68:71]
    v_mfma_f32_16x16x32_bf16 v[72:75], v[160:163], v[196:199], v[72:75]
    v_mfma_f32_16x16x32_bf16 v[76:79], v[164:167], v[196:199], v[76:79]
    v_mfma_f32_16x16x32_bf16 v[80:83], v[160:163], v[200:203], v[80:83]
    v_mfma_f32_16x16x32_bf16 v[84:87], v[164:167], v[200:203], v[84:87]
    s_waitcnt lgkmcnt(0)
    s_barrier
    v_mfma_f32_16x16x32_bf16 v[16:19], v[204:207], v[212:215], v[16:19]
    ds_read_b128 v[160:163], v3 offset:36864
    v_mfma_f32_16x16x32_bf16 v[20:23], v[208:211], v[212:215], v[20:23]
    ds_read_b128 v[164:167], v3 offset:38912
    v_mfma_f32_16x16x32_bf16 v[24:27], v[204:207], v[216:219], v[24:27]
    ds_read_b128 v[168:171], v1 offset:36864
    v_mfma_f32_16x16x32_bf16 v[28:31], v[208:211], v[216:219], v[28:31]
    ds_read_b128 v[172:175], v1 offset:37888
    v_mfma_f32_16x16x32_bf16 v[32:35], v[204:207], v[220:223], v[32:35]
    ds_read_b128 v[176:179], v1 offset:38912
    v_mfma_f32_16x16x32_bf16 v[36:39], v[208:211], v[220:223], v[36:39]
    ds_read_b128 v[180:183], v1 offset:39936
    v_mfma_f32_16x16x32_bf16 v[40:43], v[204:207], v[224:227], v[40:43]
    ds_read_b128 v[184:187], v1 offset:40960
    v_mfma_f32_16x16x32_bf16 v[44:47], v[208:211], v[224:227], v[44:47]
    ds_read_b128 v[188:191], v1 offset:41984
    v_mfma_f32_16x16x32_bf16 v[48:51], v[204:207], v[228:231], v[48:51]
    ds_read_b128 v[192:195], v1 offset:43008
    v_mfma_f32_16x16x32_bf16 v[52:55], v[208:211], v[228:231], v[52:55]
    ds_read_b128 v[196:199], v1 offset:44032
    v_mfma_f32_16x16x32_bf16 v[56:59], v[204:207], v[232:235], v[56:59]
    ds_read_b128 v[200:203], v1 offset:45056
    v_mfma_f32_16x16x32_bf16 v[60:63], v[208:211], v[232:235], v[60:63]
    v_mfma_f32_16x16x32_bf16 v[64:67], v[204:207], v[236:239], v[64:67]
    v_mfma_f32_16x16x32_bf16 v[68:71], v[208:211], v[236:239], v[68:71]
    v_mfma_f32_16x16x32_bf16 v[72:75], v[204:207], v[240:243], v[72:75]
    v_mfma_f32_16x16x32_bf16 v[76:79], v[208:211], v[240:243], v[76:79]
    v_mfma_f32_16x16x32_bf16 v[80:83], v[204:207], v[244:247], v[80:83]
    v_mfma_f32_16x16x32_bf16 v[84:87], v[208:211], v[244:247], v[84:87]
    v_pk_fma_f32 v[16:17], v[88:89], v[128:129], v[16:17] op_sel:[0,0,0] op_sel_hi:[1,0,1] neg_lo:[1,0,0] neg_hi:[1,0,0]
    v_pk_fma_f32 v[18:19], v[90:91], v[128:129], v[18:19] op_sel:[0,0,0] op_sel_hi:[1,0,1] neg_lo:[1,0,0] neg_hi:[1,0,0]
    v_pk_fma_f32 v[20:21], v[92:93], v[128:129], v[20:21] op_sel:[0,0,0] op_sel_hi:[1,0,1] neg_lo:[1,0,0] neg_hi:[1,0,0]
    v_pk_fma_f32 v[22:23], v[94:95], v[128:129], v[22:23] op_sel:[0,0,0] op_sel_hi:[1,0,1] neg_lo:[1,0,0] neg_hi:[1,0,0]
    v_pk_mul_f32 v[220:221], v[16:17], v[16:17]
    v_pk_mul_f32 v[222:223], v[18:19], v[18:19]
    v_pk_mul_f32 v[224:225], v[20:21], v[20:21]
    v_pk_mul_f32 v[226:227], v[22:23], v[22:23]
    v_pk_fma_f32 v[220:221], v[220:221], v[112:113], v[104:105]
    v_pk_fma_f32 v[222:223], v[222:223], v[114:115], v[106:107]
    v_pk_fma_f32 v[224:225], v[224:225], v[116:117], v[108:109]
    v_pk_fma_f32 v[226:227], v[226:227], v[118:119], v[110:111]
    v_pk_mul_f32 v[220:221], v[220:221], v[16:17]
    v_pk_mul_f32 v[222:223], v[222:223], v[18:19]
    v_pk_mul_f32 v[224:225], v[224:225], v[20:21]
    v_pk_mul_f32 v[226:227], v[226:227], v[22:23]
    v_exp_f32 v220, v220
    v_exp_f32 v221, v221
    v_exp_f32 v222, v222
    v_exp_f32 v223, v223
    v_exp_f32 v224, v224
    v_exp_f32 v225, v225
    v_exp_f32 v226, v226
    v_exp_f32 v227, v227
    v_pk_fma_f32 v[220:221], v[220:221], v[120:121], v[120:121]
    v_pk_fma_f32 v[222:223], v[222:223], v[122:123], v[122:123]
    v_pk_fma_f32 v[224:225], v[224:225], v[124:125], v[124:125]
    v_pk_fma_f32 v[226:227], v[226:227], v[126:127], v[126:127]
    v_rcp_f32 v220, v220
    v_rcp_f32 v221, v221
    v_rcp_f32 v222, v222
    v_rcp_f32 v223, v223
    v_rcp_f32 v224, v224
    v_rcp_f32 v225, v225
    v_rcp_f32 v226, v226
    v_rcp_f32 v227, v227
    v_pk_mul_f32 v[16:17], v[16:17], v[220:221]
    v_pk_mul_f32 v[18:19], v[18:19], v[222:223]
    v_pk_mul_f32 v[20:21], v[20:21], v[224:225]
    v_pk_mul_f32 v[22:23], v[22:23], v[226:227]
    v_pk_mul_f32 v[206:207], v[16:17], v[16:17]
    v_pk_mul_f32 v[210:211], v[18:19], v[18:19]
    v_pk_mul_f32 v[214:215], v[20:21], v[20:21]
    v_pk_mul_f32 v[218:219], v[22:23], v[22:23]
    v_pk_fma_f32 v[24:25], v[88:89], v[128:129], v[24:25] op_sel:[0,1,0] op_sel_hi:[1,1,1] neg_lo:[1,0,0] neg_hi:[1,0,0]
    v_pk_fma_f32 v[26:27], v[90:91], v[128:129], v[26:27] op_sel:[0,1,0] op_sel_hi:[1,1,1] neg_lo:[1,0,0] neg_hi:[1,0,0]
    v_pk_fma_f32 v[28:29], v[92:93], v[128:129], v[28:29] op_sel:[0,1,0] op_sel_hi:[1,1,1] neg_lo:[1,0,0] neg_hi:[1,0,0]
    v_pk_fma_f32 v[30:31], v[94:95], v[128:129], v[30:31] op_sel:[0,1,0] op_sel_hi:[1,1,1] neg_lo:[1,0,0] neg_hi:[1,0,0]
    v_pk_mul_f32 v[228:229], v[24:25], v[24:25]
    v_pk_mul_f32 v[230:231], v[26:27], v[26:27]
    v_pk_mul_f32 v[232:233], v[28:29], v[28:29]
    v_pk_mul_f32 v[234:235], v[30:31], v[30:31]
    v_pk_fma_f32 v[228:229], v[228:229], v[112:113], v[104:105]
    v_pk_fma_f32 v[230:231], v[230:231], v[114:115], v[106:107]
    v_pk_fma_f32 v[232:233], v[232:233], v[116:117], v[108:109]
    v_pk_fma_f32 v[234:235], v[234:235], v[118:119], v[110:111]
    v_pk_mul_f32 v[228:229], v[228:229], v[24:25]
    v_pk_mul_f32 v[230:231], v[230:231], v[26:27]
    v_pk_mul_f32 v[232:233], v[232:233], v[28:29]
    v_pk_mul_f32 v[234:235], v[234:235], v[30:31]
    v_exp_f32 v228, v228
    v_exp_f32 v229, v229
    v_exp_f32 v230, v230
    v_exp_f32 v231, v231
    v_exp_f32 v232, v232
    v_exp_f32 v233, v233
    v_exp_f32 v234, v234
    v_exp_f32 v235, v235
    v_pk_fma_f32 v[228:229], v[228:229], v[120:121], v[120:121]
    v_pk_fma_f32 v[230:231], v[230:231], v[122:123], v[122:123]
    v_pk_fma_f32 v[232:233], v[232:233], v[124:125], v[124:125]
    v_pk_fma_f32 v[234:235], v[234:235], v[126:127], v[126:127]
    v_rcp_f32 v228, v228
    v_rcp_f32 v229, v229
    v_rcp_f32 v230, v230
    v_rcp_f32 v231, v231
    v_rcp_f32 v232, v232
    v_rcp_f32 v233, v233
    v_rcp_f32 v234, v234
    v_rcp_f32 v235, v235
    v_pk_mul_f32 v[24:25], v[24:25], v[228:229]
    v_pk_mul_f32 v[26:27], v[26:27], v[230:231]
    v_pk_mul_f32 v[28:29], v[28:29], v[232:233]
    v_pk_mul_f32 v[30:31], v[30:31], v[234:235]
    v_pk_add_f32 v[204:205], v[16:17], v[24:25]
    v_pk_fma_f32 v[206:207], v[24:25], v[24:25], v[206:207]
    v_pk_add_f32 v[208:209], v[18:19], v[26:27]
    v_pk_fma_f32 v[210:211], v[26:27], v[26:27], v[210:211]
    v_pk_add_f32 v[212:213], v[20:21], v[28:29]
    v_pk_fma_f32 v[214:215], v[28:29], v[28:29], v[214:215]
    v_pk_add_f32 v[216:217], v[22:23], v[30:31]
    v_pk_fma_f32 v[218:219], v[30:31], v[30:31], v[218:219]
    v_pk_fma_f32 v[32:33], v[88:89], v[130:131], v[32:33] op_sel:[0,0,0] op_sel_hi:[1,0,1] neg_lo:[1,0,0] neg_hi:[1,0,0]
    v_pk_fma_f32 v[34:35], v[90:91], v[130:131], v[34:35] op_sel:[0,0,0] op_sel_hi:[1,0,1] neg_lo:[1,0,0] neg_hi:[1,0,0]
    v_pk_fma_f32 v[36:37], v[92:93], v[130:131], v[36:37] op_sel:[0,0,0] op_sel_hi:[1,0,1] neg_lo:[1,0,0] neg_hi:[1,0,0]
    v_pk_fma_f32 v[38:39], v[94:95], v[130:131], v[38:39] op_sel:[0,0,0] op_sel_hi:[1,0,1] neg_lo:[1,0,0] neg_hi:[1,0,0]
    v_pk_mul_f32 v[220:221], v[32:33], v[32:33]
    v_pk_mul_f32 v[222:223], v[34:35], v[34:35]
    v_pk_mul_f32 v[224:225], v[36:37], v[36:37]
    v_pk_mul_f32 v[226:227], v[38:39], v[38:39]
    v_pk_fma_f32 v[220:221], v[220:221], v[112:113], v[104:105]
    v_pk_fma_f32 v[222:223], v[222:223], v[114:115], v[106:107]
    v_pk_fma_f32 v[224:225], v[224:225], v[116:117], v[108:109]
    v_pk_fma_f32 v[226:227], v[226:227], v[118:119], v[110:111]
    v_pk_mul_f32 v[220:221], v[220:221], v[32:33]
    v_pk_mul_f32 v[222:223], v[222:223], v[34:35]
    v_pk_mul_f32 v[224:225], v[224:225], v[36:37]
    v_pk_mul_f32 v[226:227], v[226:227], v[38:39]
    v_exp_f32 v220, v220
    v_exp_f32 v221, v221
    v_exp_f32 v222, v222
    v_exp_f32 v223, v223
    v_exp_f32 v224, v224
    v_exp_f32 v225, v225
    v_exp_f32 v226, v226
    v_exp_f32 v227, v227
    v_pk_fma_f32 v[220:221], v[220:221], v[120:121], v[120:121]
    v_pk_fma_f32 v[222:223], v[222:223], v[122:123], v[122:123]
    v_pk_fma_f32 v[224:225], v[224:225], v[124:125], v[124:125]
    v_pk_fma_f32 v[226:227], v[226:227], v[126:127], v[126:127]
    v_rcp_f32 v220, v220
    v_rcp_f32 v221, v221
    v_rcp_f32 v222, v222
    v_rcp_f32 v223, v223
    v_rcp_f32 v224, v224
    v_rcp_f32 v225, v225
    v_rcp_f32 v226, v226
    v_rcp_f32 v227, v227
    v_pk_mul_f32 v[32:33], v[32:33], v[220:221]
    v_pk_mul_f32 v[34:35], v[34:35], v[222:223]
    v_pk_mul_f32 v[36:37], v[36:37], v[224:225]
    v_pk_mul_f32 v[38:39], v[38:39], v[226:227]
    v_pk_add_f32 v[204:205], v[204:205], v[32:33]
    v_pk_fma_f32 v[206:207], v[32:33], v[32:33], v[206:207]
    v_pk_add_f32 v[208:209], v[208:209], v[34:35]
    v_pk_fma_f32 v[210:211], v[34:35], v[34:35], v[210:211]
    v_pk_add_f32 v[212:213], v[212:213], v[36:37]
    v_pk_fma_f32 v[214:215], v[36:37], v[36:37], v[214:215]
    v_pk_add_f32 v[216:217], v[216:217], v[38:39]
    v_pk_fma_f32 v[218:219], v[38:39], v[38:39], v[218:219]
    v_pk_fma_f32 v[40:41], v[88:89], v[130:131], v[40:41] op_sel:[0,1,0] op_sel_hi:[1,1,1] neg_lo:[1,0,0] neg_hi:[1,0,0]
    v_pk_fma_f32 v[42:43], v[90:91], v[130:131], v[42:43] op_sel:[0,1,0] op_sel_hi:[1,1,1] neg_lo:[1,0,0] neg_hi:[1,0,0]
    v_pk_fma_f32 v[44:45], v[92:93], v[130:131], v[44:45] op_sel:[0,1,0] op_sel_hi:[1,1,1] neg_lo:[1,0,0] neg_hi:[1,0,0]
    v_pk_fma_f32 v[46:47], v[94:95], v[130:131], v[46:47] op_sel:[0,1,0] op_sel_hi:[1,1,1] neg_lo:[1,0,0] neg_hi:[1,0,0]
    v_pk_mul_f32 v[228:229], v[40:41], v[40:41]
    v_pk_mul_f32 v[230:231], v[42:43], v[42:43]
    v_pk_mul_f32 v[232:233], v[44:45], v[44:45]
    v_pk_mul_f32 v[234:235], v[46:47], v[46:47]
    v_pk_fma_f32 v[228:229], v[228:229], v[112:113], v[104:105]
    v_pk_fma_f32 v[230:231], v[230:231], v[114:115], v[106:107]
    v_pk_fma_f32 v[232:233], v[232:233], v[116:117], v[108:109]
    v_pk_fma_f32 v[234:235], v[234:235], v[118:119], v[110:111]
    v_pk_mul_f32 v[228:229], v[228:229], v[40:41]
    v_pk_mul_f32 v[230:231], v[230:231], v[42:43]
    v_pk_mul_f32 v[232:233], v[232:233], v[44:45]
    v_pk_mul_f32 v[234:235], v[234:235], v[46:47]
    v_exp_f32 v228, v228
    v_exp_f32 v229, v229
    v_exp_f32 v230, v230
    v_exp_f32 v231, v231
    v_exp_f32 v232, v232
    v_exp_f32 v233, v233
    v_exp_f32 v234, v234
    v_exp_f32 v235, v235
    v_pk_fma_f32 v[228:229], v[228:229], v[120:121], v[120:121]
    v_pk_fma_f32 v[230:231], v[230:231], v[122:123], v[122:123]
    v_pk_fma_f32 v[232:233], v[232:233], v[124:125], v[124:125]
    v_pk_fma_f32 v[234:235], v[234:235], v[126:127], v[126:127]
    v_rcp_f32 v228, v228
    v_rcp_f32 v229, v229
    v_rcp_f32 v230, v230
    v_rcp_f32 v231, v231
    v_rcp_f32 v232, v232
    v_rcp_f32 v233, v233
    v_rcp_f32 v234, v234
    v_rcp_f32 v235, v235
    v_pk_mul_f32 v[40:41], v[40:41], v[228:229]
    v_pk_mul_f32 v[42:43], v[42:43], v[230:231]
    v_pk_mul_f32 v[44:45], v[44:45], v[232:233]
    v_pk_mul_f32 v[46:47], v[46:47], v[234:235]
    v_pk_add_f32 v[204:205], v[204:205], v[40:41]
    v_pk_fma_f32 v[206:207], v[40:41], v[40:41], v[206:207]
    v_pk_add_f32 v[208:209], v[208:209], v[42:43]
    v_pk_fma_f32 v[210:211], v[42:43], v[42:43], v[210:211]
    v_pk_add_f32 v[212:213], v[212:213], v[44:45]
    v_pk_fma_f32 v[214:215], v[44:45], v[44:45], v[214:215]
    v_pk_add_f32 v[216:217], v[216:217], v[46:47]
    v_pk_fma_f32 v[218:219], v[46:47], v[46:47], v[218:219]
    v_pk_fma_f32 v[48:49], v[88:89], v[132:133], v[48:49] op_sel:[0,0,0] op_sel_hi:[1,0,1] neg_lo:[1,0,0] neg_hi:[1,0,0]
    v_pk_fma_f32 v[50:51], v[90:91], v[132:133], v[50:51] op_sel:[0,0,0] op_sel_hi:[1,0,1] neg_lo:[1,0,0] neg_hi:[1,0,0]
    v_pk_fma_f32 v[52:53], v[92:93], v[132:133], v[52:53] op_sel:[0,0,0] op_sel_hi:[1,0,1] neg_lo:[1,0,0] neg_hi:[1,0,0]
    v_pk_fma_f32 v[54:55], v[94:95], v[132:133], v[54:55] op_sel:[0,0,0] op_sel_hi:[1,0,1] neg_lo:[1,0,0] neg_hi:[1,0,0]
    v_pk_mul_f32 v[220:221], v[48:49], v[48:49]
    v_pk_mul_f32 v[222:223], v[50:51], v[50:51]
    v_pk_mul_f32 v[224:225], v[52:53], v[52:53]
    v_pk_mul_f32 v[226:227], v[54:55], v[54:55]
    v_pk_fma_f32 v[220:221], v[220:221], v[112:113], v[104:105]
    v_pk_fma_f32 v[222:223], v[222:223], v[114:115], v[106:107]
    v_pk_fma_f32 v[224:225], v[224:225], v[116:117], v[108:109]
    v_pk_fma_f32 v[226:227], v[226:227], v[118:119], v[110:111]
    v_pk_mul_f32 v[220:221], v[220:221], v[48:49]
    v_pk_mul_f32 v[222:223], v[222:223], v[50:51]
    v_pk_mul_f32 v[224:225], v[224:225], v[52:53]
    v_pk_mul_f32 v[226:227], v[226:227], v[54:55]
    v_exp_f32 v220, v220
    v_exp_f32 v221, v221
    v_exp_f32 v222, v222
    v_exp_f32 v223, v223
    v_exp_f32 v224, v224
    v_exp_f32 v225, v225
    v_exp_f32 v226, v226
    v_exp_f32 v227, v227
    v_pk_fma_f32 v[220:221], v[220:221], v[120:121], v[120:121]
    v_pk_fma_f32 v[222:223], v[222:223], v[122:123], v[122:123]
    v_pk_fma_f32 v[224:225], v[224:225], v[124:125], v[124:125]
    v_pk_fma_f32 v[226:227], v[226:227], v[126:127], v[126:127]
    v_rcp_f32 v220, v220
    v_rcp_f32 v221, v221
    v_rcp_f32 v222, v222
    v_rcp_f32 v223, v223
    v_rcp_f32 v224, v224
    v_rcp_f32 v225, v225
    v_rcp_f32 v226, v226
    v_rcp_f32 v227, v227
    v_pk_mul_f32 v[48:49], v[48:49], v[220:221]
    v_pk_mul_f32 v[50:51], v[50:51], v[222:223]
    v_pk_mul_f32 v[52:53], v[52:53], v[224:225]
    v_pk_mul_f32 v[54:55], v[54:55], v[226:227]
    v_pk_add_f32 v[204:205], v[204:205], v[48:49]
    v_pk_fma_f32 v[206:207], v[48:49], v[48:49], v[206:207]
    v_pk_add_f32 v[208:209], v[208:209], v[50:51]
    v_pk_fma_f32 v[210:211], v[50:51], v[50:51], v[210:211]
    v_pk_add_f32 v[212:213], v[212:213], v[52:53]
    v_pk_fma_f32 v[214:215], v[52:53], v[52:53], v[214:215]
    v_pk_add_f32 v[216:217], v[216:217], v[54:55]
    v_pk_fma_f32 v[218:219], v[54:55], v[54:55], v[218:219]
    v_pk_fma_f32 v[56:57], v[88:89], v[132:133], v[56:57] op_sel:[0,1,0] op_sel_hi:[1,1,1] neg_lo:[1,0,0] neg_hi:[1,0,0]
    v_pk_fma_f32 v[58:59], v[90:91], v[132:133], v[58:59] op_sel:[0,1,0] op_sel_hi:[1,1,1] neg_lo:[1,0,0] neg_hi:[1,0,0]
    v_pk_fma_f32 v[60:61], v[92:93], v[132:133], v[60:61] op_sel:[0,1,0] op_sel_hi:[1,1,1] neg_lo:[1,0,0] neg_hi:[1,0,0]
    v_pk_fma_f32 v[62:63], v[94:95], v[132:133], v[62:63] op_sel:[0,1,0] op_sel_hi:[1,1,1] neg_lo:[1,0,0] neg_hi:[1,0,0]
    v_pk_mul_f32 v[228:229], v[56:57], v[56:57]
    v_pk_mul_f32 v[230:231], v[58:59], v[58:59]
    v_pk_mul_f32 v[232:233], v[60:61], v[60:61]
    v_pk_mul_f32 v[234:235], v[62:63], v[62:63]
    v_pk_fma_f32 v[228:229], v[228:229], v[112:113], v[104:105]
    v_pk_fma_f32 v[230:231], v[230:231], v[114:115], v[106:107]
    v_pk_fma_f32 v[232:233], v[232:233], v[116:117], v[108:109]
    v_pk_fma_f32 v[234:235], v[234:235], v[118:119], v[110:111]
    v_pk_mul_f32 v[228:229], v[228:229], v[56:57]
    v_pk_mul_f32 v[230:231], v[230:231], v[58:59]
    v_pk_mul_f32 v[232:233], v[232:233], v[60:61]
    v_pk_mul_f32 v[234:235], v[234:235], v[62:63]
    v_exp_f32 v228, v228
    v_exp_f32 v229, v229
    v_exp_f32 v230, v230
    v_exp_f32 v231, v231
    v_exp_f32 v232, v232
    v_exp_f32 v233, v233
    v_exp_f32 v234, v234
    v_exp_f32 v235, v235
    v_pk_fma_f32 v[228:229], v[228:229], v[120:121], v[120:121]
    v_pk_fma_f32 v[230:231], v[230:231], v[122:123], v[122:123]
    v_pk_fma_f32 v[232:233], v[232:233], v[124:125], v[124:125]
    v_pk_fma_f32 v[234:235], v[234:235], v[126:127], v[126:127]
    v_rcp_f32 v228, v228
    v_rcp_f32 v229, v229
    v_rcp_f32 v230, v230
    v_rcp_f32 v231, v231
    v_rcp_f32 v232, v232
    v_rcp_f32 v233, v233
    v_rcp_f32 v234, v234
    v_rcp_f32 v235, v235
    v_pk_mul_f32 v[56:57], v[56:57], v[228:229]
    v_pk_mul_f32 v[58:59], v[58:59], v[230:231]
    v_pk_mul_f32 v[60:61], v[60:61], v[232:233]
    v_pk_mul_f32 v[62:63], v[62:63], v[234:235]
    v_pk_add_f32 v[204:205], v[204:205], v[56:57]
    v_pk_fma_f32 v[206:207], v[56:57], v[56:57], v[206:207]
    v_pk_add_f32 v[208:209], v[208:209], v[58:59]
    v_pk_fma_f32 v[210:211], v[58:59], v[58:59], v[210:211]
    v_pk_add_f32 v[212:213], v[212:213], v[60:61]
    v_pk_fma_f32 v[214:215], v[60:61], v[60:61], v[214:215]
    v_pk_add_f32 v[216:217], v[216:217], v[62:63]
    v_pk_fma_f32 v[218:219], v[62:63], v[62:63], v[218:219]
    v_pk_fma_f32 v[64:65], v[88:89], v[134:135], v[64:65] op_sel:[0,0,0] op_sel_hi:[1,0,1] neg_lo:[1,0,0] neg_hi:[1,0,0]
    v_pk_fma_f32 v[66:67], v[90:91], v[134:135], v[66:67] op_sel:[0,0,0] op_sel_hi:[1,0,1] neg_lo:[1,0,0] neg_hi:[1,0,0]
    v_pk_fma_f32 v[68:69], v[92:93], v[134:135], v[68:69] op_sel:[0,0,0] op_sel_hi:[1,0,1] neg_lo:[1,0,0] neg_hi:[1,0,0]
    v_pk_fma_f32 v[70:71], v[94:95], v[134:135], v[70:71] op_sel:[0,0,0] op_sel_hi:[1,0,1] neg_lo:[1,0,0] neg_hi:[1,0,0]
    v_pk_mul_f32 v[220:221], v[64:65], v[64:65]
    v_pk_mul_f32 v[222:223], v[66:67], v[66:67]
    v_pk_mul_f32 v[224:225], v[68:69], v[68:69]
    v_pk_mul_f32 v[226:227], v[70:71], v[70:71]
    v_pk_fma_f32 v[220:221], v[220:221], v[112:113], v[104:105]
    v_pk_fma_f32 v[222:223], v[222:223], v[114:115], v[106:107]
    v_pk_fma_f32 v[224:225], v[224:225], v[116:117], v[108:109]
    v_pk_fma_f32 v[226:227], v[226:227], v[118:119], v[110:111]
    v_pk_mul_f32 v[220:221], v[220:221], v[64:65]
    v_pk_mul_f32 v[222:223], v[222:223], v[66:67]
    v_pk_mul_f32 v[224:225], v[224:225], v[68:69]
    v_pk_mul_f32 v[226:227], v[226:227], v[70:71]
    v_exp_f32 v220, v220
    v_exp_f32 v221, v221
    v_exp_f32 v222, v222
    v_exp_f32 v223, v223
    v_exp_f32 v224, v224
    v_exp_f32 v225, v225
    v_exp_f32 v226, v226
    v_exp_f32 v227, v227
    v_pk_fma_f32 v[220:221], v[220:221], v[120:121], v[120:121]
    v_pk_fma_f32 v[222:223], v[222:223], v[122:123], v[122:123]
    v_pk_fma_f32 v[224:225], v[224:225], v[124:125], v[124:125]
    v_pk_fma_f32 v[226:227], v[226:227], v[126:127], v[126:127]
    v_rcp_f32 v220, v220
    v_rcp_f32 v221, v221
    v_rcp_f32 v222, v222
    v_rcp_f32 v223, v223
    v_rcp_f32 v224, v224
    v_rcp_f32 v225, v225
    v_rcp_f32 v226, v226
    v_rcp_f32 v227, v227
    v_pk_mul_f32 v[64:65], v[64:65], v[220:221]
    v_pk_mul_f32 v[66:67], v[66:67], v[222:223]
    v_pk_mul_f32 v[68:69], v[68:69], v[224:225]
    v_pk_mul_f32 v[70:71], v[70:71], v[226:227]
    v_pk_add_f32 v[204:205], v[204:205], v[64:65]
    v_pk_fma_f32 v[206:207], v[64:65], v[64:65], v[206:207]
    v_pk_add_f32 v[208:209], v[208:209], v[66:67]
    v_pk_fma_f32 v[210:211], v[66:67], v[66:67], v[210:211]
    v_pk_add_f32 v[212:213], v[212:213], v[68:69]
    v_pk_fma_f32 v[214:215], v[68:69], v[68:69], v[214:215]
    v_pk_add_f32 v[216:217], v[216:217], v[70:71]
    v_pk_fma_f32 v[218:219], v[70:71], v[70:71], v[218:219]
    v_pk_fma_f32 v[72:73], v[88:89], v[134:135], v[72:73] op_sel:[0,1,0] op_sel_hi:[1,1,1] neg_lo:[1,0,0] neg_hi:[1,0,0]
    v_pk_fma_f32 v[74:75], v[90:91], v[134:135], v[74:75] op_sel:[0,1,0] op_sel_hi:[1,1,1] neg_lo:[1,0,0] neg_hi:[1,0,0]
    v_pk_fma_f32 v[76:77], v[92:93], v[134:135], v[76:77] op_sel:[0,1,0] op_sel_hi:[1,1,1] neg_lo:[1,0,0] neg_hi:[1,0,0]
    v_pk_fma_f32 v[78:79], v[94:95], v[134:135], v[78:79] op_sel:[0,1,0] op_sel_hi:[1,1,1] neg_lo:[1,0,0] neg_hi:[1,0,0]
    v_pk_mul_f32 v[228:229], v[72:73], v[72:73]
    v_pk_mul_f32 v[230:231], v[74:75], v[74:75]
    v_pk_mul_f32 v[232:233], v[76:77], v[76:77]
    v_pk_mul_f32 v[234:235], v[78:79], v[78:79]
    v_pk_fma_f32 v[228:229], v[228:229], v[112:113], v[104:105]
    v_pk_fma_f32 v[230:231], v[230:231], v[114:115], v[106:107]
    v_pk_fma_f32 v[232:233], v[232:233], v[116:117], v[108:109]
    v_pk_fma_f32 v[234:235], v[234:235], v[118:119], v[110:111]
    v_pk_mul_f32 v[228:229], v[228:229], v[72:73]
    v_pk_mul_f32 v[230:231], v[230:231], v[74:75]
    v_pk_mul_f32 v[232:233], v[232:233], v[76:77]
    v_pk_mul_f32 v[234:235], v[234:235], v[78:79]
    v_exp_f32 v228, v228
    v_exp_f32 v229, v229
    v_exp_f32 v230, v230
    v_exp_f32 v231, v231
    v_exp_f32 v232, v232
    v_exp_f32 v233, v233
    v_exp_f32 v234, v234
    v_exp_f32 v235, v235
    v_pk_fma_f32 v[228:229], v[228:229], v[120:121], v[120:121]
    v_pk_fma_f32 v[230:231], v[230:231], v[122:123], v[122:123]
    v_pk_fma_f32 v[232:233], v[232:233], v[124:125], v[124:125]
    v_pk_fma_f32 v[234:235], v[234:235], v[126:127], v[126:127]
    v_rcp_f32 v228, v228
    v_rcp_f32 v229, v229
    v_rcp_f32 v230, v230
    v_rcp_f32 v231, v231
    v_rcp_f32 v232, v232
    v_rcp_f32 v233, v233
    v_rcp_f32 v234, v234
    v_rcp_f32 v235, v235
    v_pk_mul_f32 v[72:73], v[72:73], v[228:229]
    v_pk_mul_f32 v[74:75], v[74:75], v[230:231]
    v_pk_mul_f32 v[76:77], v[76:77], v[232:233]
    v_pk_mul_f32 v[78:79], v[78:79], v[234:235]
    v_pk_add_f32 v[204:205], v[204:205], v[72:73]
    v_pk_fma_f32 v[206:207], v[72:73], v[72:73], v[206:207]
    v_pk_add_f32 v[208:209], v[208:209], v[74:75]
    v_pk_fma_f32 v[210:211], v[74:75], v[74:75], v[210:211]
    v_pk_add_f32 v[212:213], v[212:213], v[76:77]
    v_pk_fma_f32 v[214:215], v[76:77], v[76:77], v[214:215]
    v_pk_add_f32 v[216:217], v[216:217], v[78:79]
    v_pk_fma_f32 v[218:219], v[78:79], v[78:79], v[218:219]
    v_pk_fma_f32 v[80:81], v[88:89], v[136:137], v[80:81] op_sel:[0,0,0] op_sel_hi:[1,0,1] neg_lo:[1,0,0] neg_hi:[1,0,0]
    v_pk_fma_f32 v[82:83], v[90:91], v[136:137], v[82:83] op_sel:[0,0,0] op_sel_hi:[1,0,1] neg_lo:[1,0,0] neg_hi:[1,0,0]
    v_pk_fma_f32 v[84:85], v[92:93], v[136:137], v[84:85] op_sel:[0,0,0] op_sel_hi:[1,0,1] neg_lo:[1,0,0] neg_hi:[1,0,0]
    v_pk_fma_f32 v[86:87], v[94:95], v[136:137], v[86:87] op_sel:[0,0,0] op_sel_hi:[1,0,1] neg_lo:[1,0,0] neg_hi:[1,0,0]
    v_pk_mul_f32 v[220:221], v[80:81], v[80:81]
    v_pk_mul_f32 v[222:223], v[82:83], v[82:83]
    v_pk_mul_f32 v[224:225], v[84:85], v[84:85]
    v_pk_mul_f32 v[226:227], v[86:87], v[86:87]
    v_pk_fma_f32 v[220:221], v[220:221], v[112:113], v[104:105]
    v_pk_fma_f32 v[222:223], v[222:223], v[114:115], v[106:107]
    v_pk_fma_f32 v[224:225], v[224:225], v[116:117], v[108:109]
    v_pk_fma_f32 v[226:227], v[226:227], v[118:119], v[110:111]
    v_pk_mul_f32 v[220:221], v[220:221], v[80:81]
    v_pk_mul_f32 v[222:223], v[222:223], v[82:83]
    v_pk_mul_f32 v[224:225], v[224:225], v[84:85]
    v_pk_mul_f32 v[226:227], v[226:227], v[86:87]
    v_exp_f32 v220, v220
    v_exp_f32 v221, v221
    v_exp_f32 v222, v222
    v_exp_f32 v223, v223
    v_exp_f32 v224, v224
    v_exp_f32 v225, v225
    v_exp_f32 v226, v226
    v_exp_f32 v227, v227
    v_pk_fma_f32 v[220:221], v[220:221], v[120:121], v[120:121]
    v_pk_fma_f32 v[222:223], v[222:223], v[122:123], v[122:123]
    v_pk_fma_f32 v[224:225], v[224:225], v[124:125], v[124:125]
    v_pk_fma_f32 v[226:227], v[226:227], v[126:127], v[126:127]
    v_rcp_f32 v220, v220
    v_rcp_f32 v221, v221
    v_rcp_f32 v222, v222
    v_rcp_f32 v223, v223
    v_rcp_f32 v224, v224
    v_rcp_f32 v225, v225
    v_rcp_f32 v226, v226
    v_rcp_f32 v227, v227
    v_pk_mul_f32 v[80:81], v[80:81], v[220:221]
    v_pk_mul_f32 v[82:83], v[82:83], v[222:223]
    v_pk_mul_f32 v[84:85], v[84:85], v[224:225]
    v_pk_mul_f32 v[86:87], v[86:87], v[226:227]
    v_pk_add_f32 v[204:205], v[204:205], v[80:81]
    v_pk_fma_f32 v[206:207], v[80:81], v[80:81], v[206:207]
    v_pk_add_f32 v[208:209], v[208:209], v[82:83]
    v_pk_fma_f32 v[210:211], v[82:83], v[82:83], v[210:211]
    v_pk_add_f32 v[212:213], v[212:213], v[84:85]
    v_pk_fma_f32 v[214:215], v[84:85], v[84:85], v[214:215]
    v_pk_add_f32 v[216:217], v[216:217], v[86:87]
    v_pk_fma_f32 v[218:219], v[86:87], v[86:87], v[218:219]
    v_add_f32_dpp v204, v204, v204 row_mirror row_mask:0xf bank_mask:0x3
    v_add_f32_dpp v205, v205, v205 row_mirror row_mask:0xf bank_mask:0x3
    v_add_f32_dpp v206, v206, v206 row_mirror row_mask:0xf bank_mask:0x3
    v_add_f32_dpp v207, v207, v207 row_mirror row_mask:0xf bank_mask:0x3
    v_add_f32_dpp v208, v208, v208 row_mirror row_mask:0xf bank_mask:0x3
    v_add_f32_dpp v209, v209, v209 row_mirror row_mask:0xf bank_mask:0x3
    v_add_f32_dpp v210, v210, v210 row_mirror row_mask:0xf bank_mask:0x3
    v_add_f32_dpp v211, v211, v211 row_mirror row_mask:0xf bank_mask:0x3
    v_add_f32_dpp v204, v212, v212 row_mirror row_mask:0xf bank_mask:0xc
    v_add_f32_dpp v205, v213, v213 row_mirror row_mask:0xf bank_mask:0xc
    v_add_f32_dpp v206, v214, v214 row_mirror row_mask:0xf bank_mask:0xc
    v_add_f32_dpp v207, v215, v215 row_mirror row_mask:0xf bank_mask:0xc
    v_add_f32_dpp v208, v216, v216 row_mirror row_mask:0xf bank_mask:0xc
    v_add_f32_dpp v209, v217, v217 row_mirror row_mask:0xf bank_mask:0xc
    v_add_f32_dpp v210, v218, v218 row_mirror row_mask:0xf bank_mask:0xc
    v_add_f32_dpp v211, v219, v219 row_mirror row_mask:0xf bank_mask:0xc
    v_add_f32_dpp v204, v204, v204 row_half_mirror row_mask:0xf bank_mask:0x5
    v_add_f32_dpp v205, v205, v205 row_half_mirror row_mask:0xf bank_mask:0x5
    v_add_f32_dpp v206, v206, v206 row_half_mirror row_mask:0xf bank_mask:0x5
    v_add_f32_dpp v207, v207, v207 row_half_mirror row_mask:0xf bank_mask:0x5
    v_add_f32_dpp v204, v208, v208 row_half_mirror row_mask:0xf bank_mask:0xa
    v_add_f32_dpp v205, v209, v209 row_half_mirror row_mask:0xf bank_mask:0xa
    v_add_f32_dpp v206, v210, v210 row_half_mirror row_mask:0xf bank_mask:0xa
    v_add_f32_dpp v207, v211, v211 row_half_mirror row_mask:0xf bank_mask:0xa
    v_add_f32_dpp v204, v204, v204 quad_perm:[1,0,3,2] row_mask:0xf bank_mask:0xf
    v_add_f32_dpp v205, v205, v205 quad_perm:[1,0,3,2] row_mask:0xf bank_mask:0xf
    v_add_f32_dpp v206, v206, v206 quad_perm:[1,0,3,2] row_mask:0xf bank_mask:0xf
    v_add_f32_dpp v207, v207, v207 quad_perm:[1,0,3,2] row_mask:0xf bank_mask:0xf
    v_add_f32_dpp v12, v204, v204 quad_perm:[2,3,0,1] row_mask:0xf bank_mask:0xf
    v_add_f32_dpp v14, v205, v205 quad_perm:[2,3,0,1] row_mask:0xf bank_mask:0xf
    v_add_f32_dpp v13, v206, v206 quad_perm:[2,3,0,1] row_mask:0xf bank_mask:0xf
    v_add_f32_dpp v15, v207, v207 quad_perm:[2,3,0,1] row_mask:0xf bank_mask:0xf
    buffer_store_dwordx4 v[12:15], v8, s[4:7], s36 offen sc1
    s_waitcnt lgkmcnt(5)
    v_mfma_f32_16x16x32_bf16 v[88:91], v[168:171], v[160:163], 0
    ds_read_b128 v[204:207], v3 offset:37888
    v_mfma_f32_16x16x32_bf16 v[92:95], v[168:171], v[164:167], 0
    ds_read_b128 v[208:211], v3 offset:39936
    v_mfma_f32_16x16x32_bf16 v[96:99], v[172:175], v[160:163], 0
    ds_read_b128 v[212:215], v1 offset:46080
    v_mfma_f32_16x16x32_bf16 v[100:103], v[172:175], v[164:167], 0
    ds_read_b128 v[216:219], v1 offset:47104
    v_mfma_f32_16x16x32_bf16 v[104:107], v[176:179], v[160:163], 0
    ds_read_b128 v[220:223], v1 offset:48128
    v_mfma_f32_16x16x32_bf16 v[108:111], v[176:179], v[164:167], 0
    ds_read_b128 v[224:227], v1 offset:49152
    v_mfma_f32_16x16x32_bf16 v[112:115], v[180:183], v[160:163], 0
    ds_read_b128 v[228:231], v1 offset:50176
    v_mfma_f32_16x16x32_bf16 v[116:119], v[180:183], v[164:167], 0
    ds_read_b128 v[232:235], v1 offset:51200
    s_waitcnt lgkmcnt(8)
    v_mfma_f32_16x16x32_bf16 v[120:123], v[184:187], v[160:163], 0
    ds_read_b128 v[236:239], v1 offset:52224
    v_mfma_f32_16x16x32_bf16 v[124:127], v[184:187], v[164:167], 0
    ds_read_b128 v[240:243], v1 offset:53248
    v_mfma_f32_16x16x32_bf16 v[128:131], v[188:191], v[160:163], 0
    ds_read_b128 v[244:247], v1 offset:54272
    v_mfma_f32_16x16x32_bf16 v[132:135], v[188:191], v[164:167], 0
    v_mfma_f32_16x16x32_bf16 v[136:139], v[192:195], v[160:163], 0
    v_mfma_f32_16x16x32_bf16 v[140:143], v[192:195], v[164:167], 0
    v_mfma_f32_16x16x32_bf16 v[144:147], v[196:199], v[160:163], 0
    v_mfma_f32_16x16x32_bf16 v[148:151], v[196:199], v[164:167], 0
    v_mfma_f32_16x16x32_bf16 v[152:155], v[200:203], v[160:163], 0
    v_mfma_f32_16x16x32_bf16 v[156:159], v[200:203], v[164:167], 0
    s_waitcnt lgkmcnt(0)
    s_barrier
    v_mfma_f32_16x16x32_bf16 v[88:91], v[212:215], v[204:207], v[88:91]
    ds_read_b128 v[160:163], v0 offset:0
    v_mfma_f32_16x16x32_bf16 v[92:95], v[212:215], v[208:211], v[92:95]
    ds_read_b128 v[164:167], v0 offset:2048
    v_mfma_f32_16x16x32_bf16 v[96:99], v[216:219], v[204:207], v[96:99]
    ds_read_b128 v[168:171], v2 offset:0
    v_mfma_f32_16x16x32_bf16 v[100:103], v[216:219], v[208:211], v[100:103]
    ds_read_b128 v[172:175], v2 offset:1024
    v_mfma_f32_16x16x32_bf16 v[104:107], v[220:223], v[204:207], v[104:107]
    ds_read_b128 v[176:179], v2 offset:2048
    v_mfma_f32_16x16x32_bf16 v[108:111], v[220:223], v[208:211], v[108:111]
    ds_read_b128 v[180:183], v2 offset:3072
    v_mfma_f32_16x16x32_bf16 v[112:115], v[224:227], v[204:207], v[112:115]
    ds_read_b128 v[184:187], v2 offset:4096
    v_mfma_f32_16x16x32_bf16 v[116:119], v[224:227], v[208:211], v[116:119]
    ds_read_b128 v[188:191], v2 offset:5120
    v_mfma_f32_16x16x32_bf16 v[120:123], v[228:231], v[204:207], v[120:123]
    ds_read_b128 v[192:195], v2 offset:6144
    v_mfma_f32_16x16x32_bf16 v[124:127], v[228:231], v[208:211], v[124:127]
    ds_read_b128 v[196:199], v2 offset:7168
    v_mfma_f32_16x16x32_bf16 v[128:131], v[232:235], v[204:207], v[128:131]
    ds_read_b128 v[200:203], v2 offset:8192
    v_mfma_f32_16x16x32_bf16 v[132:135], v[232:235], v[208:211], v[132:135]
    v_mfma_f32_16x16x32_bf16 v[136:139], v[236:239], v[204:207], v[136:139]
    v_mfma_f32_16x16x32_bf16 v[140:143], v[236:239], v[208:211], v[140:143]
    v_mfma_f32_16x16x32_bf16 v[144:147], v[240:243], v[204:207], v[144:147]
    v_mfma_f32_16x16x32_bf16 v[148:151], v[240:243], v[208:211], v[148:151]
    v_mfma_f32_16x16x32_bf16 v[152:155], v[244:247], v[204:207], v[152:155]
    v_mfma_f32_16x16x32_bf16 v[156:159], v[244:247], v[208:211], v[156:159]
    s_waitcnt lgkmcnt(5)
    v_mfma_f32_16x16x32_bf16 v[88:91], v[168:171], v[160:163], v[88:91]
    ds_read_b128 v[204:207], v0 offset:1024
    v_mfma_f32_16x16x32_bf16 v[92:95], v[168:171], v[164:167], v[92:95]
    ds_read_b128 v[208:211], v0 offset:3072
    v_mfma_f32_16x16x32_bf16 v[96:99], v[172:175], v[160:163], v[96:99]
    ds_read_b128 v[212:215], v2 offset:9216
    v_mfma_f32_16x16x32_bf16 v[100:103], v[172:175], v[164:167], v[100:103]
    ds_read_b128 v[216:219], v2 offset:10240
    v_mfma_f32_16x16x32_bf16 v[104:107], v[176:179], v[160:163], v[104:107]
    ds_read_b128 v[220:223], v2 offset:11264
    v_mfma_f32_16x16x32_bf16 v[108:111], v[176:179], v[164:167], v[108:111]
    ds_read_b128 v[224:227], v2 offset:12288
    v_mfma_f32_16x16x32_bf16 v[112:115], v[180:183], v[160:163], v[112:115]
    ds_read_b128 v[228:231], v2 offset:13312
    v_mfma_f32_16x16x32_bf16 v[116:119], v[180:183], v[164:167], v[116:119]
    ds_read_b128 v[232:235], v2 offset:14336
    s_waitcnt lgkmcnt(8)
    v_mfma_f32_16x16x32_bf16 v[120:123], v[184:187], v[160:163], v[120:123]
    ds_read_b128 v[236:239], v2 offset:15360
    v_mfma_f32_16x16x32_bf16 v[124:127], v[184:187], v[164:167], v[124:127]
    ds_read_b128 v[240:243], v2 offset:16384
    v_mfma_f32_16x16x32_bf16 v[128:131], v[188:191], v[160:163], v[128:131]
    ds_read_b128 v[244:247], v2 offset:17408
    v_mfma_f32_16x16x32_bf16 v[132:135], v[188:191], v[164:167], v[132:135]
    v_mfma_f32_16x16x32_bf16 v[136:139], v[192:195], v[160:163], v[136:139]
    v_mfma_f32_16x16x32_bf16 v[140:143], v[192:195], v[164:167], v[140:143]
    v_mfma_f32_16x16x32_bf16 v[144:147], v[196:199], v[160:163], v[144:147]
    v_mfma_f32_16x16x32_bf16 v[148:151], v[196:199], v[164:167], v[148:151]
    v_mfma_f32_16x16x32_bf16 v[152:155], v[200:203], v[160:163], v[152:155]
    v_mfma_f32_16x16x32_bf16 v[156:159], v[200:203], v[164:167], v[156:159]
    s_waitcnt lgkmcnt(0)
    s_barrier
    v_mfma_f32_16x16x32_bf16 v[88:91], v[212:215], v[204:207], v[88:91]
    ds_read_b128 v[160:163], v0 offset:36864
    v_mfma_f32_16x16x32_bf16 v[92:95], v[212:215], v[208:211], v[92:95]
    ds_read_b128 v[164:167], v0 offset:38912
    v_mfma_f32_16x16x32_bf16 v[96:99], v[216:219], v[204:207], v[96:99]
    ds_read_b128 v[168:171], v2 offset:36864
    v_mfma_f32_16x16x32_bf16 v[100:103], v[216:219], v[208:211], v[100:103]
    ds_read_b128 v[172:175], v2 offset:37888
    v_mfma_f32_16x16x32_bf16 v[104:107], v[220:223], v[204:207], v[104:107]
    ds_read_b128 v[176:179], v2 offset:38912
    v_mfma_f32_16x16x32_bf16 v[108:111], v[220:223], v[208:211], v[108:111]
    ds_read_b128 v[180:183], v2 offset:39936
    v_mfma_f32_16x16x32_bf16 v[112:115], v[224:227], v[204:207], v[112:115]
    ds_read_b128 v[184:187], v2 offset:40960
    v_mfma_f32_16x16x32_bf16 v[116:119], v[224:227], v[208:211], v[116:119]
    ds_read_b128 v[188:191], v2 offset:41984
    v_mfma_f32_16x16x32_bf16 v[120:123], v[228:231], v[204:207], v[120:123]
    ds_read_b128 v[192:195], v2 offset:43008
    v_mfma_f32_16x16x32_bf16 v[124:127], v[228:231], v[208:211], v[124:127]
    ds_read_b128 v[196:199], v2 offset:44032
    v_mfma_f32_16x16x32_bf16 v[128:131], v[232:235], v[204:207], v[128:131]
    ds_read_b128 v[200:203], v2 offset:45056
    v_mfma_f32_16x16x32_bf16 v[132:135], v[232:235], v[208:211], v[132:135]
    v_mfma_f32_16x16x32_bf16 v[136:139], v[236:239], v[204:207], v[136:139]
    v_mfma_f32_16x16x32_bf16 v[140:143], v[236:239], v[208:211], v[140:143]
    v_mfma_f32_16x16x32_bf16 v[144:147], v[240:243], v[204:207], v[144:147]
    v_mfma_f32_16x16x32_bf16 v[148:151], v[240:243], v[208:211], v[148:151]
    v_mfma_f32_16x16x32_bf16 v[152:155], v[244:247], v[204:207], v[152:155]
    v_mfma_f32_16x16x32_bf16 v[156:159], v[244:247], v[208:211], v[156:159]
    s_waitcnt lgkmcnt(5)
    v_mfma_f32_16x16x32_bf16 v[88:91], v[168:171], v[160:163], v[88:91]
    ds_read_b128 v[204:207], v0 offset:37888
    v_mfma_f32_16x16x32_bf16 v[92:95], v[168:171], v[164:167], v[92:95]
    ds_read_b128 v[208:211], v0 offset:39936
    v_mfma_f32_16x16x32_bf16 v[96:99], v[172:175], v[160:163], v[96:99]
    ds_read_b128 v[212:215], v2 offset:46080
    v_mfma_f32_16x16x32_bf16 v[100:103], v[172:175], v[164:167], v[100:103]
    ds_read_b128 v[216:219], v2 offset:47104
    v_mfma_f32_16x16x32_bf16 v[104:107], v[176:179], v[160:163], v[104:107]
    ds_read_b128 v[220:223], v2 offset:48128
    v_mfma_f32_16x16x32_bf16 v[108:111], v[176:179], v[164:167], v[108:111]
    ds_read_b128 v[224:227], v2 offset:49152
    v_mfma_f32_16x16x32_bf16 v[112:115], v[180:183], v[160:163], v[112:115]
    ds_read_b128 v[228:231], v2 offset:50176
    v_mfma_f32_16x16x32_bf16 v[116:119], v[180:183], v[164:167], v[116:119]
    ds_read_b128 v[232:235], v2 offset:51200
    s_waitcnt lgkmcnt(8)
    v_mfma_f32_16x16x32_bf16 v[120:123], v[184:187], v[160:163], v[120:123]
    ds_read_b128 v[236:239], v2 offset:52224
    v_mfma_f32_16x16x32_bf16 v[124:127], v[184:187], v[164:167], v[124:127]
    ds_read_b128 v[240:243], v2 offset:53248
    v_mfma_f32_16x16x32_bf16 v[128:131], v[188:191], v[160:163], v[128:131]
    ds_read_b128 v[244:247], v2 offset:54272
    v_mfma_f32_16x16x32_bf16 v[132:135], v[188:191], v[164:167], v[132:135]
    v_mfma_f32_16x16x32_bf16 v[136:139], v[192:195], v[160:163], v[136:139]
    v_mfma_f32_16x16x32_bf16 v[140:143], v[192:195], v[164:167], v[140:143]
    v_mfma_f32_16x16x32_bf16 v[144:147], v[196:199], v[160:163], v[144:147]
    v_mfma_f32_16x16x32_bf16 v[148:151], v[196:199], v[164:167], v[148:151]
    v_mfma_f32_16x16x32_bf16 v[152:155], v[200:203], v[160:163], v[152:155]
    v_mfma_f32_16x16x32_bf16 v[156:159], v[200:203], v[164:167], v[156:159]
    s_waitcnt lgkmcnt(0)
    s_barrier
    v_mfma_f32_16x16x32_bf16 v[88:91], v[212:215], v[204:207], v[88:91]
    ds_read_b128 v[160:163], v3 offset:0
    v_mfma_f32_16x16x32_bf16 v[92:95], v[212:215], v[208:211], v[92:95]
    ds_read_b128 v[164:167], v3 offset:2048
    v_mfma_f32_16x16x32_bf16 v[96:99], v[216:219], v[204:207], v[96:99]
    ds_read_b128 v[168:171], v1 offset:0
    v_mfma_f32_16x16x32_bf16 v[100:103], v[216:219], v[208:211], v[100:103]
    ds_read_b128 v[172:175], v1 offset:1024
    v_mfma_f32_16x16x32_bf16 v[104:107], v[220:223], v[204:207], v[104:107]
    ds_read_b128 v[176:179], v1 offset:2048
    v_mfma_f32_16x16x32_bf16 v[108:111], v[220:223], v[208:211], v[108:111]
    ds_read_b128 v[180:183], v1 offset:3072
    v_mfma_f32_16x16x32_bf16 v[112:115], v[224:227], v[204:207], v[112:115]
    ds_read_b128 v[184:187], v1 offset:4096
    v_mfma_f32_16x16x32_bf16 v[116:119], v[224:227], v[208:211], v[116:119]
    ds_read_b128 v[188:191], v1 offset:5120
    v_mfma_f32_16x16x32_bf16 v[120:123], v[228:231], v[204:207], v[120:123]
    ds_read_b128 v[192:195], v1 offset:6144
    v_mfma_f32_16x16x32_bf16 v[124:127], v[228:231], v[208:211], v[124:127]
    ds_read_b128 v[196:199], v1 offset:7168
    v_mfma_f32_16x16x32_bf16 v[128:131], v[232:235], v[204:207], v[128:131]
    ds_read_b128 v[200:203], v1 offset:8192
    v_mfma_f32_16x16x32_bf16 v[132:135], v[232:235], v[208:211], v[132:135]
    buffer_load_dwordx4 v[4:7], v255, s[4:7], s35 offen offset:0 sc1
    v_mfma_f32_16x16x32_bf16 v[136:139], v[236:239], v[204:207], v[136:139]
    v_mfma_f32_16x16x32_bf16 v[140:143], v[236:239], v[208:211], v[140:143]
    buffer_load_dwordx4 v[8:11], v255, s[4:7], s35 offen offset:1024 sc1
    v_mfma_f32_16x16x32_bf16 v[144:147], v[240:243], v[204:207], v[144:147]
    v_mfma_f32_16x16x32_bf16 v[148:151], v[240:243], v[208:211], v[148:151]
    buffer_load_dwordx4 v[12:15], v255, s[4:7], s35 offen offset:2048 sc1
    v_mfma_f32_16x16x32_bf16 v[152:155], v[244:247], v[204:207], v[152:155]
    v_mfma_f32_16x16x32_bf16 v[156:159], v[244:247], v[208:211], v[156:159]
    buffer_load_dwordx4 v[252:255], v255, s[4:7], s35 offen offset:3072 sc1
    s_waitcnt lgkmcnt(5)
    v_mfma_f32_16x16x32_bf16 v[88:91], v[168:171], v[160:163], v[88:91]
    ds_read_b128 v[204:207], v3 offset:1024
    v_mfma_f32_16x16x32_bf16 v[92:95], v[168:171], v[164:167], v[92:95]
    ds_read_b128 v[208:211], v3 offset:3072
    v_mfma_f32_16x16x32_bf16 v[96:99], v[172:175], v[160:163], v[96:99]
    ds_read_b128 v[212:215], v1 offset:9216
    v_mfma_f32_16x16x32_bf16 v[100:103], v[172:175], v[164:167], v[100:103]
    ds_read_b128 v[216:219], v1 offset:10240
    v_mfma_f32_16x16x32_bf16 v[104:107], v[176:179], v[160:163], v[104:107]
    ds_read_b128 v[220:223], v1 offset:11264
    v_mfma_f32_16x16x32_bf16 v[108:111], v[176:179], v[164:167], v[108:111]
    ds_read_b128 v[224:227], v1 offset:12288
    v_mfma_f32_16x16x32_bf16 v[112:115], v[180:183], v[160:163], v[112:115]
    ds_read_b128 v[228:231], v1 offset:13312
    v_mfma_f32_16x16x32_bf16 v[116:119], v[180:183], v[164:167], v[116:119]
    ds_read_b128 v[232:235], v1 offset:14336
    s_waitcnt lgkmcnt(8)
    v_mfma_f32_16x16x32_bf16 v[120:123], v[184:187], v[160:163], v[120:123]
    ds_read_b128 v[236:239], v1 offset:15360
    v_mfma_f32_16x16x32_bf16 v[124:127], v[184:187], v[164:167], v[124:127]
    ds_read_b128 v[240:243], v1 offset:16384
    v_mfma_f32_16x16x32_bf16 v[128:131], v[188:191], v[160:163], v[128:131]
    ds_read_b128 v[244:247], v1 offset:17408
    v_mfma_f32_16x16x32_bf16 v[132:135], v[188:191], v[164:167], v[132:135]
    v_mfma_f32_16x16x32_bf16 v[136:139], v[192:195], v[160:163], v[136:139]
    v_mfma_f32_16x16x32_bf16 v[140:143], v[192:195], v[164:167], v[140:143]
    v_mfma_f32_16x16x32_bf16 v[144:147], v[196:199], v[160:163], v[144:147]
    v_mfma_f32_16x16x32_bf16 v[148:151], v[196:199], v[164:167], v[148:151]
    v_mfma_f32_16x16x32_bf16 v[152:155], v[200:203], v[160:163], v[152:155]
    v_mfma_f32_16x16x32_bf16 v[156:159], v[200:203], v[164:167], v[156:159]
    s_waitcnt lgkmcnt(0)
    s_barrier
    v_mfma_f32_16x16x32_bf16 v[88:91], v[212:215], v[204:207], v[88:91]
    ds_read_b128 v[160:163], v3 offset:36864
    v_mfma_f32_16x16x32_bf16 v[92:95], v[212:215], v[208:211], v[92:95]
    ds_read_b128 v[164:167], v3 offset:38912
    v_mfma_f32_16x16x32_bf16 v[96:99], v[216:219], v[204:207], v[96:99]
    ds_read_b128 v[168:171], v1 offset:36864
    v_mfma_f32_16x16x32_bf16 v[100:103], v[216:219], v[208:211], v[100:103]
    ds_read_b128 v[172:175], v1 offset:37888
    v_mfma_f32_16x16x32_bf16 v[104:107], v[220:223], v[204:207], v[104:107]
    ds_read_b128 v[176:179], v1 offset:38912
    v_mfma_f32_16x16x32_bf16 v[108:111], v[220:223], v[208:211], v[108:111]
    ds_read_b128 v[180:183], v1 offset:39936
    v_mfma_f32_16x16x32_bf16 v[112:115], v[224:227], v[204:207], v[112:115]
    ds_read_b128 v[184:187], v1 offset:40960
    v_mfma_f32_16x16x32_bf16 v[116:119], v[224:227], v[208:211], v[116:119]
    ds_read_b128 v[188:191], v1 offset:41984
    v_mfma_f32_16x16x32_bf16 v[120:123], v[228:231], v[204:207], v[120:123]
    ds_read_b128 v[192:195], v1 offset:43008
    v_mfma_f32_16x16x32_bf16 v[124:127], v[228:231], v[208:211], v[124:127]
    ds_read_b128 v[196:199], v1 offset:44032
    v_mfma_f32_16x16x32_bf16 v[128:131], v[232:235], v[204:207], v[128:131]
    ds_read_b128 v[200:203], v1 offset:45056
    v_mfma_f32_16x16x32_bf16 v[132:135], v[232:235], v[208:211], v[132:135]
    v_mfma_f32_16x16x32_bf16 v[136:139], v[236:239], v[204:207], v[136:139]
    v_mfma_f32_16x16x32_bf16 v[140:143], v[236:239], v[208:211], v[140:143]
    v_mfma_f32_16x16x32_bf16 v[144:147], v[240:243], v[204:207], v[144:147]
    v_mfma_f32_16x16x32_bf16 v[148:151], v[240:243], v[208:211], v[148:151]
    v_mfma_f32_16x16x32_bf16 v[152:155], v[244:247], v[204:207], v[152:155]
    v_mfma_f32_16x16x32_bf16 v[156:159], v[244:247], v[208:211], v[156:159]
    s_waitcnt lgkmcnt(5)
    v_mfma_f32_16x16x32_bf16 v[88:91], v[168:171], v[160:163], v[88:91]
    ds_read_b128 v[204:207], v3 offset:37888
    v_mfma_f32_16x16x32_bf16 v[92:95], v[168:171], v[164:167], v[92:95]
    ds_read_b128 v[208:211], v3 offset:39936
    s_waitcnt vmcnt(0)
    v_mfma_f32_16x16x32_bf16 v[96:99], v[172:175], v[160:163], v[96:99]
    ds_read_b128 v[212:215], v1 offset:46080
    v_or3_b32 v249, v5, v7, v9
    v_mfma_f32_16x16x32_bf16 v[100:103], v[172:175], v[164:167], v[100:103]
    ds_read_b128 v[216:219], v1 offset:47104
    v_or3_b32 v251, v11, v13, v15
    v_mfma_f32_16x16x32_bf16 v[104:107], v[176:179], v[160:163], v[104:107]
    ds_read_b128 v[220:223], v1 offset:48128
    v_or3_b32 v249, v253, v255, v249
    v_mfma_f32_16x16x32_bf16 v[108:111], v[176:179], v[164:167], v[108:111]
    ds_read_b128 v[224:227], v1 offset:49152
    v_or_b32 v249, v249, v251
    v_mfma_f32_16x16x32_bf16 v[112:115], v[180:183], v[160:163], v[112:115]
    ds_read_b128 v[228:231], v1 offset:50176
    v_cmp_gt_i32 vcc, 0, v249
    v_mfma_f32_16x16x32_bf16 v[116:119], v[180:183], v[164:167], v[116:119]
    ds_read_b128 v[232:235], v1 offset:51200
    s_waitcnt lgkmcnt(8)
    v_mfma_f32_16x16x32_bf16 v[120:123], v[184:187], v[160:163], v[120:123]
    ds_read_b128 v[236:239], v1 offset:52224
    s_nop 0
    v_mfma_f32_16x16x32_bf16 v[124:127], v[184:187], v[164:167], v[124:127]
    ds_read_b128 v[240:243], v1 offset:53248
    s_cbranch_vccnz L_g_slow
L_g_back:
    v_mfma_f32_16x16x32_bf16 v[128:131], v[188:191], v[160:163], v[128:131]
    ds_read_b128 v[244:247], v1 offset:54272
    v_add_f32 v4, v4, v8
    v_mfma_f32_16x16x32_bf16 v[132:135], v[188:191], v[164:167], v[132:135]
    v_add_f32 v252, v252, v12
    v_add_f32 v5, v5, v9
    v_mfma_f32_16x16x32_bf16 v[136:139], v[192:195], v[160:163], v[136:139]
    v_add_f32 v253, v253, v13
    v_add_f32 v6, v6, v10
    v_mfma_f32_16x16x32_bf16 v[140:143], v[192:195], v[164:167], v[140:143]
    v_add_f32 v254, v254, v14
    v_add_f32 v7, v7, v11
    v_mfma_f32_16x16x32_bf16 v[144:147], v[196:199], v[160:163], v[144:147]
    v_add_f32 v255, v255, v15
    v_add_f32 v252, v252, v4
    v_mfma_f32_16x16x32_bf16 v[148:151], v[196:199], v[164:167], v[148:151]
    v_add_f32 v253, v253, v5
    v_add_f32 v254, v254, v6
    v_mfma_f32_16x16x32_bf16 v[152:155], v[200:203], v[160:163], v[152:155]
    v_add_f32 v255, v255, v7
    v_add_f32_dpp v252, v252, v252 quad_perm:[1,0,3,2] row_mask:0xf bank_mask:0xf
    v_mfma_f32_16x16x32_bf16 v[156:159], v[200:203], v[164:167], v[156:159]
    v_add_f32_dpp v253, v253, v253 quad_perm:[1,0,3,2] row_mask:0xf bank_mask:0xf
    s_waitcnt lgkmcnt(0)
    s_barrier
    v_mfma_f32_16x16x32_bf16 v[88:91], v[212:215], v[204:207], v[88:91]
    ds_read_b128 v[160:163], v0 offset:0
    v_mfma_f32_16x16x32_bf16 v[92:95], v[212:215], v[208:211], v[92:95]
    ds_read_b128 v[164:167], v0 offset:2048
    v_add_f32_dpp v254, v254, v254 quad_perm:[1,0,3,2] row_mask:0xf bank_mask:0xf
    v_mfma_f32_16x16x32_bf16 v[96:99], v[216:219], v[204:207], v[96:99]
    ds_read_b128 v[168:171], v2 offset:0
    v_add_f32_dpp v255, v255, v255 quad_perm:[1,0,3,2] row_mask:0xf bank_mask:0xf
    v_mfma_f32_16x16x32_bf16 v[100:103], v[216:219], v[208:211], v[100:103]
    ds_read_b128 v[172:175], v2 offset:1024
    v_add_f32_dpp v252, v252, v252 quad_perm:[2,3,0,1] row_mask:0xf bank_mask:0xf
    v_mfma_f32_16x16x32_bf16 v[104:107], v[220:223], v[204:207], v[104:107]
    ds_read_b128 v[176:179], v2 offset:2048
    v_add_f32_dpp v253, v253, v253 quad_perm:[2,3,0,1] row_mask:0xf bank_mask:0xf
    v_mfma_f32_16x16x32_bf16 v[108:111], v[220:223], v[208:211], v[108:111]
    ds_read_b128 v[180:183], v2 offset:3072
    v_add_f32_dpp v254, v254, v254 quad_perm:[2,3,0,1] row_mask:0xf bank_mask:0xf
    v_mfma_f32_16x16x32_bf16 v[112:115], v[224:227], v[204:207], v[112:115]
    ds_read_b128 v[184:187], v2 offset:4096
    v_add_f32_dpp v255, v255, v255 quad_perm:[2,3,0,1] row_mask:0xf bank_mask:0xf
    v_mfma_f32_16x16x32_bf16 v[116:119], v[224:227], v[208:211], v[116:119]
    ds_read_b128 v[188:191], v2 offset:5120
    v_mfma_f32_16x16x32_bf16 v[120:123], v[228:231], v[204:207], v[120:123]
    ds_read_b128 v[192:195], v2 offset:6144
    v_mul_f32 v252, s44, v252
    v_mfma_f32_16x16x32_bf16 v[124:127], v[228:231], v[208:211], v[124:127]
    ds_read_b128 v[196:199], v2 offset:7168
    v_mul_f32 v253, s44, v253
    v_mfma_f32_16x16x32_bf16 v[128:131], v[232:235], v[204:207], v[128:131]
    ds_read_b128 v[200:203], v2 offset:8192
    v_mul_f32 v254, s44, v254
    v_mfma_f32_16x16x32_bf16 v[132:135], v[232:235], v[208:211], v[132:135]
    v_mul_f32 v255, s44, v255
    v_fma_f32 v253, -v252, v252, v253
    v_mfma_f32_16x16x32_bf16 v[136:139], v[236:239], v[204:207], v[136:139]
    v_fma_f32 v255, -v254, v254, v255
    v_max_f32 v253, 0, v253
    v_mfma_f32_16x16x32_bf16 v[140:143], v[236:239], v[208:211], v[140:143]
    v_max_f32 v255, 0, v255
    v_add_f32 v253, s45, v253
    v_mfma_f32_16x16x32_bf16 v[144:147], v[240:243], v[204:207], v[144:147]
    v_add_f32 v255, s45, v255
    v_rsq_f32 v253, v253
    v_mfma_f32_16x16x32_bf16 v[148:151], v[240:243], v[208:211], v[148:151]
    v_rsq_f32 v255, v255
    s_nop 0
    v_mfma_f32_16x16x32_bf16 v[152:155], v[244:247], v[204:207], v[152:155]
    v_mul_f32 v252, v252, v253
    v_mul_f32 v254, v254, v255
    v_mfma_f32_16x16x32_bf16 v[156:159], v[244:247], v[208:211], v[156:159]
    s_nop 0
    s_waitcnt lgkmcnt(5)
    v_mfma_f32_16x16x32_bf16 v[88:91], v[168:171], v[160:163], v[88:91]
    ds_read_b128 v[204:207], v0 offset:1024
    v_mfma_f32_16x16x32_bf16 v[92:95], v[168:171], v[164:167], v[92:95]
    ds_read_b128 v[208:211], v0 offset:3072
    v_mov_b32_dpp v5, v253 row_newbcast:0 row_mask:0xf bank_mask:0xf
    v_mfma_f32_16x16x32_bf16 v[96:99], v[172:175], v[160:163], v[96:99]
    ds_read_b128 v[212:215], v2 offset:9216
    v_mov_b32_dpp v7, v255 row_newbcast:0 row_mask:0xf bank_mask:0xf
    v_mfma_f32_16x16x32_bf16 v[100:103], v[172:175], v[164:167], v[100:103]
    ds_read_b128 v[216:219], v2 offset:10240
    v_mov_b32_dpp v4, v252 row_newbcast:0 row_mask:0xf bank_mask:0xf
    v_mfma_f32_16x16x32_bf16 v[104:107], v[176:179], v[160:163], v[104:107]
    ds_read_b128 v[220:223], v2 offset:11264
    v_mov_b32_dpp v6, v254 row_newbcast:0 row_mask:0xf bank_mask:0xf
    v_mfma_f32_16x16x32_bf16 v[108:111], v[176:179], v[164:167], v[108:111]
    ds_read_b128 v[224:227], v2 offset:12288
    v_mov_b32_dpp v9, v253 row_newbcast:4 row_mask:0xf bank_mask:0xf
    v_mfma_f32_16x16x32_bf16 v[112:115], v[180:183], v[160:163], v[112:115]
    ds_read_b128 v[228:231], v2 offset:13312
    v_mov_b32_dpp v11, v255 row_newbcast:4 row_mask:0xf bank_mask:0xf
    v_mfma_f32_16x16x32_bf16 v[116:119], v[180:183], v[164:167], v[116:119]
    ds_read_b128 v[232:235], v2 offset:14336
    s_waitcnt lgkmcnt(8)
    v_mfma_f32_16x16x32_bf16 v[120:123], v[184:187], v[160:163], v[120:123]
    ds_read_b128 v[236:239], v2 offset:15360
    v_mov_b32_dpp v8, v252 row_newbcast:4 row_mask:0xf bank_mask:0xf
    v_mfma_f32_16x16x32_bf16 v[124:127], v[184:187], v[164:167], v[124:127]
    ds_read_b128 v[240:243], v2 offset:16384
    v_mov_b32_dpp v10, v254 row_newbcast:4 row_mask:0xf bank_mask:0xf
    v_mfma_f32_16x16x32_bf16 v[128:131], v[188:191], v[160:163], v[128:131]
    ds_read_b128 v[244:247], v2 offset:17408
    v_mov_b32_dpp v13, v253 row_newbcast:8 row_mask:0xf bank_mask:0xf
    v_mfma_f32_16x16x32_bf16 v[132:135], v[188:191], v[164:167], v[132:135]
    v_mov_b32_dpp v15, v255 row_newbcast:8 row_mask:0xf bank_mask:0xf
    v_mov_b32_dpp v12, v252 row_newbcast:8 row_mask:0xf bank_mask:0xf
    v_mfma_f32_16x16x32_bf16 v[136:139], v[192:195], v[160:163], v[136:139]
    v_mov_b32_dpp v14, v254 row_newbcast:8 row_mask:0xf bank_mask:0xf
    v_mov_b32_dpp v253, v253 row_newbcast:12 row_mask:0xf bank_mask:0xf
    v_mfma_f32_16x16x32_bf16 v[140:143], v[192:195], v[164:167], v[140:143]
    v_mov_b32_dpp v255, v255 row_newbcast:12 row_mask:0xf bank_mask:0xf
    v_mov_b32_dpp v252, v252 row_newbcast:12 row_mask:0xf bank_mask:0xf
    v_mfma_f32_16x16x32_bf16 v[144:147], v[196:199], v[160:163], v[144:147]
    v_mov_b32_dpp v254, v254 row_newbcast:12 row_mask:0xf bank_mask:0xf
    v_fma_f32 v16, v16, v5, -v4
    v_mfma_f32_16x16x32_bf16 v[148:151], v[196:199], v[164:167], v[148:151]
    v_fma_f32 v17, v17, v7, -v6
    v_fma_f32 v18, v18, v9, -v8
    v_mfma_f32_16x16x32_bf16 v[152:155], v[200:203], v[160:163], v[152:155]
    v_fma_f32 v19, v19, v11, -v10
    v_fma_f32 v20, v20, v13, -v12
    v_mfma_f32_16x16x32_bf16 v[156:159], v[200:203], v[164:167], v[156:159]
    v_fma_f32 v21, v21, v15, -v14
    s_waitcnt lgkmcnt(0)
    s_barrier
    v_mfma_f32_16x16x32_bf16 v[88:91], v[212:215], v[204:207], v[88:91]
    ds_read_b128 v[160:163], v0 offset:36864
    v_mfma_f32_16x16x32_bf16 v[92:95], v[212:215], v[208:211], v[92:95]
    ds_read_b128 v[164:167], v0 offset:38912
    v_fma_f32 v22, v22, v253, -v252
    v_mfma_f32_16x16x32_bf16 v[96:99], v[216:219], v[204:207], v[96:99]
    ds_read_b128 v[168:171], v2 offset:36864
    v_fma_f32 v23, v23, v255, -v254
    v_mfma_f32_16x16x32_bf16 v[100:103], v[216:219], v[208:211], v[100:103]
    ds_read_b128 v[172:175], v2 offset:37888
    v_cvt_pk_bf16_f32 v16, v16, v17
    v_mfma_f32_16x16x32_bf16 v[104:107], v[220:223], v[204:207], v[104:107]
    ds_read_b128 v[176:179], v2 offset:38912
    v_cvt_pk_bf16_f32 v17, v18, v19
    v_mfma_f32_16x16x32_bf16 v[108:111], v[220:223], v[208:211], v[108:111]
    ds_read_b128 v[180:183], v2 offset:39936
    v_cvt_pk_bf16_f32 v18, v20, v21
    v_mfma_f32_16x16x32_bf16 v[112:115], v[224:227], v[204:207], v[112:115]
    ds_read_b128 v[184:187], v2 offset:40960
    v_cvt_pk_bf16_f32 v19, v22, v23
    v_mfma_f32_16x16x32_bf16 v[116:119], v[224:227], v[208:211], v[116:119]
    ds_read_b128 v[188:191], v2 offset:41984
    v_mfma_f32_16x16x32_bf16 v[120:123], v[228:231], v[204:207], v[120:123]
    ds_read_b128 v[192:195], v2 offset:43008
    v_fma_f32 v24, v24, v5, -v4
    v_mfma_f32_16x16x32_bf16 v[124:127], v[228:231], v[208:211], v[124:127]
    ds_read_b128 v[196:199], v2 offset:44032
    v_fma_f32 v25, v25, v7, -v6
    v_mfma_f32_16x16x32_bf16 v[128:131], v[232:235], v[204:207], v[128:131]
    ds_read_b128 v[200:203], v2 offset:45056
    v_fma_f32 v26, v26, v9, -v8
    v_mfma_f32_16x16x32_bf16 v[132:135], v[232:235], v[208:211], v[132:135]
    v_fma_f32 v27, v27, v11, -v10
    v_fma_f32 v28, v28, v13, -v12
    v_mfma_f32_16x16x32_bf16 v[136:139], v[236:239], v[204:207], v[136:139]
    v_fma_f32 v29, v29, v15, -v14
    v_fma_f32 v30, v30, v253, -v252
    v_mfma_f32_16x16x32_bf16 v[140:143], v[236:239], v[208:211], v[140:143]
    v_fma_f32 v31, v31, v255, -v254
    v_permlane32_swap_b32 v16, v18
    v_mfma_f32_16x16x32_bf16 v[144:147], v[240:243], v[204:207], v[144:147]
    v_permlane32_swap_b32 v17, v19
    v_cvt_pk_bf16_f32 v24, v24, v25
    v_mfma_f32_16x16x32_bf16 v[148:151], v[240:243], v[208:211], v[148:151]
    v_cvt_pk_bf16_f32 v25, v26, v27
    v_cvt_pk_bf16_f32 v26, v28, v29
    v_mfma_f32_16x16x32_bf16 v[152:155], v[244:247], v[204:207], v[152:155]
    v_cvt_pk_bf16_f32 v27, v30, v31
    v_permlane16_swap_b32 v16, v18
    v_mfma_f32_16x16x32_bf16 v[156:159], v[244:247], v[208:211], v[156:159]
    v_permlane16_swap_b32 v17, v19
    s_waitcnt lgkmcnt(5)
    v_mfma_f32_16x16x32_bf16 v[88:91], v[168:171], v[160:163], v[88:91]
    ds_read_b128 v[204:207], v0 offset:37888
    v_mfma_f32_16x16x32_bf16 v[92:95], v[168:171], v[164:167], v[92:95]
    ds_read_b128 v[208:211], v0 offset:39936
    buffer_store_dwordx4 v[16:19], v1, s[4:7], s38 offen offset:0 sc1
    v_mfma_f32_16x16x32_bf16 v[96:99], v[172:175], v[160:163], v[96:99]
    ds_read_b128 v[212:215], v2 offset:46080
    v_fma_f32 v32, v32, v5, -v4
    v_mfma_f32_16x16x32_bf16 v[100:103], v[172:175], v[164:167], v[100:103]
    ds_read_b128 v[216:219], v2 offset:47104
    v_fma_f32 v33, v33, v7, -v6
    v_mfma_f32_16x16x32_bf16 v[104:107], v[176:179], v[160:163], v[104:107]
    ds_read_b128 v[220:223], v2 offset:48128
    v_fma_f32 v34, v34, v9, -v8
    v_mfma_f32_16x16x32_bf16 v[108:111], v[176:179], v[164:167], v[108:111]
    ds_read_b128 v[224:227], v2 offset:49152
    v_fma_f32 v35, v35, v11, -v10
    v_mfma_f32_16x16x32_bf16 v[112:115], v[180:183], v[160:163], v[112:115]
    ds_read_b128 v[228:231], v2 offset:50176
    v_fma_f32 v36, v36, v13, -v12
    v_mfma_f32_16x16x32_bf16 v[116:119], v[180:183], v[164:167], v[116:119]
    ds_read_b128 v[232:235], v2 offset:51200
    s_waitcnt lgkmcnt(8)
    v_mfma_f32_16x16x32_bf16 v[120:123], v[184:187], v[160:163], v[120:123]
    ds_read_b128 v[236:239], v2 offset:52224
    v_fma_f32 v37, v37, v15, -v14
    v_mfma_f32_16x16x32_bf16 v[124:127], v[184:187], v[164:167], v[124:127]
    ds_read_b128 v[240:243], v2 offset:53248
    v_fma_f32 v38, v38, v253, -v252
    v_mfma_f32_16x16x32_bf16 v[128:131], v[188:191], v[160:163], v[128:131]
    ds_read_b128 v[244:247], v2 offset:54272
    v_fma_f32 v39, v39, v255, -v254
    v_mfma_f32_16x16x32_bf16 v[132:135], v[188:191], v[164:167], v[132:135]
    v_permlane32_swap_b32 v24, v26
    v_permlane32_swap_b32 v25, v27
    v_mfma_f32_16x16x32_bf16 v[136:139], v[192:195], v[160:163], v[136:139]
    v_cvt_pk_bf16_f32 v32, v32, v33
    v_cvt_pk_bf16_f32 v33, v34, v35
    v_mfma_f32_16x16x32_bf16 v[140:143], v[192:195], v[164:167], v[140:143]
    v_cvt_pk_bf16_f32 v34, v36, v37
    v_cvt_pk_bf16_f32 v35, v38, v39
    v_mfma_f32_16x16x32_bf16 v[144:147], v[196:199], v[160:163], v[144:147]
    v_permlane16_swap_b32 v24, v26
    v_permlane16_swap_b32 v25, v27
    v_mfma_f32_16x16x32_bf16 v[148:151], v[196:199], v[164:167], v[148:151]
    buffer_store_dwordx4 v[24:27], v1, s[4:7], s38 offen offset:1024 sc1
    v_fma_f32 v40, v40, v5, -v4
    v_mfma_f32_16x16x32_bf16 v[152:155], v[200:203], v[160:163], v[152:155]
    v_fma_f32 v41, v41, v7, -v6
    v_fma_f32 v42, v42, v9, -v8
    v_mfma_f32_16x16x32_bf16 v[156:159], v[200:203], v[164:167], v[156:159]
    v_fma_f32 v43, v43, v11, -v10
    s_waitcnt lgkmcnt(0)
    s_barrier
    v_mfma_f32_16x16x32_bf16 v[88:91], v[212:215], v[204:207], v[88:91]
    ds_read_b128 v[160:163], v3 offset:0
    v_mfma_f32_16x16x32_bf16 v[92:95], v[212:215], v[208:211], v[92:95]
    ds_read_b128 v[164:167], v3 offset:2048
    v_fma_f32 v44, v44, v13, -v12
    v_mfma_f32_16x16x32_bf16 v[96:99], v[216:219], v[204:207], v[96:99]
    ds_read_b128 v[168:171], v1 offset:0
    v_fma_f32 v45, v45, v15, -v14
    v_mfma_f32_16x16x32_bf16 v[100:103], v[216:219], v[208:211], v[100:103]
    ds_read_b128 v[172:175], v1 offset:1024
    v_fma_f32 v46, v46, v253, -v252
    v_mfma_f32_16x16x32_bf16 v[104:107], v[220:223], v[204:207], v[104:107]
    ds_read_b128 v[176:179], v1 offset:2048
    v_fma_f32 v47, v47, v255, -v254
    v_mfma_f32_16x16x32_bf16 v[108:111], v[220:223], v[208:211], v[108:111]
    ds_read_b128 v[180:183], v1 offset:3072
    v_permlane32_swap_b32 v32, v34
    v_mfma_f32_16x16x32_bf16 v[112:115], v[224:227], v[204:207], v[112:115]
    ds_read_b128 v[184:187], v1 offset:4096
    v_permlane32_swap_b32 v33, v35
    v_mfma_f32_16x16x32_bf16 v[116:119], v[224:227], v[208:211], v[116:119]
    ds_read_b128 v[188:191], v1 offset:5120
    v_mfma_f32_16x16x32_bf16 v[120:123], v[228:231], v[204:207], v[120:123]
    ds_read_b128 v[192:195], v1 offset:6144
    v_cvt_pk_bf16_f32 v40, v40, v41
    v_mfma_f32_16x16x32_bf16 v[124:127], v[228:231], v[208:211], v[124:127]
    ds_read_b128 v[196:199], v1 offset:7168
    v_cvt_pk_bf16_f32 v41, v42, v43
    v_mfma_f32_16x16x32_bf16 v[128:131], v[232:235], v[204:207], v[128:131]
    ds_read_b128 v[200:203], v1 offset:8192
    v_cvt_pk_bf16_f32 v42, v44, v45
    v_mfma_f32_16x16x32_bf16 v[132:135], v[232:235], v[208:211], v[132:135]
    v_cvt_pk_bf16_f32 v43, v46, v47
    v_permlane16_swap_b32 v32, v34
    v_mfma_f32_16x16x32_bf16 v[136:139], v[236:239], v[204:207], v[136:139]
    v_permlane16_swap_b32 v33, v35
    buffer_store_dwordx4 v[32:35], v1, s[4:7], s38 offen offset:2048 sc1
    v_mfma_f32_16x16x32_bf16 v[140:143], v[236:239], v[208:211], v[140:143]
    v_fma_f32 v48, v48, v5, -v4
    v_fma_f32 v49, v49, v7, -v6
    v_mfma_f32_16x16x32_bf16 v[144:147], v[240:243], v[204:207], v[144:147]
    v_fma_f32 v50, v50, v9, -v8
    v_fma_f32 v51, v51, v11, -v10
    v_mfma_f32_16x16x32_bf16 v[148:151], v[240:243], v[208:211], v[148:151]
    v_fma_f32 v52, v52, v13, -v12
    v_fma_f32 v53, v53, v15, -v14
    v_mfma_f32_16x16x32_bf16 v[152:155], v[244:247], v[204:207], v[152:155]
    v_fma_f32 v54, v54, v253, -v252
    v_fma_f32 v55, v55, v255, -v254
    v_mfma_f32_16x16x32_bf16 v[156:159], v[244:247], v[208:211], v[156:159]
    v_permlane32_swap_b32 v40, v42
    s_waitcnt lgkmcnt(5)
    v_mfma_f32_16x16x32_bf16 v[88:91], v[168:171], v[160:163], v[88:91]
    ds_read_b128 v[204:207], v3 offset:1024
    v_mfma_f32_16x16x32_bf16 v[92:95], v[168:171], v[164:167], v[92:95]
    ds_read_b128 v[208:211], v3 offset:3072
    v_permlane32_swap_b32 v41, v43
    v_mfma_f32_16x16x32_bf16 v[96:99], v[172:175], v[160:163], v[96:99]
    ds_read_b128 v[212:215], v1 offset:9216
    v_cvt_pk_bf16_f32 v48, v48, v49
    v_mfma_f32_16x16x32_bf16 v[100:103], v[172:175], v[164:167], v[100:103]
    ds_read_b128 v[216:219], v1 offset:10240
    v_cvt_pk_bf16_f32 v49, v50, v51
    v_mfma_f32_16x16x32_bf16 v[104:107], v[176:179], v[160:163], v[104:107]
    ds_read_b128 v[220:223], v1 offset:11264
    v_cvt_pk_bf16_f32 v50, v52, v53
    v_mfma_f32_16x16x32_bf16 v[108:111], v[176:179], v[164:167], v[108:111]
    ds_read_b128 v[224:227], v1 offset:12288
    v_cvt_pk_bf16_f32 v51, v54, v55
    v_mfma_f32_16x16x32_bf16 v[112:115], v[180:183], v[160:163], v[112:115]
    ds_read_b128 v[228:231], v1 offset:13312
    v_permlane16_swap_b32 v40, v42
    v_mfma_f32_16x16x32_bf16 v[116:119], v[180:183], v[164:167], v[116:119]
    ds_read_b128 v[232:235], v1 offset:14336
    s_waitcnt lgkmcnt(8)
    v_mfma_f32_16x16x32_bf16 v[120:123], v[184:187], v[160:163], v[120:123]
    ds_read_b128 v[236:239], v1 offset:15360
    v_permlane16_swap_b32 v41, v43
    v_mfma_f32_16x16x32_bf16 v[124:127], v[184:187], v[164:167], v[124:127]
    ds_read_b128 v[240:243], v1 offset:16384
    buffer_store_dwordx4 v[40:43], v1, s[4:7], s38 offen offset:3072 sc1
    v_mfma_f32_16x16x32_bf16 v[128:131], v[188:191], v[160:163], v[128:131]
    ds_read_b128 v[244:247], v1 offset:17408
    v_fma_f32 v56, v56, v5, -v4
    v_mfma_f32_16x16x32_bf16 v[132:135], v[188:191], v[164:167], v[132:135]
    v_fma_f32 v57, v57, v7, -v6
    v_fma_f32 v58, v58, v9, -v8
    v_mfma_f32_16x16x32_bf16 v[136:139], v[192:195], v[160:163], v[136:139]
    v_fma_f32 v59, v59, v11, -v10
    v_fma_f32 v60, v60, v13, -v12
    v_mfma_f32_16x16x32_bf16 v[140:143], v[192:195], v[164:167], v[140:143]
    v_fma_f32 v61, v61, v15, -v14
    v_fma_f32 v62, v62, v253, -v252
    v_mfma_f32_16x16x32_bf16 v[144:147], v[196:199], v[160:163], v[144:147]
    v_fma_f32 v63, v63, v255, -v254
    v_permlane32_swap_b32 v48, v50
    v_mfma_f32_16x16x32_bf16 v[148:151], v[196:199], v[164:167], v[148:151]
    v_permlane32_swap_b32 v49, v51
    v_cvt_pk_bf16_f32 v56, v56, v57
    v_mfma_f32_16x16x32_bf16 v[152:155], v[200:203], v[160:163], v[152:155]
    v_cvt_pk_bf16_f32 v57, v58, v59
    v_cvt_pk_bf16_f32 v58, v60, v61
    v_mfma_f32_16x16x32_bf16 v[156:159], v[200:203], v[164:167], v[156:159]
    v_cvt_pk_bf16_f32 v59, v62, v63
    s_waitcnt lgkmcnt(0)
    s_barrier
    v_mfma_f32_16x16x32_bf16 v[88:91], v[212:215], v[204:207], v[88:91]
    ds_read_b128 v[160:163], v3 offset:36864
    v_mfma_f32_16x16x32_bf16 v[92:95], v[212:215], v[208:211], v[92:95]
    ds_read_b128 v[164:167], v3 offset:38912
    v_permlane16_swap_b32 v48, v50
    v_mfma_f32_16x16x32_bf16 v[96:99], v[216:219], v[204:207], v[96:99]
    ds_read_b128 v[168:171], v1 offset:36864
    v_permlane16_swap_b32 v49, v51
    v_mfma_f32_16x16x32_bf16 v[100:103], v[216:219], v[208:211], v[100:103]
    ds_read_b128 v[172:175], v1 offset:37888
    buffer_store_dwordx4 v[48:51], v1, s[4:7], s39 offen offset:0 sc1
    v_mfma_f32_16x16x32_bf16 v[104:107], v[220:223], v[204:207], v[104:107]
    ds_read_b128 v[176:179], v1 offset:38912
    v_fma_f32 v64, v64, v5, -v4
    v_mfma_f32_16x16x32_bf16 v[108:111], v[220:223], v[208:211], v[108:111]
    ds_read_b128 v[180:183], v1 offset:39936
    v_fma_f32 v65, v65, v7, -v6
    v_mfma_f32_16x16x32_bf16 v[112:115], v[224:227], v[204:207], v[112:115]
    ds_read_b128 v[184:187], v1 offset:40960
    v_fma_f32 v66, v66, v9, -v8
    v_mfma_f32_16x16x32_bf16 v[116:119], v[224:227], v[208:211], v[116:119]
    ds_read_b128 v[188:191], v1 offset:41984
    v_mfma_f32_16x16x32_bf16 v[120:123], v[228:231], v[204:207], v[120:123]
    ds_read_b128 v[192:195], v1 offset:43008
    v_fma_f32 v67, v67, v11, -v10
    v_mfma_f32_16x16x32_bf16 v[124:127], v[228:231], v[208:211], v[124:127]
    ds_read_b128 v[196:199], v1 offset:44032
    v_fma_f32 v68, v68, v13, -v12
    v_mfma_f32_16x16x32_bf16 v[128:131], v[232:235], v[204:207], v[128:131]
    ds_read_b128 v[200:203], v1 offset:45056
    v_fma_f32 v69, v69, v15, -v14
    v_mfma_f32_16x16x32_bf16 v[132:135], v[232:235], v[208:211], v[132:135]
    v_fma_f32 v70, v70, v253, -v252
    v_fma_f32 v71, v71, v255, -v254
    v_mfma_f32_16x16x32_bf16 v[136:139], v[236:239], v[204:207], v[136:139]
    v_permlane32_swap_b32 v56, v58
    v_permlane32_swap_b32 v57, v59
    v_mfma_f32_16x16x32_bf16 v[140:143], v[236:239], v[208:211], v[140:143]
    v_cvt_pk_bf16_f32 v64, v64, v65
    v_cvt_pk_bf16_f32 v65, v66, v67
    v_mfma_f32_16x16x32_bf16 v[144:147], v[240:243], v[204:207], v[144:147]
    v_cvt_pk_bf16_f32 v66, v68, v69
    v_cvt_pk_bf16_f32 v67, v70, v71
    v_mfma_f32_16x16x32_bf16 v[148:151], v[240:243], v[208:211], v[148:151]
    v_permlane16_swap_b32 v56, v58
    v_permlane16_swap_b32 v57, v59
    v_mfma_f32_16x16x32_bf16 v[152:155], v[244:247], v[204:207], v[152:155]
    buffer_store_dwordx4 v[56:59], v1, s[4:7], s39 offen offset:1024 sc1
    v_fma_f32 v72, v72, v5, -v4
    v_mfma_f32_16x16x32_bf16 v[156:159], v[244:247], v[208:211], v[156:159]
    v_fma_f32 v73, v73, v7, -v6
    s_waitcnt lgkmcnt(5)
    v_mfma_f32_16x16x32_bf16 v[88:91], v[168:171], v[160:163], v[88:91]
    ds_read_b128 v[204:207], v3 offset:37888
    v_mfma_f32_16x16x32_bf16 v[92:95], v[168:171], v[164:167], v[92:95]
    ds_read_b128 v[208:211], v3 offset:39936
    v_fma_f32 v74, v74, v9, -v8
    v_mfma_f32_16x16x32_bf16 v[96:99], v[172:175], v[160:163], v[96:99]
    ds_read_b128 v[212:215], v1 offset:46080
    v_fma_f32 v75, v75, v11, -v10
    v_mfma_f32_16x16x32_bf16 v[100:103], v[172:175], v[164:167], v[100:103]
    ds_read_b128 v[216:219], v1 offset:47104
    v_fma_f32 v76, v76, v13, -v12
    v_mfma_f32_16x16x32_bf16 v[104:107], v[176:179], v[160:163], v[104:107]
    ds_read_b128 v[220:223], v1 offset:48128
    v_fma_f32 v77, v77, v15, -v14
    v_mfma_f32_16x16x32_bf16 v[108:111], v[176:179], v[164:167], v[108:111]
    ds_read_b128 v[224:227], v1 offset:49152
    v_fma_f32 v78, v78, v253, -v252
    v_mfma_f32_16x16x32_bf16 v[112:115], v[180:183], v[160:163], v[112:115]
    ds_read_b128 v[228:231], v1 offset:50176
    v_fma_f32 v79, v79, v255, -v254
    v_mfma_f32_16x16x32_bf16 v[116:119], v[180:183], v[164:167], v[116:119]
    ds_read_b128 v[232:235], v1 offset:51200
    s_waitcnt lgkmcnt(8)
    v_mfma_f32_16x16x32_bf16 v[120:123], v[184:187], v[160:163], v[120:123]
    ds_read_b128 v[236:239], v1 offset:52224
    v_permlane32_swap_b32 v64, v66
    v_mfma_f32_16x16x32_bf16 v[124:127], v[184:187], v[164:167], v[124:127]
    ds_read_b128 v[240:243], v1 offset:53248
    v_permlane32_swap_b32 v65, v67
    v_mfma_f32_16x16x32_bf16 v[128:131], v[188:191], v[160:163], v[128:131]
    ds_read_b128 v[244:247], v1 offset:54272
    v_cvt_pk_bf16_f32 v72, v72, v73
    v_mfma_f32_16x16x32_bf16 v[132:135], v[188:191], v[164:167], v[132:135]
    v_cvt_pk_bf16_f32 v73, v74, v75
    v_cvt_pk_bf16_f32 v74, v76, v77
    v_mfma_f32_16x16x32_bf16 v[136:139], v[192:195], v[160:163], v[136:139]
    v_cvt_pk_bf16_f32 v75, v78, v79
    v_permlane16_swap_b32 v64, v66
    v_lshrrev_b32 v0, 4, v1
    v_mfma_f32_16x16x32_bf16 v[140:143], v[192:195], v[164:167], v[140:143]
    v_permlane16_swap_b32 v65, v67
    buffer_store_dwordx4 v[64:67], v1, s[4:7], s39 offen offset:2048 sc1
    v_and_b32 v0, 48, v0
    v_mfma_f32_16x16x32_bf16 v[144:147], v[196:199], v[160:163], v[144:147]
    v_fma_f32 v80, v80, v5, -v4
    v_fma_f32 v81, v81, v7, -v6
    v_add_u32 v0, 160320, v0
    v_mfma_f32_16x16x32_bf16 v[148:151], v[196:199], v[164:167], v[148:151]
    v_fma_f32 v82, v82, v9, -v8
    v_fma_f32 v83, v83, v11, -v10
    v_mfma_f32_16x16x32_bf16 v[152:155], v[200:203], v[160:163], v[152:155]
    v_fma_f32 v84, v84, v13, -v12
    v_fma_f32 v85, v85, v15, -v14
    v_mfma_f32_16x16x32_bf16 v[156:159], v[200:203], v[164:167], v[156:159]
    v_fma_f32 v86, v86, v253, -v252
    s_waitcnt lgkmcnt(0)
    v_mfma_f32_16x16x32_bf16 v[88:91], v[212:215], v[204:207], v[88:91]
    ds_read_b128 v[168:171], v0 offset:0
    v_mfma_f32_16x16x32_bf16 v[92:95], v[212:215], v[208:211], v[92:95]
    ds_read_b128 v[172:175], v0 offset:64
    v_fma_f32 v87, v87, v255, -v254
    v_mfma_f32_16x16x32_bf16 v[96:99], v[216:219], v[204:207], v[96:99]
    ds_read_b128 v[176:179], v0 offset:128
    v_permlane32_swap_b32 v72, v74
    v_mfma_f32_16x16x32_bf16 v[100:103], v[216:219], v[208:211], v[100:103]
    ds_read_b128 v[180:183], v0 offset:192
    v_permlane32_swap_b32 v73, v75
    v_mfma_f32_16x16x32_bf16 v[104:107], v[220:223], v[204:207], v[104:107]
    ds_read_b128 v[184:187], v0 offset:256
    v_cvt_pk_bf16_f32 v80, v80, v81
    v_mfma_f32_16x16x32_bf16 v[108:111], v[220:223], v[208:211], v[108:111]
    ds_read_b128 v[188:191], v0 offset:320
    v_cvt_pk_bf16_f32 v81, v82, v83
    v_mfma_f32_16x16x32_bf16 v[112:115], v[224:227], v[204:207], v[112:115]
    ds_read_b128 v[192:195], v0 offset:384
    v_cvt_pk_bf16_f32 v82, v84, v85
    v_mfma_f32_16x16x32_bf16 v[116:119], v[224:227], v[208:211], v[116:119]
    ds_read_b128 v[196:199], v0 offset:448
    v_mfma_f32_16x16x32_bf16 v[120:123], v[228:231], v[204:207], v[120:123]
    ds_read_b128 v[200:203], v0 offset:512
    v_cvt_pk_bf16_f32 v83, v86, v87
    v_mfma_f32_16x16x32_bf16 v[124:127], v[228:231], v[208:211], v[124:127]
    v_permlane16_swap_b32 v72, v74
    v_mfma_f32_16x16x32_bf16 v[128:131], v[232:235], v[204:207], v[128:131]
    v_permlane16_swap_b32 v73, v75
    v_mfma_f32_16x16x32_bf16 v[132:135], v[232:235], v[208:211], v[132:135]
    buffer_store_dwordx4 v[72:75], v1, s[4:7], s39 offen offset:3072 sc1
    s_nop 1
    v_mfma_f32_16x16x32_bf16 v[136:139], v[236:239], v[204:207], v[136:139]
    v_permlane32_swap_b32 v80, v82
    v_permlane32_swap_b32 v81, v83
    v_mfma_f32_16x16x32_bf16 v[140:143], v[236:239], v[208:211], v[140:143]
    s_nop 1
    v_permlane16_swap_b32 v80, v82
    v_mfma_f32_16x16x32_bf16 v[144:147], v[240:243], v[204:207], v[144:147]
    v_permlane16_swap_b32 v81, v83
    buffer_store_dwordx4 v[80:83], v1, s[4:7], s46 offen offset:0 sc1
    v_mfma_f32_16x16x32_bf16 v[148:151], v[240:243], v[208:211], v[148:151]
    v_mfma_f32_16x16x32_bf16 v[152:155], v[244:247], v[204:207], v[152:155]
    v_mfma_f32_16x16x32_bf16 v[156:159], v[244:247], v[208:211], v[156:159]
    v_bfe_u32 v8, v1, 4, 4
    v_lshl_add_u32 v8, v8, 2, s33
    ds_read2_b32 v[4:5], v8 offset0:32 offset1:48
    ds_read_b128 v[212:215], v0 offset:1152
    ds_read_b128 v[216:219], v0 offset:1216
    ds_read_b128 v[220:223], v0 offset:1280
    ds_read_b128 v[224:227], v0 offset:1344
    ds_read_b128 v[228:231], v0 offset:1408
    ds_read_b128 v[232:235], v0 offset:1472
    ds_read_b128 v[236:239], v0 offset:1536
    ds_read_b128 v[240:243], v0 offset:1600
    ds_read_b128 v[244:247], v0 offset:1664
    v_bfe_u32 v8, v1, 4, 4
    s_lshl_b32 s33, s31, 5
    v_lshl_add_u32 v8, v8, 1, s33
    buffer_load_ushort v252, v8, s[12:15], 0 offen
    buffer_load_ushort v254, v8, s[12:15], 0 offen offset:32
    s_waitcnt lgkmcnt(9)
    v_rcp_f32 v249, v4
    v_rcp_f32 v251, v5
    v_mul_f32 v6, s40, v5
    v_mul_f32 v7, v5, v5
    v_mul_f32 v5, v4, v4
    v_mul_f32 v4, s40, v4
    v_mul_f32 v5, s42, v5
    v_mul_f32 v7, s42, v7
    v_mul_f32 v5, v5, v4
    v_mul_f32 v7, v7, v6
    s_waitcnt lgkmcnt(8)
    v_pk_add_f32 v[168:169], v[168:169], v[212:213]
    v_pk_add_f32 v[170:171], v[170:171], v[214:215]
    v_pk_fma_f32 v[88:89], v[248:249], v[168:169], v[88:89] op_sel_hi:[0,1,1] neg_lo:[1,0,0] neg_hi:[1,0,0]
    v_pk_fma_f32 v[90:91], v[248:249], v[170:171], v[90:91] op_sel_hi:[0,1,1] neg_lo:[1,0,0] neg_hi:[1,0,0]
    v_pk_fma_f32 v[92:93], v[250:251], v[168:169], v[92:93] op_sel_hi:[0,1,1] neg_lo:[1,0,0] neg_hi:[1,0,0]
    v_pk_fma_f32 v[94:95], v[250:251], v[170:171], v[94:95] op_sel_hi:[0,1,1] neg_lo:[1,0,0] neg_hi:[1,0,0]
    v_pk_mul_f32 v[160:161], v[88:89], v[88:89]
    v_pk_mul_f32 v[162:163], v[90:91], v[90:91]
    v_pk_mul_f32 v[164:165], v[92:93], v[92:93]
    v_pk_mul_f32 v[166:167], v[94:95], v[94:95]
    v_pk_fma_f32 v[160:161], v[160:161], v[4:5], v[4:5] op_sel:[0,1,0] op_sel_hi:[1,1,0]
    v_pk_fma_f32 v[162:163], v[162:163], v[4:5], v[4:5] op_sel:[0,1,0] op_sel_hi:[1,1,0]
    v_pk_fma_f32 v[164:165], v[164:165], v[6:7], v[6:7] op_sel:[0,1,0] op_sel_hi:[1,1,0]
    v_pk_fma_f32 v[166:167], v[166:167], v[6:7], v[6:7] op_sel:[0,1,0] op_sel_hi:[1,1,0]
    v_pk_mul_f32 v[160:161], v[160:161], v[88:89]
    v_pk_mul_f32 v[162:163], v[162:163], v[90:91]
    v_pk_mul_f32 v[164:165], v[164:165], v[92:93]
    v_pk_mul_f32 v[166:167], v[166:167], v[94:95]
    v_exp_f32 v160, v160
    v_exp_f32 v161, v161
    v_exp_f32 v162, v162
    v_exp_f32 v163, v163
    v_exp_f32 v164, v164
    v_exp_f32 v165, v165
    v_exp_f32 v166, v166
    v_exp_f32 v167, v167
    v_pk_fma_f32 v[160:161], v[160:161], v[248:249], v[248:249] op_sel:[0,1,1] op_sel_hi:[1,1,1]
    v_pk_fma_f32 v[162:163], v[162:163], v[248:249], v[248:249] op_sel:[0,1,1] op_sel_hi:[1,1,1]
    v_pk_fma_f32 v[164:165], v[164:165], v[250:251], v[250:251] op_sel:[0,1,1] op_sel_hi:[1,1,1]
    v_pk_fma_f32 v[166:167], v[166:167], v[250:251], v[250:251] op_sel:[0,1,1] op_sel_hi:[1,1,1]
    v_rcp_f32 v160, v160
    v_rcp_f32 v161, v161
    v_rcp_f32 v162, v162
    v_rcp_f32 v163, v163
    v_rcp_f32 v164, v164
    v_rcp_f32 v165, v165
    v_rcp_f32 v166, v166
    v_rcp_f32 v167, v167
    v_pk_mul_f32 v[88:89], v[88:89], v[160:161]
    v_pk_mul_f32 v[90:91], v[90:91], v[162:163]
    v_pk_mul_f32 v[92:93], v[92:93], v[164:165]
    v_pk_mul_f32 v[94:95], v[94:95], v[166:167]
    s_waitcnt lgkmcnt(7)
    v_pk_add_f32 v[172:173], v[172:173], v[216:217]
    v_pk_add_f32 v[174:175], v[174:175], v[218:219]
    v_pk_fma_f32 v[96:97], v[248:249], v[172:173], v[96:97] op_sel_hi:[0,1,1] neg_lo:[1,0,0] neg_hi:[1,0,0]
    v_pk_fma_f32 v[98:99], v[248:249], v[174:175], v[98:99] op_sel_hi:[0,1,1] neg_lo:[1,0,0] neg_hi:[1,0,0]
    v_pk_fma_f32 v[100:101], v[250:251], v[172:173], v[100:101] op_sel_hi:[0,1,1] neg_lo:[1,0,0] neg_hi:[1,0,0]
    v_pk_fma_f32 v[102:103], v[250:251], v[174:175], v[102:103] op_sel_hi:[0,1,1] neg_lo:[1,0,0] neg_hi:[1,0,0]
    v_pk_mul_f32 v[204:205], v[96:97], v[96:97]
    v_pk_mul_f32 v[206:207], v[98:99], v[98:99]
    v_pk_mul_f32 v[208:209], v[100:101], v[100:101]
    v_pk_mul_f32 v[210:211], v[102:103], v[102:103]
    v_pk_fma_f32 v[204:205], v[204:205], v[4:5], v[4:5] op_sel:[0,1,0] op_sel_hi:[1,1,0]
    v_pk_fma_f32 v[206:207], v[206:207], v[4:5], v[4:5] op_sel:[0,1,0] op_sel_hi:[1,1,0]
    v_pk_fma_f32 v[208:209], v[208:209], v[6:7], v[6:7] op_sel:[0,1,0] op_sel_hi:[1,1,0]
    v_pk_fma_f32 v[210:211], v[210:211], v[6:7], v[6:7] op_sel:[0,1,0] op_sel_hi:[1,1,0]
    v_pk_mul_f32 v[204:205], v[204:205], v[96:97]
    v_pk_mul_f32 v[206:207], v[206:207], v[98:99]
    v_pk_mul_f32 v[208:209], v[208:209], v[100:101]
    v_pk_mul_f32 v[210:211], v[210:211], v[102:103]
    v_exp_f32 v204, v204
    v_exp_f32 v205, v205
    v_exp_f32 v206, v206
    v_exp_f32 v207, v207
    v_exp_f32 v208, v208
    v_exp_f32 v209, v209
    v_exp_f32 v210, v210
    v_exp_f32 v211, v211
    v_pk_fma_f32 v[204:205], v[204:205], v[248:249], v[248:249] op_sel:[0,1,1] op_sel_hi:[1,1,1]
    v_pk_fma_f32 v[206:207], v[206:207], v[248:249], v[248:249] op_sel:[0,1,1] op_sel_hi:[1,1,1]
    v_pk_fma_f32 v[208:209], v[208:209], v[250:251], v[250:251] op_sel:[0,1,1] op_sel_hi:[1,1,1]
    v_pk_fma_f32 v[210:211], v[210:211], v[250:251], v[250:251] op_sel:[0,1,1] op_sel_hi:[1,1,1]
    v_rcp_f32 v204, v204
    v_rcp_f32 v205, v205
    v_rcp_f32 v206, v206
    v_rcp_f32 v207, v207
    v_rcp_f32 v208, v208
    v_rcp_f32 v209, v209
    v_rcp_f32 v210, v210
    v_rcp_f32 v211, v211
    v_pk_mul_f32 v[96:97], v[96:97], v[204:205]
    v_pk_mul_f32 v[98:99], v[98:99], v[206:207]
    v_pk_mul_f32 v[100:101], v[100:101], v[208:209]
    v_pk_mul_f32 v[102:103], v[102:103], v[210:211]
    s_waitcnt vmcnt(2)
    s_barrier
    s_waitcnt lgkmcnt(6)
    v_pk_add_f32 v[176:177], v[176:177], v[220:221]
    v_pk_add_f32 v[178:179], v[178:179], v[222:223]
    v_pk_fma_f32 v[104:105], v[248:249], v[176:177], v[104:105] op_sel_hi:[0,1,1] neg_lo:[1,0,0] neg_hi:[1,0,0]
    v_pk_fma_f32 v[106:107], v[248:249], v[178:179], v[106:107] op_sel_hi:[0,1,1] neg_lo:[1,0,0] neg_hi:[1,0,0]
    v_pk_fma_f32 v[108:109], v[250:251], v[176:177], v[108:109] op_sel_hi:[0,1,1] neg_lo:[1,0,0] neg_hi:[1,0,0]
    v_pk_fma_f32 v[110:111], v[250:251], v[178:179], v[110:111] op_sel_hi:[0,1,1] neg_lo:[1,0,0] neg_hi:[1,0,0]
    v_pk_mul_f32 v[160:161], v[104:105], v[104:105]
    v_pk_mul_f32 v[162:163], v[106:107], v[106:107]
    v_pk_mul_f32 v[164:165], v[108:109], v[108:109]
    v_pk_mul_f32 v[166:167], v[110:111], v[110:111]
    v_pk_fma_f32 v[160:161], v[160:161], v[4:5], v[4:5] op_sel:[0,1,0] op_sel_hi:[1,1,0]
    v_pk_fma_f32 v[162:163], v[162:163], v[4:5], v[4:5] op_sel:[0,1,0] op_sel_hi:[1,1,0]
    v_pk_fma_f32 v[164:165], v[164:165], v[6:7], v[6:7] op_sel:[0,1,0] op_sel_hi:[1,1,0]
    v_pk_fma_f32 v[166:167], v[166:167], v[6:7], v[6:7] op_sel:[0,1,0] op_sel_hi:[1,1,0]
    v_pk_mul_f32 v[160:161], v[160:161], v[104:105]
    v_pk_mul_f32 v[162:163], v[162:163], v[106:107]
    v_pk_mul_f32 v[164:165], v[164:165], v[108:109]
    v_pk_mul_f32 v[166:167], v[166:167], v[110:111]
    v_exp_f32 v160, v160
    v_exp_f32 v161, v161
    v_exp_f32 v162, v162
    v_exp_f32 v163, v163
    v_exp_f32 v164, v164
    v_exp_f32 v165, v165
    v_exp_f32 v166, v166
    v_exp_f32 v167, v167
    v_pk_fma_f32 v[160:161], v[160:161], v[248:249], v[248:249] op_sel:[0,1,1] op_sel_hi:[1,1,1]
    v_pk_fma_f32 v[162:163], v[162:163], v[248:249], v[248:249] op_sel:[0,1,1] op_sel_hi:[1,1,1]
    v_pk_fma_f32 v[164:165], v[164:165], v[250:251], v[250:251] op_sel:[0,1,1] op_sel_hi:[1,1,1]
    v_pk_fma_f32 v[166:167], v[166:167], v[250:251], v[250:251] op_sel:[0,1,1] op_sel_hi:[1,1,1]
    v_rcp_f32 v160, v160
    v_rcp_f32 v161, v161
    v_rcp_f32 v162, v162
    v_rcp_f32 v163, v163
    v_rcp_f32 v164, v164
    v_rcp_f32 v165, v165
    v_rcp_f32 v166, v166
    v_rcp_f32 v167, v167
    v_pk_mul_f32 v[104:105], v[104:105], v[160:161]
    v_pk_mul_f32 v[106:107], v[106:107], v[162:163]
    v_pk_mul_f32 v[108:109], v[108:109], v[164:165]
    v_pk_mul_f32 v[110:111], v[110:111], v[166:167]
    s_waitcnt lgkmcnt(5)
    v_pk_add_f32 v[180:181], v[180:181], v[224:225]
    v_pk_add_f32 v[182:183], v[182:183], v[226:227]
    v_pk_fma_f32 v[112:113], v[248:249], v[180:181], v[112:113] op_sel_hi:[0,1,1] neg_lo:[1,0,0] neg_hi:[1,0,0]
    v_pk_fma_f32 v[114:115], v[248:249], v[182:183], v[114:115] op_sel_hi:[0,1,1] neg_lo:[1,0,0] neg_hi:[1,0,0]
    v_pk_fma_f32 v[116:117], v[250:251], v[180:181], v[116:117] op_sel_hi:[0,1,1] neg_lo:[1,0,0] neg_hi:[1,0,0]
    v_pk_fma_f32 v[118:119], v[250:251], v[182:183], v[118:119] op_sel_hi:[0,1,1] neg_lo:[1,0,0] neg_hi:[1,0,0]
    v_pk_mul_f32 v[204:205], v[112:113], v[112:113]
    v_pk_mul_f32 v[206:207], v[114:115], v[114:115]
    v_pk_mul_f32 v[208:209], v[116:117], v[116:117]
    v_pk_mul_f32 v[210:211], v[118:119], v[118:119]
    v_pk_fma_f32 v[204:205], v[204:205], v[4:5], v[4:5] op_sel:[0,1,0] op_sel_hi:[1,1,0]
    v_pk_fma_f32 v[206:207], v[206:207], v[4:5], v[4:5] op_sel:[0,1,0] op_sel_hi:[1,1,0]
    v_pk_fma_f32 v[208:209], v[208:209], v[6:7], v[6:7] op_sel:[0,1,0] op_sel_hi:[1,1,0]
    v_pk_fma_f32 v[210:211], v[210:211], v[6:7], v[6:7] op_sel:[0,1,0] op_sel_hi:[1,1,0]
    v_pk_mul_f32 v[204:205], v[204:205], v[112:113]
    v_pk_mul_f32 v[206:207], v[206:207], v[114:115]
    v_pk_mul_f32 v[208:209], v[208:209], v[116:117]
    v_pk_mul_f32 v[210:211], v[210:211], v[118:119]
    v_exp_f32 v204, v204
    v_exp_f32 v205, v205
    v_exp_f32 v206, v206
    v_exp_f32 v207, v207
    v_exp_f32 v208, v208
    v_exp_f32 v209, v209
    v_exp_f32 v210, v210
    v_exp_f32 v211, v211
    v_pk_fma_f32 v[204:205], v[204:205], v[248:249], v[248:249] op_sel:[0,1,1] op_sel_hi:[1,1,1]
    v_pk_fma_f32 v[206:207], v[206:207], v[248:249], v[248:249] op_sel:[0,1,1] op_sel_hi:[1,1,1]
    v_pk_fma_f32 v[208:209], v[208:209], v[250:251], v[250:251] op_sel:[0,1,1] op_sel_hi:[1,1,1]
    v_pk_fma_f32 v[210:211], v[210:211], v[250:251], v[250:251] op_sel:[0,1,1] op_sel_hi:[1,1,1]
    v_rcp_f32 v204, v204
    v_rcp_f32 v205, v205
    v_rcp_f32 v206, v206
    v_rcp_f32 v207, v207
    v_rcp_f32 v208, v208
    v_rcp_f32 v209, v209
    v_rcp_f32 v210, v210
    v_rcp_f32 v211, v211
    v_pk_mul_f32 v[112:113], v[112:113], v[204:205]
    v_pk_mul_f32 v[114:115], v[114:115], v[206:207]
    v_pk_mul_f32 v[116:117], v[116:117], v[208:209]
    v_pk_mul_f32 v[118:119], v[118:119], v[210:211]
    s_waitcnt lgkmcnt(4)
    v_pk_add_f32 v[184:185], v[184:185], v[228:229]
    v_pk_add_f32 v[186:187], v[186:187], v[230:231]
    v_pk_fma_f32 v[120:121], v[248:249], v[184:185], v[120:121] op_sel_hi:[0,1,1] neg_lo:[1,0,0] neg_hi:[1,0,0]
    v_pk_fma_f32 v[122:123], v[248:249], v[186:187], v[122:123] op_sel_hi:[0,1,1] neg_lo:[1,0,0] neg_hi:[1,0,0]
    v_pk_fma_f32 v[124:125], v[250:251], v[184:185], v[124:125] op_sel_hi:[0,1,1] neg_lo:[1,0,0] neg_hi:[1,0,0]
    v_pk_fma_f32 v[126:127], v[250:251], v[186:187], v[126:127] op_sel_hi:[0,1,1] neg_lo:[1,0,0] neg_hi:[1,0,0]
    v_pk_mul_f32 v[160:161], v[120:121], v[120:121]
    v_pk_mul_f32 v[162:163], v[122:123], v[122:123]
    v_pk_mul_f32 v[164:165], v[124:125], v[124:125]
    v_pk_mul_f32 v[166:167], v[126:127], v[126:127]
    v_pk_fma_f32 v[160:161], v[160:161], v[4:5], v[4:5] op_sel:[0,1,0] op_sel_hi:[1,1,0]
    v_pk_fma_f32 v[162:163], v[162:163], v[4:5], v[4:5] op_sel:[0,1,0] op_sel_hi:[1,1,0]
    v_pk_fma_f32 v[164:165], v[164:165], v[6:7], v[6:7] op_sel:[0,1,0] op_sel_hi:[1,1,0]
    v_pk_fma_f32 v[166:167], v[166:167], v[6:7], v[6:7] op_sel:[0,1,0] op_sel_hi:[1,1,0]
    v_pk_mul_f32 v[160:161], v[160:161], v[120:121]
    v_pk_mul_f32 v[162:163], v[162:163], v[122:123]
    v_pk_mul_f32 v[164:165], v[164:165], v[124:125]
    v_pk_mul_f32 v[166:167], v[166:167], v[126:127]
    v_exp_f32 v160, v160
    v_exp_f32 v161, v161
    v_exp_f32 v162, v162
    v_exp_f32 v163, v163
    v_exp_f32 v164, v164
    v_exp_f32 v165, v165
    v_exp_f32 v166, v166
    v_exp_f32 v167, v167
    v_pk_fma_f32 v[160:161], v[160:161], v[248:249], v[248:249] op_sel:[0,1,1] op_sel_hi:[1,1,1]
    v_pk_fma_f32 v[162:163], v[162:163], v[248:249], v[248:249] op_sel:[0,1,1] op_sel_hi:[1,1,1]
    v_pk_fma_f32 v[164:165], v[164:165], v[250:251], v[250:251] op_sel:[0,1,1] op_sel_hi:[1,1,1]
    v_pk_fma_f32 v[166:167], v[166:167], v[250:251], v[250:251] op_sel:[0,1,1] op_sel_hi:[1,1,1]
    v_rcp_f32 v160, v160
    v_rcp_f32 v161, v161
    v_rcp_f32 v162, v162
    v_rcp_f32 v163, v163
    v_rcp_f32 v164, v164
    v_rcp_f32 v165, v165
    v_rcp_f32 v166, v166
    v_rcp_f32 v167, v167
    v_pk_mul_f32 v[120:121], v[120:121], v[160:161]
    v_pk_mul_f32 v[122:123], v[122:123], v[162:163]
    v_pk_mul_f32 v[124:125], v[124:125], v[164:165]
    v_pk_mul_f32 v[126:127], v[126:127], v[166:167]
    s_waitcnt lgkmcnt(3)
    v_pk_add_f32 v[188:189], v[188:189], v[232:233]
    v_pk_add_f32 v[190:191], v[190:191], v[234:235]
    v_pk_fma_f32 v[128:129], v[248:249], v[188:189], v[128:129] op_sel_hi:[0,1,1] neg_lo:[1,0,0] neg_hi:[1,0,0]
    v_pk_fma_f32 v[130:131], v[248:249], v[190:191], v[130:131] op_sel_hi:[0,1,1] neg_lo:[1,0,0] neg_hi:[1,0,0]
    v_pk_fma_f32 v[132:133], v[250:251], v[188:189], v[132:133] op_sel_hi:[0,1,1] neg_lo:[1,0,0] neg_hi:[1,0,0]
    v_pk_fma_f32 v[134:135], v[250:251], v[190:191], v[134:135] op_sel_hi:[0,1,1] neg_lo:[1,0,0] neg_hi:[1,0,0]
    v_pk_mul_f32 v[204:205], v[128:129], v[128:129]
    v_pk_mul_f32 v[206:207], v[130:131], v[130:131]
    v_pk_mul_f32 v[208:209], v[132:133], v[132:133]
    v_pk_mul_f32 v[210:211], v[134:135], v[134:135]
    v_pk_fma_f32 v[204:205], v[204:205], v[4:5], v[4:5] op_sel:[0,1,0] op_sel_hi:[1,1,0]
    v_pk_fma_f32 v[206:207], v[206:207], v[4:5], v[4:5] op_sel:[0,1,0] op_sel_hi:[1,1,0]
    v_pk_fma_f32 v[208:209], v[208:209], v[6:7], v[6:7] op_sel:[0,1,0] op_sel_hi:[1,1,0]
    v_pk_fma_f32 v[210:211], v[210:211], v[6:7], v[6:7] op_sel:[0,1,0] op_sel_hi:[1,1,0]
    v_pk_mul_f32 v[204:205], v[204:205], v[128:129]
    v_pk_mul_f32 v[206:207], v[206:207], v[130:131]
    v_pk_mul_f32 v[208:209], v[208:209], v[132:133]
    v_pk_mul_f32 v[210:211], v[210:211], v[134:135]
    v_exp_f32 v204, v204
    v_exp_f32 v205, v205
    v_exp_f32 v206, v206
    v_exp_f32 v207, v207
    v_exp_f32 v208, v208
    v_exp_f32 v209, v209
    v_exp_f32 v210, v210
    v_exp_f32 v211, v211
    v_pk_fma_f32 v[204:205], v[204:205], v[248:249], v[248:249] op_sel:[0,1,1] op_sel_hi:[1,1,1]
    v_pk_fma_f32 v[206:207], v[206:207], v[248:249], v[248:249] op_sel:[0,1,1] op_sel_hi:[1,1,1]
    v_pk_fma_f32 v[208:209], v[208:209], v[250:251], v[250:251] op_sel:[0,1,1] op_sel_hi:[1,1,1]
    v_pk_fma_f32 v[210:211], v[210:211], v[250:251], v[250:251] op_sel:[0,1,1] op_sel_hi:[1,1,1]
    v_rcp_f32 v204, v204
    v_rcp_f32 v205, v205
    v_rcp_f32 v206, v206
    v_rcp_f32 v207, v207
    v_rcp_f32 v208, v208
    v_rcp_f32 v209, v209
    v_rcp_f32 v210, v210
    v_rcp_f32 v211, v211
    v_pk_mul_f32 v[128:129], v[128:129], v[204:205]
    v_pk_mul_f32 v[130:131], v[130:131], v[206:207]
    v_pk_mul_f32 v[132:133], v[132:133], v[208:209]
    v_pk_mul_f32 v[134:135], v[134:135], v[210:211]
    s_waitcnt lgkmcnt(2)
    v_pk_add_f32 v[192:193], v[192:193], v[236:237]
    v_pk_add_f32 v[194:195], v[194:195], v[238:239]
    v_pk_fma_f32 v[136:137], v[248:249], v[192:193], v[136:137] op_sel_hi:[0,1,1] neg_lo:[1,0,0] neg_hi:[1,0,0]
    v_pk_fma_f32 v[138:139], v[248:249], v[194:195], v[138:139] op_sel_hi:[0,1,1] neg_lo:[1,0,0] neg_hi:[1,0,0]
    v_pk_fma_f32 v[140:141], v[250:251], v[192:193], v[140:141] op_sel_hi:[0,1,1] neg_lo:[1,0,0] neg_hi:[1,0,0]
    v_pk_fma_f32 v[142:143], v[250:251], v[194:195], v[142:143] op_sel_hi:[0,1,1] neg_lo:[1,0,0] neg_hi:[1,0,0]
    v_pk_mul_f32 v[160:161], v[136:137], v[136:137]
    v_pk_mul_f32 v[162:163], v[138:139], v[138:139]
    v_pk_mul_f32 v[164:165], v[140:141], v[140:141]
    v_pk_mul_f32 v[166:167], v[142:143], v[142:143]
    v_pk_fma_f32 v[160:161], v[160:161], v[4:5], v[4:5] op_sel:[0,1,0] op_sel_hi:[1,1,0]
    v_pk_fma_f32 v[162:163], v[162:163], v[4:5], v[4:5] op_sel:[0,1,0] op_sel_hi:[1,1,0]
    v_pk_fma_f32 v[164:165], v[164:165], v[6:7], v[6:7] op_sel:[0,1,0] op_sel_hi:[1,1,0]
    v_pk_fma_f32 v[166:167], v[166:167], v[6:7], v[6:7] op_sel:[0,1,0] op_sel_hi:[1,1,0]
    v_pk_mul_f32 v[160:161], v[160:161], v[136:137]
    v_pk_mul_f32 v[162:163], v[162:163], v[138:139]
    v_pk_mul_f32 v[164:165], v[164:165], v[140:141]
    v_pk_mul_f32 v[166:167], v[166:167], v[142:143]
    v_exp_f32 v160, v160
    v_exp_f32 v161, v161
    v_exp_f32 v162, v162
    v_exp_f32 v163, v163
    v_exp_f32 v164, v164
    v_exp_f32 v165, v165
    v_exp_f32 v166, v166
    v_exp_f32 v167, v167
    v_pk_fma_f32 v[160:161], v[160:161], v[248:249], v[248:249] op_sel:[0,1,1] op_sel_hi:[1,1,1]
    v_pk_fma_f32 v[162:163], v[162:163], v[248:249], v[248:249] op_sel:[0,1,1] op_sel_hi:[1,1,1]
    v_pk_fma_f32 v[164:165], v[164:165], v[250:251], v[250:251] op_sel:[0,1,1] op_sel_hi:[1,1,1]
    v_pk_fma_f32 v[166:167], v[166:167], v[250:251], v[250:251] op_sel:[0,1,1] op_sel_hi:[1,1,1]
    v_rcp_f32 v160, v160
    v_rcp_f32 v161, v161
    v_rcp_f32 v162, v162
    v_rcp_f32 v163, v163
    v_rcp_f32 v164, v164
    v_rcp_f32 v165, v165
    v_rcp_f32 v166, v166
    v_rcp_f32 v167, v167
    v_pk_mul_f32 v[136:137], v[136:137], v[160:161]
    v_pk_mul_f32 v[138:139], v[138:139], v[162:163]
    v_pk_mul_f32 v[140:141], v[140:141], v[164:165]
    v_pk_mul_f32 v[142:143], v[142:143], v[166:167]
    s_waitcnt lgkmcnt(1)
    v_pk_add_f32 v[196:197], v[196:197], v[240:241]
    v_pk_add_f32 v[198:199], v[198:199], v[242:243]
    v_pk_fma_f32 v[144:145], v[248:249], v[196:197], v[144:145] op_sel_hi:[0,1,1] neg_lo:[1,0,0] neg_hi:[1,0,0]
    v_pk_fma_f32 v[146:147], v[248:249], v[198:199], v[146:147] op_sel_hi:[0,1,1] neg_lo:[1,0,0] neg_hi:[1,0,0]
    v_pk_fma_f32 v[148:149], v[250:251], v[196:197], v[148:149] op_sel_hi:[0,1,1] neg_lo:[1,0,0] neg_hi:[1,0,0]
    v_pk_fma_f32 v[150:151], v[250:251], v[198:199], v[150:151] op_sel_hi:[0,1,1] neg_lo:[1,0,0] neg_hi:[1,0,0]
    v_pk_mul_f32 v[204:205], v[144:145], v[144:145]
    v_pk_mul_f32 v[206:207], v[146:147], v[146:147]
    v_pk_mul_f32 v[208:209], v[148:149], v[148:149]
    v_pk_mul_f32 v[210:211], v[150:151], v[150:151]
    v_pk_fma_f32 v[204:205], v[204:205], v[4:5], v[4:5] op_sel:[0,1,0] op_sel_hi:[1,1,0]
    v_pk_fma_f32 v[206:207], v[206:207], v[4:5], v[4:5] op_sel:[0,1,0] op_sel_hi:[1,1,0]
    v_pk_fma_f32 v[208:209], v[208:209], v[6:7], v[6:7] op_sel:[0,1,0] op_sel_hi:[1,1,0]
    v_pk_fma_f32 v[210:211], v[210:211], v[6:7], v[6:7] op_sel:[0,1,0] op_sel_hi:[1,1,0]
    v_pk_mul_f32 v[204:205], v[204:205], v[144:145]
    v_pk_mul_f32 v[206:207], v[206:207], v[146:147]
    v_pk_mul_f32 v[208:209], v[208:209], v[148:149]
    v_pk_mul_f32 v[210:211], v[210:211], v[150:151]
    v_exp_f32 v204, v204
    v_exp_f32 v205, v205
    v_exp_f32 v206, v206
    v_exp_f32 v207, v207
    v_exp_f32 v208, v208
    v_exp_f32 v209, v209
    v_exp_f32 v210, v210
    v_exp_f32 v211, v211
    v_pk_fma_f32 v[204:205], v[204:205], v[248:249], v[248:249] op_sel:[0,1,1] op_sel_hi:[1,1,1]
    v_pk_fma_f32 v[206:207], v[206:207], v[248:249], v[248:249] op_sel:[0,1,1] op_sel_hi:[1,1,1]
    v_pk_fma_f32 v[208:209], v[208:209], v[250:251], v[250:251] op_sel:[0,1,1] op_sel_hi:[1,1,1]
    v_pk_fma_f32 v[210:211], v[210:211], v[250:251], v[250:251] op_sel:[0,1,1] op_sel_hi:[1,1,1]
    v_rcp_f32 v204, v204
    v_rcp_f32 v205, v205
    v_rcp_f32 v206, v206
    v_rcp_f32 v207, v207
    v_rcp_f32 v208, v208
    v_rcp_f32 v209, v209
    v_rcp_f32 v210, v210
    v_rcp_f32 v211, v211
    v_pk_mul_f32 v[144:145], v[144:145], v[204:205]
    v_pk_mul_f32 v[146:147], v[146:147], v[206:207]
    v_pk_mul_f32 v[148:149], v[148:149], v[208:209]
    v_pk_mul_f32 v[150:151], v[150:151], v[210:211]
    s_waitcnt lgkmcnt(0)
    v_pk_add_f32 v[200:201], v[200:201], v[244:245]
    v_pk_add_f32 v[202:203], v[202:203], v[246:247]
    v_pk_fma_f32 v[152:153], v[248:249], v[200:201], v[152:153] op_sel_hi:[0,1,1] neg_lo:[1,0,0] neg_hi:[1,0,0]
    v_pk_fma_f32 v[154:155], v[248:249], v[202:203], v[154:155] op_sel_hi:[0,1,1] neg_lo:[1,0,0] neg_hi:[1,0,0]
    v_pk_fma_f32 v[156:157], v[250:251], v[200:201], v[156:157] op_sel_hi:[0,1,1] neg_lo:[1,0,0] neg_hi:[1,0,0]
    v_pk_fma_f32 v[158:159], v[250:251], v[202:203], v[158:159] op_sel_hi:[0,1,1] neg_lo:[1,0,0] neg_hi:[1,0,0]
    v_pk_mul_f32 v[160:161], v[152:153], v[152:153]
    v_pk_mul_f32 v[162:163], v[154:155], v[154:155]
    v_pk_mul_f32 v[164:165], v[156:157], v[156:157]
    v_pk_mul_f32 v[166:167], v[158:159], v[158:159]
    v_pk_fma_f32 v[160:161], v[160:161], v[4:5], v[4:5] op_sel:[0,1,0] op_sel_hi:[1,1,0]
    v_pk_fma_f32 v[162:163], v[162:163], v[4:5], v[4:5] op_sel:[0,1,0] op_sel_hi:[1,1,0]
    v_pk_fma_f32 v[164:165], v[164:165], v[6:7], v[6:7] op_sel:[0,1,0] op_sel_hi:[1,1,0]
    v_pk_fma_f32 v[166:167], v[166:167], v[6:7], v[6:7] op_sel:[0,1,0] op_sel_hi:[1,1,0]
    v_pk_mul_f32 v[160:161], v[160:161], v[152:153]
    v_pk_mul_f32 v[162:163], v[162:163], v[154:155]
    v_pk_mul_f32 v[164:165], v[164:165], v[156:157]
    v_pk_mul_f32 v[166:167], v[166:167], v[158:159]
    v_exp_f32 v160, v160
    v_exp_f32 v161, v161
    v_exp_f32 v162, v162
    v_exp_f32 v163, v163
    v_exp_f32 v164, v164
    v_exp_f32 v165, v165
    v_exp_f32 v166, v166
    v_exp_f32 v167, v167
    v_pk_fma_f32 v[160:161], v[160:161], v[248:249], v[248:249] op_sel:[0,1,1] op_sel_hi:[1,1,1]
    v_pk_fma_f32 v[162:163], v[162:163], v[248:249], v[248:249] op_sel:[0,1,1] op_sel_hi:[1,1,1]
    v_pk_fma_f32 v[164:165], v[164:165], v[250:251], v[250:251] op_sel:[0,1,1] op_sel_hi:[1,1,1]
    v_pk_fma_f32 v[166:167], v[166:167], v[250:251], v[250:251] op_sel:[0,1,1] op_sel_hi:[1,1,1]
    v_rcp_f32 v160, v160
    v_rcp_f32 v161, v161
    v_rcp_f32 v162, v162
    v_rcp_f32 v163, v163
    v_rcp_f32 v164, v164
    v_rcp_f32 v165, v165
    v_rcp_f32 v166, v166
    v_rcp_f32 v167, v167
    v_pk_mul_f32 v[152:153], v[152:153], v[160:161]
    v_pk_mul_f32 v[154:155], v[154:155], v[162:163]
    v_pk_mul_f32 v[156:157], v[156:157], v[164:165]
    v_pk_mul_f32 v[158:159], v[158:159], v[166:167]
    s_waitcnt vmcnt(0)
    v_lshlrev_b32 v252, 16, v252
    v_lshlrev_b32 v254, 16, v254
    v_mov_b32 v253, v252
    v_mov_b32 v255, v254
    v_bfe_u32 v6, v1, 4, 4
    v_lshrrev_b32 v3, 1, v6
    v_lshrrev_b32 v4, 8, v1
    v_xor_b32 v3, v3, v4
    v_lshlrev_b32 v3, 4, v3
    v_lshl_add_u32 v3, v6, 7, v3
    s_add_u32 s33, s30, 18432
    v_add_u32 v3, s33, v3
    v_xor_b32 v4, 64, v3
    v_add_u32 v5, 73728, v3
    v_add_u32 v6, 73728, v4
    v_mov_b64 v[16:17], v[252:253]
    v_mov_b64 v[18:19], v[252:253]
    v_mov_b64 v[20:21], v[254:255]
    v_mov_b64 v[22:23], v[254:255]
    v_mov_b64 v[24:25], v[252:253]
    v_mov_b64 v[26:27], v[252:253]
    v_mov_b64 v[28:29], v[254:255]
    v_mov_b64 v[30:31], v[254:255]
    v_mov_b64 v[32:33], v[252:253]
    v_mov_b64 v[34:35], v[252:253]
    v_mov_b64 v[36:37], v[254:255]
    v_mov_b64 v[38:39], v[254:255]
    v_mov_b64 v[40:41], v[252:253]
    v_mov_b64 v[42:43], v[252:253]
    v_mov_b64 v[44:45], v[254:255]
    v_mov_b64 v[46:47], v[254:255]
    v_mov_b64 v[48:49], v[252:253]
    v_mov_b64 v[50:51], v[252:253]
    v_mov_b64 v[52:53], v[254:255]
    v_mov_b64 v[54:55], v[254:255]
    v_mov_b64 v[56:57], v[252:253]
    v_mov_b64 v[58:59], v[252:253]
    v_mov_b64 v[60:61], v[254:255]
    v_mov_b64 v[62:63], v[254:255]
    v_mov_b64 v[64:65], v[252:253]
    v_mov_b64 v[66:67], v[252:253]
    v_mov_b64 v[68:69], v[254:255]
    v_mov_b64 v[70:71], v[254:255]
    v_mov_b64 v[72:73], v[252:253]
    v_mov_b64 v[74:75], v[252:253]
    v_mov_b64 v[76:77], v[254:255]
    v_mov_b64 v[78:79], v[254:255]
    v_mov_b64 v[80:81], v[252:253]
    v_mov_b64 v[82:83], v[252:253]
    v_mov_b64 v[84:85], v[254:255]
    v_mov_b64 v[86:87], v[254:255]
    s_mul_i32 s36, s31, 73728
    s_add_u32 s36, s36, s21
    s_lshl_b32 s34, s24, 12
    s_lshl_b32 s35, s24, 9
    s_add_u32 s35, s35, 65536
    v_add_u32 v14, s34, v1
    v_lshrrev_b32 v15, 1, v1
    v_add_u32 v15, s35, v15
    s_add_u32 s39, s36, 0x1200000
    s_add_u32 s40, s36, 0x1212000
    s_mov_b32 s41, 7
    s_barrier
    ds_read_b128 v[160:163], v5 offset:0
    ds_read_b128 v[164:167], v5 offset:2048
    ds_read_b128 v[168:171], v2 offset:0
    ds_read_b128 v[172:175], v2 offset:1024
    ds_read_b128 v[176:179], v2 offset:2048
    ds_read_b128 v[180:183], v2 offset:3072
    ds_read_b128 v[184:187], v2 offset:4096
    ds_read_b128 v[188:191], v2 offset:5120
    ds_read_b128 v[192:195], v2 offset:6144
    ds_read_b128 v[196:199], v2 offset:7168
    ds_read_b128 v[200:203], v2 offset:8192
    .p2align 6
L_g_loop:
    s_waitcnt lgkmcnt(5)
    v_mfma_f32_16x16x32_bf16 v[16:19], v[168:171], v[160:163], v[16:19]
    ds_read_b128 v[204:207], v6 offset:0
    v_mfma_f32_16x16x32_bf16 v[20:23], v[168:171], v[164:167], v[20:23]
    ds_read_b128 v[208:211], v6 offset:2048
    v_mfma_f32_16x16x32_bf16 v[24:27], v[172:175], v[160:163], v[24:27]
    ds_read_b128 v[212:215], v2 offset:9216
    v_mfma_f32_16x16x32_bf16 v[28:31], v[172:175], v[164:167], v[28:31]
    ds_read_b128 v[216:219], v2 offset:10240
    v_mfma_f32_16x16x32_bf16 v[32:35], v[176:179], v[160:163], v[32:35]
    ds_read_b128 v[220:223], v2 offset:11264
    v_mfma_f32_16x16x32_bf16 v[36:39], v[176:179], v[164:167], v[36:39]
    ds_read_b128 v[224:227], v2 offset:12288
    v_mfma_f32_16x16x32_bf16 v[40:43], v[180:183], v[160:163], v[40:43]
    ds_read_b128 v[228:231], v2 offset:13312
    v_mfma_f32_16x16x32_bf16 v[44:47], v[180:183], v[164:167], v[44:47]
    ds_read_b128 v[232:235], v2 offset:14336
    s_waitcnt lgkmcnt(8)
    v_mfma_f32_16x16x32_bf16 v[48:51], v[184:187], v[160:163], v[48:51]
    ds_read_b128 v[236:239], v2 offset:15360
    v_mfma_f32_16x16x32_bf16 v[52:55], v[184:187], v[164:167], v[52:55]
    ds_read_b128 v[240:243], v2 offset:16384
    v_mfma_f32_16x16x32_bf16 v[56:59], v[188:191], v[160:163], v[56:59]
    ds_read_b128 v[244:247], v2 offset:17408
    v_mfma_f32_16x16x32_bf16 v[60:63], v[188:191], v[164:167], v[60:63]
    v_mfma_f32_16x16x32_bf16 v[64:67], v[192:195], v[160:163], v[64:67]
    v_mfma_f32_16x16x32_bf16 v[68:71], v[192:195], v[164:167], v[68:71]
    v_mfma_f32_16x16x32_bf16 v[72:75], v[196:199], v[160:163], v[72:75]
    v_mfma_f32_16x16x32_bf16 v[76:79], v[196:199], v[164:167], v[76:79]
    v_mfma_f32_16x16x32_bf16 v[80:83], v[200:203], v[160:163], v[80:83]
    v_mfma_f32_16x16x32_bf16 v[84:87], v[200:203], v[164:167], v[84:87]
    s_waitcnt lgkmcnt(0)
    s_barrier
    v_mfma_f32_16x16x32_bf16 v[16:19], v[212:215], v[204:207], v[16:19]
    ds_read_b128 v[160:163], v5 offset:36864
    v_mfma_f32_16x16x32_bf16 v[20:23], v[212:215], v[208:211], v[20:23]
    ds_read_b128 v[164:167], v5 offset:38912
    v_mfma_f32_16x16x32_bf16 v[24:27], v[216:219], v[204:207], v[24:27]
    ds_read_b128 v[168:171], v2 offset:36864
    v_mfma_f32_16x16x32_bf16 v[28:31], v[216:219], v[208:211], v[28:31]
    ds_read_b128 v[172:175], v2 offset:37888
    v_mfma_f32_16x16x32_bf16 v[32:35], v[220:223], v[204:207], v[32:35]
    ds_read_b128 v[176:179], v2 offset:38912
    v_mfma_f32_16x16x32_bf16 v[36:39], v[220:223], v[208:211], v[36:39]
    ds_read_b128 v[180:183], v2 offset:39936
    v_mfma_f32_16x16x32_bf16 v[40:43], v[224:227], v[204:207], v[40:43]
    ds_read_b128 v[184:187], v2 offset:40960
    v_mfma_f32_16x16x32_bf16 v[44:47], v[224:227], v[208:211], v[44:47]
    ds_read_b128 v[188:191], v2 offset:41984
    v_mfma_f32_16x16x32_bf16 v[48:51], v[228:231], v[204:207], v[48:51]
    ds_read_b128 v[192:195], v2 offset:43008
    v_mfma_f32_16x16x32_bf16 v[52:55], v[228:231], v[208:211], v[52:55]
    ds_read_b128 v[196:199], v2 offset:44032
    v_mfma_f32_16x16x32_bf16 v[56:59], v[232:235], v[204:207], v[56:59]
    ds_read_b128 v[200:203], v2 offset:45056
    v_mfma_f32_16x16x32_bf16 v[60:63], v[232:235], v[208:211], v[60:63]
    v_mfma_f32_16x16x32_bf16 v[64:67], v[236:239], v[204:207], v[64:67]
    v_mfma_f32_16x16x32_bf16 v[68:71], v[236:239], v[208:211], v[68:71]
    v_mfma_f32_16x16x32_bf16 v[72:75], v[240:243], v[204:207], v[72:75]
    v_mfma_f32_16x16x32_bf16 v[76:79], v[240:243], v[208:211], v[76:79]
    v_mfma_f32_16x16x32_bf16 v[80:83], v[244:247], v[204:207], v[80:83]
    v_mfma_f32_16x16x32_bf16 v[84:87], v[244:247], v[208:211], v[84:87]
    s_waitcnt lgkmcnt(5)
    v_mfma_f32_16x16x32_bf16 v[16:19], v[168:171], v[160:163], v[16:19]
    ds_read_b128 v[204:207], v6 offset:36864
    v_mfma_f32_16x16x32_bf16 v[20:23], v[168:171], v[164:167], v[20:23]
    ds_read_b128 v[208:211], v6 offset:38912
    v_mfma_f32_16x16x32_bf16 v[24:27], v[172:175], v[160:163], v[24:27]
    ds_read_b128 v[212:215], v2 offset:46080
    v_mfma_f32_16x16x32_bf16 v[28:31], v[172:175], v[164:167], v[28:31]
    ds_read_b128 v[216:219], v2 offset:47104
    v_mfma_f32_16x16x32_bf16 v[32:35], v[176:179], v[160:163], v[32:35]
    ds_read_b128 v[220:223], v2 offset:48128
    v_mfma_f32_16x16x32_bf16 v[36:39], v[176:179], v[164:167], v[36:39]
    ds_read_b128 v[224:227], v2 offset:49152
    v_mfma_f32_16x16x32_bf16 v[40:43], v[180:183], v[160:163], v[40:43]
    ds_read_b128 v[228:231], v2 offset:50176
    v_mfma_f32_16x16x32_bf16 v[44:47], v[180:183], v[164:167], v[44:47]
    ds_read_b128 v[232:235], v2 offset:51200
    s_waitcnt lgkmcnt(8)
    v_mfma_f32_16x16x32_bf16 v[48:51], v[184:187], v[160:163], v[48:51]
    ds_read_b128 v[236:239], v2 offset:52224
    v_mfma_f32_16x16x32_bf16 v[52:55], v[184:187], v[164:167], v[52:55]
    ds_read_b128 v[240:243], v2 offset:53248
    v_mfma_f32_16x16x32_bf16 v[56:59], v[188:191], v[160:163], v[56:59]
    ds_read_b128 v[244:247], v2 offset:54272
    v_mfma_f32_16x16x32_bf16 v[60:63], v[188:191], v[164:167], v[60:63]
    v_mfma_f32_16x16x32_bf16 v[64:67], v[192:195], v[160:163], v[64:67]
    v_mfma_f32_16x16x32_bf16 v[68:71], v[192:195], v[164:167], v[68:71]
    v_mfma_f32_16x16x32_bf16 v[72:75], v[196:199], v[160:163], v[72:75]
    v_mfma_f32_16x16x32_bf16 v[76:79], v[196:199], v[164:167], v[76:79]
    v_mfma_f32_16x16x32_bf16 v[80:83], v[200:203], v[160:163], v[80:83]
    v_mfma_f32_16x16x32_bf16 v[84:87], v[200:203], v[164:167], v[84:87]
    s_waitcnt lgkmcnt(0)
    s_barrier
    v_mfma_f32_16x16x32_bf16 v[16:19], v[212:215], v[204:207], v[16:19]
    ds_read_b128 v[160:163], v3 offset:0
    v_mfma_f32_16x16x32_bf16 v[20:23], v[212:215], v[208:211], v[20:23]
    ds_read_b128 v[164:167], v3 offset:2048
    v_mfma_f32_16x16x32_bf16 v[24:27], v[216:219], v[204:207], v[24:27]
    ds_read_b128 v[168:171], v1 offset:0
    v_mfma_f32_16x16x32_bf16 v[28:31], v[216:219], v[208:211], v[28:31]
    ds_read_b128 v[172:175], v1 offset:1024
    v_mfma_f32_16x16x32_bf16 v[32:35], v[220:223], v[204:207], v[32:35]
    ds_read_b128 v[176:179], v1 offset:2048
    v_mfma_f32_16x16x32_bf16 v[36:39], v[220:223], v[208:211], v[36:39]
    ds_read_b128 v[180:183], v1 offset:3072
    v_mfma_f32_16x16x32_bf16 v[40:43], v[224:227], v[204:207], v[40:43]
    ds_read_b128 v[184:187], v1 offset:4096
    v_mfma_f32_16x16x32_bf16 v[44:47], v[224:227], v[208:211], v[44:47]
    ds_read_b128 v[188:191], v1 offset:5120
    v_mfma_f32_16x16x32_bf16 v[48:51], v[228:231], v[204:207], v[48:51]
    ds_read_b128 v[192:195], v1 offset:6144
    v_mfma_f32_16x16x32_bf16 v[52:55], v[228:231], v[208:211], v[52:55]
    ds_read_b128 v[196:199], v1 offset:7168
    v_mfma_f32_16x16x32_bf16 v[56:59], v[232:235], v[204:207], v[56:59]
    ds_read_b128 v[200:203], v1 offset:8192
    v_mfma_f32_16x16x32_bf16 v[60:63], v[232:235], v[208:211], v[60:63]
    v_mfma_f32_16x16x32_bf16 v[64:67], v[236:239], v[204:207], v[64:67]
    v_mfma_f32_16x16x32_bf16 v[68:71], v[236:239], v[208:211], v[68:71]
    v_mfma_f32_16x16x32_bf16 v[72:75], v[240:243], v[204:207], v[72:75]
    v_mfma_f32_16x16x32_bf16 v[76:79], v[240:243], v[208:211], v[76:79]
    v_mfma_f32_16x16x32_bf16 v[80:83], v[244:247], v[204:207], v[80:83]
    v_mfma_f32_16x16x32_bf16 v[84:87], v[244:247], v[208:211], v[84:87]
    s_waitcnt lgkmcnt(5)
    v_mfma_f32_16x16x32_bf16 v[16:19], v[168:171], v[160:163], v[16:19]
    ds_read_b128 v[204:207], v4 offset:0
    v_mfma_f32_16x16x32_bf16 v[20:23], v[168:171], v[164:167], v[20:23]
    ds_read_b128 v[208:211], v4 offset:2048
    v_mfma_f32_16x16x32_bf16 v[24:27], v[172:175], v[160:163], v[24:27]
    ds_read_b128 v[212:215], v1 offset:9216
    v_mfma_f32_16x16x32_bf16 v[28:31], v[172:175], v[164:167], v[28:31]
    ds_read_b128 v[216:219], v1 offset:10240
    v_mfma_f32_16x16x32_bf16 v[32:35], v[176:179], v[160:163], v[32:35]
    ds_read_b128 v[220:223], v1 offset:11264
    v_mfma_f32_16x16x32_bf16 v[36:39], v[176:179], v[164:167], v[36:39]
    ds_read_b128 v[224:227], v1 offset:12288
    v_mfma_f32_16x16x32_bf16 v[40:43], v[180:183], v[160:163], v[40:43]
    ds_read_b128 v[228:231], v1 offset:13312
    v_mfma_f32_16x16x32_bf16 v[44:47], v[180:183], v[164:167], v[44:47]
    ds_read_b128 v[232:235], v1 offset:14336
    s_waitcnt lgkmcnt(8)
    v_mfma_f32_16x16x32_bf16 v[48:51], v[184:187], v[160:163], v[48:51]
    ds_read_b128 v[236:239], v1 offset:15360
    v_mfma_f32_16x16x32_bf16 v[52:55], v[184:187], v[164:167], v[52:55]
    ds_read_b128 v[240:243], v1 offset:16384
    v_mfma_f32_16x16x32_bf16 v[56:59], v[188:191], v[160:163], v[56:59]
    ds_read_b128 v[244:247], v1 offset:17408
    v_mfma_f32_16x16x32_bf16 v[60:63], v[188:191], v[164:167], v[60:63]
    v_mfma_f32_16x16x32_bf16 v[64:67], v[192:195], v[160:163], v[64:67]
    v_mfma_f32_16x16x32_bf16 v[68:71], v[192:195], v[164:167], v[68:71]
    v_mfma_f32_16x16x32_bf16 v[72:75], v[196:199], v[160:163], v[72:75]
    v_mfma_f32_16x16x32_bf16 v[76:79], v[196:199], v[164:167], v[76:79]
    v_mfma_f32_16x16x32_bf16 v[80:83], v[200:203], v[160:163], v[80:83]
    v_mfma_f32_16x16x32_bf16 v[84:87], v[200:203], v[164:167], v[84:87]
    s_waitcnt lgkmcnt(0)
    s_barrier
    v_mfma_f32_16x16x32_bf16 v[16:19], v[212:215], v[204:207], v[16:19]
    ds_read_b128 v[160:163], v3 offset:36864
    v_mfma_f32_16x16x32_bf16 v[20:23], v[212:215], v[208:211], v[20:23]
    ds_read_b128 v[164:167], v3 offset:38912
    v_mfma_f32_16x16x32_bf16 v[24:27], v[216:219], v[204:207], v[24:27]
    ds_read_b128 v[168:171], v1 offset:36864
    v_mfma_f32_16x16x32_bf16 v[28:31], v[216:219], v[208:211], v[28:31]
    ds_read_b128 v[172:175], v1 offset:37888
    v_mfma_f32_16x16x32_bf16 v[32:35], v[220:223], v[204:207], v[32:35]
    ds_read_b128 v[176:179], v1 offset:38912
    v_mfma_f32_16x16x32_bf16 v[36:39], v[220:223], v[208:211], v[36:39]
    ds_read_b128 v[180:183], v1 offset:39936
    v_mfma_f32_16x16x32_bf16 v[40:43], v[224:227], v[204:207], v[40:43]
    ds_read_b128 v[184:187], v1 offset:40960
    v_mfma_f32_16x16x32_bf16 v[44:47], v[224:227], v[208:211], v[44:47]
    ds_read_b128 v[188:191], v1 offset:41984
    v_mfma_f32_16x16x32_bf16 v[48:51], v[228:231], v[204:207], v[48:51]
    ds_read_b128 v[192:195], v1 offset:43008
    v_mfma_f32_16x16x32_bf16 v[52:55], v[228:231], v[208:211], v[52:55]
    ds_read_b128 v[196:199], v1 offset:44032
    v_mfma_f32_16x16x32_bf16 v[56:59], v[232:235], v[204:207], v[56:59]
    ds_read_b128 v[200:203], v1 offset:45056
    v_mfma_f32_16x16x32_bf16 v[60:63], v[232:235], v[208:211], v[60:63]
    v_mfma_f32_16x16x32_bf16 v[64:67], v[236:239], v[204:207], v[64:67]
    v_mfma_f32_16x16x32_bf16 v[68:71], v[236:239], v[208:211], v[68:71]
    v_mfma_f32_16x16x32_bf16 v[72:75], v[240:243], v[204:207], v[72:75]
    v_mfma_f32_16x16x32_bf16 v[76:79], v[240:243], v[208:211], v[76:79]
    v_mfma_f32_16x16x32_bf16 v[80:83], v[244:247], v[204:207], v[80:83]
    v_mfma_f32_16x16x32_bf16 v[84:87], v[244:247], v[208:211], v[84:87]
    s_waitcnt lgkmcnt(5)
    v_mfma_f32_16x16x32_bf16 v[16:19], v[168:171], v[160:163], v[16:19]
    ds_read_b128 v[204:207], v4 offset:36864
    v_mfma_f32_16x16x32_bf16 v[20:23], v[168:171], v[164:167], v[20:23]
    ds_read_b128 v[208:211], v4 offset:38912
    v_mfma_f32_16x16x32_bf16 v[24:27], v[172:175], v[160:163], v[24:27]
    ds_read_b128 v[212:215], v1 offset:46080
    v_mfma_f32_16x16x32_bf16 v[28:31], v[172:175], v[164:167], v[28:31]
    ds_read_b128 v[216:219], v1 offset:47104
    v_mfma_f32_16x16x32_bf16 v[32:35], v[176:179], v[160:163], v[32:35]
    ds_read_b128 v[220:223], v1 offset:48128
    v_mfma_f32_16x16x32_bf16 v[36:39], v[176:179], v[164:167], v[36:39]
    ds_read_b128 v[224:227], v1 offset:49152
    v_mfma_f32_16x16x32_bf16 v[40:43], v[180:183], v[160:163], v[40:43]
    ds_read_b128 v[228:231], v1 offset:50176
    v_mfma_f32_16x16x32_bf16 v[44:47], v[180:183], v[164:167], v[44:47]
    ds_read_b128 v[232:235], v1 offset:51200
    s_waitcnt lgkmcnt(8)
    v_mfma_f32_16x16x32_bf16 v[48:51], v[184:187], v[160:163], v[48:51]
    ds_read_b128 v[236:239], v1 offset:52224
    v_mfma_f32_16x16x32_bf16 v[52:55], v[184:187], v[164:167], v[52:55]
    ds_read_b128 v[240:243], v1 offset:53248
    v_mfma_f32_16x16x32_bf16 v[56:59], v[188:191], v[160:163], v[56:59]
    ds_read_b128 v[244:247], v1 offset:54272
    v_mfma_f32_16x16x32_bf16 v[60:63], v[188:191], v[164:167], v[60:63]
    v_mfma_f32_16x16x32_bf16 v[64:67], v[192:195], v[160:163], v[64:67]
    v_mfma_f32_16x16x32_bf16 v[68:71], v[192:195], v[164:167], v[68:71]
    v_mfma_f32_16x16x32_bf16 v[72:75], v[196:199], v[160:163], v[72:75]
    v_mfma_f32_16x16x32_bf16 v[76:79], v[196:199], v[164:167], v[76:79]
    v_mfma_f32_16x16x32_bf16 v[80:83], v[200:203], v[160:163], v[80:83]
    v_mfma_f32_16x16x32_bf16 v[84:87], v[200:203], v[164:167], v[84:87]
    s_waitcnt lgkmcnt(0)
    s_barrier
    v_mfma_f32_16x16x32_bf16 v[16:19], v[212:215], v[204:207], v[16:19]
    ds_read_b128 v[160:163], v5 offset:0
    v_mfma_f32_16x16x32_bf16 v[20:23], v[212:215], v[208:211], v[20:23]
    ds_read_b128 v[164:167], v5 offset:2048
    v_mfma_f32_16x16x32_bf16 v[24:27], v[216:219], v[204:207], v[24:27]
    ds_read_b128 v[168:171], v2 offset:0
    v_mfma_f32_16x16x32_bf16 v[28:31], v[216:219], v[208:211], v[28:31]
    ds_read_b128 v[172:175], v2 offset:1024
    v_mfma_f32_16x16x32_bf16 v[32:35], v[220:223], v[204:207], v[32:35]
    ds_read_b128 v[176:179], v2 offset:2048
    v_mfma_f32_16x16x32_bf16 v[36:39], v[220:223], v[208:211], v[36:39]
    ds_read_b128 v[180:183], v2 offset:3072
    v_mfma_f32_16x16x32_bf16 v[40:43], v[224:227], v[204:207], v[40:43]
    ds_read_b128 v[184:187], v2 offset:4096
    v_mfma_f32_16x16x32_bf16 v[44:47], v[224:227], v[208:211], v[44:47]
    ds_read_b128 v[188:191], v2 offset:5120
    v_mfma_f32_16x16x32_bf16 v[48:51], v[228:231], v[204:207], v[48:51]
    ds_read_b128 v[192:195], v2 offset:6144
    v_mfma_f32_16x16x32_bf16 v[52:55], v[228:231], v[208:211], v[52:55]
    ds_read_b128 v[196:199], v2 offset:7168
    v_mfma_f32_16x16x32_bf16 v[56:59], v[232:235], v[204:207], v[56:59]
    ds_read_b128 v[200:203], v2 offset:8192
    v_mfma_f32_16x16x32_bf16 v[60:63], v[232:235], v[208:211], v[60:63]
    v_mfma_f32_16x16x32_bf16 v[64:67], v[236:239], v[204:207], v[64:67]
    v_mfma_f32_16x16x32_bf16 v[68:71], v[236:239], v[208:211], v[68:71]
    v_mfma_f32_16x16x32_bf16 v[72:75], v[240:243], v[204:207], v[72:75]
    v_mfma_f32_16x16x32_bf16 v[76:79], v[240:243], v[208:211], v[76:79]
    v_mfma_f32_16x16x32_bf16 v[80:83], v[244:247], v[204:207], v[80:83]
    s_sub_u32 s41, s41, 1
    v_mfma_f32_16x16x32_bf16 v[84:87], v[244:247], v[208:211], v[84:87]
    s_cmp_lg_u32 s41, 0
    s_cbranch_scc1 L_g_loop
    s_waitcnt lgkmcnt(5)
    v_mfma_f32_16x16x32_bf16 v[16:19], v[168:171], v[160:163], v[16:19]
    ds_read_b128 v[204:207], v6 offset:0
    v_mfma_f32_16x16x32_bf16 v[20:23], v[168:171], v[164:167], v[20:23]
    ds_read_b128 v[208:211], v6 offset:2048
    v_mfma_f32_16x16x32_bf16 v[24:27], v[172:175], v[160:163], v[24:27]
    ds_read_b128 v[212:215], v2 offset:9216
    v_mfma_f32_16x16x32_bf16 v[28:31], v[172:175], v[164:167], v[28:31]
    ds_read_b128 v[216:219], v2 offset:10240
    v_mfma_f32_16x16x32_bf16 v[32:35], v[176:179], v[160:163], v[32:35]
    ds_read_b128 v[220:223], v2 offset:11264
    v_mfma_f32_16x16x32_bf16 v[36:39], v[176:179], v[164:167], v[36:39]
    ds_read_b128 v[224:227], v2 offset:12288
    v_mfma_f32_16x16x32_bf16 v[40:43], v[180:183], v[160:163], v[40:43]
    ds_read_b128 v[228:231], v2 offset:13312
    v_mfma_f32_16x16x32_bf16 v[44:47], v[180:183], v[164:167], v[44:47]
    ds_read_b128 v[232:235], v2 offset:14336
    s_waitcnt lgkmcnt(8)
    v_mfma_f32_16x16x32_bf16 v[48:51], v[184:187], v[160:163], v[48:51]
    ds_read_b128 v[236:239], v2 offset:15360
    v_mfma_f32_16x16x32_bf16 v[52:55], v[184:187], v[164:167], v[52:55]
    ds_read_b128 v[240:243], v2 offset:16384
    v_mfma_f32_16x16x32_bf16 v[56:59], v[188:191], v[160:163], v[56:59]
    ds_read_b128 v[244:247], v2 offset:17408
    v_mfma_f32_16x16x32_bf16 v[60:63], v[188:191], v[164:167], v[60:63]
    v_mfma_f32_16x16x32_bf16 v[64:67], v[192:195], v[160:163], v[64:67]
    v_mfma_f32_16x16x32_bf16 v[68:71], v[192:195], v[164:167], v[68:71]
    v_mfma_f32_16x16x32_bf16 v[72:75], v[196:199], v[160:163], v[72:75]
    v_mfma_f32_16x16x32_bf16 v[76:79], v[196:199], v[164:167], v[76:79]
    v_mfma_f32_16x16x32_bf16 v[80:83], v[200:203], v[160:163], v[80:83]
    v_mfma_f32_16x16x32_bf16 v[84:87], v[200:203], v[164:167], v[84:87]
    s_waitcnt lgkmcnt(0)
    s_barrier
    v_mfma_f32_16x16x32_bf16 v[16:19], v[212:215], v[204:207], v[16:19]
    ds_read_b128 v[160:163], v5 offset:36864
    v_mfma_f32_16x16x32_bf16 v[20:23], v[212:215], v[208:211], v[20:23]
    ds_read_b128 v[164:167], v5 offset:38912
    v_mfma_f32_16x16x32_bf16 v[24:27], v[216:219], v[204:207], v[24:27]
    ds_read_b128 v[168:171], v2 offset:36864
    v_mfma_f32_16x16x32_bf16 v[28:31], v[216:219], v[208:211], v[28:31]
    ds_read_b128 v[172:175], v2 offset:37888
    v_mfma_f32_16x16x32_bf16 v[32:35], v[220:223], v[204:207], v[32:35]
    ds_read_b128 v[176:179], v2 offset:38912
    v_mfma_f32_16x16x32_bf16 v[36:39], v[220:223], v[208:211], v[36:39]
    ds_read_b128 v[180:183], v2 offset:39936
    v_mfma_f32_16x16x32_bf16 v[40:43], v[224:227], v[204:207], v[40:43]
    ds_read_b128 v[184:187], v2 offset:40960
    v_mfma_f32_16x16x32_bf16 v[44:47], v[224:227], v[208:211], v[44:47]
    ds_read_b128 v[188:191], v2 offset:41984
    v_mfma_f32_16x16x32_bf16 v[48:51], v[228:231], v[204:207], v[48:51]
    ds_read_b128 v[192:195], v2 offset:43008
    v_mfma_f32_16x16x32_bf16 v[52:55], v[228:231], v[208:211], v[52:55]
    ds_read_b128 v[196:199], v2 offset:44032
    v_mfma_f32_16x16x32_bf16 v[56:59], v[232:235], v[204:207], v[56:59]
    ds_read_b128 v[200:203], v2 offset:45056
    v_mfma_f32_16x16x32_bf16 v[60:63], v[232:235], v[208:211], v[60:63]
    v_mfma_f32_16x16x32_bf16 v[64:67], v[236:239], v[204:207], v[64:67]
    v_mfma_f32_16x16x32_bf16 v[68:71], v[236:239], v[208:211], v[68:71]
    v_mfma_f32_16x16x32_bf16 v[72:75], v[240:243], v[204:207], v[72:75]
    v_mfma_f32_16x16x32_bf16 v[76:79], v[240:243], v[208:211], v[76:79]
    v_mfma_f32_16x16x32_bf16 v[80:83], v[244:247], v[204:207], v[80:83]
    v_mfma_f32_16x16x32_bf16 v[84:87], v[244:247], v[208:211], v[84:87]
    s_waitcnt lgkmcnt(5)
    v_mfma_f32_16x16x32_bf16 v[16:19], v[168:171], v[160:163], v[16:19]
    ds_read_b128 v[204:207], v6 offset:36864
    v_mfma_f32_16x16x32_bf16 v[20:23], v[168:171], v[164:167], v[20:23]
    ds_read_b128 v[208:211], v6 offset:38912
    v_mfma_f32_16x16x32_bf16 v[24:27], v[172:175], v[160:163], v[24:27]
    ds_read_b128 v[212:215], v2 offset:46080
    v_mfma_f32_16x16x32_bf16 v[28:31], v[172:175], v[164:167], v[28:31]
    ds_read_b128 v[216:219], v2 offset:47104
    v_mfma_f32_16x16x32_bf16 v[32:35], v[176:179], v[160:163], v[32:35]
    ds_read_b128 v[220:223], v2 offset:48128
    v_mfma_f32_16x16x32_bf16 v[36:39], v[176:179], v[164:167], v[36:39]
    ds_read_b128 v[224:227], v2 offset:49152
    v_mfma_f32_16x16x32_bf16 v[40:43], v[180:183], v[160:163], v[40:43]
    ds_read_b128 v[228:231], v2 offset:50176
    v_mfma_f32_16x16x32_bf16 v[44:47], v[180:183], v[164:167], v[44:47]
    ds_read_b128 v[232:235], v2 offset:51200
    s_waitcnt lgkmcnt(8)
    v_mfma_f32_16x16x32_bf16 v[48:51], v[184:187], v[160:163], v[48:51]
    ds_read_b128 v[236:239], v2 offset:52224
    v_mfma_f32_16x16x32_bf16 v[52:55], v[184:187], v[164:167], v[52:55]
    ds_read_b128 v[240:243], v2 offset:53248
    v_mfma_f32_16x16x32_bf16 v[56:59], v[188:191], v[160:163], v[56:59]
    ds_read_b128 v[244:247], v2 offset:54272
    v_mfma_f32_16x16x32_bf16 v[60:63], v[188:191], v[164:167], v[60:63]
    v_mfma_f32_16x16x32_bf16 v[64:67], v[192:195], v[160:163], v[64:67]
    v_mfma_f32_16x16x32_bf16 v[68:71], v[192:195], v[164:167], v[68:71]
    v_mfma_f32_16x16x32_bf16 v[72:75], v[196:199], v[160:163], v[72:75]
    v_mfma_f32_16x16x32_bf16 v[76:79], v[196:199], v[164:167], v[76:79]
    v_mfma_f32_16x16x32_bf16 v[80:83], v[200:203], v[160:163], v[80:83]
    v_mfma_f32_16x16x32_bf16 v[84:87], v[200:203], v[164:167], v[84:87]
    s_waitcnt lgkmcnt(0)
    s_barrier
    v_mfma_f32_16x16x32_bf16 v[16:19], v[212:215], v[204:207], v[16:19]
    ds_read_b128 v[160:163], v3 offset:0
    v_mfma_f32_16x16x32_bf16 v[20:23], v[212:215], v[208:211], v[20:23]
    ds_read_b128 v[164:167], v3 offset:2048
    v_mfma_f32_16x16x32_bf16 v[24:27], v[216:219], v[204:207], v[24:27]
    ds_read_b128 v[168:171], v1 offset:0
    v_mfma_f32_16x16x32_bf16 v[28:31], v[216:219], v[208:211], v[28:31]
    ds_read_b128 v[172:175], v1 offset:1024
    v_mfma_f32_16x16x32_bf16 v[32:35], v[220:223], v[204:207], v[32:35]
    ds_read_b128 v[176:179], v1 offset:2048
    v_mfma_f32_16x16x32_bf16 v[36:39], v[220:223], v[208:211], v[36:39]
    ds_read_b128 v[180:183], v1 offset:3072
    v_mfma_f32_16x16x32_bf16 v[40:43], v[224:227], v[204:207], v[40:43]
    ds_read_b128 v[184:187], v1 offset:4096
    v_mfma_f32_16x16x32_bf16 v[44:47], v[224:227], v[208:211], v[44:47]
    ds_read_b128 v[188:191], v1 offset:5120
    v_mfma_f32_16x16x32_bf16 v[48:51], v[228:231], v[204:207], v[48:51]
    ds_read_b128 v[192:195], v1 offset:6144
    v_mfma_f32_16x16x32_bf16 v[52:55], v[228:231], v[208:211], v[52:55]
    ds_read_b128 v[196:199], v1 offset:7168
    v_mfma_f32_16x16x32_bf16 v[56:59], v[232:235], v[204:207], v[56:59]
    ds_read_b128 v[200:203], v1 offset:8192
    v_mfma_f32_16x16x32_bf16 v[60:63], v[232:235], v[208:211], v[60:63]
    v_mfma_f32_16x16x32_bf16 v[64:67], v[236:239], v[204:207], v[64:67]
    v_mfma_f32_16x16x32_bf16 v[68:71], v[236:239], v[208:211], v[68:71]
    v_mfma_f32_16x16x32_bf16 v[72:75], v[240:243], v[204:207], v[72:75]
    v_mfma_f32_16x16x32_bf16 v[76:79], v[240:243], v[208:211], v[76:79]
    v_mfma_f32_16x16x32_bf16 v[80:83], v[244:247], v[204:207], v[80:83]
    v_mfma_f32_16x16x32_bf16 v[84:87], v[244:247], v[208:211], v[84:87]
    s_waitcnt lgkmcnt(5)
    v_mfma_f32_16x16x32_bf16 v[16:19], v[168:171], v[160:163], v[16:19]
    ds_read_b128 v[204:207], v4 offset:0
    v_mfma_f32_16x16x32_bf16 v[20:23], v[168:171], v[164:167], v[20:23]
    ds_read_b128 v[208:211], v4 offset:2048
    v_mfma_f32_16x16x32_bf16 v[24:27], v[172:175], v[160:163], v[24:27]
    ds_read_b128 v[212:215], v1 offset:9216
    v_mfma_f32_16x16x32_bf16 v[28:31], v[172:175], v[164:167], v[28:31]
    ds_read_b128 v[216:219], v1 offset:10240
    v_mfma_f32_16x16x32_bf16 v[32:35], v[176:179], v[160:163], v[32:35]
    ds_read_b128 v[220:223], v1 offset:11264
    v_mfma_f32_16x16x32_bf16 v[36:39], v[176:179], v[164:167], v[36:39]
    ds_read_b128 v[224:227], v1 offset:12288
    v_mfma_f32_16x16x32_bf16 v[40:43], v[180:183], v[160:163], v[40:43]
    ds_read_b128 v[228:231], v1 offset:13312
    v_mfma_f32_16x16x32_bf16 v[44:47], v[180:183], v[164:167], v[44:47]
    ds_read_b128 v[232:235], v1 offset:14336
    s_waitcnt lgkmcnt(8)
    v_mfma_f32_16x16x32_bf16 v[48:51], v[184:187], v[160:163], v[48:51]
    ds_read_b128 v[236:239], v1 offset:15360
    v_mfma_f32_16x16x32_bf16 v[52:55], v[184:187], v[164:167], v[52:55]
    ds_read_b128 v[240:243], v1 offset:16384
    v_mfma_f32_16x16x32_bf16 v[56:59], v[188:191], v[160:163], v[56:59]
    ds_read_b128 v[244:247], v1 offset:17408
    v_mfma_f32_16x16x32_bf16 v[60:63], v[188:191], v[164:167], v[60:63]
    v_mfma_f32_16x16x32_bf16 v[64:67], v[192:195], v[160:163], v[64:67]
    v_mfma_f32_16x16x32_bf16 v[68:71], v[192:195], v[164:167], v[68:71]
    v_mfma_f32_16x16x32_bf16 v[72:75], v[196:199], v[160:163], v[72:75]
    v_mfma_f32_16x16x32_bf16 v[76:79], v[196:199], v[164:167], v[76:79]
    v_mfma_f32_16x16x32_bf16 v[80:83], v[200:203], v[160:163], v[80:83]
    v_mfma_f32_16x16x32_bf16 v[84:87], v[200:203], v[164:167], v[84:87]
    s_waitcnt lgkmcnt(0)
    s_barrier
    v_mfma_f32_16x16x32_bf16 v[16:19], v[212:215], v[204:207], v[16:19]
    ds_read_b128 v[160:163], v3 offset:36864
    v_mfma_f32_16x16x32_bf16 v[20:23], v[212:215], v[208:211], v[20:23]
    ds_read_b128 v[164:167], v3 offset:38912
    v_mfma_f32_16x16x32_bf16 v[24:27], v[216:219], v[204:207], v[24:27]
    ds_read_b128 v[168:171], v1 offset:36864
    v_mfma_f32_16x16x32_bf16 v[28:31], v[216:219], v[208:211], v[28:31]
    ds_read_b128 v[172:175], v1 offset:37888
    v_mfma_f32_16x16x32_bf16 v[32:35], v[220:223], v[204:207], v[32:35]
    ds_read_b128 v[176:179], v1 offset:38912
    v_mfma_f32_16x16x32_bf16 v[36:39], v[220:223], v[208:211], v[36:39]
    ds_read_b128 v[180:183], v1 offset:39936
    v_mfma_f32_16x16x32_bf16 v[40:43], v[224:227], v[204:207], v[40:43]
    ds_read_b128 v[184:187], v1 offset:40960
    v_mfma_f32_16x16x32_bf16 v[44:47], v[224:227], v[208:211], v[44:47]
    ds_read_b128 v[188:191], v1 offset:41984
    v_mfma_f32_16x16x32_bf16 v[48:51], v[228:231], v[204:207], v[48:51]
    ds_read_b128 v[192:195], v1 offset:43008
    v_mfma_f32_16x16x32_bf16 v[52:55], v[228:231], v[208:211], v[52:55]
    ds_read_b128 v[196:199], v1 offset:44032
    v_mfma_f32_16x16x32_bf16 v[56:59], v[232:235], v[204:207], v[56:59]
    ds_read_b128 v[200:203], v1 offset:45056
    v_mfma_f32_16x16x32_bf16 v[60:63], v[232:235], v[208:211], v[60:63]
    v_mfma_f32_16x16x32_bf16 v[64:67], v[236:239], v[204:207], v[64:67]
    v_mfma_f32_16x16x32_bf16 v[68:71], v[236:239], v[208:211], v[68:71]
    v_mfma_f32_16x16x32_bf16 v[72:75], v[240:243], v[204:207], v[72:75]
    v_mfma_f32_16x16x32_bf16 v[76:79], v[240:243], v[208:211], v[76:79]
    v_mfma_f32_16x16x32_bf16 v[80:83], v[244:247], v[204:207], v[80:83]
    v_mfma_f32_16x16x32_bf16 v[84:87], v[244:247], v[208:211], v[84:87]
    s_waitcnt lgkmcnt(5)
    v_mfma_f32_16x16x32_bf16 v[16:19], v[168:171], v[160:163], v[16:19]
    ds_read_b128 v[204:207], v4 offset:36864
    v_mfma_f32_16x16x32_bf16 v[20:23], v[168:171], v[164:167], v[20:23]
    ds_read_b128 v[208:211], v4 offset:38912
    v_mfma_f32_16x16x32_bf16 v[24:27], v[172:175], v[160:163], v[24:27]
    ds_read_b128 v[212:215], v1 offset:46080
    v_mfma_f32_16x16x32_bf16 v[28:31], v[172:175], v[164:167], v[28:31]
    ds_read_b128 v[216:219], v1 offset:47104
    v_mfma_f32_16x16x32_bf16 v[32:35], v[176:179], v[160:163], v[32:35]
    ds_read_b128 v[220:223], v1 offset:48128
    v_mfma_f32_16x16x32_bf16 v[36:39], v[176:179], v[164:167], v[36:39]
    ds_read_b128 v[224:227], v1 offset:49152
    v_mfma_f32_16x16x32_bf16 v[40:43], v[180:183], v[160:163], v[40:43]
    ds_read_b128 v[228:231], v1 offset:50176
    v_mfma_f32_16x16x32_bf16 v[44:47], v[180:183], v[164:167], v[44:47]
    ds_read_b128 v[232:235], v1 offset:51200
    s_waitcnt lgkmcnt(8)
    v_mfma_f32_16x16x32_bf16 v[48:51], v[184:187], v[160:163], v[48:51]
    ds_read_b128 v[236:239], v1 offset:52224
    v_mfma_f32_16x16x32_bf16 v[52:55], v[184:187], v[164:167], v[52:55]
    ds_read_b128 v[240:243], v1 offset:53248
    v_mfma_f32_16x16x32_bf16 v[56:59], v[188:191], v[160:163], v[56:59]
    ds_read_b128 v[244:247], v1 offset:54272
    v_mfma_f32_16x16x32_bf16 v[60:63], v[188:191], v[164:167], v[60:63]
    v_mfma_f32_16x16x32_bf16 v[64:67], v[192:195], v[160:163], v[64:67]
    v_mfma_f32_16x16x32_bf16 v[68:71], v[192:195], v[164:167], v[68:71]
    v_mfma_f32_16x16x32_bf16 v[72:75], v[196:199], v[160:163], v[72:75]
    v_mfma_f32_16x16x32_bf16 v[76:79], v[196:199], v[164:167], v[76:79]
    v_mfma_f32_16x16x32_bf16 v[80:83], v[200:203], v[160:163], v[80:83]
    v_mfma_f32_16x16x32_bf16 v[84:87], v[200:203], v[164:167], v[84:87]
    s_waitcnt lgkmcnt(0)
    v_mfma_f32_16x16x32_bf16 v[16:19], v[212:215], v[204:207], v[16:19]
    v_mfma_f32_16x16x32_bf16 v[20:23], v[212:215], v[208:211], v[20:23]
    v_mfma_f32_16x16x32_bf16 v[24:27], v[216:219], v[204:207], v[24:27]
    v_mfma_f32_16x16x32_bf16 v[28:31], v[216:219], v[208:211], v[28:31]
    v_mfma_f32_16x16x32_bf16 v[32:35], v[220:223], v[204:207], v[32:35]
    v_mfma_f32_16x16x32_bf16 v[36:39], v[220:223], v[208:211], v[36:39]
    v_mfma_f32_16x16x32_bf16 v[40:43], v[224:227], v[204:207], v[40:43]
    v_mfma_f32_16x16x32_bf16 v[44:47], v[224:227], v[208:211], v[44:47]
    v_mfma_f32_16x16x32_bf16 v[48:51], v[228:231], v[204:207], v[48:51]
    v_mfma_f32_16x16x32_bf16 v[52:55], v[228:231], v[208:211], v[52:55]
    v_mfma_f32_16x16x32_bf16 v[56:59], v[232:235], v[204:207], v[56:59]
    v_mfma_f32_16x16x32_bf16 v[60:63], v[232:235], v[208:211], v[60:63]
    v_mfma_f32_16x16x32_bf16 v[64:67], v[236:239], v[204:207], v[64:67]
    v_mfma_f32_16x16x32_bf16 v[68:71], v[236:239], v[208:211], v[68:71]
    v_mfma_f32_16x16x32_bf16 v[72:75], v[240:243], v[204:207], v[72:75]
    v_mfma_f32_16x16x32_bf16 v[76:79], v[240:243], v[208:211], v[76:79]
    v_mfma_f32_16x16x32_bf16 v[80:83], v[244:247], v[204:207], v[80:83]
    v_mfma_f32_16x16x32_bf16 v[84:87], v[244:247], v[208:211], v[84:87]
    v_pk_mul_f32 v[16:17], v[16:17], v[88:89]
    v_pk_mul_f32 v[18:19], v[18:19], v[90:91]
    v_pk_mul_f32 v[24:25], v[24:25], v[96:97]
    v_pk_mul_f32 v[26:27], v[26:27], v[98:99]
    v_cvt_pk_bf16_f32 v160, v16, v17
    v_cvt_pk_bf16_f32 v161, v18, v19
    v_cvt_pk_bf16_f32 v162, v24, v25
    v_cvt_pk_bf16_f32 v163, v26, v27
    buffer_store_dwordx4 v[160:163], v14, s[4:7], s39 offen offset:0 sc1
    v_pk_mul_f32 v[20:21], v[20:21], v[92:93]
    v_pk_mul_f32 v[22:23], v[22:23], v[94:95]
    v_pk_mul_f32 v[28:29], v[28:29], v[100:101]
    v_pk_mul_f32 v[30:31], v[30:31], v[102:103]
    v_cvt_pk_bf16_f32 v164, v20, v21
    v_cvt_pk_bf16_f32 v165, v22, v23
    v_cvt_pk_bf16_f32 v166, v28, v29
    v_cvt_pk_bf16_f32 v167, v30, v31
    buffer_store_dwordx4 v[164:167], v14, s[4:7], s40 offen offset:0 sc1
    v_pk_mul_f32 v[32:33], v[32:33], v[104:105]
    v_pk_mul_f32 v[34:35], v[34:35], v[106:107]
    v_pk_mul_f32 v[40:41], v[40:41], v[112:113]
    v_pk_mul_f32 v[42:43], v[42:43], v[114:115]
    v_cvt_pk_bf16_f32 v168, v32, v33
    v_cvt_pk_bf16_f32 v169, v34, v35
    v_cvt_pk_bf16_f32 v170, v40, v41
    v_cvt_pk_bf16_f32 v171, v42, v43
    buffer_store_dwordx4 v[168:171], v14, s[4:7], s39 offen offset:1024 sc1
    v_pk_mul_f32 v[36:37], v[36:37], v[108:109]
    v_pk_mul_f32 v[38:39], v[38:39], v[110:111]
    v_pk_mul_f32 v[44:45], v[44:45], v[116:117]
    v_pk_mul_f32 v[46:47], v[46:47], v[118:119]
    v_cvt_pk_bf16_f32 v172, v36, v37
    v_cvt_pk_bf16_f32 v173, v38, v39
    v_cvt_pk_bf16_f32 v174, v44, v45
    v_cvt_pk_bf16_f32 v175, v46, v47
    buffer_store_dwordx4 v[172:175], v14, s[4:7], s40 offen offset:1024 sc1
    v_pk_mul_f32 v[48:49], v[48:49], v[120:121]
    v_pk_mul_f32 v[50:51], v[50:51], v[122:123]
    v_pk_mul_f32 v[56:57], v[56:57], v[128:129]
    v_pk_mul_f32 v[58:59], v[58:59], v[130:131]
    v_cvt_pk_bf16_f32 v176, v48, v49
    v_cvt_pk_bf16_f32 v177, v50, v51
    v_cvt_pk_bf16_f32 v178, v56, v57
    v_cvt_pk_bf16_f32 v179, v58, v59
    buffer_store_dwordx4 v[176:179], v14, s[4:7], s39 offen offset:2048 sc1
    v_pk_mul_f32 v[52:53], v[52:53], v[124:125]
    v_pk_mul_f32 v[54:55], v[54:55], v[126:127]
    v_pk_mul_f32 v[60:61], v[60:61], v[132:133]
    v_pk_mul_f32 v[62:63], v[62:63], v[134:135]
    v_cvt_pk_bf16_f32 v180, v52, v53
    v_cvt_pk_bf16_f32 v181, v54, v55
    v_cvt_pk_bf16_f32 v182, v60, v61
    v_cvt_pk_bf16_f32 v183, v62, v63
    buffer_store_dwordx4 v[180:183], v14, s[4:7], s40 offen offset:2048 sc1
    v_pk_mul_f32 v[64:65], v[64:65], v[136:137]
    v_pk_mul_f32 v[66:67], v[66:67], v[138:139]
    v_pk_mul_f32 v[72:73], v[72:73], v[144:145]
    v_pk_mul_f32 v[74:75], v[74:75], v[146:147]
    v_cvt_pk_bf16_f32 v184, v64, v65
    v_cvt_pk_bf16_f32 v185, v66, v67
    v_cvt_pk_bf16_f32 v186, v72, v73
    v_cvt_pk_bf16_f32 v187, v74, v75
    buffer_store_dwordx4 v[184:187], v14, s[4:7], s39 offen offset:3072 sc1
    v_pk_mul_f32 v[68:69], v[68:69], v[140:141]
    v_pk_mul_f32 v[70:71], v[70:71], v[142:143]
    v_pk_mul_f32 v[76:77], v[76:77], v[148:149]
    v_pk_mul_f32 v[78:79], v[78:79], v[150:151]
    v_cvt_pk_bf16_f32 v188, v68, v69
    v_cvt_pk_bf16_f32 v189, v70, v71
    v_cvt_pk_bf16_f32 v190, v76, v77
    v_cvt_pk_bf16_f32 v191, v78, v79
    buffer_store_dwordx4 v[188:191], v14, s[4:7], s40 offen offset:3072 sc1
    v_pk_mul_f32 v[80:81], v[80:81], v[152:153]
    v_pk_mul_f32 v[82:83], v[82:83], v[154:155]
    v_cvt_pk_bf16_f32 v192, v80, v81
    v_cvt_pk_bf16_f32 v193, v82, v83
    buffer_store_dwordx2 v[192:193], v15, s[4:7], s39 offen sc1
    v_pk_mul_f32 v[84:85], v[84:85], v[156:157]
    v_pk_mul_f32 v[86:87], v[86:87], v[158:159]
    v_cvt_pk_bf16_f32 v196, v84, v85
    v_cvt_pk_bf16_f32 v197, v86, v87
    buffer_store_dwordx2 v[196:197], v15, s[4:7], s40 offen sc1
    s_and_b32 s25, s2, 7
    s_lshr_b32 s26, s2, 3
    s_lshl_b32 s23, s25, 2
    s_lshr_b32 s27, s26, 3
    s_add_u32 s23, s23, s27
    s_and_b32 s24, s26, 7
    s_add_u32 s25, s23, s24
    s_and_b32 s25, s25, 3
    s_lshl_b32 s30, s23, 2
    s_add_u32 s30, s30, s20
    s_mul_i32 s29, s30, 73728
    s_add_u32 s29, s29, s21
    s_add_u32 s29, s29, 0x1200000
    s_mul_i32 s34, s30, 18432
    s_add_u32 s34, s34, s21
    s_add_u32 s34, s34, 0x300000
    s_lshl_b32 s35, s24, 11
    s_lshr_b32 s36, s24, 2
    s_lshl_b32 s36, s36, 10
    s_and_b32 s37, s24, 3
    s_lshl_b32 s37, s37, 8
    s_add_u32 s36, s36, s37
    s_add_u32 s36, s36, 16384
    v_bfe_u32 v2, v1, 4, 4
    v_lshrrev_b32 v3, 8, v1
    v_add_u32 v4, s35, v1
    v_lshlrev_b32 v5, 4, v2
    v_lshl_add_u32 v5, v3, 3, v5
    v_add_u32 v5, s36, v5
    v_cmp_gt_u32 s[40:41], 2, v3
    v_bfrev_b32 v6, 1
    v_add_u32 v12, 0, v1
    v_add_u32 v13, 36864, v1
    v_add_u32 v14, 73728, v1
    v_add_u32 v15, 110592, v1
    v_cndmask_b32 v5, v6, v5, s[40:41]
    buffer_load_dwordx4 v[208:211], v4, s[4:7], s34 offen offset:0 sc1
    buffer_load_dwordx4 v[212:215], v4, s[4:7], s34 offen offset:1024 sc1
    buffer_load_dwordx2 v[216:217], v5, s[4:7], s34 offen sc1
    s_add_u32 s34, s34, 0x1900000
    s_lshl_b32 s39, s30, 10
    s_add_u32 s39, s39, s21
    s_lshl_b32 s42, s24, 7
    s_add_u32 s39, s39, s42
    s_add_u32 s39, s39, 0x3700000
    v_cmp_eq_u32 vcc, 0, v3
    v_lshlrev_b32 v10, 3, v2
    v_mov_b32 v11, 0x3f803f80
    v_lshrrev_b32 v7, 1, v1
    v_cndmask_b32 v10, v6, v10, vcc
    s_cmp_eq_u32 s22, 0
    s_cbranch_scc1 L_p5_nf
    v_mul_u32_u24 v9, 1152, v2
    s_mul_i32 s34, s30, 18432
    s_mul_i32 s42, s24, 144
    s_add_u32 s34, s34, s42
    v_lshl_add_u32 v4, v3, 4, v9
    v_lshl_add_u32 v5, v3, 3, v9
    v_cndmask_b32 v5, v6, v5, s[40:41]
L_p5_nf:
    s_lshr_b32 s44, s23, 1
    s_lshl_b32 s52, s22, 7
    s_add_u32 s52, s52, s44
    s_lshl_b32 s52, s52, 8
    s_add_u32 s52, s52, 0x450a000
    s_add_u32 s52, s52, s4
    s_addc_u32 s53, s5, 0
    s_waitcnt vmcnt(0)
    s_barrier
    s_cmp_lg_u32 s20, 0
    s_cbranch_scc1 L_ns_d5
    s_mov_b32 s56, 1
    s_atomic_add s56, s[50:51], 0
L_ns_d5:
    v_lshlrev_b32 v16, 16, v208
    v_and_b32 v17, 0xffff0000, v208
    v_lshlrev_b32 v18, 16, v209
    v_and_b32 v19, 0xffff0000, v209
    v_lshlrev_b32 v20, 16, v210
    v_and_b32 v21, 0xffff0000, v210
    v_lshlrev_b32 v22, 16, v211
    v_and_b32 v23, 0xffff0000, v211
    v_lshlrev_b32 v24, 16, v212
    v_and_b32 v25, 0xffff0000, v212
    v_lshlrev_b32 v26, 16, v213
    v_and_b32 v27, 0xffff0000, v213
    v_lshlrev_b32 v28, 16, v214
    v_and_b32 v29, 0xffff0000, v214
    v_lshlrev_b32 v30, 16, v215
    v_and_b32 v31, 0xffff0000, v215
    v_lshlrev_b32 v32, 16, v216
    v_and_b32 v33, 0xffff0000, v216
    v_lshlrev_b32 v34, 16, v217
    v_and_b32 v35, 0xffff0000, v217
    s_cmp_lg_u32 s20, 0
    s_cbranch_scc1 L_pd_d5
    s_mov_b32 s60, 65536
L_poll_d5:
    s_mov_b32 s57, 0
    s_atomic_add s57, s[52:53], 0 glc
    s_waitcnt lgkmcnt(0)
    s_cmp_ge_u32 s57, 16
    s_cbranch_scc1 L_pd_d5
    s_sub_u32 s60, s60, 1
    s_cbranch_scc1 L_pd_d5
    s_sleep 2
    s_branch L_poll_d5
L_pd_d5:
    s_barrier
    s_cmp_eq_u32 s25, 0
    s_cselect_b32 s32, 4, 0
    s_lshl_b32 s32, s32, 13
    s_add_u32 s32, s32, s29
    s_add_u32 s33, s32, 4096
    buffer_load_dwordx4 v[112:115], v1, s[4:7], s32 offen offset:0 sc1
    buffer_load_dwordx4 v[116:119], v1, s[4:7], s32 offen offset:1024 sc1
    buffer_load_dwordx4 v[120:123], v1, s[4:7], s32 offen offset:2048 sc1
    buffer_load_dwordx4 v[124:127], v1, s[4:7], s32 offen offset:3072 sc1
    buffer_load_dwordx4 v[128:131], v1, s[4:7], s33 offen offset:0 sc1
    buffer_load_dwordx4 v[132:135], v1, s[4:7], s33 offen offset:1024 sc1
    buffer_load_dwordx4 v[136:139], v1, s[4:7], s33 offen offset:2048 sc1
    buffer_load_dwordx4 v[140:143], v1, s[4:7], s33 offen offset:3072 sc1
    ds_read_b128 v[40:43], v14 offset:0
    ds_read_b128 v[44:47], v14 offset:1024
    ds_read_b128 v[48:51], v14 offset:2048
    ds_read_b128 v[52:55], v14 offset:3072
    ds_read_b128 v[72:75], v14 offset:8192
    ds_read_b128 v[56:59], v14 offset:4096
    ds_read_b128 v[60:63], v14 offset:5120
    ds_read_b128 v[64:67], v14 offset:6144
    ds_read_b128 v[68:71], v14 offset:7168
    s_cmp_eq_u32 s25, 1
    s_cselect_b32 s32, 5, 1
    s_lshl_b32 s32, s32, 13
    s_add_u32 s32, s32, s29
    s_add_u32 s33, s32, 4096
    buffer_load_dwordx4 v[144:147], v1, s[4:7], s32 offen offset:0 sc1
    buffer_load_dwordx4 v[148:151], v1, s[4:7], s32 offen offset:1024 sc1
    buffer_load_dwordx4 v[152:155], v1, s[4:7], s32 offen offset:2048 sc1
    buffer_load_dwordx4 v[156:159], v1, s[4:7], s32 offen offset:3072 sc1
    buffer_load_dwordx4 v[160:163], v1, s[4:7], s33 offen offset:0 sc1
    buffer_load_dwordx4 v[164:167], v1, s[4:7], s33 offen offset:1024 sc1
    buffer_load_dwordx4 v[168:171], v1, s[4:7], s33 offen offset:2048 sc1
    buffer_load_dwordx4 v[172:175], v1, s[4:7], s33 offen offset:3072 sc1
    s_lshl_b32 s50, s22, 7
    s_add_u32 s50, s50, s44
    s_lshl_b32 s50, s50, 8
    s_add_u32 s50, s50, 0x450b000
    s_add_u32 s50, s50, s4
    s_addc_u32 s51, s5, 0
    s_waitcnt vmcnt(14) lgkmcnt(4)
    v_mfma_f32_16x16x32_bf16 v[16:19], v[40:43], v[112:115], v[16:19]
    ds_read_b128 v[76:79], v14 offset:9216
    s_cmp_eq_u32 s25, 2
    s_cselect_b32 s32, 6, 2
    s_lshl_b32 s32, s32, 13
    s_add_u32 s32, s32, s29
    s_add_u32 s33, s32, 4096
    v_mfma_f32_16x16x32_bf16 v[20:23], v[44:47], v[112:115], v[20:23]
    ds_read_b128 v[80:83], v14 offset:10240
    v_mfma_f32_16x16x32_bf16 v[24:27], v[48:51], v[112:115], v[24:27]
    ds_read_b128 v[84:87], v14 offset:11264
    buffer_load_dwordx4 v[176:179], v1, s[4:7], s32 offen offset:0 sc1
    v_mfma_f32_16x16x32_bf16 v[28:31], v[52:55], v[112:115], v[28:31]
    ds_read_b128 v[88:91], v14 offset:12288
    v_mfma_f32_16x16x32_bf16 v[32:35], v[72:75], v[112:115], v[32:35]
    ds_read_b128 v[108:111], v14 offset:17408
    s_waitcnt lgkmcnt(5)
    v_mfma_f32_16x16x32_bf16 v[16:19], v[56:59], v[116:119], v[16:19]
    ds_read_b128 v[92:95], v14 offset:13312
    v_mfma_f32_16x16x32_bf16 v[20:23], v[60:63], v[116:119], v[20:23]
    ds_read_b128 v[96:99], v14 offset:14336
    buffer_load_dwordx4 v[180:183], v1, s[4:7], s32 offen offset:1024 sc1
    v_mfma_f32_16x16x32_bf16 v[24:27], v[64:67], v[116:119], v[24:27]
    ds_read_b128 v[100:103], v14 offset:15360
    v_mfma_f32_16x16x32_bf16 v[28:31], v[68:71], v[116:119], v[28:31]
    ds_read_b128 v[104:107], v14 offset:16384
    v_mfma_f32_16x16x32_bf16 v[36:39], v[72:75], v[116:119], 0
    s_waitcnt vmcnt(14) lgkmcnt(4)
    v_mfma_f32_16x16x32_bf16 v[16:19], v[76:79], v[120:123], v[16:19]
    ds_read_b128 v[40:43], v14 offset:18432
    v_mfma_f32_16x16x32_bf16 v[20:23], v[80:83], v[120:123], v[20:23]
    ds_read_b128 v[44:47], v14 offset:19456
    v_mfma_f32_16x16x32_bf16 v[24:27], v[84:87], v[120:123], v[24:27]
    ds_read_b128 v[48:51], v14 offset:20480
    buffer_load_dwordx4 v[184:187], v1, s[4:7], s32 offen offset:2048 sc1
    v_mfma_f32_16x16x32_bf16 v[28:31], v[88:91], v[120:123], v[28:31]
    ds_read_b128 v[52:55], v14 offset:21504
    v_mfma_f32_16x16x32_bf16 v[32:35], v[108:111], v[120:123], v[32:35]
    ds_read_b128 v[72:75], v14 offset:26624
    s_waitcnt lgkmcnt(5)
    v_mfma_f32_16x16x32_bf16 v[16:19], v[92:95], v[124:127], v[16:19]
    ds_read_b128 v[56:59], v14 offset:22528
    v_mfma_f32_16x16x32_bf16 v[20:23], v[96:99], v[124:127], v[20:23]
    ds_read_b128 v[60:63], v14 offset:23552
    buffer_load_dwordx4 v[188:191], v1, s[4:7], s32 offen offset:3072 sc1
    v_mfma_f32_16x16x32_bf16 v[24:27], v[100:103], v[124:127], v[24:27]
    ds_read_b128 v[64:67], v14 offset:24576
    v_mfma_f32_16x16x32_bf16 v[28:31], v[104:107], v[124:127], v[28:31]
    ds_read_b128 v[68:71], v14 offset:25600
    v_mfma_f32_16x16x32_bf16 v[36:39], v[108:111], v[124:127], v[36:39]
    s_waitcnt vmcnt(14) lgkmcnt(4)
    v_mfma_f32_16x16x32_bf16 v[16:19], v[40:43], v[128:131], v[16:19]
    ds_read_b128 v[76:79], v14 offset:27648
    v_mfma_f32_16x16x32_bf16 v[20:23], v[44:47], v[128:131], v[20:23]
    ds_read_b128 v[80:83], v14 offset:28672
    v_mfma_f32_16x16x32_bf16 v[24:27], v[48:51], v[128:131], v[24:27]
    ds_read_b128 v[84:87], v14 offset:29696
    buffer_load_dwordx4 v[192:195], v1, s[4:7], s33 offen offset:0 sc1
    v_mfma_f32_16x16x32_bf16 v[28:31], v[52:55], v[128:131], v[28:31]
    ds_read_b128 v[88:91], v14 offset:30720
    v_mfma_f32_16x16x32_bf16 v[32:35], v[72:75], v[128:131], v[32:35]
    ds_read_b128 v[108:111], v14 offset:35840
    s_waitcnt lgkmcnt(5)
    v_mfma_f32_16x16x32_bf16 v[16:19], v[56:59], v[132:135], v[16:19]
    ds_read_b128 v[92:95], v14 offset:31744
    v_mfma_f32_16x16x32_bf16 v[20:23], v[60:63], v[132:135], v[20:23]
    ds_read_b128 v[96:99], v14 offset:32768
    buffer_load_dwordx4 v[196:199], v1, s[4:7], s33 offen offset:1024 sc1
    v_mfma_f32_16x16x32_bf16 v[24:27], v[64:67], v[132:135], v[24:27]
    ds_read_b128 v[100:103], v14 offset:33792
    v_mfma_f32_16x16x32_bf16 v[28:31], v[68:71], v[132:135], v[28:31]
    ds_read_b128 v[104:107], v14 offset:34816
    v_mfma_f32_16x16x32_bf16 v[36:39], v[72:75], v[132:135], v[36:39]
    s_waitcnt vmcnt(14) lgkmcnt(0)
    s_barrier
    v_mfma_f32_16x16x32_bf16 v[16:19], v[76:79], v[136:139], v[16:19]
    ds_read_b128 v[40:43], v15 offset:0
    v_mfma_f32_16x16x32_bf16 v[20:23], v[80:83], v[136:139], v[20:23]
    ds_read_b128 v[44:47], v15 offset:1024
    v_mfma_f32_16x16x32_bf16 v[24:27], v[84:87], v[136:139], v[24:27]
    ds_read_b128 v[48:51], v15 offset:2048
    buffer_load_dwordx4 v[200:203], v1, s[4:7], s33 offen offset:2048 sc1
    v_mfma_f32_16x16x32_bf16 v[28:31], v[88:91], v[136:139], v[28:31]
    ds_read_b128 v[52:55], v15 offset:3072
    v_mfma_f32_16x16x32_bf16 v[32:35], v[108:111], v[136:139], v[32:35]
    ds_read_b128 v[72:75], v15 offset:8192
    v_mfma_f32_16x16x32_bf16 v[16:19], v[92:95], v[140:143], v[16:19]
    ds_read_b128 v[56:59], v15 offset:4096
    v_mfma_f32_16x16x32_bf16 v[20:23], v[96:99], v[140:143], v[20:23]
    ds_read_b128 v[60:63], v15 offset:5120
    buffer_load_dwordx4 v[204:207], v1, s[4:7], s33 offen offset:3072 sc1
    v_mfma_f32_16x16x32_bf16 v[24:27], v[100:103], v[140:143], v[24:27]
    ds_read_b128 v[64:67], v15 offset:6144
    v_mfma_f32_16x16x32_bf16 v[28:31], v[104:107], v[140:143], v[28:31]
    ds_read_b128 v[68:71], v15 offset:7168
    v_mfma_f32_16x16x32_bf16 v[36:39], v[108:111], v[140:143], v[36:39]
    s_waitcnt vmcnt(14) lgkmcnt(4)
    v_mfma_f32_16x16x32_bf16 v[16:19], v[40:43], v[144:147], v[16:19]
    ds_read_b128 v[76:79], v15 offset:9216
    s_cmp_eq_u32 s25, 3
    s_cselect_b32 s32, 7, 3
    s_lshl_b32 s32, s32, 13
    s_add_u32 s32, s32, s29
    s_add_u32 s33, s32, 4096
    v_mfma_f32_16x16x32_bf16 v[20:23], v[44:47], v[144:147], v[20:23]
    ds_read_b128 v[80:83], v15 offset:10240
    v_mfma_f32_16x16x32_bf16 v[24:27], v[48:51], v[144:147], v[24:27]
    ds_read_b128 v[84:87], v15 offset:11264
    buffer_load_dwordx4 v[112:115], v1, s[4:7], s32 offen offset:0 sc1
    v_mfma_f32_16x16x32_bf16 v[28:31], v[52:55], v[144:147], v[28:31]
    ds_read_b128 v[88:91], v15 offset:12288
    v_mfma_f32_16x16x32_bf16 v[32:35], v[72:75], v[144:147], v[32:35]
    ds_read_b128 v[108:111], v15 offset:17408
    s_waitcnt lgkmcnt(5)
    v_mfma_f32_16x16x32_bf16 v[16:19], v[56:59], v[148:151], v[16:19]
    ds_read_b128 v[92:95], v15 offset:13312
    v_mfma_f32_16x16x32_bf16 v[20:23], v[60:63], v[148:151], v[20:23]
    ds_read_b128 v[96:99], v15 offset:14336
    buffer_load_dwordx4 v[116:119], v1, s[4:7], s32 offen offset:1024 sc1
    v_mfma_f32_16x16x32_bf16 v[24:27], v[64:67], v[148:151], v[24:27]
    ds_read_b128 v[100:103], v15 offset:15360
    v_mfma_f32_16x16x32_bf16 v[28:31], v[68:71], v[148:151], v[28:31]
    ds_read_b128 v[104:107], v15 offset:16384
    v_mfma_f32_16x16x32_bf16 v[36:39], v[72:75], v[148:151], v[36:39]
    s_waitcnt vmcnt(14) lgkmcnt(4)
    v_mfma_f32_16x16x32_bf16 v[16:19], v[76:79], v[152:155], v[16:19]
    ds_read_b128 v[40:43], v15 offset:18432
    v_mfma_f32_16x16x32_bf16 v[20:23], v[80:83], v[152:155], v[20:23]
    ds_read_b128 v[44:47], v15 offset:19456
    v_mfma_f32_16x16x32_bf16 v[24:27], v[84:87], v[152:155], v[24:27]
    ds_read_b128 v[48:51], v15 offset:20480
    buffer_load_dwordx4 v[120:123], v1, s[4:7], s32 offen offset:2048 sc1
    v_mfma_f32_16x16x32_bf16 v[28:31], v[88:91], v[152:155], v[28:31]
    ds_read_b128 v[52:55], v15 offset:21504
    v_mfma_f32_16x16x32_bf16 v[32:35], v[108:111], v[152:155], v[32:35]
    ds_read_b128 v[72:75], v15 offset:26624
    s_waitcnt lgkmcnt(5)
    v_mfma_f32_16x16x32_bf16 v[16:19], v[92:95], v[156:159], v[16:19]
    ds_read_b128 v[56:59], v15 offset:22528
    v_mfma_f32_16x16x32_bf16 v[20:23], v[96:99], v[156:159], v[20:23]
    ds_read_b128 v[60:63], v15 offset:23552
    buffer_load_dwordx4 v[124:127], v1, s[4:7], s32 offen offset:3072 sc1
    v_mfma_f32_16x16x32_bf16 v[24:27], v[100:103], v[156:159], v[24:27]
    ds_read_b128 v[64:67], v15 offset:24576
    v_mfma_f32_16x16x32_bf16 v[28:31], v[104:107], v[156:159], v[28:31]
    ds_read_b128 v[68:71], v15 offset:25600
    v_mfma_f32_16x16x32_bf16 v[36:39], v[108:111], v[156:159], v[36:39]
    s_waitcnt vmcnt(14) lgkmcnt(4)
    v_mfma_f32_16x16x32_bf16 v[16:19], v[40:43], v[160:163], v[16:19]
    ds_read_b128 v[76:79], v15 offset:27648
    v_mfma_f32_16x16x32_bf16 v[20:23], v[44:47], v[160:163], v[20:23]
    ds_read_b128 v[80:83], v15 offset:28672
    v_mfma_f32_16x16x32_bf16 v[24:27], v[48:51], v[160:163], v[24:27]
    ds_read_b128 v[84:87], v15 offset:29696
    buffer_load_dwordx4 v[128:131], v1, s[4:7], s33 offen offset:0 sc1
    v_mfma_f32_16x16x32_bf16 v[28:31], v[52:55], v[160:163], v[28:31]
    ds_read_b128 v[88:91], v15 offset:30720
    v_mfma_f32_16x16x32_bf16 v[32:35], v[72:75], v[160:163], v[32:35]
    ds_read_b128 v[108:111], v15 offset:35840
    s_waitcnt lgkmcnt(5)
    v_mfma_f32_16x16x32_bf16 v[16:19], v[56:59], v[164:167], v[16:19]
    ds_read_b128 v[92:95], v15 offset:31744
    v_mfma_f32_16x16x32_bf16 v[20:23], v[60:63], v[164:167], v[20:23]
    ds_read_b128 v[96:99], v15 offset:32768
    buffer_load_dwordx4 v[132:135], v1, s[4:7], s33 offen offset:1024 sc1
    v_mfma_f32_16x16x32_bf16 v[24:27], v[64:67], v[164:167], v[24:27]
    ds_read_b128 v[100:103], v15 offset:33792
    v_mfma_f32_16x16x32_bf16 v[28:31], v[68:71], v[164:167], v[28:31]
    ds_read_b128 v[104:107], v15 offset:34816
    v_mfma_f32_16x16x32_bf16 v[36:39], v[72:75], v[164:167], v[36:39]
    s_waitcnt vmcnt(14) lgkmcnt(0)
    s_barrier
    v_mfma_f32_16x16x32_bf16 v[16:19], v[76:79], v[168:171], v[16:19]
    ds_read_b128 v[40:43], v12 offset:0
    v_mfma_f32_16x16x32_bf16 v[20:23], v[80:83], v[168:171], v[20:23]
    ds_read_b128 v[44:47], v12 offset:1024
    v_mfma_f32_16x16x32_bf16 v[24:27], v[84:87], v[168:171], v[24:27]
    ds_read_b128 v[48:51], v12 offset:2048
    buffer_load_dwordx4 v[136:139], v1, s[4:7], s33 offen offset:2048 sc1
    v_mfma_f32_16x16x32_bf16 v[28:31], v[88:91], v[168:171], v[28:31]
    ds_read_b128 v[52:55], v12 offset:3072
    v_mfma_f32_16x16x32_bf16 v[32:35], v[108:111], v[168:171], v[32:35]
    ds_read_b128 v[72:75], v12 offset:8192
    v_mfma_f32_16x16x32_bf16 v[16:19], v[92:95], v[172:175], v[16:19]
    ds_read_b128 v[56:59], v12 offset:4096
    v_mfma_f32_16x16x32_bf16 v[20:23], v[96:99], v[172:175], v[20:23]
    ds_read_b128 v[60:63], v12 offset:5120
    buffer_load_dwordx4 v[140:143], v1, s[4:7], s33 offen offset:3072 sc1
    v_mfma_f32_16x16x32_bf16 v[24:27], v[100:103], v[172:175], v[24:27]
    ds_read_b128 v[64:67], v12 offset:6144
    v_mfma_f32_16x16x32_bf16 v[28:31], v[104:107], v[172:175], v[28:31]
    ds_read_b128 v[68:71], v12 offset:7168
    v_mfma_f32_16x16x32_bf16 v[36:39], v[108:111], v[172:175], v[36:39]
    s_waitcnt vmcnt(14) lgkmcnt(4)
    v_mfma_f32_16x16x32_bf16 v[16:19], v[40:43], v[176:179], v[16:19]
    ds_read_b128 v[76:79], v12 offset:9216
    s_cmp_eq_u32 s25, 0
    s_cselect_b32 s32, 0, 4
    s_lshl_b32 s32, s32, 13
    s_add_u32 s32, s32, s29
    s_add_u32 s33, s32, 4096
    v_mfma_f32_16x16x32_bf16 v[20:23], v[44:47], v[176:179], v[20:23]
    ds_read_b128 v[80:83], v12 offset:10240
    v_mfma_f32_16x16x32_bf16 v[24:27], v[48:51], v[176:179], v[24:27]
    ds_read_b128 v[84:87], v12 offset:11264
    buffer_load_dwordx4 v[144:147], v1, s[4:7], s32 offen offset:0 sc1
    v_mfma_f32_16x16x32_bf16 v[28:31], v[52:55], v[176:179], v[28:31]
    ds_read_b128 v[88:91], v12 offset:12288
    v_mfma_f32_16x16x32_bf16 v[32:35], v[72:75], v[176:179], v[32:35]
    ds_read_b128 v[108:111], v12 offset:17408
    s_waitcnt lgkmcnt(5)
    v_mfma_f32_16x16x32_bf16 v[16:19], v[56:59], v[180:183], v[16:19]
    ds_read_b128 v[92:95], v12 offset:13312
    v_mfma_f32_16x16x32_bf16 v[20:23], v[60:63], v[180:183], v[20:23]
    ds_read_b128 v[96:99], v12 offset:14336
    buffer_load_dwordx4 v[148:151], v1, s[4:7], s32 offen offset:1024 sc1
    v_mfma_f32_16x16x32_bf16 v[24:27], v[64:67], v[180:183], v[24:27]
    ds_read_b128 v[100:103], v12 offset:15360
    v_mfma_f32_16x16x32_bf16 v[28:31], v[68:71], v[180:183], v[28:31]
    ds_read_b128 v[104:107], v12 offset:16384
    v_mfma_f32_16x16x32_bf16 v[36:39], v[72:75], v[180:183], v[36:39]
    s_waitcnt vmcnt(14) lgkmcnt(4)
    v_mfma_f32_16x16x32_bf16 v[16:19], v[76:79], v[184:187], v[16:19]
    ds_read_b128 v[40:43], v12 offset:18432
    v_mfma_f32_16x16x32_bf16 v[20:23], v[80:83], v[184:187], v[20:23]
    ds_read_b128 v[44:47], v12 offset:19456
    v_mfma_f32_16x16x32_bf16 v[24:27], v[84:87], v[184:187], v[24:27]
    ds_read_b128 v[48:51], v12 offset:20480
    buffer_load_dwordx4 v[152:155], v1, s[4:7], s32 offen offset:2048 sc1
    v_mfma_f32_16x16x32_bf16 v[28:31], v[88:91], v[184:187], v[28:31]
    ds_read_b128 v[52:55], v12 offset:21504
    v_mfma_f32_16x16x32_bf16 v[32:35], v[108:111], v[184:187], v[32:35]
    ds_read_b128 v[72:75], v12 offset:26624
    s_waitcnt lgkmcnt(5)
    v_mfma_f32_16x16x32_bf16 v[16:19], v[92:95], v[188:191], v[16:19]
    ds_read_b128 v[56:59], v12 offset:22528
    v_mfma_f32_16x16x32_bf16 v[20:23], v[96:99], v[188:191], v[20:23]
    ds_read_b128 v[60:63], v12 offset:23552
    buffer_load_dwordx4 v[156:159], v1, s[4:7], s32 offen offset:3072 sc1
    v_mfma_f32_16x16x32_bf16 v[24:27], v[100:103], v[188:191], v[24:27]
    ds_read_b128 v[64:67], v12 offset:24576
    v_mfma_f32_16x16x32_bf16 v[28:31], v[104:107], v[188:191], v[28:31]
    ds_read_b128 v[68:71], v12 offset:25600
    v_mfma_f32_16x16x32_bf16 v[36:39], v[108:111], v[188:191], v[36:39]
    s_waitcnt vmcnt(14) lgkmcnt(4)
    v_mfma_f32_16x16x32_bf16 v[16:19], v[40:43], v[192:195], v[16:19]
    ds_read_b128 v[76:79], v12 offset:27648
    v_mfma_f32_16x16x32_bf16 v[20:23], v[44:47], v[192:195], v[20:23]
    ds_read_b128 v[80:83], v12 offset:28672
    v_mfma_f32_16x16x32_bf16 v[24:27], v[48:51], v[192:195], v[24:27]
    ds_read_b128 v[84:87], v12 offset:29696
    buffer_load_dwordx4 v[160:163], v1, s[4:7], s33 offen offset:0 sc1
    v_mfma_f32_16x16x32_bf16 v[28:31], v[52:55], v[192:195], v[28:31]
    ds_read_b128 v[88:91], v12 offset:30720
    v_mfma_f32_16x16x32_bf16 v[32:35], v[72:75], v[192:195], v[32:35]
    ds_read_b128 v[108:111], v12 offset:35840
    s_waitcnt lgkmcnt(5)
    v_mfma_f32_16x16x32_bf16 v[16:19], v[56:59], v[196:199], v[16:19]
    ds_read_b128 v[92:95], v12 offset:31744
    v_mfma_f32_16x16x32_bf16 v[20:23], v[60:63], v[196:199], v[20:23]
    ds_read_b128 v[96:99], v12 offset:32768
    buffer_load_dwordx4 v[164:167], v1, s[4:7], s33 offen offset:1024 sc1
    v_mfma_f32_16x16x32_bf16 v[24:27], v[64:67], v[196:199], v[24:27]
    ds_read_b128 v[100:103], v12 offset:33792
    v_mfma_f32_16x16x32_bf16 v[28:31], v[68:71], v[196:199], v[28:31]
    ds_read_b128 v[104:107], v12 offset:34816
    v_mfma_f32_16x16x32_bf16 v[36:39], v[72:75], v[196:199], v[36:39]
    s_waitcnt vmcnt(14) lgkmcnt(0)
    s_barrier
    v_mfma_f32_16x16x32_bf16 v[16:19], v[76:79], v[200:203], v[16:19]
    ds_read_b128 v[40:43], v13 offset:0
    v_mfma_f32_16x16x32_bf16 v[20:23], v[80:83], v[200:203], v[20:23]
    ds_read_b128 v[44:47], v13 offset:1024
    v_mfma_f32_16x16x32_bf16 v[24:27], v[84:87], v[200:203], v[24:27]
    ds_read_b128 v[48:51], v13 offset:2048
    buffer_load_dwordx4 v[168:171], v1, s[4:7], s33 offen offset:2048 sc1
    v_mfma_f32_16x16x32_bf16 v[28:31], v[88:91], v[200:203], v[28:31]
    ds_read_b128 v[52:55], v13 offset:3072
    v_mfma_f32_16x16x32_bf16 v[32:35], v[108:111], v[200:203], v[32:35]
    ds_read_b128 v[72:75], v13 offset:8192
    v_mfma_f32_16x16x32_bf16 v[16:19], v[92:95], v[204:207], v[16:19]
    ds_read_b128 v[56:59], v13 offset:4096
    v_mfma_f32_16x16x32_bf16 v[20:23], v[96:99], v[204:207], v[20:23]
    ds_read_b128 v[60:63], v13 offset:5120
    buffer_load_dwordx4 v[172:175], v1, s[4:7], s33 offen offset:3072 sc1
    v_mfma_f32_16x16x32_bf16 v[24:27], v[100:103], v[204:207], v[24:27]
    ds_read_b128 v[64:67], v13 offset:6144
    v_mfma_f32_16x16x32_bf16 v[28:31], v[104:107], v[204:207], v[28:31]
    ds_read_b128 v[68:71], v13 offset:7168
    v_mfma_f32_16x16x32_bf16 v[36:39], v[108:111], v[204:207], v[36:39]
    s_waitcnt vmcnt(14) lgkmcnt(4)
    v_mfma_f32_16x16x32_bf16 v[16:19], v[40:43], v[112:115], v[16:19]
    ds_read_b128 v[76:79], v13 offset:9216
    s_cmp_eq_u32 s25, 1
    s_cselect_b32 s32, 1, 5
    s_lshl_b32 s32, s32, 13
    s_add_u32 s32, s32, s29
    s_add_u32 s33, s32, 4096
    v_mfma_f32_16x16x32_bf16 v[20:23], v[44:47], v[112:115], v[20:23]
    ds_read_b128 v[80:83], v13 offset:10240
    v_mfma_f32_16x16x32_bf16 v[24:27], v[48:51], v[112:115], v[24:27]
    ds_read_b128 v[84:87], v13 offset:11264
    buffer_load_dwordx4 v[176:179], v1, s[4:7], s32 offen offset:0 sc1
    v_mfma_f32_16x16x32_bf16 v[28:31], v[52:55], v[112:115], v[28:31]
    ds_read_b128 v[88:91], v13 offset:12288
    v_mfma_f32_16x16x32_bf16 v[32:35], v[72:75], v[112:115], v[32:35]
    ds_read_b128 v[108:111], v13 offset:17408
    s_waitcnt lgkmcnt(5)
    v_mfma_f32_16x16x32_bf16 v[16:19], v[56:59], v[116:119], v[16:19]
    ds_read_b128 v[92:95], v13 offset:13312
    v_mfma_f32_16x16x32_bf16 v[20:23], v[60:63], v[116:119], v[20:23]
    ds_read_b128 v[96:99], v13 offset:14336
    buffer_load_dwordx4 v[180:183], v1, s[4:7], s32 offen offset:1024 sc1
    v_mfma_f32_16x16x32_bf16 v[24:27], v[64:67], v[116:119], v[24:27]
    ds_read_b128 v[100:103], v13 offset:15360
    v_mfma_f32_16x16x32_bf16 v[28:31], v[68:71], v[116:119], v[28:31]
    ds_read_b128 v[104:107], v13 offset:16384
    v_mfma_f32_16x16x32_bf16 v[36:39], v[72:75], v[116:119], v[36:39]
    s_waitcnt vmcnt(14) lgkmcnt(4)
    v_mfma_f32_16x16x32_bf16 v[16:19], v[76:79], v[120:123], v[16:19]
    ds_read_b128 v[40:43], v13 offset:18432
    v_mfma_f32_16x16x32_bf16 v[20:23], v[80:83], v[120:123], v[20:23]
    ds_read_b128 v[44:47], v13 offset:19456
    v_mfma_f32_16x16x32_bf16 v[24:27], v[84:87], v[120:123], v[24:27]
    ds_read_b128 v[48:51], v13 offset:20480
    buffer_load_dwordx4 v[184:187], v1, s[4:7], s32 offen offset:2048 sc1
    v_mfma_f32_16x16x32_bf16 v[28:31], v[88:91], v[120:123], v[28:31]
    ds_read_b128 v[52:55], v13 offset:21504
    v_mfma_f32_16x16x32_bf16 v[32:35], v[108:111], v[120:123], v[32:35]
    ds_read_b128 v[72:75], v13 offset:26624
    s_waitcnt lgkmcnt(5)
    v_mfma_f32_16x16x32_bf16 v[16:19], v[92:95], v[124:127], v[16:19]
    ds_read_b128 v[56:59], v13 offset:22528
    v_mfma_f32_16x16x32_bf16 v[20:23], v[96:99], v[124:127], v[20:23]
    ds_read_b128 v[60:63], v13 offset:23552
    buffer_load_dwordx4 v[188:191], v1, s[4:7], s32 offen offset:3072 sc1
    v_mfma_f32_16x16x32_bf16 v[24:27], v[100:103], v[124:127], v[24:27]
    ds_read_b128 v[64:67], v13 offset:24576
    v_mfma_f32_16x16x32_bf16 v[28:31], v[104:107], v[124:127], v[28:31]
    ds_read_b128 v[68:71], v13 offset:25600
    v_mfma_f32_16x16x32_bf16 v[36:39], v[108:111], v[124:127], v[36:39]
    s_waitcnt vmcnt(14) lgkmcnt(4)
    v_mfma_f32_16x16x32_bf16 v[16:19], v[40:43], v[128:131], v[16:19]
    ds_read_b128 v[76:79], v13 offset:27648
    v_mfma_f32_16x16x32_bf16 v[20:23], v[44:47], v[128:131], v[20:23]
    ds_read_b128 v[80:83], v13 offset:28672
    v_mfma_f32_16x16x32_bf16 v[24:27], v[48:51], v[128:131], v[24:27]
    ds_read_b128 v[84:87], v13 offset:29696
    buffer_load_dwordx4 v[192:195], v1, s[4:7], s33 offen offset:0 sc1
    v_mfma_f32_16x16x32_bf16 v[28:31], v[52:55], v[128:131], v[28:31]
    ds_read_b128 v[88:91], v13 offset:30720
    v_mfma_f32_16x16x32_bf16 v[32:35], v[72:75], v[128:131], v[32:35]
    ds_read_b128 v[108:111], v13 offset:35840
    s_waitcnt lgkmcnt(5)
    v_mfma_f32_16x16x32_bf16 v[16:19], v[56:59], v[132:135], v[16:19]
    ds_read_b128 v[92:95], v13 offset:31744
    v_mfma_f32_16x16x32_bf16 v[20:23], v[60:63], v[132:135], v[20:23]
    ds_read_b128 v[96:99], v13 offset:32768
    buffer_load_dwordx4 v[196:199], v1, s[4:7], s33 offen offset:1024 sc1
    v_mfma_f32_16x16x32_bf16 v[24:27], v[64:67], v[132:135], v[24:27]
    ds_read_b128 v[100:103], v13 offset:33792
    v_mfma_f32_16x16x32_bf16 v[28:31], v[68:71], v[132:135], v[28:31]
    ds_read_b128 v[104:107], v13 offset:34816
    v_mfma_f32_16x16x32_bf16 v[36:39], v[72:75], v[132:135], v[36:39]
    s_waitcnt vmcnt(14) lgkmcnt(0)
    s_barrier
    v_mfma_f32_16x16x32_bf16 v[16:19], v[76:79], v[136:139], v[16:19]
    ds_read_b128 v[40:43], v14 offset:0
    v_mfma_f32_16x16x32_bf16 v[20:23], v[80:83], v[136:139], v[20:23]
    ds_read_b128 v[44:47], v14 offset:1024
    v_mfma_f32_16x16x32_bf16 v[24:27], v[84:87], v[136:139], v[24:27]
    ds_read_b128 v[48:51], v14 offset:2048
    buffer_load_dwordx4 v[200:203], v1, s[4:7], s33 offen offset:2048 sc1
    v_mfma_f32_16x16x32_bf16 v[28:31], v[88:91], v[136:139], v[28:31]
    ds_read_b128 v[52:55], v14 offset:3072
    v_mfma_f32_16x16x32_bf16 v[32:35], v[108:111], v[136:139], v[32:35]
    ds_read_b128 v[72:75], v14 offset:8192
    v_mfma_f32_16x16x32_bf16 v[16:19], v[92:95], v[140:143], v[16:19]
    ds_read_b128 v[56:59], v14 offset:4096
    v_mfma_f32_16x16x32_bf16 v[20:23], v[96:99], v[140:143], v[20:23]
    ds_read_b128 v[60:63], v14 offset:5120
    buffer_load_dwordx4 v[204:207], v1, s[4:7], s33 offen offset:3072 sc1
    v_mfma_f32_16x16x32_bf16 v[24:27], v[100:103], v[140:143], v[24:27]
    ds_read_b128 v[64:67], v14 offset:6144
    v_mfma_f32_16x16x32_bf16 v[28:31], v[104:107], v[140:143], v[28:31]
    ds_read_b128 v[68:71], v14 offset:7168
    v_mfma_f32_16x16x32_bf16 v[36:39], v[108:111], v[140:143], v[36:39]
    s_waitcnt vmcnt(14) lgkmcnt(4)
    v_mfma_f32_16x16x32_bf16 v[16:19], v[40:43], v[144:147], v[16:19]
    ds_read_b128 v[76:79], v14 offset:9216
    s_cmp_eq_u32 s25, 2
    s_cselect_b32 s32, 2, 6
    s_lshl_b32 s32, s32, 13
    s_add_u32 s32, s32, s29
    s_add_u32 s33, s32, 4096
    v_mfma_f32_16x16x32_bf16 v[20:23], v[44:47], v[144:147], v[20:23]
    ds_read_b128 v[80:83], v14 offset:10240
    v_mfma_f32_16x16x32_bf16 v[24:27], v[48:51], v[144:147], v[24:27]
    ds_read_b128 v[84:87], v14 offset:11264
    buffer_load_dwordx4 v[112:115], v1, s[4:7], s32 offen offset:0 sc1
    v_mfma_f32_16x16x32_bf16 v[28:31], v[52:55], v[144:147], v[28:31]
    ds_read_b128 v[88:91], v14 offset:12288
    v_mfma_f32_16x16x32_bf16 v[32:35], v[72:75], v[144:147], v[32:35]
    ds_read_b128 v[108:111], v14 offset:17408
    s_waitcnt lgkmcnt(5)
    v_mfma_f32_16x16x32_bf16 v[16:19], v[56:59], v[148:151], v[16:19]
    ds_read_b128 v[92:95], v14 offset:13312
    v_mfma_f32_16x16x32_bf16 v[20:23], v[60:63], v[148:151], v[20:23]
    ds_read_b128 v[96:99], v14 offset:14336
    buffer_load_dwordx4 v[116:119], v1, s[4:7], s32 offen offset:1024 sc1
    v_mfma_f32_16x16x32_bf16 v[24:27], v[64:67], v[148:151], v[24:27]
    ds_read_b128 v[100:103], v14 offset:15360
    v_mfma_f32_16x16x32_bf16 v[28:31], v[68:71], v[148:151], v[28:31]
    ds_read_b128 v[104:107], v14 offset:16384
    v_mfma_f32_16x16x32_bf16 v[36:39], v[72:75], v[148:151], v[36:39]
    s_waitcnt vmcnt(14) lgkmcnt(4)
    v_mfma_f32_16x16x32_bf16 v[16:19], v[76:79], v[152:155], v[16:19]
    ds_read_b128 v[40:43], v14 offset:18432
    v_mfma_f32_16x16x32_bf16 v[20:23], v[80:83], v[152:155], v[20:23]
    ds_read_b128 v[44:47], v14 offset:19456
    v_mfma_f32_16x16x32_bf16 v[24:27], v[84:87], v[152:155], v[24:27]
    ds_read_b128 v[48:51], v14 offset:20480
    buffer_load_dwordx4 v[120:123], v1, s[4:7], s32 offen offset:2048 sc1
    v_mfma_f32_16x16x32_bf16 v[28:31], v[88:91], v[152:155], v[28:31]
    ds_read_b128 v[52:55], v14 offset:21504
    v_mfma_f32_16x16x32_bf16 v[32:35], v[108:111], v[152:155], v[32:35]
    ds_read_b128 v[72:75], v14 offset:26624
    s_waitcnt lgkmcnt(5)
    v_mfma_f32_16x16x32_bf16 v[16:19], v[92:95], v[156:159], v[16:19]
    ds_read_b128 v[56:59], v14 offset:22528
    v_mfma_f32_16x16x32_bf16 v[20:23], v[96:99], v[156:159], v[20:23]
    ds_read_b128 v[60:63], v14 offset:23552
    buffer_load_dwordx4 v[124:127], v1, s[4:7], s32 offen offset:3072 sc1
    v_mfma_f32_16x16x32_bf16 v[24:27], v[100:103], v[156:159], v[24:27]
    ds_read_b128 v[64:67], v14 offset:24576
    v_mfma_f32_16x16x32_bf16 v[28:31], v[104:107], v[156:159], v[28:31]
    ds_read_b128 v[68:71], v14 offset:25600
    v_mfma_f32_16x16x32_bf16 v[36:39], v[108:111], v[156:159], v[36:39]
    s_waitcnt vmcnt(14) lgkmcnt(4)
    v_mfma_f32_16x16x32_bf16 v[16:19], v[40:43], v[160:163], v[16:19]
    ds_read_b128 v[76:79], v14 offset:27648
    v_mfma_f32_16x16x32_bf16 v[20:23], v[44:47], v[160:163], v[20:23]
    ds_read_b128 v[80:83], v14 offset:28672
    v_mfma_f32_16x16x32_bf16 v[24:27], v[48:51], v[160:163], v[24:27]
    ds_read_b128 v[84:87], v14 offset:29696
    buffer_load_dwordx4 v[128:131], v1, s[4:7], s33 offen offset:0 sc1
    v_mfma_f32_16x16x32_bf16 v[28:31], v[52:55], v[160:163], v[28:31]
    ds_read_b128 v[88:91], v14 offset:30720
    v_mfma_f32_16x16x32_bf16 v[32:35], v[72:75], v[160:163], v[32:35]
    ds_read_b128 v[108:111], v14 offset:35840
    s_waitcnt lgkmcnt(5)
    v_mfma_f32_16x16x32_bf16 v[16:19], v[56:59], v[164:167], v[16:19]
    ds_read_b128 v[92:95], v14 offset:31744
    v_mfma_f32_16x16x32_bf16 v[20:23], v[60:63], v[164:167], v[20:23]
    ds_read_b128 v[96:99], v14 offset:32768
    buffer_load_dwordx4 v[132:135], v1, s[4:7], s33 offen offset:1024 sc1
    v_mfma_f32_16x16x32_bf16 v[24:27], v[64:67], v[164:167], v[24:27]
    ds_read_b128 v[100:103], v14 offset:33792
    v_mfma_f32_16x16x32_bf16 v[28:31], v[68:71], v[164:167], v[28:31]
    ds_read_b128 v[104:107], v14 offset:34816
    v_mfma_f32_16x16x32_bf16 v[36:39], v[72:75], v[164:167], v[36:39]
    s_waitcnt vmcnt(14) lgkmcnt(0)
    s_barrier
    v_mfma_f32_16x16x32_bf16 v[16:19], v[76:79], v[168:171], v[16:19]
    ds_read_b128 v[40:43], v15 offset:0
    v_mfma_f32_16x16x32_bf16 v[20:23], v[80:83], v[168:171], v[20:23]
    ds_read_b128 v[44:47], v15 offset:1024
    v_mfma_f32_16x16x32_bf16 v[24:27], v[84:87], v[168:171], v[24:27]
    ds_read_b128 v[48:51], v15 offset:2048
    buffer_load_dwordx4 v[136:139], v1, s[4:7], s33 offen offset:2048 sc1
    v_mfma_f32_16x16x32_bf16 v[28:31], v[88:91], v[168:171], v[28:31]
    ds_read_b128 v[52:55], v15 offset:3072
    v_mfma_f32_16x16x32_bf16 v[32:35], v[108:111], v[168:171], v[32:35]
    ds_read_b128 v[72:75], v15 offset:8192
    v_mfma_f32_16x16x32_bf16 v[16:19], v[92:95], v[172:175], v[16:19]
    ds_read_b128 v[56:59], v15 offset:4096
    v_mfma_f32_16x16x32_bf16 v[20:23], v[96:99], v[172:175], v[20:23]
    ds_read_b128 v[60:63], v15 offset:5120
    buffer_load_dwordx4 v[140:143], v1, s[4:7], s33 offen offset:3072 sc1
    v_mfma_f32_16x16x32_bf16 v[24:27], v[100:103], v[172:175], v[24:27]
    ds_read_b128 v[64:67], v15 offset:6144
    v_mfma_f32_16x16x32_bf16 v[28:31], v[104:107], v[172:175], v[28:31]
    ds_read_b128 v[68:71], v15 offset:7168
    v_mfma_f32_16x16x32_bf16 v[36:39], v[108:111], v[172:175], v[36:39]
    s_waitcnt vmcnt(14) lgkmcnt(4)
    v_mfma_f32_16x16x32_bf16 v[16:19], v[40:43], v[176:179], v[16:19]
    ds_read_b128 v[76:79], v15 offset:9216
    s_cmp_eq_u32 s25, 3
    s_cselect_b32 s32, 3, 7
    s_lshl_b32 s32, s32, 13
    s_add_u32 s32, s32, s29
    s_add_u32 s33, s32, 4096
    v_mfma_f32_16x16x32_bf16 v[20:23], v[44:47], v[176:179], v[20:23]
    ds_read_b128 v[80:83], v15 offset:10240
    v_mfma_f32_16x16x32_bf16 v[24:27], v[48:51], v[176:179], v[24:27]
    ds_read_b128 v[84:87], v15 offset:11264
    buffer_load_dwordx4 v[144:147], v1, s[4:7], s32 offen offset:0 sc1
    v_mfma_f32_16x16x32_bf16 v[28:31], v[52:55], v[176:179], v[28:31]
    ds_read_b128 v[88:91], v15 offset:12288
    v_mfma_f32_16x16x32_bf16 v[32:35], v[72:75], v[176:179], v[32:35]
    ds_read_b128 v[108:111], v15 offset:17408
    s_waitcnt lgkmcnt(5)
    v_mfma_f32_16x16x32_bf16 v[16:19], v[56:59], v[180:183], v[16:19]
    ds_read_b128 v[92:95], v15 offset:13312
    v_mfma_f32_16x16x32_bf16 v[20:23], v[60:63], v[180:183], v[20:23]
    ds_read_b128 v[96:99], v15 offset:14336
    buffer_load_dwordx4 v[148:151], v1, s[4:7], s32 offen offset:1024 sc1
    v_mfma_f32_16x16x32_bf16 v[24:27], v[64:67], v[180:183], v[24:27]
    ds_read_b128 v[100:103], v15 offset:15360
    v_mfma_f32_16x16x32_bf16 v[28:31], v[68:71], v[180:183], v[28:31]
    ds_read_b128 v[104:107], v15 offset:16384
    v_mfma_f32_16x16x32_bf16 v[36:39], v[72:75], v[180:183], v[36:39]
    s_waitcnt vmcnt(14) lgkmcnt(4)
    v_mfma_f32_16x16x32_bf16 v[16:19], v[76:79], v[184:187], v[16:19]
    ds_read_b128 v[40:43], v15 offset:18432
    v_mfma_f32_16x16x32_bf16 v[20:23], v[80:83], v[184:187], v[20:23]
    ds_read_b128 v[44:47], v15 offset:19456
    v_mfma_f32_16x16x32_bf16 v[24:27], v[84:87], v[184:187], v[24:27]
    ds_read_b128 v[48:51], v15 offset:20480
    buffer_load_dwordx4 v[152:155], v1, s[4:7], s32 offen offset:2048 sc1
    v_mfma_f32_16x16x32_bf16 v[28:31], v[88:91], v[184:187], v[28:31]
    ds_read_b128 v[52:55], v15 offset:21504
    v_mfma_f32_16x16x32_bf16 v[32:35], v[108:111], v[184:187], v[32:35]
    ds_read_b128 v[72:75], v15 offset:26624
    s_waitcnt lgkmcnt(5)
    v_mfma_f32_16x16x32_bf16 v[16:19], v[92:95], v[188:191], v[16:19]
    ds_read_b128 v[56:59], v15 offset:22528
    v_mfma_f32_16x16x32_bf16 v[20:23], v[96:99], v[188:191], v[20:23]
    ds_read_b128 v[60:63], v15 offset:23552
    buffer_load_dwordx4 v[156:159], v1, s[4:7], s32 offen offset:3072 sc1
    v_mfma_f32_16x16x32_bf16 v[24:27], v[100:103], v[188:191], v[24:27]
    ds_read_b128 v[64:67], v15 offset:24576
    v_mfma_f32_16x16x32_bf16 v[28:31], v[104:107], v[188:191], v[28:31]
    ds_read_b128 v[68:71], v15 offset:25600
    v_mfma_f32_16x16x32_bf16 v[36:39], v[108:111], v[188:191], v[36:39]
    s_waitcnt vmcnt(14) lgkmcnt(4)
    v_mfma_f32_16x16x32_bf16 v[16:19], v[40:43], v[192:195], v[16:19]
    ds_read_b128 v[76:79], v15 offset:27648
    v_mfma_f32_16x16x32_bf16 v[20:23], v[44:47], v[192:195], v[20:23]
    ds_read_b128 v[80:83], v15 offset:28672
    v_mfma_f32_16x16x32_bf16 v[24:27], v[48:51], v[192:195], v[24:27]
    ds_read_b128 v[84:87], v15 offset:29696
    buffer_load_dwordx4 v[160:163], v1, s[4:7], s33 offen offset:0 sc1
    v_mfma_f32_16x16x32_bf16 v[28:31], v[52:55], v[192:195], v[28:31]
    ds_read_b128 v[88:91], v15 offset:30720
    v_mfma_f32_16x16x32_bf16 v[32:35], v[72:75], v[192:195], v[32:35]
    ds_read_b128 v[108:111], v15 offset:35840
    s_waitcnt lgkmcnt(5)
    v_mfma_f32_16x16x32_bf16 v[16:19], v[56:59], v[196:199], v[16:19]
    ds_read_b128 v[92:95], v15 offset:31744
    v_mfma_f32_16x16x32_bf16 v[20:23], v[60:63], v[196:199], v[20:23]
    ds_read_b128 v[96:99], v15 offset:32768
    buffer_load_dwordx4 v[164:167], v1, s[4:7], s33 offen offset:1024 sc1
    v_mfma_f32_16x16x32_bf16 v[24:27], v[64:67], v[196:199], v[24:27]
    ds_read_b128 v[100:103], v15 offset:33792
    v_mfma_f32_16x16x32_bf16 v[28:31], v[68:71], v[196:199], v[28:31]
    ds_read_b128 v[104:107], v15 offset:34816
    v_mfma_f32_16x16x32_bf16 v[36:39], v[72:75], v[196:199], v[36:39]
    s_waitcnt vmcnt(14) lgkmcnt(0)
    s_barrier
    v_mfma_f32_16x16x32_bf16 v[16:19], v[76:79], v[200:203], v[16:19]
    ds_read_b128 v[40:43], v12 offset:0
    v_mfma_f32_16x16x32_bf16 v[20:23], v[80:83], v[200:203], v[20:23]
    ds_read_b128 v[44:47], v12 offset:1024
    v_mfma_f32_16x16x32_bf16 v[24:27], v[84:87], v[200:203], v[24:27]
    ds_read_b128 v[48:51], v12 offset:2048
    buffer_load_dwordx4 v[168:171], v1, s[4:7], s33 offen offset:2048 sc1
    v_mfma_f32_16x16x32_bf16 v[28:31], v[88:91], v[200:203], v[28:31]
    ds_read_b128 v[52:55], v12 offset:3072
    v_mfma_f32_16x16x32_bf16 v[32:35], v[108:111], v[200:203], v[32:35]
    ds_read_b128 v[72:75], v12 offset:8192
    v_mfma_f32_16x16x32_bf16 v[16:19], v[92:95], v[204:207], v[16:19]
    ds_read_b128 v[56:59], v12 offset:4096
    v_mfma_f32_16x16x32_bf16 v[20:23], v[96:99], v[204:207], v[20:23]
    ds_read_b128 v[60:63], v12 offset:5120
    buffer_load_dwordx4 v[172:175], v1, s[4:7], s33 offen offset:3072 sc1
    v_mfma_f32_16x16x32_bf16 v[24:27], v[100:103], v[204:207], v[24:27]
    ds_read_b128 v[64:67], v12 offset:6144
    v_mfma_f32_16x16x32_bf16 v[28:31], v[104:107], v[204:207], v[28:31]
    ds_read_b128 v[68:71], v12 offset:7168
    v_mfma_f32_16x16x32_bf16 v[36:39], v[108:111], v[204:207], v[36:39]
    s_waitcnt vmcnt(14) lgkmcnt(4)
    v_mfma_f32_16x16x32_bf16 v[16:19], v[40:43], v[112:115], v[16:19]
    ds_read_b128 v[76:79], v12 offset:9216
    s_mov_b32 s32, 8
    s_lshl_b32 s32, s32, 13
    s_add_u32 s32, s32, s29
    s_add_u32 s33, s32, 4096
    v_mfma_f32_16x16x32_bf16 v[20:23], v[44:47], v[112:115], v[20:23]
    ds_read_b128 v[80:83], v12 offset:10240
    v_mfma_f32_16x16x32_bf16 v[24:27], v[48:51], v[112:115], v[24:27]
    ds_read_b128 v[84:87], v12 offset:11264
    buffer_load_dwordx2 v[176:177], v7, s[4:7], s32 offen offset:0 sc1
    v_mfma_f32_16x16x32_bf16 v[28:31], v[52:55], v[112:115], v[28:31]
    ds_read_b128 v[88:91], v12 offset:12288
    v_mfma_f32_16x16x32_bf16 v[32:35], v[72:75], v[112:115], v[32:35]
    ds_read_b128 v[108:111], v12 offset:17408
    s_waitcnt lgkmcnt(5)
    buffer_load_dwordx2 v[178:179], v7, s[4:7], s32 offen offset:512 sc1
    v_mfma_f32_16x16x32_bf16 v[16:19], v[56:59], v[116:119], v[16:19]
    ds_read_b128 v[92:95], v12 offset:13312
    v_mfma_f32_16x16x32_bf16 v[20:23], v[60:63], v[116:119], v[20:23]
    ds_read_b128 v[96:99], v12 offset:14336
    buffer_load_dwordx2 v[180:181], v7, s[4:7], s32 offen offset:1024 sc1
    v_mfma_f32_16x16x32_bf16 v[24:27], v[64:67], v[116:119], v[24:27]
    ds_read_b128 v[100:103], v12 offset:15360
    v_mfma_f32_16x16x32_bf16 v[28:31], v[68:71], v[116:119], v[28:31]
    ds_read_b128 v[104:107], v12 offset:16384
    buffer_load_dwordx2 v[182:183], v7, s[4:7], s32 offen offset:1536 sc1
    v_mfma_f32_16x16x32_bf16 v[36:39], v[72:75], v[116:119], v[36:39]
    s_waitcnt vmcnt(16) lgkmcnt(4)
    v_mfma_f32_16x16x32_bf16 v[16:19], v[76:79], v[120:123], v[16:19]
    ds_read_b128 v[40:43], v12 offset:18432
    v_mfma_f32_16x16x32_bf16 v[20:23], v[80:83], v[120:123], v[20:23]
    ds_read_b128 v[44:47], v12 offset:19456
    v_mfma_f32_16x16x32_bf16 v[24:27], v[84:87], v[120:123], v[24:27]
    ds_read_b128 v[48:51], v12 offset:20480
    buffer_load_dwordx2 v[184:185], v7, s[4:7], s32 offen offset:2048 sc1
    v_mfma_f32_16x16x32_bf16 v[28:31], v[88:91], v[120:123], v[28:31]
    ds_read_b128 v[52:55], v12 offset:21504
    v_mfma_f32_16x16x32_bf16 v[32:35], v[108:111], v[120:123], v[32:35]
    ds_read_b128 v[72:75], v12 offset:26624
    s_waitcnt lgkmcnt(5)
    buffer_load_dwordx2 v[186:187], v7, s[4:7], s32 offen offset:2560 sc1
    v_mfma_f32_16x16x32_bf16 v[16:19], v[92:95], v[124:127], v[16:19]
    ds_read_b128 v[56:59], v12 offset:22528
    v_mfma_f32_16x16x32_bf16 v[20:23], v[96:99], v[124:127], v[20:23]
    ds_read_b128 v[60:63], v12 offset:23552
    buffer_load_dwordx2 v[188:189], v7, s[4:7], s32 offen offset:3072 sc1
    v_mfma_f32_16x16x32_bf16 v[24:27], v[100:103], v[124:127], v[24:27]
    ds_read_b128 v[64:67], v12 offset:24576
    v_mfma_f32_16x16x32_bf16 v[28:31], v[104:107], v[124:127], v[28:31]
    ds_read_b128 v[68:71], v12 offset:25600
    buffer_load_dwordx2 v[190:191], v7, s[4:7], s32 offen offset:3584 sc1
    v_mfma_f32_16x16x32_bf16 v[36:39], v[108:111], v[124:127], v[36:39]
    s_waitcnt vmcnt(18) lgkmcnt(4)
    v_mfma_f32_16x16x32_bf16 v[16:19], v[40:43], v[128:131], v[16:19]
    ds_read_b128 v[76:79], v12 offset:27648
    v_mfma_f32_16x16x32_bf16 v[20:23], v[44:47], v[128:131], v[20:23]
    ds_read_b128 v[80:83], v12 offset:28672
    v_mfma_f32_16x16x32_bf16 v[24:27], v[48:51], v[128:131], v[24:27]
    ds_read_b128 v[84:87], v12 offset:29696
    buffer_load_dwordx2 v[192:193], v7, s[4:7], s33 offen offset:0 sc1
    v_mfma_f32_16x16x32_bf16 v[28:31], v[52:55], v[128:131], v[28:31]
    ds_read_b128 v[88:91], v12 offset:30720
    v_mfma_f32_16x16x32_bf16 v[32:35], v[72:75], v[128:131], v[32:35]
    ds_read_b128 v[108:111], v12 offset:35840
    s_waitcnt lgkmcnt(5)
    buffer_load_dwordx2 v[194:195], v7, s[4:7], s33 offen offset:512 sc1
    v_mfma_f32_16x16x32_bf16 v[16:19], v[56:59], v[132:135], v[16:19]
    ds_read_b128 v[92:95], v12 offset:31744
    v_mfma_f32_16x16x32_bf16 v[20:23], v[60:63], v[132:135], v[20:23]
    ds_read_b128 v[96:99], v12 offset:32768
    buffer_load_dwordx2 v[196:197], v7, s[4:7], s33 offen offset:1024 sc1
    v_mfma_f32_16x16x32_bf16 v[24:27], v[64:67], v[132:135], v[24:27]
    ds_read_b128 v[100:103], v12 offset:33792
    v_mfma_f32_16x16x32_bf16 v[28:31], v[68:71], v[132:135], v[28:31]
    ds_read_b128 v[104:107], v12 offset:34816
    buffer_load_dwordx2 v[198:199], v7, s[4:7], s33 offen offset:1536 sc1
    v_mfma_f32_16x16x32_bf16 v[36:39], v[72:75], v[132:135], v[36:39]
    s_waitcnt vmcnt(20) lgkmcnt(0)
    s_barrier
    v_mfma_f32_16x16x32_bf16 v[16:19], v[76:79], v[136:139], v[16:19]
    ds_read_b128 v[40:43], v13 offset:0
    v_mfma_f32_16x16x32_bf16 v[20:23], v[80:83], v[136:139], v[20:23]
    ds_read_b128 v[44:47], v13 offset:1024
    v_mfma_f32_16x16x32_bf16 v[24:27], v[84:87], v[136:139], v[24:27]
    ds_read_b128 v[48:51], v13 offset:2048
    buffer_load_dwordx2 v[200:201], v7, s[4:7], s33 offen offset:2048 sc1
    v_mfma_f32_16x16x32_bf16 v[28:31], v[88:91], v[136:139], v[28:31]
    ds_read_b128 v[52:55], v13 offset:3072
    v_mfma_f32_16x16x32_bf16 v[32:35], v[108:111], v[136:139], v[32:35]
    ds_read_b128 v[72:75], v13 offset:8192
    buffer_load_dwordx2 v[202:203], v7, s[4:7], s33 offen offset:2560 sc1
    v_mfma_f32_16x16x32_bf16 v[16:19], v[92:95], v[140:143], v[16:19]
    ds_read_b128 v[56:59], v13 offset:4096
    v_mfma_f32_16x16x32_bf16 v[20:23], v[96:99], v[140:143], v[20:23]
    ds_read_b128 v[60:63], v13 offset:5120
    buffer_load_dwordx2 v[204:205], v7, s[4:7], s33 offen offset:3072 sc1
    v_mfma_f32_16x16x32_bf16 v[24:27], v[100:103], v[140:143], v[24:27]
    ds_read_b128 v[64:67], v13 offset:6144
    v_mfma_f32_16x16x32_bf16 v[28:31], v[104:107], v[140:143], v[28:31]
    ds_read_b128 v[68:71], v13 offset:7168
    buffer_load_dwordx2 v[206:207], v7, s[4:7], s33 offen offset:3584 sc1
    v_mfma_f32_16x16x32_bf16 v[36:39], v[108:111], v[140:143], v[36:39]
    s_waitcnt vmcnt(22) lgkmcnt(4)
    v_mfma_f32_16x16x32_bf16 v[16:19], v[40:43], v[144:147], v[16:19]
    ds_read_b128 v[76:79], v13 offset:9216
    v_mfma_f32_16x16x32_bf16 v[20:23], v[44:47], v[144:147], v[20:23]
    ds_read_b128 v[80:83], v13 offset:10240
    v_mfma_f32_16x16x32_bf16 v[24:27], v[48:51], v[144:147], v[24:27]
    ds_read_b128 v[84:87], v13 offset:11264
    v_mfma_f32_16x16x32_bf16 v[28:31], v[52:55], v[144:147], v[28:31]
    ds_read_b128 v[88:91], v13 offset:12288
    v_mfma_f32_16x16x32_bf16 v[32:35], v[72:75], v[144:147], v[32:35]
    ds_read_b128 v[108:111], v13 offset:17408
    s_waitcnt lgkmcnt(5)
    v_mfma_f32_16x16x32_bf16 v[16:19], v[56:59], v[148:151], v[16:19]
    ds_read_b128 v[92:95], v13 offset:13312
    v_mfma_f32_16x16x32_bf16 v[20:23], v[60:63], v[148:151], v[20:23]
    ds_read_b128 v[96:99], v13 offset:14336
    v_mfma_f32_16x16x32_bf16 v[24:27], v[64:67], v[148:151], v[24:27]
    ds_read_b128 v[100:103], v13 offset:15360
    v_mfma_f32_16x16x32_bf16 v[28:31], v[68:71], v[148:151], v[28:31]
    ds_read_b128 v[104:107], v13 offset:16384
    v_mfma_f32_16x16x32_bf16 v[36:39], v[72:75], v[148:151], v[36:39]
    s_waitcnt vmcnt(20) lgkmcnt(4)
    v_mfma_f32_16x16x32_bf16 v[16:19], v[76:79], v[152:155], v[16:19]
    ds_read_b128 v[40:43], v13 offset:18432
    v_mfma_f32_16x16x32_bf16 v[20:23], v[80:83], v[152:155], v[20:23]
    ds_read_b128 v[44:47], v13 offset:19456
    v_mfma_f32_16x16x32_bf16 v[24:27], v[84:87], v[152:155], v[24:27]
    ds_read_b128 v[48:51], v13 offset:20480
    v_mfma_f32_16x16x32_bf16 v[28:31], v[88:91], v[152:155], v[28:31]
    ds_read_b128 v[52:55], v13 offset:21504
    v_mfma_f32_16x16x32_bf16 v[32:35], v[108:111], v[152:155], v[32:35]
    ds_read_b128 v[72:75], v13 offset:26624
    s_waitcnt lgkmcnt(5)
    v_mfma_f32_16x16x32_bf16 v[16:19], v[92:95], v[156:159], v[16:19]
    ds_read_b128 v[56:59], v13 offset:22528
    v_mfma_f32_16x16x32_bf16 v[20:23], v[96:99], v[156:159], v[20:23]
    ds_read_b128 v[60:63], v13 offset:23552
    v_mfma_f32_16x16x32_bf16 v[24:27], v[100:103], v[156:159], v[24:27]
    ds_read_b128 v[64:67], v13 offset:24576
    v_mfma_f32_16x16x32_bf16 v[28:31], v[104:107], v[156:159], v[28:31]
    ds_read_b128 v[68:71], v13 offset:25600
    v_mfma_f32_16x16x32_bf16 v[36:39], v[108:111], v[156:159], v[36:39]
    s_waitcnt vmcnt(18) lgkmcnt(4)
    v_mfma_f32_16x16x32_bf16 v[16:19], v[40:43], v[160:163], v[16:19]
    ds_read_b128 v[76:79], v13 offset:27648
    v_mfma_f32_16x16x32_bf16 v[20:23], v[44:47], v[160:163], v[20:23]
    ds_read_b128 v[80:83], v13 offset:28672
    v_mfma_f32_16x16x32_bf16 v[24:27], v[48:51], v[160:163], v[24:27]
    ds_read_b128 v[84:87], v13 offset:29696
    v_mfma_f32_16x16x32_bf16 v[28:31], v[52:55], v[160:163], v[28:31]
    ds_read_b128 v[88:91], v13 offset:30720
    v_mfma_f32_16x16x32_bf16 v[32:35], v[72:75], v[160:163], v[32:35]
    ds_read_b128 v[108:111], v13 offset:35840
    s_waitcnt lgkmcnt(5)
    v_mfma_f32_16x16x32_bf16 v[16:19], v[56:59], v[164:167], v[16:19]
    ds_read_b128 v[92:95], v13 offset:31744
    v_mfma_f32_16x16x32_bf16 v[20:23], v[60:63], v[164:167], v[20:23]
    ds_read_b128 v[96:99], v13 offset:32768
    v_mfma_f32_16x16x32_bf16 v[24:27], v[64:67], v[164:167], v[24:27]
    ds_read_b128 v[100:103], v13 offset:33792
    v_mfma_f32_16x16x32_bf16 v[28:31], v[68:71], v[164:167], v[28:31]
    ds_read_b128 v[104:107], v13 offset:34816
    v_mfma_f32_16x16x32_bf16 v[36:39], v[72:75], v[164:167], v[36:39]
    s_waitcnt vmcnt(16) lgkmcnt(0)
    s_barrier
    v_mfma_f32_16x16x32_bf16 v[16:19], v[76:79], v[168:171], v[16:19]
    ds_read_b128 v[40:43], v14 offset:0
    v_mfma_f32_16x16x32_bf16 v[20:23], v[80:83], v[168:171], v[20:23]
    ds_read_b128 v[44:47], v14 offset:1024
    v_mfma_f32_16x16x32_bf16 v[24:27], v[84:87], v[168:171], v[24:27]
    ds_read_b128 v[48:51], v14 offset:2048
    v_mfma_f32_16x16x32_bf16 v[28:31], v[88:91], v[168:171], v[28:31]
    ds_read_b128 v[52:55], v14 offset:3072
    v_mfma_f32_16x16x32_bf16 v[32:35], v[108:111], v[168:171], v[32:35]
    ds_read_b128 v[72:75], v14 offset:8192
    v_mfma_f32_16x16x32_bf16 v[16:19], v[92:95], v[172:175], v[16:19]
    ds_read_b128 v[56:59], v14 offset:4096
    v_mfma_f32_16x16x32_bf16 v[20:23], v[96:99], v[172:175], v[20:23]
    ds_read_b128 v[60:63], v14 offset:5120
    v_mfma_f32_16x16x32_bf16 v[24:27], v[100:103], v[172:175], v[24:27]
    ds_read_b128 v[64:67], v14 offset:6144
    v_mfma_f32_16x16x32_bf16 v[28:31], v[104:107], v[172:175], v[28:31]
    ds_read_b128 v[68:71], v14 offset:7168
    v_mfma_f32_16x16x32_bf16 v[36:39], v[108:111], v[172:175], v[36:39]
    s_waitcnt vmcnt(12) lgkmcnt(4)
    v_mfma_f32_16x16x32_bf16 v[16:19], v[40:43], v[176:179], v[16:19]
    ds_read_b128 v[76:79], v14 offset:9216
    v_mfma_f32_16x16x32_bf16 v[20:23], v[44:47], v[176:179], v[20:23]
    ds_read_b128 v[80:83], v14 offset:10240
    v_mfma_f32_16x16x32_bf16 v[24:27], v[48:51], v[176:179], v[24:27]
    ds_read_b128 v[84:87], v14 offset:11264
    v_mfma_f32_16x16x32_bf16 v[28:31], v[52:55], v[176:179], v[28:31]
    ds_read_b128 v[88:91], v14 offset:12288
    v_mfma_f32_16x16x32_bf16 v[32:35], v[72:75], v[176:179], v[32:35]
    ds_read_b128 v[108:111], v14 offset:17408
    s_waitcnt lgkmcnt(5)
    v_mfma_f32_16x16x32_bf16 v[16:19], v[56:59], v[180:183], v[16:19]
    ds_read_b128 v[92:95], v14 offset:13312
    v_mfma_f32_16x16x32_bf16 v[20:23], v[60:63], v[180:183], v[20:23]
    ds_read_b128 v[96:99], v14 offset:14336
    v_mfma_f32_16x16x32_bf16 v[24:27], v[64:67], v[180:183], v[24:27]
    ds_read_b128 v[100:103], v14 offset:15360
    v_mfma_f32_16x16x32_bf16 v[28:31], v[68:71], v[180:183], v[28:31]
    ds_read_b128 v[104:107], v14 offset:16384
    v_mfma_f32_16x16x32_bf16 v[36:39], v[72:75], v[180:183], v[36:39]
    s_waitcnt vmcnt(8) lgkmcnt(4)
    v_mfma_f32_16x16x32_bf16 v[16:19], v[76:79], v[184:187], v[16:19]
    ds_read_b128 v[40:43], v14 offset:18432
    v_mfma_f32_16x16x32_bf16 v[20:23], v[80:83], v[184:187], v[20:23]
    ds_read_b128 v[44:47], v14 offset:19456
    v_mfma_f32_16x16x32_bf16 v[24:27], v[84:87], v[184:187], v[24:27]
    ds_read_b128 v[48:51], v14 offset:20480
    v_mfma_f32_16x16x32_bf16 v[28:31], v[88:91], v[184:187], v[28:31]
    ds_read_b128 v[52:55], v14 offset:21504
    v_mfma_f32_16x16x32_bf16 v[32:35], v[108:111], v[184:187], v[32:35]
    ds_read_b128 v[72:75], v14 offset:26624
    s_waitcnt lgkmcnt(5)
    v_mfma_f32_16x16x32_bf16 v[16:19], v[92:95], v[188:191], v[16:19]
    ds_read_b128 v[56:59], v14 offset:22528
    v_mfma_f32_16x16x32_bf16 v[20:23], v[96:99], v[188:191], v[20:23]
    ds_read_b128 v[60:63], v14 offset:23552
    v_mfma_f32_16x16x32_bf16 v[24:27], v[100:103], v[188:191], v[24:27]
    ds_read_b128 v[64:67], v14 offset:24576
    v_mfma_f32_16x16x32_bf16 v[28:31], v[104:107], v[188:191], v[28:31]
    ds_read_b128 v[68:71], v14 offset:25600
    v_mfma_f32_16x16x32_bf16 v[36:39], v[108:111], v[188:191], v[36:39]
    s_waitcnt vmcnt(4) lgkmcnt(4)
    v_mfma_f32_16x16x32_bf16 v[16:19], v[40:43], v[192:195], v[16:19]
    ds_read_b128 v[76:79], v14 offset:27648
    v_mfma_f32_16x16x32_bf16 v[20:23], v[44:47], v[192:195], v[20:23]
    ds_read_b128 v[80:83], v14 offset:28672
    v_mfma_f32_16x16x32_bf16 v[24:27], v[48:51], v[192:195], v[24:27]
    ds_read_b128 v[84:87], v14 offset:29696
    v_mfma_f32_16x16x32_bf16 v[28:31], v[52:55], v[192:195], v[28:31]
    ds_read_b128 v[88:91], v14 offset:30720
    v_mfma_f32_16x16x32_bf16 v[32:35], v[72:75], v[192:195], v[32:35]
    ds_read_b128 v[108:111], v14 offset:35840
    s_waitcnt lgkmcnt(5)
    v_mfma_f32_16x16x32_bf16 v[16:19], v[56:59], v[196:199], v[16:19]
    ds_read_b128 v[92:95], v14 offset:31744
    v_mfma_f32_16x16x32_bf16 v[20:23], v[60:63], v[196:199], v[20:23]
    ds_read_b128 v[96:99], v14 offset:32768
    v_mfma_f32_16x16x32_bf16 v[24:27], v[64:67], v[196:199], v[24:27]
    ds_read_b128 v[100:103], v14 offset:33792
    v_mfma_f32_16x16x32_bf16 v[28:31], v[68:71], v[196:199], v[28:31]
    ds_read_b128 v[104:107], v14 offset:34816
    v_mfma_f32_16x16x32_bf16 v[36:39], v[72:75], v[196:199], v[36:39]
    s_waitcnt vmcnt(0) lgkmcnt(4)
    v_mfma_f32_16x16x32_bf16 v[16:19], v[76:79], v[200:203], v[16:19]
    v_mfma_f32_16x16x32_bf16 v[20:23], v[80:83], v[200:203], v[20:23]
    v_mfma_f32_16x16x32_bf16 v[24:27], v[84:87], v[200:203], v[24:27]
    v_mfma_f32_16x16x32_bf16 v[28:31], v[88:91], v[200:203], v[28:31]
    v_mfma_f32_16x16x32_bf16 v[32:35], v[108:111], v[200:203], v[32:35]
    s_waitcnt lgkmcnt(0)
    v_mfma_f32_16x16x32_bf16 v[16:19], v[92:95], v[204:207], v[16:19]
    v_mfma_f32_16x16x32_bf16 v[20:23], v[96:99], v[204:207], v[20:23]
    v_mfma_f32_16x16x32_bf16 v[24:27], v[100:103], v[204:207], v[24:27]
    v_mfma_f32_16x16x32_bf16 v[28:31], v[104:107], v[204:207], v[28:31]
    v_mfma_f32_16x16x32_bf16 v[36:39], v[108:111], v[204:207], v[36:39]
    s_nop 3
    v_cvt_pk_bf16_f32 v208, v16, v17
    v_cvt_pk_bf16_f32 v209, v18, v19
    v_cvt_pk_bf16_f32 v210, v20, v21
    v_cvt_pk_bf16_f32 v211, v22, v23
    v_cvt_pk_bf16_f32 v212, v24, v25
    v_cvt_pk_bf16_f32 v213, v26, v27
    v_cvt_pk_bf16_f32 v214, v28, v29
    v_cvt_pk_bf16_f32 v215, v30, v31
    s_cmp_eq_u32 s22, 1
    s_cbranch_scc1 L_fin_p5
    buffer_store_dwordx4 v[208:211], v4, s[4:7], s34 offen offset:0 sc1
    buffer_store_dwordx4 v[212:215], v4, s[4:7], s34 offen offset:1024 sc1
    v_permlane32_swap_b32 v36, v220
    v_permlane32_swap_b32 v37, v221
    v_permlane32_swap_b32 v38, v222
    v_permlane32_swap_b32 v39, v223
    v_pk_add_f32 v[32:33], v[32:33], v[220:221]
    v_pk_add_f32 v[34:35], v[34:35], v[222:223]
    v_cvt_pk_bf16_f32 v216, v32, v33
    v_cvt_pk_bf16_f32 v217, v34, v35
    buffer_store_dwordx2 v[216:217], v5, s[4:7], s34 offen sc1
    v_cndmask_b32 v222, 0, v216, s[40:41]
    v_cndmask_b32 v223, 0, v217, s[40:41]
    v_dot2_f32_bf16 v220, v208, v11, 0
    v_dot2_f32_bf16 v221, v208, v208, 0
    v_dot2_f32_bf16 v220, v209, v11, v220
    v_dot2_f32_bf16 v221, v209, v209, v221
    v_dot2_f32_bf16 v220, v210, v11, v220
    v_dot2_f32_bf16 v221, v210, v210, v221
    v_dot2_f32_bf16 v220, v211, v11, v220
    v_dot2_f32_bf16 v221, v211, v211, v221
    v_dot2_f32_bf16 v220, v212, v11, v220
    v_dot2_f32_bf16 v221, v212, v212, v221
    v_dot2_f32_bf16 v220, v213, v11, v220
    v_dot2_f32_bf16 v221, v213, v213, v221
    v_dot2_f32_bf16 v220, v214, v11, v220
    v_dot2_f32_bf16 v221, v214, v214, v221
    v_dot2_f32_bf16 v220, v215, v11, v220
    v_dot2_f32_bf16 v221, v215, v215, v221
    v_dot2_f32_bf16 v220, v222, v11, v220
    v_dot2_f32_bf16 v221, v222, v222, v221
    v_dot2_f32_bf16 v220, v223, v11, v220
    v_dot2_f32_bf16 v221, v223, v223, v221
    s_nop 2
    v_mov_b32 v222, v220
    v_mov_b32 v223, v221
    s_nop 1
    v_permlane32_swap_b32 v220, v222
    v_permlane32_swap_b32 v221, v223
    v_add_f32 v220, v220, v222
    v_add_f32 v221, v221, v223
    v_mov_b32 v222, v220
    v_mov_b32 v223, v221
    s_nop 1
    v_permlane16_swap_b32 v220, v222
    v_permlane16_swap_b32 v221, v223
    v_add_f32 v220, v220, v222
    v_add_f32 v221, v221, v223
    buffer_store_dwordx2 v[220:221], v10, s[4:7], s39 offen sc1
    s_mov_b32 s22, 1
    s_mov_b32 s21, 0x1c00000
    s_mov_b32 s46, 1
    s_mov_b32 s47, 0
    s_mov_b64 s[48:49], s[4:5]
    s_branch L_m_cl
L_fin_p5:
    buffer_store_dwordx4 v[208:211], v4, s[16:19], s34 offen offset:0
    buffer_store_dwordx4 v[212:215], v4, s[16:19], s34 offen offset:64
    v_permlane32_swap_b32 v36, v220
    v_permlane32_swap_b32 v37, v221
    v_permlane32_swap_b32 v38, v222
    v_permlane32_swap_b32 v39, v223
    v_pk_add_f32 v[32:33], v[32:33], v[220:221]
    v_pk_add_f32 v[34:35], v[34:35], v[222:223]
    v_cvt_pk_bf16_f32 v216, v32, v33
    v_cvt_pk_bf16_f32 v217, v34, v35
    buffer_store_dwordx2 v[216:217], v5, s[16:19], s34 offen offset:128
    s_endpgm
L_g_slow:
    s_mov_b32 s60, 65536
L_g_sl:
    s_sleep 2
    v_lshrrev_b32 v4, 8, v1
    v_bfe_u32 v5, v1, 6, 2
    v_bfe_u32 v6, v1, 4, 2
    v_lshlrev_b32 v255, 6, v4
    v_lshl_add_u32 v255, v5, 4, v255
    v_lshl_add_u32 v255, v6, 8, v255
    buffer_load_dwordx4 v[4:7], v255, s[4:7], s35 offen offset:0 sc1
    buffer_load_dwordx4 v[8:11], v255, s[4:7], s35 offen offset:1024 sc1
    buffer_load_dwordx4 v[12:15], v255, s[4:7], s35 offen offset:2048 sc1
    buffer_load_dwordx4 v[252:255], v255, s[4:7], s35 offen offset:3072 sc1
    s_waitcnt vmcnt(0)
    v_or3_b32 v249, v5, v7, v9
    v_or3_b32 v251, v11, v13, v15
    v_or3_b32 v249, v253, v255, v249
    v_or_b32 v249, v249, v251
    v_cmp_gt_i32 vcc, 0, v249
    s_sub_u32 s60, s60, 1
    s_cbranch_scc1 L_g_back
    s_cbranch_vccnz L_g_sl
    s_branch L_g_back
L_ld_m:
    s_getpc_b64 s[26:27]
L_m_pc:
    s_sub_u32 s26, s26, L_m_pc-interleave_layers__sliding_local_dilated__mixer_gmlp__prompt_kernel
    s_subb_u32 s27, s27, 0
    s_lshr_b32 s28, s2, 3
    s_lshl_b32 s28, s28, 2
    s_add_u32 s28, s28, s20
    s_lshl_b32 s28, s28, 9
    v_lshrrev_b32 v4, 1, v1
    v_add_u32 v4, s28, v4
    v_min_u32 v4, L_end_m-interleave_layers__sliding_local_dilated__mixer_gmlp__prompt_kernel-8, v4
    v_mov_b32 v5, s27
    v_add_co_u32 v4, vcc, s26, v4
    s_nop 1
    v_addc_co_u32 v5, vcc, 0, v5, vcc
    global_load_dwordx2 v[60:61], v[4:5], off
    v_bfe_u32 v2, v1, 4, 4
    v_lshrrev_b32 v3, 8, v1
    v_bfrev_b32 v6, 1
    v_mov_b32 v11, 0x3f803f80
    s_mul_i32 s30, s20, 9216
    s_cmp_lt_u32 s2, 144
    s_cbranch_scc1 L_p0_wi
    s_cmp_lt_u32 s2, 216
    s_cbranch_scc1 L_p0_wu
    v_mov_b32 v9, v6
    v_mov_b32 v10, v6
    v_mov_b32 v14, v6
    v_mov_b32 v15, v6
    s_mov_b32 s37, 0
    s_mov_b32 s38, 0
    s_mov_b32 s39, 0
    s_mov_b32 s40, 0
    s_mov_b32 s41, 0
    s_mov_b32 s42, 0
    s_mov_b32 s43, 0
    s_mov_b32 s47, 0
    s_mov_b32 s48, 0
    s_mov_b32 s49, 0
    s_barrier
    s_barrier
    s_barrier
    s_barrier
    s_barrier
    s_branch L_p0_ld
L_p0_wu:
    s_sub_u32 s26, s2, 144
    s_mul_i32 s28, s26, 57
    s_lshr_b32 s28, s28, 9
    s_mul_i32 s27, s28, 9
    s_sub_u32 s27, s26, s27
    s_mov_b32 s32, s50
    s_mov_b32 s33, s51
    s_mov_b32 s34, 0x288000
    s_mov_b32 s35, 0x20000
    s_mul_i32 s29, s28, 331776
    s_lshl_b32 s31, s27, 7
    s_add_u32 s29, s29, s31
    s_mul_i32 s31, s20, 82944
    s_add_u32 s29, s29, s31
    v_lshrrev_b32 v4, 7, v1
    v_mul_u32_u24 v4, 1152, v4
    v_and_b32 v5, 0x70, v1
    v_add_u32 v4, v4, v5
    s_barrier
    s_add_u32 m0, s30, 36864
    s_add_u32 s31, s29, 0
    buffer_load_dwordx4 v4, s[32:35], s31 offen nt lds
    s_barrier
    s_barrier
    s_add_u32 m0, s30, 37888
    s_add_u32 s31, s29, 9216
    buffer_load_dwordx4 v4, s[32:35], s31 offen nt lds
    s_add_u32 m0, s30, 38912
    s_add_u32 s31, s29, 18432
    buffer_load_dwordx4 v4, s[32:35], s31 offen nt lds
    s_add_u32 m0, s30, 39936
    s_add_u32 s31, s29, 27648
    buffer_load_dwordx4 v4, s[32:35], s31 offen nt lds
    s_add_u32 m0, s30, 40960
    s_add_u32 s31, s29, 36864
    buffer_load_dwordx4 v4, s[32:35], s31 offen nt lds
    s_add_u32 m0, s30, 41984
    s_add_u32 s31, s29, 46080
    buffer_load_dwordx4 v4, s[32:35], s31 offen nt lds
    s_add_u32 m0, s30, 43008
    s_add_u32 s31, s29, 55296
    buffer_load_dwordx4 v4, s[32:35], s31 offen nt lds
    s_add_u32 m0, s30, 44032
    s_add_u32 s31, s29, 64512
    buffer_load_dwordx4 v4, s[32:35], s31 offen nt lds
    s_add_u32 m0, s30, 45056
    s_add_u32 s31, s29, 73728
    buffer_load_dwordx4 v4, s[32:35], s31 offen nt lds
    v_lshrrev_b32 v7, 2, v2
    v_and_b32 v8, 3, v2
    s_lshl_b32 s31, s20, 5
    s_add_u32 s31, s31, 36864
    v_lshlrev_b32 v9, 7, v7
    v_lshl_add_u32 v9, v8, 3, v9
    v_add_u32 v9, s31, v9
    v_mul_u32_u24 v4, 512, v3
    v_add_u32 v4, v4, v9
    v_mul_u32_u24 v5, 512, v3
    v_add_u32 v5, v5, v9
    s_lshl_b32 s31, s27, 2
    s_add_u32 s31, s31, s20
    v_lshl_add_u32 v7, s31, 2, v7
    v_lshlrev_b32 v8, 4, v8
    v_lshl_add_u32 v8, v3, 8, v8
    v_mul_u32_u24 v9, 57, v7
    v_lshrrev_b32 v9, 10, v9
    v_mul_u32_u24 v10, 18, v9
    v_sub_u32 v10, v7, v10
    v_lshrrev_b32 v12, 3, v10
    v_and_b32 v13, 1, v10
    v_lshl_add_u32 v12, v12, 1, v13
    v_bfe_u32 v14, v10, 1, 2
    v_cmp_gt_u32 vcc, 16, v10
    v_mul_u32_u24 v9, 331776, v9
    v_add_u32 v9, v9, v8
    v_cndmask_b32 v12, 8, v12, vcc
    v_cndmask_b32 v14, v13, v14, vcc
    v_mov_b32 v15, 0x1000
    v_mov_b32 v13, 0x80
    v_cndmask_b32 v15, v13, v15, vcc
    v_lshl_add_u32 v9, v12, 10, v9
    v_lshl_add_u32 v9, v14, 6, v9
    v_add_u32 v10, v9, v15
    s_and_b32 s31, s28, 1
    s_cmp_eq_u32 s31, 1
    s_cselect_b64 vcc, -1, 0
    v_cndmask_b32 v14, v9, v10, vcc
    s_mul_i32 s31, s28, 36864
    s_add_u32 s37, s31, 0x4100000
    s_add_u32 s38, s31, 0x4100000
    s_add_u32 s39, s31, 0x4102400
    s_add_u32 s40, s31, 0x4102400
    s_add_u32 s41, s31, 0x4104800
    s_add_u32 s42, s31, 0x4104800
    s_add_u32 s43, s31, 0x4106c00
    s_add_u32 s47, s31, 0x4106c00
    s_lshr_b32 s31, s28, 1
    s_mul_i32 s31, s31, 9216
    s_add_u32 s48, s31, 0x4148000
    v_mov_b32 v15, v6
    s_mov_b32 s49, 0
    s_barrier
    s_waitcnt vmcnt(0)
    s_barrier
    ds_read_b64_tr_b16 v[16:17], v4 offset:0
    ds_read_b64_tr_b16 v[18:19], v4 offset:2048
    ds_read_b64_tr_b16 v[20:21], v4 offset:4096
    ds_read_b64_tr_b16 v[22:23], v4 offset:6144
    ds_read_b64_tr_b16 v[24:25], v4 offset:8192
    ds_read_b64_tr_b16 v[26:27], v4 offset:10240
    ds_read_b64_tr_b16 v[28:29], v4 offset:12288
    ds_read_b64_tr_b16 v[30:31], v4 offset:14336
    ds_read_b64_tr_b16 v[32:33], v4 offset:18432
    ds_read_b64_tr_b16 v[34:35], v4 offset:20480
    ds_read_b64_tr_b16 v[36:37], v4 offset:22528
    ds_read_b64_tr_b16 v[38:39], v4 offset:24576
    ds_read_b64_tr_b16 v[40:41], v4 offset:26624
    ds_read_b64_tr_b16 v[42:43], v4 offset:28672
    ds_read_b64_tr_b16 v[44:45], v4 offset:30720
    ds_read_b64_tr_b16 v[46:47], v4 offset:32768
    ds_read_b64_tr_b16 v[48:49], v5 offset:16384
    ds_read_b64_tr_b16 v[50:51], v5 offset:34816
    s_branch L_p0_ld
L_p0_wi:
    s_mov_b32 s26, s2
    s_mul_i32 s28, s26, 57
    s_lshr_b32 s28, s28, 12
    s_mul_i32 s27, s28, 72
    s_sub_u32 s27, s26, s27
    s_mov_b32 s32, s44
    s_mov_b32 s33, s45
    s_mov_b32 s34, 0x510000
    s_mov_b32 s35, 0x20000
    s_mul_i32 s29, s28, 2654208
    s_lshl_b32 s31, s27, 7
    s_add_u32 s29, s29, s31
    s_mul_i32 s31, s20, 663552
    s_add_u32 s29, s29, s31
    v_lshrrev_b32 v4, 7, v1
    v_mul_u32_u24 v4, 9216, v4
    v_and_b32 v5, 0x70, v1
    v_add_u32 v4, v4, v5
    s_barrier
    s_add_u32 m0, s30, 36864
    s_add_u32 s31, s29, 0
    buffer_load_dwordx4 v4, s[32:35], s31 offen nt lds
    s_barrier
    s_barrier
    s_add_u32 m0, s30, 37888
    s_add_u32 s31, s29, 73728
    buffer_load_dwordx4 v4, s[32:35], s31 offen nt lds
    s_add_u32 m0, s30, 38912
    s_add_u32 s31, s29, 147456
    buffer_load_dwordx4 v4, s[32:35], s31 offen nt lds
    s_add_u32 m0, s30, 39936
    s_add_u32 s31, s29, 221184
    buffer_load_dwordx4 v4, s[32:35], s31 offen nt lds
    s_add_u32 m0, s30, 40960
    s_add_u32 s31, s29, 294912
    buffer_load_dwordx4 v4, s[32:35], s31 offen nt lds
    s_add_u32 m0, s30, 41984
    s_add_u32 s31, s29, 368640
    buffer_load_dwordx4 v4, s[32:35], s31 offen nt lds
    s_add_u32 m0, s30, 43008
    s_add_u32 s31, s29, 442368
    buffer_load_dwordx4 v4, s[32:35], s31 offen nt lds
    s_add_u32 m0, s30, 44032
    s_add_u32 s31, s29, 516096
    buffer_load_dwordx4 v4, s[32:35], s31 offen nt lds
    s_add_u32 m0, s30, 45056
    s_add_u32 s31, s29, 589824
    buffer_load_dwordx4 v4, s[32:35], s31 offen nt lds
    v_lshrrev_b32 v7, 2, v2
    v_and_b32 v8, 3, v2
    s_lshl_b32 s31, s20, 5
    s_add_u32 s31, s31, 36864
    v_lshlrev_b32 v9, 7, v7
    v_lshl_add_u32 v9, v8, 3, v9
    v_add_u32 v9, s31, v9
    v_mul_u32_u24 v4, 1024, v3
    v_add_u32 v4, v4, v9
    v_mul_u32_u24 v5, 9216, v3
    v_add_u32 v5, v5, v9
    s_lshl_b32 s31, s27, 2
    s_add_u32 s31, s31, s20
    v_lshl_add_u32 v7, s31, 2, v7
    v_lshlrev_b32 v8, 4, v8
    v_lshl_add_u32 v8, v3, 8, v8
    s_cmp_lt_u32 s31, 144
    s_cselect_b32 s23, 1, 0
    s_cselect_b32 s24, 0, 144
    s_sub_u32 s26, s31, s24
    s_mul_i32 s25, s26, 57
    s_lshr_b32 s25, s25, 9
    s_mul_i32 s24, s25, 9
    s_sub_u32 s24, s26, s24
    s_lshl_b32 s26, s25, 1
    s_add_u32 s26, s26, s23
    s_mul_i32 s26, s26, 165888
    s_lshl_b32 s31, s24, 10
    s_add_u32 s26, s26, s31
    s_add_u32 s26, s26, 0x3b00000
    s_mul_i32 s31, s28, 9216
    s_add_u32 s48, s26, s31
    s_add_u32 s48, s48, 147456
    s_lshl_b32 s31, s31, 3
    s_add_u32 s26, s26, s31
    s_add_u32 s37, s26, 0
    s_add_u32 s38, s26, 9216
    s_add_u32 s39, s26, 18432
    s_add_u32 s40, s26, 27648
    s_add_u32 s41, s26, 36864
    s_add_u32 s42, s26, 46080
    s_add_u32 s43, s26, 55296
    s_add_u32 s47, s26, 64512
    s_lshl_b32 s49, s25, 12
    s_mul_i32 s31, s28, 1152
    s_add_u32 s49, s49, s31
    s_mul_i32 s31, s23, 576
    s_add_u32 s49, s49, s31
    s_lshl_b32 s31, s24, 6
    s_add_u32 s49, s49, s31
    s_add_u32 s49, s49, 0x4410000
    v_cmp_eq_u32 vcc, 0, v3
    v_lshlrev_b32 v15, 2, v2
    v_mov_b32 v9, v1
    v_mov_b32 v10, v1
    v_mov_b32 v14, v1
    v_cndmask_b32 v15, v6, v15, vcc
    s_barrier
    s_waitcnt vmcnt(0)
    s_barrier
    ds_read_b64_tr_b16 v[16:17], v4 offset:0
    ds_read_b64_tr_b16 v[18:19], v4 offset:512
    ds_read_b64_tr_b16 v[20:21], v4 offset:4096
    ds_read_b64_tr_b16 v[22:23], v4 offset:4608
    ds_read_b64_tr_b16 v[24:25], v4 offset:9216
    ds_read_b64_tr_b16 v[26:27], v4 offset:9728
    ds_read_b64_tr_b16 v[28:29], v4 offset:13312
    ds_read_b64_tr_b16 v[30:31], v4 offset:13824
    ds_read_b64_tr_b16 v[32:33], v4 offset:18432
    ds_read_b64_tr_b16 v[34:35], v4 offset:18944
    ds_read_b64_tr_b16 v[36:37], v4 offset:22528
    ds_read_b64_tr_b16 v[38:39], v4 offset:23040
    ds_read_b64_tr_b16 v[40:41], v4 offset:27648
    ds_read_b64_tr_b16 v[42:43], v4 offset:28160
    ds_read_b64_tr_b16 v[44:45], v4 offset:31744
    ds_read_b64_tr_b16 v[46:47], v4 offset:32256
    ds_read_b64_tr_b16 v[48:49], v5 offset:8192
    ds_read_b64_tr_b16 v[50:51], v5 offset:8704
L_p0_ld:
    s_waitcnt lgkmcnt(0)
    s_and_b32 s25, s2, 7
    s_lshr_b32 s26, s2, 3
    s_lshr_b32 s23, s25, 1
    s_lshl_b32 s23, s23, 2
    s_lshr_b32 s27, s26, 3
    s_add_u32 s23, s23, s27
    s_and_b32 s24, s25, 1
    s_lshl_b32 s24, s24, 3
    s_and_b32 s27, s26, 7
    s_add_u32 s24, s24, s27
    s_mul_i32 s29, s24, 129024
    s_lshl_b32 s30, s20, 12
    s_add_u32 s29, s29, s30
    s_add_u32 s29, s29, 0x3800000
    s_lshl_b32 s31, s23, 3
    s_max_u32 s31, s31, 1
    s_sub_u32 s31, s31, 1
    s_mul_i32 s31, s31, 18432
    s_add_u32 s31, s31, 0x0
    s_lshl_b32 s35, s20, 10
    s_and_b32 s36, s35, 1024
    s_barrier
    s_add_u32 m0, s35, 131072
    s_add_u32 s34, s31, s35
    s_add_u32 s34, s34, 0
    buffer_load_dwordx4 v1, s[4:7], s34 offen sc1 lds
    s_add_u32 m0, s30, 0
    s_add_u32 s34, s29, 0
    buffer_load_dwordx4 v1, s[4:7], s34 offen offset:0 lds
    buffer_load_dwordx4 v1, s[4:7], s34 offen offset:1024 lds
    buffer_load_dwordx4 v1, s[4:7], s34 offen offset:2048 lds
    buffer_load_dwordx4 v1, s[4:7], s34 offen offset:3072 lds
    s_add_u32 m0, s30, 16384
    s_add_u32 s34, s29, 16384
    buffer_load_dwordx4 v1, s[4:7], s34 offen offset:0 lds
    buffer_load_dwordx4 v1, s[4:7], s34 offen offset:1024 lds
    buffer_load_dwordx4 v1, s[4:7], s34 offen offset:2048 lds
    buffer_load_dwordx4 v1, s[4:7], s34 offen offset:3072 lds
    s_waitcnt vmcnt(4)
    s_barrier
    s_add_u32 m0, s35, 135168
    s_add_u32 s34, s31, s35
    s_add_u32 s34, s34, 4096
    buffer_load_dwordx4 v1, s[4:7], s34 offen sc1 lds
    s_add_u32 m0, s30, 32768
    s_add_u32 s34, s29, 32768
    buffer_load_dwordx4 v1, s[4:7], s34 offen offset:0 lds
    buffer_load_dwordx4 v1, s[4:7], s34 offen offset:1024 lds
    buffer_load_dwordx4 v1, s[4:7], s34 offen offset:2048 lds
    buffer_load_dwordx4 v1, s[4:7], s34 offen offset:3072 lds
    s_add_u32 m0, s30, 49152
    s_add_u32 s34, s29, 49152
    buffer_load_dwordx4 v1, s[4:7], s34 offen offset:0 lds
    buffer_load_dwordx4 v1, s[4:7], s34 offen offset:1024 lds
    buffer_load_dwordx4 v1, s[4:7], s34 offen offset:2048 lds
    buffer_load_dwordx4 v1, s[4:7], s34 offen offset:3072 lds
    s_add_u32 m0, s35, 139264
    s_add_u32 s34, s31, s35
    s_add_u32 s34, s34, 8192
    buffer_load_dwordx4 v1, s[4:7], s34 offen sc1 lds
    s_waitcnt vmcnt(10)
    s_barrier
    s_mov_b32 m0, 161792
    s_lshl_b32 s34, s24, 10
    s_add_u32 s34, s34, 0x4400000
    buffer_load_dwordx4 v1, s[4:7], s34 offen lds
    s_add_u32 m0, s30, 65536
    s_add_u32 s34, s29, 65536
    buffer_load_dwordx4 v1, s[4:7], s34 offen offset:0 lds
    buffer_load_dwordx4 v1, s[4:7], s34 offen offset:1024 lds
    buffer_load_dwordx4 v1, s[4:7], s34 offen offset:2048 lds
    buffer_load_dwordx4 v1, s[4:7], s34 offen offset:3072 lds
    s_waitcnt vmcnt(10)
    s_barrier
    s_add_u32 m0, s30, 81920
    s_add_u32 s34, s29, 81920
    buffer_load_dwordx4 v1, s[4:7], s34 offen offset:0 lds
    buffer_load_dwordx4 v1, s[4:7], s34 offen offset:1024 lds
    buffer_load_dwordx4 v1, s[4:7], s34 offen offset:2048 lds
    buffer_load_dwordx4 v1, s[4:7], s34 offen offset:3072 lds
    s_add_u32 m0, s35, 143360
    s_add_u32 s34, s31, s35
    s_add_u32 s34, s34, 12288
    buffer_load_dwordx4 v1, s[4:7], s34 offen sc1 lds
    s_waitcnt vmcnt(10)
    s_barrier
    s_add_u32 m0, s30, 98304
    s_add_u32 s34, s29, 98304
    buffer_load_dwordx4 v1, s[4:7], s34 offen offset:0 lds
    buffer_load_dwordx4 v1, s[4:7], s34 offen offset:1024 lds
    buffer_load_dwordx4 v1, s[4:7], s34 offen offset:2048 lds
    buffer_load_dwordx4 v1, s[4:7], s34 offen offset:3072 lds
    s_waitcnt vmcnt(9)
    s_barrier
    s_add_u32 m0, s36, 147456
    s_add_u32 s34, s31, s36
    s_add_u32 s34, s34, 16384
    buffer_load_dwordx4 v1, s[4:7], s34 offen sc1 lds
    s_add_u32 m0, s30, 114688
    s_add_u32 s34, s29, 114688
    buffer_load_dwordx4 v1, s[4:7], s34 offen offset:0 lds
    buffer_load_dwordx4 v1, s[4:7], s34 offen offset:1024 lds
    buffer_load_dwordx4 v1, s[4:7], s34 offen offset:2048 lds
    buffer_load_dwordx4 v1, s[4:7], s34 offen offset:3072 lds
    s_waitcnt vmcnt(9)
    s_barrier
    s_waitcnt vmcnt(5)
    s_barrier
    buffer_store_dwordx4 v[16:19], v9, s[4:7], s37 offen sc1
    buffer_store_dwordx4 v[20:23], v10, s[4:7], s38 offen sc1
    buffer_store_dwordx4 v[24:27], v9, s[4:7], s39 offen sc1
    buffer_store_dwordx4 v[28:31], v10, s[4:7], s40 offen sc1
    buffer_store_dwordx4 v[32:35], v9, s[4:7], s41 offen sc1
    buffer_store_dwordx4 v[36:39], v10, s[4:7], s42 offen sc1
    buffer_store_dwordx4 v[40:43], v9, s[4:7], s43 offen sc1
    buffer_store_dwordx4 v[44:47], v10, s[4:7], s47 offen sc1
    buffer_store_dwordx4 v[48:51], v14, s[4:7], s48 offen sc1
    v_dot2_f32_bf16 v12, v16, v11, 0
    v_dot2_f32_bf16 v13, v17, v11, 0
    v_dot2_f32_bf16 v12, v18, v11, v12
    v_dot2_f32_bf16 v13, v19, v11, v13
    v_dot2_f32_bf16 v12, v20, v11, v12
    v_dot2_f32_bf16 v13, v21, v11, v13
    v_dot2_f32_bf16 v12, v22, v11, v12
    v_dot2_f32_bf16 v13, v23, v11, v13
    v_dot2_f32_bf16 v12, v24, v11, v12
    v_dot2_f32_bf16 v13, v25, v11, v13
    v_dot2_f32_bf16 v12, v26, v11, v12
    v_dot2_f32_bf16 v13, v27, v11, v13
    v_dot2_f32_bf16 v12, v28, v11, v12
    v_dot2_f32_bf16 v13, v29, v11, v13
    v_dot2_f32_bf16 v12, v30, v11, v12
    v_dot2_f32_bf16 v13, v31, v11, v13
    v_dot2_f32_bf16 v12, v32, v11, v12
    v_dot2_f32_bf16 v13, v33, v11, v13
    v_dot2_f32_bf16 v12, v34, v11, v12
    v_dot2_f32_bf16 v13, v35, v11, v13
    v_dot2_f32_bf16 v12, v36, v11, v12
    v_dot2_f32_bf16 v13, v37, v11, v13
    v_dot2_f32_bf16 v12, v38, v11, v12
    v_dot2_f32_bf16 v13, v39, v11, v13
    v_dot2_f32_bf16 v12, v40, v11, v12
    v_dot2_f32_bf16 v13, v41, v11, v13
    v_dot2_f32_bf16 v12, v42, v11, v12
    v_dot2_f32_bf16 v13, v43, v11, v13
    v_dot2_f32_bf16 v12, v44, v11, v12
    v_dot2_f32_bf16 v13, v45, v11, v13
    v_dot2_f32_bf16 v12, v46, v11, v12
    v_dot2_f32_bf16 v13, v47, v11, v13
    v_dot2_f32_bf16 v12, v48, v11, v12
    v_dot2_f32_bf16 v13, v49, v11, v13
    v_dot2_f32_bf16 v12, v50, v11, v12
    v_dot2_f32_bf16 v13, v51, v11, v13
    s_nop 2
    v_add_f32 v12, v12, v13
    v_mov_b32 v13, v12
    s_nop 1
    v_permlane32_swap_b32 v12, v13
    v_add_f32 v12, v12, v13
    v_mov_b32 v13, v12
    s_nop 1
    v_permlane16_swap_b32 v12, v13
    v_add_f32 v12, v12, v13
    buffer_store_dword v12, v15, s[4:7], s49 offen sc1
    s_waitcnt vmcnt(10)
    s_barrier
    s_mov_b32 s46, 0x4502000
    v_mov_b32 v4, 0
    s_mov_b32 s60, 65536
L_poll_wo:
    buffer_load_dword v5, v4, s[4:7], s46 offen sc1
    s_waitcnt vmcnt(0)
    v_cmp_gt_u32 vcc, 18, v5
    s_sub_u32 s60, s60, 1
    s_cbranch_scc1 L_pd_wo
    s_cbranch_vccz L_pd_wo
    s_sleep 4
    s_branch L_poll_wo
L_pd_wo:
    s_barrier
    s_cmp_lg_u32 s20, 0
    s_cbranch_scc1 L_p1_ns
    s_and_b32 s44, s2, 15
    s_lshl_b32 s44, s44, 8
    s_add_u32 s44, s44, 0x4501000
    s_add_u32 s44, s44, s4
    s_addc_u32 s45, s5, 0
    s_mov_b32 s56, 1
    s_atomic_add s56, s[44:45], 0
L_p1_ns:
L_m_ll:
    s_and_b32 s25, s2, 7
    s_lshr_b32 s26, s2, 3
    s_lshl_b32 s23, s25, 2
    s_lshr_b32 s27, s26, 3
    s_add_u32 s23, s23, s27
    s_and_b32 s24, s26, 7
    s_add_u32 s25, s23, s24
    s_and_b32 s25, s25, 3
    s_mul_i32 s29, s24, 82944
    s_add_u32 s29, s29, 0x3a00000
    s_mul_i32 s30, s20, 36864
    s_mul_i32 s31, s20, 18432
    s_add_u32 s31, s31, s29
    s_add_u32 m0, s30, 18432
    s_add_u32 s33, s31, 0
    buffer_load_dwordx4 v1, s[4:7], s33 offen offset:0  lds
    buffer_load_dwordx4 v1, s[4:7], s33 offen offset:1024  lds
    buffer_load_dwordx4 v1, s[4:7], s33 offen offset:2048  lds
    buffer_load_dwordx4 v1, s[4:7], s33 offen offset:3072  lds
    s_add_u32 m0, s30, 22528
    s_add_u32 s33, s31, 4096
    buffer_load_dwordx4 v1, s[4:7], s33 offen offset:0  lds
    buffer_load_dwordx4 v1, s[4:7], s33 offen offset:1024  lds
    buffer_load_dwordx4 v1, s[4:7], s33 offen offset:2048  lds
    buffer_load_dwordx4 v1, s[4:7], s33 offen offset:3072  lds
    s_add_u32 m0, s30, 26624
    s_add_u32 s33, s31, 8192
    buffer_load_dwordx4 v1, s[4:7], s33 offen offset:0  lds
    buffer_load_dwordx4 v1, s[4:7], s33 offen offset:1024  lds
    buffer_load_dwordx4 v1, s[4:7], s33 offen offset:2048  lds
    buffer_load_dwordx4 v1, s[4:7], s33 offen offset:3072  lds
    s_add_u32 m0, s30, 30720
    s_add_u32 s33, s31, 12288
    buffer_load_dwordx4 v1, s[4:7], s33 offen offset:0  lds
    buffer_load_dwordx4 v1, s[4:7], s33 offen offset:1024  lds
    buffer_load_dwordx4 v1, s[4:7], s33 offen offset:2048  lds
    buffer_load_dwordx4 v1, s[4:7], s33 offen offset:3072  lds
    s_add_u32 m0, s30, 34816
    s_add_u32 s33, s31, 16384
    buffer_load_dwordx4 v1, s[4:7], s33 offen offset:0  lds
    buffer_load_dwordx4 v1, s[4:7], s33 offen offset:1024  lds
    s_mul_i32 s30, s20, 3072
    s_add_u32 s31, s30, s29
    s_barrier
    s_add_u32 m0, s30, 147456
    s_add_u32 s33, s31, 73728
    buffer_load_dwordx4 v1, s[4:7], s33 offen offset:0  lds
    buffer_load_dwordx4 v1, s[4:7], s33 offen offset:1024  lds
    buffer_load_dwordx4 v1, s[4:7], s33 offen offset:2048  lds
    s_waitcnt vmcnt(0)
    s_barrier
    s_and_b32 s25, s2, 7
    s_lshr_b32 s26, s2, 3
    s_and_b32 s23, s25, 1
    s_lshl_b32 s23, s23, 3
    s_and_b32 s27, s26, 7
    s_add_u32 s23, s23, s27
    s_lshr_b32 s24, s25, 1
    s_lshl_b32 s24, s24, 2
    s_lshr_b32 s27, s26, 3
    s_add_u32 s24, s24, s27
    s_add_u32 s28, s23, s24
    s_and_b32 s28, s28, 3
    s_lshl_b32 s30, s20, 12
    s_lshr_b32 s33, s20, 1
    s_mul_i32 s31, s33, 36864
    s_and_b32 s33, s20, 1
    s_lshl_b32 s33, s33, 10
    s_add_u32 s33, s33, 16384
    s_add_u32 s31, s31, s33
    s_sub_u32 s49, s33, s30
    s_mul_i32 s34, s24, 331776
    s_add_u32 s34, s34, s30
    s_add_u32 s34, s34, 0x3b00000
    s_lshl_b32 s35, s23, 3
    s_lshl_b32 s33, s20, 1
    s_add_u32 s35, s35, s33
    s_mul_i32 s35, s35, 18432
    s_add_u32 s35, s35, s21
    s_add_u32 s35, s35, 0x300000
    s_mul_i32 s36, s24, 589824
    s_add_u32 s36, s36, s30
    s_add_u32 s36, s36, s21
    s_add_u32 s36, s36, 0x900000
    v_add_u32 v2, 16384, v1
    s_lshl_b32 s33, s23, 7
    s_lshl_b32 s37, s20, 5
    s_add_u32 s33, s33, s37
    v_lshrrev_b32 v8, 7, v1
    v_add_u32 v8, s33, v8
    v_lshlrev_b32 v8, 12, v8
    v_lshrrev_b32 v9, 8, v1
    v_bfe_u32 v10, v1, 4, 3
    v_xor_b32 v9, v9, v10
    v_lshl_add_u32 v8, v9, 4, v8
    v_xor_b32 v9, 64, v8
    v_add_u32 v9, 31744, v9
    v_add_u32 v10, 63488, v8
    v_add_u32 v11, 63488, v9
    s_cmp_eq_u32 s28, 0
    s_cselect_b32 s44, 4, 0
    s_cmp_eq_u32 s28, 1
    s_cselect_b32 s45, 5, 1
    s_cmp_eq_u32 s28, 2
    s_cselect_b32 s46, 6, 2
    s_cmp_eq_u32 s28, 3
    s_cselect_b32 s47, 7, 3
    s_lshl_b32 s33, s20, 4
    s_add_u32 s33, s33, s24
    s_lshl_b32 s54, s22, 7
    s_add_u32 s54, s54, s33
    s_lshl_b32 s54, s54, 8
    s_add_u32 s54, s54, 0x450c000
    s_add_u32 s54, s54, s4
    s_addc_u32 s55, s5, 0
    s_mov_b32 s33, 0x4501000
    v_and_b32 v4, 0xf0, v1
    v_lshlrev_b32 v4, 4, v4
    s_mov_b32 s60, 65536
L_poll_wr:
    buffer_load_dword v5, v4, s[4:7], s33 offen sc1
    s_waitcnt vmcnt(0)
    v_cmp_gt_u32 vcc, 16, v5
    s_sub_u32 s60, s60, 1
    s_cbranch_scc1 L_pd_wr
    s_cbranch_vccz L_pd_wr
    s_sleep 4
    s_branch L_poll_wr
L_pd_wr:
    s_cmp_eq_u32 s28, 0
    s_cselect_b32 s48, 4, 0
    s_mul_i32 s50, s48, 18432
    s_add_u32 s50, s50, s34
    s_add_u32 m0, s30, 0
    s_mov_b32 s53, s50
    buffer_load_dwordx4 v1, s[4:7], s50 offen offset:0  lds
    buffer_load_dwordx4 v1, s[4:7], s50 offen offset:1024  lds
    buffer_load_dwordx4 v1, s[4:7], s50 offen offset:2048  lds
    buffer_load_dwordx4 v1, s[4:7], s50 offen offset:3072  lds
    s_cmp_eq_u32 s28, 1
    s_cselect_b32 s48, 5, 1
    s_mul_i32 s50, s48, 18432
    s_add_u32 s50, s50, s34
    s_cmp_ge_u32 s20, 2
    s_cselect_b32 s52, s50, s53
    s_add_u32 m0, s31, 0
    s_add_u32 s52, s52, s49
    buffer_load_dwordx4 v1, s[4:7], s52 offen  lds
    s_add_u32 m0, s30, 36864
    s_mov_b32 s53, s50
    buffer_load_dwordx4 v1, s[4:7], s50 offen offset:0  lds
    buffer_load_dwordx4 v1, s[4:7], s50 offen offset:1024  lds
    buffer_load_dwordx4 v1, s[4:7], s50 offen offset:2048  lds
    buffer_load_dwordx4 v1, s[4:7], s50 offen offset:3072  lds
    s_cmp_eq_u32 s28, 2
    s_cselect_b32 s48, 6, 2
    s_mul_i32 s50, s48, 18432
    s_add_u32 s50, s50, s34
    s_add_u32 m0, s30, 73728
    s_mov_b32 s53, s50
    buffer_load_dwordx4 v1, s[4:7], s50 offen offset:0  lds
    buffer_load_dwordx4 v1, s[4:7], s50 offen offset:1024  lds
    buffer_load_dwordx4 v1, s[4:7], s50 offen offset:2048  lds
    buffer_load_dwordx4 v1, s[4:7], s50 offen offset:3072  lds
    s_cmp_eq_u32 s28, 3
    s_cselect_b32 s48, 7, 3
    s_mul_i32 s50, s48, 18432
    s_add_u32 s50, s50, s34
    s_cmp_ge_u32 s20, 2
    s_cselect_b32 s52, s50, s53
    s_add_u32 m0, s31, 73728
    s_add_u32 s52, s52, s49
    buffer_load_dwordx4 v1, s[4:7], s52 offen  lds
    s_add_u32 m0, s30, 110592
    s_mov_b32 s53, s50
    buffer_load_dwordx4 v1, s[4:7], s50 offen offset:0  lds
    buffer_load_dwordx4 v1, s[4:7], s50 offen offset:1024  lds
    buffer_load_dwordx4 v1, s[4:7], s50 offen offset:2048  lds
    buffer_load_dwordx4 v1, s[4:7], s50 offen offset:3072  lds
    s_min_u32 s33, s20, 2
    s_lshl_b32 s33, s33, 10
    s_add_u32 m0, s33, 159744
    s_lshl_b32 s51, s24, 12
    s_add_u32 s51, s51, s33
    s_add_u32 s51, s51, 0x4410000
    buffer_load_dwordx4 v1, s[4:7], s51 offen lds
    s_barrier
    s_barrier
    s_cmp_eq_u32 s28, 0
    s_cselect_b32 s48, 4, 0
    s_lshl_b32 s51, s48, 11
    s_add_u32 m0, s30, 18432
    s_add_u32 s51, s51, s35
    buffer_load_dwordx4 v1, s[4:7], s51 offen offset:0 sc1 lds
    buffer_load_dwordx4 v1, s[4:7], s51 offen offset:1024 sc1 lds
    buffer_load_dwordx4 v2, s[4:7], s51 offen offset:2048 sc1 lds
    buffer_load_dwordx4 v2, s[4:7], s51 offen offset:3072 sc1 lds
    s_cmp_eq_u32 s28, 1
    s_cselect_b32 s48, 5, 1
    s_lshl_b32 s51, s48, 11
    s_add_u32 m0, s30, 55296
    s_add_u32 s51, s51, s35
    buffer_load_dwordx4 v1, s[4:7], s51 offen offset:0 sc1 lds
    buffer_load_dwordx4 v1, s[4:7], s51 offen offset:1024 sc1 lds
    buffer_load_dwordx4 v2, s[4:7], s51 offen offset:2048 sc1 lds
    buffer_load_dwordx4 v2, s[4:7], s51 offen offset:3072 sc1 lds
    s_waitcnt vmcnt(4)
    s_barrier
    s_cmp_eq_u32 s28, 2
    s_cselect_b32 s48, 6, 2
    s_lshl_b32 s51, s48, 11
    s_add_u32 m0, s30, 92160
    s_add_u32 s51, s51, s35
    buffer_load_dwordx4 v1, s[4:7], s51 offen offset:0 sc1 lds
    buffer_load_dwordx4 v1, s[4:7], s51 offen offset:1024 sc1 lds
    buffer_load_dwordx4 v2, s[4:7], s51 offen offset:2048 sc1 lds
    buffer_load_dwordx4 v2, s[4:7], s51 offen offset:3072 sc1 lds
    s_cmp_eq_u32 s28, 3
    s_cselect_b32 s48, 7, 3
    s_lshl_b32 s51, s48, 11
    s_add_u32 m0, s30, 129024
    s_add_u32 s51, s51, s35
    buffer_load_dwordx4 v1, s[4:7], s51 offen offset:0 sc1 lds
    buffer_load_dwordx4 v1, s[4:7], s51 offen offset:1024 sc1 lds
    buffer_load_dwordx4 v2, s[4:7], s51 offen offset:2048 sc1 lds
    buffer_load_dwordx4 v2, s[4:7], s51 offen offset:3072 sc1 lds
    s_waitcnt vmcnt(8)
    s_barrier
    s_cmp_eq_u32 s28, 0
    s_cselect_b32 s48, 8, 4
    s_mul_i32 s50, s48, 18432
    s_add_u32 s50, s50, s34
    s_add_u32 m0, s30, 0
    s_mov_b32 s53, s50
    buffer_load_dwordx4 v1, s[4:7], s50 offen offset:0  lds
    buffer_load_dwordx4 v1, s[4:7], s50 offen offset:1024  lds
    buffer_load_dwordx4 v1, s[4:7], s50 offen offset:2048  lds
    buffer_load_dwordx4 v1, s[4:7], s50 offen offset:3072  lds
    s_cmp_eq_u32 s28, 0
    s_cselect_b32 s48, 8, 4
    s_lshl_b32 s51, s48, 11
    s_add_u32 m0, s30, 18432
    s_add_u32 s51, s51, s35
    buffer_load_dwordx4 v1, s[4:7], s51 offen offset:0 sc1 lds
    buffer_load_dwordx4 v1, s[4:7], s51 offen offset:1024 sc1 lds
    buffer_load_dwordx4 v2, s[4:7], s51 offen offset:2048 sc1 lds
    buffer_load_dwordx4 v2, s[4:7], s51 offen offset:3072 sc1 lds
    s_waitcnt vmcnt(12)
    s_barrier
    s_cmp_eq_u32 s28, 1
    s_cselect_b32 s48, 1, 5
    s_mul_i32 s50, s48, 18432
    s_add_u32 s50, s50, s34
    s_cmp_ge_u32 s20, 2
    s_cselect_b32 s52, s50, s53
    s_add_u32 m0, s31, 0
    s_add_u32 s52, s52, s49
    buffer_load_dwordx4 v1, s[4:7], s52 offen  lds
    s_add_u32 m0, s30, 36864
    s_mov_b32 s53, s50
    buffer_load_dwordx4 v1, s[4:7], s50 offen offset:0  lds
    buffer_load_dwordx4 v1, s[4:7], s50 offen offset:1024  lds
    buffer_load_dwordx4 v1, s[4:7], s50 offen offset:2048  lds
    buffer_load_dwordx4 v1, s[4:7], s50 offen offset:3072  lds
    s_cmp_eq_u32 s28, 1
    s_cselect_b32 s48, 1, 5
    s_lshl_b32 s51, s48, 11
    s_add_u32 m0, s30, 55296
    s_add_u32 s51, s51, s35
    buffer_load_dwordx4 v1, s[4:7], s51 offen offset:0 sc1 lds
    buffer_load_dwordx4 v1, s[4:7], s51 offen offset:1024 sc1 lds
    buffer_load_dwordx4 v2, s[4:7], s51 offen offset:2048 sc1 lds
    buffer_load_dwordx4 v2, s[4:7], s51 offen offset:3072 sc1 lds
    s_waitcnt vmcnt(17)
    s_barrier
    s_cmp_eq_u32 s28, 2
    s_cselect_b32 s48, 2, 6
    s_mul_i32 s50, s48, 18432
    s_add_u32 s50, s50, s34
    s_add_u32 m0, s30, 73728
    s_mov_b32 s53, s50
    buffer_load_dwordx4 v1, s[4:7], s50 offen offset:0  lds
    buffer_load_dwordx4 v1, s[4:7], s50 offen offset:1024  lds
    buffer_load_dwordx4 v1, s[4:7], s50 offen offset:2048  lds
    buffer_load_dwordx4 v1, s[4:7], s50 offen offset:3072  lds
    s_cmp_eq_u32 s28, 2
    s_cselect_b32 s48, 2, 6
    s_lshl_b32 s51, s48, 11
    s_add_u32 m0, s30, 92160
    s_add_u32 s51, s51, s35
    buffer_load_dwordx4 v1, s[4:7], s51 offen offset:0 sc1 lds
    buffer_load_dwordx4 v1, s[4:7], s51 offen offset:1024 sc1 lds
    buffer_load_dwordx4 v2, s[4:7], s51 offen offset:2048 sc1 lds
    buffer_load_dwordx4 v2, s[4:7], s51 offen offset:3072 sc1 lds
    s_waitcnt vmcnt(16)
    s_barrier
    s_cmp_eq_u32 s28, 3
    s_cselect_b32 s48, 3, 7
    s_mul_i32 s50, s48, 18432
    s_add_u32 s50, s50, s34
    s_cmp_ge_u32 s20, 2
    s_cselect_b32 s52, s50, s53
    s_add_u32 m0, s31, 73728
    s_add_u32 s52, s52, s49
    buffer_load_dwordx4 v1, s[4:7], s52 offen  lds
    s_add_u32 m0, s30, 110592
    s_mov_b32 s53, s50
    buffer_load_dwordx4 v1, s[4:7], s50 offen offset:0  lds
    buffer_load_dwordx4 v1, s[4:7], s50 offen offset:1024  lds
    buffer_load_dwordx4 v1, s[4:7], s50 offen offset:2048  lds
    buffer_load_dwordx4 v1, s[4:7], s50 offen offset:3072  lds
    s_cmp_eq_u32 s28, 3
    s_cselect_b32 s48, 3, 7
    s_lshl_b32 s51, s48, 11
    s_add_u32 m0, s30, 129024
    s_add_u32 s51, s51, s35
    buffer_load_dwordx4 v1, s[4:7], s51 offen offset:0 sc1 lds
    buffer_load_dwordx4 v1, s[4:7], s51 offen offset:1024 sc1 lds
    buffer_load_dwordx4 v2, s[4:7], s51 offen offset:2048 sc1 lds
    buffer_load_dwordx4 v2, s[4:7], s51 offen offset:3072 sc1 lds
    s_waitcnt vmcnt(17)
    s_barrier
    s_cmp_eq_u32 s28, 0
    s_cselect_b32 s48, 0, 8
    s_mul_i32 s50, s48, 18432
    s_add_u32 s50, s50, s34
    s_add_u32 m0, s30, 0
    s_mov_b32 s53, s50
    buffer_load_dwordx4 v1, s[4:7], s50 offen offset:0  lds
    buffer_load_dwordx4 v1, s[4:7], s50 offen offset:1024  lds
    buffer_load_dwordx4 v1, s[4:7], s50 offen offset:2048  lds
    buffer_load_dwordx4 v1, s[4:7], s50 offen offset:3072  lds
    s_cmp_eq_u32 s28, 0
    s_cselect_b32 s48, 0, 8
    s_lshl_b32 s51, s48, 11
    s_add_u32 m0, s30, 18432
    s_add_u32 s51, s51, s35
    buffer_load_dwordx4 v1, s[4:7], s51 offen offset:0 sc1 lds
    buffer_load_dwordx4 v1, s[4:7], s51 offen offset:1024 sc1 lds
    buffer_load_dwordx4 v2, s[4:7], s51 offen offset:2048 sc1 lds
    buffer_load_dwordx4 v2, s[4:7], s51 offen offset:3072 sc1 lds
    s_waitcnt vmcnt(16)
    s_barrier
    s_cmp_eq_u32 s28, 0
    s_cselect_b32 s48, 4, 0
    s_mul_i32 s50, s48, 18432
    s_add_u32 s50, s50, s34
    s_add_u32 s50, s50, 165888
    s_cmp_ge_u32 s20, 2
    s_cselect_b32 s52, s50, s53
    s_add_u32 m0, s31, 0
    s_add_u32 s52, s52, s49
    buffer_load_dwordx4 v1, s[4:7], s52 offen  lds
    s_add_u32 m0, s30, 36864
    s_mov_b32 s53, s50
    buffer_load_dwordx4 v1, s[4:7], s50 offen offset:0  lds
    buffer_load_dwordx4 v1, s[4:7], s50 offen offset:1024  lds
    buffer_load_dwordx4 v1, s[4:7], s50 offen offset:2048  lds
    buffer_load_dwordx4 v1, s[4:7], s50 offen offset:3072  lds
    s_cmp_eq_u32 s28, 0
    s_cselect_b32 s48, 4, 0
    s_lshl_b32 s51, s48, 11
    s_add_u32 m0, s30, 55296
    s_add_u32 s51, s51, s35
    buffer_load_dwordx4 v1, s[4:7], s51 offen offset:0 sc1 lds
    buffer_load_dwordx4 v1, s[4:7], s51 offen offset:1024 sc1 lds
    buffer_load_dwordx4 v2, s[4:7], s51 offen offset:2048 sc1 lds
    buffer_load_dwordx4 v2, s[4:7], s51 offen offset:3072 sc1 lds
    s_waitcnt vmcnt(17)
    s_barrier
    s_cmp_eq_u32 s28, 1
    s_cselect_b32 s48, 5, 1
    s_mul_i32 s50, s48, 18432
    s_add_u32 s50, s50, s34
    s_add_u32 s50, s50, 165888
    s_add_u32 m0, s30, 73728
    s_mov_b32 s53, s50
    buffer_load_dwordx4 v1, s[4:7], s50 offen offset:0  lds
    buffer_load_dwordx4 v1, s[4:7], s50 offen offset:1024  lds
    buffer_load_dwordx4 v1, s[4:7], s50 offen offset:2048  lds
    buffer_load_dwordx4 v1, s[4:7], s50 offen offset:3072  lds
    s_cmp_eq_u32 s28, 1
    s_cselect_b32 s48, 5, 1
    s_lshl_b32 s51, s48, 11
    s_add_u32 m0, s30, 92160
    s_add_u32 s51, s51, s35
    buffer_load_dwordx4 v1, s[4:7], s51 offen offset:0 sc1 lds
    buffer_load_dwordx4 v1, s[4:7], s51 offen offset:1024 sc1 lds
    buffer_load_dwordx4 v2, s[4:7], s51 offen offset:2048 sc1 lds
    buffer_load_dwordx4 v2, s[4:7], s51 offen offset:3072 sc1 lds
    s_waitcnt vmcnt(16)
    s_barrier
    s_cmp_eq_u32 s28, 2
    s_cselect_b32 s48, 6, 2
    s_mul_i32 s50, s48, 18432
    s_add_u32 s50, s50, s34
    s_add_u32 s50, s50, 165888
    s_cmp_ge_u32 s20, 2
    s_cselect_b32 s52, s50, s53
    s_add_u32 m0, s31, 73728
    s_add_u32 s52, s52, s49
    buffer_load_dwordx4 v1, s[4:7], s52 offen  lds
    s_add_u32 m0, s30, 110592
    s_mov_b32 s53, s50
    buffer_load_dwordx4 v1, s[4:7], s50 offen offset:0  lds
    buffer_load_dwordx4 v1, s[4:7], s50 offen offset:1024  lds
    buffer_load_dwordx4 v1, s[4:7], s50 offen offset:2048  lds
    buffer_load_dwordx4 v1, s[4:7], s50 offen offset:3072  lds
    s_cmp_eq_u32 s28, 2
    s_cselect_b32 s48, 6, 2
    s_lshl_b32 s51, s48, 11
    s_add_u32 m0, s30, 129024
    s_add_u32 s51, s51, s35
    buffer_load_dwordx4 v1, s[4:7], s51 offen offset:0 sc1 lds
    buffer_load_dwordx4 v1, s[4:7], s51 offen offset:1024 sc1 lds
    buffer_load_dwordx4 v2, s[4:7], s51 offen offset:2048 sc1 lds
    buffer_load_dwordx4 v2, s[4:7], s51 offen offset:3072 sc1 lds
    s_waitcnt vmcnt(17)
    s_barrier
    s_cmp_eq_u32 s28, 3
    s_cselect_b32 s48, 7, 3
    s_mul_i32 s50, s48, 18432
    s_add_u32 s50, s50, s34
    s_add_u32 s50, s50, 165888
    s_add_u32 m0, s30, 0
    s_mov_b32 s53, s50
    buffer_load_dwordx4 v1, s[4:7], s50 offen offset:0  lds
    buffer_load_dwordx4 v1, s[4:7], s50 offen offset:1024  lds
    buffer_load_dwordx4 v1, s[4:7], s50 offen offset:2048  lds
    buffer_load_dwordx4 v1, s[4:7], s50 offen offset:3072  lds
    s_cmp_eq_u32 s28, 3
    s_cselect_b32 s48, 7, 3
    s_lshl_b32 s51, s48, 11
    s_add_u32 m0, s30, 18432
    s_add_u32 s51, s51, s35
    buffer_load_dwordx4 v1, s[4:7], s51 offen offset:0 sc1 lds
    buffer_load_dwordx4 v1, s[4:7], s51 offen offset:1024 sc1 lds
    buffer_load_dwordx4 v2, s[4:7], s51 offen offset:2048 sc1 lds
    buffer_load_dwordx4 v2, s[4:7], s51 offen offset:3072 sc1 lds
    s_cmp_lg_u32 s22, 0
    s_cbranch_scc1 L_g_nw
    s_lshl_b32 s33, s2, 15
    s_lshl_b32 s37, s20, 13
    s_add_u32 s33, s33, s37
    s_add_u32 s37, s33, 4096
    buffer_load_dwordx4 v[16:19], v1, s[8:11], s33 offen offset:0
    buffer_load_dwordx4 v[20:23], v1, s[8:11], s33 offen offset:1024
    buffer_load_dwordx4 v[24:27], v1, s[8:11], s33 offen offset:2048
    buffer_load_dwordx4 v[28:31], v1, s[8:11], s33 offen offset:3072
    buffer_load_dwordx4 v[32:35], v1, s[8:11], s37 offen offset:0
    buffer_load_dwordx4 v[36:39], v1, s[8:11], s37 offen offset:1024
    buffer_load_dwordx4 v[40:43], v1, s[8:11], s37 offen offset:2048
    buffer_load_dwordx4 v[44:47], v1, s[8:11], s37 offen offset:3072
L_g_nw:
    s_waitcnt vmcnt(16)
    s_barrier
    s_cmp_eq_u32 s28, 0
    s_cselect_b32 s48, 8, 4
    s_mul_i32 s50, s48, 18432
    s_add_u32 s50, s50, s34
    s_add_u32 s50, s50, 165888
    s_cmp_ge_u32 s20, 2
    s_cselect_b32 s52, s50, s53
    s_add_u32 m0, s31, 0
    s_add_u32 s52, s52, s49
    buffer_load_dwordx4 v1, s[4:7], s52 offen  lds
    s_add_u32 m0, s30, 36864
    s_mov_b32 s53, s50
    buffer_load_dwordx4 v1, s[4:7], s50 offen offset:0  lds
    buffer_load_dwordx4 v1, s[4:7], s50 offen offset:1024  lds
    buffer_load_dwordx4 v1, s[4:7], s50 offen offset:2048  lds
    buffer_load_dwordx4 v1, s[4:7], s50 offen offset:3072  lds
    s_cmp_eq_u32 s28, 0
    s_cselect_b32 s48, 8, 4
    s_lshl_b32 s51, s48, 11
    s_add_u32 m0, s30, 55296
    s_add_u32 s51, s51, s35
    buffer_load_dwordx4 v1, s[4:7], s51 offen offset:0 sc1 lds
    buffer_load_dwordx4 v1, s[4:7], s51 offen offset:1024 sc1 lds
    buffer_load_dwordx4 v2, s[4:7], s51 offen offset:2048 sc1 lds
    buffer_load_dwordx4 v2, s[4:7], s51 offen offset:3072 sc1 lds
    s_waitcnt vmcnt(17)
    s_barrier
    s_cmp_eq_u32 s28, 1
    s_cselect_b32 s48, 1, 5
    s_mul_i32 s50, s48, 18432
    s_add_u32 s50, s50, s34
    s_add_u32 s50, s50, 165888
    s_add_u32 m0, s30, 73728
    s_mov_b32 s53, s50
    buffer_load_dwordx4 v1, s[4:7], s50 offen offset:0  lds
    buffer_load_dwordx4 v1, s[4:7], s50 offen offset:1024  lds
    buffer_load_dwordx4 v1, s[4:7], s50 offen offset:2048  lds
    buffer_load_dwordx4 v1, s[4:7], s50 offen offset:3072  lds
    s_cmp_eq_u32 s28, 1
    s_cselect_b32 s48, 1, 5
    s_lshl_b32 s51, s48, 11
    s_add_u32 m0, s30, 92160
    s_add_u32 s51, s51, s35
    buffer_load_dwordx4 v1, s[4:7], s51 offen offset:0 sc1 lds
    buffer_load_dwordx4 v1, s[4:7], s51 offen offset:1024 sc1 lds
    buffer_load_dwordx4 v2, s[4:7], s51 offen offset:2048 sc1 lds
    buffer_load_dwordx4 v2, s[4:7], s51 offen offset:3072 sc1 lds
    s_waitcnt vmcnt(16)
    s_barrier
    s_cmp_eq_u32 s28, 2
    s_cselect_b32 s48, 2, 6
    s_mul_i32 s50, s48, 18432
    s_add_u32 s50, s50, s34
    s_add_u32 s50, s50, 165888
    s_cmp_ge_u32 s20, 2
    s_cselect_b32 s52, s50, s53
    s_add_u32 m0, s31, 73728
    s_add_u32 s52, s52, s49
    buffer_load_dwordx4 v1, s[4:7], s52 offen  lds
    s_add_u32 m0, s30, 110592
    s_mov_b32 s53, s50
    buffer_load_dwordx4 v1, s[4:7], s50 offen offset:0  lds
    buffer_load_dwordx4 v1, s[4:7], s50 offen offset:1024  lds
    buffer_load_dwordx4 v1, s[4:7], s50 offen offset:2048  lds
    buffer_load_dwordx4 v1, s[4:7], s50 offen offset:3072  lds
    s_cmp_eq_u32 s28, 2
    s_cselect_b32 s48, 2, 6
    s_lshl_b32 s51, s48, 11
    s_add_u32 m0, s30, 129024
    s_add_u32 s51, s51, s35
    buffer_load_dwordx4 v1, s[4:7], s51 offen offset:0 sc1 lds
    buffer_load_dwordx4 v1, s[4:7], s51 offen offset:1024 sc1 lds
    buffer_load_dwordx4 v2, s[4:7], s51 offen offset:2048 sc1 lds
    buffer_load_dwordx4 v2, s[4:7], s51 offen offset:3072 sc1 lds
    s_waitcnt vmcnt(17)
    s_barrier
    s_cmp_eq_u32 s28, 3
    s_cselect_b32 s48, 3, 7
    s_mul_i32 s50, s48, 18432
    s_add_u32 s50, s50, s34
    s_add_u32 s50, s50, 165888
    s_add_u32 m0, s30, 0
    s_mov_b32 s53, s50
    buffer_load_dwordx4 v1, s[4:7], s50 offen offset:0  lds
    buffer_load_dwordx4 v1, s[4:7], s50 offen offset:1024  lds
    buffer_load_dwordx4 v1, s[4:7], s50 offen offset:2048  lds
    buffer_load_dwordx4 v1, s[4:7], s50 offen offset:3072  lds
    s_cmp_eq_u32 s28, 3
    s_cselect_b32 s48, 3, 7
    s_lshl_b32 s51, s48, 11
    s_add_u32 m0, s30, 18432
    s_add_u32 s51, s51, s35
    buffer_load_dwordx4 v1, s[4:7], s51 offen offset:0 sc1 lds
    buffer_load_dwordx4 v1, s[4:7], s51 offen offset:1024 sc1 lds
    buffer_load_dwordx4 v2, s[4:7], s51 offen offset:2048 sc1 lds
    buffer_load_dwordx4 v2, s[4:7], s51 offen offset:3072 sc1 lds
    s_waitcnt vmcnt(16)
    s_barrier
    s_cmp_eq_u32 s28, 0
    s_cselect_b32 s48, 0, 8
    s_mul_i32 s50, s48, 18432
    s_add_u32 s50, s50, s34
    s_add_u32 s50, s50, 165888
    s_cmp_ge_u32 s20, 2
    s_cselect_b32 s52, s50, s53
    s_add_u32 m0, s31, 0
    s_add_u32 s52, s52, s49
    buffer_load_dwordx4 v1, s[4:7], s52 offen  lds
    s_add_u32 m0, s30, 36864
    s_mov_b32 s53, s50
    buffer_load_dwordx4 v1, s[4:7], s50 offen offset:0  lds
    buffer_load_dwordx4 v1, s[4:7], s50 offen offset:1024  lds
    buffer_load_dwordx4 v1, s[4:7], s50 offen offset:2048  lds
    buffer_load_dwordx4 v1, s[4:7], s50 offen offset:3072  lds
    s_cmp_eq_u32 s28, 0
    s_cselect_b32 s48, 0, 8
    s_lshl_b32 s51, s48, 11
    s_add_u32 m0, s30, 55296
    s_add_u32 s51, s51, s35
    buffer_load_dwordx4 v1, s[4:7], s51 offen offset:0 sc1 lds
    buffer_load_dwordx4 v1, s[4:7], s51 offen offset:1024 sc1 lds
    buffer_load_dwordx4 v2, s[4:7], s51 offen offset:2048 sc1 lds
    buffer_load_dwordx4 v2, s[4:7], s51 offen offset:3072 sc1 lds
    s_waitcnt vmcnt(17)
    s_barrier
    s_add_u32 m0, s30, 92160
    s_lshl_b32 s51, s44, 7
    buffer_load_dwordx4 v8, s[8:11], s51 offen offset:0  lds
    buffer_load_dwordx4 v9, s[8:11], s51 offen offset:1024  lds
    buffer_load_dwordx4 v10, s[8:11], s51 offen offset:2048  lds
    buffer_load_dwordx4 v11, s[8:11], s51 offen offset:3072  lds
    s_waitcnt vmcnt(12)
    s_barrier
    s_add_u32 m0, s30, 129024
    s_lshl_b32 s51, s45, 7
    buffer_load_dwordx4 v8, s[8:11], s51 offen offset:0  lds
    buffer_load_dwordx4 v9, s[8:11], s51 offen offset:1024  lds
    buffer_load_dwordx4 v10, s[8:11], s51 offen offset:2048  lds
    buffer_load_dwordx4 v11, s[8:11], s51 offen offset:3072  lds
    s_waitcnt vmcnt(8)
    s_barrier
    s_add_u32 m0, s30, 18432
    s_lshl_b32 s51, s46, 7
    buffer_load_dwordx4 v8, s[8:11], s51 offen offset:0  lds
    buffer_load_dwordx4 v9, s[8:11], s51 offen offset:1024  lds
    buffer_load_dwordx4 v10, s[8:11], s51 offen offset:2048  lds
    buffer_load_dwordx4 v11, s[8:11], s51 offen offset:3072  lds
    s_barrier
    s_mov_b32 s56, 1
    s_atomic_add s56, s[54:55], 0
    s_add_u32 m0, s30, 55296
    s_lshl_b32 s51, s47, 7
    buffer_load_dwordx4 v8, s[8:11], s51 offen offset:0  lds
    buffer_load_dwordx4 v9, s[8:11], s51 offen offset:1024  lds
    buffer_load_dwordx4 v10, s[8:11], s51 offen offset:2048  lds
    buffer_load_dwordx4 v11, s[8:11], s51 offen offset:3072  lds
    s_and_b32 s40, s2, 7
    s_lshr_b32 s26, s2, 3
    s_lshl_b32 s38, s40, 2
    s_lshr_b32 s27, s26, 3
    s_add_u32 s38, s38, s27
    s_and_b32 s39, s26, 7
    s_add_u32 s40, s38, s39
    s_and_b32 s40, s40, 3
    s_mul_i32 s42, s20, 9216
    s_mul_i32 s43, s39, 331776
    s_add_u32 s43, s43, s42
    s_add_u32 s43, s43, 0x4100000
    s_mov_b32 s60, 65536
L_poll_z2:
    s_mov_b32 s57, 0
    s_atomic_add s57, s[54:55], 0 glc
    s_waitcnt lgkmcnt(0)
    s_cmp_ge_u32 s57, 16
    s_cbranch_scc1 L_pd_z2
    s_sub_u32 s60, s60, 1
    s_cbranch_scc1 L_pd_z2
    s_sleep 2
    s_branch L_poll_z2
L_pd_z2:
    s_mul_i32 s50, s44, 18432
    s_add_u32 s50, s50, s36
    s_add_u32 m0, s30, 73728
    s_mov_b32 s53, s50
    buffer_load_dwordx4 v1, s[4:7], s50 offen offset:0 sc1 lds
    buffer_load_dwordx4 v1, s[4:7], s50 offen offset:1024 sc1 lds
    buffer_load_dwordx4 v1, s[4:7], s50 offen offset:2048 sc1 lds
    buffer_load_dwordx4 v1, s[4:7], s50 offen offset:3072 sc1 lds
    s_mul_i32 s50, s45, 18432
    s_add_u32 s50, s50, s36
    s_cmp_ge_u32 s20, 2
    s_cselect_b32 s52, s50, s53
    s_add_u32 m0, s31, 73728
    s_add_u32 s52, s52, s49
    buffer_load_dwordx4 v1, s[4:7], s52 offen sc1 lds
    s_add_u32 m0, s30, 110592
    s_mov_b32 s53, s50
    buffer_load_dwordx4 v1, s[4:7], s50 offen offset:0 sc1 lds
    buffer_load_dwordx4 v1, s[4:7], s50 offen offset:1024 sc1 lds
    buffer_load_dwordx4 v1, s[4:7], s50 offen offset:2048 sc1 lds
    buffer_load_dwordx4 v1, s[4:7], s50 offen offset:3072 sc1 lds
    s_waitcnt vmcnt(4)
    s_barrier
    s_mul_i32 s50, s46, 18432
    s_add_u32 s50, s50, s36
    s_add_u32 m0, s30, 0
    s_mov_b32 s53, s50
    buffer_load_dwordx4 v1, s[4:7], s50 offen offset:0 sc1 lds
    buffer_load_dwordx4 v1, s[4:7], s50 offen offset:1024 sc1 lds
    buffer_load_dwordx4 v1, s[4:7], s50 offen offset:2048 sc1 lds
    buffer_load_dwordx4 v1, s[4:7], s50 offen offset:3072 sc1 lds
    s_mul_i32 s50, s47, 18432
    s_add_u32 s50, s50, s36
    s_cmp_ge_u32 s20, 2
    s_cselect_b32 s52, s50, s53
    s_add_u32 m0, s31, 0
    s_add_u32 s52, s52, s49
    buffer_load_dwordx4 v1, s[4:7], s52 offen sc1 lds
    s_add_u32 m0, s30, 36864
    s_mov_b32 s53, s50
    buffer_load_dwordx4 v1, s[4:7], s50 offen offset:0 sc1 lds
    buffer_load_dwordx4 v1, s[4:7], s50 offen offset:1024 sc1 lds
    buffer_load_dwordx4 v1, s[4:7], s50 offen offset:2048 sc1 lds
    buffer_load_dwordx4 v1, s[4:7], s50 offen offset:3072 sc1 lds
    s_add_u32 s44, s44, 4
    s_and_b32 s44, s44, 31
    s_add_u32 s45, s45, 4
    s_and_b32 s45, s45, 31
    s_add_u32 s46, s46, 4
    s_and_b32 s46, s46, 31
    s_add_u32 s47, s47, 4
    s_and_b32 s47, s47, 31
    s_waitcnt vmcnt(9)
    s_barrier
    s_mul_i32 s50, s44, 18432
    s_add_u32 s50, s50, s36
    s_add_u32 m0, s30, 73728
    s_mov_b32 s53, s50
    buffer_load_dwordx4 v1, s[4:7], s50 offen offset:0 sc1 lds
    buffer_load_dwordx4 v1, s[4:7], s50 offen offset:1024 sc1 lds
    buffer_load_dwordx4 v1, s[4:7], s50 offen offset:2048 sc1 lds
    buffer_load_dwordx4 v1, s[4:7], s50 offen offset:3072 sc1 lds
    s_add_u32 m0, s30, 92160
    s_lshl_b32 s51, s44, 7
    buffer_load_dwordx4 v8, s[8:11], s51 offen offset:0  lds
    buffer_load_dwordx4 v9, s[8:11], s51 offen offset:1024  lds
    buffer_load_dwordx4 v10, s[8:11], s51 offen offset:2048  lds
    buffer_load_dwordx4 v11, s[8:11], s51 offen offset:3072  lds
    s_add_u32 s44, s44, 4
    s_and_b32 s44, s44, 31
    s_waitcnt vmcnt(12)
    s_barrier
    s_mul_i32 s50, s45, 18432
    s_add_u32 s50, s50, s36
    s_cmp_ge_u32 s20, 2
    s_cselect_b32 s52, s50, s53
    s_add_u32 m0, s31, 73728
    s_add_u32 s52, s52, s49
    buffer_load_dwordx4 v1, s[4:7], s52 offen sc1 lds
    s_add_u32 m0, s30, 110592
    s_mov_b32 s53, s50
    buffer_load_dwordx4 v1, s[4:7], s50 offen offset:0 sc1 lds
    buffer_load_dwordx4 v1, s[4:7], s50 offen offset:1024 sc1 lds
    buffer_load_dwordx4 v1, s[4:7], s50 offen offset:2048 sc1 lds
    buffer_load_dwordx4 v1, s[4:7], s50 offen offset:3072 sc1 lds
    s_add_u32 m0, s30, 129024
    s_lshl_b32 s51, s45, 7
    buffer_load_dwordx4 v8, s[8:11], s51 offen offset:0  lds
    buffer_load_dwordx4 v9, s[8:11], s51 offen offset:1024  lds
    buffer_load_dwordx4 v10, s[8:11], s51 offen offset:2048  lds
    buffer_load_dwordx4 v11, s[8:11], s51 offen offset:3072  lds
    s_add_u32 s45, s45, 4
    s_and_b32 s45, s45, 31
    s_waitcnt vmcnt(17)
    s_barrier
    s_mul_i32 s50, s46, 18432
    s_add_u32 s50, s50, s36
    s_add_u32 m0, s30, 0
    s_mov_b32 s53, s50
    buffer_load_dwordx4 v1, s[4:7], s50 offen offset:0 sc1 lds
    buffer_load_dwordx4 v1, s[4:7], s50 offen offset:1024 sc1 lds
    buffer_load_dwordx4 v1, s[4:7], s50 offen offset:2048 sc1 lds
    buffer_load_dwordx4 v1, s[4:7], s50 offen offset:3072 sc1 lds
    s_add_u32 m0, s30, 18432
    s_lshl_b32 s51, s46, 7
    buffer_load_dwordx4 v8, s[8:11], s51 offen offset:0  lds
    buffer_load_dwordx4 v9, s[8:11], s51 offen offset:1024  lds
    buffer_load_dwordx4 v10, s[8:11], s51 offen offset:2048  lds
    buffer_load_dwordx4 v11, s[8:11], s51 offen offset:3072  lds
    s_add_u32 s46, s46, 4
    s_and_b32 s46, s46, 31
    s_waitcnt vmcnt(16)
    s_barrier
    s_mul_i32 s50, s47, 18432
    s_add_u32 s50, s50, s36
    s_cmp_ge_u32 s20, 2
    s_cselect_b32 s52, s50, s53
    s_add_u32 m0, s31, 0
    s_add_u32 s52, s52, s49
    buffer_load_dwordx4 v1, s[4:7], s52 offen sc1 lds
    s_add_u32 m0, s30, 36864
    s_mov_b32 s53, s50
    buffer_load_dwordx4 v1, s[4:7], s50 offen offset:0 sc1 lds
    buffer_load_dwordx4 v1, s[4:7], s50 offen offset:1024 sc1 lds
    buffer_load_dwordx4 v1, s[4:7], s50 offen offset:2048 sc1 lds
    buffer_load_dwordx4 v1, s[4:7], s50 offen offset:3072 sc1 lds
    s_add_u32 m0, s30, 55296
    s_lshl_b32 s51, s47, 7
    buffer_load_dwordx4 v8, s[8:11], s51 offen offset:0  lds
    buffer_load_dwordx4 v9, s[8:11], s51 offen offset:1024  lds
    buffer_load_dwordx4 v10, s[8:11], s51 offen offset:2048  lds
    buffer_load_dwordx4 v11, s[8:11], s51 offen offset:3072  lds
    s_add_u32 s47, s47, 4
    s_and_b32 s47, s47, 31
    s_mov_b32 s41, 6
L_g_ll:
    s_waitcnt vmcnt(17)
    s_barrier
    s_mul_i32 s50, s44, 18432
    s_add_u32 s50, s50, s36
    s_add_u32 m0, s30, 73728
    s_mov_b32 s53, s50
    buffer_load_dwordx4 v1, s[4:7], s50 offen offset:0 sc1 lds
    buffer_load_dwordx4 v1, s[4:7], s50 offen offset:1024 sc1 lds
    buffer_load_dwordx4 v1, s[4:7], s50 offen offset:2048 sc1 lds
    buffer_load_dwordx4 v1, s[4:7], s50 offen offset:3072 sc1 lds
    s_add_u32 m0, s30, 92160
    s_lshl_b32 s51, s44, 7
    buffer_load_dwordx4 v8, s[8:11], s51 offen offset:0  lds
    buffer_load_dwordx4 v9, s[8:11], s51 offen offset:1024  lds
    buffer_load_dwordx4 v10, s[8:11], s51 offen offset:2048  lds
    buffer_load_dwordx4 v11, s[8:11], s51 offen offset:3072  lds
    s_add_u32 s44, s44, 4
    s_and_b32 s44, s44, 31
    s_waitcnt vmcnt(16)
    s_barrier
    s_mul_i32 s50, s45, 18432
    s_add_u32 s50, s50, s36
    s_cmp_ge_u32 s20, 2
    s_cselect_b32 s52, s50, s53
    s_add_u32 m0, s31, 73728
    s_add_u32 s52, s52, s49
    buffer_load_dwordx4 v1, s[4:7], s52 offen sc1 lds
    s_add_u32 m0, s30, 110592
    s_mov_b32 s53, s50
    buffer_load_dwordx4 v1, s[4:7], s50 offen offset:0 sc1 lds
    buffer_load_dwordx4 v1, s[4:7], s50 offen offset:1024 sc1 lds
    buffer_load_dwordx4 v1, s[4:7], s50 offen offset:2048 sc1 lds
    buffer_load_dwordx4 v1, s[4:7], s50 offen offset:3072 sc1 lds
    s_add_u32 m0, s30, 129024
    s_lshl_b32 s51, s45, 7
    buffer_load_dwordx4 v8, s[8:11], s51 offen offset:0  lds
    buffer_load_dwordx4 v9, s[8:11], s51 offen offset:1024  lds
    buffer_load_dwordx4 v10, s[8:11], s51 offen offset:2048  lds
    buffer_load_dwordx4 v11, s[8:11], s51 offen offset:3072  lds
    s_add_u32 s45, s45, 4
    s_and_b32 s45, s45, 31
    s_waitcnt vmcnt(17)
    s_barrier
    s_mul_i32 s50, s46, 18432
    s_add_u32 s50, s50, s36
    s_add_u32 m0, s30, 0
    s_mov_b32 s53, s50
    buffer_load_dwordx4 v1, s[4:7], s50 offen offset:0 sc1 lds
    buffer_load_dwordx4 v1, s[4:7], s50 offen offset:1024 sc1 lds
    buffer_load_dwordx4 v1, s[4:7], s50 offen offset:2048 sc1 lds
    buffer_load_dwordx4 v1, s[4:7], s50 offen offset:3072 sc1 lds
    s_add_u32 m0, s30, 18432
    s_lshl_b32 s51, s46, 7
    buffer_load_dwordx4 v8, s[8:11], s51 offen offset:0  lds
    buffer_load_dwordx4 v9, s[8:11], s51 offen offset:1024  lds
    buffer_load_dwordx4 v10, s[8:11], s51 offen offset:2048  lds
    buffer_load_dwordx4 v11, s[8:11], s51 offen offset:3072  lds
    s_add_u32 s46, s46, 4
    s_and_b32 s46, s46, 31
    s_waitcnt vmcnt(16)
    s_barrier
    s_mul_i32 s50, s47, 18432
    s_add_u32 s50, s50, s36
    s_cmp_ge_u32 s20, 2
    s_cselect_b32 s52, s50, s53
    s_add_u32 m0, s31, 0
    s_add_u32 s52, s52, s49
    buffer_load_dwordx4 v1, s[4:7], s52 offen sc1 lds
    s_add_u32 m0, s30, 36864
    s_mov_b32 s53, s50
    buffer_load_dwordx4 v1, s[4:7], s50 offen offset:0 sc1 lds
    buffer_load_dwordx4 v1, s[4:7], s50 offen offset:1024 sc1 lds
    buffer_load_dwordx4 v1, s[4:7], s50 offen offset:2048 sc1 lds
    buffer_load_dwordx4 v1, s[4:7], s50 offen offset:3072 sc1 lds
    s_add_u32 m0, s30, 55296
    s_lshl_b32 s51, s47, 7
    buffer_load_dwordx4 v8, s[8:11], s51 offen offset:0  lds
    buffer_load_dwordx4 v9, s[8:11], s51 offen offset:1024  lds
    buffer_load_dwordx4 v10, s[8:11], s51 offen offset:2048  lds
    buffer_load_dwordx4 v11, s[8:11], s51 offen offset:3072  lds
    s_add_u32 s47, s47, 4
    s_and_b32 s47, s47, 31
    s_sub_u32 s41, s41, 1
    s_cmp_lg_u32 s41, 0
    s_cbranch_scc1 L_g_ll
    s_waitcnt vmcnt(17)
    s_barrier
    s_cmp_eq_u32 s40, 0
    s_cselect_b32 s32, 4, 0
    s_mul_i32 s32, s32, 36864
    s_add_u32 s32, s32, s43
    s_add_u32 m0, s42, 73728
    s_add_u32 s33, s32, 0
    buffer_load_dwordx4 v1, s[4:7], s33 offen offset:0  lds
    buffer_load_dwordx4 v1, s[4:7], s33 offen offset:1024  lds
    buffer_load_dwordx4 v1, s[4:7], s33 offen offset:2048  lds
    buffer_load_dwordx4 v1, s[4:7], s33 offen offset:3072  lds
    s_add_u32 m0, s42, 77824
    s_add_u32 s33, s32, 4096
    buffer_load_dwordx4 v1, s[4:7], s33 offen offset:0  lds
    buffer_load_dwordx4 v1, s[4:7], s33 offen offset:1024  lds
    buffer_load_dwordx4 v1, s[4:7], s33 offen offset:2048  lds
    buffer_load_dwordx4 v1, s[4:7], s33 offen offset:3072  lds
    s_add_u32 m0, s42, 81920
    s_add_u32 s33, s32, 8192
    buffer_load_dwordx4 v1, s[4:7], s33 offen offset:0  lds
    s_waitcnt vmcnt(17)
    s_barrier
    s_cmp_eq_u32 s40, 1
    s_cselect_b32 s32, 5, 1
    s_mul_i32 s32, s32, 36864
    s_add_u32 s32, s32, s43
    s_add_u32 m0, s42, 110592
    s_add_u32 s33, s32, 0
    buffer_load_dwordx4 v1, s[4:7], s33 offen offset:0  lds
    buffer_load_dwordx4 v1, s[4:7], s33 offen offset:1024  lds
    buffer_load_dwordx4 v1, s[4:7], s33 offen offset:2048  lds
    buffer_load_dwordx4 v1, s[4:7], s33 offen offset:3072  lds
    s_add_u32 m0, s42, 114688
    s_add_u32 s33, s32, 4096
    buffer_load_dwordx4 v1, s[4:7], s33 offen offset:0  lds
    buffer_load_dwordx4 v1, s[4:7], s33 offen offset:1024  lds
    buffer_load_dwordx4 v1, s[4:7], s33 offen offset:2048  lds
    buffer_load_dwordx4 v1, s[4:7], s33 offen offset:3072  lds
    s_add_u32 m0, s42, 118784
    s_add_u32 s33, s32, 8192
    buffer_load_dwordx4 v1, s[4:7], s33 offen offset:0  lds
    s_waitcnt vmcnt(18)
    s_barrier
    s_cmp_eq_u32 s40, 2
    s_cselect_b32 s32, 6, 2
    s_mul_i32 s32, s32, 36864
    s_add_u32 s32, s32, s43
    s_add_u32 m0, s42, 0
    s_add_u32 s33, s32, 0
    buffer_load_dwordx4 v1, s[4:7], s33 offen offset:0  lds
    buffer_load_dwordx4 v1, s[4:7], s33 offen offset:1024  lds
    buffer_load_dwordx4 v1, s[4:7], s33 offen offset:2048  lds
    buffer_load_dwordx4 v1, s[4:7], s33 offen offset:3072  lds
    s_add_u32 m0, s42, 4096
    s_add_u32 s33, s32, 4096
    buffer_load_dwordx4 v1, s[4:7], s33 offen offset:0  lds
    buffer_load_dwordx4 v1, s[4:7], s33 offen offset:1024  lds
    buffer_load_dwordx4 v1, s[4:7], s33 offen offset:2048  lds
    buffer_load_dwordx4 v1, s[4:7], s33 offen offset:3072  lds
    s_add_u32 m0, s42, 8192
    s_add_u32 s33, s32, 8192
    buffer_load_dwordx4 v1, s[4:7], s33 offen offset:0  lds
    s_barrier
    s_cmp_eq_u32 s40, 3
    s_cselect_b32 s32, 7, 3
    s_mul_i32 s32, s32, 36864
    s_add_u32 s32, s32, s43
    s_add_u32 m0, s42, 36864
    s_add_u32 s33, s32, 0
    buffer_load_dwordx4 v1, s[4:7], s33 offen offset:0  lds
    buffer_load_dwordx4 v1, s[4:7], s33 offen offset:1024  lds
    buffer_load_dwordx4 v1, s[4:7], s33 offen offset:2048  lds
    buffer_load_dwordx4 v1, s[4:7], s33 offen offset:3072  lds
    s_add_u32 m0, s42, 40960
    s_add_u32 s33, s32, 4096
    buffer_load_dwordx4 v1, s[4:7], s33 offen offset:0  lds
    buffer_load_dwordx4 v1, s[4:7], s33 offen offset:1024  lds
    buffer_load_dwordx4 v1, s[4:7], s33 offen offset:2048  lds
    buffer_load_dwordx4 v1, s[4:7], s33 offen offset:3072  lds
    s_add_u32 m0, s42, 45056
    s_add_u32 s33, s32, 8192
    buffer_load_dwordx4 v1, s[4:7], s33 offen offset:0  lds
    s_waitcnt vmcnt(27)
    s_barrier
    s_waitcnt vmcnt(18)
    s_barrier
    s_cmp_eq_u32 s40, 0
    s_cselect_b32 s32, 0, 4
    s_mul_i32 s32, s32, 36864
    s_add_u32 s32, s32, s43
    s_add_u32 m0, s42, 73728
    s_add_u32 s33, s32, 0
    buffer_load_dwordx4 v1, s[4:7], s33 offen offset:0  lds
    buffer_load_dwordx4 v1, s[4:7], s33 offen offset:1024  lds
    buffer_load_dwordx4 v1, s[4:7], s33 offen offset:2048  lds
    buffer_load_dwordx4 v1, s[4:7], s33 offen offset:3072  lds
    s_add_u32 m0, s42, 77824
    s_add_u32 s33, s32, 4096
    buffer_load_dwordx4 v1, s[4:7], s33 offen offset:0  lds
    buffer_load_dwordx4 v1, s[4:7], s33 offen offset:1024  lds
    buffer_load_dwordx4 v1, s[4:7], s33 offen offset:2048  lds
    buffer_load_dwordx4 v1, s[4:7], s33 offen offset:3072  lds
    s_add_u32 m0, s42, 81920
    s_add_u32 s33, s32, 8192
    buffer_load_dwordx4 v1, s[4:7], s33 offen offset:0  lds
    s_waitcnt vmcnt(18)
    s_barrier
    s_cmp_eq_u32 s40, 1
    s_cselect_b32 s32, 1, 5
    s_mul_i32 s32, s32, 36864
    s_add_u32 s32, s32, s43
    s_add_u32 m0, s42, 110592
    s_add_u32 s33, s32, 0
    buffer_load_dwordx4 v1, s[4:7], s33 offen offset:0  lds
    buffer_load_dwordx4 v1, s[4:7], s33 offen offset:1024  lds
    buffer_load_dwordx4 v1, s[4:7], s33 offen offset:2048  lds
    buffer_load_dwordx4 v1, s[4:7], s33 offen offset:3072  lds
    s_add_u32 m0, s42, 114688
    s_add_u32 s33, s32, 4096
    buffer_load_dwordx4 v1, s[4:7], s33 offen offset:0  lds
    buffer_load_dwordx4 v1, s[4:7], s33 offen offset:1024  lds
    buffer_load_dwordx4 v1, s[4:7], s33 offen offset:2048  lds
    buffer_load_dwordx4 v1, s[4:7], s33 offen offset:3072  lds
    s_add_u32 m0, s42, 118784
    s_add_u32 s33, s32, 8192
    buffer_load_dwordx4 v1, s[4:7], s33 offen offset:0  lds
    s_waitcnt vmcnt(18)
    s_barrier
    s_cmp_eq_u32 s40, 2
    s_cselect_b32 s32, 2, 6
    s_mul_i32 s32, s32, 36864
    s_add_u32 s32, s32, s43
    s_add_u32 m0, s42, 0
    s_add_u32 s33, s32, 0
    buffer_load_dwordx4 v1, s[4:7], s33 offen offset:0  lds
    buffer_load_dwordx4 v1, s[4:7], s33 offen offset:1024  lds
    buffer_load_dwordx4 v1, s[4:7], s33 offen offset:2048  lds
    buffer_load_dwordx4 v1, s[4:7], s33 offen offset:3072  lds
    s_add_u32 m0, s42, 4096
    s_add_u32 s33, s32, 4096
    buffer_load_dwordx4 v1, s[4:7], s33 offen offset:0  lds
    buffer_load_dwordx4 v1, s[4:7], s33 offen offset:1024  lds
    buffer_load_dwordx4 v1, s[4:7], s33 offen offset:2048  lds
    buffer_load_dwordx4 v1, s[4:7], s33 offen offset:3072  lds
    s_add_u32 m0, s42, 8192
    s_add_u32 s33, s32, 8192
    buffer_load_dwordx4 v1, s[4:7], s33 offen offset:0  lds
    s_waitcnt vmcnt(18)
    s_barrier
    s_cmp_eq_u32 s40, 3
    s_cselect_b32 s32, 3, 7
    s_mul_i32 s32, s32, 36864
    s_add_u32 s32, s32, s43
    s_add_u32 m0, s42, 36864
    s_add_u32 s33, s32, 0
    buffer_load_dwordx4 v1, s[4:7], s33 offen offset:0  lds
    buffer_load_dwordx4 v1, s[4:7], s33 offen offset:1024  lds
    buffer_load_dwordx4 v1, s[4:7], s33 offen offset:2048  lds
    buffer_load_dwordx4 v1, s[4:7], s33 offen offset:3072  lds
    s_add_u32 m0, s42, 40960
    s_add_u32 s33, s32, 4096
    buffer_load_dwordx4 v1, s[4:7], s33 offen offset:0  lds
    buffer_load_dwordx4 v1, s[4:7], s33 offen offset:1024  lds
    buffer_load_dwordx4 v1, s[4:7], s33 offen offset:2048  lds
    buffer_load_dwordx4 v1, s[4:7], s33 offen offset:3072  lds
    s_add_u32 m0, s42, 45056
    s_add_u32 s33, s32, 8192
    buffer_load_dwordx4 v1, s[4:7], s33 offen offset:0  lds
    s_waitcnt vmcnt(18)
    s_barrier
    s_mov_b32 s32, 8
    s_mul_i32 s32, s32, 36864
    s_add_u32 s32, s32, s43
    s_add_u32 m0, s42, 73728
    s_add_u32 s33, s32, 0
    buffer_load_dwordx4 v1, s[4:7], s33 offen offset:0  lds
    buffer_load_dwordx4 v1, s[4:7], s33 offen offset:1024  lds
    buffer_load_dwordx4 v1, s[4:7], s33 offen offset:2048  lds
    buffer_load_dwordx4 v1, s[4:7], s33 offen offset:3072  lds
    s_add_u32 m0, s42, 77824
    s_add_u32 s33, s32, 4096
    buffer_load_dwordx4 v1, s[4:7], s33 offen offset:0  lds
    buffer_load_dwordx4 v1, s[4:7], s33 offen offset:1024  lds
    buffer_load_dwordx4 v1, s[4:7], s33 offen offset:2048  lds
    buffer_load_dwordx4 v1, s[4:7], s33 offen offset:3072  lds
    s_add_u32 m0, s42, 81920
    s_add_u32 s33, s32, 8192
    buffer_load_dwordx4 v1, s[4:7], s33 offen offset:0  lds
    s_waitcnt vmcnt(18)
    s_barrier
    s_cmp_eq_u32 s22, 1
    s_cbranch_scc1 L_m_lfin
    s_and_b32 s25, s2, 7
    s_lshr_b32 s26, s2, 3
    s_lshr_b32 s23, s25, 1
    s_lshl_b32 s23, s23, 2
    s_lshr_b32 s27, s26, 3
    s_add_u32 s23, s23, s27
    s_and_b32 s24, s25, 1
    s_lshl_b32 s24, s24, 3
    s_and_b32 s27, s26, 7
    s_add_u32 s24, s24, s27
    s_mul_i32 s29, s24, 129024
    s_lshl_b32 s30, s20, 12
    s_add_u32 s29, s29, s30
    s_add_u32 s29, s29, 0x3800000
    s_lshl_b32 s31, s23, 3
    s_max_u32 s31, s31, 1
    s_sub_u32 s31, s31, 1
    s_mul_i32 s31, s31, 18432
    s_add_u32 s31, s31, 0x1c00000
    s_lshl_b32 s35, s20, 10
    s_and_b32 s36, s35, 1024
    s_waitcnt vmcnt(9)
    s_barrier
    s_add_u32 m0, s30, 0
    s_add_u32 s34, s29, 0
    buffer_load_dwordx4 v1, s[4:7], s34 offen offset:0 lds
    buffer_load_dwordx4 v1, s[4:7], s34 offen offset:1024 lds
    buffer_load_dwordx4 v1, s[4:7], s34 offen offset:2048 lds
    buffer_load_dwordx4 v1, s[4:7], s34 offen offset:3072 lds
    s_add_u32 m0, s30, 16384
    s_add_u32 s34, s29, 16384
    buffer_load_dwordx4 v1, s[4:7], s34 offen offset:0 lds
    buffer_load_dwordx4 v1, s[4:7], s34 offen offset:1024 lds
    buffer_load_dwordx4 v1, s[4:7], s34 offen offset:2048 lds
    buffer_load_dwordx4 v1, s[4:7], s34 offen offset:3072 lds
    s_add_u32 m0, s30, 114688
    s_add_u32 s34, s29, 114688
    buffer_load_dwordx4 v1, s[4:7], s34 offen offset:0 lds
    buffer_load_dwordx4 v1, s[4:7], s34 offen offset:1024 lds
    buffer_load_dwordx4 v1, s[4:7], s34 offen offset:2048 lds
    buffer_load_dwordx4 v1, s[4:7], s34 offen offset:3072 lds
    s_waitcnt vmcnt(12)
    s_barrier
    s_add_u32 m0, s30, 32768
    s_add_u32 s34, s29, 32768
    buffer_load_dwordx4 v1, s[4:7], s34 offen offset:0 lds
    buffer_load_dwordx4 v1, s[4:7], s34 offen offset:1024 lds
    buffer_load_dwordx4 v1, s[4:7], s34 offen offset:2048 lds
    buffer_load_dwordx4 v1, s[4:7], s34 offen offset:3072 lds
    s_add_u32 m0, s30, 49152
    s_add_u32 s34, s29, 49152
    buffer_load_dwordx4 v1, s[4:7], s34 offen offset:0 lds
    buffer_load_dwordx4 v1, s[4:7], s34 offen offset:1024 lds
    buffer_load_dwordx4 v1, s[4:7], s34 offen offset:2048 lds
    buffer_load_dwordx4 v1, s[4:7], s34 offen offset:3072 lds
    s_mov_b32 s22, 1
    s_mov_b32 s21, 0x1c00000
    s_barrier
    s_barrier
    s_mov_b32 m0, 161792
    s_lshl_b32 s34, s24, 10
    s_add_u32 s34, s34, 0x4400000
    buffer_load_dwordx4 v1, s[4:7], s34 offen lds
    s_add_u32 m0, s30, 65536
    s_add_u32 s34, s29, 65536
    buffer_load_dwordx4 v1, s[4:7], s34 offen offset:0 lds
    buffer_load_dwordx4 v1, s[4:7], s34 offen offset:1024 lds
    buffer_load_dwordx4 v1, s[4:7], s34 offen offset:2048 lds
    buffer_load_dwordx4 v1, s[4:7], s34 offen offset:3072 lds
    s_add_u32 m0, s30, 81920
    s_add_u32 s34, s29, 81920
    buffer_load_dwordx4 v1, s[4:7], s34 offen offset:0 lds
    buffer_load_dwordx4 v1, s[4:7], s34 offen offset:1024 lds
    buffer_load_dwordx4 v1, s[4:7], s34 offen offset:2048 lds
    buffer_load_dwordx4 v1, s[4:7], s34 offen offset:3072 lds
    s_add_u32 m0, s30, 98304
    s_add_u32 s34, s29, 98304
    buffer_load_dwordx4 v1, s[4:7], s34 offen offset:0 lds
    buffer_load_dwordx4 v1, s[4:7], s34 offen offset:1024 lds
    buffer_load_dwordx4 v1, s[4:7], s34 offen offset:2048 lds
    buffer_load_dwordx4 v1, s[4:7], s34 offen offset:3072 lds
    s_barrier
    s_add_u32 m0, s35, 131072
    s_add_u32 s34, s31, s35
    s_add_u32 s34, s34, 0
    buffer_load_dwordx4 v1, s[4:7], s34 offen sc1 lds
    s_waitcnt vmcnt(0)
    s_barrier
    s_add_u32 m0, s35, 135168
    s_add_u32 s34, s31, s35
    s_add_u32 s34, s34, 4096
    buffer_load_dwordx4 v1, s[4:7], s34 offen sc1 lds
    s_add_u32 m0, s35, 139264
    s_add_u32 s34, s31, s35
    s_add_u32 s34, s34, 8192
    buffer_load_dwordx4 v1, s[4:7], s34 offen sc1 lds
    s_waitcnt vmcnt(2)
    s_barrier
    s_waitcnt vmcnt(1)
    s_barrier
    s_add_u32 m0, s35, 143360
    s_add_u32 s34, s31, s35
    s_add_u32 s34, s34, 12288
    buffer_load_dwordx4 v1, s[4:7], s34 offen sc1 lds
    s_waitcnt vmcnt(1)
    s_barrier
    s_waitcnt vmcnt(1)
    s_barrier
    s_add_u32 m0, s36, 147456
    s_add_u32 s34, s31, s36
    s_add_u32 s34, s34, 16384
    buffer_load_dwordx4 v1, s[4:7], s34 offen sc1 lds
    s_waitcnt vmcnt(1)
    s_barrier
    s_waitcnt vmcnt(1)
    s_barrier
    s_waitcnt vmcnt(0)
    s_barrier
    s_barrier
    s_branch L_m_ll
L_m_lfin:
    s_waitcnt vmcnt(9)
    s_barrier
    s_waitcnt vmcnt(0)
    s_barrier
L_end_m:
    s_endpgm

.section .rodata,"a"
.p2align 6
.amdhsa_kernel interleave_layers__sliding_local_dilated__mixer_gmlp__prompt_kernel
  .amdhsa_next_free_vgpr 256
  .amdhsa_next_free_sgpr 102
  .amdhsa_accum_offset 256
  .amdhsa_group_segment_fixed_size 0
  .amdhsa_kernarg_size 88
  .amdhsa_user_sgpr_count 2
  .amdhsa_user_sgpr_kernarg_segment_ptr 1
  .amdhsa_system_sgpr_workgroup_id_x 1
  .amdhsa_float_denorm_mode_32 3
.end_amdhsa_kernel
```

```asm
; @launch grid=(256,1,1) block=(512,1,1) lds=163840
.amdgcn_target "amdgcn-amd-amdhsa--gfx950"
.text
.globl interleave_layers__sliding_local_dilated__mixer_gmlp__prompt_kernel
.p2align 8
.type interleave_layers__sliding_local_dilated__mixer_gmlp__prompt_kernel,@function
interleave_layers__sliding_local_dilated__mixer_gmlp__prompt_kernel:
    s_cmp_ge_u32 s2, 256
    s_cbranch_scc1 L_end_m
    s_load_dwordx16 s[36:51], s[0:1], 0
    s_load_dwordx4 s[56:59], s[0:1], 64
    s_load_dwordx2 s[24:25], s[0:1], 80
    s_getpc_b64 s[26:27]
L_m_pc:
    s_sub_u32 s26, s26, L_m_pc-interleave_layers__sliding_local_dilated__mixer_gmlp__prompt_kernel
    s_subb_u32 s27, s27, 0
    v_lshlrev_b32 v4, 4, v0
    v_mov_b32 v5, s27
    v_add_co_u32 v6, vcc, s26, v4
    s_lshr_b32 s28, s2, 3
    s_lshl_b32 s28, s28, 11
    v_addc_co_u32 v7, vcc, 0, v5, vcc
    global_load_dwordx4 v[60:63], v[6:7], off
    v_lshl_add_u32 v4, v0, 2, s28
    v_min_u32 v4, L_end_m-interleave_layers__sliding_local_dilated__mixer_gmlp__prompt_kernel-4, v4
    v_add_co_u32 v6, vcc, s26, v4
    s_nop 1
    v_addc_co_u32 v7, vcc, 0, v5, vcc
    global_load_dword v64, v[6:7], off
    v_lshrrev_b32 v2, 6, v0
    v_and_b32 v1, 63, v0
    v_lshlrev_b32 v1, 4, v1
    v_readfirstlane_b32 s23, v2
    s_mov_b32 s22, 0
    s_mov_b32 s21, 0
    s_and_b32 s20, s23, 3
    s_waitcnt lgkmcnt(0)
    s_mov_b32 s4, s24
    s_mov_b32 s5, s25
    s_mov_b32 s6, 0x10000000
    s_mov_b32 s7, 0x20000
    s_mov_b32 s8, s46
    s_mov_b32 s9, s47
    s_mov_b32 s10, 0x800000
    s_mov_b32 s11, 0x20000
    s_mov_b32 s12, s48
    s_mov_b32 s13, s49
    s_mov_b32 s14, 0x1000
    s_mov_b32 s15, 0x20000
    s_mov_b32 s16, s56
    s_mov_b32 s17, s57
    s_mov_b32 s18, 0x240000
    s_mov_b32 s19, 0x20000
    s_cmp_ge_u32 s23, 4
    s_cbranch_scc1 L_ld_m
    v_bfe_u32 v2, v1, 4, 4
    v_lshrrev_b32 v3, 8, v1
    v_bfrev_b32 v6, 1
    v_mov_b32 v11, 0x3f803f80
    s_lshl_b32 s30, s20, 12
    s_and_b32 s29, s20, 1
    s_cmp_lt_u32 s2, 128
    s_cbranch_scc1 L_p0_x
    s_cmp_lt_u32 s2, 236
    s_cbranch_scc1 L_p0_wq
    s_cmp_lt_u32 s2, 254
    s_cbranch_scc1 L_p0_wo
    s_mov_b32 s46, 0
    s_mov_b32 s47, 0
    s_mov_b32 s27, 0
    s_mov_b32 s28, 0
    s_barrier
    s_barrier
    s_branch L_p0_cd
L_p0_wo:
    s_mul_i32 s30, s20, 9216
    s_sub_u32 s26, s2, 236
    s_mul_i32 s28, s26, 57
    s_lshr_b32 s28, s28, 9
    s_mul_i32 s27, s28, 9
    s_sub_u32 s27, s26, s27
    s_mov_b32 s32, s40
    s_mov_b32 s33, s41
    s_mov_b32 s34, 0xa2000
    s_mov_b32 s35, 0x20000
    s_mul_i32 s29, s28, 331776
    s_lshl_b32 s31, s27, 7
    s_add_u32 s29, s29, s31
    s_mul_i32 s31, s20, 82944
    s_add_u32 s29, s29, s31
    v_lshrrev_b32 v4, 7, v1
    v_mul_u32_u24 v4, 1152, v4
    v_and_b32 v5, 0x70, v1
    v_add_u32 v4, v4, v5
    s_add_u32 m0, s30, 0
    s_add_u32 s31, s29, 0
    buffer_load_dwordx4 v4, s[32:35], s31 offen  lds
    s_add_u32 m0, s30, 1024
    s_add_u32 s31, s29, 9216
    buffer_load_dwordx4 v4, s[32:35], s31 offen  lds
    s_add_u32 m0, s30, 2048
    s_add_u32 s31, s29, 18432
    buffer_load_dwordx4 v4, s[32:35], s31 offen  lds
    s_add_u32 m0, s30, 3072
    s_add_u32 s31, s29, 27648
    buffer_load_dwordx4 v4, s[32:35], s31 offen  lds
    s_add_u32 m0, s30, 4096
    s_add_u32 s31, s29, 36864
    buffer_load_dwordx4 v4, s[32:35], s31 offen  lds
    s_add_u32 m0, s30, 5120
    s_add_u32 s31, s29, 46080
    buffer_load_dwordx4 v4, s[32:35], s31 offen  lds
    s_add_u32 m0, s30, 6144
    s_add_u32 s31, s29, 55296
    buffer_load_dwordx4 v4, s[32:35], s31 offen  lds
    s_add_u32 m0, s30, 7168
    s_add_u32 s31, s29, 64512
    buffer_load_dwordx4 v4, s[32:35], s31 offen  lds
    s_add_u32 m0, s30, 8192
    s_add_u32 s31, s29, 73728
    buffer_load_dwordx4 v4, s[32:35], s31 offen  lds
    s_barrier
    v_lshrrev_b32 v7, 2, v2
    v_and_b32 v8, 3, v2
    s_lshl_b32 s31, s20, 5
    s_add_u32 s31, s31, 0
    v_lshlrev_b32 v9, 7, v7
    v_lshl_add_u32 v9, v8, 3, v9
    v_add_u32 v9, s31, v9
    v_mul_u32_u24 v4, 512, v3
    v_add_u32 v4, v4, v9
    v_mul_u32_u24 v5, 9216, v3
    v_add_u32 v5, v5, v9
    s_lshl_b32 s31, s27, 2
    s_add_u32 s31, s31, s20
    v_lshl_add_u32 v7, s31, 2, v7
    v_lshlrev_b32 v8, 4, v8
    v_lshl_add_u32 v8, v3, 8, v8
    v_mul_u32_u24 v9, 57, v7
    v_lshrrev_b32 v9, 10, v9
    v_mul_u32_u24 v10, 18, v9
    v_sub_u32 v10, v7, v10
    v_lshrrev_b32 v12, 3, v10
    v_and_b32 v13, 1, v10
    v_lshl_add_u32 v12, v12, 1, v13
    v_bfe_u32 v14, v10, 1, 2
    v_cmp_gt_u32 vcc, 16, v10
    v_mul_u32_u24 v9, 82944, v9
    v_add_u32 v9, v9, v8
    v_cndmask_b32 v12, 8, v12, vcc
    v_cndmask_b32 v14, v13, v14, vcc
    v_mov_b32 v15, 0x1000
    v_mov_b32 v13, 0x80
    v_cndmask_b32 v15, v13, v15, vcc
    v_lshl_add_u32 v9, v12, 10, v9
    v_lshl_add_u32 v9, v14, 6, v9
    v_add_u32 v10, v9, v15
    s_and_b32 s31, s28, 1
    s_cmp_eq_u32 s31, 1
    s_cselect_b64 vcc, -1, 0
    v_cndmask_b32 v14, v9, v10, vcc
    s_mul_i32 s31, s28, 36864
    s_add_u32 s37, s31, 0x3a00000
    s_add_u32 s38, s31, 0x3a00000
    s_add_u32 s39, s31, 0x3a02400
    s_add_u32 s40, s31, 0x3a02400
    s_add_u32 s41, s31, 0x3a04800
    s_add_u32 s42, s31, 0x3a04800
    s_add_u32 s43, s31, 0x3a06c00
    s_add_u32 s47, s31, 0x3a06c00
    s_lshr_b32 s31, s28, 1
    s_mul_i32 s31, s31, 9216
    s_add_u32 s48, s31, 0x3a12000
    s_cmp_ge_u32 s26, 4
    s_cbranch_scc1 L_p0_n2
    s_lshl_b32 s31, s26, 2
    s_add_u32 s31, s31, s20
    s_lshl_b32 s31, s31, 12
    s_add_u32 s31, s31, 0x4508000
    v_and_b32 v56, 0x380, v1
    v_add_u32 v56, v56, v1
    v_mov_b32 v52, 0
    v_mov_b32 v53, 0
    v_mov_b32 v54, 0
    v_mov_b32 v55, 0
    buffer_store_dwordx4 v[52:55], v56, s[4:7], s31 offen offset:0 sc1
    buffer_store_dwordx4 v[52:55], v56, s[4:7], s31 offen offset:2048 sc1
L_p0_n2:
    s_waitcnt vmcnt(0)
    s_barrier
    ds_read_b64_tr_b16 v[16:17], v4 offset:0
    ds_read_b64_tr_b16 v[18:19], v4 offset:2560
    ds_read_b64_tr_b16 v[20:21], v4 offset:4608
    ds_read_b64_tr_b16 v[22:23], v4 offset:7168
    ds_read_b64_tr_b16 v[24:25], v4 offset:9216
    ds_read_b64_tr_b16 v[26:27], v4 offset:11776
    ds_read_b64_tr_b16 v[28:29], v4 offset:13824
    ds_read_b64_tr_b16 v[30:31], v4 offset:16384
    ds_read_b64_tr_b16 v[32:33], v4 offset:18432
    ds_read_b64_tr_b16 v[34:35], v4 offset:20992
    ds_read_b64_tr_b16 v[36:37], v4 offset:23040
    ds_read_b64_tr_b16 v[38:39], v4 offset:25600
    ds_read_b64_tr_b16 v[40:41], v4 offset:27648
    ds_read_b64_tr_b16 v[42:43], v4 offset:30208
    ds_read_b64_tr_b16 v[44:45], v4 offset:32256
    ds_read_b64_tr_b16 v[46:47], v4 offset:34816
    ds_read_b64_tr_b16 v[48:49], v5 offset:2048
    ds_read_b64_tr_b16 v[50:51], v5 offset:6656
    s_waitcnt lgkmcnt(15)
    s_mov_b32 s31, s37
    buffer_store_dwordx4 v[16:19], v9, s[4:7], s31 offen sc1
    s_waitcnt lgkmcnt(14)
    s_mov_b32 s31, s38
    buffer_store_dwordx4 v[20:23], v10, s[4:7], s31 offen sc1
    s_waitcnt lgkmcnt(12)
    s_mov_b32 s31, s39
    buffer_store_dwordx4 v[24:27], v9, s[4:7], s31 offen sc1
    s_waitcnt lgkmcnt(10)
    s_mov_b32 s31, s40
    buffer_store_dwordx4 v[28:31], v10, s[4:7], s31 offen sc1
    s_waitcnt lgkmcnt(8)
    s_mov_b32 s31, s41
    buffer_store_dwordx4 v[32:35], v9, s[4:7], s31 offen sc1
    s_waitcnt lgkmcnt(6)
    s_mov_b32 s31, s42
    buffer_store_dwordx4 v[36:39], v10, s[4:7], s31 offen sc1
    s_waitcnt lgkmcnt(4)
    s_mov_b32 s31, s43
    buffer_store_dwordx4 v[40:43], v9, s[4:7], s31 offen sc1
    s_waitcnt lgkmcnt(2)
    s_mov_b32 s31, s47
    buffer_store_dwordx4 v[44:47], v10, s[4:7], s31 offen sc1
    s_waitcnt lgkmcnt(0)
    s_mov_b32 s31, s48
    buffer_store_dwordx4 v[48:51], v14, s[4:7], s31 offen sc1
    s_mov_b32 s46, 1
    s_mov_b32 s47, 0
    s_mov_b32 s27, 32
    s_mov_b32 s28, 0
    s_branch L_p0_cd
L_p0_wq:
    s_mov_b32 s32, s38
    s_mov_b32 s33, s39
    s_mov_b32 s34, 0x1e6000
    s_mov_b32 s35, 0x20000
    s_sub_u32 s23, s2, 128
    s_mul_i32 s25, s23, 19
    s_lshr_b32 s25, s25, 10
    s_mul_i32 s24, s25, 54
    s_sub_u32 s24, s23, s24
    s_mul_i32 s26, s25, 995328
    s_lshl_b32 s31, s24, 6
    s_add_u32 s26, s26, s31
    v_lshrrev_b32 v4, 6, v1
    v_mul_u32_u24 v4, 3456, v4
    v_and_b32 v5, 48, v1
    v_add_u32 v4, v4, v5
    s_mul_i32 s31, s20, 221184
    s_add_u32 s27, s26, s31
    s_add_u32 m0, s30, 0
    s_add_u32 s31, s27, 0
    buffer_load_dwordx4 v4, s[32:35], s31 offen  lds
    s_add_u32 m0, s30, 1024
    s_add_u32 s31, s27, 55296
    buffer_load_dwordx4 v4, s[32:35], s31 offen  lds
    s_add_u32 m0, s30, 2048
    s_add_u32 s31, s27, 110592
    buffer_load_dwordx4 v4, s[32:35], s31 offen  lds
    s_add_u32 m0, s30, 3072
    s_add_u32 s31, s27, 165888
    buffer_load_dwordx4 v4, s[32:35], s31 offen  lds
    s_lshl_b32 s31, s29, 10
    s_add_u32 m0, s31, 16384
    s_mul_i32 s31, s29, 55296
    s_add_u32 s31, s31, s26
    s_add_u32 s31, s31, 884736
    buffer_load_dwordx4 v4, s[32:35], s31 offen  lds
    s_barrier
    v_lshrrev_b32 v7, 2, v2
    v_and_b32 v8, 3, v2
    s_lshl_b32 s31, s29, 5
    v_lshlrev_b32 v9, 6, v7
    v_lshl_add_u32 v9, v8, 3, v9
    v_add_u32 v9, s31, v9
    v_lshl_add_u32 v4, v3, 9, v9
    v_mul_u32_u24 v5, 4608, v3
    v_add_u32 v5, v5, v9
    s_lshl_b32 s31, s24, 1
    s_add_u32 s31, s31, s29
    v_lshl_add_u32 v7, s31, 2, v7
    v_lshlrev_b32 v8, 4, v8
    v_lshl_add_u32 v8, v3, 8, v8
    v_mul_u32_u24 v9, 57, v7
    v_lshrrev_b32 v9, 13, v9
    v_mul_u32_u24 v10, 144, v9
    v_sub_u32 v10, v7, v10
    v_mul_u32_u24 v12, 57, v10
    v_lshrrev_b32 v12, 9, v12
    v_mul_u32_u24 v13, 9, v12
    v_sub_u32 v13, v10, v13
    v_cmp_lt_u32 s[36:37], 4, v13
    v_cmp_eq_u32 s[38:39], 4, v13
    v_cmp_eq_u32 s[40:41], 2, v9
    v_lshlrev_b32 v14, 1, v9
    v_add_u32 v15, 1, v14
    v_subrev_u32 v10, 5, v13
    v_cndmask_b32 v14, v14, v15, s[36:37]
    v_cndmask_b32 v13, v13, v10, s[36:37]
    v_cndmask_b32 v14, v14, 6, s[38:39]
    v_cndmask_b32 v13, v13, v9, s[38:39]
    s_and_b64 s[40:41], s[40:41], s[38:39]
    s_mov_b32 s31, 129024
    v_mul_lo_u32 v9, v12, s31
    v_add_u32 v9, v9, v8
    v_lshl_add_u32 v9, v14, 10, v9
    v_lshl_add_u32 v9, v13, 6, v9
    v_add_u32 v15, 64, v9
    v_cndmask_b32 v15, v6, v15, s[40:41]
    v_and_b32 v10, 3, v2
    v_lshlrev_b32 v10, 2, v10
    v_lshl_add_u32 v10, v13, 4, v10
    v_lshl_add_u32 v10, v14, 6, v10
    v_lshl_add_u32 v10, v12, 10, v10
    v_cmp_eq_u32 vcc, 0, v3
    s_lshl_b32 s45, s25, 9
    s_add_u32 s45, s45, 0x4400000
    v_cndmask_b32 v10, v6, v10, vcc
    s_mul_i32 s43, s25, 7168
    s_add_u32 s44, s43, 0x381c000
    s_lshl_b32 s43, s43, 3
    s_add_u32 s42, s43, 0x3800000
    s_mul_i32 s26, s24, 57
    s_lshr_b32 s26, s26, 9
    s_mul_i32 s27, s26, 9
    s_sub_u32 s27, s24, s27
    s_cmp_lt_u32 s26, 2
    s_cselect_b32 s31, 2, 1
    s_cmp_ge_u32 s27, 1
    s_cselect_b32 s46, s31, 0
    s_cmp_le_u32 s27, 7
    s_cselect_b32 s47, s31, 0
    s_and_b32 s26, s26, 1
    s_lshl_b32 s26, s26, 3
    s_min_u32 s28, s27, 7
    s_add_u32 s28, s28, s26
    s_max_u32 s27, s27, 1
    s_sub_u32 s27, s27, 1
    s_add_u32 s27, s27, s26
    s_waitcnt vmcnt(0)
    s_barrier
    ds_read_b64_tr_b16 v[16:17], v4 offset:0
    ds_read_b64_tr_b16 v[18:19], v4 offset:256
    ds_read_b64_tr_b16 v[20:21], v4 offset:2048
    ds_read_b64_tr_b16 v[22:23], v4 offset:2304
    ds_read_b64_tr_b16 v[24:25], v4 offset:4608
    ds_read_b64_tr_b16 v[26:27], v4 offset:4864
    ds_read_b64_tr_b16 v[28:29], v4 offset:6656
    ds_read_b64_tr_b16 v[30:31], v4 offset:6912
    ds_read_b64_tr_b16 v[32:33], v4 offset:9216
    ds_read_b64_tr_b16 v[34:35], v4 offset:9472
    ds_read_b64_tr_b16 v[36:37], v4 offset:11264
    ds_read_b64_tr_b16 v[38:39], v4 offset:11520
    ds_read_b64_tr_b16 v[40:41], v4 offset:13824
    ds_read_b64_tr_b16 v[42:43], v4 offset:14080
    ds_read_b64_tr_b16 v[44:45], v4 offset:15872
    ds_read_b64_tr_b16 v[46:47], v4 offset:16128
    ds_read_b64_tr_b16 v[48:49], v5 offset:4096
    ds_read_b64_tr_b16 v[50:51], v5 offset:4352
    s_cmp_ge_u32 s20, 2
    s_cbranch_scc1 L_p0_cs
    s_waitcnt lgkmcnt(15)
    s_add_u32 s31, s42, 0
    buffer_store_dwordx4 v[16:19], v9, s[4:7], s31 offen sc1
    s_waitcnt lgkmcnt(14)
    s_add_u32 s31, s42, 7168
    buffer_store_dwordx4 v[20:23], v9, s[4:7], s31 offen sc1
    s_waitcnt lgkmcnt(12)
    s_add_u32 s31, s42, 14336
    buffer_store_dwordx4 v[24:27], v9, s[4:7], s31 offen sc1
    s_waitcnt lgkmcnt(10)
    s_add_u32 s31, s42, 21504
    buffer_store_dwordx4 v[28:31], v9, s[4:7], s31 offen sc1
    s_waitcnt lgkmcnt(8)
    s_add_u32 s31, s42, 28672
    buffer_store_dwordx4 v[32:35], v9, s[4:7], s31 offen sc1
    s_waitcnt lgkmcnt(6)
    s_add_u32 s31, s42, 35840
    buffer_store_dwordx4 v[36:39], v9, s[4:7], s31 offen sc1
    s_waitcnt lgkmcnt(4)
    s_add_u32 s31, s42, 43008
    buffer_store_dwordx4 v[40:43], v9, s[4:7], s31 offen sc1
    s_waitcnt lgkmcnt(2)
    s_add_u32 s31, s42, 50176
    buffer_store_dwordx4 v[44:47], v9, s[4:7], s31 offen sc1
    s_waitcnt lgkmcnt(0)
    s_mov_b32 s31, s44
    buffer_store_dwordx4 v[48:51], v9, s[4:7], s31 offen sc1
    s_branch L_p0_cd
L_p0_cs:
    v_mov_b32 v52, 0
    v_mov_b32 v53, 0
    v_mov_b32 v54, 0
    v_mov_b32 v55, 0
    s_cmp_eq_u64 s[40:41], 0
    s_cbranch_scc1 L_p0_np
    s_add_u32 s31, s42, 0
    buffer_store_dwordx4 v[52:55], v15, s[4:7], s31 offen sc1
    s_add_u32 s31, s42, 7168
    buffer_store_dwordx4 v[52:55], v15, s[4:7], s31 offen sc1
    s_add_u32 s31, s42, 14336
    buffer_store_dwordx4 v[52:55], v15, s[4:7], s31 offen sc1
    s_add_u32 s31, s42, 21504
    buffer_store_dwordx4 v[52:55], v15, s[4:7], s31 offen sc1
    s_add_u32 s31, s42, 28672
    buffer_store_dwordx4 v[52:55], v15, s[4:7], s31 offen sc1
    s_add_u32 s31, s42, 35840
    buffer_store_dwordx4 v[52:55], v15, s[4:7], s31 offen sc1
    s_add_u32 s31, s42, 43008
    buffer_store_dwordx4 v[52:55], v15, s[4:7], s31 offen sc1
    s_add_u32 s31, s42, 50176
    buffer_store_dwordx4 v[52:55], v15, s[4:7], s31 offen sc1
    s_mov_b32 s31, s44
    buffer_store_dwordx4 v[52:55], v15, s[4:7], s31 offen sc1
L_p0_np:
    s_waitcnt lgkmcnt(0)
    v_dot2_f32_bf16 v12, v16, v11, 0
    v_dot2_f32_bf16 v13, v17, v11, 0
    v_dot2_f32_bf16 v12, v18, v11, v12
    v_dot2_f32_bf16 v13, v19, v11, v13
    v_dot2_f32_bf16 v12, v20, v11, v12
    v_dot2_f32_bf16 v13, v21, v11, v13
    v_dot2_f32_bf16 v12, v22, v11, v12
    v_dot2_f32_bf16 v13, v23, v11, v13
    v_dot2_f32_bf16 v12, v24, v11, v12
    v_dot2_f32_bf16 v13, v25, v11, v13
    v_dot2_f32_bf16 v12, v26, v11, v12
    v_dot2_f32_bf16 v13, v27, v11, v13
    v_dot2_f32_bf16 v12, v28, v11, v12
    v_dot2_f32_bf16 v13, v29, v11, v13
    v_dot2_f32_bf16 v12, v30, v11, v12
    v_dot2_f32_bf16 v13, v31, v11, v13
    v_dot2_f32_bf16 v12, v32, v11, v12
    v_dot2_f32_bf16 v13, v33, v11, v13
    v_dot2_f32_bf16 v12, v34, v11, v12
    v_dot2_f32_bf16 v13, v35, v11, v13
    v_dot2_f32_bf16 v12, v36, v11, v12
    v_dot2_f32_bf16 v13, v37, v11, v13
    v_dot2_f32_bf16 v12, v38, v11, v12
    v_dot2_f32_bf16 v13, v39, v11, v13
    v_dot2_f32_bf16 v12, v40, v11, v12
    v_dot2_f32_bf16 v13, v41, v11, v13
    v_dot2_f32_bf16 v12, v42, v11, v12
    v_dot2_f32_bf16 v13, v43, v11, v13
    v_dot2_f32_bf16 v12, v44, v11, v12
    v_dot2_f32_bf16 v13, v45, v11, v13
    v_dot2_f32_bf16 v12, v46, v11, v12
    v_dot2_f32_bf16 v13, v47, v11, v13
    v_dot2_f32_bf16 v12, v48, v11, v12
    v_dot2_f32_bf16 v13, v49, v11, v13
    v_dot2_f32_bf16 v12, v50, v11, v12
    v_dot2_f32_bf16 v13, v51, v11, v13
    s_nop 2
    v_add_f32 v12, v12, v13
    v_mov_b32 v13, v12
    s_nop 1
    v_permlane32_swap_b32 v12, v13
    v_add_f32 v12, v12, v13
    v_mov_b32 v13, v12
    s_nop 1
    v_permlane16_swap_b32 v12, v13
    v_add_f32 v12, v12, v13
    buffer_store_dword v12, v10, s[4:7], s45 offen sc1
    s_branch L_p0_cd
L_p0_x:
    s_mov_b32 s32, s36
    s_mov_b32 s33, s37
    s_mov_b32 s34, 0x240000
    s_mov_b32 s35, 0x20000
    s_mul_i32 s26, s2, 18432
    s_mov_b32 m0, s30
    s_add_u32 s31, s26, s30
    buffer_load_dwordx4 v1, s[32:35], s31 offen offset:0  lds
    buffer_load_dwordx4 v1, s[32:35], s31 offen offset:1024  lds
    buffer_load_dwordx4 v1, s[32:35], s31 offen offset:2048  lds
    buffer_load_dwordx4 v1, s[32:35], s31 offen offset:3072  lds
    s_lshl_b32 s27, s29, 10
    s_add_u32 s27, s27, 16384
    s_mov_b32 m0, s27
    s_add_u32 s31, s26, s27
    buffer_load_dwordx4 v1, s[32:35], s31 offen  lds
    s_barrier
    s_mul_i32 s31, s20, 288
    v_mul_u32_u24 v7, 1152, v2
    v_lshl_add_u32 v4, v3, 4, v7
    v_add_u32 v4, s31, v4
    s_mul_i32 s31, s29, 576
    v_mul_u32_u24 v5, 144, v3
    v_add3_u32 v5, v5, v7, s31
    s_add_u32 s26, s26, 0x0
    s_add_u32 s42, s26, s30
    s_add_u32 s44, s26, s27
    s_lshl_b32 s45, s2, 10
    s_lshl_b32 s31, s20, 8
    s_add_u32 s45, s45, s31
    s_add_u32 s45, s45, 0x1b00000
    v_cmp_gt_u32 vcc, 2, v3
    v_lshrrev_b32 v10, 1, v1
    s_mov_b32 s46, 2
    s_mov_b32 s47, 0
    v_cndmask_b32 v10, v6, v10, vcc
    s_lshr_b32 s27, s2, 3
    s_add_u32 s27, s27, 48
    s_mov_b32 s28, 0
    s_waitcnt vmcnt(0)
    s_barrier
    ds_read_b128 v[16:19], v4 offset:0
    ds_read_b128 v[20:23], v4 offset:64
    ds_read_b128 v[24:27], v4 offset:144
    ds_read_b128 v[28:31], v4 offset:208
    ds_read_b128 v[32:35], v5 offset:128
    s_waitcnt lgkmcnt(4)
    buffer_store_dwordx4 v[16:19], v1, s[4:7], s42 offen offset:0 sc1
    s_waitcnt lgkmcnt(3)
    buffer_store_dwordx4 v[20:23], v1, s[4:7], s42 offen offset:1024 sc1
    s_waitcnt lgkmcnt(2)
    buffer_store_dwordx4 v[24:27], v1, s[4:7], s42 offen offset:2048 sc1
    s_waitcnt lgkmcnt(1)
    buffer_store_dwordx4 v[28:31], v1, s[4:7], s42 offen offset:3072 sc1
    v_dot2_f32_bf16 v12, v16, v11, 0
    v_dot2_f32_bf16 v13, v16, v16, 0
    v_dot2_f32_bf16 v12, v17, v11, v12
    v_dot2_f32_bf16 v13, v17, v17, v13
    v_dot2_f32_bf16 v12, v18, v11, v12
    v_dot2_f32_bf16 v13, v18, v18, v13
    v_dot2_f32_bf16 v12, v19, v11, v12
    v_dot2_f32_bf16 v13, v19, v19, v13
    v_dot2_f32_bf16 v12, v20, v11, v12
    v_dot2_f32_bf16 v13, v20, v20, v13
    v_dot2_f32_bf16 v12, v21, v11, v12
    v_dot2_f32_bf16 v13, v21, v21, v13
    v_dot2_f32_bf16 v12, v22, v11, v12
    v_dot2_f32_bf16 v13, v22, v22, v13
    v_dot2_f32_bf16 v12, v23, v11, v12
    v_dot2_f32_bf16 v13, v23, v23, v13
    v_dot2_f32_bf16 v12, v24, v11, v12
    v_dot2_f32_bf16 v13, v24, v24, v13
    v_dot2_f32_bf16 v12, v25, v11, v12
    v_dot2_f32_bf16 v13, v25, v25, v13
    v_dot2_f32_bf16 v12, v26, v11, v12
    v_dot2_f32_bf16 v13, v26, v26, v13
    v_dot2_f32_bf16 v12, v27, v11, v12
    v_dot2_f32_bf16 v13, v27, v27, v13
    v_dot2_f32_bf16 v12, v28, v11, v12
    v_dot2_f32_bf16 v13, v28, v28, v13
    v_dot2_f32_bf16 v12, v29, v11, v12
    v_dot2_f32_bf16 v13, v29, v29, v13
    v_dot2_f32_bf16 v12, v30, v11, v12
    v_dot2_f32_bf16 v13, v30, v30, v13
    v_dot2_f32_bf16 v12, v31, v11, v12
    v_dot2_f32_bf16 v13, v31, v31, v13
    s_waitcnt lgkmcnt(0)
    s_cmp_ge_u32 s20, 2
    s_cbranch_scc1 L_p0_xs
    buffer_store_dwordx4 v[32:35], v1, s[4:7], s44 offen sc1
    v_dot2_f32_bf16 v12, v32, v11, v12
    v_dot2_f32_bf16 v13, v32, v32, v13
    v_dot2_f32_bf16 v12, v33, v11, v12
    v_dot2_f32_bf16 v13, v33, v33, v13
    v_dot2_f32_bf16 v12, v34, v11, v12
    v_dot2_f32_bf16 v13, v34, v34, v13
    v_dot2_f32_bf16 v12, v35, v11, v12
    v_dot2_f32_bf16 v13, v35, v35, v13
L_p0_xs:
    s_nop 2
    v_mov_b32 v14, v12
    v_mov_b32 v15, v13
    s_nop 1
    v_permlane32_swap_b32 v12, v14
    v_permlane32_swap_b32 v13, v15
    v_add_f32 v12, v12, v14
    v_add_f32 v13, v13, v15
    buffer_store_dwordx2 v[12:13], v10, s[4:7], s45 offen sc1
L_p0_cd:
    s_mov_b32 s32, s58
    s_mov_b32 s33, s59
    s_mov_b32 s34, 0x100
    s_mov_b32 s35, 0x20000
    v_mov_b32 v4, 0
    buffer_load_dword v5, v4, s[32:35], 0 offen sc1
    s_barrier
    s_lshl_b32 s50, s22, 7
    s_add_u32 s50, s50, s27
    s_lshl_b32 s50, s50, 8
    s_add_u32 s50, s50, 0x4500000
    s_add_u32 s50, s50, s4
    s_addc_u32 s51, s5, 0
    s_lshl_b32 s48, s22, 7
    s_add_u32 s48, s48, s28
    s_lshl_b32 s48, s48, 8
    s_add_u32 s48, s48, 0x4500000
    s_add_u32 s48, s48, s4
    s_addc_u32 s49, s5, 0
    s_cmp_lg_u32 s20, 0
    s_cbranch_scc1 L_pd_dbg
    s_waitcnt vmcnt(0)
    v_cmp_gt_u32 vcc, 4, v5
    s_nop 1
    s_cbranch_vccz L_pd_dbg
    s_mov_b32 s60, 65536
L_poll_dbg:
    buffer_load_dword v5, v4, s[32:35], 0 offen sc1
    s_waitcnt vmcnt(0)
    v_cmp_gt_u32 vcc, 4, v5
    s_sub_u32 s60, s60, 1
    s_cbranch_scc1 L_pd_dbg
    s_cbranch_vccz L_pd_dbg
    s_sleep 4
    s_branch L_poll_dbg
L_pd_dbg:
    s_branch L_m_cl
L_ld_m:
    s_cmp_lg_u32 s2, 0
    s_cbranch_scc1 L_p0_nz
    s_lshl_b32 s31, s20, 12
    s_add_u32 s31, s31, 0x4500000
    v_and_b32 v56, 0x380, v1
    v_add_u32 v56, v56, v1
    v_mov_b32 v52, 0
    v_mov_b32 v53, 0
    v_mov_b32 v54, 0
    v_mov_b32 v55, 0
    buffer_store_dwordx4 v[52:55], v56, s[4:7], s31 offen offset:0 sc1
    buffer_store_dwordx4 v[52:55], v56, s[4:7], s31 offen offset:2048 sc1
    s_waitcnt vmcnt(0)
    s_mov_b32 s53, 1
    s_atomic_add s53, s[58:59], 0
L_p0_nz:
    v_bfe_u32 v2, v1, 4, 4
    v_lshrrev_b32 v3, 8, v1
    v_bfrev_b32 v6, 1
    v_mov_b32 v11, 0x3f803f80
    s_mul_i32 s30, s20, 9216
    s_cmp_lt_u32 s2, 144
    s_cbranch_scc1 L_p0_wi
    s_cmp_lt_u32 s2, 216
    s_cbranch_scc1 L_p0_wu
    v_mov_b32 v9, v6
    v_mov_b32 v10, v6
    v_mov_b32 v14, v6
    v_mov_b32 v15, v6
    s_mov_b32 s37, 0
    s_mov_b32 s38, 0
    s_mov_b32 s39, 0
    s_mov_b32 s40, 0
    s_mov_b32 s41, 0
    s_mov_b32 s42, 0
    s_mov_b32 s43, 0
    s_mov_b32 s47, 0
    s_mov_b32 s48, 0
    s_mov_b32 s49, 0
    s_barrier
    s_barrier
    s_barrier
    s_barrier
    s_barrier
    s_branch L_p0_ld
L_p0_wu:
    s_sub_u32 s26, s2, 144
    s_mul_i32 s28, s26, 57
    s_lshr_b32 s28, s28, 9
    s_mul_i32 s27, s28, 9
    s_sub_u32 s27, s26, s27
    s_mov_b32 s32, s50
    s_mov_b32 s33, s51
    s_mov_b32 s34, 0x288000
    s_mov_b32 s35, 0x20000
    s_mul_i32 s29, s28, 331776
    s_lshl_b32 s31, s27, 7
    s_add_u32 s29, s29, s31
    s_mul_i32 s31, s20, 82944
    s_add_u32 s29, s29, s31
    v_lshrrev_b32 v4, 7, v1
    v_mul_u32_u24 v4, 1152, v4
    v_and_b32 v5, 0x70, v1
    v_add_u32 v4, v4, v5
    s_barrier
    s_barrier
    s_barrier
    s_barrier
    s_barrier
    s_add_u32 m0, s30, 94208
    s_add_u32 s31, s29, 0
    buffer_load_dwordx4 v4, s[32:35], s31 offen  lds
    s_add_u32 m0, s30, 95232
    s_add_u32 s31, s29, 9216
    buffer_load_dwordx4 v4, s[32:35], s31 offen  lds
    s_add_u32 m0, s30, 96256
    s_add_u32 s31, s29, 18432
    buffer_load_dwordx4 v4, s[32:35], s31 offen  lds
    s_add_u32 m0, s30, 97280
    s_add_u32 s31, s29, 27648
    buffer_load_dwordx4 v4, s[32:35], s31 offen  lds
    s_add_u32 m0, s30, 98304
    s_add_u32 s31, s29, 36864
    buffer_load_dwordx4 v4, s[32:35], s31 offen  lds
    s_add_u32 m0, s30, 99328
    s_add_u32 s31, s29, 46080
    buffer_load_dwordx4 v4, s[32:35], s31 offen  lds
    s_add_u32 m0, s30, 100352
    s_add_u32 s31, s29, 55296
    buffer_load_dwordx4 v4, s[32:35], s31 offen  lds
    s_add_u32 m0, s30, 101376
    s_add_u32 s31, s29, 64512
    buffer_load_dwordx4 v4, s[32:35], s31 offen  lds
    s_add_u32 m0, s30, 102400
    s_add_u32 s31, s29, 73728
    buffer_load_dwordx4 v4, s[32:35], s31 offen  lds
    v_lshrrev_b32 v7, 2, v2
    v_and_b32 v8, 3, v2
    s_lshl_b32 s31, s20, 5
    s_add_u32 s31, s31, 94208
    v_lshlrev_b32 v9, 7, v7
    v_lshl_add_u32 v9, v8, 3, v9
    v_add_u32 v9, s31, v9
    v_mul_u32_u24 v4, 512, v3
    v_add_u32 v4, v4, v9
    v_mul_u32_u24 v5, 512, v3
    v_add_u32 v5, v5, v9
    s_lshl_b32 s31, s27, 2
    s_add_u32 s31, s31, s20
    v_lshl_add_u32 v7, s31, 2, v7
    v_lshlrev_b32 v8, 4, v8
    v_lshl_add_u32 v8, v3, 8, v8
    v_mul_u32_u24 v9, 57, v7
    v_lshrrev_b32 v9, 10, v9
    v_mul_u32_u24 v10, 18, v9
    v_sub_u32 v10, v7, v10
    v_lshrrev_b32 v12, 3, v10
    v_and_b32 v13, 1, v10
    v_lshl_add_u32 v12, v12, 1, v13
    v_bfe_u32 v14, v10, 1, 2
    v_cmp_gt_u32 vcc, 16, v10
    v_mul_u32_u24 v9, 331776, v9
    v_add_u32 v9, v9, v8
    v_cndmask_b32 v12, 8, v12, vcc
    v_cndmask_b32 v14, v13, v14, vcc
    v_mov_b32 v15, 0x1000
    v_mov_b32 v13, 0x80
    v_cndmask_b32 v15, v13, v15, vcc
    v_lshl_add_u32 v9, v12, 10, v9
    v_lshl_add_u32 v9, v14, 6, v9
    v_add_u32 v10, v9, v15
    s_and_b32 s31, s28, 1
    s_cmp_eq_u32 s31, 1
    s_cselect_b64 vcc, -1, 0
    v_cndmask_b32 v14, v9, v10, vcc
    s_mul_i32 s31, s28, 36864
    s_add_u32 s37, s31, 0x4100000
    s_add_u32 s38, s31, 0x4100000
    s_add_u32 s39, s31, 0x4102400
    s_add_u32 s40, s31, 0x4102400
    s_add_u32 s41, s31, 0x4104800
    s_add_u32 s42, s31, 0x4104800
    s_add_u32 s43, s31, 0x4106c00
    s_add_u32 s47, s31, 0x4106c00
    s_lshr_b32 s31, s28, 1
    s_mul_i32 s31, s31, 9216
    s_add_u32 s48, s31, 0x4148000
    v_mov_b32 v15, v6
    s_mov_b32 s49, 0
    s_branch L_p0_ld
L_p0_wi:
    s_mov_b32 s26, s2
    s_mul_i32 s28, s26, 57
    s_lshr_b32 s28, s28, 12
    s_mul_i32 s27, s28, 72
    s_sub_u32 s27, s26, s27
    s_mov_b32 s32, s44
    s_mov_b32 s33, s45
    s_mov_b32 s34, 0x510000
    s_mov_b32 s35, 0x20000
    s_mul_i32 s29, s28, 2654208
    s_lshl_b32 s31, s27, 7
    s_add_u32 s29, s29, s31
    s_mul_i32 s31, s20, 663552
    s_add_u32 s29, s29, s31
    v_lshrrev_b32 v4, 7, v1
    v_mul_u32_u24 v4, 9216, v4
    v_and_b32 v5, 0x70, v1
    v_add_u32 v4, v4, v5
    s_barrier
    s_barrier
    s_barrier
    s_barrier
    s_barrier
    s_add_u32 m0, s30, 94208
    s_add_u32 s31, s29, 0
    buffer_load_dwordx4 v4, s[32:35], s31 offen  lds
    s_add_u32 m0, s30, 95232
    s_add_u32 s31, s29, 73728
    buffer_load_dwordx4 v4, s[32:35], s31 offen  lds
    s_add_u32 m0, s30, 96256
    s_add_u32 s31, s29, 147456
    buffer_load_dwordx4 v4, s[32:35], s31 offen  lds
    s_add_u32 m0, s30, 97280
    s_add_u32 s31, s29, 221184
    buffer_load_dwordx4 v4, s[32:35], s31 offen  lds
    s_add_u32 m0, s30, 98304
    s_add_u32 s31, s29, 294912
    buffer_load_dwordx4 v4, s[32:35], s31 offen  lds
    s_add_u32 m0, s30, 99328
    s_add_u32 s31, s29, 368640
    buffer_load_dwordx4 v4, s[32:35], s31 offen  lds
    s_add_u32 m0, s30, 100352
    s_add_u32 s31, s29, 442368
    buffer_load_dwordx4 v4, s[32:35], s31 offen  lds
    s_add_u32 m0, s30, 101376
    s_add_u32 s31, s29, 516096
    buffer_load_dwordx4 v4, s[32:35], s31 offen  lds
    s_add_u32 m0, s30, 102400
    s_add_u32 s31, s29, 589824
    buffer_load_dwordx4 v4, s[32:35], s31 offen  lds
    v_lshrrev_b32 v7, 2, v2
    v_and_b32 v8, 3, v2
    s_lshl_b32 s31, s20, 5
    s_add_u32 s31, s31, 94208
    v_lshlrev_b32 v9, 7, v7
    v_lshl_add_u32 v9, v8, 3, v9
    v_add_u32 v9, s31, v9
    v_mul_u32_u24 v4, 1024, v3
    v_add_u32 v4, v4, v9
    v_mul_u32_u24 v5, 9216, v3
    v_add_u32 v5, v5, v9
    s_lshl_b32 s31, s27, 2
    s_add_u32 s31, s31, s20
    v_lshl_add_u32 v7, s31, 2, v7
    v_lshlrev_b32 v8, 4, v8
    v_lshl_add_u32 v8, v3, 8, v8
    s_cmp_lt_u32 s31, 144
    s_cselect_b32 s23, 1, 0
    s_cselect_b32 s24, 0, 144
    s_sub_u32 s26, s31, s24
    s_mul_i32 s25, s26, 57
    s_lshr_b32 s25, s25, 9
    s_mul_i32 s24, s25, 9
    s_sub_u32 s24, s26, s24
    s_lshl_b32 s26, s25, 1
    s_add_u32 s26, s26, s23
    s_mul_i32 s26, s26, 165888
    s_lshl_b32 s31, s24, 10
    s_add_u32 s26, s26, s31
    s_add_u32 s26, s26, 0x3b00000
    s_mul_i32 s31, s28, 9216
    s_add_u32 s48, s26, s31
    s_add_u32 s48, s48, 147456
    s_lshl_b32 s31, s31, 3
    s_add_u32 s26, s26, s31
    s_add_u32 s37, s26, 0
    s_add_u32 s38, s26, 9216
    s_add_u32 s39, s26, 18432
    s_add_u32 s40, s26, 27648
    s_add_u32 s41, s26, 36864
    s_add_u32 s42, s26, 46080
    s_add_u32 s43, s26, 55296
    s_add_u32 s47, s26, 64512
    s_lshl_b32 s49, s25, 12
    s_mul_i32 s31, s28, 1152
    s_add_u32 s49, s49, s31
    s_mul_i32 s31, s23, 576
    s_add_u32 s49, s49, s31
    s_lshl_b32 s31, s24, 6
    s_add_u32 s49, s49, s31
    s_add_u32 s49, s49, 0x4410000
    v_cmp_eq_u32 vcc, 0, v3
    v_lshlrev_b32 v15, 2, v2
    v_mov_b32 v9, v1
    v_mov_b32 v10, v1
    v_mov_b32 v14, v1
    v_cndmask_b32 v15, v6, v15, vcc
L_p0_ld:
    s_waitcnt lgkmcnt(0)
    s_branch L_m_l1
L_m_cl:
    s_and_b32 s25, s2, 7
    s_lshr_b32 s26, s2, 3
    s_lshr_b32 s23, s25, 1
    s_lshl_b32 s23, s23, 2
    s_lshr_b32 s27, s26, 3
    s_add_u32 s23, s23, s27
    s_and_b32 s24, s25, 1
    s_lshl_b32 s24, s24, 3
    s_and_b32 s27, s26, 7
    s_add_u32 s24, s24, s27
    s_lshl_b32 s30, s23, 3
    s_lshl_b32 s31, s20, 1
    s_add_u32 s31, s30, s31
    s_mul_i32 s29, s31, 18432
    s_add_u32 s29, s29, s21
    s_add_u32 s35, s29, 0x600000
    s_add_u32 s29, s29, 0x0
    s_max_u32 s30, s30, 1
    s_sub_u32 s30, s30, 1
    s_lshl_b32 s30, s30, 10
    s_add_u32 s30, s30, s21
    s_add_u32 s30, s30, 0x1b00000
    s_lshl_b32 s32, s31, 10
    s_add_u32 s32, s32, s21
    s_add_u32 s32, s32, 0x1b00000
    v_bfe_u32 v2, v1, 4, 4
    v_lshrrev_b32 v3, 8, v1
    s_add_u32 s33, s20, 2
    s_add_u32 s34, s20, 4
    s_cmp_ge_u32 s20, 2
    s_cselect_b32 s33, 6, s33
    s_cselect_b32 s34, 6, s34
    s_lshl_b32 s36, s33, 10
    s_lshl_b32 s37, s34, 10
    v_add_u32 v247, 64512, v1
    v_add_u32 v248, 131072, v1
    v_add_u32 v249, s36, v1
    v_add_u32 v250, s36, v247
    v_add_u32 v251, s37, v1
    v_add_u32 v252, s37, v247
    v_add_u32 v253, 18432, v1
    v_lshrrev_b32 v0, 1, v1
    s_add_u32 s38, s29, 0
    s_add_u32 s39, s29, 4096
    s_add_u32 s40, s29, 8192
    s_add_u32 s41, s29, 12288
    s_add_u32 s42, s29, 16384
    s_max_u32 s44, s23, 1
    s_sub_u32 s44, s44, 1
    s_lshl_b32 s52, s22, 7
    s_add_u32 s52, s52, s23
    s_lshl_b32 s52, s52, 8
    s_add_u32 s52, s52, 0x4503000
    s_add_u32 s52, s52, s4
    s_addc_u32 s53, s5, 0
    s_lshl_b32 s54, s22, 7
    s_add_u32 s54, s54, s44
    s_lshl_b32 s54, s54, 8
    s_add_u32 s54, s54, 0x4503000
    s_add_u32 s54, s54, s4
    s_addc_u32 s55, s5, 0
    s_lshl_b32 s44, s24, 8
    s_add_u32 s44, s44, 0x4500000
    s_add_u32 s44, s44, s4
    s_addc_u32 s45, s5, 0
    s_waitcnt vmcnt(0)
    s_barrier
    s_cmp_lg_u32 s20, 0
    s_cbranch_scc1 L_ns_d1
    s_atomic_add s46, s[50:51], 0
    s_cmp_eq_u32 s47, 0
    s_cbranch_scc1 L_ns_d1
    s_atomic_add s47, s[48:49], 0
L_ns_d1:
    s_barrier
    s_cmp_lg_u32 s20, 0
    s_cbranch_scc1 L_pd_d1
    s_mov_b32 s60, 65536
L_poll_d1:
    s_mov_b32 s57, 0
    s_atomic_add s57, s[52:53], 0 glc
    s_mov_b32 s58, 0
    s_atomic_add s58, s[54:55], 0 glc
    s_mov_b32 s59, 0
    s_atomic_add s59, s[44:45], 0 glc
    s_waitcnt lgkmcnt(0)
    s_min_u32 s57, s57, s58
    s_min_u32 s57, s57, s59
    s_cmp_ge_u32 s57, 16
    s_cbranch_scc1 L_pd_d1
    s_sub_u32 s60, s60, 1
    s_cbranch_scc1 L_pd_d1
    s_sleep 2
    s_branch L_poll_d1
L_pd_d1:
    s_barrier
    buffer_load_dwordx4 v[168:171], v1, s[4:7], s38 offen offset:0 sc1
    buffer_load_dwordx4 v[172:175], v253, s[4:7], s38 offen offset:0 sc1
    buffer_load_dwordx2 v[4:5], v0, s[4:7], s30 offen offset:0 sc1
    buffer_load_dwordx2 v[6:7], v0, s[4:7], s30 offen offset:512 sc1
    buffer_load_dwordx2 v[8:9], v0, s[4:7], s32 offen offset:0 sc1
    buffer_load_dwordx2 v[10:11], v0, s[4:7], s32 offen offset:512 sc1
    buffer_load_dwordx2 v[12:13], v0, s[4:7], s32 offen offset:1024 sc1
    buffer_load_dwordx2 v[14:15], v0, s[4:7], s32 offen offset:1536 sc1
    buffer_load_dwordx4 v[176:179], v1, s[4:7], s38 offen offset:1024 sc1
    buffer_load_dwordx4 v[180:183], v253, s[4:7], s38 offen offset:1024 sc1
    buffer_load_dwordx4 v[184:187], v1, s[4:7], s38 offen offset:2048 sc1
    buffer_load_dwordx4 v[188:191], v253, s[4:7], s38 offen offset:2048 sc1
    buffer_load_dwordx4 v[192:195], v1, s[4:7], s38 offen offset:3072 sc1
    buffer_load_dwordx4 v[196:199], v253, s[4:7], s38 offen offset:3072 sc1
    s_lshl_b32 s50, s22, 7
    s_add_u32 s50, s50, s23
    s_lshl_b32 s50, s50, 8
    s_add_u32 s50, s50, 0x4508000
    s_add_u32 s50, s50, s4
    s_addc_u32 s51, s5, 0
    s_barrier
    ds_read_b128 v[88:91], v1 offset:0
    ds_read_b128 v[92:95], v1 offset:1024
    ds_read_b128 v[96:99], v1 offset:2048
    ds_read_b128 v[100:103], v1 offset:3072
    ds_read_b128 v[104:107], v1 offset:4096
    ds_read_b128 v[108:111], v1 offset:5120
    ds_read_b128 v[112:115], v1 offset:6144
    ds_read_b128 v[116:119], v248 offset:0
    ds_read_b128 v[120:123], v249 offset:0
    ds_read_b128 v[124:127], v251 offset:0
    s_waitcnt vmcnt(12) lgkmcnt(6)
    v_mfma_f32_16x16x32_bf16 v[16:19], v[88:91], v[168:171], 0
    ds_read_b128 v[128:131], v1 offset:7168
    v_mfma_f32_16x16x32_bf16 v[48:51], v[88:91], v[172:175], 0
    ds_read_b128 v[132:135], v1 offset:8192
    v_mfma_f32_16x16x32_bf16 v[20:23], v[92:95], v[168:171], 0
    ds_read_b128 v[136:139], v1 offset:9216
    v_mfma_f32_16x16x32_bf16 v[52:55], v[92:95], v[172:175], 0
    ds_read_b128 v[140:143], v1 offset:10240
    v_mfma_f32_16x16x32_bf16 v[24:27], v[96:99], v[168:171], 0
    ds_read_b128 v[144:147], v1 offset:11264
    v_mfma_f32_16x16x32_bf16 v[56:59], v[96:99], v[172:175], 0
    ds_read_b128 v[148:151], v1 offset:12288
    v_mfma_f32_16x16x32_bf16 v[28:31], v[100:103], v[168:171], 0
    ds_read_b128 v[152:155], v1 offset:13312
    v_mfma_f32_16x16x32_bf16 v[60:63], v[100:103], v[172:175], 0
    ds_read_b128 v[156:159], v248 offset:1024
    s_waitcnt lgkmcnt(8)
    v_mfma_f32_16x16x32_bf16 v[36:39], v[168:171], v[104:107], 0
    ds_read_b128 v[160:163], v249 offset:7168
    v_mfma_f32_16x16x32_bf16 v[68:71], v[172:175], v[104:107], 0
    ds_read_b128 v[164:167], v251 offset:7168
    v_mfma_f32_16x16x32_bf16 v[40:43], v[168:171], v[108:111], 0
    buffer_load_dwordx4 v[200:203], v1, s[4:7], s39 offen offset:0 sc1
    v_mfma_f32_16x16x32_bf16 v[72:75], v[172:175], v[108:111], 0
    v_mfma_f32_16x16x32_bf16 v[32:35], v[112:115], v[168:171], 0
    buffer_load_dwordx4 v[204:207], v253, s[4:7], s39 offen offset:0 sc1
    v_mfma_f32_16x16x32_bf16 v[64:67], v[112:115], v[172:175], 0
    v_mfma_f32_16x16x32_bf16 v[44:47], v[168:171], v[112:115], 0
    buffer_load_dwordx4 v[208:211], v1, s[4:7], s39 offen offset:1024 sc1
    v_mfma_f32_16x16x32_bf16 v[76:79], v[172:175], v[112:115], 0
    v_mfma_f32_16x16x32_bf16 v[80:83], v[120:123], v[116:119], 0
    buffer_load_dwordx4 v[212:215], v253, s[4:7], s39 offen offset:1024 sc1
    v_mfma_f32_16x16x32_bf16 v[84:87], v[116:119], v[124:127], 0
    s_waitcnt vmcnt(8) lgkmcnt(6)
    s_barrier
    v_mfma_f32_16x16x32_bf16 v[16:19], v[128:131], v[176:179], v[16:19]
    ds_read_b128 v[88:91], v1 offset:14336
    v_mfma_f32_16x16x32_bf16 v[48:51], v[128:131], v[180:183], v[48:51]
    ds_read_b128 v[92:95], v1 offset:15360
    v_mfma_f32_16x16x32_bf16 v[20:23], v[132:135], v[176:179], v[20:23]
    ds_read_b128 v[96:99], v1 offset:16384
    v_mfma_f32_16x16x32_bf16 v[52:55], v[132:135], v[180:183], v[52:55]
    ds_read_b128 v[100:103], v1 offset:17408
    v_mfma_f32_16x16x32_bf16 v[24:27], v[136:139], v[176:179], v[24:27]
    ds_read_b128 v[104:107], v1 offset:18432
    v_mfma_f32_16x16x32_bf16 v[56:59], v[136:139], v[180:183], v[56:59]
    ds_read_b128 v[108:111], v1 offset:19456
    v_mfma_f32_16x16x32_bf16 v[28:31], v[140:143], v[176:179], v[28:31]
    ds_read_b128 v[112:115], v1 offset:20480
    v_mfma_f32_16x16x32_bf16 v[60:63], v[140:143], v[180:183], v[60:63]
    ds_read_b128 v[116:119], v248 offset:2048
    s_waitcnt lgkmcnt(8)
    v_mfma_f32_16x16x32_bf16 v[36:39], v[176:179], v[144:147], v[36:39]
    ds_read_b128 v[120:123], v249 offset:14336
    v_add_f32 v240, v4, v6
    v_mfma_f32_16x16x32_bf16 v[68:71], v[180:183], v[144:147], v[68:71]
    ds_read_b128 v[124:127], v251 offset:14336
    v_add_f32 v241, v5, v7
    v_mfma_f32_16x16x32_bf16 v[40:43], v[176:179], v[148:151], v[40:43]
    buffer_load_dwordx4 v[216:219], v1, s[4:7], s39 offen offset:2048 sc1
    v_add_f32 v242, v8, v10
    v_mfma_f32_16x16x32_bf16 v[72:75], v[180:183], v[148:151], v[72:75]
    v_add_f32 v243, v9, v11
    v_mfma_f32_16x16x32_bf16 v[32:35], v[152:155], v[176:179], v[32:35]
    buffer_load_dwordx4 v[220:223], v253, s[4:7], s39 offen offset:2048 sc1
    v_add_f32 v244, v12, v14
    v_mfma_f32_16x16x32_bf16 v[64:67], v[152:155], v[180:183], v[64:67]
    v_add_f32 v245, v13, v15
    v_mfma_f32_16x16x32_bf16 v[44:47], v[176:179], v[152:155], v[44:47]
    buffer_load_dwordx4 v[224:227], v1, s[4:7], s39 offen offset:3072 sc1
    v_mov_b32 v4, v240
    v_mfma_f32_16x16x32_bf16 v[76:79], v[180:183], v[152:155], v[76:79]
    v_mov_b32 v5, v241
    v_mfma_f32_16x16x32_bf16 v[80:83], v[160:163], v[156:159], v[80:83]
    buffer_load_dwordx4 v[228:231], v253, s[4:7], s39 offen offset:3072 sc1
    v_mov_b32 v8, v242
    v_mfma_f32_16x16x32_bf16 v[84:87], v[156:159], v[164:167], v[84:87]
    v_mov_b32 v9, v243
    s_waitcnt vmcnt(10) lgkmcnt(6)
    v_mfma_f32_16x16x32_bf16 v[16:19], v[88:91], v[184:187], v[16:19]
    ds_read_b128 v[128:131], v1 offset:21504
    v_mfma_f32_16x16x32_bf16 v[48:51], v[88:91], v[188:191], v[48:51]
    ds_read_b128 v[132:135], v1 offset:22528
    v_mfma_f32_16x16x32_bf16 v[20:23], v[92:95], v[184:187], v[20:23]
    ds_read_b128 v[136:139], v1 offset:23552
    v_mfma_f32_16x16x32_bf16 v[52:55], v[92:95], v[188:191], v[52:55]
    ds_read_b128 v[140:143], v1 offset:24576
    v_mfma_f32_16x16x32_bf16 v[24:27], v[96:99], v[184:187], v[24:27]
    ds_read_b128 v[144:147], v1 offset:25600
    v_mfma_f32_16x16x32_bf16 v[56:59], v[96:99], v[188:191], v[56:59]
    ds_read_b128 v[148:151], v1 offset:26624
    v_mfma_f32_16x16x32_bf16 v[28:31], v[100:103], v[184:187], v[28:31]
    ds_read_b128 v[152:155], v1 offset:27648
    v_mfma_f32_16x16x32_bf16 v[60:63], v[100:103], v[188:191], v[60:63]
    ds_read_b128 v[156:159], v248 offset:3072
    s_waitcnt lgkmcnt(8)
    v_mfma_f32_16x16x32_bf16 v[36:39], v[184:187], v[104:107], v[36:39]
    ds_read_b128 v[160:163], v249 offset:21504
    v_mov_b32 v12, v244
    v_mfma_f32_16x16x32_bf16 v[68:71], v[188:191], v[104:107], v[68:71]
    ds_read_b128 v[164:167], v251 offset:21504
    v_mov_b32 v13, v245
    v_mfma_f32_16x16x32_bf16 v[40:43], v[184:187], v[108:111], v[40:43]
    buffer_load_dwordx4 v[232:235], v1, s[4:7], s40 offen offset:0 sc1
    v_permlane32_swap_b32 v240, v4
    v_mfma_f32_16x16x32_bf16 v[72:75], v[188:191], v[108:111], v[72:75]
    v_permlane32_swap_b32 v241, v5
    v_mfma_f32_16x16x32_bf16 v[32:35], v[112:115], v[184:187], v[32:35]
    buffer_load_dwordx4 v[236:239], v253, s[4:7], s40 offen offset:0 sc1
    v_permlane32_swap_b32 v242, v8
    v_mfma_f32_16x16x32_bf16 v[64:67], v[112:115], v[188:191], v[64:67]
    v_permlane32_swap_b32 v243, v9
    v_mfma_f32_16x16x32_bf16 v[44:47], v[184:187], v[112:115], v[44:47]
    buffer_load_dwordx4 v[168:171], v1, s[4:7], s40 offen offset:1024 sc1
    v_permlane32_swap_b32 v244, v12
    v_mfma_f32_16x16x32_bf16 v[76:79], v[188:191], v[112:115], v[76:79]
    v_permlane32_swap_b32 v245, v13
    v_mfma_f32_16x16x32_bf16 v[80:83], v[120:123], v[116:119], v[80:83]
    buffer_load_dwordx4 v[172:175], v253, s[4:7], s40 offen offset:1024 sc1
    v_add_f32 v240, v240, v4
    v_mfma_f32_16x16x32_bf16 v[84:87], v[116:119], v[124:127], v[84:87]
    v_add_f32 v241, v241, v5
    s_waitcnt vmcnt(12) lgkmcnt(6)
    s_barrier
    v_mfma_f32_16x16x32_bf16 v[16:19], v[128:131], v[192:195], v[16:19]
    ds_read_b128 v[88:91], v1 offset:28672
    v_mfma_f32_16x16x32_bf16 v[48:51], v[128:131], v[196:199], v[48:51]
    ds_read_b128 v[92:95], v1 offset:29696
    v_mfma_f32_16x16x32_bf16 v[20:23], v[132:135], v[192:195], v[20:23]
    ds_read_b128 v[96:99], v1 offset:30720
    v_mfma_f32_16x16x32_bf16 v[52:55], v[132:135], v[196:199], v[52:55]
    ds_read_b128 v[100:103], v1 offset:31744
    v_mfma_f32_16x16x32_bf16 v[24:27], v[136:139], v[192:195], v[24:27]
    ds_read_b128 v[104:107], v1 offset:32768
    v_mfma_f32_16x16x32_bf16 v[56:59], v[136:139], v[196:199], v[56:59]
    ds_read_b128 v[108:111], v1 offset:33792
    v_mfma_f32_16x16x32_bf16 v[28:31], v[140:143], v[192:195], v[28:31]
    ds_read_b128 v[112:115], v1 offset:34816
    v_mfma_f32_16x16x32_bf16 v[60:63], v[140:143], v[196:199], v[60:63]
    ds_read_b128 v[116:119], v248 offset:4096
    s_waitcnt lgkmcnt(8)
    v_mfma_f32_16x16x32_bf16 v[36:39], v[192:195], v[144:147], v[36:39]
    ds_read_b128 v[120:123], v249 offset:28672
    v_add_f32 v242, v242, v8
    v_mfma_f32_16x16x32_bf16 v[68:71], v[196:199], v[144:147], v[68:71]
    ds_read_b128 v[124:127], v251 offset:28672
    v_add_f32 v243, v243, v9
    v_mfma_f32_16x16x32_bf16 v[40:43], v[192:195], v[148:151], v[40:43]
    buffer_load_dwordx4 v[176:179], v1, s[4:7], s40 offen offset:2048 sc1
    v_add_f32 v244, v244, v12
    v_mfma_f32_16x16x32_bf16 v[72:75], v[196:199], v[148:151], v[72:75]
    v_add_f32 v245, v245, v13
    v_mfma_f32_16x16x32_bf16 v[32:35], v[152:155], v[192:195], v[32:35]
    buffer_load_dwordx4 v[180:183], v253, s[4:7], s40 offen offset:2048 sc1
    v_mov_b32 v4, v240
    v_mfma_f32_16x16x32_bf16 v[64:67], v[152:155], v[196:199], v[64:67]
    v_mov_b32 v5, v241
    v_mfma_f32_16x16x32_bf16 v[44:47], v[192:195], v[152:155], v[44:47]
    buffer_load_dwordx4 v[184:187], v1, s[4:7], s40 offen offset:3072 sc1
    v_mov_b32 v8, v242
    v_mfma_f32_16x16x32_bf16 v[76:79], v[196:199], v[152:155], v[76:79]
    v_mov_b32 v9, v243
    v_mfma_f32_16x16x32_bf16 v[80:83], v[160:163], v[156:159], v[80:83]
    buffer_load_dwordx4 v[188:191], v253, s[4:7], s40 offen offset:3072 sc1
    v_mov_b32 v12, v244
    v_mfma_f32_16x16x32_bf16 v[84:87], v[156:159], v[164:167], v[84:87]
    v_mov_b32 v13, v245
    s_waitcnt vmcnt(14) lgkmcnt(6)
    v_mfma_f32_16x16x32_bf16 v[16:19], v[88:91], v[200:203], v[16:19]
    ds_read_b128 v[128:131], v1 offset:35840
    v_mfma_f32_16x16x32_bf16 v[48:51], v[88:91], v[204:207], v[48:51]
    ds_read_b128 v[132:135], v1 offset:36864
    v_mfma_f32_16x16x32_bf16 v[20:23], v[92:95], v[200:203], v[20:23]
    ds_read_b128 v[136:139], v1 offset:37888
    v_mfma_f32_16x16x32_bf16 v[52:55], v[92:95], v[204:207], v[52:55]
    ds_read_b128 v[140:143], v1 offset:38912
    v_mfma_f32_16x16x32_bf16 v[24:27], v[96:99], v[200:203], v[24:27]
    ds_read_b128 v[144:147], v1 offset:39936
    v_mfma_f32_16x16x32_bf16 v[56:59], v[96:99], v[204:207], v[56:59]
    ds_read_b128 v[148:151], v1 offset:40960
    v_mfma_f32_16x16x32_bf16 v[28:31], v[100:103], v[200:203], v[28:31]
    ds_read_b128 v[152:155], v1 offset:41984
    v_mfma_f32_16x16x32_bf16 v[60:63], v[100:103], v[204:207], v[60:63]
    ds_read_b128 v[156:159], v248 offset:5120
    s_waitcnt lgkmcnt(8)
    v_mfma_f32_16x16x32_bf16 v[36:39], v[200:203], v[104:107], v[36:39]
    ds_read_b128 v[160:163], v249 offset:35840
    v_permlane16_swap_b32 v240, v4
    v_mfma_f32_16x16x32_bf16 v[68:71], v[204:207], v[104:107], v[68:71]
    ds_read_b128 v[164:167], v251 offset:35840
    v_permlane16_swap_b32 v241, v5
    v_mfma_f32_16x16x32_bf16 v[40:43], v[200:203], v[108:111], v[40:43]
    buffer_load_dwordx4 v[192:195], v1, s[4:7], s41 offen offset:0 sc1
    v_permlane16_swap_b32 v242, v8
    v_mfma_f32_16x16x32_bf16 v[72:75], v[204:207], v[108:111], v[72:75]
    v_permlane16_swap_b32 v243, v9
    v_mfma_f32_16x16x32_bf16 v[32:35], v[112:115], v[200:203], v[32:35]
    buffer_load_dwordx4 v[196:199], v253, s[4:7], s41 offen offset:0 sc1
    v_permlane16_swap_b32 v244, v12
    v_mfma_f32_16x16x32_bf16 v[64:67], v[112:115], v[204:207], v[64:67]
    v_permlane16_swap_b32 v245, v13
    v_mfma_f32_16x16x32_bf16 v[44:47], v[200:203], v[112:115], v[44:47]
    v_add_f32 v240, v240, v4
    v_mfma_f32_16x16x32_bf16 v[76:79], v[204:207], v[112:115], v[76:79]
    v_add_f32 v241, v241, v5
    v_mfma_f32_16x16x32_bf16 v[80:83], v[120:123], v[116:119], v[80:83]
    v_add_f32 v242, v242, v8
    v_mfma_f32_16x16x32_bf16 v[84:87], v[116:119], v[124:127], v[84:87]
    v_add_f32 v243, v243, v9
    s_waitcnt vmcnt(14) lgkmcnt(6)
    s_barrier
    v_mfma_f32_16x16x32_bf16 v[16:19], v[128:131], v[208:211], v[16:19]
    ds_read_b128 v[88:91], v1 offset:43008
    v_mfma_f32_16x16x32_bf16 v[48:51], v[128:131], v[212:215], v[48:51]
    ds_read_b128 v[92:95], v1 offset:44032
    v_mfma_f32_16x16x32_bf16 v[20:23], v[132:135], v[208:211], v[20:23]
    ds_read_b128 v[96:99], v1 offset:45056
    v_mfma_f32_16x16x32_bf16 v[52:55], v[132:135], v[212:215], v[52:55]
    ds_read_b128 v[100:103], v1 offset:46080
    v_mfma_f32_16x16x32_bf16 v[24:27], v[136:139], v[208:211], v[24:27]
    ds_read_b128 v[104:107], v1 offset:47104
    v_mfma_f32_16x16x32_bf16 v[56:59], v[136:139], v[212:215], v[56:59]
    ds_read_b128 v[108:111], v1 offset:48128
    v_mfma_f32_16x16x32_bf16 v[28:31], v[140:143], v[208:211], v[28:31]
    ds_read_b128 v[112:115], v1 offset:49152
    v_mfma_f32_16x16x32_bf16 v[60:63], v[140:143], v[212:215], v[60:63]
    ds_read_b128 v[116:119], v248 offset:6144
    s_waitcnt lgkmcnt(8)
    v_mfma_f32_16x16x32_bf16 v[36:39], v[208:211], v[144:147], v[36:39]
    ds_read_b128 v[120:123], v249 offset:43008
    v_add_f32 v244, v244, v12
    v_mfma_f32_16x16x32_bf16 v[68:71], v[212:215], v[144:147], v[68:71]
    ds_read_b128 v[124:127], v251 offset:43008
    v_add_f32 v245, v245, v13
    v_mfma_f32_16x16x32_bf16 v[40:43], v[208:211], v[148:151], v[40:43]
    buffer_load_dwordx4 v[200:203], v1, s[4:7], s41 offen offset:1024 sc1
    v_mul_f32 v240, 0x3ae38e39, v240
    v_mfma_f32_16x16x32_bf16 v[72:75], v[212:215], v[148:151], v[72:75]
    v_mul_f32 v241, 0x3ae38e39, v241
    v_mfma_f32_16x16x32_bf16 v[32:35], v[152:155], v[208:211], v[32:35]
    buffer_load_dwordx4 v[204:207], v253, s[4:7], s41 offen offset:1024 sc1
    v_mul_f32 v242, 0x3ae38e39, v242
    v_mfma_f32_16x16x32_bf16 v[64:67], v[152:155], v[212:215], v[64:67]
    v_mul_f32 v243, 0x3ae38e39, v243
    v_mfma_f32_16x16x32_bf16 v[44:47], v[208:211], v[152:155], v[44:47]
    v_mul_f32 v244, 0x3ae38e39, v244
    v_mfma_f32_16x16x32_bf16 v[76:79], v[212:215], v[152:155], v[76:79]
    v_mul_f32 v245, 0x3ae38e39, v245
    v_mfma_f32_16x16x32_bf16 v[80:83], v[160:163], v[156:159], v[80:83]
    v_fma_f32 v241, -v240, v240, v241
    v_mfma_f32_16x16x32_bf16 v[84:87], v[156:159], v[164:167], v[84:87]
    v_fma_f32 v243, -v242, v242, v243
    s_waitcnt vmcnt(14) lgkmcnt(6)
    v_mfma_f32_16x16x32_bf16 v[16:19], v[88:91], v[216:219], v[16:19]
    ds_read_b128 v[128:131], v1 offset:50176
    v_mfma_f32_16x16x32_bf16 v[48:51], v[88:91], v[220:223], v[48:51]
    ds_read_b128 v[132:135], v1 offset:51200
    v_mfma_f32_16x16x32_bf16 v[20:23], v[92:95], v[216:219], v[20:23]
    ds_read_b128 v[136:139], v1 offset:52224
    v_mfma_f32_16x16x32_bf16 v[52:55], v[92:95], v[220:223], v[52:55]
    ds_read_b128 v[140:143], v1 offset:53248
    v_mfma_f32_16x16x32_bf16 v[24:27], v[96:99], v[216:219], v[24:27]
    ds_read_b128 v[144:147], v1 offset:54272
    v_mfma_f32_16x16x32_bf16 v[56:59], v[96:99], v[220:223], v[56:59]
    ds_read_b128 v[148:151], v1 offset:55296
    v_mfma_f32_16x16x32_bf16 v[28:31], v[100:103], v[216:219], v[28:31]
    ds_read_b128 v[152:155], v1 offset:56320
    v_mfma_f32_16x16x32_bf16 v[60:63], v[100:103], v[220:223], v[60:63]
    ds_read_b128 v[156:159], v248 offset:7168
    s_waitcnt lgkmcnt(8)
    v_mfma_f32_16x16x32_bf16 v[36:39], v[216:219], v[104:107], v[36:39]
    ds_read_b128 v[160:163], v249 offset:50176
    v_fma_f32 v245, -v244, v244, v245
    v_mfma_f32_16x16x32_bf16 v[68:71], v[220:223], v[104:107], v[68:71]
    ds_read_b128 v[164:167], v251 offset:50176
    v_max_f32 v241, 0, v241
    v_mfma_f32_16x16x32_bf16 v[40:43], v[216:219], v[108:111], v[40:43]
    buffer_load_dwordx4 v[208:211], v1, s[4:7], s41 offen offset:2048 sc1
    v_max_f32 v243, 0, v243
    v_mfma_f32_16x16x32_bf16 v[72:75], v[220:223], v[108:111], v[72:75]
    v_max_f32 v245, 0, v245
    v_mfma_f32_16x16x32_bf16 v[32:35], v[112:115], v[216:219], v[32:35]
    buffer_load_dwordx4 v[212:215], v253, s[4:7], s41 offen offset:2048 sc1
    v_add_f32 v241, 0x3727c5ac, v241
    v_mfma_f32_16x16x32_bf16 v[64:67], v[112:115], v[220:223], v[64:67]
    v_add_f32 v243, 0x3727c5ac, v243
    v_mfma_f32_16x16x32_bf16 v[44:47], v[216:219], v[112:115], v[44:47]
    v_add_f32 v245, 0x3727c5ac, v245
    v_mfma_f32_16x16x32_bf16 v[76:79], v[220:223], v[112:115], v[76:79]
    v_rsq_f32 v241, v241
    v_mfma_f32_16x16x32_bf16 v[80:83], v[120:123], v[116:119], v[80:83]
    v_rsq_f32 v243, v243
    v_mfma_f32_16x16x32_bf16 v[84:87], v[116:119], v[124:127], v[84:87]
    v_rsq_f32 v245, v245
    s_waitcnt vmcnt(14) lgkmcnt(6)
    v_mfma_f32_16x16x32_bf16 v[16:19], v[128:131], v[224:227], v[16:19]
    ds_read_b128 v[88:91], v1 offset:57344
    v_mfma_f32_16x16x32_bf16 v[48:51], v[128:131], v[228:231], v[48:51]
    ds_read_b128 v[92:95], v1 offset:58368
    v_mfma_f32_16x16x32_bf16 v[20:23], v[132:135], v[224:227], v[20:23]
    ds_read_b128 v[96:99], v1 offset:59392
    v_mfma_f32_16x16x32_bf16 v[52:55], v[132:135], v[228:231], v[52:55]
    ds_read_b128 v[100:103], v1 offset:60416
    v_mfma_f32_16x16x32_bf16 v[24:27], v[136:139], v[224:227], v[24:27]
    ds_read_b128 v[104:107], v1 offset:61440
    v_mfma_f32_16x16x32_bf16 v[56:59], v[136:139], v[228:231], v[56:59]
    ds_read_b128 v[108:111], v1 offset:62464
    v_mfma_f32_16x16x32_bf16 v[28:31], v[140:143], v[224:227], v[28:31]
    ds_read_b128 v[112:115], v1 offset:63488
    v_mfma_f32_16x16x32_bf16 v[60:63], v[140:143], v[228:231], v[60:63]
    ds_read_b128 v[116:119], v248 offset:8192
    s_waitcnt lgkmcnt(8)
    v_mfma_f32_16x16x32_bf16 v[36:39], v[224:227], v[144:147], v[36:39]
    ds_read_b128 v[120:123], v249 offset:57344
    s_nop 0
    v_mfma_f32_16x16x32_bf16 v[68:71], v[228:231], v[144:147], v[68:71]
    ds_read_b128 v[124:127], v251 offset:57344
    v_lshlrev_b32 v9, 4, v3
    v_mfma_f32_16x16x32_bf16 v[40:43], v[224:227], v[148:151], v[40:43]
    buffer_load_dwordx4 v[216:219], v1, s[4:7], s41 offen offset:3072 sc1
    v_add_u32 v4, 161792, v9
    v_mfma_f32_16x16x32_bf16 v[72:75], v[228:231], v[148:151], v[72:75]
    s_lshl_b32 s36, s33, 6
    v_mfma_f32_16x16x32_bf16 v[32:35], v[152:155], v[224:227], v[32:35]
    buffer_load_dwordx4 v[220:223], v253, s[4:7], s41 offen offset:3072 sc1
    v_add_u32 v5, s36, v4
    v_mfma_f32_16x16x32_bf16 v[64:67], v[152:155], v[228:231], v[64:67]
    v_lshlrev_b32 v8, 2, v2
    v_mfma_f32_16x16x32_bf16 v[44:47], v[224:227], v[152:155], v[44:47]
    v_add_u32 v6, 161792, v8
    v_mfma_f32_16x16x32_bf16 v[76:79], v[228:231], v[152:155], v[76:79]
    s_lshl_b32 s37, s34, 6
    v_mfma_f32_16x16x32_bf16 v[80:83], v[160:163], v[156:159], v[80:83]
    v_add_u32 v7, s37, v6
    v_mfma_f32_16x16x32_bf16 v[84:87], v[156:159], v[164:167], v[84:87]
    s_mul_i32 s36, s20, 3072
    s_waitcnt vmcnt(14) lgkmcnt(6)
    s_barrier
    v_mfma_f32_16x16x32_bf16 v[16:19], v[88:91], v[232:235], v[16:19]
    ds_read_b128 v[128:131], v247 offset:0
    v_mfma_f32_16x16x32_bf16 v[48:51], v[88:91], v[236:239], v[48:51]
    ds_read_b128 v[132:135], v247 offset:1024
    v_mfma_f32_16x16x32_bf16 v[20:23], v[92:95], v[232:235], v[20:23]
    ds_read_b128 v[136:139], v247 offset:2048
    v_mfma_f32_16x16x32_bf16 v[52:55], v[92:95], v[236:239], v[52:55]
    ds_read_b128 v[140:143], v247 offset:3072
    v_mfma_f32_16x16x32_bf16 v[24:27], v[96:99], v[232:235], v[24:27]
    ds_read_b128 v[144:147], v247 offset:4096
    v_mfma_f32_16x16x32_bf16 v[56:59], v[96:99], v[236:239], v[56:59]
    ds_read_b128 v[148:151], v247 offset:5120
    v_mfma_f32_16x16x32_bf16 v[28:31], v[100:103], v[232:235], v[28:31]
    ds_read_b128 v[152:155], v247 offset:6144
    v_mfma_f32_16x16x32_bf16 v[60:63], v[100:103], v[236:239], v[60:63]
    ds_read_b128 v[156:159], v248 offset:9216
    s_waitcnt lgkmcnt(8)
    v_mfma_f32_16x16x32_bf16 v[36:39], v[232:235], v[104:107], v[36:39]
    ds_read_b128 v[160:163], v250 offset:0
    s_add_u32 s36, s36, 153600
    v_mfma_f32_16x16x32_bf16 v[68:71], v[236:239], v[104:107], v[68:71]
    ds_read_b128 v[164:167], v252 offset:0
    v_add_u32 v8, s36, v8
    v_mfma_f32_16x16x32_bf16 v[40:43], v[232:235], v[108:111], v[40:43]
    buffer_load_dwordx4 v[224:227], v1, s[4:7], s42 offen offset:0 sc1
    v_add_u32 v9, s36, v9
    v_mfma_f32_16x16x32_bf16 v[72:75], v[236:239], v[108:111], v[72:75]
    v_add_u32 v10, 256, v6
    v_mfma_f32_16x16x32_bf16 v[32:35], v[112:115], v[232:235], v[32:35]
    buffer_load_dwordx4 v[228:231], v253, s[4:7], s42 offen offset:0 sc1
    v_add_u32 v11, 320, v6
    v_mfma_f32_16x16x32_bf16 v[64:67], v[112:115], v[236:239], v[64:67]
    v_add_u32 v12, 384, v6
    v_mfma_f32_16x16x32_bf16 v[44:47], v[232:235], v[112:115], v[44:47]
    v_mfma_f32_16x16x32_bf16 v[76:79], v[236:239], v[112:115], v[76:79]
    v_mfma_f32_16x16x32_bf16 v[80:83], v[120:123], v[116:119], v[80:83]
    v_mfma_f32_16x16x32_bf16 v[84:87], v[116:119], v[124:127], v[84:87]
    s_waitcnt vmcnt(14) lgkmcnt(6)
    v_mfma_f32_16x16x32_bf16 v[16:19], v[128:131], v[168:171], v[16:19]
    ds_write2_b32 v8, v240, v241 offset0:0 offset1:16
    ds_write2_b32 v8, v242, v243 offset0:32 offset1:48
    ds_write2_b32 v8, v244, v245 offset0:64 offset1:80
    ds_read_b128 v[88:91], v247 offset:7168
    v_mfma_f32_16x16x32_bf16 v[48:51], v[128:131], v[172:175], v[48:51]
    ds_read_b128 v[92:95], v247 offset:8192
    v_mfma_f32_16x16x32_bf16 v[20:23], v[132:135], v[168:171], v[20:23]
    ds_read_b128 v[96:99], v247 offset:9216
    v_mfma_f32_16x16x32_bf16 v[52:55], v[132:135], v[172:175], v[52:55]
    ds_read_b128 v[100:103], v247 offset:10240
    v_mfma_f32_16x16x32_bf16 v[24:27], v[136:139], v[168:171], v[24:27]
    ds_read_b128 v[104:107], v247 offset:11264
    v_mfma_f32_16x16x32_bf16 v[56:59], v[136:139], v[172:175], v[56:59]
    ds_read_b128 v[108:111], v247 offset:12288
    v_mfma_f32_16x16x32_bf16 v[28:31], v[140:143], v[168:171], v[28:31]
    ds_read_b128 v[112:115], v247 offset:13312
    v_mfma_f32_16x16x32_bf16 v[60:63], v[140:143], v[172:175], v[60:63]
    ds_read_b128 v[116:119], v248 offset:10240
    s_waitcnt lgkmcnt(8)
    v_mfma_f32_16x16x32_bf16 v[36:39], v[168:171], v[144:147], v[36:39]
    ds_read_b128 v[120:123], v250 offset:7168
    v_mfma_f32_16x16x32_bf16 v[68:71], v[172:175], v[144:147], v[68:71]
    ds_read_b128 v[124:127], v252 offset:7168
    v_mfma_f32_16x16x32_bf16 v[40:43], v[168:171], v[148:151], v[40:43]
    buffer_load_dwordx4 v[232:235], v1, s[4:7], s42 offen offset:1024 sc1
    v_mfma_f32_16x16x32_bf16 v[72:75], v[172:175], v[148:151], v[72:75]
    v_mfma_f32_16x16x32_bf16 v[32:35], v[152:155], v[168:171], v[32:35]
    buffer_load_dwordx4 v[236:239], v253, s[4:7], s42 offen offset:1024 sc1
    v_mfma_f32_16x16x32_bf16 v[64:67], v[152:155], v[172:175], v[64:67]
    v_mfma_f32_16x16x32_bf16 v[44:47], v[168:171], v[152:155], v[44:47]
    v_mfma_f32_16x16x32_bf16 v[76:79], v[172:175], v[152:155], v[76:79]
    v_mfma_f32_16x16x32_bf16 v[80:83], v[160:163], v[156:159], v[80:83]
    v_mfma_f32_16x16x32_bf16 v[84:87], v[156:159], v[164:167], v[84:87]
    s_waitcnt vmcnt(14) lgkmcnt(6)
    s_barrier
    v_mfma_f32_16x16x32_bf16 v[16:19], v[88:91], v[176:179], v[16:19]
    ds_read_b128 v[168:171], v4 offset:128
    ds_read_b128 v[172:175], v4 offset:192
    ds_read_b128 v[128:131], v247 offset:14336
    v_mfma_f32_16x16x32_bf16 v[48:51], v[88:91], v[180:183], v[48:51]
    ds_read_b128 v[132:135], v247 offset:15360
    v_mfma_f32_16x16x32_bf16 v[20:23], v[92:95], v[176:179], v[20:23]
    ds_read_b128 v[136:139], v247 offset:16384
    v_mfma_f32_16x16x32_bf16 v[52:55], v[92:95], v[180:183], v[52:55]
    ds_read_b128 v[140:143], v247 offset:17408
    v_mfma_f32_16x16x32_bf16 v[24:27], v[96:99], v[176:179], v[24:27]
    ds_read_b128 v[144:147], v247 offset:18432
    v_mfma_f32_16x16x32_bf16 v[56:59], v[96:99], v[180:183], v[56:59]
    ds_read_b128 v[148:151], v247 offset:19456
    v_mfma_f32_16x16x32_bf16 v[28:31], v[100:103], v[176:179], v[28:31]
    ds_read_b128 v[152:155], v247 offset:20480
    v_mfma_f32_16x16x32_bf16 v[60:63], v[100:103], v[180:183], v[60:63]
    ds_read_b128 v[156:159], v248 offset:11264
    s_waitcnt lgkmcnt(8)
    v_mfma_f32_16x16x32_bf16 v[36:39], v[176:179], v[104:107], v[36:39]
    ds_read_b128 v[160:163], v250 offset:14336
    v_mfma_f32_16x16x32_bf16 v[68:71], v[180:183], v[104:107], v[68:71]
    ds_read_b128 v[164:167], v252 offset:14336
    v_mfma_f32_16x16x32_bf16 v[40:43], v[176:179], v[108:111], v[40:43]
    v_mfma_f32_16x16x32_bf16 v[72:75], v[180:183], v[108:111], v[72:75]
    v_mfma_f32_16x16x32_bf16 v[32:35], v[112:115], v[176:179], v[32:35]
    v_mfma_f32_16x16x32_bf16 v[64:67], v[112:115], v[180:183], v[64:67]
    v_mfma_f32_16x16x32_bf16 v[44:47], v[176:179], v[112:115], v[44:47]
    v_mfma_f32_16x16x32_bf16 v[76:79], v[180:183], v[112:115], v[76:79]
    v_mfma_f32_16x16x32_bf16 v[80:83], v[120:123], v[116:119], v[80:83]
    v_mfma_f32_16x16x32_bf16 v[84:87], v[116:119], v[124:127], v[84:87]
    s_waitcnt vmcnt(12) lgkmcnt(6)
    v_mfma_f32_16x16x32_bf16 v[16:19], v[128:131], v[184:187], v[16:19]
    ds_read_b128 v[176:179], v4 offset:384
    ds_read_b128 v[180:183], v5 offset:0
    ds_read_b128 v[88:91], v247 offset:21504
    v_mfma_f32_16x16x32_bf16 v[48:51], v[128:131], v[188:191], v[48:51]
    ds_read_b128 v[92:95], v247 offset:22528
    v_mfma_f32_16x16x32_bf16 v[20:23], v[132:135], v[184:187], v[20:23]
    ds_read_b128 v[96:99], v247 offset:23552
    v_mfma_f32_16x16x32_bf16 v[52:55], v[132:135], v[188:191], v[52:55]
    ds_read_b128 v[100:103], v247 offset:24576
    v_mfma_f32_16x16x32_bf16 v[24:27], v[136:139], v[184:187], v[24:27]
    ds_read_b128 v[104:107], v247 offset:25600
    v_mfma_f32_16x16x32_bf16 v[56:59], v[136:139], v[188:191], v[56:59]
    ds_read_b128 v[108:111], v247 offset:26624
    v_mfma_f32_16x16x32_bf16 v[28:31], v[140:143], v[184:187], v[28:31]
    ds_read_b128 v[112:115], v247 offset:27648
    v_mfma_f32_16x16x32_bf16 v[60:63], v[140:143], v[188:191], v[60:63]
    ds_read_b128 v[116:119], v248 offset:12288
    s_waitcnt lgkmcnt(8)
    v_mfma_f32_16x16x32_bf16 v[36:39], v[184:187], v[144:147], v[36:39]
    ds_read_b128 v[120:123], v250 offset:21504
    v_mfma_f32_16x16x32_bf16 v[68:71], v[188:191], v[144:147], v[68:71]
    ds_read_b128 v[124:127], v252 offset:21504
    v_mfma_f32_16x16x32_bf16 v[40:43], v[184:187], v[148:151], v[40:43]
    v_mfma_f32_16x16x32_bf16 v[72:75], v[188:191], v[148:151], v[72:75]
    v_mfma_f32_16x16x32_bf16 v[32:35], v[152:155], v[184:187], v[32:35]
    v_mfma_f32_16x16x32_bf16 v[64:67], v[152:155], v[188:191], v[64:67]
    v_mfma_f32_16x16x32_bf16 v[44:47], v[184:187], v[152:155], v[44:47]
    v_mfma_f32_16x16x32_bf16 v[76:79], v[188:191], v[152:155], v[76:79]
    v_mfma_f32_16x16x32_bf16 v[80:83], v[160:163], v[156:159], v[80:83]
    v_mfma_f32_16x16x32_bf16 v[84:87], v[156:159], v[164:167], v[84:87]
    s_waitcnt vmcnt(10) lgkmcnt(6)
    s_barrier
    v_mfma_f32_16x16x32_bf16 v[16:19], v[88:91], v[192:195], v[16:19]
    ds_read_b128 v[184:187], v4 offset:0
    ds_read_b128 v[188:191], v4 offset:64
    ds_read_b128 v[128:131], v247 offset:28672
    v_mfma_f32_16x16x32_bf16 v[48:51], v[88:91], v[196:199], v[48:51]
    ds_read_b128 v[132:135], v247 offset:29696
    v_mfma_f32_16x16x32_bf16 v[20:23], v[92:95], v[192:195], v[20:23]
    ds_read_b128 v[136:139], v247 offset:30720
    v_mfma_f32_16x16x32_bf16 v[52:55], v[92:95], v[196:199], v[52:55]
    ds_read_b128 v[140:143], v247 offset:31744
    v_mfma_f32_16x16x32_bf16 v[24:27], v[96:99], v[192:195], v[24:27]
    ds_read_b128 v[144:147], v247 offset:32768
    v_mfma_f32_16x16x32_bf16 v[56:59], v[96:99], v[196:199], v[56:59]
    ds_read_b128 v[148:151], v247 offset:33792
    v_mfma_f32_16x16x32_bf16 v[28:31], v[100:103], v[192:195], v[28:31]
    ds_read_b128 v[152:155], v247 offset:34816
    v_mfma_f32_16x16x32_bf16 v[60:63], v[100:103], v[196:199], v[60:63]
    ds_read_b128 v[156:159], v248 offset:13312
    s_waitcnt lgkmcnt(8)
    v_mfma_f32_16x16x32_bf16 v[36:39], v[192:195], v[104:107], v[36:39]
    ds_read_b128 v[160:163], v250 offset:28672
    v_mfma_f32_16x16x32_bf16 v[68:71], v[196:199], v[104:107], v[68:71]
    ds_read_b128 v[164:167], v252 offset:28672
    v_mfma_f32_16x16x32_bf16 v[40:43], v[192:195], v[108:111], v[40:43]
    v_mfma_f32_16x16x32_bf16 v[72:75], v[196:199], v[108:111], v[72:75]
    v_mfma_f32_16x16x32_bf16 v[32:35], v[112:115], v[192:195], v[32:35]
    v_mfma_f32_16x16x32_bf16 v[64:67], v[112:115], v[196:199], v[64:67]
    v_mfma_f32_16x16x32_bf16 v[44:47], v[192:195], v[112:115], v[44:47]
    v_mfma_f32_16x16x32_bf16 v[76:79], v[196:199], v[112:115], v[76:79]
    v_mfma_f32_16x16x32_bf16 v[80:83], v[120:123], v[116:119], v[80:83]
    v_mfma_f32_16x16x32_bf16 v[84:87], v[116:119], v[124:127], v[84:87]
    s_waitcnt vmcnt(8) lgkmcnt(6)
    v_mfma_f32_16x16x32_bf16 v[16:19], v[128:131], v[200:203], v[16:19]
    ds_read_b128 v[192:195], v4 offset:640
    ds_read_b128 v[196:199], v4 offset:704
    ds_read_b128 v[88:91], v247 offset:35840
    v_mfma_f32_16x16x32_bf16 v[48:51], v[128:131], v[204:207], v[48:51]
    ds_read_b128 v[92:95], v247 offset:36864
    v_mfma_f32_16x16x32_bf16 v[20:23], v[132:135], v[200:203], v[20:23]
    ds_read_b128 v[96:99], v247 offset:37888
    v_mfma_f32_16x16x32_bf16 v[52:55], v[132:135], v[204:207], v[52:55]
    ds_read_b128 v[100:103], v247 offset:38912
    v_mfma_f32_16x16x32_bf16 v[24:27], v[136:139], v[200:203], v[24:27]
    ds_read_b128 v[104:107], v247 offset:39936
    v_mfma_f32_16x16x32_bf16 v[56:59], v[136:139], v[204:207], v[56:59]
    ds_read_b128 v[108:111], v247 offset:40960
    v_mfma_f32_16x16x32_bf16 v[28:31], v[140:143], v[200:203], v[28:31]
    ds_read_b128 v[112:115], v247 offset:41984
    v_mfma_f32_16x16x32_bf16 v[60:63], v[140:143], v[204:207], v[60:63]
    ds_read_b128 v[116:119], v248 offset:14336
    s_waitcnt lgkmcnt(8)
    v_mfma_f32_16x16x32_bf16 v[36:39], v[200:203], v[144:147], v[36:39]
    ds_read_b128 v[120:123], v250 offset:35840
    v_mfma_f32_16x16x32_bf16 v[68:71], v[204:207], v[144:147], v[68:71]
    ds_read_b128 v[124:127], v252 offset:35840
    v_mfma_f32_16x16x32_bf16 v[40:43], v[200:203], v[148:151], v[40:43]
    v_mfma_f32_16x16x32_bf16 v[72:75], v[204:207], v[148:151], v[72:75]
    v_mfma_f32_16x16x32_bf16 v[32:35], v[152:155], v[200:203], v[32:35]
    v_mfma_f32_16x16x32_bf16 v[64:67], v[152:155], v[204:207], v[64:67]
    v_mfma_f32_16x16x32_bf16 v[44:47], v[200:203], v[152:155], v[44:47]
    v_mfma_f32_16x16x32_bf16 v[76:79], v[204:207], v[152:155], v[76:79]
    v_mfma_f32_16x16x32_bf16 v[80:83], v[160:163], v[156:159], v[80:83]
    v_mfma_f32_16x16x32_bf16 v[84:87], v[156:159], v[164:167], v[84:87]
    s_waitcnt vmcnt(6) lgkmcnt(6)
    v_mfma_f32_16x16x32_bf16 v[16:19], v[88:91], v[208:211], v[16:19]
    ds_read_b128 v[200:203], v4 offset:896
    ds_read_b128 v[204:207], v5 offset:512
    ds_read_b128 v[128:131], v247 offset:43008
    v_mfma_f32_16x16x32_bf16 v[48:51], v[88:91], v[212:215], v[48:51]
    ds_read_b128 v[132:135], v247 offset:44032
    v_mfma_f32_16x16x32_bf16 v[20:23], v[92:95], v[208:211], v[20:23]
    ds_read_b128 v[136:139], v247 offset:45056
    v_mfma_f32_16x16x32_bf16 v[52:55], v[92:95], v[212:215], v[52:55]
    ds_read_b128 v[140:143], v247 offset:46080
    v_mfma_f32_16x16x32_bf16 v[24:27], v[96:99], v[208:211], v[24:27]
    ds_read_b128 v[144:147], v247 offset:47104
    v_mfma_f32_16x16x32_bf16 v[56:59], v[96:99], v[212:215], v[56:59]
    ds_read_b128 v[148:151], v247 offset:48128
    v_mfma_f32_16x16x32_bf16 v[28:31], v[100:103], v[208:211], v[28:31]
    ds_read_b128 v[152:155], v247 offset:49152
    v_mfma_f32_16x16x32_bf16 v[60:63], v[100:103], v[212:215], v[60:63]
    ds_read_b128 v[156:159], v248 offset:15360
    s_waitcnt lgkmcnt(8)
    v_mfma_f32_16x16x32_bf16 v[36:39], v[208:211], v[104:107], v[36:39]
    ds_read_b128 v[160:163], v250 offset:43008
    v_mfma_f32_16x16x32_bf16 v[68:71], v[212:215], v[104:107], v[68:71]
    ds_read_b128 v[164:167], v252 offset:43008
    v_mfma_f32_16x16x32_bf16 v[40:43], v[208:211], v[108:111], v[40:43]
    v_mfma_f32_16x16x32_bf16 v[72:75], v[212:215], v[108:111], v[72:75]
    v_mfma_f32_16x16x32_bf16 v[32:35], v[112:115], v[208:211], v[32:35]
    v_mfma_f32_16x16x32_bf16 v[64:67], v[112:115], v[212:215], v[64:67]
    v_mfma_f32_16x16x32_bf16 v[44:47], v[208:211], v[112:115], v[44:47]
    v_mfma_f32_16x16x32_bf16 v[76:79], v[212:215], v[112:115], v[76:79]
    v_mfma_f32_16x16x32_bf16 v[80:83], v[120:123], v[116:119], v[80:83]
    v_mfma_f32_16x16x32_bf16 v[84:87], v[116:119], v[124:127], v[84:87]
    s_waitcnt vmcnt(4) lgkmcnt(6)
    s_barrier
    v_mfma_f32_16x16x32_bf16 v[16:19], v[128:131], v[216:219], v[16:19]
    ds_read_b128 v[208:211], v4 offset:512
    ds_read_b128 v[212:215], v4 offset:576
    ds_read_b128 v[88:91], v247 offset:50176
    v_mfma_f32_16x16x32_bf16 v[48:51], v[128:131], v[220:223], v[48:51]
    ds_read_b128 v[92:95], v247 offset:51200
    v_mfma_f32_16x16x32_bf16 v[20:23], v[132:135], v[216:219], v[20:23]
    ds_read_b128 v[96:99], v247 offset:52224
    v_mfma_f32_16x16x32_bf16 v[52:55], v[132:135], v[220:223], v[52:55]
    ds_read_b128 v[100:103], v247 offset:53248
    v_mfma_f32_16x16x32_bf16 v[24:27], v[136:139], v[216:219], v[24:27]
    ds_read_b128 v[104:107], v247 offset:54272
    v_mfma_f32_16x16x32_bf16 v[56:59], v[136:139], v[220:223], v[56:59]
    ds_read_b128 v[108:111], v247 offset:55296
    v_mfma_f32_16x16x32_bf16 v[28:31], v[140:143], v[216:219], v[28:31]
    ds_read_b128 v[112:115], v247 offset:56320
    v_mfma_f32_16x16x32_bf16 v[60:63], v[140:143], v[220:223], v[60:63]
    ds_read_b128 v[116:119], v248 offset:16384
    s_waitcnt lgkmcnt(8)
    v_mfma_f32_16x16x32_bf16 v[36:39], v[216:219], v[144:147], v[36:39]
    ds_read_b128 v[120:123], v250 offset:50176
    v_mfma_f32_16x16x32_bf16 v[68:71], v[220:223], v[144:147], v[68:71]
    ds_read_b128 v[124:127], v252 offset:50176
    v_mfma_f32_16x16x32_bf16 v[40:43], v[216:219], v[148:151], v[40:43]
    v_mfma_f32_16x16x32_bf16 v[72:75], v[220:223], v[148:151], v[72:75]
    v_mfma_f32_16x16x32_bf16 v[32:35], v[152:155], v[216:219], v[32:35]
    v_mfma_f32_16x16x32_bf16 v[64:67], v[152:155], v[220:223], v[64:67]
    v_mfma_f32_16x16x32_bf16 v[44:47], v[216:219], v[152:155], v[44:47]
    v_mfma_f32_16x16x32_bf16 v[76:79], v[220:223], v[152:155], v[76:79]
    v_mfma_f32_16x16x32_bf16 v[80:83], v[160:163], v[156:159], v[80:83]
    v_mfma_f32_16x16x32_bf16 v[84:87], v[156:159], v[164:167], v[84:87]
    s_waitcnt vmcnt(2) lgkmcnt(6)
    v_mfma_f32_16x16x32_bf16 v[16:19], v[88:91], v[224:227], v[16:19]
    ds_read2st64_b32 v[216:217], v10 offset0:0 offset1:2
    ds_read2st64_b32 v[218:219], v11 offset0:0 offset1:2
    ds_read2st64_b32 v[220:221], v12 offset0:0 offset1:2
    ds_read2st64_b32 v[222:223], v7 offset0:0 offset1:2
    ds_read_b128 v[128:131], v247 offset:57344
    v_mfma_f32_16x16x32_bf16 v[48:51], v[88:91], v[228:231], v[48:51]
    ds_read_b128 v[132:135], v247 offset:58368
    v_mfma_f32_16x16x32_bf16 v[20:23], v[92:95], v[224:227], v[20:23]
    ds_read_b128 v[136:139], v247 offset:59392
    v_mfma_f32_16x16x32_bf16 v[52:55], v[92:95], v[228:231], v[52:55]
    ds_read_b128 v[140:143], v247 offset:60416
    v_mfma_f32_16x16x32_bf16 v[24:27], v[96:99], v[224:227], v[24:27]
    ds_read_b128 v[144:147], v247 offset:61440
    v_mfma_f32_16x16x32_bf16 v[56:59], v[96:99], v[228:231], v[56:59]
    ds_read_b128 v[148:151], v247 offset:62464
    v_mfma_f32_16x16x32_bf16 v[28:31], v[100:103], v[224:227], v[28:31]
    ds_read_b128 v[152:155], v247 offset:63488
    v_mfma_f32_16x16x32_bf16 v[60:63], v[100:103], v[228:231], v[60:63]
    ds_read_b128 v[156:159], v248 offset:17408
    s_waitcnt lgkmcnt(8)
    v_mfma_f32_16x16x32_bf16 v[36:39], v[224:227], v[104:107], v[36:39]
    ds_read_b128 v[160:163], v250 offset:57344
    v_mfma_f32_16x16x32_bf16 v[68:71], v[228:231], v[104:107], v[68:71]
    ds_read_b128 v[164:167], v252 offset:57344
    v_mfma_f32_16x16x32_bf16 v[40:43], v[224:227], v[108:111], v[40:43]
    v_add_f32 v168, v168, v192
    v_add_f32 v169, v169, v193
    v_mfma_f32_16x16x32_bf16 v[72:75], v[228:231], v[108:111], v[72:75]
    v_add_f32 v170, v170, v194
    v_add_f32 v171, v171, v195
    v_mfma_f32_16x16x32_bf16 v[32:35], v[112:115], v[224:227], v[32:35]
    v_add_f32 v172, v172, v196
    v_add_f32 v173, v173, v197
    v_mfma_f32_16x16x32_bf16 v[64:67], v[112:115], v[228:231], v[64:67]
    v_add_f32 v174, v174, v198
    v_add_f32 v175, v175, v199
    v_mfma_f32_16x16x32_bf16 v[44:47], v[224:227], v[112:115], v[44:47]
    v_add_f32 v176, v176, v200
    v_add_f32 v177, v177, v201
    v_mfma_f32_16x16x32_bf16 v[76:79], v[228:231], v[112:115], v[76:79]
    v_add_f32 v178, v178, v202
    v_add_f32 v179, v179, v203
    v_mfma_f32_16x16x32_bf16 v[80:83], v[120:123], v[116:119], v[80:83]
    v_add_f32 v180, v180, v204
    v_add_f32 v181, v181, v205
    v_mfma_f32_16x16x32_bf16 v[84:87], v[116:119], v[124:127], v[84:87]
    v_add_f32 v182, v182, v206
    v_add_f32 v183, v183, v207
    s_waitcnt vmcnt(0) lgkmcnt(6)
    v_mfma_f32_16x16x32_bf16 v[16:19], v[128:131], v[232:235], v[16:19]
    ds_read_b128 v[96:99], v9 offset:256
    v_mfma_f32_16x16x32_bf16 v[48:51], v[128:131], v[236:239], v[48:51]
    ds_read_b128 v[108:111], v9 offset:320
    v_mfma_f32_16x16x32_bf16 v[20:23], v[132:135], v[232:235], v[20:23]
    ds_read_b128 v[88:91], v9 offset:0
    v_mfma_f32_16x16x32_bf16 v[52:55], v[132:135], v[236:239], v[52:55]
    ds_read_b128 v[100:103], v9 offset:64
    v_mfma_f32_16x16x32_bf16 v[24:27], v[136:139], v[232:235], v[24:27]
    ds_read_b128 v[92:95], v9 offset:128
    v_mfma_f32_16x16x32_bf16 v[56:59], v[136:139], v[236:239], v[56:59]
    ds_read_b128 v[104:107], v9 offset:192
    v_mfma_f32_16x16x32_bf16 v[28:31], v[140:143], v[232:235], v[28:31]
    v_add_f32 v184, v184, v208
    v_add_f32 v185, v185, v209
    v_mfma_f32_16x16x32_bf16 v[60:63], v[140:143], v[236:239], v[60:63]
    s_waitcnt lgkmcnt(6)
    v_add_f32 v186, v186, v210
    v_mfma_f32_16x16x32_bf16 v[36:39], v[232:235], v[144:147], v[36:39]
    v_add_f32 v187, v187, v211
    v_add_f32 v188, v188, v212
    v_mfma_f32_16x16x32_bf16 v[68:71], v[236:239], v[144:147], v[68:71]
    v_add_f32 v189, v189, v213
    v_add_f32 v190, v190, v214
    v_mfma_f32_16x16x32_bf16 v[40:43], v[232:235], v[148:151], v[40:43]
    v_add_f32 v191, v191, v215
    v_add_f32 v216, v216, v217
    v_mfma_f32_16x16x32_bf16 v[72:75], v[236:239], v[148:151], v[72:75]
    v_add_f32 v217, v218, v219
    v_add_f32 v218, v220, v221
    v_mfma_f32_16x16x32_bf16 v[32:35], v[152:155], v[232:235], v[32:35]
    v_add_f32 v219, v222, v223
    v_mfma_f32_16x16x32_bf16 v[64:67], v[152:155], v[236:239], v[64:67]
    v_mfma_f32_16x16x32_bf16 v[44:47], v[232:235], v[152:155], v[44:47]
    v_mfma_f32_16x16x32_bf16 v[76:79], v[236:239], v[152:155], v[76:79]
    v_mfma_f32_16x16x32_bf16 v[80:83], v[160:163], v[156:159], v[80:83]
    v_mfma_f32_16x16x32_bf16 v[84:87], v[156:159], v[164:167], v[84:87]
    v_and_b32 v4, 1, v2
    v_lshl_add_u32 v5, v3, 2, v4
    v_add_u32 v6, 2, v5
    v_cmp_eq_u32 s[40:41], 1, v4
    v_cmp_le_u32 s[42:43], v5, v2
    v_cmp_le_u32 s[44:45], v6, v2
    v_cmp_eq_u32 s[46:47], 0, v3
    v_mov_b32 v4, 0xffff
    v_mov_b32 v5, 0xffff0000
    v_cndmask_b32 v4, v4, v5, s[40:41]
    v_cndmask_b32 v12, v4, 0, s[42:43]
    v_cndmask_b32 v13, v4, 0, s[44:45]
    v_cndmask_b32 v14, 0, v4, s[42:43]
    v_cndmask_b32 v15, 0, v4, s[44:45]
    s_cmp_eq_u32 s31, 0
    s_cselect_b64 s[48:49], s[42:43], -1
    s_cselect_b64 s[38:39], s[44:45], -1
    v_lshrrev_b32 v8, 1, v1
    s_mul_i32 s36, s20, 3072
    s_add_u32 s36, s36, 149504
    v_add_u32 v9, s36, v8
    s_lshl_b32 s37, s20, 9
    s_add_u32 s37, s37, 149504
    v_add_u32 v10, s37, v8
    s_waitcnt lgkmcnt(0)
    v_pk_fma_f32 v[56:57], v[244:245], v[168:169], v[56:57] op_sel_hi:[0,1,1] neg_lo:[1,0,0] neg_hi:[1,0,0]
    v_pk_fma_f32 v[58:59], v[244:245], v[170:171], v[58:59] op_sel_hi:[0,1,1] neg_lo:[1,0,0] neg_hi:[1,0,0]
    v_pk_fma_f32 v[60:61], v[244:245], v[172:173], v[60:61] op_sel_hi:[0,1,1] neg_lo:[1,0,0] neg_hi:[1,0,0]
    v_pk_fma_f32 v[62:63], v[244:245], v[174:175], v[62:63] op_sel_hi:[0,1,1] neg_lo:[1,0,0] neg_hi:[1,0,0]
    v_pk_fma_f32 v[64:65], v[244:245], v[176:177], v[64:65] op_sel_hi:[0,1,1] neg_lo:[1,0,0] neg_hi:[1,0,0]
    v_pk_fma_f32 v[66:67], v[244:245], v[178:179], v[66:67] op_sel_hi:[0,1,1] neg_lo:[1,0,0] neg_hi:[1,0,0]
    v_pk_fma_f32 v[68:69], v[96:97], v[216:217], v[68:69] op_sel:[0,0,0] op_sel_hi:[1,0,1] neg_lo:[1,0,0] neg_hi:[1,0,0]
    v_pk_fma_f32 v[70:71], v[98:99], v[216:217], v[70:71] op_sel:[0,0,0] op_sel_hi:[1,0,1] neg_lo:[1,0,0] neg_hi:[1,0,0]
    v_pk_fma_f32 v[72:73], v[96:97], v[216:217], v[72:73] op_sel:[0,1,0] op_sel_hi:[1,1,1] neg_lo:[1,0,0] neg_hi:[1,0,0]
    v_pk_fma_f32 v[74:75], v[98:99], v[216:217], v[74:75] op_sel:[0,1,0] op_sel_hi:[1,1,1] neg_lo:[1,0,0] neg_hi:[1,0,0]
    v_pk_fma_f32 v[76:77], v[96:97], v[218:219], v[76:77] op_sel:[0,0,0] op_sel_hi:[1,0,1] neg_lo:[1,0,0] neg_hi:[1,0,0]
    v_pk_fma_f32 v[78:79], v[98:99], v[218:219], v[78:79] op_sel:[0,0,0] op_sel_hi:[1,0,1] neg_lo:[1,0,0] neg_hi:[1,0,0]
    v_pk_fma_f32 v[80:81], v[240:241], v[180:181], v[80:81] op_sel_hi:[0,1,1] neg_lo:[1,0,0] neg_hi:[1,0,0]
    v_pk_fma_f32 v[82:83], v[240:241], v[182:183], v[82:83] op_sel_hi:[0,1,1] neg_lo:[1,0,0] neg_hi:[1,0,0]
    v_pk_fma_f32 v[84:85], v[88:89], v[218:219], v[84:85] op_sel:[0,1,0] op_sel_hi:[1,1,1] neg_lo:[1,0,0] neg_hi:[1,0,0]
    v_pk_fma_f32 v[86:87], v[90:91], v[218:219], v[86:87] op_sel:[0,1,0] op_sel_hi:[1,1,1] neg_lo:[1,0,0] neg_hi:[1,0,0]
    v_pk_mul_f32 v[56:57], v[56:57], v[244:245] op_sel:[0,1] op_sel_hi:[1,1]
    v_pk_mul_f32 v[58:59], v[58:59], v[244:245] op_sel:[0,1] op_sel_hi:[1,1]
    v_pk_mul_f32 v[60:61], v[60:61], v[244:245] op_sel:[0,1] op_sel_hi:[1,1]
    v_pk_mul_f32 v[62:63], v[62:63], v[244:245] op_sel:[0,1] op_sel_hi:[1,1]
    v_pk_mul_f32 v[64:65], v[64:65], v[244:245] op_sel:[0,1] op_sel_hi:[1,1]
    v_pk_mul_f32 v[66:67], v[66:67], v[244:245] op_sel:[0,1] op_sel_hi:[1,1]
    v_pk_mul_f32 v[68:69], v[68:69], v[108:109]
    v_pk_mul_f32 v[70:71], v[70:71], v[110:111]
    v_pk_mul_f32 v[72:73], v[72:73], v[108:109]
    v_pk_mul_f32 v[74:75], v[74:75], v[110:111]
    v_pk_mul_f32 v[76:77], v[76:77], v[108:109]
    v_pk_mul_f32 v[78:79], v[78:79], v[110:111]
    v_pk_mul_f32 v[80:81], v[80:81], v[240:241] op_sel:[0,1] op_sel_hi:[1,1]
    v_pk_mul_f32 v[82:83], v[82:83], v[240:241] op_sel:[0,1] op_sel_hi:[1,1]
    v_pk_mul_f32 v[84:85], v[84:85], v[100:101]
    v_pk_mul_f32 v[86:87], v[86:87], v[102:103]
    v_cvt_pk_bf16_f32 v144, v56, v57
    v_cvt_pk_bf16_f32 v145, v58, v59
    v_cvt_pk_bf16_f32 v148, v60, v61
    v_cvt_pk_bf16_f32 v149, v62, v63
    v_cvt_pk_bf16_f32 v214, v64, v65
    v_cvt_pk_bf16_f32 v215, v66, v67
    v_cvt_pk_bf16_f32 v196, v68, v69
    v_cvt_pk_bf16_f32 v197, v70, v71
    v_cvt_pk_bf16_f32 v202, v72, v73
    v_cvt_pk_bf16_f32 v203, v74, v75
    v_cvt_pk_bf16_f32 v208, v76, v77
    v_cvt_pk_bf16_f32 v209, v78, v79
    v_cvt_pk_bf16_f32 v224, v80, v81
    v_cvt_pk_bf16_f32 v225, v82, v83
    v_cvt_pk_bf16_f32 v226, v84, v85
    v_cvt_pk_bf16_f32 v227, v86, v87
    s_cmp_eq_u32 s20, 3
    s_cbranch_scc1 L_a_nw
    ds_write_b64 v9, v[144:145] offset:3072
    ds_write_b64 v9, v[148:149] offset:3584
    ds_write_b64 v9, v[214:215] offset:4096
    ds_write_b64 v9, v[196:197] offset:4608
    ds_write_b64 v9, v[202:203] offset:5120
    ds_write_b64 v9, v[208:209] offset:5632
    ds_write_b64 v10, v[224:225]
    ds_write_b64 v10, v[226:227] offset:1536
L_a_nw:
    v_pk_fma_f32 v[24:25], v[242:243], v[168:169], v[24:25] op_sel_hi:[0,1,1] neg_lo:[1,0,0] neg_hi:[1,0,0]
    v_pk_fma_f32 v[26:27], v[242:243], v[170:171], v[26:27] op_sel_hi:[0,1,1] neg_lo:[1,0,0] neg_hi:[1,0,0]
    v_pk_fma_f32 v[28:29], v[242:243], v[172:173], v[28:29] op_sel_hi:[0,1,1] neg_lo:[1,0,0] neg_hi:[1,0,0]
    v_pk_fma_f32 v[30:31], v[242:243], v[174:175], v[30:31] op_sel_hi:[0,1,1] neg_lo:[1,0,0] neg_hi:[1,0,0]
    v_pk_fma_f32 v[32:33], v[242:243], v[176:177], v[32:33] op_sel_hi:[0,1,1] neg_lo:[1,0,0] neg_hi:[1,0,0]
    v_pk_fma_f32 v[34:35], v[242:243], v[178:179], v[34:35] op_sel_hi:[0,1,1] neg_lo:[1,0,0] neg_hi:[1,0,0]
    v_pk_fma_f32 v[36:37], v[92:93], v[216:217], v[36:37] op_sel:[0,0,0] op_sel_hi:[1,0,1] neg_lo:[1,0,0] neg_hi:[1,0,0]
    v_pk_fma_f32 v[38:39], v[94:95], v[216:217], v[38:39] op_sel:[0,0,0] op_sel_hi:[1,0,1] neg_lo:[1,0,0] neg_hi:[1,0,0]
    v_pk_fma_f32 v[40:41], v[92:93], v[216:217], v[40:41] op_sel:[0,1,0] op_sel_hi:[1,1,1] neg_lo:[1,0,0] neg_hi:[1,0,0]
    v_pk_fma_f32 v[42:43], v[94:95], v[216:217], v[42:43] op_sel:[0,1,0] op_sel_hi:[1,1,1] neg_lo:[1,0,0] neg_hi:[1,0,0]
    v_pk_fma_f32 v[44:45], v[92:93], v[218:219], v[44:45] op_sel:[0,0,0] op_sel_hi:[1,0,1] neg_lo:[1,0,0] neg_hi:[1,0,0]
    v_pk_fma_f32 v[46:47], v[94:95], v[218:219], v[46:47] op_sel:[0,0,0] op_sel_hi:[1,0,1] neg_lo:[1,0,0] neg_hi:[1,0,0]
    v_pk_mul_f32 v[24:25], v[24:25], v[242:243] op_sel:[0,1] op_sel_hi:[1,1]
    v_pk_mul_f32 v[26:27], v[26:27], v[242:243] op_sel:[0,1] op_sel_hi:[1,1]
    v_pk_mul_f32 v[28:29], v[28:29], v[242:243] op_sel:[0,1] op_sel_hi:[1,1]
    v_pk_mul_f32 v[30:31], v[30:31], v[242:243] op_sel:[0,1] op_sel_hi:[1,1]
    v_pk_mul_f32 v[32:33], v[32:33], v[242:243] op_sel:[0,1] op_sel_hi:[1,1]
    v_pk_mul_f32 v[34:35], v[34:35], v[242:243] op_sel:[0,1] op_sel_hi:[1,1]
    v_pk_mul_f32 v[36:37], v[36:37], v[104:105]
    v_pk_mul_f32 v[38:39], v[38:39], v[106:107]
    v_pk_mul_f32 v[40:41], v[40:41], v[104:105]
    v_pk_mul_f32 v[42:43], v[42:43], v[106:107]
    v_pk_mul_f32 v[44:45], v[44:45], v[104:105]
    v_pk_mul_f32 v[46:47], v[46:47], v[106:107]
    v_cvt_pk_bf16_f32 v136, v24, v25
    v_cvt_pk_bf16_f32 v137, v26, v27
    v_cvt_pk_bf16_f32 v140, v28, v29
    v_cvt_pk_bf16_f32 v141, v30, v31
    v_cvt_pk_bf16_f32 v212, v32, v33
    v_cvt_pk_bf16_f32 v213, v34, v35
    v_cvt_pk_bf16_f32 v194, v36, v37
    v_cvt_pk_bf16_f32 v195, v38, v39
    v_cvt_pk_bf16_f32 v200, v40, v41
    v_cvt_pk_bf16_f32 v201, v42, v43
    v_cvt_pk_bf16_f32 v206, v44, v45
    v_cvt_pk_bf16_f32 v207, v46, v47
    s_waitcnt lgkmcnt(0)
    s_barrier
    ds_read_b64 v[128:129], v9 offset:0
    ds_read_b64 v[132:133], v9 offset:512
    ds_read_b64 v[210:211], v9 offset:1024
    ds_read_b64 v[192:193], v9 offset:1536
    ds_read_b64 v[198:199], v9 offset:2048
    ds_read_b64 v[204:205], v9 offset:2560
    v_pk_fma_f32 v[16:17], v[242:243], v[184:185], v[16:17] op_sel_hi:[0,1,1] neg_lo:[1,0,0] neg_hi:[1,0,0]
    v_pk_fma_f32 v[18:19], v[242:243], v[186:187], v[18:19] op_sel_hi:[0,1,1] neg_lo:[1,0,0] neg_hi:[1,0,0]
    v_pk_fma_f32 v[20:21], v[242:243], v[188:189], v[20:21] op_sel_hi:[0,1,1] neg_lo:[1,0,0] neg_hi:[1,0,0]
    v_pk_fma_f32 v[22:23], v[242:243], v[190:191], v[22:23] op_sel_hi:[0,1,1] neg_lo:[1,0,0] neg_hi:[1,0,0]
    v_pk_fma_f32 v[48:49], v[244:245], v[184:185], v[48:49] op_sel_hi:[0,1,1] neg_lo:[1,0,0] neg_hi:[1,0,0]
    v_pk_fma_f32 v[50:51], v[244:245], v[186:187], v[50:51] op_sel_hi:[0,1,1] neg_lo:[1,0,0] neg_hi:[1,0,0]
    v_pk_fma_f32 v[52:53], v[244:245], v[188:189], v[52:53] op_sel_hi:[0,1,1] neg_lo:[1,0,0] neg_hi:[1,0,0]
    v_pk_fma_f32 v[54:55], v[244:245], v[190:191], v[54:55] op_sel_hi:[0,1,1] neg_lo:[1,0,0] neg_hi:[1,0,0]
    v_pk_mul_f32 v[16:17], v[16:17], v[242:243] op_sel:[0,1] op_sel_hi:[1,1]
    v_pk_mul_f32 v[18:19], v[18:19], v[242:243] op_sel:[0,1] op_sel_hi:[1,1]
    v_pk_mul_f32 v[20:21], v[20:21], v[242:243] op_sel:[0,1] op_sel_hi:[1,1]
    v_pk_mul_f32 v[22:23], v[22:23], v[242:243] op_sel:[0,1] op_sel_hi:[1,1]
    v_pk_mul_f32 v[48:49], v[48:49], v[244:245] op_sel:[0,1] op_sel_hi:[1,1]
    v_pk_mul_f32 v[50:51], v[50:51], v[244:245] op_sel:[0,1] op_sel_hi:[1,1]
    v_pk_mul_f32 v[52:53], v[52:53], v[244:245] op_sel:[0,1] op_sel_hi:[1,1]
    v_pk_mul_f32 v[54:55], v[54:55], v[244:245] op_sel:[0,1] op_sel_hi:[1,1]
    v_cvt_pk_bf16_f32 v152, v16, v17
    v_cvt_pk_bf16_f32 v153, v18, v19
    v_cvt_pk_bf16_f32 v156, v20, v21
    v_cvt_pk_bf16_f32 v157, v22, v23
    v_cvt_pk_bf16_f32 v160, v48, v49
    v_cvt_pk_bf16_f32 v161, v50, v51
    v_cvt_pk_bf16_f32 v164, v52, v53
    v_cvt_pk_bf16_f32 v165, v54, v55
    v_cndmask_b32 v154, 0, v212, s[46:47]
    v_mov_b32 v155, 0
    v_cndmask_b32 v158, 0, v213, s[46:47]
    v_mov_b32 v159, 0
    v_cndmask_b32 v162, 0, v214, s[46:47]
    v_mov_b32 v163, 0
    v_cndmask_b32 v166, 0, v215, s[46:47]
    v_mov_b32 v167, 0
    v_mov_b32 v131, 0
    v_mov_b32 v135, 0
    v_mov_b32 v139, 0
    v_mov_b32 v143, 0
    v_mov_b32 v147, 0
    v_mov_b32 v151, 0
    s_waitcnt lgkmcnt(0)
    v_permlane16_swap_b32 v212, v138
    v_permlane16_swap_b32 v213, v142
    v_permlane16_swap_b32 v214, v146
    v_permlane16_swap_b32 v215, v150
    v_permlane16_swap_b32 v210, v130
    v_permlane16_swap_b32 v211, v134
    v_cndmask_b32 v138, 0, v138, s[46:47]
    v_cndmask_b32 v142, 0, v142, s[46:47]
    v_cndmask_b32 v146, 0, v146, s[46:47]
    v_cndmask_b32 v150, 0, v150, s[46:47]
    v_cndmask_b32 v130, 0, v130, s[46:47]
    v_cndmask_b32 v134, 0, v134, s[46:47]
    s_nop 1
    v_mfma_f32_16x16x32_bf16 v[20:23], v[144:147], v[160:163], 0
    v_mfma_f32_16x16x32_bf16 v[16:19], v[136:139], v[160:163], 0
    v_mfma_f32_16x16x32_bf16 v[28:31], v[148:151], v[164:167], 0
    v_mfma_f32_16x16x32_bf16 v[24:27], v[140:143], v[164:167], 0
    v_mfma_f32_16x16x32_bf16 v[36:39], v[136:139], v[152:155], 0
    v_mfma_f32_16x16x32_bf16 v[32:35], v[128:131], v[152:155], 0
    v_mfma_f32_16x16x32_bf16 v[44:47], v[140:143], v[156:159], 0
    v_mfma_f32_16x16x32_bf16 v[40:43], v[132:135], v[156:159], 0
    s_lshl_b32 s36, s24, 10
    v_add_u32 v4, s36, v1
    v_add_u32 v5, 18432, v4
    s_lshl_b32 s36, s24, 7
    s_add_u32 s36, s36, 16384
    v_cmp_eq_u32 vcc, 2, v3
    v_lshl_add_u32 v6, v2, 3, s36
    v_bfrev_b32 v7, 1
    v_cndmask_b32 v6, v7, v6, vcc
    v_add_u32 v7, 18432, v6
    v_mov_b32 v8, 0xf149f2ca
    s_mov_b32 s33, 0x3eae1a93
    v_cndmask_b32 v20, v20, v21, s[40:41]
    v_cndmask_b32 v16, v16, v17, s[40:41]
    v_cndmask_b32 v48, v16, v20, s[42:43]
    v_cndmask_b32 v22, v22, v23, s[40:41]
    v_cndmask_b32 v18, v18, v19, s[40:41]
    v_cndmask_b32 v49, v18, v22, s[44:45]
    v_max_f32 v56, v48, v49
    v_cndmask_b32 v28, v28, v29, s[40:41]
    v_cndmask_b32 v24, v24, v25, s[40:41]
    v_cndmask_b32 v50, v24, v28, s[42:43]
    v_cndmask_b32 v30, v30, v31, s[40:41]
    v_cndmask_b32 v26, v26, v27, s[40:41]
    v_cndmask_b32 v51, v26, v30, s[44:45]
    v_max_f32 v57, v50, v51
    v_cndmask_b32 v36, v36, v37, s[40:41]
    v_cndmask_b32 v32, v32, v33, s[40:41]
    v_cndmask_b32 v52, v32, v36, s[42:43]
    v_cndmask_b32 v52, v8, v52, s[48:49]
    v_cndmask_b32 v38, v38, v39, s[40:41]
    v_cndmask_b32 v34, v34, v35, s[40:41]
    v_cndmask_b32 v53, v34, v38, s[44:45]
    v_cndmask_b32 v53, v8, v53, s[38:39]
    v_max_f32 v58, v52, v53
    v_cndmask_b32 v44, v44, v45, s[40:41]
    v_cndmask_b32 v40, v40, v41, s[40:41]
    v_cndmask_b32 v54, v40, v44, s[42:43]
    v_cndmask_b32 v54, v8, v54, s[48:49]
    v_cndmask_b32 v46, v46, v47, s[40:41]
    v_cndmask_b32 v42, v42, v43, s[40:41]
    v_cndmask_b32 v55, v42, v46, s[44:45]
    v_cndmask_b32 v55, v8, v55, s[38:39]
    v_max_f32 v59, v54, v55
    v_mov_b32 v60, v56
    v_mov_b32 v61, v57
    v_mov_b32 v62, v58
    v_mov_b32 v63, v59
    v_permlane32_swap_b32 v56, v60
    v_permlane32_swap_b32 v57, v61
    v_permlane32_swap_b32 v58, v62
    v_permlane32_swap_b32 v59, v63
    v_max_f32 v56, v56, v60
    v_max_f32 v57, v57, v61
    v_max_f32 v58, v58, v62
    v_max_f32 v59, v59, v63
    v_mov_b32 v60, v56
    v_mov_b32 v61, v57
    v_mov_b32 v62, v58
    v_mov_b32 v63, v59
    v_permlane16_swap_b32 v56, v60
    v_permlane16_swap_b32 v57, v61
    v_permlane16_swap_b32 v58, v62
    v_permlane16_swap_b32 v59, v63
    v_max_f32 v56, v56, v60
    v_max_f32 v57, v57, v61
    v_max_f32 v58, v58, v62
    v_max_f32 v59, v59, v63
    v_mul_f32 v56, s33, v56
    v_mul_f32 v57, s33, v57
    v_mul_f32 v58, s33, v58
    v_mul_f32 v59, s33, v59
    v_fma_f32 v48, v48, s33, -v56
    v_fma_f32 v49, v49, s33, -v56
    v_fma_f32 v50, v50, s33, -v57
    v_fma_f32 v51, v51, s33, -v57
    v_fma_f32 v52, v52, s33, -v58
    v_fma_f32 v53, v53, s33, -v58
    v_fma_f32 v54, v54, s33, -v59
    v_fma_f32 v55, v55, s33, -v59
    v_exp_f32 v48, v48
    v_exp_f32 v49, v49
    v_exp_f32 v50, v50
    v_exp_f32 v51, v51
    v_exp_f32 v52, v52
    v_exp_f32 v53, v53
    v_exp_f32 v54, v54
    v_exp_f32 v55, v55
    v_add_f32 v56, v48, v49
    v_add_f32 v57, v50, v51
    v_add_f32 v58, v52, v53
    v_add_f32 v59, v54, v55
    v_mov_b32 v60, v56
    v_mov_b32 v61, v57
    v_mov_b32 v62, v58
    v_mov_b32 v63, v59
    v_permlane32_swap_b32 v56, v60
    v_permlane32_swap_b32 v57, v61
    v_permlane32_swap_b32 v58, v62
    v_permlane32_swap_b32 v59, v63
    v_add_f32 v56, v56, v60
    v_add_f32 v57, v57, v61
    v_add_f32 v58, v58, v62
    v_add_f32 v59, v59, v63
    v_mov_b32 v60, v56
    v_mov_b32 v61, v57
    v_mov_b32 v62, v58
    v_mov_b32 v63, v59
    v_permlane16_swap_b32 v56, v60
    v_permlane16_swap_b32 v57, v61
    v_permlane16_swap_b32 v58, v62
    v_permlane16_swap_b32 v59, v63
    v_add_f32 v56, v56, v60
    v_add_f32 v57, v57, v61
    v_add_f32 v58, v58, v62
    v_add_f32 v59, v59, v63
    v_rcp_f32 v56, v56
    v_rcp_f32 v57, v57
    v_rcp_f32 v58, v58
    v_rcp_f32 v59, v59
    v_mul_f32 v48, v48, v56
    v_mul_f32 v49, v49, v56
    v_mul_f32 v50, v50, v57
    v_mul_f32 v51, v51, v57
    v_mul_f32 v52, v52, v58
    v_mul_f32 v53, v53, v58
    v_mul_f32 v54, v54, v59
    v_mul_f32 v55, v55, v59
    v_cvt_pk_bf16_f32 v48, v48, v48
    v_cvt_pk_bf16_f32 v49, v49, v49
    v_cvt_pk_bf16_f32 v50, v50, v50
    v_cvt_pk_bf16_f32 v51, v51, v51
    v_cvt_pk_bf16_f32 v52, v52, v52
    v_cvt_pk_bf16_f32 v53, v53, v53
    v_cvt_pk_bf16_f32 v54, v54, v54
    v_cvt_pk_bf16_f32 v55, v55, v55
    v_and_b32 v64, v48, v12
    v_and_b32 v65, v49, v13
    v_and_b32 v66, v48, v14
    v_and_b32 v67, v49, v15
    v_and_b32 v68, v50, v12
    v_and_b32 v69, v51, v13
    v_and_b32 v70, v50, v14
    v_and_b32 v71, v51, v15
    v_and_b32 v72, v52, v12
    v_and_b32 v73, v53, v13
    v_and_b32 v74, v52, v14
    v_and_b32 v75, v53, v15
    v_and_b32 v76, v54, v12
    v_and_b32 v77, v55, v13
    v_and_b32 v78, v54, v14
    v_and_b32 v79, v55, v15
    s_nop 1
    v_mfma_f32_16x16x32_bf16 v[16:19], v[194:197], v[64:67], 0
    v_mfma_f32_16x16x32_bf16 v[20:23], v[206:209], v[64:67], 0
    v_mfma_f32_16x16x32_bf16 v[24:27], v[200:203], v[68:71], 0
    v_mfma_f32_16x16x32_bf16 v[28:31], v[206:209], v[68:71], 0
    v_mfma_f32_16x16x32_bf16 v[32:35], v[192:195], v[72:75], 0
    v_mfma_f32_16x16x32_bf16 v[36:39], v[204:207], v[72:75], 0
    v_mfma_f32_16x16x32_bf16 v[40:43], v[198:201], v[76:79], 0
    v_mfma_f32_16x16x32_bf16 v[44:47], v[204:207], v[76:79], 0
    s_nop 3
    v_cvt_pk_bf16_f32 v224, v16, v17
    v_cvt_pk_bf16_f32 v225, v18, v19
    v_cvt_pk_bf16_f32 v228, v20, v21
    v_cvt_pk_bf16_f32 v226, v24, v25
    v_cvt_pk_bf16_f32 v227, v26, v27
    v_cvt_pk_bf16_f32 v229, v30, v31
    buffer_store_dwordx4 v[224:227], v5, s[4:7], s35 offen sc1
    buffer_store_dwordx2 v[228:229], v7, s[4:7], s35 offen sc1
    s_nop 0
    v_cvt_pk_bf16_f32 v232, v32, v33
    v_cvt_pk_bf16_f32 v233, v34, v35
    v_cvt_pk_bf16_f32 v236, v36, v37
    v_cvt_pk_bf16_f32 v234, v40, v41
    v_cvt_pk_bf16_f32 v235, v42, v43
    v_cvt_pk_bf16_f32 v237, v46, v47
    buffer_store_dwordx4 v[232:235], v4, s[4:7], s35 offen sc1
    buffer_store_dwordx2 v[236:237], v6, s[4:7], s35 offen sc1
    s_and_b32 s25, s2, 7
    s_lshr_b32 s26, s2, 3
    s_lshl_b32 s23, s25, 2
    s_lshr_b32 s27, s26, 3
    s_add_u32 s23, s23, s27
    s_and_b32 s24, s26, 7
    s_add_u32 s25, s23, s24
    s_and_b32 s25, s25, 3
    s_lshl_b32 s30, s23, 2
    s_add_u32 s30, s30, s20
    s_mul_i32 s29, s30, 18432
    s_add_u32 s29, s29, s21
    s_add_u32 s29, s29, 0x600000
    s_mul_i32 s34, s30, 18432
    s_add_u32 s34, s34, s21
    s_add_u32 s34, s34, 0x0
    s_lshl_b32 s35, s24, 11
    s_lshr_b32 s36, s24, 2
    s_lshl_b32 s36, s36, 10
    s_and_b32 s37, s24, 3
    s_lshl_b32 s37, s37, 8
    s_add_u32 s36, s36, s37
    s_add_u32 s36, s36, 16384
    v_bfe_u32 v2, v1, 4, 4
    v_lshrrev_b32 v3, 8, v1
    v_add_u32 v4, s35, v1
    v_lshlrev_b32 v5, 4, v2
    v_lshl_add_u32 v5, v3, 3, v5
    v_add_u32 v5, s36, v5
    v_cmp_gt_u32 s[40:41], 2, v3
    v_bfrev_b32 v6, 1
    v_add_u32 v12, 0, v1
    v_add_u32 v13, 36864, v1
    v_add_u32 v14, 73728, v1
    v_add_u32 v15, 110592, v1
    v_cndmask_b32 v5, v6, v5, s[40:41]
    buffer_load_dwordx4 v[208:211], v4, s[4:7], s34 offen offset:0 sc1
    buffer_load_dwordx4 v[212:215], v4, s[4:7], s34 offen offset:1024 sc1
    buffer_load_dwordx2 v[216:217], v5, s[4:7], s34 offen sc1
    s_add_u32 s34, s34, 0x300000
    s_lshl_b32 s39, s30, 10
    s_add_u32 s39, s39, s21
    s_lshl_b32 s42, s24, 7
    s_add_u32 s39, s39, s42
    s_add_u32 s39, s39, 0x1b20000
    v_cmp_eq_u32 vcc, 0, v3
    v_lshlrev_b32 v10, 3, v2
    v_mov_b32 v11, 0x3f803f80
    v_lshl_add_u32 v7, v3, 8, v10
    v_cndmask_b32 v10, v6, v10, vcc
    s_lshr_b32 s44, s23, 1
    s_lshl_b32 s52, s22, 7
    s_add_u32 s52, s52, s44
    s_lshl_b32 s52, s52, 8
    s_add_u32 s52, s52, 0x4508000
    s_add_u32 s52, s52, s4
    s_addc_u32 s53, s5, 0
    s_waitcnt vmcnt(3)
    s_barrier
    s_cmp_lg_u32 s20, 0
    s_cbranch_scc1 L_ns_d2
    s_mov_b32 s56, 1
    s_atomic_add s56, s[50:51], 0
L_ns_d2:
    s_cmp_lg_u32 s20, 0
    s_cbranch_scc1 L_pd_d2
    s_mov_b32 s60, 65536
L_poll_d2:
    s_mov_b32 s57, 0
    s_atomic_add s57, s[52:53], 0 glc
    s_waitcnt lgkmcnt(0)
    s_cmp_ge_u32 s57, 16
    s_cbranch_scc1 L_pd_d2
    s_sub_u32 s60, s60, 1
    s_cbranch_scc1 L_pd_d2
    s_sleep 2
    s_branch L_poll_d2
L_pd_d2:
    s_barrier
    s_mov_b32 s32, 0
    s_lshl_b32 s32, s32, 13
    s_add_u32 s32, s32, s29
    s_add_u32 s33, s32, 4096
    buffer_load_dwordx4 v[112:115], v1, s[4:7], s32 offen offset:0 sc1
    buffer_load_dwordx4 v[116:119], v1, s[4:7], s32 offen offset:1024 sc1
    buffer_load_dwordx4 v[120:123], v1, s[4:7], s32 offen offset:2048 sc1
    buffer_load_dwordx4 v[124:127], v1, s[4:7], s32 offen offset:3072 sc1
    buffer_load_dwordx4 v[128:131], v1, s[4:7], s33 offen offset:0 sc1
    buffer_load_dwordx4 v[132:135], v1, s[4:7], s33 offen offset:1024 sc1
    buffer_load_dwordx4 v[136:139], v1, s[4:7], s33 offen offset:2048 sc1
    buffer_load_dwordx4 v[140:143], v1, s[4:7], s33 offen offset:3072 sc1
    ds_read_b128 v[40:43], v12 offset:18432
    ds_read_b128 v[44:47], v12 offset:19456
    ds_read_b128 v[48:51], v12 offset:20480
    ds_read_b128 v[52:55], v12 offset:21504
    ds_read_b128 v[72:75], v12 offset:26624
    ds_read_b128 v[56:59], v12 offset:22528
    ds_read_b128 v[60:63], v12 offset:23552
    ds_read_b128 v[64:67], v12 offset:24576
    ds_read_b128 v[68:71], v12 offset:25600
    s_mov_b32 s32, 1
    s_lshl_b32 s32, s32, 13
    s_add_u32 s32, s32, s29
    s_add_u32 s33, s32, 4096
    buffer_load_dwordx4 v[144:147], v1, s[4:7], s32 offen offset:0 sc1
    buffer_load_dwordx4 v[148:151], v1, s[4:7], s32 offen offset:1024 sc1
    buffer_load_dwordx4 v[152:155], v1, s[4:7], s32 offen offset:2048 sc1
    buffer_load_dwordx4 v[156:159], v1, s[4:7], s32 offen offset:3072 sc1
    buffer_load_dwordx4 v[160:163], v1, s[4:7], s33 offen offset:0 sc1
    buffer_load_dwordx4 v[164:167], v1, s[4:7], s33 offen offset:1024 sc1
    buffer_load_dwordx4 v[168:171], v1, s[4:7], s33 offen offset:2048 sc1
    buffer_load_dwordx4 v[172:175], v1, s[4:7], s33 offen offset:3072 sc1
    s_mov_b32 s32, 2
    s_lshl_b32 s32, s32, 13
    s_add_u32 s32, s32, s29
    s_add_u32 s33, s32, 4096
    buffer_load_dwordx2 v[176:177], v7, s[4:7], s32 offen offset:0 sc1
    buffer_load_dwordx2 v[178:179], v7, s[4:7], s32 offen offset:128 sc1
    buffer_load_dwordx2 v[180:181], v7, s[4:7], s32 offen offset:1024 sc1
    buffer_load_dwordx2 v[182:183], v7, s[4:7], s32 offen offset:1152 sc1
    s_lshl_b32 s42, s23, 3
    s_add_u32 s42, s42, s24
    s_lshl_b32 s42, s42, 2
    s_add_u32 s42, s42, s20
    s_lshl_b32 s42, s42, 8
    s_add_u32 s42, s42, s21
    s_add_u32 s42, s42, 0x1b40000
    v_mov_b32 v220, -1.0
    v_lshrrev_b32 v221, 2, v1
    buffer_store_dword v220, v221, s[4:7], s42 offen sc1
    s_lshl_b32 s50, s22, 7
    s_add_u32 s50, s50, s44
    s_lshl_b32 s50, s50, 8
    s_add_u32 s50, s50, 0x4509000
    s_add_u32 s50, s50, s4
    s_addc_u32 s51, s5, 0
    s_waitcnt vmcnt(21)
    v_lshlrev_b32 v16, 16, v208
    v_and_b32 v17, 0xffff0000, v208
    v_lshlrev_b32 v18, 16, v209
    v_and_b32 v19, 0xffff0000, v209
    v_lshlrev_b32 v20, 16, v210
    v_and_b32 v21, 0xffff0000, v210
    v_lshlrev_b32 v22, 16, v211
    v_and_b32 v23, 0xffff0000, v211
    v_lshlrev_b32 v24, 16, v212
    v_and_b32 v25, 0xffff0000, v212
    v_lshlrev_b32 v26, 16, v213
    v_and_b32 v27, 0xffff0000, v213
    v_lshlrev_b32 v28, 16, v214
    v_and_b32 v29, 0xffff0000, v214
    v_lshlrev_b32 v30, 16, v215
    v_and_b32 v31, 0xffff0000, v215
    v_lshlrev_b32 v32, 16, v216
    v_and_b32 v33, 0xffff0000, v216
    v_lshlrev_b32 v34, 16, v217
    v_and_b32 v35, 0xffff0000, v217
    s_waitcnt vmcnt(19) lgkmcnt(4)
    v_mfma_f32_16x16x32_bf16 v[16:19], v[40:43], v[112:115], v[16:19]
    ds_read_b128 v[76:79], v12 offset:27648
    v_mfma_f32_16x16x32_bf16 v[20:23], v[44:47], v[112:115], v[20:23]
    ds_read_b128 v[80:83], v12 offset:28672
    v_mfma_f32_16x16x32_bf16 v[24:27], v[48:51], v[112:115], v[24:27]
    ds_read_b128 v[84:87], v12 offset:29696
    v_mfma_f32_16x16x32_bf16 v[28:31], v[52:55], v[112:115], v[28:31]
    ds_read_b128 v[88:91], v12 offset:30720
    v_mfma_f32_16x16x32_bf16 v[32:35], v[72:75], v[112:115], v[32:35]
    ds_read_b128 v[108:111], v12 offset:35840
    s_waitcnt lgkmcnt(5)
    v_mfma_f32_16x16x32_bf16 v[16:19], v[56:59], v[116:119], v[16:19]
    ds_read_b128 v[92:95], v12 offset:31744
    v_mfma_f32_16x16x32_bf16 v[20:23], v[60:63], v[116:119], v[20:23]
    ds_read_b128 v[96:99], v12 offset:32768
    v_mfma_f32_16x16x32_bf16 v[24:27], v[64:67], v[116:119], v[24:27]
    ds_read_b128 v[100:103], v12 offset:33792
    v_mfma_f32_16x16x32_bf16 v[28:31], v[68:71], v[116:119], v[28:31]
    ds_read_b128 v[104:107], v12 offset:34816
    v_mfma_f32_16x16x32_bf16 v[36:39], v[72:75], v[116:119], 0
    s_waitcnt vmcnt(17) lgkmcnt(4)
    v_mfma_f32_16x16x32_bf16 v[16:19], v[76:79], v[120:123], v[16:19]
    ds_read_b128 v[40:43], v13 offset:18432
    v_mfma_f32_16x16x32_bf16 v[20:23], v[80:83], v[120:123], v[20:23]
    ds_read_b128 v[44:47], v13 offset:19456
    v_mfma_f32_16x16x32_bf16 v[24:27], v[84:87], v[120:123], v[24:27]
    ds_read_b128 v[48:51], v13 offset:20480
    v_mfma_f32_16x16x32_bf16 v[28:31], v[88:91], v[120:123], v[28:31]
    ds_read_b128 v[52:55], v13 offset:21504
    v_mfma_f32_16x16x32_bf16 v[32:35], v[108:111], v[120:123], v[32:35]
    ds_read_b128 v[72:75], v13 offset:26624
    s_waitcnt lgkmcnt(5)
    v_mfma_f32_16x16x32_bf16 v[16:19], v[92:95], v[124:127], v[16:19]
    ds_read_b128 v[56:59], v13 offset:22528
    v_mfma_f32_16x16x32_bf16 v[20:23], v[96:99], v[124:127], v[20:23]
    ds_read_b128 v[60:63], v13 offset:23552
    v_mfma_f32_16x16x32_bf16 v[24:27], v[100:103], v[124:127], v[24:27]
    ds_read_b128 v[64:67], v13 offset:24576
    v_mfma_f32_16x16x32_bf16 v[28:31], v[104:107], v[124:127], v[28:31]
    ds_read_b128 v[68:71], v13 offset:25600
    v_mfma_f32_16x16x32_bf16 v[36:39], v[108:111], v[124:127], v[36:39]
    s_waitcnt vmcnt(15) lgkmcnt(4)
    v_mfma_f32_16x16x32_bf16 v[16:19], v[40:43], v[128:131], v[16:19]
    ds_read_b128 v[76:79], v13 offset:27648
    v_mfma_f32_16x16x32_bf16 v[20:23], v[44:47], v[128:131], v[20:23]
    ds_read_b128 v[80:83], v13 offset:28672
    v_mfma_f32_16x16x32_bf16 v[24:27], v[48:51], v[128:131], v[24:27]
    ds_read_b128 v[84:87], v13 offset:29696
    v_mfma_f32_16x16x32_bf16 v[28:31], v[52:55], v[128:131], v[28:31]
    ds_read_b128 v[88:91], v13 offset:30720
    v_mfma_f32_16x16x32_bf16 v[32:35], v[72:75], v[128:131], v[32:35]
    ds_read_b128 v[108:111], v13 offset:35840
    s_waitcnt lgkmcnt(5)
    v_mfma_f32_16x16x32_bf16 v[16:19], v[56:59], v[132:135], v[16:19]
    ds_read_b128 v[92:95], v13 offset:31744
    v_mfma_f32_16x16x32_bf16 v[20:23], v[60:63], v[132:135], v[20:23]
    ds_read_b128 v[96:99], v13 offset:32768
    v_mfma_f32_16x16x32_bf16 v[24:27], v[64:67], v[132:135], v[24:27]
    ds_read_b128 v[100:103], v13 offset:33792
    v_mfma_f32_16x16x32_bf16 v[28:31], v[68:71], v[132:135], v[28:31]
    ds_read_b128 v[104:107], v13 offset:34816
    v_mfma_f32_16x16x32_bf16 v[36:39], v[72:75], v[132:135], v[36:39]
    s_waitcnt vmcnt(13) lgkmcnt(4)
    v_mfma_f32_16x16x32_bf16 v[16:19], v[76:79], v[136:139], v[16:19]
    ds_read_b128 v[40:43], v14 offset:18432
    v_mfma_f32_16x16x32_bf16 v[20:23], v[80:83], v[136:139], v[20:23]
    ds_read_b128 v[44:47], v14 offset:19456
    v_mfma_f32_16x16x32_bf16 v[24:27], v[84:87], v[136:139], v[24:27]
    ds_read_b128 v[48:51], v14 offset:20480
    v_mfma_f32_16x16x32_bf16 v[28:31], v[88:91], v[136:139], v[28:31]
    ds_read_b128 v[52:55], v14 offset:21504
    v_mfma_f32_16x16x32_bf16 v[32:35], v[108:111], v[136:139], v[32:35]
    ds_read_b128 v[72:75], v14 offset:26624
    s_waitcnt lgkmcnt(5)
    v_mfma_f32_16x16x32_bf16 v[16:19], v[92:95], v[140:143], v[16:19]
    ds_read_b128 v[56:59], v14 offset:22528
    v_mfma_f32_16x16x32_bf16 v[20:23], v[96:99], v[140:143], v[20:23]
    ds_read_b128 v[60:63], v14 offset:23552
    v_mfma_f32_16x16x32_bf16 v[24:27], v[100:103], v[140:143], v[24:27]
    ds_read_b128 v[64:67], v14 offset:24576
    v_mfma_f32_16x16x32_bf16 v[28:31], v[104:107], v[140:143], v[28:31]
    ds_read_b128 v[68:71], v14 offset:25600
    v_mfma_f32_16x16x32_bf16 v[36:39], v[108:111], v[140:143], v[36:39]
    s_waitcnt vmcnt(11) lgkmcnt(4)
    v_mfma_f32_16x16x32_bf16 v[16:19], v[40:43], v[144:147], v[16:19]
    ds_read_b128 v[76:79], v14 offset:27648
    v_mfma_f32_16x16x32_bf16 v[20:23], v[44:47], v[144:147], v[20:23]
    ds_read_b128 v[80:83], v14 offset:28672
    v_mfma_f32_16x16x32_bf16 v[24:27], v[48:51], v[144:147], v[24:27]
    ds_read_b128 v[84:87], v14 offset:29696
    v_mfma_f32_16x16x32_bf16 v[28:31], v[52:55], v[144:147], v[28:31]
    ds_read_b128 v[88:91], v14 offset:30720
    v_mfma_f32_16x16x32_bf16 v[32:35], v[72:75], v[144:147], v[32:35]
    ds_read_b128 v[108:111], v14 offset:35840
    s_waitcnt lgkmcnt(5)
    v_mfma_f32_16x16x32_bf16 v[16:19], v[56:59], v[148:151], v[16:19]
    ds_read_b128 v[92:95], v14 offset:31744
    v_mfma_f32_16x16x32_bf16 v[20:23], v[60:63], v[148:151], v[20:23]
    ds_read_b128 v[96:99], v14 offset:32768
    v_mfma_f32_16x16x32_bf16 v[24:27], v[64:67], v[148:151], v[24:27]
    ds_read_b128 v[100:103], v14 offset:33792
    v_mfma_f32_16x16x32_bf16 v[28:31], v[68:71], v[148:151], v[28:31]
    ds_read_b128 v[104:107], v14 offset:34816
    v_mfma_f32_16x16x32_bf16 v[36:39], v[72:75], v[148:151], v[36:39]
    s_waitcnt vmcnt(9) lgkmcnt(4)
    v_mfma_f32_16x16x32_bf16 v[16:19], v[76:79], v[152:155], v[16:19]
    ds_read_b128 v[40:43], v15 offset:18432
    v_mfma_f32_16x16x32_bf16 v[20:23], v[80:83], v[152:155], v[20:23]
    ds_read_b128 v[44:47], v15 offset:19456
    v_mfma_f32_16x16x32_bf16 v[24:27], v[84:87], v[152:155], v[24:27]
    ds_read_b128 v[48:51], v15 offset:20480
    v_mfma_f32_16x16x32_bf16 v[28:31], v[88:91], v[152:155], v[28:31]
    ds_read_b128 v[52:55], v15 offset:21504
    v_mfma_f32_16x16x32_bf16 v[32:35], v[108:111], v[152:155], v[32:35]
    ds_read_b128 v[72:75], v15 offset:26624
    s_waitcnt lgkmcnt(5)
    v_mfma_f32_16x16x32_bf16 v[16:19], v[92:95], v[156:159], v[16:19]
    ds_read_b128 v[56:59], v15 offset:22528
    v_mfma_f32_16x16x32_bf16 v[20:23], v[96:99], v[156:159], v[20:23]
    ds_read_b128 v[60:63], v15 offset:23552
    v_mfma_f32_16x16x32_bf16 v[24:27], v[100:103], v[156:159], v[24:27]
    ds_read_b128 v[64:67], v15 offset:24576
    v_mfma_f32_16x16x32_bf16 v[28:31], v[104:107], v[156:159], v[28:31]
    ds_read_b128 v[68:71], v15 offset:25600
    v_mfma_f32_16x16x32_bf16 v[36:39], v[108:111], v[156:159], v[36:39]
    s_waitcnt vmcnt(7) lgkmcnt(4)
    v_mfma_f32_16x16x32_bf16 v[16:19], v[40:43], v[160:163], v[16:19]
    ds_read_b128 v[76:79], v15 offset:27648
    v_mfma_f32_16x16x32_bf16 v[20:23], v[44:47], v[160:163], v[20:23]
    ds_read_b128 v[80:83], v15 offset:28672
    v_mfma_f32_16x16x32_bf16 v[24:27], v[48:51], v[160:163], v[24:27]
    ds_read_b128 v[84:87], v15 offset:29696
    v_mfma_f32_16x16x32_bf16 v[28:31], v[52:55], v[160:163], v[28:31]
    ds_read_b128 v[88:91], v15 offset:30720
    v_mfma_f32_16x16x32_bf16 v[32:35], v[72:75], v[160:163], v[32:35]
    ds_read_b128 v[108:111], v15 offset:35840
    s_waitcnt lgkmcnt(5)
    v_mfma_f32_16x16x32_bf16 v[16:19], v[56:59], v[164:167], v[16:19]
    ds_read_b128 v[92:95], v15 offset:31744
    v_mfma_f32_16x16x32_bf16 v[20:23], v[60:63], v[164:167], v[20:23]
    ds_read_b128 v[96:99], v15 offset:32768
    v_mfma_f32_16x16x32_bf16 v[24:27], v[64:67], v[164:167], v[24:27]
    ds_read_b128 v[100:103], v15 offset:33792
    v_mfma_f32_16x16x32_bf16 v[28:31], v[68:71], v[164:167], v[28:31]
    ds_read_b128 v[104:107], v15 offset:34816
    v_mfma_f32_16x16x32_bf16 v[36:39], v[72:75], v[164:167], v[36:39]
    s_waitcnt vmcnt(5) lgkmcnt(4)
    v_mfma_f32_16x16x32_bf16 v[16:19], v[76:79], v[168:171], v[16:19]
    ds_read_b128 v[40:43], v15 offset:36864
    v_mfma_f32_16x16x32_bf16 v[20:23], v[80:83], v[168:171], v[20:23]
    ds_read_b128 v[44:47], v15 offset:37888
    v_mfma_f32_16x16x32_bf16 v[24:27], v[84:87], v[168:171], v[24:27]
    ds_read_b128 v[48:51], v15 offset:38912
    v_mfma_f32_16x16x32_bf16 v[28:31], v[88:91], v[168:171], v[28:31]
    ds_read_b128 v[52:55], v15 offset:39936
    v_mfma_f32_16x16x32_bf16 v[32:35], v[108:111], v[168:171], v[32:35]
    ds_read_b128 v[72:75], v15 offset:45056
    s_waitcnt lgkmcnt(5)
    v_mfma_f32_16x16x32_bf16 v[16:19], v[92:95], v[172:175], v[16:19]
    ds_read_b128 v[56:59], v15 offset:40960
    v_mfma_f32_16x16x32_bf16 v[20:23], v[96:99], v[172:175], v[20:23]
    ds_read_b128 v[60:63], v15 offset:41984
    v_mfma_f32_16x16x32_bf16 v[24:27], v[100:103], v[172:175], v[24:27]
    ds_read_b128 v[64:67], v15 offset:43008
    v_mfma_f32_16x16x32_bf16 v[28:31], v[104:107], v[172:175], v[28:31]
    ds_read_b128 v[68:71], v15 offset:44032
    v_mfma_f32_16x16x32_bf16 v[36:39], v[108:111], v[172:175], v[36:39]
    s_waitcnt vmcnt(1) lgkmcnt(4)
    v_mfma_f32_16x16x32_bf16 v[16:19], v[40:43], v[176:179], v[16:19]
    v_mfma_f32_16x16x32_bf16 v[20:23], v[44:47], v[176:179], v[20:23]
    v_mfma_f32_16x16x32_bf16 v[24:27], v[48:51], v[176:179], v[24:27]
    v_mfma_f32_16x16x32_bf16 v[28:31], v[52:55], v[176:179], v[28:31]
    v_mfma_f32_16x16x32_bf16 v[32:35], v[72:75], v[176:179], v[32:35]
    s_waitcnt lgkmcnt(0)
    v_mfma_f32_16x16x32_bf16 v[16:19], v[56:59], v[180:183], v[16:19]
    v_mfma_f32_16x16x32_bf16 v[20:23], v[60:63], v[180:183], v[20:23]
    v_mfma_f32_16x16x32_bf16 v[24:27], v[64:67], v[180:183], v[24:27]
    v_mfma_f32_16x16x32_bf16 v[28:31], v[68:71], v[180:183], v[28:31]
    v_mfma_f32_16x16x32_bf16 v[36:39], v[72:75], v[180:183], v[36:39]
    s_nop 3
    v_cvt_pk_bf16_f32 v208, v16, v17
    v_cvt_pk_bf16_f32 v209, v18, v19
    v_cvt_pk_bf16_f32 v210, v20, v21
    v_cvt_pk_bf16_f32 v211, v22, v23
    v_cvt_pk_bf16_f32 v212, v24, v25
    v_cvt_pk_bf16_f32 v213, v26, v27
    v_cvt_pk_bf16_f32 v214, v28, v29
    v_cvt_pk_bf16_f32 v215, v30, v31
    buffer_store_dwordx4 v[208:211], v4, s[4:7], s34 offen offset:0 sc1
    buffer_store_dwordx4 v[212:215], v4, s[4:7], s34 offen offset:1024 sc1
    v_permlane32_swap_b32 v36, v220
    v_permlane32_swap_b32 v37, v221
    v_permlane32_swap_b32 v38, v222
    v_permlane32_swap_b32 v39, v223
    v_pk_add_f32 v[32:33], v[32:33], v[220:221]
    v_pk_add_f32 v[34:35], v[34:35], v[222:223]
    v_cvt_pk_bf16_f32 v216, v32, v33
    v_cvt_pk_bf16_f32 v217, v34, v35
    buffer_store_dwordx2 v[216:217], v5, s[4:7], s34 offen sc1
    v_cndmask_b32 v222, 0, v216, s[40:41]
    v_cndmask_b32 v223, 0, v217, s[40:41]
    v_dot2_f32_bf16 v220, v208, v11, 0
    v_dot2_f32_bf16 v221, v208, v208, 0
    v_dot2_f32_bf16 v220, v209, v11, v220
    v_dot2_f32_bf16 v221, v209, v209, v221
    v_dot2_f32_bf16 v220, v210, v11, v220
    v_dot2_f32_bf16 v221, v210, v210, v221
    v_dot2_f32_bf16 v220, v211, v11, v220
    v_dot2_f32_bf16 v221, v211, v211, v221
    v_dot2_f32_bf16 v220, v212, v11, v220
    v_dot2_f32_bf16 v221, v212, v212, v221
    v_dot2_f32_bf16 v220, v213, v11, v220
    v_dot2_f32_bf16 v221, v213, v213, v221
    v_dot2_f32_bf16 v220, v214, v11, v220
    v_dot2_f32_bf16 v221, v214, v214, v221
    v_dot2_f32_bf16 v220, v215, v11, v220
    v_dot2_f32_bf16 v221, v215, v215, v221
    v_dot2_f32_bf16 v220, v222, v11, v220
    v_dot2_f32_bf16 v221, v222, v222, v221
    v_dot2_f32_bf16 v220, v223, v11, v220
    v_dot2_f32_bf16 v221, v223, v223, v221
    s_nop 2
    v_mov_b32 v222, v220
    v_mov_b32 v223, v221
    s_nop 1
    v_permlane32_swap_b32 v220, v222
    v_permlane32_swap_b32 v221, v223
    v_add_f32 v220, v220, v222
    v_add_f32 v221, v221, v223
    v_mov_b32 v222, v220
    v_mov_b32 v223, v221
    s_nop 1
    v_permlane16_swap_b32 v220, v222
    v_permlane16_swap_b32 v221, v223
    v_add_f32 v220, v220, v222
    v_add_f32 v221, v221, v223
    buffer_store_dwordx2 v[220:221], v10, s[4:7], s39 offen sc1
    s_and_b32 s25, s2, 7
    s_lshr_b32 s26, s2, 3
    s_and_b32 s23, s25, 1
    s_lshl_b32 s23, s23, 3
    s_and_b32 s27, s26, 7
    s_add_u32 s23, s23, s27
    s_lshr_b32 s24, s25, 1
    s_lshl_b32 s24, s24, 2
    s_lshr_b32 s27, s26, 3
    s_add_u32 s24, s24, s27
    s_add_u32 s28, s23, s24
    s_and_b32 s28, s28, 3
    s_lshl_b32 s30, s20, 12
    s_lshl_b32 s31, s23, 3
    s_lshl_b32 s33, s20, 1
    s_add_u32 s31, s31, s33
    s_lshl_b32 s32, s31, 10
    s_add_u32 s32, s32, s21
    s_add_u32 s32, s32, 0x1b20000
    v_add_u32 v2, 73728, v1
    s_add_u32 s33, s30, 18432
    v_add_u32 v3, s33, v1
    v_add_u32 v0, s33, v2
    s_lshr_b32 s34, s31, 1
    s_lshl_b32 s35, s34, 12
    s_add_u32 s35, s35, s21
    s_add_u32 s35, s35, 0x1b40000
    s_lshl_b32 s36, s24, 8
    s_add_u32 s36, s36, s35
    s_lshl_b32 s38, s24, 6
    s_add_u32 s38, s38, s34
    s_mul_i32 s38, s38, 9216
    s_add_u32 s38, s38, s21
    s_add_u32 s38, s38, 0x900000
    s_add_u32 s39, s38, 4096
    s_add_u32 s46, s38, 8192
    s_mov_b32 s40, 0xc0135761
    s_mov_b32 s42, 0x3d372713
    s_mov_b32 s44, 0x39e38e39
    s_mov_b32 s45, 0x3727c5ac
    v_lshrrev_b32 v4, 1, v1
    s_lshl_b32 s52, s22, 7
    s_add_u32 s52, s52, s23
    s_lshl_b32 s52, s52, 8
    s_add_u32 s52, s52, 0x4509000
    s_add_u32 s52, s52, s4
    s_addc_u32 s53, s5, 0
    s_waitcnt vmcnt(0)
    s_barrier
    s_cmp_lg_u32 s20, 0
    s_cbranch_scc1 L_ns_d3
    s_mov_b32 s56, 1
    s_atomic_add s56, s[50:51], 0
L_ns_d3:
    s_cmp_lg_u32 s20, 0
    s_cbranch_scc1 L_pd_d3
    s_mov_b32 s60, 65536
L_poll_d3:
    s_mov_b32 s57, 0
    s_atomic_add s57, s[52:53], 0 glc
    s_waitcnt lgkmcnt(0)
    s_cmp_ge_u32 s57, 16
    s_cbranch_scc1 L_pd_d3
    s_sub_u32 s60, s60, 1
    s_cbranch_scc1 L_pd_d3
    s_sleep 2
    s_branch L_poll_d3
L_pd_d3:
    s_barrier
    buffer_load_dwordx2 v[8:9], v4, s[4:7], s32 offen offset:0 sc1
    buffer_load_dwordx2 v[10:11], v4, s[4:7], s32 offen offset:512 sc1
    buffer_load_dwordx2 v[12:13], v4, s[4:7], s32 offen offset:1024 sc1
    buffer_load_dwordx2 v[14:15], v4, s[4:7], s32 offen offset:1536 sc1
    s_lshl_b32 s50, s22, 7
    s_add_u32 s50, s50, s23
    s_lshl_b32 s50, s50, 8
    s_add_u32 s50, s50, 0x450a000
    s_add_u32 s50, s50, s4
    s_addc_u32 s51, s5, 0
    s_barrier
    ds_read_b128 v[160:163], v3 offset:0
    ds_read_b128 v[164:167], v3 offset:2048
    ds_read_b128 v[168:171], v1 offset:0
    ds_read_b128 v[172:175], v1 offset:1024
    ds_read_b128 v[176:179], v1 offset:2048
    ds_read_b128 v[180:183], v1 offset:3072
    ds_read_b128 v[184:187], v1 offset:4096
    ds_read_b128 v[188:191], v1 offset:5120
    ds_read_b128 v[192:195], v1 offset:6144
    ds_read_b128 v[196:199], v1 offset:7168
    ds_read_b128 v[200:203], v1 offset:8192
    s_waitcnt lgkmcnt(5)
    v_mfma_f32_16x16x32_bf16 v[16:19], v[160:163], v[168:171], 0
    ds_read_b128 v[204:207], v3 offset:1024
    v_mfma_f32_16x16x32_bf16 v[20:23], v[164:167], v[168:171], 0
    ds_read_b128 v[208:211], v3 offset:3072
    v_mfma_f32_16x16x32_bf16 v[24:27], v[160:163], v[172:175], 0
    ds_read_b128 v[212:215], v1 offset:9216
    v_mfma_f32_16x16x32_bf16 v[28:31], v[164:167], v[172:175], 0
    ds_read_b128 v[216:219], v1 offset:10240
    v_mfma_f32_16x16x32_bf16 v[32:35], v[160:163], v[176:179], 0
    ds_read_b128 v[220:223], v1 offset:11264
    v_mfma_f32_16x16x32_bf16 v[36:39], v[164:167], v[176:179], 0
    ds_read_b128 v[224:227], v1 offset:12288
    v_mfma_f32_16x16x32_bf16 v[40:43], v[160:163], v[180:183], 0
    ds_read_b128 v[228:231], v1 offset:13312
    v_mfma_f32_16x16x32_bf16 v[44:47], v[164:167], v[180:183], 0
    ds_read_b128 v[232:235], v1 offset:14336
    s_waitcnt lgkmcnt(8)
    v_mfma_f32_16x16x32_bf16 v[48:51], v[160:163], v[184:187], 0
    ds_read_b128 v[236:239], v1 offset:15360
    v_mfma_f32_16x16x32_bf16 v[52:55], v[164:167], v[184:187], 0
    ds_read_b128 v[240:243], v1 offset:16384
    v_mfma_f32_16x16x32_bf16 v[56:59], v[160:163], v[188:191], 0
    ds_read_b128 v[244:247], v1 offset:17408
    v_mfma_f32_16x16x32_bf16 v[60:63], v[164:167], v[188:191], 0
    v_mfma_f32_16x16x32_bf16 v[64:67], v[160:163], v[192:195], 0
    v_mfma_f32_16x16x32_bf16 v[68:71], v[164:167], v[192:195], 0
    v_mfma_f32_16x16x32_bf16 v[72:75], v[160:163], v[196:199], 0
    v_mfma_f32_16x16x32_bf16 v[76:79], v[164:167], v[196:199], 0
    v_mfma_f32_16x16x32_bf16 v[80:83], v[160:163], v[200:203], 0
    v_mfma_f32_16x16x32_bf16 v[84:87], v[164:167], v[200:203], 0
    s_waitcnt lgkmcnt(0)
    s_barrier
    v_mfma_f32_16x16x32_bf16 v[16:19], v[204:207], v[212:215], v[16:19]
    ds_read_b128 v[160:163], v3 offset:36864
    v_mfma_f32_16x16x32_bf16 v[20:23], v[208:211], v[212:215], v[20:23]
    ds_read_b128 v[164:167], v3 offset:38912
    v_mfma_f32_16x16x32_bf16 v[24:27], v[204:207], v[216:219], v[24:27]
    ds_read_b128 v[168:171], v1 offset:36864
    v_mfma_f32_16x16x32_bf16 v[28:31], v[208:211], v[216:219], v[28:31]
    ds_read_b128 v[172:175], v1 offset:37888
    v_mfma_f32_16x16x32_bf16 v[32:35], v[204:207], v[220:223], v[32:35]
    ds_read_b128 v[176:179], v1 offset:38912
    v_mfma_f32_16x16x32_bf16 v[36:39], v[208:211], v[220:223], v[36:39]
    ds_read_b128 v[180:183], v1 offset:39936
    v_mfma_f32_16x16x32_bf16 v[40:43], v[204:207], v[224:227], v[40:43]
    ds_read_b128 v[184:187], v1 offset:40960
    v_mfma_f32_16x16x32_bf16 v[44:47], v[208:211], v[224:227], v[44:47]
    ds_read_b128 v[188:191], v1 offset:41984
    v_mfma_f32_16x16x32_bf16 v[48:51], v[204:207], v[228:231], v[48:51]
    ds_read_b128 v[192:195], v1 offset:43008
    v_mfma_f32_16x16x32_bf16 v[52:55], v[208:211], v[228:231], v[52:55]
    ds_read_b128 v[196:199], v1 offset:44032
    v_lshrrev_b32 v5, 8, v1
    v_mfma_f32_16x16x32_bf16 v[56:59], v[204:207], v[232:235], v[56:59]
    ds_read_b128 v[200:203], v1 offset:45056
    v_bfe_u32 v6, v1, 4, 4
    v_mfma_f32_16x16x32_bf16 v[60:63], v[208:211], v[232:235], v[60:63]
    v_lshlrev_b32 v7, 2, v6
    v_mfma_f32_16x16x32_bf16 v[64:67], v[204:207], v[236:239], v[64:67]
    s_lshl_b32 s33, s20, 8
    v_mfma_f32_16x16x32_bf16 v[68:71], v[208:211], v[236:239], v[68:71]
    s_add_u32 s33, s33, 147456
    v_mfma_f32_16x16x32_bf16 v[72:75], v[204:207], v[240:243], v[72:75]
    v_add_u32 v4, s33, v7
    v_mfma_f32_16x16x32_bf16 v[76:79], v[208:211], v[240:243], v[76:79]
    v_lshl_add_u32 v252, v5, 4, s33
    v_mfma_f32_16x16x32_bf16 v[80:83], v[204:207], v[244:247], v[80:83]
    v_add_u32 v7, 159744, v7
    v_mfma_f32_16x16x32_bf16 v[84:87], v[208:211], v[244:247], v[84:87]
    v_add_u32 v253, 1152, v7
    s_waitcnt vmcnt(0)
    s_waitcnt lgkmcnt(5)
    v_mfma_f32_16x16x32_bf16 v[16:19], v[160:163], v[168:171], v[16:19]
    ds_read2_b32 v[128:129], v7 offset0:0 offset1:16
    ds_read2_b32 v[130:131], v7 offset0:32 offset1:48
    ds_read_b128 v[204:207], v3 offset:37888
    v_mfma_f32_16x16x32_bf16 v[20:23], v[164:167], v[168:171], v[20:23]
    ds_read_b128 v[208:211], v3 offset:39936
    v_mfma_f32_16x16x32_bf16 v[24:27], v[160:163], v[172:175], v[24:27]
    ds_read_b128 v[212:215], v1 offset:46080
    v_mfma_f32_16x16x32_bf16 v[28:31], v[164:167], v[172:175], v[28:31]
    ds_read_b128 v[216:219], v1 offset:47104
    v_mfma_f32_16x16x32_bf16 v[32:35], v[160:163], v[176:179], v[32:35]
    ds_read_b128 v[220:223], v1 offset:48128
    v_mfma_f32_16x16x32_bf16 v[36:39], v[164:167], v[176:179], v[36:39]
    ds_read_b128 v[224:227], v1 offset:49152
    v_mfma_f32_16x16x32_bf16 v[40:43], v[160:163], v[180:183], v[40:43]
    ds_read_b128 v[228:231], v1 offset:50176
    v_mfma_f32_16x16x32_bf16 v[44:47], v[164:167], v[180:183], v[44:47]
    ds_read_b128 v[232:235], v1 offset:51200
    s_waitcnt lgkmcnt(8)
    v_mfma_f32_16x16x32_bf16 v[48:51], v[160:163], v[184:187], v[48:51]
    ds_read_b128 v[236:239], v1 offset:52224
    v_mfma_f32_16x16x32_bf16 v[52:55], v[164:167], v[184:187], v[52:55]
    ds_read_b128 v[240:243], v1 offset:53248
    v_add_f32 v248, v8, v10
    v_mfma_f32_16x16x32_bf16 v[56:59], v[160:163], v[188:191], v[56:59]
    ds_read_b128 v[244:247], v1 offset:54272
    v_add_f32 v249, v9, v11
    v_mfma_f32_16x16x32_bf16 v[60:63], v[164:167], v[188:191], v[60:63]
    v_add_f32 v250, v12, v14
    v_mfma_f32_16x16x32_bf16 v[64:67], v[160:163], v[192:195], v[64:67]
    v_add_f32 v251, v13, v15
    v_mfma_f32_16x16x32_bf16 v[68:71], v[164:167], v[192:195], v[68:71]
    v_mov_b32 v8, v248
    v_mfma_f32_16x16x32_bf16 v[72:75], v[160:163], v[196:199], v[72:75]
    v_mov_b32 v9, v249
    v_mfma_f32_16x16x32_bf16 v[76:79], v[164:167], v[196:199], v[76:79]
    v_mov_b32 v12, v250
    v_mfma_f32_16x16x32_bf16 v[80:83], v[160:163], v[200:203], v[80:83]
    v_mov_b32 v13, v251
    v_mfma_f32_16x16x32_bf16 v[84:87], v[164:167], v[200:203], v[84:87]
    v_permlane32_swap_b32 v248, v8
    v_permlane32_swap_b32 v249, v9
    s_waitcnt lgkmcnt(0)
    s_barrier
    v_mfma_f32_16x16x32_bf16 v[16:19], v[204:207], v[212:215], v[16:19]
    ds_read2_b32 v[132:133], v7 offset0:64 offset1:80
    ds_read2_b32 v[134:135], v7 offset0:96 offset1:112
    ds_read_b128 v[160:163], v0 offset:0
    v_mfma_f32_16x16x32_bf16 v[20:23], v[208:211], v[212:215], v[20:23]
    ds_read_b128 v[164:167], v0 offset:2048
    v_mfma_f32_16x16x32_bf16 v[24:27], v[204:207], v[216:219], v[24:27]
    ds_read_b128 v[168:171], v2 offset:0
    v_mfma_f32_16x16x32_bf16 v[28:31], v[208:211], v[216:219], v[28:31]
    ds_read_b128 v[172:175], v2 offset:1024
    v_mfma_f32_16x16x32_bf16 v[32:35], v[204:207], v[220:223], v[32:35]
    ds_read_b128 v[176:179], v2 offset:2048
    v_mfma_f32_16x16x32_bf16 v[36:39], v[208:211], v[220:223], v[36:39]
    ds_read_b128 v[180:183], v2 offset:3072
    v_mfma_f32_16x16x32_bf16 v[40:43], v[204:207], v[224:227], v[40:43]
    ds_read_b128 v[184:187], v2 offset:4096
    v_mfma_f32_16x16x32_bf16 v[44:47], v[208:211], v[224:227], v[44:47]
    ds_read_b128 v[188:191], v2 offset:5120
    v_mfma_f32_16x16x32_bf16 v[48:51], v[204:207], v[228:231], v[48:51]
    ds_read_b128 v[192:195], v2 offset:6144
    v_mfma_f32_16x16x32_bf16 v[52:55], v[208:211], v[228:231], v[52:55]
    ds_read_b128 v[196:199], v2 offset:7168
    v_permlane32_swap_b32 v250, v12
    v_mfma_f32_16x16x32_bf16 v[56:59], v[204:207], v[232:235], v[56:59]
    ds_read_b128 v[200:203], v2 offset:8192
    v_permlane32_swap_b32 v251, v13
    v_mfma_f32_16x16x32_bf16 v[60:63], v[208:211], v[232:235], v[60:63]
    v_add_f32 v248, v248, v8
    v_mfma_f32_16x16x32_bf16 v[64:67], v[204:207], v[236:239], v[64:67]
    v_add_f32 v249, v249, v9
    v_mfma_f32_16x16x32_bf16 v[68:71], v[208:211], v[236:239], v[68:71]
    v_add_f32 v250, v250, v12
    v_mfma_f32_16x16x32_bf16 v[72:75], v[204:207], v[240:243], v[72:75]
    v_add_f32 v251, v251, v13
    v_mfma_f32_16x16x32_bf16 v[76:79], v[208:211], v[240:243], v[76:79]
    v_mov_b32 v8, v248
    v_mfma_f32_16x16x32_bf16 v[80:83], v[204:207], v[244:247], v[80:83]
    v_mov_b32 v9, v249
    v_mfma_f32_16x16x32_bf16 v[84:87], v[208:211], v[244:247], v[84:87]
    v_mov_b32 v12, v250
    v_mov_b32 v13, v251
    s_waitcnt lgkmcnt(5)
    v_mfma_f32_16x16x32_bf16 v[16:19], v[160:163], v[168:171], v[16:19]
    ds_read2_b32 v[136:137], v7 offset0:128 offset1:144
    ds_read2_b32 v[138:139], v253 offset0:0 offset1:16
    ds_read_b128 v[204:207], v0 offset:1024
    v_mfma_f32_16x16x32_bf16 v[20:23], v[164:167], v[168:171], v[20:23]
    ds_read_b128 v[208:211], v0 offset:3072
    v_mfma_f32_16x16x32_bf16 v[24:27], v[160:163], v[172:175], v[24:27]
    ds_read_b128 v[212:215], v2 offset:9216
    v_mfma_f32_16x16x32_bf16 v[28:31], v[164:167], v[172:175], v[28:31]
    ds_read_b128 v[216:219], v2 offset:10240
    v_mfma_f32_16x16x32_bf16 v[32:35], v[160:163], v[176:179], v[32:35]
    ds_read_b128 v[220:223], v2 offset:11264
    v_mfma_f32_16x16x32_bf16 v[36:39], v[164:167], v[176:179], v[36:39]
    ds_read_b128 v[224:227], v2 offset:12288
    v_mfma_f32_16x16x32_bf16 v[40:43], v[160:163], v[180:183], v[40:43]
    ds_read_b128 v[228:231], v2 offset:13312
    v_mfma_f32_16x16x32_bf16 v[44:47], v[164:167], v[180:183], v[44:47]
    ds_read_b128 v[232:235], v2 offset:14336
    s_waitcnt lgkmcnt(8)
    v_mfma_f32_16x16x32_bf16 v[48:51], v[160:163], v[184:187], v[48:51]
    ds_read_b128 v[236:239], v2 offset:15360
    v_mfma_f32_16x16x32_bf16 v[52:55], v[164:167], v[184:187], v[52:55]
    ds_read_b128 v[240:243], v2 offset:16384
    v_permlane16_swap_b32 v248, v8
    v_mfma_f32_16x16x32_bf16 v[56:59], v[160:163], v[188:191], v[56:59]
    ds_read_b128 v[244:247], v2 offset:17408
    v_permlane16_swap_b32 v249, v9
    v_mfma_f32_16x16x32_bf16 v[60:63], v[164:167], v[188:191], v[60:63]
    v_permlane16_swap_b32 v250, v12
    v_mfma_f32_16x16x32_bf16 v[64:67], v[160:163], v[192:195], v[64:67]
    v_permlane16_swap_b32 v251, v13
    v_mfma_f32_16x16x32_bf16 v[68:71], v[164:167], v[192:195], v[68:71]
    v_add_f32 v248, v248, v8
    v_mfma_f32_16x16x32_bf16 v[72:75], v[160:163], v[196:199], v[72:75]
    v_add_f32 v249, v249, v9
    v_mfma_f32_16x16x32_bf16 v[76:79], v[164:167], v[196:199], v[76:79]
    v_add_f32 v250, v250, v12
    v_mfma_f32_16x16x32_bf16 v[80:83], v[160:163], v[200:203], v[80:83]
    v_add_f32 v251, v251, v13
    v_mfma_f32_16x16x32_bf16 v[84:87], v[164:167], v[200:203], v[84:87]
    v_mul_f32 v248, 0x3ae38e39, v248
    v_mul_f32 v249, 0x3ae38e39, v249
    s_waitcnt lgkmcnt(0)
    s_barrier
    v_mfma_f32_16x16x32_bf16 v[16:19], v[204:207], v[212:215], v[16:19]
    ds_read2_b32 v[140:141], v253 offset0:32 offset1:48
    ds_read2_b32 v[142:143], v253 offset0:64 offset1:80
    ds_read_b128 v[160:163], v0 offset:36864
    v_mfma_f32_16x16x32_bf16 v[20:23], v[208:211], v[212:215], v[20:23]
    ds_read_b128 v[164:167], v0 offset:38912
    v_mfma_f32_16x16x32_bf16 v[24:27], v[204:207], v[216:219], v[24:27]
    ds_read_b128 v[168:171], v2 offset:36864
    v_mfma_f32_16x16x32_bf16 v[28:31], v[208:211], v[216:219], v[28:31]
    ds_read_b128 v[172:175], v2 offset:37888
    v_mfma_f32_16x16x32_bf16 v[32:35], v[204:207], v[220:223], v[32:35]
    ds_read_b128 v[176:179], v2 offset:38912
    v_mfma_f32_16x16x32_bf16 v[36:39], v[208:211], v[220:223], v[36:39]
    ds_read_b128 v[180:183], v2 offset:39936
    v_mfma_f32_16x16x32_bf16 v[40:43], v[204:207], v[224:227], v[40:43]
    ds_read_b128 v[184:187], v2 offset:40960
    v_mfma_f32_16x16x32_bf16 v[44:47], v[208:211], v[224:227], v[44:47]
    ds_read_b128 v[188:191], v2 offset:41984
    v_mfma_f32_16x16x32_bf16 v[48:51], v[204:207], v[228:231], v[48:51]
    ds_read_b128 v[192:195], v2 offset:43008
    v_mfma_f32_16x16x32_bf16 v[52:55], v[208:211], v[228:231], v[52:55]
    ds_read_b128 v[196:199], v2 offset:44032
    v_mul_f32 v250, 0x3ae38e39, v250
    v_mfma_f32_16x16x32_bf16 v[56:59], v[204:207], v[232:235], v[56:59]
    ds_read_b128 v[200:203], v2 offset:45056
    v_mul_f32 v251, 0x3ae38e39, v251
    v_mfma_f32_16x16x32_bf16 v[60:63], v[208:211], v[232:235], v[60:63]
    v_fma_f32 v249, -v248, v248, v249
    v_mfma_f32_16x16x32_bf16 v[64:67], v[204:207], v[236:239], v[64:67]
    v_fma_f32 v251, -v250, v250, v251
    v_mfma_f32_16x16x32_bf16 v[68:71], v[208:211], v[236:239], v[68:71]
    v_max_f32 v249, 0, v249
    v_mfma_f32_16x16x32_bf16 v[72:75], v[204:207], v[240:243], v[72:75]
    v_max_f32 v251, 0, v251
    v_mfma_f32_16x16x32_bf16 v[76:79], v[208:211], v[240:243], v[76:79]
    v_add_f32 v249, 0x3727c5ac, v249
    v_mfma_f32_16x16x32_bf16 v[80:83], v[204:207], v[244:247], v[80:83]
    v_add_f32 v251, 0x3727c5ac, v251
    v_mfma_f32_16x16x32_bf16 v[84:87], v[208:211], v[244:247], v[84:87]
    v_rsq_f32 v249, v249
    v_rsq_f32 v251, v251
    s_waitcnt lgkmcnt(5)
    v_mfma_f32_16x16x32_bf16 v[16:19], v[160:163], v[168:171], v[16:19]
    ds_read2_b32 v[144:145], v253 offset0:96 offset1:112
    ds_read2_b32 v[146:147], v253 offset0:128 offset1:144
    ds_read_b128 v[204:207], v0 offset:37888
    v_mfma_f32_16x16x32_bf16 v[20:23], v[164:167], v[168:171], v[20:23]
    ds_read_b128 v[208:211], v0 offset:39936
    v_mfma_f32_16x16x32_bf16 v[24:27], v[160:163], v[172:175], v[24:27]
    ds_read_b128 v[212:215], v2 offset:46080
    v_mfma_f32_16x16x32_bf16 v[28:31], v[164:167], v[172:175], v[28:31]
    ds_read_b128 v[216:219], v2 offset:47104
    v_mfma_f32_16x16x32_bf16 v[32:35], v[160:163], v[176:179], v[32:35]
    ds_read_b128 v[220:223], v2 offset:48128
    v_mfma_f32_16x16x32_bf16 v[36:39], v[164:167], v[176:179], v[36:39]
    ds_read_b128 v[224:227], v2 offset:49152
    v_mfma_f32_16x16x32_bf16 v[40:43], v[160:163], v[180:183], v[40:43]
    ds_read_b128 v[228:231], v2 offset:50176
    v_mfma_f32_16x16x32_bf16 v[44:47], v[164:167], v[180:183], v[44:47]
    ds_read_b128 v[232:235], v2 offset:51200
    s_waitcnt lgkmcnt(8)
    v_mfma_f32_16x16x32_bf16 v[48:51], v[160:163], v[184:187], v[48:51]
    ds_read_b128 v[236:239], v2 offset:52224
    v_mfma_f32_16x16x32_bf16 v[52:55], v[164:167], v[184:187], v[52:55]
    ds_read_b128 v[240:243], v2 offset:53248
    s_nop 0
    v_mfma_f32_16x16x32_bf16 v[56:59], v[160:163], v[188:191], v[56:59]
    ds_read_b128 v[244:247], v2 offset:54272
    v_mfma_f32_16x16x32_bf16 v[60:63], v[164:167], v[188:191], v[60:63]
    v_mfma_f32_16x16x32_bf16 v[64:67], v[160:163], v[192:195], v[64:67]
    v_mfma_f32_16x16x32_bf16 v[68:71], v[164:167], v[192:195], v[68:71]
    v_mfma_f32_16x16x32_bf16 v[72:75], v[160:163], v[196:199], v[72:75]
    v_mfma_f32_16x16x32_bf16 v[76:79], v[164:167], v[196:199], v[76:79]
    v_mfma_f32_16x16x32_bf16 v[80:83], v[160:163], v[200:203], v[80:83]
    v_mfma_f32_16x16x32_bf16 v[84:87], v[164:167], v[200:203], v[84:87]
    s_waitcnt lgkmcnt(0)
    s_barrier
    v_mfma_f32_16x16x32_bf16 v[16:19], v[204:207], v[212:215], v[16:19]
    ds_read_b128 v[160:163], v3 offset:0
    v_mfma_f32_16x16x32_bf16 v[20:23], v[208:211], v[212:215], v[20:23]
    ds_read_b128 v[164:167], v3 offset:2048
    v_mfma_f32_16x16x32_bf16 v[24:27], v[204:207], v[216:219], v[24:27]
    ds_read_b128 v[168:171], v1 offset:0
    v_mfma_f32_16x16x32_bf16 v[28:31], v[208:211], v[216:219], v[28:31]
    ds_read_b128 v[172:175], v1 offset:1024
    v_mfma_f32_16x16x32_bf16 v[32:35], v[204:207], v[220:223], v[32:35]
    ds_read_b128 v[176:179], v1 offset:2048
    v_mfma_f32_16x16x32_bf16 v[36:39], v[208:211], v[220:223], v[36:39]
    ds_read_b128 v[180:183], v1 offset:3072
    v_mfma_f32_16x16x32_bf16 v[40:43], v[204:207], v[224:227], v[40:43]
    ds_read_b128 v[184:187], v1 offset:4096
    v_mfma_f32_16x16x32_bf16 v[44:47], v[208:211], v[224:227], v[44:47]
    ds_read_b128 v[188:191], v1 offset:5120
    v_mfma_f32_16x16x32_bf16 v[48:51], v[204:207], v[228:231], v[48:51]
    ds_read_b128 v[192:195], v1 offset:6144
    v_mfma_f32_16x16x32_bf16 v[52:55], v[208:211], v[228:231], v[52:55]
    ds_read_b128 v[196:199], v1 offset:7168
    v_mfma_f32_16x16x32_bf16 v[56:59], v[204:207], v[232:235], v[56:59]
    ds_read_b128 v[200:203], v1 offset:8192
    v_mfma_f32_16x16x32_bf16 v[60:63], v[208:211], v[232:235], v[60:63]
    v_mfma_f32_16x16x32_bf16 v[64:67], v[204:207], v[236:239], v[64:67]
    v_mfma_f32_16x16x32_bf16 v[68:71], v[208:211], v[236:239], v[68:71]
    v_mfma_f32_16x16x32_bf16 v[72:75], v[204:207], v[240:243], v[72:75]
    v_mfma_f32_16x16x32_bf16 v[76:79], v[208:211], v[240:243], v[76:79]
    v_mfma_f32_16x16x32_bf16 v[80:83], v[204:207], v[244:247], v[80:83]
    v_mfma_f32_16x16x32_bf16 v[84:87], v[208:211], v[244:247], v[84:87]
    s_waitcnt lgkmcnt(5)
    v_mfma_f32_16x16x32_bf16 v[16:19], v[160:163], v[168:171], v[16:19]
    ds_write2_b32 v4, v248, v249 offset0:0 offset1:32
    ds_write2_b32 v4, v250, v251 offset0:16 offset1:48
    ds_read_b128 v[204:207], v3 offset:1024
    v_mfma_f32_16x16x32_bf16 v[20:23], v[164:167], v[168:171], v[20:23]
    ds_read_b128 v[208:211], v3 offset:3072
    v_mfma_f32_16x16x32_bf16 v[24:27], v[160:163], v[172:175], v[24:27]
    ds_read_b128 v[212:215], v1 offset:9216
    v_mfma_f32_16x16x32_bf16 v[28:31], v[164:167], v[172:175], v[28:31]
    ds_read_b128 v[216:219], v1 offset:10240
    v_mfma_f32_16x16x32_bf16 v[32:35], v[160:163], v[176:179], v[32:35]
    ds_read_b128 v[220:223], v1 offset:11264
    v_mfma_f32_16x16x32_bf16 v[36:39], v[164:167], v[176:179], v[36:39]
    ds_read_b128 v[224:227], v1 offset:12288
    v_mfma_f32_16x16x32_bf16 v[40:43], v[160:163], v[180:183], v[40:43]
    ds_read_b128 v[228:231], v1 offset:13312
    v_mfma_f32_16x16x32_bf16 v[44:47], v[164:167], v[180:183], v[44:47]
    ds_read_b128 v[232:235], v1 offset:14336
    s_waitcnt lgkmcnt(8)
    v_mfma_f32_16x16x32_bf16 v[48:51], v[160:163], v[184:187], v[48:51]
    ds_read_b128 v[236:239], v1 offset:15360
    v_mfma_f32_16x16x32_bf16 v[52:55], v[164:167], v[184:187], v[52:55]
    ds_read_b128 v[240:243], v1 offset:16384
    v_mfma_f32_16x16x32_bf16 v[56:59], v[160:163], v[188:191], v[56:59]
    ds_read_b128 v[244:247], v1 offset:17408
    v_mfma_f32_16x16x32_bf16 v[60:63], v[164:167], v[188:191], v[60:63]
    v_mfma_f32_16x16x32_bf16 v[64:67], v[160:163], v[192:195], v[64:67]
    v_mfma_f32_16x16x32_bf16 v[68:71], v[164:167], v[192:195], v[68:71]
    v_mfma_f32_16x16x32_bf16 v[72:75], v[160:163], v[196:199], v[72:75]
    v_mfma_f32_16x16x32_bf16 v[76:79], v[164:167], v[196:199], v[76:79]
    v_mfma_f32_16x16x32_bf16 v[80:83], v[160:163], v[200:203], v[80:83]
    v_mfma_f32_16x16x32_bf16 v[84:87], v[164:167], v[200:203], v[84:87]
    s_waitcnt lgkmcnt(0)
    s_barrier
    v_mfma_f32_16x16x32_bf16 v[16:19], v[204:207], v[212:215], v[16:19]
    ds_read_b128 v[88:91], v252 offset:0
    ds_read_b128 v[92:95], v252 offset:64
    ds_read_b128 v[96:99], v252 offset:128
    ds_read_b128 v[100:103], v252 offset:192
    ds_read_b128 v[160:163], v3 offset:36864
    v_mfma_f32_16x16x32_bf16 v[20:23], v[208:211], v[212:215], v[20:23]
    ds_read_b128 v[164:167], v3 offset:38912
    v_mfma_f32_16x16x32_bf16 v[24:27], v[204:207], v[216:219], v[24:27]
    ds_read_b128 v[168:171], v1 offset:36864
    v_mfma_f32_16x16x32_bf16 v[28:31], v[208:211], v[216:219], v[28:31]
    ds_read_b128 v[172:175], v1 offset:37888
    v_mfma_f32_16x16x32_bf16 v[32:35], v[204:207], v[220:223], v[32:35]
    ds_read_b128 v[176:179], v1 offset:38912
    v_mfma_f32_16x16x32_bf16 v[36:39], v[208:211], v[220:223], v[36:39]
    ds_read_b128 v[180:183], v1 offset:39936
    v_mfma_f32_16x16x32_bf16 v[40:43], v[204:207], v[224:227], v[40:43]
    ds_read_b128 v[184:187], v1 offset:40960
    v_mfma_f32_16x16x32_bf16 v[44:47], v[208:211], v[224:227], v[44:47]
    ds_read_b128 v[188:191], v1 offset:41984
    v_mfma_f32_16x16x32_bf16 v[48:51], v[204:207], v[228:231], v[48:51]
    ds_read_b128 v[192:195], v1 offset:43008
    v_mfma_f32_16x16x32_bf16 v[52:55], v[208:211], v[228:231], v[52:55]
    ds_read_b128 v[196:199], v1 offset:44032
    v_mfma_f32_16x16x32_bf16 v[56:59], v[204:207], v[232:235], v[56:59]
    ds_read_b128 v[200:203], v1 offset:45056
    v_mfma_f32_16x16x32_bf16 v[60:63], v[208:211], v[232:235], v[60:63]
    v_mfma_f32_16x16x32_bf16 v[64:67], v[204:207], v[236:239], v[64:67]
    v_mfma_f32_16x16x32_bf16 v[68:71], v[208:211], v[236:239], v[68:71]
    v_mfma_f32_16x16x32_bf16 v[72:75], v[204:207], v[240:243], v[72:75]
    v_mfma_f32_16x16x32_bf16 v[76:79], v[208:211], v[240:243], v[76:79]
    v_mfma_f32_16x16x32_bf16 v[80:83], v[204:207], v[244:247], v[80:83]
    v_mfma_f32_16x16x32_bf16 v[84:87], v[208:211], v[244:247], v[84:87]
    s_waitcnt lgkmcnt(5)
    v_mfma_f32_16x16x32_bf16 v[16:19], v[160:163], v[168:171], v[16:19]
    ds_read_b128 v[204:207], v3 offset:37888
    v_mfma_f32_16x16x32_bf16 v[20:23], v[164:167], v[168:171], v[20:23]
    ds_read_b128 v[208:211], v3 offset:39936
    v_mfma_f32_16x16x32_bf16 v[24:27], v[160:163], v[172:175], v[24:27]
    ds_read_b128 v[212:215], v1 offset:46080
    v_mfma_f32_16x16x32_bf16 v[28:31], v[164:167], v[172:175], v[28:31]
    ds_read_b128 v[216:219], v1 offset:47104
    v_mfma_f32_16x16x32_bf16 v[32:35], v[160:163], v[176:179], v[32:35]
    ds_read_b128 v[220:223], v1 offset:48128
    v_mfma_f32_16x16x32_bf16 v[36:39], v[164:167], v[176:179], v[36:39]
    ds_read_b128 v[224:227], v1 offset:49152
    v_mfma_f32_16x16x32_bf16 v[40:43], v[160:163], v[180:183], v[40:43]
    ds_read_b128 v[228:231], v1 offset:50176
    v_mfma_f32_16x16x32_bf16 v[44:47], v[164:167], v[180:183], v[44:47]
    ds_read_b128 v[232:235], v1 offset:51200
    s_waitcnt lgkmcnt(8)
    v_mfma_f32_16x16x32_bf16 v[48:51], v[160:163], v[184:187], v[48:51]
    ds_read_b128 v[236:239], v1 offset:52224
    v_mfma_f32_16x16x32_bf16 v[52:55], v[164:167], v[184:187], v[52:55]
    ds_read_b128 v[240:243], v1 offset:53248
    v_rcp_f32 v120, v96
    v_mfma_f32_16x16x32_bf16 v[56:59], v[160:163], v[188:191], v[56:59]
    ds_read_b128 v[244:247], v1 offset:54272
    v_mul_f32 v104, s40, v96
    v_mfma_f32_16x16x32_bf16 v[60:63], v[164:167], v[188:191], v[60:63]
    v_mul_f32 v112, v96, v96
    v_mfma_f32_16x16x32_bf16 v[64:67], v[160:163], v[192:195], v[64:67]
    v_rcp_f32 v121, v97
    v_mfma_f32_16x16x32_bf16 v[68:71], v[164:167], v[192:195], v[68:71]
    v_mul_f32 v105, s40, v97
    v_mfma_f32_16x16x32_bf16 v[72:75], v[160:163], v[196:199], v[72:75]
    v_mul_f32 v113, v97, v97
    v_mfma_f32_16x16x32_bf16 v[76:79], v[164:167], v[196:199], v[76:79]
    v_rcp_f32 v122, v98
    v_mfma_f32_16x16x32_bf16 v[80:83], v[160:163], v[200:203], v[80:83]
    v_mul_f32 v106, s40, v98
    v_mfma_f32_16x16x32_bf16 v[84:87], v[164:167], v[200:203], v[84:87]
    v_mul_f32 v114, v98, v98
    v_rcp_f32 v123, v99
    s_waitcnt lgkmcnt(0)
    s_barrier
    v_mfma_f32_16x16x32_bf16 v[16:19], v[204:207], v[212:215], v[16:19]
    ds_read_b128 v[160:163], v0 offset:0
    v_mfma_f32_16x16x32_bf16 v[20:23], v[208:211], v[212:215], v[20:23]
    ds_read_b128 v[164:167], v0 offset:2048
    v_mfma_f32_16x16x32_bf16 v[24:27], v[204:207], v[216:219], v[24:27]
    ds_read_b128 v[168:171], v2 offset:0
    v_mfma_f32_16x16x32_bf16 v[28:31], v[208:211], v[216:219], v[28:31]
    ds_read_b128 v[172:175], v2 offset:1024
    v_mfma_f32_16x16x32_bf16 v[32:35], v[204:207], v[220:223], v[32:35]
    ds_read_b128 v[176:179], v2 offset:2048
    v_mfma_f32_16x16x32_bf16 v[36:39], v[208:211], v[220:223], v[36:39]
    ds_read_b128 v[180:183], v2 offset:3072
    v_mfma_f32_16x16x32_bf16 v[40:43], v[204:207], v[224:227], v[40:43]
    ds_read_b128 v[184:187], v2 offset:4096
    v_mfma_f32_16x16x32_bf16 v[44:47], v[208:211], v[224:227], v[44:47]
    ds_read_b128 v[188:191], v2 offset:5120
    v_mfma_f32_16x16x32_bf16 v[48:51], v[204:207], v[228:231], v[48:51]
    ds_read_b128 v[192:195], v2 offset:6144
    v_mfma_f32_16x16x32_bf16 v[52:55], v[208:211], v[228:231], v[52:55]
    ds_read_b128 v[196:199], v2 offset:7168
    v_mul_f32 v107, s40, v99
    v_mfma_f32_16x16x32_bf16 v[56:59], v[204:207], v[232:235], v[56:59]
    ds_read_b128 v[200:203], v2 offset:8192
    v_mul_f32 v115, v99, v99
    v_mfma_f32_16x16x32_bf16 v[60:63], v[208:211], v[232:235], v[60:63]
    v_rcp_f32 v124, v100
    v_mfma_f32_16x16x32_bf16 v[64:67], v[204:207], v[236:239], v[64:67]
    v_mul_f32 v108, s40, v100
    v_mfma_f32_16x16x32_bf16 v[68:71], v[208:211], v[236:239], v[68:71]
    v_mul_f32 v116, v100, v100
    v_mfma_f32_16x16x32_bf16 v[72:75], v[204:207], v[240:243], v[72:75]
    v_rcp_f32 v125, v101
    v_mfma_f32_16x16x32_bf16 v[76:79], v[208:211], v[240:243], v[76:79]
    v_mul_f32 v109, s40, v101
    v_mfma_f32_16x16x32_bf16 v[80:83], v[204:207], v[244:247], v[80:83]
    v_mul_f32 v117, v101, v101
    v_mfma_f32_16x16x32_bf16 v[84:87], v[208:211], v[244:247], v[84:87]
    v_rcp_f32 v126, v102
    v_mul_f32 v110, s40, v102
    s_waitcnt lgkmcnt(5)
    v_mfma_f32_16x16x32_bf16 v[16:19], v[160:163], v[168:171], v[16:19]
    ds_read_b128 v[204:207], v0 offset:1024
    v_mfma_f32_16x16x32_bf16 v[20:23], v[164:167], v[168:171], v[20:23]
    ds_read_b128 v[208:211], v0 offset:3072
    v_mfma_f32_16x16x32_bf16 v[24:27], v[160:163], v[172:175], v[24:27]
    ds_read_b128 v[212:215], v2 offset:9216
    v_mfma_f32_16x16x32_bf16 v[28:31], v[164:167], v[172:175], v[28:31]
    ds_read_b128 v[216:219], v2 offset:10240
    v_mfma_f32_16x16x32_bf16 v[32:35], v[160:163], v[176:179], v[32:35]
    ds_read_b128 v[220:223], v2 offset:11264
    v_mfma_f32_16x16x32_bf16 v[36:39], v[164:167], v[176:179], v[36:39]
    ds_read_b128 v[224:227], v2 offset:12288
    v_mfma_f32_16x16x32_bf16 v[40:43], v[160:163], v[180:183], v[40:43]
    ds_read_b128 v[228:231], v2 offset:13312
    v_mfma_f32_16x16x32_bf16 v[44:47], v[164:167], v[180:183], v[44:47]
    ds_read_b128 v[232:235], v2 offset:14336
    s_waitcnt lgkmcnt(8)
    v_mfma_f32_16x16x32_bf16 v[48:51], v[160:163], v[184:187], v[48:51]
    ds_read_b128 v[236:239], v2 offset:15360
    v_mfma_f32_16x16x32_bf16 v[52:55], v[164:167], v[184:187], v[52:55]
    ds_read_b128 v[240:243], v2 offset:16384
    v_mul_f32 v118, v102, v102
    v_mfma_f32_16x16x32_bf16 v[56:59], v[160:163], v[188:191], v[56:59]
    ds_read_b128 v[244:247], v2 offset:17408
    v_rcp_f32 v127, v103
    v_mfma_f32_16x16x32_bf16 v[60:63], v[164:167], v[188:191], v[60:63]
    v_mul_f32 v111, s40, v103
    v_mfma_f32_16x16x32_bf16 v[64:67], v[160:163], v[192:195], v[64:67]
    v_mul_f32 v119, v103, v103
    v_mfma_f32_16x16x32_bf16 v[68:71], v[164:167], v[192:195], v[68:71]
    v_mul_f32 v112, s42, v112
    v_mfma_f32_16x16x32_bf16 v[72:75], v[160:163], v[196:199], v[72:75]
    v_mul_f32 v113, s42, v113
    v_mfma_f32_16x16x32_bf16 v[76:79], v[164:167], v[196:199], v[76:79]
    v_mul_f32 v114, s42, v114
    v_mfma_f32_16x16x32_bf16 v[80:83], v[160:163], v[200:203], v[80:83]
    v_mul_f32 v115, s42, v115
    v_mfma_f32_16x16x32_bf16 v[84:87], v[164:167], v[200:203], v[84:87]
    v_mul_f32 v116, s42, v116
    v_mul_f32 v117, s42, v117
    s_waitcnt lgkmcnt(0)
    s_barrier
    v_mfma_f32_16x16x32_bf16 v[16:19], v[204:207], v[212:215], v[16:19]
    ds_read_b128 v[160:163], v0 offset:36864
    v_mfma_f32_16x16x32_bf16 v[20:23], v[208:211], v[212:215], v[20:23]
    ds_read_b128 v[164:167], v0 offset:38912
    v_mfma_f32_16x16x32_bf16 v[24:27], v[204:207], v[216:219], v[24:27]
    ds_read_b128 v[168:171], v2 offset:36864
    v_mfma_f32_16x16x32_bf16 v[28:31], v[208:211], v[216:219], v[28:31]
    ds_read_b128 v[172:175], v2 offset:37888
    v_mfma_f32_16x16x32_bf16 v[32:35], v[204:207], v[220:223], v[32:35]
    ds_read_b128 v[176:179], v2 offset:38912
    v_mfma_f32_16x16x32_bf16 v[36:39], v[208:211], v[220:223], v[36:39]
    ds_read_b128 v[180:183], v2 offset:39936
    v_mfma_f32_16x16x32_bf16 v[40:43], v[204:207], v[224:227], v[40:43]
    ds_read_b128 v[184:187], v2 offset:40960
    v_mfma_f32_16x16x32_bf16 v[44:47], v[208:211], v[224:227], v[44:47]
    ds_read_b128 v[188:191], v2 offset:41984
    v_mfma_f32_16x16x32_bf16 v[48:51], v[204:207], v[228:231], v[48:51]
    ds_read_b128 v[192:195], v2 offset:43008
    v_mfma_f32_16x16x32_bf16 v[52:55], v[208:211], v[228:231], v[52:55]
    ds_read_b128 v[196:199], v2 offset:44032
    v_mul_f32 v118, s42, v118
    v_mfma_f32_16x16x32_bf16 v[56:59], v[204:207], v[232:235], v[56:59]
    ds_read_b128 v[200:203], v2 offset:45056
    v_mul_f32 v119, s42, v119
    v_mfma_f32_16x16x32_bf16 v[60:63], v[208:211], v[232:235], v[60:63]
    v_mul_f32 v112, v112, v104
    v_mfma_f32_16x16x32_bf16 v[64:67], v[204:207], v[236:239], v[64:67]
    v_mul_f32 v113, v113, v105
    v_mfma_f32_16x16x32_bf16 v[68:71], v[208:211], v[236:239], v[68:71]
    v_mul_f32 v114, v114, v106
    v_mfma_f32_16x16x32_bf16 v[72:75], v[204:207], v[240:243], v[72:75]
    v_mul_f32 v115, v115, v107
    v_mfma_f32_16x16x32_bf16 v[76:79], v[208:211], v[240:243], v[76:79]
    v_mul_f32 v116, v116, v108
    v_mfma_f32_16x16x32_bf16 v[80:83], v[204:207], v[244:247], v[80:83]
    v_mul_f32 v117, v117, v109
    v_mfma_f32_16x16x32_bf16 v[84:87], v[208:211], v[244:247], v[84:87]
    v_mul_f32 v118, v118, v110
    v_mul_f32 v119, v119, v111
    s_waitcnt lgkmcnt(5)
    v_mfma_f32_16x16x32_bf16 v[16:19], v[160:163], v[168:171], v[16:19]
    ds_read_b128 v[204:207], v0 offset:37888
    v_mfma_f32_16x16x32_bf16 v[20:23], v[164:167], v[168:171], v[20:23]
    ds_read_b128 v[208:211], v0 offset:39936
    v_mfma_f32_16x16x32_bf16 v[24:27], v[160:163], v[172:175], v[24:27]
    ds_read_b128 v[212:215], v2 offset:46080
    v_mfma_f32_16x16x32_bf16 v[28:31], v[164:167], v[172:175], v[28:31]
    ds_read_b128 v[216:219], v2 offset:47104
    v_mfma_f32_16x16x32_bf16 v[32:35], v[160:163], v[176:179], v[32:35]
    ds_read_b128 v[220:223], v2 offset:48128
    v_mfma_f32_16x16x32_bf16 v[36:39], v[164:167], v[176:179], v[36:39]
    ds_read_b128 v[224:227], v2 offset:49152
    v_mfma_f32_16x16x32_bf16 v[40:43], v[160:163], v[180:183], v[40:43]
    ds_read_b128 v[228:231], v2 offset:50176
    v_mfma_f32_16x16x32_bf16 v[44:47], v[164:167], v[180:183], v[44:47]
    ds_read_b128 v[232:235], v2 offset:51200
    s_waitcnt lgkmcnt(8)
    v_mfma_f32_16x16x32_bf16 v[48:51], v[160:163], v[184:187], v[48:51]
    ds_read_b128 v[236:239], v2 offset:52224
    v_mfma_f32_16x16x32_bf16 v[52:55], v[164:167], v[184:187], v[52:55]
    ds_read_b128 v[240:243], v2 offset:53248
    v_add_f32 v128, v128, v138
    v_mfma_f32_16x16x32_bf16 v[56:59], v[160:163], v[188:191], v[56:59]
    ds_read_b128 v[244:247], v2 offset:54272
    v_add_f32 v129, v129, v139
    v_mfma_f32_16x16x32_bf16 v[60:63], v[164:167], v[188:191], v[60:63]
    v_add_f32 v130, v130, v140
    v_mfma_f32_16x16x32_bf16 v[64:67], v[160:163], v[192:195], v[64:67]
    v_add_f32 v131, v131, v141
    v_mfma_f32_16x16x32_bf16 v[68:71], v[164:167], v[192:195], v[68:71]
    v_add_f32 v132, v132, v142
    v_mfma_f32_16x16x32_bf16 v[72:75], v[160:163], v[196:199], v[72:75]
    v_add_f32 v133, v133, v143
    v_mfma_f32_16x16x32_bf16 v[76:79], v[164:167], v[196:199], v[76:79]
    v_add_f32 v134, v134, v144
    v_mfma_f32_16x16x32_bf16 v[80:83], v[160:163], v[200:203], v[80:83]
    v_add_f32 v135, v135, v145
    v_mfma_f32_16x16x32_bf16 v[84:87], v[164:167], v[200:203], v[84:87]
    v_add_f32 v136, v136, v146
    v_lshrrev_b32 v8, 2, v6
    s_waitcnt lgkmcnt(0)
    s_barrier
    v_mfma_f32_16x16x32_bf16 v[16:19], v[204:207], v[212:215], v[16:19]
    ds_read_b128 v[160:163], v3 offset:0
    v_mfma_f32_16x16x32_bf16 v[20:23], v[208:211], v[212:215], v[20:23]
    ds_read_b128 v[164:167], v3 offset:2048
    v_mfma_f32_16x16x32_bf16 v[24:27], v[204:207], v[216:219], v[24:27]
    ds_read_b128 v[168:171], v1 offset:0
    v_mfma_f32_16x16x32_bf16 v[28:31], v[208:211], v[216:219], v[28:31]
    ds_read_b128 v[172:175], v1 offset:1024
    v_mfma_f32_16x16x32_bf16 v[32:35], v[204:207], v[220:223], v[32:35]
    ds_read_b128 v[176:179], v1 offset:2048
    v_mfma_f32_16x16x32_bf16 v[36:39], v[208:211], v[220:223], v[36:39]
    ds_read_b128 v[180:183], v1 offset:3072
    v_mfma_f32_16x16x32_bf16 v[40:43], v[204:207], v[224:227], v[40:43]
    ds_read_b128 v[184:187], v1 offset:4096
    v_mfma_f32_16x16x32_bf16 v[44:47], v[208:211], v[224:227], v[44:47]
    ds_read_b128 v[188:191], v1 offset:5120
    v_mfma_f32_16x16x32_bf16 v[48:51], v[204:207], v[228:231], v[48:51]
    ds_read_b128 v[192:195], v1 offset:6144
    v_mfma_f32_16x16x32_bf16 v[52:55], v[208:211], v[228:231], v[52:55]
    ds_read_b128 v[196:199], v1 offset:7168
    v_lshlrev_b32 v8, 4, v8
    v_mfma_f32_16x16x32_bf16 v[56:59], v[204:207], v[232:235], v[56:59]
    ds_read_b128 v[200:203], v1 offset:8192
    v_lshl_add_u32 v8, v5, 6, v8
    v_mfma_f32_16x16x32_bf16 v[60:63], v[208:211], v[232:235], v[60:63]
    v_and_b32 v9, 3, v6
    v_mfma_f32_16x16x32_bf16 v[64:67], v[204:207], v[236:239], v[64:67]
    v_cmp_eq_u32 vcc, 0, v9
    v_mfma_f32_16x16x32_bf16 v[68:71], v[208:211], v[236:239], v[68:71]
    v_bfrev_b32 v10, 1
    v_mfma_f32_16x16x32_bf16 v[72:75], v[204:207], v[240:243], v[72:75]
    v_lshlrev_b32 v9, 4, v9
    v_mfma_f32_16x16x32_bf16 v[76:79], v[208:211], v[240:243], v[76:79]
    v_cndmask_b32 v8, v10, v8, vcc
    v_mfma_f32_16x16x32_bf16 v[80:83], v[204:207], v[244:247], v[80:83]
    v_lshl_add_u32 v9, v5, 6, v9
    v_mfma_f32_16x16x32_bf16 v[84:87], v[208:211], v[244:247], v[84:87]
    v_lshrrev_b32 v255, 2, v6
    v_lshl_add_u32 v255, v255, 8, v9
    s_waitcnt lgkmcnt(5)
    v_mfma_f32_16x16x32_bf16 v[16:19], v[160:163], v[168:171], v[16:19]
    ds_read_b128 v[204:207], v3 offset:1024
    v_mfma_f32_16x16x32_bf16 v[20:23], v[164:167], v[168:171], v[20:23]
    ds_read_b128 v[208:211], v3 offset:3072
    v_mfma_f32_16x16x32_bf16 v[24:27], v[160:163], v[172:175], v[24:27]
    ds_read_b128 v[212:215], v1 offset:9216
    v_mfma_f32_16x16x32_bf16 v[28:31], v[164:167], v[172:175], v[28:31]
    ds_read_b128 v[216:219], v1 offset:10240
    v_mfma_f32_16x16x32_bf16 v[32:35], v[160:163], v[176:179], v[32:35]
    ds_read_b128 v[220:223], v1 offset:11264
    v_mfma_f32_16x16x32_bf16 v[36:39], v[164:167], v[176:179], v[36:39]
    ds_read_b128 v[224:227], v1 offset:12288
    v_mfma_f32_16x16x32_bf16 v[40:43], v[160:163], v[180:183], v[40:43]
    ds_read_b128 v[228:231], v1 offset:13312
    v_mfma_f32_16x16x32_bf16 v[44:47], v[164:167], v[180:183], v[44:47]
    ds_read_b128 v[232:235], v1 offset:14336
    s_waitcnt lgkmcnt(8)
    v_mfma_f32_16x16x32_bf16 v[48:51], v[160:163], v[184:187], v[48:51]
    ds_read_b128 v[236:239], v1 offset:15360
    v_mfma_f32_16x16x32_bf16 v[52:55], v[164:167], v[184:187], v[52:55]
    ds_read_b128 v[240:243], v1 offset:16384
    v_mfma_f32_16x16x32_bf16 v[56:59], v[160:163], v[188:191], v[56:59]
    ds_read_b128 v[244:247], v1 offset:17408
    v_mfma_f32_16x16x32_bf16 v[60:63], v[164:167], v[188:191], v[60:63]
    v_mfma_f32_16x16x32_bf16 v[64:67], v[160:163], v[192:195], v[64:67]
    v_mfma_f32_16x16x32_bf16 v[68:71], v[164:167], v[192:195], v[68:71]
    v_mfma_f32_16x16x32_bf16 v[72:75], v[160:163], v[196:199], v[72:75]
    v_mfma_f32_16x16x32_bf16 v[76:79], v[164:167], v[196:199], v[76:79]
    v_mfma_f32_16x16x32_bf16 v[80:83], v[160:163], v[200:203], v[80:83]
    v_mfma_f32_16x16x32_bf16 v[84:87], v[164:167], v[200:203], v[84:87]
    s_waitcnt lgkmcnt(0)
    s_barrier
    v_mfma_f32_16x16x32_bf16 v[16:19], v[204:207], v[212:215], v[16:19]
    ds_read_b128 v[160:163], v3 offset:36864
    v_mfma_f32_16x16x32_bf16 v[20:23], v[208:211], v[212:215], v[20:23]
    ds_read_b128 v[164:167], v3 offset:38912
    v_mfma_f32_16x16x32_bf16 v[24:27], v[204:207], v[216:219], v[24:27]
    ds_read_b128 v[168:171], v1 offset:36864
    v_mfma_f32_16x16x32_bf16 v[28:31], v[208:211], v[216:219], v[28:31]
    ds_read_b128 v[172:175], v1 offset:37888
    v_mfma_f32_16x16x32_bf16 v[32:35], v[204:207], v[220:223], v[32:35]
    ds_read_b128 v[176:179], v1 offset:38912
    v_mfma_f32_16x16x32_bf16 v[36:39], v[208:211], v[220:223], v[36:39]
    ds_read_b128 v[180:183], v1 offset:39936
    v_mfma_f32_16x16x32_bf16 v[40:43], v[204:207], v[224:227], v[40:43]
    ds_read_b128 v[184:187], v1 offset:40960
    v_mfma_f32_16x16x32_bf16 v[44:47], v[208:211], v[224:227], v[44:47]
    ds_read_b128 v[188:191], v1 offset:41984
    v_mfma_f32_16x16x32_bf16 v[48:51], v[204:207], v[228:231], v[48:51]
    ds_read_b128 v[192:195], v1 offset:43008
    v_mfma_f32_16x16x32_bf16 v[52:55], v[208:211], v[228:231], v[52:55]
    ds_read_b128 v[196:199], v1 offset:44032
    v_mfma_f32_16x16x32_bf16 v[56:59], v[204:207], v[232:235], v[56:59]
    ds_read_b128 v[200:203], v1 offset:45056
    v_mfma_f32_16x16x32_bf16 v[60:63], v[208:211], v[232:235], v[60:63]
    v_mfma_f32_16x16x32_bf16 v[64:67], v[204:207], v[236:239], v[64:67]
    v_mfma_f32_16x16x32_bf16 v[68:71], v[208:211], v[236:239], v[68:71]
    v_mfma_f32_16x16x32_bf16 v[72:75], v[204:207], v[240:243], v[72:75]
    v_mfma_f32_16x16x32_bf16 v[76:79], v[208:211], v[240:243], v[76:79]
    v_mfma_f32_16x16x32_bf16 v[80:83], v[204:207], v[244:247], v[80:83]
    v_mfma_f32_16x16x32_bf16 v[84:87], v[208:211], v[244:247], v[84:87]
    v_pk_fma_f32 v[16:17], v[88:89], v[128:129], v[16:17] op_sel:[0,0,0] op_sel_hi:[1,0,1] neg_lo:[1,0,0] neg_hi:[1,0,0]
    v_pk_fma_f32 v[18:19], v[90:91], v[128:129], v[18:19] op_sel:[0,0,0] op_sel_hi:[1,0,1] neg_lo:[1,0,0] neg_hi:[1,0,0]
    v_pk_fma_f32 v[20:21], v[92:93], v[128:129], v[20:21] op_sel:[0,0,0] op_sel_hi:[1,0,1] neg_lo:[1,0,0] neg_hi:[1,0,0]
    v_pk_fma_f32 v[22:23], v[94:95], v[128:129], v[22:23] op_sel:[0,0,0] op_sel_hi:[1,0,1] neg_lo:[1,0,0] neg_hi:[1,0,0]
    v_pk_mul_f32 v[220:221], v[16:17], v[16:17]
    v_pk_mul_f32 v[222:223], v[18:19], v[18:19]
    v_pk_mul_f32 v[224:225], v[20:21], v[20:21]
    v_pk_mul_f32 v[226:227], v[22:23], v[22:23]
    v_pk_fma_f32 v[220:221], v[220:221], v[112:113], v[104:105]
    v_pk_fma_f32 v[222:223], v[222:223], v[114:115], v[106:107]
    v_pk_fma_f32 v[224:225], v[224:225], v[116:117], v[108:109]
    v_pk_fma_f32 v[226:227], v[226:227], v[118:119], v[110:111]
    v_pk_mul_f32 v[220:221], v[220:221], v[16:17]
    v_pk_mul_f32 v[222:223], v[222:223], v[18:19]
    v_pk_mul_f32 v[224:225], v[224:225], v[20:21]
    v_pk_mul_f32 v[226:227], v[226:227], v[22:23]
    v_exp_f32 v220, v220
    v_exp_f32 v221, v221
    v_exp_f32 v222, v222
    v_exp_f32 v223, v223
    v_exp_f32 v224, v224
    v_exp_f32 v225, v225
    v_exp_f32 v226, v226
    v_exp_f32 v227, v227
    v_pk_fma_f32 v[220:221], v[220:221], v[120:121], v[120:121]
    v_pk_fma_f32 v[222:223], v[222:223], v[122:123], v[122:123]
    v_pk_fma_f32 v[224:225], v[224:225], v[124:125], v[124:125]
    v_pk_fma_f32 v[226:227], v[226:227], v[126:127], v[126:127]
    v_rcp_f32 v220, v220
    v_rcp_f32 v221, v221
    v_rcp_f32 v222, v222
    v_rcp_f32 v223, v223
    v_rcp_f32 v224, v224
    v_rcp_f32 v225, v225
    v_rcp_f32 v226, v226
    v_rcp_f32 v227, v227
    v_pk_mul_f32 v[16:17], v[16:17], v[220:221]
    v_pk_mul_f32 v[18:19], v[18:19], v[222:223]
    v_pk_mul_f32 v[20:21], v[20:21], v[224:225]
    v_pk_mul_f32 v[22:23], v[22:23], v[226:227]
    v_pk_mul_f32 v[206:207], v[16:17], v[16:17]
    v_pk_mul_f32 v[210:211], v[18:19], v[18:19]
    v_pk_mul_f32 v[214:215], v[20:21], v[20:21]
    v_pk_mul_f32 v[218:219], v[22:23], v[22:23]
    v_pk_fma_f32 v[24:25], v[88:89], v[128:129], v[24:25] op_sel:[0,1,0] op_sel_hi:[1,1,1] neg_lo:[1,0,0] neg_hi:[1,0,0]
    v_pk_fma_f32 v[26:27], v[90:91], v[128:129], v[26:27] op_sel:[0,1,0] op_sel_hi:[1,1,1] neg_lo:[1,0,0] neg_hi:[1,0,0]
    v_pk_fma_f32 v[28:29], v[92:93], v[128:129], v[28:29] op_sel:[0,1,0] op_sel_hi:[1,1,1] neg_lo:[1,0,0] neg_hi:[1,0,0]
    v_pk_fma_f32 v[30:31], v[94:95], v[128:129], v[30:31] op_sel:[0,1,0] op_sel_hi:[1,1,1] neg_lo:[1,0,0] neg_hi:[1,0,0]
    v_pk_mul_f32 v[228:229], v[24:25], v[24:25]
    v_pk_mul_f32 v[230:231], v[26:27], v[26:27]
    v_pk_mul_f32 v[232:233], v[28:29], v[28:29]
    v_pk_mul_f32 v[234:235], v[30:31], v[30:31]
    v_pk_fma_f32 v[228:229], v[228:229], v[112:113], v[104:105]
    v_pk_fma_f32 v[230:231], v[230:231], v[114:115], v[106:107]
    v_pk_fma_f32 v[232:233], v[232:233], v[116:117], v[108:109]
    v_pk_fma_f32 v[234:235], v[234:235], v[118:119], v[110:111]
    v_pk_mul_f32 v[228:229], v[228:229], v[24:25]
    v_pk_mul_f32 v[230:231], v[230:231], v[26:27]
    v_pk_mul_f32 v[232:233], v[232:233], v[28:29]
    v_pk_mul_f32 v[234:235], v[234:235], v[30:31]
    v_exp_f32 v228, v228
    v_exp_f32 v229, v229
    v_exp_f32 v230, v230
    v_exp_f32 v231, v231
    v_exp_f32 v232, v232
    v_exp_f32 v233, v233
    v_exp_f32 v234, v234
    v_exp_f32 v235, v235
    v_pk_fma_f32 v[228:229], v[228:229], v[120:121], v[120:121]
    v_pk_fma_f32 v[230:231], v[230:231], v[122:123], v[122:123]
    v_pk_fma_f32 v[232:233], v[232:233], v[124:125], v[124:125]
    v_pk_fma_f32 v[234:235], v[234:235], v[126:127], v[126:127]
    v_rcp_f32 v228, v228
    v_rcp_f32 v229, v229
    v_rcp_f32 v230, v230
    v_rcp_f32 v231, v231
    v_rcp_f32 v232, v232
    v_rcp_f32 v233, v233
    v_rcp_f32 v234, v234
    v_rcp_f32 v235, v235
    v_pk_mul_f32 v[24:25], v[24:25], v[228:229]
    v_pk_mul_f32 v[26:27], v[26:27], v[230:231]
    v_pk_mul_f32 v[28:29], v[28:29], v[232:233]
    v_pk_mul_f32 v[30:31], v[30:31], v[234:235]
    v_pk_add_f32 v[204:205], v[16:17], v[24:25]
    v_pk_fma_f32 v[206:207], v[24:25], v[24:25], v[206:207]
    v_pk_add_f32 v[208:209], v[18:19], v[26:27]
    v_pk_fma_f32 v[210:211], v[26:27], v[26:27], v[210:211]
    v_pk_add_f32 v[212:213], v[20:21], v[28:29]
    v_pk_fma_f32 v[214:215], v[28:29], v[28:29], v[214:215]
    v_pk_add_f32 v[216:217], v[22:23], v[30:31]
    v_pk_fma_f32 v[218:219], v[30:31], v[30:31], v[218:219]
    v_pk_fma_f32 v[32:33], v[88:89], v[130:131], v[32:33] op_sel:[0,0,0] op_sel_hi:[1,0,1] neg_lo:[1,0,0] neg_hi:[1,0,0]
    v_pk_fma_f32 v[34:35], v[90:91], v[130:131], v[34:35] op_sel:[0,0,0] op_sel_hi:[1,0,1] neg_lo:[1,0,0] neg_hi:[1,0,0]
    v_pk_fma_f32 v[36:37], v[92:93], v[130:131], v[36:37] op_sel:[0,0,0] op_sel_hi:[1,0,1] neg_lo:[1,0,0] neg_hi:[1,0,0]
    v_pk_fma_f32 v[38:39], v[94:95], v[130:131], v[38:39] op_sel:[0,0,0] op_sel_hi:[1,0,1] neg_lo:[1,0,0] neg_hi:[1,0,0]
    v_pk_mul_f32 v[220:221], v[32:33], v[32:33]
    v_pk_mul_f32 v[222:223], v[34:35], v[34:35]
    v_pk_mul_f32 v[224:225], v[36:37], v[36:37]
    v_pk_mul_f32 v[226:227], v[38:39], v[38:39]
    v_pk_fma_f32 v[220:221], v[220:221], v[112:113], v[104:105]
    v_pk_fma_f32 v[222:223], v[222:223], v[114:115], v[106:107]
    v_pk_fma_f32 v[224:225], v[224:225], v[116:117], v[108:109]
    v_pk_fma_f32 v[226:227], v[226:227], v[118:119], v[110:111]
    v_pk_mul_f32 v[220:221], v[220:221], v[32:33]
    v_pk_mul_f32 v[222:223], v[222:223], v[34:35]
    v_pk_mul_f32 v[224:225], v[224:225], v[36:37]
    v_pk_mul_f32 v[226:227], v[226:227], v[38:39]
    v_exp_f32 v220, v220
    v_exp_f32 v221, v221
    v_exp_f32 v222, v222
    v_exp_f32 v223, v223
    v_exp_f32 v224, v224
    v_exp_f32 v225, v225
    v_exp_f32 v226, v226
    v_exp_f32 v227, v227
    v_pk_fma_f32 v[220:221], v[220:221], v[120:121], v[120:121]
    v_pk_fma_f32 v[222:223], v[222:223], v[122:123], v[122:123]
    v_pk_fma_f32 v[224:225], v[224:225], v[124:125], v[124:125]
    v_pk_fma_f32 v[226:227], v[226:227], v[126:127], v[126:127]
    v_rcp_f32 v220, v220
    v_rcp_f32 v221, v221
    v_rcp_f32 v222, v222
    v_rcp_f32 v223, v223
    v_rcp_f32 v224, v224
    v_rcp_f32 v225, v225
    v_rcp_f32 v226, v226
    v_rcp_f32 v227, v227
    v_pk_mul_f32 v[32:33], v[32:33], v[220:221]
    v_pk_mul_f32 v[34:35], v[34:35], v[222:223]
    v_pk_mul_f32 v[36:37], v[36:37], v[224:225]
    v_pk_mul_f32 v[38:39], v[38:39], v[226:227]
    v_pk_add_f32 v[204:205], v[204:205], v[32:33]
    v_pk_fma_f32 v[206:207], v[32:33], v[32:33], v[206:207]
    v_pk_add_f32 v[208:209], v[208:209], v[34:35]
    v_pk_fma_f32 v[210:211], v[34:35], v[34:35], v[210:211]
    v_pk_add_f32 v[212:213], v[212:213], v[36:37]
    v_pk_fma_f32 v[214:215], v[36:37], v[36:37], v[214:215]
    v_pk_add_f32 v[216:217], v[216:217], v[38:39]
    v_pk_fma_f32 v[218:219], v[38:39], v[38:39], v[218:219]
    v_pk_fma_f32 v[40:41], v[88:89], v[130:131], v[40:41] op_sel:[0,1,0] op_sel_hi:[1,1,1] neg_lo:[1,0,0] neg_hi:[1,0,0]
    v_pk_fma_f32 v[42:43], v[90:91], v[130:131], v[42:43] op_sel:[0,1,0] op_sel_hi:[1,1,1] neg_lo:[1,0,0] neg_hi:[1,0,0]
    v_pk_fma_f32 v[44:45], v[92:93], v[130:131], v[44:45] op_sel:[0,1,0] op_sel_hi:[1,1,1] neg_lo:[1,0,0] neg_hi:[1,0,0]
    v_pk_fma_f32 v[46:47], v[94:95], v[130:131], v[46:47] op_sel:[0,1,0] op_sel_hi:[1,1,1] neg_lo:[1,0,0] neg_hi:[1,0,0]
    v_pk_mul_f32 v[228:229], v[40:41], v[40:41]
    v_pk_mul_f32 v[230:231], v[42:43], v[42:43]
    v_pk_mul_f32 v[232:233], v[44:45], v[44:45]
    v_pk_mul_f32 v[234:235], v[46:47], v[46:47]
    v_pk_fma_f32 v[228:229], v[228:229], v[112:113], v[104:105]
    v_pk_fma_f32 v[230:231], v[230:231], v[114:115], v[106:107]
    v_pk_fma_f32 v[232:233], v[232:233], v[116:117], v[108:109]
    v_pk_fma_f32 v[234:235], v[234:235], v[118:119], v[110:111]
    v_pk_mul_f32 v[228:229], v[228:229], v[40:41]
    v_pk_mul_f32 v[230:231], v[230:231], v[42:43]
    v_pk_mul_f32 v[232:233], v[232:233], v[44:45]
    v_pk_mul_f32 v[234:235], v[234:235], v[46:47]
    v_exp_f32 v228, v228
    v_exp_f32 v229, v229
    v_exp_f32 v230, v230
    v_exp_f32 v231, v231
    v_exp_f32 v232, v232
    v_exp_f32 v233, v233
    v_exp_f32 v234, v234
    v_exp_f32 v235, v235
    v_pk_fma_f32 v[228:229], v[228:229], v[120:121], v[120:121]
    v_pk_fma_f32 v[230:231], v[230:231], v[122:123], v[122:123]
    v_pk_fma_f32 v[232:233], v[232:233], v[124:125], v[124:125]
    v_pk_fma_f32 v[234:235], v[234:235], v[126:127], v[126:127]
    v_rcp_f32 v228, v228
    v_rcp_f32 v229, v229
    v_rcp_f32 v230, v230
    v_rcp_f32 v231, v231
    v_rcp_f32 v232, v232
    v_rcp_f32 v233, v233
    v_rcp_f32 v234, v234
    v_rcp_f32 v235, v235
    v_pk_mul_f32 v[40:41], v[40:41], v[228:229]
    v_pk_mul_f32 v[42:43], v[42:43], v[230:231]
    v_pk_mul_f32 v[44:45], v[44:45], v[232:233]
    v_pk_mul_f32 v[46:47], v[46:47], v[234:235]
    v_pk_add_f32 v[204:205], v[204:205], v[40:41]
    v_pk_fma_f32 v[206:207], v[40:41], v[40:41], v[206:207]
    v_pk_add_f32 v[208:209], v[208:209], v[42:43]
    v_pk_fma_f32 v[210:211], v[42:43], v[42:43], v[210:211]
    v_pk_add_f32 v[212:213], v[212:213], v[44:45]
    v_pk_fma_f32 v[214:215], v[44:45], v[44:45], v[214:215]
    v_pk_add_f32 v[216:217], v[216:217], v[46:47]
    v_pk_fma_f32 v[218:219], v[46:47], v[46:47], v[218:219]
    v_pk_fma_f32 v[48:49], v[88:89], v[132:133], v[48:49] op_sel:[0,0,0] op_sel_hi:[1,0,1] neg_lo:[1,0,0] neg_hi:[1,0,0]
    v_pk_fma_f32 v[50:51], v[90:91], v[132:133], v[50:51] op_sel:[0,0,0] op_sel_hi:[1,0,1] neg_lo:[1,0,0] neg_hi:[1,0,0]
    v_pk_fma_f32 v[52:53], v[92:93], v[132:133], v[52:53] op_sel:[0,0,0] op_sel_hi:[1,0,1] neg_lo:[1,0,0] neg_hi:[1,0,0]
    v_pk_fma_f32 v[54:55], v[94:95], v[132:133], v[54:55] op_sel:[0,0,0] op_sel_hi:[1,0,1] neg_lo:[1,0,0] neg_hi:[1,0,0]
    v_pk_mul_f32 v[220:221], v[48:49], v[48:49]
    v_pk_mul_f32 v[222:223], v[50:51], v[50:51]
    v_pk_mul_f32 v[224:225], v[52:53], v[52:53]
    v_pk_mul_f32 v[226:227], v[54:55], v[54:55]
    v_pk_fma_f32 v[220:221], v[220:221], v[112:113], v[104:105]
    v_pk_fma_f32 v[222:223], v[222:223], v[114:115], v[106:107]
    v_pk_fma_f32 v[224:225], v[224:225], v[116:117], v[108:109]
    v_pk_fma_f32 v[226:227], v[226:227], v[118:119], v[110:111]
    v_pk_mul_f32 v[220:221], v[220:221], v[48:49]
    v_pk_mul_f32 v[222:223], v[222:223], v[50:51]
    v_pk_mul_f32 v[224:225], v[224:225], v[52:53]
    v_pk_mul_f32 v[226:227], v[226:227], v[54:55]
    v_exp_f32 v220, v220
    v_exp_f32 v221, v221
    v_exp_f32 v222, v222
    v_exp_f32 v223, v223
    v_exp_f32 v224, v224
    v_exp_f32 v225, v225
    v_exp_f32 v226, v226
    v_exp_f32 v227, v227
    v_pk_fma_f32 v[220:221], v[220:221], v[120:121], v[120:121]
    v_pk_fma_f32 v[222:223], v[222:223], v[122:123], v[122:123]
    v_pk_fma_f32 v[224:225], v[224:225], v[124:125], v[124:125]
    v_pk_fma_f32 v[226:227], v[226:227], v[126:127], v[126:127]
    v_rcp_f32 v220, v220
    v_rcp_f32 v221, v221
    v_rcp_f32 v222, v222
    v_rcp_f32 v223, v223
    v_rcp_f32 v224, v224
    v_rcp_f32 v225, v225
    v_rcp_f32 v226, v226
    v_rcp_f32 v227, v227
    v_pk_mul_f32 v[48:49], v[48:49], v[220:221]
    v_pk_mul_f32 v[50:51], v[50:51], v[222:223]
    v_pk_mul_f32 v[52:53], v[52:53], v[224:225]
    v_pk_mul_f32 v[54:55], v[54:55], v[226:227]
    v_pk_add_f32 v[204:205], v[204:205], v[48:49]
    v_pk_fma_f32 v[206:207], v[48:49], v[48:49], v[206:207]
    v_pk_add_f32 v[208:209], v[208:209], v[50:51]
    v_pk_fma_f32 v[210:211], v[50:51], v[50:51], v[210:211]
    v_pk_add_f32 v[212:213], v[212:213], v[52:53]
    v_pk_fma_f32 v[214:215], v[52:53], v[52:53], v[214:215]
    v_pk_add_f32 v[216:217], v[216:217], v[54:55]
    v_pk_fma_f32 v[218:219], v[54:55], v[54:55], v[218:219]
    v_pk_fma_f32 v[56:57], v[88:89], v[132:133], v[56:57] op_sel:[0,1,0] op_sel_hi:[1,1,1] neg_lo:[1,0,0] neg_hi:[1,0,0]
    v_pk_fma_f32 v[58:59], v[90:91], v[132:133], v[58:59] op_sel:[0,1,0] op_sel_hi:[1,1,1] neg_lo:[1,0,0] neg_hi:[1,0,0]
    v_pk_fma_f32 v[60:61], v[92:93], v[132:133], v[60:61] op_sel:[0,1,0] op_sel_hi:[1,1,1] neg_lo:[1,0,0] neg_hi:[1,0,0]
    v_pk_fma_f32 v[62:63], v[94:95], v[132:133], v[62:63] op_sel:[0,1,0] op_sel_hi:[1,1,1] neg_lo:[1,0,0] neg_hi:[1,0,0]
    v_pk_mul_f32 v[228:229], v[56:57], v[56:57]
    v_pk_mul_f32 v[230:231], v[58:59], v[58:59]
    v_pk_mul_f32 v[232:233], v[60:61], v[60:61]
    v_pk_mul_f32 v[234:235], v[62:63], v[62:63]
    v_pk_fma_f32 v[228:229], v[228:229], v[112:113], v[104:105]
    v_pk_fma_f32 v[230:231], v[230:231], v[114:115], v[106:107]
    v_pk_fma_f32 v[232:233], v[232:233], v[116:117], v[108:109]
    v_pk_fma_f32 v[234:235], v[234:235], v[118:119], v[110:111]
    v_pk_mul_f32 v[228:229], v[228:229], v[56:57]
    v_pk_mul_f32 v[230:231], v[230:231], v[58:59]
    v_pk_mul_f32 v[232:233], v[232:233], v[60:61]
    v_pk_mul_f32 v[234:235], v[234:235], v[62:63]
    v_exp_f32 v228, v228
    v_exp_f32 v229, v229
    v_exp_f32 v230, v230
    v_exp_f32 v231, v231
    v_exp_f32 v232, v232
    v_exp_f32 v233, v233
    v_exp_f32 v234, v234
    v_exp_f32 v235, v235
    v_pk_fma_f32 v[228:229], v[228:229], v[120:121], v[120:121]
    v_pk_fma_f32 v[230:231], v[230:231], v[122:123], v[122:123]
    v_pk_fma_f32 v[232:233], v[232:233], v[124:125], v[124:125]
    v_pk_fma_f32 v[234:235], v[234:235], v[126:127], v[126:127]
    v_rcp_f32 v228, v228
    v_rcp_f32 v229, v229
    v_rcp_f32 v230, v230
    v_rcp_f32 v231, v231
    v_rcp_f32 v232, v232
    v_rcp_f32 v233, v233
    v_rcp_f32 v234, v234
    v_rcp_f32 v235, v235
    v_pk_mul_f32 v[56:57], v[56:57], v[228:229]
    v_pk_mul_f32 v[58:59], v[58:59], v[230:231]
    v_pk_mul_f32 v[60:61], v[60:61], v[232:233]
    v_pk_mul_f32 v[62:63], v[62:63], v[234:235]
    v_pk_add_f32 v[204:205], v[204:205], v[56:57]
    v_pk_fma_f32 v[206:207], v[56:57], v[56:57], v[206:207]
    v_pk_add_f32 v[208:209], v[208:209], v[58:59]
    v_pk_fma_f32 v[210:211], v[58:59], v[58:59], v[210:211]
    v_pk_add_f32 v[212:213], v[212:213], v[60:61]
    v_pk_fma_f32 v[214:215], v[60:61], v[60:61], v[214:215]
    v_pk_add_f32 v[216:217], v[216:217], v[62:63]
    v_pk_fma_f32 v[218:219], v[62:63], v[62:63], v[218:219]
    v_pk_fma_f32 v[64:65], v[88:89], v[134:135], v[64:65] op_sel:[0,0,0] op_sel_hi:[1,0,1] neg_lo:[1,0,0] neg_hi:[1,0,0]
    v_pk_fma_f32 v[66:67], v[90:91], v[134:135], v[66:67] op_sel:[0,0,0] op_sel_hi:[1,0,1] neg_lo:[1,0,0] neg_hi:[1,0,0]
    v_pk_fma_f32 v[68:69], v[92:93], v[134:135], v[68:69] op_sel:[0,0,0] op_sel_hi:[1,0,1] neg_lo:[1,0,0] neg_hi:[1,0,0]
    v_pk_fma_f32 v[70:71], v[94:95], v[134:135], v[70:71] op_sel:[0,0,0] op_sel_hi:[1,0,1] neg_lo:[1,0,0] neg_hi:[1,0,0]
    v_pk_mul_f32 v[220:221], v[64:65], v[64:65]
    v_pk_mul_f32 v[222:223], v[66:67], v[66:67]
    v_pk_mul_f32 v[224:225], v[68:69], v[68:69]
    v_pk_mul_f32 v[226:227], v[70:71], v[70:71]
    v_pk_fma_f32 v[220:221], v[220:221], v[112:113], v[104:105]
    v_pk_fma_f32 v[222:223], v[222:223], v[114:115], v[106:107]
    v_pk_fma_f32 v[224:225], v[224:225], v[116:117], v[108:109]
    v_pk_fma_f32 v[226:227], v[226:227], v[118:119], v[110:111]
    v_pk_mul_f32 v[220:221], v[220:221], v[64:65]
    v_pk_mul_f32 v[222:223], v[222:223], v[66:67]
    v_pk_mul_f32 v[224:225], v[224:225], v[68:69]
    v_pk_mul_f32 v[226:227], v[226:227], v[70:71]
    v_exp_f32 v220, v220
    v_exp_f32 v221, v221
    v_exp_f32 v222, v222
    v_exp_f32 v223, v223
    v_exp_f32 v224, v224
    v_exp_f32 v225, v225
    v_exp_f32 v226, v226
    v_exp_f32 v227, v227
    v_pk_fma_f32 v[220:221], v[220:221], v[120:121], v[120:121]
    v_pk_fma_f32 v[222:223], v[222:223], v[122:123], v[122:123]
    v_pk_fma_f32 v[224:225], v[224:225], v[124:125], v[124:125]
    v_pk_fma_f32 v[226:227], v[226:227], v[126:127], v[126:127]
    v_rcp_f32 v220, v220
    v_rcp_f32 v221, v221
    v_rcp_f32 v222, v222
    v_rcp_f32 v223, v223
    v_rcp_f32 v224, v224
    v_rcp_f32 v225, v225
    v_rcp_f32 v226, v226
    v_rcp_f32 v227, v227
    v_pk_mul_f32 v[64:65], v[64:65], v[220:221]
    v_pk_mul_f32 v[66:67], v[66:67], v[222:223]
    v_pk_mul_f32 v[68:69], v[68:69], v[224:225]
    v_pk_mul_f32 v[70:71], v[70:71], v[226:227]
    v_pk_add_f32 v[204:205], v[204:205], v[64:65]
    v_pk_fma_f32 v[206:207], v[64:65], v[64:65], v[206:207]
    v_pk_add_f32 v[208:209], v[208:209], v[66:67]
    v_pk_fma_f32 v[210:211], v[66:67], v[66:67], v[210:211]
    v_pk_add_f32 v[212:213], v[212:213], v[68:69]
    v_pk_fma_f32 v[214:215], v[68:69], v[68:69], v[214:215]
    v_pk_add_f32 v[216:217], v[216:217], v[70:71]
    v_pk_fma_f32 v[218:219], v[70:71], v[70:71], v[218:219]
    v_pk_fma_f32 v[72:73], v[88:89], v[134:135], v[72:73] op_sel:[0,1,0] op_sel_hi:[1,1,1] neg_lo:[1,0,0] neg_hi:[1,0,0]
    v_pk_fma_f32 v[74:75], v[90:91], v[134:135], v[74:75] op_sel:[0,1,0] op_sel_hi:[1,1,1] neg_lo:[1,0,0] neg_hi:[1,0,0]
    v_pk_fma_f32 v[76:77], v[92:93], v[134:135], v[76:77] op_sel:[0,1,0] op_sel_hi:[1,1,1] neg_lo:[1,0,0] neg_hi:[1,0,0]
    v_pk_fma_f32 v[78:79], v[94:95], v[134:135], v[78:79] op_sel:[0,1,0] op_sel_hi:[1,1,1] neg_lo:[1,0,0] neg_hi:[1,0,0]
    v_pk_mul_f32 v[228:229], v[72:73], v[72:73]
    v_pk_mul_f32 v[230:231], v[74:75], v[74:75]
    v_pk_mul_f32 v[232:233], v[76:77], v[76:77]
    v_pk_mul_f32 v[234:235], v[78:79], v[78:79]
    v_pk_fma_f32 v[228:229], v[228:229], v[112:113], v[104:105]
    v_pk_fma_f32 v[230:231], v[230:231], v[114:115], v[106:107]
    v_pk_fma_f32 v[232:233], v[232:233], v[116:117], v[108:109]
    v_pk_fma_f32 v[234:235], v[234:235], v[118:119], v[110:111]
    v_pk_mul_f32 v[228:229], v[228:229], v[72:73]
    v_pk_mul_f32 v[230:231], v[230:231], v[74:75]
    v_pk_mul_f32 v[232:233], v[232:233], v[76:77]
    v_pk_mul_f32 v[234:235], v[234:235], v[78:79]
    v_exp_f32 v228, v228
    v_exp_f32 v229, v229
    v_exp_f32 v230, v230
    v_exp_f32 v231, v231
    v_exp_f32 v232, v232
    v_exp_f32 v233, v233
    v_exp_f32 v234, v234
    v_exp_f32 v235, v235
    v_pk_fma_f32 v[228:229], v[228:229], v[120:121], v[120:121]
    v_pk_fma_f32 v[230:231], v[230:231], v[122:123], v[122:123]
    v_pk_fma_f32 v[232:233], v[232:233], v[124:125], v[124:125]
    v_pk_fma_f32 v[234:235], v[234:235], v[126:127], v[126:127]
    v_rcp_f32 v228, v228
    v_rcp_f32 v229, v229
    v_rcp_f32 v230, v230
    v_rcp_f32 v231, v231
    v_rcp_f32 v232, v232
    v_rcp_f32 v233, v233
    v_rcp_f32 v234, v234
    v_rcp_f32 v235, v235
    v_pk_mul_f32 v[72:73], v[72:73], v[228:229]
    v_pk_mul_f32 v[74:75], v[74:75], v[230:231]
    v_pk_mul_f32 v[76:77], v[76:77], v[232:233]
    v_pk_mul_f32 v[78:79], v[78:79], v[234:235]
    v_pk_add_f32 v[204:205], v[204:205], v[72:73]
    v_pk_fma_f32 v[206:207], v[72:73], v[72:73], v[206:207]
    v_pk_add_f32 v[208:209], v[208:209], v[74:75]
    v_pk_fma_f32 v[210:211], v[74:75], v[74:75], v[210:211]
    v_pk_add_f32 v[212:213], v[212:213], v[76:77]
    v_pk_fma_f32 v[214:215], v[76:77], v[76:77], v[214:215]
    v_pk_add_f32 v[216:217], v[216:217], v[78:79]
    v_pk_fma_f32 v[218:219], v[78:79], v[78:79], v[218:219]
    v_pk_fma_f32 v[80:81], v[88:89], v[136:137], v[80:81] op_sel:[0,0,0] op_sel_hi:[1,0,1] neg_lo:[1,0,0] neg_hi:[1,0,0]
    v_pk_fma_f32 v[82:83], v[90:91], v[136:137], v[82:83] op_sel:[0,0,0] op_sel_hi:[1,0,1] neg_lo:[1,0,0] neg_hi:[1,0,0]
    v_pk_fma_f32 v[84:85], v[92:93], v[136:137], v[84:85] op_sel:[0,0,0] op_sel_hi:[1,0,1] neg_lo:[1,0,0] neg_hi:[1,0,0]
    v_pk_fma_f32 v[86:87], v[94:95], v[136:137], v[86:87] op_sel:[0,0,0] op_sel_hi:[1,0,1] neg_lo:[1,0,0] neg_hi:[1,0,0]
    v_pk_mul_f32 v[220:221], v[80:81], v[80:81]
    v_pk_mul_f32 v[222:223], v[82:83], v[82:83]
    v_pk_mul_f32 v[224:225], v[84:85], v[84:85]
    v_pk_mul_f32 v[226:227], v[86:87], v[86:87]
    v_pk_fma_f32 v[220:221], v[220:221], v[112:113], v[104:105]
    v_pk_fma_f32 v[222:223], v[222:223], v[114:115], v[106:107]
    v_pk_fma_f32 v[224:225], v[224:225], v[116:117], v[108:109]
    v_pk_fma_f32 v[226:227], v[226:227], v[118:119], v[110:111]
    v_pk_mul_f32 v[220:221], v[220:221], v[80:81]
    v_pk_mul_f32 v[222:223], v[222:223], v[82:83]
    v_pk_mul_f32 v[224:225], v[224:225], v[84:85]
    v_pk_mul_f32 v[226:227], v[226:227], v[86:87]
    v_exp_f32 v220, v220
    v_exp_f32 v221, v221
    v_exp_f32 v222, v222
    v_exp_f32 v223, v223
    v_exp_f32 v224, v224
    v_exp_f32 v225, v225
    v_exp_f32 v226, v226
    v_exp_f32 v227, v227
    v_pk_fma_f32 v[220:221], v[220:221], v[120:121], v[120:121]
    v_pk_fma_f32 v[222:223], v[222:223], v[122:123], v[122:123]
    v_pk_fma_f32 v[224:225], v[224:225], v[124:125], v[124:125]
    v_pk_fma_f32 v[226:227], v[226:227], v[126:127], v[126:127]
    v_rcp_f32 v220, v220
    v_rcp_f32 v221, v221
    v_rcp_f32 v222, v222
    v_rcp_f32 v223, v223
    v_rcp_f32 v224, v224
    v_rcp_f32 v225, v225
    v_rcp_f32 v226, v226
    v_rcp_f32 v227, v227
    v_pk_mul_f32 v[80:81], v[80:81], v[220:221]
    v_pk_mul_f32 v[82:83], v[82:83], v[222:223]
    v_pk_mul_f32 v[84:85], v[84:85], v[224:225]
    v_pk_mul_f32 v[86:87], v[86:87], v[226:227]
    v_pk_add_f32 v[204:205], v[204:205], v[80:81]
    v_pk_fma_f32 v[206:207], v[80:81], v[80:81], v[206:207]
    v_pk_add_f32 v[208:209], v[208:209], v[82:83]
    v_pk_fma_f32 v[210:211], v[82:83], v[82:83], v[210:211]
    v_pk_add_f32 v[212:213], v[212:213], v[84:85]
    v_pk_fma_f32 v[214:215], v[84:85], v[84:85], v[214:215]
    v_pk_add_f32 v[216:217], v[216:217], v[86:87]
    v_pk_fma_f32 v[218:219], v[86:87], v[86:87], v[218:219]
    v_add_f32_dpp v204, v204, v204 row_mirror row_mask:0xf bank_mask:0x3
    v_add_f32_dpp v205, v205, v205 row_mirror row_mask:0xf bank_mask:0x3
    v_add_f32_dpp v206, v206, v206 row_mirror row_mask:0xf bank_mask:0x3
    v_add_f32_dpp v207, v207, v207 row_mirror row_mask:0xf bank_mask:0x3
    v_add_f32_dpp v208, v208, v208 row_mirror row_mask:0xf bank_mask:0x3
    v_add_f32_dpp v209, v209, v209 row_mirror row_mask:0xf bank_mask:0x3
    v_add_f32_dpp v210, v210, v210 row_mirror row_mask:0xf bank_mask:0x3
    v_add_f32_dpp v211, v211, v211 row_mirror row_mask:0xf bank_mask:0x3
    v_add_f32_dpp v204, v212, v212 row_mirror row_mask:0xf bank_mask:0xc
    v_add_f32_dpp v205, v213, v213 row_mirror row_mask:0xf bank_mask:0xc
    v_add_f32_dpp v206, v214, v214 row_mirror row_mask:0xf bank_mask:0xc
    v_add_f32_dpp v207, v215, v215 row_mirror row_mask:0xf bank_mask:0xc
    v_add_f32_dpp v208, v216, v216 row_mirror row_mask:0xf bank_mask:0xc
    v_add_f32_dpp v209, v217, v217 row_mirror row_mask:0xf bank_mask:0xc
    v_add_f32_dpp v210, v218, v218 row_mirror row_mask:0xf bank_mask:0xc
    v_add_f32_dpp v211, v219, v219 row_mirror row_mask:0xf bank_mask:0xc
    v_add_f32_dpp v204, v204, v204 row_half_mirror row_mask:0xf bank_mask:0x5
    v_add_f32_dpp v205, v205, v205 row_half_mirror row_mask:0xf bank_mask:0x5
    v_add_f32_dpp v206, v206, v206 row_half_mirror row_mask:0xf bank_mask:0x5
    v_add_f32_dpp v207, v207, v207 row_half_mirror row_mask:0xf bank_mask:0x5
    v_add_f32_dpp v204, v208, v208 row_half_mirror row_mask:0xf bank_mask:0xa
    v_add_f32_dpp v205, v209, v209 row_half_mirror row_mask:0xf bank_mask:0xa
    v_add_f32_dpp v206, v210, v210 row_half_mirror row_mask:0xf bank_mask:0xa
    v_add_f32_dpp v207, v211, v211 row_half_mirror row_mask:0xf bank_mask:0xa
    v_add_f32_dpp v204, v204, v204 quad_perm:[1,0,3,2] row_mask:0xf bank_mask:0xf
    v_add_f32_dpp v205, v205, v205 quad_perm:[1,0,3,2] row_mask:0xf bank_mask:0xf
    v_add_f32_dpp v206, v206, v206 quad_perm:[1,0,3,2] row_mask:0xf bank_mask:0xf
    v_add_f32_dpp v207, v207, v207 quad_perm:[1,0,3,2] row_mask:0xf bank_mask:0xf
    v_add_f32_dpp v12, v204, v204 quad_perm:[2,3,0,1] row_mask:0xf bank_mask:0xf
    v_add_f32_dpp v14, v205, v205 quad_perm:[2,3,0,1] row_mask:0xf bank_mask:0xf
    v_add_f32_dpp v13, v206, v206 quad_perm:[2,3,0,1] row_mask:0xf bank_mask:0xf
    v_add_f32_dpp v15, v207, v207 quad_perm:[2,3,0,1] row_mask:0xf bank_mask:0xf
    buffer_store_dwordx4 v[12:15], v8, s[4:7], s36 offen sc1
    s_waitcnt lgkmcnt(5)
    v_mfma_f32_16x16x32_bf16 v[88:91], v[168:171], v[160:163], 0
    ds_read_b128 v[204:207], v3 offset:37888
    v_mfma_f32_16x16x32_bf16 v[92:95], v[168:171], v[164:167], 0
    ds_read_b128 v[208:211], v3 offset:39936
    v_mfma_f32_16x16x32_bf16 v[96:99], v[172:175], v[160:163], 0
    ds_read_b128 v[212:215], v1 offset:46080
    v_mfma_f32_16x16x32_bf16 v[100:103], v[172:175], v[164:167], 0
    ds_read_b128 v[216:219], v1 offset:47104
    v_mfma_f32_16x16x32_bf16 v[104:107], v[176:179], v[160:163], 0
    ds_read_b128 v[220:223], v1 offset:48128
    v_mfma_f32_16x16x32_bf16 v[108:111], v[176:179], v[164:167], 0
    ds_read_b128 v[224:227], v1 offset:49152
    v_mfma_f32_16x16x32_bf16 v[112:115], v[180:183], v[160:163], 0
    ds_read_b128 v[228:231], v1 offset:50176
    v_mfma_f32_16x16x32_bf16 v[116:119], v[180:183], v[164:167], 0
    ds_read_b128 v[232:235], v1 offset:51200
    s_waitcnt lgkmcnt(8)
    v_mfma_f32_16x16x32_bf16 v[120:123], v[184:187], v[160:163], 0
    ds_read_b128 v[236:239], v1 offset:52224
    v_mfma_f32_16x16x32_bf16 v[124:127], v[184:187], v[164:167], 0
    ds_read_b128 v[240:243], v1 offset:53248
    v_mfma_f32_16x16x32_bf16 v[128:131], v[188:191], v[160:163], 0
    ds_read_b128 v[244:247], v1 offset:54272
    v_mfma_f32_16x16x32_bf16 v[132:135], v[188:191], v[164:167], 0
    v_mfma_f32_16x16x32_bf16 v[136:139], v[192:195], v[160:163], 0
    v_mfma_f32_16x16x32_bf16 v[140:143], v[192:195], v[164:167], 0
    v_mfma_f32_16x16x32_bf16 v[144:147], v[196:199], v[160:163], 0
    v_mfma_f32_16x16x32_bf16 v[148:151], v[196:199], v[164:167], 0
    v_mfma_f32_16x16x32_bf16 v[152:155], v[200:203], v[160:163], 0
    v_mfma_f32_16x16x32_bf16 v[156:159], v[200:203], v[164:167], 0
    s_waitcnt lgkmcnt(0)
    s_barrier
    v_mfma_f32_16x16x32_bf16 v[88:91], v[212:215], v[204:207], v[88:91]
    ds_read_b128 v[160:163], v0 offset:0
    v_mfma_f32_16x16x32_bf16 v[92:95], v[212:215], v[208:211], v[92:95]
    ds_read_b128 v[164:167], v0 offset:2048
    v_mfma_f32_16x16x32_bf16 v[96:99], v[216:219], v[204:207], v[96:99]
    ds_read_b128 v[168:171], v2 offset:0
    v_mfma_f32_16x16x32_bf16 v[100:103], v[216:219], v[208:211], v[100:103]
    ds_read_b128 v[172:175], v2 offset:1024
    v_mfma_f32_16x16x32_bf16 v[104:107], v[220:223], v[204:207], v[104:107]
    ds_read_b128 v[176:179], v2 offset:2048
    v_mfma_f32_16x16x32_bf16 v[108:111], v[220:223], v[208:211], v[108:111]
    ds_read_b128 v[180:183], v2 offset:3072
    v_mfma_f32_16x16x32_bf16 v[112:115], v[224:227], v[204:207], v[112:115]
    ds_read_b128 v[184:187], v2 offset:4096
    v_mfma_f32_16x16x32_bf16 v[116:119], v[224:227], v[208:211], v[116:119]
    ds_read_b128 v[188:191], v2 offset:5120
    v_mfma_f32_16x16x32_bf16 v[120:123], v[228:231], v[204:207], v[120:123]
    ds_read_b128 v[192:195], v2 offset:6144
    v_mfma_f32_16x16x32_bf16 v[124:127], v[228:231], v[208:211], v[124:127]
    ds_read_b128 v[196:199], v2 offset:7168
    v_mfma_f32_16x16x32_bf16 v[128:131], v[232:235], v[204:207], v[128:131]
    ds_read_b128 v[200:203], v2 offset:8192
    v_mfma_f32_16x16x32_bf16 v[132:135], v[232:235], v[208:211], v[132:135]
    v_mfma_f32_16x16x32_bf16 v[136:139], v[236:239], v[204:207], v[136:139]
    v_mfma_f32_16x16x32_bf16 v[140:143], v[236:239], v[208:211], v[140:143]
    v_mfma_f32_16x16x32_bf16 v[144:147], v[240:243], v[204:207], v[144:147]
    v_mfma_f32_16x16x32_bf16 v[148:151], v[240:243], v[208:211], v[148:151]
    v_mfma_f32_16x16x32_bf16 v[152:155], v[244:247], v[204:207], v[152:155]
    v_mfma_f32_16x16x32_bf16 v[156:159], v[244:247], v[208:211], v[156:159]
    s_waitcnt lgkmcnt(5)
    v_mfma_f32_16x16x32_bf16 v[88:91], v[168:171], v[160:163], v[88:91]
    ds_read_b128 v[204:207], v0 offset:1024
    v_mfma_f32_16x16x32_bf16 v[92:95], v[168:171], v[164:167], v[92:95]
    ds_read_b128 v[208:211], v0 offset:3072
    v_mfma_f32_16x16x32_bf16 v[96:99], v[172:175], v[160:163], v[96:99]
    ds_read_b128 v[212:215], v2 offset:9216
    v_mfma_f32_16x16x32_bf16 v[100:103], v[172:175], v[164:167], v[100:103]
    ds_read_b128 v[216:219], v2 offset:10240
    v_mfma_f32_16x16x32_bf16 v[104:107], v[176:179], v[160:163], v[104:107]
    ds_read_b128 v[220:223], v2 offset:11264
    v_mfma_f32_16x16x32_bf16 v[108:111], v[176:179], v[164:167], v[108:111]
    ds_read_b128 v[224:227], v2 offset:12288
    v_mfma_f32_16x16x32_bf16 v[112:115], v[180:183], v[160:163], v[112:115]
    ds_read_b128 v[228:231], v2 offset:13312
    v_mfma_f32_16x16x32_bf16 v[116:119], v[180:183], v[164:167], v[116:119]
    ds_read_b128 v[232:235], v2 offset:14336
    s_waitcnt lgkmcnt(8)
    v_mfma_f32_16x16x32_bf16 v[120:123], v[184:187], v[160:163], v[120:123]
    ds_read_b128 v[236:239], v2 offset:15360
    v_mfma_f32_16x16x32_bf16 v[124:127], v[184:187], v[164:167], v[124:127]
    ds_read_b128 v[240:243], v2 offset:16384
    v_mfma_f32_16x16x32_bf16 v[128:131], v[188:191], v[160:163], v[128:131]
    ds_read_b128 v[244:247], v2 offset:17408
    v_mfma_f32_16x16x32_bf16 v[132:135], v[188:191], v[164:167], v[132:135]
    v_mfma_f32_16x16x32_bf16 v[136:139], v[192:195], v[160:163], v[136:139]
    v_mfma_f32_16x16x32_bf16 v[140:143], v[192:195], v[164:167], v[140:143]
    v_mfma_f32_16x16x32_bf16 v[144:147], v[196:199], v[160:163], v[144:147]
    v_mfma_f32_16x16x32_bf16 v[148:151], v[196:199], v[164:167], v[148:151]
    v_mfma_f32_16x16x32_bf16 v[152:155], v[200:203], v[160:163], v[152:155]
    v_mfma_f32_16x16x32_bf16 v[156:159], v[200:203], v[164:167], v[156:159]
    s_waitcnt lgkmcnt(0)
    s_barrier
    v_mfma_f32_16x16x32_bf16 v[88:91], v[212:215], v[204:207], v[88:91]
    ds_read_b128 v[160:163], v0 offset:36864
    v_mfma_f32_16x16x32_bf16 v[92:95], v[212:215], v[208:211], v[92:95]
    ds_read_b128 v[164:167], v0 offset:38912
    v_mfma_f32_16x16x32_bf16 v[96:99], v[216:219], v[204:207], v[96:99]
    ds_read_b128 v[168:171], v2 offset:36864
    v_mfma_f32_16x16x32_bf16 v[100:103], v[216:219], v[208:211], v[100:103]
    ds_read_b128 v[172:175], v2 offset:37888
    v_mfma_f32_16x16x32_bf16 v[104:107], v[220:223], v[204:207], v[104:107]
    ds_read_b128 v[176:179], v2 offset:38912
    v_mfma_f32_16x16x32_bf16 v[108:111], v[220:223], v[208:211], v[108:111]
    ds_read_b128 v[180:183], v2 offset:39936
    v_mfma_f32_16x16x32_bf16 v[112:115], v[224:227], v[204:207], v[112:115]
    ds_read_b128 v[184:187], v2 offset:40960
    v_mfma_f32_16x16x32_bf16 v[116:119], v[224:227], v[208:211], v[116:119]
    ds_read_b128 v[188:191], v2 offset:41984
    v_mfma_f32_16x16x32_bf16 v[120:123], v[228:231], v[204:207], v[120:123]
    ds_read_b128 v[192:195], v2 offset:43008
    v_mfma_f32_16x16x32_bf16 v[124:127], v[228:231], v[208:211], v[124:127]
    ds_read_b128 v[196:199], v2 offset:44032
    v_mfma_f32_16x16x32_bf16 v[128:131], v[232:235], v[204:207], v[128:131]
    ds_read_b128 v[200:203], v2 offset:45056
    v_mfma_f32_16x16x32_bf16 v[132:135], v[232:235], v[208:211], v[132:135]
    v_mfma_f32_16x16x32_bf16 v[136:139], v[236:239], v[204:207], v[136:139]
    v_mfma_f32_16x16x32_bf16 v[140:143], v[236:239], v[208:211], v[140:143]
    v_mfma_f32_16x16x32_bf16 v[144:147], v[240:243], v[204:207], v[144:147]
    v_mfma_f32_16x16x32_bf16 v[148:151], v[240:243], v[208:211], v[148:151]
    v_mfma_f32_16x16x32_bf16 v[152:155], v[244:247], v[204:207], v[152:155]
    v_mfma_f32_16x16x32_bf16 v[156:159], v[244:247], v[208:211], v[156:159]
    s_waitcnt lgkmcnt(5)
    v_mfma_f32_16x16x32_bf16 v[88:91], v[168:171], v[160:163], v[88:91]
    ds_read_b128 v[204:207], v0 offset:37888
    v_mfma_f32_16x16x32_bf16 v[92:95], v[168:171], v[164:167], v[92:95]
    ds_read_b128 v[208:211], v0 offset:39936
    v_mfma_f32_16x16x32_bf16 v[96:99], v[172:175], v[160:163], v[96:99]
    ds_read_b128 v[212:215], v2 offset:46080
    v_mfma_f32_16x16x32_bf16 v[100:103], v[172:175], v[164:167], v[100:103]
    ds_read_b128 v[216:219], v2 offset:47104
    v_mfma_f32_16x16x32_bf16 v[104:107], v[176:179], v[160:163], v[104:107]
    ds_read_b128 v[220:223], v2 offset:48128
    v_mfma_f32_16x16x32_bf16 v[108:111], v[176:179], v[164:167], v[108:111]
    ds_read_b128 v[224:227], v2 offset:49152
    v_mfma_f32_16x16x32_bf16 v[112:115], v[180:183], v[160:163], v[112:115]
    ds_read_b128 v[228:231], v2 offset:50176
    v_mfma_f32_16x16x32_bf16 v[116:119], v[180:183], v[164:167], v[116:119]
    ds_read_b128 v[232:235], v2 offset:51200
    s_waitcnt lgkmcnt(8)
    v_mfma_f32_16x16x32_bf16 v[120:123], v[184:187], v[160:163], v[120:123]
    ds_read_b128 v[236:239], v2 offset:52224
    v_mfma_f32_16x16x32_bf16 v[124:127], v[184:187], v[164:167], v[124:127]
    ds_read_b128 v[240:243], v2 offset:53248
    v_mfma_f32_16x16x32_bf16 v[128:131], v[188:191], v[160:163], v[128:131]
    ds_read_b128 v[244:247], v2 offset:54272
    v_mfma_f32_16x16x32_bf16 v[132:135], v[188:191], v[164:167], v[132:135]
    buffer_load_dwordx4 v[4:7], v255, s[4:7], s35 offen offset:0 sc1
    v_mfma_f32_16x16x32_bf16 v[136:139], v[192:195], v[160:163], v[136:139]
    v_mfma_f32_16x16x32_bf16 v[140:143], v[192:195], v[164:167], v[140:143]
    buffer_load_dwordx4 v[8:11], v255, s[4:7], s35 offen offset:1024 sc1
    v_mfma_f32_16x16x32_bf16 v[144:147], v[196:199], v[160:163], v[144:147]
    v_mfma_f32_16x16x32_bf16 v[148:151], v[196:199], v[164:167], v[148:151]
    buffer_load_dwordx4 v[12:15], v255, s[4:7], s35 offen offset:2048 sc1
    v_mfma_f32_16x16x32_bf16 v[152:155], v[200:203], v[160:163], v[152:155]
    v_mfma_f32_16x16x32_bf16 v[156:159], v[200:203], v[164:167], v[156:159]
    buffer_load_dwordx4 v[252:255], v255, s[4:7], s35 offen offset:3072 sc1
    s_waitcnt lgkmcnt(0)
    s_barrier
    v_mfma_f32_16x16x32_bf16 v[88:91], v[212:215], v[204:207], v[88:91]
    ds_read_b128 v[160:163], v3 offset:0
    v_mfma_f32_16x16x32_bf16 v[92:95], v[212:215], v[208:211], v[92:95]
    ds_read_b128 v[164:167], v3 offset:2048
    v_mfma_f32_16x16x32_bf16 v[96:99], v[216:219], v[204:207], v[96:99]
    ds_read_b128 v[168:171], v1 offset:0
    v_mfma_f32_16x16x32_bf16 v[100:103], v[216:219], v[208:211], v[100:103]
    ds_read_b128 v[172:175], v1 offset:1024
    v_mfma_f32_16x16x32_bf16 v[104:107], v[220:223], v[204:207], v[104:107]
    ds_read_b128 v[176:179], v1 offset:2048
    v_mfma_f32_16x16x32_bf16 v[108:111], v[220:223], v[208:211], v[108:111]
    ds_read_b128 v[180:183], v1 offset:3072
    v_mfma_f32_16x16x32_bf16 v[112:115], v[224:227], v[204:207], v[112:115]
    ds_read_b128 v[184:187], v1 offset:4096
    v_mfma_f32_16x16x32_bf16 v[116:119], v[224:227], v[208:211], v[116:119]
    ds_read_b128 v[188:191], v1 offset:5120
    v_mfma_f32_16x16x32_bf16 v[120:123], v[228:231], v[204:207], v[120:123]
    ds_read_b128 v[192:195], v1 offset:6144
    v_mfma_f32_16x16x32_bf16 v[124:127], v[228:231], v[208:211], v[124:127]
    ds_read_b128 v[196:199], v1 offset:7168
    v_mfma_f32_16x16x32_bf16 v[128:131], v[232:235], v[204:207], v[128:131]
    ds_read_b128 v[200:203], v1 offset:8192
    v_mfma_f32_16x16x32_bf16 v[132:135], v[232:235], v[208:211], v[132:135]
    v_mfma_f32_16x16x32_bf16 v[136:139], v[236:239], v[204:207], v[136:139]
    v_mfma_f32_16x16x32_bf16 v[140:143], v[236:239], v[208:211], v[140:143]
    v_mfma_f32_16x16x32_bf16 v[144:147], v[240:243], v[204:207], v[144:147]
    v_mfma_f32_16x16x32_bf16 v[148:151], v[240:243], v[208:211], v[148:151]
    v_mfma_f32_16x16x32_bf16 v[152:155], v[244:247], v[204:207], v[152:155]
    v_mfma_f32_16x16x32_bf16 v[156:159], v[244:247], v[208:211], v[156:159]
    s_waitcnt lgkmcnt(5)
    v_mfma_f32_16x16x32_bf16 v[88:91], v[168:171], v[160:163], v[88:91]
    ds_read_b128 v[204:207], v3 offset:1024
    v_mfma_f32_16x16x32_bf16 v[92:95], v[168:171], v[164:167], v[92:95]
    ds_read_b128 v[208:211], v3 offset:3072
    s_waitcnt vmcnt(0)
    v_mfma_f32_16x16x32_bf16 v[96:99], v[172:175], v[160:163], v[96:99]
    ds_read_b128 v[212:215], v1 offset:9216
    v_or3_b32 v249, v5, v7, v9
    v_mfma_f32_16x16x32_bf16 v[100:103], v[172:175], v[164:167], v[100:103]
    ds_read_b128 v[216:219], v1 offset:10240
    v_or3_b32 v251, v11, v13, v15
    v_mfma_f32_16x16x32_bf16 v[104:107], v[176:179], v[160:163], v[104:107]
    ds_read_b128 v[220:223], v1 offset:11264
    v_or3_b32 v249, v253, v255, v249
    v_mfma_f32_16x16x32_bf16 v[108:111], v[176:179], v[164:167], v[108:111]
    ds_read_b128 v[224:227], v1 offset:12288
    v_or_b32 v249, v249, v251
    v_mfma_f32_16x16x32_bf16 v[112:115], v[180:183], v[160:163], v[112:115]
    ds_read_b128 v[228:231], v1 offset:13312
    v_cmp_gt_i32 vcc, 0, v249
    v_mfma_f32_16x16x32_bf16 v[116:119], v[180:183], v[164:167], v[116:119]
    ds_read_b128 v[232:235], v1 offset:14336
    s_waitcnt lgkmcnt(8)
    v_mfma_f32_16x16x32_bf16 v[120:123], v[184:187], v[160:163], v[120:123]
    ds_read_b128 v[236:239], v1 offset:15360
    s_nop 0
    v_mfma_f32_16x16x32_bf16 v[124:127], v[184:187], v[164:167], v[124:127]
    ds_read_b128 v[240:243], v1 offset:16384
    s_cbranch_vccnz L_g_slow
L_g_back:
    v_mfma_f32_16x16x32_bf16 v[128:131], v[188:191], v[160:163], v[128:131]
    ds_read_b128 v[244:247], v1 offset:17408
    v_add_f32 v4, v4, v8
    v_mfma_f32_16x16x32_bf16 v[132:135], v[188:191], v[164:167], v[132:135]
    v_add_f32 v252, v252, v12
    v_add_f32 v5, v5, v9
    v_mfma_f32_16x16x32_bf16 v[136:139], v[192:195], v[160:163], v[136:139]
    v_add_f32 v253, v253, v13
    v_add_f32 v6, v6, v10
    v_mfma_f32_16x16x32_bf16 v[140:143], v[192:195], v[164:167], v[140:143]
    v_add_f32 v254, v254, v14
    v_add_f32 v7, v7, v11
    v_mfma_f32_16x16x32_bf16 v[144:147], v[196:199], v[160:163], v[144:147]
    v_add_f32 v255, v255, v15
    v_add_f32 v252, v252, v4
    v_mfma_f32_16x16x32_bf16 v[148:151], v[196:199], v[164:167], v[148:151]
    v_add_f32 v253, v253, v5
    v_add_f32 v254, v254, v6
    v_mfma_f32_16x16x32_bf16 v[152:155], v[200:203], v[160:163], v[152:155]
    v_add_f32 v255, v255, v7
    v_add_f32_dpp v252, v252, v252 row_ror:4 row_mask:0xf bank_mask:0xf
    v_mfma_f32_16x16x32_bf16 v[156:159], v[200:203], v[164:167], v[156:159]
    v_add_f32_dpp v253, v253, v253 row_ror:4 row_mask:0xf bank_mask:0xf
    s_waitcnt lgkmcnt(0)
    s_barrier
    v_mfma_f32_16x16x32_bf16 v[88:91], v[212:215], v[204:207], v[88:91]
    ds_read_b128 v[160:163], v3 offset:36864
    v_mfma_f32_16x16x32_bf16 v[92:95], v[212:215], v[208:211], v[92:95]
    ds_read_b128 v[164:167], v3 offset:38912
    v_add_f32_dpp v254, v254, v254 row_ror:4 row_mask:0xf bank_mask:0xf
    v_mfma_f32_16x16x32_bf16 v[96:99], v[216:219], v[204:207], v[96:99]
    ds_read_b128 v[168:171], v1 offset:36864
    v_add_f32_dpp v255, v255, v255 row_ror:4 row_mask:0xf bank_mask:0xf
    v_mfma_f32_16x16x32_bf16 v[100:103], v[216:219], v[208:211], v[100:103]
    ds_read_b128 v[172:175], v1 offset:37888
    v_add_f32_dpp v252, v252, v252 row_ror:8 row_mask:0xf bank_mask:0xf
    v_mfma_f32_16x16x32_bf16 v[104:107], v[220:223], v[204:207], v[104:107]
    ds_read_b128 v[176:179], v1 offset:38912
    v_add_f32_dpp v253, v253, v253 row_ror:8 row_mask:0xf bank_mask:0xf
    v_mfma_f32_16x16x32_bf16 v[108:111], v[220:223], v[208:211], v[108:111]
    ds_read_b128 v[180:183], v1 offset:39936
    v_add_f32_dpp v254, v254, v254 row_ror:8 row_mask:0xf bank_mask:0xf
    v_mfma_f32_16x16x32_bf16 v[112:115], v[224:227], v[204:207], v[112:115]
    ds_read_b128 v[184:187], v1 offset:40960
    v_add_f32_dpp v255, v255, v255 row_ror:8 row_mask:0xf bank_mask:0xf
    v_mfma_f32_16x16x32_bf16 v[116:119], v[224:227], v[208:211], v[116:119]
    ds_read_b128 v[188:191], v1 offset:41984
    v_mfma_f32_16x16x32_bf16 v[120:123], v[228:231], v[204:207], v[120:123]
    ds_read_b128 v[192:195], v1 offset:43008
    v_mul_f32 v252, s44, v252
    v_mfma_f32_16x16x32_bf16 v[124:127], v[228:231], v[208:211], v[124:127]
    ds_read_b128 v[196:199], v1 offset:44032
    v_mul_f32 v253, s44, v253
    v_mfma_f32_16x16x32_bf16 v[128:131], v[232:235], v[204:207], v[128:131]
    ds_read_b128 v[200:203], v1 offset:45056
    v_mul_f32 v254, s44, v254
    v_mfma_f32_16x16x32_bf16 v[132:135], v[232:235], v[208:211], v[132:135]
    v_mul_f32 v255, s44, v255
    v_fma_f32 v253, -v252, v252, v253
    v_mfma_f32_16x16x32_bf16 v[136:139], v[236:239], v[204:207], v[136:139]
    v_fma_f32 v255, -v254, v254, v255
    v_max_f32 v253, 0, v253
    v_mfma_f32_16x16x32_bf16 v[140:143], v[236:239], v[208:211], v[140:143]
    v_max_f32 v255, 0, v255
    v_add_f32 v253, s45, v253
    v_mfma_f32_16x16x32_bf16 v[144:147], v[240:243], v[204:207], v[144:147]
    v_add_f32 v255, s45, v255
    v_rsq_f32 v249, v253
    v_mfma_f32_16x16x32_bf16 v[148:151], v[240:243], v[208:211], v[148:151]
    v_rsq_f32 v253, v255
    s_nop 0
    v_mfma_f32_16x16x32_bf16 v[152:155], v[244:247], v[204:207], v[152:155]
    v_mul_f32 v255, v254, v253
    v_mul_f32 v254, v252, v249
    v_mfma_f32_16x16x32_bf16 v[156:159], v[244:247], v[208:211], v[156:159]
    v_mov_b32 v252, v249
    s_waitcnt lgkmcnt(5)
    v_mfma_f32_16x16x32_bf16 v[88:91], v[168:171], v[160:163], v[88:91]
    ds_read_b128 v[204:207], v3 offset:37888
    v_mfma_f32_16x16x32_bf16 v[92:95], v[168:171], v[164:167], v[92:95]
    ds_read_b128 v[208:211], v3 offset:39936
    s_nop 0
    v_mfma_f32_16x16x32_bf16 v[96:99], v[172:175], v[160:163], v[96:99]
    ds_read_b128 v[212:215], v1 offset:46080
    v_mov_b32_dpp v5, v253 row_newbcast:0 row_mask:0xf bank_mask:0xf
    v_mfma_f32_16x16x32_bf16 v[100:103], v[172:175], v[164:167], v[100:103]
    ds_read_b128 v[216:219], v1 offset:47104
    v_mov_b32_dpp v7, v255 row_newbcast:0 row_mask:0xf bank_mask:0xf
    v_mfma_f32_16x16x32_bf16 v[104:107], v[176:179], v[160:163], v[104:107]
    ds_read_b128 v[220:223], v1 offset:48128
    v_mov_b32_dpp v6, v254 row_newbcast:0 row_mask:0xf bank_mask:0xf
    v_mfma_f32_16x16x32_bf16 v[108:111], v[176:179], v[164:167], v[108:111]
    ds_read_b128 v[224:227], v1 offset:49152
    v_mov_b32_dpp v4, v252 row_newbcast:0 row_mask:0xf bank_mask:0xf
    v_mfma_f32_16x16x32_bf16 v[112:115], v[180:183], v[160:163], v[112:115]
    ds_read_b128 v[228:231], v1 offset:50176
    v_mov_b32_dpp v9, v253 row_newbcast:1 row_mask:0xf bank_mask:0xf
    v_mfma_f32_16x16x32_bf16 v[116:119], v[180:183], v[164:167], v[116:119]
    ds_read_b128 v[232:235], v1 offset:51200
    s_waitcnt lgkmcnt(8)
    v_mfma_f32_16x16x32_bf16 v[120:123], v[184:187], v[160:163], v[120:123]
    ds_read_b128 v[236:239], v1 offset:52224
    v_mov_b32_dpp v11, v255 row_newbcast:1 row_mask:0xf bank_mask:0xf
    v_mfma_f32_16x16x32_bf16 v[124:127], v[184:187], v[164:167], v[124:127]
    ds_read_b128 v[240:243], v1 offset:53248
    v_mov_b32_dpp v10, v254 row_newbcast:1 row_mask:0xf bank_mask:0xf
    v_mfma_f32_16x16x32_bf16 v[128:131], v[188:191], v[160:163], v[128:131]
    ds_read_b128 v[244:247], v1 offset:54272
    v_mov_b32_dpp v8, v252 row_newbcast:1 row_mask:0xf bank_mask:0xf
    v_mfma_f32_16x16x32_bf16 v[132:135], v[188:191], v[164:167], v[132:135]
    v_mov_b32_dpp v13, v253 row_newbcast:2 row_mask:0xf bank_mask:0xf
    v_mov_b32_dpp v15, v255 row_newbcast:2 row_mask:0xf bank_mask:0xf
    v_mfma_f32_16x16x32_bf16 v[136:139], v[192:195], v[160:163], v[136:139]
    v_mov_b32_dpp v14, v254 row_newbcast:2 row_mask:0xf bank_mask:0xf
    v_mov_b32_dpp v12, v252 row_newbcast:2 row_mask:0xf bank_mask:0xf
    v_mfma_f32_16x16x32_bf16 v[140:143], v[192:195], v[164:167], v[140:143]
    v_mov_b32_dpp v253, v253 row_newbcast:3 row_mask:0xf bank_mask:0xf
    v_mov_b32_dpp v255, v255 row_newbcast:3 row_mask:0xf bank_mask:0xf
    v_mfma_f32_16x16x32_bf16 v[144:147], v[196:199], v[160:163], v[144:147]
    v_mov_b32_dpp v254, v254 row_newbcast:3 row_mask:0xf bank_mask:0xf
    v_mov_b32_dpp v252, v252 row_newbcast:3 row_mask:0xf bank_mask:0xf
    v_mfma_f32_16x16x32_bf16 v[148:151], v[196:199], v[164:167], v[148:151]
    v_fma_f32 v16, v16, v4, -v6
    v_fma_f32 v17, v17, v5, -v7
    v_mfma_f32_16x16x32_bf16 v[152:155], v[200:203], v[160:163], v[152:155]
    v_fma_f32 v18, v18, v8, -v10
    v_fma_f32 v19, v19, v9, -v11
    v_mfma_f32_16x16x32_bf16 v[156:159], v[200:203], v[164:167], v[156:159]
    v_fma_f32 v20, v20, v12, -v14
    s_waitcnt lgkmcnt(0)
    s_barrier
    v_mfma_f32_16x16x32_bf16 v[88:91], v[212:215], v[204:207], v[88:91]
    ds_read_b128 v[160:163], v0 offset:0
    v_mfma_f32_16x16x32_bf16 v[92:95], v[212:215], v[208:211], v[92:95]
    ds_read_b128 v[164:167], v0 offset:2048
    v_fma_f32 v21, v21, v13, -v15
    v_mfma_f32_16x16x32_bf16 v[96:99], v[216:219], v[204:207], v[96:99]
    ds_read_b128 v[168:171], v2 offset:0
    v_fma_f32 v22, v22, v252, -v254
    v_mfma_f32_16x16x32_bf16 v[100:103], v[216:219], v[208:211], v[100:103]
    ds_read_b128 v[172:175], v2 offset:1024
    v_fma_f32 v23, v23, v253, -v255
    v_mfma_f32_16x16x32_bf16 v[104:107], v[220:223], v[204:207], v[104:107]
    ds_read_b128 v[176:179], v2 offset:2048
    v_cvt_pk_bf16_f32 v16, v16, v17
    v_mfma_f32_16x16x32_bf16 v[108:111], v[220:223], v[208:211], v[108:111]
    ds_read_b128 v[180:183], v2 offset:3072
    v_cvt_pk_bf16_f32 v17, v18, v19
    v_mfma_f32_16x16x32_bf16 v[112:115], v[224:227], v[204:207], v[112:115]
    ds_read_b128 v[184:187], v2 offset:4096
    v_cvt_pk_bf16_f32 v18, v20, v21
    v_mfma_f32_16x16x32_bf16 v[116:119], v[224:227], v[208:211], v[116:119]
    ds_read_b128 v[188:191], v2 offset:5120
    v_mfma_f32_16x16x32_bf16 v[120:123], v[228:231], v[204:207], v[120:123]
    ds_read_b128 v[192:195], v2 offset:6144
    v_cvt_pk_bf16_f32 v19, v22, v23
    v_mfma_f32_16x16x32_bf16 v[124:127], v[228:231], v[208:211], v[124:127]
    ds_read_b128 v[196:199], v2 offset:7168
    v_fma_f32 v24, v24, v4, -v6
    v_mfma_f32_16x16x32_bf16 v[128:131], v[232:235], v[204:207], v[128:131]
    ds_read_b128 v[200:203], v2 offset:8192
    v_fma_f32 v25, v25, v5, -v7
    v_mfma_f32_16x16x32_bf16 v[132:135], v[232:235], v[208:211], v[132:135]
    v_fma_f32 v26, v26, v8, -v10
    v_fma_f32 v27, v27, v9, -v11
    v_mfma_f32_16x16x32_bf16 v[136:139], v[236:239], v[204:207], v[136:139]
    v_fma_f32 v28, v28, v12, -v14
    v_fma_f32 v29, v29, v13, -v15
    v_mfma_f32_16x16x32_bf16 v[140:143], v[236:239], v[208:211], v[140:143]
    v_fma_f32 v30, v30, v252, -v254
    v_fma_f32 v31, v31, v253, -v255
    v_mfma_f32_16x16x32_bf16 v[144:147], v[240:243], v[204:207], v[144:147]
    v_permlane32_swap_b32 v16, v18
    v_permlane32_swap_b32 v17, v19
    v_mfma_f32_16x16x32_bf16 v[148:151], v[240:243], v[208:211], v[148:151]
    v_cvt_pk_bf16_f32 v24, v24, v25
    v_cvt_pk_bf16_f32 v25, v26, v27
    v_mfma_f32_16x16x32_bf16 v[152:155], v[244:247], v[204:207], v[152:155]
    v_cvt_pk_bf16_f32 v26, v28, v29
    v_cvt_pk_bf16_f32 v27, v30, v31
    v_mfma_f32_16x16x32_bf16 v[156:159], v[244:247], v[208:211], v[156:159]
    v_permlane16_swap_b32 v16, v18
    s_waitcnt lgkmcnt(5)
    v_mfma_f32_16x16x32_bf16 v[88:91], v[168:171], v[160:163], v[88:91]
    ds_read_b128 v[204:207], v0 offset:1024
    v_mfma_f32_16x16x32_bf16 v[92:95], v[168:171], v[164:167], v[92:95]
    ds_read_b128 v[208:211], v0 offset:3072
    v_permlane16_swap_b32 v17, v19
    v_mfma_f32_16x16x32_bf16 v[96:99], v[172:175], v[160:163], v[96:99]
    ds_read_b128 v[212:215], v2 offset:9216
    v_fma_f32 v32, v32, v4, -v6
    v_mfma_f32_16x16x32_bf16 v[100:103], v[172:175], v[164:167], v[100:103]
    ds_read_b128 v[216:219], v2 offset:10240
    v_fma_f32 v33, v33, v5, -v7
    v_mfma_f32_16x16x32_bf16 v[104:107], v[176:179], v[160:163], v[104:107]
    ds_read_b128 v[220:223], v2 offset:11264
    v_fma_f32 v34, v34, v8, -v10
    v_mfma_f32_16x16x32_bf16 v[108:111], v[176:179], v[164:167], v[108:111]
    ds_read_b128 v[224:227], v2 offset:12288
    v_fma_f32 v35, v35, v9, -v11
    v_mfma_f32_16x16x32_bf16 v[112:115], v[180:183], v[160:163], v[112:115]
    ds_read_b128 v[228:231], v2 offset:13312
    v_fma_f32 v36, v36, v12, -v14
    v_mfma_f32_16x16x32_bf16 v[116:119], v[180:183], v[164:167], v[116:119]
    ds_read_b128 v[232:235], v2 offset:14336
    s_waitcnt lgkmcnt(8)
    v_mfma_f32_16x16x32_bf16 v[120:123], v[184:187], v[160:163], v[120:123]
    ds_read_b128 v[236:239], v2 offset:15360
    v_fma_f32 v37, v37, v13, -v15
    v_mfma_f32_16x16x32_bf16 v[124:127], v[184:187], v[164:167], v[124:127]
    ds_read_b128 v[240:243], v2 offset:16384
    v_fma_f32 v38, v38, v252, -v254
    v_mfma_f32_16x16x32_bf16 v[128:131], v[188:191], v[160:163], v[128:131]
    ds_read_b128 v[244:247], v2 offset:17408
    v_fma_f32 v39, v39, v253, -v255
    v_mfma_f32_16x16x32_bf16 v[132:135], v[188:191], v[164:167], v[132:135]
    v_permlane32_swap_b32 v24, v26
    v_permlane32_swap_b32 v25, v27
    v_mfma_f32_16x16x32_bf16 v[136:139], v[192:195], v[160:163], v[136:139]
    v_cvt_pk_bf16_f32 v32, v32, v33
    v_cvt_pk_bf16_f32 v33, v34, v35
    v_mfma_f32_16x16x32_bf16 v[140:143], v[192:195], v[164:167], v[140:143]
    v_cvt_pk_bf16_f32 v34, v36, v37
    v_cvt_pk_bf16_f32 v35, v38, v39
    v_mfma_f32_16x16x32_bf16 v[144:147], v[196:199], v[160:163], v[144:147]
    v_permlane16_swap_b32 v24, v26
    v_permlane16_swap_b32 v25, v27
    v_mfma_f32_16x16x32_bf16 v[148:151], v[196:199], v[164:167], v[148:151]
    v_fma_f32 v40, v40, v4, -v6
    v_fma_f32 v41, v41, v5, -v7
    v_mfma_f32_16x16x32_bf16 v[152:155], v[200:203], v[160:163], v[152:155]
    v_fma_f32 v42, v42, v8, -v10
    v_fma_f32 v43, v43, v9, -v11
    v_mfma_f32_16x16x32_bf16 v[156:159], v[200:203], v[164:167], v[156:159]
    v_fma_f32 v44, v44, v12, -v14
    s_waitcnt lgkmcnt(0)
    s_barrier
    v_mfma_f32_16x16x32_bf16 v[88:91], v[212:215], v[204:207], v[88:91]
    ds_read_b128 v[160:163], v0 offset:36864
    v_mfma_f32_16x16x32_bf16 v[92:95], v[212:215], v[208:211], v[92:95]
    ds_read_b128 v[164:167], v0 offset:38912
    v_fma_f32 v45, v45, v13, -v15
    v_mfma_f32_16x16x32_bf16 v[96:99], v[216:219], v[204:207], v[96:99]
    ds_read_b128 v[168:171], v2 offset:36864
    v_fma_f32 v46, v46, v252, -v254
    v_mfma_f32_16x16x32_bf16 v[100:103], v[216:219], v[208:211], v[100:103]
    ds_read_b128 v[172:175], v2 offset:37888
    v_fma_f32 v47, v47, v253, -v255
    v_mfma_f32_16x16x32_bf16 v[104:107], v[220:223], v[204:207], v[104:107]
    ds_read_b128 v[176:179], v2 offset:38912
    v_permlane32_swap_b32 v32, v34
    v_mfma_f32_16x16x32_bf16 v[108:111], v[220:223], v[208:211], v[108:111]
    ds_read_b128 v[180:183], v2 offset:39936
    v_permlane32_swap_b32 v33, v35
    v_mfma_f32_16x16x32_bf16 v[112:115], v[224:227], v[204:207], v[112:115]
    ds_read_b128 v[184:187], v2 offset:40960
    v_cvt_pk_bf16_f32 v40, v40, v41
    v_mfma_f32_16x16x32_bf16 v[116:119], v[224:227], v[208:211], v[116:119]
    ds_read_b128 v[188:191], v2 offset:41984
    v_mfma_f32_16x16x32_bf16 v[120:123], v[228:231], v[204:207], v[120:123]
    ds_read_b128 v[192:195], v2 offset:43008
    v_cvt_pk_bf16_f32 v41, v42, v43
    v_mfma_f32_16x16x32_bf16 v[124:127], v[228:231], v[208:211], v[124:127]
    ds_read_b128 v[196:199], v2 offset:44032
    v_cvt_pk_bf16_f32 v42, v44, v45
    v_mfma_f32_16x16x32_bf16 v[128:131], v[232:235], v[204:207], v[128:131]
    ds_read_b128 v[200:203], v2 offset:45056
    v_cvt_pk_bf16_f32 v43, v46, v47
    v_mfma_f32_16x16x32_bf16 v[132:135], v[232:235], v[208:211], v[132:135]
    v_permlane16_swap_b32 v32, v34
    v_permlane16_swap_b32 v33, v35
    v_mfma_f32_16x16x32_bf16 v[136:139], v[236:239], v[204:207], v[136:139]
    v_fma_f32 v48, v48, v4, -v6
    v_fma_f32 v49, v49, v5, -v7
    v_mfma_f32_16x16x32_bf16 v[140:143], v[236:239], v[208:211], v[140:143]
    v_fma_f32 v50, v50, v8, -v10
    v_fma_f32 v51, v51, v9, -v11
    v_mfma_f32_16x16x32_bf16 v[144:147], v[240:243], v[204:207], v[144:147]
    v_fma_f32 v52, v52, v12, -v14
    v_fma_f32 v53, v53, v13, -v15
    v_mfma_f32_16x16x32_bf16 v[148:151], v[240:243], v[208:211], v[148:151]
    v_fma_f32 v54, v54, v252, -v254
    v_fma_f32 v55, v55, v253, -v255
    v_mfma_f32_16x16x32_bf16 v[152:155], v[244:247], v[204:207], v[152:155]
    v_permlane32_swap_b32 v40, v42
    v_permlane32_swap_b32 v41, v43
    v_mfma_f32_16x16x32_bf16 v[156:159], v[244:247], v[208:211], v[156:159]
    v_cvt_pk_bf16_f32 v48, v48, v49
    s_waitcnt lgkmcnt(5)
    v_mfma_f32_16x16x32_bf16 v[88:91], v[168:171], v[160:163], v[88:91]
    ds_read_b128 v[204:207], v0 offset:37888
    v_mfma_f32_16x16x32_bf16 v[92:95], v[168:171], v[164:167], v[92:95]
    ds_read_b128 v[208:211], v0 offset:39936
    v_cvt_pk_bf16_f32 v49, v50, v51
    v_mfma_f32_16x16x32_bf16 v[96:99], v[172:175], v[160:163], v[96:99]
    ds_read_b128 v[212:215], v2 offset:46080
    buffer_store_dwordx4 v[16:19], v1, s[4:7], s38 offen offset:0 sc1
    v_cvt_pk_bf16_f32 v50, v52, v53
    v_mfma_f32_16x16x32_bf16 v[100:103], v[172:175], v[164:167], v[100:103]
    ds_read_b128 v[216:219], v2 offset:47104
    v_cvt_pk_bf16_f32 v51, v54, v55
    v_mfma_f32_16x16x32_bf16 v[104:107], v[176:179], v[160:163], v[104:107]
    ds_read_b128 v[220:223], v2 offset:48128
    v_permlane16_swap_b32 v40, v42
    v_mfma_f32_16x16x32_bf16 v[108:111], v[176:179], v[164:167], v[108:111]
    ds_read_b128 v[224:227], v2 offset:49152
    v_permlane16_swap_b32 v41, v43
    v_mfma_f32_16x16x32_bf16 v[112:115], v[180:183], v[160:163], v[112:115]
    ds_read_b128 v[228:231], v2 offset:50176
    v_fma_f32 v56, v56, v4, -v6
    v_mfma_f32_16x16x32_bf16 v[116:119], v[180:183], v[164:167], v[116:119]
    ds_read_b128 v[232:235], v2 offset:51200
    s_waitcnt lgkmcnt(8)
    buffer_store_dwordx4 v[24:27], v1, s[4:7], s38 offen offset:1024 sc1
    v_mfma_f32_16x16x32_bf16 v[120:123], v[184:187], v[160:163], v[120:123]
    ds_read_b128 v[236:239], v2 offset:52224
    v_fma_f32 v57, v57, v5, -v7
    v_mfma_f32_16x16x32_bf16 v[124:127], v[184:187], v[164:167], v[124:127]
    ds_read_b128 v[240:243], v2 offset:53248
    v_fma_f32 v58, v58, v8, -v10
    v_mfma_f32_16x16x32_bf16 v[128:131], v[188:191], v[160:163], v[128:131]
    ds_read_b128 v[244:247], v2 offset:54272
    v_fma_f32 v59, v59, v9, -v11
    v_mfma_f32_16x16x32_bf16 v[132:135], v[188:191], v[164:167], v[132:135]
    v_fma_f32 v60, v60, v12, -v14
    v_fma_f32 v61, v61, v13, -v15
    v_mfma_f32_16x16x32_bf16 v[136:139], v[192:195], v[160:163], v[136:139]
    buffer_store_dwordx4 v[32:35], v1, s[4:7], s38 offen offset:2048 sc1
    v_fma_f32 v62, v62, v252, -v254
    v_fma_f32 v63, v63, v253, -v255
    v_mfma_f32_16x16x32_bf16 v[140:143], v[192:195], v[164:167], v[140:143]
    v_permlane32_swap_b32 v48, v50
    v_permlane32_swap_b32 v49, v51
    v_mfma_f32_16x16x32_bf16 v[144:147], v[196:199], v[160:163], v[144:147]
    v_cvt_pk_bf16_f32 v56, v56, v57
    v_cvt_pk_bf16_f32 v57, v58, v59
    v_mfma_f32_16x16x32_bf16 v[148:151], v[196:199], v[164:167], v[148:151]
    v_cvt_pk_bf16_f32 v58, v60, v61
    v_cvt_pk_bf16_f32 v59, v62, v63
    v_mfma_f32_16x16x32_bf16 v[152:155], v[200:203], v[160:163], v[152:155]
    v_permlane16_swap_b32 v48, v50
    v_permlane16_swap_b32 v49, v51
    v_mfma_f32_16x16x32_bf16 v[156:159], v[200:203], v[164:167], v[156:159]
    v_fma_f32 v64, v64, v4, -v6
    s_waitcnt lgkmcnt(0)
    s_barrier
    v_mfma_f32_16x16x32_bf16 v[88:91], v[212:215], v[204:207], v[88:91]
    ds_read_b128 v[160:163], v3 offset:0
    v_mfma_f32_16x16x32_bf16 v[92:95], v[212:215], v[208:211], v[92:95]
    ds_read_b128 v[164:167], v3 offset:2048
    v_fma_f32 v65, v65, v5, -v7
    v_mfma_f32_16x16x32_bf16 v[96:99], v[216:219], v[204:207], v[96:99]
    ds_read_b128 v[168:171], v1 offset:0
    buffer_store_dwordx4 v[40:43], v1, s[4:7], s38 offen offset:3072 sc1
    v_fma_f32 v66, v66, v8, -v10
    v_mfma_f32_16x16x32_bf16 v[100:103], v[216:219], v[208:211], v[100:103]
    ds_read_b128 v[172:175], v1 offset:1024
    v_fma_f32 v67, v67, v9, -v11
    v_mfma_f32_16x16x32_bf16 v[104:107], v[220:223], v[204:207], v[104:107]
    ds_read_b128 v[176:179], v1 offset:2048
    v_fma_f32 v68, v68, v12, -v14
    v_mfma_f32_16x16x32_bf16 v[108:111], v[220:223], v[208:211], v[108:111]
    ds_read_b128 v[180:183], v1 offset:3072
    v_fma_f32 v69, v69, v13, -v15
    v_mfma_f32_16x16x32_bf16 v[112:115], v[224:227], v[204:207], v[112:115]
    ds_read_b128 v[184:187], v1 offset:4096
    v_fma_f32 v70, v70, v252, -v254
    v_mfma_f32_16x16x32_bf16 v[116:119], v[224:227], v[208:211], v[116:119]
    ds_read_b128 v[188:191], v1 offset:5120
    buffer_store_dwordx4 v[48:51], v1, s[4:7], s39 offen offset:0 sc1
    v_mfma_f32_16x16x32_bf16 v[120:123], v[228:231], v[204:207], v[120:123]
    ds_read_b128 v[192:195], v1 offset:6144
    v_fma_f32 v71, v71, v253, -v255
    v_mfma_f32_16x16x32_bf16 v[124:127], v[228:231], v[208:211], v[124:127]
    ds_read_b128 v[196:199], v1 offset:7168
    v_permlane32_swap_b32 v56, v58
    v_mfma_f32_16x16x32_bf16 v[128:131], v[232:235], v[204:207], v[128:131]
    ds_read_b128 v[200:203], v1 offset:8192
    v_permlane32_swap_b32 v57, v59
    v_mfma_f32_16x16x32_bf16 v[132:135], v[232:235], v[208:211], v[132:135]
    v_cvt_pk_bf16_f32 v64, v64, v65
    v_cvt_pk_bf16_f32 v65, v66, v67
    v_mfma_f32_16x16x32_bf16 v[136:139], v[236:239], v[204:207], v[136:139]
    v_cvt_pk_bf16_f32 v66, v68, v69
    v_cvt_pk_bf16_f32 v67, v70, v71
    v_mfma_f32_16x16x32_bf16 v[140:143], v[236:239], v[208:211], v[140:143]
    v_permlane16_swap_b32 v56, v58
    v_permlane16_swap_b32 v57, v59
    v_mfma_f32_16x16x32_bf16 v[144:147], v[240:243], v[204:207], v[144:147]
    v_fma_f32 v72, v72, v4, -v6
    v_fma_f32 v73, v73, v5, -v7
    v_mfma_f32_16x16x32_bf16 v[148:151], v[240:243], v[208:211], v[148:151]
    v_fma_f32 v74, v74, v8, -v10
    v_fma_f32 v75, v75, v9, -v11
    v_mfma_f32_16x16x32_bf16 v[152:155], v[244:247], v[204:207], v[152:155]
    v_fma_f32 v76, v76, v12, -v14
    v_fma_f32 v77, v77, v13, -v15
    v_mfma_f32_16x16x32_bf16 v[156:159], v[244:247], v[208:211], v[156:159]
    v_fma_f32 v78, v78, v252, -v254
    s_waitcnt lgkmcnt(5)
    v_mfma_f32_16x16x32_bf16 v[88:91], v[168:171], v[160:163], v[88:91]
    ds_read_b128 v[204:207], v3 offset:1024
    v_mfma_f32_16x16x32_bf16 v[92:95], v[168:171], v[164:167], v[92:95]
    ds_read_b128 v[208:211], v3 offset:3072
    v_fma_f32 v79, v79, v253, -v255
    v_mfma_f32_16x16x32_bf16 v[96:99], v[172:175], v[160:163], v[96:99]
    ds_read_b128 v[212:215], v1 offset:9216
    buffer_store_dwordx4 v[56:59], v1, s[4:7], s39 offen offset:1024 sc1
    v_permlane32_swap_b32 v64, v66
    v_mfma_f32_16x16x32_bf16 v[100:103], v[172:175], v[164:167], v[100:103]
    ds_read_b128 v[216:219], v1 offset:10240
    v_permlane32_swap_b32 v65, v67
    v_mfma_f32_16x16x32_bf16 v[104:107], v[176:179], v[160:163], v[104:107]
    ds_read_b128 v[220:223], v1 offset:11264
    v_cvt_pk_bf16_f32 v72, v72, v73
    v_mfma_f32_16x16x32_bf16 v[108:111], v[176:179], v[164:167], v[108:111]
    ds_read_b128 v[224:227], v1 offset:12288
    v_cvt_pk_bf16_f32 v73, v74, v75
    v_mfma_f32_16x16x32_bf16 v[112:115], v[180:183], v[160:163], v[112:115]
    ds_read_b128 v[228:231], v1 offset:13312
    v_cvt_pk_bf16_f32 v74, v76, v77
    v_mfma_f32_16x16x32_bf16 v[116:119], v[180:183], v[164:167], v[116:119]
    ds_read_b128 v[232:235], v1 offset:14336
    s_waitcnt lgkmcnt(8)
    v_mfma_f32_16x16x32_bf16 v[120:123], v[184:187], v[160:163], v[120:123]
    ds_read_b128 v[236:239], v1 offset:15360
    v_cvt_pk_bf16_f32 v75, v78, v79
    v_mfma_f32_16x16x32_bf16 v[124:127], v[184:187], v[164:167], v[124:127]
    ds_read_b128 v[240:243], v1 offset:16384
    v_permlane16_swap_b32 v64, v66
    v_mfma_f32_16x16x32_bf16 v[128:131], v[188:191], v[160:163], v[128:131]
    ds_read_b128 v[244:247], v1 offset:17408
    v_permlane16_swap_b32 v65, v67
    v_mfma_f32_16x16x32_bf16 v[132:135], v[188:191], v[164:167], v[132:135]
    v_fma_f32 v80, v80, v4, -v6
    v_fma_f32 v81, v81, v5, -v7
    v_mfma_f32_16x16x32_bf16 v[136:139], v[192:195], v[160:163], v[136:139]
    v_fma_f32 v82, v82, v8, -v10
    v_fma_f32 v83, v83, v9, -v11
    v_mfma_f32_16x16x32_bf16 v[140:143], v[192:195], v[164:167], v[140:143]
    v_fma_f32 v84, v84, v12, -v14
    v_fma_f32 v85, v85, v13, -v15
    v_mfma_f32_16x16x32_bf16 v[144:147], v[196:199], v[160:163], v[144:147]
    v_fma_f32 v86, v86, v252, -v254
    v_fma_f32 v87, v87, v253, -v255
    v_mfma_f32_16x16x32_bf16 v[148:151], v[196:199], v[164:167], v[148:151]
    v_permlane32_swap_b32 v72, v74
    v_permlane32_swap_b32 v73, v75
    v_mfma_f32_16x16x32_bf16 v[152:155], v[200:203], v[160:163], v[152:155]
    v_cvt_pk_bf16_f32 v80, v80, v81
    v_cvt_pk_bf16_f32 v81, v82, v83
    v_mfma_f32_16x16x32_bf16 v[156:159], v[200:203], v[164:167], v[156:159]
    v_cvt_pk_bf16_f32 v82, v84, v85
    s_waitcnt lgkmcnt(0)
    s_barrier
    v_mfma_f32_16x16x32_bf16 v[88:91], v[212:215], v[204:207], v[88:91]
    ds_read_b128 v[160:163], v3 offset:36864
    v_mfma_f32_16x16x32_bf16 v[92:95], v[212:215], v[208:211], v[92:95]
    ds_read_b128 v[164:167], v3 offset:38912
    v_cvt_pk_bf16_f32 v83, v86, v87
    v_mfma_f32_16x16x32_bf16 v[96:99], v[216:219], v[204:207], v[96:99]
    ds_read_b128 v[168:171], v1 offset:36864
    buffer_store_dwordx4 v[64:67], v1, s[4:7], s39 offen offset:2048 sc1
    v_permlane16_swap_b32 v72, v74
    v_mfma_f32_16x16x32_bf16 v[100:103], v[216:219], v[208:211], v[100:103]
    ds_read_b128 v[172:175], v1 offset:37888
    v_permlane16_swap_b32 v73, v75
    v_mfma_f32_16x16x32_bf16 v[104:107], v[220:223], v[204:207], v[104:107]
    ds_read_b128 v[176:179], v1 offset:38912
    s_nop 0
    v_mfma_f32_16x16x32_bf16 v[108:111], v[220:223], v[208:211], v[108:111]
    ds_read_b128 v[180:183], v1 offset:39936
    v_permlane32_swap_b32 v80, v82
    v_mfma_f32_16x16x32_bf16 v[112:115], v[224:227], v[204:207], v[112:115]
    ds_read_b128 v[184:187], v1 offset:40960
    v_permlane32_swap_b32 v81, v83
    v_mfma_f32_16x16x32_bf16 v[116:119], v[224:227], v[208:211], v[116:119]
    ds_read_b128 v[188:191], v1 offset:41984
    v_mfma_f32_16x16x32_bf16 v[120:123], v[228:231], v[204:207], v[120:123]
    ds_read_b128 v[192:195], v1 offset:43008
    s_nop 0
    v_mfma_f32_16x16x32_bf16 v[124:127], v[228:231], v[208:211], v[124:127]
    ds_read_b128 v[196:199], v1 offset:44032
    v_permlane16_swap_b32 v80, v82
    v_mfma_f32_16x16x32_bf16 v[128:131], v[232:235], v[204:207], v[128:131]
    ds_read_b128 v[200:203], v1 offset:45056
    v_permlane16_swap_b32 v81, v83
    v_mfma_f32_16x16x32_bf16 v[132:135], v[232:235], v[208:211], v[132:135]
    v_mfma_f32_16x16x32_bf16 v[136:139], v[236:239], v[204:207], v[136:139]
    v_mfma_f32_16x16x32_bf16 v[140:143], v[236:239], v[208:211], v[140:143]
    v_mfma_f32_16x16x32_bf16 v[144:147], v[240:243], v[204:207], v[144:147]
    v_mfma_f32_16x16x32_bf16 v[148:151], v[240:243], v[208:211], v[148:151]
    v_mfma_f32_16x16x32_bf16 v[152:155], v[244:247], v[204:207], v[152:155]
    v_mfma_f32_16x16x32_bf16 v[156:159], v[244:247], v[208:211], v[156:159]
    s_waitcnt lgkmcnt(5)
    v_mfma_f32_16x16x32_bf16 v[88:91], v[168:171], v[160:163], v[88:91]
    ds_read_b128 v[204:207], v3 offset:37888
    v_mfma_f32_16x16x32_bf16 v[92:95], v[168:171], v[164:167], v[92:95]
    ds_read_b128 v[208:211], v3 offset:39936
    v_mfma_f32_16x16x32_bf16 v[96:99], v[172:175], v[160:163], v[96:99]
    ds_read_b128 v[212:215], v1 offset:46080
    buffer_store_dwordx4 v[72:75], v1, s[4:7], s39 offen offset:3072 sc1
    v_mfma_f32_16x16x32_bf16 v[100:103], v[172:175], v[164:167], v[100:103]
    ds_read_b128 v[216:219], v1 offset:47104
    v_mfma_f32_16x16x32_bf16 v[104:107], v[176:179], v[160:163], v[104:107]
    ds_read_b128 v[220:223], v1 offset:48128
    v_mfma_f32_16x16x32_bf16 v[108:111], v[176:179], v[164:167], v[108:111]
    ds_read_b128 v[224:227], v1 offset:49152
    v_mfma_f32_16x16x32_bf16 v[112:115], v[180:183], v[160:163], v[112:115]
    ds_read_b128 v[228:231], v1 offset:50176
    v_mfma_f32_16x16x32_bf16 v[116:119], v[180:183], v[164:167], v[116:119]
    ds_read_b128 v[232:235], v1 offset:51200
    s_waitcnt lgkmcnt(8)
    buffer_store_dwordx4 v[80:83], v1, s[4:7], s46 offen offset:0 sc1
    v_mfma_f32_16x16x32_bf16 v[120:123], v[184:187], v[160:163], v[120:123]
    ds_read_b128 v[236:239], v1 offset:52224
    v_mfma_f32_16x16x32_bf16 v[124:127], v[184:187], v[164:167], v[124:127]
    ds_read_b128 v[240:243], v1 offset:53248
    v_mfma_f32_16x16x32_bf16 v[128:131], v[188:191], v[160:163], v[128:131]
    ds_read_b128 v[244:247], v1 offset:54272
    v_mfma_f32_16x16x32_bf16 v[132:135], v[188:191], v[164:167], v[132:135]
    v_mfma_f32_16x16x32_bf16 v[136:139], v[192:195], v[160:163], v[136:139]
    v_lshrrev_b32 v0, 4, v1
    v_mfma_f32_16x16x32_bf16 v[140:143], v[192:195], v[164:167], v[140:143]
    v_and_b32 v0, 48, v0
    v_mfma_f32_16x16x32_bf16 v[144:147], v[196:199], v[160:163], v[144:147]
    v_add_u32 v0, 160320, v0
    v_mfma_f32_16x16x32_bf16 v[148:151], v[196:199], v[164:167], v[148:151]
    v_mfma_f32_16x16x32_bf16 v[152:155], v[200:203], v[160:163], v[152:155]
    v_mfma_f32_16x16x32_bf16 v[156:159], v[200:203], v[164:167], v[156:159]
    s_waitcnt lgkmcnt(0)
    v_mfma_f32_16x16x32_bf16 v[88:91], v[212:215], v[204:207], v[88:91]
    ds_read_b128 v[168:171], v0 offset:0
    v_mfma_f32_16x16x32_bf16 v[92:95], v[212:215], v[208:211], v[92:95]
    ds_read_b128 v[172:175], v0 offset:64
    v_mfma_f32_16x16x32_bf16 v[96:99], v[216:219], v[204:207], v[96:99]
    ds_read_b128 v[176:179], v0 offset:128
    v_mfma_f32_16x16x32_bf16 v[100:103], v[216:219], v[208:211], v[100:103]
    ds_read_b128 v[180:183], v0 offset:192
    v_mfma_f32_16x16x32_bf16 v[104:107], v[220:223], v[204:207], v[104:107]
    ds_read_b128 v[184:187], v0 offset:256
    v_mfma_f32_16x16x32_bf16 v[108:111], v[220:223], v[208:211], v[108:111]
    ds_read_b128 v[188:191], v0 offset:320
    v_mfma_f32_16x16x32_bf16 v[112:115], v[224:227], v[204:207], v[112:115]
    ds_read_b128 v[192:195], v0 offset:384
    v_mfma_f32_16x16x32_bf16 v[116:119], v[224:227], v[208:211], v[116:119]
    ds_read_b128 v[196:199], v0 offset:448
    v_mfma_f32_16x16x32_bf16 v[120:123], v[228:231], v[204:207], v[120:123]
    ds_read_b128 v[200:203], v0 offset:512
    v_mfma_f32_16x16x32_bf16 v[124:127], v[228:231], v[208:211], v[124:127]
    v_mfma_f32_16x16x32_bf16 v[128:131], v[232:235], v[204:207], v[128:131]
    v_mfma_f32_16x16x32_bf16 v[132:135], v[232:235], v[208:211], v[132:135]
    v_mfma_f32_16x16x32_bf16 v[136:139], v[236:239], v[204:207], v[136:139]
    v_mfma_f32_16x16x32_bf16 v[140:143], v[236:239], v[208:211], v[140:143]
    v_mfma_f32_16x16x32_bf16 v[144:147], v[240:243], v[204:207], v[144:147]
    v_mfma_f32_16x16x32_bf16 v[148:151], v[240:243], v[208:211], v[148:151]
    v_mfma_f32_16x16x32_bf16 v[152:155], v[244:247], v[204:207], v[152:155]
    v_mfma_f32_16x16x32_bf16 v[156:159], v[244:247], v[208:211], v[156:159]
    v_bfe_u32 v8, v1, 4, 4
    v_lshl_add_u32 v8, v8, 2, s33
    ds_read2_b32 v[4:5], v8 offset0:32 offset1:48
    ds_read_b128 v[212:215], v0 offset:1152
    ds_read_b128 v[216:219], v0 offset:1216
    ds_read_b128 v[220:223], v0 offset:1280
    ds_read_b128 v[224:227], v0 offset:1344
    ds_read_b128 v[228:231], v0 offset:1408
    ds_read_b128 v[232:235], v0 offset:1472
    ds_read_b128 v[236:239], v0 offset:1536
    ds_read_b128 v[240:243], v0 offset:1600
    ds_read_b128 v[244:247], v0 offset:1664
    v_bfe_u32 v8, v1, 4, 4
    s_lshl_b32 s33, s31, 5
    v_lshl_add_u32 v8, v8, 1, s33
    buffer_load_ushort v252, v8, s[12:15], 0 offen
    buffer_load_ushort v254, v8, s[12:15], 0 offen offset:32
    s_waitcnt lgkmcnt(9)
    v_rcp_f32 v249, v4
    v_rcp_f32 v251, v5
    v_mul_f32 v6, s40, v5
    v_mul_f32 v7, v5, v5
    v_mul_f32 v5, v4, v4
    v_mul_f32 v4, s40, v4
    v_mul_f32 v5, s42, v5
    v_mul_f32 v7, s42, v7
    v_mul_f32 v5, v5, v4
    v_mul_f32 v7, v7, v6
    s_waitcnt lgkmcnt(8)
    v_pk_add_f32 v[168:169], v[168:169], v[212:213]
    v_pk_add_f32 v[170:171], v[170:171], v[214:215]
    v_pk_fma_f32 v[88:89], v[248:249], v[168:169], v[88:89] op_sel_hi:[0,1,1] neg_lo:[1,0,0] neg_hi:[1,0,0]
    v_pk_fma_f32 v[90:91], v[248:249], v[170:171], v[90:91] op_sel_hi:[0,1,1] neg_lo:[1,0,0] neg_hi:[1,0,0]
    v_pk_fma_f32 v[92:93], v[250:251], v[168:169], v[92:93] op_sel_hi:[0,1,1] neg_lo:[1,0,0] neg_hi:[1,0,0]
    v_pk_fma_f32 v[94:95], v[250:251], v[170:171], v[94:95] op_sel_hi:[0,1,1] neg_lo:[1,0,0] neg_hi:[1,0,0]
    v_pk_mul_f32 v[160:161], v[88:89], v[88:89]
    v_pk_mul_f32 v[162:163], v[90:91], v[90:91]
    v_pk_mul_f32 v[164:165], v[92:93], v[92:93]
    v_pk_mul_f32 v[166:167], v[94:95], v[94:95]
    v_pk_fma_f32 v[160:161], v[160:161], v[4:5], v[4:5] op_sel:[0,1,0] op_sel_hi:[1,1,0]
    v_pk_fma_f32 v[162:163], v[162:163], v[4:5], v[4:5] op_sel:[0,1,0] op_sel_hi:[1,1,0]
    v_pk_fma_f32 v[164:165], v[164:165], v[6:7], v[6:7] op_sel:[0,1,0] op_sel_hi:[1,1,0]
    v_pk_fma_f32 v[166:167], v[166:167], v[6:7], v[6:7] op_sel:[0,1,0] op_sel_hi:[1,1,0]
    v_pk_mul_f32 v[160:161], v[160:161], v[88:89]
    v_pk_mul_f32 v[162:163], v[162:163], v[90:91]
    v_pk_mul_f32 v[164:165], v[164:165], v[92:93]
    v_pk_mul_f32 v[166:167], v[166:167], v[94:95]
    v_exp_f32 v160, v160
    v_exp_f32 v161, v161
    v_exp_f32 v162, v162
    v_exp_f32 v163, v163
    v_exp_f32 v164, v164
    v_exp_f32 v165, v165
    v_exp_f32 v166, v166
    v_exp_f32 v167, v167
    v_pk_fma_f32 v[160:161], v[160:161], v[248:249], v[248:249] op_sel:[0,1,1] op_sel_hi:[1,1,1]
    v_pk_fma_f32 v[162:163], v[162:163], v[248:249], v[248:249] op_sel:[0,1,1] op_sel_hi:[1,1,1]
    v_pk_fma_f32 v[164:165], v[164:165], v[250:251], v[250:251] op_sel:[0,1,1] op_sel_hi:[1,1,1]
    v_pk_fma_f32 v[166:167], v[166:167], v[250:251], v[250:251] op_sel:[0,1,1] op_sel_hi:[1,1,1]
    v_rcp_f32 v160, v160
    v_rcp_f32 v161, v161
    v_rcp_f32 v162, v162
    v_rcp_f32 v163, v163
    v_rcp_f32 v164, v164
    v_rcp_f32 v165, v165
    v_rcp_f32 v166, v166
    v_rcp_f32 v167, v167
    v_pk_mul_f32 v[88:89], v[88:89], v[160:161]
    v_pk_mul_f32 v[90:91], v[90:91], v[162:163]
    v_pk_mul_f32 v[92:93], v[92:93], v[164:165]
    v_pk_mul_f32 v[94:95], v[94:95], v[166:167]
    s_waitcnt vmcnt(2)
    s_barrier
    s_waitcnt lgkmcnt(7)
    v_pk_add_f32 v[172:173], v[172:173], v[216:217]
    v_pk_add_f32 v[174:175], v[174:175], v[218:219]
    v_pk_fma_f32 v[96:97], v[248:249], v[172:173], v[96:97] op_sel_hi:[0,1,1] neg_lo:[1,0,0] neg_hi:[1,0,0]
    v_pk_fma_f32 v[98:99], v[248:249], v[174:175], v[98:99] op_sel_hi:[0,1,1] neg_lo:[1,0,0] neg_hi:[1,0,0]
    v_pk_fma_f32 v[100:101], v[250:251], v[172:173], v[100:101] op_sel_hi:[0,1,1] neg_lo:[1,0,0] neg_hi:[1,0,0]
    v_pk_fma_f32 v[102:103], v[250:251], v[174:175], v[102:103] op_sel_hi:[0,1,1] neg_lo:[1,0,0] neg_hi:[1,0,0]
    v_pk_mul_f32 v[204:205], v[96:97], v[96:97]
    v_pk_mul_f32 v[206:207], v[98:99], v[98:99]
    v_pk_mul_f32 v[208:209], v[100:101], v[100:101]
    v_pk_mul_f32 v[210:211], v[102:103], v[102:103]
    v_pk_fma_f32 v[204:205], v[204:205], v[4:5], v[4:5] op_sel:[0,1,0] op_sel_hi:[1,1,0]
    v_pk_fma_f32 v[206:207], v[206:207], v[4:5], v[4:5] op_sel:[0,1,0] op_sel_hi:[1,1,0]
    v_pk_fma_f32 v[208:209], v[208:209], v[6:7], v[6:7] op_sel:[0,1,0] op_sel_hi:[1,1,0]
    v_pk_fma_f32 v[210:211], v[210:211], v[6:7], v[6:7] op_sel:[0,1,0] op_sel_hi:[1,1,0]
    v_pk_mul_f32 v[204:205], v[204:205], v[96:97]
    v_pk_mul_f32 v[206:207], v[206:207], v[98:99]
    v_pk_mul_f32 v[208:209], v[208:209], v[100:101]
    v_pk_mul_f32 v[210:211], v[210:211], v[102:103]
    v_exp_f32 v204, v204
    v_exp_f32 v205, v205
    v_exp_f32 v206, v206
    v_exp_f32 v207, v207
    v_exp_f32 v208, v208
    v_exp_f32 v209, v209
    v_exp_f32 v210, v210
    v_exp_f32 v211, v211
    v_pk_fma_f32 v[204:205], v[204:205], v[248:249], v[248:249] op_sel:[0,1,1] op_sel_hi:[1,1,1]
    v_pk_fma_f32 v[206:207], v[206:207], v[248:249], v[248:249] op_sel:[0,1,1] op_sel_hi:[1,1,1]
    v_pk_fma_f32 v[208:209], v[208:209], v[250:251], v[250:251] op_sel:[0,1,1] op_sel_hi:[1,1,1]
    v_pk_fma_f32 v[210:211], v[210:211], v[250:251], v[250:251] op_sel:[0,1,1] op_sel_hi:[1,1,1]
    v_rcp_f32 v204, v204
    v_rcp_f32 v205, v205
    v_rcp_f32 v206, v206
    v_rcp_f32 v207, v207
    v_rcp_f32 v208, v208
    v_rcp_f32 v209, v209
    v_rcp_f32 v210, v210
    v_rcp_f32 v211, v211
    v_pk_mul_f32 v[96:97], v[96:97], v[204:205]
    v_pk_mul_f32 v[98:99], v[98:99], v[206:207]
    v_pk_mul_f32 v[100:101], v[100:101], v[208:209]
    v_pk_mul_f32 v[102:103], v[102:103], v[210:211]
    s_waitcnt lgkmcnt(6)
    v_pk_add_f32 v[176:177], v[176:177], v[220:221]
    v_pk_add_f32 v[178:179], v[178:179], v[222:223]
    v_pk_fma_f32 v[104:105], v[248:249], v[176:177], v[104:105] op_sel_hi:[0,1,1] neg_lo:[1,0,0] neg_hi:[1,0,0]
    v_pk_fma_f32 v[106:107], v[248:249], v[178:179], v[106:107] op_sel_hi:[0,1,1] neg_lo:[1,0,0] neg_hi:[1,0,0]
    v_pk_fma_f32 v[108:109], v[250:251], v[176:177], v[108:109] op_sel_hi:[0,1,1] neg_lo:[1,0,0] neg_hi:[1,0,0]
    v_pk_fma_f32 v[110:111], v[250:251], v[178:179], v[110:111] op_sel_hi:[0,1,1] neg_lo:[1,0,0] neg_hi:[1,0,0]
    v_pk_mul_f32 v[160:161], v[104:105], v[104:105]
    v_pk_mul_f32 v[162:163], v[106:107], v[106:107]
    v_pk_mul_f32 v[164:165], v[108:109], v[108:109]
    v_pk_mul_f32 v[166:167], v[110:111], v[110:111]
    v_pk_fma_f32 v[160:161], v[160:161], v[4:5], v[4:5] op_sel:[0,1,0] op_sel_hi:[1,1,0]
    v_pk_fma_f32 v[162:163], v[162:163], v[4:5], v[4:5] op_sel:[0,1,0] op_sel_hi:[1,1,0]
    v_pk_fma_f32 v[164:165], v[164:165], v[6:7], v[6:7] op_sel:[0,1,0] op_sel_hi:[1,1,0]
    v_pk_fma_f32 v[166:167], v[166:167], v[6:7], v[6:7] op_sel:[0,1,0] op_sel_hi:[1,1,0]
    v_pk_mul_f32 v[160:161], v[160:161], v[104:105]
    v_pk_mul_f32 v[162:163], v[162:163], v[106:107]
    v_pk_mul_f32 v[164:165], v[164:165], v[108:109]
    v_pk_mul_f32 v[166:167], v[166:167], v[110:111]
    v_exp_f32 v160, v160
    v_exp_f32 v161, v161
    v_exp_f32 v162, v162
    v_exp_f32 v163, v163
    v_exp_f32 v164, v164
    v_exp_f32 v165, v165
    v_exp_f32 v166, v166
    v_exp_f32 v167, v167
    v_pk_fma_f32 v[160:161], v[160:161], v[248:249], v[248:249] op_sel:[0,1,1] op_sel_hi:[1,1,1]
    v_pk_fma_f32 v[162:163], v[162:163], v[248:249], v[248:249] op_sel:[0,1,1] op_sel_hi:[1,1,1]
    v_pk_fma_f32 v[164:165], v[164:165], v[250:251], v[250:251] op_sel:[0,1,1] op_sel_hi:[1,1,1]
    v_pk_fma_f32 v[166:167], v[166:167], v[250:251], v[250:251] op_sel:[0,1,1] op_sel_hi:[1,1,1]
    v_rcp_f32 v160, v160
    v_rcp_f32 v161, v161
    v_rcp_f32 v162, v162
    v_rcp_f32 v163, v163
    v_rcp_f32 v164, v164
    v_rcp_f32 v165, v165
    v_rcp_f32 v166, v166
    v_rcp_f32 v167, v167
    v_pk_mul_f32 v[104:105], v[104:105], v[160:161]
    v_pk_mul_f32 v[106:107], v[106:107], v[162:163]
    v_pk_mul_f32 v[108:109], v[108:109], v[164:165]
    v_pk_mul_f32 v[110:111], v[110:111], v[166:167]
    s_waitcnt lgkmcnt(5)
    v_pk_add_f32 v[180:181], v[180:181], v[224:225]
    v_pk_add_f32 v[182:183], v[182:183], v[226:227]
    v_pk_fma_f32 v[112:113], v[248:249], v[180:181], v[112:113] op_sel_hi:[0,1,1] neg_lo:[1,0,0] neg_hi:[1,0,0]
    v_pk_fma_f32 v[114:115], v[248:249], v[182:183], v[114:115] op_sel_hi:[0,1,1] neg_lo:[1,0,0] neg_hi:[1,0,0]
    v_pk_fma_f32 v[116:117], v[250:251], v[180:181], v[116:117] op_sel_hi:[0,1,1] neg_lo:[1,0,0] neg_hi:[1,0,0]
    v_pk_fma_f32 v[118:119], v[250:251], v[182:183], v[118:119] op_sel_hi:[0,1,1] neg_lo:[1,0,0] neg_hi:[1,0,0]
    v_pk_mul_f32 v[204:205], v[112:113], v[112:113]
    v_pk_mul_f32 v[206:207], v[114:115], v[114:115]
    v_pk_mul_f32 v[208:209], v[116:117], v[116:117]
    v_pk_mul_f32 v[210:211], v[118:119], v[118:119]
    v_pk_fma_f32 v[204:205], v[204:205], v[4:5], v[4:5] op_sel:[0,1,0] op_sel_hi:[1,1,0]
    v_pk_fma_f32 v[206:207], v[206:207], v[4:5], v[4:5] op_sel:[0,1,0] op_sel_hi:[1,1,0]
    v_pk_fma_f32 v[208:209], v[208:209], v[6:7], v[6:7] op_sel:[0,1,0] op_sel_hi:[1,1,0]
    v_pk_fma_f32 v[210:211], v[210:211], v[6:7], v[6:7] op_sel:[0,1,0] op_sel_hi:[1,1,0]
    v_pk_mul_f32 v[204:205], v[204:205], v[112:113]
    v_pk_mul_f32 v[206:207], v[206:207], v[114:115]
    v_pk_mul_f32 v[208:209], v[208:209], v[116:117]
    v_pk_mul_f32 v[210:211], v[210:211], v[118:119]
    v_exp_f32 v204, v204
    v_exp_f32 v205, v205
    v_exp_f32 v206, v206
    v_exp_f32 v207, v207
    v_exp_f32 v208, v208
    v_exp_f32 v209, v209
    v_exp_f32 v210, v210
    v_exp_f32 v211, v211
    v_pk_fma_f32 v[204:205], v[204:205], v[248:249], v[248:249] op_sel:[0,1,1] op_sel_hi:[1,1,1]
    v_pk_fma_f32 v[206:207], v[206:207], v[248:249], v[248:249] op_sel:[0,1,1] op_sel_hi:[1,1,1]
    v_pk_fma_f32 v[208:209], v[208:209], v[250:251], v[250:251] op_sel:[0,1,1] op_sel_hi:[1,1,1]
    v_pk_fma_f32 v[210:211], v[210:211], v[250:251], v[250:251] op_sel:[0,1,1] op_sel_hi:[1,1,1]
    v_rcp_f32 v204, v204
    v_rcp_f32 v205, v205
    v_rcp_f32 v206, v206
    v_rcp_f32 v207, v207
    v_rcp_f32 v208, v208
    v_rcp_f32 v209, v209
    v_rcp_f32 v210, v210
    v_rcp_f32 v211, v211
    v_pk_mul_f32 v[112:113], v[112:113], v[204:205]
    v_pk_mul_f32 v[114:115], v[114:115], v[206:207]
    v_pk_mul_f32 v[116:117], v[116:117], v[208:209]
    v_pk_mul_f32 v[118:119], v[118:119], v[210:211]
    s_waitcnt lgkmcnt(4)
    v_pk_add_f32 v[184:185], v[184:185], v[228:229]
    v_pk_add_f32 v[186:187], v[186:187], v[230:231]
    v_pk_fma_f32 v[120:121], v[248:249], v[184:185], v[120:121] op_sel_hi:[0,1,1] neg_lo:[1,0,0] neg_hi:[1,0,0]
    v_pk_fma_f32 v[122:123], v[248:249], v[186:187], v[122:123] op_sel_hi:[0,1,1] neg_lo:[1,0,0] neg_hi:[1,0,0]
    v_pk_fma_f32 v[124:125], v[250:251], v[184:185], v[124:125] op_sel_hi:[0,1,1] neg_lo:[1,0,0] neg_hi:[1,0,0]
    v_pk_fma_f32 v[126:127], v[250:251], v[186:187], v[126:127] op_sel_hi:[0,1,1] neg_lo:[1,0,0] neg_hi:[1,0,0]
    v_pk_mul_f32 v[160:161], v[120:121], v[120:121]
    v_pk_mul_f32 v[162:163], v[122:123], v[122:123]
    v_pk_mul_f32 v[164:165], v[124:125], v[124:125]
    v_pk_mul_f32 v[166:167], v[126:127], v[126:127]
    v_pk_fma_f32 v[160:161], v[160:161], v[4:5], v[4:5] op_sel:[0,1,0] op_sel_hi:[1,1,0]
    v_pk_fma_f32 v[162:163], v[162:163], v[4:5], v[4:5] op_sel:[0,1,0] op_sel_hi:[1,1,0]
    v_pk_fma_f32 v[164:165], v[164:165], v[6:7], v[6:7] op_sel:[0,1,0] op_sel_hi:[1,1,0]
    v_pk_fma_f32 v[166:167], v[166:167], v[6:7], v[6:7] op_sel:[0,1,0] op_sel_hi:[1,1,0]
    v_pk_mul_f32 v[160:161], v[160:161], v[120:121]
    v_pk_mul_f32 v[162:163], v[162:163], v[122:123]
    v_pk_mul_f32 v[164:165], v[164:165], v[124:125]
    v_pk_mul_f32 v[166:167], v[166:167], v[126:127]
    v_exp_f32 v160, v160
    v_exp_f32 v161, v161
    v_exp_f32 v162, v162
    v_exp_f32 v163, v163
    v_exp_f32 v164, v164
    v_exp_f32 v165, v165
    v_exp_f32 v166, v166
    v_exp_f32 v167, v167
    v_pk_fma_f32 v[160:161], v[160:161], v[248:249], v[248:249] op_sel:[0,1,1] op_sel_hi:[1,1,1]
    v_pk_fma_f32 v[162:163], v[162:163], v[248:249], v[248:249] op_sel:[0,1,1] op_sel_hi:[1,1,1]
    v_pk_fma_f32 v[164:165], v[164:165], v[250:251], v[250:251] op_sel:[0,1,1] op_sel_hi:[1,1,1]
    v_pk_fma_f32 v[166:167], v[166:167], v[250:251], v[250:251] op_sel:[0,1,1] op_sel_hi:[1,1,1]
    v_rcp_f32 v160, v160
    v_rcp_f32 v161, v161
    v_rcp_f32 v162, v162
    v_rcp_f32 v163, v163
    v_rcp_f32 v164, v164
    v_rcp_f32 v165, v165
    v_rcp_f32 v166, v166
    v_rcp_f32 v167, v167
    v_pk_mul_f32 v[120:121], v[120:121], v[160:161]
    v_pk_mul_f32 v[122:123], v[122:123], v[162:163]
    v_pk_mul_f32 v[124:125], v[124:125], v[164:165]
    v_pk_mul_f32 v[126:127], v[126:127], v[166:167]
    s_waitcnt lgkmcnt(3)
    v_pk_add_f32 v[188:189], v[188:189], v[232:233]
    v_pk_add_f32 v[190:191], v[190:191], v[234:235]
    v_pk_fma_f32 v[128:129], v[248:249], v[188:189], v[128:129] op_sel_hi:[0,1,1] neg_lo:[1,0,0] neg_hi:[1,0,0]
    v_pk_fma_f32 v[130:131], v[248:249], v[190:191], v[130:131] op_sel_hi:[0,1,1] neg_lo:[1,0,0] neg_hi:[1,0,0]
    v_pk_fma_f32 v[132:133], v[250:251], v[188:189], v[132:133] op_sel_hi:[0,1,1] neg_lo:[1,0,0] neg_hi:[1,0,0]
    v_pk_fma_f32 v[134:135], v[250:251], v[190:191], v[134:135] op_sel_hi:[0,1,1] neg_lo:[1,0,0] neg_hi:[1,0,0]
    v_pk_mul_f32 v[204:205], v[128:129], v[128:129]
    v_pk_mul_f32 v[206:207], v[130:131], v[130:131]
    v_pk_mul_f32 v[208:209], v[132:133], v[132:133]
    v_pk_mul_f32 v[210:211], v[134:135], v[134:135]
    v_pk_fma_f32 v[204:205], v[204:205], v[4:5], v[4:5] op_sel:[0,1,0] op_sel_hi:[1,1,0]
    v_pk_fma_f32 v[206:207], v[206:207], v[4:5], v[4:5] op_sel:[0,1,0] op_sel_hi:[1,1,0]
    v_pk_fma_f32 v[208:209], v[208:209], v[6:7], v[6:7] op_sel:[0,1,0] op_sel_hi:[1,1,0]
    v_pk_fma_f32 v[210:211], v[210:211], v[6:7], v[6:7] op_sel:[0,1,0] op_sel_hi:[1,1,0]
    v_pk_mul_f32 v[204:205], v[204:205], v[128:129]
    v_pk_mul_f32 v[206:207], v[206:207], v[130:131]
    v_pk_mul_f32 v[208:209], v[208:209], v[132:133]
    v_pk_mul_f32 v[210:211], v[210:211], v[134:135]
    v_exp_f32 v204, v204
    v_exp_f32 v205, v205
    v_exp_f32 v206, v206
    v_exp_f32 v207, v207
    v_exp_f32 v208, v208
    v_exp_f32 v209, v209
    v_exp_f32 v210, v210
    v_exp_f32 v211, v211
    v_pk_fma_f32 v[204:205], v[204:205], v[248:249], v[248:249] op_sel:[0,1,1] op_sel_hi:[1,1,1]
    v_pk_fma_f32 v[206:207], v[206:207], v[248:249], v[248:249] op_sel:[0,1,1] op_sel_hi:[1,1,1]
    v_pk_fma_f32 v[208:209], v[208:209], v[250:251], v[250:251] op_sel:[0,1,1] op_sel_hi:[1,1,1]
    v_pk_fma_f32 v[210:211], v[210:211], v[250:251], v[250:251] op_sel:[0,1,1] op_sel_hi:[1,1,1]
    v_rcp_f32 v204, v204
    v_rcp_f32 v205, v205
    v_rcp_f32 v206, v206
    v_rcp_f32 v207, v207
    v_rcp_f32 v208, v208
    v_rcp_f32 v209, v209
    v_rcp_f32 v210, v210
    v_rcp_f32 v211, v211
    v_pk_mul_f32 v[128:129], v[128:129], v[204:205]
    v_pk_mul_f32 v[130:131], v[130:131], v[206:207]
    v_pk_mul_f32 v[132:133], v[132:133], v[208:209]
    v_pk_mul_f32 v[134:135], v[134:135], v[210:211]
    s_waitcnt lgkmcnt(2)
    v_pk_add_f32 v[192:193], v[192:193], v[236:237]
    v_pk_add_f32 v[194:195], v[194:195], v[238:239]
    v_pk_fma_f32 v[136:137], v[248:249], v[192:193], v[136:137] op_sel_hi:[0,1,1] neg_lo:[1,0,0] neg_hi:[1,0,0]
    v_pk_fma_f32 v[138:139], v[248:249], v[194:195], v[138:139] op_sel_hi:[0,1,1] neg_lo:[1,0,0] neg_hi:[1,0,0]
    v_pk_fma_f32 v[140:141], v[250:251], v[192:193], v[140:141] op_sel_hi:[0,1,1] neg_lo:[1,0,0] neg_hi:[1,0,0]
    v_pk_fma_f32 v[142:143], v[250:251], v[194:195], v[142:143] op_sel_hi:[0,1,1] neg_lo:[1,0,0] neg_hi:[1,0,0]
    v_pk_mul_f32 v[160:161], v[136:137], v[136:137]
    v_pk_mul_f32 v[162:163], v[138:139], v[138:139]
    v_pk_mul_f32 v[164:165], v[140:141], v[140:141]
    v_pk_mul_f32 v[166:167], v[142:143], v[142:143]
    v_pk_fma_f32 v[160:161], v[160:161], v[4:5], v[4:5] op_sel:[0,1,0] op_sel_hi:[1,1,0]
    v_pk_fma_f32 v[162:163], v[162:163], v[4:5], v[4:5] op_sel:[0,1,0] op_sel_hi:[1,1,0]
    v_pk_fma_f32 v[164:165], v[164:165], v[6:7], v[6:7] op_sel:[0,1,0] op_sel_hi:[1,1,0]
    v_pk_fma_f32 v[166:167], v[166:167], v[6:7], v[6:7] op_sel:[0,1,0] op_sel_hi:[1,1,0]
    v_pk_mul_f32 v[160:161], v[160:161], v[136:137]
    v_pk_mul_f32 v[162:163], v[162:163], v[138:139]
    v_pk_mul_f32 v[164:165], v[164:165], v[140:141]
    v_pk_mul_f32 v[166:167], v[166:167], v[142:143]
    v_exp_f32 v160, v160
    v_exp_f32 v161, v161
    v_exp_f32 v162, v162
    v_exp_f32 v163, v163
    v_exp_f32 v164, v164
    v_exp_f32 v165, v165
    v_exp_f32 v166, v166
    v_exp_f32 v167, v167
    v_pk_fma_f32 v[160:161], v[160:161], v[248:249], v[248:249] op_sel:[0,1,1] op_sel_hi:[1,1,1]
    v_pk_fma_f32 v[162:163], v[162:163], v[248:249], v[248:249] op_sel:[0,1,1] op_sel_hi:[1,1,1]
    v_pk_fma_f32 v[164:165], v[164:165], v[250:251], v[250:251] op_sel:[0,1,1] op_sel_hi:[1,1,1]
    v_pk_fma_f32 v[166:167], v[166:167], v[250:251], v[250:251] op_sel:[0,1,1] op_sel_hi:[1,1,1]
    v_rcp_f32 v160, v160
    v_rcp_f32 v161, v161
    v_rcp_f32 v162, v162
    v_rcp_f32 v163, v163
    v_rcp_f32 v164, v164
    v_rcp_f32 v165, v165
    v_rcp_f32 v166, v166
    v_rcp_f32 v167, v167
    v_pk_mul_f32 v[136:137], v[136:137], v[160:161]
    v_pk_mul_f32 v[138:139], v[138:139], v[162:163]
    v_pk_mul_f32 v[140:141], v[140:141], v[164:165]
    v_pk_mul_f32 v[142:143], v[142:143], v[166:167]
    s_waitcnt lgkmcnt(1)
    v_pk_add_f32 v[196:197], v[196:197], v[240:241]
    v_pk_add_f32 v[198:199], v[198:199], v[242:243]
    v_pk_fma_f32 v[144:145], v[248:249], v[196:197], v[144:145] op_sel_hi:[0,1,1] neg_lo:[1,0,0] neg_hi:[1,0,0]
    v_pk_fma_f32 v[146:147], v[248:249], v[198:199], v[146:147] op_sel_hi:[0,1,1] neg_lo:[1,0,0] neg_hi:[1,0,0]
    v_pk_fma_f32 v[148:149], v[250:251], v[196:197], v[148:149] op_sel_hi:[0,1,1] neg_lo:[1,0,0] neg_hi:[1,0,0]
    v_pk_fma_f32 v[150:151], v[250:251], v[198:199], v[150:151] op_sel_hi:[0,1,1] neg_lo:[1,0,0] neg_hi:[1,0,0]
    v_pk_mul_f32 v[204:205], v[144:145], v[144:145]
    v_pk_mul_f32 v[206:207], v[146:147], v[146:147]
    v_pk_mul_f32 v[208:209], v[148:149], v[148:149]
    v_pk_mul_f32 v[210:211], v[150:151], v[150:151]
    v_pk_fma_f32 v[204:205], v[204:205], v[4:5], v[4:5] op_sel:[0,1,0] op_sel_hi:[1,1,0]
    v_pk_fma_f32 v[206:207], v[206:207], v[4:5], v[4:5] op_sel:[0,1,0] op_sel_hi:[1,1,0]
    v_pk_fma_f32 v[208:209], v[208:209], v[6:7], v[6:7] op_sel:[0,1,0] op_sel_hi:[1,1,0]
    v_pk_fma_f32 v[210:211], v[210:211], v[6:7], v[6:7] op_sel:[0,1,0] op_sel_hi:[1,1,0]
    v_pk_mul_f32 v[204:205], v[204:205], v[144:145]
    v_pk_mul_f32 v[206:207], v[206:207], v[146:147]
    v_pk_mul_f32 v[208:209], v[208:209], v[148:149]
    v_pk_mul_f32 v[210:211], v[210:211], v[150:151]
    v_exp_f32 v204, v204
    v_exp_f32 v205, v205
    v_exp_f32 v206, v206
    v_exp_f32 v207, v207
    v_exp_f32 v208, v208
    v_exp_f32 v209, v209
    v_exp_f32 v210, v210
    v_exp_f32 v211, v211
    v_pk_fma_f32 v[204:205], v[204:205], v[248:249], v[248:249] op_sel:[0,1,1] op_sel_hi:[1,1,1]
    v_pk_fma_f32 v[206:207], v[206:207], v[248:249], v[248:249] op_sel:[0,1,1] op_sel_hi:[1,1,1]
    v_pk_fma_f32 v[208:209], v[208:209], v[250:251], v[250:251] op_sel:[0,1,1] op_sel_hi:[1,1,1]
    v_pk_fma_f32 v[210:211], v[210:211], v[250:251], v[250:251] op_sel:[0,1,1] op_sel_hi:[1,1,1]
    v_rcp_f32 v204, v204
    v_rcp_f32 v205, v205
    v_rcp_f32 v206, v206
    v_rcp_f32 v207, v207
    v_rcp_f32 v208, v208
    v_rcp_f32 v209, v209
    v_rcp_f32 v210, v210
    v_rcp_f32 v211, v211
    v_pk_mul_f32 v[144:145], v[144:145], v[204:205]
    v_pk_mul_f32 v[146:147], v[146:147], v[206:207]
    v_pk_mul_f32 v[148:149], v[148:149], v[208:209]
    v_pk_mul_f32 v[150:151], v[150:151], v[210:211]
    s_waitcnt lgkmcnt(0)
    v_pk_add_f32 v[200:201], v[200:201], v[244:245]
    v_pk_add_f32 v[202:203], v[202:203], v[246:247]
    v_pk_fma_f32 v[152:153], v[248:249], v[200:201], v[152:153] op_sel_hi:[0,1,1] neg_lo:[1,0,0] neg_hi:[1,0,0]
    v_pk_fma_f32 v[154:155], v[248:249], v[202:203], v[154:155] op_sel_hi:[0,1,1] neg_lo:[1,0,0] neg_hi:[1,0,0]
    v_pk_fma_f32 v[156:157], v[250:251], v[200:201], v[156:157] op_sel_hi:[0,1,1] neg_lo:[1,0,0] neg_hi:[1,0,0]
    v_pk_fma_f32 v[158:159], v[250:251], v[202:203], v[158:159] op_sel_hi:[0,1,1] neg_lo:[1,0,0] neg_hi:[1,0,0]
    v_pk_mul_f32 v[160:161], v[152:153], v[152:153]
    v_pk_mul_f32 v[162:163], v[154:155], v[154:155]
    v_pk_mul_f32 v[164:165], v[156:157], v[156:157]
    v_pk_mul_f32 v[166:167], v[158:159], v[158:159]
    v_pk_fma_f32 v[160:161], v[160:161], v[4:5], v[4:5] op_sel:[0,1,0] op_sel_hi:[1,1,0]
    v_pk_fma_f32 v[162:163], v[162:163], v[4:5], v[4:5] op_sel:[0,1,0] op_sel_hi:[1,1,0]
    v_pk_fma_f32 v[164:165], v[164:165], v[6:7], v[6:7] op_sel:[0,1,0] op_sel_hi:[1,1,0]
    v_pk_fma_f32 v[166:167], v[166:167], v[6:7], v[6:7] op_sel:[0,1,0] op_sel_hi:[1,1,0]
    v_pk_mul_f32 v[160:161], v[160:161], v[152:153]
    v_pk_mul_f32 v[162:163], v[162:163], v[154:155]
    v_pk_mul_f32 v[164:165], v[164:165], v[156:157]
    v_pk_mul_f32 v[166:167], v[166:167], v[158:159]
    v_exp_f32 v160, v160
    v_exp_f32 v161, v161
    v_exp_f32 v162, v162
    v_exp_f32 v163, v163
    v_exp_f32 v164, v164
    v_exp_f32 v165, v165
    v_exp_f32 v166, v166
    v_exp_f32 v167, v167
    v_pk_fma_f32 v[160:161], v[160:161], v[248:249], v[248:249] op_sel:[0,1,1] op_sel_hi:[1,1,1]
    v_pk_fma_f32 v[162:163], v[162:163], v[248:249], v[248:249] op_sel:[0,1,1] op_sel_hi:[1,1,1]
    v_pk_fma_f32 v[164:165], v[164:165], v[250:251], v[250:251] op_sel:[0,1,1] op_sel_hi:[1,1,1]
    v_pk_fma_f32 v[166:167], v[166:167], v[250:251], v[250:251] op_sel:[0,1,1] op_sel_hi:[1,1,1]
    v_rcp_f32 v160, v160
    v_rcp_f32 v161, v161
    v_rcp_f32 v162, v162
    v_rcp_f32 v163, v163
    v_rcp_f32 v164, v164
    v_rcp_f32 v165, v165
    v_rcp_f32 v166, v166
    v_rcp_f32 v167, v167
    v_pk_mul_f32 v[152:153], v[152:153], v[160:161]
    v_pk_mul_f32 v[154:155], v[154:155], v[162:163]
    v_pk_mul_f32 v[156:157], v[156:157], v[164:165]
    v_pk_mul_f32 v[158:159], v[158:159], v[166:167]
    s_waitcnt vmcnt(0)
    v_lshlrev_b32 v252, 16, v252
    v_lshlrev_b32 v254, 16, v254
    v_mov_b32 v253, v252
    v_mov_b32 v255, v254
    v_bfe_u32 v6, v1, 4, 4
    v_lshrrev_b32 v3, 1, v6
    v_lshrrev_b32 v4, 8, v1
    v_xor_b32 v3, v3, v4
    v_lshlrev_b32 v3, 4, v3
    v_lshl_add_u32 v3, v6, 7, v3
    s_add_u32 s33, s30, 18432
    v_add_u32 v3, s33, v3
    v_xor_b32 v4, 64, v3
    v_add_u32 v5, 73728, v3
    v_add_u32 v6, 73728, v4
    v_mov_b64 v[16:17], v[252:253]
    v_mov_b64 v[18:19], v[252:253]
    v_mov_b64 v[20:21], v[254:255]
    v_mov_b64 v[22:23], v[254:255]
    v_mov_b64 v[24:25], v[252:253]
    v_mov_b64 v[26:27], v[252:253]
    v_mov_b64 v[28:29], v[254:255]
    v_mov_b64 v[30:31], v[254:255]
    v_mov_b64 v[32:33], v[252:253]
    v_mov_b64 v[34:35], v[252:253]
    v_mov_b64 v[36:37], v[254:255]
    v_mov_b64 v[38:39], v[254:255]
    v_mov_b64 v[40:41], v[252:253]
    v_mov_b64 v[42:43], v[252:253]
    v_mov_b64 v[44:45], v[254:255]
    v_mov_b64 v[46:47], v[254:255]
    v_mov_b64 v[48:49], v[252:253]
    v_mov_b64 v[50:51], v[252:253]
    v_mov_b64 v[52:53], v[254:255]
    v_mov_b64 v[54:55], v[254:255]
    v_mov_b64 v[56:57], v[252:253]
    v_mov_b64 v[58:59], v[252:253]
    v_mov_b64 v[60:61], v[254:255]
    v_mov_b64 v[62:63], v[254:255]
    v_mov_b64 v[64:65], v[252:253]
    v_mov_b64 v[66:67], v[252:253]
    v_mov_b64 v[68:69], v[254:255]
    v_mov_b64 v[70:71], v[254:255]
    v_mov_b64 v[72:73], v[252:253]
    v_mov_b64 v[74:75], v[252:253]
    v_mov_b64 v[76:77], v[254:255]
    v_mov_b64 v[78:79], v[254:255]
    v_mov_b64 v[80:81], v[252:253]
    v_mov_b64 v[82:83], v[252:253]
    v_mov_b64 v[84:85], v[254:255]
    v_mov_b64 v[86:87], v[254:255]
    s_mul_i32 s36, s31, 73728
    s_add_u32 s36, s36, s21
    s_lshl_b32 s34, s24, 12
    s_lshl_b32 s35, s24, 9
    s_add_u32 s35, s35, 65536
    v_add_u32 v14, s34, v1
    v_lshrrev_b32 v15, 1, v1
    v_add_u32 v15, s35, v15
    s_add_u32 s39, s36, 0x1200000
    s_add_u32 s40, s36, 0x1212000
    s_mov_b32 s41, 7
    s_barrier
    ds_read_b128 v[160:163], v5 offset:0
    ds_read_b128 v[164:167], v5 offset:2048
    ds_read_b128 v[168:171], v2 offset:0
    ds_read_b128 v[172:175], v2 offset:1024
    ds_read_b128 v[176:179], v2 offset:2048
    ds_read_b128 v[180:183], v2 offset:3072
    ds_read_b128 v[184:187], v2 offset:4096
    ds_read_b128 v[188:191], v2 offset:5120
    ds_read_b128 v[192:195], v2 offset:6144
    ds_read_b128 v[196:199], v2 offset:7168
    ds_read_b128 v[200:203], v2 offset:8192
    .p2align 6
L_g_loop:
    s_waitcnt lgkmcnt(5)
    v_mfma_f32_16x16x32_bf16 v[16:19], v[168:171], v[160:163], v[16:19]
    ds_read_b128 v[204:207], v6 offset:0
    v_mfma_f32_16x16x32_bf16 v[20:23], v[168:171], v[164:167], v[20:23]
    ds_read_b128 v[208:211], v6 offset:2048
    v_mfma_f32_16x16x32_bf16 v[24:27], v[172:175], v[160:163], v[24:27]
    ds_read_b128 v[212:215], v2 offset:9216
    v_mfma_f32_16x16x32_bf16 v[28:31], v[172:175], v[164:167], v[28:31]
    ds_read_b128 v[216:219], v2 offset:10240
    v_mfma_f32_16x16x32_bf16 v[32:35], v[176:179], v[160:163], v[32:35]
    ds_read_b128 v[220:223], v2 offset:11264
    v_mfma_f32_16x16x32_bf16 v[36:39], v[176:179], v[164:167], v[36:39]
    ds_read_b128 v[224:227], v2 offset:12288
    v_mfma_f32_16x16x32_bf16 v[40:43], v[180:183], v[160:163], v[40:43]
    ds_read_b128 v[228:231], v2 offset:13312
    v_mfma_f32_16x16x32_bf16 v[44:47], v[180:183], v[164:167], v[44:47]
    ds_read_b128 v[232:235], v2 offset:14336
    s_waitcnt lgkmcnt(8)
    v_mfma_f32_16x16x32_bf16 v[48:51], v[184:187], v[160:163], v[48:51]
    ds_read_b128 v[236:239], v2 offset:15360
    v_mfma_f32_16x16x32_bf16 v[52:55], v[184:187], v[164:167], v[52:55]
    ds_read_b128 v[240:243], v2 offset:16384
    v_mfma_f32_16x16x32_bf16 v[56:59], v[188:191], v[160:163], v[56:59]
    ds_read_b128 v[244:247], v2 offset:17408
    v_mfma_f32_16x16x32_bf16 v[60:63], v[188:191], v[164:167], v[60:63]
    v_mfma_f32_16x16x32_bf16 v[64:67], v[192:195], v[160:163], v[64:67]
    v_mfma_f32_16x16x32_bf16 v[68:71], v[192:195], v[164:167], v[68:71]
    v_mfma_f32_16x16x32_bf16 v[72:75], v[196:199], v[160:163], v[72:75]
    v_mfma_f32_16x16x32_bf16 v[76:79], v[196:199], v[164:167], v[76:79]
    v_mfma_f32_16x16x32_bf16 v[80:83], v[200:203], v[160:163], v[80:83]
    v_mfma_f32_16x16x32_bf16 v[84:87], v[200:203], v[164:167], v[84:87]
    s_waitcnt lgkmcnt(0)
    s_barrier
    v_mfma_f32_16x16x32_bf16 v[16:19], v[212:215], v[204:207], v[16:19]
    ds_read_b128 v[160:163], v5 offset:36864
    v_mfma_f32_16x16x32_bf16 v[20:23], v[212:215], v[208:211], v[20:23]
    ds_read_b128 v[164:167], v5 offset:38912
    v_mfma_f32_16x16x32_bf16 v[24:27], v[216:219], v[204:207], v[24:27]
    ds_read_b128 v[168:171], v2 offset:36864
    v_mfma_f32_16x16x32_bf16 v[28:31], v[216:219], v[208:211], v[28:31]
    ds_read_b128 v[172:175], v2 offset:37888
    v_mfma_f32_16x16x32_bf16 v[32:35], v[220:223], v[204:207], v[32:35]
    ds_read_b128 v[176:179], v2 offset:38912
    v_mfma_f32_16x16x32_bf16 v[36:39], v[220:223], v[208:211], v[36:39]
    ds_read_b128 v[180:183], v2 offset:39936
    v_mfma_f32_16x16x32_bf16 v[40:43], v[224:227], v[204:207], v[40:43]
    ds_read_b128 v[184:187], v2 offset:40960
    v_mfma_f32_16x16x32_bf16 v[44:47], v[224:227], v[208:211], v[44:47]
    ds_read_b128 v[188:191], v2 offset:41984
    v_mfma_f32_16x16x32_bf16 v[48:51], v[228:231], v[204:207], v[48:51]
    ds_read_b128 v[192:195], v2 offset:43008
    v_mfma_f32_16x16x32_bf16 v[52:55], v[228:231], v[208:211], v[52:55]
    ds_read_b128 v[196:199], v2 offset:44032
    v_mfma_f32_16x16x32_bf16 v[56:59], v[232:235], v[204:207], v[56:59]
    ds_read_b128 v[200:203], v2 offset:45056
    v_mfma_f32_16x16x32_bf16 v[60:63], v[232:235], v[208:211], v[60:63]
    v_mfma_f32_16x16x32_bf16 v[64:67], v[236:239], v[204:207], v[64:67]
    v_mfma_f32_16x16x32_bf16 v[68:71], v[236:239], v[208:211], v[68:71]
    v_mfma_f32_16x16x32_bf16 v[72:75], v[240:243], v[204:207], v[72:75]
    v_mfma_f32_16x16x32_bf16 v[76:79], v[240:243], v[208:211], v[76:79]
    v_mfma_f32_16x16x32_bf16 v[80:83], v[244:247], v[204:207], v[80:83]
    v_mfma_f32_16x16x32_bf16 v[84:87], v[244:247], v[208:211], v[84:87]
    s_waitcnt lgkmcnt(5)
    v_mfma_f32_16x16x32_bf16 v[16:19], v[168:171], v[160:163], v[16:19]
    ds_read_b128 v[204:207], v6 offset:36864
    v_mfma_f32_16x16x32_bf16 v[20:23], v[168:171], v[164:167], v[20:23]
    ds_read_b128 v[208:211], v6 offset:38912
    v_mfma_f32_16x16x32_bf16 v[24:27], v[172:175], v[160:163], v[24:27]
    ds_read_b128 v[212:215], v2 offset:46080
    v_mfma_f32_16x16x32_bf16 v[28:31], v[172:175], v[164:167], v[28:31]
    ds_read_b128 v[216:219], v2 offset:47104
    v_mfma_f32_16x16x32_bf16 v[32:35], v[176:179], v[160:163], v[32:35]
    ds_read_b128 v[220:223], v2 offset:48128
    v_mfma_f32_16x16x32_bf16 v[36:39], v[176:179], v[164:167], v[36:39]
    ds_read_b128 v[224:227], v2 offset:49152
    v_mfma_f32_16x16x32_bf16 v[40:43], v[180:183], v[160:163], v[40:43]
    ds_read_b128 v[228:231], v2 offset:50176
    v_mfma_f32_16x16x32_bf16 v[44:47], v[180:183], v[164:167], v[44:47]
    ds_read_b128 v[232:235], v2 offset:51200
    s_waitcnt lgkmcnt(8)
    v_mfma_f32_16x16x32_bf16 v[48:51], v[184:187], v[160:163], v[48:51]
    ds_read_b128 v[236:239], v2 offset:52224
    v_mfma_f32_16x16x32_bf16 v[52:55], v[184:187], v[164:167], v[52:55]
    ds_read_b128 v[240:243], v2 offset:53248
    v_mfma_f32_16x16x32_bf16 v[56:59], v[188:191], v[160:163], v[56:59]
    ds_read_b128 v[244:247], v2 offset:54272
    v_mfma_f32_16x16x32_bf16 v[60:63], v[188:191], v[164:167], v[60:63]
    v_mfma_f32_16x16x32_bf16 v[64:67], v[192:195], v[160:163], v[64:67]
    v_mfma_f32_16x16x32_bf16 v[68:71], v[192:195], v[164:167], v[68:71]
    v_mfma_f32_16x16x32_bf16 v[72:75], v[196:199], v[160:163], v[72:75]
    v_mfma_f32_16x16x32_bf16 v[76:79], v[196:199], v[164:167], v[76:79]
    v_mfma_f32_16x16x32_bf16 v[80:83], v[200:203], v[160:163], v[80:83]
    v_mfma_f32_16x16x32_bf16 v[84:87], v[200:203], v[164:167], v[84:87]
    s_waitcnt lgkmcnt(0)
    s_barrier
    v_mfma_f32_16x16x32_bf16 v[16:19], v[212:215], v[204:207], v[16:19]
    ds_read_b128 v[160:163], v3 offset:0
    v_mfma_f32_16x16x32_bf16 v[20:23], v[212:215], v[208:211], v[20:23]
    ds_read_b128 v[164:167], v3 offset:2048
    v_mfma_f32_16x16x32_bf16 v[24:27], v[216:219], v[204:207], v[24:27]
    ds_read_b128 v[168:171], v1 offset:0
    v_mfma_f32_16x16x32_bf16 v[28:31], v[216:219], v[208:211], v[28:31]
    ds_read_b128 v[172:175], v1 offset:1024
    v_mfma_f32_16x16x32_bf16 v[32:35], v[220:223], v[204:207], v[32:35]
    ds_read_b128 v[176:179], v1 offset:2048
    v_mfma_f32_16x16x32_bf16 v[36:39], v[220:223], v[208:211], v[36:39]
    ds_read_b128 v[180:183], v1 offset:3072
    v_mfma_f32_16x16x32_bf16 v[40:43], v[224:227], v[204:207], v[40:43]
    ds_read_b128 v[184:187], v1 offset:4096
    v_mfma_f32_16x16x32_bf16 v[44:47], v[224:227], v[208:211], v[44:47]
    ds_read_b128 v[188:191], v1 offset:5120
    v_mfma_f32_16x16x32_bf16 v[48:51], v[228:231], v[204:207], v[48:51]
    ds_read_b128 v[192:195], v1 offset:6144
    v_mfma_f32_16x16x32_bf16 v[52:55], v[228:231], v[208:211], v[52:55]
    ds_read_b128 v[196:199], v1 offset:7168
    v_mfma_f32_16x16x32_bf16 v[56:59], v[232:235], v[204:207], v[56:59]
    ds_read_b128 v[200:203], v1 offset:8192
    v_mfma_f32_16x16x32_bf16 v[60:63], v[232:235], v[208:211], v[60:63]
    v_mfma_f32_16x16x32_bf16 v[64:67], v[236:239], v[204:207], v[64:67]
    v_mfma_f32_16x16x32_bf16 v[68:71], v[236:239], v[208:211], v[68:71]
    v_mfma_f32_16x16x32_bf16 v[72:75], v[240:243], v[204:207], v[72:75]
    v_mfma_f32_16x16x32_bf16 v[76:79], v[240:243], v[208:211], v[76:79]
    v_mfma_f32_16x16x32_bf16 v[80:83], v[244:247], v[204:207], v[80:83]
    v_mfma_f32_16x16x32_bf16 v[84:87], v[244:247], v[208:211], v[84:87]
    s_waitcnt lgkmcnt(5)
    v_mfma_f32_16x16x32_bf16 v[16:19], v[168:171], v[160:163], v[16:19]
    ds_read_b128 v[204:207], v4 offset:0
    v_mfma_f32_16x16x32_bf16 v[20:23], v[168:171], v[164:167], v[20:23]
    ds_read_b128 v[208:211], v4 offset:2048
    v_mfma_f32_16x16x32_bf16 v[24:27], v[172:175], v[160:163], v[24:27]
    ds_read_b128 v[212:215], v1 offset:9216
    v_mfma_f32_16x16x32_bf16 v[28:31], v[172:175], v[164:167], v[28:31]
    ds_read_b128 v[216:219], v1 offset:10240
    v_mfma_f32_16x16x32_bf16 v[32:35], v[176:179], v[160:163], v[32:35]
    ds_read_b128 v[220:223], v1 offset:11264
    v_mfma_f32_16x16x32_bf16 v[36:39], v[176:179], v[164:167], v[36:39]
    ds_read_b128 v[224:227], v1 offset:12288
    v_mfma_f32_16x16x32_bf16 v[40:43], v[180:183], v[160:163], v[40:43]
    ds_read_b128 v[228:231], v1 offset:13312
    v_mfma_f32_16x16x32_bf16 v[44:47], v[180:183], v[164:167], v[44:47]
    ds_read_b128 v[232:235], v1 offset:14336
    s_waitcnt lgkmcnt(8)
    v_mfma_f32_16x16x32_bf16 v[48:51], v[184:187], v[160:163], v[48:51]
    ds_read_b128 v[236:239], v1 offset:15360
    v_mfma_f32_16x16x32_bf16 v[52:55], v[184:187], v[164:167], v[52:55]
    ds_read_b128 v[240:243], v1 offset:16384
    v_mfma_f32_16x16x32_bf16 v[56:59], v[188:191], v[160:163], v[56:59]
    ds_read_b128 v[244:247], v1 offset:17408
    v_mfma_f32_16x16x32_bf16 v[60:63], v[188:191], v[164:167], v[60:63]
    v_mfma_f32_16x16x32_bf16 v[64:67], v[192:195], v[160:163], v[64:67]
    v_mfma_f32_16x16x32_bf16 v[68:71], v[192:195], v[164:167], v[68:71]
    v_mfma_f32_16x16x32_bf16 v[72:75], v[196:199], v[160:163], v[72:75]
    v_mfma_f32_16x16x32_bf16 v[76:79], v[196:199], v[164:167], v[76:79]
    v_mfma_f32_16x16x32_bf16 v[80:83], v[200:203], v[160:163], v[80:83]
    v_mfma_f32_16x16x32_bf16 v[84:87], v[200:203], v[164:167], v[84:87]
    s_waitcnt lgkmcnt(0)
    s_barrier
    v_mfma_f32_16x16x32_bf16 v[16:19], v[212:215], v[204:207], v[16:19]
    ds_read_b128 v[160:163], v3 offset:36864
    v_mfma_f32_16x16x32_bf16 v[20:23], v[212:215], v[208:211], v[20:23]
    ds_read_b128 v[164:167], v3 offset:38912
    v_mfma_f32_16x16x32_bf16 v[24:27], v[216:219], v[204:207], v[24:27]
    ds_read_b128 v[168:171], v1 offset:36864
    v_mfma_f32_16x16x32_bf16 v[28:31], v[216:219], v[208:211], v[28:31]
    ds_read_b128 v[172:175], v1 offset:37888
    v_mfma_f32_16x16x32_bf16 v[32:35], v[220:223], v[204:207], v[32:35]
    ds_read_b128 v[176:179], v1 offset:38912
    v_mfma_f32_16x16x32_bf16 v[36:39], v[220:223], v[208:211], v[36:39]
    ds_read_b128 v[180:183], v1 offset:39936
    v_mfma_f32_16x16x32_bf16 v[40:43], v[224:227], v[204:207], v[40:43]
    ds_read_b128 v[184:187], v1 offset:40960
    v_mfma_f32_16x16x32_bf16 v[44:47], v[224:227], v[208:211], v[44:47]
    ds_read_b128 v[188:191], v1 offset:41984
    v_mfma_f32_16x16x32_bf16 v[48:51], v[228:231], v[204:207], v[48:51]
    ds_read_b128 v[192:195], v1 offset:43008
    v_mfma_f32_16x16x32_bf16 v[52:55], v[228:231], v[208:211], v[52:55]
    ds_read_b128 v[196:199], v1 offset:44032
    v_mfma_f32_16x16x32_bf16 v[56:59], v[232:235], v[204:207], v[56:59]
    ds_read_b128 v[200:203], v1 offset:45056
    v_mfma_f32_16x16x32_bf16 v[60:63], v[232:235], v[208:211], v[60:63]
    v_mfma_f32_16x16x32_bf16 v[64:67], v[236:239], v[204:207], v[64:67]
    v_mfma_f32_16x16x32_bf16 v[68:71], v[236:239], v[208:211], v[68:71]
    v_mfma_f32_16x16x32_bf16 v[72:75], v[240:243], v[204:207], v[72:75]
    v_mfma_f32_16x16x32_bf16 v[76:79], v[240:243], v[208:211], v[76:79]
    v_mfma_f32_16x16x32_bf16 v[80:83], v[244:247], v[204:207], v[80:83]
    v_mfma_f32_16x16x32_bf16 v[84:87], v[244:247], v[208:211], v[84:87]
    s_waitcnt lgkmcnt(5)
    v_mfma_f32_16x16x32_bf16 v[16:19], v[168:171], v[160:163], v[16:19]
    ds_read_b128 v[204:207], v4 offset:36864
    v_mfma_f32_16x16x32_bf16 v[20:23], v[168:171], v[164:167], v[20:23]
    ds_read_b128 v[208:211], v4 offset:38912
    v_mfma_f32_16x16x32_bf16 v[24:27], v[172:175], v[160:163], v[24:27]
    ds_read_b128 v[212:215], v1 offset:46080
    v_mfma_f32_16x16x32_bf16 v[28:31], v[172:175], v[164:167], v[28:31]
    ds_read_b128 v[216:219], v1 offset:47104
    v_mfma_f32_16x16x32_bf16 v[32:35], v[176:179], v[160:163], v[32:35]
    ds_read_b128 v[220:223], v1 offset:48128
    v_mfma_f32_16x16x32_bf16 v[36:39], v[176:179], v[164:167], v[36:39]
    ds_read_b128 v[224:227], v1 offset:49152
    v_mfma_f32_16x16x32_bf16 v[40:43], v[180:183], v[160:163], v[40:43]
    ds_read_b128 v[228:231], v1 offset:50176
    v_mfma_f32_16x16x32_bf16 v[44:47], v[180:183], v[164:167], v[44:47]
    ds_read_b128 v[232:235], v1 offset:51200
    s_waitcnt lgkmcnt(8)
    v_mfma_f32_16x16x32_bf16 v[48:51], v[184:187], v[160:163], v[48:51]
    ds_read_b128 v[236:239], v1 offset:52224
    v_mfma_f32_16x16x32_bf16 v[52:55], v[184:187], v[164:167], v[52:55]
    ds_read_b128 v[240:243], v1 offset:53248
    v_mfma_f32_16x16x32_bf16 v[56:59], v[188:191], v[160:163], v[56:59]
    ds_read_b128 v[244:247], v1 offset:54272
    v_mfma_f32_16x16x32_bf16 v[60:63], v[188:191], v[164:167], v[60:63]
    v_mfma_f32_16x16x32_bf16 v[64:67], v[192:195], v[160:163], v[64:67]
    v_mfma_f32_16x16x32_bf16 v[68:71], v[192:195], v[164:167], v[68:71]
    v_mfma_f32_16x16x32_bf16 v[72:75], v[196:199], v[160:163], v[72:75]
    v_mfma_f32_16x16x32_bf16 v[76:79], v[196:199], v[164:167], v[76:79]
    v_mfma_f32_16x16x32_bf16 v[80:83], v[200:203], v[160:163], v[80:83]
    v_mfma_f32_16x16x32_bf16 v[84:87], v[200:203], v[164:167], v[84:87]
    s_waitcnt lgkmcnt(0)
    s_barrier
    v_mfma_f32_16x16x32_bf16 v[16:19], v[212:215], v[204:207], v[16:19]
    ds_read_b128 v[160:163], v5 offset:0
    v_mfma_f32_16x16x32_bf16 v[20:23], v[212:215], v[208:211], v[20:23]
    ds_read_b128 v[164:167], v5 offset:2048
    v_mfma_f32_16x16x32_bf16 v[24:27], v[216:219], v[204:207], v[24:27]
    ds_read_b128 v[168:171], v2 offset:0
    v_mfma_f32_16x16x32_bf16 v[28:31], v[216:219], v[208:211], v[28:31]
    ds_read_b128 v[172:175], v2 offset:1024
    v_mfma_f32_16x16x32_bf16 v[32:35], v[220:223], v[204:207], v[32:35]
    ds_read_b128 v[176:179], v2 offset:2048
    v_mfma_f32_16x16x32_bf16 v[36:39], v[220:223], v[208:211], v[36:39]
    ds_read_b128 v[180:183], v2 offset:3072
    v_mfma_f32_16x16x32_bf16 v[40:43], v[224:227], v[204:207], v[40:43]
    ds_read_b128 v[184:187], v2 offset:4096
    v_mfma_f32_16x16x32_bf16 v[44:47], v[224:227], v[208:211], v[44:47]
    ds_read_b128 v[188:191], v2 offset:5120
    v_mfma_f32_16x16x32_bf16 v[48:51], v[228:231], v[204:207], v[48:51]
    ds_read_b128 v[192:195], v2 offset:6144
    v_mfma_f32_16x16x32_bf16 v[52:55], v[228:231], v[208:211], v[52:55]
    ds_read_b128 v[196:199], v2 offset:7168
    v_mfma_f32_16x16x32_bf16 v[56:59], v[232:235], v[204:207], v[56:59]
    ds_read_b128 v[200:203], v2 offset:8192
    v_mfma_f32_16x16x32_bf16 v[60:63], v[232:235], v[208:211], v[60:63]
    v_mfma_f32_16x16x32_bf16 v[64:67], v[236:239], v[204:207], v[64:67]
    v_mfma_f32_16x16x32_bf16 v[68:71], v[236:239], v[208:211], v[68:71]
    v_mfma_f32_16x16x32_bf16 v[72:75], v[240:243], v[204:207], v[72:75]
    v_mfma_f32_16x16x32_bf16 v[76:79], v[240:243], v[208:211], v[76:79]
    v_mfma_f32_16x16x32_bf16 v[80:83], v[244:247], v[204:207], v[80:83]
    s_sub_u32 s41, s41, 1
    v_mfma_f32_16x16x32_bf16 v[84:87], v[244:247], v[208:211], v[84:87]
    s_cmp_lg_u32 s41, 0
    s_cbranch_scc1 L_g_loop
    s_waitcnt lgkmcnt(5)
    v_mfma_f32_16x16x32_bf16 v[16:19], v[168:171], v[160:163], v[16:19]
    ds_read_b128 v[204:207], v6 offset:0
    v_mfma_f32_16x16x32_bf16 v[20:23], v[168:171], v[164:167], v[20:23]
    ds_read_b128 v[208:211], v6 offset:2048
    v_mfma_f32_16x16x32_bf16 v[24:27], v[172:175], v[160:163], v[24:27]
    ds_read_b128 v[212:215], v2 offset:9216
    v_mfma_f32_16x16x32_bf16 v[28:31], v[172:175], v[164:167], v[28:31]
    ds_read_b128 v[216:219], v2 offset:10240
    v_mfma_f32_16x16x32_bf16 v[32:35], v[176:179], v[160:163], v[32:35]
    ds_read_b128 v[220:223], v2 offset:11264
    v_mfma_f32_16x16x32_bf16 v[36:39], v[176:179], v[164:167], v[36:39]
    ds_read_b128 v[224:227], v2 offset:12288
    v_mfma_f32_16x16x32_bf16 v[40:43], v[180:183], v[160:163], v[40:43]
    ds_read_b128 v[228:231], v2 offset:13312
    v_mfma_f32_16x16x32_bf16 v[44:47], v[180:183], v[164:167], v[44:47]
    ds_read_b128 v[232:235], v2 offset:14336
    s_waitcnt lgkmcnt(8)
    v_mfma_f32_16x16x32_bf16 v[48:51], v[184:187], v[160:163], v[48:51]
    ds_read_b128 v[236:239], v2 offset:15360
    v_mfma_f32_16x16x32_bf16 v[52:55], v[184:187], v[164:167], v[52:55]
    ds_read_b128 v[240:243], v2 offset:16384
    v_mfma_f32_16x16x32_bf16 v[56:59], v[188:191], v[160:163], v[56:59]
    ds_read_b128 v[244:247], v2 offset:17408
    v_mfma_f32_16x16x32_bf16 v[60:63], v[188:191], v[164:167], v[60:63]
    v_mfma_f32_16x16x32_bf16 v[64:67], v[192:195], v[160:163], v[64:67]
    v_mfma_f32_16x16x32_bf16 v[68:71], v[192:195], v[164:167], v[68:71]
    v_mfma_f32_16x16x32_bf16 v[72:75], v[196:199], v[160:163], v[72:75]
    v_mfma_f32_16x16x32_bf16 v[76:79], v[196:199], v[164:167], v[76:79]
    v_mfma_f32_16x16x32_bf16 v[80:83], v[200:203], v[160:163], v[80:83]
    v_mfma_f32_16x16x32_bf16 v[84:87], v[200:203], v[164:167], v[84:87]
    s_waitcnt lgkmcnt(0)
    s_barrier
    v_mfma_f32_16x16x32_bf16 v[16:19], v[212:215], v[204:207], v[16:19]
    ds_read_b128 v[160:163], v5 offset:36864
    v_mfma_f32_16x16x32_bf16 v[20:23], v[212:215], v[208:211], v[20:23]
    ds_read_b128 v[164:167], v5 offset:38912
    v_mfma_f32_16x16x32_bf16 v[24:27], v[216:219], v[204:207], v[24:27]
    ds_read_b128 v[168:171], v2 offset:36864
    v_mfma_f32_16x16x32_bf16 v[28:31], v[216:219], v[208:211], v[28:31]
    ds_read_b128 v[172:175], v2 offset:37888
    v_mfma_f32_16x16x32_bf16 v[32:35], v[220:223], v[204:207], v[32:35]
    ds_read_b128 v[176:179], v2 offset:38912
    v_mfma_f32_16x16x32_bf16 v[36:39], v[220:223], v[208:211], v[36:39]
    ds_read_b128 v[180:183], v2 offset:39936
    v_mfma_f32_16x16x32_bf16 v[40:43], v[224:227], v[204:207], v[40:43]
    ds_read_b128 v[184:187], v2 offset:40960
    v_mfma_f32_16x16x32_bf16 v[44:47], v[224:227], v[208:211], v[44:47]
    ds_read_b128 v[188:191], v2 offset:41984
    v_mfma_f32_16x16x32_bf16 v[48:51], v[228:231], v[204:207], v[48:51]
    ds_read_b128 v[192:195], v2 offset:43008
    v_mfma_f32_16x16x32_bf16 v[52:55], v[228:231], v[208:211], v[52:55]
    ds_read_b128 v[196:199], v2 offset:44032
    v_mfma_f32_16x16x32_bf16 v[56:59], v[232:235], v[204:207], v[56:59]
    ds_read_b128 v[200:203], v2 offset:45056
    v_mfma_f32_16x16x32_bf16 v[60:63], v[232:235], v[208:211], v[60:63]
    v_mfma_f32_16x16x32_bf16 v[64:67], v[236:239], v[204:207], v[64:67]
    v_mfma_f32_16x16x32_bf16 v[68:71], v[236:239], v[208:211], v[68:71]
    v_mfma_f32_16x16x32_bf16 v[72:75], v[240:243], v[204:207], v[72:75]
    v_mfma_f32_16x16x32_bf16 v[76:79], v[240:243], v[208:211], v[76:79]
    v_mfma_f32_16x16x32_bf16 v[80:83], v[244:247], v[204:207], v[80:83]
    v_mfma_f32_16x16x32_bf16 v[84:87], v[244:247], v[208:211], v[84:87]
    s_waitcnt lgkmcnt(5)
    v_mfma_f32_16x16x32_bf16 v[16:19], v[168:171], v[160:163], v[16:19]
    ds_read_b128 v[204:207], v6 offset:36864
    v_mfma_f32_16x16x32_bf16 v[20:23], v[168:171], v[164:167], v[20:23]
    ds_read_b128 v[208:211], v6 offset:38912
    v_mfma_f32_16x16x32_bf16 v[24:27], v[172:175], v[160:163], v[24:27]
    ds_read_b128 v[212:215], v2 offset:46080
    v_mfma_f32_16x16x32_bf16 v[28:31], v[172:175], v[164:167], v[28:31]
    ds_read_b128 v[216:219], v2 offset:47104
    v_mfma_f32_16x16x32_bf16 v[32:35], v[176:179], v[160:163], v[32:35]
    ds_read_b128 v[220:223], v2 offset:48128
    v_mfma_f32_16x16x32_bf16 v[36:39], v[176:179], v[164:167], v[36:39]
    ds_read_b128 v[224:227], v2 offset:49152
    v_mfma_f32_16x16x32_bf16 v[40:43], v[180:183], v[160:163], v[40:43]
    ds_read_b128 v[228:231], v2 offset:50176
    v_mfma_f32_16x16x32_bf16 v[44:47], v[180:183], v[164:167], v[44:47]
    ds_read_b128 v[232:235], v2 offset:51200
    s_waitcnt lgkmcnt(8)
    v_mfma_f32_16x16x32_bf16 v[48:51], v[184:187], v[160:163], v[48:51]
    ds_read_b128 v[236:239], v2 offset:52224
    v_mfma_f32_16x16x32_bf16 v[52:55], v[184:187], v[164:167], v[52:55]
    ds_read_b128 v[240:243], v2 offset:53248
    v_mfma_f32_16x16x32_bf16 v[56:59], v[188:191], v[160:163], v[56:59]
    ds_read_b128 v[244:247], v2 offset:54272
    v_mfma_f32_16x16x32_bf16 v[60:63], v[188:191], v[164:167], v[60:63]
    v_mfma_f32_16x16x32_bf16 v[64:67], v[192:195], v[160:163], v[64:67]
    v_mfma_f32_16x16x32_bf16 v[68:71], v[192:195], v[164:167], v[68:71]
    v_mfma_f32_16x16x32_bf16 v[72:75], v[196:199], v[160:163], v[72:75]
    v_mfma_f32_16x16x32_bf16 v[76:79], v[196:199], v[164:167], v[76:79]
    v_mfma_f32_16x16x32_bf16 v[80:83], v[200:203], v[160:163], v[80:83]
    v_mfma_f32_16x16x32_bf16 v[84:87], v[200:203], v[164:167], v[84:87]
    s_waitcnt lgkmcnt(0)
    s_barrier
    v_mfma_f32_16x16x32_bf16 v[16:19], v[212:215], v[204:207], v[16:19]
    ds_read_b128 v[160:163], v3 offset:0
    v_mfma_f32_16x16x32_bf16 v[20:23], v[212:215], v[208:211], v[20:23]
    ds_read_b128 v[164:167], v3 offset:2048
    v_mfma_f32_16x16x32_bf16 v[24:27], v[216:219], v[204:207], v[24:27]
    ds_read_b128 v[168:171], v1 offset:0
    v_mfma_f32_16x16x32_bf16 v[28:31], v[216:219], v[208:211], v[28:31]
    ds_read_b128 v[172:175], v1 offset:1024
    v_mfma_f32_16x16x32_bf16 v[32:35], v[220:223], v[204:207], v[32:35]
    ds_read_b128 v[176:179], v1 offset:2048
    v_mfma_f32_16x16x32_bf16 v[36:39], v[220:223], v[208:211], v[36:39]
    ds_read_b128 v[180:183], v1 offset:3072
    v_mfma_f32_16x16x32_bf16 v[40:43], v[224:227], v[204:207], v[40:43]
    ds_read_b128 v[184:187], v1 offset:4096
    v_mfma_f32_16x16x32_bf16 v[44:47], v[224:227], v[208:211], v[44:47]
    ds_read_b128 v[188:191], v1 offset:5120
    v_mfma_f32_16x16x32_bf16 v[48:51], v[228:231], v[204:207], v[48:51]
    ds_read_b128 v[192:195], v1 offset:6144
    v_mfma_f32_16x16x32_bf16 v[52:55], v[228:231], v[208:211], v[52:55]
    ds_read_b128 v[196:199], v1 offset:7168
    v_mfma_f32_16x16x32_bf16 v[56:59], v[232:235], v[204:207], v[56:59]
    ds_read_b128 v[200:203], v1 offset:8192
    v_mfma_f32_16x16x32_bf16 v[60:63], v[232:235], v[208:211], v[60:63]
    v_mfma_f32_16x16x32_bf16 v[64:67], v[236:239], v[204:207], v[64:67]
    v_mfma_f32_16x16x32_bf16 v[68:71], v[236:239], v[208:211], v[68:71]
    v_mfma_f32_16x16x32_bf16 v[72:75], v[240:243], v[204:207], v[72:75]
    v_mfma_f32_16x16x32_bf16 v[76:79], v[240:243], v[208:211], v[76:79]
    v_mfma_f32_16x16x32_bf16 v[80:83], v[244:247], v[204:207], v[80:83]
    v_mfma_f32_16x16x32_bf16 v[84:87], v[244:247], v[208:211], v[84:87]
    s_waitcnt lgkmcnt(5)
    v_mfma_f32_16x16x32_bf16 v[16:19], v[168:171], v[160:163], v[16:19]
    ds_read_b128 v[204:207], v4 offset:0
    v_mfma_f32_16x16x32_bf16 v[20:23], v[168:171], v[164:167], v[20:23]
    ds_read_b128 v[208:211], v4 offset:2048
    v_mfma_f32_16x16x32_bf16 v[24:27], v[172:175], v[160:163], v[24:27]
    ds_read_b128 v[212:215], v1 offset:9216
    v_mfma_f32_16x16x32_bf16 v[28:31], v[172:175], v[164:167], v[28:31]
    ds_read_b128 v[216:219], v1 offset:10240
    v_mfma_f32_16x16x32_bf16 v[32:35], v[176:179], v[160:163], v[32:35]
    ds_read_b128 v[220:223], v1 offset:11264
    v_mfma_f32_16x16x32_bf16 v[36:39], v[176:179], v[164:167], v[36:39]
    ds_read_b128 v[224:227], v1 offset:12288
    v_mfma_f32_16x16x32_bf16 v[40:43], v[180:183], v[160:163], v[40:43]
    ds_read_b128 v[228:231], v1 offset:13312
    v_mfma_f32_16x16x32_bf16 v[44:47], v[180:183], v[164:167], v[44:47]
    ds_read_b128 v[232:235], v1 offset:14336
    s_waitcnt lgkmcnt(8)
    v_mfma_f32_16x16x32_bf16 v[48:51], v[184:187], v[160:163], v[48:51]
    ds_read_b128 v[236:239], v1 offset:15360
    v_mfma_f32_16x16x32_bf16 v[52:55], v[184:187], v[164:167], v[52:55]
    ds_read_b128 v[240:243], v1 offset:16384
    v_mfma_f32_16x16x32_bf16 v[56:59], v[188:191], v[160:163], v[56:59]
    ds_read_b128 v[244:247], v1 offset:17408
    v_mfma_f32_16x16x32_bf16 v[60:63], v[188:191], v[164:167], v[60:63]
    v_mfma_f32_16x16x32_bf16 v[64:67], v[192:195], v[160:163], v[64:67]
    v_mfma_f32_16x16x32_bf16 v[68:71], v[192:195], v[164:167], v[68:71]
    v_mfma_f32_16x16x32_bf16 v[72:75], v[196:199], v[160:163], v[72:75]
    v_mfma_f32_16x16x32_bf16 v[76:79], v[196:199], v[164:167], v[76:79]
    v_mfma_f32_16x16x32_bf16 v[80:83], v[200:203], v[160:163], v[80:83]
    v_mfma_f32_16x16x32_bf16 v[84:87], v[200:203], v[164:167], v[84:87]
    s_waitcnt lgkmcnt(0)
    s_barrier
    v_mfma_f32_16x16x32_bf16 v[16:19], v[212:215], v[204:207], v[16:19]
    ds_read_b128 v[160:163], v3 offset:36864
    v_mfma_f32_16x16x32_bf16 v[20:23], v[212:215], v[208:211], v[20:23]
    ds_read_b128 v[164:167], v3 offset:38912
    v_mfma_f32_16x16x32_bf16 v[24:27], v[216:219], v[204:207], v[24:27]
    ds_read_b128 v[168:171], v1 offset:36864
    v_mfma_f32_16x16x32_bf16 v[28:31], v[216:219], v[208:211], v[28:31]
    ds_read_b128 v[172:175], v1 offset:37888
    v_mfma_f32_16x16x32_bf16 v[32:35], v[220:223], v[204:207], v[32:35]
    ds_read_b128 v[176:179], v1 offset:38912
    v_mfma_f32_16x16x32_bf16 v[36:39], v[220:223], v[208:211], v[36:39]
    ds_read_b128 v[180:183], v1 offset:39936
    v_mfma_f32_16x16x32_bf16 v[40:43], v[224:227], v[204:207], v[40:43]
    ds_read_b128 v[184:187], v1 offset:40960
    v_mfma_f32_16x16x32_bf16 v[44:47], v[224:227], v[208:211], v[44:47]
    ds_read_b128 v[188:191], v1 offset:41984
    v_mfma_f32_16x16x32_bf16 v[48:51], v[228:231], v[204:207], v[48:51]
    ds_read_b128 v[192:195], v1 offset:43008
    v_mfma_f32_16x16x32_bf16 v[52:55], v[228:231], v[208:211], v[52:55]
    ds_read_b128 v[196:199], v1 offset:44032
    v_mfma_f32_16x16x32_bf16 v[56:59], v[232:235], v[204:207], v[56:59]
    ds_read_b128 v[200:203], v1 offset:45056
    v_mfma_f32_16x16x32_bf16 v[60:63], v[232:235], v[208:211], v[60:63]
    v_mfma_f32_16x16x32_bf16 v[64:67], v[236:239], v[204:207], v[64:67]
    v_mfma_f32_16x16x32_bf16 v[68:71], v[236:239], v[208:211], v[68:71]
    v_mfma_f32_16x16x32_bf16 v[72:75], v[240:243], v[204:207], v[72:75]
    v_mfma_f32_16x16x32_bf16 v[76:79], v[240:243], v[208:211], v[76:79]
    v_mfma_f32_16x16x32_bf16 v[80:83], v[244:247], v[204:207], v[80:83]
    v_mfma_f32_16x16x32_bf16 v[84:87], v[244:247], v[208:211], v[84:87]
    s_waitcnt lgkmcnt(5)
    v_mfma_f32_16x16x32_bf16 v[16:19], v[168:171], v[160:163], v[16:19]
    ds_read_b128 v[204:207], v4 offset:36864
    v_mfma_f32_16x16x32_bf16 v[20:23], v[168:171], v[164:167], v[20:23]
    ds_read_b128 v[208:211], v4 offset:38912
    v_mfma_f32_16x16x32_bf16 v[24:27], v[172:175], v[160:163], v[24:27]
    ds_read_b128 v[212:215], v1 offset:46080
    v_mfma_f32_16x16x32_bf16 v[28:31], v[172:175], v[164:167], v[28:31]
    ds_read_b128 v[216:219], v1 offset:47104
    v_mfma_f32_16x16x32_bf16 v[32:35], v[176:179], v[160:163], v[32:35]
    ds_read_b128 v[220:223], v1 offset:48128
    v_mfma_f32_16x16x32_bf16 v[36:39], v[176:179], v[164:167], v[36:39]
    ds_read_b128 v[224:227], v1 offset:49152
    v_mfma_f32_16x16x32_bf16 v[40:43], v[180:183], v[160:163], v[40:43]
    ds_read_b128 v[228:231], v1 offset:50176
    v_mfma_f32_16x16x32_bf16 v[44:47], v[180:183], v[164:167], v[44:47]
    ds_read_b128 v[232:235], v1 offset:51200
    s_waitcnt lgkmcnt(8)
    v_mfma_f32_16x16x32_bf16 v[48:51], v[184:187], v[160:163], v[48:51]
    ds_read_b128 v[236:239], v1 offset:52224
    v_mfma_f32_16x16x32_bf16 v[52:55], v[184:187], v[164:167], v[52:55]
    ds_read_b128 v[240:243], v1 offset:53248
    v_mfma_f32_16x16x32_bf16 v[56:59], v[188:191], v[160:163], v[56:59]
    ds_read_b128 v[244:247], v1 offset:54272
    v_mfma_f32_16x16x32_bf16 v[60:63], v[188:191], v[164:167], v[60:63]
    v_mfma_f32_16x16x32_bf16 v[64:67], v[192:195], v[160:163], v[64:67]
    v_mfma_f32_16x16x32_bf16 v[68:71], v[192:195], v[164:167], v[68:71]
    v_mfma_f32_16x16x32_bf16 v[72:75], v[196:199], v[160:163], v[72:75]
    v_mfma_f32_16x16x32_bf16 v[76:79], v[196:199], v[164:167], v[76:79]
    v_mfma_f32_16x16x32_bf16 v[80:83], v[200:203], v[160:163], v[80:83]
    v_mfma_f32_16x16x32_bf16 v[84:87], v[200:203], v[164:167], v[84:87]
    s_waitcnt lgkmcnt(0)
    v_mfma_f32_16x16x32_bf16 v[16:19], v[212:215], v[204:207], v[16:19]
    v_mfma_f32_16x16x32_bf16 v[20:23], v[212:215], v[208:211], v[20:23]
    v_mfma_f32_16x16x32_bf16 v[24:27], v[216:219], v[204:207], v[24:27]
    v_mfma_f32_16x16x32_bf16 v[28:31], v[216:219], v[208:211], v[28:31]
    v_mfma_f32_16x16x32_bf16 v[32:35], v[220:223], v[204:207], v[32:35]
    v_mfma_f32_16x16x32_bf16 v[36:39], v[220:223], v[208:211], v[36:39]
    v_mfma_f32_16x16x32_bf16 v[40:43], v[224:227], v[204:207], v[40:43]
    v_mfma_f32_16x16x32_bf16 v[44:47], v[224:227], v[208:211], v[44:47]
    v_mfma_f32_16x16x32_bf16 v[48:51], v[228:231], v[204:207], v[48:51]
    v_mfma_f32_16x16x32_bf16 v[52:55], v[228:231], v[208:211], v[52:55]
    v_mfma_f32_16x16x32_bf16 v[56:59], v[232:235], v[204:207], v[56:59]
    v_mfma_f32_16x16x32_bf16 v[60:63], v[232:235], v[208:211], v[60:63]
    v_mfma_f32_16x16x32_bf16 v[64:67], v[236:239], v[204:207], v[64:67]
    v_mfma_f32_16x16x32_bf16 v[68:71], v[236:239], v[208:211], v[68:71]
    v_mfma_f32_16x16x32_bf16 v[72:75], v[240:243], v[204:207], v[72:75]
    v_mfma_f32_16x16x32_bf16 v[76:79], v[240:243], v[208:211], v[76:79]
    v_mfma_f32_16x16x32_bf16 v[80:83], v[244:247], v[204:207], v[80:83]
    v_mfma_f32_16x16x32_bf16 v[84:87], v[244:247], v[208:211], v[84:87]
    v_pk_mul_f32 v[16:17], v[16:17], v[88:89]
    v_pk_mul_f32 v[18:19], v[18:19], v[90:91]
    v_pk_mul_f32 v[24:25], v[24:25], v[96:97]
    v_pk_mul_f32 v[26:27], v[26:27], v[98:99]
    v_cvt_pk_bf16_f32 v160, v16, v17
    v_cvt_pk_bf16_f32 v161, v18, v19
    v_cvt_pk_bf16_f32 v162, v24, v25
    v_cvt_pk_bf16_f32 v163, v26, v27
    buffer_store_dwordx4 v[160:163], v14, s[4:7], s39 offen offset:0 sc1
    v_pk_mul_f32 v[20:21], v[20:21], v[92:93]
    v_pk_mul_f32 v[22:23], v[22:23], v[94:95]
    v_pk_mul_f32 v[28:29], v[28:29], v[100:101]
    v_pk_mul_f32 v[30:31], v[30:31], v[102:103]
    v_cvt_pk_bf16_f32 v164, v20, v21
    v_cvt_pk_bf16_f32 v165, v22, v23
    v_cvt_pk_bf16_f32 v166, v28, v29
    v_cvt_pk_bf16_f32 v167, v30, v31
    buffer_store_dwordx4 v[164:167], v14, s[4:7], s40 offen offset:0 sc1
    v_pk_mul_f32 v[32:33], v[32:33], v[104:105]
    v_pk_mul_f32 v[34:35], v[34:35], v[106:107]
    v_pk_mul_f32 v[40:41], v[40:41], v[112:113]
    v_pk_mul_f32 v[42:43], v[42:43], v[114:115]
    v_cvt_pk_bf16_f32 v168, v32, v33
    v_cvt_pk_bf16_f32 v169, v34, v35
    v_cvt_pk_bf16_f32 v170, v40, v41
    v_cvt_pk_bf16_f32 v171, v42, v43
    buffer_store_dwordx4 v[168:171], v14, s[4:7], s39 offen offset:1024 sc1
    v_pk_mul_f32 v[36:37], v[36:37], v[108:109]
    v_pk_mul_f32 v[38:39], v[38:39], v[110:111]
    v_pk_mul_f32 v[44:45], v[44:45], v[116:117]
    v_pk_mul_f32 v[46:47], v[46:47], v[118:119]
    v_cvt_pk_bf16_f32 v172, v36, v37
    v_cvt_pk_bf16_f32 v173, v38, v39
    v_cvt_pk_bf16_f32 v174, v44, v45
    v_cvt_pk_bf16_f32 v175, v46, v47
    buffer_store_dwordx4 v[172:175], v14, s[4:7], s40 offen offset:1024 sc1
    v_pk_mul_f32 v[48:49], v[48:49], v[120:121]
    v_pk_mul_f32 v[50:51], v[50:51], v[122:123]
    v_pk_mul_f32 v[56:57], v[56:57], v[128:129]
    v_pk_mul_f32 v[58:59], v[58:59], v[130:131]
    v_cvt_pk_bf16_f32 v176, v48, v49
    v_cvt_pk_bf16_f32 v177, v50, v51
    v_cvt_pk_bf16_f32 v178, v56, v57
    v_cvt_pk_bf16_f32 v179, v58, v59
    buffer_store_dwordx4 v[176:179], v14, s[4:7], s39 offen offset:2048 sc1
    v_pk_mul_f32 v[52:53], v[52:53], v[124:125]
    v_pk_mul_f32 v[54:55], v[54:55], v[126:127]
    v_pk_mul_f32 v[60:61], v[60:61], v[132:133]
    v_pk_mul_f32 v[62:63], v[62:63], v[134:135]
    v_cvt_pk_bf16_f32 v180, v52, v53
    v_cvt_pk_bf16_f32 v181, v54, v55
    v_cvt_pk_bf16_f32 v182, v60, v61
    v_cvt_pk_bf16_f32 v183, v62, v63
    buffer_store_dwordx4 v[180:183], v14, s[4:7], s40 offen offset:2048 sc1
    v_pk_mul_f32 v[64:65], v[64:65], v[136:137]
    v_pk_mul_f32 v[66:67], v[66:67], v[138:139]
    v_pk_mul_f32 v[72:73], v[72:73], v[144:145]
    v_pk_mul_f32 v[74:75], v[74:75], v[146:147]
    v_cvt_pk_bf16_f32 v184, v64, v65
    v_cvt_pk_bf16_f32 v185, v66, v67
    v_cvt_pk_bf16_f32 v186, v72, v73
    v_cvt_pk_bf16_f32 v187, v74, v75
    buffer_store_dwordx4 v[184:187], v14, s[4:7], s39 offen offset:3072 sc1
    v_pk_mul_f32 v[68:69], v[68:69], v[140:141]
    v_pk_mul_f32 v[70:71], v[70:71], v[142:143]
    v_pk_mul_f32 v[76:77], v[76:77], v[148:149]
    v_pk_mul_f32 v[78:79], v[78:79], v[150:151]
    v_cvt_pk_bf16_f32 v188, v68, v69
    v_cvt_pk_bf16_f32 v189, v70, v71
    v_cvt_pk_bf16_f32 v190, v76, v77
    v_cvt_pk_bf16_f32 v191, v78, v79
    buffer_store_dwordx4 v[188:191], v14, s[4:7], s40 offen offset:3072 sc1
    v_pk_mul_f32 v[80:81], v[80:81], v[152:153]
    v_pk_mul_f32 v[82:83], v[82:83], v[154:155]
    v_cvt_pk_bf16_f32 v192, v80, v81
    v_cvt_pk_bf16_f32 v193, v82, v83
    buffer_store_dwordx2 v[192:193], v15, s[4:7], s39 offen sc1
    v_pk_mul_f32 v[84:85], v[84:85], v[156:157]
    v_pk_mul_f32 v[86:87], v[86:87], v[158:159]
    v_cvt_pk_bf16_f32 v196, v84, v85
    v_cvt_pk_bf16_f32 v197, v86, v87
    buffer_store_dwordx2 v[196:197], v15, s[4:7], s40 offen sc1
    s_and_b32 s25, s2, 7
    s_lshr_b32 s26, s2, 3
    s_lshl_b32 s23, s25, 2
    s_lshr_b32 s27, s26, 3
    s_add_u32 s23, s23, s27
    s_and_b32 s24, s26, 7
    s_add_u32 s25, s23, s24
    s_and_b32 s25, s25, 3
    s_lshl_b32 s30, s23, 2
    s_add_u32 s30, s30, s20
    s_mul_i32 s29, s30, 73728
    s_add_u32 s29, s29, s21
    s_add_u32 s29, s29, 0x1200000
    s_mul_i32 s34, s30, 18432
    s_add_u32 s34, s34, s21
    s_add_u32 s34, s34, 0x300000
    s_lshl_b32 s35, s24, 11
    s_lshr_b32 s36, s24, 2
    s_lshl_b32 s36, s36, 10
    s_and_b32 s37, s24, 3
    s_lshl_b32 s37, s37, 8
    s_add_u32 s36, s36, s37
    s_add_u32 s36, s36, 16384
    v_bfe_u32 v2, v1, 4, 4
    v_lshrrev_b32 v3, 8, v1
    v_add_u32 v4, s35, v1
    v_lshlrev_b32 v5, 4, v2
    v_lshl_add_u32 v5, v3, 3, v5
    v_add_u32 v5, s36, v5
    v_cmp_gt_u32 s[40:41], 2, v3
    v_bfrev_b32 v6, 1
    v_add_u32 v12, 0, v1
    v_add_u32 v13, 36864, v1
    v_add_u32 v14, 73728, v1
    v_add_u32 v15, 110592, v1
    v_cndmask_b32 v5, v6, v5, s[40:41]
    buffer_load_dwordx4 v[208:211], v4, s[4:7], s34 offen offset:0 sc1
    buffer_load_dwordx4 v[212:215], v4, s[4:7], s34 offen offset:1024 sc1
    buffer_load_dwordx2 v[216:217], v5, s[4:7], s34 offen sc1
    s_add_u32 s34, s34, 0x1900000
    s_lshl_b32 s39, s30, 10
    s_add_u32 s39, s39, s21
    s_lshl_b32 s42, s24, 7
    s_add_u32 s39, s39, s42
    s_add_u32 s39, s39, 0x3700000
    v_cmp_eq_u32 vcc, 0, v3
    v_lshlrev_b32 v10, 3, v2
    v_mov_b32 v11, 0x3f803f80
    v_lshrrev_b32 v7, 1, v1
    v_cndmask_b32 v10, v6, v10, vcc
    s_cmp_eq_u32 s22, 0
    s_cbranch_scc1 L_p5_nf
    v_mul_u32_u24 v9, 1152, v2
    s_mul_i32 s34, s30, 18432
    s_mul_i32 s42, s24, 144
    s_add_u32 s34, s34, s42
    v_lshl_add_u32 v4, v3, 4, v9
    v_lshl_add_u32 v5, v3, 3, v9
    v_cndmask_b32 v5, v6, v5, s[40:41]
L_p5_nf:
    s_lshr_b32 s44, s23, 1
    s_lshl_b32 s52, s22, 7
    s_add_u32 s52, s52, s44
    s_lshl_b32 s52, s52, 8
    s_add_u32 s52, s52, 0x450a000
    s_add_u32 s52, s52, s4
    s_addc_u32 s53, s5, 0
    s_waitcnt vmcnt(3)
    s_barrier
    s_cmp_lg_u32 s20, 0
    s_cbranch_scc1 L_ns_d5
    s_mov_b32 s56, 1
    s_atomic_add s56, s[50:51], 0
L_ns_d5:
    s_cmp_lg_u32 s20, 0
    s_cbranch_scc1 L_pd_d5
    s_mov_b32 s60, 65536
L_poll_d5:
    s_mov_b32 s57, 0
    s_atomic_add s57, s[52:53], 0 glc
    s_waitcnt lgkmcnt(0)
    s_cmp_ge_u32 s57, 16
    s_cbranch_scc1 L_pd_d5
    s_sub_u32 s60, s60, 1
    s_cbranch_scc1 L_pd_d5
    s_sleep 2
    s_branch L_poll_d5
L_pd_d5:
    s_barrier
    s_mov_b32 s32, 0
    s_lshl_b32 s32, s32, 13
    s_add_u32 s32, s32, s29
    s_add_u32 s33, s32, 4096
    buffer_load_dwordx4 v[112:115], v1, s[4:7], s32 offen offset:0 sc1
    buffer_load_dwordx4 v[116:119], v1, s[4:7], s32 offen offset:1024 sc1
    buffer_load_dwordx4 v[120:123], v1, s[4:7], s32 offen offset:2048 sc1
    buffer_load_dwordx4 v[124:127], v1, s[4:7], s32 offen offset:3072 sc1
    buffer_load_dwordx4 v[128:131], v1, s[4:7], s33 offen offset:0 sc1
    buffer_load_dwordx4 v[132:135], v1, s[4:7], s33 offen offset:1024 sc1
    buffer_load_dwordx4 v[136:139], v1, s[4:7], s33 offen offset:2048 sc1
    buffer_load_dwordx4 v[140:143], v1, s[4:7], s33 offen offset:3072 sc1
    ds_read_b128 v[40:43], v14 offset:0
    ds_read_b128 v[44:47], v14 offset:1024
    ds_read_b128 v[48:51], v14 offset:2048
    ds_read_b128 v[52:55], v14 offset:3072
    ds_read_b128 v[72:75], v14 offset:8192
    ds_read_b128 v[56:59], v14 offset:4096
    ds_read_b128 v[60:63], v14 offset:5120
    ds_read_b128 v[64:67], v14 offset:6144
    ds_read_b128 v[68:71], v14 offset:7168
    s_mov_b32 s32, 1
    s_lshl_b32 s32, s32, 13
    s_add_u32 s32, s32, s29
    s_add_u32 s33, s32, 4096
    buffer_load_dwordx4 v[144:147], v1, s[4:7], s32 offen offset:0 sc1
    buffer_load_dwordx4 v[148:151], v1, s[4:7], s32 offen offset:1024 sc1
    buffer_load_dwordx4 v[152:155], v1, s[4:7], s32 offen offset:2048 sc1
    buffer_load_dwordx4 v[156:159], v1, s[4:7], s32 offen offset:3072 sc1
    buffer_load_dwordx4 v[160:163], v1, s[4:7], s33 offen offset:0 sc1
    buffer_load_dwordx4 v[164:167], v1, s[4:7], s33 offen offset:1024 sc1
    buffer_load_dwordx4 v[168:171], v1, s[4:7], s33 offen offset:2048 sc1
    buffer_load_dwordx4 v[172:175], v1, s[4:7], s33 offen offset:3072 sc1
    s_lshl_b32 s50, s22, 7
    s_add_u32 s50, s50, s44
    s_lshl_b32 s50, s50, 8
    s_add_u32 s50, s50, 0x450b000
    s_add_u32 s50, s50, s4
    s_addc_u32 s51, s5, 0
    s_waitcnt vmcnt(16)
    v_lshlrev_b32 v16, 16, v208
    v_and_b32 v17, 0xffff0000, v208
    v_lshlrev_b32 v18, 16, v209
    v_and_b32 v19, 0xffff0000, v209
    v_lshlrev_b32 v20, 16, v210
    v_and_b32 v21, 0xffff0000, v210
    v_lshlrev_b32 v22, 16, v211
    v_and_b32 v23, 0xffff0000, v211
    v_lshlrev_b32 v24, 16, v212
    v_and_b32 v25, 0xffff0000, v212
    v_lshlrev_b32 v26, 16, v213
    v_and_b32 v27, 0xffff0000, v213
    v_lshlrev_b32 v28, 16, v214
    v_and_b32 v29, 0xffff0000, v214
    v_lshlrev_b32 v30, 16, v215
    v_and_b32 v31, 0xffff0000, v215
    v_lshlrev_b32 v32, 16, v216
    v_and_b32 v33, 0xffff0000, v216
    v_lshlrev_b32 v34, 16, v217
    v_and_b32 v35, 0xffff0000, v217
    s_waitcnt vmcnt(14) lgkmcnt(4)
    v_mfma_f32_16x16x32_bf16 v[16:19], v[40:43], v[112:115], v[16:19]
    ds_read_b128 v[76:79], v14 offset:9216
    s_mov_b32 s32, 2
    s_lshl_b32 s32, s32, 13
    s_add_u32 s32, s32, s29
    s_add_u32 s33, s32, 4096
    v_mfma_f32_16x16x32_bf16 v[20:23], v[44:47], v[112:115], v[20:23]
    ds_read_b128 v[80:83], v14 offset:10240
    v_mfma_f32_16x16x32_bf16 v[24:27], v[48:51], v[112:115], v[24:27]
    ds_read_b128 v[84:87], v14 offset:11264
    buffer_load_dwordx4 v[176:179], v1, s[4:7], s32 offen offset:0 sc1
    v_mfma_f32_16x16x32_bf16 v[28:31], v[52:55], v[112:115], v[28:31]
    ds_read_b128 v[88:91], v14 offset:12288
    v_mfma_f32_16x16x32_bf16 v[32:35], v[72:75], v[112:115], v[32:35]
    ds_read_b128 v[108:111], v14 offset:17408
    s_waitcnt lgkmcnt(5)
    v_mfma_f32_16x16x32_bf16 v[16:19], v[56:59], v[116:119], v[16:19]
    ds_read_b128 v[92:95], v14 offset:13312
    v_mfma_f32_16x16x32_bf16 v[20:23], v[60:63], v[116:119], v[20:23]
    ds_read_b128 v[96:99], v14 offset:14336
    buffer_load_dwordx4 v[180:183], v1, s[4:7], s32 offen offset:1024 sc1
    v_mfma_f32_16x16x32_bf16 v[24:27], v[64:67], v[116:119], v[24:27]
    ds_read_b128 v[100:103], v14 offset:15360
    v_mfma_f32_16x16x32_bf16 v[28:31], v[68:71], v[116:119], v[28:31]
    ds_read_b128 v[104:107], v14 offset:16384
    v_mfma_f32_16x16x32_bf16 v[36:39], v[72:75], v[116:119], 0
    s_waitcnt vmcnt(14) lgkmcnt(4)
    v_mfma_f32_16x16x32_bf16 v[16:19], v[76:79], v[120:123], v[16:19]
    ds_read_b128 v[40:43], v14 offset:18432
    v_mfma_f32_16x16x32_bf16 v[20:23], v[80:83], v[120:123], v[20:23]
    ds_read_b128 v[44:47], v14 offset:19456
    v_mfma_f32_16x16x32_bf16 v[24:27], v[84:87], v[120:123], v[24:27]
    ds_read_b128 v[48:51], v14 offset:20480
    buffer_load_dwordx4 v[184:187], v1, s[4:7], s32 offen offset:2048 sc1
    v_mfma_f32_16x16x32_bf16 v[28:31], v[88:91], v[120:123], v[28:31]
    ds_read_b128 v[52:55], v14 offset:21504
    v_mfma_f32_16x16x32_bf16 v[32:35], v[108:111], v[120:123], v[32:35]
    ds_read_b128 v[72:75], v14 offset:26624
    s_waitcnt lgkmcnt(5)
    v_mfma_f32_16x16x32_bf16 v[16:19], v[92:95], v[124:127], v[16:19]
    ds_read_b128 v[56:59], v14 offset:22528
    v_mfma_f32_16x16x32_bf16 v[20:23], v[96:99], v[124:127], v[20:23]
    ds_read_b128 v[60:63], v14 offset:23552
    buffer_load_dwordx4 v[188:191], v1, s[4:7], s32 offen offset:3072 sc1
    v_mfma_f32_16x16x32_bf16 v[24:27], v[100:103], v[124:127], v[24:27]
    ds_read_b128 v[64:67], v14 offset:24576
    v_mfma_f32_16x16x32_bf16 v[28:31], v[104:107], v[124:127], v[28:31]
    ds_read_b128 v[68:71], v14 offset:25600
    v_mfma_f32_16x16x32_bf16 v[36:39], v[108:111], v[124:127], v[36:39]
    s_waitcnt vmcnt(14) lgkmcnt(4)
    v_mfma_f32_16x16x32_bf16 v[16:19], v[40:43], v[128:131], v[16:19]
    ds_read_b128 v[76:79], v14 offset:27648
    v_mfma_f32_16x16x32_bf16 v[20:23], v[44:47], v[128:131], v[20:23]
    ds_read_b128 v[80:83], v14 offset:28672
    v_mfma_f32_16x16x32_bf16 v[24:27], v[48:51], v[128:131], v[24:27]
    ds_read_b128 v[84:87], v14 offset:29696
    buffer_load_dwordx4 v[192:195], v1, s[4:7], s33 offen offset:0 sc1
    v_mfma_f32_16x16x32_bf16 v[28:31], v[52:55], v[128:131], v[28:31]
    ds_read_b128 v[88:91], v14 offset:30720
    v_mfma_f32_16x16x32_bf16 v[32:35], v[72:75], v[128:131], v[32:35]
    ds_read_b128 v[108:111], v14 offset:35840
    s_waitcnt lgkmcnt(5)
    v_mfma_f32_16x16x32_bf16 v[16:19], v[56:59], v[132:135], v[16:19]
    ds_read_b128 v[92:95], v14 offset:31744
    v_mfma_f32_16x16x32_bf16 v[20:23], v[60:63], v[132:135], v[20:23]
    ds_read_b128 v[96:99], v14 offset:32768
    buffer_load_dwordx4 v[196:199], v1, s[4:7], s33 offen offset:1024 sc1
    v_mfma_f32_16x16x32_bf16 v[24:27], v[64:67], v[132:135], v[24:27]
    ds_read_b128 v[100:103], v14 offset:33792
    v_mfma_f32_16x16x32_bf16 v[28:31], v[68:71], v[132:135], v[28:31]
    ds_read_b128 v[104:107], v14 offset:34816
    v_mfma_f32_16x16x32_bf16 v[36:39], v[72:75], v[132:135], v[36:39]
    s_waitcnt vmcnt(14) lgkmcnt(0)
    s_barrier
    v_mfma_f32_16x16x32_bf16 v[16:19], v[76:79], v[136:139], v[16:19]
    ds_read_b128 v[40:43], v15 offset:0
    v_mfma_f32_16x16x32_bf16 v[20:23], v[80:83], v[136:139], v[20:23]
    ds_read_b128 v[44:47], v15 offset:1024
    v_mfma_f32_16x16x32_bf16 v[24:27], v[84:87], v[136:139], v[24:27]
    ds_read_b128 v[48:51], v15 offset:2048
    buffer_load_dwordx4 v[200:203], v1, s[4:7], s33 offen offset:2048 sc1
    v_mfma_f32_16x16x32_bf16 v[28:31], v[88:91], v[136:139], v[28:31]
    ds_read_b128 v[52:55], v15 offset:3072
    v_mfma_f32_16x16x32_bf16 v[32:35], v[108:111], v[136:139], v[32:35]
    ds_read_b128 v[72:75], v15 offset:8192
    v_mfma_f32_16x16x32_bf16 v[16:19], v[92:95], v[140:143], v[16:19]
    ds_read_b128 v[56:59], v15 offset:4096
    v_mfma_f32_16x16x32_bf16 v[20:23], v[96:99], v[140:143], v[20:23]
    ds_read_b128 v[60:63], v15 offset:5120
    buffer_load_dwordx4 v[204:207], v1, s[4:7], s33 offen offset:3072 sc1
    v_mfma_f32_16x16x32_bf16 v[24:27], v[100:103], v[140:143], v[24:27]
    ds_read_b128 v[64:67], v15 offset:6144
    v_mfma_f32_16x16x32_bf16 v[28:31], v[104:107], v[140:143], v[28:31]
    ds_read_b128 v[68:71], v15 offset:7168
    v_mfma_f32_16x16x32_bf16 v[36:39], v[108:111], v[140:143], v[36:39]
    s_waitcnt vmcnt(14) lgkmcnt(4)
    v_mfma_f32_16x16x32_bf16 v[16:19], v[40:43], v[144:147], v[16:19]
    ds_read_b128 v[76:79], v15 offset:9216
    s_mov_b32 s32, 3
    s_lshl_b32 s32, s32, 13
    s_add_u32 s32, s32, s29
    s_add_u32 s33, s32, 4096
    v_mfma_f32_16x16x32_bf16 v[20:23], v[44:47], v[144:147], v[20:23]
    ds_read_b128 v[80:83], v15 offset:10240
    v_mfma_f32_16x16x32_bf16 v[24:27], v[48:51], v[144:147], v[24:27]
    ds_read_b128 v[84:87], v15 offset:11264
    buffer_load_dwordx4 v[112:115], v1, s[4:7], s32 offen offset:0 sc1
    v_mfma_f32_16x16x32_bf16 v[28:31], v[52:55], v[144:147], v[28:31]
    ds_read_b128 v[88:91], v15 offset:12288
    v_mfma_f32_16x16x32_bf16 v[32:35], v[72:75], v[144:147], v[32:35]
    ds_read_b128 v[108:111], v15 offset:17408
    s_waitcnt lgkmcnt(5)
    v_mfma_f32_16x16x32_bf16 v[16:19], v[56:59], v[148:151], v[16:19]
    ds_read_b128 v[92:95], v15 offset:13312
    v_mfma_f32_16x16x32_bf16 v[20:23], v[60:63], v[148:151], v[20:23]
    ds_read_b128 v[96:99], v15 offset:14336
    buffer_load_dwordx4 v[116:119], v1, s[4:7], s32 offen offset:1024 sc1
    v_mfma_f32_16x16x32_bf16 v[24:27], v[64:67], v[148:151], v[24:27]
    ds_read_b128 v[100:103], v15 offset:15360
    v_mfma_f32_16x16x32_bf16 v[28:31], v[68:71], v[148:151], v[28:31]
    ds_read_b128 v[104:107], v15 offset:16384
    v_mfma_f32_16x16x32_bf16 v[36:39], v[72:75], v[148:151], v[36:39]
    s_waitcnt vmcnt(14) lgkmcnt(4)
    v_mfma_f32_16x16x32_bf16 v[16:19], v[76:79], v[152:155], v[16:19]
    ds_read_b128 v[40:43], v15 offset:18432
    v_mfma_f32_16x16x32_bf16 v[20:23], v[80:83], v[152:155], v[20:23]
    ds_read_b128 v[44:47], v15 offset:19456
    v_mfma_f32_16x16x32_bf16 v[24:27], v[84:87], v[152:155], v[24:27]
    ds_read_b128 v[48:51], v15 offset:20480
    buffer_load_dwordx4 v[120:123], v1, s[4:7], s32 offen offset:2048 sc1
    v_mfma_f32_16x16x32_bf16 v[28:31], v[88:91], v[152:155], v[28:31]
    ds_read_b128 v[52:55], v15 offset:21504
    v_mfma_f32_16x16x32_bf16 v[32:35], v[108:111], v[152:155], v[32:35]
    ds_read_b128 v[72:75], v15 offset:26624
    s_waitcnt lgkmcnt(5)
    v_mfma_f32_16x16x32_bf16 v[16:19], v[92:95], v[156:159], v[16:19]
    ds_read_b128 v[56:59], v15 offset:22528
    v_mfma_f32_16x16x32_bf16 v[20:23], v[96:99], v[156:159], v[20:23]
    ds_read_b128 v[60:63], v15 offset:23552
    buffer_load_dwordx4 v[124:127], v1, s[4:7], s32 offen offset:3072 sc1
    v_mfma_f32_16x16x32_bf16 v[24:27], v[100:103], v[156:159], v[24:27]
    ds_read_b128 v[64:67], v15 offset:24576
    v_mfma_f32_16x16x32_bf16 v[28:31], v[104:107], v[156:159], v[28:31]
    ds_read_b128 v[68:71], v15 offset:25600
    v_mfma_f32_16x16x32_bf16 v[36:39], v[108:111], v[156:159], v[36:39]
    s_waitcnt vmcnt(14) lgkmcnt(4)
    v_mfma_f32_16x16x32_bf16 v[16:19], v[40:43], v[160:163], v[16:19]
    ds_read_b128 v[76:79], v15 offset:27648
    v_mfma_f32_16x16x32_bf16 v[20:23], v[44:47], v[160:163], v[20:23]
    ds_read_b128 v[80:83], v15 offset:28672
    v_mfma_f32_16x16x32_bf16 v[24:27], v[48:51], v[160:163], v[24:27]
    ds_read_b128 v[84:87], v15 offset:29696
    buffer_load_dwordx4 v[128:131], v1, s[4:7], s33 offen offset:0 sc1
    v_mfma_f32_16x16x32_bf16 v[28:31], v[52:55], v[160:163], v[28:31]
    ds_read_b128 v[88:91], v15 offset:30720
    v_mfma_f32_16x16x32_bf16 v[32:35], v[72:75], v[160:163], v[32:35]
    ds_read_b128 v[108:111], v15 offset:35840
    s_waitcnt lgkmcnt(5)
    v_mfma_f32_16x16x32_bf16 v[16:19], v[56:59], v[164:167], v[16:19]
    ds_read_b128 v[92:95], v15 offset:31744
    v_mfma_f32_16x16x32_bf16 v[20:23], v[60:63], v[164:167], v[20:23]
    ds_read_b128 v[96:99], v15 offset:32768
    buffer_load_dwordx4 v[132:135], v1, s[4:7], s33 offen offset:1024 sc1
    v_mfma_f32_16x16x32_bf16 v[24:27], v[64:67], v[164:167], v[24:27]
    ds_read_b128 v[100:103], v15 offset:33792
    v_mfma_f32_16x16x32_bf16 v[28:31], v[68:71], v[164:167], v[28:31]
    ds_read_b128 v[104:107], v15 offset:34816
    v_mfma_f32_16x16x32_bf16 v[36:39], v[72:75], v[164:167], v[36:39]
    s_waitcnt vmcnt(14) lgkmcnt(0)
    s_barrier
    v_mfma_f32_16x16x32_bf16 v[16:19], v[76:79], v[168:171], v[16:19]
    ds_read_b128 v[40:43], v12 offset:0
    v_mfma_f32_16x16x32_bf16 v[20:23], v[80:83], v[168:171], v[20:23]
    ds_read_b128 v[44:47], v12 offset:1024
    v_mfma_f32_16x16x32_bf16 v[24:27], v[84:87], v[168:171], v[24:27]
    ds_read_b128 v[48:51], v12 offset:2048
    buffer_load_dwordx4 v[136:139], v1, s[4:7], s33 offen offset:2048 sc1
    v_mfma_f32_16x16x32_bf16 v[28:31], v[88:91], v[168:171], v[28:31]
    ds_read_b128 v[52:55], v12 offset:3072
    v_mfma_f32_16x16x32_bf16 v[32:35], v[108:111], v[168:171], v[32:35]
    ds_read_b128 v[72:75], v12 offset:8192
    v_mfma_f32_16x16x32_bf16 v[16:19], v[92:95], v[172:175], v[16:19]
    ds_read_b128 v[56:59], v12 offset:4096
    v_mfma_f32_16x16x32_bf16 v[20:23], v[96:99], v[172:175], v[20:23]
    ds_read_b128 v[60:63], v12 offset:5120
    buffer_load_dwordx4 v[140:143], v1, s[4:7], s33 offen offset:3072 sc1
    v_mfma_f32_16x16x32_bf16 v[24:27], v[100:103], v[172:175], v[24:27]
    ds_read_b128 v[64:67], v12 offset:6144
    v_mfma_f32_16x16x32_bf16 v[28:31], v[104:107], v[172:175], v[28:31]
    ds_read_b128 v[68:71], v12 offset:7168
    v_mfma_f32_16x16x32_bf16 v[36:39], v[108:111], v[172:175], v[36:39]
    s_waitcnt vmcnt(14) lgkmcnt(4)
    v_mfma_f32_16x16x32_bf16 v[16:19], v[40:43], v[176:179], v[16:19]
    ds_read_b128 v[76:79], v12 offset:9216
    s_mov_b32 s32, 4
    s_lshl_b32 s32, s32, 13
    s_add_u32 s32, s32, s29
    s_add_u32 s33, s32, 4096
    v_mfma_f32_16x16x32_bf16 v[20:23], v[44:47], v[176:179], v[20:23]
    ds_read_b128 v[80:83], v12 offset:10240
    v_mfma_f32_16x16x32_bf16 v[24:27], v[48:51], v[176:179], v[24:27]
    ds_read_b128 v[84:87], v12 offset:11264
    buffer_load_dwordx4 v[144:147], v1, s[4:7], s32 offen offset:0 sc1
    v_mfma_f32_16x16x32_bf16 v[28:31], v[52:55], v[176:179], v[28:31]
    ds_read_b128 v[88:91], v12 offset:12288
    v_mfma_f32_16x16x32_bf16 v[32:35], v[72:75], v[176:179], v[32:35]
    ds_read_b128 v[108:111], v12 offset:17408
    s_waitcnt lgkmcnt(5)
    v_mfma_f32_16x16x32_bf16 v[16:19], v[56:59], v[180:183], v[16:19]
    ds_read_b128 v[92:95], v12 offset:13312
    v_mfma_f32_16x16x32_bf16 v[20:23], v[60:63], v[180:183], v[20:23]
    ds_read_b128 v[96:99], v12 offset:14336
    buffer_load_dwordx4 v[148:151], v1, s[4:7], s32 offen offset:1024 sc1
    v_mfma_f32_16x16x32_bf16 v[24:27], v[64:67], v[180:183], v[24:27]
    ds_read_b128 v[100:103], v12 offset:15360
    v_mfma_f32_16x16x32_bf16 v[28:31], v[68:71], v[180:183], v[28:31]
    ds_read_b128 v[104:107], v12 offset:16384
    v_mfma_f32_16x16x32_bf16 v[36:39], v[72:75], v[180:183], v[36:39]
    s_waitcnt vmcnt(14) lgkmcnt(4)
    v_mfma_f32_16x16x32_bf16 v[16:19], v[76:79], v[184:187], v[16:19]
    ds_read_b128 v[40:43], v12 offset:18432
    v_mfma_f32_16x16x32_bf16 v[20:23], v[80:83], v[184:187], v[20:23]
    ds_read_b128 v[44:47], v12 offset:19456
    v_mfma_f32_16x16x32_bf16 v[24:27], v[84:87], v[184:187], v[24:27]
    ds_read_b128 v[48:51], v12 offset:20480
    buffer_load_dwordx4 v[152:155], v1, s[4:7], s32 offen offset:2048 sc1
    v_mfma_f32_16x16x32_bf16 v[28:31], v[88:91], v[184:187], v[28:31]
    ds_read_b128 v[52:55], v12 offset:21504
    v_mfma_f32_16x16x32_bf16 v[32:35], v[108:111], v[184:187], v[32:35]
    ds_read_b128 v[72:75], v12 offset:26624
    s_waitcnt lgkmcnt(5)
    v_mfma_f32_16x16x32_bf16 v[16:19], v[92:95], v[188:191], v[16:19]
    ds_read_b128 v[56:59], v12 offset:22528
    v_mfma_f32_16x16x32_bf16 v[20:23], v[96:99], v[188:191], v[20:23]
    ds_read_b128 v[60:63], v12 offset:23552
    buffer_load_dwordx4 v[156:159], v1, s[4:7], s32 offen offset:3072 sc1
    v_mfma_f32_16x16x32_bf16 v[24:27], v[100:103], v[188:191], v[24:27]
    ds_read_b128 v[64:67], v12 offset:24576
    v_mfma_f32_16x16x32_bf16 v[28:31], v[104:107], v[188:191], v[28:31]
    ds_read_b128 v[68:71], v12 offset:25600
    v_mfma_f32_16x16x32_bf16 v[36:39], v[108:111], v[188:191], v[36:39]
    s_waitcnt vmcnt(14) lgkmcnt(4)
    v_mfma_f32_16x16x32_bf16 v[16:19], v[40:43], v[192:195], v[16:19]
    ds_read_b128 v[76:79], v12 offset:27648
    v_mfma_f32_16x16x32_bf16 v[20:23], v[44:47], v[192:195], v[20:23]
    ds_read_b128 v[80:83], v12 offset:28672
    v_mfma_f32_16x16x32_bf16 v[24:27], v[48:51], v[192:195], v[24:27]
    ds_read_b128 v[84:87], v12 offset:29696
    buffer_load_dwordx4 v[160:163], v1, s[4:7], s33 offen offset:0 sc1
    v_mfma_f32_16x16x32_bf16 v[28:31], v[52:55], v[192:195], v[28:31]
    ds_read_b128 v[88:91], v12 offset:30720
    v_mfma_f32_16x16x32_bf16 v[32:35], v[72:75], v[192:195], v[32:35]
    ds_read_b128 v[108:111], v12 offset:35840
    s_waitcnt lgkmcnt(5)
    v_mfma_f32_16x16x32_bf16 v[16:19], v[56:59], v[196:199], v[16:19]
    ds_read_b128 v[92:95], v12 offset:31744
    v_mfma_f32_16x16x32_bf16 v[20:23], v[60:63], v[196:199], v[20:23]
    ds_read_b128 v[96:99], v12 offset:32768
    buffer_load_dwordx4 v[164:167], v1, s[4:7], s33 offen offset:1024 sc1
    v_mfma_f32_16x16x32_bf16 v[24:27], v[64:67], v[196:199], v[24:27]
    ds_read_b128 v[100:103], v12 offset:33792
    v_mfma_f32_16x16x32_bf16 v[28:31], v[68:71], v[196:199], v[28:31]
    ds_read_b128 v[104:107], v12 offset:34816
    v_mfma_f32_16x16x32_bf16 v[36:39], v[72:75], v[196:199], v[36:39]
    s_waitcnt vmcnt(14) lgkmcnt(0)
    s_barrier
    v_mfma_f32_16x16x32_bf16 v[16:19], v[76:79], v[200:203], v[16:19]
    ds_read_b128 v[40:43], v13 offset:0
    v_mfma_f32_16x16x32_bf16 v[20:23], v[80:83], v[200:203], v[20:23]
    ds_read_b128 v[44:47], v13 offset:1024
    v_mfma_f32_16x16x32_bf16 v[24:27], v[84:87], v[200:203], v[24:27]
    ds_read_b128 v[48:51], v13 offset:2048
    buffer_load_dwordx4 v[168:171], v1, s[4:7], s33 offen offset:2048 sc1
    v_mfma_f32_16x16x32_bf16 v[28:31], v[88:91], v[200:203], v[28:31]
    ds_read_b128 v[52:55], v13 offset:3072
    v_mfma_f32_16x16x32_bf16 v[32:35], v[108:111], v[200:203], v[32:35]
    ds_read_b128 v[72:75], v13 offset:8192
    v_mfma_f32_16x16x32_bf16 v[16:19], v[92:95], v[204:207], v[16:19]
    ds_read_b128 v[56:59], v13 offset:4096
    v_mfma_f32_16x16x32_bf16 v[20:23], v[96:99], v[204:207], v[20:23]
    ds_read_b128 v[60:63], v13 offset:5120
    buffer_load_dwordx4 v[172:175], v1, s[4:7], s33 offen offset:3072 sc1
    v_mfma_f32_16x16x32_bf16 v[24:27], v[100:103], v[204:207], v[24:27]
    ds_read_b128 v[64:67], v13 offset:6144
    v_mfma_f32_16x16x32_bf16 v[28:31], v[104:107], v[204:207], v[28:31]
    ds_read_b128 v[68:71], v13 offset:7168
    v_mfma_f32_16x16x32_bf16 v[36:39], v[108:111], v[204:207], v[36:39]
    s_waitcnt vmcnt(14) lgkmcnt(4)
    v_mfma_f32_16x16x32_bf16 v[16:19], v[40:43], v[112:115], v[16:19]
    ds_read_b128 v[76:79], v13 offset:9216
    s_mov_b32 s32, 5
    s_lshl_b32 s32, s32, 13
    s_add_u32 s32, s32, s29
    s_add_u32 s33, s32, 4096
    v_mfma_f32_16x16x32_bf16 v[20:23], v[44:47], v[112:115], v[20:23]
    ds_read_b128 v[80:83], v13 offset:10240
    v_mfma_f32_16x16x32_bf16 v[24:27], v[48:51], v[112:115], v[24:27]
    ds_read_b128 v[84:87], v13 offset:11264
    buffer_load_dwordx4 v[176:179], v1, s[4:7], s32 offen offset:0 sc1
    v_mfma_f32_16x16x32_bf16 v[28:31], v[52:55], v[112:115], v[28:31]
    ds_read_b128 v[88:91], v13 offset:12288
    v_mfma_f32_16x16x32_bf16 v[32:35], v[72:75], v[112:115], v[32:35]
    ds_read_b128 v[108:111], v13 offset:17408
    s_waitcnt lgkmcnt(5)
    v_mfma_f32_16x16x32_bf16 v[16:19], v[56:59], v[116:119], v[16:19]
    ds_read_b128 v[92:95], v13 offset:13312
    v_mfma_f32_16x16x32_bf16 v[20:23], v[60:63], v[116:119], v[20:23]
    ds_read_b128 v[96:99], v13 offset:14336
    buffer_load_dwordx4 v[180:183], v1, s[4:7], s32 offen offset:1024 sc1
    v_mfma_f32_16x16x32_bf16 v[24:27], v[64:67], v[116:119], v[24:27]
    ds_read_b128 v[100:103], v13 offset:15360
    v_mfma_f32_16x16x32_bf16 v[28:31], v[68:71], v[116:119], v[28:31]
    ds_read_b128 v[104:107], v13 offset:16384
    v_mfma_f32_16x16x32_bf16 v[36:39], v[72:75], v[116:119], v[36:39]
    s_waitcnt vmcnt(14) lgkmcnt(4)
    v_mfma_f32_16x16x32_bf16 v[16:19], v[76:79], v[120:123], v[16:19]
    ds_read_b128 v[40:43], v13 offset:18432
    v_mfma_f32_16x16x32_bf16 v[20:23], v[80:83], v[120:123], v[20:23]
    ds_read_b128 v[44:47], v13 offset:19456
    v_mfma_f32_16x16x32_bf16 v[24:27], v[84:87], v[120:123], v[24:27]
    ds_read_b128 v[48:51], v13 offset:20480
    buffer_load_dwordx4 v[184:187], v1, s[4:7], s32 offen offset:2048 sc1
    v_mfma_f32_16x16x32_bf16 v[28:31], v[88:91], v[120:123], v[28:31]
    ds_read_b128 v[52:55], v13 offset:21504
    v_mfma_f32_16x16x32_bf16 v[32:35], v[108:111], v[120:123], v[32:35]
    ds_read_b128 v[72:75], v13 offset:26624
    s_waitcnt lgkmcnt(5)
    v_mfma_f32_16x16x32_bf16 v[16:19], v[92:95], v[124:127], v[16:19]
    ds_read_b128 v[56:59], v13 offset:22528
    v_mfma_f32_16x16x32_bf16 v[20:23], v[96:99], v[124:127], v[20:23]
    ds_read_b128 v[60:63], v13 offset:23552
    buffer_load_dwordx4 v[188:191], v1, s[4:7], s32 offen offset:3072 sc1
    v_mfma_f32_16x16x32_bf16 v[24:27], v[100:103], v[124:127], v[24:27]
    ds_read_b128 v[64:67], v13 offset:24576
    v_mfma_f32_16x16x32_bf16 v[28:31], v[104:107], v[124:127], v[28:31]
    ds_read_b128 v[68:71], v13 offset:25600
    v_mfma_f32_16x16x32_bf16 v[36:39], v[108:111], v[124:127], v[36:39]
    s_waitcnt vmcnt(14) lgkmcnt(4)
    v_mfma_f32_16x16x32_bf16 v[16:19], v[40:43], v[128:131], v[16:19]
    ds_read_b128 v[76:79], v13 offset:27648
    v_mfma_f32_16x16x32_bf16 v[20:23], v[44:47], v[128:131], v[20:23]
    ds_read_b128 v[80:83], v13 offset:28672
    v_mfma_f32_16x16x32_bf16 v[24:27], v[48:51], v[128:131], v[24:27]
    ds_read_b128 v[84:87], v13 offset:29696
    buffer_load_dwordx4 v[192:195], v1, s[4:7], s33 offen offset:0 sc1
    v_mfma_f32_16x16x32_bf16 v[28:31], v[52:55], v[128:131], v[28:31]
    ds_read_b128 v[88:91], v13 offset:30720
    v_mfma_f32_16x16x32_bf16 v[32:35], v[72:75], v[128:131], v[32:35]
    ds_read_b128 v[108:111], v13 offset:35840
    s_waitcnt lgkmcnt(5)
    v_mfma_f32_16x16x32_bf16 v[16:19], v[56:59], v[132:135], v[16:19]
    ds_read_b128 v[92:95], v13 offset:31744
    v_mfma_f32_16x16x32_bf16 v[20:23], v[60:63], v[132:135], v[20:23]
    ds_read_b128 v[96:99], v13 offset:32768
    buffer_load_dwordx4 v[196:199], v1, s[4:7], s33 offen offset:1024 sc1
    v_mfma_f32_16x16x32_bf16 v[24:27], v[64:67], v[132:135], v[24:27]
    ds_read_b128 v[100:103], v13 offset:33792
    v_mfma_f32_16x16x32_bf16 v[28:31], v[68:71], v[132:135], v[28:31]
    ds_read_b128 v[104:107], v13 offset:34816
    v_mfma_f32_16x16x32_bf16 v[36:39], v[72:75], v[132:135], v[36:39]
    s_waitcnt vmcnt(14) lgkmcnt(0)
    s_barrier
    v_mfma_f32_16x16x32_bf16 v[16:19], v[76:79], v[136:139], v[16:19]
    ds_read_b128 v[40:43], v14 offset:0
    v_mfma_f32_16x16x32_bf16 v[20:23], v[80:83], v[136:139], v[20:23]
    ds_read_b128 v[44:47], v14 offset:1024
    v_mfma_f32_16x16x32_bf16 v[24:27], v[84:87], v[136:139], v[24:27]
    ds_read_b128 v[48:51], v14 offset:2048
    buffer_load_dwordx4 v[200:203], v1, s[4:7], s33 offen offset:2048 sc1
    v_mfma_f32_16x16x32_bf16 v[28:31], v[88:91], v[136:139], v[28:31]
    ds_read_b128 v[52:55], v14 offset:3072
    v_mfma_f32_16x16x32_bf16 v[32:35], v[108:111], v[136:139], v[32:35]
    ds_read_b128 v[72:75], v14 offset:8192
    v_mfma_f32_16x16x32_bf16 v[16:19], v[92:95], v[140:143], v[16:19]
    ds_read_b128 v[56:59], v14 offset:4096
    v_mfma_f32_16x16x32_bf16 v[20:23], v[96:99], v[140:143], v[20:23]
    ds_read_b128 v[60:63], v14 offset:5120
    buffer_load_dwordx4 v[204:207], v1, s[4:7], s33 offen offset:3072 sc1
    v_mfma_f32_16x16x32_bf16 v[24:27], v[100:103], v[140:143], v[24:27]
    ds_read_b128 v[64:67], v14 offset:6144
    v_mfma_f32_16x16x32_bf16 v[28:31], v[104:107], v[140:143], v[28:31]
    ds_read_b128 v[68:71], v14 offset:7168
    v_mfma_f32_16x16x32_bf16 v[36:39], v[108:111], v[140:143], v[36:39]
    s_waitcnt vmcnt(14) lgkmcnt(4)
    v_mfma_f32_16x16x32_bf16 v[16:19], v[40:43], v[144:147], v[16:19]
    ds_read_b128 v[76:79], v14 offset:9216
    s_mov_b32 s32, 6
    s_lshl_b32 s32, s32, 13
    s_add_u32 s32, s32, s29
    s_add_u32 s33, s32, 4096
    v_mfma_f32_16x16x32_bf16 v[20:23], v[44:47], v[144:147], v[20:23]
    ds_read_b128 v[80:83], v14 offset:10240
    v_mfma_f32_16x16x32_bf16 v[24:27], v[48:51], v[144:147], v[24:27]
    ds_read_b128 v[84:87], v14 offset:11264
    buffer_load_dwordx4 v[112:115], v1, s[4:7], s32 offen offset:0 sc1
    v_mfma_f32_16x16x32_bf16 v[28:31], v[52:55], v[144:147], v[28:31]
    ds_read_b128 v[88:91], v14 offset:12288
    v_mfma_f32_16x16x32_bf16 v[32:35], v[72:75], v[144:147], v[32:35]
    ds_read_b128 v[108:111], v14 offset:17408
    s_waitcnt lgkmcnt(5)
    v_mfma_f32_16x16x32_bf16 v[16:19], v[56:59], v[148:151], v[16:19]
    ds_read_b128 v[92:95], v14 offset:13312
    v_mfma_f32_16x16x32_bf16 v[20:23], v[60:63], v[148:151], v[20:23]
    ds_read_b128 v[96:99], v14 offset:14336
    buffer_load_dwordx4 v[116:119], v1, s[4:7], s32 offen offset:1024 sc1
    v_mfma_f32_16x16x32_bf16 v[24:27], v[64:67], v[148:151], v[24:27]
    ds_read_b128 v[100:103], v14 offset:15360
    v_mfma_f32_16x16x32_bf16 v[28:31], v[68:71], v[148:151], v[28:31]
    ds_read_b128 v[104:107], v14 offset:16384
    v_mfma_f32_16x16x32_bf16 v[36:39], v[72:75], v[148:151], v[36:39]
    s_waitcnt vmcnt(14) lgkmcnt(4)
    v_mfma_f32_16x16x32_bf16 v[16:19], v[76:79], v[152:155], v[16:19]
    ds_read_b128 v[40:43], v14 offset:18432
    v_mfma_f32_16x16x32_bf16 v[20:23], v[80:83], v[152:155], v[20:23]
    ds_read_b128 v[44:47], v14 offset:19456
    v_mfma_f32_16x16x32_bf16 v[24:27], v[84:87], v[152:155], v[24:27]
    ds_read_b128 v[48:51], v14 offset:20480
    buffer_load_dwordx4 v[120:123], v1, s[4:7], s32 offen offset:2048 sc1
    v_mfma_f32_16x16x32_bf16 v[28:31], v[88:91], v[152:155], v[28:31]
    ds_read_b128 v[52:55], v14 offset:21504
    v_mfma_f32_16x16x32_bf16 v[32:35], v[108:111], v[152:155], v[32:35]
    ds_read_b128 v[72:75], v14 offset:26624
    s_waitcnt lgkmcnt(5)
    v_mfma_f32_16x16x32_bf16 v[16:19], v[92:95], v[156:159], v[16:19]
    ds_read_b128 v[56:59], v14 offset:22528
    v_mfma_f32_16x16x32_bf16 v[20:23], v[96:99], v[156:159], v[20:23]
    ds_read_b128 v[60:63], v14 offset:23552
    buffer_load_dwordx4 v[124:127], v1, s[4:7], s32 offen offset:3072 sc1
    v_mfma_f32_16x16x32_bf16 v[24:27], v[100:103], v[156:159], v[24:27]
    ds_read_b128 v[64:67], v14 offset:24576
    v_mfma_f32_16x16x32_bf16 v[28:31], v[104:107], v[156:159], v[28:31]
    ds_read_b128 v[68:71], v14 offset:25600
    v_mfma_f32_16x16x32_bf16 v[36:39], v[108:111], v[156:159], v[36:39]
    s_waitcnt vmcnt(14) lgkmcnt(4)
    v_mfma_f32_16x16x32_bf16 v[16:19], v[40:43], v[160:163], v[16:19]
    ds_read_b128 v[76:79], v14 offset:27648
    v_mfma_f32_16x16x32_bf16 v[20:23], v[44:47], v[160:163], v[20:23]
    ds_read_b128 v[80:83], v14 offset:28672
    v_mfma_f32_16x16x32_bf16 v[24:27], v[48:51], v[160:163], v[24:27]
    ds_read_b128 v[84:87], v14 offset:29696
    buffer_load_dwordx4 v[128:131], v1, s[4:7], s33 offen offset:0 sc1
    v_mfma_f32_16x16x32_bf16 v[28:31], v[52:55], v[160:163], v[28:31]
    ds_read_b128 v[88:91], v14 offset:30720
    v_mfma_f32_16x16x32_bf16 v[32:35], v[72:75], v[160:163], v[32:35]
    ds_read_b128 v[108:111], v14 offset:35840
    s_waitcnt lgkmcnt(5)
    v_mfma_f32_16x16x32_bf16 v[16:19], v[56:59], v[164:167], v[16:19]
    ds_read_b128 v[92:95], v14 offset:31744
    v_mfma_f32_16x16x32_bf16 v[20:23], v[60:63], v[164:167], v[20:23]
    ds_read_b128 v[96:99], v14 offset:32768
    buffer_load_dwordx4 v[132:135], v1, s[4:7], s33 offen offset:1024 sc1
    v_mfma_f32_16x16x32_bf16 v[24:27], v[64:67], v[164:167], v[24:27]
    ds_read_b128 v[100:103], v14 offset:33792
    v_mfma_f32_16x16x32_bf16 v[28:31], v[68:71], v[164:167], v[28:31]
    ds_read_b128 v[104:107], v14 offset:34816
    v_mfma_f32_16x16x32_bf16 v[36:39], v[72:75], v[164:167], v[36:39]
    s_waitcnt vmcnt(14) lgkmcnt(0)
    s_barrier
    v_mfma_f32_16x16x32_bf16 v[16:19], v[76:79], v[168:171], v[16:19]
    ds_read_b128 v[40:43], v15 offset:0
    v_mfma_f32_16x16x32_bf16 v[20:23], v[80:83], v[168:171], v[20:23]
    ds_read_b128 v[44:47], v15 offset:1024
    v_mfma_f32_16x16x32_bf16 v[24:27], v[84:87], v[168:171], v[24:27]
    ds_read_b128 v[48:51], v15 offset:2048
    buffer_load_dwordx4 v[136:139], v1, s[4:7], s33 offen offset:2048 sc1
    v_mfma_f32_16x16x32_bf16 v[28:31], v[88:91], v[168:171], v[28:31]
    ds_read_b128 v[52:55], v15 offset:3072
    v_mfma_f32_16x16x32_bf16 v[32:35], v[108:111], v[168:171], v[32:35]
    ds_read_b128 v[72:75], v15 offset:8192
    v_mfma_f32_16x16x32_bf16 v[16:19], v[92:95], v[172:175], v[16:19]
    ds_read_b128 v[56:59], v15 offset:4096
    v_mfma_f32_16x16x32_bf16 v[20:23], v[96:99], v[172:175], v[20:23]
    ds_read_b128 v[60:63], v15 offset:5120
    buffer_load_dwordx4 v[140:143], v1, s[4:7], s33 offen offset:3072 sc1
    v_mfma_f32_16x16x32_bf16 v[24:27], v[100:103], v[172:175], v[24:27]
    ds_read_b128 v[64:67], v15 offset:6144
    v_mfma_f32_16x16x32_bf16 v[28:31], v[104:107], v[172:175], v[28:31]
    ds_read_b128 v[68:71], v15 offset:7168
    v_mfma_f32_16x16x32_bf16 v[36:39], v[108:111], v[172:175], v[36:39]
    s_waitcnt vmcnt(14) lgkmcnt(4)
    v_mfma_f32_16x16x32_bf16 v[16:19], v[40:43], v[176:179], v[16:19]
    ds_read_b128 v[76:79], v15 offset:9216
    s_mov_b32 s32, 7
    s_lshl_b32 s32, s32, 13
    s_add_u32 s32, s32, s29
    s_add_u32 s33, s32, 4096
    v_mfma_f32_16x16x32_bf16 v[20:23], v[44:47], v[176:179], v[20:23]
    ds_read_b128 v[80:83], v15 offset:10240
    v_mfma_f32_16x16x32_bf16 v[24:27], v[48:51], v[176:179], v[24:27]
    ds_read_b128 v[84:87], v15 offset:11264
    buffer_load_dwordx4 v[144:147], v1, s[4:7], s32 offen offset:0 sc1
    v_mfma_f32_16x16x32_bf16 v[28:31], v[52:55], v[176:179], v[28:31]
    ds_read_b128 v[88:91], v15 offset:12288
    v_mfma_f32_16x16x32_bf16 v[32:35], v[72:75], v[176:179], v[32:35]
    ds_read_b128 v[108:111], v15 offset:17408
    s_waitcnt lgkmcnt(5)
    v_mfma_f32_16x16x32_bf16 v[16:19], v[56:59], v[180:183], v[16:19]
    ds_read_b128 v[92:95], v15 offset:13312
    v_mfma_f32_16x16x32_bf16 v[20:23], v[60:63], v[180:183], v[20:23]
    ds_read_b128 v[96:99], v15 offset:14336
    buffer_load_dwordx4 v[148:151], v1, s[4:7], s32 offen offset:1024 sc1
    v_mfma_f32_16x16x32_bf16 v[24:27], v[64:67], v[180:183], v[24:27]
    ds_read_b128 v[100:103], v15 offset:15360
    v_mfma_f32_16x16x32_bf16 v[28:31], v[68:71], v[180:183], v[28:31]
    ds_read_b128 v[104:107], v15 offset:16384
    v_mfma_f32_16x16x32_bf16 v[36:39], v[72:75], v[180:183], v[36:39]
    s_waitcnt vmcnt(14) lgkmcnt(4)
    v_mfma_f32_16x16x32_bf16 v[16:19], v[76:79], v[184:187], v[16:19]
    ds_read_b128 v[40:43], v15 offset:18432
    v_mfma_f32_16x16x32_bf16 v[20:23], v[80:83], v[184:187], v[20:23]
    ds_read_b128 v[44:47], v15 offset:19456
    v_mfma_f32_16x16x32_bf16 v[24:27], v[84:87], v[184:187], v[24:27]
    ds_read_b128 v[48:51], v15 offset:20480
    buffer_load_dwordx4 v[152:155], v1, s[4:7], s32 offen offset:2048 sc1
    v_mfma_f32_16x16x32_bf16 v[28:31], v[88:91], v[184:187], v[28:31]
    ds_read_b128 v[52:55], v15 offset:21504
    v_mfma_f32_16x16x32_bf16 v[32:35], v[108:111], v[184:187], v[32:35]
    ds_read_b128 v[72:75], v15 offset:26624
    s_waitcnt lgkmcnt(5)
    v_mfma_f32_16x16x32_bf16 v[16:19], v[92:95], v[188:191], v[16:19]
    ds_read_b128 v[56:59], v15 offset:22528
    v_mfma_f32_16x16x32_bf16 v[20:23], v[96:99], v[188:191], v[20:23]
    ds_read_b128 v[60:63], v15 offset:23552
    buffer_load_dwordx4 v[156:159], v1, s[4:7], s32 offen offset:3072 sc1
    v_mfma_f32_16x16x32_bf16 v[24:27], v[100:103], v[188:191], v[24:27]
    ds_read_b128 v[64:67], v15 offset:24576
    v_mfma_f32_16x16x32_bf16 v[28:31], v[104:107], v[188:191], v[28:31]
    ds_read_b128 v[68:71], v15 offset:25600
    v_mfma_f32_16x16x32_bf16 v[36:39], v[108:111], v[188:191], v[36:39]
    s_waitcnt vmcnt(14) lgkmcnt(4)
    v_mfma_f32_16x16x32_bf16 v[16:19], v[40:43], v[192:195], v[16:19]
    ds_read_b128 v[76:79], v15 offset:27648
    v_mfma_f32_16x16x32_bf16 v[20:23], v[44:47], v[192:195], v[20:23]
    ds_read_b128 v[80:83], v15 offset:28672
    v_mfma_f32_16x16x32_bf16 v[24:27], v[48:51], v[192:195], v[24:27]
    ds_read_b128 v[84:87], v15 offset:29696
    buffer_load_dwordx4 v[160:163], v1, s[4:7], s33 offen offset:0 sc1
    v_mfma_f32_16x16x32_bf16 v[28:31], v[52:55], v[192:195], v[28:31]
    ds_read_b128 v[88:91], v15 offset:30720
    v_mfma_f32_16x16x32_bf16 v[32:35], v[72:75], v[192:195], v[32:35]
    ds_read_b128 v[108:111], v15 offset:35840
    s_waitcnt lgkmcnt(5)
    v_mfma_f32_16x16x32_bf16 v[16:19], v[56:59], v[196:199], v[16:19]
    ds_read_b128 v[92:95], v15 offset:31744
    v_mfma_f32_16x16x32_bf16 v[20:23], v[60:63], v[196:199], v[20:23]
    ds_read_b128 v[96:99], v15 offset:32768
    buffer_load_dwordx4 v[164:167], v1, s[4:7], s33 offen offset:1024 sc1
    v_mfma_f32_16x16x32_bf16 v[24:27], v[64:67], v[196:199], v[24:27]
    ds_read_b128 v[100:103], v15 offset:33792
    v_mfma_f32_16x16x32_bf16 v[28:31], v[68:71], v[196:199], v[28:31]
    ds_read_b128 v[104:107], v15 offset:34816
    v_mfma_f32_16x16x32_bf16 v[36:39], v[72:75], v[196:199], v[36:39]
    s_waitcnt vmcnt(14) lgkmcnt(0)
    s_barrier
    v_mfma_f32_16x16x32_bf16 v[16:19], v[76:79], v[200:203], v[16:19]
    ds_read_b128 v[40:43], v12 offset:0
    v_mfma_f32_16x16x32_bf16 v[20:23], v[80:83], v[200:203], v[20:23]
    ds_read_b128 v[44:47], v12 offset:1024
    v_mfma_f32_16x16x32_bf16 v[24:27], v[84:87], v[200:203], v[24:27]
    ds_read_b128 v[48:51], v12 offset:2048
    buffer_load_dwordx4 v[168:171], v1, s[4:7], s33 offen offset:2048 sc1
    v_mfma_f32_16x16x32_bf16 v[28:31], v[88:91], v[200:203], v[28:31]
    ds_read_b128 v[52:55], v12 offset:3072
    v_mfma_f32_16x16x32_bf16 v[32:35], v[108:111], v[200:203], v[32:35]
    ds_read_b128 v[72:75], v12 offset:8192
    v_mfma_f32_16x16x32_bf16 v[16:19], v[92:95], v[204:207], v[16:19]
    ds_read_b128 v[56:59], v12 offset:4096
    v_mfma_f32_16x16x32_bf16 v[20:23], v[96:99], v[204:207], v[20:23]
    ds_read_b128 v[60:63], v12 offset:5120
    buffer_load_dwordx4 v[172:175], v1, s[4:7], s33 offen offset:3072 sc1
    v_mfma_f32_16x16x32_bf16 v[24:27], v[100:103], v[204:207], v[24:27]
    ds_read_b128 v[64:67], v12 offset:6144
    v_mfma_f32_16x16x32_bf16 v[28:31], v[104:107], v[204:207], v[28:31]
    ds_read_b128 v[68:71], v12 offset:7168
    v_mfma_f32_16x16x32_bf16 v[36:39], v[108:111], v[204:207], v[36:39]
    s_waitcnt vmcnt(14) lgkmcnt(4)
    v_mfma_f32_16x16x32_bf16 v[16:19], v[40:43], v[112:115], v[16:19]
    ds_read_b128 v[76:79], v12 offset:9216
    s_mov_b32 s32, 8
    s_lshl_b32 s32, s32, 13
    s_add_u32 s32, s32, s29
    s_add_u32 s33, s32, 4096
    v_mfma_f32_16x16x32_bf16 v[20:23], v[44:47], v[112:115], v[20:23]
    ds_read_b128 v[80:83], v12 offset:10240
    v_mfma_f32_16x16x32_bf16 v[24:27], v[48:51], v[112:115], v[24:27]
    ds_read_b128 v[84:87], v12 offset:11264
    buffer_load_dwordx2 v[176:177], v7, s[4:7], s32 offen offset:0 sc1
    v_mfma_f32_16x16x32_bf16 v[28:31], v[52:55], v[112:115], v[28:31]
    ds_read_b128 v[88:91], v12 offset:12288
    v_mfma_f32_16x16x32_bf16 v[32:35], v[72:75], v[112:115], v[32:35]
    ds_read_b128 v[108:111], v12 offset:17408
    s_waitcnt lgkmcnt(5)
    buffer_load_dwordx2 v[178:179], v7, s[4:7], s32 offen offset:512 sc1
    v_mfma_f32_16x16x32_bf16 v[16:19], v[56:59], v[116:119], v[16:19]
    ds_read_b128 v[92:95], v12 offset:13312
    v_mfma_f32_16x16x32_bf16 v[20:23], v[60:63], v[116:119], v[20:23]
    ds_read_b128 v[96:99], v12 offset:14336
    buffer_load_dwordx2 v[180:181], v7, s[4:7], s32 offen offset:1024 sc1
    v_mfma_f32_16x16x32_bf16 v[24:27], v[64:67], v[116:119], v[24:27]
    ds_read_b128 v[100:103], v12 offset:15360
    v_mfma_f32_16x16x32_bf16 v[28:31], v[68:71], v[116:119], v[28:31]
    ds_read_b128 v[104:107], v12 offset:16384
    buffer_load_dwordx2 v[182:183], v7, s[4:7], s32 offen offset:1536 sc1
    v_mfma_f32_16x16x32_bf16 v[36:39], v[72:75], v[116:119], v[36:39]
    s_waitcnt vmcnt(16) lgkmcnt(4)
    v_mfma_f32_16x16x32_bf16 v[16:19], v[76:79], v[120:123], v[16:19]
    ds_read_b128 v[40:43], v12 offset:18432
    v_mfma_f32_16x16x32_bf16 v[20:23], v[80:83], v[120:123], v[20:23]
    ds_read_b128 v[44:47], v12 offset:19456
    v_mfma_f32_16x16x32_bf16 v[24:27], v[84:87], v[120:123], v[24:27]
    ds_read_b128 v[48:51], v12 offset:20480
    buffer_load_dwordx2 v[184:185], v7, s[4:7], s32 offen offset:2048 sc1
    v_mfma_f32_16x16x32_bf16 v[28:31], v[88:91], v[120:123], v[28:31]
    ds_read_b128 v[52:55], v12 offset:21504
    v_mfma_f32_16x16x32_bf16 v[32:35], v[108:111], v[120:123], v[32:35]
    ds_read_b128 v[72:75], v12 offset:26624
    s_waitcnt lgkmcnt(5)
    buffer_load_dwordx2 v[186:187], v7, s[4:7], s32 offen offset:2560 sc1
    v_mfma_f32_16x16x32_bf16 v[16:19], v[92:95], v[124:127], v[16:19]
    ds_read_b128 v[56:59], v12 offset:22528
    v_mfma_f32_16x16x32_bf16 v[20:23], v[96:99], v[124:127], v[20:23]
    ds_read_b128 v[60:63], v12 offset:23552
    buffer_load_dwordx2 v[188:189], v7, s[4:7], s32 offen offset:3072 sc1
    v_mfma_f32_16x16x32_bf16 v[24:27], v[100:103], v[124:127], v[24:27]
    ds_read_b128 v[64:67], v12 offset:24576
    v_mfma_f32_16x16x32_bf16 v[28:31], v[104:107], v[124:127], v[28:31]
    ds_read_b128 v[68:71], v12 offset:25600
    buffer_load_dwordx2 v[190:191], v7, s[4:7], s32 offen offset:3584 sc1
    v_mfma_f32_16x16x32_bf16 v[36:39], v[108:111], v[124:127], v[36:39]
    s_waitcnt vmcnt(18) lgkmcnt(4)
    v_mfma_f32_16x16x32_bf16 v[16:19], v[40:43], v[128:131], v[16:19]
    ds_read_b128 v[76:79], v12 offset:27648
    v_mfma_f32_16x16x32_bf16 v[20:23], v[44:47], v[128:131], v[20:23]
    ds_read_b128 v[80:83], v12 offset:28672
    v_mfma_f32_16x16x32_bf16 v[24:27], v[48:51], v[128:131], v[24:27]
    ds_read_b128 v[84:87], v12 offset:29696
    buffer_load_dwordx2 v[192:193], v7, s[4:7], s33 offen offset:0 sc1
    v_mfma_f32_16x16x32_bf16 v[28:31], v[52:55], v[128:131], v[28:31]
    ds_read_b128 v[88:91], v12 offset:30720
    v_mfma_f32_16x16x32_bf16 v[32:35], v[72:75], v[128:131], v[32:35]
    ds_read_b128 v[108:111], v12 offset:35840
    s_waitcnt lgkmcnt(5)
    buffer_load_dwordx2 v[194:195], v7, s[4:7], s33 offen offset:512 sc1
    v_mfma_f32_16x16x32_bf16 v[16:19], v[56:59], v[132:135], v[16:19]
    ds_read_b128 v[92:95], v12 offset:31744
    v_mfma_f32_16x16x32_bf16 v[20:23], v[60:63], v[132:135], v[20:23]
    ds_read_b128 v[96:99], v12 offset:32768
    buffer_load_dwordx2 v[196:197], v7, s[4:7], s33 offen offset:1024 sc1
    v_mfma_f32_16x16x32_bf16 v[24:27], v[64:67], v[132:135], v[24:27]
    ds_read_b128 v[100:103], v12 offset:33792
    v_mfma_f32_16x16x32_bf16 v[28:31], v[68:71], v[132:135], v[28:31]
    ds_read_b128 v[104:107], v12 offset:34816
    buffer_load_dwordx2 v[198:199], v7, s[4:7], s33 offen offset:1536 sc1
    v_mfma_f32_16x16x32_bf16 v[36:39], v[72:75], v[132:135], v[36:39]
    s_waitcnt vmcnt(20) lgkmcnt(0)
    s_barrier
    v_mfma_f32_16x16x32_bf16 v[16:19], v[76:79], v[136:139], v[16:19]
    ds_read_b128 v[40:43], v13 offset:0
    v_mfma_f32_16x16x32_bf16 v[20:23], v[80:83], v[136:139], v[20:23]
    ds_read_b128 v[44:47], v13 offset:1024
    v_mfma_f32_16x16x32_bf16 v[24:27], v[84:87], v[136:139], v[24:27]
    ds_read_b128 v[48:51], v13 offset:2048
    buffer_load_dwordx2 v[200:201], v7, s[4:7], s33 offen offset:2048 sc1
    v_mfma_f32_16x16x32_bf16 v[28:31], v[88:91], v[136:139], v[28:31]
    ds_read_b128 v[52:55], v13 offset:3072
    v_mfma_f32_16x16x32_bf16 v[32:35], v[108:111], v[136:139], v[32:35]
    ds_read_b128 v[72:75], v13 offset:8192
    buffer_load_dwordx2 v[202:203], v7, s[4:7], s33 offen offset:2560 sc1
    v_mfma_f32_16x16x32_bf16 v[16:19], v[92:95], v[140:143], v[16:19]
    ds_read_b128 v[56:59], v13 offset:4096
    v_mfma_f32_16x16x32_bf16 v[20:23], v[96:99], v[140:143], v[20:23]
    ds_read_b128 v[60:63], v13 offset:5120
    buffer_load_dwordx2 v[204:205], v7, s[4:7], s33 offen offset:3072 sc1
    v_mfma_f32_16x16x32_bf16 v[24:27], v[100:103], v[140:143], v[24:27]
    ds_read_b128 v[64:67], v13 offset:6144
    v_mfma_f32_16x16x32_bf16 v[28:31], v[104:107], v[140:143], v[28:31]
    ds_read_b128 v[68:71], v13 offset:7168
    buffer_load_dwordx2 v[206:207], v7, s[4:7], s33 offen offset:3584 sc1
    v_mfma_f32_16x16x32_bf16 v[36:39], v[108:111], v[140:143], v[36:39]
    s_waitcnt vmcnt(22) lgkmcnt(4)
    v_mfma_f32_16x16x32_bf16 v[16:19], v[40:43], v[144:147], v[16:19]
    ds_read_b128 v[76:79], v13 offset:9216
    v_mfma_f32_16x16x32_bf16 v[20:23], v[44:47], v[144:147], v[20:23]
    ds_read_b128 v[80:83], v13 offset:10240
    v_mfma_f32_16x16x32_bf16 v[24:27], v[48:51], v[144:147], v[24:27]
    ds_read_b128 v[84:87], v13 offset:11264
    v_mfma_f32_16x16x32_bf16 v[28:31], v[52:55], v[144:147], v[28:31]
    ds_read_b128 v[88:91], v13 offset:12288
    v_mfma_f32_16x16x32_bf16 v[32:35], v[72:75], v[144:147], v[32:35]
    ds_read_b128 v[108:111], v13 offset:17408
    s_waitcnt lgkmcnt(5)
    v_mfma_f32_16x16x32_bf16 v[16:19], v[56:59], v[148:151], v[16:19]
    ds_read_b128 v[92:95], v13 offset:13312
    v_mfma_f32_16x16x32_bf16 v[20:23], v[60:63], v[148:151], v[20:23]
    ds_read_b128 v[96:99], v13 offset:14336
    v_mfma_f32_16x16x32_bf16 v[24:27], v[64:67], v[148:151], v[24:27]
    ds_read_b128 v[100:103], v13 offset:15360
    v_mfma_f32_16x16x32_bf16 v[28:31], v[68:71], v[148:151], v[28:31]
    ds_read_b128 v[104:107], v13 offset:16384
    v_mfma_f32_16x16x32_bf16 v[36:39], v[72:75], v[148:151], v[36:39]
    s_waitcnt vmcnt(20) lgkmcnt(4)
    v_mfma_f32_16x16x32_bf16 v[16:19], v[76:79], v[152:155], v[16:19]
    ds_read_b128 v[40:43], v13 offset:18432
    v_mfma_f32_16x16x32_bf16 v[20:23], v[80:83], v[152:155], v[20:23]
    ds_read_b128 v[44:47], v13 offset:19456
    v_mfma_f32_16x16x32_bf16 v[24:27], v[84:87], v[152:155], v[24:27]
    ds_read_b128 v[48:51], v13 offset:20480
    v_mfma_f32_16x16x32_bf16 v[28:31], v[88:91], v[152:155], v[28:31]
    ds_read_b128 v[52:55], v13 offset:21504
    v_mfma_f32_16x16x32_bf16 v[32:35], v[108:111], v[152:155], v[32:35]
    ds_read_b128 v[72:75], v13 offset:26624
    s_waitcnt lgkmcnt(5)
    v_mfma_f32_16x16x32_bf16 v[16:19], v[92:95], v[156:159], v[16:19]
    ds_read_b128 v[56:59], v13 offset:22528
    v_mfma_f32_16x16x32_bf16 v[20:23], v[96:99], v[156:159], v[20:23]
    ds_read_b128 v[60:63], v13 offset:23552
    v_mfma_f32_16x16x32_bf16 v[24:27], v[100:103], v[156:159], v[24:27]
    ds_read_b128 v[64:67], v13 offset:24576
    v_mfma_f32_16x16x32_bf16 v[28:31], v[104:107], v[156:159], v[28:31]
    ds_read_b128 v[68:71], v13 offset:25600
    v_mfma_f32_16x16x32_bf16 v[36:39], v[108:111], v[156:159], v[36:39]
    s_waitcnt vmcnt(18) lgkmcnt(4)
    v_mfma_f32_16x16x32_bf16 v[16:19], v[40:43], v[160:163], v[16:19]
    ds_read_b128 v[76:79], v13 offset:27648
    v_mfma_f32_16x16x32_bf16 v[20:23], v[44:47], v[160:163], v[20:23]
    ds_read_b128 v[80:83], v13 offset:28672
    v_mfma_f32_16x16x32_bf16 v[24:27], v[48:51], v[160:163], v[24:27]
    ds_read_b128 v[84:87], v13 offset:29696
    v_mfma_f32_16x16x32_bf16 v[28:31], v[52:55], v[160:163], v[28:31]
    ds_read_b128 v[88:91], v13 offset:30720
    v_mfma_f32_16x16x32_bf16 v[32:35], v[72:75], v[160:163], v[32:35]
    ds_read_b128 v[108:111], v13 offset:35840
    s_waitcnt lgkmcnt(5)
    v_mfma_f32_16x16x32_bf16 v[16:19], v[56:59], v[164:167], v[16:19]
    ds_read_b128 v[92:95], v13 offset:31744
    v_mfma_f32_16x16x32_bf16 v[20:23], v[60:63], v[164:167], v[20:23]
    ds_read_b128 v[96:99], v13 offset:32768
    v_mfma_f32_16x16x32_bf16 v[24:27], v[64:67], v[164:167], v[24:27]
    ds_read_b128 v[100:103], v13 offset:33792
    v_mfma_f32_16x16x32_bf16 v[28:31], v[68:71], v[164:167], v[28:31]
    ds_read_b128 v[104:107], v13 offset:34816
    v_mfma_f32_16x16x32_bf16 v[36:39], v[72:75], v[164:167], v[36:39]
    s_waitcnt vmcnt(16) lgkmcnt(0)
    s_barrier
    v_mfma_f32_16x16x32_bf16 v[16:19], v[76:79], v[168:171], v[16:19]
    ds_read_b128 v[40:43], v14 offset:0
    v_mfma_f32_16x16x32_bf16 v[20:23], v[80:83], v[168:171], v[20:23]
    ds_read_b128 v[44:47], v14 offset:1024
    v_mfma_f32_16x16x32_bf16 v[24:27], v[84:87], v[168:171], v[24:27]
    ds_read_b128 v[48:51], v14 offset:2048
    v_mfma_f32_16x16x32_bf16 v[28:31], v[88:91], v[168:171], v[28:31]
    ds_read_b128 v[52:55], v14 offset:3072
    v_mfma_f32_16x16x32_bf16 v[32:35], v[108:111], v[168:171], v[32:35]
    ds_read_b128 v[72:75], v14 offset:8192
    v_mfma_f32_16x16x32_bf16 v[16:19], v[92:95], v[172:175], v[16:19]
    ds_read_b128 v[56:59], v14 offset:4096
    v_mfma_f32_16x16x32_bf16 v[20:23], v[96:99], v[172:175], v[20:23]
    ds_read_b128 v[60:63], v14 offset:5120
    v_mfma_f32_16x16x32_bf16 v[24:27], v[100:103], v[172:175], v[24:27]
    ds_read_b128 v[64:67], v14 offset:6144
    v_mfma_f32_16x16x32_bf16 v[28:31], v[104:107], v[172:175], v[28:31]
    ds_read_b128 v[68:71], v14 offset:7168
    v_mfma_f32_16x16x32_bf16 v[36:39], v[108:111], v[172:175], v[36:39]
    s_waitcnt vmcnt(12) lgkmcnt(4)
    v_mfma_f32_16x16x32_bf16 v[16:19], v[40:43], v[176:179], v[16:19]
    ds_read_b128 v[76:79], v14 offset:9216
    v_mfma_f32_16x16x32_bf16 v[20:23], v[44:47], v[176:179], v[20:23]
    ds_read_b128 v[80:83], v14 offset:10240
    v_mfma_f32_16x16x32_bf16 v[24:27], v[48:51], v[176:179], v[24:27]
    ds_read_b128 v[84:87], v14 offset:11264
    v_mfma_f32_16x16x32_bf16 v[28:31], v[52:55], v[176:179], v[28:31]
    ds_read_b128 v[88:91], v14 offset:12288
    v_mfma_f32_16x16x32_bf16 v[32:35], v[72:75], v[176:179], v[32:35]
    ds_read_b128 v[108:111], v14 offset:17408
    s_waitcnt lgkmcnt(5)
    v_mfma_f32_16x16x32_bf16 v[16:19], v[56:59], v[180:183], v[16:19]
    ds_read_b128 v[92:95], v14 offset:13312
    v_mfma_f32_16x16x32_bf16 v[20:23], v[60:63], v[180:183], v[20:23]
    ds_read_b128 v[96:99], v14 offset:14336
    v_mfma_f32_16x16x32_bf16 v[24:27], v[64:67], v[180:183], v[24:27]
    ds_read_b128 v[100:103], v14 offset:15360
    v_mfma_f32_16x16x32_bf16 v[28:31], v[68:71], v[180:183], v[28:31]
    ds_read_b128 v[104:107], v14 offset:16384
    v_mfma_f32_16x16x32_bf16 v[36:39], v[72:75], v[180:183], v[36:39]
    s_waitcnt vmcnt(8) lgkmcnt(4)
    v_mfma_f32_16x16x32_bf16 v[16:19], v[76:79], v[184:187], v[16:19]
    ds_read_b128 v[40:43], v14 offset:18432
    v_mfma_f32_16x16x32_bf16 v[20:23], v[80:83], v[184:187], v[20:23]
    ds_read_b128 v[44:47], v14 offset:19456
    v_mfma_f32_16x16x32_bf16 v[24:27], v[84:87], v[184:187], v[24:27]
    ds_read_b128 v[48:51], v14 offset:20480
    v_mfma_f32_16x16x32_bf16 v[28:31], v[88:91], v[184:187], v[28:31]
    ds_read_b128 v[52:55], v14 offset:21504
    v_mfma_f32_16x16x32_bf16 v[32:35], v[108:111], v[184:187], v[32:35]
    ds_read_b128 v[72:75], v14 offset:26624
    s_waitcnt lgkmcnt(5)
    v_mfma_f32_16x16x32_bf16 v[16:19], v[92:95], v[188:191], v[16:19]
    ds_read_b128 v[56:59], v14 offset:22528
    v_mfma_f32_16x16x32_bf16 v[20:23], v[96:99], v[188:191], v[20:23]
    ds_read_b128 v[60:63], v14 offset:23552
    v_mfma_f32_16x16x32_bf16 v[24:27], v[100:103], v[188:191], v[24:27]
    ds_read_b128 v[64:67], v14 offset:24576
    v_mfma_f32_16x16x32_bf16 v[28:31], v[104:107], v[188:191], v[28:31]
    ds_read_b128 v[68:71], v14 offset:25600
    v_mfma_f32_16x16x32_bf16 v[36:39], v[108:111], v[188:191], v[36:39]
    s_waitcnt vmcnt(4) lgkmcnt(4)
    v_mfma_f32_16x16x32_bf16 v[16:19], v[40:43], v[192:195], v[16:19]
    ds_read_b128 v[76:79], v14 offset:27648
    v_mfma_f32_16x16x32_bf16 v[20:23], v[44:47], v[192:195], v[20:23]
    ds_read_b128 v[80:83], v14 offset:28672
    v_mfma_f32_16x16x32_bf16 v[24:27], v[48:51], v[192:195], v[24:27]
    ds_read_b128 v[84:87], v14 offset:29696
    v_mfma_f32_16x16x32_bf16 v[28:31], v[52:55], v[192:195], v[28:31]
    ds_read_b128 v[88:91], v14 offset:30720
    v_mfma_f32_16x16x32_bf16 v[32:35], v[72:75], v[192:195], v[32:35]
    ds_read_b128 v[108:111], v14 offset:35840
    s_waitcnt lgkmcnt(5)
    v_mfma_f32_16x16x32_bf16 v[16:19], v[56:59], v[196:199], v[16:19]
    ds_read_b128 v[92:95], v14 offset:31744
    v_mfma_f32_16x16x32_bf16 v[20:23], v[60:63], v[196:199], v[20:23]
    ds_read_b128 v[96:99], v14 offset:32768
    v_mfma_f32_16x16x32_bf16 v[24:27], v[64:67], v[196:199], v[24:27]
    ds_read_b128 v[100:103], v14 offset:33792
    v_mfma_f32_16x16x32_bf16 v[28:31], v[68:71], v[196:199], v[28:31]
    ds_read_b128 v[104:107], v14 offset:34816
    v_mfma_f32_16x16x32_bf16 v[36:39], v[72:75], v[196:199], v[36:39]
    s_waitcnt vmcnt(0) lgkmcnt(4)
    v_mfma_f32_16x16x32_bf16 v[16:19], v[76:79], v[200:203], v[16:19]
    v_mfma_f32_16x16x32_bf16 v[20:23], v[80:83], v[200:203], v[20:23]
    v_mfma_f32_16x16x32_bf16 v[24:27], v[84:87], v[200:203], v[24:27]
    v_mfma_f32_16x16x32_bf16 v[28:31], v[88:91], v[200:203], v[28:31]
    v_mfma_f32_16x16x32_bf16 v[32:35], v[108:111], v[200:203], v[32:35]
    s_waitcnt lgkmcnt(0)
    v_mfma_f32_16x16x32_bf16 v[16:19], v[92:95], v[204:207], v[16:19]
    v_mfma_f32_16x16x32_bf16 v[20:23], v[96:99], v[204:207], v[20:23]
    v_mfma_f32_16x16x32_bf16 v[24:27], v[100:103], v[204:207], v[24:27]
    v_mfma_f32_16x16x32_bf16 v[28:31], v[104:107], v[204:207], v[28:31]
    v_mfma_f32_16x16x32_bf16 v[36:39], v[108:111], v[204:207], v[36:39]
    s_nop 3
    v_cvt_pk_bf16_f32 v208, v16, v17
    v_cvt_pk_bf16_f32 v209, v18, v19
    v_cvt_pk_bf16_f32 v210, v20, v21
    v_cvt_pk_bf16_f32 v211, v22, v23
    v_cvt_pk_bf16_f32 v212, v24, v25
    v_cvt_pk_bf16_f32 v213, v26, v27
    v_cvt_pk_bf16_f32 v214, v28, v29
    v_cvt_pk_bf16_f32 v215, v30, v31
    s_cmp_eq_u32 s22, 1
    s_cbranch_scc1 L_fin_p5
    buffer_store_dwordx4 v[208:211], v4, s[4:7], s34 offen offset:0 sc1
    buffer_store_dwordx4 v[212:215], v4, s[4:7], s34 offen offset:1024 sc1
    v_permlane32_swap_b32 v36, v220
    v_permlane32_swap_b32 v37, v221
    v_permlane32_swap_b32 v38, v222
    v_permlane32_swap_b32 v39, v223
    v_pk_add_f32 v[32:33], v[32:33], v[220:221]
    v_pk_add_f32 v[34:35], v[34:35], v[222:223]
    v_cvt_pk_bf16_f32 v216, v32, v33
    v_cvt_pk_bf16_f32 v217, v34, v35
    buffer_store_dwordx2 v[216:217], v5, s[4:7], s34 offen sc1
    v_cndmask_b32 v222, 0, v216, s[40:41]
    v_cndmask_b32 v223, 0, v217, s[40:41]
    v_dot2_f32_bf16 v220, v208, v11, 0
    v_dot2_f32_bf16 v221, v208, v208, 0
    v_dot2_f32_bf16 v220, v209, v11, v220
    v_dot2_f32_bf16 v221, v209, v209, v221
    v_dot2_f32_bf16 v220, v210, v11, v220
    v_dot2_f32_bf16 v221, v210, v210, v221
    v_dot2_f32_bf16 v220, v211, v11, v220
    v_dot2_f32_bf16 v221, v211, v211, v221
    v_dot2_f32_bf16 v220, v212, v11, v220
    v_dot2_f32_bf16 v221, v212, v212, v221
    v_dot2_f32_bf16 v220, v213, v11, v220
    v_dot2_f32_bf16 v221, v213, v213, v221
    v_dot2_f32_bf16 v220, v214, v11, v220
    v_dot2_f32_bf16 v221, v214, v214, v221
    v_dot2_f32_bf16 v220, v215, v11, v220
    v_dot2_f32_bf16 v221, v215, v215, v221
    v_dot2_f32_bf16 v220, v222, v11, v220
    v_dot2_f32_bf16 v221, v222, v222, v221
    v_dot2_f32_bf16 v220, v223, v11, v220
    v_dot2_f32_bf16 v221, v223, v223, v221
    s_nop 2
    v_mov_b32 v222, v220
    v_mov_b32 v223, v221
    s_nop 1
    v_permlane32_swap_b32 v220, v222
    v_permlane32_swap_b32 v221, v223
    v_add_f32 v220, v220, v222
    v_add_f32 v221, v221, v223
    v_mov_b32 v222, v220
    v_mov_b32 v223, v221
    s_nop 1
    v_permlane16_swap_b32 v220, v222
    v_permlane16_swap_b32 v221, v223
    v_add_f32 v220, v220, v222
    v_add_f32 v221, v221, v223
    buffer_store_dwordx2 v[220:221], v10, s[4:7], s39 offen sc1
    s_mov_b32 s22, 1
    s_mov_b32 s21, 0x1c00000
    s_mov_b32 s46, 1
    s_mov_b32 s47, 0
    s_mov_b64 s[48:49], s[4:5]
    s_branch L_m_cl
L_fin_p5:
    buffer_store_dwordx4 v[208:211], v4, s[16:19], s34 offen offset:0
    buffer_store_dwordx4 v[212:215], v4, s[16:19], s34 offen offset:64
    v_permlane32_swap_b32 v36, v220
    v_permlane32_swap_b32 v37, v221
    v_permlane32_swap_b32 v38, v222
    v_permlane32_swap_b32 v39, v223
    v_pk_add_f32 v[32:33], v[32:33], v[220:221]
    v_pk_add_f32 v[34:35], v[34:35], v[222:223]
    v_cvt_pk_bf16_f32 v216, v32, v33
    v_cvt_pk_bf16_f32 v217, v34, v35
    buffer_store_dwordx2 v[216:217], v5, s[16:19], s34 offen offset:128
    s_endpgm
L_g_slow:
    s_mov_b32 s60, 65536
L_g_sl:
    s_sleep 2
    v_lshrrev_b32 v4, 8, v1
    v_bfe_u32 v5, v1, 6, 2
    v_bfe_u32 v6, v1, 4, 2
    v_lshlrev_b32 v255, 6, v4
    v_lshl_add_u32 v255, v5, 8, v255
    v_lshl_add_u32 v255, v6, 4, v255
    buffer_load_dwordx4 v[4:7], v255, s[4:7], s35 offen offset:0 sc1
    buffer_load_dwordx4 v[8:11], v255, s[4:7], s35 offen offset:1024 sc1
    buffer_load_dwordx4 v[12:15], v255, s[4:7], s35 offen offset:2048 sc1
    buffer_load_dwordx4 v[252:255], v255, s[4:7], s35 offen offset:3072 sc1
    s_waitcnt vmcnt(0)
    v_or3_b32 v249, v5, v7, v9
    v_or3_b32 v251, v11, v13, v15
    v_or3_b32 v249, v253, v255, v249
    v_or_b32 v249, v249, v251
    v_cmp_gt_i32 vcc, 0, v249
    s_sub_u32 s60, s60, 1
    s_cbranch_scc1 L_g_back
    s_cbranch_vccnz L_g_sl
    s_branch L_g_back
L_m_l1:
    s_and_b32 s25, s2, 7
    s_lshr_b32 s26, s2, 3
    s_lshr_b32 s23, s25, 1
    s_lshl_b32 s23, s23, 2
    s_lshr_b32 s27, s26, 3
    s_add_u32 s23, s23, s27
    s_and_b32 s24, s25, 1
    s_lshl_b32 s24, s24, 3
    s_and_b32 s27, s26, 7
    s_add_u32 s24, s24, s27
    s_mul_i32 s29, s24, 129024
    s_lshl_b32 s30, s20, 12
    s_add_u32 s29, s29, s30
    s_add_u32 s29, s29, 0x3800000
    s_lshl_b32 s31, s23, 3
    s_max_u32 s31, s31, 1
    s_sub_u32 s31, s31, 1
    s_mul_i32 s31, s31, 18432
    s_add_u32 s31, s31, 0x0
    s_lshl_b32 s35, s20, 10
    s_and_b32 s36, s35, 1024
    s_barrier
    s_add_u32 m0, s35, 131072
    s_add_u32 s34, s31, s35
    s_add_u32 s34, s34, 0
    buffer_load_dwordx4 v1, s[4:7], s34 offen sc1 lds
    s_add_u32 m0, s30, 0
    s_add_u32 s34, s29, 0
    buffer_load_dwordx4 v1, s[4:7], s34 offen offset:0 lds
    buffer_load_dwordx4 v1, s[4:7], s34 offen offset:1024 lds
    buffer_load_dwordx4 v1, s[4:7], s34 offen offset:2048 lds
    buffer_load_dwordx4 v1, s[4:7], s34 offen offset:3072 lds
    s_add_u32 m0, s30, 16384
    s_add_u32 s34, s29, 16384
    buffer_load_dwordx4 v1, s[4:7], s34 offen offset:0 lds
    buffer_load_dwordx4 v1, s[4:7], s34 offen offset:1024 lds
    buffer_load_dwordx4 v1, s[4:7], s34 offen offset:2048 lds
    buffer_load_dwordx4 v1, s[4:7], s34 offen offset:3072 lds
    s_waitcnt vmcnt(4)
    s_barrier
    s_add_u32 m0, s35, 135168
    s_add_u32 s34, s31, s35
    s_add_u32 s34, s34, 4096
    buffer_load_dwordx4 v1, s[4:7], s34 offen sc1 lds
    s_add_u32 m0, s30, 32768
    s_add_u32 s34, s29, 32768
    buffer_load_dwordx4 v1, s[4:7], s34 offen offset:0 lds
    buffer_load_dwordx4 v1, s[4:7], s34 offen offset:1024 lds
    buffer_load_dwordx4 v1, s[4:7], s34 offen offset:2048 lds
    buffer_load_dwordx4 v1, s[4:7], s34 offen offset:3072 lds
    s_add_u32 m0, s30, 49152
    s_add_u32 s34, s29, 49152
    buffer_load_dwordx4 v1, s[4:7], s34 offen offset:0 lds
    buffer_load_dwordx4 v1, s[4:7], s34 offen offset:1024 lds
    buffer_load_dwordx4 v1, s[4:7], s34 offen offset:2048 lds
    buffer_load_dwordx4 v1, s[4:7], s34 offen offset:3072 lds
    s_add_u32 m0, s35, 139264
    s_add_u32 s34, s31, s35
    s_add_u32 s34, s34, 8192
    buffer_load_dwordx4 v1, s[4:7], s34 offen sc1 lds
    s_cmp_lt_u32 s2, 144
    s_cbranch_scc1 L_p0_t1
    s_cmp_ge_u32 s2, 216
    s_cbranch_scc1 L_p0_t2
    ds_read_b64_tr_b16 v[16:17], v4 offset:0
    ds_read_b64_tr_b16 v[18:19], v4 offset:2048
    ds_read_b64_tr_b16 v[20:21], v4 offset:4096
    ds_read_b64_tr_b16 v[22:23], v4 offset:6144
    ds_read_b64_tr_b16 v[24:25], v4 offset:8192
    ds_read_b64_tr_b16 v[26:27], v4 offset:10240
    ds_read_b64_tr_b16 v[28:29], v4 offset:12288
    ds_read_b64_tr_b16 v[30:31], v4 offset:14336
    ds_read_b64_tr_b16 v[32:33], v4 offset:18432
    ds_read_b64_tr_b16 v[34:35], v4 offset:20480
    ds_read_b64_tr_b16 v[36:37], v4 offset:22528
    ds_read_b64_tr_b16 v[38:39], v4 offset:24576
    ds_read_b64_tr_b16 v[40:41], v4 offset:26624
    ds_read_b64_tr_b16 v[42:43], v4 offset:28672
    ds_read_b64_tr_b16 v[44:45], v4 offset:30720
    ds_read_b64_tr_b16 v[46:47], v4 offset:32768
    ds_read_b64_tr_b16 v[48:49], v5 offset:16384
    ds_read_b64_tr_b16 v[50:51], v5 offset:34816
    s_branch L_p0_t2
L_p0_t1:
    ds_read_b64_tr_b16 v[16:17], v4 offset:0
    ds_read_b64_tr_b16 v[18:19], v4 offset:512
    ds_read_b64_tr_b16 v[20:21], v4 offset:4096
    ds_read_b64_tr_b16 v[22:23], v4 offset:4608
    ds_read_b64_tr_b16 v[24:25], v4 offset:9216
    ds_read_b64_tr_b16 v[26:27], v4 offset:9728
    ds_read_b64_tr_b16 v[28:29], v4 offset:13312
    ds_read_b64_tr_b16 v[30:31], v4 offset:13824
    ds_read_b64_tr_b16 v[32:33], v4 offset:18432
    ds_read_b64_tr_b16 v[34:35], v4 offset:18944
    ds_read_b64_tr_b16 v[36:37], v4 offset:22528
    ds_read_b64_tr_b16 v[38:39], v4 offset:23040
    ds_read_b64_tr_b16 v[40:41], v4 offset:27648
    ds_read_b64_tr_b16 v[42:43], v4 offset:28160
    ds_read_b64_tr_b16 v[44:45], v4 offset:31744
    ds_read_b64_tr_b16 v[46:47], v4 offset:32256
    ds_read_b64_tr_b16 v[48:49], v5 offset:8192
    ds_read_b64_tr_b16 v[50:51], v5 offset:8704
L_p0_t2:
    s_waitcnt lgkmcnt(0)
    s_waitcnt vmcnt(10)
    s_barrier
    s_mov_b32 m0, 161792
    s_lshl_b32 s34, s24, 10
    s_add_u32 s34, s34, 0x4400000
    buffer_load_dwordx4 v1, s[4:7], s34 offen lds
    s_add_u32 m0, s30, 65536
    s_add_u32 s34, s29, 65536
    buffer_load_dwordx4 v1, s[4:7], s34 offen offset:0 lds
    buffer_load_dwordx4 v1, s[4:7], s34 offen offset:1024 lds
    buffer_load_dwordx4 v1, s[4:7], s34 offen offset:2048 lds
    buffer_load_dwordx4 v1, s[4:7], s34 offen offset:3072 lds
    s_waitcnt vmcnt(10)
    s_barrier
    s_add_u32 m0, s30, 81920
    s_add_u32 s34, s29, 81920
    buffer_load_dwordx4 v1, s[4:7], s34 offen offset:0 lds
    buffer_load_dwordx4 v1, s[4:7], s34 offen offset:1024 lds
    buffer_load_dwordx4 v1, s[4:7], s34 offen offset:2048 lds
    buffer_load_dwordx4 v1, s[4:7], s34 offen offset:3072 lds
    s_add_u32 m0, s35, 143360
    s_add_u32 s34, s31, s35
    s_add_u32 s34, s34, 12288
    buffer_load_dwordx4 v1, s[4:7], s34 offen sc1 lds
    s_waitcnt vmcnt(10)
    s_barrier
    s_add_u32 m0, s30, 98304
    s_add_u32 s34, s29, 98304
    buffer_load_dwordx4 v1, s[4:7], s34 offen offset:0 lds
    buffer_load_dwordx4 v1, s[4:7], s34 offen offset:1024 lds
    buffer_load_dwordx4 v1, s[4:7], s34 offen offset:2048 lds
    buffer_load_dwordx4 v1, s[4:7], s34 offen offset:3072 lds
    s_waitcnt vmcnt(9)
    s_barrier
    s_add_u32 m0, s36, 147456
    s_add_u32 s34, s31, s36
    s_add_u32 s34, s34, 16384
    buffer_load_dwordx4 v1, s[4:7], s34 offen sc1 lds
    s_add_u32 m0, s30, 114688
    s_add_u32 s34, s29, 114688
    buffer_load_dwordx4 v1, s[4:7], s34 offen offset:0 lds
    buffer_load_dwordx4 v1, s[4:7], s34 offen offset:1024 lds
    buffer_load_dwordx4 v1, s[4:7], s34 offen offset:2048 lds
    buffer_load_dwordx4 v1, s[4:7], s34 offen offset:3072 lds
    s_waitcnt vmcnt(9)
    s_barrier
    buffer_store_dwordx4 v[16:19], v9, s[4:7], s37 offen sc1
    buffer_store_dwordx4 v[20:23], v10, s[4:7], s38 offen sc1
    buffer_store_dwordx4 v[24:27], v9, s[4:7], s39 offen sc1
    buffer_store_dwordx4 v[28:31], v10, s[4:7], s40 offen sc1
    s_waitcnt vmcnt(9)
    s_barrier
    buffer_store_dwordx4 v[32:35], v9, s[4:7], s41 offen sc1
    buffer_store_dwordx4 v[36:39], v10, s[4:7], s42 offen sc1
    buffer_store_dwordx4 v[40:43], v9, s[4:7], s43 offen sc1
    s_waitcnt vmcnt(7)
    s_barrier
    s_mov_b32 s46, 0x4502000
    v_mov_b32 v4, 0
    s_mov_b32 s60, 65536
L_poll_wo:
    buffer_load_dword v5, v4, s[4:7], s46 offen sc1
    s_waitcnt vmcnt(0)
    v_cmp_gt_u32 vcc, 18, v5
    s_sub_u32 s60, s60, 1
    s_cbranch_scc1 L_pd_wo
    s_cbranch_vccz L_pd_wo
    s_sleep 4
    s_branch L_poll_wo
L_pd_wo:
    buffer_store_dwordx4 v[44:47], v10, s[4:7], s47 offen sc1
    buffer_store_dwordx4 v[48:51], v14, s[4:7], s48 offen sc1
    v_dot2_f32_bf16 v12, v16, v11, 0
    v_dot2_f32_bf16 v13, v17, v11, 0
    v_dot2_f32_bf16 v12, v18, v11, v12
    v_dot2_f32_bf16 v13, v19, v11, v13
    v_dot2_f32_bf16 v12, v20, v11, v12
    v_dot2_f32_bf16 v13, v21, v11, v13
    v_dot2_f32_bf16 v12, v22, v11, v12
    v_dot2_f32_bf16 v13, v23, v11, v13
    v_dot2_f32_bf16 v12, v24, v11, v12
    v_dot2_f32_bf16 v13, v25, v11, v13
    v_dot2_f32_bf16 v12, v26, v11, v12
    v_dot2_f32_bf16 v13, v27, v11, v13
    v_dot2_f32_bf16 v12, v28, v11, v12
    v_dot2_f32_bf16 v13, v29, v11, v13
    v_dot2_f32_bf16 v12, v30, v11, v12
    v_dot2_f32_bf16 v13, v31, v11, v13
    v_dot2_f32_bf16 v12, v32, v11, v12
    v_dot2_f32_bf16 v13, v33, v11, v13
    v_dot2_f32_bf16 v12, v34, v11, v12
    v_dot2_f32_bf16 v13, v35, v11, v13
    v_dot2_f32_bf16 v12, v36, v11, v12
    v_dot2_f32_bf16 v13, v37, v11, v13
    v_dot2_f32_bf16 v12, v38, v11, v12
    v_dot2_f32_bf16 v13, v39, v11, v13
    v_dot2_f32_bf16 v12, v40, v11, v12
    v_dot2_f32_bf16 v13, v41, v11, v13
    v_dot2_f32_bf16 v12, v42, v11, v12
    v_dot2_f32_bf16 v13, v43, v11, v13
    v_dot2_f32_bf16 v12, v44, v11, v12
    v_dot2_f32_bf16 v13, v45, v11, v13
    v_dot2_f32_bf16 v12, v46, v11, v12
    v_dot2_f32_bf16 v13, v47, v11, v13
    v_dot2_f32_bf16 v12, v48, v11, v12
    v_dot2_f32_bf16 v13, v49, v11, v13
    v_dot2_f32_bf16 v12, v50, v11, v12
    v_dot2_f32_bf16 v13, v51, v11, v13
    s_nop 2
    v_add_f32 v12, v12, v13
    v_mov_b32 v13, v12
    s_nop 1
    v_permlane32_swap_b32 v12, v13
    v_add_f32 v12, v12, v13
    v_mov_b32 v13, v12
    s_nop 1
    v_permlane16_swap_b32 v12, v13
    v_add_f32 v12, v12, v13
    buffer_store_dword v12, v15, s[4:7], s49 offen sc1
    s_barrier
L_m_ll:
    s_and_b32 s25, s2, 7
    s_lshr_b32 s26, s2, 3
    s_lshl_b32 s23, s25, 2
    s_lshr_b32 s27, s26, 3
    s_add_u32 s23, s23, s27
    s_and_b32 s24, s26, 7
    s_add_u32 s25, s23, s24
    s_and_b32 s25, s25, 3
    s_mul_i32 s29, s24, 82944
    s_add_u32 s29, s29, 0x3a00000
    s_mul_i32 s30, s20, 36864
    s_mul_i32 s31, s20, 18432
    s_add_u32 s31, s31, s29
    s_add_u32 m0, s30, 18432
    s_add_u32 s33, s31, 0
    buffer_load_dwordx4 v1, s[4:7], s33 offen offset:0  lds
    buffer_load_dwordx4 v1, s[4:7], s33 offen offset:1024  lds
    buffer_load_dwordx4 v1, s[4:7], s33 offen offset:2048  lds
    buffer_load_dwordx4 v1, s[4:7], s33 offen offset:3072  lds
    s_add_u32 m0, s30, 22528
    s_add_u32 s33, s31, 4096
    buffer_load_dwordx4 v1, s[4:7], s33 offen offset:0  lds
    buffer_load_dwordx4 v1, s[4:7], s33 offen offset:1024  lds
    buffer_load_dwordx4 v1, s[4:7], s33 offen offset:2048  lds
    buffer_load_dwordx4 v1, s[4:7], s33 offen offset:3072  lds
    s_add_u32 m0, s30, 26624
    s_add_u32 s33, s31, 8192
    buffer_load_dwordx4 v1, s[4:7], s33 offen offset:0  lds
    buffer_load_dwordx4 v1, s[4:7], s33 offen offset:1024  lds
    buffer_load_dwordx4 v1, s[4:7], s33 offen offset:2048  lds
    buffer_load_dwordx4 v1, s[4:7], s33 offen offset:3072  lds
    s_add_u32 m0, s30, 30720
    s_add_u32 s33, s31, 12288
    buffer_load_dwordx4 v1, s[4:7], s33 offen offset:0  lds
    buffer_load_dwordx4 v1, s[4:7], s33 offen offset:1024  lds
    buffer_load_dwordx4 v1, s[4:7], s33 offen offset:2048  lds
    buffer_load_dwordx4 v1, s[4:7], s33 offen offset:3072  lds
    s_add_u32 m0, s30, 34816
    s_add_u32 s33, s31, 16384
    buffer_load_dwordx4 v1, s[4:7], s33 offen offset:0  lds
    buffer_load_dwordx4 v1, s[4:7], s33 offen offset:1024  lds
    s_mul_i32 s30, s20, 3072
    s_add_u32 s31, s30, s29
    s_waitcnt vmcnt(18)
    s_barrier
    s_add_u32 m0, s30, 147456
    s_add_u32 s33, s31, 73728
    buffer_load_dwordx4 v1, s[4:7], s33 offen offset:0  lds
    buffer_load_dwordx4 v1, s[4:7], s33 offen offset:1024  lds
    buffer_load_dwordx4 v1, s[4:7], s33 offen offset:2048  lds
    s_or_b32 s44, s20, s22
    s_cbranch_scc1 L_p2_ns
    s_and_b32 s44, s2, 15
    s_lshl_b32 s44, s44, 8
    s_add_u32 s44, s44, 0x4501000
    s_add_u32 s44, s44, s4
    s_addc_u32 s45, s5, 0
    s_mov_b32 s56, 1
    s_atomic_add s56, s[44:45], 0
L_p2_ns:
    s_waitcnt vmcnt(0)
    s_barrier
    s_and_b32 s25, s2, 7
    s_lshr_b32 s26, s2, 3
    s_and_b32 s23, s25, 1
    s_lshl_b32 s23, s23, 3
    s_and_b32 s27, s26, 7
    s_add_u32 s23, s23, s27
    s_lshr_b32 s24, s25, 1
    s_lshl_b32 s24, s24, 2
    s_lshr_b32 s27, s26, 3
    s_add_u32 s24, s24, s27
    s_add_u32 s28, s23, s24
    s_and_b32 s28, s28, 3
    s_lshl_b32 s30, s20, 12
    s_lshr_b32 s33, s20, 1
    s_mul_i32 s31, s33, 36864
    s_and_b32 s33, s20, 1
    s_lshl_b32 s33, s33, 10
    s_add_u32 s33, s33, 16384
    s_add_u32 s31, s31, s33
    s_sub_u32 s49, s33, s30
    s_mul_i32 s34, s24, 331776
    s_add_u32 s34, s34, s30
    s_add_u32 s34, s34, 0x3b00000
    s_lshl_b32 s35, s23, 3
    s_lshl_b32 s33, s20, 1
    s_add_u32 s35, s35, s33
    s_mul_i32 s35, s35, 18432
    s_add_u32 s35, s35, s21
    s_add_u32 s35, s35, 0x300000
    s_mul_i32 s36, s24, 589824
    s_add_u32 s36, s36, s30
    s_add_u32 s36, s36, s21
    s_add_u32 s36, s36, 0x900000
    v_add_u32 v2, 16384, v1
    s_lshl_b32 s33, s23, 7
    s_lshl_b32 s37, s20, 5
    s_add_u32 s33, s33, s37
    v_lshrrev_b32 v8, 7, v1
    v_add_u32 v8, s33, v8
    v_lshlrev_b32 v8, 12, v8
    v_lshrrev_b32 v9, 8, v1
    v_bfe_u32 v10, v1, 4, 3
    v_xor_b32 v9, v9, v10
    v_lshl_add_u32 v8, v9, 4, v8
    v_xor_b32 v9, 64, v8
    v_add_u32 v9, 31744, v9
    v_add_u32 v10, 63488, v8
    v_add_u32 v11, 63488, v9
    s_cmp_eq_u32 s28, 0
    s_cselect_b32 s44, 4, 0
    s_cmp_eq_u32 s28, 1
    s_cselect_b32 s45, 5, 1
    s_cmp_eq_u32 s28, 2
    s_cselect_b32 s46, 6, 2
    s_cmp_eq_u32 s28, 3
    s_cselect_b32 s47, 7, 3
    s_lshl_b32 s33, s20, 4
    s_add_u32 s33, s33, s24
    s_lshl_b32 s54, s22, 7
    s_add_u32 s54, s54, s33
    s_lshl_b32 s54, s54, 8
    s_add_u32 s54, s54, 0x450c000
    s_add_u32 s54, s54, s4
    s_addc_u32 s55, s5, 0
    s_mov_b32 s33, 0x4501000
    v_and_b32 v4, 0xf0, v1
    v_lshlrev_b32 v4, 4, v4
    s_mov_b32 s60, 65536
L_poll_wr:
    buffer_load_dword v5, v4, s[4:7], s33 offen sc1
    s_waitcnt vmcnt(0)
    v_cmp_gt_u32 vcc, 16, v5
    s_sub_u32 s60, s60, 1
    s_cbranch_scc1 L_pd_wr
    s_cbranch_vccz L_pd_wr
    s_sleep 4
    s_branch L_poll_wr
L_pd_wr:
    s_mov_b32 s48, 0
    s_mul_i32 s50, s48, 18432
    s_add_u32 s50, s50, s34
    s_add_u32 m0, s30, 0
    s_mov_b32 s53, s50
    buffer_load_dwordx4 v1, s[4:7], s50 offen offset:0  lds
    buffer_load_dwordx4 v1, s[4:7], s50 offen offset:1024  lds
    buffer_load_dwordx4 v1, s[4:7], s50 offen offset:2048  lds
    buffer_load_dwordx4 v1, s[4:7], s50 offen offset:3072  lds
    s_mov_b32 s48, 1
    s_mul_i32 s50, s48, 18432
    s_add_u32 s50, s50, s34
    s_cmp_ge_u32 s20, 2
    s_cselect_b32 s52, s50, s53
    s_add_u32 m0, s31, 0
    s_add_u32 s52, s52, s49
    buffer_load_dwordx4 v1, s[4:7], s52 offen  lds
    s_add_u32 m0, s30, 36864
    s_mov_b32 s53, s50
    buffer_load_dwordx4 v1, s[4:7], s50 offen offset:0  lds
    buffer_load_dwordx4 v1, s[4:7], s50 offen offset:1024  lds
    buffer_load_dwordx4 v1, s[4:7], s50 offen offset:2048  lds
    buffer_load_dwordx4 v1, s[4:7], s50 offen offset:3072  lds
    s_mov_b32 s48, 2
    s_mul_i32 s50, s48, 18432
    s_add_u32 s50, s50, s34
    s_add_u32 m0, s30, 73728
    s_mov_b32 s53, s50
    buffer_load_dwordx4 v1, s[4:7], s50 offen offset:0  lds
    buffer_load_dwordx4 v1, s[4:7], s50 offen offset:1024  lds
    buffer_load_dwordx4 v1, s[4:7], s50 offen offset:2048  lds
    buffer_load_dwordx4 v1, s[4:7], s50 offen offset:3072  lds
    s_min_u32 s33, s20, 2
    s_lshl_b32 s33, s33, 10
    s_add_u32 m0, s33, 159744
    s_lshl_b32 s51, s24, 12
    s_add_u32 s51, s51, s33
    s_add_u32 s51, s51, 0x4410000
    buffer_load_dwordx4 v1, s[4:7], s51 offen lds
    s_barrier
    s_mov_b32 s48, 3
    s_mul_i32 s50, s48, 18432
    s_add_u32 s50, s50, s34
    s_cmp_ge_u32 s20, 2
    s_cselect_b32 s52, s50, s53
    s_add_u32 m0, s31, 73728
    s_add_u32 s52, s52, s49
    buffer_load_dwordx4 v1, s[4:7], s52 offen  lds
    s_add_u32 m0, s30, 110592
    s_mov_b32 s53, s50
    buffer_load_dwordx4 v1, s[4:7], s50 offen offset:0  lds
    buffer_load_dwordx4 v1, s[4:7], s50 offen offset:1024  lds
    buffer_load_dwordx4 v1, s[4:7], s50 offen offset:2048  lds
    buffer_load_dwordx4 v1, s[4:7], s50 offen offset:3072  lds
    s_barrier
    s_mov_b32 s48, 0
    s_lshl_b32 s51, s48, 11
    s_add_u32 m0, s30, 18432
    s_add_u32 s51, s51, s35
    buffer_load_dwordx4 v1, s[4:7], s51 offen offset:0 sc1 lds
    buffer_load_dwordx4 v1, s[4:7], s51 offen offset:1024 sc1 lds
    buffer_load_dwordx4 v2, s[4:7], s51 offen offset:2048 sc1 lds
    buffer_load_dwordx4 v2, s[4:7], s51 offen offset:3072 sc1 lds
    s_mov_b32 s48, 1
    s_lshl_b32 s51, s48, 11
    s_add_u32 m0, s30, 55296
    s_add_u32 s51, s51, s35
    buffer_load_dwordx4 v1, s[4:7], s51 offen offset:0 sc1 lds
    buffer_load_dwordx4 v1, s[4:7], s51 offen offset:1024 sc1 lds
    buffer_load_dwordx4 v2, s[4:7], s51 offen offset:2048 sc1 lds
    buffer_load_dwordx4 v2, s[4:7], s51 offen offset:3072 sc1 lds
    s_waitcnt vmcnt(4)
    s_barrier
    s_mov_b32 s48, 2
    s_lshl_b32 s51, s48, 11
    s_add_u32 m0, s30, 92160
    s_add_u32 s51, s51, s35
    buffer_load_dwordx4 v1, s[4:7], s51 offen offset:0 sc1 lds
    buffer_load_dwordx4 v1, s[4:7], s51 offen offset:1024 sc1 lds
    buffer_load_dwordx4 v2, s[4:7], s51 offen offset:2048 sc1 lds
    buffer_load_dwordx4 v2, s[4:7], s51 offen offset:3072 sc1 lds
    s_mov_b32 s48, 3
    s_lshl_b32 s51, s48, 11
    s_add_u32 m0, s30, 129024
    s_add_u32 s51, s51, s35
    buffer_load_dwordx4 v1, s[4:7], s51 offen offset:0 sc1 lds
    buffer_load_dwordx4 v1, s[4:7], s51 offen offset:1024 sc1 lds
    buffer_load_dwordx4 v2, s[4:7], s51 offen offset:2048 sc1 lds
    buffer_load_dwordx4 v2, s[4:7], s51 offen offset:3072 sc1 lds
    s_waitcnt vmcnt(8)
    s_barrier
    s_mov_b32 s48, 4
    s_mul_i32 s50, s48, 18432
    s_add_u32 s50, s50, s34
    s_add_u32 m0, s30, 0
    s_mov_b32 s53, s50
    buffer_load_dwordx4 v1, s[4:7], s50 offen offset:0  lds
    buffer_load_dwordx4 v1, s[4:7], s50 offen offset:1024  lds
    buffer_load_dwordx4 v1, s[4:7], s50 offen offset:2048  lds
    buffer_load_dwordx4 v1, s[4:7], s50 offen offset:3072  lds
    s_mov_b32 s48, 4
    s_lshl_b32 s51, s48, 11
    s_add_u32 m0, s30, 18432
    s_add_u32 s51, s51, s35
    buffer_load_dwordx4 v1, s[4:7], s51 offen offset:0 sc1 lds
    buffer_load_dwordx4 v1, s[4:7], s51 offen offset:1024 sc1 lds
    buffer_load_dwordx4 v2, s[4:7], s51 offen offset:2048 sc1 lds
    buffer_load_dwordx4 v2, s[4:7], s51 offen offset:3072 sc1 lds
    s_waitcnt vmcnt(12)
    s_barrier
    s_mov_b32 s48, 5
    s_mul_i32 s50, s48, 18432
    s_add_u32 s50, s50, s34
    s_cmp_ge_u32 s20, 2
    s_cselect_b32 s52, s50, s53
    s_add_u32 m0, s31, 0
    s_add_u32 s52, s52, s49
    buffer_load_dwordx4 v1, s[4:7], s52 offen  lds
    s_add_u32 m0, s30, 36864
    s_mov_b32 s53, s50
    buffer_load_dwordx4 v1, s[4:7], s50 offen offset:0  lds
    buffer_load_dwordx4 v1, s[4:7], s50 offen offset:1024  lds
    buffer_load_dwordx4 v1, s[4:7], s50 offen offset:2048  lds
    buffer_load_dwordx4 v1, s[4:7], s50 offen offset:3072  lds
    s_mov_b32 s48, 5
    s_lshl_b32 s51, s48, 11
    s_add_u32 m0, s30, 55296
    s_add_u32 s51, s51, s35
    buffer_load_dwordx4 v1, s[4:7], s51 offen offset:0 sc1 lds
    buffer_load_dwordx4 v1, s[4:7], s51 offen offset:1024 sc1 lds
    buffer_load_dwordx4 v2, s[4:7], s51 offen offset:2048 sc1 lds
    buffer_load_dwordx4 v2, s[4:7], s51 offen offset:3072 sc1 lds
    s_waitcnt vmcnt(17)
    s_barrier
    s_mov_b32 s48, 6
    s_mul_i32 s50, s48, 18432
    s_add_u32 s50, s50, s34
    s_add_u32 m0, s30, 73728
    s_mov_b32 s53, s50
    buffer_load_dwordx4 v1, s[4:7], s50 offen offset:0  lds
    buffer_load_dwordx4 v1, s[4:7], s50 offen offset:1024  lds
    buffer_load_dwordx4 v1, s[4:7], s50 offen offset:2048  lds
    buffer_load_dwordx4 v1, s[4:7], s50 offen offset:3072  lds
    s_mov_b32 s48, 6
    s_lshl_b32 s51, s48, 11
    s_add_u32 m0, s30, 92160
    s_add_u32 s51, s51, s35
    buffer_load_dwordx4 v1, s[4:7], s51 offen offset:0 sc1 lds
    buffer_load_dwordx4 v1, s[4:7], s51 offen offset:1024 sc1 lds
    buffer_load_dwordx4 v2, s[4:7], s51 offen offset:2048 sc1 lds
    buffer_load_dwordx4 v2, s[4:7], s51 offen offset:3072 sc1 lds
    s_waitcnt vmcnt(16)
    s_barrier
    s_mov_b32 s48, 7
    s_mul_i32 s50, s48, 18432
    s_add_u32 s50, s50, s34
    s_cmp_ge_u32 s20, 2
    s_cselect_b32 s52, s50, s53
    s_add_u32 m0, s31, 73728
    s_add_u32 s52, s52, s49
    buffer_load_dwordx4 v1, s[4:7], s52 offen  lds
    s_add_u32 m0, s30, 110592
    s_mov_b32 s53, s50
    buffer_load_dwordx4 v1, s[4:7], s50 offen offset:0  lds
    buffer_load_dwordx4 v1, s[4:7], s50 offen offset:1024  lds
    buffer_load_dwordx4 v1, s[4:7], s50 offen offset:2048  lds
    buffer_load_dwordx4 v1, s[4:7], s50 offen offset:3072  lds
    s_mov_b32 s48, 7
    s_lshl_b32 s51, s48, 11
    s_add_u32 m0, s30, 129024
    s_add_u32 s51, s51, s35
    buffer_load_dwordx4 v1, s[4:7], s51 offen offset:0 sc1 lds
    buffer_load_dwordx4 v1, s[4:7], s51 offen offset:1024 sc1 lds
    buffer_load_dwordx4 v2, s[4:7], s51 offen offset:2048 sc1 lds
    buffer_load_dwordx4 v2, s[4:7], s51 offen offset:3072 sc1 lds
    s_waitcnt vmcnt(17)
    s_barrier
    s_mov_b32 s48, 8
    s_mul_i32 s50, s48, 18432
    s_add_u32 s50, s50, s34
    s_add_u32 m0, s30, 0
    s_mov_b32 s53, s50
    buffer_load_dwordx4 v1, s[4:7], s50 offen offset:0  lds
    buffer_load_dwordx4 v1, s[4:7], s50 offen offset:1024  lds
    buffer_load_dwordx4 v1, s[4:7], s50 offen offset:2048  lds
    buffer_load_dwordx4 v1, s[4:7], s50 offen offset:3072  lds
    s_mov_b32 s48, 8
    s_lshl_b32 s51, s48, 11
    s_add_u32 m0, s30, 18432
    s_add_u32 s51, s51, s35
    buffer_load_dwordx4 v1, s[4:7], s51 offen offset:0 sc1 lds
    buffer_load_dwordx4 v1, s[4:7], s51 offen offset:1024 sc1 lds
    buffer_load_dwordx4 v2, s[4:7], s51 offen offset:2048 sc1 lds
    buffer_load_dwordx4 v2, s[4:7], s51 offen offset:3072 sc1 lds
    s_waitcnt vmcnt(16)
    s_barrier
    s_mov_b32 s48, 0
    s_mul_i32 s50, s48, 18432
    s_add_u32 s50, s50, s34
    s_add_u32 s50, s50, 165888
    s_cmp_ge_u32 s20, 2
    s_cselect_b32 s52, s50, s53
    s_add_u32 m0, s31, 0
    s_add_u32 s52, s52, s49
    buffer_load_dwordx4 v1, s[4:7], s52 offen  lds
    s_add_u32 m0, s30, 36864
    s_mov_b32 s53, s50
    buffer_load_dwordx4 v1, s[4:7], s50 offen offset:0  lds
    buffer_load_dwordx4 v1, s[4:7], s50 offen offset:1024  lds
    buffer_load_dwordx4 v1, s[4:7], s50 offen offset:2048  lds
    buffer_load_dwordx4 v1, s[4:7], s50 offen offset:3072  lds
    s_mov_b32 s48, 0
    s_lshl_b32 s51, s48, 11
    s_add_u32 m0, s30, 55296
    s_add_u32 s51, s51, s35
    buffer_load_dwordx4 v1, s[4:7], s51 offen offset:0 sc1 lds
    buffer_load_dwordx4 v1, s[4:7], s51 offen offset:1024 sc1 lds
    buffer_load_dwordx4 v2, s[4:7], s51 offen offset:2048 sc1 lds
    buffer_load_dwordx4 v2, s[4:7], s51 offen offset:3072 sc1 lds
    s_waitcnt vmcnt(17)
    s_barrier
    s_mov_b32 s48, 1
    s_mul_i32 s50, s48, 18432
    s_add_u32 s50, s50, s34
    s_add_u32 s50, s50, 165888
    s_add_u32 m0, s30, 73728
    s_mov_b32 s53, s50
    buffer_load_dwordx4 v1, s[4:7], s50 offen offset:0  lds
    buffer_load_dwordx4 v1, s[4:7], s50 offen offset:1024  lds
    buffer_load_dwordx4 v1, s[4:7], s50 offen offset:2048  lds
    buffer_load_dwordx4 v1, s[4:7], s50 offen offset:3072  lds
    s_mov_b32 s48, 1
    s_lshl_b32 s51, s48, 11
    s_add_u32 m0, s30, 92160
    s_add_u32 s51, s51, s35
    buffer_load_dwordx4 v1, s[4:7], s51 offen offset:0 sc1 lds
    buffer_load_dwordx4 v1, s[4:7], s51 offen offset:1024 sc1 lds
    buffer_load_dwordx4 v2, s[4:7], s51 offen offset:2048 sc1 lds
    buffer_load_dwordx4 v2, s[4:7], s51 offen offset:3072 sc1 lds
    s_waitcnt vmcnt(16)
    s_barrier
    s_mov_b32 s48, 2
    s_mul_i32 s50, s48, 18432
    s_add_u32 s50, s50, s34
    s_add_u32 s50, s50, 165888
    s_cmp_ge_u32 s20, 2
    s_cselect_b32 s52, s50, s53
    s_add_u32 m0, s31, 73728
    s_add_u32 s52, s52, s49
    buffer_load_dwordx4 v1, s[4:7], s52 offen  lds
    s_add_u32 m0, s30, 110592
    s_mov_b32 s53, s50
    buffer_load_dwordx4 v1, s[4:7], s50 offen offset:0  lds
    buffer_load_dwordx4 v1, s[4:7], s50 offen offset:1024  lds
    buffer_load_dwordx4 v1, s[4:7], s50 offen offset:2048  lds
    buffer_load_dwordx4 v1, s[4:7], s50 offen offset:3072  lds
    s_mov_b32 s48, 2
    s_lshl_b32 s51, s48, 11
    s_add_u32 m0, s30, 129024
    s_add_u32 s51, s51, s35
    buffer_load_dwordx4 v1, s[4:7], s51 offen offset:0 sc1 lds
    buffer_load_dwordx4 v1, s[4:7], s51 offen offset:1024 sc1 lds
    buffer_load_dwordx4 v2, s[4:7], s51 offen offset:2048 sc1 lds
    buffer_load_dwordx4 v2, s[4:7], s51 offen offset:3072 sc1 lds
    s_waitcnt vmcnt(17)
    s_barrier
    s_mov_b32 s48, 3
    s_mul_i32 s50, s48, 18432
    s_add_u32 s50, s50, s34
    s_add_u32 s50, s50, 165888
    s_add_u32 m0, s30, 0
    s_mov_b32 s53, s50
    buffer_load_dwordx4 v1, s[4:7], s50 offen offset:0  lds
    buffer_load_dwordx4 v1, s[4:7], s50 offen offset:1024  lds
    buffer_load_dwordx4 v1, s[4:7], s50 offen offset:2048  lds
    buffer_load_dwordx4 v1, s[4:7], s50 offen offset:3072  lds
    s_mov_b32 s48, 3
    s_lshl_b32 s51, s48, 11
    s_add_u32 m0, s30, 18432
    s_add_u32 s51, s51, s35
    buffer_load_dwordx4 v1, s[4:7], s51 offen offset:0 sc1 lds
    buffer_load_dwordx4 v1, s[4:7], s51 offen offset:1024 sc1 lds
    buffer_load_dwordx4 v2, s[4:7], s51 offen offset:2048 sc1 lds
    buffer_load_dwordx4 v2, s[4:7], s51 offen offset:3072 sc1 lds
    s_waitcnt vmcnt(16)
    s_barrier
    s_mov_b32 s48, 4
    s_mul_i32 s50, s48, 18432
    s_add_u32 s50, s50, s34
    s_add_u32 s50, s50, 165888
    s_cmp_ge_u32 s20, 2
    s_cselect_b32 s52, s50, s53
    s_add_u32 m0, s31, 0
    s_add_u32 s52, s52, s49
    buffer_load_dwordx4 v1, s[4:7], s52 offen  lds
    s_add_u32 m0, s30, 36864
    s_mov_b32 s53, s50
    buffer_load_dwordx4 v1, s[4:7], s50 offen offset:0  lds
    buffer_load_dwordx4 v1, s[4:7], s50 offen offset:1024  lds
    buffer_load_dwordx4 v1, s[4:7], s50 offen offset:2048  lds
    buffer_load_dwordx4 v1, s[4:7], s50 offen offset:3072  lds
    s_mov_b32 s48, 4
    s_lshl_b32 s51, s48, 11
    s_add_u32 m0, s30, 55296
    s_add_u32 s51, s51, s35
    buffer_load_dwordx4 v1, s[4:7], s51 offen offset:0 sc1 lds
    buffer_load_dwordx4 v1, s[4:7], s51 offen offset:1024 sc1 lds
    buffer_load_dwordx4 v2, s[4:7], s51 offen offset:2048 sc1 lds
    buffer_load_dwordx4 v2, s[4:7], s51 offen offset:3072 sc1 lds
    s_waitcnt vmcnt(17)
    s_barrier
    s_mov_b32 s48, 5
    s_mul_i32 s50, s48, 18432
    s_add_u32 s50, s50, s34
    s_add_u32 s50, s50, 165888
    s_add_u32 m0, s30, 73728
    s_mov_b32 s53, s50
    buffer_load_dwordx4 v1, s[4:7], s50 offen offset:0  lds
    buffer_load_dwordx4 v1, s[4:7], s50 offen offset:1024  lds
    buffer_load_dwordx4 v1, s[4:7], s50 offen offset:2048  lds
    buffer_load_dwordx4 v1, s[4:7], s50 offen offset:3072  lds
    s_mov_b32 s48, 5
    s_lshl_b32 s51, s48, 11
    s_add_u32 m0, s30, 92160
    s_add_u32 s51, s51, s35
    buffer_load_dwordx4 v1, s[4:7], s51 offen offset:0 sc1 lds
    buffer_load_dwordx4 v1, s[4:7], s51 offen offset:1024 sc1 lds
    buffer_load_dwordx4 v2, s[4:7], s51 offen offset:2048 sc1 lds
    buffer_load_dwordx4 v2, s[4:7], s51 offen offset:3072 sc1 lds
    s_waitcnt vmcnt(16)
    s_barrier
    s_mov_b32 s48, 6
    s_mul_i32 s50, s48, 18432
    s_add_u32 s50, s50, s34
    s_add_u32 s50, s50, 165888
    s_cmp_ge_u32 s20, 2
    s_cselect_b32 s52, s50, s53
    s_add_u32 m0, s31, 73728
    s_add_u32 s52, s52, s49
    buffer_load_dwordx4 v1, s[4:7], s52 offen  lds
    s_add_u32 m0, s30, 110592
    s_mov_b32 s53, s50
    buffer_load_dwordx4 v1, s[4:7], s50 offen offset:0  lds
    buffer_load_dwordx4 v1, s[4:7], s50 offen offset:1024  lds
    buffer_load_dwordx4 v1, s[4:7], s50 offen offset:2048  lds
    buffer_load_dwordx4 v1, s[4:7], s50 offen offset:3072  lds
    s_mov_b32 s48, 6
    s_lshl_b32 s51, s48, 11
    s_add_u32 m0, s30, 129024
    s_add_u32 s51, s51, s35
    buffer_load_dwordx4 v1, s[4:7], s51 offen offset:0 sc1 lds
    buffer_load_dwordx4 v1, s[4:7], s51 offen offset:1024 sc1 lds
    buffer_load_dwordx4 v2, s[4:7], s51 offen offset:2048 sc1 lds
    buffer_load_dwordx4 v2, s[4:7], s51 offen offset:3072 sc1 lds
    s_waitcnt vmcnt(17)
    s_barrier
    s_mov_b32 s48, 7
    s_mul_i32 s50, s48, 18432
    s_add_u32 s50, s50, s34
    s_add_u32 s50, s50, 165888
    s_add_u32 m0, s30, 0
    s_mov_b32 s53, s50
    buffer_load_dwordx4 v1, s[4:7], s50 offen offset:0  lds
    buffer_load_dwordx4 v1, s[4:7], s50 offen offset:1024  lds
    buffer_load_dwordx4 v1, s[4:7], s50 offen offset:2048  lds
    buffer_load_dwordx4 v1, s[4:7], s50 offen offset:3072  lds
    s_mov_b32 s48, 7
    s_lshl_b32 s51, s48, 11
    s_add_u32 m0, s30, 18432
    s_add_u32 s51, s51, s35
    buffer_load_dwordx4 v1, s[4:7], s51 offen offset:0 sc1 lds
    buffer_load_dwordx4 v1, s[4:7], s51 offen offset:1024 sc1 lds
    buffer_load_dwordx4 v2, s[4:7], s51 offen offset:2048 sc1 lds
    buffer_load_dwordx4 v2, s[4:7], s51 offen offset:3072 sc1 lds
    s_waitcnt vmcnt(16)
    s_barrier
    s_mov_b32 s48, 8
    s_mul_i32 s50, s48, 18432
    s_add_u32 s50, s50, s34
    s_add_u32 s50, s50, 165888
    s_cmp_ge_u32 s20, 2
    s_cselect_b32 s52, s50, s53
    s_add_u32 m0, s31, 0
    s_add_u32 s52, s52, s49
    buffer_load_dwordx4 v1, s[4:7], s52 offen  lds
    s_add_u32 m0, s30, 36864
    s_mov_b32 s53, s50
    buffer_load_dwordx4 v1, s[4:7], s50 offen offset:0  lds
    buffer_load_dwordx4 v1, s[4:7], s50 offen offset:1024  lds
    buffer_load_dwordx4 v1, s[4:7], s50 offen offset:2048  lds
    buffer_load_dwordx4 v1, s[4:7], s50 offen offset:3072  lds
    s_mov_b32 s48, 8
    s_lshl_b32 s51, s48, 11
    s_add_u32 m0, s30, 55296
    s_add_u32 s51, s51, s35
    buffer_load_dwordx4 v1, s[4:7], s51 offen offset:0 sc1 lds
    buffer_load_dwordx4 v1, s[4:7], s51 offen offset:1024 sc1 lds
    buffer_load_dwordx4 v2, s[4:7], s51 offen offset:2048 sc1 lds
    buffer_load_dwordx4 v2, s[4:7], s51 offen offset:3072 sc1 lds
    s_waitcnt vmcnt(17)
    s_barrier
    s_waitcnt vmcnt(8)
    s_barrier
    s_waitcnt vmcnt(0)
    s_barrier
    s_barrier
    s_mov_b32 s56, 1
    s_atomic_add s56, s[54:55], 0
    s_add_u32 m0, s30, 92160
    s_lshl_b32 s51, s44, 7
    buffer_load_dwordx4 v8, s[8:11], s51 offen offset:0  lds
    buffer_load_dwordx4 v9, s[8:11], s51 offen offset:1024  lds
    buffer_load_dwordx4 v10, s[8:11], s51 offen offset:2048  lds
    buffer_load_dwordx4 v11, s[8:11], s51 offen offset:3072  lds
    s_add_u32 m0, s30, 129024
    s_lshl_b32 s51, s45, 7
    buffer_load_dwordx4 v8, s[8:11], s51 offen offset:0  lds
    buffer_load_dwordx4 v9, s[8:11], s51 offen offset:1024  lds
    buffer_load_dwordx4 v10, s[8:11], s51 offen offset:2048  lds
    buffer_load_dwordx4 v11, s[8:11], s51 offen offset:3072  lds
    s_add_u32 m0, s30, 18432
    s_lshl_b32 s51, s46, 7
    buffer_load_dwordx4 v8, s[8:11], s51 offen offset:0  lds
    buffer_load_dwordx4 v9, s[8:11], s51 offen offset:1024  lds
    buffer_load_dwordx4 v10, s[8:11], s51 offen offset:2048  lds
    buffer_load_dwordx4 v11, s[8:11], s51 offen offset:3072  lds
    s_and_b32 s40, s2, 7
    s_lshr_b32 s26, s2, 3
    s_lshl_b32 s38, s40, 2
    s_lshr_b32 s27, s26, 3
    s_add_u32 s38, s38, s27
    s_and_b32 s39, s26, 7
    s_add_u32 s40, s38, s39
    s_and_b32 s40, s40, 3
    s_mul_i32 s42, s20, 9216
    s_mul_i32 s43, s39, 331776
    s_add_u32 s43, s43, s42
    s_add_u32 s43, s43, 0x4100000
    v_add_u32 v12, s42, v1
    v_add_u32 v13, 36864, v12
    v_add_u32 v14, 73728, v12
    v_add_u32 v15, 110592, v12
    s_mov_b32 s60, 65536
L_poll_z2:
    s_mov_b32 s57, 0
    s_atomic_add s57, s[54:55], 0 glc
    s_waitcnt lgkmcnt(0)
    s_cmp_ge_u32 s57, 16
    s_cbranch_scc1 L_pd_z2
    s_sub_u32 s60, s60, 1
    s_cbranch_scc1 L_pd_z2
    s_sleep 2
    s_branch L_poll_z2
L_pd_z2:
    s_mul_i32 s50, s44, 18432
    s_add_u32 s50, s50, s36
    s_add_u32 m0, s30, 73728
    s_mov_b32 s53, s50
    buffer_load_dwordx4 v1, s[4:7], s50 offen offset:0 sc1 lds
    buffer_load_dwordx4 v1, s[4:7], s50 offen offset:1024 sc1 lds
    buffer_load_dwordx4 v1, s[4:7], s50 offen offset:2048 sc1 lds
    buffer_load_dwordx4 v1, s[4:7], s50 offen offset:3072 sc1 lds
    s_add_u32 s44, s44, 4
    s_and_b32 s44, s44, 31
    s_mul_i32 s50, s45, 18432
    s_add_u32 s50, s50, s36
    s_cmp_ge_u32 s20, 2
    s_cselect_b32 s52, s50, s53
    s_add_u32 m0, s31, 73728
    s_add_u32 s52, s52, s49
    buffer_load_dwordx4 v1, s[4:7], s52 offen sc1 lds
    s_add_u32 m0, s30, 110592
    s_mov_b32 s53, s50
    buffer_load_dwordx4 v1, s[4:7], s50 offen offset:0 sc1 lds
    buffer_load_dwordx4 v1, s[4:7], s50 offen offset:1024 sc1 lds
    buffer_load_dwordx4 v1, s[4:7], s50 offen offset:2048 sc1 lds
    buffer_load_dwordx4 v1, s[4:7], s50 offen offset:3072 sc1 lds
    s_add_u32 s45, s45, 4
    s_and_b32 s45, s45, 31
    s_mul_i32 s50, s46, 18432
    s_add_u32 s50, s50, s36
    s_add_u32 m0, s30, 0
    s_mov_b32 s53, s50
    buffer_load_dwordx4 v1, s[4:7], s50 offen offset:0 sc1 lds
    buffer_load_dwordx4 v1, s[4:7], s50 offen offset:1024 sc1 lds
    buffer_load_dwordx4 v1, s[4:7], s50 offen offset:2048 sc1 lds
    buffer_load_dwordx4 v1, s[4:7], s50 offen offset:3072 sc1 lds
    s_add_u32 s46, s46, 4
    s_and_b32 s46, s46, 31
    s_waitcnt vmcnt(8)
    s_barrier
    s_mul_i32 s50, s47, 18432
    s_add_u32 s50, s50, s36
    s_cmp_ge_u32 s20, 2
    s_cselect_b32 s52, s50, s53
    s_add_u32 m0, s31, 0
    s_add_u32 s52, s52, s49
    buffer_load_dwordx4 v1, s[4:7], s52 offen sc1 lds
    s_add_u32 m0, s30, 36864
    s_mov_b32 s53, s50
    buffer_load_dwordx4 v1, s[4:7], s50 offen offset:0 sc1 lds
    buffer_load_dwordx4 v1, s[4:7], s50 offen offset:1024 sc1 lds
    buffer_load_dwordx4 v1, s[4:7], s50 offen offset:2048 sc1 lds
    buffer_load_dwordx4 v1, s[4:7], s50 offen offset:3072 sc1 lds
    s_add_u32 m0, s30, 55296
    s_lshl_b32 s51, s47, 7
    buffer_load_dwordx4 v8, s[8:11], s51 offen offset:0  lds
    buffer_load_dwordx4 v9, s[8:11], s51 offen offset:1024  lds
    buffer_load_dwordx4 v10, s[8:11], s51 offen offset:2048  lds
    buffer_load_dwordx4 v11, s[8:11], s51 offen offset:3072  lds
    s_add_u32 s47, s47, 4
    s_and_b32 s47, s47, 31
    s_waitcnt vmcnt(13)
    s_barrier
    s_mul_i32 s50, s44, 18432
    s_add_u32 s50, s50, s36
    s_add_u32 m0, s30, 73728
    s_mov_b32 s53, s50
    buffer_load_dwordx4 v1, s[4:7], s50 offen offset:0 sc1 lds
    buffer_load_dwordx4 v1, s[4:7], s50 offen offset:1024 sc1 lds
    buffer_load_dwordx4 v1, s[4:7], s50 offen offset:2048 sc1 lds
    buffer_load_dwordx4 v1, s[4:7], s50 offen offset:3072 sc1 lds
    s_add_u32 m0, s30, 92160
    s_lshl_b32 s51, s44, 7
    buffer_load_dwordx4 v8, s[8:11], s51 offen offset:0  lds
    buffer_load_dwordx4 v9, s[8:11], s51 offen offset:1024  lds
    buffer_load_dwordx4 v10, s[8:11], s51 offen offset:2048  lds
    buffer_load_dwordx4 v11, s[8:11], s51 offen offset:3072  lds
    s_add_u32 s44, s44, 4
    s_and_b32 s44, s44, 31
    s_waitcnt vmcnt(16)
    s_barrier
    s_mul_i32 s50, s45, 18432
    s_add_u32 s50, s50, s36
    s_cmp_ge_u32 s20, 2
    s_cselect_b32 s52, s50, s53
    s_add_u32 m0, s31, 73728
    s_add_u32 s52, s52, s49
    buffer_load_dwordx4 v1, s[4:7], s52 offen sc1 lds
    s_add_u32 m0, s30, 110592
    s_mov_b32 s53, s50
    buffer_load_dwordx4 v1, s[4:7], s50 offen offset:0 sc1 lds
    buffer_load_dwordx4 v1, s[4:7], s50 offen offset:1024 sc1 lds
    buffer_load_dwordx4 v1, s[4:7], s50 offen offset:2048 sc1 lds
    buffer_load_dwordx4 v1, s[4:7], s50 offen offset:3072 sc1 lds
    s_add_u32 m0, s30, 129024
    s_lshl_b32 s51, s45, 7
    buffer_load_dwordx4 v8, s[8:11], s51 offen offset:0  lds
    buffer_load_dwordx4 v9, s[8:11], s51 offen offset:1024  lds
    buffer_load_dwordx4 v10, s[8:11], s51 offen offset:2048  lds
    buffer_load_dwordx4 v11, s[8:11], s51 offen offset:3072  lds
    s_add_u32 s45, s45, 4
    s_and_b32 s45, s45, 31
    s_waitcnt vmcnt(17)
    s_barrier
    s_mul_i32 s50, s46, 18432
    s_add_u32 s50, s50, s36
    s_add_u32 m0, s30, 0
    s_mov_b32 s53, s50
    buffer_load_dwordx4 v1, s[4:7], s50 offen offset:0 sc1 lds
    buffer_load_dwordx4 v1, s[4:7], s50 offen offset:1024 sc1 lds
    buffer_load_dwordx4 v1, s[4:7], s50 offen offset:2048 sc1 lds
    buffer_load_dwordx4 v1, s[4:7], s50 offen offset:3072 sc1 lds
    s_add_u32 m0, s30, 18432
    s_lshl_b32 s51, s46, 7
    buffer_load_dwordx4 v8, s[8:11], s51 offen offset:0  lds
    buffer_load_dwordx4 v9, s[8:11], s51 offen offset:1024  lds
    buffer_load_dwordx4 v10, s[8:11], s51 offen offset:2048  lds
    buffer_load_dwordx4 v11, s[8:11], s51 offen offset:3072  lds
    s_add_u32 s46, s46, 4
    s_and_b32 s46, s46, 31
    s_waitcnt vmcnt(16)
    s_barrier
    s_mul_i32 s50, s47, 18432
    s_add_u32 s50, s50, s36
    s_cmp_ge_u32 s20, 2
    s_cselect_b32 s52, s50, s53
    s_add_u32 m0, s31, 0
    s_add_u32 s52, s52, s49
    buffer_load_dwordx4 v1, s[4:7], s52 offen sc1 lds
    s_add_u32 m0, s30, 36864
    s_mov_b32 s53, s50
    buffer_load_dwordx4 v1, s[4:7], s50 offen offset:0 sc1 lds
    buffer_load_dwordx4 v1, s[4:7], s50 offen offset:1024 sc1 lds
    buffer_load_dwordx4 v1, s[4:7], s50 offen offset:2048 sc1 lds
    buffer_load_dwordx4 v1, s[4:7], s50 offen offset:3072 sc1 lds
    s_add_u32 m0, s30, 55296
    s_lshl_b32 s51, s47, 7
    buffer_load_dwordx4 v8, s[8:11], s51 offen offset:0  lds
    buffer_load_dwordx4 v9, s[8:11], s51 offen offset:1024  lds
    buffer_load_dwordx4 v10, s[8:11], s51 offen offset:2048  lds
    buffer_load_dwordx4 v11, s[8:11], s51 offen offset:3072  lds
    s_add_u32 s47, s47, 4
    s_and_b32 s47, s47, 31
    s_mov_b32 s41, 6
L_g_ll:
    s_waitcnt vmcnt(17)
    s_barrier
    s_mul_i32 s50, s44, 18432
    s_add_u32 s50, s50, s36
    s_add_u32 m0, s30, 73728
    s_mov_b32 s53, s50
    buffer_load_dwordx4 v1, s[4:7], s50 offen offset:0 sc1 lds
    buffer_load_dwordx4 v1, s[4:7], s50 offen offset:1024 sc1 lds
    buffer_load_dwordx4 v1, s[4:7], s50 offen offset:2048 sc1 lds
    buffer_load_dwordx4 v1, s[4:7], s50 offen offset:3072 sc1 lds
    s_add_u32 m0, s30, 92160
    s_lshl_b32 s51, s44, 7
    buffer_load_dwordx4 v8, s[8:11], s51 offen offset:0  lds
    buffer_load_dwordx4 v9, s[8:11], s51 offen offset:1024  lds
    buffer_load_dwordx4 v10, s[8:11], s51 offen offset:2048  lds
    buffer_load_dwordx4 v11, s[8:11], s51 offen offset:3072  lds
    s_add_u32 s44, s44, 4
    s_and_b32 s44, s44, 31
    s_waitcnt vmcnt(16)
    s_barrier
    s_mul_i32 s50, s45, 18432
    s_add_u32 s50, s50, s36
    s_cmp_ge_u32 s20, 2
    s_cselect_b32 s52, s50, s53
    s_add_u32 m0, s31, 73728
    s_add_u32 s52, s52, s49
    buffer_load_dwordx4 v1, s[4:7], s52 offen sc1 lds
    s_add_u32 m0, s30, 110592
    s_mov_b32 s53, s50
    buffer_load_dwordx4 v1, s[4:7], s50 offen offset:0 sc1 lds
    buffer_load_dwordx4 v1, s[4:7], s50 offen offset:1024 sc1 lds
    buffer_load_dwordx4 v1, s[4:7], s50 offen offset:2048 sc1 lds
    buffer_load_dwordx4 v1, s[4:7], s50 offen offset:3072 sc1 lds
    s_add_u32 m0, s30, 129024
    s_lshl_b32 s51, s45, 7
    buffer_load_dwordx4 v8, s[8:11], s51 offen offset:0  lds
    buffer_load_dwordx4 v9, s[8:11], s51 offen offset:1024  lds
    buffer_load_dwordx4 v10, s[8:11], s51 offen offset:2048  lds
    buffer_load_dwordx4 v11, s[8:11], s51 offen offset:3072  lds
    s_add_u32 s45, s45, 4
    s_and_b32 s45, s45, 31
    s_waitcnt vmcnt(17)
    s_barrier
    s_mul_i32 s50, s46, 18432
    s_add_u32 s50, s50, s36
    s_add_u32 m0, s30, 0
    s_mov_b32 s53, s50
    buffer_load_dwordx4 v1, s[4:7], s50 offen offset:0 sc1 lds
    buffer_load_dwordx4 v1, s[4:7], s50 offen offset:1024 sc1 lds
    buffer_load_dwordx4 v1, s[4:7], s50 offen offset:2048 sc1 lds
    buffer_load_dwordx4 v1, s[4:7], s50 offen offset:3072 sc1 lds
    s_add_u32 m0, s30, 18432
    s_lshl_b32 s51, s46, 7
    buffer_load_dwordx4 v8, s[8:11], s51 offen offset:0  lds
    buffer_load_dwordx4 v9, s[8:11], s51 offen offset:1024  lds
    buffer_load_dwordx4 v10, s[8:11], s51 offen offset:2048  lds
    buffer_load_dwordx4 v11, s[8:11], s51 offen offset:3072  lds
    s_add_u32 s46, s46, 4
    s_and_b32 s46, s46, 31
    s_waitcnt vmcnt(16)
    s_barrier
    s_mul_i32 s50, s47, 18432
    s_add_u32 s50, s50, s36
    s_cmp_ge_u32 s20, 2
    s_cselect_b32 s52, s50, s53
    s_add_u32 m0, s31, 0
    s_add_u32 s52, s52, s49
    buffer_load_dwordx4 v1, s[4:7], s52 offen sc1 lds
    s_add_u32 m0, s30, 36864
    s_mov_b32 s53, s50
    buffer_load_dwordx4 v1, s[4:7], s50 offen offset:0 sc1 lds
    buffer_load_dwordx4 v1, s[4:7], s50 offen offset:1024 sc1 lds
    buffer_load_dwordx4 v1, s[4:7], s50 offen offset:2048 sc1 lds
    buffer_load_dwordx4 v1, s[4:7], s50 offen offset:3072 sc1 lds
    s_add_u32 m0, s30, 55296
    s_lshl_b32 s51, s47, 7
    buffer_load_dwordx4 v8, s[8:11], s51 offen offset:0  lds
    buffer_load_dwordx4 v9, s[8:11], s51 offen offset:1024  lds
    buffer_load_dwordx4 v10, s[8:11], s51 offen offset:2048  lds
    buffer_load_dwordx4 v11, s[8:11], s51 offen offset:3072  lds
    s_add_u32 s47, s47, 4
    s_and_b32 s47, s47, 31
    s_sub_u32 s41, s41, 1
    s_cmp_lg_u32 s41, 0
    s_cbranch_scc1 L_g_ll
    s_waitcnt vmcnt(17)
    s_barrier
    s_mov_b32 s32, 0
    s_mul_i32 s32, s32, 36864
    s_add_u32 s32, s32, s43
    s_add_u32 m0, s42, 73728
    s_add_u32 s33, s32, 0
    buffer_load_dwordx4 v1, s[4:7], s33 offen offset:0  lds
    buffer_load_dwordx4 v1, s[4:7], s33 offen offset:1024  lds
    buffer_load_dwordx4 v1, s[4:7], s33 offen offset:2048  lds
    buffer_load_dwordx4 v1, s[4:7], s33 offen offset:3072  lds
    s_add_u32 m0, s42, 77824
    s_add_u32 s33, s32, 4096
    buffer_load_dwordx4 v1, s[4:7], s33 offen offset:0  lds
    buffer_load_dwordx4 v1, s[4:7], s33 offen offset:1024  lds
    buffer_load_dwordx4 v1, s[4:7], s33 offen offset:2048  lds
    buffer_load_dwordx4 v1, s[4:7], s33 offen offset:3072  lds
    s_add_u32 m0, s42, 81920
    s_add_u32 s33, s32, 8192
    buffer_load_dwordx4 v1, s[4:7], s33 offen offset:0  lds
    s_waitcnt vmcnt(17)
    s_barrier
    s_mov_b32 s32, 1
    s_mul_i32 s32, s32, 36864
    s_add_u32 s32, s32, s43
    s_add_u32 m0, s42, 110592
    s_add_u32 s33, s32, 0
    buffer_load_dwordx4 v1, s[4:7], s33 offen offset:0  lds
    buffer_load_dwordx4 v1, s[4:7], s33 offen offset:1024  lds
    buffer_load_dwordx4 v1, s[4:7], s33 offen offset:2048  lds
    buffer_load_dwordx4 v1, s[4:7], s33 offen offset:3072  lds
    s_add_u32 m0, s42, 114688
    s_add_u32 s33, s32, 4096
    buffer_load_dwordx4 v1, s[4:7], s33 offen offset:0  lds
    buffer_load_dwordx4 v1, s[4:7], s33 offen offset:1024  lds
    buffer_load_dwordx4 v1, s[4:7], s33 offen offset:2048  lds
    buffer_load_dwordx4 v1, s[4:7], s33 offen offset:3072  lds
    s_add_u32 m0, s42, 118784
    s_add_u32 s33, s32, 8192
    buffer_load_dwordx4 v1, s[4:7], s33 offen offset:0  lds
    s_waitcnt vmcnt(18)
    s_barrier
    s_mov_b32 s32, 2
    s_mul_i32 s32, s32, 36864
    s_add_u32 s32, s32, s43
    s_add_u32 m0, s42, 0
    s_add_u32 s33, s32, 0
    buffer_load_dwordx4 v1, s[4:7], s33 offen offset:0  lds
    buffer_load_dwordx4 v1, s[4:7], s33 offen offset:1024  lds
    buffer_load_dwordx4 v1, s[4:7], s33 offen offset:2048  lds
    buffer_load_dwordx4 v1, s[4:7], s33 offen offset:3072  lds
    s_add_u32 m0, s42, 4096
    s_add_u32 s33, s32, 4096
    buffer_load_dwordx4 v1, s[4:7], s33 offen offset:0  lds
    buffer_load_dwordx4 v1, s[4:7], s33 offen offset:1024  lds
    buffer_load_dwordx4 v1, s[4:7], s33 offen offset:2048  lds
    buffer_load_dwordx4 v1, s[4:7], s33 offen offset:3072  lds
    s_add_u32 m0, s42, 8192
    s_add_u32 s33, s32, 8192
    buffer_load_dwordx4 v1, s[4:7], s33 offen offset:0  lds
    s_barrier
    s_mov_b32 s32, 3
    s_mul_i32 s32, s32, 36864
    s_add_u32 s32, s32, s43
    s_add_u32 m0, s42, 36864
    s_add_u32 s33, s32, 0
    buffer_load_dwordx4 v1, s[4:7], s33 offen offset:0  lds
    buffer_load_dwordx4 v1, s[4:7], s33 offen offset:1024  lds
    buffer_load_dwordx4 v1, s[4:7], s33 offen offset:2048  lds
    buffer_load_dwordx4 v1, s[4:7], s33 offen offset:3072  lds
    s_add_u32 m0, s42, 40960
    s_add_u32 s33, s32, 4096
    buffer_load_dwordx4 v1, s[4:7], s33 offen offset:0  lds
    buffer_load_dwordx4 v1, s[4:7], s33 offen offset:1024  lds
    buffer_load_dwordx4 v1, s[4:7], s33 offen offset:2048  lds
    buffer_load_dwordx4 v1, s[4:7], s33 offen offset:3072  lds
    s_add_u32 m0, s42, 45056
    s_add_u32 s33, s32, 8192
    buffer_load_dwordx4 v1, s[4:7], s33 offen offset:0  lds
    s_waitcnt vmcnt(27)
    s_barrier
    s_waitcnt vmcnt(18) lgkmcnt(0)
    s_barrier
    s_mov_b32 s32, 4
    s_mul_i32 s32, s32, 36864
    s_add_u32 s32, s32, s43
    s_add_u32 m0, s42, 73728
    s_add_u32 s33, s32, 0
    buffer_load_dwordx4 v1, s[4:7], s33 offen offset:0  lds
    buffer_load_dwordx4 v1, s[4:7], s33 offen offset:1024  lds
    buffer_load_dwordx4 v1, s[4:7], s33 offen offset:2048  lds
    buffer_load_dwordx4 v1, s[4:7], s33 offen offset:3072  lds
    s_add_u32 m0, s42, 77824
    s_add_u32 s33, s32, 4096
    buffer_load_dwordx4 v1, s[4:7], s33 offen offset:0  lds
    buffer_load_dwordx4 v1, s[4:7], s33 offen offset:1024  lds
    buffer_load_dwordx4 v1, s[4:7], s33 offen offset:2048  lds
    buffer_load_dwordx4 v1, s[4:7], s33 offen offset:3072  lds
    s_add_u32 m0, s42, 81920
    s_add_u32 s33, s32, 8192
    buffer_load_dwordx4 v1, s[4:7], s33 offen offset:0  lds
    s_waitcnt vmcnt(18) lgkmcnt(0)
    s_barrier
    s_mov_b32 s32, 5
    s_mul_i32 s32, s32, 36864
    s_add_u32 s32, s32, s43
    s_add_u32 m0, s42, 110592
    s_add_u32 s33, s32, 0
    buffer_load_dwordx4 v1, s[4:7], s33 offen offset:0  lds
    buffer_load_dwordx4 v1, s[4:7], s33 offen offset:1024  lds
    buffer_load_dwordx4 v1, s[4:7], s33 offen offset:2048  lds
    buffer_load_dwordx4 v1, s[4:7], s33 offen offset:3072  lds
    s_add_u32 m0, s42, 114688
    s_add_u32 s33, s32, 4096
    buffer_load_dwordx4 v1, s[4:7], s33 offen offset:0  lds
    buffer_load_dwordx4 v1, s[4:7], s33 offen offset:1024  lds
    buffer_load_dwordx4 v1, s[4:7], s33 offen offset:2048  lds
    buffer_load_dwordx4 v1, s[4:7], s33 offen offset:3072  lds
    s_add_u32 m0, s42, 118784
    s_add_u32 s33, s32, 8192
    buffer_load_dwordx4 v1, s[4:7], s33 offen offset:0  lds
    s_waitcnt vmcnt(18) lgkmcnt(0)
    s_barrier
    s_mov_b32 s32, 6
    s_mul_i32 s32, s32, 36864
    s_add_u32 s32, s32, s43
    s_add_u32 m0, s42, 0
    s_add_u32 s33, s32, 0
    buffer_load_dwordx4 v1, s[4:7], s33 offen offset:0  lds
    buffer_load_dwordx4 v1, s[4:7], s33 offen offset:1024  lds
    buffer_load_dwordx4 v1, s[4:7], s33 offen offset:2048  lds
    buffer_load_dwordx4 v1, s[4:7], s33 offen offset:3072  lds
    s_add_u32 m0, s42, 4096
    s_add_u32 s33, s32, 4096
    buffer_load_dwordx4 v1, s[4:7], s33 offen offset:0  lds
    buffer_load_dwordx4 v1, s[4:7], s33 offen offset:1024  lds
    buffer_load_dwordx4 v1, s[4:7], s33 offen offset:2048  lds
    buffer_load_dwordx4 v1, s[4:7], s33 offen offset:3072  lds
    s_add_u32 m0, s42, 8192
    s_add_u32 s33, s32, 8192
    buffer_load_dwordx4 v1, s[4:7], s33 offen offset:0  lds
    s_waitcnt vmcnt(18) lgkmcnt(0)
    s_barrier
    s_mov_b32 s32, 7
    s_mul_i32 s32, s32, 36864
    s_add_u32 s32, s32, s43
    s_add_u32 m0, s42, 36864
    s_add_u32 s33, s32, 0
    buffer_load_dwordx4 v1, s[4:7], s33 offen offset:0  lds
    buffer_load_dwordx4 v1, s[4:7], s33 offen offset:1024  lds
    buffer_load_dwordx4 v1, s[4:7], s33 offen offset:2048  lds
    buffer_load_dwordx4 v1, s[4:7], s33 offen offset:3072  lds
    s_add_u32 m0, s42, 40960
    s_add_u32 s33, s32, 4096
    buffer_load_dwordx4 v1, s[4:7], s33 offen offset:0  lds
    buffer_load_dwordx4 v1, s[4:7], s33 offen offset:1024  lds
    buffer_load_dwordx4 v1, s[4:7], s33 offen offset:2048  lds
    buffer_load_dwordx4 v1, s[4:7], s33 offen offset:3072  lds
    s_add_u32 m0, s42, 45056
    s_add_u32 s33, s32, 8192
    buffer_load_dwordx4 v1, s[4:7], s33 offen offset:0  lds
    s_waitcnt vmcnt(18) lgkmcnt(0)
    s_barrier
    s_mov_b32 s32, 8
    s_mul_i32 s32, s32, 36864
    s_add_u32 s32, s32, s43
    s_add_u32 m0, s42, 73728
    s_add_u32 s33, s32, 0
    buffer_load_dwordx4 v1, s[4:7], s33 offen offset:0  lds
    buffer_load_dwordx4 v1, s[4:7], s33 offen offset:1024  lds
    buffer_load_dwordx4 v1, s[4:7], s33 offen offset:2048  lds
    buffer_load_dwordx4 v1, s[4:7], s33 offen offset:3072  lds
    s_add_u32 m0, s42, 77824
    s_add_u32 s33, s32, 4096
    buffer_load_dwordx4 v1, s[4:7], s33 offen offset:0  lds
    buffer_load_dwordx4 v1, s[4:7], s33 offen offset:1024  lds
    buffer_load_dwordx4 v1, s[4:7], s33 offen offset:2048  lds
    buffer_load_dwordx4 v1, s[4:7], s33 offen offset:3072  lds
    s_add_u32 m0, s42, 81920
    s_add_u32 s33, s32, 8192
    buffer_load_dwordx4 v1, s[4:7], s33 offen offset:0  lds
    s_waitcnt vmcnt(18) lgkmcnt(0)
    s_barrier
    s_cmp_eq_u32 s22, 1
    s_cbranch_scc1 L_m_lfin
    s_and_b32 s25, s2, 7
    s_lshr_b32 s26, s2, 3
    s_lshr_b32 s23, s25, 1
    s_lshl_b32 s23, s23, 2
    s_lshr_b32 s27, s26, 3
    s_add_u32 s23, s23, s27
    s_and_b32 s24, s25, 1
    s_lshl_b32 s24, s24, 3
    s_and_b32 s27, s26, 7
    s_add_u32 s24, s24, s27
    s_mul_i32 s29, s24, 129024
    s_lshl_b32 s30, s20, 12
    s_add_u32 s29, s29, s30
    s_add_u32 s29, s29, 0x3800000
    s_lshl_b32 s31, s23, 3
    s_max_u32 s31, s31, 1
    s_sub_u32 s31, s31, 1
    s_mul_i32 s31, s31, 18432
    s_add_u32 s31, s31, 0x1c00000
    s_lshl_b32 s35, s20, 10
    s_and_b32 s36, s35, 1024
    s_waitcnt vmcnt(9) lgkmcnt(0)
    s_barrier
    s_add_u32 m0, s30, 0
    s_add_u32 s34, s29, 0
    buffer_load_dwordx4 v1, s[4:7], s34 offen offset:0 lds
    buffer_load_dwordx4 v1, s[4:7], s34 offen offset:1024 lds
    buffer_load_dwordx4 v1, s[4:7], s34 offen offset:2048 lds
    buffer_load_dwordx4 v1, s[4:7], s34 offen offset:3072 lds
    s_add_u32 m0, s30, 16384
    s_add_u32 s34, s29, 16384
    buffer_load_dwordx4 v1, s[4:7], s34 offen offset:0 lds
    buffer_load_dwordx4 v1, s[4:7], s34 offen offset:1024 lds
    buffer_load_dwordx4 v1, s[4:7], s34 offen offset:2048 lds
    buffer_load_dwordx4 v1, s[4:7], s34 offen offset:3072 lds
    s_add_u32 m0, s30, 114688
    s_add_u32 s34, s29, 114688
    buffer_load_dwordx4 v1, s[4:7], s34 offen offset:0 lds
    buffer_load_dwordx4 v1, s[4:7], s34 offen offset:1024 lds
    buffer_load_dwordx4 v1, s[4:7], s34 offen offset:2048 lds
    buffer_load_dwordx4 v1, s[4:7], s34 offen offset:3072 lds
    s_waitcnt vmcnt(12) lgkmcnt(0)
    s_barrier
    s_add_u32 m0, s30, 32768
    s_add_u32 s34, s29, 32768
    buffer_load_dwordx4 v1, s[4:7], s34 offen offset:0 lds
    buffer_load_dwordx4 v1, s[4:7], s34 offen offset:1024 lds
    buffer_load_dwordx4 v1, s[4:7], s34 offen offset:2048 lds
    buffer_load_dwordx4 v1, s[4:7], s34 offen offset:3072 lds
    s_add_u32 m0, s30, 49152
    s_add_u32 s34, s29, 49152
    buffer_load_dwordx4 v1, s[4:7], s34 offen offset:0 lds
    buffer_load_dwordx4 v1, s[4:7], s34 offen offset:1024 lds
    buffer_load_dwordx4 v1, s[4:7], s34 offen offset:2048 lds
    buffer_load_dwordx4 v1, s[4:7], s34 offen offset:3072 lds
    s_mov_b32 s22, 1
    s_mov_b32 s21, 0x1c00000
    s_barrier
    s_barrier
    s_mov_b32 m0, 161792
    s_lshl_b32 s34, s24, 10
    s_add_u32 s34, s34, 0x4400000
    buffer_load_dwordx4 v1, s[4:7], s34 offen lds
    s_add_u32 m0, s30, 65536
    s_add_u32 s34, s29, 65536
    buffer_load_dwordx4 v1, s[4:7], s34 offen offset:0 lds
    buffer_load_dwordx4 v1, s[4:7], s34 offen offset:1024 lds
    buffer_load_dwordx4 v1, s[4:7], s34 offen offset:2048 lds
    buffer_load_dwordx4 v1, s[4:7], s34 offen offset:3072 lds
    s_add_u32 m0, s30, 81920
    s_add_u32 s34, s29, 81920
    buffer_load_dwordx4 v1, s[4:7], s34 offen offset:0 lds
    buffer_load_dwordx4 v1, s[4:7], s34 offen offset:1024 lds
    buffer_load_dwordx4 v1, s[4:7], s34 offen offset:2048 lds
    buffer_load_dwordx4 v1, s[4:7], s34 offen offset:3072 lds
    s_add_u32 m0, s30, 98304
    s_add_u32 s34, s29, 98304
    buffer_load_dwordx4 v1, s[4:7], s34 offen offset:0 lds
    buffer_load_dwordx4 v1, s[4:7], s34 offen offset:1024 lds
    buffer_load_dwordx4 v1, s[4:7], s34 offen offset:2048 lds
    buffer_load_dwordx4 v1, s[4:7], s34 offen offset:3072 lds
    s_barrier
    s_add_u32 m0, s35, 131072
    s_add_u32 s34, s31, s35
    s_add_u32 s34, s34, 0
    buffer_load_dwordx4 v1, s[4:7], s34 offen sc1 lds
    s_waitcnt vmcnt(0)
    s_barrier
    s_add_u32 m0, s35, 135168
    s_add_u32 s34, s31, s35
    s_add_u32 s34, s34, 4096
    buffer_load_dwordx4 v1, s[4:7], s34 offen sc1 lds
    s_add_u32 m0, s35, 139264
    s_add_u32 s34, s31, s35
    s_add_u32 s34, s34, 8192
    buffer_load_dwordx4 v1, s[4:7], s34 offen sc1 lds
    s_waitcnt vmcnt(2)
    s_barrier
    s_waitcnt vmcnt(1)
    s_barrier
    s_add_u32 m0, s35, 143360
    s_add_u32 s34, s31, s35
    s_add_u32 s34, s34, 12288
    buffer_load_dwordx4 v1, s[4:7], s34 offen sc1 lds
    s_waitcnt vmcnt(1)
    s_barrier
    s_waitcnt vmcnt(1)
    s_barrier
    s_add_u32 m0, s36, 147456
    s_add_u32 s34, s31, s36
    s_add_u32 s34, s34, 16384
    buffer_load_dwordx4 v1, s[4:7], s34 offen sc1 lds
    s_waitcnt vmcnt(1)
    s_barrier
    s_waitcnt vmcnt(1)
    s_barrier
    s_waitcnt vmcnt(0)
    s_barrier
    s_barrier
    s_branch L_m_ll
L_m_lfin:
    s_waitcnt vmcnt(0) lgkmcnt(0)
    s_barrier
    s_barrier
L_end_m:
    s_endpgm

.section .rodata,"a"
.p2align 6
.amdhsa_kernel interleave_layers__sliding_local_dilated__mixer_gmlp__prompt_kernel
  .amdhsa_next_free_vgpr 256
  .amdhsa_next_free_sgpr 102
  .amdhsa_accum_offset 256
  .amdhsa_group_segment_fixed_size 0
  .amdhsa_kernarg_size 88
  .amdhsa_user_sgpr_count 2
  .amdhsa_user_sgpr_kernarg_segment_ptr 1
  .amdhsa_system_sgpr_workgroup_id_x 1
  .amdhsa_float_denorm_mode_32 3
.end_amdhsa_kernel
```

```asm
; @launch grid=(256,1,1) block=(512,1,1) lds=163840
.amdgcn_target "amdgcn-amd-amdhsa--gfx950"
.text
.globl interleave_layers__sliding_local_dilated__mixer_gmlp__prompt_kernel
.p2align 8
.type interleave_layers__sliding_local_dilated__mixer_gmlp__prompt_kernel,@function
interleave_layers__sliding_local_dilated__mixer_gmlp__prompt_kernel:
    s_cmp_ge_u32 s2, 256
    s_cbranch_scc1 L_end_m
    s_load_dwordx16 s[36:51], s[0:1], 0
    s_load_dwordx4 s[56:59], s[0:1], 64
    s_load_dwordx2 s[24:25], s[0:1], 80
    s_getpc_b64 s[26:27]
L_m_pc:
    s_sub_u32 s26, s26, L_m_pc-interleave_layers__sliding_local_dilated__mixer_gmlp__prompt_kernel
    s_subb_u32 s27, s27, 0
    v_lshlrev_b32 v4, 4, v0
    v_mov_b32 v5, s27
    v_add_co_u32 v6, vcc, s26, v4
    s_lshr_b32 s28, s2, 3
    s_lshl_b32 s28, s28, 11
    v_addc_co_u32 v7, vcc, 0, v5, vcc
    global_load_dwordx4 v[60:63], v[6:7], off
    v_lshl_add_u32 v4, v0, 2, s28
    v_min_u32 v4, L_end_m-interleave_layers__sliding_local_dilated__mixer_gmlp__prompt_kernel-4, v4
    v_add_co_u32 v6, vcc, s26, v4
    s_nop 1
    v_addc_co_u32 v7, vcc, 0, v5, vcc
    global_load_dword v64, v[6:7], off
    v_lshrrev_b32 v2, 6, v0
    v_and_b32 v1, 63, v0
    v_lshlrev_b32 v1, 4, v1
    v_readfirstlane_b32 s23, v2
    s_mov_b32 s22, 0
    s_mov_b32 s21, 0
    s_and_b32 s20, s23, 3
    s_waitcnt lgkmcnt(0)
    s_mov_b32 s4, s24
    s_mov_b32 s5, s25
    s_mov_b32 s6, 0x10000000
    s_mov_b32 s7, 0x20000
    s_mov_b32 s8, s46
    s_mov_b32 s9, s47
    s_mov_b32 s10, 0x800000
    s_mov_b32 s11, 0x20000
    s_mov_b32 s12, s48
    s_mov_b32 s13, s49
    s_mov_b32 s14, 0x1000
    s_mov_b32 s15, 0x20000
    s_mov_b32 s16, s56
    s_mov_b32 s17, s57
    s_mov_b32 s18, 0x240000
    s_mov_b32 s19, 0x20000
    s_cmp_ge_u32 s23, 4
    s_cbranch_scc1 L_ld_m
    v_bfe_u32 v2, v1, 4, 4
    v_lshrrev_b32 v3, 8, v1
    v_bfrev_b32 v6, 1
    v_mov_b32 v11, 0x3f803f80
    s_lshl_b32 s30, s20, 12
    s_and_b32 s29, s20, 1
    s_cmp_lt_u32 s2, 128
    s_cbranch_scc1 L_p0_x
    s_cmp_lt_u32 s2, 236
    s_cbranch_scc1 L_p0_wq
    s_cmp_lt_u32 s2, 254
    s_cbranch_scc1 L_p0_wo
    s_mov_b32 s46, 0
    s_mov_b32 s27, 0x800000
    s_barrier
    s_barrier
    s_branch L_p0_cd
L_p0_wo:
    s_mul_i32 s30, s20, 9216
    s_sub_u32 s26, s2, 236
    s_mul_i32 s28, s26, 57
    s_lshr_b32 s28, s28, 9
    s_mul_i32 s27, s28, 9
    s_sub_u32 s27, s26, s27
    s_mov_b32 s32, s40
    s_mov_b32 s33, s41
    s_mov_b32 s34, 0xa2000
    s_mov_b32 s35, 0x20000
    s_mul_i32 s29, s28, 331776
    s_lshl_b32 s31, s27, 7
    s_add_u32 s29, s29, s31
    s_mul_i32 s31, s20, 82944
    s_add_u32 s29, s29, s31
    v_lshrrev_b32 v4, 7, v1
    v_mul_u32_u24 v4, 1152, v4
    v_and_b32 v5, 0x70, v1
    v_add_u32 v4, v4, v5
    s_add_u32 m0, s30, 0
    s_add_u32 s31, s29, 0
    buffer_load_dwordx4 v4, s[32:35], s31 offen  lds
    s_add_u32 m0, s30, 1024
    s_add_u32 s31, s29, 9216
    buffer_load_dwordx4 v4, s[32:35], s31 offen  lds
    s_add_u32 m0, s30, 2048
    s_add_u32 s31, s29, 18432
    buffer_load_dwordx4 v4, s[32:35], s31 offen  lds
    s_add_u32 m0, s30, 3072
    s_add_u32 s31, s29, 27648
    buffer_load_dwordx4 v4, s[32:35], s31 offen  lds
    s_add_u32 m0, s30, 4096
    s_add_u32 s31, s29, 36864
    buffer_load_dwordx4 v4, s[32:35], s31 offen  lds
    s_add_u32 m0, s30, 5120
    s_add_u32 s31, s29, 46080
    buffer_load_dwordx4 v4, s[32:35], s31 offen  lds
    s_add_u32 m0, s30, 6144
    s_add_u32 s31, s29, 55296
    buffer_load_dwordx4 v4, s[32:35], s31 offen  lds
    s_add_u32 m0, s30, 7168
    s_add_u32 s31, s29, 64512
    buffer_load_dwordx4 v4, s[32:35], s31 offen  lds
    s_add_u32 m0, s30, 8192
    s_add_u32 s31, s29, 73728
    buffer_load_dwordx4 v4, s[32:35], s31 offen  lds
    s_barrier
    v_lshrrev_b32 v7, 2, v2
    v_and_b32 v8, 3, v2
    s_lshl_b32 s31, s20, 5
    s_add_u32 s31, s31, 0
    v_lshlrev_b32 v9, 7, v7
    v_lshl_add_u32 v9, v8, 3, v9
    v_add_u32 v9, s31, v9
    v_mul_u32_u24 v4, 512, v3
    v_add_u32 v4, v4, v9
    v_mul_u32_u24 v5, 9216, v3
    v_add_u32 v5, v5, v9
    s_lshl_b32 s31, s27, 2
    s_add_u32 s31, s31, s20
    v_lshl_add_u32 v7, s31, 2, v7
    v_lshlrev_b32 v8, 4, v8
    v_lshl_add_u32 v8, v3, 8, v8
    v_mul_u32_u24 v9, 57, v7
    v_lshrrev_b32 v9, 10, v9
    v_mul_u32_u24 v10, 18, v9
    v_sub_u32 v10, v7, v10
    v_lshrrev_b32 v12, 3, v10
    v_and_b32 v13, 1, v10
    v_lshl_add_u32 v12, v12, 1, v13
    v_bfe_u32 v14, v10, 1, 2
    v_cmp_gt_u32 vcc, 16, v10
    v_mul_u32_u24 v9, 82944, v9
    v_add_u32 v9, v9, v8
    v_cndmask_b32 v12, 8, v12, vcc
    v_cndmask_b32 v14, v13, v14, vcc
    v_mov_b32 v15, 0x1000
    v_mov_b32 v13, 0x80
    v_cndmask_b32 v15, v13, v15, vcc
    v_lshl_add_u32 v9, v12, 10, v9
    v_lshl_add_u32 v9, v14, 6, v9
    v_add_u32 v10, v9, v15
    s_and_b32 s31, s28, 1
    s_cmp_eq_u32 s31, 1
    s_cselect_b64 vcc, -1, 0
    v_cndmask_b32 v14, v9, v10, vcc
    s_mul_i32 s31, s28, 36864
    s_add_u32 s37, s31, 0x3a00000
    s_add_u32 s38, s31, 0x3a00000
    s_add_u32 s39, s31, 0x3a02400
    s_add_u32 s40, s31, 0x3a02400
    s_add_u32 s41, s31, 0x3a04800
    s_add_u32 s42, s31, 0x3a04800
    s_add_u32 s43, s31, 0x3a06c00
    s_add_u32 s47, s31, 0x3a06c00
    s_lshr_b32 s31, s28, 1
    s_mul_i32 s31, s31, 9216
    s_add_u32 s48, s31, 0x3a12000
    s_cmp_ge_u32 s26, 4
    s_cbranch_scc1 L_p0_n2
    s_lshl_b32 s31, s26, 2
    s_add_u32 s31, s31, s20
    s_lshl_b32 s31, s31, 12
    s_add_u32 s31, s31, 0x4508000
    v_and_b32 v56, 0x380, v1
    v_add_u32 v56, v56, v1
    v_mov_b32 v52, 0
    v_mov_b32 v53, 0
    v_mov_b32 v54, 0
    v_mov_b32 v55, 0
    buffer_store_dwordx4 v[52:55], v56, s[4:7], s31 offen offset:0 sc1
    buffer_store_dwordx4 v[52:55], v56, s[4:7], s31 offen offset:2048 sc1
L_p0_n2:
    s_waitcnt vmcnt(0)
    s_barrier
    ds_read_b64_tr_b16 v[16:17], v4 offset:0
    ds_read_b64_tr_b16 v[18:19], v4 offset:2560
    ds_read_b64_tr_b16 v[20:21], v4 offset:4608
    ds_read_b64_tr_b16 v[22:23], v4 offset:7168
    ds_read_b64_tr_b16 v[24:25], v4 offset:9216
    ds_read_b64_tr_b16 v[26:27], v4 offset:11776
    ds_read_b64_tr_b16 v[28:29], v4 offset:13824
    ds_read_b64_tr_b16 v[30:31], v4 offset:16384
    ds_read_b64_tr_b16 v[32:33], v4 offset:18432
    ds_read_b64_tr_b16 v[34:35], v4 offset:20992
    ds_read_b64_tr_b16 v[36:37], v4 offset:23040
    ds_read_b64_tr_b16 v[38:39], v4 offset:25600
    ds_read_b64_tr_b16 v[40:41], v4 offset:27648
    ds_read_b64_tr_b16 v[42:43], v4 offset:30208
    ds_read_b64_tr_b16 v[44:45], v4 offset:32256
    ds_read_b64_tr_b16 v[46:47], v4 offset:34816
    ds_read_b64_tr_b16 v[48:49], v5 offset:2048
    ds_read_b64_tr_b16 v[50:51], v5 offset:6656
    s_waitcnt lgkmcnt(15)
    s_mov_b32 s31, s37
    buffer_store_dwordx4 v[16:19], v9, s[4:7], s31 offen sc1
    s_waitcnt lgkmcnt(14)
    s_mov_b32 s31, s38
    buffer_store_dwordx4 v[20:23], v10, s[4:7], s31 offen sc1
    s_waitcnt lgkmcnt(12)
    s_mov_b32 s31, s39
    buffer_store_dwordx4 v[24:27], v9, s[4:7], s31 offen sc1
    s_waitcnt lgkmcnt(10)
    s_mov_b32 s31, s40
    buffer_store_dwordx4 v[28:31], v10, s[4:7], s31 offen sc1
    s_waitcnt lgkmcnt(8)
    s_mov_b32 s31, s41
    buffer_store_dwordx4 v[32:35], v9, s[4:7], s31 offen sc1
    s_waitcnt lgkmcnt(6)
    s_mov_b32 s31, s42
    buffer_store_dwordx4 v[36:39], v10, s[4:7], s31 offen sc1
    s_waitcnt lgkmcnt(4)
    s_mov_b32 s31, s43
    buffer_store_dwordx4 v[40:43], v9, s[4:7], s31 offen sc1
    s_waitcnt lgkmcnt(2)
    s_mov_b32 s31, s47
    buffer_store_dwordx4 v[44:47], v10, s[4:7], s31 offen sc1
    s_waitcnt lgkmcnt(0)
    s_mov_b32 s31, s48
    buffer_store_dwordx4 v[48:51], v14, s[4:7], s31 offen sc1
    s_mov_b32 s46, 1
    s_mov_b32 s27, 32
    s_branch L_p0_cd
L_p0_wq:
    s_mov_b32 s32, s38
    s_mov_b32 s33, s39
    s_mov_b32 s34, 0x1e6000
    s_mov_b32 s35, 0x20000
    s_sub_u32 s23, s2, 128
    s_mul_i32 s25, s23, 19
    s_lshr_b32 s25, s25, 9
    s_mul_i32 s24, s25, 27
    s_sub_u32 s24, s23, s24
    s_mul_i32 s26, s25, 497664
    s_lshl_b32 s31, s24, 7
    s_add_u32 s26, s26, s31
    v_lshrrev_b32 v4, 7, v1
    v_mul_u32_u24 v4, 3456, v4
    v_and_b32 v5, 0x70, v1
    v_add_u32 v4, v4, v5
    s_mul_i32 s31, s20, 110592
    s_add_u32 s27, s26, s31
    s_add_u32 m0, s30, 0
    s_add_u32 s31, s27, 0
    buffer_load_dwordx4 v4, s[32:35], s31 offen  lds
    s_add_u32 m0, s30, 1024
    s_add_u32 s31, s27, 27648
    buffer_load_dwordx4 v4, s[32:35], s31 offen  lds
    s_add_u32 m0, s30, 2048
    s_add_u32 s31, s27, 55296
    buffer_load_dwordx4 v4, s[32:35], s31 offen  lds
    s_add_u32 m0, s30, 3072
    s_add_u32 s31, s27, 82944
    buffer_load_dwordx4 v4, s[32:35], s31 offen  lds
    s_cmp_ge_u32 s20, 2
    s_cbranch_scc1 L_p0_q5
    s_lshl_b32 s31, s29, 10
    s_add_u32 m0, s31, 16384
    s_mul_i32 s31, s29, 27648
    s_add_u32 s31, s31, s26
    s_add_u32 s31, s31, 442368
    buffer_load_dwordx4 v4, s[32:35], s31 offen  lds
L_p0_q5:
    s_barrier
    v_lshrrev_b32 v7, 2, v2
    v_and_b32 v8, 3, v2
    s_lshl_b32 s31, s20, 5
    v_lshlrev_b32 v9, 7, v7
    v_lshl_add_u32 v9, v3, 3, v9
    v_add_u32 v9, s31, v9
    v_lshl_add_u32 v4, v8, 10, v9
    v_and_b32 v5, 1, v2
    v_mul_u32_u24 v5, 9216, v5
    v_add_u32 v5, v5, v9
    s_lshl_b32 s31, s24, 2
    s_add_u32 s31, s31, s20
    v_lshl_add_u32 v7, s31, 2, v3
    v_lshlrev_b32 v8, 4, v2
    v_mul_u32_u24 v9, 57, v7
    v_lshrrev_b32 v9, 13, v9
    v_mul_u32_u24 v10, 144, v9
    v_sub_u32 v10, v7, v10
    v_mul_u32_u24 v12, 57, v10
    v_lshrrev_b32 v12, 9, v12
    v_mul_u32_u24 v13, 9, v12
    v_sub_u32 v13, v10, v13
    v_cmp_lt_u32 s[36:37], 4, v13
    v_cmp_eq_u32 s[38:39], 4, v13
    v_cmp_eq_u32 s[40:41], 2, v9
    v_lshlrev_b32 v14, 1, v9
    v_add_u32 v15, 1, v14
    v_subrev_u32 v10, 5, v13
    v_cndmask_b32 v14, v14, v15, s[36:37]
    v_cndmask_b32 v13, v13, v10, s[36:37]
    v_cndmask_b32 v14, v14, 6, s[38:39]
    v_cndmask_b32 v13, v13, v9, s[38:39]
    s_and_b64 s[40:41], s[40:41], s[38:39]
    s_mov_b32 s31, 129024
    v_mul_lo_u32 v9, v12, s31
    v_add_u32 v9, v9, v8
    v_lshl_add_u32 v9, v14, 10, v9
    v_lshl_add_u32 v9, v13, 8, v9
    s_and_b32 s31, s25, 1
    v_lshrrev_b32 v8, 3, v2
    v_cmp_eq_u32 vcc, s31, v8
    v_add_u32 v15, 256, v9
    v_cndmask_b32 v15, v6, v15, s[40:41]
    v_cndmask_b32 v8, v6, v9, vcc
    v_lshlrev_b32 v10, 2, v2
    v_lshl_add_u32 v10, v7, 4, v10
    v_cmp_gt_u32 vcc, 4, v2
    s_lshl_b32 s45, s25, 13
    s_add_u32 s45, s45, 0x4400000
    v_cndmask_b32 v10, v6, v10, vcc
    s_mul_i32 s42, s25, 28672
    s_add_u32 s42, s42, 0x3800000
    s_lshr_b32 s44, s25, 1
    s_mul_i32 s44, s44, 7168
    s_add_u32 s44, s44, 0x381c000
    s_mul_i32 s26, s24, 29
    s_lshr_b32 s26, s26, 8
    s_mul_i32 s27, s26, 9
    s_sub_u32 s27, s24, s27
    s_lshl_b32 s27, s27, 4
    s_add_u32 s28, s27, 16
    v_lshrrev_b32 v254, 4, v1
    v_mul_u32_u24 v7, 9, v254
    v_add_u32 v255, 9, v7
    v_min_u32 v255, s28, v255
    v_max_u32 v7, s27, v7
    v_sub_u32 v255, v255, v7
    v_cmp_lt_i32 vcc, 0, v255
    v_lshlrev_b32 v254, 8, v254
    v_mov_b32 v14, 0x3f003f00
    v_cndmask_b32 v254, v6, v254, vcc
    s_cmp_eq_u64 s[40:41], 0
    s_cbranch_scc1 L_p0_np
    v_mov_b32 v52, 0
    v_mov_b32 v53, 0
    v_mov_b32 v54, 0
    v_mov_b32 v55, 0
    s_add_u32 s31, s42, 0
    buffer_store_dwordx4 v[52:55], v15, s[4:7], s31 offen sc1
    s_add_u32 s31, s42, 7168
    buffer_store_dwordx4 v[52:55], v15, s[4:7], s31 offen sc1
    s_add_u32 s31, s42, 14336
    buffer_store_dwordx4 v[52:55], v15, s[4:7], s31 offen sc1
    s_add_u32 s31, s42, 21504
    buffer_store_dwordx4 v[52:55], v15, s[4:7], s31 offen sc1
    s_mov_b32 s31, s44
    buffer_store_dwordx4 v[52:55], v15, s[4:7], s31 offen sc1
    s_waitcnt vmcnt(5)
    s_branch L_p0_n3
L_p0_np:
    s_waitcnt vmcnt(0)
L_p0_n3:
    s_barrier
    ds_read_b64_tr_b16 v[16:17], v4 offset:0
    ds_read_b64_tr_b16 v[18:19], v4 offset:512
    ds_read_b64_tr_b16 v[20:21], v4 offset:4096
    ds_read_b64_tr_b16 v[22:23], v4 offset:4608
    ds_read_b64_tr_b16 v[24:25], v4 offset:9216
    ds_read_b64_tr_b16 v[26:27], v4 offset:9728
    ds_read_b64_tr_b16 v[28:29], v4 offset:13312
    ds_read_b64_tr_b16 v[30:31], v4 offset:13824
    ds_read_b64_tr_b16 v[32:33], v5 offset:8192
    ds_read_b64_tr_b16 v[34:35], v5 offset:8704
    s_waitcnt lgkmcnt(8)
    s_add_u32 s31, s42, 0
    buffer_store_dwordx4 v[16:19], v9, s[4:7], s31 offen sc1
    s_waitcnt lgkmcnt(6)
    s_add_u32 s31, s42, 7168
    buffer_store_dwordx4 v[20:23], v9, s[4:7], s31 offen sc1
    s_waitcnt lgkmcnt(4)
    s_add_u32 s31, s42, 14336
    buffer_store_dwordx4 v[24:27], v9, s[4:7], s31 offen sc1
    s_waitcnt lgkmcnt(2)
    s_add_u32 s31, s42, 21504
    buffer_store_dwordx4 v[28:31], v9, s[4:7], s31 offen sc1
    s_waitcnt lgkmcnt(0)
    s_mov_b32 s31, s44
    buffer_store_dwordx4 v[32:35], v8, s[4:7], s31 offen sc1
    v_dot2_f32_bf16 v12, v16, v11, 0
    v_dot2_f32_bf16 v13, v17, v11, 0
    v_dot2_f32_bf16 v12, v18, v11, v12
    v_dot2_f32_bf16 v13, v19, v11, v13
    v_dot2_f32_bf16 v12, v20, v11, v12
    v_dot2_f32_bf16 v13, v21, v11, v13
    v_dot2_f32_bf16 v12, v22, v11, v12
    v_dot2_f32_bf16 v13, v23, v11, v13
    v_dot2_f32_bf16 v12, v24, v11, v12
    v_dot2_f32_bf16 v13, v25, v11, v13
    v_dot2_f32_bf16 v12, v26, v11, v12
    v_dot2_f32_bf16 v13, v27, v11, v13
    v_dot2_f32_bf16 v12, v28, v11, v12
    v_dot2_f32_bf16 v13, v29, v11, v13
    v_dot2_f32_bf16 v12, v30, v11, v12
    v_dot2_f32_bf16 v13, v31, v11, v13
    v_dot2_f32_bf16 v12, v32, v14, v12
    v_dot2_f32_bf16 v13, v33, v14, v13
    v_dot2_f32_bf16 v12, v34, v14, v12
    v_dot2_f32_bf16 v13, v35, v14, v13
    s_nop 2
    v_add_f32 v12, v12, v13
    s_nop 1
    v_add_f32_dpp v12, v12, v12 row_ror:4 row_mask:0xf bank_mask:0xf
    s_nop 1
    v_add_f32_dpp v12, v12, v12 row_ror:8 row_mask:0xf bank_mask:0xf
    buffer_store_dword v12, v10, s[4:7], s45 offen sc1
    s_branch L_p0_ce
L_p0_x:
    s_mov_b32 s32, s36
    s_mov_b32 s33, s37
    s_mov_b32 s34, 0x240000
    s_mov_b32 s35, 0x20000
    s_mul_i32 s26, s2, 18432
    s_mov_b32 m0, s30
    s_add_u32 s31, s26, s30
    buffer_load_dwordx4 v1, s[32:35], s31 offen offset:0  lds
    buffer_load_dwordx4 v1, s[32:35], s31 offen offset:1024  lds
    buffer_load_dwordx4 v1, s[32:35], s31 offen offset:2048  lds
    buffer_load_dwordx4 v1, s[32:35], s31 offen offset:3072  lds
    s_lshl_b32 s27, s29, 10
    s_add_u32 s27, s27, 16384
    s_mov_b32 m0, s27
    s_add_u32 s31, s26, s27
    buffer_load_dwordx4 v1, s[32:35], s31 offen  lds
    s_barrier
    s_mul_i32 s31, s20, 288
    v_mul_u32_u24 v7, 1152, v2
    v_lshl_add_u32 v4, v3, 4, v7
    v_add_u32 v4, s31, v4
    s_mul_i32 s31, s29, 576
    v_mul_u32_u24 v5, 144, v3
    v_add3_u32 v5, v5, v7, s31
    s_add_u32 s26, s26, 0x0
    s_add_u32 s42, s26, s30
    s_add_u32 s44, s26, s27
    s_lshl_b32 s45, s2, 10
    s_lshl_b32 s31, s20, 8
    s_add_u32 s45, s45, s31
    s_add_u32 s45, s45, 0x1b00000
    v_cmp_gt_u32 vcc, 2, v3
    v_lshrrev_b32 v10, 1, v1
    s_mov_b32 s46, 2
    v_cndmask_b32 v10, v6, v10, vcc
    s_lshr_b32 s27, s2, 3
    s_add_u32 s27, s27, 48
    s_waitcnt vmcnt(0)
    s_barrier
    ds_read_b128 v[16:19], v4 offset:0
    ds_read_b128 v[20:23], v4 offset:64
    ds_read_b128 v[24:27], v4 offset:144
    ds_read_b128 v[28:31], v4 offset:208
    ds_read_b128 v[32:35], v5 offset:128
    s_waitcnt lgkmcnt(4)
    buffer_store_dwordx4 v[16:19], v1, s[4:7], s42 offen offset:0 sc1
    s_waitcnt lgkmcnt(3)
    buffer_store_dwordx4 v[20:23], v1, s[4:7], s42 offen offset:1024 sc1
    s_waitcnt lgkmcnt(2)
    buffer_store_dwordx4 v[24:27], v1, s[4:7], s42 offen offset:2048 sc1
    s_waitcnt lgkmcnt(1)
    buffer_store_dwordx4 v[28:31], v1, s[4:7], s42 offen offset:3072 sc1
    v_dot2_f32_bf16 v12, v16, v11, 0
    v_dot2_f32_bf16 v13, v16, v16, 0
    v_dot2_f32_bf16 v12, v17, v11, v12
    v_dot2_f32_bf16 v13, v17, v17, v13
    v_dot2_f32_bf16 v12, v18, v11, v12
    v_dot2_f32_bf16 v13, v18, v18, v13
    v_dot2_f32_bf16 v12, v19, v11, v12
    v_dot2_f32_bf16 v13, v19, v19, v13
    v_dot2_f32_bf16 v12, v20, v11, v12
    v_dot2_f32_bf16 v13, v20, v20, v13
    v_dot2_f32_bf16 v12, v21, v11, v12
    v_dot2_f32_bf16 v13, v21, v21, v13
    v_dot2_f32_bf16 v12, v22, v11, v12
    v_dot2_f32_bf16 v13, v22, v22, v13
    v_dot2_f32_bf16 v12, v23, v11, v12
    v_dot2_f32_bf16 v13, v23, v23, v13
    v_dot2_f32_bf16 v12, v24, v11, v12
    v_dot2_f32_bf16 v13, v24, v24, v13
    v_dot2_f32_bf16 v12, v25, v11, v12
    v_dot2_f32_bf16 v13, v25, v25, v13
    v_dot2_f32_bf16 v12, v26, v11, v12
    v_dot2_f32_bf16 v13, v26, v26, v13
    v_dot2_f32_bf16 v12, v27, v11, v12
    v_dot2_f32_bf16 v13, v27, v27, v13
    v_dot2_f32_bf16 v12, v28, v11, v12
    v_dot2_f32_bf16 v13, v28, v28, v13
    v_dot2_f32_bf16 v12, v29, v11, v12
    v_dot2_f32_bf16 v13, v29, v29, v13
    v_dot2_f32_bf16 v12, v30, v11, v12
    v_dot2_f32_bf16 v13, v30, v30, v13
    v_dot2_f32_bf16 v12, v31, v11, v12
    v_dot2_f32_bf16 v13, v31, v31, v13
    s_waitcnt lgkmcnt(0)
    s_cmp_ge_u32 s20, 2
    s_cbranch_scc1 L_p0_xs
    buffer_store_dwordx4 v[32:35], v1, s[4:7], s44 offen sc1
    v_dot2_f32_bf16 v12, v32, v11, v12
    v_dot2_f32_bf16 v13, v32, v32, v13
    v_dot2_f32_bf16 v12, v33, v11, v12
    v_dot2_f32_bf16 v13, v33, v33, v13
    v_dot2_f32_bf16 v12, v34, v11, v12
    v_dot2_f32_bf16 v13, v34, v34, v13
    v_dot2_f32_bf16 v12, v35, v11, v12
    v_dot2_f32_bf16 v13, v35, v35, v13
L_p0_xs:
    s_nop 2
    v_mov_b32 v14, v12
    v_mov_b32 v15, v13
    s_nop 1
    v_permlane32_swap_b32 v12, v14
    v_permlane32_swap_b32 v13, v15
    v_add_f32 v12, v12, v14
    v_add_f32 v13, v13, v15
    buffer_store_dwordx2 v[12:13], v10, s[4:7], s45 offen sc1
L_p0_cd:
    v_cmp_eq_u32 vcc, 0, v1
    s_lshl_b32 s27, s27, 8
    v_mov_b32 v255, s46
    v_mov_b32 v254, s27
    v_cndmask_b32 v254, v6, v254, vcc
L_p0_ce:
    s_mov_b32 s48, s58
    s_mov_b32 s49, s59
    s_mov_b32 s50, 0x100
    s_mov_b32 s51, 0x20000
    v_mov_b32 v4, 0
    buffer_load_dword v246, v4, s[48:51], 0 offen sc1
    s_barrier
    s_branch L_m_cl
L_d1_first:
    v_cmp_gt_u32 vcc, 4, v246
    v_mov_b32 v4, 0
    s_mov_b32 s46, 0x4500000
    s_cbranch_vccz L_pd_dbg
    s_mov_b32 s60, 65536
L_poll_dbg:
    buffer_load_dword v5, v4, s[48:51], 0 offen sc1
    s_waitcnt vmcnt(0)
    v_cmp_gt_u32 vcc, 4, v5
    s_sub_u32 s60, s60, 1
    s_cbranch_scc1 L_pd_dbg
    s_cbranch_vccz L_pd_dbg
    s_sleep 4
    s_branch L_poll_dbg
L_pd_dbg:
    buffer_atomic_add v255, v254, s[4:7], s46 offen sc1
    s_branch L_ns_d1
L_ld_m:
    s_cmp_lg_u32 s2, 0
    s_cbranch_scc1 L_p0_nz
    s_lshl_b32 s31, s20, 12
    s_add_u32 s31, s31, 0x4500000
    v_and_b32 v56, 0x380, v1
    v_add_u32 v56, v56, v1
    v_mov_b32 v52, 0
    v_mov_b32 v53, 0
    v_mov_b32 v54, 0
    v_mov_b32 v55, 0
    buffer_store_dwordx4 v[52:55], v56, s[4:7], s31 offen offset:0 sc1
    buffer_store_dwordx4 v[52:55], v56, s[4:7], s31 offen offset:2048 sc1
    s_waitcnt vmcnt(0)
    s_mov_b32 s53, 1
    s_atomic_add s53, s[58:59], 0
L_p0_nz:
    v_bfe_u32 v2, v1, 4, 4
    v_lshrrev_b32 v3, 8, v1
    v_bfrev_b32 v6, 1
    v_mov_b32 v11, 0x3f803f80
    s_mul_i32 s30, s20, 9216
    s_cmp_lt_u32 s2, 144
    s_cbranch_scc1 L_p0_wi
    s_cmp_lt_u32 s2, 216
    s_cbranch_scc1 L_p0_wu
    v_mov_b32 v9, v6
    v_mov_b32 v10, v6
    v_mov_b32 v14, v6
    v_mov_b32 v15, v6
    s_mov_b32 s37, 0
    s_mov_b32 s38, 0
    s_mov_b32 s39, 0
    s_mov_b32 s40, 0
    s_mov_b32 s41, 0
    s_mov_b32 s42, 0
    s_mov_b32 s43, 0
    s_mov_b32 s47, 0
    s_mov_b32 s48, 0
    s_mov_b32 s49, 0
    s_barrier
    s_barrier
    s_barrier
    s_barrier
    s_barrier
    s_branch L_p0_ld
L_p0_wu:
    s_sub_u32 s26, s2, 144
    s_mul_i32 s28, s26, 57
    s_lshr_b32 s28, s28, 9
    s_mul_i32 s27, s28, 9
    s_sub_u32 s27, s26, s27
    s_mov_b32 s32, s50
    s_mov_b32 s33, s51
    s_mov_b32 s34, 0x288000
    s_mov_b32 s35, 0x20000
    s_mul_i32 s29, s28, 331776
    s_lshl_b32 s31, s27, 7
    s_add_u32 s29, s29, s31
    s_mul_i32 s31, s20, 82944
    s_add_u32 s29, s29, s31
    v_lshrrev_b32 v4, 7, v1
    v_mul_u32_u24 v4, 1152, v4
    v_and_b32 v5, 0x70, v1
    v_add_u32 v4, v4, v5
    s_barrier
    s_barrier
    s_barrier
    s_barrier
    s_barrier
    s_add_u32 m0, s30, 94208
    s_add_u32 s31, s29, 0
    buffer_load_dwordx4 v4, s[32:35], s31 offen  lds
    s_add_u32 m0, s30, 95232
    s_add_u32 s31, s29, 9216
    buffer_load_dwordx4 v4, s[32:35], s31 offen  lds
    s_add_u32 m0, s30, 96256
    s_add_u32 s31, s29, 18432
    buffer_load_dwordx4 v4, s[32:35], s31 offen  lds
    s_add_u32 m0, s30, 97280
    s_add_u32 s31, s29, 27648
    buffer_load_dwordx4 v4, s[32:35], s31 offen  lds
    s_add_u32 m0, s30, 98304
    s_add_u32 s31, s29, 36864
    buffer_load_dwordx4 v4, s[32:35], s31 offen  lds
    s_add_u32 m0, s30, 99328
    s_add_u32 s31, s29, 46080
    buffer_load_dwordx4 v4, s[32:35], s31 offen  lds
    s_add_u32 m0, s30, 100352
    s_add_u32 s31, s29, 55296
    buffer_load_dwordx4 v4, s[32:35], s31 offen  lds
    s_add_u32 m0, s30, 101376
    s_add_u32 s31, s29, 64512
    buffer_load_dwordx4 v4, s[32:35], s31 offen  lds
    s_add_u32 m0, s30, 102400
    s_add_u32 s31, s29, 73728
    buffer_load_dwordx4 v4, s[32:35], s31 offen  lds
    v_lshrrev_b32 v7, 2, v2
    v_and_b32 v8, 3, v2
    s_lshl_b32 s31, s20, 5
    s_add_u32 s31, s31, 94208
    v_lshlrev_b32 v9, 7, v7
    v_lshl_add_u32 v9, v8, 3, v9
    v_add_u32 v9, s31, v9
    v_mul_u32_u24 v4, 512, v3
    v_add_u32 v4, v4, v9
    v_mul_u32_u24 v5, 512, v3
    v_add_u32 v5, v5, v9
    s_lshl_b32 s31, s27, 2
    s_add_u32 s31, s31, s20
    v_lshl_add_u32 v7, s31, 2, v7
    v_lshlrev_b32 v8, 4, v8
    v_lshl_add_u32 v8, v3, 8, v8
    v_mul_u32_u24 v9, 57, v7
    v_lshrrev_b32 v9, 10, v9
    v_mul_u32_u24 v10, 18, v9
    v_sub_u32 v10, v7, v10
    v_lshrrev_b32 v12, 3, v10
    v_and_b32 v13, 1, v10
    v_lshl_add_u32 v12, v12, 1, v13
    v_bfe_u32 v14, v10, 1, 2
    v_cmp_gt_u32 vcc, 16, v10
    v_mul_u32_u24 v9, 331776, v9
    v_add_u32 v9, v9, v8
    v_cndmask_b32 v12, 8, v12, vcc
    v_cndmask_b32 v14, v13, v14, vcc
    v_mov_b32 v15, 0x1000
    v_mov_b32 v13, 0x80
    v_cndmask_b32 v15, v13, v15, vcc
    v_lshl_add_u32 v9, v12, 10, v9
    v_lshl_add_u32 v9, v14, 6, v9
    v_add_u32 v10, v9, v15
    s_and_b32 s31, s28, 1
    s_cmp_eq_u32 s31, 1
    s_cselect_b64 vcc, -1, 0
    v_cndmask_b32 v14, v9, v10, vcc
    s_mul_i32 s31, s28, 36864
    s_add_u32 s37, s31, 0x4100000
    s_add_u32 s38, s31, 0x4100000
    s_add_u32 s39, s31, 0x4102400
    s_add_u32 s40, s31, 0x4102400
    s_add_u32 s41, s31, 0x4104800
    s_add_u32 s42, s31, 0x4104800
    s_add_u32 s43, s31, 0x4106c00
    s_add_u32 s47, s31, 0x4106c00
    s_lshr_b32 s31, s28, 1
    s_mul_i32 s31, s31, 9216
    s_add_u32 s48, s31, 0x4148000
    v_mov_b32 v15, v6
    s_mov_b32 s49, 0
    s_branch L_p0_ld
L_p0_wi:
    s_mov_b32 s26, s2
    s_mul_i32 s28, s26, 57
    s_lshr_b32 s28, s28, 12
    s_mul_i32 s27, s28, 72
    s_sub_u32 s27, s26, s27
    s_mov_b32 s32, s44
    s_mov_b32 s33, s45
    s_mov_b32 s34, 0x510000
    s_mov_b32 s35, 0x20000
    s_mul_i32 s29, s28, 2654208
    s_lshl_b32 s31, s27, 7
    s_add_u32 s29, s29, s31
    s_mul_i32 s31, s20, 663552
    s_add_u32 s29, s29, s31
    v_lshrrev_b32 v4, 7, v1
    v_mul_u32_u24 v4, 9216, v4
    v_and_b32 v5, 0x70, v1
    v_add_u32 v4, v4, v5
    s_barrier
    s_barrier
    s_barrier
    s_barrier
    s_barrier
    s_add_u32 m0, s30, 94208
    s_add_u32 s31, s29, 0
    buffer_load_dwordx4 v4, s[32:35], s31 offen  lds
    s_add_u32 m0, s30, 95232
    s_add_u32 s31, s29, 73728
    buffer_load_dwordx4 v4, s[32:35], s31 offen  lds
    s_add_u32 m0, s30, 96256
    s_add_u32 s31, s29, 147456
    buffer_load_dwordx4 v4, s[32:35], s31 offen  lds
    s_add_u32 m0, s30, 97280
    s_add_u32 s31, s29, 221184
    buffer_load_dwordx4 v4, s[32:35], s31 offen  lds
    s_add_u32 m0, s30, 98304
    s_add_u32 s31, s29, 294912
    buffer_load_dwordx4 v4, s[32:35], s31 offen  lds
    s_add_u32 m0, s30, 99328
    s_add_u32 s31, s29, 368640
    buffer_load_dwordx4 v4, s[32:35], s31 offen  lds
    s_add_u32 m0, s30, 100352
    s_add_u32 s31, s29, 442368
    buffer_load_dwordx4 v4, s[32:35], s31 offen  lds
    s_add_u32 m0, s30, 101376
    s_add_u32 s31, s29, 516096
    buffer_load_dwordx4 v4, s[32:35], s31 offen  lds
    s_add_u32 m0, s30, 102400
    s_add_u32 s31, s29, 589824
    buffer_load_dwordx4 v4, s[32:35], s31 offen  lds
    v_lshrrev_b32 v7, 2, v2
    v_and_b32 v8, 3, v2
    s_lshl_b32 s31, s20, 5
    s_add_u32 s31, s31, 94208
    v_lshlrev_b32 v9, 7, v7
    v_lshl_add_u32 v9, v8, 3, v9
    v_add_u32 v9, s31, v9
    v_mul_u32_u24 v4, 1024, v3
    v_add_u32 v4, v4, v9
    v_mul_u32_u24 v5, 9216, v3
    v_add_u32 v5, v5, v9
    s_lshl_b32 s31, s27, 2
    s_add_u32 s31, s31, s20
    v_lshl_add_u32 v7, s31, 2, v7
    v_lshlrev_b32 v8, 4, v8
    v_lshl_add_u32 v8, v3, 8, v8
    s_cmp_lt_u32 s31, 144
    s_cselect_b32 s23, 1, 0
    s_cselect_b32 s24, 0, 144
    s_sub_u32 s26, s31, s24
    s_mul_i32 s25, s26, 57
    s_lshr_b32 s25, s25, 9
    s_mul_i32 s24, s25, 9
    s_sub_u32 s24, s26, s24
    s_lshl_b32 s26, s25, 1
    s_add_u32 s26, s26, s23
    s_mul_i32 s26, s26, 165888
    s_lshl_b32 s31, s24, 10
    s_add_u32 s26, s26, s31
    s_add_u32 s26, s26, 0x3b00000
    s_mul_i32 s31, s28, 9216
    s_add_u32 s48, s26, s31
    s_add_u32 s48, s48, 147456
    s_lshl_b32 s31, s31, 3
    s_add_u32 s26, s26, s31
    s_add_u32 s37, s26, 0
    s_add_u32 s38, s26, 9216
    s_add_u32 s39, s26, 18432
    s_add_u32 s40, s26, 27648
    s_add_u32 s41, s26, 36864
    s_add_u32 s42, s26, 46080
    s_add_u32 s43, s26, 55296
    s_add_u32 s47, s26, 64512
    s_lshl_b32 s49, s25, 12
    s_mul_i32 s31, s28, 1152
    s_add_u32 s49, s49, s31
    s_mul_i32 s31, s23, 576
    s_add_u32 s49, s49, s31
    s_lshl_b32 s31, s24, 6
    s_add_u32 s49, s49, s31
    s_add_u32 s49, s49, 0x4410000
    v_cmp_eq_u32 vcc, 0, v3
    v_lshlrev_b32 v15, 2, v2
    v_mov_b32 v9, v1
    v_mov_b32 v10, v1
    v_mov_b32 v14, v1
    v_cndmask_b32 v15, v6, v15, vcc
L_p0_ld:
    s_waitcnt lgkmcnt(0)
    s_branch L_m_l1
L_m_cl:
    s_and_b32 s25, s2, 7
    s_lshr_b32 s26, s2, 3
    s_lshr_b32 s23, s25, 1
    s_lshl_b32 s23, s23, 2
    s_lshr_b32 s27, s26, 3
    s_add_u32 s23, s23, s27
    s_and_b32 s24, s25, 1
    s_lshl_b32 s24, s24, 3
    s_and_b32 s27, s26, 7
    s_add_u32 s24, s24, s27
    s_lshl_b32 s30, s23, 3
    s_lshl_b32 s31, s20, 1
    s_add_u32 s31, s30, s31
    s_mul_i32 s29, s31, 18432
    s_add_u32 s29, s29, s21
    s_add_u32 s35, s29, 0x600000
    s_add_u32 s29, s29, 0x0
    s_max_u32 s30, s30, 1
    s_sub_u32 s30, s30, 1
    s_lshl_b32 s30, s30, 10
    s_add_u32 s30, s30, s21
    s_add_u32 s30, s30, 0x1b00000
    s_lshl_b32 s32, s31, 10
    s_add_u32 s32, s32, s21
    s_add_u32 s32, s32, 0x1b00000
    v_bfe_u32 v2, v1, 4, 4
    v_lshrrev_b32 v3, 8, v1
    s_lshl_b32 s33, s20, 2
    s_lshr_b32 s33, 0x3362, s33
    s_and_b32 s33, s33, 15
    s_min_u32 s34, s20, 1
    s_add_u32 s34, s34, 4
    s_lshl_b32 s36, s33, 10
    s_lshl_b32 s37, s34, 10
    v_add_u32 v247, 64512, v1
    v_add_u32 v248, 131072, v1
    v_add_u32 v249, s36, v1
    v_add_u32 v250, s36, v247
    v_add_u32 v251, s37, v1
    v_add_u32 v252, s37, v247
    v_add_u32 v253, 18432, v1
    v_lshrrev_b32 v0, 1, v1
    s_add_u32 s38, s29, 0
    s_add_u32 s39, s29, 4096
    s_add_u32 s40, s29, 8192
    s_add_u32 s41, s29, 12288
    s_add_u32 s42, s29, 16384
    s_max_u32 s44, s23, 1
    s_sub_u32 s44, s44, 1
    s_lshl_b32 s52, s22, 7
    s_add_u32 s52, s52, s23
    s_lshl_b32 s52, s52, 8
    s_add_u32 s52, s52, 0x4503000
    s_add_u32 s52, s52, s4
    s_addc_u32 s53, s5, 0
    s_lshl_b32 s54, s22, 7
    s_add_u32 s54, s54, s44
    s_lshl_b32 s54, s54, 8
    s_add_u32 s54, s54, 0x4503000
    s_add_u32 s54, s54, s4
    s_addc_u32 s55, s5, 0
    s_lshl_b32 s44, s24, 8
    s_add_u32 s44, s44, 0x4500000
    s_add_u32 s44, s44, s4
    s_addc_u32 s45, s5, 0
    s_waitcnt vmcnt(0)
    s_barrier
    s_cmp_lg_u32 s20, 0
    s_cbranch_scc1 L_ns_d1
    s_cmp_eq_u32 s22, 0
    s_cbranch_scc1 L_d1_first
    s_mov_b32 s56, 1
    s_atomic_add s56, s[50:51], 0
L_ns_d1:
    s_barrier
    s_cmp_lg_u32 s20, 0
    s_cbranch_scc1 L_pd_d1
    s_mov_b32 s60, 65536
L_poll_d1:
    s_mov_b32 s57, 0
    s_atomic_add s57, s[52:53], 0 glc
    s_mov_b32 s58, 0
    s_atomic_add s58, s[54:55], 0 glc
    s_mov_b32 s59, 0
    s_atomic_add s59, s[44:45], 0 glc
    s_waitcnt lgkmcnt(0)
    s_cmp_ge_u32 s59, 108
    s_cselect_b32 s59, 16, 0
    s_min_u32 s57, s57, s58
    s_min_u32 s57, s57, s59
    s_cmp_ge_u32 s57, 16
    s_cbranch_scc1 L_pd_d1
    s_sub_u32 s60, s60, 1
    s_cbranch_scc1 L_pd_d1
    s_sleep 2
    s_branch L_poll_d1
L_pd_d1:
    s_barrier
    buffer_load_dwordx4 v[160:163], v1, s[4:7], s38 offen offset:0 sc1
    buffer_load_dwordx4 v[164:167], v253, s[4:7], s38 offen offset:0 sc1
    buffer_load_dwordx4 v[168:171], v1, s[4:7], s38 offen offset:1024 sc1
    buffer_load_dwordx4 v[172:175], v253, s[4:7], s38 offen offset:1024 sc1
    buffer_load_dwordx4 v[176:179], v1, s[4:7], s38 offen offset:2048 sc1
    buffer_load_dwordx4 v[180:183], v253, s[4:7], s38 offen offset:2048 sc1
    buffer_load_dwordx4 v[184:187], v1, s[4:7], s38 offen offset:3072 sc1
    buffer_load_dwordx4 v[188:191], v253, s[4:7], s38 offen offset:3072 sc1
    s_barrier
    ds_read_b128 v[80:83], v1 offset:0
    ds_read_b128 v[84:87], v1 offset:1024
    ds_read_b128 v[88:91], v1 offset:2048
    ds_read_b128 v[92:95], v1 offset:3072
    ds_read_b128 v[96:99], v1 offset:4096
    ds_read_b128 v[100:103], v1 offset:5120
    ds_read_b128 v[104:107], v1 offset:6144
    buffer_load_dwordx2 v[4:5], v0, s[4:7], s30 offen offset:0 sc1
    buffer_load_dwordx2 v[6:7], v0, s[4:7], s30 offen offset:512 sc1
    buffer_load_dwordx2 v[8:9], v0, s[4:7], s32 offen offset:0 sc1
    buffer_load_dwordx2 v[10:11], v0, s[4:7], s32 offen offset:512 sc1
    buffer_load_dwordx2 v[12:13], v0, s[4:7], s32 offen offset:1024 sc1
    buffer_load_dwordx2 v[14:15], v0, s[4:7], s32 offen offset:1536 sc1
    s_lshl_b32 s50, s22, 7
    s_add_u32 s50, s50, s23
    s_lshl_b32 s50, s50, 8
    s_add_u32 s50, s50, 0x4508000
    s_add_u32 s50, s50, s4
    s_addc_u32 s51, s5, 0
    s_waitcnt vmcnt(12) lgkmcnt(3)
    v_mfma_f32_16x16x32_bf16 v[16:19], v[80:83], v[160:163], 0
    ds_read_b128 v[120:123], v1 offset:7168
    v_mfma_f32_16x16x32_bf16 v[44:47], v[80:83], v[164:167], 0
    ds_read_b128 v[124:127], v1 offset:8192
    v_mfma_f32_16x16x32_bf16 v[20:23], v[84:87], v[160:163], 0
    ds_read_b128 v[128:131], v1 offset:9216
    v_mfma_f32_16x16x32_bf16 v[48:51], v[84:87], v[164:167], 0
    ds_read_b128 v[132:135], v1 offset:10240
    v_mfma_f32_16x16x32_bf16 v[24:27], v[88:91], v[160:163], 0
    ds_read_b128 v[136:139], v1 offset:11264
    v_mfma_f32_16x16x32_bf16 v[52:55], v[88:91], v[164:167], 0
    ds_read_b128 v[140:143], v1 offset:12288
    v_mfma_f32_16x16x32_bf16 v[28:31], v[92:95], v[160:163], 0
    ds_read_b128 v[144:147], v1 offset:13312
    v_mfma_f32_16x16x32_bf16 v[56:59], v[92:95], v[164:167], 0
    s_waitcnt lgkmcnt(7)
    v_mfma_f32_16x16x32_bf16 v[32:35], v[160:163], v[96:99], 0
    v_mfma_f32_16x16x32_bf16 v[60:63], v[164:167], v[96:99], 0
    v_mfma_f32_16x16x32_bf16 v[36:39], v[160:163], v[100:103], 0
    buffer_load_dwordx4 v[192:195], v1, s[4:7], s39 offen offset:0 sc1
    v_mfma_f32_16x16x32_bf16 v[64:67], v[164:167], v[100:103], 0
    buffer_load_dwordx4 v[196:199], v253, s[4:7], s39 offen offset:0 sc1
    v_mfma_f32_16x16x32_bf16 v[40:43], v[104:107], v[160:163], 0
    buffer_load_dwordx4 v[200:203], v1, s[4:7], s39 offen offset:1024 sc1
    v_mfma_f32_16x16x32_bf16 v[68:71], v[104:107], v[164:167], 0
    buffer_load_dwordx4 v[204:207], v253, s[4:7], s39 offen offset:1024 sc1
    s_waitcnt vmcnt(14) lgkmcnt(3)
    s_barrier
    v_mfma_f32_16x16x32_bf16 v[16:19], v[120:123], v[168:171], v[16:19]
    ds_read_b128 v[80:83], v1 offset:14336
    v_mfma_f32_16x16x32_bf16 v[44:47], v[120:123], v[172:175], v[44:47]
    ds_read_b128 v[84:87], v1 offset:15360
    v_mfma_f32_16x16x32_bf16 v[20:23], v[124:127], v[168:171], v[20:23]
    ds_read_b128 v[88:91], v1 offset:16384
    v_mfma_f32_16x16x32_bf16 v[48:51], v[124:127], v[172:175], v[48:51]
    ds_read_b128 v[92:95], v1 offset:17408
    v_mfma_f32_16x16x32_bf16 v[24:27], v[128:131], v[168:171], v[24:27]
    ds_read_b128 v[96:99], v1 offset:18432
    v_mfma_f32_16x16x32_bf16 v[52:55], v[128:131], v[172:175], v[52:55]
    ds_read_b128 v[100:103], v1 offset:19456
    v_mfma_f32_16x16x32_bf16 v[28:31], v[132:135], v[168:171], v[28:31]
    ds_read_b128 v[104:107], v1 offset:20480
    v_mfma_f32_16x16x32_bf16 v[56:59], v[132:135], v[172:175], v[56:59]
    ds_read_b128 v[108:111], v248 offset:0
    s_waitcnt lgkmcnt(8)
    v_mfma_f32_16x16x32_bf16 v[32:35], v[168:171], v[136:139], v[32:35]
    ds_read_b128 v[112:115], v249 offset:0
    v_mfma_f32_16x16x32_bf16 v[60:63], v[172:175], v[136:139], v[60:63]
    ds_read_b128 v[116:119], v251 offset:0
    v_mfma_f32_16x16x32_bf16 v[36:39], v[168:171], v[140:143], v[36:39]
    buffer_load_dwordx4 v[160:163], v1, s[4:7], s39 offen offset:2048 sc1
    v_mfma_f32_16x16x32_bf16 v[64:67], v[172:175], v[140:143], v[64:67]
    buffer_load_dwordx4 v[164:167], v253, s[4:7], s39 offen offset:2048 sc1
    v_mfma_f32_16x16x32_bf16 v[40:43], v[144:147], v[168:171], v[40:43]
    v_mfma_f32_16x16x32_bf16 v[68:71], v[144:147], v[172:175], v[68:71]
    s_waitcnt vmcnt(6) lgkmcnt(6)
    v_mfma_f32_16x16x32_bf16 v[16:19], v[80:83], v[176:179], v[16:19]
    ds_read_b128 v[120:123], v1 offset:21504
    v_mfma_f32_16x16x32_bf16 v[44:47], v[80:83], v[180:183], v[44:47]
    ds_read_b128 v[124:127], v1 offset:22528
    v_add_f32 v240, v4, v6
    v_mfma_f32_16x16x32_bf16 v[20:23], v[84:87], v[176:179], v[20:23]
    ds_read_b128 v[128:131], v1 offset:23552
    v_add_f32 v241, v5, v7
    v_mfma_f32_16x16x32_bf16 v[48:51], v[84:87], v[180:183], v[48:51]
    ds_read_b128 v[132:135], v1 offset:24576
    v_add_f32 v242, v8, v10
    v_mfma_f32_16x16x32_bf16 v[24:27], v[88:91], v[176:179], v[24:27]
    ds_read_b128 v[136:139], v1 offset:25600
    v_add_f32 v243, v9, v11
    v_mfma_f32_16x16x32_bf16 v[52:55], v[88:91], v[180:183], v[52:55]
    ds_read_b128 v[140:143], v1 offset:26624
    v_add_f32 v244, v12, v14
    v_mfma_f32_16x16x32_bf16 v[28:31], v[92:95], v[176:179], v[28:31]
    ds_read_b128 v[144:147], v1 offset:27648
    v_add_f32 v245, v13, v15
    v_mfma_f32_16x16x32_bf16 v[56:59], v[92:95], v[180:183], v[56:59]
    ds_read_b128 v[148:151], v248 offset:1024
    s_waitcnt lgkmcnt(8)
    v_mfma_f32_16x16x32_bf16 v[32:35], v[176:179], v[96:99], v[32:35]
    ds_read_b128 v[152:155], v249 offset:7168
    v_mov_b32 v4, v240
    v_mfma_f32_16x16x32_bf16 v[60:63], v[180:183], v[96:99], v[60:63]
    ds_read_b128 v[156:159], v251 offset:7168
    v_mov_b32 v5, v241
    v_mfma_f32_16x16x32_bf16 v[36:39], v[176:179], v[100:103], v[36:39]
    buffer_load_dwordx4 v[168:171], v1, s[4:7], s39 offen offset:3072 sc1
    v_mfma_f32_16x16x32_bf16 v[64:67], v[180:183], v[100:103], v[64:67]
    buffer_load_dwordx4 v[172:175], v253, s[4:7], s39 offen offset:3072 sc1
    v_mfma_f32_16x16x32_bf16 v[40:43], v[104:107], v[176:179], v[40:43]
    v_mov_b32 v8, v242
    v_mfma_f32_16x16x32_bf16 v[68:71], v[104:107], v[180:183], v[68:71]
    v_mov_b32 v9, v243
    v_mfma_f32_16x16x32_bf16 v[72:75], v[112:115], v[108:111], 0
    v_mov_b32 v12, v244
    v_mov_b32 v13, v245
    v_mfma_f32_16x16x32_bf16 v[76:79], v[108:111], v[116:119], 0
    v_permlane32_swap_b32 v240, v4
    s_waitcnt vmcnt(8) lgkmcnt(6)
    s_barrier
    v_mfma_f32_16x16x32_bf16 v[16:19], v[120:123], v[184:187], v[16:19]
    ds_read_b128 v[80:83], v1 offset:28672
    v_mfma_f32_16x16x32_bf16 v[44:47], v[120:123], v[188:191], v[44:47]
    ds_read_b128 v[84:87], v1 offset:29696
    v_permlane32_swap_b32 v241, v5
    v_mfma_f32_16x16x32_bf16 v[20:23], v[124:127], v[184:187], v[20:23]
    ds_read_b128 v[88:91], v1 offset:30720
    v_permlane32_swap_b32 v242, v8
    v_mfma_f32_16x16x32_bf16 v[48:51], v[124:127], v[188:191], v[48:51]
    ds_read_b128 v[92:95], v1 offset:31744
    v_permlane32_swap_b32 v243, v9
    v_mfma_f32_16x16x32_bf16 v[24:27], v[128:131], v[184:187], v[24:27]
    ds_read_b128 v[96:99], v1 offset:32768
    v_permlane32_swap_b32 v244, v12
    v_mfma_f32_16x16x32_bf16 v[52:55], v[128:131], v[188:191], v[52:55]
    ds_read_b128 v[100:103], v1 offset:33792
    v_permlane32_swap_b32 v245, v13
    v_mfma_f32_16x16x32_bf16 v[28:31], v[132:135], v[184:187], v[28:31]
    ds_read_b128 v[104:107], v1 offset:34816
    v_add_f32 v240, v240, v4
    v_mfma_f32_16x16x32_bf16 v[56:59], v[132:135], v[188:191], v[56:59]
    ds_read_b128 v[108:111], v248 offset:2048
    s_waitcnt lgkmcnt(8)
    v_mfma_f32_16x16x32_bf16 v[32:35], v[184:187], v[136:139], v[32:35]
    ds_read_b128 v[112:115], v249 offset:14336
    v_add_f32 v241, v241, v5
    v_mfma_f32_16x16x32_bf16 v[60:63], v[188:191], v[136:139], v[60:63]
    ds_read_b128 v[116:119], v251 offset:14336
    v_add_f32 v242, v242, v8
    v_mfma_f32_16x16x32_bf16 v[36:39], v[184:187], v[140:143], v[36:39]
    buffer_load_dwordx4 v[176:179], v1, s[4:7], s40 offen offset:0 sc1
    v_mfma_f32_16x16x32_bf16 v[64:67], v[188:191], v[140:143], v[64:67]
    buffer_load_dwordx4 v[180:183], v253, s[4:7], s40 offen offset:0 sc1
    v_mfma_f32_16x16x32_bf16 v[40:43], v[144:147], v[184:187], v[40:43]
    v_add_f32 v243, v243, v9
    v_mfma_f32_16x16x32_bf16 v[68:71], v[144:147], v[188:191], v[68:71]
    v_add_f32 v244, v244, v12
    v_mfma_f32_16x16x32_bf16 v[72:75], v[152:155], v[148:151], v[72:75]
    v_add_f32 v245, v245, v13
    v_mov_b32 v4, v240
    v_mfma_f32_16x16x32_bf16 v[76:79], v[148:151], v[156:159], v[76:79]
    v_mov_b32 v5, v241
    s_waitcnt vmcnt(8) lgkmcnt(6)
    v_mfma_f32_16x16x32_bf16 v[16:19], v[80:83], v[192:195], v[16:19]
    ds_read_b128 v[120:123], v1 offset:35840
    v_mfma_f32_16x16x32_bf16 v[44:47], v[80:83], v[196:199], v[44:47]
    ds_read_b128 v[124:127], v1 offset:36864
    v_mov_b32 v8, v242
    v_mfma_f32_16x16x32_bf16 v[20:23], v[84:87], v[192:195], v[20:23]
    ds_read_b128 v[128:131], v1 offset:37888
    v_mov_b32 v9, v243
    v_mfma_f32_16x16x32_bf16 v[48:51], v[84:87], v[196:199], v[48:51]
    ds_read_b128 v[132:135], v1 offset:38912
    v_mov_b32 v12, v244
    v_mfma_f32_16x16x32_bf16 v[24:27], v[88:91], v[192:195], v[24:27]
    ds_read_b128 v[136:139], v1 offset:39936
    v_mov_b32 v13, v245
    v_mfma_f32_16x16x32_bf16 v[52:55], v[88:91], v[196:199], v[52:55]
    ds_read_b128 v[140:143], v1 offset:40960
    v_permlane16_swap_b32 v240, v4
    v_mfma_f32_16x16x32_bf16 v[28:31], v[92:95], v[192:195], v[28:31]
    ds_read_b128 v[144:147], v1 offset:41984
    v_permlane16_swap_b32 v241, v5
    v_mfma_f32_16x16x32_bf16 v[56:59], v[92:95], v[196:199], v[56:59]
    ds_read_b128 v[148:151], v248 offset:3072
    s_waitcnt lgkmcnt(8)
    v_mfma_f32_16x16x32_bf16 v[32:35], v[192:195], v[96:99], v[32:35]
    ds_read_b128 v[152:155], v249 offset:21504
    v_permlane16_swap_b32 v242, v8
    v_mfma_f32_16x16x32_bf16 v[60:63], v[196:199], v[96:99], v[60:63]
    ds_read_b128 v[156:159], v251 offset:21504
    v_permlane16_swap_b32 v243, v9
    v_mfma_f32_16x16x32_bf16 v[36:39], v[192:195], v[100:103], v[36:39]
    buffer_load_dwordx4 v[184:187], v1, s[4:7], s40 offen offset:1024 sc1
    v_mfma_f32_16x16x32_bf16 v[64:67], v[196:199], v[100:103], v[64:67]
    buffer_load_dwordx4 v[188:191], v253, s[4:7], s40 offen offset:1024 sc1
    v_mfma_f32_16x16x32_bf16 v[40:43], v[104:107], v[192:195], v[40:43]
    v_permlane16_swap_b32 v244, v12
    v_mfma_f32_16x16x32_bf16 v[68:71], v[104:107], v[196:199], v[68:71]
    v_permlane16_swap_b32 v245, v13
    v_mfma_f32_16x16x32_bf16 v[72:75], v[112:115], v[108:111], v[72:75]
    v_add_f32 v240, v240, v4
    v_add_f32 v241, v241, v5
    v_mfma_f32_16x16x32_bf16 v[76:79], v[108:111], v[116:119], v[76:79]
    v_add_f32 v242, v242, v8
    s_waitcnt vmcnt(8) lgkmcnt(6)
    s_barrier
    v_mfma_f32_16x16x32_bf16 v[16:19], v[120:123], v[200:203], v[16:19]
    ds_read_b128 v[80:83], v1 offset:43008
    v_mfma_f32_16x16x32_bf16 v[44:47], v[120:123], v[204:207], v[44:47]
    ds_read_b128 v[84:87], v1 offset:44032
    v_add_f32 v243, v243, v9
    v_mfma_f32_16x16x32_bf16 v[20:23], v[124:127], v[200:203], v[20:23]
    ds_read_b128 v[88:91], v1 offset:45056
    v_add_f32 v244, v244, v12
    v_mfma_f32_16x16x32_bf16 v[48:51], v[124:127], v[204:207], v[48:51]
    ds_read_b128 v[92:95], v1 offset:46080
    v_add_f32 v245, v245, v13
    v_mfma_f32_16x16x32_bf16 v[24:27], v[128:131], v[200:203], v[24:27]
    ds_read_b128 v[96:99], v1 offset:47104
    v_mul_f32 v240, 0x3ae38e39, v240
    v_mfma_f32_16x16x32_bf16 v[52:55], v[128:131], v[204:207], v[52:55]
    ds_read_b128 v[100:103], v1 offset:48128
    v_mul_f32 v241, 0x3ae38e39, v241
    v_mfma_f32_16x16x32_bf16 v[28:31], v[132:135], v[200:203], v[28:31]
    ds_read_b128 v[104:107], v1 offset:49152
    v_mul_f32 v242, 0x3ae38e39, v242
    v_mfma_f32_16x16x32_bf16 v[56:59], v[132:135], v[204:207], v[56:59]
    ds_read_b128 v[108:111], v248 offset:4096
    s_waitcnt lgkmcnt(8)
    v_mfma_f32_16x16x32_bf16 v[32:35], v[200:203], v[136:139], v[32:35]
    ds_read_b128 v[112:115], v249 offset:28672
    v_mul_f32 v243, 0x3ae38e39, v243
    v_mfma_f32_16x16x32_bf16 v[60:63], v[204:207], v[136:139], v[60:63]
    ds_read_b128 v[116:119], v251 offset:28672
    v_mul_f32 v244, 0x3ae38e39, v244
    v_mfma_f32_16x16x32_bf16 v[36:39], v[200:203], v[140:143], v[36:39]
    buffer_load_dwordx4 v[192:195], v1, s[4:7], s40 offen offset:2048 sc1
    v_mfma_f32_16x16x32_bf16 v[64:67], v[204:207], v[140:143], v[64:67]
    buffer_load_dwordx4 v[196:199], v253, s[4:7], s40 offen offset:2048 sc1
    v_mfma_f32_16x16x32_bf16 v[40:43], v[144:147], v[200:203], v[40:43]
    v_mul_f32 v245, 0x3ae38e39, v245
    v_mfma_f32_16x16x32_bf16 v[68:71], v[144:147], v[204:207], v[68:71]
    v_fma_f32 v241, -v240, v240, v241
    v_mfma_f32_16x16x32_bf16 v[72:75], v[152:155], v[148:151], v[72:75]
    v_fma_f32 v243, -v242, v242, v243
    v_fma_f32 v245, -v244, v244, v245
    v_mfma_f32_16x16x32_bf16 v[76:79], v[148:151], v[156:159], v[76:79]
    v_max_f32 v241, 0, v241
    s_waitcnt vmcnt(8) lgkmcnt(6)
    v_mfma_f32_16x16x32_bf16 v[16:19], v[80:83], v[160:163], v[16:19]
    ds_read_b128 v[120:123], v1 offset:50176
    v_mfma_f32_16x16x32_bf16 v[44:47], v[80:83], v[164:167], v[44:47]
    ds_read_b128 v[124:127], v1 offset:51200
    v_max_f32 v243, 0, v243
    v_mfma_f32_16x16x32_bf16 v[20:23], v[84:87], v[160:163], v[20:23]
    ds_read_b128 v[128:131], v1 offset:52224
    v_max_f32 v245, 0, v245
    v_mfma_f32_16x16x32_bf16 v[48:51], v[84:87], v[164:167], v[48:51]
    ds_read_b128 v[132:135], v1 offset:53248
    v_add_f32 v241, 0x3727c5ac, v241
    v_mfma_f32_16x16x32_bf16 v[24:27], v[88:91], v[160:163], v[24:27]
    ds_read_b128 v[136:139], v1 offset:54272
    v_add_f32 v243, 0x3727c5ac, v243
    v_mfma_f32_16x16x32_bf16 v[52:55], v[88:91], v[164:167], v[52:55]
    ds_read_b128 v[140:143], v1 offset:55296
    v_add_f32 v245, 0x3727c5ac, v245
    v_mfma_f32_16x16x32_bf16 v[28:31], v[92:95], v[160:163], v[28:31]
    ds_read_b128 v[144:147], v1 offset:56320
    v_rsq_f32 v241, v241
    v_mfma_f32_16x16x32_bf16 v[56:59], v[92:95], v[164:167], v[56:59]
    ds_read_b128 v[148:151], v248 offset:5120
    s_waitcnt lgkmcnt(8)
    v_mfma_f32_16x16x32_bf16 v[32:35], v[160:163], v[96:99], v[32:35]
    ds_read_b128 v[152:155], v249 offset:35840
    v_rsq_f32 v243, v243
    v_mfma_f32_16x16x32_bf16 v[60:63], v[164:167], v[96:99], v[60:63]
    ds_read_b128 v[156:159], v251 offset:35840
    v_rsq_f32 v245, v245
    v_mfma_f32_16x16x32_bf16 v[36:39], v[160:163], v[100:103], v[36:39]
    buffer_load_dwordx4 v[200:203], v1, s[4:7], s40 offen offset:3072 sc1
    v_mfma_f32_16x16x32_bf16 v[64:67], v[164:167], v[100:103], v[64:67]
    buffer_load_dwordx4 v[204:207], v253, s[4:7], s40 offen offset:3072 sc1
    v_mfma_f32_16x16x32_bf16 v[40:43], v[104:107], v[160:163], v[40:43]
    s_nop 0
    v_mfma_f32_16x16x32_bf16 v[68:71], v[104:107], v[164:167], v[68:71]
    v_lshlrev_b32 v255, 4, v3
    v_mfma_f32_16x16x32_bf16 v[72:75], v[112:115], v[108:111], v[72:75]
    v_add_u32 v236, 161792, v255
    s_lshl_b32 s36, s33, 6
    v_mfma_f32_16x16x32_bf16 v[76:79], v[108:111], v[116:119], v[76:79]
    v_add_u32 v237, s36, v236
    s_waitcnt vmcnt(8) lgkmcnt(6)
    v_mfma_f32_16x16x32_bf16 v[16:19], v[120:123], v[168:171], v[16:19]
    ds_read_b128 v[80:83], v1 offset:57344
    v_mfma_f32_16x16x32_bf16 v[44:47], v[120:123], v[172:175], v[44:47]
    ds_read_b128 v[84:87], v1 offset:58368
    v_lshlrev_b32 v254, 2, v2
    v_mfma_f32_16x16x32_bf16 v[20:23], v[124:127], v[168:171], v[20:23]
    ds_read_b128 v[88:91], v1 offset:59392
    v_add_u32 v238, 161792, v254
    v_mfma_f32_16x16x32_bf16 v[48:51], v[124:127], v[172:175], v[48:51]
    ds_read_b128 v[92:95], v1 offset:60416
    s_lshl_b32 s37, s34, 6
    v_mfma_f32_16x16x32_bf16 v[24:27], v[128:131], v[168:171], v[24:27]
    ds_read_b128 v[96:99], v1 offset:61440
    v_add_u32 v239, s37, v238
    v_mfma_f32_16x16x32_bf16 v[52:55], v[128:131], v[172:175], v[52:55]
    ds_read_b128 v[100:103], v1 offset:62464
    s_mul_i32 s36, s20, 3072
    v_mfma_f32_16x16x32_bf16 v[28:31], v[132:135], v[168:171], v[28:31]
    ds_read_b128 v[104:107], v1 offset:63488
    s_add_u32 s36, s36, 153600
    v_mfma_f32_16x16x32_bf16 v[56:59], v[132:135], v[172:175], v[56:59]
    ds_read_b128 v[108:111], v248 offset:6144
    s_waitcnt lgkmcnt(8)
    v_mfma_f32_16x16x32_bf16 v[32:35], v[168:171], v[136:139], v[32:35]
    ds_read_b128 v[112:115], v249 offset:43008
    v_add_u32 v254, s36, v254
    v_mfma_f32_16x16x32_bf16 v[60:63], v[172:175], v[136:139], v[60:63]
    ds_read_b128 v[116:119], v251 offset:43008
    v_add_u32 v255, s36, v255
    v_mfma_f32_16x16x32_bf16 v[36:39], v[168:171], v[140:143], v[36:39]
    buffer_load_dwordx4 v[160:163], v1, s[4:7], s41 offen offset:0 sc1
    v_mfma_f32_16x16x32_bf16 v[64:67], v[172:175], v[140:143], v[64:67]
    buffer_load_dwordx4 v[164:167], v253, s[4:7], s41 offen offset:0 sc1
    v_mfma_f32_16x16x32_bf16 v[40:43], v[144:147], v[168:171], v[40:43]
    v_mfma_f32_16x16x32_bf16 v[68:71], v[144:147], v[172:175], v[68:71]
    ds_write2_b32 v254, v240, v241 offset0:0 offset1:16
    v_mfma_f32_16x16x32_bf16 v[72:75], v[152:155], v[148:151], v[72:75]
    ds_write2_b32 v254, v242, v243 offset0:32 offset1:48
    v_mfma_f32_16x16x32_bf16 v[76:79], v[148:151], v[156:159], v[76:79]
    ds_write2_b32 v254, v244, v245 offset0:64 offset1:80
    s_waitcnt vmcnt(8) lgkmcnt(9)
    s_barrier
    v_mfma_f32_16x16x32_bf16 v[16:19], v[80:83], v[176:179], v[16:19]
    ds_read_b128 v[120:123], v247 offset:0
    v_mfma_f32_16x16x32_bf16 v[44:47], v[80:83], v[180:183], v[44:47]
    ds_read_b128 v[124:127], v247 offset:1024
    v_mfma_f32_16x16x32_bf16 v[20:23], v[84:87], v[176:179], v[20:23]
    ds_read_b128 v[128:131], v247 offset:2048
    v_mfma_f32_16x16x32_bf16 v[48:51], v[84:87], v[180:183], v[48:51]
    ds_read_b128 v[132:135], v247 offset:3072
    v_mfma_f32_16x16x32_bf16 v[24:27], v[88:91], v[176:179], v[24:27]
    ds_read_b128 v[136:139], v247 offset:4096
    v_mfma_f32_16x16x32_bf16 v[52:55], v[88:91], v[180:183], v[52:55]
    ds_read_b128 v[140:143], v247 offset:5120
    v_mfma_f32_16x16x32_bf16 v[28:31], v[92:95], v[176:179], v[28:31]
    ds_read_b128 v[144:147], v247 offset:6144
    v_mfma_f32_16x16x32_bf16 v[56:59], v[92:95], v[180:183], v[56:59]
    ds_read_b128 v[148:151], v248 offset:7168
    s_waitcnt lgkmcnt(8)
    v_mfma_f32_16x16x32_bf16 v[32:35], v[176:179], v[96:99], v[32:35]
    ds_read_b128 v[152:155], v249 offset:50176
    v_mfma_f32_16x16x32_bf16 v[60:63], v[180:183], v[96:99], v[60:63]
    ds_read_b128 v[156:159], v251 offset:50176
    v_mfma_f32_16x16x32_bf16 v[36:39], v[176:179], v[100:103], v[36:39]
    buffer_load_dwordx4 v[168:171], v1, s[4:7], s41 offen offset:1024 sc1
    ds_read_b128 v[208:211], v236 offset:0
    v_mfma_f32_16x16x32_bf16 v[64:67], v[180:183], v[100:103], v[64:67]
    buffer_load_dwordx4 v[172:175], v253, s[4:7], s41 offen offset:1024 sc1
    ds_read_b128 v[212:215], v236 offset:64
    v_mfma_f32_16x16x32_bf16 v[40:43], v[104:107], v[176:179], v[40:43]
    ds_read_b128 v[216:219], v236 offset:128
    v_mfma_f32_16x16x32_bf16 v[68:71], v[104:107], v[180:183], v[68:71]
    ds_read_b128 v[220:223], v236 offset:192
    v_mfma_f32_16x16x32_bf16 v[72:75], v[112:115], v[108:111], v[72:75]
    ds_read_b128 v[224:227], v236 offset:384
    v_mfma_f32_16x16x32_bf16 v[76:79], v[108:111], v[116:119], v[76:79]
    ds_read_b128 v[228:231], v237
    s_waitcnt vmcnt(8) lgkmcnt(12)
    v_mfma_f32_16x16x32_bf16 v[16:19], v[120:123], v[184:187], v[16:19]
    ds_read_b128 v[80:83], v247 offset:7168
    v_mfma_f32_16x16x32_bf16 v[44:47], v[120:123], v[188:191], v[44:47]
    ds_read_b128 v[84:87], v247 offset:8192
    v_mfma_f32_16x16x32_bf16 v[20:23], v[124:127], v[184:187], v[20:23]
    ds_read_b128 v[88:91], v247 offset:9216
    v_mfma_f32_16x16x32_bf16 v[48:51], v[124:127], v[188:191], v[48:51]
    ds_read_b128 v[92:95], v247 offset:10240
    v_mfma_f32_16x16x32_bf16 v[24:27], v[128:131], v[184:187], v[24:27]
    ds_read_b128 v[96:99], v247 offset:11264
    v_mfma_f32_16x16x32_bf16 v[52:55], v[128:131], v[188:191], v[52:55]
    ds_read_b128 v[100:103], v247 offset:12288
    v_mfma_f32_16x16x32_bf16 v[28:31], v[132:135], v[184:187], v[28:31]
    ds_read_b128 v[104:107], v247 offset:13312
    v_mfma_f32_16x16x32_bf16 v[56:59], v[132:135], v[188:191], v[56:59]
    ds_read_b128 v[108:111], v248 offset:8192
    s_waitcnt lgkmcnt(8)
    v_mfma_f32_16x16x32_bf16 v[32:35], v[184:187], v[136:139], v[32:35]
    ds_read_b128 v[112:115], v249 offset:57344
    v_mfma_f32_16x16x32_bf16 v[60:63], v[188:191], v[136:139], v[60:63]
    ds_read_b128 v[116:119], v251 offset:57344
    v_mfma_f32_16x16x32_bf16 v[36:39], v[184:187], v[140:143], v[36:39]
    buffer_load_dwordx4 v[176:179], v1, s[4:7], s41 offen offset:2048 sc1
    v_mfma_f32_16x16x32_bf16 v[64:67], v[188:191], v[140:143], v[64:67]
    buffer_load_dwordx4 v[180:183], v253, s[4:7], s41 offen offset:2048 sc1
    ds_read2_b32 v[232:233], v238 offset0:64 offset1:80
    v_mfma_f32_16x16x32_bf16 v[40:43], v[144:147], v[184:187], v[40:43]
    ds_read_b32 v234, v239
    v_mfma_f32_16x16x32_bf16 v[68:71], v[144:147], v[188:191], v[68:71]
    ds_read_b128 v[4:7], v255 offset:0
    v_mfma_f32_16x16x32_bf16 v[72:75], v[152:155], v[148:151], v[72:75]
    ds_read_b128 v[8:11], v255 offset:128
    v_mfma_f32_16x16x32_bf16 v[76:79], v[148:151], v[156:159], v[76:79]
    ds_read_b128 v[12:15], v255 offset:256
    s_waitcnt vmcnt(8) lgkmcnt(11)
    s_barrier
    v_mfma_f32_16x16x32_bf16 v[16:19], v[80:83], v[192:195], v[16:19]
    ds_read_b128 v[120:123], v247 offset:14336
    v_mfma_f32_16x16x32_bf16 v[44:47], v[80:83], v[196:199], v[44:47]
    ds_read_b128 v[124:127], v247 offset:15360
    v_mfma_f32_16x16x32_bf16 v[20:23], v[84:87], v[192:195], v[20:23]
    ds_read_b128 v[128:131], v247 offset:16384
    v_mfma_f32_16x16x32_bf16 v[48:51], v[84:87], v[196:199], v[48:51]
    ds_read_b128 v[132:135], v247 offset:17408
    v_mfma_f32_16x16x32_bf16 v[24:27], v[88:91], v[192:195], v[24:27]
    ds_read_b128 v[136:139], v247 offset:18432
    v_mfma_f32_16x16x32_bf16 v[52:55], v[88:91], v[196:199], v[52:55]
    ds_read_b128 v[140:143], v247 offset:19456
    v_mfma_f32_16x16x32_bf16 v[28:31], v[92:95], v[192:195], v[28:31]
    ds_read_b128 v[144:147], v247 offset:20480
    v_mfma_f32_16x16x32_bf16 v[56:59], v[92:95], v[196:199], v[56:59]
    ds_read_b128 v[148:151], v248 offset:9216
    s_waitcnt lgkmcnt(8)
    v_mfma_f32_16x16x32_bf16 v[32:35], v[192:195], v[96:99], v[32:35]
    ds_read_b128 v[152:155], v250 offset:0
    v_mfma_f32_16x16x32_bf16 v[60:63], v[196:199], v[96:99], v[60:63]
    ds_read_b128 v[156:159], v252 offset:0
    v_mfma_f32_16x16x32_bf16 v[36:39], v[192:195], v[100:103], v[36:39]
    buffer_load_dwordx4 v[184:187], v1, s[4:7], s41 offen offset:3072 sc1
    v_mfma_f32_16x16x32_bf16 v[64:67], v[196:199], v[100:103], v[64:67]
    buffer_load_dwordx4 v[188:191], v253, s[4:7], s41 offen offset:3072 sc1
    v_mfma_f32_16x16x32_bf16 v[40:43], v[104:107], v[192:195], v[40:43]
    v_mfma_f32_16x16x32_bf16 v[68:71], v[104:107], v[196:199], v[68:71]
    v_mfma_f32_16x16x32_bf16 v[72:75], v[112:115], v[108:111], v[72:75]
    v_mfma_f32_16x16x32_bf16 v[76:79], v[108:111], v[116:119], v[76:79]
    s_waitcnt vmcnt(8) lgkmcnt(6)
    v_mfma_f32_16x16x32_bf16 v[16:19], v[120:123], v[200:203], v[16:19]
    ds_read_b128 v[80:83], v247 offset:21504
    v_fma_f32 v32, -v8, v232, v32
    v_mfma_f32_16x16x32_bf16 v[44:47], v[120:123], v[204:207], v[44:47]
    ds_read_b128 v[84:87], v247 offset:22528
    v_fma_f32 v60, -v12, v232, v60
    v_mfma_f32_16x16x32_bf16 v[20:23], v[124:127], v[200:203], v[20:23]
    ds_read_b128 v[88:91], v247 offset:23552
    v_fma_f32 v36, -v8, v233, v36
    v_mfma_f32_16x16x32_bf16 v[48:51], v[124:127], v[204:207], v[48:51]
    ds_read_b128 v[92:95], v247 offset:24576
    v_fma_f32 v64, -v12, v233, v64
    v_mfma_f32_16x16x32_bf16 v[24:27], v[128:131], v[200:203], v[24:27]
    ds_read_b128 v[96:99], v247 offset:25600
    v_fma_f32 v40, -v242, v224, v40
    v_mfma_f32_16x16x32_bf16 v[52:55], v[128:131], v[204:207], v[52:55]
    ds_read_b128 v[100:103], v247 offset:26624
    v_fma_f32 v68, -v244, v224, v68
    v_mfma_f32_16x16x32_bf16 v[28:31], v[132:135], v[200:203], v[28:31]
    ds_read_b128 v[104:107], v247 offset:27648
    v_fma_f32 v72, -v240, v228, v72
    v_mfma_f32_16x16x32_bf16 v[56:59], v[132:135], v[204:207], v[56:59]
    ds_read_b128 v[108:111], v248 offset:10240
    s_waitcnt lgkmcnt(8)
    v_fma_f32 v76, -v4, v234, v76
    v_mfma_f32_16x16x32_bf16 v[32:35], v[200:203], v[136:139], v[32:35]
    ds_read_b128 v[112:115], v250 offset:7168
    v_fma_f32 v16, -v242, v208, v16
    v_mfma_f32_16x16x32_bf16 v[60:63], v[204:207], v[136:139], v[60:63]
    ds_read_b128 v[116:119], v252 offset:7168
    v_fma_f32 v44, -v244, v208, v44
    v_mfma_f32_16x16x32_bf16 v[36:39], v[200:203], v[140:143], v[36:39]
    buffer_load_dwordx4 v[192:195], v1, s[4:7], s42 offen offset:0 sc1
    v_fma_f32 v20, -v242, v212, v20
    v_mfma_f32_16x16x32_bf16 v[64:67], v[204:207], v[140:143], v[64:67]
    buffer_load_dwordx4 v[196:199], v253, s[4:7], s42 offen offset:0 sc1
    v_fma_f32 v48, -v244, v212, v48
    v_mfma_f32_16x16x32_bf16 v[40:43], v[144:147], v[200:203], v[40:43]
    v_fma_f32 v24, -v242, v216, v24
    v_mfma_f32_16x16x32_bf16 v[68:71], v[144:147], v[204:207], v[68:71]
    v_fma_f32 v52, -v244, v216, v52
    v_mfma_f32_16x16x32_bf16 v[72:75], v[152:155], v[148:151], v[72:75]
    v_fma_f32 v28, -v242, v220, v28
    v_mfma_f32_16x16x32_bf16 v[76:79], v[148:151], v[156:159], v[76:79]
    v_fma_f32 v56, -v244, v220, v56
    s_waitcnt vmcnt(8) lgkmcnt(6)
    s_barrier
    v_mfma_f32_16x16x32_bf16 v[16:19], v[80:83], v[160:163], v[16:19]
    ds_read_b128 v[120:123], v247 offset:28672
    v_fma_f32 v33, -v9, v232, v33
    v_mfma_f32_16x16x32_bf16 v[44:47], v[80:83], v[164:167], v[44:47]
    ds_read_b128 v[124:127], v247 offset:29696
    v_fma_f32 v61, -v13, v232, v61
    v_mfma_f32_16x16x32_bf16 v[20:23], v[84:87], v[160:163], v[20:23]
    ds_read_b128 v[128:131], v247 offset:30720
    v_fma_f32 v37, -v9, v233, v37
    v_mfma_f32_16x16x32_bf16 v[48:51], v[84:87], v[164:167], v[48:51]
    ds_read_b128 v[132:135], v247 offset:31744
    v_fma_f32 v65, -v13, v233, v65
    v_mfma_f32_16x16x32_bf16 v[24:27], v[88:91], v[160:163], v[24:27]
    ds_read_b128 v[136:139], v247 offset:32768
    v_fma_f32 v41, -v242, v225, v41
    v_mfma_f32_16x16x32_bf16 v[52:55], v[88:91], v[164:167], v[52:55]
    ds_read_b128 v[140:143], v247 offset:33792
    v_fma_f32 v69, -v244, v225, v69
    v_mfma_f32_16x16x32_bf16 v[28:31], v[92:95], v[160:163], v[28:31]
    ds_read_b128 v[144:147], v247 offset:34816
    v_fma_f32 v73, -v240, v229, v73
    v_mfma_f32_16x16x32_bf16 v[56:59], v[92:95], v[164:167], v[56:59]
    ds_read_b128 v[148:151], v248 offset:11264
    s_waitcnt lgkmcnt(8)
    v_fma_f32 v77, -v5, v234, v77
    v_mfma_f32_16x16x32_bf16 v[32:35], v[160:163], v[96:99], v[32:35]
    ds_read_b128 v[152:155], v250 offset:14336
    v_fma_f32 v17, -v242, v209, v17
    v_mfma_f32_16x16x32_bf16 v[60:63], v[164:167], v[96:99], v[60:63]
    ds_read_b128 v[156:159], v252 offset:14336
    v_fma_f32 v45, -v244, v209, v45
    v_mfma_f32_16x16x32_bf16 v[36:39], v[160:163], v[100:103], v[36:39]
    buffer_load_dwordx4 v[200:203], v1, s[4:7], s42 offen offset:1024 sc1
    v_fma_f32 v21, -v242, v213, v21
    v_mfma_f32_16x16x32_bf16 v[64:67], v[164:167], v[100:103], v[64:67]
    buffer_load_dwordx4 v[204:207], v253, s[4:7], s42 offen offset:1024 sc1
    v_fma_f32 v49, -v244, v213, v49
    v_mfma_f32_16x16x32_bf16 v[40:43], v[104:107], v[160:163], v[40:43]
    v_fma_f32 v25, -v242, v217, v25
    v_mfma_f32_16x16x32_bf16 v[68:71], v[104:107], v[164:167], v[68:71]
    v_fma_f32 v53, -v244, v217, v53
    v_mfma_f32_16x16x32_bf16 v[72:75], v[112:115], v[108:111], v[72:75]
    v_fma_f32 v29, -v242, v221, v29
    v_mfma_f32_16x16x32_bf16 v[76:79], v[108:111], v[116:119], v[76:79]
    v_fma_f32 v57, -v244, v221, v57
    s_waitcnt vmcnt(8) lgkmcnt(6)
    v_mfma_f32_16x16x32_bf16 v[16:19], v[120:123], v[168:171], v[16:19]
    ds_read_b128 v[80:83], v247 offset:35840
    v_fma_f32 v34, -v10, v232, v34
    v_mfma_f32_16x16x32_bf16 v[44:47], v[120:123], v[172:175], v[44:47]
    ds_read_b128 v[84:87], v247 offset:36864
    v_fma_f32 v62, -v14, v232, v62
    v_mfma_f32_16x16x32_bf16 v[20:23], v[124:127], v[168:171], v[20:23]
    ds_read_b128 v[88:91], v247 offset:37888
    v_fma_f32 v38, -v10, v233, v38
    v_mfma_f32_16x16x32_bf16 v[48:51], v[124:127], v[172:175], v[48:51]
    ds_read_b128 v[92:95], v247 offset:38912
    v_fma_f32 v66, -v14, v233, v66
    v_mfma_f32_16x16x32_bf16 v[24:27], v[128:131], v[168:171], v[24:27]
    ds_read_b128 v[96:99], v247 offset:39936
    v_fma_f32 v42, -v242, v226, v42
    v_mfma_f32_16x16x32_bf16 v[52:55], v[128:131], v[172:175], v[52:55]
    ds_read_b128 v[100:103], v247 offset:40960
    v_fma_f32 v70, -v244, v226, v70
    v_mfma_f32_16x16x32_bf16 v[28:31], v[132:135], v[168:171], v[28:31]
    ds_read_b128 v[104:107], v247 offset:41984
    v_fma_f32 v74, -v240, v230, v74
    v_mfma_f32_16x16x32_bf16 v[56:59], v[132:135], v[172:175], v[56:59]
    ds_read_b128 v[108:111], v248 offset:12288
    s_waitcnt lgkmcnt(8)
    v_fma_f32 v78, -v6, v234, v78
    v_mfma_f32_16x16x32_bf16 v[32:35], v[168:171], v[136:139], v[32:35]
    ds_read_b128 v[112:115], v250 offset:21504
    v_fma_f32 v18, -v242, v210, v18
    v_mfma_f32_16x16x32_bf16 v[60:63], v[172:175], v[136:139], v[60:63]
    ds_read_b128 v[116:119], v252 offset:21504
    v_fma_f32 v46, -v244, v210, v46
    v_mfma_f32_16x16x32_bf16 v[36:39], v[168:171], v[140:143], v[36:39]
    v_fma_f32 v22, -v242, v214, v22
    v_mfma_f32_16x16x32_bf16 v[64:67], v[172:175], v[140:143], v[64:67]
    v_fma_f32 v50, -v244, v214, v50
    v_mfma_f32_16x16x32_bf16 v[40:43], v[144:147], v[168:171], v[40:43]
    v_fma_f32 v26, -v242, v218, v26
    v_mfma_f32_16x16x32_bf16 v[68:71], v[144:147], v[172:175], v[68:71]
    v_fma_f32 v54, -v244, v218, v54
    v_mfma_f32_16x16x32_bf16 v[72:75], v[152:155], v[148:151], v[72:75]
    v_fma_f32 v30, -v242, v222, v30
    v_mfma_f32_16x16x32_bf16 v[76:79], v[148:151], v[156:159], v[76:79]
    v_fma_f32 v58, -v244, v222, v58
    s_waitcnt vmcnt(6) lgkmcnt(6)
    v_mfma_f32_16x16x32_bf16 v[16:19], v[80:83], v[176:179], v[16:19]
    ds_read_b128 v[120:123], v247 offset:43008
    v_fma_f32 v35, -v11, v232, v35
    v_mfma_f32_16x16x32_bf16 v[44:47], v[80:83], v[180:183], v[44:47]
    ds_read_b128 v[124:127], v247 offset:44032
    v_fma_f32 v63, -v15, v232, v63
    v_mfma_f32_16x16x32_bf16 v[20:23], v[84:87], v[176:179], v[20:23]
    ds_read_b128 v[128:131], v247 offset:45056
    v_fma_f32 v39, -v11, v233, v39
    v_mfma_f32_16x16x32_bf16 v[48:51], v[84:87], v[180:183], v[48:51]
    ds_read_b128 v[132:135], v247 offset:46080
    v_fma_f32 v67, -v15, v233, v67
    v_mfma_f32_16x16x32_bf16 v[24:27], v[88:91], v[176:179], v[24:27]
    ds_read_b128 v[136:139], v247 offset:47104
    v_fma_f32 v43, -v242, v227, v43
    v_mfma_f32_16x16x32_bf16 v[52:55], v[88:91], v[180:183], v[52:55]
    ds_read_b128 v[140:143], v247 offset:48128
    v_fma_f32 v71, -v244, v227, v71
    v_mfma_f32_16x16x32_bf16 v[28:31], v[92:95], v[176:179], v[28:31]
    ds_read_b128 v[144:147], v247 offset:49152
    v_fma_f32 v75, -v240, v231, v75
    v_mfma_f32_16x16x32_bf16 v[56:59], v[92:95], v[180:183], v[56:59]
    ds_read_b128 v[148:151], v248 offset:13312
    s_waitcnt lgkmcnt(8)
    v_fma_f32 v79, -v7, v234, v79
    v_mfma_f32_16x16x32_bf16 v[32:35], v[176:179], v[96:99], v[32:35]
    ds_read_b128 v[152:155], v250 offset:28672
    v_fma_f32 v19, -v242, v211, v19
    v_mfma_f32_16x16x32_bf16 v[60:63], v[180:183], v[96:99], v[60:63]
    ds_read_b128 v[156:159], v252 offset:28672
    v_fma_f32 v47, -v244, v211, v47
    v_mfma_f32_16x16x32_bf16 v[36:39], v[176:179], v[100:103], v[36:39]
    v_fma_f32 v23, -v242, v215, v23
    v_mfma_f32_16x16x32_bf16 v[64:67], v[180:183], v[100:103], v[64:67]
    v_fma_f32 v51, -v244, v215, v51
    v_mfma_f32_16x16x32_bf16 v[40:43], v[104:107], v[176:179], v[40:43]
    v_fma_f32 v27, -v242, v219, v27
    v_mfma_f32_16x16x32_bf16 v[68:71], v[104:107], v[180:183], v[68:71]
    v_fma_f32 v55, -v244, v219, v55
    v_mfma_f32_16x16x32_bf16 v[72:75], v[112:115], v[108:111], v[72:75]
    v_fma_f32 v31, -v242, v223, v31
    v_mfma_f32_16x16x32_bf16 v[76:79], v[108:111], v[116:119], v[76:79]
    v_fma_f32 v59, -v244, v223, v59
    s_waitcnt vmcnt(4) lgkmcnt(6)
    s_barrier
    v_mfma_f32_16x16x32_bf16 v[16:19], v[120:123], v[184:187], v[16:19]
    ds_read_b128 v[80:83], v247 offset:50176
    v_mfma_f32_16x16x32_bf16 v[44:47], v[120:123], v[188:191], v[44:47]
    ds_read_b128 v[84:87], v247 offset:51200
    v_and_b32 v4, 1, v2
    v_mfma_f32_16x16x32_bf16 v[20:23], v[124:127], v[184:187], v[20:23]
    ds_read_b128 v[88:91], v247 offset:52224
    v_lshl_add_u32 v5, v3, 2, v4
    v_mfma_f32_16x16x32_bf16 v[48:51], v[124:127], v[188:191], v[48:51]
    ds_read_b128 v[92:95], v247 offset:53248
    v_add_u32 v6, 2, v5
    v_mfma_f32_16x16x32_bf16 v[24:27], v[128:131], v[184:187], v[24:27]
    ds_read_b128 v[96:99], v247 offset:54272
    v_cmp_eq_u32 s[40:41], 1, v4
    v_mfma_f32_16x16x32_bf16 v[52:55], v[128:131], v[188:191], v[52:55]
    ds_read_b128 v[100:103], v247 offset:55296
    v_cmp_le_u32 s[42:43], v5, v2
    v_mfma_f32_16x16x32_bf16 v[28:31], v[132:135], v[184:187], v[28:31]
    ds_read_b128 v[104:107], v247 offset:56320
    v_cmp_le_u32 s[44:45], v6, v2
    v_mfma_f32_16x16x32_bf16 v[56:59], v[132:135], v[188:191], v[56:59]
    ds_read_b128 v[108:111], v248 offset:14336
    s_waitcnt lgkmcnt(8)
    v_mfma_f32_16x16x32_bf16 v[32:35], v[184:187], v[136:139], v[32:35]
    ds_read_b128 v[112:115], v250 offset:35840
    v_mov_b32 v4, 0x0c0c0100
    v_mfma_f32_16x16x32_bf16 v[60:63], v[188:191], v[136:139], v[60:63]
    ds_read_b128 v[116:119], v252 offset:35840
    v_mov_b32 v5, 0x01000c0c
    v_mfma_f32_16x16x32_bf16 v[36:39], v[184:187], v[140:143], v[36:39]
    v_mov_b32 v6, 0x0c0c0302
    v_mov_b32 v7, 0x03020c0c
    v_mfma_f32_16x16x32_bf16 v[64:67], v[188:191], v[140:143], v[64:67]
    v_mov_b32 v8, 0x0c0c0c0c
    v_cndmask_b32 v4, v4, v5, s[40:41]
    v_mfma_f32_16x16x32_bf16 v[40:43], v[144:147], v[184:187], v[40:43]
    v_cndmask_b32 v6, v6, v7, s[40:41]
    v_cndmask_b32 v12, v4, v8, s[42:43]
    v_mfma_f32_16x16x32_bf16 v[68:71], v[144:147], v[188:191], v[68:71]
    v_cndmask_b32 v13, v6, v8, s[44:45]
    v_cndmask_b32 v14, v8, v4, s[42:43]
    v_mfma_f32_16x16x32_bf16 v[72:75], v[152:155], v[148:151], v[72:75]
    v_cndmask_b32 v15, v8, v6, s[44:45]
    s_cmp_eq_u32 s31, 0
    v_mfma_f32_16x16x32_bf16 v[76:79], v[148:151], v[156:159], v[76:79]
    s_cselect_b64 s[48:49], s[42:43], -1
    s_cselect_b64 s[38:39], s[44:45], -1
    s_waitcnt vmcnt(2) lgkmcnt(6)
    v_mfma_f32_16x16x32_bf16 v[16:19], v[80:83], v[192:195], v[16:19]
    ds_read_b128 v[120:123], v247 offset:57344
    v_mfma_f32_16x16x32_bf16 v[44:47], v[80:83], v[196:199], v[44:47]
    ds_read_b128 v[124:127], v247 offset:58368
    s_mul_i32 s36, s20, 3072
    v_mfma_f32_16x16x32_bf16 v[20:23], v[84:87], v[192:195], v[20:23]
    ds_read_b128 v[128:131], v247 offset:59392
    s_add_u32 s36, s36, 149504
    v_mfma_f32_16x16x32_bf16 v[48:51], v[84:87], v[196:199], v[48:51]
    ds_read_b128 v[132:135], v247 offset:60416
    v_add_u32 v9, s36, v0
    v_mfma_f32_16x16x32_bf16 v[24:27], v[88:91], v[192:195], v[24:27]
    ds_read_b128 v[136:139], v247 offset:61440
    s_lshl_b32 s37, s20, 9
    v_mfma_f32_16x16x32_bf16 v[52:55], v[88:91], v[196:199], v[52:55]
    ds_read_b128 v[140:143], v247 offset:62464
    s_add_u32 s37, s37, 149504
    v_mfma_f32_16x16x32_bf16 v[28:31], v[92:95], v[192:195], v[28:31]
    ds_read_b128 v[144:147], v247 offset:63488
    v_add_u32 v10, s37, v0
    v_mfma_f32_16x16x32_bf16 v[56:59], v[92:95], v[196:199], v[56:59]
    ds_read_b128 v[148:151], v248 offset:15360
    s_waitcnt lgkmcnt(8)
    v_mfma_f32_16x16x32_bf16 v[32:35], v[192:195], v[96:99], v[32:35]
    ds_read_b128 v[152:155], v250 offset:43008
    v_lshlrev_b32 v4, 2, v3
    v_mfma_f32_16x16x32_bf16 v[60:63], v[196:199], v[96:99], v[60:63]
    ds_read_b128 v[156:159], v252 offset:43008
    v_sub_u32 v4, v2, v4
    v_mfma_f32_16x16x32_bf16 v[36:39], v[192:195], v[100:103], v[36:39]
    v_lshlrev_b32 v5, 4, v4
    v_lshrrev_b32 v4, 1, v4
    v_mfma_f32_16x16x32_bf16 v[64:67], v[196:199], v[100:103], v[64:67]
    v_mov_b32 v6, 0x3f80
    v_lshlrev_b32 v5, v5, v6
    v_mfma_f32_16x16x32_bf16 v[40:43], v[104:107], v[192:195], v[40:43]
    v_cmp_eq_u32 vcc, 0, v4
    v_cmp_eq_u32 s[46:47], 1, v4
    v_mfma_f32_16x16x32_bf16 v[68:71], v[104:107], v[196:199], v[68:71]
    ds_read_b128 v[208:211], v255 offset:64
    s_lshl_b32 s36, s24, 10
    v_add_u32 v4, s36, v1
    v_mfma_f32_16x16x32_bf16 v[72:75], v[112:115], v[108:111], v[72:75]
    ds_read_b128 v[212:215], v255 offset:192
    v_cndmask_b32 v234, 0, v5, vcc
    v_cndmask_b32 v235, 0, v5, s[46:47]
    v_mfma_f32_16x16x32_bf16 v[76:79], v[108:111], v[116:119], v[76:79]
    ds_read_b128 v[216:219], v255 offset:320
    v_add_u32 v5, 18432, v4
    s_lshl_b32 s36, s24, 7
    s_waitcnt vmcnt(0) lgkmcnt(9)
    v_mfma_f32_16x16x32_bf16 v[16:19], v[120:123], v[200:203], v[16:19]
    ds_read_b128 v[80:83], v248 offset:16384
    v_mfma_f32_16x16x32_bf16 v[44:47], v[120:123], v[204:207], v[44:47]
    ds_read_b128 v[84:87], v250 offset:50176
    s_add_u32 s36, s36, 16384
    v_mfma_f32_16x16x32_bf16 v[20:23], v[124:127], v[200:203], v[20:23]
    ds_read_b128 v[88:91], v252 offset:50176
    v_cmp_eq_u32 vcc, 2, v3
    v_mfma_f32_16x16x32_bf16 v[48:51], v[124:127], v[204:207], v[48:51]
    ds_read_b128 v[92:95], v248 offset:17408
    v_lshl_add_u32 v6, v2, 3, s36
    v_mfma_f32_16x16x32_bf16 v[24:27], v[128:131], v[200:203], v[24:27]
    ds_read_b128 v[96:99], v250 offset:57344
    v_bfrev_b32 v7, 1
    v_mfma_f32_16x16x32_bf16 v[52:55], v[128:131], v[204:207], v[52:55]
    ds_read_b128 v[100:103], v252 offset:57344
    v_cndmask_b32 v6, v7, v6, vcc
    v_mfma_f32_16x16x32_bf16 v[28:31], v[132:135], v[200:203], v[28:31]
    v_add_u32 v7, 18432, v6
    v_mov_b32 v106, 0
    v_mfma_f32_16x16x32_bf16 v[56:59], v[132:135], v[204:207], v[56:59]
    s_waitcnt lgkmcnt(6)
    v_mov_b32 v107, 0
    v_mfma_f32_16x16x32_bf16 v[32:35], v[200:203], v[136:139], v[32:35]
    v_mov_b32 v8, 0xf149f2ca
    v_mov_b32 v108, 0
    v_mfma_f32_16x16x32_bf16 v[60:63], v[204:207], v[136:139], v[60:63]
    s_mov_b32 s33, 0x3eae1a93
    v_mov_b32 v109, 0
    v_mfma_f32_16x16x32_bf16 v[36:39], v[200:203], v[140:143], v[36:39]
    v_mov_b32 v236, 0x3f803f80
    v_mov_b32 v237, 0x3f803f80
    v_mfma_f32_16x16x32_bf16 v[64:67], v[204:207], v[140:143], v[64:67]
    v_mov_b32 v238, 0x3f803f80
    v_mov_b32 v239, 0x3f803f80
    v_mfma_f32_16x16x32_bf16 v[40:43], v[144:147], v[200:203], v[40:43]
    v_mov_b32 v114, 0
    v_mfma_f32_16x16x32_bf16 v[68:71], v[144:147], v[204:207], v[68:71]
    v_mov_b32 v115, 0
    v_mfma_f32_16x16x32_bf16 v[72:75], v[152:155], v[148:151], v[72:75]
    v_mov_b32 v116, 0
    v_mfma_f32_16x16x32_bf16 v[76:79], v[148:151], v[156:159], v[76:79]
    v_mov_b32 v117, 0
    s_waitcnt lgkmcnt(0)
    v_mfma_f32_16x16x32_bf16 v[72:75], v[84:87], v[80:83], v[72:75]
    v_mfma_f32_16x16x32_bf16 v[76:79], v[80:83], v[88:91], v[76:79]
    v_mfma_f32_16x16x32_bf16 v[72:75], v[96:99], v[92:95], v[72:75]
    v_mfma_f32_16x16x32_bf16 v[76:79], v[92:95], v[100:103], v[76:79]
    v_pk_mul_f32 v[52:53], v[52:53], v[244:245] op_sel:[0,1] op_sel_hi:[1,1]
    v_pk_mul_f32 v[54:55], v[54:55], v[244:245] op_sel:[0,1] op_sel_hi:[1,1]
    v_pk_mul_f32 v[56:57], v[56:57], v[244:245] op_sel:[0,1] op_sel_hi:[1,1]
    v_pk_mul_f32 v[58:59], v[58:59], v[244:245] op_sel:[0,1] op_sel_hi:[1,1]
    v_pk_mul_f32 v[60:61], v[60:61], v[216:217]
    v_pk_mul_f32 v[62:63], v[62:63], v[218:219]
    v_pk_mul_f32 v[64:65], v[64:65], v[216:217]
    v_pk_mul_f32 v[66:67], v[66:67], v[218:219]
    v_pk_mul_f32 v[68:69], v[68:69], v[244:245] op_sel:[0,1] op_sel_hi:[1,1]
    v_pk_mul_f32 v[70:71], v[70:71], v[244:245] op_sel:[0,1] op_sel_hi:[1,1]
    v_pk_mul_f32 v[72:73], v[72:73], v[240:241] op_sel:[0,1] op_sel_hi:[1,1]
    v_pk_mul_f32 v[74:75], v[74:75], v[240:241] op_sel:[0,1] op_sel_hi:[1,1]
    v_pk_mul_f32 v[76:77], v[76:77], v[208:209]
    v_pk_mul_f32 v[78:79], v[78:79], v[210:211]
    v_cvt_pk_bf16_f32 v172, v52, v53
    v_cvt_pk_bf16_f32 v173, v54, v55
    v_cvt_pk_bf16_f32 v176, v56, v57
    v_cvt_pk_bf16_f32 v177, v58, v59
    v_cvt_pk_bf16_f32 v182, v60, v61
    v_cvt_pk_bf16_f32 v183, v62, v63
    v_cvt_pk_bf16_f32 v188, v64, v65
    v_cvt_pk_bf16_f32 v189, v66, v67
    v_cvt_pk_bf16_f32 v174, v68, v69
    v_cvt_pk_bf16_f32 v175, v70, v71
    v_cvt_pk_bf16_f32 v220, v72, v73
    v_cvt_pk_bf16_f32 v221, v74, v75
    v_cvt_pk_bf16_f32 v222, v76, v77
    v_cvt_pk_bf16_f32 v223, v78, v79
    s_cmp_eq_u32 s20, 3
    s_cbranch_scc1 L_a_nw
    ds_write2st64_b64 v9, v[172:173], v[174:175] offset0:6 offset1:7
    ds_write2st64_b64 v9, v[176:177], v[182:183] offset0:8 offset1:9
    ds_write_b64 v9, v[188:189] offset:5120
    ds_write2st64_b64 v10, v[220:221], v[222:223] offset0:0 offset1:3
L_a_nw:
    v_pk_mul_f32 v[24:25], v[24:25], v[242:243] op_sel:[0,1] op_sel_hi:[1,1]
    v_pk_mul_f32 v[26:27], v[26:27], v[242:243] op_sel:[0,1] op_sel_hi:[1,1]
    v_pk_mul_f32 v[28:29], v[28:29], v[242:243] op_sel:[0,1] op_sel_hi:[1,1]
    v_pk_mul_f32 v[30:31], v[30:31], v[242:243] op_sel:[0,1] op_sel_hi:[1,1]
    v_pk_mul_f32 v[32:33], v[32:33], v[212:213]
    v_pk_mul_f32 v[34:35], v[34:35], v[214:215]
    v_pk_mul_f32 v[36:37], v[36:37], v[212:213]
    v_pk_mul_f32 v[38:39], v[38:39], v[214:215]
    v_pk_mul_f32 v[40:41], v[40:41], v[242:243] op_sel:[0,1] op_sel_hi:[1,1]
    v_pk_mul_f32 v[42:43], v[42:43], v[242:243] op_sel:[0,1] op_sel_hi:[1,1]
    v_cvt_pk_bf16_f32 v166, v24, v25
    v_cvt_pk_bf16_f32 v167, v26, v27
    v_cvt_pk_bf16_f32 v170, v28, v29
    v_cvt_pk_bf16_f32 v171, v30, v31
    v_cvt_pk_bf16_f32 v180, v32, v33
    v_cvt_pk_bf16_f32 v181, v34, v35
    v_cvt_pk_bf16_f32 v186, v36, v37
    v_cvt_pk_bf16_f32 v187, v38, v39
    v_cvt_pk_bf16_f32 v168, v40, v41
    v_cvt_pk_bf16_f32 v169, v42, v43
    s_waitcnt lgkmcnt(0)
    s_barrier
    ds_read2st64_b64 v[160:163], v9 offset0:0 offset1:1
    ds_read_b64 v[164:165], v9 offset:1024
    ds_read_b64 v[178:179], v9 offset:1536
    ds_read_b64 v[184:185], v9 offset:2048
    v_mfma_f32_16x16x16_bf16 v[128:131], v[174:175], v[234:235], 0
    v_mfma_f32_16x16x16_bf16 v[124:127], v[168:169], v[234:235], 0
    v_pk_mul_f32 v[44:45], v[44:45], v[244:245] op_sel:[0,1] op_sel_hi:[1,1]
    v_pk_mul_f32 v[46:47], v[46:47], v[244:245] op_sel:[0,1] op_sel_hi:[1,1]
    v_pk_mul_f32 v[48:49], v[48:49], v[244:245] op_sel:[0,1] op_sel_hi:[1,1]
    v_pk_mul_f32 v[50:51], v[50:51], v[244:245] op_sel:[0,1] op_sel_hi:[1,1]
    v_pk_mul_f32 v[16:17], v[16:17], v[242:243] op_sel:[0,1] op_sel_hi:[1,1]
    v_pk_mul_f32 v[18:19], v[18:19], v[242:243] op_sel:[0,1] op_sel_hi:[1,1]
    v_pk_mul_f32 v[20:21], v[20:21], v[242:243] op_sel:[0,1] op_sel_hi:[1,1]
    v_pk_mul_f32 v[22:23], v[22:23], v[242:243] op_sel:[0,1] op_sel_hi:[1,1]
    v_cvt_pk_bf16_f32 v112, v44, v45
    v_cvt_pk_bf16_f32 v113, v46, v47
    v_cvt_pk_bf16_f32 v118, v48, v49
    v_cvt_pk_bf16_f32 v119, v50, v51
    v_cvt_pk_bf16_f32 v104, v16, v17
    v_cvt_pk_bf16_f32 v105, v18, v19
    v_cvt_pk_bf16_f32 v110, v20, v21
    v_cvt_pk_bf16_f32 v111, v22, v23
    v_permlane16_swap_b32 v114, v174
    v_permlane16_swap_b32 v117, v175
    v_permlane16_swap_b32 v106, v168
    v_permlane16_swap_b32 v109, v169
    s_waitcnt lgkmcnt(0)
    v_mfma_f32_16x16x16_bf16 v[120:123], v[162:163], v[234:235], 0
    v_mfma_f32_16x16x32_bf16 v[20:23], v[172:175], v[112:115], 0
    v_mfma_f32_16x16x32_bf16 v[16:19], v[166:169], v[112:115], 0
    v_mfma_f32_16x16x32_bf16 v[28:31], v[174:177], v[116:119], 0
    v_mfma_f32_16x16x32_bf16 v[24:27], v[168:171], v[116:119], 0
    v_mfma_f32_16x16x32_bf16 v[36:39], v[166:169], v[104:107], 0
    v_mfma_f32_16x16x32_bf16 v[32:35], v[160:163], v[104:107], 0
    v_mfma_f32_16x16x32_bf16 v[44:47], v[168:171], v[108:111], 0
    v_mfma_f32_16x16x32_bf16 v[40:43], v[162:165], v[108:111], 0
    v_cvt_pk_bf16_f32 v194, v128, v129
    v_cvt_pk_bf16_f32 v195, v130, v131
    v_cvt_pk_bf16_f32 v192, v124, v125
    v_cvt_pk_bf16_f32 v193, v126, v127
    v_cvt_pk_bf16_f32 v190, v120, v121
    v_cvt_pk_bf16_f32 v191, v122, v123
    v_cndmask_b32 v20, v20, v21, s[40:41]
    v_cndmask_b32 v16, v16, v17, s[40:41]
    v_cndmask_b32 v48, v16, v20, s[42:43]
    v_cndmask_b32 v22, v22, v23, s[40:41]
    v_cndmask_b32 v18, v18, v19, s[40:41]
    v_cndmask_b32 v49, v18, v22, s[44:45]
    v_max_f32 v56, v48, v49
    v_cndmask_b32 v28, v28, v29, s[40:41]
    v_cndmask_b32 v24, v24, v25, s[40:41]
    v_cndmask_b32 v50, v24, v28, s[42:43]
    v_cndmask_b32 v30, v30, v31, s[40:41]
    v_cndmask_b32 v26, v26, v27, s[40:41]
    v_cndmask_b32 v51, v26, v30, s[44:45]
    v_max_f32 v57, v50, v51
    v_cndmask_b32 v36, v36, v37, s[40:41]
    v_cndmask_b32 v32, v32, v33, s[40:41]
    v_cndmask_b32 v52, v32, v36, s[42:43]
    v_cndmask_b32 v52, v8, v52, s[48:49]
    v_cndmask_b32 v38, v38, v39, s[40:41]
    v_cndmask_b32 v34, v34, v35, s[40:41]
    v_cndmask_b32 v53, v34, v38, s[44:45]
    v_cndmask_b32 v53, v8, v53, s[38:39]
    v_max_f32 v58, v52, v53
    v_permlane32_swap_b32 v56, v57
    v_max_f32 v56, v56, v57
    v_cndmask_b32 v44, v44, v45, s[40:41]
    v_cndmask_b32 v40, v40, v41, s[40:41]
    v_cndmask_b32 v54, v40, v44, s[42:43]
    v_cndmask_b32 v54, v8, v54, s[48:49]
    v_cndmask_b32 v46, v46, v47, s[40:41]
    v_cndmask_b32 v42, v42, v43, s[40:41]
    v_cndmask_b32 v55, v42, v46, s[44:45]
    v_cndmask_b32 v55, v8, v55, s[38:39]
    v_max_f32 v59, v54, v55
    s_nop 1
    v_permlane32_swap_b32 v58, v59
    v_max_f32 v58, v58, v59
    s_nop 1
    v_permlane16_swap_b32 v56, v58
    v_max_f32 v57, v56, v58
    v_mul_f32 v56, s33, v57
    v_mul_f32 v58, s33, v57
    s_nop 1
    v_permlane16_swap_b32 v56, v58
    v_mov_b32 v57, v56
    v_mov_b32 v59, v58
    s_nop 0
    v_permlane32_swap_b32 v56, v57
    v_permlane32_swap_b32 v58, v59
    v_fma_f32 v48, v48, s33, -v56
    v_fma_f32 v49, v49, s33, -v56
    v_fma_f32 v50, v50, s33, -v57
    v_fma_f32 v51, v51, s33, -v57
    v_fma_f32 v52, v52, s33, -v58
    v_fma_f32 v53, v53, s33, -v58
    v_fma_f32 v54, v54, s33, -v59
    v_fma_f32 v55, v55, s33, -v59
    v_exp_f32 v48, v48
    v_exp_f32 v49, v49
    v_exp_f32 v50, v50
    v_exp_f32 v51, v51
    v_exp_f32 v52, v52
    v_exp_f32 v53, v53
    v_exp_f32 v54, v54
    v_exp_f32 v55, v55
    v_cvt_pk_bf16_f32 v56, v48, v49
    v_cvt_pk_bf16_f32 v57, v50, v51
    v_cvt_pk_bf16_f32 v58, v52, v53
    v_cvt_pk_bf16_f32 v59, v54, v55
    v_perm_b32 v64, v56, v56, v12
    v_perm_b32 v65, v56, v56, v13
    v_perm_b32 v66, v56, v56, v14
    v_perm_b32 v67, v56, v56, v15
    v_perm_b32 v68, v57, v57, v12
    v_perm_b32 v69, v57, v57, v13
    v_perm_b32 v70, v57, v57, v14
    v_perm_b32 v71, v57, v57, v15
    v_perm_b32 v72, v58, v58, v12
    v_perm_b32 v73, v58, v58, v13
    v_perm_b32 v74, v58, v58, v14
    v_perm_b32 v75, v58, v58, v15
    v_perm_b32 v76, v59, v59, v12
    v_perm_b32 v77, v59, v59, v13
    v_perm_b32 v78, v59, v59, v14
    v_perm_b32 v79, v59, v59, v15
    v_mfma_f32_16x16x32_bf16 v[80:83], v[236:239], v[64:67], 0
    v_mfma_f32_16x16x32_bf16 v[84:87], v[236:239], v[68:71], 0
    v_mfma_f32_16x16x32_bf16 v[88:91], v[236:239], v[72:75], 0
    v_mfma_f32_16x16x32_bf16 v[92:95], v[236:239], v[76:79], 0
    v_mfma_f32_16x16x32_bf16 v[16:19], v[180:183], v[64:67], 0
    v_mfma_f32_16x16x32_bf16 v[20:23], v[192:195], v[64:67], 0
    v_mfma_f32_16x16x32_bf16 v[24:27], v[186:189], v[68:71], 0
    v_mfma_f32_16x16x32_bf16 v[28:31], v[192:195], v[68:71], 0
    v_mfma_f32_16x16x32_bf16 v[32:35], v[178:181], v[72:75], 0
    v_mfma_f32_16x16x32_bf16 v[36:39], v[190:193], v[72:75], 0
    v_mfma_f32_16x16x32_bf16 v[40:43], v[184:187], v[76:79], 0
    v_mfma_f32_16x16x32_bf16 v[44:47], v[190:193], v[76:79], 0
    v_rcp_f32 v80, v80
    v_rcp_f32 v84, v84
    v_rcp_f32 v88, v88
    v_rcp_f32 v92, v92
    v_pk_mul_f32 v[16:17], v[16:17], v[80:81] op_sel_hi:[1,0]
    v_pk_mul_f32 v[18:19], v[18:19], v[80:81] op_sel_hi:[1,0]
    v_pk_mul_f32 v[20:21], v[20:21], v[80:81] op_sel_hi:[1,0]
    v_pk_mul_f32 v[24:25], v[24:25], v[84:85] op_sel_hi:[1,0]
    v_pk_mul_f32 v[26:27], v[26:27], v[84:85] op_sel_hi:[1,0]
    v_pk_mul_f32 v[30:31], v[30:31], v[84:85] op_sel_hi:[1,0]
    v_cvt_pk_bf16_f32 v220, v16, v17
    v_cvt_pk_bf16_f32 v221, v18, v19
    v_cvt_pk_bf16_f32 v224, v20, v21
    v_cvt_pk_bf16_f32 v222, v24, v25
    v_cvt_pk_bf16_f32 v223, v26, v27
    v_cvt_pk_bf16_f32 v225, v30, v31
    buffer_store_dwordx4 v[220:223], v5, s[4:7], s35 offen sc1
    buffer_store_dwordx2 v[224:225], v7, s[4:7], s35 offen sc1
    v_pk_mul_f32 v[32:33], v[32:33], v[88:89] op_sel_hi:[1,0]
    v_pk_mul_f32 v[34:35], v[34:35], v[88:89] op_sel_hi:[1,0]
    v_pk_mul_f32 v[36:37], v[36:37], v[88:89] op_sel_hi:[1,0]
    v_pk_mul_f32 v[40:41], v[40:41], v[92:93] op_sel_hi:[1,0]
    v_pk_mul_f32 v[42:43], v[42:43], v[92:93] op_sel_hi:[1,0]
    v_pk_mul_f32 v[46:47], v[46:47], v[92:93] op_sel_hi:[1,0]
    v_cvt_pk_bf16_f32 v228, v32, v33
    v_cvt_pk_bf16_f32 v229, v34, v35
    v_cvt_pk_bf16_f32 v232, v36, v37
    v_cvt_pk_bf16_f32 v230, v40, v41
    v_cvt_pk_bf16_f32 v231, v42, v43
    v_cvt_pk_bf16_f32 v233, v46, v47
    buffer_store_dwordx4 v[228:231], v4, s[4:7], s35 offen sc1
    buffer_store_dwordx2 v[232:233], v6, s[4:7], s35 offen sc1
    s_and_b32 s25, s2, 7
    s_lshr_b32 s26, s2, 3
    s_lshl_b32 s23, s25, 2
    s_lshr_b32 s27, s26, 3
    s_add_u32 s23, s23, s27
    s_and_b32 s24, s26, 7
    s_add_u32 s25, s23, s24
    s_and_b32 s25, s25, 3
    s_lshl_b32 s30, s23, 2
    s_add_u32 s30, s30, s20
    s_mul_i32 s29, s30, 18432
    s_add_u32 s29, s29, s21
    s_add_u32 s29, s29, 0x600000
    s_mul_i32 s34, s30, 18432
    s_add_u32 s34, s34, s21
    s_add_u32 s34, s34, 0x0
    s_lshl_b32 s35, s24, 11
    s_lshr_b32 s36, s24, 2
    s_lshl_b32 s36, s36, 10
    s_and_b32 s37, s24, 3
    s_lshl_b32 s37, s37, 8
    s_add_u32 s36, s36, s37
    s_add_u32 s36, s36, 16384
    v_bfe_u32 v2, v1, 4, 4
    v_lshrrev_b32 v3, 8, v1
    v_add_u32 v4, s35, v1
    v_lshlrev_b32 v5, 4, v2
    v_lshl_add_u32 v5, v3, 3, v5
    v_add_u32 v5, s36, v5
    v_cmp_gt_u32 s[40:41], 2, v3
    v_bfrev_b32 v6, 1
    v_add_u32 v12, 0, v1
    v_add_u32 v13, 36864, v1
    v_add_u32 v14, 73728, v1
    v_add_u32 v15, 110592, v1
    v_cndmask_b32 v5, v6, v5, s[40:41]
    buffer_load_dwordx4 v[208:211], v4, s[4:7], s34 offen offset:0 sc1
    buffer_load_dwordx4 v[212:215], v4, s[4:7], s34 offen offset:1024 sc1
    buffer_load_dwordx2 v[216:217], v5, s[4:7], s34 offen sc1
    s_add_u32 s34, s34, 0x300000
    s_lshl_b32 s39, s30, 10
    s_add_u32 s39, s39, s21
    s_lshl_b32 s42, s24, 7
    s_add_u32 s39, s39, s42
    s_add_u32 s39, s39, 0x1b20000
    v_cmp_eq_u32 vcc, 0, v3
    v_lshlrev_b32 v10, 3, v2
    v_mov_b32 v11, 0x3f803f80
    v_lshl_add_u32 v7, v3, 8, v10
    v_cndmask_b32 v10, v6, v10, vcc
    s_lshr_b32 s44, s23, 1
    s_lshl_b32 s52, s22, 7
    s_add_u32 s52, s52, s44
    s_lshl_b32 s52, s52, 8
    s_add_u32 s52, s52, 0x4508000
    s_add_u32 s52, s52, s4
    s_addc_u32 s53, s5, 0
    s_waitcnt vmcnt(3)
    s_barrier
    s_cmp_lg_u32 s20, 0
    s_cbranch_scc1 L_ns_d2
    s_mov_b32 s56, 1
    s_atomic_add s56, s[50:51], 0
L_ns_d2:
    s_cmp_lg_u32 s20, 0
    s_cbranch_scc1 L_pd_d2
    s_mov_b32 s60, 65536
L_poll_d2:
    s_mov_b32 s57, 0
    s_atomic_add s57, s[52:53], 0 glc
    s_waitcnt lgkmcnt(0)
    s_cmp_ge_u32 s57, 16
    s_cbranch_scc1 L_pd_d2
    s_sub_u32 s60, s60, 1
    s_cbranch_scc1 L_pd_d2
    s_sleep 2
    s_branch L_poll_d2
L_pd_d2:
    s_barrier
    s_mov_b32 s32, 0
    s_lshl_b32 s32, s32, 13
    s_add_u32 s32, s32, s29
    s_add_u32 s33, s32, 4096
    buffer_load_dwordx4 v[112:115], v1, s[4:7], s32 offen offset:0 sc1
    buffer_load_dwordx4 v[116:119], v1, s[4:7], s32 offen offset:1024 sc1
    buffer_load_dwordx4 v[120:123], v1, s[4:7], s32 offen offset:2048 sc1
    buffer_load_dwordx4 v[124:127], v1, s[4:7], s32 offen offset:3072 sc1
    buffer_load_dwordx4 v[128:131], v1, s[4:7], s33 offen offset:0 sc1
    buffer_load_dwordx4 v[132:135], v1, s[4:7], s33 offen offset:1024 sc1
    buffer_load_dwordx4 v[136:139], v1, s[4:7], s33 offen offset:2048 sc1
    buffer_load_dwordx4 v[140:143], v1, s[4:7], s33 offen offset:3072 sc1
    ds_read_b128 v[40:43], v12 offset:18432
    ds_read_b128 v[44:47], v12 offset:19456
    ds_read_b128 v[48:51], v12 offset:20480
    ds_read_b128 v[52:55], v12 offset:21504
    ds_read_b128 v[72:75], v12 offset:26624
    ds_read_b128 v[56:59], v12 offset:22528
    ds_read_b128 v[60:63], v12 offset:23552
    ds_read_b128 v[64:67], v12 offset:24576
    ds_read_b128 v[68:71], v12 offset:25600
    s_mov_b32 s32, 1
    s_lshl_b32 s32, s32, 13
    s_add_u32 s32, s32, s29
    s_add_u32 s33, s32, 4096
    buffer_load_dwordx4 v[144:147], v1, s[4:7], s32 offen offset:0 sc1
    buffer_load_dwordx4 v[148:151], v1, s[4:7], s32 offen offset:1024 sc1
    buffer_load_dwordx4 v[152:155], v1, s[4:7], s32 offen offset:2048 sc1
    buffer_load_dwordx4 v[156:159], v1, s[4:7], s32 offen offset:3072 sc1
    buffer_load_dwordx4 v[160:163], v1, s[4:7], s33 offen offset:0 sc1
    buffer_load_dwordx4 v[164:167], v1, s[4:7], s33 offen offset:1024 sc1
    buffer_load_dwordx4 v[168:171], v1, s[4:7], s33 offen offset:2048 sc1
    buffer_load_dwordx4 v[172:175], v1, s[4:7], s33 offen offset:3072 sc1
    s_mov_b32 s32, 2
    s_lshl_b32 s32, s32, 13
    s_add_u32 s32, s32, s29
    s_add_u32 s33, s32, 4096
    buffer_load_dwordx2 v[176:177], v7, s[4:7], s32 offen offset:0 sc1
    buffer_load_dwordx2 v[178:179], v7, s[4:7], s32 offen offset:128 sc1
    buffer_load_dwordx2 v[180:181], v7, s[4:7], s32 offen offset:1024 sc1
    buffer_load_dwordx2 v[182:183], v7, s[4:7], s32 offen offset:1152 sc1
    s_lshl_b32 s42, s23, 3
    s_add_u32 s42, s42, s24
    s_lshl_b32 s42, s42, 2
    s_add_u32 s42, s42, s20
    s_lshl_b32 s42, s42, 8
    s_add_u32 s42, s42, s21
    s_add_u32 s42, s42, 0x1b40000
    v_mov_b32 v220, -1.0
    v_lshrrev_b32 v221, 2, v1
    buffer_store_dword v220, v221, s[4:7], s42 offen sc1
    s_lshl_b32 s50, s22, 7
    s_add_u32 s50, s50, s44
    s_lshl_b32 s50, s50, 8
    s_add_u32 s50, s50, 0x4509000
    s_add_u32 s50, s50, s4
    s_addc_u32 s51, s5, 0
    s_waitcnt vmcnt(21)
    v_lshlrev_b32 v16, 16, v208
    v_and_b32 v17, 0xffff0000, v208
    v_lshlrev_b32 v18, 16, v209
    v_and_b32 v19, 0xffff0000, v209
    v_lshlrev_b32 v20, 16, v210
    v_and_b32 v21, 0xffff0000, v210
    v_lshlrev_b32 v22, 16, v211
    v_and_b32 v23, 0xffff0000, v211
    v_lshlrev_b32 v24, 16, v212
    v_and_b32 v25, 0xffff0000, v212
    v_lshlrev_b32 v26, 16, v213
    v_and_b32 v27, 0xffff0000, v213
    v_lshlrev_b32 v28, 16, v214
    v_and_b32 v29, 0xffff0000, v214
    v_lshlrev_b32 v30, 16, v215
    v_and_b32 v31, 0xffff0000, v215
    v_lshlrev_b32 v32, 16, v216
    v_and_b32 v33, 0xffff0000, v216
    v_lshlrev_b32 v34, 16, v217
    v_and_b32 v35, 0xffff0000, v217
    s_waitcnt vmcnt(19) lgkmcnt(4)
    v_mfma_f32_16x16x32_bf16 v[16:19], v[40:43], v[112:115], v[16:19]
    ds_read_b128 v[76:79], v12 offset:27648
    v_mfma_f32_16x16x32_bf16 v[20:23], v[44:47], v[112:115], v[20:23]
    ds_read_b128 v[80:83], v12 offset:28672
    v_mfma_f32_16x16x32_bf16 v[24:27], v[48:51], v[112:115], v[24:27]
    ds_read_b128 v[84:87], v12 offset:29696
    v_mfma_f32_16x16x32_bf16 v[28:31], v[52:55], v[112:115], v[28:31]
    ds_read_b128 v[88:91], v12 offset:30720
    v_mfma_f32_16x16x32_bf16 v[32:35], v[72:75], v[112:115], v[32:35]
    ds_read_b128 v[108:111], v12 offset:35840
    s_waitcnt lgkmcnt(5)
    v_mfma_f32_16x16x32_bf16 v[16:19], v[56:59], v[116:119], v[16:19]
    ds_read_b128 v[92:95], v12 offset:31744
    v_mfma_f32_16x16x32_bf16 v[20:23], v[60:63], v[116:119], v[20:23]
    ds_read_b128 v[96:99], v12 offset:32768
    v_mfma_f32_16x16x32_bf16 v[24:27], v[64:67], v[116:119], v[24:27]
    ds_read_b128 v[100:103], v12 offset:33792
    v_mfma_f32_16x16x32_bf16 v[28:31], v[68:71], v[116:119], v[28:31]
    ds_read_b128 v[104:107], v12 offset:34816
    v_mfma_f32_16x16x32_bf16 v[36:39], v[72:75], v[116:119], 0
    s_waitcnt vmcnt(17) lgkmcnt(4)
    v_mfma_f32_16x16x32_bf16 v[16:19], v[76:79], v[120:123], v[16:19]
    ds_read_b128 v[40:43], v13 offset:18432
    v_mfma_f32_16x16x32_bf16 v[20:23], v[80:83], v[120:123], v[20:23]
    ds_read_b128 v[44:47], v13 offset:19456
    v_mfma_f32_16x16x32_bf16 v[24:27], v[84:87], v[120:123], v[24:27]
    ds_read_b128 v[48:51], v13 offset:20480
    v_mfma_f32_16x16x32_bf16 v[28:31], v[88:91], v[120:123], v[28:31]
    ds_read_b128 v[52:55], v13 offset:21504
    v_mfma_f32_16x16x32_bf16 v[32:35], v[108:111], v[120:123], v[32:35]
    ds_read_b128 v[72:75], v13 offset:26624
    s_waitcnt lgkmcnt(5)
    v_mfma_f32_16x16x32_bf16 v[16:19], v[92:95], v[124:127], v[16:19]
    ds_read_b128 v[56:59], v13 offset:22528
    v_mfma_f32_16x16x32_bf16 v[20:23], v[96:99], v[124:127], v[20:23]
    ds_read_b128 v[60:63], v13 offset:23552
    v_mfma_f32_16x16x32_bf16 v[24:27], v[100:103], v[124:127], v[24:27]
    ds_read_b128 v[64:67], v13 offset:24576
    v_mfma_f32_16x16x32_bf16 v[28:31], v[104:107], v[124:127], v[28:31]
    ds_read_b128 v[68:71], v13 offset:25600
    v_mfma_f32_16x16x32_bf16 v[36:39], v[108:111], v[124:127], v[36:39]
    s_waitcnt vmcnt(15) lgkmcnt(4)
    v_mfma_f32_16x16x32_bf16 v[16:19], v[40:43], v[128:131], v[16:19]
    ds_read_b128 v[76:79], v13 offset:27648
    v_mfma_f32_16x16x32_bf16 v[20:23], v[44:47], v[128:131], v[20:23]
    ds_read_b128 v[80:83], v13 offset:28672
    v_mfma_f32_16x16x32_bf16 v[24:27], v[48:51], v[128:131], v[24:27]
    ds_read_b128 v[84:87], v13 offset:29696
    v_mfma_f32_16x16x32_bf16 v[28:31], v[52:55], v[128:131], v[28:31]
    ds_read_b128 v[88:91], v13 offset:30720
    v_mfma_f32_16x16x32_bf16 v[32:35], v[72:75], v[128:131], v[32:35]
    ds_read_b128 v[108:111], v13 offset:35840
    s_waitcnt lgkmcnt(5)
    v_mfma_f32_16x16x32_bf16 v[16:19], v[56:59], v[132:135], v[16:19]
    ds_read_b128 v[92:95], v13 offset:31744
    v_mfma_f32_16x16x32_bf16 v[20:23], v[60:63], v[132:135], v[20:23]
    ds_read_b128 v[96:99], v13 offset:32768
    v_mfma_f32_16x16x32_bf16 v[24:27], v[64:67], v[132:135], v[24:27]
    ds_read_b128 v[100:103], v13 offset:33792
    v_mfma_f32_16x16x32_bf16 v[28:31], v[68:71], v[132:135], v[28:31]
    ds_read_b128 v[104:107], v13 offset:34816
    v_mfma_f32_16x16x32_bf16 v[36:39], v[72:75], v[132:135], v[36:39]
    s_waitcnt vmcnt(13) lgkmcnt(4)
    v_mfma_f32_16x16x32_bf16 v[16:19], v[76:79], v[136:139], v[16:19]
    ds_read_b128 v[40:43], v14 offset:18432
    v_mfma_f32_16x16x32_bf16 v[20:23], v[80:83], v[136:139], v[20:23]
    ds_read_b128 v[44:47], v14 offset:19456
    v_mfma_f32_16x16x32_bf16 v[24:27], v[84:87], v[136:139], v[24:27]
    ds_read_b128 v[48:51], v14 offset:20480
    v_mfma_f32_16x16x32_bf16 v[28:31], v[88:91], v[136:139], v[28:31]
    ds_read_b128 v[52:55], v14 offset:21504
    v_mfma_f32_16x16x32_bf16 v[32:35], v[108:111], v[136:139], v[32:35]
    ds_read_b128 v[72:75], v14 offset:26624
    s_waitcnt lgkmcnt(5)
    v_mfma_f32_16x16x32_bf16 v[16:19], v[92:95], v[140:143], v[16:19]
    ds_read_b128 v[56:59], v14 offset:22528
    v_mfma_f32_16x16x32_bf16 v[20:23], v[96:99], v[140:143], v[20:23]
    ds_read_b128 v[60:63], v14 offset:23552
    v_mfma_f32_16x16x32_bf16 v[24:27], v[100:103], v[140:143], v[24:27]
    ds_read_b128 v[64:67], v14 offset:24576
    v_mfma_f32_16x16x32_bf16 v[28:31], v[104:107], v[140:143], v[28:31]
    ds_read_b128 v[68:71], v14 offset:25600
    v_mfma_f32_16x16x32_bf16 v[36:39], v[108:111], v[140:143], v[36:39]
    s_waitcnt vmcnt(11) lgkmcnt(4)
    v_mfma_f32_16x16x32_bf16 v[16:19], v[40:43], v[144:147], v[16:19]
    ds_read_b128 v[76:79], v14 offset:27648
    v_mfma_f32_16x16x32_bf16 v[20:23], v[44:47], v[144:147], v[20:23]
    ds_read_b128 v[80:83], v14 offset:28672
    v_mfma_f32_16x16x32_bf16 v[24:27], v[48:51], v[144:147], v[24:27]
    ds_read_b128 v[84:87], v14 offset:29696
    v_mfma_f32_16x16x32_bf16 v[28:31], v[52:55], v[144:147], v[28:31]
    ds_read_b128 v[88:91], v14 offset:30720
    v_mfma_f32_16x16x32_bf16 v[32:35], v[72:75], v[144:147], v[32:35]
    ds_read_b128 v[108:111], v14 offset:35840
    s_waitcnt lgkmcnt(5)
    v_mfma_f32_16x16x32_bf16 v[16:19], v[56:59], v[148:151], v[16:19]
    ds_read_b128 v[92:95], v14 offset:31744
    v_mfma_f32_16x16x32_bf16 v[20:23], v[60:63], v[148:151], v[20:23]
    ds_read_b128 v[96:99], v14 offset:32768
    v_mfma_f32_16x16x32_bf16 v[24:27], v[64:67], v[148:151], v[24:27]
    ds_read_b128 v[100:103], v14 offset:33792
    v_mfma_f32_16x16x32_bf16 v[28:31], v[68:71], v[148:151], v[28:31]
    ds_read_b128 v[104:107], v14 offset:34816
    v_mfma_f32_16x16x32_bf16 v[36:39], v[72:75], v[148:151], v[36:39]
    s_waitcnt vmcnt(9) lgkmcnt(4)
    v_mfma_f32_16x16x32_bf16 v[16:19], v[76:79], v[152:155], v[16:19]
    ds_read_b128 v[40:43], v15 offset:18432
    v_mfma_f32_16x16x32_bf16 v[20:23], v[80:83], v[152:155], v[20:23]
    ds_read_b128 v[44:47], v15 offset:19456
    v_mfma_f32_16x16x32_bf16 v[24:27], v[84:87], v[152:155], v[24:27]
    ds_read_b128 v[48:51], v15 offset:20480
    v_mfma_f32_16x16x32_bf16 v[28:31], v[88:91], v[152:155], v[28:31]
    ds_read_b128 v[52:55], v15 offset:21504
    v_mfma_f32_16x16x32_bf16 v[32:35], v[108:111], v[152:155], v[32:35]
    ds_read_b128 v[72:75], v15 offset:26624
    s_waitcnt lgkmcnt(5)
    v_mfma_f32_16x16x32_bf16 v[16:19], v[92:95], v[156:159], v[16:19]
    ds_read_b128 v[56:59], v15 offset:22528
    v_mfma_f32_16x16x32_bf16 v[20:23], v[96:99], v[156:159], v[20:23]
    ds_read_b128 v[60:63], v15 offset:23552
    v_mfma_f32_16x16x32_bf16 v[24:27], v[100:103], v[156:159], v[24:27]
    ds_read_b128 v[64:67], v15 offset:24576
    v_mfma_f32_16x16x32_bf16 v[28:31], v[104:107], v[156:159], v[28:31]
    ds_read_b128 v[68:71], v15 offset:25600
    v_mfma_f32_16x16x32_bf16 v[36:39], v[108:111], v[156:159], v[36:39]
    s_waitcnt vmcnt(7) lgkmcnt(4)
    v_mfma_f32_16x16x32_bf16 v[16:19], v[40:43], v[160:163], v[16:19]
    ds_read_b128 v[76:79], v15 offset:27648
    v_mfma_f32_16x16x32_bf16 v[20:23], v[44:47], v[160:163], v[20:23]
    ds_read_b128 v[80:83], v15 offset:28672
    v_mfma_f32_16x16x32_bf16 v[24:27], v[48:51], v[160:163], v[24:27]
    ds_read_b128 v[84:87], v15 offset:29696
    v_mfma_f32_16x16x32_bf16 v[28:31], v[52:55], v[160:163], v[28:31]
    ds_read_b128 v[88:91], v15 offset:30720
    v_mfma_f32_16x16x32_bf16 v[32:35], v[72:75], v[160:163], v[32:35]
    ds_read_b128 v[108:111], v15 offset:35840
    s_waitcnt lgkmcnt(5)
    v_mfma_f32_16x16x32_bf16 v[16:19], v[56:59], v[164:167], v[16:19]
    ds_read_b128 v[92:95], v15 offset:31744
    v_mfma_f32_16x16x32_bf16 v[20:23], v[60:63], v[164:167], v[20:23]
    ds_read_b128 v[96:99], v15 offset:32768
    v_mfma_f32_16x16x32_bf16 v[24:27], v[64:67], v[164:167], v[24:27]
    ds_read_b128 v[100:103], v15 offset:33792
    v_mfma_f32_16x16x32_bf16 v[28:31], v[68:71], v[164:167], v[28:31]
    ds_read_b128 v[104:107], v15 offset:34816
    v_mfma_f32_16x16x32_bf16 v[36:39], v[72:75], v[164:167], v[36:39]
    s_waitcnt vmcnt(5) lgkmcnt(4)
    v_mfma_f32_16x16x32_bf16 v[16:19], v[76:79], v[168:171], v[16:19]
    ds_read_b128 v[40:43], v15 offset:36864
    v_mfma_f32_16x16x32_bf16 v[20:23], v[80:83], v[168:171], v[20:23]
    ds_read_b128 v[44:47], v15 offset:37888
    v_mfma_f32_16x16x32_bf16 v[24:27], v[84:87], v[168:171], v[24:27]
    ds_read_b128 v[48:51], v15 offset:38912
    v_mfma_f32_16x16x32_bf16 v[28:31], v[88:91], v[168:171], v[28:31]
    ds_read_b128 v[52:55], v15 offset:39936
    v_mfma_f32_16x16x32_bf16 v[32:35], v[108:111], v[168:171], v[32:35]
    ds_read_b128 v[72:75], v15 offset:45056
    s_waitcnt lgkmcnt(5)
    v_mfma_f32_16x16x32_bf16 v[16:19], v[92:95], v[172:175], v[16:19]
    ds_read_b128 v[56:59], v15 offset:40960
    v_mfma_f32_16x16x32_bf16 v[20:23], v[96:99], v[172:175], v[20:23]
    ds_read_b128 v[60:63], v15 offset:41984
    v_mfma_f32_16x16x32_bf16 v[24:27], v[100:103], v[172:175], v[24:27]
    ds_read_b128 v[64:67], v15 offset:43008
    v_mfma_f32_16x16x32_bf16 v[28:31], v[104:107], v[172:175], v[28:31]
    ds_read_b128 v[68:71], v15 offset:44032
    v_mfma_f32_16x16x32_bf16 v[36:39], v[108:111], v[172:175], v[36:39]
    s_waitcnt vmcnt(1) lgkmcnt(4)
    v_mfma_f32_16x16x32_bf16 v[16:19], v[40:43], v[176:179], v[16:19]
    v_mfma_f32_16x16x32_bf16 v[20:23], v[44:47], v[176:179], v[20:23]
    v_mfma_f32_16x16x32_bf16 v[24:27], v[48:51], v[176:179], v[24:27]
    v_mfma_f32_16x16x32_bf16 v[28:31], v[52:55], v[176:179], v[28:31]
    v_mfma_f32_16x16x32_bf16 v[32:35], v[72:75], v[176:179], v[32:35]
    s_waitcnt lgkmcnt(0)
    v_mfma_f32_16x16x32_bf16 v[16:19], v[56:59], v[180:183], v[16:19]
    v_mfma_f32_16x16x32_bf16 v[20:23], v[60:63], v[180:183], v[20:23]
    v_mfma_f32_16x16x32_bf16 v[24:27], v[64:67], v[180:183], v[24:27]
    v_mfma_f32_16x16x32_bf16 v[28:31], v[68:71], v[180:183], v[28:31]
    v_mfma_f32_16x16x32_bf16 v[36:39], v[72:75], v[180:183], v[36:39]
    s_nop 3
    v_cvt_pk_bf16_f32 v208, v16, v17
    v_cvt_pk_bf16_f32 v209, v18, v19
    v_cvt_pk_bf16_f32 v210, v20, v21
    v_cvt_pk_bf16_f32 v211, v22, v23
    v_cvt_pk_bf16_f32 v212, v24, v25
    v_cvt_pk_bf16_f32 v213, v26, v27
    v_cvt_pk_bf16_f32 v214, v28, v29
    v_cvt_pk_bf16_f32 v215, v30, v31
    buffer_store_dwordx4 v[208:211], v4, s[4:7], s34 offen offset:0 sc1
    buffer_store_dwordx4 v[212:215], v4, s[4:7], s34 offen offset:1024 sc1
    v_permlane32_swap_b32 v36, v220
    v_permlane32_swap_b32 v37, v221
    v_permlane32_swap_b32 v38, v222
    v_permlane32_swap_b32 v39, v223
    v_pk_add_f32 v[32:33], v[32:33], v[220:221]
    v_pk_add_f32 v[34:35], v[34:35], v[222:223]
    v_cvt_pk_bf16_f32 v216, v32, v33
    v_cvt_pk_bf16_f32 v217, v34, v35
    buffer_store_dwordx2 v[216:217], v5, s[4:7], s34 offen sc1
    v_cndmask_b32 v222, 0, v216, s[40:41]
    v_cndmask_b32 v223, 0, v217, s[40:41]
    v_dot2_f32_bf16 v220, v208, v11, 0
    v_dot2_f32_bf16 v221, v208, v208, 0
    v_dot2_f32_bf16 v220, v209, v11, v220
    v_dot2_f32_bf16 v221, v209, v209, v221
    v_dot2_f32_bf16 v220, v210, v11, v220
    v_dot2_f32_bf16 v221, v210, v210, v221
    v_dot2_f32_bf16 v220, v211, v11, v220
    v_dot2_f32_bf16 v221, v211, v211, v221
    v_dot2_f32_bf16 v220, v212, v11, v220
    v_dot2_f32_bf16 v221, v212, v212, v221
    v_dot2_f32_bf16 v220, v213, v11, v220
    v_dot2_f32_bf16 v221, v213, v213, v221
    v_dot2_f32_bf16 v220, v214, v11, v220
    v_dot2_f32_bf16 v221, v214, v214, v221
    v_dot2_f32_bf16 v220, v215, v11, v220
    v_dot2_f32_bf16 v221, v215, v215, v221
    v_dot2_f32_bf16 v220, v222, v11, v220
    v_dot2_f32_bf16 v221, v222, v222, v221
    v_dot2_f32_bf16 v220, v223, v11, v220
    v_dot2_f32_bf16 v221, v223, v223, v221
    s_nop 2
    v_mov_b32 v222, v220
    v_mov_b32 v223, v221
    s_nop 1
    v_permlane32_swap_b32 v220, v222
    v_permlane32_swap_b32 v221, v223
    v_add_f32 v220, v220, v222
    v_add_f32 v221, v221, v223
    v_mov_b32 v222, v220
    v_mov_b32 v223, v221
    s_nop 1
    v_permlane16_swap_b32 v220, v222
    v_permlane16_swap_b32 v221, v223
    v_add_f32 v220, v220, v222
    v_add_f32 v221, v221, v223
    buffer_store_dwordx2 v[220:221], v10, s[4:7], s39 offen sc1
    s_and_b32 s25, s2, 7
    s_lshr_b32 s26, s2, 3
    s_and_b32 s23, s25, 1
    s_lshl_b32 s23, s23, 3
    s_and_b32 s27, s26, 7
    s_add_u32 s23, s23, s27
    s_lshr_b32 s24, s25, 1
    s_lshl_b32 s24, s24, 2
    s_lshr_b32 s27, s26, 3
    s_add_u32 s24, s24, s27
    s_add_u32 s28, s23, s24
    s_and_b32 s28, s28, 3
    s_lshl_b32 s30, s20, 12
    s_lshl_b32 s31, s23, 3
    s_lshl_b32 s33, s20, 1
    s_add_u32 s31, s31, s33
    s_lshl_b32 s32, s31, 10
    s_add_u32 s32, s32, s21
    s_add_u32 s32, s32, 0x1b20000
    v_add_u32 v2, 73728, v1
    s_add_u32 s33, s30, 18432
    v_add_u32 v3, s33, v1
    v_add_u32 v0, s33, v2
    s_lshr_b32 s34, s31, 1
    s_lshl_b32 s35, s34, 12
    s_add_u32 s35, s35, s21
    s_add_u32 s35, s35, 0x1b40000
    s_lshl_b32 s36, s24, 8
    s_add_u32 s36, s36, s35
    s_lshl_b32 s38, s24, 6
    s_add_u32 s38, s38, s34
    s_mul_i32 s38, s38, 9216
    s_add_u32 s38, s38, s21
    s_add_u32 s38, s38, 0x900000
    s_add_u32 s39, s38, 4096
    s_add_u32 s46, s38, 8192
    s_mov_b32 s40, 0xc0135761
    s_mov_b32 s42, 0x3d372713
    s_mov_b32 s44, 0x39e38e39
    s_mov_b32 s45, 0x3727c5ac
    v_lshrrev_b32 v4, 1, v1
    s_lshl_b32 s52, s22, 7
    s_add_u32 s52, s52, s23
    s_lshl_b32 s52, s52, 8
    s_add_u32 s52, s52, 0x4509000
    s_add_u32 s52, s52, s4
    s_addc_u32 s53, s5, 0
    s_waitcnt vmcnt(0)
    s_barrier
    s_cmp_lg_u32 s20, 0
    s_cbranch_scc1 L_ns_d3
    s_mov_b32 s56, 1
    s_atomic_add s56, s[50:51], 0
L_ns_d3:
    s_cmp_lg_u32 s20, 0
    s_cbranch_scc1 L_pd_d3
    s_mov_b32 s60, 65536
L_poll_d3:
    s_mov_b32 s57, 0
    s_atomic_add s57, s[52:53], 0 glc
    s_waitcnt lgkmcnt(0)
    s_cmp_ge_u32 s57, 16
    s_cbranch_scc1 L_pd_d3
    s_sub_u32 s60, s60, 1
    s_cbranch_scc1 L_pd_d3
    s_sleep 2
    s_branch L_poll_d3
L_pd_d3:
    s_barrier
    buffer_load_dwordx2 v[8:9], v4, s[4:7], s32 offen offset:0 sc1
    buffer_load_dwordx2 v[10:11], v4, s[4:7], s32 offen offset:512 sc1
    buffer_load_dwordx2 v[12:13], v4, s[4:7], s32 offen offset:1024 sc1
    buffer_load_dwordx2 v[14:15], v4, s[4:7], s32 offen offset:1536 sc1
    s_lshl_b32 s50, s22, 7
    s_add_u32 s50, s50, s23
    s_lshl_b32 s50, s50, 8
    s_add_u32 s50, s50, 0x450a000
    s_add_u32 s50, s50, s4
    s_addc_u32 s51, s5, 0
    s_barrier
    ds_read_b128 v[160:163], v3 offset:0
    ds_read_b128 v[164:167], v3 offset:2048
    ds_read_b128 v[168:171], v1 offset:0
    ds_read_b128 v[172:175], v1 offset:1024
    ds_read_b128 v[176:179], v1 offset:2048
    ds_read_b128 v[180:183], v1 offset:3072
    ds_read_b128 v[184:187], v1 offset:4096
    ds_read_b128 v[188:191], v1 offset:5120
    ds_read_b128 v[192:195], v1 offset:6144
    ds_read_b128 v[196:199], v1 offset:7168
    ds_read_b128 v[200:203], v1 offset:8192
    s_waitcnt lgkmcnt(5)
    v_mfma_f32_16x16x32_bf16 v[16:19], v[160:163], v[168:171], 0
    ds_read_b128 v[204:207], v3 offset:1024
    v_mfma_f32_16x16x32_bf16 v[20:23], v[164:167], v[168:171], 0
    ds_read_b128 v[208:211], v3 offset:3072
    v_mfma_f32_16x16x32_bf16 v[24:27], v[160:163], v[172:175], 0
    ds_read_b128 v[212:215], v1 offset:9216
    v_mfma_f32_16x16x32_bf16 v[28:31], v[164:167], v[172:175], 0
    ds_read_b128 v[216:219], v1 offset:10240
    v_mfma_f32_16x16x32_bf16 v[32:35], v[160:163], v[176:179], 0
    ds_read_b128 v[220:223], v1 offset:11264
    v_mfma_f32_16x16x32_bf16 v[36:39], v[164:167], v[176:179], 0
    ds_read_b128 v[224:227], v1 offset:12288
    v_mfma_f32_16x16x32_bf16 v[40:43], v[160:163], v[180:183], 0
    ds_read_b128 v[228:231], v1 offset:13312
    v_mfma_f32_16x16x32_bf16 v[44:47], v[164:167], v[180:183], 0
    ds_read_b128 v[232:235], v1 offset:14336
    s_waitcnt lgkmcnt(8)
    v_mfma_f32_16x16x32_bf16 v[48:51], v[160:163], v[184:187], 0
    ds_read_b128 v[236:239], v1 offset:15360
    v_mfma_f32_16x16x32_bf16 v[52:55], v[164:167], v[184:187], 0
    ds_read_b128 v[240:243], v1 offset:16384
    v_mfma_f32_16x16x32_bf16 v[56:59], v[160:163], v[188:191], 0
    ds_read_b128 v[244:247], v1 offset:17408
    v_mfma_f32_16x16x32_bf16 v[60:63], v[164:167], v[188:191], 0
    v_mfma_f32_16x16x32_bf16 v[64:67], v[160:163], v[192:195], 0
    v_mfma_f32_16x16x32_bf16 v[68:71], v[164:167], v[192:195], 0
    v_mfma_f32_16x16x32_bf16 v[72:75], v[160:163], v[196:199], 0
    v_mfma_f32_16x16x32_bf16 v[76:79], v[164:167], v[196:199], 0
    v_mfma_f32_16x16x32_bf16 v[80:83], v[160:163], v[200:203], 0
    v_mfma_f32_16x16x32_bf16 v[84:87], v[164:167], v[200:203], 0
    s_waitcnt lgkmcnt(0)
    s_barrier
    v_mfma_f32_16x16x32_bf16 v[16:19], v[204:207], v[212:215], v[16:19]
    ds_read_b128 v[160:163], v3 offset:36864
    v_mfma_f32_16x16x32_bf16 v[20:23], v[208:211], v[212:215], v[20:23]
    ds_read_b128 v[164:167], v3 offset:38912
    v_mfma_f32_16x16x32_bf16 v[24:27], v[204:207], v[216:219], v[24:27]
    ds_read_b128 v[168:171], v1 offset:36864
    v_mfma_f32_16x16x32_bf16 v[28:31], v[208:211], v[216:219], v[28:31]
    ds_read_b128 v[172:175], v1 offset:37888
    v_mfma_f32_16x16x32_bf16 v[32:35], v[204:207], v[220:223], v[32:35]
    ds_read_b128 v[176:179], v1 offset:38912
    v_mfma_f32_16x16x32_bf16 v[36:39], v[208:211], v[220:223], v[36:39]
    ds_read_b128 v[180:183], v1 offset:39936
    v_mfma_f32_16x16x32_bf16 v[40:43], v[204:207], v[224:227], v[40:43]
    ds_read_b128 v[184:187], v1 offset:40960
    v_mfma_f32_16x16x32_bf16 v[44:47], v[208:211], v[224:227], v[44:47]
    ds_read_b128 v[188:191], v1 offset:41984
    v_mfma_f32_16x16x32_bf16 v[48:51], v[204:207], v[228:231], v[48:51]
    ds_read_b128 v[192:195], v1 offset:43008
    v_mfma_f32_16x16x32_bf16 v[52:55], v[208:211], v[228:231], v[52:55]
    ds_read_b128 v[196:199], v1 offset:44032
    v_lshrrev_b32 v5, 8, v1
    v_mfma_f32_16x16x32_bf16 v[56:59], v[204:207], v[232:235], v[56:59]
    ds_read_b128 v[200:203], v1 offset:45056
    v_bfe_u32 v6, v1, 4, 4
    v_mfma_f32_16x16x32_bf16 v[60:63], v[208:211], v[232:235], v[60:63]
    v_lshlrev_b32 v7, 2, v6
    v_mfma_f32_16x16x32_bf16 v[64:67], v[204:207], v[236:239], v[64:67]
    s_lshl_b32 s33, s20, 8
    v_mfma_f32_16x16x32_bf16 v[68:71], v[208:211], v[236:239], v[68:71]
    s_add_u32 s33, s33, 147456
    v_mfma_f32_16x16x32_bf16 v[72:75], v[204:207], v[240:243], v[72:75]
    v_add_u32 v4, s33, v7
    v_mfma_f32_16x16x32_bf16 v[76:79], v[208:211], v[240:243], v[76:79]
    v_lshl_add_u32 v252, v5, 4, s33
    v_mfma_f32_16x16x32_bf16 v[80:83], v[204:207], v[244:247], v[80:83]
    v_add_u32 v7, 159744, v7
    v_mfma_f32_16x16x32_bf16 v[84:87], v[208:211], v[244:247], v[84:87]
    s_waitcnt vmcnt(0)
    v_add_f32 v248, v8, v10
    s_waitcnt lgkmcnt(5)
    v_mfma_f32_16x16x32_bf16 v[16:19], v[160:163], v[168:171], v[16:19]
    ds_read_b128 v[204:207], v3 offset:37888
    v_mfma_f32_16x16x32_bf16 v[20:23], v[164:167], v[168:171], v[20:23]
    ds_read_b128 v[208:211], v3 offset:39936
    v_mfma_f32_16x16x32_bf16 v[24:27], v[160:163], v[172:175], v[24:27]
    ds_read_b128 v[212:215], v1 offset:46080
    v_mfma_f32_16x16x32_bf16 v[28:31], v[164:167], v[172:175], v[28:31]
    ds_read_b128 v[216:219], v1 offset:47104
    v_mfma_f32_16x16x32_bf16 v[32:35], v[160:163], v[176:179], v[32:35]
    ds_read_b128 v[220:223], v1 offset:48128
    v_mfma_f32_16x16x32_bf16 v[36:39], v[164:167], v[176:179], v[36:39]
    ds_read_b128 v[224:227], v1 offset:49152
    v_mfma_f32_16x16x32_bf16 v[40:43], v[160:163], v[180:183], v[40:43]
    ds_read_b128 v[228:231], v1 offset:50176
    v_mfma_f32_16x16x32_bf16 v[44:47], v[164:167], v[180:183], v[44:47]
    ds_read_b128 v[232:235], v1 offset:51200
    s_waitcnt lgkmcnt(8)
    v_mfma_f32_16x16x32_bf16 v[48:51], v[160:163], v[184:187], v[48:51]
    ds_read_b128 v[236:239], v1 offset:52224
    v_mfma_f32_16x16x32_bf16 v[52:55], v[164:167], v[184:187], v[52:55]
    ds_read_b128 v[240:243], v1 offset:53248
    v_add_f32 v249, v9, v11
    v_mfma_f32_16x16x32_bf16 v[56:59], v[160:163], v[188:191], v[56:59]
    ds_read_b128 v[244:247], v1 offset:54272
    v_add_f32 v250, v12, v14
    v_mfma_f32_16x16x32_bf16 v[60:63], v[164:167], v[188:191], v[60:63]
    v_add_f32 v251, v13, v15
    v_mfma_f32_16x16x32_bf16 v[64:67], v[160:163], v[192:195], v[64:67]
    v_mov_b32 v8, v248
    v_mfma_f32_16x16x32_bf16 v[68:71], v[164:167], v[192:195], v[68:71]
    v_mov_b32 v9, v249
    v_mfma_f32_16x16x32_bf16 v[72:75], v[160:163], v[196:199], v[72:75]
    v_mov_b32 v12, v250
    v_mfma_f32_16x16x32_bf16 v[76:79], v[164:167], v[196:199], v[76:79]
    v_mov_b32 v13, v251
    v_mfma_f32_16x16x32_bf16 v[80:83], v[160:163], v[200:203], v[80:83]
    v_permlane32_swap_b32 v248, v8
    v_mfma_f32_16x16x32_bf16 v[84:87], v[164:167], v[200:203], v[84:87]
    v_permlane32_swap_b32 v249, v9
    v_permlane32_swap_b32 v250, v12
    s_waitcnt lgkmcnt(0)
    s_barrier
    v_mfma_f32_16x16x32_bf16 v[16:19], v[204:207], v[212:215], v[16:19]
    ds_read_b128 v[160:163], v0 offset:0
    v_mfma_f32_16x16x32_bf16 v[20:23], v[208:211], v[212:215], v[20:23]
    ds_read_b128 v[164:167], v0 offset:2048
    v_mfma_f32_16x16x32_bf16 v[24:27], v[204:207], v[216:219], v[24:27]
    ds_read_b128 v[168:171], v2 offset:0
    v_mfma_f32_16x16x32_bf16 v[28:31], v[208:211], v[216:219], v[28:31]
    ds_read_b128 v[172:175], v2 offset:1024
    v_mfma_f32_16x16x32_bf16 v[32:35], v[204:207], v[220:223], v[32:35]
    ds_read_b128 v[176:179], v2 offset:2048
    v_mfma_f32_16x16x32_bf16 v[36:39], v[208:211], v[220:223], v[36:39]
    ds_read_b128 v[180:183], v2 offset:3072
    v_mfma_f32_16x16x32_bf16 v[40:43], v[204:207], v[224:227], v[40:43]
    ds_read_b128 v[184:187], v2 offset:4096
    v_mfma_f32_16x16x32_bf16 v[44:47], v[208:211], v[224:227], v[44:47]
    ds_read_b128 v[188:191], v2 offset:5120
    v_mfma_f32_16x16x32_bf16 v[48:51], v[204:207], v[228:231], v[48:51]
    ds_read_b128 v[192:195], v2 offset:6144
    v_mfma_f32_16x16x32_bf16 v[52:55], v[208:211], v[228:231], v[52:55]
    ds_read_b128 v[196:199], v2 offset:7168
    v_permlane32_swap_b32 v251, v13
    v_mfma_f32_16x16x32_bf16 v[56:59], v[204:207], v[232:235], v[56:59]
    ds_read_b128 v[200:203], v2 offset:8192
    v_add_f32 v248, v248, v8
    v_mfma_f32_16x16x32_bf16 v[60:63], v[208:211], v[232:235], v[60:63]
    ds_read2_b32 v[128:129], v7 offset0:0 offset1:16
    v_add_f32 v249, v249, v9
    v_mfma_f32_16x16x32_bf16 v[64:67], v[204:207], v[236:239], v[64:67]
    ds_read2_b32 v[130:131], v7 offset0:32 offset1:48
    v_add_f32 v250, v250, v12
    v_mfma_f32_16x16x32_bf16 v[68:71], v[208:211], v[236:239], v[68:71]
    ds_read2_b32 v[132:133], v7 offset0:64 offset1:80
    v_add_f32 v251, v251, v13
    v_mfma_f32_16x16x32_bf16 v[72:75], v[204:207], v[240:243], v[72:75]
    ds_read2_b32 v[134:135], v7 offset0:96 offset1:112
    v_mov_b32 v8, v248
    v_mfma_f32_16x16x32_bf16 v[76:79], v[208:211], v[240:243], v[76:79]
    ds_read2_b32 v[136:137], v7 offset0:128 offset1:144
    v_mov_b32 v9, v249
    v_mfma_f32_16x16x32_bf16 v[80:83], v[204:207], v[244:247], v[80:83]
    v_mov_b32 v12, v250
    v_mfma_f32_16x16x32_bf16 v[84:87], v[208:211], v[244:247], v[84:87]
    v_mov_b32 v13, v251
    v_permlane16_swap_b32 v248, v8
    s_waitcnt lgkmcnt(10)
    v_mfma_f32_16x16x32_bf16 v[16:19], v[160:163], v[168:171], v[16:19]
    ds_read_b128 v[204:207], v0 offset:1024
    v_mfma_f32_16x16x32_bf16 v[20:23], v[164:167], v[168:171], v[20:23]
    ds_read_b128 v[208:211], v0 offset:3072
    v_mfma_f32_16x16x32_bf16 v[24:27], v[160:163], v[172:175], v[24:27]
    ds_read_b128 v[212:215], v2 offset:9216
    v_mfma_f32_16x16x32_bf16 v[28:31], v[164:167], v[172:175], v[28:31]
    ds_read_b128 v[216:219], v2 offset:10240
    v_mfma_f32_16x16x32_bf16 v[32:35], v[160:163], v[176:179], v[32:35]
    ds_read_b128 v[220:223], v2 offset:11264
    v_mfma_f32_16x16x32_bf16 v[36:39], v[164:167], v[176:179], v[36:39]
    ds_read_b128 v[224:227], v2 offset:12288
    v_mfma_f32_16x16x32_bf16 v[40:43], v[160:163], v[180:183], v[40:43]
    ds_read_b128 v[228:231], v2 offset:13312
    v_mfma_f32_16x16x32_bf16 v[44:47], v[164:167], v[180:183], v[44:47]
    ds_read_b128 v[232:235], v2 offset:14336
    s_waitcnt lgkmcnt(8)
    v_mfma_f32_16x16x32_bf16 v[48:51], v[160:163], v[184:187], v[48:51]
    ds_read_b128 v[236:239], v2 offset:15360
    v_mfma_f32_16x16x32_bf16 v[52:55], v[164:167], v[184:187], v[52:55]
    ds_read_b128 v[240:243], v2 offset:16384
    v_permlane16_swap_b32 v249, v9
    v_mfma_f32_16x16x32_bf16 v[56:59], v[160:163], v[188:191], v[56:59]
    ds_read_b128 v[244:247], v2 offset:17408
    v_permlane16_swap_b32 v250, v12
    v_mfma_f32_16x16x32_bf16 v[60:63], v[164:167], v[188:191], v[60:63]
    v_permlane16_swap_b32 v251, v13
    v_mfma_f32_16x16x32_bf16 v[64:67], v[160:163], v[192:195], v[64:67]
    v_add_f32 v248, v248, v8
    v_mfma_f32_16x16x32_bf16 v[68:71], v[164:167], v[192:195], v[68:71]
    v_add_f32 v249, v249, v9
    v_mfma_f32_16x16x32_bf16 v[72:75], v[160:163], v[196:199], v[72:75]
    v_add_f32 v250, v250, v12
    v_mfma_f32_16x16x32_bf16 v[76:79], v[164:167], v[196:199], v[76:79]
    v_add_f32 v251, v251, v13
    v_mfma_f32_16x16x32_bf16 v[80:83], v[160:163], v[200:203], v[80:83]
    v_mul_f32 v248, 0x3ae38e39, v248
    v_mfma_f32_16x16x32_bf16 v[84:87], v[164:167], v[200:203], v[84:87]
    v_mul_f32 v249, 0x3ae38e39, v249
    v_mul_f32 v250, 0x3ae38e39, v250
    s_waitcnt lgkmcnt(0)
    s_barrier
    v_mfma_f32_16x16x32_bf16 v[16:19], v[204:207], v[212:215], v[16:19]
    ds_read_b128 v[160:163], v0 offset:36864
    v_mfma_f32_16x16x32_bf16 v[20:23], v[208:211], v[212:215], v[20:23]
    ds_read_b128 v[164:167], v0 offset:38912
    v_mfma_f32_16x16x32_bf16 v[24:27], v[204:207], v[216:219], v[24:27]
    ds_read_b128 v[168:171], v2 offset:36864
    v_mfma_f32_16x16x32_bf16 v[28:31], v[208:211], v[216:219], v[28:31]
    ds_read_b128 v[172:175], v2 offset:37888
    v_mfma_f32_16x16x32_bf16 v[32:35], v[204:207], v[220:223], v[32:35]
    ds_read_b128 v[176:179], v2 offset:38912
    v_mfma_f32_16x16x32_bf16 v[36:39], v[208:211], v[220:223], v[36:39]
    ds_read_b128 v[180:183], v2 offset:39936
    v_mfma_f32_16x16x32_bf16 v[40:43], v[204:207], v[224:227], v[40:43]
    ds_read_b128 v[184:187], v2 offset:40960
    v_mfma_f32_16x16x32_bf16 v[44:47], v[208:211], v[224:227], v[44:47]
    ds_read_b128 v[188:191], v2 offset:41984
    v_mfma_f32_16x16x32_bf16 v[48:51], v[204:207], v[228:231], v[48:51]
    ds_read_b128 v[192:195], v2 offset:43008
    v_mfma_f32_16x16x32_bf16 v[52:55], v[208:211], v[228:231], v[52:55]
    ds_read_b128 v[196:199], v2 offset:44032
    v_mul_f32 v251, 0x3ae38e39, v251
    v_mfma_f32_16x16x32_bf16 v[56:59], v[204:207], v[232:235], v[56:59]
    ds_read_b128 v[200:203], v2 offset:45056
    v_fma_f32 v249, -v248, v248, v249
    v_mfma_f32_16x16x32_bf16 v[60:63], v[208:211], v[232:235], v[60:63]
    v_fma_f32 v251, -v250, v250, v251
    v_mfma_f32_16x16x32_bf16 v[64:67], v[204:207], v[236:239], v[64:67]
    v_max_f32 v249, 0, v249
    v_mfma_f32_16x16x32_bf16 v[68:71], v[208:211], v[236:239], v[68:71]
    v_max_f32 v251, 0, v251
    v_mfma_f32_16x16x32_bf16 v[72:75], v[204:207], v[240:243], v[72:75]
    v_add_f32 v249, 0x3727c5ac, v249
    v_mfma_f32_16x16x32_bf16 v[76:79], v[208:211], v[240:243], v[76:79]
    v_add_f32 v251, 0x3727c5ac, v251
    v_mfma_f32_16x16x32_bf16 v[80:83], v[204:207], v[244:247], v[80:83]
    v_rsq_f32 v249, v249
    v_mfma_f32_16x16x32_bf16 v[84:87], v[208:211], v[244:247], v[84:87]
    v_rsq_f32 v251, v251
    s_nop 0
    s_waitcnt lgkmcnt(5)
    v_mfma_f32_16x16x32_bf16 v[16:19], v[160:163], v[168:171], v[16:19]
    ds_read_b128 v[204:207], v0 offset:37888
    v_mfma_f32_16x16x32_bf16 v[20:23], v[164:167], v[168:171], v[20:23]
    ds_read_b128 v[208:211], v0 offset:39936
    v_mfma_f32_16x16x32_bf16 v[24:27], v[160:163], v[172:175], v[24:27]
    ds_read_b128 v[212:215], v2 offset:46080
    v_mfma_f32_16x16x32_bf16 v[28:31], v[164:167], v[172:175], v[28:31]
    ds_read_b128 v[216:219], v2 offset:47104
    v_mfma_f32_16x16x32_bf16 v[32:35], v[160:163], v[176:179], v[32:35]
    ds_read_b128 v[220:223], v2 offset:48128
    v_mfma_f32_16x16x32_bf16 v[36:39], v[164:167], v[176:179], v[36:39]
    ds_read_b128 v[224:227], v2 offset:49152
    v_mfma_f32_16x16x32_bf16 v[40:43], v[160:163], v[180:183], v[40:43]
    ds_read_b128 v[228:231], v2 offset:50176
    v_mfma_f32_16x16x32_bf16 v[44:47], v[164:167], v[180:183], v[44:47]
    ds_read_b128 v[232:235], v2 offset:51200
    s_waitcnt lgkmcnt(8)
    v_mfma_f32_16x16x32_bf16 v[48:51], v[160:163], v[184:187], v[48:51]
    ds_read_b128 v[236:239], v2 offset:52224
    v_mfma_f32_16x16x32_bf16 v[52:55], v[164:167], v[184:187], v[52:55]
    ds_read_b128 v[240:243], v2 offset:53248
    v_mfma_f32_16x16x32_bf16 v[56:59], v[160:163], v[188:191], v[56:59]
    ds_read_b128 v[244:247], v2 offset:54272
    v_mfma_f32_16x16x32_bf16 v[60:63], v[164:167], v[188:191], v[60:63]
    v_mfma_f32_16x16x32_bf16 v[64:67], v[160:163], v[192:195], v[64:67]
    v_mfma_f32_16x16x32_bf16 v[68:71], v[164:167], v[192:195], v[68:71]
    v_mfma_f32_16x16x32_bf16 v[72:75], v[160:163], v[196:199], v[72:75]
    v_mfma_f32_16x16x32_bf16 v[76:79], v[164:167], v[196:199], v[76:79]
    v_mfma_f32_16x16x32_bf16 v[80:83], v[160:163], v[200:203], v[80:83]
    v_mfma_f32_16x16x32_bf16 v[84:87], v[164:167], v[200:203], v[84:87]
    s_waitcnt lgkmcnt(0)
    s_barrier
    v_mfma_f32_16x16x32_bf16 v[16:19], v[204:207], v[212:215], v[16:19]
    ds_read_b128 v[160:163], v3 offset:0
    v_mfma_f32_16x16x32_bf16 v[20:23], v[208:211], v[212:215], v[20:23]
    ds_read_b128 v[164:167], v3 offset:2048
    v_mfma_f32_16x16x32_bf16 v[24:27], v[204:207], v[216:219], v[24:27]
    ds_read_b128 v[168:171], v1 offset:0
    v_mfma_f32_16x16x32_bf16 v[28:31], v[208:211], v[216:219], v[28:31]
    ds_read_b128 v[172:175], v1 offset:1024
    v_mfma_f32_16x16x32_bf16 v[32:35], v[204:207], v[220:223], v[32:35]
    ds_read_b128 v[176:179], v1 offset:2048
    v_mfma_f32_16x16x32_bf16 v[36:39], v[208:211], v[220:223], v[36:39]
    ds_read_b128 v[180:183], v1 offset:3072
    v_mfma_f32_16x16x32_bf16 v[40:43], v[204:207], v[224:227], v[40:43]
    ds_read_b128 v[184:187], v1 offset:4096
    v_mfma_f32_16x16x32_bf16 v[44:47], v[208:211], v[224:227], v[44:47]
    ds_read_b128 v[188:191], v1 offset:5120
    v_mfma_f32_16x16x32_bf16 v[48:51], v[204:207], v[228:231], v[48:51]
    ds_read_b128 v[192:195], v1 offset:6144
    v_mfma_f32_16x16x32_bf16 v[52:55], v[208:211], v[228:231], v[52:55]
    ds_read_b128 v[196:199], v1 offset:7168
    v_mfma_f32_16x16x32_bf16 v[56:59], v[204:207], v[232:235], v[56:59]
    ds_read_b128 v[200:203], v1 offset:8192
    v_mfma_f32_16x16x32_bf16 v[60:63], v[208:211], v[232:235], v[60:63]
    ds_write2_b32 v4, v248, v249 offset0:0 offset1:32
    v_mfma_f32_16x16x32_bf16 v[64:67], v[204:207], v[236:239], v[64:67]
    ds_write2_b32 v4, v250, v251 offset0:16 offset1:48
    v_mfma_f32_16x16x32_bf16 v[68:71], v[208:211], v[236:239], v[68:71]
    ds_read_b128 v[88:91], v252 offset:0
    v_mfma_f32_16x16x32_bf16 v[72:75], v[204:207], v[240:243], v[72:75]
    ds_read_b128 v[92:95], v252 offset:64
    v_mfma_f32_16x16x32_bf16 v[76:79], v[208:211], v[240:243], v[76:79]
    ds_read_b128 v[96:99], v252 offset:128
    v_mfma_f32_16x16x32_bf16 v[80:83], v[204:207], v[244:247], v[80:83]
    ds_read_b128 v[100:103], v252 offset:192
    v_mfma_f32_16x16x32_bf16 v[84:87], v[208:211], v[244:247], v[84:87]
    s_waitcnt lgkmcnt(11)
    v_mfma_f32_16x16x32_bf16 v[16:19], v[160:163], v[168:171], v[16:19]
    ds_read_b128 v[204:207], v3 offset:1024
    v_mfma_f32_16x16x32_bf16 v[20:23], v[164:167], v[168:171], v[20:23]
    ds_read_b128 v[208:211], v3 offset:3072
    v_mfma_f32_16x16x32_bf16 v[24:27], v[160:163], v[172:175], v[24:27]
    ds_read_b128 v[212:215], v1 offset:9216
    v_mfma_f32_16x16x32_bf16 v[28:31], v[164:167], v[172:175], v[28:31]
    ds_read_b128 v[216:219], v1 offset:10240
    v_mfma_f32_16x16x32_bf16 v[32:35], v[160:163], v[176:179], v[32:35]
    ds_read_b128 v[220:223], v1 offset:11264
    v_mfma_f32_16x16x32_bf16 v[36:39], v[164:167], v[176:179], v[36:39]
    ds_read_b128 v[224:227], v1 offset:12288
    v_mfma_f32_16x16x32_bf16 v[40:43], v[160:163], v[180:183], v[40:43]
    ds_read_b128 v[228:231], v1 offset:13312
    v_mfma_f32_16x16x32_bf16 v[44:47], v[164:167], v[180:183], v[44:47]
    ds_read_b128 v[232:235], v1 offset:14336
    s_waitcnt lgkmcnt(8)
    v_mfma_f32_16x16x32_bf16 v[48:51], v[160:163], v[184:187], v[48:51]
    ds_read_b128 v[236:239], v1 offset:15360
    v_mfma_f32_16x16x32_bf16 v[52:55], v[164:167], v[184:187], v[52:55]
    ds_read_b128 v[240:243], v1 offset:16384
    v_rcp_f32 v120, v96
    v_mfma_f32_16x16x32_bf16 v[56:59], v[160:163], v[188:191], v[56:59]
    ds_read_b128 v[244:247], v1 offset:17408
    v_mul_f32 v104, s40, v96
    v_mfma_f32_16x16x32_bf16 v[60:63], v[164:167], v[188:191], v[60:63]
    v_mul_f32 v112, v96, v96
    v_mfma_f32_16x16x32_bf16 v[64:67], v[160:163], v[192:195], v[64:67]
    v_rcp_f32 v121, v97
    v_mfma_f32_16x16x32_bf16 v[68:71], v[164:167], v[192:195], v[68:71]
    v_mul_f32 v105, s40, v97
    v_mfma_f32_16x16x32_bf16 v[72:75], v[160:163], v[196:199], v[72:75]
    v_mul_f32 v113, v97, v97
    v_mfma_f32_16x16x32_bf16 v[76:79], v[164:167], v[196:199], v[76:79]
    v_rcp_f32 v122, v98
    v_mfma_f32_16x16x32_bf16 v[80:83], v[160:163], v[200:203], v[80:83]
    v_mul_f32 v106, s40, v98
    v_mfma_f32_16x16x32_bf16 v[84:87], v[164:167], v[200:203], v[84:87]
    v_mul_f32 v114, v98, v98
    v_rcp_f32 v123, v99
    s_waitcnt lgkmcnt(0)
    s_barrier
    v_mfma_f32_16x16x32_bf16 v[16:19], v[204:207], v[212:215], v[16:19]
    ds_read_b128 v[160:163], v3 offset:36864
    v_mfma_f32_16x16x32_bf16 v[20:23], v[208:211], v[212:215], v[20:23]
    ds_read_b128 v[164:167], v3 offset:38912
    v_mfma_f32_16x16x32_bf16 v[24:27], v[204:207], v[216:219], v[24:27]
    ds_read_b128 v[168:171], v1 offset:36864
    v_mfma_f32_16x16x32_bf16 v[28:31], v[208:211], v[216:219], v[28:31]
    ds_read_b128 v[172:175], v1 offset:37888
    v_mfma_f32_16x16x32_bf16 v[32:35], v[204:207], v[220:223], v[32:35]
    ds_read_b128 v[176:179], v1 offset:38912
    v_mfma_f32_16x16x32_bf16 v[36:39], v[208:211], v[220:223], v[36:39]
    ds_read_b128 v[180:183], v1 offset:39936
    v_mfma_f32_16x16x32_bf16 v[40:43], v[204:207], v[224:227], v[40:43]
    ds_read_b128 v[184:187], v1 offset:40960
    v_mfma_f32_16x16x32_bf16 v[44:47], v[208:211], v[224:227], v[44:47]
    ds_read_b128 v[188:191], v1 offset:41984
    v_mfma_f32_16x16x32_bf16 v[48:51], v[204:207], v[228:231], v[48:51]
    ds_read_b128 v[192:195], v1 offset:43008
    v_mfma_f32_16x16x32_bf16 v[52:55], v[208:211], v[228:231], v[52:55]
    ds_read_b128 v[196:199], v1 offset:44032
    v_mul_f32 v107, s40, v99
    v_mfma_f32_16x16x32_bf16 v[56:59], v[204:207], v[232:235], v[56:59]
    ds_read_b128 v[200:203], v1 offset:45056
    v_mul_f32 v115, v99, v99
    v_mfma_f32_16x16x32_bf16 v[60:63], v[208:211], v[232:235], v[60:63]
    v_rcp_f32 v124, v100
    v_mfma_f32_16x16x32_bf16 v[64:67], v[204:207], v[236:239], v[64:67]
    v_mul_f32 v108, s40, v100
    v_mfma_f32_16x16x32_bf16 v[68:71], v[208:211], v[236:239], v[68:71]
    v_mul_f32 v116, v100, v100
    v_mfma_f32_16x16x32_bf16 v[72:75], v[204:207], v[240:243], v[72:75]
    v_rcp_f32 v125, v101
    v_mfma_f32_16x16x32_bf16 v[76:79], v[208:211], v[240:243], v[76:79]
    v_mul_f32 v109, s40, v101
    v_mfma_f32_16x16x32_bf16 v[80:83], v[204:207], v[244:247], v[80:83]
    v_mul_f32 v117, v101, v101
    v_mfma_f32_16x16x32_bf16 v[84:87], v[208:211], v[244:247], v[84:87]
    v_rcp_f32 v126, v102
    v_mul_f32 v110, s40, v102
    s_waitcnt lgkmcnt(5)
    v_mfma_f32_16x16x32_bf16 v[16:19], v[160:163], v[168:171], v[16:19]
    ds_read_b128 v[204:207], v3 offset:37888
    v_mfma_f32_16x16x32_bf16 v[20:23], v[164:167], v[168:171], v[20:23]
    ds_read_b128 v[208:211], v3 offset:39936
    v_mfma_f32_16x16x32_bf16 v[24:27], v[160:163], v[172:175], v[24:27]
    ds_read_b128 v[212:215], v1 offset:46080
    v_mfma_f32_16x16x32_bf16 v[28:31], v[164:167], v[172:175], v[28:31]
    ds_read_b128 v[216:219], v1 offset:47104
    v_mfma_f32_16x16x32_bf16 v[32:35], v[160:163], v[176:179], v[32:35]
    ds_read_b128 v[220:223], v1 offset:48128
    v_mfma_f32_16x16x32_bf16 v[36:39], v[164:167], v[176:179], v[36:39]
    ds_read_b128 v[224:227], v1 offset:49152
    v_mfma_f32_16x16x32_bf16 v[40:43], v[160:163], v[180:183], v[40:43]
    ds_read_b128 v[228:231], v1 offset:50176
    v_mfma_f32_16x16x32_bf16 v[44:47], v[164:167], v[180:183], v[44:47]
    ds_read_b128 v[232:235], v1 offset:51200
    s_waitcnt lgkmcnt(8)
    v_mfma_f32_16x16x32_bf16 v[48:51], v[160:163], v[184:187], v[48:51]
    ds_read_b128 v[236:239], v1 offset:52224
    v_mfma_f32_16x16x32_bf16 v[52:55], v[164:167], v[184:187], v[52:55]
    ds_read_b128 v[240:243], v1 offset:53248
    v_mul_f32 v118, v102, v102
    v_mfma_f32_16x16x32_bf16 v[56:59], v[160:163], v[188:191], v[56:59]
    ds_read_b128 v[244:247], v1 offset:54272
    v_rcp_f32 v127, v103
    v_mfma_f32_16x16x32_bf16 v[60:63], v[164:167], v[188:191], v[60:63]
    v_mul_f32 v111, s40, v103
    v_mfma_f32_16x16x32_bf16 v[64:67], v[160:163], v[192:195], v[64:67]
    v_mul_f32 v119, v103, v103
    v_mfma_f32_16x16x32_bf16 v[68:71], v[164:167], v[192:195], v[68:71]
    v_mul_f32 v112, s42, v112
    v_mfma_f32_16x16x32_bf16 v[72:75], v[160:163], v[196:199], v[72:75]
    v_mul_f32 v113, s42, v113
    v_mfma_f32_16x16x32_bf16 v[76:79], v[164:167], v[196:199], v[76:79]
    v_mul_f32 v114, s42, v114
    v_mfma_f32_16x16x32_bf16 v[80:83], v[160:163], v[200:203], v[80:83]
    v_mul_f32 v115, s42, v115
    v_mfma_f32_16x16x32_bf16 v[84:87], v[164:167], v[200:203], v[84:87]
    v_mul_f32 v116, s42, v116
    v_mul_f32 v117, s42, v117
    s_waitcnt lgkmcnt(0)
    s_barrier
    v_mfma_f32_16x16x32_bf16 v[16:19], v[204:207], v[212:215], v[16:19]
    ds_read_b128 v[160:163], v0 offset:0
    v_mfma_f32_16x16x32_bf16 v[20:23], v[208:211], v[212:215], v[20:23]
    ds_read_b128 v[164:167], v0 offset:2048
    v_mfma_f32_16x16x32_bf16 v[24:27], v[204:207], v[216:219], v[24:27]
    ds_read_b128 v[168:171], v2 offset:0
    v_mfma_f32_16x16x32_bf16 v[28:31], v[208:211], v[216:219], v[28:31]
    ds_read_b128 v[172:175], v2 offset:1024
    v_mfma_f32_16x16x32_bf16 v[32:35], v[204:207], v[220:223], v[32:35]
    ds_read_b128 v[176:179], v2 offset:2048
    v_mfma_f32_16x16x32_bf16 v[36:39], v[208:211], v[220:223], v[36:39]
    ds_read_b128 v[180:183], v2 offset:3072
    v_mfma_f32_16x16x32_bf16 v[40:43], v[204:207], v[224:227], v[40:43]
    ds_read_b128 v[184:187], v2 offset:4096
    v_mfma_f32_16x16x32_bf16 v[44:47], v[208:211], v[224:227], v[44:47]
    ds_read_b128 v[188:191], v2 offset:5120
    v_mfma_f32_16x16x32_bf16 v[48:51], v[204:207], v[228:231], v[48:51]
    ds_read_b128 v[192:195], v2 offset:6144
    v_mfma_f32_16x16x32_bf16 v[52:55], v[208:211], v[228:231], v[52:55]
    ds_read_b128 v[196:199], v2 offset:7168
    v_mul_f32 v118, s42, v118
    v_mfma_f32_16x16x32_bf16 v[56:59], v[204:207], v[232:235], v[56:59]
    ds_read_b128 v[200:203], v2 offset:8192
    v_mul_f32 v119, s42, v119
    v_mfma_f32_16x16x32_bf16 v[60:63], v[208:211], v[232:235], v[60:63]
    v_mul_f32 v112, v112, v104
    v_mfma_f32_16x16x32_bf16 v[64:67], v[204:207], v[236:239], v[64:67]
    v_mul_f32 v113, v113, v105
    v_mfma_f32_16x16x32_bf16 v[68:71], v[208:211], v[236:239], v[68:71]
    v_mul_f32 v114, v114, v106
    v_mfma_f32_16x16x32_bf16 v[72:75], v[204:207], v[240:243], v[72:75]
    v_mul_f32 v115, v115, v107
    v_mfma_f32_16x16x32_bf16 v[76:79], v[208:211], v[240:243], v[76:79]
    v_mul_f32 v116, v116, v108
    v_mfma_f32_16x16x32_bf16 v[80:83], v[204:207], v[244:247], v[80:83]
    v_mul_f32 v117, v117, v109
    v_mfma_f32_16x16x32_bf16 v[84:87], v[208:211], v[244:247], v[84:87]
    v_mul_f32 v118, v118, v110
    v_mul_f32 v119, v119, v111
    s_waitcnt lgkmcnt(5)
    v_mfma_f32_16x16x32_bf16 v[16:19], v[160:163], v[168:171], v[16:19]
    ds_read_b128 v[204:207], v0 offset:1024
    v_mfma_f32_16x16x32_bf16 v[20:23], v[164:167], v[168:171], v[20:23]
    ds_read_b128 v[208:211], v0 offset:3072
    v_mfma_f32_16x16x32_bf16 v[24:27], v[160:163], v[172:175], v[24:27]
    ds_read_b128 v[212:215], v2 offset:9216
    v_mfma_f32_16x16x32_bf16 v[28:31], v[164:167], v[172:175], v[28:31]
    ds_read_b128 v[216:219], v2 offset:10240
    v_mfma_f32_16x16x32_bf16 v[32:35], v[160:163], v[176:179], v[32:35]
    ds_read_b128 v[220:223], v2 offset:11264
    v_mfma_f32_16x16x32_bf16 v[36:39], v[164:167], v[176:179], v[36:39]
    ds_read_b128 v[224:227], v2 offset:12288
    v_mfma_f32_16x16x32_bf16 v[40:43], v[160:163], v[180:183], v[40:43]
    ds_read_b128 v[228:231], v2 offset:13312
    v_mfma_f32_16x16x32_bf16 v[44:47], v[164:167], v[180:183], v[44:47]
    ds_read_b128 v[232:235], v2 offset:14336
    s_waitcnt lgkmcnt(8)
    v_mfma_f32_16x16x32_bf16 v[48:51], v[160:163], v[184:187], v[48:51]
    ds_read_b128 v[236:239], v2 offset:15360
    v_mfma_f32_16x16x32_bf16 v[52:55], v[164:167], v[184:187], v[52:55]
    ds_read_b128 v[240:243], v2 offset:16384
    v_lshrrev_b32 v8, 2, v6
    v_mfma_f32_16x16x32_bf16 v[56:59], v[160:163], v[188:191], v[56:59]
    ds_read_b128 v[244:247], v2 offset:17408
    v_lshlrev_b32 v8, 4, v8
    v_mfma_f32_16x16x32_bf16 v[60:63], v[164:167], v[188:191], v[60:63]
    v_lshl_add_u32 v8, v5, 6, v8
    v_mfma_f32_16x16x32_bf16 v[64:67], v[160:163], v[192:195], v[64:67]
    v_and_b32 v9, 3, v6
    v_mfma_f32_16x16x32_bf16 v[68:71], v[164:167], v[192:195], v[68:71]
    v_cmp_eq_u32 vcc, 0, v9
    v_mfma_f32_16x16x32_bf16 v[72:75], v[160:163], v[196:199], v[72:75]
    v_bfrev_b32 v10, 1
    v_mfma_f32_16x16x32_bf16 v[76:79], v[164:167], v[196:199], v[76:79]
    v_lshlrev_b32 v9, 4, v9
    v_mfma_f32_16x16x32_bf16 v[80:83], v[160:163], v[200:203], v[80:83]
    v_cndmask_b32 v8, v10, v8, vcc
    v_mfma_f32_16x16x32_bf16 v[84:87], v[164:167], v[200:203], v[84:87]
    v_lshl_add_u32 v9, v5, 6, v9
    v_lshrrev_b32 v255, 2, v6
    s_waitcnt lgkmcnt(0)
    s_barrier
    v_mfma_f32_16x16x32_bf16 v[16:19], v[204:207], v[212:215], v[16:19]
    ds_read_b128 v[160:163], v0 offset:36864
    v_fma_f32 v52, -v92, v132, v52
    v_mfma_f32_16x16x32_bf16 v[20:23], v[208:211], v[212:215], v[20:23]
    ds_read_b128 v[164:167], v0 offset:38912
    v_fma_f32 v56, -v88, v133, v56
    v_mfma_f32_16x16x32_bf16 v[24:27], v[204:207], v[216:219], v[24:27]
    ds_read_b128 v[168:171], v2 offset:36864
    v_fma_f32 v60, -v92, v133, v60
    v_mfma_f32_16x16x32_bf16 v[28:31], v[208:211], v[216:219], v[28:31]
    ds_read_b128 v[172:175], v2 offset:37888
    v_fma_f32 v64, -v88, v134, v64
    v_mfma_f32_16x16x32_bf16 v[32:35], v[204:207], v[220:223], v[32:35]
    ds_read_b128 v[176:179], v2 offset:38912
    v_fma_f32 v68, -v92, v134, v68
    v_mfma_f32_16x16x32_bf16 v[36:39], v[208:211], v[220:223], v[36:39]
    ds_read_b128 v[180:183], v2 offset:39936
    v_fma_f32 v72, -v88, v135, v72
    v_mfma_f32_16x16x32_bf16 v[40:43], v[204:207], v[224:227], v[40:43]
    ds_read_b128 v[184:187], v2 offset:40960
    v_fma_f32 v76, -v92, v135, v76
    v_mfma_f32_16x16x32_bf16 v[44:47], v[208:211], v[224:227], v[44:47]
    ds_read_b128 v[188:191], v2 offset:41984
    v_fma_f32 v80, -v88, v136, v80
    v_mfma_f32_16x16x32_bf16 v[48:51], v[204:207], v[228:231], v[48:51]
    ds_read_b128 v[192:195], v2 offset:43008
    v_fma_f32 v84, -v92, v136, v84
    v_mfma_f32_16x16x32_bf16 v[52:55], v[208:211], v[228:231], v[52:55]
    ds_read_b128 v[196:199], v2 offset:44032
    v_lshl_add_u32 v255, v255, 8, v9
    v_fma_f32 v16, -v88, v128, v16
    v_mfma_f32_16x16x32_bf16 v[56:59], v[204:207], v[232:235], v[56:59]
    ds_read_b128 v[200:203], v2 offset:45056
    v_fma_f32 v20, -v92, v128, v20
    v_mfma_f32_16x16x32_bf16 v[60:63], v[208:211], v[232:235], v[60:63]
    v_fma_f32 v24, -v88, v129, v24
    v_mfma_f32_16x16x32_bf16 v[64:67], v[204:207], v[236:239], v[64:67]
    v_fma_f32 v28, -v92, v129, v28
    v_mfma_f32_16x16x32_bf16 v[68:71], v[208:211], v[236:239], v[68:71]
    v_fma_f32 v32, -v88, v130, v32
    v_mfma_f32_16x16x32_bf16 v[72:75], v[204:207], v[240:243], v[72:75]
    v_fma_f32 v36, -v92, v130, v36
    v_mfma_f32_16x16x32_bf16 v[76:79], v[208:211], v[240:243], v[76:79]
    v_fma_f32 v40, -v88, v131, v40
    v_mfma_f32_16x16x32_bf16 v[80:83], v[204:207], v[244:247], v[80:83]
    v_fma_f32 v44, -v92, v131, v44
    v_mfma_f32_16x16x32_bf16 v[84:87], v[208:211], v[244:247], v[84:87]
    v_fma_f32 v48, -v88, v132, v48
    s_waitcnt lgkmcnt(5)
    v_mfma_f32_16x16x32_bf16 v[16:19], v[160:163], v[168:171], v[16:19]
    ds_read_b128 v[204:207], v0 offset:37888
    v_fma_f32 v53, -v93, v132, v53
    v_mfma_f32_16x16x32_bf16 v[20:23], v[164:167], v[168:171], v[20:23]
    ds_read_b128 v[208:211], v0 offset:39936
    v_fma_f32 v57, -v89, v133, v57
    v_mfma_f32_16x16x32_bf16 v[24:27], v[160:163], v[172:175], v[24:27]
    ds_read_b128 v[212:215], v2 offset:46080
    v_fma_f32 v61, -v93, v133, v61
    v_mfma_f32_16x16x32_bf16 v[28:31], v[164:167], v[172:175], v[28:31]
    ds_read_b128 v[216:219], v2 offset:47104
    v_fma_f32 v65, -v89, v134, v65
    v_mfma_f32_16x16x32_bf16 v[32:35], v[160:163], v[176:179], v[32:35]
    ds_read_b128 v[220:223], v2 offset:48128
    v_fma_f32 v69, -v93, v134, v69
    v_mfma_f32_16x16x32_bf16 v[36:39], v[164:167], v[176:179], v[36:39]
    ds_read_b128 v[224:227], v2 offset:49152
    v_fma_f32 v73, -v89, v135, v73
    v_mfma_f32_16x16x32_bf16 v[40:43], v[160:163], v[180:183], v[40:43]
    ds_read_b128 v[228:231], v2 offset:50176
    v_fma_f32 v77, -v93, v135, v77
    v_mfma_f32_16x16x32_bf16 v[44:47], v[164:167], v[180:183], v[44:47]
    ds_read_b128 v[232:235], v2 offset:51200
    s_waitcnt lgkmcnt(8)
    v_fma_f32 v81, -v89, v136, v81
    v_mfma_f32_16x16x32_bf16 v[48:51], v[160:163], v[184:187], v[48:51]
    ds_read_b128 v[236:239], v2 offset:52224
    v_fma_f32 v85, -v93, v136, v85
    v_mfma_f32_16x16x32_bf16 v[52:55], v[164:167], v[184:187], v[52:55]
    ds_read_b128 v[240:243], v2 offset:53248
    v_fma_f32 v17, -v89, v128, v17
    v_mfma_f32_16x16x32_bf16 v[56:59], v[160:163], v[188:191], v[56:59]
    ds_read_b128 v[244:247], v2 offset:54272
    v_fma_f32 v21, -v93, v128, v21
    v_mfma_f32_16x16x32_bf16 v[60:63], v[164:167], v[188:191], v[60:63]
    v_fma_f32 v25, -v89, v129, v25
    v_mfma_f32_16x16x32_bf16 v[64:67], v[160:163], v[192:195], v[64:67]
    v_fma_f32 v29, -v93, v129, v29
    v_mfma_f32_16x16x32_bf16 v[68:71], v[164:167], v[192:195], v[68:71]
    v_fma_f32 v33, -v89, v130, v33
    v_mfma_f32_16x16x32_bf16 v[72:75], v[160:163], v[196:199], v[72:75]
    v_fma_f32 v37, -v93, v130, v37
    v_mfma_f32_16x16x32_bf16 v[76:79], v[164:167], v[196:199], v[76:79]
    v_fma_f32 v41, -v89, v131, v41
    v_mfma_f32_16x16x32_bf16 v[80:83], v[160:163], v[200:203], v[80:83]
    v_fma_f32 v45, -v93, v131, v45
    v_mfma_f32_16x16x32_bf16 v[84:87], v[164:167], v[200:203], v[84:87]
    v_fma_f32 v49, -v89, v132, v49
    s_waitcnt lgkmcnt(0)
    s_barrier
    v_mfma_f32_16x16x32_bf16 v[16:19], v[204:207], v[212:215], v[16:19]
    ds_read_b128 v[160:163], v3 offset:0
    v_fma_f32 v54, -v94, v132, v54
    v_mfma_f32_16x16x32_bf16 v[20:23], v[208:211], v[212:215], v[20:23]
    ds_read_b128 v[164:167], v3 offset:2048
    v_fma_f32 v58, -v90, v133, v58
    v_mfma_f32_16x16x32_bf16 v[24:27], v[204:207], v[216:219], v[24:27]
    ds_read_b128 v[168:171], v1 offset:0
    v_fma_f32 v62, -v94, v133, v62
    v_mfma_f32_16x16x32_bf16 v[28:31], v[208:211], v[216:219], v[28:31]
    ds_read_b128 v[172:175], v1 offset:1024
    v_fma_f32 v66, -v90, v134, v66
    v_mfma_f32_16x16x32_bf16 v[32:35], v[204:207], v[220:223], v[32:35]
    ds_read_b128 v[176:179], v1 offset:2048
    v_fma_f32 v70, -v94, v134, v70
    v_mfma_f32_16x16x32_bf16 v[36:39], v[208:211], v[220:223], v[36:39]
    ds_read_b128 v[180:183], v1 offset:3072
    v_fma_f32 v74, -v90, v135, v74
    v_mfma_f32_16x16x32_bf16 v[40:43], v[204:207], v[224:227], v[40:43]
    ds_read_b128 v[184:187], v1 offset:4096
    v_fma_f32 v78, -v94, v135, v78
    v_mfma_f32_16x16x32_bf16 v[44:47], v[208:211], v[224:227], v[44:47]
    ds_read_b128 v[188:191], v1 offset:5120
    v_fma_f32 v82, -v90, v136, v82
    v_mfma_f32_16x16x32_bf16 v[48:51], v[204:207], v[228:231], v[48:51]
    ds_read_b128 v[192:195], v1 offset:6144
    v_fma_f32 v86, -v94, v136, v86
    v_mfma_f32_16x16x32_bf16 v[52:55], v[208:211], v[228:231], v[52:55]
    ds_read_b128 v[196:199], v1 offset:7168
    v_fma_f32 v18, -v90, v128, v18
    v_mfma_f32_16x16x32_bf16 v[56:59], v[204:207], v[232:235], v[56:59]
    ds_read_b128 v[200:203], v1 offset:8192
    v_fma_f32 v22, -v94, v128, v22
    v_mfma_f32_16x16x32_bf16 v[60:63], v[208:211], v[232:235], v[60:63]
    v_fma_f32 v26, -v90, v129, v26
    v_mfma_f32_16x16x32_bf16 v[64:67], v[204:207], v[236:239], v[64:67]
    v_fma_f32 v30, -v94, v129, v30
    v_mfma_f32_16x16x32_bf16 v[68:71], v[208:211], v[236:239], v[68:71]
    v_fma_f32 v34, -v90, v130, v34
    v_mfma_f32_16x16x32_bf16 v[72:75], v[204:207], v[240:243], v[72:75]
    v_fma_f32 v38, -v94, v130, v38
    v_mfma_f32_16x16x32_bf16 v[76:79], v[208:211], v[240:243], v[76:79]
    v_fma_f32 v42, -v90, v131, v42
    v_mfma_f32_16x16x32_bf16 v[80:83], v[204:207], v[244:247], v[80:83]
    v_fma_f32 v46, -v94, v131, v46
    v_mfma_f32_16x16x32_bf16 v[84:87], v[208:211], v[244:247], v[84:87]
    v_fma_f32 v50, -v90, v132, v50
    s_waitcnt lgkmcnt(5)
    v_mfma_f32_16x16x32_bf16 v[16:19], v[160:163], v[168:171], v[16:19]
    ds_read_b128 v[204:207], v3 offset:1024
    v_fma_f32 v55, -v95, v132, v55
    v_mfma_f32_16x16x32_bf16 v[20:23], v[164:167], v[168:171], v[20:23]
    ds_read_b128 v[208:211], v3 offset:3072
    v_fma_f32 v59, -v91, v133, v59
    v_mfma_f32_16x16x32_bf16 v[24:27], v[160:163], v[172:175], v[24:27]
    ds_read_b128 v[212:215], v1 offset:9216
    v_fma_f32 v63, -v95, v133, v63
    v_mfma_f32_16x16x32_bf16 v[28:31], v[164:167], v[172:175], v[28:31]
    ds_read_b128 v[216:219], v1 offset:10240
    v_fma_f32 v67, -v91, v134, v67
    v_mfma_f32_16x16x32_bf16 v[32:35], v[160:163], v[176:179], v[32:35]
    ds_read_b128 v[220:223], v1 offset:11264
    v_fma_f32 v71, -v95, v134, v71
    v_mfma_f32_16x16x32_bf16 v[36:39], v[164:167], v[176:179], v[36:39]
    ds_read_b128 v[224:227], v1 offset:12288
    v_fma_f32 v75, -v91, v135, v75
    v_mfma_f32_16x16x32_bf16 v[40:43], v[160:163], v[180:183], v[40:43]
    ds_read_b128 v[228:231], v1 offset:13312
    v_fma_f32 v79, -v95, v135, v79
    v_mfma_f32_16x16x32_bf16 v[44:47], v[164:167], v[180:183], v[44:47]
    ds_read_b128 v[232:235], v1 offset:14336
    s_waitcnt lgkmcnt(8)
    v_fma_f32 v83, -v91, v136, v83
    v_mfma_f32_16x16x32_bf16 v[48:51], v[160:163], v[184:187], v[48:51]
    ds_read_b128 v[236:239], v1 offset:15360
    v_fma_f32 v87, -v95, v136, v87
    v_mfma_f32_16x16x32_bf16 v[52:55], v[164:167], v[184:187], v[52:55]
    ds_read_b128 v[240:243], v1 offset:16384
    v_fma_f32 v19, -v91, v128, v19
    v_mfma_f32_16x16x32_bf16 v[56:59], v[160:163], v[188:191], v[56:59]
    ds_read_b128 v[244:247], v1 offset:17408
    v_fma_f32 v23, -v95, v128, v23
    v_mfma_f32_16x16x32_bf16 v[60:63], v[164:167], v[188:191], v[60:63]
    v_fma_f32 v27, -v91, v129, v27
    v_mfma_f32_16x16x32_bf16 v[64:67], v[160:163], v[192:195], v[64:67]
    v_fma_f32 v31, -v95, v129, v31
    v_mfma_f32_16x16x32_bf16 v[68:71], v[164:167], v[192:195], v[68:71]
    v_fma_f32 v35, -v91, v130, v35
    v_mfma_f32_16x16x32_bf16 v[72:75], v[160:163], v[196:199], v[72:75]
    v_fma_f32 v39, -v95, v130, v39
    v_mfma_f32_16x16x32_bf16 v[76:79], v[164:167], v[196:199], v[76:79]
    v_fma_f32 v43, -v91, v131, v43
    v_mfma_f32_16x16x32_bf16 v[80:83], v[160:163], v[200:203], v[80:83]
    v_fma_f32 v47, -v95, v131, v47
    v_mfma_f32_16x16x32_bf16 v[84:87], v[164:167], v[200:203], v[84:87]
    v_fma_f32 v51, -v91, v132, v51
    s_waitcnt lgkmcnt(0)
    s_barrier
    v_mfma_f32_16x16x32_bf16 v[16:19], v[204:207], v[212:215], v[16:19]
    ds_read_b128 v[160:163], v3 offset:36864
    v_mfma_f32_16x16x32_bf16 v[20:23], v[208:211], v[212:215], v[20:23]
    ds_read_b128 v[164:167], v3 offset:38912
    v_mfma_f32_16x16x32_bf16 v[24:27], v[204:207], v[216:219], v[24:27]
    ds_read_b128 v[168:171], v1 offset:36864
    v_mfma_f32_16x16x32_bf16 v[28:31], v[208:211], v[216:219], v[28:31]
    ds_read_b128 v[172:175], v1 offset:37888
    v_mfma_f32_16x16x32_bf16 v[32:35], v[204:207], v[220:223], v[32:35]
    ds_read_b128 v[176:179], v1 offset:38912
    v_mfma_f32_16x16x32_bf16 v[36:39], v[208:211], v[220:223], v[36:39]
    ds_read_b128 v[180:183], v1 offset:39936
    v_mfma_f32_16x16x32_bf16 v[40:43], v[204:207], v[224:227], v[40:43]
    ds_read_b128 v[184:187], v1 offset:40960
    v_mfma_f32_16x16x32_bf16 v[44:47], v[208:211], v[224:227], v[44:47]
    ds_read_b128 v[188:191], v1 offset:41984
    v_mfma_f32_16x16x32_bf16 v[48:51], v[204:207], v[228:231], v[48:51]
    ds_read_b128 v[192:195], v1 offset:43008
    v_mfma_f32_16x16x32_bf16 v[52:55], v[208:211], v[228:231], v[52:55]
    ds_read_b128 v[196:199], v1 offset:44032
    v_mfma_f32_16x16x32_bf16 v[56:59], v[204:207], v[232:235], v[56:59]
    ds_read_b128 v[200:203], v1 offset:45056
    v_mfma_f32_16x16x32_bf16 v[60:63], v[208:211], v[232:235], v[60:63]
    v_mfma_f32_16x16x32_bf16 v[64:67], v[204:207], v[236:239], v[64:67]
    v_mfma_f32_16x16x32_bf16 v[68:71], v[208:211], v[236:239], v[68:71]
    v_mfma_f32_16x16x32_bf16 v[72:75], v[204:207], v[240:243], v[72:75]
    v_mfma_f32_16x16x32_bf16 v[76:79], v[208:211], v[240:243], v[76:79]
    v_mfma_f32_16x16x32_bf16 v[80:83], v[204:207], v[244:247], v[80:83]
    v_mfma_f32_16x16x32_bf16 v[84:87], v[208:211], v[244:247], v[84:87]
    v_pk_mul_f32 v[220:221], v[16:17], v[16:17]
    v_pk_mul_f32 v[222:223], v[18:19], v[18:19]
    v_pk_mul_f32 v[224:225], v[20:21], v[20:21]
    v_pk_mul_f32 v[226:227], v[22:23], v[22:23]
    v_pk_fma_f32 v[220:221], v[220:221], v[112:113], v[104:105]
    v_pk_fma_f32 v[222:223], v[222:223], v[114:115], v[106:107]
    v_pk_fma_f32 v[224:225], v[224:225], v[116:117], v[108:109]
    v_pk_fma_f32 v[226:227], v[226:227], v[118:119], v[110:111]
    v_pk_mul_f32 v[220:221], v[220:221], v[16:17]
    v_pk_mul_f32 v[222:223], v[222:223], v[18:19]
    v_pk_mul_f32 v[224:225], v[224:225], v[20:21]
    v_pk_mul_f32 v[226:227], v[226:227], v[22:23]
    v_exp_f32 v220, v220
    v_exp_f32 v221, v221
    v_exp_f32 v222, v222
    v_exp_f32 v223, v223
    v_exp_f32 v224, v224
    v_exp_f32 v225, v225
    v_exp_f32 v226, v226
    v_exp_f32 v227, v227
    v_pk_fma_f32 v[220:221], v[220:221], v[120:121], v[120:121]
    v_pk_fma_f32 v[222:223], v[222:223], v[122:123], v[122:123]
    v_pk_fma_f32 v[224:225], v[224:225], v[124:125], v[124:125]
    v_pk_fma_f32 v[226:227], v[226:227], v[126:127], v[126:127]
    v_rcp_f32 v220, v220
    v_rcp_f32 v221, v221
    v_rcp_f32 v222, v222
    v_rcp_f32 v223, v223
    v_rcp_f32 v224, v224
    v_rcp_f32 v225, v225
    v_rcp_f32 v226, v226
    v_rcp_f32 v227, v227
    v_pk_mul_f32 v[16:17], v[16:17], v[220:221]
    v_pk_mul_f32 v[18:19], v[18:19], v[222:223]
    v_pk_mul_f32 v[20:21], v[20:21], v[224:225]
    v_pk_mul_f32 v[22:23], v[22:23], v[226:227]
    v_pk_mul_f32 v[206:207], v[16:17], v[16:17]
    v_pk_mul_f32 v[210:211], v[18:19], v[18:19]
    v_pk_mul_f32 v[214:215], v[20:21], v[20:21]
    v_pk_mul_f32 v[218:219], v[22:23], v[22:23]
    v_pk_mul_f32 v[228:229], v[24:25], v[24:25]
    v_pk_mul_f32 v[230:231], v[26:27], v[26:27]
    v_pk_mul_f32 v[232:233], v[28:29], v[28:29]
    v_pk_mul_f32 v[234:235], v[30:31], v[30:31]
    v_pk_fma_f32 v[228:229], v[228:229], v[112:113], v[104:105]
    v_pk_fma_f32 v[230:231], v[230:231], v[114:115], v[106:107]
    v_pk_fma_f32 v[232:233], v[232:233], v[116:117], v[108:109]
    v_pk_fma_f32 v[234:235], v[234:235], v[118:119], v[110:111]
    v_pk_mul_f32 v[228:229], v[228:229], v[24:25]
    v_pk_mul_f32 v[230:231], v[230:231], v[26:27]
    v_pk_mul_f32 v[232:233], v[232:233], v[28:29]
    v_pk_mul_f32 v[234:235], v[234:235], v[30:31]
    v_exp_f32 v228, v228
    v_exp_f32 v229, v229
    v_exp_f32 v230, v230
    v_exp_f32 v231, v231
    v_exp_f32 v232, v232
    v_exp_f32 v233, v233
    v_exp_f32 v234, v234
    v_exp_f32 v235, v235
    v_pk_fma_f32 v[228:229], v[228:229], v[120:121], v[120:121]
    v_pk_fma_f32 v[230:231], v[230:231], v[122:123], v[122:123]
    v_pk_fma_f32 v[232:233], v[232:233], v[124:125], v[124:125]
    v_pk_fma_f32 v[234:235], v[234:235], v[126:127], v[126:127]
    v_rcp_f32 v228, v228
    v_rcp_f32 v229, v229
    v_rcp_f32 v230, v230
    v_rcp_f32 v231, v231
    v_rcp_f32 v232, v232
    v_rcp_f32 v233, v233
    v_rcp_f32 v234, v234
    v_rcp_f32 v235, v235
    v_pk_mul_f32 v[24:25], v[24:25], v[228:229]
    v_pk_mul_f32 v[26:27], v[26:27], v[230:231]
    v_pk_mul_f32 v[28:29], v[28:29], v[232:233]
    v_pk_mul_f32 v[30:31], v[30:31], v[234:235]
    v_pk_add_f32 v[204:205], v[16:17], v[24:25]
    v_pk_fma_f32 v[206:207], v[24:25], v[24:25], v[206:207]
    v_pk_add_f32 v[208:209], v[18:19], v[26:27]
    v_pk_fma_f32 v[210:211], v[26:27], v[26:27], v[210:211]
    v_pk_add_f32 v[212:213], v[20:21], v[28:29]
    v_pk_fma_f32 v[214:215], v[28:29], v[28:29], v[214:215]
    v_pk_add_f32 v[216:217], v[22:23], v[30:31]
    v_pk_fma_f32 v[218:219], v[30:31], v[30:31], v[218:219]
    v_pk_mul_f32 v[220:221], v[32:33], v[32:33]
    v_pk_mul_f32 v[222:223], v[34:35], v[34:35]
    v_pk_mul_f32 v[224:225], v[36:37], v[36:37]
    v_pk_mul_f32 v[226:227], v[38:39], v[38:39]
    v_pk_fma_f32 v[220:221], v[220:221], v[112:113], v[104:105]
    v_pk_fma_f32 v[222:223], v[222:223], v[114:115], v[106:107]
    v_pk_fma_f32 v[224:225], v[224:225], v[116:117], v[108:109]
    v_pk_fma_f32 v[226:227], v[226:227], v[118:119], v[110:111]
    v_pk_mul_f32 v[220:221], v[220:221], v[32:33]
    v_pk_mul_f32 v[222:223], v[222:223], v[34:35]
    v_pk_mul_f32 v[224:225], v[224:225], v[36:37]
    v_pk_mul_f32 v[226:227], v[226:227], v[38:39]
    v_exp_f32 v220, v220
    v_exp_f32 v221, v221
    v_exp_f32 v222, v222
    v_exp_f32 v223, v223
    v_exp_f32 v224, v224
    v_exp_f32 v225, v225
    v_exp_f32 v226, v226
    v_exp_f32 v227, v227
    v_pk_fma_f32 v[220:221], v[220:221], v[120:121], v[120:121]
    v_pk_fma_f32 v[222:223], v[222:223], v[122:123], v[122:123]
    v_pk_fma_f32 v[224:225], v[224:225], v[124:125], v[124:125]
    v_pk_fma_f32 v[226:227], v[226:227], v[126:127], v[126:127]
    v_rcp_f32 v220, v220
    v_rcp_f32 v221, v221
    v_rcp_f32 v222, v222
    v_rcp_f32 v223, v223
    v_rcp_f32 v224, v224
    v_rcp_f32 v225, v225
    v_rcp_f32 v226, v226
    v_rcp_f32 v227, v227
    v_pk_mul_f32 v[32:33], v[32:33], v[220:221]
    v_pk_mul_f32 v[34:35], v[34:35], v[222:223]
    v_pk_mul_f32 v[36:37], v[36:37], v[224:225]
    v_pk_mul_f32 v[38:39], v[38:39], v[226:227]
    v_pk_add_f32 v[204:205], v[204:205], v[32:33]
    v_pk_fma_f32 v[206:207], v[32:33], v[32:33], v[206:207]
    v_pk_add_f32 v[208:209], v[208:209], v[34:35]
    v_pk_fma_f32 v[210:211], v[34:35], v[34:35], v[210:211]
    v_pk_add_f32 v[212:213], v[212:213], v[36:37]
    v_pk_fma_f32 v[214:215], v[36:37], v[36:37], v[214:215]
    v_pk_add_f32 v[216:217], v[216:217], v[38:39]
    v_pk_fma_f32 v[218:219], v[38:39], v[38:39], v[218:219]
    v_pk_mul_f32 v[228:229], v[40:41], v[40:41]
    v_pk_mul_f32 v[230:231], v[42:43], v[42:43]
    v_pk_mul_f32 v[232:233], v[44:45], v[44:45]
    v_pk_mul_f32 v[234:235], v[46:47], v[46:47]
    v_pk_fma_f32 v[228:229], v[228:229], v[112:113], v[104:105]
    v_pk_fma_f32 v[230:231], v[230:231], v[114:115], v[106:107]
    v_pk_fma_f32 v[232:233], v[232:233], v[116:117], v[108:109]
    v_pk_fma_f32 v[234:235], v[234:235], v[118:119], v[110:111]
    v_pk_mul_f32 v[228:229], v[228:229], v[40:41]
    v_pk_mul_f32 v[230:231], v[230:231], v[42:43]
    v_pk_mul_f32 v[232:233], v[232:233], v[44:45]
    v_pk_mul_f32 v[234:235], v[234:235], v[46:47]
    v_exp_f32 v228, v228
    v_exp_f32 v229, v229
    v_exp_f32 v230, v230
    v_exp_f32 v231, v231
    v_exp_f32 v232, v232
    v_exp_f32 v233, v233
    v_exp_f32 v234, v234
    v_exp_f32 v235, v235
    v_pk_fma_f32 v[228:229], v[228:229], v[120:121], v[120:121]
    v_pk_fma_f32 v[230:231], v[230:231], v[122:123], v[122:123]
    v_pk_fma_f32 v[232:233], v[232:233], v[124:125], v[124:125]
    v_pk_fma_f32 v[234:235], v[234:235], v[126:127], v[126:127]
    v_rcp_f32 v228, v228
    v_rcp_f32 v229, v229
    v_rcp_f32 v230, v230
    v_rcp_f32 v231, v231
    v_rcp_f32 v232, v232
    v_rcp_f32 v233, v233
    v_rcp_f32 v234, v234
    v_rcp_f32 v235, v235
    v_pk_mul_f32 v[40:41], v[40:41], v[228:229]
    v_pk_mul_f32 v[42:43], v[42:43], v[230:231]
    v_pk_mul_f32 v[44:45], v[44:45], v[232:233]
    v_pk_mul_f32 v[46:47], v[46:47], v[234:235]
    v_pk_add_f32 v[204:205], v[204:205], v[40:41]
    v_pk_fma_f32 v[206:207], v[40:41], v[40:41], v[206:207]
    v_pk_add_f32 v[208:209], v[208:209], v[42:43]
    v_pk_fma_f32 v[210:211], v[42:43], v[42:43], v[210:211]
    v_pk_add_f32 v[212:213], v[212:213], v[44:45]
    v_pk_fma_f32 v[214:215], v[44:45], v[44:45], v[214:215]
    v_pk_add_f32 v[216:217], v[216:217], v[46:47]
    v_pk_fma_f32 v[218:219], v[46:47], v[46:47], v[218:219]
    v_pk_mul_f32 v[220:221], v[48:49], v[48:49]
    v_pk_mul_f32 v[222:223], v[50:51], v[50:51]
    v_pk_mul_f32 v[224:225], v[52:53], v[52:53]
    v_pk_mul_f32 v[226:227], v[54:55], v[54:55]
    v_pk_fma_f32 v[220:221], v[220:221], v[112:113], v[104:105]
    v_pk_fma_f32 v[222:223], v[222:223], v[114:115], v[106:107]
    v_pk_fma_f32 v[224:225], v[224:225], v[116:117], v[108:109]
    v_pk_fma_f32 v[226:227], v[226:227], v[118:119], v[110:111]
    v_pk_mul_f32 v[220:221], v[220:221], v[48:49]
    v_pk_mul_f32 v[222:223], v[222:223], v[50:51]
    v_pk_mul_f32 v[224:225], v[224:225], v[52:53]
    v_pk_mul_f32 v[226:227], v[226:227], v[54:55]
    v_exp_f32 v220, v220
    v_exp_f32 v221, v221
    v_exp_f32 v222, v222
    v_exp_f32 v223, v223
    v_exp_f32 v224, v224
    v_exp_f32 v225, v225
    v_exp_f32 v226, v226
    v_exp_f32 v227, v227
    v_pk_fma_f32 v[220:221], v[220:221], v[120:121], v[120:121]
    v_pk_fma_f32 v[222:223], v[222:223], v[122:123], v[122:123]
    v_pk_fma_f32 v[224:225], v[224:225], v[124:125], v[124:125]
    v_pk_fma_f32 v[226:227], v[226:227], v[126:127], v[126:127]
    v_rcp_f32 v220, v220
    v_rcp_f32 v221, v221
    v_rcp_f32 v222, v222
    v_rcp_f32 v223, v223
    v_rcp_f32 v224, v224
    v_rcp_f32 v225, v225
    v_rcp_f32 v226, v226
    v_rcp_f32 v227, v227
    v_pk_mul_f32 v[48:49], v[48:49], v[220:221]
    v_pk_mul_f32 v[50:51], v[50:51], v[222:223]
    v_pk_mul_f32 v[52:53], v[52:53], v[224:225]
    v_pk_mul_f32 v[54:55], v[54:55], v[226:227]
    v_pk_add_f32 v[204:205], v[204:205], v[48:49]
    v_pk_fma_f32 v[206:207], v[48:49], v[48:49], v[206:207]
    v_pk_add_f32 v[208:209], v[208:209], v[50:51]
    v_pk_fma_f32 v[210:211], v[50:51], v[50:51], v[210:211]
    v_pk_add_f32 v[212:213], v[212:213], v[52:53]
    v_pk_fma_f32 v[214:215], v[52:53], v[52:53], v[214:215]
    v_pk_add_f32 v[216:217], v[216:217], v[54:55]
    v_pk_fma_f32 v[218:219], v[54:55], v[54:55], v[218:219]
    v_pk_mul_f32 v[228:229], v[56:57], v[56:57]
    v_pk_mul_f32 v[230:231], v[58:59], v[58:59]
    v_pk_mul_f32 v[232:233], v[60:61], v[60:61]
    v_pk_mul_f32 v[234:235], v[62:63], v[62:63]
    v_pk_fma_f32 v[228:229], v[228:229], v[112:113], v[104:105]
    v_pk_fma_f32 v[230:231], v[230:231], v[114:115], v[106:107]
    v_pk_fma_f32 v[232:233], v[232:233], v[116:117], v[108:109]
    v_pk_fma_f32 v[234:235], v[234:235], v[118:119], v[110:111]
    v_pk_mul_f32 v[228:229], v[228:229], v[56:57]
    v_pk_mul_f32 v[230:231], v[230:231], v[58:59]
    v_pk_mul_f32 v[232:233], v[232:233], v[60:61]
    v_pk_mul_f32 v[234:235], v[234:235], v[62:63]
    v_exp_f32 v228, v228
    v_exp_f32 v229, v229
    v_exp_f32 v230, v230
    v_exp_f32 v231, v231
    v_exp_f32 v232, v232
    v_exp_f32 v233, v233
    v_exp_f32 v234, v234
    v_exp_f32 v235, v235
    v_pk_fma_f32 v[228:229], v[228:229], v[120:121], v[120:121]
    v_pk_fma_f32 v[230:231], v[230:231], v[122:123], v[122:123]
    v_pk_fma_f32 v[232:233], v[232:233], v[124:125], v[124:125]
    v_pk_fma_f32 v[234:235], v[234:235], v[126:127], v[126:127]
    v_rcp_f32 v228, v228
    v_rcp_f32 v229, v229
    v_rcp_f32 v230, v230
    v_rcp_f32 v231, v231
    v_rcp_f32 v232, v232
    v_rcp_f32 v233, v233
    v_rcp_f32 v234, v234
    v_rcp_f32 v235, v235
    v_pk_mul_f32 v[56:57], v[56:57], v[228:229]
    v_pk_mul_f32 v[58:59], v[58:59], v[230:231]
    v_pk_mul_f32 v[60:61], v[60:61], v[232:233]
    v_pk_mul_f32 v[62:63], v[62:63], v[234:235]
    v_pk_add_f32 v[204:205], v[204:205], v[56:57]
    v_pk_fma_f32 v[206:207], v[56:57], v[56:57], v[206:207]
    v_pk_add_f32 v[208:209], v[208:209], v[58:59]
    v_pk_fma_f32 v[210:211], v[58:59], v[58:59], v[210:211]
    v_pk_add_f32 v[212:213], v[212:213], v[60:61]
    v_pk_fma_f32 v[214:215], v[60:61], v[60:61], v[214:215]
    v_pk_add_f32 v[216:217], v[216:217], v[62:63]
    v_pk_fma_f32 v[218:219], v[62:63], v[62:63], v[218:219]
    v_pk_mul_f32 v[220:221], v[64:65], v[64:65]
    v_pk_mul_f32 v[222:223], v[66:67], v[66:67]
    v_pk_mul_f32 v[224:225], v[68:69], v[68:69]
    v_pk_mul_f32 v[226:227], v[70:71], v[70:71]
    v_pk_fma_f32 v[220:221], v[220:221], v[112:113], v[104:105]
    v_pk_fma_f32 v[222:223], v[222:223], v[114:115], v[106:107]
    v_pk_fma_f32 v[224:225], v[224:225], v[116:117], v[108:109]
    v_pk_fma_f32 v[226:227], v[226:227], v[118:119], v[110:111]
    v_pk_mul_f32 v[220:221], v[220:221], v[64:65]
    v_pk_mul_f32 v[222:223], v[222:223], v[66:67]
    v_pk_mul_f32 v[224:225], v[224:225], v[68:69]
    v_pk_mul_f32 v[226:227], v[226:227], v[70:71]
    v_exp_f32 v220, v220
    v_exp_f32 v221, v221
    v_exp_f32 v222, v222
    v_exp_f32 v223, v223
    v_exp_f32 v224, v224
    v_exp_f32 v225, v225
    v_exp_f32 v226, v226
    v_exp_f32 v227, v227
    v_pk_fma_f32 v[220:221], v[220:221], v[120:121], v[120:121]
    v_pk_fma_f32 v[222:223], v[222:223], v[122:123], v[122:123]
    v_pk_fma_f32 v[224:225], v[224:225], v[124:125], v[124:125]
    v_pk_fma_f32 v[226:227], v[226:227], v[126:127], v[126:127]
    v_rcp_f32 v220, v220
    v_rcp_f32 v221, v221
    v_rcp_f32 v222, v222
    v_rcp_f32 v223, v223
    v_rcp_f32 v224, v224
    v_rcp_f32 v225, v225
    v_rcp_f32 v226, v226
    v_rcp_f32 v227, v227
    v_pk_mul_f32 v[64:65], v[64:65], v[220:221]
    v_pk_mul_f32 v[66:67], v[66:67], v[222:223]
    v_pk_mul_f32 v[68:69], v[68:69], v[224:225]
    v_pk_mul_f32 v[70:71], v[70:71], v[226:227]
    v_pk_add_f32 v[204:205], v[204:205], v[64:65]
    v_pk_fma_f32 v[206:207], v[64:65], v[64:65], v[206:207]
    v_pk_add_f32 v[208:209], v[208:209], v[66:67]
    v_pk_fma_f32 v[210:211], v[66:67], v[66:67], v[210:211]
    v_pk_add_f32 v[212:213], v[212:213], v[68:69]
    v_pk_fma_f32 v[214:215], v[68:69], v[68:69], v[214:215]
    v_pk_add_f32 v[216:217], v[216:217], v[70:71]
    v_pk_fma_f32 v[218:219], v[70:71], v[70:71], v[218:219]
    v_pk_mul_f32 v[228:229], v[72:73], v[72:73]
    v_pk_mul_f32 v[230:231], v[74:75], v[74:75]
    v_pk_mul_f32 v[232:233], v[76:77], v[76:77]
    v_pk_mul_f32 v[234:235], v[78:79], v[78:79]
    v_pk_fma_f32 v[228:229], v[228:229], v[112:113], v[104:105]
    v_pk_fma_f32 v[230:231], v[230:231], v[114:115], v[106:107]
    v_pk_fma_f32 v[232:233], v[232:233], v[116:117], v[108:109]
    v_pk_fma_f32 v[234:235], v[234:235], v[118:119], v[110:111]
    v_pk_mul_f32 v[228:229], v[228:229], v[72:73]
    v_pk_mul_f32 v[230:231], v[230:231], v[74:75]
    v_pk_mul_f32 v[232:233], v[232:233], v[76:77]
    v_pk_mul_f32 v[234:235], v[234:235], v[78:79]
    v_exp_f32 v228, v228
    v_exp_f32 v229, v229
    v_exp_f32 v230, v230
    v_exp_f32 v231, v231
    v_exp_f32 v232, v232
    v_exp_f32 v233, v233
    v_exp_f32 v234, v234
    v_exp_f32 v235, v235
    v_pk_fma_f32 v[228:229], v[228:229], v[120:121], v[120:121]
    v_pk_fma_f32 v[230:231], v[230:231], v[122:123], v[122:123]
    v_pk_fma_f32 v[232:233], v[232:233], v[124:125], v[124:125]
    v_pk_fma_f32 v[234:235], v[234:235], v[126:127], v[126:127]
    v_rcp_f32 v228, v228
    v_rcp_f32 v229, v229
    v_rcp_f32 v230, v230
    v_rcp_f32 v231, v231
    v_rcp_f32 v232, v232
    v_rcp_f32 v233, v233
    v_rcp_f32 v234, v234
    v_rcp_f32 v235, v235
    v_pk_mul_f32 v[72:73], v[72:73], v[228:229]
    v_pk_mul_f32 v[74:75], v[74:75], v[230:231]
    v_pk_mul_f32 v[76:77], v[76:77], v[232:233]
    v_pk_mul_f32 v[78:79], v[78:79], v[234:235]
    v_pk_add_f32 v[204:205], v[204:205], v[72:73]
    v_pk_fma_f32 v[206:207], v[72:73], v[72:73], v[206:207]
    v_pk_add_f32 v[208:209], v[208:209], v[74:75]
    v_pk_fma_f32 v[210:211], v[74:75], v[74:75], v[210:211]
    v_pk_add_f32 v[212:213], v[212:213], v[76:77]
    v_pk_fma_f32 v[214:215], v[76:77], v[76:77], v[214:215]
    v_pk_add_f32 v[216:217], v[216:217], v[78:79]
    v_pk_fma_f32 v[218:219], v[78:79], v[78:79], v[218:219]
    v_pk_mul_f32 v[220:221], v[80:81], v[80:81]
    v_pk_mul_f32 v[222:223], v[82:83], v[82:83]
    v_pk_mul_f32 v[224:225], v[84:85], v[84:85]
    v_pk_mul_f32 v[226:227], v[86:87], v[86:87]
    v_pk_fma_f32 v[220:221], v[220:221], v[112:113], v[104:105]
    v_pk_fma_f32 v[222:223], v[222:223], v[114:115], v[106:107]
    v_pk_fma_f32 v[224:225], v[224:225], v[116:117], v[108:109]
    v_pk_fma_f32 v[226:227], v[226:227], v[118:119], v[110:111]
    v_pk_mul_f32 v[220:221], v[220:221], v[80:81]
    v_pk_mul_f32 v[222:223], v[222:223], v[82:83]
    v_pk_mul_f32 v[224:225], v[224:225], v[84:85]
    v_pk_mul_f32 v[226:227], v[226:227], v[86:87]
    v_exp_f32 v220, v220
    v_exp_f32 v221, v221
    v_exp_f32 v222, v222
    v_exp_f32 v223, v223
    v_exp_f32 v224, v224
    v_exp_f32 v225, v225
    v_exp_f32 v226, v226
    v_exp_f32 v227, v227
    v_pk_fma_f32 v[220:221], v[220:221], v[120:121], v[120:121]
    v_pk_fma_f32 v[222:223], v[222:223], v[122:123], v[122:123]
    v_pk_fma_f32 v[224:225], v[224:225], v[124:125], v[124:125]
    v_pk_fma_f32 v[226:227], v[226:227], v[126:127], v[126:127]
    v_rcp_f32 v220, v220
    v_rcp_f32 v221, v221
    v_rcp_f32 v222, v222
    v_rcp_f32 v223, v223
    v_rcp_f32 v224, v224
    v_rcp_f32 v225, v225
    v_rcp_f32 v226, v226
    v_rcp_f32 v227, v227
    v_pk_mul_f32 v[80:81], v[80:81], v[220:221]
    v_pk_mul_f32 v[82:83], v[82:83], v[222:223]
    v_pk_mul_f32 v[84:85], v[84:85], v[224:225]
    v_pk_mul_f32 v[86:87], v[86:87], v[226:227]
    v_pk_add_f32 v[204:205], v[204:205], v[80:81]
    v_pk_fma_f32 v[206:207], v[80:81], v[80:81], v[206:207]
    v_pk_add_f32 v[208:209], v[208:209], v[82:83]
    v_pk_fma_f32 v[210:211], v[82:83], v[82:83], v[210:211]
    v_pk_add_f32 v[212:213], v[212:213], v[84:85]
    v_pk_fma_f32 v[214:215], v[84:85], v[84:85], v[214:215]
    v_pk_add_f32 v[216:217], v[216:217], v[86:87]
    v_pk_fma_f32 v[218:219], v[86:87], v[86:87], v[218:219]
    v_add_f32_dpp v204, v204, v204 row_mirror row_mask:0xf bank_mask:0x3
    v_add_f32_dpp v205, v205, v205 row_mirror row_mask:0xf bank_mask:0x3
    v_add_f32_dpp v206, v206, v206 row_mirror row_mask:0xf bank_mask:0x3
    v_add_f32_dpp v207, v207, v207 row_mirror row_mask:0xf bank_mask:0x3
    v_add_f32_dpp v208, v208, v208 row_mirror row_mask:0xf bank_mask:0x3
    v_add_f32_dpp v209, v209, v209 row_mirror row_mask:0xf bank_mask:0x3
    v_add_f32_dpp v210, v210, v210 row_mirror row_mask:0xf bank_mask:0x3
    v_add_f32_dpp v211, v211, v211 row_mirror row_mask:0xf bank_mask:0x3
    v_add_f32_dpp v204, v212, v212 row_mirror row_mask:0xf bank_mask:0xc
    v_add_f32_dpp v205, v213, v213 row_mirror row_mask:0xf bank_mask:0xc
    v_add_f32_dpp v206, v214, v214 row_mirror row_mask:0xf bank_mask:0xc
    v_add_f32_dpp v207, v215, v215 row_mirror row_mask:0xf bank_mask:0xc
    v_add_f32_dpp v208, v216, v216 row_mirror row_mask:0xf bank_mask:0xc
    v_add_f32_dpp v209, v217, v217 row_mirror row_mask:0xf bank_mask:0xc
    v_add_f32_dpp v210, v218, v218 row_mirror row_mask:0xf bank_mask:0xc
    v_add_f32_dpp v211, v219, v219 row_mirror row_mask:0xf bank_mask:0xc
    v_add_f32_dpp v204, v204, v204 row_half_mirror row_mask:0xf bank_mask:0x5
    v_add_f32_dpp v205, v205, v205 row_half_mirror row_mask:0xf bank_mask:0x5
    v_add_f32_dpp v206, v206, v206 row_half_mirror row_mask:0xf bank_mask:0x5
    v_add_f32_dpp v207, v207, v207 row_half_mirror row_mask:0xf bank_mask:0x5
    v_add_f32_dpp v204, v208, v208 row_half_mirror row_mask:0xf bank_mask:0xa
    v_add_f32_dpp v205, v209, v209 row_half_mirror row_mask:0xf bank_mask:0xa
    v_add_f32_dpp v206, v210, v210 row_half_mirror row_mask:0xf bank_mask:0xa
    v_add_f32_dpp v207, v211, v211 row_half_mirror row_mask:0xf bank_mask:0xa
    v_add_f32_dpp v204, v204, v204 quad_perm:[1,0,3,2] row_mask:0xf bank_mask:0xf
    v_add_f32_dpp v205, v205, v205 quad_perm:[1,0,3,2] row_mask:0xf bank_mask:0xf
    v_add_f32_dpp v206, v206, v206 quad_perm:[1,0,3,2] row_mask:0xf bank_mask:0xf
    v_add_f32_dpp v207, v207, v207 quad_perm:[1,0,3,2] row_mask:0xf bank_mask:0xf
    v_add_f32_dpp v12, v204, v204 quad_perm:[2,3,0,1] row_mask:0xf bank_mask:0xf
    v_add_f32_dpp v14, v205, v205 quad_perm:[2,3,0,1] row_mask:0xf bank_mask:0xf
    v_add_f32_dpp v13, v206, v206 quad_perm:[2,3,0,1] row_mask:0xf bank_mask:0xf
    v_add_f32_dpp v15, v207, v207 quad_perm:[2,3,0,1] row_mask:0xf bank_mask:0xf
    buffer_store_dwordx4 v[12:15], v8, s[4:7], s36 offen sc1
    s_waitcnt lgkmcnt(5)
    v_mfma_f32_16x16x32_bf16 v[88:91], v[168:171], v[160:163], 0
    ds_read_b128 v[204:207], v3 offset:37888
    v_mfma_f32_16x16x32_bf16 v[92:95], v[168:171], v[164:167], 0
    ds_read_b128 v[208:211], v3 offset:39936
    v_mfma_f32_16x16x32_bf16 v[96:99], v[172:175], v[160:163], 0
    ds_read_b128 v[212:215], v1 offset:46080
    v_mfma_f32_16x16x32_bf16 v[100:103], v[172:175], v[164:167], 0
    ds_read_b128 v[216:219], v1 offset:47104
    v_mfma_f32_16x16x32_bf16 v[104:107], v[176:179], v[160:163], 0
    ds_read_b128 v[220:223], v1 offset:48128
    v_mfma_f32_16x16x32_bf16 v[108:111], v[176:179], v[164:167], 0
    ds_read_b128 v[224:227], v1 offset:49152
    v_mfma_f32_16x16x32_bf16 v[112:115], v[180:183], v[160:163], 0
    ds_read_b128 v[228:231], v1 offset:50176
    v_mfma_f32_16x16x32_bf16 v[116:119], v[180:183], v[164:167], 0
    ds_read_b128 v[232:235], v1 offset:51200
    s_waitcnt lgkmcnt(8)
    v_mfma_f32_16x16x32_bf16 v[120:123], v[184:187], v[160:163], 0
    ds_read_b128 v[236:239], v1 offset:52224
    v_mfma_f32_16x16x32_bf16 v[124:127], v[184:187], v[164:167], 0
    ds_read_b128 v[240:243], v1 offset:53248
    v_mfma_f32_16x16x32_bf16 v[128:131], v[188:191], v[160:163], 0
    ds_read_b128 v[244:247], v1 offset:54272
    v_mfma_f32_16x16x32_bf16 v[132:135], v[188:191], v[164:167], 0
    v_mfma_f32_16x16x32_bf16 v[136:139], v[192:195], v[160:163], 0
    v_mfma_f32_16x16x32_bf16 v[140:143], v[192:195], v[164:167], 0
    v_mfma_f32_16x16x32_bf16 v[144:147], v[196:199], v[160:163], 0
    v_mfma_f32_16x16x32_bf16 v[148:151], v[196:199], v[164:167], 0
    v_mfma_f32_16x16x32_bf16 v[152:155], v[200:203], v[160:163], 0
    v_mfma_f32_16x16x32_bf16 v[156:159], v[200:203], v[164:167], 0
    s_waitcnt lgkmcnt(0)
    s_barrier
    v_mfma_f32_16x16x32_bf16 v[88:91], v[212:215], v[204:207], v[88:91]
    ds_read_b128 v[160:163], v0 offset:0
    v_mfma_f32_16x16x32_bf16 v[92:95], v[212:215], v[208:211], v[92:95]
    ds_read_b128 v[164:167], v0 offset:2048
    v_mfma_f32_16x16x32_bf16 v[96:99], v[216:219], v[204:207], v[96:99]
    ds_read_b128 v[168:171], v2 offset:0
    v_mfma_f32_16x16x32_bf16 v[100:103], v[216:219], v[208:211], v[100:103]
    ds_read_b128 v[172:175], v2 offset:1024
    v_mfma_f32_16x16x32_bf16 v[104:107], v[220:223], v[204:207], v[104:107]
    ds_read_b128 v[176:179], v2 offset:2048
    v_mfma_f32_16x16x32_bf16 v[108:111], v[220:223], v[208:211], v[108:111]
    ds_read_b128 v[180:183], v2 offset:3072
    v_mfma_f32_16x16x32_bf16 v[112:115], v[224:227], v[204:207], v[112:115]
    ds_read_b128 v[184:187], v2 offset:4096
    v_mfma_f32_16x16x32_bf16 v[116:119], v[224:227], v[208:211], v[116:119]
    ds_read_b128 v[188:191], v2 offset:5120
    v_mfma_f32_16x16x32_bf16 v[120:123], v[228:231], v[204:207], v[120:123]
    ds_read_b128 v[192:195], v2 offset:6144
    v_mfma_f32_16x16x32_bf16 v[124:127], v[228:231], v[208:211], v[124:127]
    ds_read_b128 v[196:199], v2 offset:7168
    v_mfma_f32_16x16x32_bf16 v[128:131], v[232:235], v[204:207], v[128:131]
    ds_read_b128 v[200:203], v2 offset:8192
    v_mfma_f32_16x16x32_bf16 v[132:135], v[232:235], v[208:211], v[132:135]
    v_mfma_f32_16x16x32_bf16 v[136:139], v[236:239], v[204:207], v[136:139]
    v_mfma_f32_16x16x32_bf16 v[140:143], v[236:239], v[208:211], v[140:143]
    v_mfma_f32_16x16x32_bf16 v[144:147], v[240:243], v[204:207], v[144:147]
    v_mfma_f32_16x16x32_bf16 v[148:151], v[240:243], v[208:211], v[148:151]
    v_mfma_f32_16x16x32_bf16 v[152:155], v[244:247], v[204:207], v[152:155]
    v_mfma_f32_16x16x32_bf16 v[156:159], v[244:247], v[208:211], v[156:159]
    s_waitcnt lgkmcnt(5)
    v_mfma_f32_16x16x32_bf16 v[88:91], v[168:171], v[160:163], v[88:91]
    ds_read_b128 v[204:207], v0 offset:1024
    v_mfma_f32_16x16x32_bf16 v[92:95], v[168:171], v[164:167], v[92:95]
    ds_read_b128 v[208:211], v0 offset:3072
    v_mfma_f32_16x16x32_bf16 v[96:99], v[172:175], v[160:163], v[96:99]
    ds_read_b128 v[212:215], v2 offset:9216
    v_mfma_f32_16x16x32_bf16 v[100:103], v[172:175], v[164:167], v[100:103]
    ds_read_b128 v[216:219], v2 offset:10240
    v_mfma_f32_16x16x32_bf16 v[104:107], v[176:179], v[160:163], v[104:107]
    ds_read_b128 v[220:223], v2 offset:11264
    v_mfma_f32_16x16x32_bf16 v[108:111], v[176:179], v[164:167], v[108:111]
    ds_read_b128 v[224:227], v2 offset:12288
    v_mfma_f32_16x16x32_bf16 v[112:115], v[180:183], v[160:163], v[112:115]
    ds_read_b128 v[228:231], v2 offset:13312
    v_mfma_f32_16x16x32_bf16 v[116:119], v[180:183], v[164:167], v[116:119]
    ds_read_b128 v[232:235], v2 offset:14336
    s_waitcnt lgkmcnt(8)
    v_mfma_f32_16x16x32_bf16 v[120:123], v[184:187], v[160:163], v[120:123]
    ds_read_b128 v[236:239], v2 offset:15360
    v_mfma_f32_16x16x32_bf16 v[124:127], v[184:187], v[164:167], v[124:127]
    ds_read_b128 v[240:243], v2 offset:16384
    v_mfma_f32_16x16x32_bf16 v[128:131], v[188:191], v[160:163], v[128:131]
    ds_read_b128 v[244:247], v2 offset:17408
    v_mfma_f32_16x16x32_bf16 v[132:135], v[188:191], v[164:167], v[132:135]
    v_mfma_f32_16x16x32_bf16 v[136:139], v[192:195], v[160:163], v[136:139]
    v_mfma_f32_16x16x32_bf16 v[140:143], v[192:195], v[164:167], v[140:143]
    v_mfma_f32_16x16x32_bf16 v[144:147], v[196:199], v[160:163], v[144:147]
    v_mfma_f32_16x16x32_bf16 v[148:151], v[196:199], v[164:167], v[148:151]
    v_mfma_f32_16x16x32_bf16 v[152:155], v[200:203], v[160:163], v[152:155]
    v_mfma_f32_16x16x32_bf16 v[156:159], v[200:203], v[164:167], v[156:159]
    s_waitcnt lgkmcnt(0)
    s_barrier
    v_mfma_f32_16x16x32_bf16 v[88:91], v[212:215], v[204:207], v[88:91]
    ds_read_b128 v[160:163], v0 offset:36864
    v_mfma_f32_16x16x32_bf16 v[92:95], v[212:215], v[208:211], v[92:95]
    ds_read_b128 v[164:167], v0 offset:38912
    v_mfma_f32_16x16x32_bf16 v[96:99], v[216:219], v[204:207], v[96:99]
    ds_read_b128 v[168:171], v2 offset:36864
    v_mfma_f32_16x16x32_bf16 v[100:103], v[216:219], v[208:211], v[100:103]
    ds_read_b128 v[172:175], v2 offset:37888
    v_mfma_f32_16x16x32_bf16 v[104:107], v[220:223], v[204:207], v[104:107]
    ds_read_b128 v[176:179], v2 offset:38912
    v_mfma_f32_16x16x32_bf16 v[108:111], v[220:223], v[208:211], v[108:111]
    ds_read_b128 v[180:183], v2 offset:39936
    v_mfma_f32_16x16x32_bf16 v[112:115], v[224:227], v[204:207], v[112:115]
    ds_read_b128 v[184:187], v2 offset:40960
    v_mfma_f32_16x16x32_bf16 v[116:119], v[224:227], v[208:211], v[116:119]
    ds_read_b128 v[188:191], v2 offset:41984
    v_mfma_f32_16x16x32_bf16 v[120:123], v[228:231], v[204:207], v[120:123]
    ds_read_b128 v[192:195], v2 offset:43008
    v_mfma_f32_16x16x32_bf16 v[124:127], v[228:231], v[208:211], v[124:127]
    ds_read_b128 v[196:199], v2 offset:44032
    v_mfma_f32_16x16x32_bf16 v[128:131], v[232:235], v[204:207], v[128:131]
    ds_read_b128 v[200:203], v2 offset:45056
    v_mfma_f32_16x16x32_bf16 v[132:135], v[232:235], v[208:211], v[132:135]
    v_mfma_f32_16x16x32_bf16 v[136:139], v[236:239], v[204:207], v[136:139]
    v_mfma_f32_16x16x32_bf16 v[140:143], v[236:239], v[208:211], v[140:143]
    v_mfma_f32_16x16x32_bf16 v[144:147], v[240:243], v[204:207], v[144:147]
    v_mfma_f32_16x16x32_bf16 v[148:151], v[240:243], v[208:211], v[148:151]
    v_mfma_f32_16x16x32_bf16 v[152:155], v[244:247], v[204:207], v[152:155]
    v_mfma_f32_16x16x32_bf16 v[156:159], v[244:247], v[208:211], v[156:159]
    s_waitcnt lgkmcnt(5)
    v_mfma_f32_16x16x32_bf16 v[88:91], v[168:171], v[160:163], v[88:91]
    ds_read_b128 v[204:207], v0 offset:37888
    v_mfma_f32_16x16x32_bf16 v[92:95], v[168:171], v[164:167], v[92:95]
    ds_read_b128 v[208:211], v0 offset:39936
    v_mfma_f32_16x16x32_bf16 v[96:99], v[172:175], v[160:163], v[96:99]
    ds_read_b128 v[212:215], v2 offset:46080
    v_mfma_f32_16x16x32_bf16 v[100:103], v[172:175], v[164:167], v[100:103]
    ds_read_b128 v[216:219], v2 offset:47104
    v_mfma_f32_16x16x32_bf16 v[104:107], v[176:179], v[160:163], v[104:107]
    ds_read_b128 v[220:223], v2 offset:48128
    v_mfma_f32_16x16x32_bf16 v[108:111], v[176:179], v[164:167], v[108:111]
    ds_read_b128 v[224:227], v2 offset:49152
    v_mfma_f32_16x16x32_bf16 v[112:115], v[180:183], v[160:163], v[112:115]
    ds_read_b128 v[228:231], v2 offset:50176
    v_mfma_f32_16x16x32_bf16 v[116:119], v[180:183], v[164:167], v[116:119]
    ds_read_b128 v[232:235], v2 offset:51200
    s_waitcnt lgkmcnt(8)
    v_mfma_f32_16x16x32_bf16 v[120:123], v[184:187], v[160:163], v[120:123]
    ds_read_b128 v[236:239], v2 offset:52224
    v_mfma_f32_16x16x32_bf16 v[124:127], v[184:187], v[164:167], v[124:127]
    ds_read_b128 v[240:243], v2 offset:53248
    v_mfma_f32_16x16x32_bf16 v[128:131], v[188:191], v[160:163], v[128:131]
    ds_read_b128 v[244:247], v2 offset:54272
    v_mfma_f32_16x16x32_bf16 v[132:135], v[188:191], v[164:167], v[132:135]
    buffer_load_dwordx4 v[4:7], v255, s[4:7], s35 offen offset:0 sc1
    v_mfma_f32_16x16x32_bf16 v[136:139], v[192:195], v[160:163], v[136:139]
    v_mfma_f32_16x16x32_bf16 v[140:143], v[192:195], v[164:167], v[140:143]
    buffer_load_dwordx4 v[8:11], v255, s[4:7], s35 offen offset:1024 sc1
    v_mfma_f32_16x16x32_bf16 v[144:147], v[196:199], v[160:163], v[144:147]
    v_mfma_f32_16x16x32_bf16 v[148:151], v[196:199], v[164:167], v[148:151]
    buffer_load_dwordx4 v[12:15], v255, s[4:7], s35 offen offset:2048 sc1
    v_mfma_f32_16x16x32_bf16 v[152:155], v[200:203], v[160:163], v[152:155]
    v_mfma_f32_16x16x32_bf16 v[156:159], v[200:203], v[164:167], v[156:159]
    buffer_load_dwordx4 v[252:255], v255, s[4:7], s35 offen offset:3072 sc1
    s_waitcnt lgkmcnt(0)
    s_barrier
    v_mfma_f32_16x16x32_bf16 v[88:91], v[212:215], v[204:207], v[88:91]
    ds_read_b128 v[160:163], v3 offset:0
    v_mfma_f32_16x16x32_bf16 v[92:95], v[212:215], v[208:211], v[92:95]
    ds_read_b128 v[164:167], v3 offset:2048
    v_mfma_f32_16x16x32_bf16 v[96:99], v[216:219], v[204:207], v[96:99]
    ds_read_b128 v[168:171], v1 offset:0
    v_mfma_f32_16x16x32_bf16 v[100:103], v[216:219], v[208:211], v[100:103]
    ds_read_b128 v[172:175], v1 offset:1024
    v_mfma_f32_16x16x32_bf16 v[104:107], v[220:223], v[204:207], v[104:107]
    ds_read_b128 v[176:179], v1 offset:2048
    v_mfma_f32_16x16x32_bf16 v[108:111], v[220:223], v[208:211], v[108:111]
    ds_read_b128 v[180:183], v1 offset:3072
    v_mfma_f32_16x16x32_bf16 v[112:115], v[224:227], v[204:207], v[112:115]
    ds_read_b128 v[184:187], v1 offset:4096
    v_mfma_f32_16x16x32_bf16 v[116:119], v[224:227], v[208:211], v[116:119]
    ds_read_b128 v[188:191], v1 offset:5120
    v_mfma_f32_16x16x32_bf16 v[120:123], v[228:231], v[204:207], v[120:123]
    ds_read_b128 v[192:195], v1 offset:6144
    v_mfma_f32_16x16x32_bf16 v[124:127], v[228:231], v[208:211], v[124:127]
    ds_read_b128 v[196:199], v1 offset:7168
    v_mfma_f32_16x16x32_bf16 v[128:131], v[232:235], v[204:207], v[128:131]
    ds_read_b128 v[200:203], v1 offset:8192
    v_mfma_f32_16x16x32_bf16 v[132:135], v[232:235], v[208:211], v[132:135]
    v_mfma_f32_16x16x32_bf16 v[136:139], v[236:239], v[204:207], v[136:139]
    v_mfma_f32_16x16x32_bf16 v[140:143], v[236:239], v[208:211], v[140:143]
    v_mfma_f32_16x16x32_bf16 v[144:147], v[240:243], v[204:207], v[144:147]
    v_mfma_f32_16x16x32_bf16 v[148:151], v[240:243], v[208:211], v[148:151]
    v_mfma_f32_16x16x32_bf16 v[152:155], v[244:247], v[204:207], v[152:155]
    v_mfma_f32_16x16x32_bf16 v[156:159], v[244:247], v[208:211], v[156:159]
    s_waitcnt lgkmcnt(5)
    v_mfma_f32_16x16x32_bf16 v[88:91], v[168:171], v[160:163], v[88:91]
    ds_read_b128 v[204:207], v3 offset:1024
    v_mfma_f32_16x16x32_bf16 v[92:95], v[168:171], v[164:167], v[92:95]
    ds_read_b128 v[208:211], v3 offset:3072
    s_waitcnt vmcnt(0)
    v_mfma_f32_16x16x32_bf16 v[96:99], v[172:175], v[160:163], v[96:99]
    ds_read_b128 v[212:215], v1 offset:9216
    v_or3_b32 v249, v5, v7, v9
    v_mfma_f32_16x16x32_bf16 v[100:103], v[172:175], v[164:167], v[100:103]
    ds_read_b128 v[216:219], v1 offset:10240
    v_or3_b32 v251, v11, v13, v15
    v_mfma_f32_16x16x32_bf16 v[104:107], v[176:179], v[160:163], v[104:107]
    ds_read_b128 v[220:223], v1 offset:11264
    v_or3_b32 v249, v253, v255, v249
    v_mfma_f32_16x16x32_bf16 v[108:111], v[176:179], v[164:167], v[108:111]
    ds_read_b128 v[224:227], v1 offset:12288
    v_or_b32 v249, v249, v251
    v_mfma_f32_16x16x32_bf16 v[112:115], v[180:183], v[160:163], v[112:115]
    ds_read_b128 v[228:231], v1 offset:13312
    v_cmp_gt_i32 vcc, 0, v249
    v_mfma_f32_16x16x32_bf16 v[116:119], v[180:183], v[164:167], v[116:119]
    ds_read_b128 v[232:235], v1 offset:14336
    s_waitcnt lgkmcnt(8)
    v_mfma_f32_16x16x32_bf16 v[120:123], v[184:187], v[160:163], v[120:123]
    ds_read_b128 v[236:239], v1 offset:15360
    s_nop 0
    v_mfma_f32_16x16x32_bf16 v[124:127], v[184:187], v[164:167], v[124:127]
    ds_read_b128 v[240:243], v1 offset:16384
    s_cbranch_vccnz L_g_slow
L_g_back:
    v_mfma_f32_16x16x32_bf16 v[128:131], v[188:191], v[160:163], v[128:131]
    ds_read_b128 v[244:247], v1 offset:17408
    v_add_f32 v4, v4, v8
    v_mfma_f32_16x16x32_bf16 v[132:135], v[188:191], v[164:167], v[132:135]
    v_add_f32 v252, v252, v12
    v_add_f32 v5, v5, v9
    v_mfma_f32_16x16x32_bf16 v[136:139], v[192:195], v[160:163], v[136:139]
    v_add_f32 v253, v253, v13
    v_add_f32 v6, v6, v10
    v_mfma_f32_16x16x32_bf16 v[140:143], v[192:195], v[164:167], v[140:143]
    v_add_f32 v254, v254, v14
    v_add_f32 v7, v7, v11
    v_mfma_f32_16x16x32_bf16 v[144:147], v[196:199], v[160:163], v[144:147]
    v_add_f32 v255, v255, v15
    v_add_f32 v252, v252, v4
    v_mfma_f32_16x16x32_bf16 v[148:151], v[196:199], v[164:167], v[148:151]
    v_add_f32 v253, v253, v5
    v_add_f32 v254, v254, v6
    v_mfma_f32_16x16x32_bf16 v[152:155], v[200:203], v[160:163], v[152:155]
    v_add_f32 v255, v255, v7
    v_add_f32_dpp v252, v252, v252 row_ror:4 row_mask:0xf bank_mask:0xf
    v_mfma_f32_16x16x32_bf16 v[156:159], v[200:203], v[164:167], v[156:159]
    v_add_f32_dpp v253, v253, v253 row_ror:4 row_mask:0xf bank_mask:0xf
    s_waitcnt lgkmcnt(0)
    s_barrier
    v_mfma_f32_16x16x32_bf16 v[88:91], v[212:215], v[204:207], v[88:91]
    ds_read_b128 v[160:163], v3 offset:36864
    v_mfma_f32_16x16x32_bf16 v[92:95], v[212:215], v[208:211], v[92:95]
    ds_read_b128 v[164:167], v3 offset:38912
    v_add_f32_dpp v254, v254, v254 row_ror:4 row_mask:0xf bank_mask:0xf
    v_mfma_f32_16x16x32_bf16 v[96:99], v[216:219], v[204:207], v[96:99]
    ds_read_b128 v[168:171], v1 offset:36864
    v_add_f32_dpp v255, v255, v255 row_ror:4 row_mask:0xf bank_mask:0xf
    v_mfma_f32_16x16x32_bf16 v[100:103], v[216:219], v[208:211], v[100:103]
    ds_read_b128 v[172:175], v1 offset:37888
    v_add_f32_dpp v252, v252, v252 row_ror:8 row_mask:0xf bank_mask:0xf
    v_mfma_f32_16x16x32_bf16 v[104:107], v[220:223], v[204:207], v[104:107]
    ds_read_b128 v[176:179], v1 offset:38912
    v_add_f32_dpp v253, v253, v253 row_ror:8 row_mask:0xf bank_mask:0xf
    v_mfma_f32_16x16x32_bf16 v[108:111], v[220:223], v[208:211], v[108:111]
    ds_read_b128 v[180:183], v1 offset:39936
    v_add_f32_dpp v254, v254, v254 row_ror:8 row_mask:0xf bank_mask:0xf
    v_mfma_f32_16x16x32_bf16 v[112:115], v[224:227], v[204:207], v[112:115]
    ds_read_b128 v[184:187], v1 offset:40960
    v_add_f32_dpp v255, v255, v255 row_ror:8 row_mask:0xf bank_mask:0xf
    v_mfma_f32_16x16x32_bf16 v[116:119], v[224:227], v[208:211], v[116:119]
    ds_read_b128 v[188:191], v1 offset:41984
    v_mfma_f32_16x16x32_bf16 v[120:123], v[228:231], v[204:207], v[120:123]
    ds_read_b128 v[192:195], v1 offset:43008
    v_mul_f32 v252, s44, v252
    v_mfma_f32_16x16x32_bf16 v[124:127], v[228:231], v[208:211], v[124:127]
    ds_read_b128 v[196:199], v1 offset:44032
    v_mul_f32 v253, s44, v253
    v_mfma_f32_16x16x32_bf16 v[128:131], v[232:235], v[204:207], v[128:131]
    ds_read_b128 v[200:203], v1 offset:45056
    v_mul_f32 v254, s44, v254
    v_mfma_f32_16x16x32_bf16 v[132:135], v[232:235], v[208:211], v[132:135]
    v_mul_f32 v255, s44, v255
    v_fma_f32 v253, -v252, v252, v253
    v_mfma_f32_16x16x32_bf16 v[136:139], v[236:239], v[204:207], v[136:139]
    v_fma_f32 v255, -v254, v254, v255
    v_max_f32 v253, 0, v253
    v_mfma_f32_16x16x32_bf16 v[140:143], v[236:239], v[208:211], v[140:143]
    v_max_f32 v255, 0, v255
    v_add_f32 v253, s45, v253
    v_mfma_f32_16x16x32_bf16 v[144:147], v[240:243], v[204:207], v[144:147]
    v_add_f32 v255, s45, v255
    v_rsq_f32 v249, v253
    v_mfma_f32_16x16x32_bf16 v[148:151], v[240:243], v[208:211], v[148:151]
    v_rsq_f32 v253, v255
    s_nop 0
    v_mfma_f32_16x16x32_bf16 v[152:155], v[244:247], v[204:207], v[152:155]
    v_mul_f32 v255, v254, v253
    v_mul_f32 v254, v252, v249
    v_mfma_f32_16x16x32_bf16 v[156:159], v[244:247], v[208:211], v[156:159]
    v_mov_b32 v252, v249
    s_waitcnt lgkmcnt(5)
    v_mfma_f32_16x16x32_bf16 v[88:91], v[168:171], v[160:163], v[88:91]
    ds_read_b128 v[204:207], v3 offset:37888
    v_mfma_f32_16x16x32_bf16 v[92:95], v[168:171], v[164:167], v[92:95]
    ds_read_b128 v[208:211], v3 offset:39936
    s_nop 0
    v_mfma_f32_16x16x32_bf16 v[96:99], v[172:175], v[160:163], v[96:99]
    ds_read_b128 v[212:215], v1 offset:46080
    v_mov_b32_dpp v5, v253 row_newbcast:0 row_mask:0xf bank_mask:0xf
    v_mfma_f32_16x16x32_bf16 v[100:103], v[172:175], v[164:167], v[100:103]
    ds_read_b128 v[216:219], v1 offset:47104
    v_mov_b32_dpp v7, v255 row_newbcast:0 row_mask:0xf bank_mask:0xf
    v_mfma_f32_16x16x32_bf16 v[104:107], v[176:179], v[160:163], v[104:107]
    ds_read_b128 v[220:223], v1 offset:48128
    v_mov_b32_dpp v6, v254 row_newbcast:0 row_mask:0xf bank_mask:0xf
    v_mfma_f32_16x16x32_bf16 v[108:111], v[176:179], v[164:167], v[108:111]
    ds_read_b128 v[224:227], v1 offset:49152
    v_mov_b32_dpp v4, v252 row_newbcast:0 row_mask:0xf bank_mask:0xf
    v_mfma_f32_16x16x32_bf16 v[112:115], v[180:183], v[160:163], v[112:115]
    ds_read_b128 v[228:231], v1 offset:50176
    v_mov_b32_dpp v9, v253 row_newbcast:1 row_mask:0xf bank_mask:0xf
    v_mfma_f32_16x16x32_bf16 v[116:119], v[180:183], v[164:167], v[116:119]
    ds_read_b128 v[232:235], v1 offset:51200
    s_waitcnt lgkmcnt(8)
    v_mfma_f32_16x16x32_bf16 v[120:123], v[184:187], v[160:163], v[120:123]
    ds_read_b128 v[236:239], v1 offset:52224
    v_mov_b32_dpp v11, v255 row_newbcast:1 row_mask:0xf bank_mask:0xf
    v_mfma_f32_16x16x32_bf16 v[124:127], v[184:187], v[164:167], v[124:127]
    ds_read_b128 v[240:243], v1 offset:53248
    v_mov_b32_dpp v10, v254 row_newbcast:1 row_mask:0xf bank_mask:0xf
    v_mfma_f32_16x16x32_bf16 v[128:131], v[188:191], v[160:163], v[128:131]
    ds_read_b128 v[244:247], v1 offset:54272
    v_mov_b32_dpp v8, v252 row_newbcast:1 row_mask:0xf bank_mask:0xf
    v_mfma_f32_16x16x32_bf16 v[132:135], v[188:191], v[164:167], v[132:135]
    v_mov_b32_dpp v13, v253 row_newbcast:2 row_mask:0xf bank_mask:0xf
    v_mov_b32_dpp v15, v255 row_newbcast:2 row_mask:0xf bank_mask:0xf
    v_mfma_f32_16x16x32_bf16 v[136:139], v[192:195], v[160:163], v[136:139]
    v_mov_b32_dpp v14, v254 row_newbcast:2 row_mask:0xf bank_mask:0xf
    v_mov_b32_dpp v12, v252 row_newbcast:2 row_mask:0xf bank_mask:0xf
    v_mfma_f32_16x16x32_bf16 v[140:143], v[192:195], v[164:167], v[140:143]
    v_mov_b32_dpp v253, v253 row_newbcast:3 row_mask:0xf bank_mask:0xf
    v_mov_b32_dpp v255, v255 row_newbcast:3 row_mask:0xf bank_mask:0xf
    v_mfma_f32_16x16x32_bf16 v[144:147], v[196:199], v[160:163], v[144:147]
    v_mov_b32_dpp v254, v254 row_newbcast:3 row_mask:0xf bank_mask:0xf
    v_mov_b32_dpp v252, v252 row_newbcast:3 row_mask:0xf bank_mask:0xf
    v_mfma_f32_16x16x32_bf16 v[148:151], v[196:199], v[164:167], v[148:151]
    v_fma_f32 v16, v16, v4, -v6
    v_fma_f32 v17, v17, v5, -v7
    v_mfma_f32_16x16x32_bf16 v[152:155], v[200:203], v[160:163], v[152:155]
    v_fma_f32 v18, v18, v8, -v10
    v_fma_f32 v19, v19, v9, -v11
    v_mfma_f32_16x16x32_bf16 v[156:159], v[200:203], v[164:167], v[156:159]
    v_fma_f32 v20, v20, v12, -v14
    s_waitcnt lgkmcnt(0)
    s_barrier
    v_mfma_f32_16x16x32_bf16 v[88:91], v[212:215], v[204:207], v[88:91]
    ds_read_b128 v[160:163], v0 offset:0
    v_mfma_f32_16x16x32_bf16 v[92:95], v[212:215], v[208:211], v[92:95]
    ds_read_b128 v[164:167], v0 offset:2048
    v_fma_f32 v21, v21, v13, -v15
    v_mfma_f32_16x16x32_bf16 v[96:99], v[216:219], v[204:207], v[96:99]
    ds_read_b128 v[168:171], v2 offset:0
    v_fma_f32 v22, v22, v252, -v254
    v_mfma_f32_16x16x32_bf16 v[100:103], v[216:219], v[208:211], v[100:103]
    ds_read_b128 v[172:175], v2 offset:1024
    v_fma_f32 v23, v23, v253, -v255
    v_mfma_f32_16x16x32_bf16 v[104:107], v[220:223], v[204:207], v[104:107]
    ds_read_b128 v[176:179], v2 offset:2048
    v_cvt_pk_bf16_f32 v16, v16, v17
    v_mfma_f32_16x16x32_bf16 v[108:111], v[220:223], v[208:211], v[108:111]
    ds_read_b128 v[180:183], v2 offset:3072
    v_cvt_pk_bf16_f32 v17, v18, v19
    v_mfma_f32_16x16x32_bf16 v[112:115], v[224:227], v[204:207], v[112:115]
    ds_read_b128 v[184:187], v2 offset:4096
    v_cvt_pk_bf16_f32 v18, v20, v21
    v_mfma_f32_16x16x32_bf16 v[116:119], v[224:227], v[208:211], v[116:119]
    ds_read_b128 v[188:191], v2 offset:5120
    v_mfma_f32_16x16x32_bf16 v[120:123], v[228:231], v[204:207], v[120:123]
    ds_read_b128 v[192:195], v2 offset:6144
    v_cvt_pk_bf16_f32 v19, v22, v23
    v_mfma_f32_16x16x32_bf16 v[124:127], v[228:231], v[208:211], v[124:127]
    ds_read_b128 v[196:199], v2 offset:7168
    v_fma_f32 v24, v24, v4, -v6
    v_mfma_f32_16x16x32_bf16 v[128:131], v[232:235], v[204:207], v[128:131]
    ds_read_b128 v[200:203], v2 offset:8192
    v_fma_f32 v25, v25, v5, -v7
    v_mfma_f32_16x16x32_bf16 v[132:135], v[232:235], v[208:211], v[132:135]
    v_fma_f32 v26, v26, v8, -v10
    v_fma_f32 v27, v27, v9, -v11
    v_mfma_f32_16x16x32_bf16 v[136:139], v[236:239], v[204:207], v[136:139]
    v_fma_f32 v28, v28, v12, -v14
    v_fma_f32 v29, v29, v13, -v15
    v_mfma_f32_16x16x32_bf16 v[140:143], v[236:239], v[208:211], v[140:143]
    v_fma_f32 v30, v30, v252, -v254
    v_fma_f32 v31, v31, v253, -v255
    v_mfma_f32_16x16x32_bf16 v[144:147], v[240:243], v[204:207], v[144:147]
    v_permlane32_swap_b32 v16, v18
    v_permlane32_swap_b32 v17, v19
    v_mfma_f32_16x16x32_bf16 v[148:151], v[240:243], v[208:211], v[148:151]
    v_cvt_pk_bf16_f32 v24, v24, v25
    v_cvt_pk_bf16_f32 v25, v26, v27
    v_mfma_f32_16x16x32_bf16 v[152:155], v[244:247], v[204:207], v[152:155]
    v_cvt_pk_bf16_f32 v26, v28, v29
    v_cvt_pk_bf16_f32 v27, v30, v31
    v_mfma_f32_16x16x32_bf16 v[156:159], v[244:247], v[208:211], v[156:159]
    v_permlane16_swap_b32 v16, v18
    s_waitcnt lgkmcnt(5)
    v_mfma_f32_16x16x32_bf16 v[88:91], v[168:171], v[160:163], v[88:91]
    ds_read_b128 v[204:207], v0 offset:1024
    v_mfma_f32_16x16x32_bf16 v[92:95], v[168:171], v[164:167], v[92:95]
    ds_read_b128 v[208:211], v0 offset:3072
    v_permlane16_swap_b32 v17, v19
    v_mfma_f32_16x16x32_bf16 v[96:99], v[172:175], v[160:163], v[96:99]
    ds_read_b128 v[212:215], v2 offset:9216
    v_fma_f32 v32, v32, v4, -v6
    v_mfma_f32_16x16x32_bf16 v[100:103], v[172:175], v[164:167], v[100:103]
    ds_read_b128 v[216:219], v2 offset:10240
    v_fma_f32 v33, v33, v5, -v7
    v_mfma_f32_16x16x32_bf16 v[104:107], v[176:179], v[160:163], v[104:107]
    ds_read_b128 v[220:223], v2 offset:11264
    v_fma_f32 v34, v34, v8, -v10
    v_mfma_f32_16x16x32_bf16 v[108:111], v[176:179], v[164:167], v[108:111]
    ds_read_b128 v[224:227], v2 offset:12288
    v_fma_f32 v35, v35, v9, -v11
    v_mfma_f32_16x16x32_bf16 v[112:115], v[180:183], v[160:163], v[112:115]
    ds_read_b128 v[228:231], v2 offset:13312
    v_fma_f32 v36, v36, v12, -v14
    v_mfma_f32_16x16x32_bf16 v[116:119], v[180:183], v[164:167], v[116:119]
    ds_read_b128 v[232:235], v2 offset:14336
    s_waitcnt lgkmcnt(8)
    v_mfma_f32_16x16x32_bf16 v[120:123], v[184:187], v[160:163], v[120:123]
    ds_read_b128 v[236:239], v2 offset:15360
    v_fma_f32 v37, v37, v13, -v15
    v_mfma_f32_16x16x32_bf16 v[124:127], v[184:187], v[164:167], v[124:127]
    ds_read_b128 v[240:243], v2 offset:16384
    v_fma_f32 v38, v38, v252, -v254
    v_mfma_f32_16x16x32_bf16 v[128:131], v[188:191], v[160:163], v[128:131]
    ds_read_b128 v[244:247], v2 offset:17408
    v_fma_f32 v39, v39, v253, -v255
    v_mfma_f32_16x16x32_bf16 v[132:135], v[188:191], v[164:167], v[132:135]
    v_permlane32_swap_b32 v24, v26
    v_permlane32_swap_b32 v25, v27
    v_mfma_f32_16x16x32_bf16 v[136:139], v[192:195], v[160:163], v[136:139]
    v_cvt_pk_bf16_f32 v32, v32, v33
    v_cvt_pk_bf16_f32 v33, v34, v35
    v_mfma_f32_16x16x32_bf16 v[140:143], v[192:195], v[164:167], v[140:143]
    v_cvt_pk_bf16_f32 v34, v36, v37
    v_cvt_pk_bf16_f32 v35, v38, v39
    v_mfma_f32_16x16x32_bf16 v[144:147], v[196:199], v[160:163], v[144:147]
    v_permlane16_swap_b32 v24, v26
    v_permlane16_swap_b32 v25, v27
    v_mfma_f32_16x16x32_bf16 v[148:151], v[196:199], v[164:167], v[148:151]
    v_fma_f32 v40, v40, v4, -v6
    v_fma_f32 v41, v41, v5, -v7
    v_mfma_f32_16x16x32_bf16 v[152:155], v[200:203], v[160:163], v[152:155]
    v_fma_f32 v42, v42, v8, -v10
    v_fma_f32 v43, v43, v9, -v11
    v_mfma_f32_16x16x32_bf16 v[156:159], v[200:203], v[164:167], v[156:159]
    v_fma_f32 v44, v44, v12, -v14
    s_waitcnt lgkmcnt(0)
    s_barrier
    v_mfma_f32_16x16x32_bf16 v[88:91], v[212:215], v[204:207], v[88:91]
    ds_read_b128 v[160:163], v0 offset:36864
    v_mfma_f32_16x16x32_bf16 v[92:95], v[212:215], v[208:211], v[92:95]
    ds_read_b128 v[164:167], v0 offset:38912
    v_fma_f32 v45, v45, v13, -v15
    v_mfma_f32_16x16x32_bf16 v[96:99], v[216:219], v[204:207], v[96:99]
    ds_read_b128 v[168:171], v2 offset:36864
    v_fma_f32 v46, v46, v252, -v254
    v_mfma_f32_16x16x32_bf16 v[100:103], v[216:219], v[208:211], v[100:103]
    ds_read_b128 v[172:175], v2 offset:37888
    v_fma_f32 v47, v47, v253, -v255
    v_mfma_f32_16x16x32_bf16 v[104:107], v[220:223], v[204:207], v[104:107]
    ds_read_b128 v[176:179], v2 offset:38912
    v_permlane32_swap_b32 v32, v34
    v_mfma_f32_16x16x32_bf16 v[108:111], v[220:223], v[208:211], v[108:111]
    ds_read_b128 v[180:183], v2 offset:39936
    v_permlane32_swap_b32 v33, v35
    v_mfma_f32_16x16x32_bf16 v[112:115], v[224:227], v[204:207], v[112:115]
    ds_read_b128 v[184:187], v2 offset:40960
    v_cvt_pk_bf16_f32 v40, v40, v41
    v_mfma_f32_16x16x32_bf16 v[116:119], v[224:227], v[208:211], v[116:119]
    ds_read_b128 v[188:191], v2 offset:41984
    v_mfma_f32_16x16x32_bf16 v[120:123], v[228:231], v[204:207], v[120:123]
    ds_read_b128 v[192:195], v2 offset:43008
    v_cvt_pk_bf16_f32 v41, v42, v43
    v_mfma_f32_16x16x32_bf16 v[124:127], v[228:231], v[208:211], v[124:127]
    ds_read_b128 v[196:199], v2 offset:44032
    v_cvt_pk_bf16_f32 v42, v44, v45
    v_mfma_f32_16x16x32_bf16 v[128:131], v[232:235], v[204:207], v[128:131]
    ds_read_b128 v[200:203], v2 offset:45056
    v_cvt_pk_bf16_f32 v43, v46, v47
    v_mfma_f32_16x16x32_bf16 v[132:135], v[232:235], v[208:211], v[132:135]
    v_permlane16_swap_b32 v32, v34
    v_permlane16_swap_b32 v33, v35
    v_mfma_f32_16x16x32_bf16 v[136:139], v[236:239], v[204:207], v[136:139]
    v_fma_f32 v48, v48, v4, -v6
    v_fma_f32 v49, v49, v5, -v7
    v_mfma_f32_16x16x32_bf16 v[140:143], v[236:239], v[208:211], v[140:143]
    v_fma_f32 v50, v50, v8, -v10
    v_fma_f32 v51, v51, v9, -v11
    v_mfma_f32_16x16x32_bf16 v[144:147], v[240:243], v[204:207], v[144:147]
    v_fma_f32 v52, v52, v12, -v14
    v_fma_f32 v53, v53, v13, -v15
    v_mfma_f32_16x16x32_bf16 v[148:151], v[240:243], v[208:211], v[148:151]
    v_fma_f32 v54, v54, v252, -v254
    v_fma_f32 v55, v55, v253, -v255
    v_mfma_f32_16x16x32_bf16 v[152:155], v[244:247], v[204:207], v[152:155]
    v_permlane32_swap_b32 v40, v42
    v_permlane32_swap_b32 v41, v43
    v_mfma_f32_16x16x32_bf16 v[156:159], v[244:247], v[208:211], v[156:159]
    v_cvt_pk_bf16_f32 v48, v48, v49
    s_waitcnt lgkmcnt(5)
    v_mfma_f32_16x16x32_bf16 v[88:91], v[168:171], v[160:163], v[88:91]
    ds_read_b128 v[204:207], v0 offset:37888
    v_mfma_f32_16x16x32_bf16 v[92:95], v[168:171], v[164:167], v[92:95]
    ds_read_b128 v[208:211], v0 offset:39936
    v_cvt_pk_bf16_f32 v49, v50, v51
    v_mfma_f32_16x16x32_bf16 v[96:99], v[172:175], v[160:163], v[96:99]
    ds_read_b128 v[212:215], v2 offset:46080
    buffer_store_dwordx4 v[16:19], v1, s[4:7], s38 offen offset:0 sc1
    v_cvt_pk_bf16_f32 v50, v52, v53
    v_mfma_f32_16x16x32_bf16 v[100:103], v[172:175], v[164:167], v[100:103]
    ds_read_b128 v[216:219], v2 offset:47104
    v_cvt_pk_bf16_f32 v51, v54, v55
    v_mfma_f32_16x16x32_bf16 v[104:107], v[176:179], v[160:163], v[104:107]
    ds_read_b128 v[220:223], v2 offset:48128
    v_permlane16_swap_b32 v40, v42
    v_mfma_f32_16x16x32_bf16 v[108:111], v[176:179], v[164:167], v[108:111]
    ds_read_b128 v[224:227], v2 offset:49152
    v_permlane16_swap_b32 v41, v43
    v_mfma_f32_16x16x32_bf16 v[112:115], v[180:183], v[160:163], v[112:115]
    ds_read_b128 v[228:231], v2 offset:50176
    v_fma_f32 v56, v56, v4, -v6
    v_mfma_f32_16x16x32_bf16 v[116:119], v[180:183], v[164:167], v[116:119]
    ds_read_b128 v[232:235], v2 offset:51200
    s_waitcnt lgkmcnt(8)
    buffer_store_dwordx4 v[24:27], v1, s[4:7], s38 offen offset:1024 sc1
    v_mfma_f32_16x16x32_bf16 v[120:123], v[184:187], v[160:163], v[120:123]
    ds_read_b128 v[236:239], v2 offset:52224
    v_fma_f32 v57, v57, v5, -v7
    v_mfma_f32_16x16x32_bf16 v[124:127], v[184:187], v[164:167], v[124:127]
    ds_read_b128 v[240:243], v2 offset:53248
    v_fma_f32 v58, v58, v8, -v10
    v_mfma_f32_16x16x32_bf16 v[128:131], v[188:191], v[160:163], v[128:131]
    ds_read_b128 v[244:247], v2 offset:54272
    v_fma_f32 v59, v59, v9, -v11
    v_mfma_f32_16x16x32_bf16 v[132:135], v[188:191], v[164:167], v[132:135]
    v_fma_f32 v60, v60, v12, -v14
    v_fma_f32 v61, v61, v13, -v15
    v_mfma_f32_16x16x32_bf16 v[136:139], v[192:195], v[160:163], v[136:139]
    buffer_store_dwordx4 v[32:35], v1, s[4:7], s38 offen offset:2048 sc1
    v_fma_f32 v62, v62, v252, -v254
    v_fma_f32 v63, v63, v253, -v255
    v_mfma_f32_16x16x32_bf16 v[140:143], v[192:195], v[164:167], v[140:143]
    v_permlane32_swap_b32 v48, v50
    v_permlane32_swap_b32 v49, v51
    v_mfma_f32_16x16x32_bf16 v[144:147], v[196:199], v[160:163], v[144:147]
    v_cvt_pk_bf16_f32 v56, v56, v57
    v_cvt_pk_bf16_f32 v57, v58, v59
    v_mfma_f32_16x16x32_bf16 v[148:151], v[196:199], v[164:167], v[148:151]
    v_cvt_pk_bf16_f32 v58, v60, v61
    v_cvt_pk_bf16_f32 v59, v62, v63
    v_mfma_f32_16x16x32_bf16 v[152:155], v[200:203], v[160:163], v[152:155]
    v_permlane16_swap_b32 v48, v50
    v_permlane16_swap_b32 v49, v51
    v_mfma_f32_16x16x32_bf16 v[156:159], v[200:203], v[164:167], v[156:159]
    v_fma_f32 v64, v64, v4, -v6
    s_waitcnt lgkmcnt(0)
    s_barrier
    v_mfma_f32_16x16x32_bf16 v[88:91], v[212:215], v[204:207], v[88:91]
    ds_read_b128 v[160:163], v3 offset:0
    v_mfma_f32_16x16x32_bf16 v[92:95], v[212:215], v[208:211], v[92:95]
    ds_read_b128 v[164:167], v3 offset:2048
    v_fma_f32 v65, v65, v5, -v7
    v_mfma_f32_16x16x32_bf16 v[96:99], v[216:219], v[204:207], v[96:99]
    ds_read_b128 v[168:171], v1 offset:0
    buffer_store_dwordx4 v[40:43], v1, s[4:7], s38 offen offset:3072 sc1
    v_fma_f32 v66, v66, v8, -v10
    v_mfma_f32_16x16x32_bf16 v[100:103], v[216:219], v[208:211], v[100:103]
    ds_read_b128 v[172:175], v1 offset:1024
    v_fma_f32 v67, v67, v9, -v11
    v_mfma_f32_16x16x32_bf16 v[104:107], v[220:223], v[204:207], v[104:107]
    ds_read_b128 v[176:179], v1 offset:2048
    v_fma_f32 v68, v68, v12, -v14
    v_mfma_f32_16x16x32_bf16 v[108:111], v[220:223], v[208:211], v[108:111]
    ds_read_b128 v[180:183], v1 offset:3072
    v_fma_f32 v69, v69, v13, -v15
    v_mfma_f32_16x16x32_bf16 v[112:115], v[224:227], v[204:207], v[112:115]
    ds_read_b128 v[184:187], v1 offset:4096
    v_fma_f32 v70, v70, v252, -v254
    v_mfma_f32_16x16x32_bf16 v[116:119], v[224:227], v[208:211], v[116:119]
    ds_read_b128 v[188:191], v1 offset:5120
    buffer_store_dwordx4 v[48:51], v1, s[4:7], s39 offen offset:0 sc1
    v_mfma_f32_16x16x32_bf16 v[120:123], v[228:231], v[204:207], v[120:123]
    ds_read_b128 v[192:195], v1 offset:6144
    v_fma_f32 v71, v71, v253, -v255
    v_mfma_f32_16x16x32_bf16 v[124:127], v[228:231], v[208:211], v[124:127]
    ds_read_b128 v[196:199], v1 offset:7168
    v_permlane32_swap_b32 v56, v58
    v_mfma_f32_16x16x32_bf16 v[128:131], v[232:235], v[204:207], v[128:131]
    ds_read_b128 v[200:203], v1 offset:8192
    v_permlane32_swap_b32 v57, v59
    v_mfma_f32_16x16x32_bf16 v[132:135], v[232:235], v[208:211], v[132:135]
    v_cvt_pk_bf16_f32 v64, v64, v65
    v_cvt_pk_bf16_f32 v65, v66, v67
    v_mfma_f32_16x16x32_bf16 v[136:139], v[236:239], v[204:207], v[136:139]
    v_cvt_pk_bf16_f32 v66, v68, v69
    v_cvt_pk_bf16_f32 v67, v70, v71
    v_mfma_f32_16x16x32_bf16 v[140:143], v[236:239], v[208:211], v[140:143]
    v_permlane16_swap_b32 v56, v58
    v_permlane16_swap_b32 v57, v59
    v_mfma_f32_16x16x32_bf16 v[144:147], v[240:243], v[204:207], v[144:147]
    v_fma_f32 v72, v72, v4, -v6
    v_fma_f32 v73, v73, v5, -v7
    v_mfma_f32_16x16x32_bf16 v[148:151], v[240:243], v[208:211], v[148:151]
    v_fma_f32 v74, v74, v8, -v10
    v_fma_f32 v75, v75, v9, -v11
    v_mfma_f32_16x16x32_bf16 v[152:155], v[244:247], v[204:207], v[152:155]
    v_fma_f32 v76, v76, v12, -v14
    v_fma_f32 v77, v77, v13, -v15
    v_mfma_f32_16x16x32_bf16 v[156:159], v[244:247], v[208:211], v[156:159]
    v_fma_f32 v78, v78, v252, -v254
    s_waitcnt lgkmcnt(5)
    v_mfma_f32_16x16x32_bf16 v[88:91], v[168:171], v[160:163], v[88:91]
    ds_read_b128 v[204:207], v3 offset:1024
    v_mfma_f32_16x16x32_bf16 v[92:95], v[168:171], v[164:167], v[92:95]
    ds_read_b128 v[208:211], v3 offset:3072
    v_fma_f32 v79, v79, v253, -v255
    v_mfma_f32_16x16x32_bf16 v[96:99], v[172:175], v[160:163], v[96:99]
    ds_read_b128 v[212:215], v1 offset:9216
    buffer_store_dwordx4 v[56:59], v1, s[4:7], s39 offen offset:1024 sc1
    v_permlane32_swap_b32 v64, v66
    v_mfma_f32_16x16x32_bf16 v[100:103], v[172:175], v[164:167], v[100:103]
    ds_read_b128 v[216:219], v1 offset:10240
    v_permlane32_swap_b32 v65, v67
    v_mfma_f32_16x16x32_bf16 v[104:107], v[176:179], v[160:163], v[104:107]
    ds_read_b128 v[220:223], v1 offset:11264
    v_cvt_pk_bf16_f32 v72, v72, v73
    v_mfma_f32_16x16x32_bf16 v[108:111], v[176:179], v[164:167], v[108:111]
    ds_read_b128 v[224:227], v1 offset:12288
    v_cvt_pk_bf16_f32 v73, v74, v75
    v_mfma_f32_16x16x32_bf16 v[112:115], v[180:183], v[160:163], v[112:115]
    ds_read_b128 v[228:231], v1 offset:13312
    v_cvt_pk_bf16_f32 v74, v76, v77
    v_mfma_f32_16x16x32_bf16 v[116:119], v[180:183], v[164:167], v[116:119]
    ds_read_b128 v[232:235], v1 offset:14336
    s_waitcnt lgkmcnt(8)
    v_mfma_f32_16x16x32_bf16 v[120:123], v[184:187], v[160:163], v[120:123]
    ds_read_b128 v[236:239], v1 offset:15360
    v_cvt_pk_bf16_f32 v75, v78, v79
    v_mfma_f32_16x16x32_bf16 v[124:127], v[184:187], v[164:167], v[124:127]
    ds_read_b128 v[240:243], v1 offset:16384
    v_permlane16_swap_b32 v64, v66
    v_mfma_f32_16x16x32_bf16 v[128:131], v[188:191], v[160:163], v[128:131]
    ds_read_b128 v[244:247], v1 offset:17408
    v_permlane16_swap_b32 v65, v67
    v_mfma_f32_16x16x32_bf16 v[132:135], v[188:191], v[164:167], v[132:135]
    v_fma_f32 v80, v80, v4, -v6
    v_fma_f32 v81, v81, v5, -v7
    v_mfma_f32_16x16x32_bf16 v[136:139], v[192:195], v[160:163], v[136:139]
    v_fma_f32 v82, v82, v8, -v10
    v_fma_f32 v83, v83, v9, -v11
    v_mfma_f32_16x16x32_bf16 v[140:143], v[192:195], v[164:167], v[140:143]
    v_fma_f32 v84, v84, v12, -v14
    v_fma_f32 v85, v85, v13, -v15
    v_mfma_f32_16x16x32_bf16 v[144:147], v[196:199], v[160:163], v[144:147]
    v_fma_f32 v86, v86, v252, -v254
    v_fma_f32 v87, v87, v253, -v255
    v_mfma_f32_16x16x32_bf16 v[148:151], v[196:199], v[164:167], v[148:151]
    v_permlane32_swap_b32 v72, v74
    v_permlane32_swap_b32 v73, v75
    v_mfma_f32_16x16x32_bf16 v[152:155], v[200:203], v[160:163], v[152:155]
    v_cvt_pk_bf16_f32 v80, v80, v81
    v_cvt_pk_bf16_f32 v81, v82, v83
    v_mfma_f32_16x16x32_bf16 v[156:159], v[200:203], v[164:167], v[156:159]
    v_cvt_pk_bf16_f32 v82, v84, v85
    s_waitcnt lgkmcnt(0)
    s_barrier
    v_mfma_f32_16x16x32_bf16 v[88:91], v[212:215], v[204:207], v[88:91]
    ds_read_b128 v[160:163], v3 offset:36864
    v_mfma_f32_16x16x32_bf16 v[92:95], v[212:215], v[208:211], v[92:95]
    ds_read_b128 v[164:167], v3 offset:38912
    v_cvt_pk_bf16_f32 v83, v86, v87
    v_mfma_f32_16x16x32_bf16 v[96:99], v[216:219], v[204:207], v[96:99]
    ds_read_b128 v[168:171], v1 offset:36864
    buffer_store_dwordx4 v[64:67], v1, s[4:7], s39 offen offset:2048 sc1
    v_permlane16_swap_b32 v72, v74
    v_mfma_f32_16x16x32_bf16 v[100:103], v[216:219], v[208:211], v[100:103]
    ds_read_b128 v[172:175], v1 offset:37888
    v_permlane16_swap_b32 v73, v75
    v_mfma_f32_16x16x32_bf16 v[104:107], v[220:223], v[204:207], v[104:107]
    ds_read_b128 v[176:179], v1 offset:38912
    s_nop 0
    v_mfma_f32_16x16x32_bf16 v[108:111], v[220:223], v[208:211], v[108:111]
    ds_read_b128 v[180:183], v1 offset:39936
    v_permlane32_swap_b32 v80, v82
    v_mfma_f32_16x16x32_bf16 v[112:115], v[224:227], v[204:207], v[112:115]
    ds_read_b128 v[184:187], v1 offset:40960
    v_permlane32_swap_b32 v81, v83
    v_mfma_f32_16x16x32_bf16 v[116:119], v[224:227], v[208:211], v[116:119]
    ds_read_b128 v[188:191], v1 offset:41984
    v_mfma_f32_16x16x32_bf16 v[120:123], v[228:231], v[204:207], v[120:123]
    ds_read_b128 v[192:195], v1 offset:43008
    s_nop 0
    v_mfma_f32_16x16x32_bf16 v[124:127], v[228:231], v[208:211], v[124:127]
    ds_read_b128 v[196:199], v1 offset:44032
    v_permlane16_swap_b32 v80, v82
    v_mfma_f32_16x16x32_bf16 v[128:131], v[232:235], v[204:207], v[128:131]
    ds_read_b128 v[200:203], v1 offset:45056
    v_permlane16_swap_b32 v81, v83
    v_mfma_f32_16x16x32_bf16 v[132:135], v[232:235], v[208:211], v[132:135]
    v_mfma_f32_16x16x32_bf16 v[136:139], v[236:239], v[204:207], v[136:139]
    v_mfma_f32_16x16x32_bf16 v[140:143], v[236:239], v[208:211], v[140:143]
    v_mfma_f32_16x16x32_bf16 v[144:147], v[240:243], v[204:207], v[144:147]
    v_mfma_f32_16x16x32_bf16 v[148:151], v[240:243], v[208:211], v[148:151]
    v_mfma_f32_16x16x32_bf16 v[152:155], v[244:247], v[204:207], v[152:155]
    v_mfma_f32_16x16x32_bf16 v[156:159], v[244:247], v[208:211], v[156:159]
    s_waitcnt lgkmcnt(5)
    v_mfma_f32_16x16x32_bf16 v[88:91], v[168:171], v[160:163], v[88:91]
    ds_read_b128 v[204:207], v3 offset:37888
    v_mfma_f32_16x16x32_bf16 v[92:95], v[168:171], v[164:167], v[92:95]
    ds_read_b128 v[208:211], v3 offset:39936
    v_mfma_f32_16x16x32_bf16 v[96:99], v[172:175], v[160:163], v[96:99]
    ds_read_b128 v[212:215], v1 offset:46080
    buffer_store_dwordx4 v[72:75], v1, s[4:7], s39 offen offset:3072 sc1
    v_mfma_f32_16x16x32_bf16 v[100:103], v[172:175], v[164:167], v[100:103]
    ds_read_b128 v[216:219], v1 offset:47104
    v_mfma_f32_16x16x32_bf16 v[104:107], v[176:179], v[160:163], v[104:107]
    ds_read_b128 v[220:223], v1 offset:48128
    v_mfma_f32_16x16x32_bf16 v[108:111], v[176:179], v[164:167], v[108:111]
    ds_read_b128 v[224:227], v1 offset:49152
    v_mfma_f32_16x16x32_bf16 v[112:115], v[180:183], v[160:163], v[112:115]
    ds_read_b128 v[228:231], v1 offset:50176
    v_mfma_f32_16x16x32_bf16 v[116:119], v[180:183], v[164:167], v[116:119]
    ds_read_b128 v[232:235], v1 offset:51200
    s_waitcnt lgkmcnt(8)
    buffer_store_dwordx4 v[80:83], v1, s[4:7], s46 offen offset:0 sc1
    v_mfma_f32_16x16x32_bf16 v[120:123], v[184:187], v[160:163], v[120:123]
    ds_read_b128 v[236:239], v1 offset:52224
    v_mfma_f32_16x16x32_bf16 v[124:127], v[184:187], v[164:167], v[124:127]
    ds_read_b128 v[240:243], v1 offset:53248
    v_mfma_f32_16x16x32_bf16 v[128:131], v[188:191], v[160:163], v[128:131]
    ds_read_b128 v[244:247], v1 offset:54272
    v_mfma_f32_16x16x32_bf16 v[132:135], v[188:191], v[164:167], v[132:135]
    v_mfma_f32_16x16x32_bf16 v[136:139], v[192:195], v[160:163], v[136:139]
    v_lshrrev_b32 v0, 4, v1
    v_mfma_f32_16x16x32_bf16 v[140:143], v[192:195], v[164:167], v[140:143]
    v_and_b32 v0, 48, v0
    v_mfma_f32_16x16x32_bf16 v[144:147], v[196:199], v[160:163], v[144:147]
    v_add_u32 v0, 160320, v0
    v_mfma_f32_16x16x32_bf16 v[148:151], v[196:199], v[164:167], v[148:151]
    v_mfma_f32_16x16x32_bf16 v[152:155], v[200:203], v[160:163], v[152:155]
    v_mfma_f32_16x16x32_bf16 v[156:159], v[200:203], v[164:167], v[156:159]
    s_waitcnt lgkmcnt(0)
    v_mfma_f32_16x16x32_bf16 v[88:91], v[212:215], v[204:207], v[88:91]
    ds_read_b128 v[168:171], v0 offset:0
    v_mfma_f32_16x16x32_bf16 v[92:95], v[212:215], v[208:211], v[92:95]
    ds_read_b128 v[172:175], v0 offset:64
    v_mfma_f32_16x16x32_bf16 v[96:99], v[216:219], v[204:207], v[96:99]
    ds_read_b128 v[176:179], v0 offset:128
    v_mfma_f32_16x16x32_bf16 v[100:103], v[216:219], v[208:211], v[100:103]
    ds_read_b128 v[180:183], v0 offset:192
    v_mfma_f32_16x16x32_bf16 v[104:107], v[220:223], v[204:207], v[104:107]
    ds_read_b128 v[184:187], v0 offset:256
    v_mfma_f32_16x16x32_bf16 v[108:111], v[220:223], v[208:211], v[108:111]
    ds_read_b128 v[188:191], v0 offset:320
    v_mfma_f32_16x16x32_bf16 v[112:115], v[224:227], v[204:207], v[112:115]
    ds_read_b128 v[192:195], v0 offset:384
    v_mfma_f32_16x16x32_bf16 v[116:119], v[224:227], v[208:211], v[116:119]
    ds_read_b128 v[196:199], v0 offset:448
    v_mfma_f32_16x16x32_bf16 v[120:123], v[228:231], v[204:207], v[120:123]
    ds_read_b128 v[200:203], v0 offset:512
    v_mfma_f32_16x16x32_bf16 v[124:127], v[228:231], v[208:211], v[124:127]
    v_mfma_f32_16x16x32_bf16 v[128:131], v[232:235], v[204:207], v[128:131]
    v_mfma_f32_16x16x32_bf16 v[132:135], v[232:235], v[208:211], v[132:135]
    v_mfma_f32_16x16x32_bf16 v[136:139], v[236:239], v[204:207], v[136:139]
    v_mfma_f32_16x16x32_bf16 v[140:143], v[236:239], v[208:211], v[140:143]
    v_mfma_f32_16x16x32_bf16 v[144:147], v[240:243], v[204:207], v[144:147]
    v_mfma_f32_16x16x32_bf16 v[148:151], v[240:243], v[208:211], v[148:151]
    v_mfma_f32_16x16x32_bf16 v[152:155], v[244:247], v[204:207], v[152:155]
    v_mfma_f32_16x16x32_bf16 v[156:159], v[244:247], v[208:211], v[156:159]
    v_bfe_u32 v8, v1, 4, 4
    v_lshl_add_u32 v8, v8, 2, s33
    ds_read2_b32 v[4:5], v8 offset0:32 offset1:48
    v_bfe_u32 v8, v1, 4, 4
    s_lshl_b32 s33, s31, 5
    v_lshl_add_u32 v8, v8, 1, s33
    buffer_load_ushort v252, v8, s[12:15], 0 offen
    buffer_load_ushort v254, v8, s[12:15], 0 offen offset:32
    s_waitcnt lgkmcnt(0)
    v_rcp_f32 v249, v4
    v_rcp_f32 v251, v5
    v_mul_f32 v6, s40, v5
    v_mul_f32 v7, v5, v5
    v_mul_f32 v5, v4, v4
    v_mul_f32 v4, s40, v4
    v_mul_f32 v5, s42, v5
    v_mul_f32 v7, s42, v7
    v_mul_f32 v5, v5, v4
    v_mul_f32 v7, v7, v6
    v_pk_fma_f32 v[88:89], v[248:249], v[168:169], v[88:89] op_sel_hi:[0,1,1] neg_lo:[1,0,0] neg_hi:[1,0,0]
    v_pk_fma_f32 v[90:91], v[248:249], v[170:171], v[90:91] op_sel_hi:[0,1,1] neg_lo:[1,0,0] neg_hi:[1,0,0]
    v_pk_fma_f32 v[92:93], v[250:251], v[168:169], v[92:93] op_sel_hi:[0,1,1] neg_lo:[1,0,0] neg_hi:[1,0,0]
    v_pk_fma_f32 v[94:95], v[250:251], v[170:171], v[94:95] op_sel_hi:[0,1,1] neg_lo:[1,0,0] neg_hi:[1,0,0]
    v_pk_mul_f32 v[160:161], v[88:89], v[88:89]
    v_pk_mul_f32 v[162:163], v[90:91], v[90:91]
    v_pk_mul_f32 v[164:165], v[92:93], v[92:93]
    v_pk_mul_f32 v[166:167], v[94:95], v[94:95]
    v_pk_fma_f32 v[160:161], v[160:161], v[4:5], v[4:5] op_sel:[0,1,0] op_sel_hi:[1,1,0]
    v_pk_fma_f32 v[162:163], v[162:163], v[4:5], v[4:5] op_sel:[0,1,0] op_sel_hi:[1,1,0]
    v_pk_fma_f32 v[164:165], v[164:165], v[6:7], v[6:7] op_sel:[0,1,0] op_sel_hi:[1,1,0]
    v_pk_fma_f32 v[166:167], v[166:167], v[6:7], v[6:7] op_sel:[0,1,0] op_sel_hi:[1,1,0]
    v_pk_mul_f32 v[160:161], v[160:161], v[88:89]
    v_pk_mul_f32 v[162:163], v[162:163], v[90:91]
    v_pk_mul_f32 v[164:165], v[164:165], v[92:93]
    v_pk_mul_f32 v[166:167], v[166:167], v[94:95]
    v_exp_f32 v160, v160
    v_exp_f32 v161, v161
    v_exp_f32 v162, v162
    v_exp_f32 v163, v163
    v_exp_f32 v164, v164
    v_exp_f32 v165, v165
    v_exp_f32 v166, v166
    v_exp_f32 v167, v167
    v_pk_fma_f32 v[160:161], v[160:161], v[248:249], v[248:249] op_sel:[0,1,1] op_sel_hi:[1,1,1]
    v_pk_fma_f32 v[162:163], v[162:163], v[248:249], v[248:249] op_sel:[0,1,1] op_sel_hi:[1,1,1]
    v_pk_fma_f32 v[164:165], v[164:165], v[250:251], v[250:251] op_sel:[0,1,1] op_sel_hi:[1,1,1]
    v_pk_fma_f32 v[166:167], v[166:167], v[250:251], v[250:251] op_sel:[0,1,1] op_sel_hi:[1,1,1]
    v_rcp_f32 v160, v160
    v_rcp_f32 v161, v161
    v_rcp_f32 v162, v162
    v_rcp_f32 v163, v163
    v_rcp_f32 v164, v164
    v_rcp_f32 v165, v165
    v_rcp_f32 v166, v166
    v_rcp_f32 v167, v167
    v_pk_mul_f32 v[88:89], v[88:89], v[160:161]
    v_pk_mul_f32 v[90:91], v[90:91], v[162:163]
    v_pk_mul_f32 v[92:93], v[92:93], v[164:165]
    v_pk_mul_f32 v[94:95], v[94:95], v[166:167]
    s_waitcnt vmcnt(2)
    s_barrier
    v_pk_fma_f32 v[96:97], v[248:249], v[172:173], v[96:97] op_sel_hi:[0,1,1] neg_lo:[1,0,0] neg_hi:[1,0,0]
    v_pk_fma_f32 v[98:99], v[248:249], v[174:175], v[98:99] op_sel_hi:[0,1,1] neg_lo:[1,0,0] neg_hi:[1,0,0]
    v_pk_fma_f32 v[100:101], v[250:251], v[172:173], v[100:101] op_sel_hi:[0,1,1] neg_lo:[1,0,0] neg_hi:[1,0,0]
    v_pk_fma_f32 v[102:103], v[250:251], v[174:175], v[102:103] op_sel_hi:[0,1,1] neg_lo:[1,0,0] neg_hi:[1,0,0]
    v_pk_mul_f32 v[204:205], v[96:97], v[96:97]
    v_pk_mul_f32 v[206:207], v[98:99], v[98:99]
    v_pk_mul_f32 v[208:209], v[100:101], v[100:101]
    v_pk_mul_f32 v[210:211], v[102:103], v[102:103]
    v_pk_fma_f32 v[204:205], v[204:205], v[4:5], v[4:5] op_sel:[0,1,0] op_sel_hi:[1,1,0]
    v_pk_fma_f32 v[206:207], v[206:207], v[4:5], v[4:5] op_sel:[0,1,0] op_sel_hi:[1,1,0]
    v_pk_fma_f32 v[208:209], v[208:209], v[6:7], v[6:7] op_sel:[0,1,0] op_sel_hi:[1,1,0]
    v_pk_fma_f32 v[210:211], v[210:211], v[6:7], v[6:7] op_sel:[0,1,0] op_sel_hi:[1,1,0]
    v_pk_mul_f32 v[204:205], v[204:205], v[96:97]
    v_pk_mul_f32 v[206:207], v[206:207], v[98:99]
    v_pk_mul_f32 v[208:209], v[208:209], v[100:101]
    v_pk_mul_f32 v[210:211], v[210:211], v[102:103]
    v_exp_f32 v204, v204
    v_exp_f32 v205, v205
    v_exp_f32 v206, v206
    v_exp_f32 v207, v207
    v_exp_f32 v208, v208
    v_exp_f32 v209, v209
    v_exp_f32 v210, v210
    v_exp_f32 v211, v211
    v_pk_fma_f32 v[204:205], v[204:205], v[248:249], v[248:249] op_sel:[0,1,1] op_sel_hi:[1,1,1]
    v_pk_fma_f32 v[206:207], v[206:207], v[248:249], v[248:249] op_sel:[0,1,1] op_sel_hi:[1,1,1]
    v_pk_fma_f32 v[208:209], v[208:209], v[250:251], v[250:251] op_sel:[0,1,1] op_sel_hi:[1,1,1]
    v_pk_fma_f32 v[210:211], v[210:211], v[250:251], v[250:251] op_sel:[0,1,1] op_sel_hi:[1,1,1]
    v_rcp_f32 v204, v204
    v_rcp_f32 v205, v205
    v_rcp_f32 v206, v206
    v_rcp_f32 v207, v207
    v_rcp_f32 v208, v208
    v_rcp_f32 v209, v209
    v_rcp_f32 v210, v210
    v_rcp_f32 v211, v211
    v_pk_mul_f32 v[96:97], v[96:97], v[204:205]
    v_pk_mul_f32 v[98:99], v[98:99], v[206:207]
    v_pk_mul_f32 v[100:101], v[100:101], v[208:209]
    v_pk_mul_f32 v[102:103], v[102:103], v[210:211]
    v_pk_fma_f32 v[104:105], v[248:249], v[176:177], v[104:105] op_sel_hi:[0,1,1] neg_lo:[1,0,0] neg_hi:[1,0,0]
    v_pk_fma_f32 v[106:107], v[248:249], v[178:179], v[106:107] op_sel_hi:[0,1,1] neg_lo:[1,0,0] neg_hi:[1,0,0]
    v_pk_fma_f32 v[108:109], v[250:251], v[176:177], v[108:109] op_sel_hi:[0,1,1] neg_lo:[1,0,0] neg_hi:[1,0,0]
    v_pk_fma_f32 v[110:111], v[250:251], v[178:179], v[110:111] op_sel_hi:[0,1,1] neg_lo:[1,0,0] neg_hi:[1,0,0]
    v_pk_mul_f32 v[160:161], v[104:105], v[104:105]
    v_pk_mul_f32 v[162:163], v[106:107], v[106:107]
    v_pk_mul_f32 v[164:165], v[108:109], v[108:109]
    v_pk_mul_f32 v[166:167], v[110:111], v[110:111]
    v_pk_fma_f32 v[160:161], v[160:161], v[4:5], v[4:5] op_sel:[0,1,0] op_sel_hi:[1,1,0]
    v_pk_fma_f32 v[162:163], v[162:163], v[4:5], v[4:5] op_sel:[0,1,0] op_sel_hi:[1,1,0]
    v_pk_fma_f32 v[164:165], v[164:165], v[6:7], v[6:7] op_sel:[0,1,0] op_sel_hi:[1,1,0]
    v_pk_fma_f32 v[166:167], v[166:167], v[6:7], v[6:7] op_sel:[0,1,0] op_sel_hi:[1,1,0]
    v_pk_mul_f32 v[160:161], v[160:161], v[104:105]
    v_pk_mul_f32 v[162:163], v[162:163], v[106:107]
    v_pk_mul_f32 v[164:165], v[164:165], v[108:109]
    v_pk_mul_f32 v[166:167], v[166:167], v[110:111]
    v_exp_f32 v160, v160
    v_exp_f32 v161, v161
    v_exp_f32 v162, v162
    v_exp_f32 v163, v163
    v_exp_f32 v164, v164
    v_exp_f32 v165, v165
    v_exp_f32 v166, v166
    v_exp_f32 v167, v167
    v_pk_fma_f32 v[160:161], v[160:161], v[248:249], v[248:249] op_sel:[0,1,1] op_sel_hi:[1,1,1]
    v_pk_fma_f32 v[162:163], v[162:163], v[248:249], v[248:249] op_sel:[0,1,1] op_sel_hi:[1,1,1]
    v_pk_fma_f32 v[164:165], v[164:165], v[250:251], v[250:251] op_sel:[0,1,1] op_sel_hi:[1,1,1]
    v_pk_fma_f32 v[166:167], v[166:167], v[250:251], v[250:251] op_sel:[0,1,1] op_sel_hi:[1,1,1]
    v_rcp_f32 v160, v160
    v_rcp_f32 v161, v161
    v_rcp_f32 v162, v162
    v_rcp_f32 v163, v163
    v_rcp_f32 v164, v164
    v_rcp_f32 v165, v165
    v_rcp_f32 v166, v166
    v_rcp_f32 v167, v167
    v_pk_mul_f32 v[104:105], v[104:105], v[160:161]
    v_pk_mul_f32 v[106:107], v[106:107], v[162:163]
    v_pk_mul_f32 v[108:109], v[108:109], v[164:165]
    v_pk_mul_f32 v[110:111], v[110:111], v[166:167]
    v_pk_fma_f32 v[112:113], v[248:249], v[180:181], v[112:113] op_sel_hi:[0,1,1] neg_lo:[1,0,0] neg_hi:[1,0,0]
    v_pk_fma_f32 v[114:115], v[248:249], v[182:183], v[114:115] op_sel_hi:[0,1,1] neg_lo:[1,0,0] neg_hi:[1,0,0]
    v_pk_fma_f32 v[116:117], v[250:251], v[180:181], v[116:117] op_sel_hi:[0,1,1] neg_lo:[1,0,0] neg_hi:[1,0,0]
    v_pk_fma_f32 v[118:119], v[250:251], v[182:183], v[118:119] op_sel_hi:[0,1,1] neg_lo:[1,0,0] neg_hi:[1,0,0]
    v_pk_mul_f32 v[204:205], v[112:113], v[112:113]
    v_pk_mul_f32 v[206:207], v[114:115], v[114:115]
    v_pk_mul_f32 v[208:209], v[116:117], v[116:117]
    v_pk_mul_f32 v[210:211], v[118:119], v[118:119]
    v_pk_fma_f32 v[204:205], v[204:205], v[4:5], v[4:5] op_sel:[0,1,0] op_sel_hi:[1,1,0]
    v_pk_fma_f32 v[206:207], v[206:207], v[4:5], v[4:5] op_sel:[0,1,0] op_sel_hi:[1,1,0]
    v_pk_fma_f32 v[208:209], v[208:209], v[6:7], v[6:7] op_sel:[0,1,0] op_sel_hi:[1,1,0]
    v_pk_fma_f32 v[210:211], v[210:211], v[6:7], v[6:7] op_sel:[0,1,0] op_sel_hi:[1,1,0]
    v_pk_mul_f32 v[204:205], v[204:205], v[112:113]
    v_pk_mul_f32 v[206:207], v[206:207], v[114:115]
    v_pk_mul_f32 v[208:209], v[208:209], v[116:117]
    v_pk_mul_f32 v[210:211], v[210:211], v[118:119]
    v_exp_f32 v204, v204
    v_exp_f32 v205, v205
    v_exp_f32 v206, v206
    v_exp_f32 v207, v207
    v_exp_f32 v208, v208
    v_exp_f32 v209, v209
    v_exp_f32 v210, v210
    v_exp_f32 v211, v211
    v_pk_fma_f32 v[204:205], v[204:205], v[248:249], v[248:249] op_sel:[0,1,1] op_sel_hi:[1,1,1]
    v_pk_fma_f32 v[206:207], v[206:207], v[248:249], v[248:249] op_sel:[0,1,1] op_sel_hi:[1,1,1]
    v_pk_fma_f32 v[208:209], v[208:209], v[250:251], v[250:251] op_sel:[0,1,1] op_sel_hi:[1,1,1]
    v_pk_fma_f32 v[210:211], v[210:211], v[250:251], v[250:251] op_sel:[0,1,1] op_sel_hi:[1,1,1]
    v_rcp_f32 v204, v204
    v_rcp_f32 v205, v205
    v_rcp_f32 v206, v206
    v_rcp_f32 v207, v207
    v_rcp_f32 v208, v208
    v_rcp_f32 v209, v209
    v_rcp_f32 v210, v210
    v_rcp_f32 v211, v211
    v_pk_mul_f32 v[112:113], v[112:113], v[204:205]
    v_pk_mul_f32 v[114:115], v[114:115], v[206:207]
    v_pk_mul_f32 v[116:117], v[116:117], v[208:209]
    v_pk_mul_f32 v[118:119], v[118:119], v[210:211]
    v_pk_fma_f32 v[120:121], v[248:249], v[184:185], v[120:121] op_sel_hi:[0,1,1] neg_lo:[1,0,0] neg_hi:[1,0,0]
    v_pk_fma_f32 v[122:123], v[248:249], v[186:187], v[122:123] op_sel_hi:[0,1,1] neg_lo:[1,0,0] neg_hi:[1,0,0]
    v_pk_fma_f32 v[124:125], v[250:251], v[184:185], v[124:125] op_sel_hi:[0,1,1] neg_lo:[1,0,0] neg_hi:[1,0,0]
    v_pk_fma_f32 v[126:127], v[250:251], v[186:187], v[126:127] op_sel_hi:[0,1,1] neg_lo:[1,0,0] neg_hi:[1,0,0]
    v_pk_mul_f32 v[160:161], v[120:121], v[120:121]
    v_pk_mul_f32 v[162:163], v[122:123], v[122:123]
    v_pk_mul_f32 v[164:165], v[124:125], v[124:125]
    v_pk_mul_f32 v[166:167], v[126:127], v[126:127]
    v_pk_fma_f32 v[160:161], v[160:161], v[4:5], v[4:5] op_sel:[0,1,0] op_sel_hi:[1,1,0]
    v_pk_fma_f32 v[162:163], v[162:163], v[4:5], v[4:5] op_sel:[0,1,0] op_sel_hi:[1,1,0]
    v_pk_fma_f32 v[164:165], v[164:165], v[6:7], v[6:7] op_sel:[0,1,0] op_sel_hi:[1,1,0]
    v_pk_fma_f32 v[166:167], v[166:167], v[6:7], v[6:7] op_sel:[0,1,0] op_sel_hi:[1,1,0]
    v_pk_mul_f32 v[160:161], v[160:161], v[120:121]
    v_pk_mul_f32 v[162:163], v[162:163], v[122:123]
    v_pk_mul_f32 v[164:165], v[164:165], v[124:125]
    v_pk_mul_f32 v[166:167], v[166:167], v[126:127]
    v_exp_f32 v160, v160
    v_exp_f32 v161, v161
    v_exp_f32 v162, v162
    v_exp_f32 v163, v163
    v_exp_f32 v164, v164
    v_exp_f32 v165, v165
    v_exp_f32 v166, v166
    v_exp_f32 v167, v167
    v_pk_fma_f32 v[160:161], v[160:161], v[248:249], v[248:249] op_sel:[0,1,1] op_sel_hi:[1,1,1]
    v_pk_fma_f32 v[162:163], v[162:163], v[248:249], v[248:249] op_sel:[0,1,1] op_sel_hi:[1,1,1]
    v_pk_fma_f32 v[164:165], v[164:165], v[250:251], v[250:251] op_sel:[0,1,1] op_sel_hi:[1,1,1]
    v_pk_fma_f32 v[166:167], v[166:167], v[250:251], v[250:251] op_sel:[0,1,1] op_sel_hi:[1,1,1]
    v_rcp_f32 v160, v160
    v_rcp_f32 v161, v161
    v_rcp_f32 v162, v162
    v_rcp_f32 v163, v163
    v_rcp_f32 v164, v164
    v_rcp_f32 v165, v165
    v_rcp_f32 v166, v166
    v_rcp_f32 v167, v167
    v_pk_mul_f32 v[120:121], v[120:121], v[160:161]
    v_pk_mul_f32 v[122:123], v[122:123], v[162:163]
    v_pk_mul_f32 v[124:125], v[124:125], v[164:165]
    v_pk_mul_f32 v[126:127], v[126:127], v[166:167]
    v_pk_fma_f32 v[128:129], v[248:249], v[188:189], v[128:129] op_sel_hi:[0,1,1] neg_lo:[1,0,0] neg_hi:[1,0,0]
    v_pk_fma_f32 v[130:131], v[248:249], v[190:191], v[130:131] op_sel_hi:[0,1,1] neg_lo:[1,0,0] neg_hi:[1,0,0]
    v_pk_fma_f32 v[132:133], v[250:251], v[188:189], v[132:133] op_sel_hi:[0,1,1] neg_lo:[1,0,0] neg_hi:[1,0,0]
    v_pk_fma_f32 v[134:135], v[250:251], v[190:191], v[134:135] op_sel_hi:[0,1,1] neg_lo:[1,0,0] neg_hi:[1,0,0]
    v_pk_mul_f32 v[204:205], v[128:129], v[128:129]
    v_pk_mul_f32 v[206:207], v[130:131], v[130:131]
    v_pk_mul_f32 v[208:209], v[132:133], v[132:133]
    v_pk_mul_f32 v[210:211], v[134:135], v[134:135]
    v_pk_fma_f32 v[204:205], v[204:205], v[4:5], v[4:5] op_sel:[0,1,0] op_sel_hi:[1,1,0]
    v_pk_fma_f32 v[206:207], v[206:207], v[4:5], v[4:5] op_sel:[0,1,0] op_sel_hi:[1,1,0]
    v_pk_fma_f32 v[208:209], v[208:209], v[6:7], v[6:7] op_sel:[0,1,0] op_sel_hi:[1,1,0]
    v_pk_fma_f32 v[210:211], v[210:211], v[6:7], v[6:7] op_sel:[0,1,0] op_sel_hi:[1,1,0]
    v_pk_mul_f32 v[204:205], v[204:205], v[128:129]
    v_pk_mul_f32 v[206:207], v[206:207], v[130:131]
    v_pk_mul_f32 v[208:209], v[208:209], v[132:133]
    v_pk_mul_f32 v[210:211], v[210:211], v[134:135]
    v_exp_f32 v204, v204
    v_exp_f32 v205, v205
    v_exp_f32 v206, v206
    v_exp_f32 v207, v207
    v_exp_f32 v208, v208
    v_exp_f32 v209, v209
    v_exp_f32 v210, v210
    v_exp_f32 v211, v211
    v_pk_fma_f32 v[204:205], v[204:205], v[248:249], v[248:249] op_sel:[0,1,1] op_sel_hi:[1,1,1]
    v_pk_fma_f32 v[206:207], v[206:207], v[248:249], v[248:249] op_sel:[0,1,1] op_sel_hi:[1,1,1]
    v_pk_fma_f32 v[208:209], v[208:209], v[250:251], v[250:251] op_sel:[0,1,1] op_sel_hi:[1,1,1]
    v_pk_fma_f32 v[210:211], v[210:211], v[250:251], v[250:251] op_sel:[0,1,1] op_sel_hi:[1,1,1]
    v_rcp_f32 v204, v204
    v_rcp_f32 v205, v205
    v_rcp_f32 v206, v206
    v_rcp_f32 v207, v207
    v_rcp_f32 v208, v208
    v_rcp_f32 v209, v209
    v_rcp_f32 v210, v210
    v_rcp_f32 v211, v211
    v_pk_mul_f32 v[128:129], v[128:129], v[204:205]
    v_pk_mul_f32 v[130:131], v[130:131], v[206:207]
    v_pk_mul_f32 v[132:133], v[132:133], v[208:209]
    v_pk_mul_f32 v[134:135], v[134:135], v[210:211]
    v_pk_fma_f32 v[136:137], v[248:249], v[192:193], v[136:137] op_sel_hi:[0,1,1] neg_lo:[1,0,0] neg_hi:[1,0,0]
    v_pk_fma_f32 v[138:139], v[248:249], v[194:195], v[138:139] op_sel_hi:[0,1,1] neg_lo:[1,0,0] neg_hi:[1,0,0]
    v_pk_fma_f32 v[140:141], v[250:251], v[192:193], v[140:141] op_sel_hi:[0,1,1] neg_lo:[1,0,0] neg_hi:[1,0,0]
    v_pk_fma_f32 v[142:143], v[250:251], v[194:195], v[142:143] op_sel_hi:[0,1,1] neg_lo:[1,0,0] neg_hi:[1,0,0]
    v_pk_mul_f32 v[160:161], v[136:137], v[136:137]
    v_pk_mul_f32 v[162:163], v[138:139], v[138:139]
    v_pk_mul_f32 v[164:165], v[140:141], v[140:141]
    v_pk_mul_f32 v[166:167], v[142:143], v[142:143]
    v_pk_fma_f32 v[160:161], v[160:161], v[4:5], v[4:5] op_sel:[0,1,0] op_sel_hi:[1,1,0]
    v_pk_fma_f32 v[162:163], v[162:163], v[4:5], v[4:5] op_sel:[0,1,0] op_sel_hi:[1,1,0]
    v_pk_fma_f32 v[164:165], v[164:165], v[6:7], v[6:7] op_sel:[0,1,0] op_sel_hi:[1,1,0]
    v_pk_fma_f32 v[166:167], v[166:167], v[6:7], v[6:7] op_sel:[0,1,0] op_sel_hi:[1,1,0]
    v_pk_mul_f32 v[160:161], v[160:161], v[136:137]
    v_pk_mul_f32 v[162:163], v[162:163], v[138:139]
    v_pk_mul_f32 v[164:165], v[164:165], v[140:141]
    v_pk_mul_f32 v[166:167], v[166:167], v[142:143]
    v_exp_f32 v160, v160
    v_exp_f32 v161, v161
    v_exp_f32 v162, v162
    v_exp_f32 v163, v163
    v_exp_f32 v164, v164
    v_exp_f32 v165, v165
    v_exp_f32 v166, v166
    v_exp_f32 v167, v167
    v_pk_fma_f32 v[160:161], v[160:161], v[248:249], v[248:249] op_sel:[0,1,1] op_sel_hi:[1,1,1]
    v_pk_fma_f32 v[162:163], v[162:163], v[248:249], v[248:249] op_sel:[0,1,1] op_sel_hi:[1,1,1]
    v_pk_fma_f32 v[164:165], v[164:165], v[250:251], v[250:251] op_sel:[0,1,1] op_sel_hi:[1,1,1]
    v_pk_fma_f32 v[166:167], v[166:167], v[250:251], v[250:251] op_sel:[0,1,1] op_sel_hi:[1,1,1]
    v_rcp_f32 v160, v160
    v_rcp_f32 v161, v161
    v_rcp_f32 v162, v162
    v_rcp_f32 v163, v163
    v_rcp_f32 v164, v164
    v_rcp_f32 v165, v165
    v_rcp_f32 v166, v166
    v_rcp_f32 v167, v167
    v_pk_mul_f32 v[136:137], v[136:137], v[160:161]
    v_pk_mul_f32 v[138:139], v[138:139], v[162:163]
    v_pk_mul_f32 v[140:141], v[140:141], v[164:165]
    v_pk_mul_f32 v[142:143], v[142:143], v[166:167]
    v_pk_fma_f32 v[144:145], v[248:249], v[196:197], v[144:145] op_sel_hi:[0,1,1] neg_lo:[1,0,0] neg_hi:[1,0,0]
    v_pk_fma_f32 v[146:147], v[248:249], v[198:199], v[146:147] op_sel_hi:[0,1,1] neg_lo:[1,0,0] neg_hi:[1,0,0]
    v_pk_fma_f32 v[148:149], v[250:251], v[196:197], v[148:149] op_sel_hi:[0,1,1] neg_lo:[1,0,0] neg_hi:[1,0,0]
    v_pk_fma_f32 v[150:151], v[250:251], v[198:199], v[150:151] op_sel_hi:[0,1,1] neg_lo:[1,0,0] neg_hi:[1,0,0]
    v_pk_mul_f32 v[204:205], v[144:145], v[144:145]
    v_pk_mul_f32 v[206:207], v[146:147], v[146:147]
    v_pk_mul_f32 v[208:209], v[148:149], v[148:149]
    v_pk_mul_f32 v[210:211], v[150:151], v[150:151]
    v_pk_fma_f32 v[204:205], v[204:205], v[4:5], v[4:5] op_sel:[0,1,0] op_sel_hi:[1,1,0]
    v_pk_fma_f32 v[206:207], v[206:207], v[4:5], v[4:5] op_sel:[0,1,0] op_sel_hi:[1,1,0]
    v_pk_fma_f32 v[208:209], v[208:209], v[6:7], v[6:7] op_sel:[0,1,0] op_sel_hi:[1,1,0]
    v_pk_fma_f32 v[210:211], v[210:211], v[6:7], v[6:7] op_sel:[0,1,0] op_sel_hi:[1,1,0]
    v_pk_mul_f32 v[204:205], v[204:205], v[144:145]
    v_pk_mul_f32 v[206:207], v[206:207], v[146:147]
    v_pk_mul_f32 v[208:209], v[208:209], v[148:149]
    v_pk_mul_f32 v[210:211], v[210:211], v[150:151]
    v_exp_f32 v204, v204
    v_exp_f32 v205, v205
    v_exp_f32 v206, v206
    v_exp_f32 v207, v207
    v_exp_f32 v208, v208
    v_exp_f32 v209, v209
    v_exp_f32 v210, v210
    v_exp_f32 v211, v211
    v_pk_fma_f32 v[204:205], v[204:205], v[248:249], v[248:249] op_sel:[0,1,1] op_sel_hi:[1,1,1]
    v_pk_fma_f32 v[206:207], v[206:207], v[248:249], v[248:249] op_sel:[0,1,1] op_sel_hi:[1,1,1]
    v_pk_fma_f32 v[208:209], v[208:209], v[250:251], v[250:251] op_sel:[0,1,1] op_sel_hi:[1,1,1]
    v_pk_fma_f32 v[210:211], v[210:211], v[250:251], v[250:251] op_sel:[0,1,1] op_sel_hi:[1,1,1]
    v_rcp_f32 v204, v204
    v_rcp_f32 v205, v205
    v_rcp_f32 v206, v206
    v_rcp_f32 v207, v207
    v_rcp_f32 v208, v208
    v_rcp_f32 v209, v209
    v_rcp_f32 v210, v210
    v_rcp_f32 v211, v211
    v_pk_mul_f32 v[144:145], v[144:145], v[204:205]
    v_pk_mul_f32 v[146:147], v[146:147], v[206:207]
    v_pk_mul_f32 v[148:149], v[148:149], v[208:209]
    v_pk_mul_f32 v[150:151], v[150:151], v[210:211]
    v_pk_fma_f32 v[152:153], v[248:249], v[200:201], v[152:153] op_sel_hi:[0,1,1] neg_lo:[1,0,0] neg_hi:[1,0,0]
    v_pk_fma_f32 v[154:155], v[248:249], v[202:203], v[154:155] op_sel_hi:[0,1,1] neg_lo:[1,0,0] neg_hi:[1,0,0]
    v_pk_fma_f32 v[156:157], v[250:251], v[200:201], v[156:157] op_sel_hi:[0,1,1] neg_lo:[1,0,0] neg_hi:[1,0,0]
    v_pk_fma_f32 v[158:159], v[250:251], v[202:203], v[158:159] op_sel_hi:[0,1,1] neg_lo:[1,0,0] neg_hi:[1,0,0]
    v_pk_mul_f32 v[160:161], v[152:153], v[152:153]
    v_pk_mul_f32 v[162:163], v[154:155], v[154:155]
    v_pk_mul_f32 v[164:165], v[156:157], v[156:157]
    v_pk_mul_f32 v[166:167], v[158:159], v[158:159]
    v_pk_fma_f32 v[160:161], v[160:161], v[4:5], v[4:5] op_sel:[0,1,0] op_sel_hi:[1,1,0]
    v_pk_fma_f32 v[162:163], v[162:163], v[4:5], v[4:5] op_sel:[0,1,0] op_sel_hi:[1,1,0]
    v_pk_fma_f32 v[164:165], v[164:165], v[6:7], v[6:7] op_sel:[0,1,0] op_sel_hi:[1,1,0]
    v_pk_fma_f32 v[166:167], v[166:167], v[6:7], v[6:7] op_sel:[0,1,0] op_sel_hi:[1,1,0]
    v_pk_mul_f32 v[160:161], v[160:161], v[152:153]
    v_pk_mul_f32 v[162:163], v[162:163], v[154:155]
    v_pk_mul_f32 v[164:165], v[164:165], v[156:157]
    v_pk_mul_f32 v[166:167], v[166:167], v[158:159]
    v_exp_f32 v160, v160
    v_exp_f32 v161, v161
    v_exp_f32 v162, v162
    v_exp_f32 v163, v163
    v_exp_f32 v164, v164
    v_exp_f32 v165, v165
    v_exp_f32 v166, v166
    v_exp_f32 v167, v167
    v_pk_fma_f32 v[160:161], v[160:161], v[248:249], v[248:249] op_sel:[0,1,1] op_sel_hi:[1,1,1]
    v_pk_fma_f32 v[162:163], v[162:163], v[248:249], v[248:249] op_sel:[0,1,1] op_sel_hi:[1,1,1]
    v_pk_fma_f32 v[164:165], v[164:165], v[250:251], v[250:251] op_sel:[0,1,1] op_sel_hi:[1,1,1]
    v_pk_fma_f32 v[166:167], v[166:167], v[250:251], v[250:251] op_sel:[0,1,1] op_sel_hi:[1,1,1]
    v_rcp_f32 v160, v160
    v_rcp_f32 v161, v161
    v_rcp_f32 v162, v162
    v_rcp_f32 v163, v163
    v_rcp_f32 v164, v164
    v_rcp_f32 v165, v165
    v_rcp_f32 v166, v166
    v_rcp_f32 v167, v167
    v_pk_mul_f32 v[152:153], v[152:153], v[160:161]
    v_pk_mul_f32 v[154:155], v[154:155], v[162:163]
    v_pk_mul_f32 v[156:157], v[156:157], v[164:165]
    v_pk_mul_f32 v[158:159], v[158:159], v[166:167]
    s_waitcnt vmcnt(0)
    v_lshlrev_b32 v252, 16, v252
    v_lshlrev_b32 v254, 16, v254
    v_mov_b32 v253, v252
    v_mov_b32 v255, v254
    v_bfe_u32 v6, v1, 4, 4
    v_lshrrev_b32 v3, 1, v6
    v_lshrrev_b32 v4, 8, v1
    v_xor_b32 v3, v3, v4
    v_lshlrev_b32 v3, 4, v3
    v_lshl_add_u32 v3, v6, 7, v3
    s_add_u32 s33, s30, 18432
    v_add_u32 v3, s33, v3
    v_xor_b32 v4, 64, v3
    v_add_u32 v5, 73728, v3
    v_add_u32 v6, 73728, v4
    v_mov_b64 v[16:17], v[252:253]
    v_mov_b64 v[18:19], v[252:253]
    v_mov_b64 v[20:21], v[254:255]
    v_mov_b64 v[22:23], v[254:255]
    v_mov_b64 v[24:25], v[252:253]
    v_mov_b64 v[26:27], v[252:253]
    v_mov_b64 v[28:29], v[254:255]
    v_mov_b64 v[30:31], v[254:255]
    v_mov_b64 v[32:33], v[252:253]
    v_mov_b64 v[34:35], v[252:253]
    v_mov_b64 v[36:37], v[254:255]
    v_mov_b64 v[38:39], v[254:255]
    v_mov_b64 v[40:41], v[252:253]
    v_mov_b64 v[42:43], v[252:253]
    v_mov_b64 v[44:45], v[254:255]
    v_mov_b64 v[46:47], v[254:255]
    v_mov_b64 v[48:49], v[252:253]
    v_mov_b64 v[50:51], v[252:253]
    v_mov_b64 v[52:53], v[254:255]
    v_mov_b64 v[54:55], v[254:255]
    v_mov_b64 v[56:57], v[252:253]
    v_mov_b64 v[58:59], v[252:253]
    v_mov_b64 v[60:61], v[254:255]
    v_mov_b64 v[62:63], v[254:255]
    v_mov_b64 v[64:65], v[252:253]
    v_mov_b64 v[66:67], v[252:253]
    v_mov_b64 v[68:69], v[254:255]
    v_mov_b64 v[70:71], v[254:255]
    v_mov_b64 v[72:73], v[252:253]
    v_mov_b64 v[74:75], v[252:253]
    v_mov_b64 v[76:77], v[254:255]
    v_mov_b64 v[78:79], v[254:255]
    v_mov_b64 v[80:81], v[252:253]
    v_mov_b64 v[82:83], v[252:253]
    v_mov_b64 v[84:85], v[254:255]
    v_mov_b64 v[86:87], v[254:255]
    s_mul_i32 s36, s31, 73728
    s_add_u32 s36, s36, s21
    s_lshl_b32 s34, s24, 12
    s_lshl_b32 s35, s24, 9
    s_add_u32 s35, s35, 65536
    v_add_u32 v14, s34, v1
    v_lshrrev_b32 v15, 1, v1
    v_add_u32 v15, s35, v15
    s_add_u32 s39, s36, 0x1200000
    s_add_u32 s40, s36, 0x1212000
    s_mov_b32 s41, 7
    s_barrier
    ds_read_b128 v[160:163], v5 offset:0
    ds_read_b128 v[164:167], v5 offset:2048
    ds_read_b128 v[168:171], v2 offset:0
    ds_read_b128 v[172:175], v2 offset:1024
    ds_read_b128 v[176:179], v2 offset:2048
    ds_read_b128 v[180:183], v2 offset:3072
    ds_read_b128 v[184:187], v2 offset:4096
    ds_read_b128 v[188:191], v2 offset:5120
    ds_read_b128 v[192:195], v2 offset:6144
    ds_read_b128 v[196:199], v2 offset:7168
    ds_read_b128 v[200:203], v2 offset:8192
    .p2align 6
L_g_loop:
    s_waitcnt lgkmcnt(5)
    v_mfma_f32_16x16x32_bf16 v[16:19], v[168:171], v[160:163], v[16:19]
    ds_read_b128 v[204:207], v6 offset:0
    v_mfma_f32_16x16x32_bf16 v[20:23], v[168:171], v[164:167], v[20:23]
    ds_read_b128 v[208:211], v6 offset:2048
    v_mfma_f32_16x16x32_bf16 v[24:27], v[172:175], v[160:163], v[24:27]
    ds_read_b128 v[212:215], v2 offset:9216
    v_mfma_f32_16x16x32_bf16 v[28:31], v[172:175], v[164:167], v[28:31]
    ds_read_b128 v[216:219], v2 offset:10240
    v_mfma_f32_16x16x32_bf16 v[32:35], v[176:179], v[160:163], v[32:35]
    ds_read_b128 v[220:223], v2 offset:11264
    v_mfma_f32_16x16x32_bf16 v[36:39], v[176:179], v[164:167], v[36:39]
    ds_read_b128 v[224:227], v2 offset:12288
    v_mfma_f32_16x16x32_bf16 v[40:43], v[180:183], v[160:163], v[40:43]
    ds_read_b128 v[228:231], v2 offset:13312
    v_mfma_f32_16x16x32_bf16 v[44:47], v[180:183], v[164:167], v[44:47]
    ds_read_b128 v[232:235], v2 offset:14336
    s_waitcnt lgkmcnt(8)
    v_mfma_f32_16x16x32_bf16 v[48:51], v[184:187], v[160:163], v[48:51]
    ds_read_b128 v[236:239], v2 offset:15360
    v_mfma_f32_16x16x32_bf16 v[52:55], v[184:187], v[164:167], v[52:55]
    ds_read_b128 v[240:243], v2 offset:16384
    v_mfma_f32_16x16x32_bf16 v[56:59], v[188:191], v[160:163], v[56:59]
    ds_read_b128 v[244:247], v2 offset:17408
    v_mfma_f32_16x16x32_bf16 v[60:63], v[188:191], v[164:167], v[60:63]
    v_mfma_f32_16x16x32_bf16 v[64:67], v[192:195], v[160:163], v[64:67]
    v_mfma_f32_16x16x32_bf16 v[68:71], v[192:195], v[164:167], v[68:71]
    v_mfma_f32_16x16x32_bf16 v[72:75], v[196:199], v[160:163], v[72:75]
    v_mfma_f32_16x16x32_bf16 v[76:79], v[196:199], v[164:167], v[76:79]
    v_mfma_f32_16x16x32_bf16 v[80:83], v[200:203], v[160:163], v[80:83]
    v_mfma_f32_16x16x32_bf16 v[84:87], v[200:203], v[164:167], v[84:87]
    s_waitcnt lgkmcnt(0)
    s_barrier
    v_mfma_f32_16x16x32_bf16 v[16:19], v[212:215], v[204:207], v[16:19]
    ds_read_b128 v[160:163], v5 offset:36864
    v_mfma_f32_16x16x32_bf16 v[20:23], v[212:215], v[208:211], v[20:23]
    ds_read_b128 v[164:167], v5 offset:38912
    v_mfma_f32_16x16x32_bf16 v[24:27], v[216:219], v[204:207], v[24:27]
    ds_read_b128 v[168:171], v2 offset:36864
    v_mfma_f32_16x16x32_bf16 v[28:31], v[216:219], v[208:211], v[28:31]
    ds_read_b128 v[172:175], v2 offset:37888
    v_mfma_f32_16x16x32_bf16 v[32:35], v[220:223], v[204:207], v[32:35]
    ds_read_b128 v[176:179], v2 offset:38912
    v_mfma_f32_16x16x32_bf16 v[36:39], v[220:223], v[208:211], v[36:39]
    ds_read_b128 v[180:183], v2 offset:39936
    v_mfma_f32_16x16x32_bf16 v[40:43], v[224:227], v[204:207], v[40:43]
    ds_read_b128 v[184:187], v2 offset:40960
    v_mfma_f32_16x16x32_bf16 v[44:47], v[224:227], v[208:211], v[44:47]
    ds_read_b128 v[188:191], v2 offset:41984
    v_mfma_f32_16x16x32_bf16 v[48:51], v[228:231], v[204:207], v[48:51]
    ds_read_b128 v[192:195], v2 offset:43008
    v_mfma_f32_16x16x32_bf16 v[52:55], v[228:231], v[208:211], v[52:55]
    ds_read_b128 v[196:199], v2 offset:44032
    v_mfma_f32_16x16x32_bf16 v[56:59], v[232:235], v[204:207], v[56:59]
    ds_read_b128 v[200:203], v2 offset:45056
    v_mfma_f32_16x16x32_bf16 v[60:63], v[232:235], v[208:211], v[60:63]
    v_mfma_f32_16x16x32_bf16 v[64:67], v[236:239], v[204:207], v[64:67]
    v_mfma_f32_16x16x32_bf16 v[68:71], v[236:239], v[208:211], v[68:71]
    v_mfma_f32_16x16x32_bf16 v[72:75], v[240:243], v[204:207], v[72:75]
    v_mfma_f32_16x16x32_bf16 v[76:79], v[240:243], v[208:211], v[76:79]
    v_mfma_f32_16x16x32_bf16 v[80:83], v[244:247], v[204:207], v[80:83]
    v_mfma_f32_16x16x32_bf16 v[84:87], v[244:247], v[208:211], v[84:87]
    s_waitcnt lgkmcnt(5)
    v_mfma_f32_16x16x32_bf16 v[16:19], v[168:171], v[160:163], v[16:19]
    ds_read_b128 v[204:207], v6 offset:36864
    v_mfma_f32_16x16x32_bf16 v[20:23], v[168:171], v[164:167], v[20:23]
    ds_read_b128 v[208:211], v6 offset:38912
    v_mfma_f32_16x16x32_bf16 v[24:27], v[172:175], v[160:163], v[24:27]
    ds_read_b128 v[212:215], v2 offset:46080
    v_mfma_f32_16x16x32_bf16 v[28:31], v[172:175], v[164:167], v[28:31]
    ds_read_b128 v[216:219], v2 offset:47104
    v_mfma_f32_16x16x32_bf16 v[32:35], v[176:179], v[160:163], v[32:35]
    ds_read_b128 v[220:223], v2 offset:48128
    v_mfma_f32_16x16x32_bf16 v[36:39], v[176:179], v[164:167], v[36:39]
    ds_read_b128 v[224:227], v2 offset:49152
    v_mfma_f32_16x16x32_bf16 v[40:43], v[180:183], v[160:163], v[40:43]
    ds_read_b128 v[228:231], v2 offset:50176
    v_mfma_f32_16x16x32_bf16 v[44:47], v[180:183], v[164:167], v[44:47]
    ds_read_b128 v[232:235], v2 offset:51200
    s_waitcnt lgkmcnt(8)
    v_mfma_f32_16x16x32_bf16 v[48:51], v[184:187], v[160:163], v[48:51]
    ds_read_b128 v[236:239], v2 offset:52224
    v_mfma_f32_16x16x32_bf16 v[52:55], v[184:187], v[164:167], v[52:55]
    ds_read_b128 v[240:243], v2 offset:53248
    v_mfma_f32_16x16x32_bf16 v[56:59], v[188:191], v[160:163], v[56:59]
    ds_read_b128 v[244:247], v2 offset:54272
    v_mfma_f32_16x16x32_bf16 v[60:63], v[188:191], v[164:167], v[60:63]
    v_mfma_f32_16x16x32_bf16 v[64:67], v[192:195], v[160:163], v[64:67]
    v_mfma_f32_16x16x32_bf16 v[68:71], v[192:195], v[164:167], v[68:71]
    v_mfma_f32_16x16x32_bf16 v[72:75], v[196:199], v[160:163], v[72:75]
    v_mfma_f32_16x16x32_bf16 v[76:79], v[196:199], v[164:167], v[76:79]
    v_mfma_f32_16x16x32_bf16 v[80:83], v[200:203], v[160:163], v[80:83]
    v_mfma_f32_16x16x32_bf16 v[84:87], v[200:203], v[164:167], v[84:87]
    s_waitcnt lgkmcnt(0)
    s_barrier
    v_mfma_f32_16x16x32_bf16 v[16:19], v[212:215], v[204:207], v[16:19]
    ds_read_b128 v[160:163], v3 offset:0
    v_mfma_f32_16x16x32_bf16 v[20:23], v[212:215], v[208:211], v[20:23]
    ds_read_b128 v[164:167], v3 offset:2048
    v_mfma_f32_16x16x32_bf16 v[24:27], v[216:219], v[204:207], v[24:27]
    ds_read_b128 v[168:171], v1 offset:0
    v_mfma_f32_16x16x32_bf16 v[28:31], v[216:219], v[208:211], v[28:31]
    ds_read_b128 v[172:175], v1 offset:1024
    v_mfma_f32_16x16x32_bf16 v[32:35], v[220:223], v[204:207], v[32:35]
    ds_read_b128 v[176:179], v1 offset:2048
    v_mfma_f32_16x16x32_bf16 v[36:39], v[220:223], v[208:211], v[36:39]
    ds_read_b128 v[180:183], v1 offset:3072
    v_mfma_f32_16x16x32_bf16 v[40:43], v[224:227], v[204:207], v[40:43]
    ds_read_b128 v[184:187], v1 offset:4096
    v_mfma_f32_16x16x32_bf16 v[44:47], v[224:227], v[208:211], v[44:47]
    ds_read_b128 v[188:191], v1 offset:5120
    v_mfma_f32_16x16x32_bf16 v[48:51], v[228:231], v[204:207], v[48:51]
    ds_read_b128 v[192:195], v1 offset:6144
    v_mfma_f32_16x16x32_bf16 v[52:55], v[228:231], v[208:211], v[52:55]
    ds_read_b128 v[196:199], v1 offset:7168
    v_mfma_f32_16x16x32_bf16 v[56:59], v[232:235], v[204:207], v[56:59]
    ds_read_b128 v[200:203], v1 offset:8192
    v_mfma_f32_16x16x32_bf16 v[60:63], v[232:235], v[208:211], v[60:63]
    v_mfma_f32_16x16x32_bf16 v[64:67], v[236:239], v[204:207], v[64:67]
    v_mfma_f32_16x16x32_bf16 v[68:71], v[236:239], v[208:211], v[68:71]
    v_mfma_f32_16x16x32_bf16 v[72:75], v[240:243], v[204:207], v[72:75]
    v_mfma_f32_16x16x32_bf16 v[76:79], v[240:243], v[208:211], v[76:79]
    v_mfma_f32_16x16x32_bf16 v[80:83], v[244:247], v[204:207], v[80:83]
    v_mfma_f32_16x16x32_bf16 v[84:87], v[244:247], v[208:211], v[84:87]
    s_waitcnt lgkmcnt(5)
    v_mfma_f32_16x16x32_bf16 v[16:19], v[168:171], v[160:163], v[16:19]
    ds_read_b128 v[204:207], v4 offset:0
    v_mfma_f32_16x16x32_bf16 v[20:23], v[168:171], v[164:167], v[20:23]
    ds_read_b128 v[208:211], v4 offset:2048
    v_mfma_f32_16x16x32_bf16 v[24:27], v[172:175], v[160:163], v[24:27]
    ds_read_b128 v[212:215], v1 offset:9216
    v_mfma_f32_16x16x32_bf16 v[28:31], v[172:175], v[164:167], v[28:31]
    ds_read_b128 v[216:219], v1 offset:10240
    v_mfma_f32_16x16x32_bf16 v[32:35], v[176:179], v[160:163], v[32:35]
    ds_read_b128 v[220:223], v1 offset:11264
    v_mfma_f32_16x16x32_bf16 v[36:39], v[176:179], v[164:167], v[36:39]
    ds_read_b128 v[224:227], v1 offset:12288
    v_mfma_f32_16x16x32_bf16 v[40:43], v[180:183], v[160:163], v[40:43]
    ds_read_b128 v[228:231], v1 offset:13312
    v_mfma_f32_16x16x32_bf16 v[44:47], v[180:183], v[164:167], v[44:47]
    ds_read_b128 v[232:235], v1 offset:14336
    s_waitcnt lgkmcnt(8)
    v_mfma_f32_16x16x32_bf16 v[48:51], v[184:187], v[160:163], v[48:51]
    ds_read_b128 v[236:239], v1 offset:15360
    v_mfma_f32_16x16x32_bf16 v[52:55], v[184:187], v[164:167], v[52:55]
    ds_read_b128 v[240:243], v1 offset:16384
    v_mfma_f32_16x16x32_bf16 v[56:59], v[188:191], v[160:163], v[56:59]
    ds_read_b128 v[244:247], v1 offset:17408
    v_mfma_f32_16x16x32_bf16 v[60:63], v[188:191], v[164:167], v[60:63]
    v_mfma_f32_16x16x32_bf16 v[64:67], v[192:195], v[160:163], v[64:67]
    v_mfma_f32_16x16x32_bf16 v[68:71], v[192:195], v[164:167], v[68:71]
    v_mfma_f32_16x16x32_bf16 v[72:75], v[196:199], v[160:163], v[72:75]
    v_mfma_f32_16x16x32_bf16 v[76:79], v[196:199], v[164:167], v[76:79]
    v_mfma_f32_16x16x32_bf16 v[80:83], v[200:203], v[160:163], v[80:83]
    v_mfma_f32_16x16x32_bf16 v[84:87], v[200:203], v[164:167], v[84:87]
    s_waitcnt lgkmcnt(0)
    s_barrier
    v_mfma_f32_16x16x32_bf16 v[16:19], v[212:215], v[204:207], v[16:19]
    ds_read_b128 v[160:163], v3 offset:36864
    v_mfma_f32_16x16x32_bf16 v[20:23], v[212:215], v[208:211], v[20:23]
    ds_read_b128 v[164:167], v3 offset:38912
    v_mfma_f32_16x16x32_bf16 v[24:27], v[216:219], v[204:207], v[24:27]
    ds_read_b128 v[168:171], v1 offset:36864
    v_mfma_f32_16x16x32_bf16 v[28:31], v[216:219], v[208:211], v[28:31]
    ds_read_b128 v[172:175], v1 offset:37888
    v_mfma_f32_16x16x32_bf16 v[32:35], v[220:223], v[204:207], v[32:35]
    ds_read_b128 v[176:179], v1 offset:38912
    v_mfma_f32_16x16x32_bf16 v[36:39], v[220:223], v[208:211], v[36:39]
    ds_read_b128 v[180:183], v1 offset:39936
    v_mfma_f32_16x16x32_bf16 v[40:43], v[224:227], v[204:207], v[40:43]
    ds_read_b128 v[184:187], v1 offset:40960
    v_mfma_f32_16x16x32_bf16 v[44:47], v[224:227], v[208:211], v[44:47]
    ds_read_b128 v[188:191], v1 offset:41984
    v_mfma_f32_16x16x32_bf16 v[48:51], v[228:231], v[204:207], v[48:51]
    ds_read_b128 v[192:195], v1 offset:43008
    v_mfma_f32_16x16x32_bf16 v[52:55], v[228:231], v[208:211], v[52:55]
    ds_read_b128 v[196:199], v1 offset:44032
    v_mfma_f32_16x16x32_bf16 v[56:59], v[232:235], v[204:207], v[56:59]
    ds_read_b128 v[200:203], v1 offset:45056
    v_mfma_f32_16x16x32_bf16 v[60:63], v[232:235], v[208:211], v[60:63]
    v_mfma_f32_16x16x32_bf16 v[64:67], v[236:239], v[204:207], v[64:67]
    v_mfma_f32_16x16x32_bf16 v[68:71], v[236:239], v[208:211], v[68:71]
    v_mfma_f32_16x16x32_bf16 v[72:75], v[240:243], v[204:207], v[72:75]
    v_mfma_f32_16x16x32_bf16 v[76:79], v[240:243], v[208:211], v[76:79]
    v_mfma_f32_16x16x32_bf16 v[80:83], v[244:247], v[204:207], v[80:83]
    v_mfma_f32_16x16x32_bf16 v[84:87], v[244:247], v[208:211], v[84:87]
    s_waitcnt lgkmcnt(5)
    v_mfma_f32_16x16x32_bf16 v[16:19], v[168:171], v[160:163], v[16:19]
    ds_read_b128 v[204:207], v4 offset:36864
    v_mfma_f32_16x16x32_bf16 v[20:23], v[168:171], v[164:167], v[20:23]
    ds_read_b128 v[208:211], v4 offset:38912
    v_mfma_f32_16x16x32_bf16 v[24:27], v[172:175], v[160:163], v[24:27]
    ds_read_b128 v[212:215], v1 offset:46080
    v_mfma_f32_16x16x32_bf16 v[28:31], v[172:175], v[164:167], v[28:31]
    ds_read_b128 v[216:219], v1 offset:47104
    v_mfma_f32_16x16x32_bf16 v[32:35], v[176:179], v[160:163], v[32:35]
    ds_read_b128 v[220:223], v1 offset:48128
    v_mfma_f32_16x16x32_bf16 v[36:39], v[176:179], v[164:167], v[36:39]
    ds_read_b128 v[224:227], v1 offset:49152
    v_mfma_f32_16x16x32_bf16 v[40:43], v[180:183], v[160:163], v[40:43]
    ds_read_b128 v[228:231], v1 offset:50176
    v_mfma_f32_16x16x32_bf16 v[44:47], v[180:183], v[164:167], v[44:47]
    ds_read_b128 v[232:235], v1 offset:51200
    s_waitcnt lgkmcnt(8)
    v_mfma_f32_16x16x32_bf16 v[48:51], v[184:187], v[160:163], v[48:51]
    ds_read_b128 v[236:239], v1 offset:52224
    v_mfma_f32_16x16x32_bf16 v[52:55], v[184:187], v[164:167], v[52:55]
    ds_read_b128 v[240:243], v1 offset:53248
    v_mfma_f32_16x16x32_bf16 v[56:59], v[188:191], v[160:163], v[56:59]
    ds_read_b128 v[244:247], v1 offset:54272
    v_mfma_f32_16x16x32_bf16 v[60:63], v[188:191], v[164:167], v[60:63]
    v_mfma_f32_16x16x32_bf16 v[64:67], v[192:195], v[160:163], v[64:67]
    v_mfma_f32_16x16x32_bf16 v[68:71], v[192:195], v[164:167], v[68:71]
    v_mfma_f32_16x16x32_bf16 v[72:75], v[196:199], v[160:163], v[72:75]
    v_mfma_f32_16x16x32_bf16 v[76:79], v[196:199], v[164:167], v[76:79]
    v_mfma_f32_16x16x32_bf16 v[80:83], v[200:203], v[160:163], v[80:83]
    v_mfma_f32_16x16x32_bf16 v[84:87], v[200:203], v[164:167], v[84:87]
    s_waitcnt lgkmcnt(0)
    s_barrier
    v_mfma_f32_16x16x32_bf16 v[16:19], v[212:215], v[204:207], v[16:19]
    ds_read_b128 v[160:163], v5 offset:0
    v_mfma_f32_16x16x32_bf16 v[20:23], v[212:215], v[208:211], v[20:23]
    ds_read_b128 v[164:167], v5 offset:2048
    v_mfma_f32_16x16x32_bf16 v[24:27], v[216:219], v[204:207], v[24:27]
    ds_read_b128 v[168:171], v2 offset:0
    v_mfma_f32_16x16x32_bf16 v[28:31], v[216:219], v[208:211], v[28:31]
    ds_read_b128 v[172:175], v2 offset:1024
    v_mfma_f32_16x16x32_bf16 v[32:35], v[220:223], v[204:207], v[32:35]
    ds_read_b128 v[176:179], v2 offset:2048
    v_mfma_f32_16x16x32_bf16 v[36:39], v[220:223], v[208:211], v[36:39]
    ds_read_b128 v[180:183], v2 offset:3072
    v_mfma_f32_16x16x32_bf16 v[40:43], v[224:227], v[204:207], v[40:43]
    ds_read_b128 v[184:187], v2 offset:4096
    v_mfma_f32_16x16x32_bf16 v[44:47], v[224:227], v[208:211], v[44:47]
    ds_read_b128 v[188:191], v2 offset:5120
    v_mfma_f32_16x16x32_bf16 v[48:51], v[228:231], v[204:207], v[48:51]
    ds_read_b128 v[192:195], v2 offset:6144
    v_mfma_f32_16x16x32_bf16 v[52:55], v[228:231], v[208:211], v[52:55]
    ds_read_b128 v[196:199], v2 offset:7168
    v_mfma_f32_16x16x32_bf16 v[56:59], v[232:235], v[204:207], v[56:59]
    ds_read_b128 v[200:203], v2 offset:8192
    v_mfma_f32_16x16x32_bf16 v[60:63], v[232:235], v[208:211], v[60:63]
    v_mfma_f32_16x16x32_bf16 v[64:67], v[236:239], v[204:207], v[64:67]
    v_mfma_f32_16x16x32_bf16 v[68:71], v[236:239], v[208:211], v[68:71]
    v_mfma_f32_16x16x32_bf16 v[72:75], v[240:243], v[204:207], v[72:75]
    v_mfma_f32_16x16x32_bf16 v[76:79], v[240:243], v[208:211], v[76:79]
    v_mfma_f32_16x16x32_bf16 v[80:83], v[244:247], v[204:207], v[80:83]
    s_sub_u32 s41, s41, 1
    v_mfma_f32_16x16x32_bf16 v[84:87], v[244:247], v[208:211], v[84:87]
    s_cmp_lg_u32 s41, 0
    s_cbranch_scc1 L_g_loop
    s_waitcnt lgkmcnt(5)
    v_mfma_f32_16x16x32_bf16 v[16:19], v[168:171], v[160:163], v[16:19]
    ds_read_b128 v[204:207], v6 offset:0
    v_mfma_f32_16x16x32_bf16 v[20:23], v[168:171], v[164:167], v[20:23]
    ds_read_b128 v[208:211], v6 offset:2048
    v_mfma_f32_16x16x32_bf16 v[24:27], v[172:175], v[160:163], v[24:27]
    ds_read_b128 v[212:215], v2 offset:9216
    v_mfma_f32_16x16x32_bf16 v[28:31], v[172:175], v[164:167], v[28:31]
    ds_read_b128 v[216:219], v2 offset:10240
    v_mfma_f32_16x16x32_bf16 v[32:35], v[176:179], v[160:163], v[32:35]
    ds_read_b128 v[220:223], v2 offset:11264
    v_mfma_f32_16x16x32_bf16 v[36:39], v[176:179], v[164:167], v[36:39]
    ds_read_b128 v[224:227], v2 offset:12288
    v_mfma_f32_16x16x32_bf16 v[40:43], v[180:183], v[160:163], v[40:43]
    ds_read_b128 v[228:231], v2 offset:13312
    v_mfma_f32_16x16x32_bf16 v[44:47], v[180:183], v[164:167], v[44:47]
    ds_read_b128 v[232:235], v2 offset:14336
    s_waitcnt lgkmcnt(8)
    v_mfma_f32_16x16x32_bf16 v[48:51], v[184:187], v[160:163], v[48:51]
    ds_read_b128 v[236:239], v2 offset:15360
    v_mfma_f32_16x16x32_bf16 v[52:55], v[184:187], v[164:167], v[52:55]
    ds_read_b128 v[240:243], v2 offset:16384
    v_mfma_f32_16x16x32_bf16 v[56:59], v[188:191], v[160:163], v[56:59]
    ds_read_b128 v[244:247], v2 offset:17408
    v_mfma_f32_16x16x32_bf16 v[60:63], v[188:191], v[164:167], v[60:63]
    v_mfma_f32_16x16x32_bf16 v[64:67], v[192:195], v[160:163], v[64:67]
    v_mfma_f32_16x16x32_bf16 v[68:71], v[192:195], v[164:167], v[68:71]
    v_mfma_f32_16x16x32_bf16 v[72:75], v[196:199], v[160:163], v[72:75]
    v_mfma_f32_16x16x32_bf16 v[76:79], v[196:199], v[164:167], v[76:79]
    v_mfma_f32_16x16x32_bf16 v[80:83], v[200:203], v[160:163], v[80:83]
    v_mfma_f32_16x16x32_bf16 v[84:87], v[200:203], v[164:167], v[84:87]
    s_waitcnt lgkmcnt(0)
    s_barrier
    v_mfma_f32_16x16x32_bf16 v[16:19], v[212:215], v[204:207], v[16:19]
    ds_read_b128 v[160:163], v5 offset:36864
    v_mfma_f32_16x16x32_bf16 v[20:23], v[212:215], v[208:211], v[20:23]
    ds_read_b128 v[164:167], v5 offset:38912
    v_mfma_f32_16x16x32_bf16 v[24:27], v[216:219], v[204:207], v[24:27]
    ds_read_b128 v[168:171], v2 offset:36864
    v_mfma_f32_16x16x32_bf16 v[28:31], v[216:219], v[208:211], v[28:31]
    ds_read_b128 v[172:175], v2 offset:37888
    v_mfma_f32_16x16x32_bf16 v[32:35], v[220:223], v[204:207], v[32:35]
    ds_read_b128 v[176:179], v2 offset:38912
    v_mfma_f32_16x16x32_bf16 v[36:39], v[220:223], v[208:211], v[36:39]
    ds_read_b128 v[180:183], v2 offset:39936
    v_mfma_f32_16x16x32_bf16 v[40:43], v[224:227], v[204:207], v[40:43]
    ds_read_b128 v[184:187], v2 offset:40960
    v_mfma_f32_16x16x32_bf16 v[44:47], v[224:227], v[208:211], v[44:47]
    ds_read_b128 v[188:191], v2 offset:41984
    v_mfma_f32_16x16x32_bf16 v[48:51], v[228:231], v[204:207], v[48:51]
    ds_read_b128 v[192:195], v2 offset:43008
    v_mfma_f32_16x16x32_bf16 v[52:55], v[228:231], v[208:211], v[52:55]
    ds_read_b128 v[196:199], v2 offset:44032
    v_mfma_f32_16x16x32_bf16 v[56:59], v[232:235], v[204:207], v[56:59]
    ds_read_b128 v[200:203], v2 offset:45056
    v_mfma_f32_16x16x32_bf16 v[60:63], v[232:235], v[208:211], v[60:63]
    v_mfma_f32_16x16x32_bf16 v[64:67], v[236:239], v[204:207], v[64:67]
    v_mfma_f32_16x16x32_bf16 v[68:71], v[236:239], v[208:211], v[68:71]
    v_mfma_f32_16x16x32_bf16 v[72:75], v[240:243], v[204:207], v[72:75]
    v_mfma_f32_16x16x32_bf16 v[76:79], v[240:243], v[208:211], v[76:79]
    v_mfma_f32_16x16x32_bf16 v[80:83], v[244:247], v[204:207], v[80:83]
    v_mfma_f32_16x16x32_bf16 v[84:87], v[244:247], v[208:211], v[84:87]
    s_waitcnt lgkmcnt(5)
    v_mfma_f32_16x16x32_bf16 v[16:19], v[168:171], v[160:163], v[16:19]
    ds_read_b128 v[204:207], v6 offset:36864
    v_mfma_f32_16x16x32_bf16 v[20:23], v[168:171], v[164:167], v[20:23]
    ds_read_b128 v[208:211], v6 offset:38912
    v_mfma_f32_16x16x32_bf16 v[24:27], v[172:175], v[160:163], v[24:27]
    ds_read_b128 v[212:215], v2 offset:46080
    v_mfma_f32_16x16x32_bf16 v[28:31], v[172:175], v[164:167], v[28:31]
    ds_read_b128 v[216:219], v2 offset:47104
    v_mfma_f32_16x16x32_bf16 v[32:35], v[176:179], v[160:163], v[32:35]
    ds_read_b128 v[220:223], v2 offset:48128
    v_mfma_f32_16x16x32_bf16 v[36:39], v[176:179], v[164:167], v[36:39]
    ds_read_b128 v[224:227], v2 offset:49152
    v_mfma_f32_16x16x32_bf16 v[40:43], v[180:183], v[160:163], v[40:43]
    ds_read_b128 v[228:231], v2 offset:50176
    v_mfma_f32_16x16x32_bf16 v[44:47], v[180:183], v[164:167], v[44:47]
    ds_read_b128 v[232:235], v2 offset:51200
    s_waitcnt lgkmcnt(8)
    v_mfma_f32_16x16x32_bf16 v[48:51], v[184:187], v[160:163], v[48:51]
    ds_read_b128 v[236:239], v2 offset:52224
    v_mfma_f32_16x16x32_bf16 v[52:55], v[184:187], v[164:167], v[52:55]
    ds_read_b128 v[240:243], v2 offset:53248
    v_mfma_f32_16x16x32_bf16 v[56:59], v[188:191], v[160:163], v[56:59]
    ds_read_b128 v[244:247], v2 offset:54272
    v_mfma_f32_16x16x32_bf16 v[60:63], v[188:191], v[164:167], v[60:63]
    v_mfma_f32_16x16x32_bf16 v[64:67], v[192:195], v[160:163], v[64:67]
    v_mfma_f32_16x16x32_bf16 v[68:71], v[192:195], v[164:167], v[68:71]
    v_mfma_f32_16x16x32_bf16 v[72:75], v[196:199], v[160:163], v[72:75]
    v_mfma_f32_16x16x32_bf16 v[76:79], v[196:199], v[164:167], v[76:79]
    v_mfma_f32_16x16x32_bf16 v[80:83], v[200:203], v[160:163], v[80:83]
    v_mfma_f32_16x16x32_bf16 v[84:87], v[200:203], v[164:167], v[84:87]
    s_waitcnt lgkmcnt(0)
    s_barrier
    v_mfma_f32_16x16x32_bf16 v[16:19], v[212:215], v[204:207], v[16:19]
    ds_read_b128 v[160:163], v3 offset:0
    v_mfma_f32_16x16x32_bf16 v[20:23], v[212:215], v[208:211], v[20:23]
    ds_read_b128 v[164:167], v3 offset:2048
    v_mfma_f32_16x16x32_bf16 v[24:27], v[216:219], v[204:207], v[24:27]
    ds_read_b128 v[168:171], v1 offset:0
    v_mfma_f32_16x16x32_bf16 v[28:31], v[216:219], v[208:211], v[28:31]
    ds_read_b128 v[172:175], v1 offset:1024
    v_mfma_f32_16x16x32_bf16 v[32:35], v[220:223], v[204:207], v[32:35]
    ds_read_b128 v[176:179], v1 offset:2048
    v_mfma_f32_16x16x32_bf16 v[36:39], v[220:223], v[208:211], v[36:39]
    ds_read_b128 v[180:183], v1 offset:3072
    v_mfma_f32_16x16x32_bf16 v[40:43], v[224:227], v[204:207], v[40:43]
    ds_read_b128 v[184:187], v1 offset:4096
    v_mfma_f32_16x16x32_bf16 v[44:47], v[224:227], v[208:211], v[44:47]
    ds_read_b128 v[188:191], v1 offset:5120
    v_mfma_f32_16x16x32_bf16 v[48:51], v[228:231], v[204:207], v[48:51]
    ds_read_b128 v[192:195], v1 offset:6144
    v_mfma_f32_16x16x32_bf16 v[52:55], v[228:231], v[208:211], v[52:55]
    ds_read_b128 v[196:199], v1 offset:7168
    v_mfma_f32_16x16x32_bf16 v[56:59], v[232:235], v[204:207], v[56:59]
    ds_read_b128 v[200:203], v1 offset:8192
    v_mfma_f32_16x16x32_bf16 v[60:63], v[232:235], v[208:211], v[60:63]
    v_mfma_f32_16x16x32_bf16 v[64:67], v[236:239], v[204:207], v[64:67]
    v_mfma_f32_16x16x32_bf16 v[68:71], v[236:239], v[208:211], v[68:71]
    v_mfma_f32_16x16x32_bf16 v[72:75], v[240:243], v[204:207], v[72:75]
    v_mfma_f32_16x16x32_bf16 v[76:79], v[240:243], v[208:211], v[76:79]
    v_mfma_f32_16x16x32_bf16 v[80:83], v[244:247], v[204:207], v[80:83]
    v_mfma_f32_16x16x32_bf16 v[84:87], v[244:247], v[208:211], v[84:87]
    s_waitcnt lgkmcnt(5)
    v_mfma_f32_16x16x32_bf16 v[16:19], v[168:171], v[160:163], v[16:19]
    ds_read_b128 v[204:207], v4 offset:0
    v_mfma_f32_16x16x32_bf16 v[20:23], v[168:171], v[164:167], v[20:23]
    ds_read_b128 v[208:211], v4 offset:2048
    v_mfma_f32_16x16x32_bf16 v[24:27], v[172:175], v[160:163], v[24:27]
    ds_read_b128 v[212:215], v1 offset:9216
    v_mfma_f32_16x16x32_bf16 v[28:31], v[172:175], v[164:167], v[28:31]
    ds_read_b128 v[216:219], v1 offset:10240
    v_mfma_f32_16x16x32_bf16 v[32:35], v[176:179], v[160:163], v[32:35]
    ds_read_b128 v[220:223], v1 offset:11264
    v_mfma_f32_16x16x32_bf16 v[36:39], v[176:179], v[164:167], v[36:39]
    ds_read_b128 v[224:227], v1 offset:12288
    v_mfma_f32_16x16x32_bf16 v[40:43], v[180:183], v[160:163], v[40:43]
    ds_read_b128 v[228:231], v1 offset:13312
    v_mfma_f32_16x16x32_bf16 v[44:47], v[180:183], v[164:167], v[44:47]
    ds_read_b128 v[232:235], v1 offset:14336
    s_waitcnt lgkmcnt(8)
    v_mfma_f32_16x16x32_bf16 v[48:51], v[184:187], v[160:163], v[48:51]
    ds_read_b128 v[236:239], v1 offset:15360
    v_mfma_f32_16x16x32_bf16 v[52:55], v[184:187], v[164:167], v[52:55]
    ds_read_b128 v[240:243], v1 offset:16384
    v_mfma_f32_16x16x32_bf16 v[56:59], v[188:191], v[160:163], v[56:59]
    ds_read_b128 v[244:247], v1 offset:17408
    v_mfma_f32_16x16x32_bf16 v[60:63], v[188:191], v[164:167], v[60:63]
    v_mfma_f32_16x16x32_bf16 v[64:67], v[192:195], v[160:163], v[64:67]
    v_mfma_f32_16x16x32_bf16 v[68:71], v[192:195], v[164:167], v[68:71]
    v_mfma_f32_16x16x32_bf16 v[72:75], v[196:199], v[160:163], v[72:75]
    v_mfma_f32_16x16x32_bf16 v[76:79], v[196:199], v[164:167], v[76:79]
    v_mfma_f32_16x16x32_bf16 v[80:83], v[200:203], v[160:163], v[80:83]
    v_mfma_f32_16x16x32_bf16 v[84:87], v[200:203], v[164:167], v[84:87]
    s_waitcnt lgkmcnt(0)
    s_barrier
    v_mfma_f32_16x16x32_bf16 v[16:19], v[212:215], v[204:207], v[16:19]
    ds_read_b128 v[160:163], v3 offset:36864
    v_mfma_f32_16x16x32_bf16 v[20:23], v[212:215], v[208:211], v[20:23]
    ds_read_b128 v[164:167], v3 offset:38912
    v_mfma_f32_16x16x32_bf16 v[24:27], v[216:219], v[204:207], v[24:27]
    ds_read_b128 v[176:179], v1 offset:36864
    v_mfma_f32_16x16x32_bf16 v[28:31], v[216:219], v[208:211], v[28:31]
    ds_read_b128 v[168:171], v4 offset:36864
    v_mfma_f32_16x16x32_bf16 v[32:35], v[220:223], v[204:207], v[32:35]
    ds_read_b128 v[172:175], v4 offset:38912
    v_mfma_f32_16x16x32_bf16 v[36:39], v[220:223], v[208:211], v[36:39]
    ds_read_b128 v[180:183], v1 offset:46080
    v_mfma_f32_16x16x32_bf16 v[40:43], v[224:227], v[204:207], v[40:43]
    ds_read_b128 v[184:187], v1 offset:37888
    v_mfma_f32_16x16x32_bf16 v[44:47], v[224:227], v[208:211], v[44:47]
    ds_read_b128 v[188:191], v1 offset:47104
    v_mfma_f32_16x16x32_bf16 v[48:51], v[228:231], v[204:207], v[48:51]
    ds_read_b128 v[192:195], v1 offset:38912
    v_mfma_f32_16x16x32_bf16 v[52:55], v[228:231], v[208:211], v[52:55]
    ds_read_b128 v[196:199], v1 offset:48128
    v_mfma_f32_16x16x32_bf16 v[56:59], v[232:235], v[204:207], v[56:59]
    ds_read_b128 v[200:203], v1 offset:39936
    v_mfma_f32_16x16x32_bf16 v[60:63], v[232:235], v[208:211], v[60:63]
    v_mfma_f32_16x16x32_bf16 v[64:67], v[236:239], v[204:207], v[64:67]
    v_mfma_f32_16x16x32_bf16 v[68:71], v[236:239], v[208:211], v[68:71]
    v_mfma_f32_16x16x32_bf16 v[72:75], v[240:243], v[204:207], v[72:75]
    v_mfma_f32_16x16x32_bf16 v[76:79], v[240:243], v[208:211], v[76:79]
    v_mfma_f32_16x16x32_bf16 v[80:83], v[244:247], v[204:207], v[80:83]
    v_mfma_f32_16x16x32_bf16 v[84:87], v[244:247], v[208:211], v[84:87]
    s_waitcnt lgkmcnt(0)
    v_mfma_f32_16x16x32_bf16 v[16:19], v[176:179], v[160:163], v[16:19]
    ds_read_b128 v[204:207], v1 offset:49152
    v_mfma_f32_16x16x32_bf16 v[20:23], v[176:179], v[164:167], v[20:23]
    ds_read_b128 v[208:211], v1 offset:40960
    s_waitcnt lgkmcnt(7)
    v_mfma_f32_16x16x32_bf16 v[16:19], v[180:183], v[168:171], v[16:19]
    ds_read_b128 v[212:215], v1 offset:50176
    v_mfma_f32_16x16x32_bf16 v[20:23], v[180:183], v[172:175], v[20:23]
    s_waitcnt lgkmcnt(7)
    v_mfma_f32_16x16x32_bf16 v[24:27], v[184:187], v[160:163], v[24:27]
    ds_read_b128 v[216:219], v1 offset:41984
    v_mfma_f32_16x16x32_bf16 v[28:31], v[184:187], v[164:167], v[28:31]
    s_waitcnt lgkmcnt(7)
    v_mfma_f32_16x16x32_bf16 v[24:27], v[188:191], v[168:171], v[24:27]
    ds_read_b128 v[220:223], v1 offset:51200
    v_mfma_f32_16x16x32_bf16 v[28:31], v[188:191], v[172:175], v[28:31]
    s_waitcnt lgkmcnt(7)
    v_mfma_f32_16x16x32_bf16 v[32:35], v[192:195], v[160:163], v[32:35]
    ds_read_b128 v[224:227], v1 offset:43008
    v_mul_f32 v16, v16, v88
    v_mfma_f32_16x16x32_bf16 v[36:39], v[192:195], v[164:167], v[36:39]
    v_mul_f32 v17, v17, v89
    v_mul_f32 v18, v18, v90
    s_waitcnt lgkmcnt(7)
    v_mfma_f32_16x16x32_bf16 v[32:35], v[196:199], v[168:171], v[32:35]
    ds_read_b128 v[228:231], v1 offset:52224
    v_mul_f32 v19, v19, v91
    v_mfma_f32_16x16x32_bf16 v[36:39], v[196:199], v[172:175], v[36:39]
    v_cvt_pk_bf16_f32 v88, v16, v17
    v_cvt_pk_bf16_f32 v89, v18, v19
    s_waitcnt lgkmcnt(7)
    v_mfma_f32_16x16x32_bf16 v[40:43], v[200:203], v[160:163], v[40:43]
    ds_read_b128 v[232:235], v1 offset:44032
    v_mul_f32 v20, v20, v92
    v_mfma_f32_16x16x32_bf16 v[44:47], v[200:203], v[164:167], v[44:47]
    v_mul_f32 v21, v21, v93
    v_mul_f32 v22, v22, v94
    v_mul_f32 v23, v23, v95
    s_waitcnt lgkmcnt(7)
    v_mfma_f32_16x16x32_bf16 v[40:43], v[204:207], v[168:171], v[40:43]
    ds_read_b128 v[236:239], v1 offset:53248
    v_cvt_pk_bf16_f32 v92, v20, v21
    v_mfma_f32_16x16x32_bf16 v[44:47], v[204:207], v[172:175], v[44:47]
    v_cvt_pk_bf16_f32 v93, v22, v23
    v_mul_f32 v24, v24, v96
    v_mul_f32 v25, v25, v97
    s_waitcnt lgkmcnt(7)
    v_mfma_f32_16x16x32_bf16 v[48:51], v[208:211], v[160:163], v[48:51]
    ds_read_b128 v[240:243], v1 offset:45056
    v_mul_f32 v26, v26, v98
    v_mfma_f32_16x16x32_bf16 v[52:55], v[208:211], v[164:167], v[52:55]
    v_mul_f32 v27, v27, v99
    v_cvt_pk_bf16_f32 v90, v24, v25
    v_cvt_pk_bf16_f32 v91, v26, v27
    s_waitcnt lgkmcnt(7)
    v_mfma_f32_16x16x32_bf16 v[48:51], v[212:215], v[168:171], v[48:51]
    ds_read_b128 v[244:247], v1 offset:54272
    buffer_store_dwordx4 v[88:91], v14, s[4:7], s39 offen offset:0 sc1
    v_mfma_f32_16x16x32_bf16 v[52:55], v[212:215], v[172:175], v[52:55]
    v_mul_f32 v28, v28, v100
    v_mul_f32 v29, v29, v101
    v_mul_f32 v30, v30, v102
    s_waitcnt lgkmcnt(7)
    v_mfma_f32_16x16x32_bf16 v[56:59], v[216:219], v[160:163], v[56:59]
    v_mul_f32 v31, v31, v103
    v_cvt_pk_bf16_f32 v94, v28, v29
    v_mfma_f32_16x16x32_bf16 v[60:63], v[216:219], v[164:167], v[60:63]
    v_cvt_pk_bf16_f32 v95, v30, v31
    buffer_store_dwordx4 v[92:95], v14, s[4:7], s40 offen offset:0 sc1
    v_mul_f32 v32, v32, v104
    s_waitcnt lgkmcnt(6)
    v_mfma_f32_16x16x32_bf16 v[56:59], v[220:223], v[168:171], v[56:59]
    v_mul_f32 v33, v33, v105
    v_mul_f32 v34, v34, v106
    v_mfma_f32_16x16x32_bf16 v[60:63], v[220:223], v[172:175], v[60:63]
    v_mul_f32 v35, v35, v107
    v_cvt_pk_bf16_f32 v104, v32, v33
    v_cvt_pk_bf16_f32 v105, v34, v35
    s_waitcnt lgkmcnt(5)
    v_mfma_f32_16x16x32_bf16 v[64:67], v[224:227], v[160:163], v[64:67]
    v_mul_f32 v36, v36, v108
    v_mul_f32 v37, v37, v109
    v_mfma_f32_16x16x32_bf16 v[68:71], v[224:227], v[164:167], v[68:71]
    v_mul_f32 v38, v38, v110
    v_mul_f32 v39, v39, v111
    v_cvt_pk_bf16_f32 v108, v36, v37
    s_waitcnt lgkmcnt(4)
    v_mfma_f32_16x16x32_bf16 v[64:67], v[228:231], v[168:171], v[64:67]
    v_cvt_pk_bf16_f32 v109, v38, v39
    v_mul_f32 v40, v40, v112
    v_mfma_f32_16x16x32_bf16 v[68:71], v[228:231], v[172:175], v[68:71]
    v_mul_f32 v41, v41, v113
    v_mul_f32 v42, v42, v114
    v_mul_f32 v43, v43, v115
    s_waitcnt lgkmcnt(3)
    v_mfma_f32_16x16x32_bf16 v[72:75], v[232:235], v[160:163], v[72:75]
    v_cvt_pk_bf16_f32 v106, v40, v41
    v_cvt_pk_bf16_f32 v107, v42, v43
    v_mfma_f32_16x16x32_bf16 v[76:79], v[232:235], v[164:167], v[76:79]
    buffer_store_dwordx4 v[104:107], v14, s[4:7], s39 offen offset:1024 sc1
    v_mul_f32 v44, v44, v116
    v_mul_f32 v45, v45, v117
    s_waitcnt lgkmcnt(2)
    v_mfma_f32_16x16x32_bf16 v[72:75], v[236:239], v[168:171], v[72:75]
    v_mul_f32 v46, v46, v118
    v_mul_f32 v47, v47, v119
    v_mfma_f32_16x16x32_bf16 v[76:79], v[236:239], v[172:175], v[76:79]
    v_cvt_pk_bf16_f32 v110, v44, v45
    v_cvt_pk_bf16_f32 v111, v46, v47
    buffer_store_dwordx4 v[108:111], v14, s[4:7], s40 offen offset:1024 sc1
    s_waitcnt lgkmcnt(1)
    v_mfma_f32_16x16x32_bf16 v[80:83], v[240:243], v[160:163], v[80:83]
    v_mul_f32 v48, v48, v120
    v_mul_f32 v49, v49, v121
    v_mfma_f32_16x16x32_bf16 v[84:87], v[240:243], v[164:167], v[84:87]
    v_mul_f32 v50, v50, v122
    v_mul_f32 v51, v51, v123
    v_cvt_pk_bf16_f32 v120, v48, v49
    s_waitcnt lgkmcnt(0)
    v_mfma_f32_16x16x32_bf16 v[80:83], v[244:247], v[168:171], v[80:83]
    v_cvt_pk_bf16_f32 v121, v50, v51
    v_mul_f32 v52, v52, v124
    v_mfma_f32_16x16x32_bf16 v[84:87], v[244:247], v[172:175], v[84:87]
    v_mul_f32 v53, v53, v125
    v_mul_f32 v54, v54, v126
    v_mul_f32 v55, v55, v127
    v_cvt_pk_bf16_f32 v124, v52, v53
    v_cvt_pk_bf16_f32 v125, v54, v55
    v_mul_f32 v56, v56, v128
    v_mul_f32 v57, v57, v129
    v_mul_f32 v58, v58, v130
    v_mul_f32 v59, v59, v131
    v_cvt_pk_bf16_f32 v122, v56, v57
    v_cvt_pk_bf16_f32 v123, v58, v59
    buffer_store_dwordx4 v[120:123], v14, s[4:7], s39 offen offset:2048 sc1
    v_mul_f32 v60, v60, v132
    v_mul_f32 v61, v61, v133
    v_mul_f32 v62, v62, v134
    v_mul_f32 v63, v63, v135
    v_cvt_pk_bf16_f32 v126, v60, v61
    v_cvt_pk_bf16_f32 v127, v62, v63
    buffer_store_dwordx4 v[124:127], v14, s[4:7], s40 offen offset:2048 sc1
    v_mul_f32 v64, v64, v136
    v_mul_f32 v65, v65, v137
    v_mul_f32 v66, v66, v138
    v_mul_f32 v67, v67, v139
    v_cvt_pk_bf16_f32 v136, v64, v65
    v_cvt_pk_bf16_f32 v137, v66, v67
    v_mul_f32 v68, v68, v140
    v_mul_f32 v69, v69, v141
    v_mul_f32 v70, v70, v142
    v_mul_f32 v71, v71, v143
    v_cvt_pk_bf16_f32 v140, v68, v69
    v_cvt_pk_bf16_f32 v141, v70, v71
    s_nop 0
    v_mul_f32 v72, v72, v144
    v_mul_f32 v73, v73, v145
    v_mul_f32 v74, v74, v146
    v_mul_f32 v75, v75, v147
    v_cvt_pk_bf16_f32 v138, v72, v73
    v_cvt_pk_bf16_f32 v139, v74, v75
    buffer_store_dwordx4 v[136:139], v14, s[4:7], s39 offen offset:3072 sc1
    v_mul_f32 v76, v76, v148
    v_mul_f32 v77, v77, v149
    v_mul_f32 v78, v78, v150
    v_mul_f32 v79, v79, v151
    v_cvt_pk_bf16_f32 v142, v76, v77
    v_cvt_pk_bf16_f32 v143, v78, v79
    buffer_store_dwordx4 v[140:143], v14, s[4:7], s40 offen offset:3072 sc1
    v_mul_f32 v80, v80, v152
    v_mul_f32 v81, v81, v153
    v_mul_f32 v82, v82, v154
    v_mul_f32 v83, v83, v155
    v_cvt_pk_bf16_f32 v152, v80, v81
    v_cvt_pk_bf16_f32 v153, v82, v83
    buffer_store_dwordx2 v[152:153], v15, s[4:7], s39 offen sc1
    v_mul_f32 v84, v84, v156
    v_mul_f32 v85, v85, v157
    v_mul_f32 v86, v86, v158
    v_mul_f32 v87, v87, v159
    v_cvt_pk_bf16_f32 v156, v84, v85
    v_cvt_pk_bf16_f32 v157, v86, v87
    buffer_store_dwordx2 v[156:157], v15, s[4:7], s40 offen sc1
    s_and_b32 s25, s2, 7
    s_lshr_b32 s26, s2, 3
    s_lshl_b32 s23, s25, 2
    s_lshr_b32 s27, s26, 3
    s_add_u32 s23, s23, s27
    s_and_b32 s24, s26, 7
    s_add_u32 s25, s23, s24
    s_and_b32 s25, s25, 3
    s_lshl_b32 s30, s23, 2
    s_add_u32 s30, s30, s20
    s_mul_i32 s29, s30, 73728
    s_add_u32 s29, s29, s21
    s_add_u32 s29, s29, 0x1200000
    s_mul_i32 s34, s30, 18432
    s_add_u32 s34, s34, s21
    s_add_u32 s34, s34, 0x300000
    s_lshl_b32 s35, s24, 11
    s_lshr_b32 s36, s24, 2
    s_lshl_b32 s36, s36, 10
    s_and_b32 s37, s24, 3
    s_lshl_b32 s37, s37, 8
    s_add_u32 s36, s36, s37
    s_add_u32 s36, s36, 16384
    v_bfe_u32 v2, v1, 4, 4
    v_lshrrev_b32 v3, 8, v1
    v_add_u32 v4, s35, v1
    v_lshlrev_b32 v5, 4, v2
    v_lshl_add_u32 v5, v3, 3, v5
    v_add_u32 v5, s36, v5
    v_cmp_gt_u32 s[40:41], 2, v3
    v_bfrev_b32 v6, 1
    v_add_u32 v12, 0, v1
    v_add_u32 v13, 36864, v1
    v_add_u32 v14, 73728, v1
    v_add_u32 v15, 110592, v1
    v_cndmask_b32 v5, v6, v5, s[40:41]
    buffer_load_dwordx4 v[208:211], v4, s[4:7], s34 offen offset:0 sc1
    buffer_load_dwordx4 v[212:215], v4, s[4:7], s34 offen offset:1024 sc1
    buffer_load_dwordx2 v[216:217], v5, s[4:7], s34 offen sc1
    s_add_u32 s34, s34, 0x1900000
    s_lshl_b32 s39, s30, 10
    s_add_u32 s39, s39, s21
    s_lshl_b32 s42, s24, 7
    s_add_u32 s39, s39, s42
    s_add_u32 s39, s39, 0x3700000
    v_cmp_eq_u32 vcc, 0, v3
    v_lshlrev_b32 v10, 3, v2
    v_mov_b32 v11, 0x3f803f80
    v_lshrrev_b32 v7, 1, v1
    v_cndmask_b32 v10, v6, v10, vcc
    s_cmp_eq_u32 s22, 0
    s_cbranch_scc1 L_p5_nf
    v_mul_u32_u24 v9, 1152, v2
    s_mul_i32 s34, s30, 18432
    s_mul_i32 s42, s24, 144
    s_add_u32 s34, s34, s42
    v_lshl_add_u32 v4, v3, 4, v9
    v_lshl_add_u32 v5, v3, 3, v9
    v_cndmask_b32 v5, v6, v5, s[40:41]
L_p5_nf:
    s_lshr_b32 s44, s23, 1
    s_lshl_b32 s52, s22, 7
    s_add_u32 s52, s52, s44
    s_lshl_b32 s52, s52, 8
    s_add_u32 s52, s52, 0x450a000
    s_add_u32 s52, s52, s4
    s_addc_u32 s53, s5, 0
    s_waitcnt vmcnt(3)
    s_barrier
    s_cmp_lg_u32 s20, 0
    s_cbranch_scc1 L_ns_d5
    s_mov_b32 s56, 1
    s_atomic_add s56, s[50:51], 0
L_ns_d5:
    s_cmp_lg_u32 s20, 0
    s_cbranch_scc1 L_pd_d5
    s_mov_b32 s60, 65536
L_poll_d5:
    s_mov_b32 s57, 0
    s_atomic_add s57, s[52:53], 0 glc
    s_waitcnt lgkmcnt(0)
    s_cmp_ge_u32 s57, 16
    s_cbranch_scc1 L_pd_d5
    s_sub_u32 s60, s60, 1
    s_cbranch_scc1 L_pd_d5
    s_sleep 2
    s_branch L_poll_d5
L_pd_d5:
    s_barrier
    s_mov_b32 s32, 0
    s_lshl_b32 s32, s32, 13
    s_add_u32 s32, s32, s29
    s_add_u32 s33, s32, 4096
    buffer_load_dwordx4 v[112:115], v1, s[4:7], s32 offen offset:0 sc1
    buffer_load_dwordx4 v[116:119], v1, s[4:7], s32 offen offset:1024 sc1
    buffer_load_dwordx4 v[120:123], v1, s[4:7], s32 offen offset:2048 sc1
    buffer_load_dwordx4 v[124:127], v1, s[4:7], s32 offen offset:3072 sc1
    buffer_load_dwordx4 v[128:131], v1, s[4:7], s33 offen offset:0 sc1
    buffer_load_dwordx4 v[132:135], v1, s[4:7], s33 offen offset:1024 sc1
    buffer_load_dwordx4 v[136:139], v1, s[4:7], s33 offen offset:2048 sc1
    buffer_load_dwordx4 v[140:143], v1, s[4:7], s33 offen offset:3072 sc1
    ds_read_b128 v[40:43], v14 offset:0
    ds_read_b128 v[44:47], v14 offset:1024
    ds_read_b128 v[48:51], v14 offset:2048
    ds_read_b128 v[52:55], v14 offset:3072
    ds_read_b128 v[72:75], v14 offset:8192
    ds_read_b128 v[56:59], v14 offset:4096
    ds_read_b128 v[60:63], v14 offset:5120
    ds_read_b128 v[64:67], v14 offset:6144
    ds_read_b128 v[68:71], v14 offset:7168
    s_mov_b32 s32, 1
    s_lshl_b32 s32, s32, 13
    s_add_u32 s32, s32, s29
    s_add_u32 s33, s32, 4096
    buffer_load_dwordx4 v[144:147], v1, s[4:7], s32 offen offset:0 sc1
    buffer_load_dwordx4 v[148:151], v1, s[4:7], s32 offen offset:1024 sc1
    buffer_load_dwordx4 v[152:155], v1, s[4:7], s32 offen offset:2048 sc1
    buffer_load_dwordx4 v[156:159], v1, s[4:7], s32 offen offset:3072 sc1
    buffer_load_dwordx4 v[160:163], v1, s[4:7], s33 offen offset:0 sc1
    buffer_load_dwordx4 v[164:167], v1, s[4:7], s33 offen offset:1024 sc1
    buffer_load_dwordx4 v[168:171], v1, s[4:7], s33 offen offset:2048 sc1
    buffer_load_dwordx4 v[172:175], v1, s[4:7], s33 offen offset:3072 sc1
    s_lshl_b32 s50, s22, 7
    s_add_u32 s50, s50, s44
    s_lshl_b32 s50, s50, 8
    s_add_u32 s50, s50, 0x450b000
    s_add_u32 s50, s50, s4
    s_addc_u32 s51, s5, 0
    s_waitcnt vmcnt(16)
    v_lshlrev_b32 v16, 16, v208
    v_and_b32 v17, 0xffff0000, v208
    v_lshlrev_b32 v18, 16, v209
    v_and_b32 v19, 0xffff0000, v209
    v_lshlrev_b32 v20, 16, v210
    v_and_b32 v21, 0xffff0000, v210
    v_lshlrev_b32 v22, 16, v211
    v_and_b32 v23, 0xffff0000, v211
    v_lshlrev_b32 v24, 16, v212
    v_and_b32 v25, 0xffff0000, v212
    v_lshlrev_b32 v26, 16, v213
    v_and_b32 v27, 0xffff0000, v213
    v_lshlrev_b32 v28, 16, v214
    v_and_b32 v29, 0xffff0000, v214
    v_lshlrev_b32 v30, 16, v215
    v_and_b32 v31, 0xffff0000, v215
    v_lshlrev_b32 v32, 16, v216
    v_and_b32 v33, 0xffff0000, v216
    v_lshlrev_b32 v34, 16, v217
    v_and_b32 v35, 0xffff0000, v217
    s_waitcnt vmcnt(14) lgkmcnt(4)
    v_mfma_f32_16x16x32_bf16 v[16:19], v[40:43], v[112:115], v[16:19]
    ds_read_b128 v[76:79], v14 offset:9216
    s_mov_b32 s32, 2
    s_lshl_b32 s32, s32, 13
    s_add_u32 s32, s32, s29
    s_add_u32 s33, s32, 4096
    v_mfma_f32_16x16x32_bf16 v[20:23], v[44:47], v[112:115], v[20:23]
    ds_read_b128 v[80:83], v14 offset:10240
    v_mfma_f32_16x16x32_bf16 v[24:27], v[48:51], v[112:115], v[24:27]
    ds_read_b128 v[84:87], v14 offset:11264
    buffer_load_dwordx4 v[176:179], v1, s[4:7], s32 offen offset:0 sc1
    v_mfma_f32_16x16x32_bf16 v[28:31], v[52:55], v[112:115], v[28:31]
    ds_read_b128 v[88:91], v14 offset:12288
    v_mfma_f32_16x16x32_bf16 v[32:35], v[72:75], v[112:115], v[32:35]
    ds_read_b128 v[108:111], v14 offset:17408
    s_waitcnt lgkmcnt(5)
    v_mfma_f32_16x16x32_bf16 v[16:19], v[56:59], v[116:119], v[16:19]
    ds_read_b128 v[92:95], v14 offset:13312
    v_mfma_f32_16x16x32_bf16 v[20:23], v[60:63], v[116:119], v[20:23]
    ds_read_b128 v[96:99], v14 offset:14336
    buffer_load_dwordx4 v[180:183], v1, s[4:7], s32 offen offset:1024 sc1
    v_mfma_f32_16x16x32_bf16 v[24:27], v[64:67], v[116:119], v[24:27]
    ds_read_b128 v[100:103], v14 offset:15360
    v_mfma_f32_16x16x32_bf16 v[28:31], v[68:71], v[116:119], v[28:31]
    ds_read_b128 v[104:107], v14 offset:16384
    v_mfma_f32_16x16x32_bf16 v[36:39], v[72:75], v[116:119], 0
    s_waitcnt vmcnt(14) lgkmcnt(4)
    v_mfma_f32_16x16x32_bf16 v[16:19], v[76:79], v[120:123], v[16:19]
    ds_read_b128 v[40:43], v14 offset:18432
    v_mfma_f32_16x16x32_bf16 v[20:23], v[80:83], v[120:123], v[20:23]
    ds_read_b128 v[44:47], v14 offset:19456
    v_mfma_f32_16x16x32_bf16 v[24:27], v[84:87], v[120:123], v[24:27]
    ds_read_b128 v[48:51], v14 offset:20480
    buffer_load_dwordx4 v[184:187], v1, s[4:7], s32 offen offset:2048 sc1
    v_mfma_f32_16x16x32_bf16 v[28:31], v[88:91], v[120:123], v[28:31]
    ds_read_b128 v[52:55], v14 offset:21504
    v_mfma_f32_16x16x32_bf16 v[32:35], v[108:111], v[120:123], v[32:35]
    ds_read_b128 v[72:75], v14 offset:26624
    s_waitcnt lgkmcnt(5)
    v_mfma_f32_16x16x32_bf16 v[16:19], v[92:95], v[124:127], v[16:19]
    ds_read_b128 v[56:59], v14 offset:22528
    v_mfma_f32_16x16x32_bf16 v[20:23], v[96:99], v[124:127], v[20:23]
    ds_read_b128 v[60:63], v14 offset:23552
    buffer_load_dwordx4 v[188:191], v1, s[4:7], s32 offen offset:3072 sc1
    v_mfma_f32_16x16x32_bf16 v[24:27], v[100:103], v[124:127], v[24:27]
    ds_read_b128 v[64:67], v14 offset:24576
    v_mfma_f32_16x16x32_bf16 v[28:31], v[104:107], v[124:127], v[28:31]
    ds_read_b128 v[68:71], v14 offset:25600
    v_mfma_f32_16x16x32_bf16 v[36:39], v[108:111], v[124:127], v[36:39]
    s_waitcnt vmcnt(14) lgkmcnt(4)
    v_mfma_f32_16x16x32_bf16 v[16:19], v[40:43], v[128:131], v[16:19]
    ds_read_b128 v[76:79], v14 offset:27648
    v_mfma_f32_16x16x32_bf16 v[20:23], v[44:47], v[128:131], v[20:23]
    ds_read_b128 v[80:83], v14 offset:28672
    v_mfma_f32_16x16x32_bf16 v[24:27], v[48:51], v[128:131], v[24:27]
    ds_read_b128 v[84:87], v14 offset:29696
    buffer_load_dwordx4 v[192:195], v1, s[4:7], s33 offen offset:0 sc1
    v_mfma_f32_16x16x32_bf16 v[28:31], v[52:55], v[128:131], v[28:31]
    ds_read_b128 v[88:91], v14 offset:30720
    v_mfma_f32_16x16x32_bf16 v[32:35], v[72:75], v[128:131], v[32:35]
    ds_read_b128 v[108:111], v14 offset:35840
    s_waitcnt lgkmcnt(5)
    v_mfma_f32_16x16x32_bf16 v[16:19], v[56:59], v[132:135], v[16:19]
    ds_read_b128 v[92:95], v14 offset:31744
    v_mfma_f32_16x16x32_bf16 v[20:23], v[60:63], v[132:135], v[20:23]
    ds_read_b128 v[96:99], v14 offset:32768
    buffer_load_dwordx4 v[196:199], v1, s[4:7], s33 offen offset:1024 sc1
    v_mfma_f32_16x16x32_bf16 v[24:27], v[64:67], v[132:135], v[24:27]
    ds_read_b128 v[100:103], v14 offset:33792
    v_mfma_f32_16x16x32_bf16 v[28:31], v[68:71], v[132:135], v[28:31]
    ds_read_b128 v[104:107], v14 offset:34816
    v_mfma_f32_16x16x32_bf16 v[36:39], v[72:75], v[132:135], v[36:39]
    s_waitcnt vmcnt(14) lgkmcnt(0)
    s_barrier
    v_mfma_f32_16x16x32_bf16 v[16:19], v[76:79], v[136:139], v[16:19]
    ds_read_b128 v[40:43], v15 offset:0
    v_mfma_f32_16x16x32_bf16 v[20:23], v[80:83], v[136:139], v[20:23]
    ds_read_b128 v[44:47], v15 offset:1024
    v_mfma_f32_16x16x32_bf16 v[24:27], v[84:87], v[136:139], v[24:27]
    ds_read_b128 v[48:51], v15 offset:2048
    buffer_load_dwordx4 v[200:203], v1, s[4:7], s33 offen offset:2048 sc1
    v_mfma_f32_16x16x32_bf16 v[28:31], v[88:91], v[136:139], v[28:31]
    ds_read_b128 v[52:55], v15 offset:3072
    v_mfma_f32_16x16x32_bf16 v[32:35], v[108:111], v[136:139], v[32:35]
    ds_read_b128 v[72:75], v15 offset:8192
    v_mfma_f32_16x16x32_bf16 v[16:19], v[92:95], v[140:143], v[16:19]
    ds_read_b128 v[56:59], v15 offset:4096
    v_mfma_f32_16x16x32_bf16 v[20:23], v[96:99], v[140:143], v[20:23]
    ds_read_b128 v[60:63], v15 offset:5120
    buffer_load_dwordx4 v[204:207], v1, s[4:7], s33 offen offset:3072 sc1
    v_mfma_f32_16x16x32_bf16 v[24:27], v[100:103], v[140:143], v[24:27]
    ds_read_b128 v[64:67], v15 offset:6144
    v_mfma_f32_16x16x32_bf16 v[28:31], v[104:107], v[140:143], v[28:31]
    ds_read_b128 v[68:71], v15 offset:7168
    v_mfma_f32_16x16x32_bf16 v[36:39], v[108:111], v[140:143], v[36:39]
    s_waitcnt vmcnt(14) lgkmcnt(4)
    v_mfma_f32_16x16x32_bf16 v[16:19], v[40:43], v[144:147], v[16:19]
    ds_read_b128 v[76:79], v15 offset:9216
    s_mov_b32 s32, 3
    s_lshl_b32 s32, s32, 13
    s_add_u32 s32, s32, s29
    s_add_u32 s33, s32, 4096
    v_mfma_f32_16x16x32_bf16 v[20:23], v[44:47], v[144:147], v[20:23]
    ds_read_b128 v[80:83], v15 offset:10240
    v_mfma_f32_16x16x32_bf16 v[24:27], v[48:51], v[144:147], v[24:27]
    ds_read_b128 v[84:87], v15 offset:11264
    buffer_load_dwordx4 v[112:115], v1, s[4:7], s32 offen offset:0 sc1
    v_mfma_f32_16x16x32_bf16 v[28:31], v[52:55], v[144:147], v[28:31]
    ds_read_b128 v[88:91], v15 offset:12288
    v_mfma_f32_16x16x32_bf16 v[32:35], v[72:75], v[144:147], v[32:35]
    ds_read_b128 v[108:111], v15 offset:17408
    s_waitcnt lgkmcnt(5)
    v_mfma_f32_16x16x32_bf16 v[16:19], v[56:59], v[148:151], v[16:19]
    ds_read_b128 v[92:95], v15 offset:13312
    v_mfma_f32_16x16x32_bf16 v[20:23], v[60:63], v[148:151], v[20:23]
    ds_read_b128 v[96:99], v15 offset:14336
    buffer_load_dwordx4 v[116:119], v1, s[4:7], s32 offen offset:1024 sc1
    v_mfma_f32_16x16x32_bf16 v[24:27], v[64:67], v[148:151], v[24:27]
    ds_read_b128 v[100:103], v15 offset:15360
    v_mfma_f32_16x16x32_bf16 v[28:31], v[68:71], v[148:151], v[28:31]
    ds_read_b128 v[104:107], v15 offset:16384
    v_mfma_f32_16x16x32_bf16 v[36:39], v[72:75], v[148:151], v[36:39]
    s_waitcnt vmcnt(14) lgkmcnt(4)
    v_mfma_f32_16x16x32_bf16 v[16:19], v[76:79], v[152:155], v[16:19]
    ds_read_b128 v[40:43], v15 offset:18432
    v_mfma_f32_16x16x32_bf16 v[20:23], v[80:83], v[152:155], v[20:23]
    ds_read_b128 v[44:47], v15 offset:19456
    v_mfma_f32_16x16x32_bf16 v[24:27], v[84:87], v[152:155], v[24:27]
    ds_read_b128 v[48:51], v15 offset:20480
    buffer_load_dwordx4 v[120:123], v1, s[4:7], s32 offen offset:2048 sc1
    v_mfma_f32_16x16x32_bf16 v[28:31], v[88:91], v[152:155], v[28:31]
    ds_read_b128 v[52:55], v15 offset:21504
    v_mfma_f32_16x16x32_bf16 v[32:35], v[108:111], v[152:155], v[32:35]
    ds_read_b128 v[72:75], v15 offset:26624
    s_waitcnt lgkmcnt(5)
    v_mfma_f32_16x16x32_bf16 v[16:19], v[92:95], v[156:159], v[16:19]
    ds_read_b128 v[56:59], v15 offset:22528
    v_mfma_f32_16x16x32_bf16 v[20:23], v[96:99], v[156:159], v[20:23]
    ds_read_b128 v[60:63], v15 offset:23552
    buffer_load_dwordx4 v[124:127], v1, s[4:7], s32 offen offset:3072 sc1
    v_mfma_f32_16x16x32_bf16 v[24:27], v[100:103], v[156:159], v[24:27]
    ds_read_b128 v[64:67], v15 offset:24576
    v_mfma_f32_16x16x32_bf16 v[28:31], v[104:107], v[156:159], v[28:31]
    ds_read_b128 v[68:71], v15 offset:25600
    v_mfma_f32_16x16x32_bf16 v[36:39], v[108:111], v[156:159], v[36:39]
    s_waitcnt vmcnt(14) lgkmcnt(4)
    v_mfma_f32_16x16x32_bf16 v[16:19], v[40:43], v[160:163], v[16:19]
    ds_read_b128 v[76:79], v15 offset:27648
    v_mfma_f32_16x16x32_bf16 v[20:23], v[44:47], v[160:163], v[20:23]
    ds_read_b128 v[80:83], v15 offset:28672
    v_mfma_f32_16x16x32_bf16 v[24:27], v[48:51], v[160:163], v[24:27]
    ds_read_b128 v[84:87], v15 offset:29696
    buffer_load_dwordx4 v[128:131], v1, s[4:7], s33 offen offset:0 sc1
    v_mfma_f32_16x16x32_bf16 v[28:31], v[52:55], v[160:163], v[28:31]
    ds_read_b128 v[88:91], v15 offset:30720
    v_mfma_f32_16x16x32_bf16 v[32:35], v[72:75], v[160:163], v[32:35]
    ds_read_b128 v[108:111], v15 offset:35840
    s_waitcnt lgkmcnt(5)
    v_mfma_f32_16x16x32_bf16 v[16:19], v[56:59], v[164:167], v[16:19]
    ds_read_b128 v[92:95], v15 offset:31744
    v_mfma_f32_16x16x32_bf16 v[20:23], v[60:63], v[164:167], v[20:23]
    ds_read_b128 v[96:99], v15 offset:32768
    buffer_load_dwordx4 v[132:135], v1, s[4:7], s33 offen offset:1024 sc1
    v_mfma_f32_16x16x32_bf16 v[24:27], v[64:67], v[164:167], v[24:27]
    ds_read_b128 v[100:103], v15 offset:33792
    v_mfma_f32_16x16x32_bf16 v[28:31], v[68:71], v[164:167], v[28:31]
    ds_read_b128 v[104:107], v15 offset:34816
    v_mfma_f32_16x16x32_bf16 v[36:39], v[72:75], v[164:167], v[36:39]
    s_waitcnt vmcnt(14) lgkmcnt(0)
    s_barrier
    v_mfma_f32_16x16x32_bf16 v[16:19], v[76:79], v[168:171], v[16:19]
    ds_read_b128 v[40:43], v12 offset:0
    v_mfma_f32_16x16x32_bf16 v[20:23], v[80:83], v[168:171], v[20:23]
    ds_read_b128 v[44:47], v12 offset:1024
    v_mfma_f32_16x16x32_bf16 v[24:27], v[84:87], v[168:171], v[24:27]
    ds_read_b128 v[48:51], v12 offset:2048
    buffer_load_dwordx4 v[136:139], v1, s[4:7], s33 offen offset:2048 sc1
    v_mfma_f32_16x16x32_bf16 v[28:31], v[88:91], v[168:171], v[28:31]
    ds_read_b128 v[52:55], v12 offset:3072
    v_mfma_f32_16x16x32_bf16 v[32:35], v[108:111], v[168:171], v[32:35]
    ds_read_b128 v[72:75], v12 offset:8192
    v_mfma_f32_16x16x32_bf16 v[16:19], v[92:95], v[172:175], v[16:19]
    ds_read_b128 v[56:59], v12 offset:4096
    v_mfma_f32_16x16x32_bf16 v[20:23], v[96:99], v[172:175], v[20:23]
    ds_read_b128 v[60:63], v12 offset:5120
    buffer_load_dwordx4 v[140:143], v1, s[4:7], s33 offen offset:3072 sc1
    v_mfma_f32_16x16x32_bf16 v[24:27], v[100:103], v[172:175], v[24:27]
    ds_read_b128 v[64:67], v12 offset:6144
    v_mfma_f32_16x16x32_bf16 v[28:31], v[104:107], v[172:175], v[28:31]
    ds_read_b128 v[68:71], v12 offset:7168
    v_mfma_f32_16x16x32_bf16 v[36:39], v[108:111], v[172:175], v[36:39]
    s_waitcnt vmcnt(14) lgkmcnt(4)
    v_mfma_f32_16x16x32_bf16 v[16:19], v[40:43], v[176:179], v[16:19]
    ds_read_b128 v[76:79], v12 offset:9216
    s_mov_b32 s32, 4
    s_lshl_b32 s32, s32, 13
    s_add_u32 s32, s32, s29
    s_add_u32 s33, s32, 4096
    v_mfma_f32_16x16x32_bf16 v[20:23], v[44:47], v[176:179], v[20:23]
    ds_read_b128 v[80:83], v12 offset:10240
    v_mfma_f32_16x16x32_bf16 v[24:27], v[48:51], v[176:179], v[24:27]
    ds_read_b128 v[84:87], v12 offset:11264
    buffer_load_dwordx4 v[144:147], v1, s[4:7], s32 offen offset:0 sc1
    v_mfma_f32_16x16x32_bf16 v[28:31], v[52:55], v[176:179], v[28:31]
    ds_read_b128 v[88:91], v12 offset:12288
    v_mfma_f32_16x16x32_bf16 v[32:35], v[72:75], v[176:179], v[32:35]
    ds_read_b128 v[108:111], v12 offset:17408
    s_waitcnt lgkmcnt(5)
    v_mfma_f32_16x16x32_bf16 v[16:19], v[56:59], v[180:183], v[16:19]
    ds_read_b128 v[92:95], v12 offset:13312
    v_mfma_f32_16x16x32_bf16 v[20:23], v[60:63], v[180:183], v[20:23]
    ds_read_b128 v[96:99], v12 offset:14336
    buffer_load_dwordx4 v[148:151], v1, s[4:7], s32 offen offset:1024 sc1
    v_mfma_f32_16x16x32_bf16 v[24:27], v[64:67], v[180:183], v[24:27]
    ds_read_b128 v[100:103], v12 offset:15360
    v_mfma_f32_16x16x32_bf16 v[28:31], v[68:71], v[180:183], v[28:31]
    ds_read_b128 v[104:107], v12 offset:16384
    v_mfma_f32_16x16x32_bf16 v[36:39], v[72:75], v[180:183], v[36:39]
    s_waitcnt vmcnt(14) lgkmcnt(4)
    v_mfma_f32_16x16x32_bf16 v[16:19], v[76:79], v[184:187], v[16:19]
    ds_read_b128 v[40:43], v12 offset:18432
    v_mfma_f32_16x16x32_bf16 v[20:23], v[80:83], v[184:187], v[20:23]
    ds_read_b128 v[44:47], v12 offset:19456
    v_mfma_f32_16x16x32_bf16 v[24:27], v[84:87], v[184:187], v[24:27]
    ds_read_b128 v[48:51], v12 offset:20480
    buffer_load_dwordx4 v[152:155], v1, s[4:7], s32 offen offset:2048 sc1
    v_mfma_f32_16x16x32_bf16 v[28:31], v[88:91], v[184:187], v[28:31]
    ds_read_b128 v[52:55], v12 offset:21504
    v_mfma_f32_16x16x32_bf16 v[32:35], v[108:111], v[184:187], v[32:35]
    ds_read_b128 v[72:75], v12 offset:26624
    s_waitcnt lgkmcnt(5)
    v_mfma_f32_16x16x32_bf16 v[16:19], v[92:95], v[188:191], v[16:19]
    ds_read_b128 v[56:59], v12 offset:22528
    v_mfma_f32_16x16x32_bf16 v[20:23], v[96:99], v[188:191], v[20:23]
    ds_read_b128 v[60:63], v12 offset:23552
    buffer_load_dwordx4 v[156:159], v1, s[4:7], s32 offen offset:3072 sc1
    v_mfma_f32_16x16x32_bf16 v[24:27], v[100:103], v[188:191], v[24:27]
    ds_read_b128 v[64:67], v12 offset:24576
    v_mfma_f32_16x16x32_bf16 v[28:31], v[104:107], v[188:191], v[28:31]
    ds_read_b128 v[68:71], v12 offset:25600
    v_mfma_f32_16x16x32_bf16 v[36:39], v[108:111], v[188:191], v[36:39]
    s_waitcnt vmcnt(14) lgkmcnt(4)
    v_mfma_f32_16x16x32_bf16 v[16:19], v[40:43], v[192:195], v[16:19]
    ds_read_b128 v[76:79], v12 offset:27648
    v_mfma_f32_16x16x32_bf16 v[20:23], v[44:47], v[192:195], v[20:23]
    ds_read_b128 v[80:83], v12 offset:28672
    v_mfma_f32_16x16x32_bf16 v[24:27], v[48:51], v[192:195], v[24:27]
    ds_read_b128 v[84:87], v12 offset:29696
    buffer_load_dwordx4 v[160:163], v1, s[4:7], s33 offen offset:0 sc1
    v_mfma_f32_16x16x32_bf16 v[28:31], v[52:55], v[192:195], v[28:31]
    ds_read_b128 v[88:91], v12 offset:30720
    v_mfma_f32_16x16x32_bf16 v[32:35], v[72:75], v[192:195], v[32:35]
    ds_read_b128 v[108:111], v12 offset:35840
    s_waitcnt lgkmcnt(5)
    v_mfma_f32_16x16x32_bf16 v[16:19], v[56:59], v[196:199], v[16:19]
    ds_read_b128 v[92:95], v12 offset:31744
    v_mfma_f32_16x16x32_bf16 v[20:23], v[60:63], v[196:199], v[20:23]
    ds_read_b128 v[96:99], v12 offset:32768
    buffer_load_dwordx4 v[164:167], v1, s[4:7], s33 offen offset:1024 sc1
    v_mfma_f32_16x16x32_bf16 v[24:27], v[64:67], v[196:199], v[24:27]
    ds_read_b128 v[100:103], v12 offset:33792
    v_mfma_f32_16x16x32_bf16 v[28:31], v[68:71], v[196:199], v[28:31]
    ds_read_b128 v[104:107], v12 offset:34816
    v_mfma_f32_16x16x32_bf16 v[36:39], v[72:75], v[196:199], v[36:39]
    s_waitcnt vmcnt(14) lgkmcnt(0)
    s_barrier
    v_mfma_f32_16x16x32_bf16 v[16:19], v[76:79], v[200:203], v[16:19]
    ds_read_b128 v[40:43], v13 offset:0
    v_mfma_f32_16x16x32_bf16 v[20:23], v[80:83], v[200:203], v[20:23]
    ds_read_b128 v[44:47], v13 offset:1024
    v_mfma_f32_16x16x32_bf16 v[24:27], v[84:87], v[200:203], v[24:27]
    ds_read_b128 v[48:51], v13 offset:2048
    buffer_load_dwordx4 v[168:171], v1, s[4:7], s33 offen offset:2048 sc1
    v_mfma_f32_16x16x32_bf16 v[28:31], v[88:91], v[200:203], v[28:31]
    ds_read_b128 v[52:55], v13 offset:3072
    v_mfma_f32_16x16x32_bf16 v[32:35], v[108:111], v[200:203], v[32:35]
    ds_read_b128 v[72:75], v13 offset:8192
    v_mfma_f32_16x16x32_bf16 v[16:19], v[92:95], v[204:207], v[16:19]
    ds_read_b128 v[56:59], v13 offset:4096
    v_mfma_f32_16x16x32_bf16 v[20:23], v[96:99], v[204:207], v[20:23]
    ds_read_b128 v[60:63], v13 offset:5120
    buffer_load_dwordx4 v[172:175], v1, s[4:7], s33 offen offset:3072 sc1
    v_mfma_f32_16x16x32_bf16 v[24:27], v[100:103], v[204:207], v[24:27]
    ds_read_b128 v[64:67], v13 offset:6144
    v_mfma_f32_16x16x32_bf16 v[28:31], v[104:107], v[204:207], v[28:31]
    ds_read_b128 v[68:71], v13 offset:7168
    v_mfma_f32_16x16x32_bf16 v[36:39], v[108:111], v[204:207], v[36:39]
    s_waitcnt vmcnt(14) lgkmcnt(4)
    v_mfma_f32_16x16x32_bf16 v[16:19], v[40:43], v[112:115], v[16:19]
    ds_read_b128 v[76:79], v13 offset:9216
    s_mov_b32 s32, 5
    s_lshl_b32 s32, s32, 13
    s_add_u32 s32, s32, s29
    s_add_u32 s33, s32, 4096
    v_mfma_f32_16x16x32_bf16 v[20:23], v[44:47], v[112:115], v[20:23]
    ds_read_b128 v[80:83], v13 offset:10240
    v_mfma_f32_16x16x32_bf16 v[24:27], v[48:51], v[112:115], v[24:27]
    ds_read_b128 v[84:87], v13 offset:11264
    buffer_load_dwordx4 v[176:179], v1, s[4:7], s32 offen offset:0 sc1
    v_mfma_f32_16x16x32_bf16 v[28:31], v[52:55], v[112:115], v[28:31]
    ds_read_b128 v[88:91], v13 offset:12288
    v_mfma_f32_16x16x32_bf16 v[32:35], v[72:75], v[112:115], v[32:35]
    ds_read_b128 v[108:111], v13 offset:17408
    s_waitcnt lgkmcnt(5)
    v_mfma_f32_16x16x32_bf16 v[16:19], v[56:59], v[116:119], v[16:19]
    ds_read_b128 v[92:95], v13 offset:13312
    v_mfma_f32_16x16x32_bf16 v[20:23], v[60:63], v[116:119], v[20:23]
    ds_read_b128 v[96:99], v13 offset:14336
    buffer_load_dwordx4 v[180:183], v1, s[4:7], s32 offen offset:1024 sc1
    v_mfma_f32_16x16x32_bf16 v[24:27], v[64:67], v[116:119], v[24:27]
    ds_read_b128 v[100:103], v13 offset:15360
    v_mfma_f32_16x16x32_bf16 v[28:31], v[68:71], v[116:119], v[28:31]
    ds_read_b128 v[104:107], v13 offset:16384
    v_mfma_f32_16x16x32_bf16 v[36:39], v[72:75], v[116:119], v[36:39]
    s_waitcnt vmcnt(14) lgkmcnt(4)
    v_mfma_f32_16x16x32_bf16 v[16:19], v[76:79], v[120:123], v[16:19]
    ds_read_b128 v[40:43], v13 offset:18432
    v_mfma_f32_16x16x32_bf16 v[20:23], v[80:83], v[120:123], v[20:23]
    ds_read_b128 v[44:47], v13 offset:19456
    v_mfma_f32_16x16x32_bf16 v[24:27], v[84:87], v[120:123], v[24:27]
    ds_read_b128 v[48:51], v13 offset:20480
    buffer_load_dwordx4 v[184:187], v1, s[4:7], s32 offen offset:2048 sc1
    v_mfma_f32_16x16x32_bf16 v[28:31], v[88:91], v[120:123], v[28:31]
    ds_read_b128 v[52:55], v13 offset:21504
    v_mfma_f32_16x16x32_bf16 v[32:35], v[108:111], v[120:123], v[32:35]
    ds_read_b128 v[72:75], v13 offset:26624
    s_waitcnt lgkmcnt(5)
    v_mfma_f32_16x16x32_bf16 v[16:19], v[92:95], v[124:127], v[16:19]
    ds_read_b128 v[56:59], v13 offset:22528
    v_mfma_f32_16x16x32_bf16 v[20:23], v[96:99], v[124:127], v[20:23]
    ds_read_b128 v[60:63], v13 offset:23552
    buffer_load_dwordx4 v[188:191], v1, s[4:7], s32 offen offset:3072 sc1
    v_mfma_f32_16x16x32_bf16 v[24:27], v[100:103], v[124:127], v[24:27]
    ds_read_b128 v[64:67], v13 offset:24576
    v_mfma_f32_16x16x32_bf16 v[28:31], v[104:107], v[124:127], v[28:31]
    ds_read_b128 v[68:71], v13 offset:25600
    v_mfma_f32_16x16x32_bf16 v[36:39], v[108:111], v[124:127], v[36:39]
    s_waitcnt vmcnt(14) lgkmcnt(4)
    v_mfma_f32_16x16x32_bf16 v[16:19], v[40:43], v[128:131], v[16:19]
    ds_read_b128 v[76:79], v13 offset:27648
    v_mfma_f32_16x16x32_bf16 v[20:23], v[44:47], v[128:131], v[20:23]
    ds_read_b128 v[80:83], v13 offset:28672
    v_mfma_f32_16x16x32_bf16 v[24:27], v[48:51], v[128:131], v[24:27]
    ds_read_b128 v[84:87], v13 offset:29696
    buffer_load_dwordx4 v[192:195], v1, s[4:7], s33 offen offset:0 sc1
    v_mfma_f32_16x16x32_bf16 v[28:31], v[52:55], v[128:131], v[28:31]
    ds_read_b128 v[88:91], v13 offset:30720
    v_mfma_f32_16x16x32_bf16 v[32:35], v[72:75], v[128:131], v[32:35]
    ds_read_b128 v[108:111], v13 offset:35840
    s_waitcnt lgkmcnt(5)
    v_mfma_f32_16x16x32_bf16 v[16:19], v[56:59], v[132:135], v[16:19]
    ds_read_b128 v[92:95], v13 offset:31744
    v_mfma_f32_16x16x32_bf16 v[20:23], v[60:63], v[132:135], v[20:23]
    ds_read_b128 v[96:99], v13 offset:32768
    buffer_load_dwordx4 v[196:199], v1, s[4:7], s33 offen offset:1024 sc1
    v_mfma_f32_16x16x32_bf16 v[24:27], v[64:67], v[132:135], v[24:27]
    ds_read_b128 v[100:103], v13 offset:33792
    v_mfma_f32_16x16x32_bf16 v[28:31], v[68:71], v[132:135], v[28:31]
    ds_read_b128 v[104:107], v13 offset:34816
    v_mfma_f32_16x16x32_bf16 v[36:39], v[72:75], v[132:135], v[36:39]
    s_waitcnt vmcnt(14) lgkmcnt(0)
    s_barrier
    v_mfma_f32_16x16x32_bf16 v[16:19], v[76:79], v[136:139], v[16:19]
    ds_read_b128 v[40:43], v14 offset:0
    v_mfma_f32_16x16x32_bf16 v[20:23], v[80:83], v[136:139], v[20:23]
    ds_read_b128 v[44:47], v14 offset:1024
    v_mfma_f32_16x16x32_bf16 v[24:27], v[84:87], v[136:139], v[24:27]
    ds_read_b128 v[48:51], v14 offset:2048
    buffer_load_dwordx4 v[200:203], v1, s[4:7], s33 offen offset:2048 sc1
    v_mfma_f32_16x16x32_bf16 v[28:31], v[88:91], v[136:139], v[28:31]
    ds_read_b128 v[52:55], v14 offset:3072
    v_mfma_f32_16x16x32_bf16 v[32:35], v[108:111], v[136:139], v[32:35]
    ds_read_b128 v[72:75], v14 offset:8192
    v_mfma_f32_16x16x32_bf16 v[16:19], v[92:95], v[140:143], v[16:19]
    ds_read_b128 v[56:59], v14 offset:4096
    v_mfma_f32_16x16x32_bf16 v[20:23], v[96:99], v[140:143], v[20:23]
    ds_read_b128 v[60:63], v14 offset:5120
    buffer_load_dwordx4 v[204:207], v1, s[4:7], s33 offen offset:3072 sc1
    v_mfma_f32_16x16x32_bf16 v[24:27], v[100:103], v[140:143], v[24:27]
    ds_read_b128 v[64:67], v14 offset:6144
    v_mfma_f32_16x16x32_bf16 v[28:31], v[104:107], v[140:143], v[28:31]
    ds_read_b128 v[68:71], v14 offset:7168
    v_mfma_f32_16x16x32_bf16 v[36:39], v[108:111], v[140:143], v[36:39]
    s_waitcnt vmcnt(14) lgkmcnt(4)
    v_mfma_f32_16x16x32_bf16 v[16:19], v[40:43], v[144:147], v[16:19]
    ds_read_b128 v[76:79], v14 offset:9216
    s_mov_b32 s32, 6
    s_lshl_b32 s32, s32, 13
    s_add_u32 s32, s32, s29
    s_add_u32 s33, s32, 4096
    v_mfma_f32_16x16x32_bf16 v[20:23], v[44:47], v[144:147], v[20:23]
    ds_read_b128 v[80:83], v14 offset:10240
    v_mfma_f32_16x16x32_bf16 v[24:27], v[48:51], v[144:147], v[24:27]
    ds_read_b128 v[84:87], v14 offset:11264
    buffer_load_dwordx4 v[112:115], v1, s[4:7], s32 offen offset:0 sc1
    v_mfma_f32_16x16x32_bf16 v[28:31], v[52:55], v[144:147], v[28:31]
    ds_read_b128 v[88:91], v14 offset:12288
    v_mfma_f32_16x16x32_bf16 v[32:35], v[72:75], v[144:147], v[32:35]
    ds_read_b128 v[108:111], v14 offset:17408
    s_waitcnt lgkmcnt(5)
    v_mfma_f32_16x16x32_bf16 v[16:19], v[56:59], v[148:151], v[16:19]
    ds_read_b128 v[92:95], v14 offset:13312
    v_mfma_f32_16x16x32_bf16 v[20:23], v[60:63], v[148:151], v[20:23]
    ds_read_b128 v[96:99], v14 offset:14336
    buffer_load_dwordx4 v[116:119], v1, s[4:7], s32 offen offset:1024 sc1
    v_mfma_f32_16x16x32_bf16 v[24:27], v[64:67], v[148:151], v[24:27]
    ds_read_b128 v[100:103], v14 offset:15360
    v_mfma_f32_16x16x32_bf16 v[28:31], v[68:71], v[148:151], v[28:31]
    ds_read_b128 v[104:107], v14 offset:16384
    v_mfma_f32_16x16x32_bf16 v[36:39], v[72:75], v[148:151], v[36:39]
    s_waitcnt vmcnt(14) lgkmcnt(4)
    v_mfma_f32_16x16x32_bf16 v[16:19], v[76:79], v[152:155], v[16:19]
    ds_read_b128 v[40:43], v14 offset:18432
    v_mfma_f32_16x16x32_bf16 v[20:23], v[80:83], v[152:155], v[20:23]
    ds_read_b128 v[44:47], v14 offset:19456
    v_mfma_f32_16x16x32_bf16 v[24:27], v[84:87], v[152:155], v[24:27]
    ds_read_b128 v[48:51], v14 offset:20480
    buffer_load_dwordx4 v[120:123], v1, s[4:7], s32 offen offset:2048 sc1
    v_mfma_f32_16x16x32_bf16 v[28:31], v[88:91], v[152:155], v[28:31]
    ds_read_b128 v[52:55], v14 offset:21504
    v_mfma_f32_16x16x32_bf16 v[32:35], v[108:111], v[152:155], v[32:35]
    ds_read_b128 v[72:75], v14 offset:26624
    s_waitcnt lgkmcnt(5)
    v_mfma_f32_16x16x32_bf16 v[16:19], v[92:95], v[156:159], v[16:19]
    ds_read_b128 v[56:59], v14 offset:22528
    v_mfma_f32_16x16x32_bf16 v[20:23], v[96:99], v[156:159], v[20:23]
    ds_read_b128 v[60:63], v14 offset:23552
    buffer_load_dwordx4 v[124:127], v1, s[4:7], s32 offen offset:3072 sc1
    v_mfma_f32_16x16x32_bf16 v[24:27], v[100:103], v[156:159], v[24:27]
    ds_read_b128 v[64:67], v14 offset:24576
    v_mfma_f32_16x16x32_bf16 v[28:31], v[104:107], v[156:159], v[28:31]
    ds_read_b128 v[68:71], v14 offset:25600
    v_mfma_f32_16x16x32_bf16 v[36:39], v[108:111], v[156:159], v[36:39]
    s_waitcnt vmcnt(14) lgkmcnt(4)
    v_mfma_f32_16x16x32_bf16 v[16:19], v[40:43], v[160:163], v[16:19]
    ds_read_b128 v[76:79], v14 offset:27648
    v_mfma_f32_16x16x32_bf16 v[20:23], v[44:47], v[160:163], v[20:23]
    ds_read_b128 v[80:83], v14 offset:28672
    v_mfma_f32_16x16x32_bf16 v[24:27], v[48:51], v[160:163], v[24:27]
    ds_read_b128 v[84:87], v14 offset:29696
    buffer_load_dwordx4 v[128:131], v1, s[4:7], s33 offen offset:0 sc1
    v_mfma_f32_16x16x32_bf16 v[28:31], v[52:55], v[160:163], v[28:31]
    ds_read_b128 v[88:91], v14 offset:30720
    v_mfma_f32_16x16x32_bf16 v[32:35], v[72:75], v[160:163], v[32:35]
    ds_read_b128 v[108:111], v14 offset:35840
    s_waitcnt lgkmcnt(5)
    v_mfma_f32_16x16x32_bf16 v[16:19], v[56:59], v[164:167], v[16:19]
    ds_read_b128 v[92:95], v14 offset:31744
    v_mfma_f32_16x16x32_bf16 v[20:23], v[60:63], v[164:167], v[20:23]
    ds_read_b128 v[96:99], v14 offset:32768
    buffer_load_dwordx4 v[132:135], v1, s[4:7], s33 offen offset:1024 sc1
    v_mfma_f32_16x16x32_bf16 v[24:27], v[64:67], v[164:167], v[24:27]
    ds_read_b128 v[100:103], v14 offset:33792
    v_mfma_f32_16x16x32_bf16 v[28:31], v[68:71], v[164:167], v[28:31]
    ds_read_b128 v[104:107], v14 offset:34816
    v_mfma_f32_16x16x32_bf16 v[36:39], v[72:75], v[164:167], v[36:39]
    s_waitcnt vmcnt(14) lgkmcnt(0)
    s_barrier
    v_mfma_f32_16x16x32_bf16 v[16:19], v[76:79], v[168:171], v[16:19]
    ds_read_b128 v[40:43], v15 offset:0
    v_mfma_f32_16x16x32_bf16 v[20:23], v[80:83], v[168:171], v[20:23]
    ds_read_b128 v[44:47], v15 offset:1024
    v_mfma_f32_16x16x32_bf16 v[24:27], v[84:87], v[168:171], v[24:27]
    ds_read_b128 v[48:51], v15 offset:2048
    buffer_load_dwordx4 v[136:139], v1, s[4:7], s33 offen offset:2048 sc1
    v_mfma_f32_16x16x32_bf16 v[28:31], v[88:91], v[168:171], v[28:31]
    ds_read_b128 v[52:55], v15 offset:3072
    v_mfma_f32_16x16x32_bf16 v[32:35], v[108:111], v[168:171], v[32:35]
    ds_read_b128 v[72:75], v15 offset:8192
    v_mfma_f32_16x16x32_bf16 v[16:19], v[92:95], v[172:175], v[16:19]
    ds_read_b128 v[56:59], v15 offset:4096
    v_mfma_f32_16x16x32_bf16 v[20:23], v[96:99], v[172:175], v[20:23]
    ds_read_b128 v[60:63], v15 offset:5120
    buffer_load_dwordx4 v[140:143], v1, s[4:7], s33 offen offset:3072 sc1
    v_mfma_f32_16x16x32_bf16 v[24:27], v[100:103], v[172:175], v[24:27]
    ds_read_b128 v[64:67], v15 offset:6144
    v_mfma_f32_16x16x32_bf16 v[28:31], v[104:107], v[172:175], v[28:31]
    ds_read_b128 v[68:71], v15 offset:7168
    v_mfma_f32_16x16x32_bf16 v[36:39], v[108:111], v[172:175], v[36:39]
    s_waitcnt vmcnt(14) lgkmcnt(4)
    v_mfma_f32_16x16x32_bf16 v[16:19], v[40:43], v[176:179], v[16:19]
    ds_read_b128 v[76:79], v15 offset:9216
    s_mov_b32 s32, 7
    s_lshl_b32 s32, s32, 13
    s_add_u32 s32, s32, s29
    s_add_u32 s33, s32, 4096
    v_mfma_f32_16x16x32_bf16 v[20:23], v[44:47], v[176:179], v[20:23]
    ds_read_b128 v[80:83], v15 offset:10240
    v_mfma_f32_16x16x32_bf16 v[24:27], v[48:51], v[176:179], v[24:27]
    ds_read_b128 v[84:87], v15 offset:11264
    buffer_load_dwordx4 v[144:147], v1, s[4:7], s32 offen offset:0 sc1
    v_mfma_f32_16x16x32_bf16 v[28:31], v[52:55], v[176:179], v[28:31]
    ds_read_b128 v[88:91], v15 offset:12288
    v_mfma_f32_16x16x32_bf16 v[32:35], v[72:75], v[176:179], v[32:35]
    ds_read_b128 v[108:111], v15 offset:17408
    s_waitcnt lgkmcnt(5)
    v_mfma_f32_16x16x32_bf16 v[16:19], v[56:59], v[180:183], v[16:19]
    ds_read_b128 v[92:95], v15 offset:13312
    v_mfma_f32_16x16x32_bf16 v[20:23], v[60:63], v[180:183], v[20:23]
    ds_read_b128 v[96:99], v15 offset:14336
    buffer_load_dwordx4 v[148:151], v1, s[4:7], s32 offen offset:1024 sc1
    v_mfma_f32_16x16x32_bf16 v[24:27], v[64:67], v[180:183], v[24:27]
    ds_read_b128 v[100:103], v15 offset:15360
    v_mfma_f32_16x16x32_bf16 v[28:31], v[68:71], v[180:183], v[28:31]
    ds_read_b128 v[104:107], v15 offset:16384
    v_mfma_f32_16x16x32_bf16 v[36:39], v[72:75], v[180:183], v[36:39]
    s_waitcnt vmcnt(14) lgkmcnt(4)
    v_mfma_f32_16x16x32_bf16 v[16:19], v[76:79], v[184:187], v[16:19]
    ds_read_b128 v[40:43], v15 offset:18432
    v_mfma_f32_16x16x32_bf16 v[20:23], v[80:83], v[184:187], v[20:23]
    ds_read_b128 v[44:47], v15 offset:19456
    v_mfma_f32_16x16x32_bf16 v[24:27], v[84:87], v[184:187], v[24:27]
    ds_read_b128 v[48:51], v15 offset:20480
    buffer_load_dwordx4 v[152:155], v1, s[4:7], s32 offen offset:2048 sc1
    v_mfma_f32_16x16x32_bf16 v[28:31], v[88:91], v[184:187], v[28:31]
    ds_read_b128 v[52:55], v15 offset:21504
    v_mfma_f32_16x16x32_bf16 v[32:35], v[108:111], v[184:187], v[32:35]
    ds_read_b128 v[72:75], v15 offset:26624
    s_waitcnt lgkmcnt(5)
    v_mfma_f32_16x16x32_bf16 v[16:19], v[92:95], v[188:191], v[16:19]
    ds_read_b128 v[56:59], v15 offset:22528
    v_mfma_f32_16x16x32_bf16 v[20:23], v[96:99], v[188:191], v[20:23]
    ds_read_b128 v[60:63], v15 offset:23552
    buffer_load_dwordx4 v[156:159], v1, s[4:7], s32 offen offset:3072 sc1
    v_mfma_f32_16x16x32_bf16 v[24:27], v[100:103], v[188:191], v[24:27]
    ds_read_b128 v[64:67], v15 offset:24576
    v_mfma_f32_16x16x32_bf16 v[28:31], v[104:107], v[188:191], v[28:31]
    ds_read_b128 v[68:71], v15 offset:25600
    v_mfma_f32_16x16x32_bf16 v[36:39], v[108:111], v[188:191], v[36:39]
    s_waitcnt vmcnt(14) lgkmcnt(4)
    v_mfma_f32_16x16x32_bf16 v[16:19], v[40:43], v[192:195], v[16:19]
    ds_read_b128 v[76:79], v15 offset:27648
    v_mfma_f32_16x16x32_bf16 v[20:23], v[44:47], v[192:195], v[20:23]
    ds_read_b128 v[80:83], v15 offset:28672
    v_mfma_f32_16x16x32_bf16 v[24:27], v[48:51], v[192:195], v[24:27]
    ds_read_b128 v[84:87], v15 offset:29696
    buffer_load_dwordx4 v[160:163], v1, s[4:7], s33 offen offset:0 sc1
    v_mfma_f32_16x16x32_bf16 v[28:31], v[52:55], v[192:195], v[28:31]
    ds_read_b128 v[88:91], v15 offset:30720
    v_mfma_f32_16x16x32_bf16 v[32:35], v[72:75], v[192:195], v[32:35]
    ds_read_b128 v[108:111], v15 offset:35840
    s_waitcnt lgkmcnt(5)
    v_mfma_f32_16x16x32_bf16 v[16:19], v[56:59], v[196:199], v[16:19]
    ds_read_b128 v[92:95], v15 offset:31744
    v_mfma_f32_16x16x32_bf16 v[20:23], v[60:63], v[196:199], v[20:23]
    ds_read_b128 v[96:99], v15 offset:32768
    buffer_load_dwordx4 v[164:167], v1, s[4:7], s33 offen offset:1024 sc1
    v_mfma_f32_16x16x32_bf16 v[24:27], v[64:67], v[196:199], v[24:27]
    ds_read_b128 v[100:103], v15 offset:33792
    v_mfma_f32_16x16x32_bf16 v[28:31], v[68:71], v[196:199], v[28:31]
    ds_read_b128 v[104:107], v15 offset:34816
    v_mfma_f32_16x16x32_bf16 v[36:39], v[72:75], v[196:199], v[36:39]
    s_waitcnt vmcnt(14) lgkmcnt(0)
    s_barrier
    v_mfma_f32_16x16x32_bf16 v[16:19], v[76:79], v[200:203], v[16:19]
    ds_read_b128 v[40:43], v12 offset:0
    v_mfma_f32_16x16x32_bf16 v[20:23], v[80:83], v[200:203], v[20:23]
    ds_read_b128 v[44:47], v12 offset:1024
    v_mfma_f32_16x16x32_bf16 v[24:27], v[84:87], v[200:203], v[24:27]
    ds_read_b128 v[48:51], v12 offset:2048
    buffer_load_dwordx4 v[168:171], v1, s[4:7], s33 offen offset:2048 sc1
    v_mfma_f32_16x16x32_bf16 v[28:31], v[88:91], v[200:203], v[28:31]
    ds_read_b128 v[52:55], v12 offset:3072
    v_mfma_f32_16x16x32_bf16 v[32:35], v[108:111], v[200:203], v[32:35]
    ds_read_b128 v[72:75], v12 offset:8192
    v_mfma_f32_16x16x32_bf16 v[16:19], v[92:95], v[204:207], v[16:19]
    ds_read_b128 v[56:59], v12 offset:4096
    v_mfma_f32_16x16x32_bf16 v[20:23], v[96:99], v[204:207], v[20:23]
    ds_read_b128 v[60:63], v12 offset:5120
    buffer_load_dwordx4 v[172:175], v1, s[4:7], s33 offen offset:3072 sc1
    v_mfma_f32_16x16x32_bf16 v[24:27], v[100:103], v[204:207], v[24:27]
    ds_read_b128 v[64:67], v12 offset:6144
    v_mfma_f32_16x16x32_bf16 v[28:31], v[104:107], v[204:207], v[28:31]
    ds_read_b128 v[68:71], v12 offset:7168
    v_mfma_f32_16x16x32_bf16 v[36:39], v[108:111], v[204:207], v[36:39]
    s_waitcnt vmcnt(14) lgkmcnt(4)
    v_mfma_f32_16x16x32_bf16 v[16:19], v[40:43], v[112:115], v[16:19]
    ds_read_b128 v[76:79], v12 offset:9216
    s_mov_b32 s32, 8
    s_lshl_b32 s32, s32, 13
    s_add_u32 s32, s32, s29
    s_add_u32 s33, s32, 4096
    v_mfma_f32_16x16x32_bf16 v[20:23], v[44:47], v[112:115], v[20:23]
    ds_read_b128 v[80:83], v12 offset:10240
    v_mfma_f32_16x16x32_bf16 v[24:27], v[48:51], v[112:115], v[24:27]
    ds_read_b128 v[84:87], v12 offset:11264
    buffer_load_dwordx2 v[176:177], v7, s[4:7], s32 offen offset:0 sc1
    v_mfma_f32_16x16x32_bf16 v[28:31], v[52:55], v[112:115], v[28:31]
    ds_read_b128 v[88:91], v12 offset:12288
    v_mfma_f32_16x16x32_bf16 v[32:35], v[72:75], v[112:115], v[32:35]
    ds_read_b128 v[108:111], v12 offset:17408
    s_waitcnt lgkmcnt(5)
    buffer_load_dwordx2 v[178:179], v7, s[4:7], s32 offen offset:512 sc1
    v_mfma_f32_16x16x32_bf16 v[16:19], v[56:59], v[116:119], v[16:19]
    ds_read_b128 v[92:95], v12 offset:13312
    v_mfma_f32_16x16x32_bf16 v[20:23], v[60:63], v[116:119], v[20:23]
    ds_read_b128 v[96:99], v12 offset:14336
    buffer_load_dwordx2 v[180:181], v7, s[4:7], s32 offen offset:1024 sc1
    v_mfma_f32_16x16x32_bf16 v[24:27], v[64:67], v[116:119], v[24:27]
    ds_read_b128 v[100:103], v12 offset:15360
    v_mfma_f32_16x16x32_bf16 v[28:31], v[68:71], v[116:119], v[28:31]
    ds_read_b128 v[104:107], v12 offset:16384
    buffer_load_dwordx2 v[182:183], v7, s[4:7], s32 offen offset:1536 sc1
    v_mfma_f32_16x16x32_bf16 v[36:39], v[72:75], v[116:119], v[36:39]
    s_waitcnt vmcnt(16) lgkmcnt(4)
    v_mfma_f32_16x16x32_bf16 v[16:19], v[76:79], v[120:123], v[16:19]
    ds_read_b128 v[40:43], v12 offset:18432
    v_mfma_f32_16x16x32_bf16 v[20:23], v[80:83], v[120:123], v[20:23]
    ds_read_b128 v[44:47], v12 offset:19456
    v_mfma_f32_16x16x32_bf16 v[24:27], v[84:87], v[120:123], v[24:27]
    ds_read_b128 v[48:51], v12 offset:20480
    buffer_load_dwordx2 v[184:185], v7, s[4:7], s32 offen offset:2048 sc1
    v_mfma_f32_16x16x32_bf16 v[28:31], v[88:91], v[120:123], v[28:31]
    ds_read_b128 v[52:55], v12 offset:21504
    v_mfma_f32_16x16x32_bf16 v[32:35], v[108:111], v[120:123], v[32:35]
    ds_read_b128 v[72:75], v12 offset:26624
    s_waitcnt lgkmcnt(5)
    buffer_load_dwordx2 v[186:187], v7, s[4:7], s32 offen offset:2560 sc1
    v_mfma_f32_16x16x32_bf16 v[16:19], v[92:95], v[124:127], v[16:19]
    ds_read_b128 v[56:59], v12 offset:22528
    v_mfma_f32_16x16x32_bf16 v[20:23], v[96:99], v[124:127], v[20:23]
    ds_read_b128 v[60:63], v12 offset:23552
    buffer_load_dwordx2 v[188:189], v7, s[4:7], s32 offen offset:3072 sc1
    v_mfma_f32_16x16x32_bf16 v[24:27], v[100:103], v[124:127], v[24:27]
    ds_read_b128 v[64:67], v12 offset:24576
    v_mfma_f32_16x16x32_bf16 v[28:31], v[104:107], v[124:127], v[28:31]
    ds_read_b128 v[68:71], v12 offset:25600
    buffer_load_dwordx2 v[190:191], v7, s[4:7], s32 offen offset:3584 sc1
    v_mfma_f32_16x16x32_bf16 v[36:39], v[108:111], v[124:127], v[36:39]
    s_waitcnt vmcnt(18) lgkmcnt(4)
    v_mfma_f32_16x16x32_bf16 v[16:19], v[40:43], v[128:131], v[16:19]
    ds_read_b128 v[76:79], v12 offset:27648
    v_mfma_f32_16x16x32_bf16 v[20:23], v[44:47], v[128:131], v[20:23]
    ds_read_b128 v[80:83], v12 offset:28672
    v_mfma_f32_16x16x32_bf16 v[24:27], v[48:51], v[128:131], v[24:27]
    ds_read_b128 v[84:87], v12 offset:29696
    buffer_load_dwordx2 v[192:193], v7, s[4:7], s33 offen offset:0 sc1
    v_mfma_f32_16x16x32_bf16 v[28:31], v[52:55], v[128:131], v[28:31]
    ds_read_b128 v[88:91], v12 offset:30720
    v_mfma_f32_16x16x32_bf16 v[32:35], v[72:75], v[128:131], v[32:35]
    ds_read_b128 v[108:111], v12 offset:35840
    s_waitcnt lgkmcnt(5)
    buffer_load_dwordx2 v[194:195], v7, s[4:7], s33 offen offset:512 sc1
    v_mfma_f32_16x16x32_bf16 v[16:19], v[56:59], v[132:135], v[16:19]
    ds_read_b128 v[92:95], v12 offset:31744
    v_mfma_f32_16x16x32_bf16 v[20:23], v[60:63], v[132:135], v[20:23]
    ds_read_b128 v[96:99], v12 offset:32768
    buffer_load_dwordx2 v[196:197], v7, s[4:7], s33 offen offset:1024 sc1
    v_mfma_f32_16x16x32_bf16 v[24:27], v[64:67], v[132:135], v[24:27]
    ds_read_b128 v[100:103], v12 offset:33792
    v_mfma_f32_16x16x32_bf16 v[28:31], v[68:71], v[132:135], v[28:31]
    ds_read_b128 v[104:107], v12 offset:34816
    buffer_load_dwordx2 v[198:199], v7, s[4:7], s33 offen offset:1536 sc1
    v_mfma_f32_16x16x32_bf16 v[36:39], v[72:75], v[132:135], v[36:39]
    s_waitcnt vmcnt(20) lgkmcnt(0)
    s_barrier
    v_mfma_f32_16x16x32_bf16 v[16:19], v[76:79], v[136:139], v[16:19]
    ds_read_b128 v[40:43], v13 offset:0
    v_mfma_f32_16x16x32_bf16 v[20:23], v[80:83], v[136:139], v[20:23]
    ds_read_b128 v[44:47], v13 offset:1024
    v_mfma_f32_16x16x32_bf16 v[24:27], v[84:87], v[136:139], v[24:27]
    ds_read_b128 v[48:51], v13 offset:2048
    buffer_load_dwordx2 v[200:201], v7, s[4:7], s33 offen offset:2048 sc1
    v_mfma_f32_16x16x32_bf16 v[28:31], v[88:91], v[136:139], v[28:31]
    ds_read_b128 v[52:55], v13 offset:3072
    v_mfma_f32_16x16x32_bf16 v[32:35], v[108:111], v[136:139], v[32:35]
    ds_read_b128 v[72:75], v13 offset:8192
    buffer_load_dwordx2 v[202:203], v7, s[4:7], s33 offen offset:2560 sc1
    v_mfma_f32_16x16x32_bf16 v[16:19], v[92:95], v[140:143], v[16:19]
    ds_read_b128 v[56:59], v13 offset:4096
    v_mfma_f32_16x16x32_bf16 v[20:23], v[96:99], v[140:143], v[20:23]
    ds_read_b128 v[60:63], v13 offset:5120
    buffer_load_dwordx2 v[204:205], v7, s[4:7], s33 offen offset:3072 sc1
    v_mfma_f32_16x16x32_bf16 v[24:27], v[100:103], v[140:143], v[24:27]
    ds_read_b128 v[64:67], v13 offset:6144
    v_mfma_f32_16x16x32_bf16 v[28:31], v[104:107], v[140:143], v[28:31]
    ds_read_b128 v[68:71], v13 offset:7168
    buffer_load_dwordx2 v[206:207], v7, s[4:7], s33 offen offset:3584 sc1
    v_mfma_f32_16x16x32_bf16 v[36:39], v[108:111], v[140:143], v[36:39]
    s_waitcnt vmcnt(22) lgkmcnt(4)
    v_mfma_f32_16x16x32_bf16 v[16:19], v[40:43], v[144:147], v[16:19]
    ds_read_b128 v[76:79], v13 offset:9216
    v_mfma_f32_16x16x32_bf16 v[20:23], v[44:47], v[144:147], v[20:23]
    ds_read_b128 v[80:83], v13 offset:10240
    v_mfma_f32_16x16x32_bf16 v[24:27], v[48:51], v[144:147], v[24:27]
    ds_read_b128 v[84:87], v13 offset:11264
    v_mfma_f32_16x16x32_bf16 v[28:31], v[52:55], v[144:147], v[28:31]
    ds_read_b128 v[88:91], v13 offset:12288
    v_mfma_f32_16x16x32_bf16 v[32:35], v[72:75], v[144:147], v[32:35]
    ds_read_b128 v[108:111], v13 offset:17408
    s_waitcnt lgkmcnt(5)
    v_mfma_f32_16x16x32_bf16 v[16:19], v[56:59], v[148:151], v[16:19]
    ds_read_b128 v[92:95], v13 offset:13312
    v_mfma_f32_16x16x32_bf16 v[20:23], v[60:63], v[148:151], v[20:23]
    ds_read_b128 v[96:99], v13 offset:14336
    v_mfma_f32_16x16x32_bf16 v[24:27], v[64:67], v[148:151], v[24:27]
    ds_read_b128 v[100:103], v13 offset:15360
    v_mfma_f32_16x16x32_bf16 v[28:31], v[68:71], v[148:151], v[28:31]
    ds_read_b128 v[104:107], v13 offset:16384
    v_mfma_f32_16x16x32_bf16 v[36:39], v[72:75], v[148:151], v[36:39]
    s_waitcnt vmcnt(20) lgkmcnt(4)
    v_mfma_f32_16x16x32_bf16 v[16:19], v[76:79], v[152:155], v[16:19]
    ds_read_b128 v[40:43], v13 offset:18432
    v_mfma_f32_16x16x32_bf16 v[20:23], v[80:83], v[152:155], v[20:23]
    ds_read_b128 v[44:47], v13 offset:19456
    v_mfma_f32_16x16x32_bf16 v[24:27], v[84:87], v[152:155], v[24:27]
    ds_read_b128 v[48:51], v13 offset:20480
    v_mfma_f32_16x16x32_bf16 v[28:31], v[88:91], v[152:155], v[28:31]
    ds_read_b128 v[52:55], v13 offset:21504
    v_mfma_f32_16x16x32_bf16 v[32:35], v[108:111], v[152:155], v[32:35]
    ds_read_b128 v[72:75], v13 offset:26624
    s_waitcnt lgkmcnt(5)
    v_mfma_f32_16x16x32_bf16 v[16:19], v[92:95], v[156:159], v[16:19]
    ds_read_b128 v[56:59], v13 offset:22528
    v_mfma_f32_16x16x32_bf16 v[20:23], v[96:99], v[156:159], v[20:23]
    ds_read_b128 v[60:63], v13 offset:23552
    v_mfma_f32_16x16x32_bf16 v[24:27], v[100:103], v[156:159], v[24:27]
    ds_read_b128 v[64:67], v13 offset:24576
    v_mfma_f32_16x16x32_bf16 v[28:31], v[104:107], v[156:159], v[28:31]
    ds_read_b128 v[68:71], v13 offset:25600
    v_mfma_f32_16x16x32_bf16 v[36:39], v[108:111], v[156:159], v[36:39]
    s_waitcnt vmcnt(18) lgkmcnt(4)
    v_mfma_f32_16x16x32_bf16 v[16:19], v[40:43], v[160:163], v[16:19]
    ds_read_b128 v[76:79], v13 offset:27648
    v_mfma_f32_16x16x32_bf16 v[20:23], v[44:47], v[160:163], v[20:23]
    ds_read_b128 v[80:83], v13 offset:28672
    v_mfma_f32_16x16x32_bf16 v[24:27], v[48:51], v[160:163], v[24:27]
    ds_read_b128 v[84:87], v13 offset:29696
    v_mfma_f32_16x16x32_bf16 v[28:31], v[52:55], v[160:163], v[28:31]
    ds_read_b128 v[88:91], v13 offset:30720
    v_mfma_f32_16x16x32_bf16 v[32:35], v[72:75], v[160:163], v[32:35]
    ds_read_b128 v[108:111], v13 offset:35840
    s_waitcnt lgkmcnt(5)
    v_mfma_f32_16x16x32_bf16 v[16:19], v[56:59], v[164:167], v[16:19]
    ds_read_b128 v[92:95], v13 offset:31744
    v_mfma_f32_16x16x32_bf16 v[20:23], v[60:63], v[164:167], v[20:23]
    ds_read_b128 v[96:99], v13 offset:32768
    v_mfma_f32_16x16x32_bf16 v[24:27], v[64:67], v[164:167], v[24:27]
    ds_read_b128 v[100:103], v13 offset:33792
    v_mfma_f32_16x16x32_bf16 v[28:31], v[68:71], v[164:167], v[28:31]
    ds_read_b128 v[104:107], v13 offset:34816
    v_mfma_f32_16x16x32_bf16 v[36:39], v[72:75], v[164:167], v[36:39]
    s_waitcnt vmcnt(16) lgkmcnt(0)
    s_barrier
    v_mfma_f32_16x16x32_bf16 v[16:19], v[76:79], v[168:171], v[16:19]
    ds_read_b128 v[40:43], v14 offset:0
    v_mfma_f32_16x16x32_bf16 v[20:23], v[80:83], v[168:171], v[20:23]
    ds_read_b128 v[44:47], v14 offset:1024
    v_mfma_f32_16x16x32_bf16 v[24:27], v[84:87], v[168:171], v[24:27]
    ds_read_b128 v[48:51], v14 offset:2048
    v_mfma_f32_16x16x32_bf16 v[28:31], v[88:91], v[168:171], v[28:31]
    ds_read_b128 v[52:55], v14 offset:3072
    v_mfma_f32_16x16x32_bf16 v[32:35], v[108:111], v[168:171], v[32:35]
    ds_read_b128 v[72:75], v14 offset:8192
    v_mfma_f32_16x16x32_bf16 v[16:19], v[92:95], v[172:175], v[16:19]
    ds_read_b128 v[56:59], v14 offset:4096
    v_mfma_f32_16x16x32_bf16 v[20:23], v[96:99], v[172:175], v[20:23]
    ds_read_b128 v[60:63], v14 offset:5120
    v_mfma_f32_16x16x32_bf16 v[24:27], v[100:103], v[172:175], v[24:27]
    ds_read_b128 v[64:67], v14 offset:6144
    v_mfma_f32_16x16x32_bf16 v[28:31], v[104:107], v[172:175], v[28:31]
    ds_read_b128 v[68:71], v14 offset:7168
    v_mfma_f32_16x16x32_bf16 v[36:39], v[108:111], v[172:175], v[36:39]
    s_waitcnt vmcnt(12) lgkmcnt(4)
    v_mfma_f32_16x16x32_bf16 v[16:19], v[40:43], v[176:179], v[16:19]
    ds_read_b128 v[76:79], v14 offset:9216
    v_mfma_f32_16x16x32_bf16 v[20:23], v[44:47], v[176:179], v[20:23]
    ds_read_b128 v[80:83], v14 offset:10240
    v_mfma_f32_16x16x32_bf16 v[24:27], v[48:51], v[176:179], v[24:27]
    ds_read_b128 v[84:87], v14 offset:11264
    v_mfma_f32_16x16x32_bf16 v[28:31], v[52:55], v[176:179], v[28:31]
    ds_read_b128 v[88:91], v14 offset:12288
    v_mfma_f32_16x16x32_bf16 v[32:35], v[72:75], v[176:179], v[32:35]
    ds_read_b128 v[108:111], v14 offset:17408
    s_waitcnt lgkmcnt(5)
    v_mfma_f32_16x16x32_bf16 v[16:19], v[56:59], v[180:183], v[16:19]
    ds_read_b128 v[92:95], v14 offset:13312
    v_mfma_f32_16x16x32_bf16 v[20:23], v[60:63], v[180:183], v[20:23]
    ds_read_b128 v[96:99], v14 offset:14336
    v_mfma_f32_16x16x32_bf16 v[24:27], v[64:67], v[180:183], v[24:27]
    ds_read_b128 v[100:103], v14 offset:15360
    v_mfma_f32_16x16x32_bf16 v[28:31], v[68:71], v[180:183], v[28:31]
    ds_read_b128 v[104:107], v14 offset:16384
    v_mfma_f32_16x16x32_bf16 v[36:39], v[72:75], v[180:183], v[36:39]
    s_waitcnt vmcnt(8) lgkmcnt(4)
    v_mfma_f32_16x16x32_bf16 v[16:19], v[76:79], v[184:187], v[16:19]
    ds_read_b128 v[40:43], v14 offset:18432
    v_mfma_f32_16x16x32_bf16 v[20:23], v[80:83], v[184:187], v[20:23]
    ds_read_b128 v[44:47], v14 offset:19456
    v_mfma_f32_16x16x32_bf16 v[24:27], v[84:87], v[184:187], v[24:27]
    ds_read_b128 v[48:51], v14 offset:20480
    v_mfma_f32_16x16x32_bf16 v[28:31], v[88:91], v[184:187], v[28:31]
    ds_read_b128 v[52:55], v14 offset:21504
    v_mfma_f32_16x16x32_bf16 v[32:35], v[108:111], v[184:187], v[32:35]
    ds_read_b128 v[72:75], v14 offset:26624
    s_waitcnt lgkmcnt(5)
    v_mfma_f32_16x16x32_bf16 v[16:19], v[92:95], v[188:191], v[16:19]
    ds_read_b128 v[56:59], v14 offset:22528
    v_mfma_f32_16x16x32_bf16 v[20:23], v[96:99], v[188:191], v[20:23]
    ds_read_b128 v[60:63], v14 offset:23552
    v_mfma_f32_16x16x32_bf16 v[24:27], v[100:103], v[188:191], v[24:27]
    ds_read_b128 v[64:67], v14 offset:24576
    v_mfma_f32_16x16x32_bf16 v[28:31], v[104:107], v[188:191], v[28:31]
    ds_read_b128 v[68:71], v14 offset:25600
    v_mfma_f32_16x16x32_bf16 v[36:39], v[108:111], v[188:191], v[36:39]
    s_waitcnt vmcnt(4) lgkmcnt(4)
    v_mfma_f32_16x16x32_bf16 v[16:19], v[40:43], v[192:195], v[16:19]
    ds_read_b128 v[76:79], v14 offset:27648
    v_mfma_f32_16x16x32_bf16 v[20:23], v[44:47], v[192:195], v[20:23]
    ds_read_b128 v[80:83], v14 offset:28672
    v_mfma_f32_16x16x32_bf16 v[24:27], v[48:51], v[192:195], v[24:27]
    ds_read_b128 v[84:87], v14 offset:29696
    v_mfma_f32_16x16x32_bf16 v[28:31], v[52:55], v[192:195], v[28:31]
    ds_read_b128 v[88:91], v14 offset:30720
    v_mfma_f32_16x16x32_bf16 v[32:35], v[72:75], v[192:195], v[32:35]
    ds_read_b128 v[108:111], v14 offset:35840
    s_waitcnt lgkmcnt(5)
    v_mfma_f32_16x16x32_bf16 v[16:19], v[56:59], v[196:199], v[16:19]
    ds_read_b128 v[92:95], v14 offset:31744
    v_mfma_f32_16x16x32_bf16 v[20:23], v[60:63], v[196:199], v[20:23]
    ds_read_b128 v[96:99], v14 offset:32768
    v_mfma_f32_16x16x32_bf16 v[24:27], v[64:67], v[196:199], v[24:27]
    ds_read_b128 v[100:103], v14 offset:33792
    v_mfma_f32_16x16x32_bf16 v[28:31], v[68:71], v[196:199], v[28:31]
    ds_read_b128 v[104:107], v14 offset:34816
    v_mfma_f32_16x16x32_bf16 v[36:39], v[72:75], v[196:199], v[36:39]
    s_waitcnt vmcnt(0) lgkmcnt(4)
    v_mfma_f32_16x16x32_bf16 v[16:19], v[76:79], v[200:203], v[16:19]
    v_mfma_f32_16x16x32_bf16 v[20:23], v[80:83], v[200:203], v[20:23]
    v_mfma_f32_16x16x32_bf16 v[24:27], v[84:87], v[200:203], v[24:27]
    v_mfma_f32_16x16x32_bf16 v[28:31], v[88:91], v[200:203], v[28:31]
    v_mfma_f32_16x16x32_bf16 v[32:35], v[108:111], v[200:203], v[32:35]
    s_waitcnt lgkmcnt(0)
    v_mfma_f32_16x16x32_bf16 v[16:19], v[92:95], v[204:207], v[16:19]
    v_mfma_f32_16x16x32_bf16 v[20:23], v[96:99], v[204:207], v[20:23]
    v_mfma_f32_16x16x32_bf16 v[24:27], v[100:103], v[204:207], v[24:27]
    v_mfma_f32_16x16x32_bf16 v[28:31], v[104:107], v[204:207], v[28:31]
    v_mfma_f32_16x16x32_bf16 v[36:39], v[108:111], v[204:207], v[36:39]
    s_nop 3
    v_cvt_pk_bf16_f32 v208, v16, v17
    v_cvt_pk_bf16_f32 v209, v18, v19
    v_cvt_pk_bf16_f32 v210, v20, v21
    v_cvt_pk_bf16_f32 v211, v22, v23
    v_cvt_pk_bf16_f32 v212, v24, v25
    v_cvt_pk_bf16_f32 v213, v26, v27
    v_cvt_pk_bf16_f32 v214, v28, v29
    v_cvt_pk_bf16_f32 v215, v30, v31
    s_cmp_eq_u32 s22, 1
    s_cbranch_scc1 L_fin_p5
    buffer_store_dwordx4 v[208:211], v4, s[4:7], s34 offen offset:0 sc1
    buffer_store_dwordx4 v[212:215], v4, s[4:7], s34 offen offset:1024 sc1
    v_permlane32_swap_b32 v36, v220
    v_permlane32_swap_b32 v37, v221
    v_permlane32_swap_b32 v38, v222
    v_permlane32_swap_b32 v39, v223
    v_pk_add_f32 v[32:33], v[32:33], v[220:221]
    v_pk_add_f32 v[34:35], v[34:35], v[222:223]
    v_cvt_pk_bf16_f32 v216, v32, v33
    v_cvt_pk_bf16_f32 v217, v34, v35
    buffer_store_dwordx2 v[216:217], v5, s[4:7], s34 offen sc1
    v_cndmask_b32 v222, 0, v216, s[40:41]
    v_cndmask_b32 v223, 0, v217, s[40:41]
    v_dot2_f32_bf16 v220, v208, v11, 0
    v_dot2_f32_bf16 v221, v208, v208, 0
    v_dot2_f32_bf16 v220, v209, v11, v220
    v_dot2_f32_bf16 v221, v209, v209, v221
    v_dot2_f32_bf16 v220, v210, v11, v220
    v_dot2_f32_bf16 v221, v210, v210, v221
    v_dot2_f32_bf16 v220, v211, v11, v220
    v_dot2_f32_bf16 v221, v211, v211, v221
    v_dot2_f32_bf16 v220, v212, v11, v220
    v_dot2_f32_bf16 v221, v212, v212, v221
    v_dot2_f32_bf16 v220, v213, v11, v220
    v_dot2_f32_bf16 v221, v213, v213, v221
    v_dot2_f32_bf16 v220, v214, v11, v220
    v_dot2_f32_bf16 v221, v214, v214, v221
    v_dot2_f32_bf16 v220, v215, v11, v220
    v_dot2_f32_bf16 v221, v215, v215, v221
    v_dot2_f32_bf16 v220, v222, v11, v220
    v_dot2_f32_bf16 v221, v222, v222, v221
    v_dot2_f32_bf16 v220, v223, v11, v220
    v_dot2_f32_bf16 v221, v223, v223, v221
    s_nop 2
    v_mov_b32 v222, v220
    v_mov_b32 v223, v221
    s_nop 1
    v_permlane32_swap_b32 v220, v222
    v_permlane32_swap_b32 v221, v223
    v_add_f32 v220, v220, v222
    v_add_f32 v221, v221, v223
    v_mov_b32 v222, v220
    v_mov_b32 v223, v221
    s_nop 1
    v_permlane16_swap_b32 v220, v222
    v_permlane16_swap_b32 v221, v223
    v_add_f32 v220, v220, v222
    v_add_f32 v221, v221, v223
    buffer_store_dwordx2 v[220:221], v10, s[4:7], s39 offen sc1
    s_mov_b32 s22, 1
    s_mov_b32 s21, 0x1c00000
    s_branch L_m_cl
L_fin_p5:
    buffer_store_dwordx4 v[208:211], v4, s[16:19], s34 offen offset:0
    buffer_store_dwordx4 v[212:215], v4, s[16:19], s34 offen offset:64
    v_permlane32_swap_b32 v36, v220
    v_permlane32_swap_b32 v37, v221
    v_permlane32_swap_b32 v38, v222
    v_permlane32_swap_b32 v39, v223
    v_pk_add_f32 v[32:33], v[32:33], v[220:221]
    v_pk_add_f32 v[34:35], v[34:35], v[222:223]
    v_cvt_pk_bf16_f32 v216, v32, v33
    v_cvt_pk_bf16_f32 v217, v34, v35
    buffer_store_dwordx2 v[216:217], v5, s[16:19], s34 offen offset:128
    s_endpgm
L_g_slow:
    s_mov_b32 s60, 65536
L_g_sl:
    s_sleep 2
    v_lshrrev_b32 v4, 8, v1
    v_bfe_u32 v5, v1, 6, 2
    v_bfe_u32 v6, v1, 4, 2
    v_lshlrev_b32 v255, 6, v4
    v_lshl_add_u32 v255, v5, 8, v255
    v_lshl_add_u32 v255, v6, 4, v255
    buffer_load_dwordx4 v[4:7], v255, s[4:7], s35 offen offset:0 sc1
    buffer_load_dwordx4 v[8:11], v255, s[4:7], s35 offen offset:1024 sc1
    buffer_load_dwordx4 v[12:15], v255, s[4:7], s35 offen offset:2048 sc1
    buffer_load_dwordx4 v[252:255], v255, s[4:7], s35 offen offset:3072 sc1
    s_waitcnt vmcnt(0)
    v_or3_b32 v249, v5, v7, v9
    v_or3_b32 v251, v11, v13, v15
    v_or3_b32 v249, v253, v255, v249
    v_or_b32 v249, v249, v251
    v_cmp_gt_i32 vcc, 0, v249
    s_sub_u32 s60, s60, 1
    s_cbranch_scc1 L_g_back
    s_cbranch_vccnz L_g_sl
    s_branch L_g_back
L_m_l1:
    s_and_b32 s25, s2, 7
    s_lshr_b32 s26, s2, 3
    s_lshr_b32 s23, s25, 1
    s_lshl_b32 s23, s23, 2
    s_lshr_b32 s27, s26, 3
    s_add_u32 s23, s23, s27
    s_and_b32 s24, s25, 1
    s_lshl_b32 s24, s24, 3
    s_and_b32 s27, s26, 7
    s_add_u32 s24, s24, s27
    s_mul_i32 s29, s24, 129024
    s_lshl_b32 s30, s20, 12
    s_add_u32 s29, s29, s30
    s_add_u32 s29, s29, 0x3800000
    s_lshl_b32 s31, s23, 3
    s_max_u32 s31, s31, 1
    s_sub_u32 s31, s31, 1
    s_mul_i32 s31, s31, 18432
    s_add_u32 s31, s31, 0x0
    s_lshl_b32 s35, s20, 10
    s_and_b32 s36, s35, 1024
    v_and_b32 v70, 48, v1
    v_lshrrev_b32 v71, 8, v1
    v_lshl_add_u32 v70, v71, 6, v70
    v_bfe_u32 v71, v1, 6, 2
    v_lshl_add_u32 v70, v71, 8, v70
    s_barrier
    s_add_u32 m0, s35, 131072
    s_add_u32 s34, s31, s35
    s_add_u32 s34, s34, 0
    buffer_load_dwordx4 v1, s[4:7], s34 offen sc1 lds
    s_add_u32 m0, s30, 0
    s_add_u32 s34, s29, 0
    buffer_load_dwordx4 v70, s[4:7], s34 offen offset:0 lds
    buffer_load_dwordx4 v70, s[4:7], s34 offen offset:1024 lds
    buffer_load_dwordx4 v70, s[4:7], s34 offen offset:2048 lds
    buffer_load_dwordx4 v70, s[4:7], s34 offen offset:3072 lds
    s_add_u32 m0, s30, 16384
    s_add_u32 s34, s29, 16384
    buffer_load_dwordx4 v70, s[4:7], s34 offen offset:0 lds
    buffer_load_dwordx4 v70, s[4:7], s34 offen offset:1024 lds
    buffer_load_dwordx4 v70, s[4:7], s34 offen offset:2048 lds
    buffer_load_dwordx4 v70, s[4:7], s34 offen offset:3072 lds
    s_waitcnt vmcnt(4) lgkmcnt(0)
    s_barrier
    s_add_u32 m0, s35, 135168
    s_add_u32 s34, s31, s35
    s_add_u32 s34, s34, 4096
    buffer_load_dwordx4 v1, s[4:7], s34 offen sc1 lds
    s_add_u32 m0, s30, 32768
    s_add_u32 s34, s29, 32768
    buffer_load_dwordx4 v70, s[4:7], s34 offen offset:0 lds
    buffer_load_dwordx4 v70, s[4:7], s34 offen offset:1024 lds
    buffer_load_dwordx4 v70, s[4:7], s34 offen offset:2048 lds
    buffer_load_dwordx4 v70, s[4:7], s34 offen offset:3072 lds
    s_add_u32 m0, s30, 49152
    s_add_u32 s34, s29, 49152
    buffer_load_dwordx4 v70, s[4:7], s34 offen offset:0 lds
    buffer_load_dwordx4 v70, s[4:7], s34 offen offset:1024 lds
    buffer_load_dwordx4 v70, s[4:7], s34 offen offset:2048 lds
    buffer_load_dwordx4 v70, s[4:7], s34 offen offset:3072 lds
    s_cmp_lt_u32 s2, 144
    s_cbranch_scc1 L_p0_t1
    s_cmp_ge_u32 s2, 216
    s_cbranch_scc1 L_p0_t2
    ds_read_b64_tr_b16 v[16:17], v4 offset:0
    ds_read_b64_tr_b16 v[18:19], v4 offset:2048
    ds_read_b64_tr_b16 v[20:21], v4 offset:4096
    ds_read_b64_tr_b16 v[22:23], v4 offset:6144
    ds_read_b64_tr_b16 v[24:25], v4 offset:8192
    ds_read_b64_tr_b16 v[26:27], v4 offset:10240
    ds_read_b64_tr_b16 v[28:29], v4 offset:12288
    ds_read_b64_tr_b16 v[30:31], v4 offset:14336
    ds_read_b64_tr_b16 v[32:33], v4 offset:18432
    ds_read_b64_tr_b16 v[34:35], v4 offset:20480
    ds_read_b64_tr_b16 v[36:37], v4 offset:22528
    ds_read_b64_tr_b16 v[38:39], v4 offset:24576
    ds_read_b64_tr_b16 v[40:41], v4 offset:26624
    ds_read_b64_tr_b16 v[42:43], v4 offset:28672
    ds_read_b64_tr_b16 v[44:45], v4 offset:30720
    ds_read_b64_tr_b16 v[46:47], v4 offset:32768
    ds_read_b64_tr_b16 v[48:49], v5 offset:16384
    ds_read_b64_tr_b16 v[50:51], v5 offset:34816
    s_branch L_p0_t2
L_p0_t1:
    ds_read_b64_tr_b16 v[16:17], v4 offset:0
    ds_read_b64_tr_b16 v[18:19], v4 offset:512
    ds_read_b64_tr_b16 v[20:21], v4 offset:4096
    ds_read_b64_tr_b16 v[22:23], v4 offset:4608
    ds_read_b64_tr_b16 v[24:25], v4 offset:9216
    ds_read_b64_tr_b16 v[26:27], v4 offset:9728
    ds_read_b64_tr_b16 v[28:29], v4 offset:13312
    ds_read_b64_tr_b16 v[30:31], v4 offset:13824
    ds_read_b64_tr_b16 v[32:33], v4 offset:18432
    ds_read_b64_tr_b16 v[34:35], v4 offset:18944
    ds_read_b64_tr_b16 v[36:37], v4 offset:22528
    ds_read_b64_tr_b16 v[38:39], v4 offset:23040
    ds_read_b64_tr_b16 v[40:41], v4 offset:27648
    ds_read_b64_tr_b16 v[42:43], v4 offset:28160
    ds_read_b64_tr_b16 v[44:45], v4 offset:31744
    ds_read_b64_tr_b16 v[46:47], v4 offset:32256
    ds_read_b64_tr_b16 v[48:49], v5 offset:8192
    ds_read_b64_tr_b16 v[50:51], v5 offset:8704
L_p0_t2:
    s_waitcnt lgkmcnt(0)
    s_waitcnt vmcnt(9) lgkmcnt(0)
    s_barrier
    s_add_u32 m0, s35, 139264
    s_add_u32 s34, s31, s35
    s_add_u32 s34, s34, 8192
    buffer_load_dwordx4 v1, s[4:7], s34 offen sc1 lds
    v_lshrrev_b32 v60, 8, v1
    v_bfe_u32 v61, v1, 7, 1
    v_bfe_u32 v62, v1, 4, 3
    v_cmp_gt_u32 vcc, 3, v60
    v_mul_u32_u24 v61, 80, v61
    v_lshl_add_u32 v61, v62, 3, v61
    v_lshrrev_b32 v63, 1, v62
    v_and_b32 v62, 1, v62
    v_lshl_add_u32 v62, v62, 3, 64
    v_cndmask_b32 v60, v63, v60, vcc
    v_cndmask_b32 v61, v62, v61, vcc
    v_mul_u32_u24 v60, 2304, v60
    v_add_u32 v69, v60, v61
    v_lshrrev_b32 v68, 1, v1
    s_mul_i32 s34, s24, 144
    s_add_u32 s34, s34, 0x4400000
    buffer_load_dwordx2 v[60:61], v69, s[4:7], s34 offen
    s_mul_i32 s34, s24, 144
    s_add_u32 s34, s34, 0x4402000
    buffer_load_dwordx2 v[62:63], v69, s[4:7], s34 offen
    s_mul_i32 s34, s24, 144
    s_add_u32 s34, s34, 0x4404000
    buffer_load_dwordx2 v[64:65], v69, s[4:7], s34 offen
    s_mul_i32 s34, s24, 144
    s_add_u32 s34, s34, 0x4406000
    buffer_load_dwordx2 v[66:67], v69, s[4:7], s34 offen
    s_add_u32 m0, s30, 65536
    s_add_u32 s34, s29, 65536
    buffer_load_dwordx4 v70, s[4:7], s34 offen offset:0 lds
    buffer_load_dwordx4 v70, s[4:7], s34 offen offset:1024 lds
    buffer_load_dwordx4 v70, s[4:7], s34 offen offset:2048 lds
    buffer_load_dwordx4 v70, s[4:7], s34 offen offset:3072 lds
    s_waitcnt vmcnt(13) lgkmcnt(0)
    s_barrier
    s_add_u32 m0, s30, 81920
    s_add_u32 s34, s29, 81920
    buffer_load_dwordx4 v70, s[4:7], s34 offen offset:0 lds
    buffer_load_dwordx4 v70, s[4:7], s34 offen offset:1024 lds
    buffer_load_dwordx4 v70, s[4:7], s34 offen offset:2048 lds
    buffer_load_dwordx4 v70, s[4:7], s34 offen offset:3072 lds
    s_waitcnt vmcnt(13) lgkmcnt(0)
    s_barrier
    s_add_u32 m0, s35, 143360
    s_add_u32 s34, s31, s35
    s_add_u32 s34, s34, 12288
    buffer_load_dwordx4 v1, s[4:7], s34 offen sc1 lds
    s_add_u32 m0, s30, 98304
    s_add_u32 s34, s29, 98304
    buffer_load_dwordx4 v70, s[4:7], s34 offen offset:0 lds
    buffer_load_dwordx4 v70, s[4:7], s34 offen offset:1024 lds
    buffer_load_dwordx4 v70, s[4:7], s34 offen offset:2048 lds
    buffer_load_dwordx4 v70, s[4:7], s34 offen offset:3072 lds
    s_waitcnt vmcnt(13)
    v_add_f32 v60, v60, v62
    v_add_f32 v61, v61, v63
    v_add_f32 v64, v64, v66
    v_add_f32 v65, v65, v67
    v_add_f32 v60, v60, v64
    v_add_f32 v61, v61, v65
    v_cmp_gt_u32 vcc, 864, v1
    v_add_u32 v68, 161792, v68
    s_nop 0
    v_cndmask_b32 v60, 0, v60, vcc
    v_cndmask_b32 v61, 0, v61, vcc
    ds_write_b64 v68, v[60:61]
    s_waitcnt vmcnt(9) lgkmcnt(0)
    s_barrier
    s_add_u32 m0, s36, 147456
    s_add_u32 s34, s31, s36
    s_add_u32 s34, s34, 16384
    buffer_load_dwordx4 v1, s[4:7], s34 offen sc1 lds
    s_add_u32 m0, s30, 114688
    s_add_u32 s34, s29, 114688
    buffer_load_dwordx4 v70, s[4:7], s34 offen offset:0 lds
    buffer_load_dwordx4 v70, s[4:7], s34 offen offset:1024 lds
    buffer_load_dwordx4 v70, s[4:7], s34 offen offset:2048 lds
    buffer_load_dwordx4 v70, s[4:7], s34 offen offset:3072 lds
    s_waitcnt vmcnt(10) lgkmcnt(0)
    s_barrier
    buffer_store_dwordx4 v[16:19], v9, s[4:7], s37 offen sc1
    buffer_store_dwordx4 v[20:23], v10, s[4:7], s38 offen sc1
    buffer_store_dwordx4 v[24:27], v9, s[4:7], s39 offen sc1
    buffer_store_dwordx4 v[28:31], v10, s[4:7], s40 offen sc1
    s_waitcnt vmcnt(9) lgkmcnt(0)
    s_barrier
    buffer_store_dwordx4 v[32:35], v9, s[4:7], s41 offen sc1
    buffer_store_dwordx4 v[36:39], v10, s[4:7], s42 offen sc1
    buffer_store_dwordx4 v[40:43], v9, s[4:7], s43 offen sc1
    s_waitcnt vmcnt(7) lgkmcnt(0)
    s_barrier
    s_mov_b32 s46, 0x4502000
    v_mov_b32 v4, 0
    s_mov_b32 s60, 65536
L_poll_wo:
    buffer_load_dword v5, v4, s[4:7], s46 offen sc1
    s_waitcnt vmcnt(0)
    v_cmp_gt_u32 vcc, 18, v5
    s_sub_u32 s60, s60, 1
    s_cbranch_scc1 L_pd_wo
    s_cbranch_vccz L_pd_wo
    s_sleep 4
    s_branch L_poll_wo
L_pd_wo:
    buffer_store_dwordx4 v[44:47], v10, s[4:7], s47 offen sc1
    buffer_store_dwordx4 v[48:51], v14, s[4:7], s48 offen sc1
    v_dot2_f32_bf16 v12, v16, v11, 0
    v_dot2_f32_bf16 v13, v17, v11, 0
    v_dot2_f32_bf16 v12, v18, v11, v12
    v_dot2_f32_bf16 v13, v19, v11, v13
    v_dot2_f32_bf16 v12, v20, v11, v12
    v_dot2_f32_bf16 v13, v21, v11, v13
    v_dot2_f32_bf16 v12, v22, v11, v12
    v_dot2_f32_bf16 v13, v23, v11, v13
    v_dot2_f32_bf16 v12, v24, v11, v12
    v_dot2_f32_bf16 v13, v25, v11, v13
    v_dot2_f32_bf16 v12, v26, v11, v12
    v_dot2_f32_bf16 v13, v27, v11, v13
    v_dot2_f32_bf16 v12, v28, v11, v12
    v_dot2_f32_bf16 v13, v29, v11, v13
    v_dot2_f32_bf16 v12, v30, v11, v12
    v_dot2_f32_bf16 v13, v31, v11, v13
    v_dot2_f32_bf16 v12, v32, v11, v12
    v_dot2_f32_bf16 v13, v33, v11, v13
    v_dot2_f32_bf16 v12, v34, v11, v12
    v_dot2_f32_bf16 v13, v35, v11, v13
    v_dot2_f32_bf16 v12, v36, v11, v12
    v_dot2_f32_bf16 v13, v37, v11, v13
    v_dot2_f32_bf16 v12, v38, v11, v12
    v_dot2_f32_bf16 v13, v39, v11, v13
    v_dot2_f32_bf16 v12, v40, v11, v12
    v_dot2_f32_bf16 v13, v41, v11, v13
    v_dot2_f32_bf16 v12, v42, v11, v12
    v_dot2_f32_bf16 v13, v43, v11, v13
    v_dot2_f32_bf16 v12, v44, v11, v12
    v_dot2_f32_bf16 v13, v45, v11, v13
    v_dot2_f32_bf16 v12, v46, v11, v12
    v_dot2_f32_bf16 v13, v47, v11, v13
    v_dot2_f32_bf16 v12, v48, v11, v12
    v_dot2_f32_bf16 v13, v49, v11, v13
    v_dot2_f32_bf16 v12, v50, v11, v12
    v_dot2_f32_bf16 v13, v51, v11, v13
    s_nop 2
    v_add_f32 v12, v12, v13
    v_mov_b32 v13, v12
    s_nop 1
    v_permlane32_swap_b32 v12, v13
    v_add_f32 v12, v12, v13
    v_mov_b32 v13, v12
    s_nop 1
    v_permlane16_swap_b32 v12, v13
    v_add_f32 v12, v12, v13
    buffer_store_dword v12, v15, s[4:7], s49 offen sc1
    s_barrier
L_m_ll:
    s_and_b32 s25, s2, 7
    s_lshr_b32 s26, s2, 3
    s_lshl_b32 s23, s25, 2
    s_lshr_b32 s27, s26, 3
    s_add_u32 s23, s23, s27
    s_and_b32 s24, s26, 7
    s_add_u32 s25, s23, s24
    s_and_b32 s25, s25, 3
    s_mul_i32 s29, s24, 82944
    s_add_u32 s29, s29, 0x3a00000
    s_mul_i32 s30, s20, 36864
    s_mul_i32 s31, s20, 18432
    s_add_u32 s31, s31, s29
    s_add_u32 m0, s30, 18432
    s_add_u32 s33, s31, 0
    buffer_load_dwordx4 v1, s[4:7], s33 offen offset:0  lds
    buffer_load_dwordx4 v1, s[4:7], s33 offen offset:1024  lds
    buffer_load_dwordx4 v1, s[4:7], s33 offen offset:2048  lds
    buffer_load_dwordx4 v1, s[4:7], s33 offen offset:3072  lds
    s_add_u32 m0, s30, 22528
    s_add_u32 s33, s31, 4096
    buffer_load_dwordx4 v1, s[4:7], s33 offen offset:0  lds
    buffer_load_dwordx4 v1, s[4:7], s33 offen offset:1024  lds
    buffer_load_dwordx4 v1, s[4:7], s33 offen offset:2048  lds
    buffer_load_dwordx4 v1, s[4:7], s33 offen offset:3072  lds
    s_add_u32 m0, s30, 26624
    s_add_u32 s33, s31, 8192
    buffer_load_dwordx4 v1, s[4:7], s33 offen offset:0  lds
    buffer_load_dwordx4 v1, s[4:7], s33 offen offset:1024  lds
    buffer_load_dwordx4 v1, s[4:7], s33 offen offset:2048  lds
    buffer_load_dwordx4 v1, s[4:7], s33 offen offset:3072  lds
    s_add_u32 m0, s30, 30720
    s_add_u32 s33, s31, 12288
    buffer_load_dwordx4 v1, s[4:7], s33 offen offset:0  lds
    buffer_load_dwordx4 v1, s[4:7], s33 offen offset:1024  lds
    buffer_load_dwordx4 v1, s[4:7], s33 offen offset:2048  lds
    buffer_load_dwordx4 v1, s[4:7], s33 offen offset:3072  lds
    s_add_u32 m0, s30, 34816
    s_add_u32 s33, s31, 16384
    buffer_load_dwordx4 v1, s[4:7], s33 offen offset:0  lds
    buffer_load_dwordx4 v1, s[4:7], s33 offen offset:1024  lds
    s_mul_i32 s30, s20, 3072
    s_add_u32 s31, s30, s29
    s_waitcnt vmcnt(18)
    s_barrier
    s_add_u32 m0, s30, 147456
    s_add_u32 s33, s31, 73728
    buffer_load_dwordx4 v1, s[4:7], s33 offen offset:0  lds
    buffer_load_dwordx4 v1, s[4:7], s33 offen offset:1024  lds
    buffer_load_dwordx4 v1, s[4:7], s33 offen offset:2048  lds
    s_or_b32 s44, s20, s22
    s_cbranch_scc1 L_p2_ns
    s_and_b32 s44, s2, 15
    s_lshl_b32 s44, s44, 8
    s_add_u32 s44, s44, 0x4501000
    s_add_u32 s44, s44, s4
    s_addc_u32 s45, s5, 0
    s_mov_b32 s56, 1
    s_atomic_add s56, s[44:45], 0
L_p2_ns:
    s_waitcnt vmcnt(0)
    s_barrier
    s_and_b32 s25, s2, 7
    s_lshr_b32 s26, s2, 3
    s_and_b32 s23, s25, 1
    s_lshl_b32 s23, s23, 3
    s_and_b32 s27, s26, 7
    s_add_u32 s23, s23, s27
    s_lshr_b32 s24, s25, 1
    s_lshl_b32 s24, s24, 2
    s_lshr_b32 s27, s26, 3
    s_add_u32 s24, s24, s27
    s_add_u32 s28, s23, s24
    s_and_b32 s28, s28, 3
    s_lshl_b32 s30, s20, 12
    s_lshr_b32 s33, s20, 1
    s_mul_i32 s31, s33, 36864
    s_and_b32 s33, s20, 1
    s_lshl_b32 s33, s33, 10
    s_add_u32 s33, s33, 16384
    s_add_u32 s31, s31, s33
    s_sub_u32 s49, s33, s30
    s_mul_i32 s34, s24, 331776
    s_add_u32 s34, s34, s30
    s_add_u32 s34, s34, 0x3b00000
    s_lshl_b32 s35, s23, 3
    s_lshl_b32 s33, s20, 1
    s_add_u32 s35, s35, s33
    s_mul_i32 s35, s35, 18432
    s_add_u32 s35, s35, s21
    s_add_u32 s35, s35, 0x300000
    s_mul_i32 s36, s24, 589824
    s_add_u32 s36, s36, s30
    s_add_u32 s36, s36, s21
    s_add_u32 s36, s36, 0x900000
    v_add_u32 v2, 16384, v1
    s_add_u32 s33, s30, 18432
    v_add_u32 v6, s33, v1
    v_add_u32 v7, 73728, v6
    s_lshl_b32 s33, s23, 7
    s_lshl_b32 s37, s20, 5
    s_add_u32 s33, s33, s37
    v_lshrrev_b32 v8, 7, v1
    v_add_u32 v8, s33, v8
    v_lshlrev_b32 v8, 12, v8
    v_lshrrev_b32 v9, 8, v1
    v_bfe_u32 v10, v1, 4, 3
    v_xor_b32 v9, v9, v10
    v_lshl_add_u32 v8, v9, 4, v8
    v_xor_b32 v9, 64, v8
    v_add_u32 v9, 31744, v9
    v_add_u32 v10, 63488, v8
    v_add_u32 v11, 63488, v9
    s_cmp_eq_u32 s28, 0
    s_cselect_b32 s44, 4, 0
    s_cmp_eq_u32 s28, 1
    s_cselect_b32 s45, 5, 1
    s_cmp_eq_u32 s28, 2
    s_cselect_b32 s46, 6, 2
    s_cmp_eq_u32 s28, 3
    s_cselect_b32 s47, 7, 3
    s_lshl_b32 s33, s20, 4
    s_add_u32 s33, s33, s24
    s_lshl_b32 s54, s22, 7
    s_add_u32 s54, s54, s33
    s_lshl_b32 s54, s54, 8
    s_add_u32 s54, s54, 0x450c000
    s_add_u32 s54, s54, s4
    s_addc_u32 s55, s5, 0
    s_mov_b32 s33, 0x4501000
    v_and_b32 v4, 0xf0, v1
    v_lshlrev_b32 v4, 4, v4
    s_mov_b32 s60, 65536
L_poll_wr:
    buffer_load_dword v5, v4, s[4:7], s33 offen sc1
    s_waitcnt vmcnt(0)
    v_cmp_gt_u32 vcc, 16, v5
    s_sub_u32 s60, s60, 1
    s_cbranch_scc1 L_pd_wr
    s_cbranch_vccz L_pd_wr
    s_sleep 4
    s_branch L_poll_wr
L_pd_wr:
    s_min_u32 s33, s20, 2
    s_lshl_b32 s33, s33, 9
    v_lshrrev_b32 v4, 1, v1
    v_add_u32 v4, s33, v4
    s_lshl_b32 s51, s24, 12
    s_add_u32 s51, s51, 0x4410000
    buffer_load_dwordx2 v[60:61], v4, s[4:7], s51 offen offset:0
    buffer_load_dwordx2 v[62:63], v4, s[4:7], s51 offen offset:1152
    s_mov_b32 s48, 0
    s_mul_i32 s50, s48, 18432
    s_add_u32 s50, s50, s34
    s_add_u32 m0, s30, 0
    s_mov_b32 s53, s50
    buffer_load_dwordx4 v1, s[4:7], s50 offen offset:0  lds
    buffer_load_dwordx4 v1, s[4:7], s50 offen offset:1024  lds
    buffer_load_dwordx4 v1, s[4:7], s50 offen offset:2048  lds
    buffer_load_dwordx4 v1, s[4:7], s50 offen offset:3072  lds
    s_mov_b32 s48, 1
    s_mul_i32 s50, s48, 18432
    s_add_u32 s50, s50, s34
    s_cmp_ge_u32 s20, 2
    s_cselect_b32 s52, s50, s53
    s_add_u32 m0, s31, 0
    s_add_u32 s52, s52, s49
    buffer_load_dwordx4 v1, s[4:7], s52 offen  lds
    s_add_u32 m0, s30, 36864
    s_mov_b32 s53, s50
    buffer_load_dwordx4 v1, s[4:7], s50 offen offset:0  lds
    buffer_load_dwordx4 v1, s[4:7], s50 offen offset:1024  lds
    buffer_load_dwordx4 v1, s[4:7], s50 offen offset:2048  lds
    buffer_load_dwordx4 v1, s[4:7], s50 offen offset:3072  lds
    s_mov_b32 s48, 2
    s_mul_i32 s50, s48, 18432
    s_add_u32 s50, s50, s34
    s_add_u32 m0, s30, 73728
    s_mov_b32 s53, s50
    buffer_load_dwordx4 v1, s[4:7], s50 offen offset:0  lds
    buffer_load_dwordx4 v1, s[4:7], s50 offen offset:1024  lds
    buffer_load_dwordx4 v1, s[4:7], s50 offen offset:2048  lds
    buffer_load_dwordx4 v1, s[4:7], s50 offen offset:3072  lds
    s_waitcnt vmcnt(13)
    v_add_u32 v4, 159744, v4
    v_add_f32 v60, v60, v62
    v_add_f32 v61, v61, v63
    ds_write_b64 v4, v[60:61]
    s_waitcnt lgkmcnt(0)
    s_barrier
    s_mov_b32 s48, 3
    s_mul_i32 s50, s48, 18432
    s_add_u32 s50, s50, s34
    s_cmp_ge_u32 s20, 2
    s_cselect_b32 s52, s50, s53
    s_add_u32 m0, s31, 73728
    s_add_u32 s52, s52, s49
    buffer_load_dwordx4 v1, s[4:7], s52 offen  lds
    s_add_u32 m0, s30, 110592
    s_mov_b32 s53, s50
    buffer_load_dwordx4 v1, s[4:7], s50 offen offset:0  lds
    buffer_load_dwordx4 v1, s[4:7], s50 offen offset:1024  lds
    buffer_load_dwordx4 v1, s[4:7], s50 offen offset:2048  lds
    buffer_load_dwordx4 v1, s[4:7], s50 offen offset:3072  lds
    s_barrier
    s_add_u32 m0, s30, 18432
    s_add_u32 s51, s35, 0
    buffer_load_dwordx4 v1, s[4:7], s51 offen offset:0 sc1 lds
    buffer_load_dwordx4 v1, s[4:7], s51 offen offset:1024 sc1 lds
    buffer_load_dwordx4 v2, s[4:7], s51 offen offset:2048 sc1 lds
    buffer_load_dwordx4 v2, s[4:7], s51 offen offset:3072 sc1 lds
    s_add_u32 m0, s30, 55296
    s_add_u32 s51, s35, 2048
    buffer_load_dwordx4 v1, s[4:7], s51 offen offset:0 sc1 lds
    buffer_load_dwordx4 v1, s[4:7], s51 offen offset:1024 sc1 lds
    buffer_load_dwordx4 v2, s[4:7], s51 offen offset:2048 sc1 lds
    buffer_load_dwordx4 v2, s[4:7], s51 offen offset:3072 sc1 lds
    s_add_u32 m0, s30, 92160
    s_add_u32 s51, s35, 4096
    buffer_load_dwordx4 v1, s[4:7], s51 offen offset:0 sc1 lds
    buffer_load_dwordx4 v1, s[4:7], s51 offen offset:1024 sc1 lds
    buffer_load_dwordx4 v2, s[4:7], s51 offen offset:2048 sc1 lds
    buffer_load_dwordx4 v2, s[4:7], s51 offen offset:3072 sc1 lds
    s_waitcnt vmcnt(8)
    s_barrier
    s_add_u32 m0, s30, 129024
    s_add_u32 s51, s35, 6144
    buffer_load_dwordx4 v1, s[4:7], s51 offen offset:0 sc1 lds
    buffer_load_dwordx4 v1, s[4:7], s51 offen offset:1024 sc1 lds
    buffer_load_dwordx4 v2, s[4:7], s51 offen offset:2048 sc1 lds
    buffer_load_dwordx4 v2, s[4:7], s51 offen offset:3072 sc1 lds
    s_waitcnt vmcnt(8) lgkmcnt(0)
    s_barrier
    s_mov_b32 s48, 4
    s_mul_i32 s50, s48, 18432
    s_add_u32 s50, s50, s34
    s_add_u32 m0, s30, 0
    s_mov_b32 s53, s50
    buffer_load_dwordx4 v1, s[4:7], s50 offen offset:0  lds
    buffer_load_dwordx4 v1, s[4:7], s50 offen offset:1024  lds
    buffer_load_dwordx4 v1, s[4:7], s50 offen offset:2048  lds
    buffer_load_dwordx4 v1, s[4:7], s50 offen offset:3072  lds
    s_add_u32 m0, s30, 18432
    s_add_u32 s51, s35, 8192
    buffer_load_dwordx4 v1, s[4:7], s51 offen offset:0 sc1 lds
    buffer_load_dwordx4 v1, s[4:7], s51 offen offset:1024 sc1 lds
    buffer_load_dwordx4 v2, s[4:7], s51 offen offset:2048 sc1 lds
    buffer_load_dwordx4 v2, s[4:7], s51 offen offset:3072 sc1 lds
    s_waitcnt vmcnt(12) lgkmcnt(0)
    s_barrier
    s_mov_b32 s48, 5
    s_mul_i32 s50, s48, 18432
    s_add_u32 s50, s50, s34
    s_cmp_ge_u32 s20, 2
    s_cselect_b32 s52, s50, s53
    s_add_u32 m0, s31, 0
    s_add_u32 s52, s52, s49
    buffer_load_dwordx4 v1, s[4:7], s52 offen  lds
    s_add_u32 m0, s30, 36864
    s_mov_b32 s53, s50
    buffer_load_dwordx4 v1, s[4:7], s50 offen offset:0  lds
    buffer_load_dwordx4 v1, s[4:7], s50 offen offset:1024  lds
    buffer_load_dwordx4 v1, s[4:7], s50 offen offset:2048  lds
    buffer_load_dwordx4 v1, s[4:7], s50 offen offset:3072  lds
    s_add_u32 m0, s30, 55296
    s_add_u32 s51, s35, 10240
    buffer_load_dwordx4 v1, s[4:7], s51 offen offset:0 sc1 lds
    buffer_load_dwordx4 v1, s[4:7], s51 offen offset:1024 sc1 lds
    buffer_load_dwordx4 v2, s[4:7], s51 offen offset:2048 sc1 lds
    buffer_load_dwordx4 v2, s[4:7], s51 offen offset:3072 sc1 lds
    s_waitcnt vmcnt(17) lgkmcnt(0)
    s_barrier
    s_mov_b32 s48, 6
    s_mul_i32 s50, s48, 18432
    s_add_u32 s50, s50, s34
    s_add_u32 m0, s30, 73728
    s_mov_b32 s53, s50
    buffer_load_dwordx4 v1, s[4:7], s50 offen offset:0  lds
    buffer_load_dwordx4 v1, s[4:7], s50 offen offset:1024  lds
    buffer_load_dwordx4 v1, s[4:7], s50 offen offset:2048  lds
    buffer_load_dwordx4 v1, s[4:7], s50 offen offset:3072  lds
    s_add_u32 m0, s30, 92160
    s_add_u32 s51, s35, 12288
    buffer_load_dwordx4 v1, s[4:7], s51 offen offset:0 sc1 lds
    buffer_load_dwordx4 v1, s[4:7], s51 offen offset:1024 sc1 lds
    buffer_load_dwordx4 v2, s[4:7], s51 offen offset:2048 sc1 lds
    buffer_load_dwordx4 v2, s[4:7], s51 offen offset:3072 sc1 lds
    s_waitcnt vmcnt(16) lgkmcnt(0)
    s_barrier
    s_mov_b32 s48, 7
    s_mul_i32 s50, s48, 18432
    s_add_u32 s50, s50, s34
    s_cmp_ge_u32 s20, 2
    s_cselect_b32 s52, s50, s53
    s_add_u32 m0, s31, 73728
    s_add_u32 s52, s52, s49
    buffer_load_dwordx4 v1, s[4:7], s52 offen  lds
    s_add_u32 m0, s30, 110592
    s_mov_b32 s53, s50
    buffer_load_dwordx4 v1, s[4:7], s50 offen offset:0  lds
    buffer_load_dwordx4 v1, s[4:7], s50 offen offset:1024  lds
    buffer_load_dwordx4 v1, s[4:7], s50 offen offset:2048  lds
    buffer_load_dwordx4 v1, s[4:7], s50 offen offset:3072  lds
    s_add_u32 m0, s30, 129024
    s_add_u32 s51, s35, 14336
    buffer_load_dwordx4 v1, s[4:7], s51 offen offset:0 sc1 lds
    buffer_load_dwordx4 v1, s[4:7], s51 offen offset:1024 sc1 lds
    buffer_load_dwordx4 v2, s[4:7], s51 offen offset:2048 sc1 lds
    buffer_load_dwordx4 v2, s[4:7], s51 offen offset:3072 sc1 lds
    s_waitcnt vmcnt(17) lgkmcnt(0)
    s_barrier
    s_mov_b32 s48, 8
    s_mul_i32 s50, s48, 18432
    s_add_u32 s50, s50, s34
    s_add_u32 m0, s30, 0
    s_mov_b32 s53, s50
    buffer_load_dwordx4 v1, s[4:7], s50 offen offset:0  lds
    buffer_load_dwordx4 v1, s[4:7], s50 offen offset:1024  lds
    buffer_load_dwordx4 v1, s[4:7], s50 offen offset:2048  lds
    buffer_load_dwordx4 v1, s[4:7], s50 offen offset:3072  lds
    s_add_u32 m0, s30, 18432
    s_add_u32 s51, s35, 16384
    buffer_load_dwordx4 v1, s[4:7], s51 offen offset:0 sc1 lds
    buffer_load_dwordx4 v1, s[4:7], s51 offen offset:1024 sc1 lds
    buffer_load_dwordx4 v2, s[4:7], s51 offen offset:2048 sc1 lds
    buffer_load_dwordx4 v2, s[4:7], s51 offen offset:3072 sc1 lds
    s_waitcnt vmcnt(16) lgkmcnt(0)
    s_barrier
    s_mov_b32 s48, 5
    s_mul_i32 s50, s48, 18432
    s_add_u32 s50, s50, s34
    s_add_u32 s50, s50, 165888
    s_cmp_ge_u32 s20, 2
    s_cselect_b32 s52, s50, s53
    s_add_u32 m0, s31, 0
    s_add_u32 s52, s52, s49
    buffer_load_dwordx4 v1, s[4:7], s52 offen  lds
    s_add_u32 m0, s30, 36864
    s_mov_b32 s53, s50
    buffer_load_dwordx4 v1, s[4:7], s50 offen offset:0  lds
    buffer_load_dwordx4 v1, s[4:7], s50 offen offset:1024  lds
    buffer_load_dwordx4 v1, s[4:7], s50 offen offset:2048  lds
    buffer_load_dwordx4 v1, s[4:7], s50 offen offset:3072  lds
    s_waitcnt vmcnt(13) lgkmcnt(0)
    s_barrier
    s_mov_b32 s48, 6
    s_mul_i32 s50, s48, 18432
    s_add_u32 s50, s50, s34
    s_add_u32 s50, s50, 165888
    s_add_u32 m0, s30, 73728
    s_mov_b32 s53, s50
    buffer_load_dwordx4 v1, s[4:7], s50 offen offset:0  lds
    buffer_load_dwordx4 v1, s[4:7], s50 offen offset:1024  lds
    buffer_load_dwordx4 v1, s[4:7], s50 offen offset:2048  lds
    buffer_load_dwordx4 v1, s[4:7], s50 offen offset:3072  lds
    s_waitcnt vmcnt(8) lgkmcnt(0)
    s_barrier
    s_mov_b32 s48, 7
    s_mul_i32 s50, s48, 18432
    s_add_u32 s50, s50, s34
    s_add_u32 s50, s50, 165888
    s_cmp_ge_u32 s20, 2
    s_cselect_b32 s52, s50, s53
    s_add_u32 m0, s31, 73728
    s_add_u32 s52, s52, s49
    buffer_load_dwordx4 v1, s[4:7], s52 offen  lds
    s_add_u32 m0, s30, 110592
    s_mov_b32 s53, s50
    buffer_load_dwordx4 v1, s[4:7], s50 offen offset:0  lds
    buffer_load_dwordx4 v1, s[4:7], s50 offen offset:1024  lds
    buffer_load_dwordx4 v1, s[4:7], s50 offen offset:2048  lds
    buffer_load_dwordx4 v1, s[4:7], s50 offen offset:3072  lds
    s_waitcnt vmcnt(9) lgkmcnt(0)
    s_barrier
    s_mov_b32 s48, 8
    s_mul_i32 s50, s48, 18432
    s_add_u32 s50, s50, s34
    s_add_u32 s50, s50, 165888
    s_add_u32 m0, s30, 0
    s_mov_b32 s53, s50
    buffer_load_dwordx4 v1, s[4:7], s50 offen offset:0  lds
    buffer_load_dwordx4 v1, s[4:7], s50 offen offset:1024  lds
    buffer_load_dwordx4 v1, s[4:7], s50 offen offset:2048  lds
    buffer_load_dwordx4 v1, s[4:7], s50 offen offset:3072  lds
    s_waitcnt vmcnt(8) lgkmcnt(0)
    s_barrier
    s_mov_b32 s48, 0
    s_mul_i32 s50, s48, 18432
    s_add_u32 s50, s50, s34
    s_add_u32 s50, s50, 165888
    s_cmp_ge_u32 s20, 2
    s_cselect_b32 s52, s50, s53
    s_add_u32 m0, s31, 0
    s_add_u32 s52, s52, s49
    buffer_load_dwordx4 v1, s[4:7], s52 offen  lds
    s_add_u32 m0, s30, 36864
    s_mov_b32 s53, s50
    buffer_load_dwordx4 v1, s[4:7], s50 offen offset:0  lds
    buffer_load_dwordx4 v1, s[4:7], s50 offen offset:1024  lds
    buffer_load_dwordx4 v1, s[4:7], s50 offen offset:2048  lds
    buffer_load_dwordx4 v1, s[4:7], s50 offen offset:3072  lds
    s_add_u32 m0, s30, 55296
    s_add_u32 s51, s35, 0
    buffer_load_dwordx4 v1, s[4:7], s51 offen offset:0 sc1 lds
    buffer_load_dwordx4 v1, s[4:7], s51 offen offset:1024 sc1 lds
    buffer_load_dwordx4 v2, s[4:7], s51 offen offset:2048 sc1 lds
    buffer_load_dwordx4 v2, s[4:7], s51 offen offset:3072 sc1 lds
    s_waitcnt vmcnt(13) lgkmcnt(0)
    s_barrier
    s_mov_b32 s48, 1
    s_mul_i32 s50, s48, 18432
    s_add_u32 s50, s50, s34
    s_add_u32 s50, s50, 165888
    s_add_u32 m0, s30, 73728
    s_mov_b32 s53, s50
    buffer_load_dwordx4 v1, s[4:7], s50 offen offset:0  lds
    buffer_load_dwordx4 v1, s[4:7], s50 offen offset:1024  lds
    buffer_load_dwordx4 v1, s[4:7], s50 offen offset:2048  lds
    buffer_load_dwordx4 v1, s[4:7], s50 offen offset:3072  lds
    s_add_u32 m0, s30, 92160
    s_add_u32 s51, s35, 2048
    buffer_load_dwordx4 v1, s[4:7], s51 offen offset:0 sc1 lds
    buffer_load_dwordx4 v1, s[4:7], s51 offen offset:1024 sc1 lds
    buffer_load_dwordx4 v2, s[4:7], s51 offen offset:2048 sc1 lds
    buffer_load_dwordx4 v2, s[4:7], s51 offen offset:3072 sc1 lds
    s_waitcnt vmcnt(16) lgkmcnt(0)
    s_barrier
    s_mov_b32 s48, 2
    s_mul_i32 s50, s48, 18432
    s_add_u32 s50, s50, s34
    s_add_u32 s50, s50, 165888
    s_cmp_ge_u32 s20, 2
    s_cselect_b32 s52, s50, s53
    s_add_u32 m0, s31, 73728
    s_add_u32 s52, s52, s49
    buffer_load_dwordx4 v1, s[4:7], s52 offen  lds
    s_add_u32 m0, s30, 110592
    s_mov_b32 s53, s50
    buffer_load_dwordx4 v1, s[4:7], s50 offen offset:0  lds
    buffer_load_dwordx4 v1, s[4:7], s50 offen offset:1024  lds
    buffer_load_dwordx4 v1, s[4:7], s50 offen offset:2048  lds
    buffer_load_dwordx4 v1, s[4:7], s50 offen offset:3072  lds
    s_add_u32 m0, s30, 129024
    s_add_u32 s51, s35, 4096
    buffer_load_dwordx4 v1, s[4:7], s51 offen offset:0 sc1 lds
    buffer_load_dwordx4 v1, s[4:7], s51 offen offset:1024 sc1 lds
    buffer_load_dwordx4 v2, s[4:7], s51 offen offset:2048 sc1 lds
    buffer_load_dwordx4 v2, s[4:7], s51 offen offset:3072 sc1 lds
    s_waitcnt vmcnt(17) lgkmcnt(0)
    s_barrier
    s_mov_b32 s48, 3
    s_mul_i32 s50, s48, 18432
    s_add_u32 s50, s50, s34
    s_add_u32 s50, s50, 165888
    s_add_u32 m0, s30, 0
    s_mov_b32 s53, s50
    buffer_load_dwordx4 v1, s[4:7], s50 offen offset:0  lds
    buffer_load_dwordx4 v1, s[4:7], s50 offen offset:1024  lds
    buffer_load_dwordx4 v1, s[4:7], s50 offen offset:2048  lds
    buffer_load_dwordx4 v1, s[4:7], s50 offen offset:3072  lds
    s_add_u32 m0, s30, 18432
    s_add_u32 s51, s35, 6144
    buffer_load_dwordx4 v1, s[4:7], s51 offen offset:0 sc1 lds
    buffer_load_dwordx4 v1, s[4:7], s51 offen offset:1024 sc1 lds
    buffer_load_dwordx4 v2, s[4:7], s51 offen offset:2048 sc1 lds
    buffer_load_dwordx4 v2, s[4:7], s51 offen offset:3072 sc1 lds
    s_waitcnt vmcnt(16) lgkmcnt(0)
    s_barrier
    s_mov_b32 s48, 4
    s_mul_i32 s50, s48, 18432
    s_add_u32 s50, s50, s34
    s_add_u32 s50, s50, 165888
    s_cmp_ge_u32 s20, 2
    s_cselect_b32 s52, s50, s53
    s_add_u32 m0, s31, 0
    s_add_u32 s52, s52, s49
    buffer_load_dwordx4 v1, s[4:7], s52 offen  lds
    s_add_u32 m0, s30, 36864
    s_mov_b32 s53, s50
    buffer_load_dwordx4 v1, s[4:7], s50 offen offset:0  lds
    buffer_load_dwordx4 v1, s[4:7], s50 offen offset:1024  lds
    buffer_load_dwordx4 v1, s[4:7], s50 offen offset:2048  lds
    buffer_load_dwordx4 v1, s[4:7], s50 offen offset:3072  lds
    s_add_u32 m0, s30, 55296
    s_add_u32 s51, s35, 8192
    buffer_load_dwordx4 v1, s[4:7], s51 offen offset:0 sc1 lds
    buffer_load_dwordx4 v1, s[4:7], s51 offen offset:1024 sc1 lds
    buffer_load_dwordx4 v2, s[4:7], s51 offen offset:2048 sc1 lds
    buffer_load_dwordx4 v2, s[4:7], s51 offen offset:3072 sc1 lds
    s_waitcnt vmcnt(17) lgkmcnt(0)
    s_barrier
    s_waitcnt vmcnt(8) lgkmcnt(0)
    s_barrier
    s_waitcnt vmcnt(0) lgkmcnt(0)
    s_barrier
    s_barrier
    s_mov_b32 s56, 1
    s_atomic_add s56, s[54:55], 0
    s_add_u32 m0, s30, 92160
    s_lshl_b32 s51, s44, 7
    buffer_load_dwordx4 v8, s[8:11], s51 offen offset:0  lds
    buffer_load_dwordx4 v9, s[8:11], s51 offen offset:1024  lds
    buffer_load_dwordx4 v10, s[8:11], s51 offen offset:2048  lds
    buffer_load_dwordx4 v11, s[8:11], s51 offen offset:3072  lds
    s_add_u32 m0, s30, 129024
    s_lshl_b32 s51, s45, 7
    buffer_load_dwordx4 v8, s[8:11], s51 offen offset:0  lds
    buffer_load_dwordx4 v9, s[8:11], s51 offen offset:1024  lds
    buffer_load_dwordx4 v10, s[8:11], s51 offen offset:2048  lds
    buffer_load_dwordx4 v11, s[8:11], s51 offen offset:3072  lds
    s_add_u32 m0, s30, 18432
    s_lshl_b32 s51, s46, 7
    buffer_load_dwordx4 v8, s[8:11], s51 offen offset:0  lds
    buffer_load_dwordx4 v9, s[8:11], s51 offen offset:1024  lds
    buffer_load_dwordx4 v10, s[8:11], s51 offen offset:2048  lds
    buffer_load_dwordx4 v11, s[8:11], s51 offen offset:3072  lds
    s_and_b32 s40, s2, 7
    s_lshr_b32 s26, s2, 3
    s_lshl_b32 s38, s40, 2
    s_lshr_b32 s27, s26, 3
    s_add_u32 s38, s38, s27
    s_and_b32 s39, s26, 7
    s_add_u32 s40, s38, s39
    s_and_b32 s40, s40, 3
    s_mul_i32 s42, s20, 9216
    s_mul_i32 s43, s39, 331776
    s_add_u32 s43, s43, s42
    s_add_u32 s43, s43, 0x4100000
    v_add_u32 v12, s42, v1
    v_add_u32 v13, 36864, v12
    v_add_u32 v14, 73728, v12
    v_add_u32 v15, 110592, v12
    s_mov_b32 s60, 65536
L_poll_z2:
    s_mov_b32 s57, 0
    s_atomic_add s57, s[54:55], 0 glc
    s_waitcnt lgkmcnt(0)
    s_cmp_ge_u32 s57, 16
    s_cbranch_scc1 L_pd_z2
    s_sub_u32 s60, s60, 1
    s_cbranch_scc1 L_pd_z2
    s_sleep 2
    s_branch L_poll_z2
L_pd_z2:
    s_mul_i32 s50, s44, 18432
    s_add_u32 s50, s50, s36
    s_add_u32 m0, s30, 73728
    s_mov_b32 s53, s50
    buffer_load_dwordx4 v1, s[4:7], s50 offen offset:0 sc1 lds
    buffer_load_dwordx4 v1, s[4:7], s50 offen offset:1024 sc1 lds
    buffer_load_dwordx4 v1, s[4:7], s50 offen offset:2048 sc1 lds
    buffer_load_dwordx4 v1, s[4:7], s50 offen offset:3072 sc1 lds
    s_add_u32 s44, s44, 4
    s_and_b32 s44, s44, 31
    s_mul_i32 s50, s45, 18432
    s_add_u32 s50, s50, s36
    s_cmp_ge_u32 s20, 2
    s_cselect_b32 s52, s50, s53
    s_add_u32 m0, s31, 73728
    s_add_u32 s52, s52, s49
    buffer_load_dwordx4 v1, s[4:7], s52 offen sc1 lds
    s_add_u32 m0, s30, 110592
    s_mov_b32 s53, s50
    buffer_load_dwordx4 v1, s[4:7], s50 offen offset:0 sc1 lds
    buffer_load_dwordx4 v1, s[4:7], s50 offen offset:1024 sc1 lds
    buffer_load_dwordx4 v1, s[4:7], s50 offen offset:2048 sc1 lds
    buffer_load_dwordx4 v1, s[4:7], s50 offen offset:3072 sc1 lds
    s_add_u32 s45, s45, 4
    s_and_b32 s45, s45, 31
    s_mul_i32 s50, s46, 18432
    s_add_u32 s50, s50, s36
    s_add_u32 m0, s30, 0
    s_mov_b32 s53, s50
    buffer_load_dwordx4 v1, s[4:7], s50 offen offset:0 sc1 lds
    buffer_load_dwordx4 v1, s[4:7], s50 offen offset:1024 sc1 lds
    buffer_load_dwordx4 v1, s[4:7], s50 offen offset:2048 sc1 lds
    buffer_load_dwordx4 v1, s[4:7], s50 offen offset:3072 sc1 lds
    s_add_u32 s46, s46, 4
    s_and_b32 s46, s46, 31
    s_waitcnt vmcnt(8)
    s_barrier
    s_mul_i32 s50, s47, 18432
    s_add_u32 s50, s50, s36
    s_cmp_ge_u32 s20, 2
    s_cselect_b32 s52, s50, s53
    s_add_u32 m0, s31, 0
    s_add_u32 s52, s52, s49
    buffer_load_dwordx4 v1, s[4:7], s52 offen sc1 lds
    s_add_u32 m0, s30, 36864
    s_mov_b32 s53, s50
    buffer_load_dwordx4 v1, s[4:7], s50 offen offset:0 sc1 lds
    buffer_load_dwordx4 v1, s[4:7], s50 offen offset:1024 sc1 lds
    buffer_load_dwordx4 v1, s[4:7], s50 offen offset:2048 sc1 lds
    buffer_load_dwordx4 v1, s[4:7], s50 offen offset:3072 sc1 lds
    s_add_u32 m0, s30, 55296
    s_lshl_b32 s51, s47, 7
    buffer_load_dwordx4 v8, s[8:11], s51 offen offset:0  lds
    buffer_load_dwordx4 v9, s[8:11], s51 offen offset:1024  lds
    buffer_load_dwordx4 v10, s[8:11], s51 offen offset:2048  lds
    buffer_load_dwordx4 v11, s[8:11], s51 offen offset:3072  lds
    s_add_u32 s47, s47, 4
    s_and_b32 s47, s47, 31
    s_waitcnt vmcnt(13)
    s_barrier
    s_mul_i32 s50, s44, 18432
    s_add_u32 s50, s50, s36
    s_add_u32 m0, s30, 73728
    s_mov_b32 s53, s50
    buffer_load_dwordx4 v1, s[4:7], s50 offen offset:0 sc1 lds
    buffer_load_dwordx4 v1, s[4:7], s50 offen offset:1024 sc1 lds
    buffer_load_dwordx4 v1, s[4:7], s50 offen offset:2048 sc1 lds
    buffer_load_dwordx4 v1, s[4:7], s50 offen offset:3072 sc1 lds
    s_add_u32 m0, s30, 92160
    s_lshl_b32 s51, s44, 7
    buffer_load_dwordx4 v8, s[8:11], s51 offen offset:0  lds
    buffer_load_dwordx4 v9, s[8:11], s51 offen offset:1024  lds
    buffer_load_dwordx4 v10, s[8:11], s51 offen offset:2048  lds
    buffer_load_dwordx4 v11, s[8:11], s51 offen offset:3072  lds
    s_add_u32 s44, s44, 4
    s_and_b32 s44, s44, 31
    s_waitcnt vmcnt(16)
    s_barrier
    s_mul_i32 s50, s45, 18432
    s_add_u32 s50, s50, s36
    s_cmp_ge_u32 s20, 2
    s_cselect_b32 s52, s50, s53
    s_add_u32 m0, s31, 73728
    s_add_u32 s52, s52, s49
    buffer_load_dwordx4 v1, s[4:7], s52 offen sc1 lds
    s_add_u32 m0, s30, 110592
    s_mov_b32 s53, s50
    buffer_load_dwordx4 v1, s[4:7], s50 offen offset:0 sc1 lds
    buffer_load_dwordx4 v1, s[4:7], s50 offen offset:1024 sc1 lds
    buffer_load_dwordx4 v1, s[4:7], s50 offen offset:2048 sc1 lds
    buffer_load_dwordx4 v1, s[4:7], s50 offen offset:3072 sc1 lds
    s_add_u32 m0, s30, 129024
    s_lshl_b32 s51, s45, 7
    buffer_load_dwordx4 v8, s[8:11], s51 offen offset:0  lds
    buffer_load_dwordx4 v9, s[8:11], s51 offen offset:1024  lds
    buffer_load_dwordx4 v10, s[8:11], s51 offen offset:2048  lds
    buffer_load_dwordx4 v11, s[8:11], s51 offen offset:3072  lds
    s_add_u32 s45, s45, 4
    s_and_b32 s45, s45, 31
    s_waitcnt vmcnt(17)
    s_barrier
    s_mul_i32 s50, s46, 18432
    s_add_u32 s50, s50, s36
    s_add_u32 m0, s30, 0
    s_mov_b32 s53, s50
    buffer_load_dwordx4 v1, s[4:7], s50 offen offset:0 sc1 lds
    buffer_load_dwordx4 v1, s[4:7], s50 offen offset:1024 sc1 lds
    buffer_load_dwordx4 v1, s[4:7], s50 offen offset:2048 sc1 lds
    buffer_load_dwordx4 v1, s[4:7], s50 offen offset:3072 sc1 lds
    s_add_u32 m0, s30, 18432
    s_lshl_b32 s51, s46, 7
    buffer_load_dwordx4 v8, s[8:11], s51 offen offset:0  lds
    buffer_load_dwordx4 v9, s[8:11], s51 offen offset:1024  lds
    buffer_load_dwordx4 v10, s[8:11], s51 offen offset:2048  lds
    buffer_load_dwordx4 v11, s[8:11], s51 offen offset:3072  lds
    s_add_u32 s46, s46, 4
    s_and_b32 s46, s46, 31
    s_waitcnt vmcnt(16)
    s_barrier
    s_mul_i32 s50, s47, 18432
    s_add_u32 s50, s50, s36
    s_cmp_ge_u32 s20, 2
    s_cselect_b32 s52, s50, s53
    s_add_u32 m0, s31, 0
    s_add_u32 s52, s52, s49
    buffer_load_dwordx4 v1, s[4:7], s52 offen sc1 lds
    s_add_u32 m0, s30, 36864
    s_mov_b32 s53, s50
    buffer_load_dwordx4 v1, s[4:7], s50 offen offset:0 sc1 lds
    buffer_load_dwordx4 v1, s[4:7], s50 offen offset:1024 sc1 lds
    buffer_load_dwordx4 v1, s[4:7], s50 offen offset:2048 sc1 lds
    buffer_load_dwordx4 v1, s[4:7], s50 offen offset:3072 sc1 lds
    s_add_u32 m0, s30, 55296
    s_lshl_b32 s51, s47, 7
    buffer_load_dwordx4 v8, s[8:11], s51 offen offset:0  lds
    buffer_load_dwordx4 v9, s[8:11], s51 offen offset:1024  lds
    buffer_load_dwordx4 v10, s[8:11], s51 offen offset:2048  lds
    buffer_load_dwordx4 v11, s[8:11], s51 offen offset:3072  lds
    s_add_u32 s47, s47, 4
    s_and_b32 s47, s47, 31
    s_mov_b32 s41, 6
L_g_ll:
    s_waitcnt vmcnt(17)
    s_barrier
    s_mul_i32 s50, s44, 18432
    s_add_u32 s50, s50, s36
    s_add_u32 m0, s30, 73728
    s_mov_b32 s53, s50
    buffer_load_dwordx4 v1, s[4:7], s50 offen offset:0 sc1 lds
    buffer_load_dwordx4 v1, s[4:7], s50 offen offset:1024 sc1 lds
    buffer_load_dwordx4 v1, s[4:7], s50 offen offset:2048 sc1 lds
    buffer_load_dwordx4 v1, s[4:7], s50 offen offset:3072 sc1 lds
    s_add_u32 m0, s30, 92160
    s_lshl_b32 s51, s44, 7
    buffer_load_dwordx4 v8, s[8:11], s51 offen offset:0  lds
    buffer_load_dwordx4 v9, s[8:11], s51 offen offset:1024  lds
    buffer_load_dwordx4 v10, s[8:11], s51 offen offset:2048  lds
    buffer_load_dwordx4 v11, s[8:11], s51 offen offset:3072  lds
    s_add_u32 s44, s44, 4
    s_and_b32 s44, s44, 31
    s_waitcnt vmcnt(16)
    s_barrier
    s_mul_i32 s50, s45, 18432
    s_add_u32 s50, s50, s36
    s_cmp_ge_u32 s20, 2
    s_cselect_b32 s52, s50, s53
    s_add_u32 m0, s31, 73728
    s_add_u32 s52, s52, s49
    buffer_load_dwordx4 v1, s[4:7], s52 offen sc1 lds
    s_add_u32 m0, s30, 110592
    s_mov_b32 s53, s50
    buffer_load_dwordx4 v1, s[4:7], s50 offen offset:0 sc1 lds
    buffer_load_dwordx4 v1, s[4:7], s50 offen offset:1024 sc1 lds
    buffer_load_dwordx4 v1, s[4:7], s50 offen offset:2048 sc1 lds
    buffer_load_dwordx4 v1, s[4:7], s50 offen offset:3072 sc1 lds
    s_add_u32 m0, s30, 129024
    s_lshl_b32 s51, s45, 7
    buffer_load_dwordx4 v8, s[8:11], s51 offen offset:0  lds
    buffer_load_dwordx4 v9, s[8:11], s51 offen offset:1024  lds
    buffer_load_dwordx4 v10, s[8:11], s51 offen offset:2048  lds
    buffer_load_dwordx4 v11, s[8:11], s51 offen offset:3072  lds
    s_add_u32 s45, s45, 4
    s_and_b32 s45, s45, 31
    s_waitcnt vmcnt(17)
    s_barrier
    s_mul_i32 s50, s46, 18432
    s_add_u32 s50, s50, s36
    s_add_u32 m0, s30, 0
    s_mov_b32 s53, s50
    buffer_load_dwordx4 v1, s[4:7], s50 offen offset:0 sc1 lds
    buffer_load_dwordx4 v1, s[4:7], s50 offen offset:1024 sc1 lds
    buffer_load_dwordx4 v1, s[4:7], s50 offen offset:2048 sc1 lds
    buffer_load_dwordx4 v1, s[4:7], s50 offen offset:3072 sc1 lds
    s_add_u32 m0, s30, 18432
    s_lshl_b32 s51, s46, 7
    buffer_load_dwordx4 v8, s[8:11], s51 offen offset:0  lds
    buffer_load_dwordx4 v9, s[8:11], s51 offen offset:1024  lds
    buffer_load_dwordx4 v10, s[8:11], s51 offen offset:2048  lds
    buffer_load_dwordx4 v11, s[8:11], s51 offen offset:3072  lds
    s_add_u32 s46, s46, 4
    s_and_b32 s46, s46, 31
    s_waitcnt vmcnt(16)
    s_barrier
    s_mul_i32 s50, s47, 18432
    s_add_u32 s50, s50, s36
    s_cmp_ge_u32 s20, 2
    s_cselect_b32 s52, s50, s53
    s_add_u32 m0, s31, 0
    s_add_u32 s52, s52, s49
    buffer_load_dwordx4 v1, s[4:7], s52 offen sc1 lds
    s_add_u32 m0, s30, 36864
    s_mov_b32 s53, s50
    buffer_load_dwordx4 v1, s[4:7], s50 offen offset:0 sc1 lds
    buffer_load_dwordx4 v1, s[4:7], s50 offen offset:1024 sc1 lds
    buffer_load_dwordx4 v1, s[4:7], s50 offen offset:2048 sc1 lds
    buffer_load_dwordx4 v1, s[4:7], s50 offen offset:3072 sc1 lds
    s_add_u32 m0, s30, 55296
    s_lshl_b32 s51, s47, 7
    buffer_load_dwordx4 v8, s[8:11], s51 offen offset:0  lds
    buffer_load_dwordx4 v9, s[8:11], s51 offen offset:1024  lds
    buffer_load_dwordx4 v10, s[8:11], s51 offen offset:2048  lds
    buffer_load_dwordx4 v11, s[8:11], s51 offen offset:3072  lds
    s_add_u32 s47, s47, 4
    s_and_b32 s47, s47, 31
    s_sub_u32 s41, s41, 1
    s_cmp_lg_u32 s41, 0
    s_cbranch_scc1 L_g_ll
    s_waitcnt vmcnt(17)
    s_barrier
    s_mov_b32 s32, 0
    s_mul_i32 s32, s32, 36864
    s_add_u32 s32, s32, s43
    s_add_u32 m0, s42, 73728
    s_add_u32 s33, s32, 0
    buffer_load_dwordx4 v1, s[4:7], s33 offen offset:0  lds
    buffer_load_dwordx4 v1, s[4:7], s33 offen offset:1024  lds
    buffer_load_dwordx4 v1, s[4:7], s33 offen offset:2048  lds
    buffer_load_dwordx4 v1, s[4:7], s33 offen offset:3072  lds
    s_add_u32 m0, s42, 77824
    s_add_u32 s33, s32, 4096
    buffer_load_dwordx4 v1, s[4:7], s33 offen offset:0  lds
    buffer_load_dwordx4 v1, s[4:7], s33 offen offset:1024  lds
    buffer_load_dwordx4 v1, s[4:7], s33 offen offset:2048  lds
    buffer_load_dwordx4 v1, s[4:7], s33 offen offset:3072  lds
    s_add_u32 m0, s42, 81920
    s_add_u32 s33, s32, 8192
    buffer_load_dwordx4 v1, s[4:7], s33 offen offset:0  lds
    s_waitcnt vmcnt(17)
    s_barrier
    s_mov_b32 s32, 1
    s_mul_i32 s32, s32, 36864
    s_add_u32 s32, s32, s43
    s_add_u32 m0, s42, 110592
    s_add_u32 s33, s32, 0
    buffer_load_dwordx4 v1, s[4:7], s33 offen offset:0  lds
    buffer_load_dwordx4 v1, s[4:7], s33 offen offset:1024  lds
    buffer_load_dwordx4 v1, s[4:7], s33 offen offset:2048  lds
    buffer_load_dwordx4 v1, s[4:7], s33 offen offset:3072  lds
    s_add_u32 m0, s42, 114688
    s_add_u32 s33, s32, 4096
    buffer_load_dwordx4 v1, s[4:7], s33 offen offset:0  lds
    buffer_load_dwordx4 v1, s[4:7], s33 offen offset:1024  lds
    buffer_load_dwordx4 v1, s[4:7], s33 offen offset:2048  lds
    buffer_load_dwordx4 v1, s[4:7], s33 offen offset:3072  lds
    s_add_u32 m0, s42, 118784
    s_add_u32 s33, s32, 8192
    buffer_load_dwordx4 v1, s[4:7], s33 offen offset:0  lds
    s_waitcnt vmcnt(18)
    s_barrier
    s_mov_b32 s32, 2
    s_mul_i32 s32, s32, 36864
    s_add_u32 s32, s32, s43
    s_add_u32 m0, s42, 0
    s_add_u32 s33, s32, 0
    buffer_load_dwordx4 v1, s[4:7], s33 offen offset:0  lds
    buffer_load_dwordx4 v1, s[4:7], s33 offen offset:1024  lds
    buffer_load_dwordx4 v1, s[4:7], s33 offen offset:2048  lds
    buffer_load_dwordx4 v1, s[4:7], s33 offen offset:3072  lds
    s_add_u32 m0, s42, 4096
    s_add_u32 s33, s32, 4096
    buffer_load_dwordx4 v1, s[4:7], s33 offen offset:0  lds
    buffer_load_dwordx4 v1, s[4:7], s33 offen offset:1024  lds
    buffer_load_dwordx4 v1, s[4:7], s33 offen offset:2048  lds
    buffer_load_dwordx4 v1, s[4:7], s33 offen offset:3072  lds
    s_add_u32 m0, s42, 8192
    s_add_u32 s33, s32, 8192
    buffer_load_dwordx4 v1, s[4:7], s33 offen offset:0  lds
    s_barrier
    s_mov_b32 s32, 3
    s_mul_i32 s32, s32, 36864
    s_add_u32 s32, s32, s43
    s_add_u32 m0, s42, 36864
    s_add_u32 s33, s32, 0
    buffer_load_dwordx4 v1, s[4:7], s33 offen offset:0  lds
    buffer_load_dwordx4 v1, s[4:7], s33 offen offset:1024  lds
    buffer_load_dwordx4 v1, s[4:7], s33 offen offset:2048  lds
    buffer_load_dwordx4 v1, s[4:7], s33 offen offset:3072  lds
    s_add_u32 m0, s42, 40960
    s_add_u32 s33, s32, 4096
    buffer_load_dwordx4 v1, s[4:7], s33 offen offset:0  lds
    buffer_load_dwordx4 v1, s[4:7], s33 offen offset:1024  lds
    buffer_load_dwordx4 v1, s[4:7], s33 offen offset:2048  lds
    buffer_load_dwordx4 v1, s[4:7], s33 offen offset:3072  lds
    s_add_u32 m0, s42, 45056
    s_add_u32 s33, s32, 8192
    buffer_load_dwordx4 v1, s[4:7], s33 offen offset:0  lds
    s_waitcnt vmcnt(27)
    s_barrier
    s_waitcnt vmcnt(18) lgkmcnt(0)
    s_barrier
    s_mov_b32 s32, 4
    s_mul_i32 s32, s32, 36864
    s_add_u32 s32, s32, s43
    s_add_u32 m0, s42, 73728
    s_add_u32 s33, s32, 0
    buffer_load_dwordx4 v1, s[4:7], s33 offen offset:0  lds
    buffer_load_dwordx4 v1, s[4:7], s33 offen offset:1024  lds
    buffer_load_dwordx4 v1, s[4:7], s33 offen offset:2048  lds
    buffer_load_dwordx4 v1, s[4:7], s33 offen offset:3072  lds
    s_add_u32 m0, s42, 77824
    s_add_u32 s33, s32, 4096
    buffer_load_dwordx4 v1, s[4:7], s33 offen offset:0  lds
    buffer_load_dwordx4 v1, s[4:7], s33 offen offset:1024  lds
    buffer_load_dwordx4 v1, s[4:7], s33 offen offset:2048  lds
    buffer_load_dwordx4 v1, s[4:7], s33 offen offset:3072  lds
    s_add_u32 m0, s42, 81920
    s_add_u32 s33, s32, 8192
    buffer_load_dwordx4 v1, s[4:7], s33 offen offset:0  lds
    s_waitcnt vmcnt(18) lgkmcnt(0)
    s_barrier
    s_mov_b32 s32, 5
    s_mul_i32 s32, s32, 36864
    s_add_u32 s32, s32, s43
    s_add_u32 m0, s42, 110592
    s_add_u32 s33, s32, 0
    buffer_load_dwordx4 v1, s[4:7], s33 offen offset:0  lds
    buffer_load_dwordx4 v1, s[4:7], s33 offen offset:1024  lds
    buffer_load_dwordx4 v1, s[4:7], s33 offen offset:2048  lds
    buffer_load_dwordx4 v1, s[4:7], s33 offen offset:3072  lds
    s_add_u32 m0, s42, 114688
    s_add_u32 s33, s32, 4096
    buffer_load_dwordx4 v1, s[4:7], s33 offen offset:0  lds
    buffer_load_dwordx4 v1, s[4:7], s33 offen offset:1024  lds
    buffer_load_dwordx4 v1, s[4:7], s33 offen offset:2048  lds
    buffer_load_dwordx4 v1, s[4:7], s33 offen offset:3072  lds
    s_add_u32 m0, s42, 118784
    s_add_u32 s33, s32, 8192
    buffer_load_dwordx4 v1, s[4:7], s33 offen offset:0  lds
    s_waitcnt vmcnt(18) lgkmcnt(0)
    s_barrier
    s_mov_b32 s32, 6
    s_mul_i32 s32, s32, 36864
    s_add_u32 s32, s32, s43
    s_add_u32 m0, s42, 0
    s_add_u32 s33, s32, 0
    buffer_load_dwordx4 v1, s[4:7], s33 offen offset:0  lds
    buffer_load_dwordx4 v1, s[4:7], s33 offen offset:1024  lds
    buffer_load_dwordx4 v1, s[4:7], s33 offen offset:2048  lds
    buffer_load_dwordx4 v1, s[4:7], s33 offen offset:3072  lds
    s_add_u32 m0, s42, 4096
    s_add_u32 s33, s32, 4096
    buffer_load_dwordx4 v1, s[4:7], s33 offen offset:0  lds
    buffer_load_dwordx4 v1, s[4:7], s33 offen offset:1024  lds
    buffer_load_dwordx4 v1, s[4:7], s33 offen offset:2048  lds
    buffer_load_dwordx4 v1, s[4:7], s33 offen offset:3072  lds
    s_add_u32 m0, s42, 8192
    s_add_u32 s33, s32, 8192
    buffer_load_dwordx4 v1, s[4:7], s33 offen offset:0  lds
    s_waitcnt vmcnt(18) lgkmcnt(0)
    s_barrier
    s_mov_b32 s32, 7
    s_mul_i32 s32, s32, 36864
    s_add_u32 s32, s32, s43
    s_add_u32 m0, s42, 36864
    s_add_u32 s33, s32, 0
    buffer_load_dwordx4 v1, s[4:7], s33 offen offset:0  lds
    buffer_load_dwordx4 v1, s[4:7], s33 offen offset:1024  lds
    buffer_load_dwordx4 v1, s[4:7], s33 offen offset:2048  lds
    buffer_load_dwordx4 v1, s[4:7], s33 offen offset:3072  lds
    s_add_u32 m0, s42, 40960
    s_add_u32 s33, s32, 4096
    buffer_load_dwordx4 v1, s[4:7], s33 offen offset:0  lds
    buffer_load_dwordx4 v1, s[4:7], s33 offen offset:1024  lds
    buffer_load_dwordx4 v1, s[4:7], s33 offen offset:2048  lds
    buffer_load_dwordx4 v1, s[4:7], s33 offen offset:3072  lds
    s_add_u32 m0, s42, 45056
    s_add_u32 s33, s32, 8192
    buffer_load_dwordx4 v1, s[4:7], s33 offen offset:0  lds
    s_waitcnt vmcnt(18) lgkmcnt(0)
    s_barrier
    s_mov_b32 s32, 8
    s_mul_i32 s32, s32, 36864
    s_add_u32 s32, s32, s43
    s_add_u32 m0, s42, 73728
    s_add_u32 s33, s32, 0
    buffer_load_dwordx4 v1, s[4:7], s33 offen offset:0  lds
    buffer_load_dwordx4 v1, s[4:7], s33 offen offset:1024  lds
    buffer_load_dwordx4 v1, s[4:7], s33 offen offset:2048  lds
    buffer_load_dwordx4 v1, s[4:7], s33 offen offset:3072  lds
    s_add_u32 m0, s42, 77824
    s_add_u32 s33, s32, 4096
    buffer_load_dwordx4 v1, s[4:7], s33 offen offset:0  lds
    buffer_load_dwordx4 v1, s[4:7], s33 offen offset:1024  lds
    buffer_load_dwordx4 v1, s[4:7], s33 offen offset:2048  lds
    buffer_load_dwordx4 v1, s[4:7], s33 offen offset:3072  lds
    s_add_u32 m0, s42, 81920
    s_add_u32 s33, s32, 8192
    buffer_load_dwordx4 v1, s[4:7], s33 offen offset:0  lds
    s_waitcnt vmcnt(18) lgkmcnt(0)
    s_barrier
    s_cmp_eq_u32 s22, 1
    s_cbranch_scc1 L_m_lfin
    s_and_b32 s25, s2, 7
    s_lshr_b32 s26, s2, 3
    s_lshr_b32 s23, s25, 1
    s_lshl_b32 s23, s23, 2
    s_lshr_b32 s27, s26, 3
    s_add_u32 s23, s23, s27
    s_and_b32 s24, s25, 1
    s_lshl_b32 s24, s24, 3
    s_and_b32 s27, s26, 7
    s_add_u32 s24, s24, s27
    s_mul_i32 s29, s24, 129024
    s_lshl_b32 s30, s20, 12
    s_add_u32 s29, s29, s30
    s_add_u32 s29, s29, 0x3800000
    s_lshl_b32 s31, s23, 3
    s_max_u32 s31, s31, 1
    s_sub_u32 s31, s31, 1
    s_mul_i32 s31, s31, 18432
    s_add_u32 s31, s31, 0x1c00000
    s_lshl_b32 s35, s20, 10
    s_and_b32 s36, s35, 1024
    v_and_b32 v70, 48, v1
    v_lshrrev_b32 v71, 8, v1
    v_lshl_add_u32 v70, v71, 6, v70
    v_bfe_u32 v71, v1, 6, 2
    v_lshl_add_u32 v70, v71, 8, v70
    s_waitcnt vmcnt(9) lgkmcnt(0)
    s_barrier
    s_add_u32 m0, s30, 0
    s_add_u32 s34, s29, 0
    buffer_load_dwordx4 v70, s[4:7], s34 offen offset:0 lds
    buffer_load_dwordx4 v70, s[4:7], s34 offen offset:1024 lds
    buffer_load_dwordx4 v70, s[4:7], s34 offen offset:2048 lds
    buffer_load_dwordx4 v70, s[4:7], s34 offen offset:3072 lds
    s_add_u32 m0, s30, 16384
    s_add_u32 s34, s29, 16384
    buffer_load_dwordx4 v70, s[4:7], s34 offen offset:0 lds
    buffer_load_dwordx4 v70, s[4:7], s34 offen offset:1024 lds
    buffer_load_dwordx4 v70, s[4:7], s34 offen offset:2048 lds
    buffer_load_dwordx4 v70, s[4:7], s34 offen offset:3072 lds
    s_add_u32 m0, s30, 114688
    s_add_u32 s34, s29, 114688
    buffer_load_dwordx4 v70, s[4:7], s34 offen offset:0 lds
    buffer_load_dwordx4 v70, s[4:7], s34 offen offset:1024 lds
    buffer_load_dwordx4 v70, s[4:7], s34 offen offset:2048 lds
    buffer_load_dwordx4 v70, s[4:7], s34 offen offset:3072 lds
    s_waitcnt vmcnt(12) lgkmcnt(0)
    s_barrier
    s_add_u32 m0, s30, 32768
    s_add_u32 s34, s29, 32768
    buffer_load_dwordx4 v70, s[4:7], s34 offen offset:0 lds
    buffer_load_dwordx4 v70, s[4:7], s34 offen offset:1024 lds
    buffer_load_dwordx4 v70, s[4:7], s34 offen offset:2048 lds
    buffer_load_dwordx4 v70, s[4:7], s34 offen offset:3072 lds
    s_add_u32 m0, s30, 49152
    s_add_u32 s34, s29, 49152
    buffer_load_dwordx4 v70, s[4:7], s34 offen offset:0 lds
    buffer_load_dwordx4 v70, s[4:7], s34 offen offset:1024 lds
    buffer_load_dwordx4 v70, s[4:7], s34 offen offset:2048 lds
    buffer_load_dwordx4 v70, s[4:7], s34 offen offset:3072 lds
    s_mov_b32 s22, 1
    s_mov_b32 s21, 0x1c00000
    s_barrier
    s_barrier
    v_lshrrev_b32 v60, 8, v1
    v_bfe_u32 v61, v1, 7, 1
    v_bfe_u32 v62, v1, 4, 3
    v_cmp_gt_u32 vcc, 3, v60
    v_mul_u32_u24 v61, 80, v61
    v_lshl_add_u32 v61, v62, 3, v61
    v_lshrrev_b32 v63, 1, v62
    v_and_b32 v62, 1, v62
    v_lshl_add_u32 v62, v62, 3, 64
    v_cndmask_b32 v60, v63, v60, vcc
    v_cndmask_b32 v61, v62, v61, vcc
    v_mul_u32_u24 v60, 2304, v60
    v_add_u32 v69, v60, v61
    v_lshrrev_b32 v68, 1, v1
    s_mul_i32 s34, s24, 144
    s_add_u32 s34, s34, 0x4400000
    buffer_load_dwordx2 v[60:61], v69, s[4:7], s34 offen
    s_mul_i32 s34, s24, 144
    s_add_u32 s34, s34, 0x4402000
    buffer_load_dwordx2 v[62:63], v69, s[4:7], s34 offen
    s_mul_i32 s34, s24, 144
    s_add_u32 s34, s34, 0x4404000
    buffer_load_dwordx2 v[64:65], v69, s[4:7], s34 offen
    s_mul_i32 s34, s24, 144
    s_add_u32 s34, s34, 0x4406000
    buffer_load_dwordx2 v[66:67], v69, s[4:7], s34 offen
    s_add_u32 m0, s30, 65536
    s_add_u32 s34, s29, 65536
    buffer_load_dwordx4 v70, s[4:7], s34 offen offset:0 lds
    buffer_load_dwordx4 v70, s[4:7], s34 offen offset:1024 lds
    buffer_load_dwordx4 v70, s[4:7], s34 offen offset:2048 lds
    buffer_load_dwordx4 v70, s[4:7], s34 offen offset:3072 lds
    s_add_u32 m0, s30, 81920
    s_add_u32 s34, s29, 81920
    buffer_load_dwordx4 v70, s[4:7], s34 offen offset:0 lds
    buffer_load_dwordx4 v70, s[4:7], s34 offen offset:1024 lds
    buffer_load_dwordx4 v70, s[4:7], s34 offen offset:2048 lds
    buffer_load_dwordx4 v70, s[4:7], s34 offen offset:3072 lds
    s_add_u32 m0, s30, 98304
    s_add_u32 s34, s29, 98304
    buffer_load_dwordx4 v70, s[4:7], s34 offen offset:0 lds
    buffer_load_dwordx4 v70, s[4:7], s34 offen offset:1024 lds
    buffer_load_dwordx4 v70, s[4:7], s34 offen offset:2048 lds
    buffer_load_dwordx4 v70, s[4:7], s34 offen offset:3072 lds
    s_barrier
    s_add_u32 m0, s35, 131072
    s_add_u32 s34, s31, s35
    s_add_u32 s34, s34, 0
    buffer_load_dwordx4 v1, s[4:7], s34 offen sc1 lds
    s_waitcnt vmcnt(33) lgkmcnt(0)
    s_barrier
    s_add_u32 m0, s35, 135168
    s_add_u32 s34, s31, s35
    s_add_u32 s34, s34, 4096
    buffer_load_dwordx4 v1, s[4:7], s34 offen sc1 lds
    s_add_u32 m0, s35, 139264
    s_add_u32 s34, s31, s35
    s_add_u32 s34, s34, 8192
    buffer_load_dwordx4 v1, s[4:7], s34 offen sc1 lds
    s_add_u32 m0, s35, 143360
    s_add_u32 s34, s31, s35
    s_add_u32 s34, s34, 12288
    buffer_load_dwordx4 v1, s[4:7], s34 offen sc1 lds
    s_add_u32 m0, s36, 147456
    s_add_u32 s34, s31, s36
    s_add_u32 s34, s34, 16384
    buffer_load_dwordx4 v1, s[4:7], s34 offen sc1 lds
    s_waitcnt vmcnt(4) lgkmcnt(0)
    s_barrier
    s_waitcnt vmcnt(4) lgkmcnt(0)
    s_barrier
    s_waitcnt vmcnt(3) lgkmcnt(0)
    s_barrier
    v_add_f32 v60, v60, v62
    v_add_f32 v61, v61, v63
    v_add_f32 v64, v64, v66
    v_add_f32 v65, v65, v67
    v_add_f32 v60, v60, v64
    v_add_f32 v61, v61, v65
    v_cmp_gt_u32 vcc, 864, v1
    v_add_u32 v68, 161792, v68
    s_nop 0
    v_cndmask_b32 v60, 0, v60, vcc
    v_cndmask_b32 v61, 0, v61, vcc
    ds_write_b64 v68, v[60:61]
    s_waitcnt vmcnt(2) lgkmcnt(0)
    s_barrier
    s_waitcnt vmcnt(2) lgkmcnt(0)
    s_barrier
    s_waitcnt vmcnt(1) lgkmcnt(0)
    s_barrier
    s_waitcnt vmcnt(0) lgkmcnt(0)
    s_barrier
    s_barrier
    s_branch L_m_ll
L_m_lfin:
    s_waitcnt vmcnt(0) lgkmcnt(0)
    s_barrier
    s_barrier
L_end_m:
    s_endpgm

.section .rodata,"a"
.p2align 6
.amdhsa_kernel interleave_layers__sliding_local_dilated__mixer_gmlp__prompt_kernel
  .amdhsa_next_free_vgpr 256
  .amdhsa_next_free_sgpr 102
  .amdhsa_accum_offset 256
  .amdhsa_group_segment_fixed_size 0
  .amdhsa_kernarg_size 88
  .amdhsa_user_sgpr_count 2
  .amdhsa_user_sgpr_kernarg_segment_ptr 1
  .amdhsa_system_sgpr_workgroup_id_x 1
  .amdhsa_float_denorm_mode_32 3
.end_amdhsa_kernel
```

```asm
; @launch grid=(256,1,1) block=(512,1,1) lds=163840
.amdgcn_target "amdgcn-amd-amdhsa--gfx950"
.text
.globl interleave_layers__sliding_local_dilated__mixer_gmlp__prompt_kernel
.p2align 8
.type interleave_layers__sliding_local_dilated__mixer_gmlp__prompt_kernel,@function
interleave_layers__sliding_local_dilated__mixer_gmlp__prompt_kernel:
    s_cmp_ge_u32 s2, 256
    s_cbranch_scc1 L_end_m
    s_load_dwordx16 s[36:51], s[0:1], 0
    s_load_dwordx4 s[56:59], s[0:1], 64
    s_load_dwordx2 s[24:25], s[0:1], 80
    s_getpc_b64 s[26:27]
L_m_pc:
    s_sub_u32 s26, s26, L_m_pc-interleave_layers__sliding_local_dilated__mixer_gmlp__prompt_kernel
    s_subb_u32 s27, s27, 0
    v_lshlrev_b32 v4, 4, v0
    v_mov_b32 v5, s27
    v_add_co_u32 v6, vcc, s26, v4
    s_lshr_b32 s28, s2, 3
    s_lshl_b32 s28, s28, 11
    v_addc_co_u32 v7, vcc, 0, v5, vcc
    global_load_dwordx4 v[60:63], v[6:7], off
    v_lshl_add_u32 v4, v0, 2, s28
    v_min_u32 v4, L_end_m-interleave_layers__sliding_local_dilated__mixer_gmlp__prompt_kernel-4, v4
    v_add_co_u32 v6, vcc, s26, v4
    s_nop 1
    v_addc_co_u32 v7, vcc, 0, v5, vcc
    global_load_dword v64, v[6:7], off
    v_lshrrev_b32 v2, 6, v0
    v_and_b32 v1, 63, v0
    v_lshlrev_b32 v1, 4, v1
    v_readfirstlane_b32 s23, v2
    s_mov_b32 s22, 0
    s_mov_b32 s21, 0
    s_and_b32 s20, s23, 3
    s_waitcnt lgkmcnt(0)
    s_mov_b32 s4, s24
    s_mov_b32 s5, s25
    s_mov_b32 s6, 0x10000000
    s_mov_b32 s7, 0x20000
    s_mov_b32 s8, s46
    s_mov_b32 s9, s47
    s_mov_b32 s10, 0x800000
    s_mov_b32 s11, 0x20000
    s_mov_b32 s12, s48
    s_mov_b32 s13, s49
    s_mov_b32 s14, 0x1000
    s_mov_b32 s15, 0x20000
    s_mov_b32 s16, s56
    s_mov_b32 s17, s57
    s_mov_b32 s18, 0x240000
    s_mov_b32 s19, 0x20000
    s_cmp_ge_u32 s23, 4
    s_cbranch_scc1 L_ld_m
    v_bfe_u32 v2, v1, 4, 4
    v_lshrrev_b32 v3, 8, v1
    v_bfrev_b32 v6, 1
    v_mov_b32 v11, 0x3f803f80
    s_lshl_b32 s30, s20, 12
    s_and_b32 s29, s20, 1
    s_cmp_lt_u32 s2, 128
    s_cbranch_scc1 L_p0_x
    s_cmp_lt_u32 s2, 236
    s_cbranch_scc1 L_p0_wq
    s_cmp_lt_u32 s2, 254
    s_cbranch_scc1 L_p0_wo
    s_mov_b32 s46, 0
    s_mov_b32 s27, 0x800000
    s_barrier
    s_barrier
    s_branch L_p0_cd
L_p0_wo:
    s_mul_i32 s30, s20, 9216
    s_sub_u32 s26, s2, 236
    s_mul_i32 s28, s26, 57
    s_lshr_b32 s28, s28, 9
    s_mul_i32 s27, s28, 9
    s_sub_u32 s27, s26, s27
    s_mov_b32 s32, s40
    s_mov_b32 s33, s41
    s_mov_b32 s34, 0xa2000
    s_mov_b32 s35, 0x20000
    s_mul_i32 s29, s28, 331776
    s_lshl_b32 s31, s27, 7
    s_add_u32 s29, s29, s31
    s_mul_i32 s31, s20, 82944
    s_add_u32 s29, s29, s31
    v_lshrrev_b32 v4, 7, v1
    v_mul_u32_u24 v4, 1152, v4
    v_and_b32 v5, 0x70, v1
    v_add_u32 v4, v4, v5
    s_add_u32 m0, s30, 0
    s_add_u32 s31, s29, 0
    buffer_load_dwordx4 v4, s[32:35], s31 offen  lds
    s_add_u32 m0, s30, 1024
    s_add_u32 s31, s29, 9216
    buffer_load_dwordx4 v4, s[32:35], s31 offen  lds
    s_add_u32 m0, s30, 2048
    s_add_u32 s31, s29, 18432
    buffer_load_dwordx4 v4, s[32:35], s31 offen  lds
    s_add_u32 m0, s30, 3072
    s_add_u32 s31, s29, 27648
    buffer_load_dwordx4 v4, s[32:35], s31 offen  lds
    s_add_u32 m0, s30, 4096
    s_add_u32 s31, s29, 36864
    buffer_load_dwordx4 v4, s[32:35], s31 offen  lds
    s_add_u32 m0, s30, 5120
    s_add_u32 s31, s29, 46080
    buffer_load_dwordx4 v4, s[32:35], s31 offen  lds
    s_add_u32 m0, s30, 6144
    s_add_u32 s31, s29, 55296
    buffer_load_dwordx4 v4, s[32:35], s31 offen  lds
    s_add_u32 m0, s30, 7168
    s_add_u32 s31, s29, 64512
    buffer_load_dwordx4 v4, s[32:35], s31 offen  lds
    s_add_u32 m0, s30, 8192
    s_add_u32 s31, s29, 73728
    buffer_load_dwordx4 v4, s[32:35], s31 offen  lds
    s_barrier
    v_lshrrev_b32 v7, 2, v2
    v_and_b32 v8, 3, v2
    s_lshl_b32 s31, s20, 5
    s_add_u32 s31, s31, 0
    v_lshlrev_b32 v9, 7, v7
    v_lshl_add_u32 v9, v8, 3, v9
    v_add_u32 v9, s31, v9
    v_mul_u32_u24 v4, 512, v3
    v_add_u32 v4, v4, v9
    v_mul_u32_u24 v5, 9216, v3
    v_add_u32 v5, v5, v9
    s_lshl_b32 s31, s27, 2
    s_add_u32 s31, s31, s20
    v_lshl_add_u32 v7, s31, 2, v7
    v_lshlrev_b32 v8, 4, v8
    v_lshl_add_u32 v8, v3, 8, v8
    v_mul_u32_u24 v9, 57, v7
    v_lshrrev_b32 v9, 10, v9
    v_mul_u32_u24 v10, 18, v9
    v_sub_u32 v10, v7, v10
    v_lshrrev_b32 v12, 3, v10
    v_and_b32 v13, 1, v10
    v_lshl_add_u32 v12, v12, 1, v13
    v_bfe_u32 v14, v10, 1, 2
    v_cmp_gt_u32 vcc, 16, v10
    v_mul_u32_u24 v9, 82944, v9
    v_add_u32 v9, v9, v8
    v_cndmask_b32 v12, 8, v12, vcc
    v_cndmask_b32 v14, v13, v14, vcc
    v_mov_b32 v15, 0x1000
    v_mov_b32 v13, 0x80
    v_cndmask_b32 v15, v13, v15, vcc
    v_lshl_add_u32 v9, v12, 10, v9
    v_lshl_add_u32 v9, v14, 6, v9
    v_add_u32 v10, v9, v15
    s_and_b32 s31, s28, 1
    s_cmp_eq_u32 s31, 1
    s_cselect_b64 vcc, -1, 0
    v_cndmask_b32 v14, v9, v10, vcc
    s_mul_i32 s31, s28, 36864
    s_add_u32 s37, s31, 0x3a00000
    s_add_u32 s38, s31, 0x3a00000
    s_add_u32 s39, s31, 0x3a02400
    s_add_u32 s40, s31, 0x3a02400
    s_add_u32 s41, s31, 0x3a04800
    s_add_u32 s42, s31, 0x3a04800
    s_add_u32 s43, s31, 0x3a06c00
    s_add_u32 s47, s31, 0x3a06c00
    s_lshr_b32 s31, s28, 1
    s_mul_i32 s31, s31, 9216
    s_add_u32 s48, s31, 0x3a12000
    s_cmp_ge_u32 s26, 4
    s_cbranch_scc1 L_p0_n2
    s_lshl_b32 s31, s26, 2
    s_add_u32 s31, s31, s20
    s_lshl_b32 s31, s31, 12
    s_add_u32 s31, s31, 0x4508000
    v_and_b32 v56, 0x380, v1
    v_add_u32 v56, v56, v1
    v_mov_b32 v52, 0
    v_mov_b32 v53, 0
    v_mov_b32 v54, 0
    v_mov_b32 v55, 0
    buffer_store_dwordx4 v[52:55], v56, s[4:7], s31 offen offset:0 sc1
    buffer_store_dwordx4 v[52:55], v56, s[4:7], s31 offen offset:2048 sc1
L_p0_n2:
    s_waitcnt vmcnt(0)
    s_barrier
    ds_read_b64_tr_b16 v[16:17], v4 offset:0
    ds_read_b64_tr_b16 v[18:19], v4 offset:2560
    ds_read_b64_tr_b16 v[20:21], v4 offset:4608
    ds_read_b64_tr_b16 v[22:23], v4 offset:7168
    ds_read_b64_tr_b16 v[24:25], v4 offset:9216
    ds_read_b64_tr_b16 v[26:27], v4 offset:11776
    ds_read_b64_tr_b16 v[28:29], v4 offset:13824
    ds_read_b64_tr_b16 v[30:31], v4 offset:16384
    ds_read_b64_tr_b16 v[32:33], v4 offset:18432
    ds_read_b64_tr_b16 v[34:35], v4 offset:20992
    ds_read_b64_tr_b16 v[36:37], v4 offset:23040
    ds_read_b64_tr_b16 v[38:39], v4 offset:25600
    ds_read_b64_tr_b16 v[40:41], v4 offset:27648
    ds_read_b64_tr_b16 v[42:43], v4 offset:30208
    ds_read_b64_tr_b16 v[44:45], v4 offset:32256
    ds_read_b64_tr_b16 v[46:47], v4 offset:34816
    ds_read_b64_tr_b16 v[48:49], v5 offset:2048
    ds_read_b64_tr_b16 v[50:51], v5 offset:6656
    s_waitcnt lgkmcnt(15)
    s_mov_b32 s31, s37
    buffer_store_dwordx4 v[16:19], v9, s[4:7], s31 offen sc1
    s_waitcnt lgkmcnt(14)
    s_mov_b32 s31, s38
    buffer_store_dwordx4 v[20:23], v10, s[4:7], s31 offen sc1
    s_waitcnt lgkmcnt(12)
    s_mov_b32 s31, s39
    buffer_store_dwordx4 v[24:27], v9, s[4:7], s31 offen sc1
    s_waitcnt lgkmcnt(10)
    s_mov_b32 s31, s40
    buffer_store_dwordx4 v[28:31], v10, s[4:7], s31 offen sc1
    s_waitcnt lgkmcnt(8)
    s_mov_b32 s31, s41
    buffer_store_dwordx4 v[32:35], v9, s[4:7], s31 offen sc1
    s_waitcnt lgkmcnt(6)
    s_mov_b32 s31, s42
    buffer_store_dwordx4 v[36:39], v10, s[4:7], s31 offen sc1
    s_waitcnt lgkmcnt(4)
    s_mov_b32 s31, s43
    buffer_store_dwordx4 v[40:43], v9, s[4:7], s31 offen sc1
    s_waitcnt lgkmcnt(2)
    s_mov_b32 s31, s47
    buffer_store_dwordx4 v[44:47], v10, s[4:7], s31 offen sc1
    s_waitcnt lgkmcnt(0)
    s_mov_b32 s31, s48
    buffer_store_dwordx4 v[48:51], v14, s[4:7], s31 offen sc1
    s_mov_b32 s46, 1
    s_mov_b32 s27, 32
    s_branch L_p0_cd
L_p0_wq:
    s_mov_b32 s32, s38
    s_mov_b32 s33, s39
    s_mov_b32 s34, 0x1e6000
    s_mov_b32 s35, 0x20000
    s_sub_u32 s23, s2, 128
    s_mul_i32 s25, s23, 19
    s_lshr_b32 s25, s25, 9
    s_mul_i32 s24, s25, 27
    s_sub_u32 s24, s23, s24
    s_mul_i32 s26, s25, 497664
    s_lshl_b32 s31, s24, 7
    s_add_u32 s26, s26, s31
    v_lshrrev_b32 v4, 7, v1
    v_mul_u32_u24 v4, 3456, v4
    v_and_b32 v5, 0x70, v1
    v_add_u32 v4, v4, v5
    s_mul_i32 s31, s20, 110592
    s_add_u32 s27, s26, s31
    s_add_u32 m0, s30, 0
    s_add_u32 s31, s27, 0
    buffer_load_dwordx4 v4, s[32:35], s31 offen  lds
    s_add_u32 m0, s30, 1024
    s_add_u32 s31, s27, 27648
    buffer_load_dwordx4 v4, s[32:35], s31 offen  lds
    s_add_u32 m0, s30, 2048
    s_add_u32 s31, s27, 55296
    buffer_load_dwordx4 v4, s[32:35], s31 offen  lds
    s_add_u32 m0, s30, 3072
    s_add_u32 s31, s27, 82944
    buffer_load_dwordx4 v4, s[32:35], s31 offen  lds
    s_cmp_ge_u32 s20, 2
    s_cbranch_scc1 L_p0_q5
    s_lshl_b32 s31, s29, 10
    s_add_u32 m0, s31, 16384
    s_mul_i32 s31, s29, 27648
    s_add_u32 s31, s31, s26
    s_add_u32 s31, s31, 442368
    buffer_load_dwordx4 v4, s[32:35], s31 offen  lds
L_p0_q5:
    s_barrier
    v_lshrrev_b32 v7, 2, v2
    v_and_b32 v8, 3, v2
    s_lshl_b32 s31, s20, 5
    v_lshlrev_b32 v9, 7, v7
    v_lshl_add_u32 v9, v3, 3, v9
    v_add_u32 v9, s31, v9
    v_lshl_add_u32 v4, v8, 10, v9
    v_and_b32 v5, 1, v2
    v_mul_u32_u24 v5, 9216, v5
    v_add_u32 v5, v5, v9
    s_lshl_b32 s31, s24, 2
    s_add_u32 s31, s31, s20
    v_lshl_add_u32 v7, s31, 2, v3
    v_lshlrev_b32 v8, 4, v2
    v_mul_u32_u24 v9, 57, v7
    v_lshrrev_b32 v9, 13, v9
    v_mul_u32_u24 v10, 144, v9
    v_sub_u32 v10, v7, v10
    v_mul_u32_u24 v12, 57, v10
    v_lshrrev_b32 v12, 9, v12
    v_mul_u32_u24 v13, 9, v12
    v_sub_u32 v13, v10, v13
    v_cmp_lt_u32 s[36:37], 4, v13
    v_cmp_eq_u32 s[38:39], 4, v13
    v_cmp_eq_u32 s[40:41], 2, v9
    v_lshlrev_b32 v14, 1, v9
    v_add_u32 v15, 1, v14
    v_subrev_u32 v10, 5, v13
    v_cndmask_b32 v14, v14, v15, s[36:37]
    v_cndmask_b32 v13, v13, v10, s[36:37]
    v_cndmask_b32 v14, v14, 6, s[38:39]
    v_cndmask_b32 v13, v13, v9, s[38:39]
    s_and_b64 s[40:41], s[40:41], s[38:39]
    s_mov_b32 s31, 129024
    v_mul_lo_u32 v9, v12, s31
    v_add_u32 v9, v9, v8
    v_lshl_add_u32 v9, v14, 10, v9
    v_lshl_add_u32 v9, v13, 8, v9
    s_and_b32 s31, s25, 1
    v_lshrrev_b32 v8, 3, v2
    v_cmp_eq_u32 vcc, s31, v8
    v_add_u32 v15, 256, v9
    v_cndmask_b32 v15, v6, v15, s[40:41]
    v_cndmask_b32 v8, v6, v9, vcc
    v_lshlrev_b32 v10, 2, v2
    v_lshl_add_u32 v10, v7, 4, v10
    v_cmp_gt_u32 vcc, 4, v2
    s_lshl_b32 s45, s25, 13
    s_add_u32 s45, s45, 0x4400000
    v_cndmask_b32 v10, v6, v10, vcc
    s_mul_i32 s42, s25, 28672
    s_add_u32 s42, s42, 0x3800000
    s_lshr_b32 s44, s25, 1
    s_mul_i32 s44, s44, 7168
    s_add_u32 s44, s44, 0x381c000
    s_mul_i32 s26, s24, 29
    s_lshr_b32 s26, s26, 8
    s_mul_i32 s27, s26, 9
    s_sub_u32 s27, s24, s27
    s_lshl_b32 s27, s27, 4
    s_add_u32 s28, s27, 16
    v_lshrrev_b32 v254, 4, v1
    v_mul_u32_u24 v7, 9, v254
    v_add_u32 v255, 9, v7
    v_min_u32 v255, s28, v255
    v_max_u32 v7, s27, v7
    v_sub_u32 v255, v255, v7
    v_cmp_lt_i32 vcc, 0, v255
    v_lshlrev_b32 v254, 8, v254
    v_mov_b32 v14, 0x3f003f00
    v_cndmask_b32 v254, v6, v254, vcc
    s_cmp_eq_u64 s[40:41], 0
    s_cbranch_scc1 L_p0_np
    v_mov_b32 v52, 0
    v_mov_b32 v53, 0
    v_mov_b32 v54, 0
    v_mov_b32 v55, 0
    s_add_u32 s31, s42, 0
    buffer_store_dwordx4 v[52:55], v15, s[4:7], s31 offen sc1
    s_add_u32 s31, s42, 7168
    buffer_store_dwordx4 v[52:55], v15, s[4:7], s31 offen sc1
    s_add_u32 s31, s42, 14336
    buffer_store_dwordx4 v[52:55], v15, s[4:7], s31 offen sc1
    s_add_u32 s31, s42, 21504
    buffer_store_dwordx4 v[52:55], v15, s[4:7], s31 offen sc1
    s_mov_b32 s31, s44
    buffer_store_dwordx4 v[52:55], v15, s[4:7], s31 offen sc1
    s_waitcnt vmcnt(5)
    s_branch L_p0_n3
L_p0_np:
    s_waitcnt vmcnt(0)
L_p0_n3:
    s_barrier
    ds_read_b64_tr_b16 v[16:17], v4 offset:0
    ds_read_b64_tr_b16 v[18:19], v4 offset:512
    ds_read_b64_tr_b16 v[20:21], v4 offset:4096
    ds_read_b64_tr_b16 v[22:23], v4 offset:4608
    ds_read_b64_tr_b16 v[24:25], v4 offset:9216
    ds_read_b64_tr_b16 v[26:27], v4 offset:9728
    ds_read_b64_tr_b16 v[28:29], v4 offset:13312
    ds_read_b64_tr_b16 v[30:31], v4 offset:13824
    ds_read_b64_tr_b16 v[32:33], v5 offset:8192
    ds_read_b64_tr_b16 v[34:35], v5 offset:8704
    s_waitcnt lgkmcnt(8)
    s_add_u32 s31, s42, 0
    buffer_store_dwordx4 v[16:19], v9, s[4:7], s31 offen sc1
    s_waitcnt lgkmcnt(6)
    s_add_u32 s31, s42, 7168
    buffer_store_dwordx4 v[20:23], v9, s[4:7], s31 offen sc1
    s_waitcnt lgkmcnt(4)
    s_add_u32 s31, s42, 14336
    buffer_store_dwordx4 v[24:27], v9, s[4:7], s31 offen sc1
    s_waitcnt lgkmcnt(2)
    s_add_u32 s31, s42, 21504
    buffer_store_dwordx4 v[28:31], v9, s[4:7], s31 offen sc1
    s_waitcnt lgkmcnt(0)
    s_mov_b32 s31, s44
    buffer_store_dwordx4 v[32:35], v8, s[4:7], s31 offen sc1
    v_dot2_f32_bf16 v12, v16, v11, 0
    v_dot2_f32_bf16 v13, v17, v11, 0
    v_dot2_f32_bf16 v12, v18, v11, v12
    v_dot2_f32_bf16 v13, v19, v11, v13
    v_dot2_f32_bf16 v12, v20, v11, v12
    v_dot2_f32_bf16 v13, v21, v11, v13
    v_dot2_f32_bf16 v12, v22, v11, v12
    v_dot2_f32_bf16 v13, v23, v11, v13
    v_dot2_f32_bf16 v12, v24, v11, v12
    v_dot2_f32_bf16 v13, v25, v11, v13
    v_dot2_f32_bf16 v12, v26, v11, v12
    v_dot2_f32_bf16 v13, v27, v11, v13
    v_dot2_f32_bf16 v12, v28, v11, v12
    v_dot2_f32_bf16 v13, v29, v11, v13
    v_dot2_f32_bf16 v12, v30, v11, v12
    v_dot2_f32_bf16 v13, v31, v11, v13
    v_dot2_f32_bf16 v12, v32, v14, v12
    v_dot2_f32_bf16 v13, v33, v14, v13
    v_dot2_f32_bf16 v12, v34, v14, v12
    v_dot2_f32_bf16 v13, v35, v14, v13
    s_nop 2
    v_add_f32 v12, v12, v13
    s_nop 1
    v_add_f32_dpp v12, v12, v12 row_ror:4 row_mask:0xf bank_mask:0xf
    s_nop 1
    v_add_f32_dpp v12, v12, v12 row_ror:8 row_mask:0xf bank_mask:0xf
    buffer_store_dword v12, v10, s[4:7], s45 offen sc1
    s_branch L_p0_ce
L_p0_x:
    s_mov_b32 s32, s36
    s_mov_b32 s33, s37
    s_mov_b32 s34, 0x240000
    s_mov_b32 s35, 0x20000
    s_mul_i32 s26, s2, 18432
    s_mov_b32 m0, s30
    s_add_u32 s31, s26, s30
    buffer_load_dwordx4 v1, s[32:35], s31 offen offset:0  lds
    buffer_load_dwordx4 v1, s[32:35], s31 offen offset:1024  lds
    buffer_load_dwordx4 v1, s[32:35], s31 offen offset:2048  lds
    buffer_load_dwordx4 v1, s[32:35], s31 offen offset:3072  lds
    s_lshl_b32 s27, s29, 10
    s_add_u32 s27, s27, 16384
    s_mov_b32 m0, s27
    s_add_u32 s31, s26, s27
    buffer_load_dwordx4 v1, s[32:35], s31 offen  lds
    s_barrier
    s_mul_i32 s31, s20, 288
    v_mul_u32_u24 v7, 1152, v2
    v_lshl_add_u32 v4, v3, 4, v7
    v_add_u32 v4, s31, v4
    s_mul_i32 s31, s29, 576
    v_mul_u32_u24 v5, 144, v3
    v_add3_u32 v5, v5, v7, s31
    s_add_u32 s26, s26, 0x0
    s_add_u32 s42, s26, s30
    s_add_u32 s44, s26, s27
    s_lshl_b32 s45, s2, 10
    s_lshl_b32 s31, s20, 8
    s_add_u32 s45, s45, s31
    s_add_u32 s45, s45, 0x1b00000
    v_cmp_gt_u32 vcc, 2, v3
    v_lshrrev_b32 v10, 1, v1
    s_mov_b32 s46, 2
    v_cndmask_b32 v10, v6, v10, vcc
    s_lshr_b32 s27, s2, 3
    s_add_u32 s27, s27, 48
    s_waitcnt vmcnt(0)
    s_barrier
    ds_read_b128 v[16:19], v4 offset:0
    ds_read_b128 v[20:23], v4 offset:64
    ds_read_b128 v[24:27], v4 offset:144
    ds_read_b128 v[28:31], v4 offset:208
    ds_read_b128 v[32:35], v5 offset:128
    s_waitcnt lgkmcnt(4)
    buffer_store_dwordx4 v[16:19], v1, s[4:7], s42 offen offset:0 sc1
    s_waitcnt lgkmcnt(3)
    buffer_store_dwordx4 v[20:23], v1, s[4:7], s42 offen offset:1024 sc1
    s_waitcnt lgkmcnt(2)
    buffer_store_dwordx4 v[24:27], v1, s[4:7], s42 offen offset:2048 sc1
    s_waitcnt lgkmcnt(1)
    buffer_store_dwordx4 v[28:31], v1, s[4:7], s42 offen offset:3072 sc1
    v_dot2_f32_bf16 v12, v16, v11, 0
    v_dot2_f32_bf16 v13, v16, v16, 0
    v_dot2_f32_bf16 v12, v17, v11, v12
    v_dot2_f32_bf16 v13, v17, v17, v13
    v_dot2_f32_bf16 v12, v18, v11, v12
    v_dot2_f32_bf16 v13, v18, v18, v13
    v_dot2_f32_bf16 v12, v19, v11, v12
    v_dot2_f32_bf16 v13, v19, v19, v13
    v_dot2_f32_bf16 v12, v20, v11, v12
    v_dot2_f32_bf16 v13, v20, v20, v13
    v_dot2_f32_bf16 v12, v21, v11, v12
    v_dot2_f32_bf16 v13, v21, v21, v13
    v_dot2_f32_bf16 v12, v22, v11, v12
    v_dot2_f32_bf16 v13, v22, v22, v13
    v_dot2_f32_bf16 v12, v23, v11, v12
    v_dot2_f32_bf16 v13, v23, v23, v13
    v_dot2_f32_bf16 v12, v24, v11, v12
    v_dot2_f32_bf16 v13, v24, v24, v13
    v_dot2_f32_bf16 v12, v25, v11, v12
    v_dot2_f32_bf16 v13, v25, v25, v13
    v_dot2_f32_bf16 v12, v26, v11, v12
    v_dot2_f32_bf16 v13, v26, v26, v13
    v_dot2_f32_bf16 v12, v27, v11, v12
    v_dot2_f32_bf16 v13, v27, v27, v13
    v_dot2_f32_bf16 v12, v28, v11, v12
    v_dot2_f32_bf16 v13, v28, v28, v13
    v_dot2_f32_bf16 v12, v29, v11, v12
    v_dot2_f32_bf16 v13, v29, v29, v13
    v_dot2_f32_bf16 v12, v30, v11, v12
    v_dot2_f32_bf16 v13, v30, v30, v13
    v_dot2_f32_bf16 v12, v31, v11, v12
    v_dot2_f32_bf16 v13, v31, v31, v13
    s_waitcnt lgkmcnt(0)
    s_cmp_ge_u32 s20, 2
    s_cbranch_scc1 L_p0_xs
    buffer_store_dwordx4 v[32:35], v1, s[4:7], s44 offen sc1
    v_dot2_f32_bf16 v12, v32, v11, v12
    v_dot2_f32_bf16 v13, v32, v32, v13
    v_dot2_f32_bf16 v12, v33, v11, v12
    v_dot2_f32_bf16 v13, v33, v33, v13
    v_dot2_f32_bf16 v12, v34, v11, v12
    v_dot2_f32_bf16 v13, v34, v34, v13
    v_dot2_f32_bf16 v12, v35, v11, v12
    v_dot2_f32_bf16 v13, v35, v35, v13
L_p0_xs:
    s_nop 2
    v_mov_b32 v14, v12
    v_mov_b32 v15, v13
    s_nop 1
    v_permlane32_swap_b32 v12, v14
    v_permlane32_swap_b32 v13, v15
    v_add_f32 v12, v12, v14
    v_add_f32 v13, v13, v15
    buffer_store_dwordx2 v[12:13], v10, s[4:7], s45 offen sc1
L_p0_cd:
    v_cmp_eq_u32 vcc, 0, v1
    s_lshl_b32 s27, s27, 8
    v_mov_b32 v255, s46
    v_mov_b32 v254, s27
    v_cndmask_b32 v254, v6, v254, vcc
L_p0_ce:
    s_mov_b32 s48, s58
    s_mov_b32 s49, s59
    s_mov_b32 s50, 0x100
    s_mov_b32 s51, 0x20000
    v_mov_b32 v4, 0
    buffer_load_dword v246, v4, s[48:51], 0 offen sc1
    s_barrier
    s_branch L_m_cl
L_d1_first:
    v_cmp_gt_u32 vcc, 4, v246
    v_mov_b32 v4, 0
    s_mov_b32 s46, 0x4500000
    s_cbranch_vccz L_pd_dbg
    s_mov_b32 s60, 65536
L_poll_dbg:
    buffer_load_dword v5, v4, s[48:51], 0 offen sc1
    s_waitcnt vmcnt(0)
    v_cmp_gt_u32 vcc, 4, v5
    s_sub_u32 s60, s60, 1
    s_cbranch_scc1 L_pd_dbg
    s_cbranch_vccz L_pd_dbg
    s_sleep 4
    s_branch L_poll_dbg
L_pd_dbg:
    buffer_atomic_add v255, v254, s[4:7], s46 offen sc1
    s_branch L_ns_d1
L_ld_m:
    s_cmp_lg_u32 s2, 0
    s_cbranch_scc1 L_p0_nz
    s_lshl_b32 s31, s20, 12
    s_add_u32 s31, s31, 0x4500000
    v_and_b32 v56, 0x380, v1
    v_add_u32 v56, v56, v1
    v_mov_b32 v52, 0
    v_mov_b32 v53, 0
    v_mov_b32 v54, 0
    v_mov_b32 v55, 0
    buffer_store_dwordx4 v[52:55], v56, s[4:7], s31 offen offset:0 sc1
    buffer_store_dwordx4 v[52:55], v56, s[4:7], s31 offen offset:2048 sc1
    s_waitcnt vmcnt(0)
    s_mov_b32 s53, 1
    s_atomic_add s53, s[58:59], 0
L_p0_nz:
    v_bfe_u32 v2, v1, 4, 4
    v_lshrrev_b32 v3, 8, v1
    v_bfrev_b32 v6, 1
    v_mov_b32 v11, 0x3f803f80
    s_mul_i32 s30, s20, 9216
    s_cmp_lt_u32 s2, 144
    s_cbranch_scc1 L_p0_wi
    s_cmp_lt_u32 s2, 216
    s_cbranch_scc1 L_p0_wu
    v_mov_b32 v9, v6
    v_mov_b32 v10, v6
    v_mov_b32 v14, v6
    v_mov_b32 v15, v6
    s_mov_b32 s37, 0
    s_mov_b32 s38, 0
    s_mov_b32 s39, 0
    s_mov_b32 s40, 0
    s_mov_b32 s41, 0
    s_mov_b32 s42, 0
    s_mov_b32 s43, 0
    s_mov_b32 s47, 0
    s_mov_b32 s48, 0
    s_mov_b32 s49, 0
    s_barrier
    s_barrier
    s_barrier
    s_barrier
    s_barrier
    s_branch L_p0_ld
L_p0_wu:
    s_sub_u32 s26, s2, 144
    s_mul_i32 s28, s26, 57
    s_lshr_b32 s28, s28, 9
    s_mul_i32 s27, s28, 9
    s_sub_u32 s27, s26, s27
    s_mov_b32 s32, s50
    s_mov_b32 s33, s51
    s_mov_b32 s34, 0x288000
    s_mov_b32 s35, 0x20000
    s_mul_i32 s29, s28, 331776
    s_lshl_b32 s31, s27, 7
    s_add_u32 s29, s29, s31
    s_mul_i32 s31, s20, 82944
    s_add_u32 s29, s29, s31
    v_lshrrev_b32 v4, 7, v1
    v_mul_u32_u24 v4, 1152, v4
    v_and_b32 v5, 0x70, v1
    v_add_u32 v4, v4, v5
    s_barrier
    s_barrier
    s_barrier
    s_barrier
    s_barrier
    s_add_u32 m0, s30, 94208
    s_add_u32 s31, s29, 0
    buffer_load_dwordx4 v4, s[32:35], s31 offen  lds
    s_add_u32 m0, s30, 95232
    s_add_u32 s31, s29, 9216
    buffer_load_dwordx4 v4, s[32:35], s31 offen  lds
    s_add_u32 m0, s30, 96256
    s_add_u32 s31, s29, 18432
    buffer_load_dwordx4 v4, s[32:35], s31 offen  lds
    s_add_u32 m0, s30, 97280
    s_add_u32 s31, s29, 27648
    buffer_load_dwordx4 v4, s[32:35], s31 offen  lds
    s_add_u32 m0, s30, 98304
    s_add_u32 s31, s29, 36864
    buffer_load_dwordx4 v4, s[32:35], s31 offen  lds
    s_add_u32 m0, s30, 99328
    s_add_u32 s31, s29, 46080
    buffer_load_dwordx4 v4, s[32:35], s31 offen  lds
    s_add_u32 m0, s30, 100352
    s_add_u32 s31, s29, 55296
    buffer_load_dwordx4 v4, s[32:35], s31 offen  lds
    s_add_u32 m0, s30, 101376
    s_add_u32 s31, s29, 64512
    buffer_load_dwordx4 v4, s[32:35], s31 offen  lds
    s_add_u32 m0, s30, 102400
    s_add_u32 s31, s29, 73728
    buffer_load_dwordx4 v4, s[32:35], s31 offen  lds
    v_lshrrev_b32 v7, 2, v2
    v_and_b32 v8, 3, v2
    s_lshl_b32 s31, s20, 5
    s_add_u32 s31, s31, 94208
    v_lshlrev_b32 v9, 7, v7
    v_lshl_add_u32 v9, v8, 3, v9
    v_add_u32 v9, s31, v9
    v_mul_u32_u24 v4, 512, v3
    v_add_u32 v4, v4, v9
    v_mul_u32_u24 v5, 512, v3
    v_add_u32 v5, v5, v9
    s_lshl_b32 s31, s27, 2
    s_add_u32 s31, s31, s20
    v_lshl_add_u32 v7, s31, 2, v7
    v_lshlrev_b32 v8, 4, v8
    v_lshl_add_u32 v8, v3, 8, v8
    v_mul_u32_u24 v9, 57, v7
    v_lshrrev_b32 v9, 10, v9
    v_mul_u32_u24 v10, 18, v9
    v_sub_u32 v10, v7, v10
    v_lshrrev_b32 v12, 3, v10
    v_and_b32 v13, 1, v10
    v_lshl_add_u32 v12, v12, 1, v13
    v_bfe_u32 v14, v10, 1, 2
    v_cmp_gt_u32 vcc, 16, v10
    v_mul_u32_u24 v9, 331776, v9
    v_add_u32 v9, v9, v8
    v_cndmask_b32 v12, 8, v12, vcc
    v_cndmask_b32 v14, v13, v14, vcc
    v_mov_b32 v15, 0x1000
    v_mov_b32 v13, 0x80
    v_cndmask_b32 v15, v13, v15, vcc
    v_lshl_add_u32 v9, v12, 10, v9
    v_lshl_add_u32 v9, v14, 6, v9
    v_add_u32 v10, v9, v15
    s_and_b32 s31, s28, 1
    s_cmp_eq_u32 s31, 1
    s_cselect_b64 vcc, -1, 0
    v_cndmask_b32 v14, v9, v10, vcc
    s_mul_i32 s31, s28, 36864
    s_add_u32 s37, s31, 0x4100000
    s_add_u32 s38, s31, 0x4100000
    s_add_u32 s39, s31, 0x4102400
    s_add_u32 s40, s31, 0x4102400
    s_add_u32 s41, s31, 0x4104800
    s_add_u32 s42, s31, 0x4104800
    s_add_u32 s43, s31, 0x4106c00
    s_add_u32 s47, s31, 0x4106c00
    s_lshr_b32 s31, s28, 1
    s_mul_i32 s31, s31, 9216
    s_add_u32 s48, s31, 0x4148000
    v_mov_b32 v15, v6
    s_mov_b32 s49, 0
    s_branch L_p0_ld
L_p0_wi:
    s_mov_b32 s26, s2
    s_mul_i32 s28, s26, 57
    s_lshr_b32 s28, s28, 12
    s_mul_i32 s27, s28, 72
    s_sub_u32 s27, s26, s27
    s_mov_b32 s32, s44
    s_mov_b32 s33, s45
    s_mov_b32 s34, 0x510000
    s_mov_b32 s35, 0x20000
    s_mul_i32 s29, s28, 2654208
    s_lshl_b32 s31, s27, 7
    s_add_u32 s29, s29, s31
    s_mul_i32 s31, s20, 663552
    s_add_u32 s29, s29, s31
    v_lshrrev_b32 v4, 7, v1
    v_mul_u32_u24 v4, 9216, v4
    v_and_b32 v5, 0x70, v1
    v_add_u32 v4, v4, v5
    s_barrier
    s_barrier
    s_barrier
    s_barrier
    s_barrier
    s_add_u32 m0, s30, 94208
    s_add_u32 s31, s29, 0
    buffer_load_dwordx4 v4, s[32:35], s31 offen  lds
    s_add_u32 m0, s30, 95232
    s_add_u32 s31, s29, 73728
    buffer_load_dwordx4 v4, s[32:35], s31 offen  lds
    s_add_u32 m0, s30, 96256
    s_add_u32 s31, s29, 147456
    buffer_load_dwordx4 v4, s[32:35], s31 offen  lds
    s_add_u32 m0, s30, 97280
    s_add_u32 s31, s29, 221184
    buffer_load_dwordx4 v4, s[32:35], s31 offen  lds
    s_add_u32 m0, s30, 98304
    s_add_u32 s31, s29, 294912
    buffer_load_dwordx4 v4, s[32:35], s31 offen  lds
    s_add_u32 m0, s30, 99328
    s_add_u32 s31, s29, 368640
    buffer_load_dwordx4 v4, s[32:35], s31 offen  lds
    s_add_u32 m0, s30, 100352
    s_add_u32 s31, s29, 442368
    buffer_load_dwordx4 v4, s[32:35], s31 offen  lds
    s_add_u32 m0, s30, 101376
    s_add_u32 s31, s29, 516096
    buffer_load_dwordx4 v4, s[32:35], s31 offen  lds
    s_add_u32 m0, s30, 102400
    s_add_u32 s31, s29, 589824
    buffer_load_dwordx4 v4, s[32:35], s31 offen  lds
    v_lshrrev_b32 v7, 2, v2
    v_and_b32 v8, 3, v2
    s_lshl_b32 s31, s20, 5
    s_add_u32 s31, s31, 94208
    v_lshlrev_b32 v9, 7, v7
    v_lshl_add_u32 v9, v8, 3, v9
    v_add_u32 v9, s31, v9
    v_mul_u32_u24 v4, 1024, v3
    v_add_u32 v4, v4, v9
    v_mul_u32_u24 v5, 9216, v3
    v_add_u32 v5, v5, v9
    s_lshl_b32 s31, s27, 2
    s_add_u32 s31, s31, s20
    v_lshl_add_u32 v7, s31, 2, v7
    v_lshlrev_b32 v8, 4, v8
    v_lshl_add_u32 v8, v3, 8, v8
    s_cmp_lt_u32 s31, 144
    s_cselect_b32 s23, 1, 0
    s_cselect_b32 s24, 0, 144
    s_sub_u32 s26, s31, s24
    s_mul_i32 s25, s26, 57
    s_lshr_b32 s25, s25, 9
    s_mul_i32 s24, s25, 9
    s_sub_u32 s24, s26, s24
    s_lshl_b32 s26, s25, 1
    s_add_u32 s26, s26, s23
    s_mul_i32 s26, s26, 165888
    s_lshl_b32 s31, s24, 10
    s_add_u32 s26, s26, s31
    s_add_u32 s26, s26, 0x3b00000
    s_mul_i32 s31, s28, 9216
    s_add_u32 s48, s26, s31
    s_add_u32 s48, s48, 147456
    s_lshl_b32 s31, s31, 3
    s_add_u32 s26, s26, s31
    s_add_u32 s37, s26, 0
    s_add_u32 s38, s26, 9216
    s_add_u32 s39, s26, 18432
    s_add_u32 s40, s26, 27648
    s_add_u32 s41, s26, 36864
    s_add_u32 s42, s26, 46080
    s_add_u32 s43, s26, 55296
    s_add_u32 s47, s26, 64512
    s_lshl_b32 s49, s25, 12
    s_mul_i32 s31, s28, 1152
    s_add_u32 s49, s49, s31
    s_mul_i32 s31, s23, 576
    s_add_u32 s49, s49, s31
    s_lshl_b32 s31, s24, 6
    s_add_u32 s49, s49, s31
    s_add_u32 s49, s49, 0x4410000
    v_cmp_eq_u32 vcc, 0, v3
    v_lshlrev_b32 v15, 2, v2
    v_mov_b32 v9, v1
    v_mov_b32 v10, v1
    v_mov_b32 v14, v1
    v_cndmask_b32 v15, v6, v15, vcc
L_p0_ld:
    s_waitcnt lgkmcnt(0)
    s_branch L_m_l1
L_m_cl:
    s_and_b32 s25, s2, 7
    s_lshr_b32 s26, s2, 3
    s_lshr_b32 s23, s25, 1
    s_lshl_b32 s23, s23, 2
    s_lshr_b32 s27, s26, 3
    s_add_u32 s23, s23, s27
    s_and_b32 s24, s25, 1
    s_lshl_b32 s24, s24, 3
    s_and_b32 s27, s26, 7
    s_add_u32 s24, s24, s27
    s_lshl_b32 s30, s23, 3
    s_lshl_b32 s31, s20, 1
    s_add_u32 s31, s30, s31
    s_mul_i32 s29, s31, 18432
    s_add_u32 s29, s29, s21
    s_add_u32 s35, s29, 0x600000
    s_add_u32 s29, s29, 0x0
    s_max_u32 s30, s30, 1
    s_sub_u32 s30, s30, 1
    s_lshl_b32 s30, s30, 10
    s_add_u32 s30, s30, s21
    s_add_u32 s30, s30, 0x1b00000
    s_lshl_b32 s32, s31, 10
    s_add_u32 s32, s32, s21
    s_add_u32 s32, s32, 0x1b00000
    v_bfe_u32 v2, v1, 4, 4
    v_lshrrev_b32 v3, 8, v1
    s_lshl_b32 s33, s20, 2
    s_lshr_b32 s33, 0x3362, s33
    s_and_b32 s33, s33, 15
    s_min_u32 s34, s20, 1
    s_add_u32 s34, s34, 4
    s_lshl_b32 s36, s33, 10
    s_lshl_b32 s37, s34, 10
    v_add_u32 v247, 64512, v1
    v_add_u32 v248, 131072, v1
    v_add_u32 v249, s36, v1
    v_add_u32 v250, s36, v247
    v_add_u32 v251, s37, v1
    v_add_u32 v252, s37, v247
    v_add_u32 v253, 18432, v1
    v_lshrrev_b32 v0, 1, v1
    s_add_u32 s38, s29, 0
    s_add_u32 s39, s29, 4096
    s_add_u32 s40, s29, 8192
    s_add_u32 s41, s29, 12288
    s_add_u32 s42, s29, 16384
    s_max_u32 s44, s23, 1
    s_sub_u32 s44, s44, 1
    s_lshl_b32 s52, s22, 7
    s_add_u32 s52, s52, s23
    s_lshl_b32 s52, s52, 8
    s_add_u32 s52, s52, 0x4503000
    s_add_u32 s52, s52, s4
    s_addc_u32 s53, s5, 0
    s_lshl_b32 s54, s22, 7
    s_add_u32 s54, s54, s44
    s_lshl_b32 s54, s54, 8
    s_add_u32 s54, s54, 0x4503000
    s_add_u32 s54, s54, s4
    s_addc_u32 s55, s5, 0
    s_lshl_b32 s44, s24, 8
    s_add_u32 s44, s44, 0x4500000
    s_add_u32 s44, s44, s4
    s_addc_u32 s45, s5, 0
    s_waitcnt vmcnt(0)
    s_barrier
    s_cmp_lg_u32 s20, 0
    s_cbranch_scc1 L_ns_d1
    s_cmp_eq_u32 s22, 0
    s_cbranch_scc1 L_d1_first
    s_mov_b32 s56, 1
    s_atomic_add s56, s[50:51], 0
L_ns_d1:
    s_barrier
    s_cmp_lg_u32 s20, 0
    s_cbranch_scc1 L_pd_d1
    s_mov_b32 s60, 65536
L_poll_d1:
    s_mov_b32 s57, 0
    s_atomic_add s57, s[52:53], 0 glc
    s_mov_b32 s58, 0
    s_atomic_add s58, s[54:55], 0 glc
    s_mov_b32 s59, 0
    s_atomic_add s59, s[44:45], 0 glc
    s_waitcnt lgkmcnt(0)
    s_cmp_ge_u32 s59, 108
    s_cselect_b32 s59, 16, 0
    s_min_u32 s57, s57, s58
    s_min_u32 s57, s57, s59
    s_cmp_ge_u32 s57, 16
    s_cbranch_scc1 L_pd_d1
    s_sub_u32 s60, s60, 1
    s_cbranch_scc1 L_pd_d1
    s_sleep 2
    s_branch L_poll_d1
L_pd_d1:
    s_barrier
    buffer_load_dwordx4 v[160:163], v1, s[4:7], s38 offen offset:0 sc1
    buffer_load_dwordx4 v[164:167], v253, s[4:7], s38 offen offset:0 sc1
    buffer_load_dwordx4 v[168:171], v1, s[4:7], s38 offen offset:1024 sc1
    buffer_load_dwordx4 v[172:175], v253, s[4:7], s38 offen offset:1024 sc1
    buffer_load_dwordx4 v[176:179], v1, s[4:7], s38 offen offset:2048 sc1
    buffer_load_dwordx4 v[180:183], v253, s[4:7], s38 offen offset:2048 sc1
    buffer_load_dwordx4 v[184:187], v1, s[4:7], s38 offen offset:3072 sc1
    buffer_load_dwordx4 v[188:191], v253, s[4:7], s38 offen offset:3072 sc1
    s_barrier
    ds_read_b128 v[80:83], v1 offset:0
    ds_read_b128 v[84:87], v1 offset:1024
    ds_read_b128 v[88:91], v1 offset:2048
    ds_read_b128 v[92:95], v1 offset:3072
    ds_read_b128 v[96:99], v1 offset:4096
    ds_read_b128 v[100:103], v1 offset:5120
    ds_read_b128 v[104:107], v1 offset:6144
    buffer_load_dwordx2 v[4:5], v0, s[4:7], s30 offen offset:0 sc1
    buffer_load_dwordx2 v[6:7], v0, s[4:7], s30 offen offset:512 sc1
    buffer_load_dwordx2 v[8:9], v0, s[4:7], s32 offen offset:0 sc1
    buffer_load_dwordx2 v[10:11], v0, s[4:7], s32 offen offset:512 sc1
    buffer_load_dwordx2 v[12:13], v0, s[4:7], s32 offen offset:1024 sc1
    buffer_load_dwordx2 v[14:15], v0, s[4:7], s32 offen offset:1536 sc1
    s_lshl_b32 s50, s22, 7
    s_add_u32 s50, s50, s23
    s_lshl_b32 s50, s50, 8
    s_add_u32 s50, s50, 0x4508000
    s_add_u32 s50, s50, s4
    s_addc_u32 s51, s5, 0
    s_waitcnt vmcnt(12) lgkmcnt(3)
    v_mfma_f32_16x16x32_bf16 v[16:19], v[80:83], v[160:163], 0
    ds_read_b128 v[120:123], v1 offset:7168
    v_mfma_f32_16x16x32_bf16 v[44:47], v[80:83], v[164:167], 0
    ds_read_b128 v[124:127], v1 offset:8192
    v_mfma_f32_16x16x32_bf16 v[20:23], v[84:87], v[160:163], 0
    ds_read_b128 v[128:131], v1 offset:9216
    v_mfma_f32_16x16x32_bf16 v[48:51], v[84:87], v[164:167], 0
    ds_read_b128 v[132:135], v1 offset:10240
    v_mfma_f32_16x16x32_bf16 v[24:27], v[88:91], v[160:163], 0
    ds_read_b128 v[136:139], v1 offset:11264
    v_mfma_f32_16x16x32_bf16 v[52:55], v[88:91], v[164:167], 0
    ds_read_b128 v[140:143], v1 offset:12288
    v_mfma_f32_16x16x32_bf16 v[28:31], v[92:95], v[160:163], 0
    ds_read_b128 v[144:147], v1 offset:13312
    v_mfma_f32_16x16x32_bf16 v[56:59], v[92:95], v[164:167], 0
    s_waitcnt lgkmcnt(7)
    v_mfma_f32_16x16x32_bf16 v[32:35], v[160:163], v[96:99], 0
    v_mfma_f32_16x16x32_bf16 v[60:63], v[164:167], v[96:99], 0
    v_mfma_f32_16x16x32_bf16 v[36:39], v[160:163], v[100:103], 0
    buffer_load_dwordx4 v[192:195], v1, s[4:7], s39 offen offset:0 sc1
    v_mfma_f32_16x16x32_bf16 v[64:67], v[164:167], v[100:103], 0
    buffer_load_dwordx4 v[196:199], v253, s[4:7], s39 offen offset:0 sc1
    v_mfma_f32_16x16x32_bf16 v[40:43], v[104:107], v[160:163], 0
    buffer_load_dwordx4 v[200:203], v1, s[4:7], s39 offen offset:1024 sc1
    v_mfma_f32_16x16x32_bf16 v[68:71], v[104:107], v[164:167], 0
    buffer_load_dwordx4 v[204:207], v253, s[4:7], s39 offen offset:1024 sc1
    s_waitcnt vmcnt(14) lgkmcnt(3)
    s_barrier
    v_mfma_f32_16x16x32_bf16 v[16:19], v[120:123], v[168:171], v[16:19]
    ds_read_b128 v[80:83], v1 offset:14336
    v_mfma_f32_16x16x32_bf16 v[44:47], v[120:123], v[172:175], v[44:47]
    ds_read_b128 v[84:87], v1 offset:15360
    v_mfma_f32_16x16x32_bf16 v[20:23], v[124:127], v[168:171], v[20:23]
    ds_read_b128 v[88:91], v1 offset:16384
    v_mfma_f32_16x16x32_bf16 v[48:51], v[124:127], v[172:175], v[48:51]
    ds_read_b128 v[92:95], v1 offset:17408
    v_mfma_f32_16x16x32_bf16 v[24:27], v[128:131], v[168:171], v[24:27]
    ds_read_b128 v[96:99], v1 offset:18432
    v_mfma_f32_16x16x32_bf16 v[52:55], v[128:131], v[172:175], v[52:55]
    ds_read_b128 v[100:103], v1 offset:19456
    v_mfma_f32_16x16x32_bf16 v[28:31], v[132:135], v[168:171], v[28:31]
    ds_read_b128 v[104:107], v1 offset:20480
    v_mfma_f32_16x16x32_bf16 v[56:59], v[132:135], v[172:175], v[56:59]
    ds_read_b128 v[108:111], v248 offset:0
    s_waitcnt lgkmcnt(8)
    v_mfma_f32_16x16x32_bf16 v[32:35], v[168:171], v[136:139], v[32:35]
    ds_read_b128 v[112:115], v249 offset:0
    v_mfma_f32_16x16x32_bf16 v[60:63], v[172:175], v[136:139], v[60:63]
    ds_read_b128 v[116:119], v251 offset:0
    v_mfma_f32_16x16x32_bf16 v[36:39], v[168:171], v[140:143], v[36:39]
    buffer_load_dwordx4 v[160:163], v1, s[4:7], s39 offen offset:2048 sc1
    v_mfma_f32_16x16x32_bf16 v[64:67], v[172:175], v[140:143], v[64:67]
    buffer_load_dwordx4 v[164:167], v253, s[4:7], s39 offen offset:2048 sc1
    v_mfma_f32_16x16x32_bf16 v[40:43], v[144:147], v[168:171], v[40:43]
    v_mfma_f32_16x16x32_bf16 v[68:71], v[144:147], v[172:175], v[68:71]
    s_waitcnt vmcnt(6) lgkmcnt(6)
    v_mfma_f32_16x16x32_bf16 v[16:19], v[80:83], v[176:179], v[16:19]
    ds_read_b128 v[120:123], v1 offset:21504
    v_mfma_f32_16x16x32_bf16 v[44:47], v[80:83], v[180:183], v[44:47]
    ds_read_b128 v[124:127], v1 offset:22528
    v_add_f32 v240, v4, v6
    v_mfma_f32_16x16x32_bf16 v[20:23], v[84:87], v[176:179], v[20:23]
    ds_read_b128 v[128:131], v1 offset:23552
    v_add_f32 v241, v5, v7
    v_mfma_f32_16x16x32_bf16 v[48:51], v[84:87], v[180:183], v[48:51]
    ds_read_b128 v[132:135], v1 offset:24576
    v_add_f32 v242, v8, v10
    v_mfma_f32_16x16x32_bf16 v[24:27], v[88:91], v[176:179], v[24:27]
    ds_read_b128 v[136:139], v1 offset:25600
    v_add_f32 v243, v9, v11
    v_mfma_f32_16x16x32_bf16 v[52:55], v[88:91], v[180:183], v[52:55]
    ds_read_b128 v[140:143], v1 offset:26624
    v_add_f32 v244, v12, v14
    v_mfma_f32_16x16x32_bf16 v[28:31], v[92:95], v[176:179], v[28:31]
    ds_read_b128 v[144:147], v1 offset:27648
    v_add_f32 v245, v13, v15
    v_mfma_f32_16x16x32_bf16 v[56:59], v[92:95], v[180:183], v[56:59]
    ds_read_b128 v[148:151], v248 offset:1024
    s_waitcnt lgkmcnt(8)
    v_mfma_f32_16x16x32_bf16 v[32:35], v[176:179], v[96:99], v[32:35]
    ds_read_b128 v[152:155], v249 offset:7168
    v_mov_b32 v4, v240
    v_mfma_f32_16x16x32_bf16 v[60:63], v[180:183], v[96:99], v[60:63]
    ds_read_b128 v[156:159], v251 offset:7168
    v_mov_b32 v5, v241
    v_mfma_f32_16x16x32_bf16 v[36:39], v[176:179], v[100:103], v[36:39]
    buffer_load_dwordx4 v[168:171], v1, s[4:7], s39 offen offset:3072 sc1
    v_mfma_f32_16x16x32_bf16 v[64:67], v[180:183], v[100:103], v[64:67]
    buffer_load_dwordx4 v[172:175], v253, s[4:7], s39 offen offset:3072 sc1
    v_mfma_f32_16x16x32_bf16 v[40:43], v[104:107], v[176:179], v[40:43]
    v_mov_b32 v8, v242
    v_mfma_f32_16x16x32_bf16 v[68:71], v[104:107], v[180:183], v[68:71]
    v_mov_b32 v9, v243
    v_mfma_f32_16x16x32_bf16 v[72:75], v[112:115], v[108:111], 0
    v_mov_b32 v12, v244
    v_mov_b32 v13, v245
    v_mfma_f32_16x16x32_bf16 v[76:79], v[108:111], v[116:119], 0
    v_permlane32_swap_b32 v240, v4
    s_waitcnt vmcnt(8) lgkmcnt(6)
    s_barrier
    v_mfma_f32_16x16x32_bf16 v[16:19], v[120:123], v[184:187], v[16:19]
    ds_read_b128 v[80:83], v1 offset:28672
    v_mfma_f32_16x16x32_bf16 v[44:47], v[120:123], v[188:191], v[44:47]
    ds_read_b128 v[84:87], v1 offset:29696
    v_permlane32_swap_b32 v241, v5
    v_mfma_f32_16x16x32_bf16 v[20:23], v[124:127], v[184:187], v[20:23]
    ds_read_b128 v[88:91], v1 offset:30720
    v_permlane32_swap_b32 v242, v8
    v_mfma_f32_16x16x32_bf16 v[48:51], v[124:127], v[188:191], v[48:51]
    ds_read_b128 v[92:95], v1 offset:31744
    v_permlane32_swap_b32 v243, v9
    v_mfma_f32_16x16x32_bf16 v[24:27], v[128:131], v[184:187], v[24:27]
    ds_read_b128 v[96:99], v1 offset:32768
    v_permlane32_swap_b32 v244, v12
    v_mfma_f32_16x16x32_bf16 v[52:55], v[128:131], v[188:191], v[52:55]
    ds_read_b128 v[100:103], v1 offset:33792
    v_permlane32_swap_b32 v245, v13
    v_mfma_f32_16x16x32_bf16 v[28:31], v[132:135], v[184:187], v[28:31]
    ds_read_b128 v[104:107], v1 offset:34816
    v_add_f32 v240, v240, v4
    v_mfma_f32_16x16x32_bf16 v[56:59], v[132:135], v[188:191], v[56:59]
    ds_read_b128 v[108:111], v248 offset:2048
    s_waitcnt lgkmcnt(8)
    v_mfma_f32_16x16x32_bf16 v[32:35], v[184:187], v[136:139], v[32:35]
    ds_read_b128 v[112:115], v249 offset:14336
    v_add_f32 v241, v241, v5
    v_mfma_f32_16x16x32_bf16 v[60:63], v[188:191], v[136:139], v[60:63]
    ds_read_b128 v[116:119], v251 offset:14336
    v_add_f32 v242, v242, v8
    v_mfma_f32_16x16x32_bf16 v[36:39], v[184:187], v[140:143], v[36:39]
    buffer_load_dwordx4 v[176:179], v1, s[4:7], s40 offen offset:0 sc1
    v_mfma_f32_16x16x32_bf16 v[64:67], v[188:191], v[140:143], v[64:67]
    buffer_load_dwordx4 v[180:183], v253, s[4:7], s40 offen offset:0 sc1
    v_mfma_f32_16x16x32_bf16 v[40:43], v[144:147], v[184:187], v[40:43]
    v_add_f32 v243, v243, v9
    v_mfma_f32_16x16x32_bf16 v[68:71], v[144:147], v[188:191], v[68:71]
    v_add_f32 v244, v244, v12
    v_mfma_f32_16x16x32_bf16 v[72:75], v[152:155], v[148:151], v[72:75]
    v_add_f32 v245, v245, v13
    v_mov_b32 v4, v240
    v_mfma_f32_16x16x32_bf16 v[76:79], v[148:151], v[156:159], v[76:79]
    v_mov_b32 v5, v241
    s_waitcnt vmcnt(8) lgkmcnt(6)
    v_mfma_f32_16x16x32_bf16 v[16:19], v[80:83], v[192:195], v[16:19]
    ds_read_b128 v[120:123], v1 offset:35840
    v_mfma_f32_16x16x32_bf16 v[44:47], v[80:83], v[196:199], v[44:47]
    ds_read_b128 v[124:127], v1 offset:36864
    v_mov_b32 v8, v242
    v_mfma_f32_16x16x32_bf16 v[20:23], v[84:87], v[192:195], v[20:23]
    ds_read_b128 v[128:131], v1 offset:37888
    v_mov_b32 v9, v243
    v_mfma_f32_16x16x32_bf16 v[48:51], v[84:87], v[196:199], v[48:51]
    ds_read_b128 v[132:135], v1 offset:38912
    v_mov_b32 v12, v244
    v_mfma_f32_16x16x32_bf16 v[24:27], v[88:91], v[192:195], v[24:27]
    ds_read_b128 v[136:139], v1 offset:39936
    v_mov_b32 v13, v245
    v_mfma_f32_16x16x32_bf16 v[52:55], v[88:91], v[196:199], v[52:55]
    ds_read_b128 v[140:143], v1 offset:40960
    v_permlane16_swap_b32 v240, v4
    v_mfma_f32_16x16x32_bf16 v[28:31], v[92:95], v[192:195], v[28:31]
    ds_read_b128 v[144:147], v1 offset:41984
    v_permlane16_swap_b32 v241, v5
    v_mfma_f32_16x16x32_bf16 v[56:59], v[92:95], v[196:199], v[56:59]
    ds_read_b128 v[148:151], v248 offset:3072
    s_waitcnt lgkmcnt(8)
    v_mfma_f32_16x16x32_bf16 v[32:35], v[192:195], v[96:99], v[32:35]
    ds_read_b128 v[152:155], v249 offset:21504
    v_permlane16_swap_b32 v242, v8
    v_mfma_f32_16x16x32_bf16 v[60:63], v[196:199], v[96:99], v[60:63]
    ds_read_b128 v[156:159], v251 offset:21504
    v_permlane16_swap_b32 v243, v9
    v_mfma_f32_16x16x32_bf16 v[36:39], v[192:195], v[100:103], v[36:39]
    buffer_load_dwordx4 v[184:187], v1, s[4:7], s40 offen offset:1024 sc1
    v_mfma_f32_16x16x32_bf16 v[64:67], v[196:199], v[100:103], v[64:67]
    buffer_load_dwordx4 v[188:191], v253, s[4:7], s40 offen offset:1024 sc1
    v_mfma_f32_16x16x32_bf16 v[40:43], v[104:107], v[192:195], v[40:43]
    v_permlane16_swap_b32 v244, v12
    v_mfma_f32_16x16x32_bf16 v[68:71], v[104:107], v[196:199], v[68:71]
    v_permlane16_swap_b32 v245, v13
    v_mfma_f32_16x16x32_bf16 v[72:75], v[112:115], v[108:111], v[72:75]
    v_add_f32 v240, v240, v4
    v_add_f32 v241, v241, v5
    v_mfma_f32_16x16x32_bf16 v[76:79], v[108:111], v[116:119], v[76:79]
    v_add_f32 v242, v242, v8
    s_waitcnt vmcnt(8) lgkmcnt(6)
    s_barrier
    v_mfma_f32_16x16x32_bf16 v[16:19], v[120:123], v[200:203], v[16:19]
    ds_read_b128 v[80:83], v1 offset:43008
    v_mfma_f32_16x16x32_bf16 v[44:47], v[120:123], v[204:207], v[44:47]
    ds_read_b128 v[84:87], v1 offset:44032
    v_add_f32 v243, v243, v9
    v_mfma_f32_16x16x32_bf16 v[20:23], v[124:127], v[200:203], v[20:23]
    ds_read_b128 v[88:91], v1 offset:45056
    v_add_f32 v244, v244, v12
    v_mfma_f32_16x16x32_bf16 v[48:51], v[124:127], v[204:207], v[48:51]
    ds_read_b128 v[92:95], v1 offset:46080
    v_add_f32 v245, v245, v13
    v_mfma_f32_16x16x32_bf16 v[24:27], v[128:131], v[200:203], v[24:27]
    ds_read_b128 v[96:99], v1 offset:47104
    v_mul_f32 v240, 0x3ae38e39, v240
    v_mfma_f32_16x16x32_bf16 v[52:55], v[128:131], v[204:207], v[52:55]
    ds_read_b128 v[100:103], v1 offset:48128
    v_mul_f32 v241, 0x3ae38e39, v241
    v_mfma_f32_16x16x32_bf16 v[28:31], v[132:135], v[200:203], v[28:31]
    ds_read_b128 v[104:107], v1 offset:49152
    v_mul_f32 v242, 0x3ae38e39, v242
    v_mfma_f32_16x16x32_bf16 v[56:59], v[132:135], v[204:207], v[56:59]
    ds_read_b128 v[108:111], v248 offset:4096
    s_waitcnt lgkmcnt(8)
    v_mfma_f32_16x16x32_bf16 v[32:35], v[200:203], v[136:139], v[32:35]
    ds_read_b128 v[112:115], v249 offset:28672
    v_mul_f32 v243, 0x3ae38e39, v243
    v_mfma_f32_16x16x32_bf16 v[60:63], v[204:207], v[136:139], v[60:63]
    ds_read_b128 v[116:119], v251 offset:28672
    v_mul_f32 v244, 0x3ae38e39, v244
    v_mfma_f32_16x16x32_bf16 v[36:39], v[200:203], v[140:143], v[36:39]
    buffer_load_dwordx4 v[192:195], v1, s[4:7], s40 offen offset:2048 sc1
    v_mfma_f32_16x16x32_bf16 v[64:67], v[204:207], v[140:143], v[64:67]
    buffer_load_dwordx4 v[196:199], v253, s[4:7], s40 offen offset:2048 sc1
    v_mfma_f32_16x16x32_bf16 v[40:43], v[144:147], v[200:203], v[40:43]
    v_mul_f32 v245, 0x3ae38e39, v245
    v_mfma_f32_16x16x32_bf16 v[68:71], v[144:147], v[204:207], v[68:71]
    v_fma_f32 v241, -v240, v240, v241
    v_mfma_f32_16x16x32_bf16 v[72:75], v[152:155], v[148:151], v[72:75]
    v_fma_f32 v243, -v242, v242, v243
    v_fma_f32 v245, -v244, v244, v245
    v_mfma_f32_16x16x32_bf16 v[76:79], v[148:151], v[156:159], v[76:79]
    v_max_f32 v241, 0, v241
    s_waitcnt vmcnt(8) lgkmcnt(6)
    v_mfma_f32_16x16x32_bf16 v[16:19], v[80:83], v[160:163], v[16:19]
    ds_read_b128 v[120:123], v1 offset:50176
    v_mfma_f32_16x16x32_bf16 v[44:47], v[80:83], v[164:167], v[44:47]
    ds_read_b128 v[124:127], v1 offset:51200
    v_max_f32 v243, 0, v243
    v_mfma_f32_16x16x32_bf16 v[20:23], v[84:87], v[160:163], v[20:23]
    ds_read_b128 v[128:131], v1 offset:52224
    v_max_f32 v245, 0, v245
    v_mfma_f32_16x16x32_bf16 v[48:51], v[84:87], v[164:167], v[48:51]
    ds_read_b128 v[132:135], v1 offset:53248
    v_add_f32 v241, 0x3727c5ac, v241
    v_mfma_f32_16x16x32_bf16 v[24:27], v[88:91], v[160:163], v[24:27]
    ds_read_b128 v[136:139], v1 offset:54272
    v_add_f32 v243, 0x3727c5ac, v243
    v_mfma_f32_16x16x32_bf16 v[52:55], v[88:91], v[164:167], v[52:55]
    ds_read_b128 v[140:143], v1 offset:55296
    v_add_f32 v245, 0x3727c5ac, v245
    v_mfma_f32_16x16x32_bf16 v[28:31], v[92:95], v[160:163], v[28:31]
    ds_read_b128 v[144:147], v1 offset:56320
    v_rsq_f32 v241, v241
    v_mfma_f32_16x16x32_bf16 v[56:59], v[92:95], v[164:167], v[56:59]
    ds_read_b128 v[148:151], v248 offset:5120
    s_waitcnt lgkmcnt(8)
    v_mfma_f32_16x16x32_bf16 v[32:35], v[160:163], v[96:99], v[32:35]
    ds_read_b128 v[152:155], v249 offset:35840
    v_rsq_f32 v243, v243
    v_mfma_f32_16x16x32_bf16 v[60:63], v[164:167], v[96:99], v[60:63]
    ds_read_b128 v[156:159], v251 offset:35840
    v_rsq_f32 v245, v245
    v_mfma_f32_16x16x32_bf16 v[36:39], v[160:163], v[100:103], v[36:39]
    buffer_load_dwordx4 v[200:203], v1, s[4:7], s40 offen offset:3072 sc1
    v_mfma_f32_16x16x32_bf16 v[64:67], v[164:167], v[100:103], v[64:67]
    buffer_load_dwordx4 v[204:207], v253, s[4:7], s40 offen offset:3072 sc1
    v_mfma_f32_16x16x32_bf16 v[40:43], v[104:107], v[160:163], v[40:43]
    s_nop 0
    v_mfma_f32_16x16x32_bf16 v[68:71], v[104:107], v[164:167], v[68:71]
    v_lshlrev_b32 v255, 4, v3
    v_mfma_f32_16x16x32_bf16 v[72:75], v[112:115], v[108:111], v[72:75]
    v_add_u32 v236, 161792, v255
    s_lshl_b32 s36, s33, 6
    v_mfma_f32_16x16x32_bf16 v[76:79], v[108:111], v[116:119], v[76:79]
    v_add_u32 v237, s36, v236
    s_waitcnt vmcnt(8) lgkmcnt(6)
    v_mfma_f32_16x16x32_bf16 v[16:19], v[120:123], v[168:171], v[16:19]
    ds_read_b128 v[80:83], v1 offset:57344
    v_mfma_f32_16x16x32_bf16 v[44:47], v[120:123], v[172:175], v[44:47]
    ds_read_b128 v[84:87], v1 offset:58368
    v_lshlrev_b32 v254, 2, v2
    v_mfma_f32_16x16x32_bf16 v[20:23], v[124:127], v[168:171], v[20:23]
    ds_read_b128 v[88:91], v1 offset:59392
    v_add_u32 v238, 161792, v254
    v_mfma_f32_16x16x32_bf16 v[48:51], v[124:127], v[172:175], v[48:51]
    ds_read_b128 v[92:95], v1 offset:60416
    s_lshl_b32 s37, s34, 6
    v_mfma_f32_16x16x32_bf16 v[24:27], v[128:131], v[168:171], v[24:27]
    ds_read_b128 v[96:99], v1 offset:61440
    v_add_u32 v239, s37, v238
    v_mfma_f32_16x16x32_bf16 v[52:55], v[128:131], v[172:175], v[52:55]
    ds_read_b128 v[100:103], v1 offset:62464
    s_mul_i32 s36, s20, 3072
    v_mfma_f32_16x16x32_bf16 v[28:31], v[132:135], v[168:171], v[28:31]
    ds_read_b128 v[104:107], v1 offset:63488
    s_add_u32 s36, s36, 153600
    v_mfma_f32_16x16x32_bf16 v[56:59], v[132:135], v[172:175], v[56:59]
    ds_read_b128 v[108:111], v248 offset:6144
    s_waitcnt lgkmcnt(8)
    v_mfma_f32_16x16x32_bf16 v[32:35], v[168:171], v[136:139], v[32:35]
    ds_read_b128 v[112:115], v249 offset:43008
    v_add_u32 v254, s36, v254
    v_mfma_f32_16x16x32_bf16 v[60:63], v[172:175], v[136:139], v[60:63]
    ds_read_b128 v[116:119], v251 offset:43008
    v_add_u32 v255, s36, v255
    v_mfma_f32_16x16x32_bf16 v[36:39], v[168:171], v[140:143], v[36:39]
    buffer_load_dwordx4 v[160:163], v1, s[4:7], s41 offen offset:0 sc1
    v_mfma_f32_16x16x32_bf16 v[64:67], v[172:175], v[140:143], v[64:67]
    buffer_load_dwordx4 v[164:167], v253, s[4:7], s41 offen offset:0 sc1
    v_mfma_f32_16x16x32_bf16 v[40:43], v[144:147], v[168:171], v[40:43]
    v_mfma_f32_16x16x32_bf16 v[68:71], v[144:147], v[172:175], v[68:71]
    ds_write2_b32 v254, v240, v241 offset0:0 offset1:16
    v_mfma_f32_16x16x32_bf16 v[72:75], v[152:155], v[148:151], v[72:75]
    ds_write2_b32 v254, v242, v243 offset0:32 offset1:48
    v_mfma_f32_16x16x32_bf16 v[76:79], v[148:151], v[156:159], v[76:79]
    ds_write2_b32 v254, v244, v245 offset0:64 offset1:80
    s_waitcnt vmcnt(8) lgkmcnt(9)
    s_barrier
    v_mfma_f32_16x16x32_bf16 v[16:19], v[80:83], v[176:179], v[16:19]
    ds_read_b128 v[120:123], v247 offset:0
    v_mfma_f32_16x16x32_bf16 v[44:47], v[80:83], v[180:183], v[44:47]
    ds_read_b128 v[124:127], v247 offset:1024
    v_mfma_f32_16x16x32_bf16 v[20:23], v[84:87], v[176:179], v[20:23]
    ds_read_b128 v[128:131], v247 offset:2048
    v_mfma_f32_16x16x32_bf16 v[48:51], v[84:87], v[180:183], v[48:51]
    ds_read_b128 v[132:135], v247 offset:3072
    v_mfma_f32_16x16x32_bf16 v[24:27], v[88:91], v[176:179], v[24:27]
    ds_read_b128 v[136:139], v247 offset:4096
    v_mfma_f32_16x16x32_bf16 v[52:55], v[88:91], v[180:183], v[52:55]
    ds_read_b128 v[140:143], v247 offset:5120
    v_mfma_f32_16x16x32_bf16 v[28:31], v[92:95], v[176:179], v[28:31]
    ds_read_b128 v[144:147], v247 offset:6144
    v_mfma_f32_16x16x32_bf16 v[56:59], v[92:95], v[180:183], v[56:59]
    ds_read_b128 v[148:151], v248 offset:7168
    s_waitcnt lgkmcnt(8)
    v_mfma_f32_16x16x32_bf16 v[32:35], v[176:179], v[96:99], v[32:35]
    ds_read_b128 v[152:155], v249 offset:50176
    v_mfma_f32_16x16x32_bf16 v[60:63], v[180:183], v[96:99], v[60:63]
    ds_read_b128 v[156:159], v251 offset:50176
    v_mfma_f32_16x16x32_bf16 v[36:39], v[176:179], v[100:103], v[36:39]
    buffer_load_dwordx4 v[168:171], v1, s[4:7], s41 offen offset:1024 sc1
    ds_read_b128 v[208:211], v236 offset:0
    v_mfma_f32_16x16x32_bf16 v[64:67], v[180:183], v[100:103], v[64:67]
    buffer_load_dwordx4 v[172:175], v253, s[4:7], s41 offen offset:1024 sc1
    ds_read_b128 v[212:215], v236 offset:64
    v_mfma_f32_16x16x32_bf16 v[40:43], v[104:107], v[176:179], v[40:43]
    ds_read_b128 v[216:219], v236 offset:128
    v_mfma_f32_16x16x32_bf16 v[68:71], v[104:107], v[180:183], v[68:71]
    ds_read_b128 v[220:223], v236 offset:192
    v_mfma_f32_16x16x32_bf16 v[72:75], v[112:115], v[108:111], v[72:75]
    ds_read_b128 v[224:227], v236 offset:384
    v_mfma_f32_16x16x32_bf16 v[76:79], v[108:111], v[116:119], v[76:79]
    ds_read_b128 v[228:231], v237
    s_waitcnt vmcnt(8) lgkmcnt(12)
    v_mfma_f32_16x16x32_bf16 v[16:19], v[120:123], v[184:187], v[16:19]
    ds_read_b128 v[80:83], v247 offset:7168
    v_mfma_f32_16x16x32_bf16 v[44:47], v[120:123], v[188:191], v[44:47]
    ds_read_b128 v[84:87], v247 offset:8192
    v_mfma_f32_16x16x32_bf16 v[20:23], v[124:127], v[184:187], v[20:23]
    ds_read_b128 v[88:91], v247 offset:9216
    v_mfma_f32_16x16x32_bf16 v[48:51], v[124:127], v[188:191], v[48:51]
    ds_read_b128 v[92:95], v247 offset:10240
    v_mfma_f32_16x16x32_bf16 v[24:27], v[128:131], v[184:187], v[24:27]
    ds_read_b128 v[96:99], v247 offset:11264
    v_mfma_f32_16x16x32_bf16 v[52:55], v[128:131], v[188:191], v[52:55]
    ds_read_b128 v[100:103], v247 offset:12288
    v_mfma_f32_16x16x32_bf16 v[28:31], v[132:135], v[184:187], v[28:31]
    ds_read_b128 v[104:107], v247 offset:13312
    v_mfma_f32_16x16x32_bf16 v[56:59], v[132:135], v[188:191], v[56:59]
    ds_read_b128 v[108:111], v248 offset:8192
    s_waitcnt lgkmcnt(8)
    v_mfma_f32_16x16x32_bf16 v[32:35], v[184:187], v[136:139], v[32:35]
    ds_read_b128 v[112:115], v249 offset:57344
    v_mfma_f32_16x16x32_bf16 v[60:63], v[188:191], v[136:139], v[60:63]
    ds_read_b128 v[116:119], v251 offset:57344
    v_mfma_f32_16x16x32_bf16 v[36:39], v[184:187], v[140:143], v[36:39]
    buffer_load_dwordx4 v[176:179], v1, s[4:7], s41 offen offset:2048 sc1
    v_mfma_f32_16x16x32_bf16 v[64:67], v[188:191], v[140:143], v[64:67]
    buffer_load_dwordx4 v[180:183], v253, s[4:7], s41 offen offset:2048 sc1
    ds_read2_b32 v[232:233], v238 offset0:64 offset1:80
    v_mfma_f32_16x16x32_bf16 v[40:43], v[144:147], v[184:187], v[40:43]
    ds_read_b32 v234, v239
    v_mfma_f32_16x16x32_bf16 v[68:71], v[144:147], v[188:191], v[68:71]
    ds_read_b128 v[4:7], v255 offset:0
    v_mfma_f32_16x16x32_bf16 v[72:75], v[152:155], v[148:151], v[72:75]
    ds_read_b128 v[8:11], v255 offset:128
    v_mfma_f32_16x16x32_bf16 v[76:79], v[148:151], v[156:159], v[76:79]
    ds_read_b128 v[12:15], v255 offset:256
    s_waitcnt vmcnt(8) lgkmcnt(11)
    s_barrier
    v_mfma_f32_16x16x32_bf16 v[16:19], v[80:83], v[192:195], v[16:19]
    ds_read_b128 v[120:123], v247 offset:14336
    v_mfma_f32_16x16x32_bf16 v[44:47], v[80:83], v[196:199], v[44:47]
    ds_read_b128 v[124:127], v247 offset:15360
    v_mfma_f32_16x16x32_bf16 v[20:23], v[84:87], v[192:195], v[20:23]
    ds_read_b128 v[128:131], v247 offset:16384
    v_mfma_f32_16x16x32_bf16 v[48:51], v[84:87], v[196:199], v[48:51]
    ds_read_b128 v[132:135], v247 offset:17408
    v_mfma_f32_16x16x32_bf16 v[24:27], v[88:91], v[192:195], v[24:27]
    ds_read_b128 v[136:139], v247 offset:18432
    v_mfma_f32_16x16x32_bf16 v[52:55], v[88:91], v[196:199], v[52:55]
    ds_read_b128 v[140:143], v247 offset:19456
    v_mfma_f32_16x16x32_bf16 v[28:31], v[92:95], v[192:195], v[28:31]
    ds_read_b128 v[144:147], v247 offset:20480
    v_mfma_f32_16x16x32_bf16 v[56:59], v[92:95], v[196:199], v[56:59]
    ds_read_b128 v[148:151], v248 offset:9216
    s_waitcnt lgkmcnt(8)
    v_mfma_f32_16x16x32_bf16 v[32:35], v[192:195], v[96:99], v[32:35]
    ds_read_b128 v[152:155], v250 offset:0
    v_mfma_f32_16x16x32_bf16 v[60:63], v[196:199], v[96:99], v[60:63]
    ds_read_b128 v[156:159], v252 offset:0
    v_mfma_f32_16x16x32_bf16 v[36:39], v[192:195], v[100:103], v[36:39]
    buffer_load_dwordx4 v[184:187], v1, s[4:7], s41 offen offset:3072 sc1
    v_mfma_f32_16x16x32_bf16 v[64:67], v[196:199], v[100:103], v[64:67]
    buffer_load_dwordx4 v[188:191], v253, s[4:7], s41 offen offset:3072 sc1
    v_mfma_f32_16x16x32_bf16 v[40:43], v[104:107], v[192:195], v[40:43]
    v_mfma_f32_16x16x32_bf16 v[68:71], v[104:107], v[196:199], v[68:71]
    v_mfma_f32_16x16x32_bf16 v[72:75], v[112:115], v[108:111], v[72:75]
    v_mfma_f32_16x16x32_bf16 v[76:79], v[108:111], v[116:119], v[76:79]
    s_waitcnt vmcnt(8) lgkmcnt(6)
    v_mfma_f32_16x16x32_bf16 v[16:19], v[120:123], v[200:203], v[16:19]
    ds_read_b128 v[80:83], v247 offset:21504
    v_fma_f32 v32, -v8, v232, v32
    v_mfma_f32_16x16x32_bf16 v[44:47], v[120:123], v[204:207], v[44:47]
    ds_read_b128 v[84:87], v247 offset:22528
    v_fma_f32 v60, -v12, v232, v60
    v_mfma_f32_16x16x32_bf16 v[20:23], v[124:127], v[200:203], v[20:23]
    ds_read_b128 v[88:91], v247 offset:23552
    v_fma_f32 v36, -v8, v233, v36
    v_mfma_f32_16x16x32_bf16 v[48:51], v[124:127], v[204:207], v[48:51]
    ds_read_b128 v[92:95], v247 offset:24576
    v_fma_f32 v64, -v12, v233, v64
    v_mfma_f32_16x16x32_bf16 v[24:27], v[128:131], v[200:203], v[24:27]
    ds_read_b128 v[96:99], v247 offset:25600
    v_fma_f32 v40, -v242, v224, v40
    v_mfma_f32_16x16x32_bf16 v[52:55], v[128:131], v[204:207], v[52:55]
    ds_read_b128 v[100:103], v247 offset:26624
    v_fma_f32 v68, -v244, v224, v68
    v_mfma_f32_16x16x32_bf16 v[28:31], v[132:135], v[200:203], v[28:31]
    ds_read_b128 v[104:107], v247 offset:27648
    v_fma_f32 v72, -v240, v228, v72
    v_mfma_f32_16x16x32_bf16 v[56:59], v[132:135], v[204:207], v[56:59]
    ds_read_b128 v[108:111], v248 offset:10240
    s_waitcnt lgkmcnt(8)
    v_fma_f32 v76, -v4, v234, v76
    v_mfma_f32_16x16x32_bf16 v[32:35], v[200:203], v[136:139], v[32:35]
    ds_read_b128 v[112:115], v250 offset:7168
    v_fma_f32 v16, -v242, v208, v16
    v_mfma_f32_16x16x32_bf16 v[60:63], v[204:207], v[136:139], v[60:63]
    ds_read_b128 v[116:119], v252 offset:7168
    v_fma_f32 v44, -v244, v208, v44
    v_mfma_f32_16x16x32_bf16 v[36:39], v[200:203], v[140:143], v[36:39]
    buffer_load_dwordx4 v[192:195], v1, s[4:7], s42 offen offset:0 sc1
    v_fma_f32 v20, -v242, v212, v20
    v_mfma_f32_16x16x32_bf16 v[64:67], v[204:207], v[140:143], v[64:67]
    buffer_load_dwordx4 v[196:199], v253, s[4:7], s42 offen offset:0 sc1
    v_fma_f32 v48, -v244, v212, v48
    v_mfma_f32_16x16x32_bf16 v[40:43], v[144:147], v[200:203], v[40:43]
    v_fma_f32 v24, -v242, v216, v24
    v_mfma_f32_16x16x32_bf16 v[68:71], v[144:147], v[204:207], v[68:71]
    v_fma_f32 v52, -v244, v216, v52
    v_mfma_f32_16x16x32_bf16 v[72:75], v[152:155], v[148:151], v[72:75]
    v_fma_f32 v28, -v242, v220, v28
    v_mfma_f32_16x16x32_bf16 v[76:79], v[148:151], v[156:159], v[76:79]
    v_fma_f32 v56, -v244, v220, v56
    s_waitcnt vmcnt(8) lgkmcnt(6)
    s_barrier
    v_mfma_f32_16x16x32_bf16 v[16:19], v[80:83], v[160:163], v[16:19]
    ds_read_b128 v[120:123], v247 offset:28672
    v_fma_f32 v33, -v9, v232, v33
    v_mfma_f32_16x16x32_bf16 v[44:47], v[80:83], v[164:167], v[44:47]
    ds_read_b128 v[124:127], v247 offset:29696
    v_fma_f32 v61, -v13, v232, v61
    v_mfma_f32_16x16x32_bf16 v[20:23], v[84:87], v[160:163], v[20:23]
    ds_read_b128 v[128:131], v247 offset:30720
    v_fma_f32 v37, -v9, v233, v37
    v_mfma_f32_16x16x32_bf16 v[48:51], v[84:87], v[164:167], v[48:51]
    ds_read_b128 v[132:135], v247 offset:31744
    v_fma_f32 v65, -v13, v233, v65
    v_mfma_f32_16x16x32_bf16 v[24:27], v[88:91], v[160:163], v[24:27]
    ds_read_b128 v[136:139], v247 offset:32768
    v_fma_f32 v41, -v242, v225, v41
    v_mfma_f32_16x16x32_bf16 v[52:55], v[88:91], v[164:167], v[52:55]
    ds_read_b128 v[140:143], v247 offset:33792
    v_fma_f32 v69, -v244, v225, v69
    v_mfma_f32_16x16x32_bf16 v[28:31], v[92:95], v[160:163], v[28:31]
    ds_read_b128 v[144:147], v247 offset:34816
    v_fma_f32 v73, -v240, v229, v73
    v_mfma_f32_16x16x32_bf16 v[56:59], v[92:95], v[164:167], v[56:59]
    ds_read_b128 v[148:151], v248 offset:11264
    s_waitcnt lgkmcnt(8)
    v_fma_f32 v77, -v5, v234, v77
    v_mfma_f32_16x16x32_bf16 v[32:35], v[160:163], v[96:99], v[32:35]
    ds_read_b128 v[152:155], v250 offset:14336
    v_fma_f32 v17, -v242, v209, v17
    v_mfma_f32_16x16x32_bf16 v[60:63], v[164:167], v[96:99], v[60:63]
    ds_read_b128 v[156:159], v252 offset:14336
    v_fma_f32 v45, -v244, v209, v45
    v_mfma_f32_16x16x32_bf16 v[36:39], v[160:163], v[100:103], v[36:39]
    buffer_load_dwordx4 v[200:203], v1, s[4:7], s42 offen offset:1024 sc1
    v_fma_f32 v21, -v242, v213, v21
    v_mfma_f32_16x16x32_bf16 v[64:67], v[164:167], v[100:103], v[64:67]
    buffer_load_dwordx4 v[204:207], v253, s[4:7], s42 offen offset:1024 sc1
    v_fma_f32 v49, -v244, v213, v49
    v_mfma_f32_16x16x32_bf16 v[40:43], v[104:107], v[160:163], v[40:43]
    v_fma_f32 v25, -v242, v217, v25
    v_mfma_f32_16x16x32_bf16 v[68:71], v[104:107], v[164:167], v[68:71]
    v_fma_f32 v53, -v244, v217, v53
    v_mfma_f32_16x16x32_bf16 v[72:75], v[112:115], v[108:111], v[72:75]
    v_fma_f32 v29, -v242, v221, v29
    v_mfma_f32_16x16x32_bf16 v[76:79], v[108:111], v[116:119], v[76:79]
    v_fma_f32 v57, -v244, v221, v57
    s_waitcnt vmcnt(8) lgkmcnt(6)
    v_mfma_f32_16x16x32_bf16 v[16:19], v[120:123], v[168:171], v[16:19]
    ds_read_b128 v[80:83], v247 offset:35840
    v_fma_f32 v34, -v10, v232, v34
    v_mfma_f32_16x16x32_bf16 v[44:47], v[120:123], v[172:175], v[44:47]
    ds_read_b128 v[84:87], v247 offset:36864
    v_fma_f32 v62, -v14, v232, v62
    v_mfma_f32_16x16x32_bf16 v[20:23], v[124:127], v[168:171], v[20:23]
    ds_read_b128 v[88:91], v247 offset:37888
    v_fma_f32 v38, -v10, v233, v38
    v_mfma_f32_16x16x32_bf16 v[48:51], v[124:127], v[172:175], v[48:51]
    ds_read_b128 v[92:95], v247 offset:38912
    v_fma_f32 v66, -v14, v233, v66
    v_mfma_f32_16x16x32_bf16 v[24:27], v[128:131], v[168:171], v[24:27]
    ds_read_b128 v[96:99], v247 offset:39936
    v_fma_f32 v42, -v242, v226, v42
    v_mfma_f32_16x16x32_bf16 v[52:55], v[128:131], v[172:175], v[52:55]
    ds_read_b128 v[100:103], v247 offset:40960
    v_fma_f32 v70, -v244, v226, v70
    v_mfma_f32_16x16x32_bf16 v[28:31], v[132:135], v[168:171], v[28:31]
    ds_read_b128 v[104:107], v247 offset:41984
    v_fma_f32 v74, -v240, v230, v74
    v_mfma_f32_16x16x32_bf16 v[56:59], v[132:135], v[172:175], v[56:59]
    ds_read_b128 v[108:111], v248 offset:12288
    s_waitcnt lgkmcnt(8)
    v_fma_f32 v78, -v6, v234, v78
    v_mfma_f32_16x16x32_bf16 v[32:35], v[168:171], v[136:139], v[32:35]
    ds_read_b128 v[112:115], v250 offset:21504
    v_fma_f32 v18, -v242, v210, v18
    v_mfma_f32_16x16x32_bf16 v[60:63], v[172:175], v[136:139], v[60:63]
    ds_read_b128 v[116:119], v252 offset:21504
    v_fma_f32 v46, -v244, v210, v46
    v_mfma_f32_16x16x32_bf16 v[36:39], v[168:171], v[140:143], v[36:39]
    v_fma_f32 v22, -v242, v214, v22
    v_mfma_f32_16x16x32_bf16 v[64:67], v[172:175], v[140:143], v[64:67]
    v_fma_f32 v50, -v244, v214, v50
    v_mfma_f32_16x16x32_bf16 v[40:43], v[144:147], v[168:171], v[40:43]
    v_fma_f32 v26, -v242, v218, v26
    v_mfma_f32_16x16x32_bf16 v[68:71], v[144:147], v[172:175], v[68:71]
    v_fma_f32 v54, -v244, v218, v54
    v_mfma_f32_16x16x32_bf16 v[72:75], v[152:155], v[148:151], v[72:75]
    v_fma_f32 v30, -v242, v222, v30
    v_mfma_f32_16x16x32_bf16 v[76:79], v[148:151], v[156:159], v[76:79]
    v_fma_f32 v58, -v244, v222, v58
    s_waitcnt vmcnt(6) lgkmcnt(6)
    v_mfma_f32_16x16x32_bf16 v[16:19], v[80:83], v[176:179], v[16:19]
    ds_read_b128 v[120:123], v247 offset:43008
    v_fma_f32 v35, -v11, v232, v35
    v_mfma_f32_16x16x32_bf16 v[44:47], v[80:83], v[180:183], v[44:47]
    ds_read_b128 v[124:127], v247 offset:44032
    v_fma_f32 v63, -v15, v232, v63
    v_mfma_f32_16x16x32_bf16 v[20:23], v[84:87], v[176:179], v[20:23]
    ds_read_b128 v[128:131], v247 offset:45056
    v_fma_f32 v39, -v11, v233, v39
    v_mfma_f32_16x16x32_bf16 v[48:51], v[84:87], v[180:183], v[48:51]
    ds_read_b128 v[132:135], v247 offset:46080
    v_fma_f32 v67, -v15, v233, v67
    v_mfma_f32_16x16x32_bf16 v[24:27], v[88:91], v[176:179], v[24:27]
    ds_read_b128 v[136:139], v247 offset:47104
    v_fma_f32 v43, -v242, v227, v43
    v_mfma_f32_16x16x32_bf16 v[52:55], v[88:91], v[180:183], v[52:55]
    ds_read_b128 v[140:143], v247 offset:48128
    v_fma_f32 v71, -v244, v227, v71
    v_mfma_f32_16x16x32_bf16 v[28:31], v[92:95], v[176:179], v[28:31]
    ds_read_b128 v[144:147], v247 offset:49152
    v_fma_f32 v75, -v240, v231, v75
    v_mfma_f32_16x16x32_bf16 v[56:59], v[92:95], v[180:183], v[56:59]
    ds_read_b128 v[148:151], v248 offset:13312
    s_waitcnt lgkmcnt(8)
    v_fma_f32 v79, -v7, v234, v79
    v_mfma_f32_16x16x32_bf16 v[32:35], v[176:179], v[96:99], v[32:35]
    ds_read_b128 v[152:155], v250 offset:28672
    v_fma_f32 v19, -v242, v211, v19
    v_mfma_f32_16x16x32_bf16 v[60:63], v[180:183], v[96:99], v[60:63]
    ds_read_b128 v[156:159], v252 offset:28672
    v_fma_f32 v47, -v244, v211, v47
    v_mfma_f32_16x16x32_bf16 v[36:39], v[176:179], v[100:103], v[36:39]
    v_fma_f32 v23, -v242, v215, v23
    v_mfma_f32_16x16x32_bf16 v[64:67], v[180:183], v[100:103], v[64:67]
    v_fma_f32 v51, -v244, v215, v51
    v_mfma_f32_16x16x32_bf16 v[40:43], v[104:107], v[176:179], v[40:43]
    v_fma_f32 v27, -v242, v219, v27
    v_mfma_f32_16x16x32_bf16 v[68:71], v[104:107], v[180:183], v[68:71]
    v_fma_f32 v55, -v244, v219, v55
    v_mfma_f32_16x16x32_bf16 v[72:75], v[112:115], v[108:111], v[72:75]
    v_fma_f32 v31, -v242, v223, v31
    v_mfma_f32_16x16x32_bf16 v[76:79], v[108:111], v[116:119], v[76:79]
    v_fma_f32 v59, -v244, v223, v59
    s_waitcnt vmcnt(4) lgkmcnt(6)
    s_barrier
    v_mfma_f32_16x16x32_bf16 v[16:19], v[120:123], v[184:187], v[16:19]
    ds_read_b128 v[80:83], v247 offset:50176
    v_mfma_f32_16x16x32_bf16 v[44:47], v[120:123], v[188:191], v[44:47]
    ds_read_b128 v[84:87], v247 offset:51200
    v_and_b32 v4, 1, v2
    v_mfma_f32_16x16x32_bf16 v[20:23], v[124:127], v[184:187], v[20:23]
    ds_read_b128 v[88:91], v247 offset:52224
    v_lshl_add_u32 v5, v3, 2, v4
    v_mfma_f32_16x16x32_bf16 v[48:51], v[124:127], v[188:191], v[48:51]
    ds_read_b128 v[92:95], v247 offset:53248
    v_add_u32 v6, 2, v5
    v_mfma_f32_16x16x32_bf16 v[24:27], v[128:131], v[184:187], v[24:27]
    ds_read_b128 v[96:99], v247 offset:54272
    v_cmp_eq_u32 s[40:41], 1, v4
    v_mfma_f32_16x16x32_bf16 v[52:55], v[128:131], v[188:191], v[52:55]
    ds_read_b128 v[100:103], v247 offset:55296
    v_cmp_le_u32 s[42:43], v5, v2
    v_mfma_f32_16x16x32_bf16 v[28:31], v[132:135], v[184:187], v[28:31]
    ds_read_b128 v[104:107], v247 offset:56320
    v_cmp_le_u32 s[44:45], v6, v2
    v_mfma_f32_16x16x32_bf16 v[56:59], v[132:135], v[188:191], v[56:59]
    ds_read_b128 v[108:111], v248 offset:14336
    s_waitcnt lgkmcnt(8)
    v_mfma_f32_16x16x32_bf16 v[32:35], v[184:187], v[136:139], v[32:35]
    ds_read_b128 v[112:115], v250 offset:35840
    v_mov_b32 v4, 0x0c0c0100
    v_mfma_f32_16x16x32_bf16 v[60:63], v[188:191], v[136:139], v[60:63]
    ds_read_b128 v[116:119], v252 offset:35840
    v_mov_b32 v5, 0x01000c0c
    v_mfma_f32_16x16x32_bf16 v[36:39], v[184:187], v[140:143], v[36:39]
    v_mov_b32 v6, 0x0c0c0302
    v_mov_b32 v7, 0x03020c0c
    v_mfma_f32_16x16x32_bf16 v[64:67], v[188:191], v[140:143], v[64:67]
    v_mov_b32 v8, 0x0c0c0c0c
    v_cndmask_b32 v4, v4, v5, s[40:41]
    v_mfma_f32_16x16x32_bf16 v[40:43], v[144:147], v[184:187], v[40:43]
    v_cndmask_b32 v6, v6, v7, s[40:41]
    v_cndmask_b32 v12, v4, v8, s[42:43]
    v_mfma_f32_16x16x32_bf16 v[68:71], v[144:147], v[188:191], v[68:71]
    v_cndmask_b32 v13, v6, v8, s[44:45]
    v_cndmask_b32 v14, v8, v4, s[42:43]
    v_mfma_f32_16x16x32_bf16 v[72:75], v[152:155], v[148:151], v[72:75]
    v_cndmask_b32 v15, v8, v6, s[44:45]
    s_cmp_eq_u32 s31, 0
    v_mfma_f32_16x16x32_bf16 v[76:79], v[148:151], v[156:159], v[76:79]
    s_cselect_b64 s[48:49], s[42:43], -1
    s_cselect_b64 s[38:39], s[44:45], -1
    s_waitcnt vmcnt(2) lgkmcnt(6)
    v_mfma_f32_16x16x32_bf16 v[16:19], v[80:83], v[192:195], v[16:19]
    ds_read_b128 v[120:123], v247 offset:57344
    v_mfma_f32_16x16x32_bf16 v[44:47], v[80:83], v[196:199], v[44:47]
    ds_read_b128 v[124:127], v247 offset:58368
    s_mul_i32 s36, s20, 3072
    v_mfma_f32_16x16x32_bf16 v[20:23], v[84:87], v[192:195], v[20:23]
    ds_read_b128 v[128:131], v247 offset:59392
    s_add_u32 s36, s36, 149504
    v_mfma_f32_16x16x32_bf16 v[48:51], v[84:87], v[196:199], v[48:51]
    ds_read_b128 v[132:135], v247 offset:60416
    v_add_u32 v9, s36, v0
    v_mfma_f32_16x16x32_bf16 v[24:27], v[88:91], v[192:195], v[24:27]
    ds_read_b128 v[136:139], v247 offset:61440
    s_lshl_b32 s37, s20, 9
    v_mfma_f32_16x16x32_bf16 v[52:55], v[88:91], v[196:199], v[52:55]
    ds_read_b128 v[140:143], v247 offset:62464
    s_add_u32 s37, s37, 149504
    v_mfma_f32_16x16x32_bf16 v[28:31], v[92:95], v[192:195], v[28:31]
    ds_read_b128 v[144:147], v247 offset:63488
    v_add_u32 v10, s37, v0
    v_mfma_f32_16x16x32_bf16 v[56:59], v[92:95], v[196:199], v[56:59]
    ds_read_b128 v[148:151], v248 offset:15360
    s_waitcnt lgkmcnt(8)
    v_mfma_f32_16x16x32_bf16 v[32:35], v[192:195], v[96:99], v[32:35]
    ds_read_b128 v[152:155], v250 offset:43008
    v_lshlrev_b32 v4, 2, v3
    v_mfma_f32_16x16x32_bf16 v[60:63], v[196:199], v[96:99], v[60:63]
    ds_read_b128 v[156:159], v252 offset:43008
    v_sub_u32 v4, v2, v4
    v_mfma_f32_16x16x32_bf16 v[36:39], v[192:195], v[100:103], v[36:39]
    v_lshlrev_b32 v5, 4, v4
    v_lshrrev_b32 v4, 1, v4
    v_mfma_f32_16x16x32_bf16 v[64:67], v[196:199], v[100:103], v[64:67]
    v_mov_b32 v6, 0x3f80
    v_lshlrev_b32 v5, v5, v6
    v_mfma_f32_16x16x32_bf16 v[40:43], v[104:107], v[192:195], v[40:43]
    v_cmp_eq_u32 vcc, 0, v4
    v_cmp_eq_u32 s[46:47], 1, v4
    v_mfma_f32_16x16x32_bf16 v[68:71], v[104:107], v[196:199], v[68:71]
    ds_read_b128 v[208:211], v255 offset:64
    s_lshl_b32 s36, s24, 10
    v_add_u32 v4, s36, v1
    v_mfma_f32_16x16x32_bf16 v[72:75], v[112:115], v[108:111], v[72:75]
    ds_read_b128 v[212:215], v255 offset:192
    v_cndmask_b32 v234, 0, v5, vcc
    v_cndmask_b32 v235, 0, v5, s[46:47]
    v_mfma_f32_16x16x32_bf16 v[76:79], v[108:111], v[116:119], v[76:79]
    ds_read_b128 v[216:219], v255 offset:320
    v_add_u32 v5, 18432, v4
    s_lshl_b32 s36, s24, 7
    s_waitcnt vmcnt(0) lgkmcnt(9)
    v_mfma_f32_16x16x32_bf16 v[16:19], v[120:123], v[200:203], v[16:19]
    ds_read_b128 v[80:83], v248 offset:16384
    v_mfma_f32_16x16x32_bf16 v[44:47], v[120:123], v[204:207], v[44:47]
    ds_read_b128 v[84:87], v250 offset:50176
    s_add_u32 s36, s36, 16384
    v_mfma_f32_16x16x32_bf16 v[20:23], v[124:127], v[200:203], v[20:23]
    ds_read_b128 v[88:91], v252 offset:50176
    v_cmp_eq_u32 vcc, 2, v3
    v_mfma_f32_16x16x32_bf16 v[48:51], v[124:127], v[204:207], v[48:51]
    ds_read_b128 v[92:95], v248 offset:17408
    v_lshl_add_u32 v6, v2, 3, s36
    v_mfma_f32_16x16x32_bf16 v[24:27], v[128:131], v[200:203], v[24:27]
    ds_read_b128 v[96:99], v250 offset:57344
    v_bfrev_b32 v7, 1
    v_mfma_f32_16x16x32_bf16 v[52:55], v[128:131], v[204:207], v[52:55]
    ds_read_b128 v[100:103], v252 offset:57344
    v_cndmask_b32 v6, v7, v6, vcc
    v_mfma_f32_16x16x32_bf16 v[28:31], v[132:135], v[200:203], v[28:31]
    v_add_u32 v7, 18432, v6
    v_mov_b32 v106, 0
    v_mfma_f32_16x16x32_bf16 v[56:59], v[132:135], v[204:207], v[56:59]
    s_waitcnt lgkmcnt(6)
    v_mov_b32 v107, 0
    v_mfma_f32_16x16x32_bf16 v[32:35], v[200:203], v[136:139], v[32:35]
    v_mov_b32 v8, 0xf149f2ca
    v_mov_b32 v108, 0
    v_mfma_f32_16x16x32_bf16 v[60:63], v[204:207], v[136:139], v[60:63]
    s_mov_b32 s33, 0x3eae1a93
    v_mov_b32 v109, 0
    v_mfma_f32_16x16x32_bf16 v[36:39], v[200:203], v[140:143], v[36:39]
    v_mov_b32 v236, 0x3f803f80
    v_mov_b32 v237, 0x3f803f80
    v_mfma_f32_16x16x32_bf16 v[64:67], v[204:207], v[140:143], v[64:67]
    v_mov_b32 v238, 0x3f803f80
    v_mov_b32 v239, 0x3f803f80
    v_mfma_f32_16x16x32_bf16 v[40:43], v[144:147], v[200:203], v[40:43]
    v_mov_b32 v114, 0
    v_mfma_f32_16x16x32_bf16 v[68:71], v[144:147], v[204:207], v[68:71]
    v_mov_b32 v115, 0
    v_mfma_f32_16x16x32_bf16 v[72:75], v[152:155], v[148:151], v[72:75]
    v_mov_b32 v116, 0
    v_mfma_f32_16x16x32_bf16 v[76:79], v[148:151], v[156:159], v[76:79]
    v_mov_b32 v117, 0
    s_waitcnt lgkmcnt(0)
    v_mfma_f32_16x16x32_bf16 v[72:75], v[84:87], v[80:83], v[72:75]
    v_mfma_f32_16x16x32_bf16 v[76:79], v[80:83], v[88:91], v[76:79]
    v_mfma_f32_16x16x32_bf16 v[72:75], v[96:99], v[92:95], v[72:75]
    v_mfma_f32_16x16x32_bf16 v[76:79], v[92:95], v[100:103], v[76:79]
    v_pk_mul_f32 v[52:53], v[52:53], v[244:245] op_sel:[0,1] op_sel_hi:[1,1]
    v_pk_mul_f32 v[54:55], v[54:55], v[244:245] op_sel:[0,1] op_sel_hi:[1,1]
    v_pk_mul_f32 v[56:57], v[56:57], v[244:245] op_sel:[0,1] op_sel_hi:[1,1]
    v_pk_mul_f32 v[58:59], v[58:59], v[244:245] op_sel:[0,1] op_sel_hi:[1,1]
    v_pk_mul_f32 v[60:61], v[60:61], v[216:217]
    v_pk_mul_f32 v[62:63], v[62:63], v[218:219]
    v_pk_mul_f32 v[64:65], v[64:65], v[216:217]
    v_pk_mul_f32 v[66:67], v[66:67], v[218:219]
    v_pk_mul_f32 v[68:69], v[68:69], v[244:245] op_sel:[0,1] op_sel_hi:[1,1]
    v_pk_mul_f32 v[70:71], v[70:71], v[244:245] op_sel:[0,1] op_sel_hi:[1,1]
    v_pk_mul_f32 v[72:73], v[72:73], v[240:241] op_sel:[0,1] op_sel_hi:[1,1]
    v_pk_mul_f32 v[74:75], v[74:75], v[240:241] op_sel:[0,1] op_sel_hi:[1,1]
    v_pk_mul_f32 v[76:77], v[76:77], v[208:209]
    v_pk_mul_f32 v[78:79], v[78:79], v[210:211]
    v_cvt_pk_bf16_f32 v172, v52, v53
    v_cvt_pk_bf16_f32 v173, v54, v55
    v_cvt_pk_bf16_f32 v176, v56, v57
    v_cvt_pk_bf16_f32 v177, v58, v59
    v_cvt_pk_bf16_f32 v182, v60, v61
    v_cvt_pk_bf16_f32 v183, v62, v63
    v_cvt_pk_bf16_f32 v188, v64, v65
    v_cvt_pk_bf16_f32 v189, v66, v67
    v_cvt_pk_bf16_f32 v174, v68, v69
    v_cvt_pk_bf16_f32 v175, v70, v71
    v_cvt_pk_bf16_f32 v220, v72, v73
    v_cvt_pk_bf16_f32 v221, v74, v75
    v_cvt_pk_bf16_f32 v222, v76, v77
    v_cvt_pk_bf16_f32 v223, v78, v79
    s_cmp_eq_u32 s20, 3
    s_cbranch_scc1 L_a_nw
    ds_write2st64_b64 v9, v[172:173], v[174:175] offset0:6 offset1:7
    ds_write2st64_b64 v9, v[176:177], v[182:183] offset0:8 offset1:9
    ds_write_b64 v9, v[188:189] offset:5120
    ds_write2st64_b64 v10, v[220:221], v[222:223] offset0:0 offset1:3
L_a_nw:
    v_pk_mul_f32 v[24:25], v[24:25], v[242:243] op_sel:[0,1] op_sel_hi:[1,1]
    v_pk_mul_f32 v[26:27], v[26:27], v[242:243] op_sel:[0,1] op_sel_hi:[1,1]
    v_pk_mul_f32 v[28:29], v[28:29], v[242:243] op_sel:[0,1] op_sel_hi:[1,1]
    v_pk_mul_f32 v[30:31], v[30:31], v[242:243] op_sel:[0,1] op_sel_hi:[1,1]
    v_pk_mul_f32 v[32:33], v[32:33], v[212:213]
    v_pk_mul_f32 v[34:35], v[34:35], v[214:215]
    v_pk_mul_f32 v[36:37], v[36:37], v[212:213]
    v_pk_mul_f32 v[38:39], v[38:39], v[214:215]
    v_pk_mul_f32 v[40:41], v[40:41], v[242:243] op_sel:[0,1] op_sel_hi:[1,1]
    v_pk_mul_f32 v[42:43], v[42:43], v[242:243] op_sel:[0,1] op_sel_hi:[1,1]
    v_cvt_pk_bf16_f32 v166, v24, v25
    v_cvt_pk_bf16_f32 v167, v26, v27
    v_cvt_pk_bf16_f32 v170, v28, v29
    v_cvt_pk_bf16_f32 v171, v30, v31
    v_cvt_pk_bf16_f32 v180, v32, v33
    v_cvt_pk_bf16_f32 v181, v34, v35
    v_cvt_pk_bf16_f32 v186, v36, v37
    v_cvt_pk_bf16_f32 v187, v38, v39
    v_cvt_pk_bf16_f32 v168, v40, v41
    v_cvt_pk_bf16_f32 v169, v42, v43
    s_waitcnt lgkmcnt(0)
    s_barrier
    ds_read2st64_b64 v[160:163], v9 offset0:0 offset1:1
    ds_read_b64 v[164:165], v9 offset:1024
    ds_read_b64 v[178:179], v9 offset:1536
    ds_read_b64 v[184:185], v9 offset:2048
    v_mfma_f32_16x16x16_bf16 v[128:131], v[174:175], v[234:235], 0
    v_mfma_f32_16x16x16_bf16 v[124:127], v[168:169], v[234:235], 0
    v_pk_mul_f32 v[44:45], v[44:45], v[244:245] op_sel:[0,1] op_sel_hi:[1,1]
    v_pk_mul_f32 v[46:47], v[46:47], v[244:245] op_sel:[0,1] op_sel_hi:[1,1]
    v_pk_mul_f32 v[48:49], v[48:49], v[244:245] op_sel:[0,1] op_sel_hi:[1,1]
    v_pk_mul_f32 v[50:51], v[50:51], v[244:245] op_sel:[0,1] op_sel_hi:[1,1]
    v_pk_mul_f32 v[16:17], v[16:17], v[242:243] op_sel:[0,1] op_sel_hi:[1,1]
    v_pk_mul_f32 v[18:19], v[18:19], v[242:243] op_sel:[0,1] op_sel_hi:[1,1]
    v_pk_mul_f32 v[20:21], v[20:21], v[242:243] op_sel:[0,1] op_sel_hi:[1,1]
    v_pk_mul_f32 v[22:23], v[22:23], v[242:243] op_sel:[0,1] op_sel_hi:[1,1]
    v_cvt_pk_bf16_f32 v112, v44, v45
    v_cvt_pk_bf16_f32 v113, v46, v47
    v_cvt_pk_bf16_f32 v118, v48, v49
    v_cvt_pk_bf16_f32 v119, v50, v51
    v_cvt_pk_bf16_f32 v104, v16, v17
    v_cvt_pk_bf16_f32 v105, v18, v19
    v_cvt_pk_bf16_f32 v110, v20, v21
    v_cvt_pk_bf16_f32 v111, v22, v23
    v_permlane16_swap_b32 v114, v174
    v_permlane16_swap_b32 v117, v175
    v_permlane16_swap_b32 v106, v168
    v_permlane16_swap_b32 v109, v169
    s_waitcnt lgkmcnt(0)
    v_mfma_f32_16x16x16_bf16 v[120:123], v[162:163], v[234:235], 0
    v_mfma_f32_16x16x32_bf16 v[20:23], v[172:175], v[112:115], 0
    v_mfma_f32_16x16x32_bf16 v[16:19], v[166:169], v[112:115], 0
    v_mfma_f32_16x16x32_bf16 v[28:31], v[174:177], v[116:119], 0
    v_mfma_f32_16x16x32_bf16 v[24:27], v[168:171], v[116:119], 0
    v_mfma_f32_16x16x32_bf16 v[36:39], v[166:169], v[104:107], 0
    v_mfma_f32_16x16x32_bf16 v[32:35], v[160:163], v[104:107], 0
    v_mfma_f32_16x16x32_bf16 v[44:47], v[168:171], v[108:111], 0
    v_mfma_f32_16x16x32_bf16 v[40:43], v[162:165], v[108:111], 0
    v_cvt_pk_bf16_f32 v194, v128, v129
    v_cvt_pk_bf16_f32 v195, v130, v131
    v_cvt_pk_bf16_f32 v192, v124, v125
    v_cvt_pk_bf16_f32 v193, v126, v127
    v_cvt_pk_bf16_f32 v190, v120, v121
    v_cvt_pk_bf16_f32 v191, v122, v123
    v_cndmask_b32 v20, v20, v21, s[40:41]
    v_cndmask_b32 v16, v16, v17, s[40:41]
    v_cndmask_b32 v48, v16, v20, s[42:43]
    v_cndmask_b32 v22, v22, v23, s[40:41]
    v_cndmask_b32 v18, v18, v19, s[40:41]
    v_cndmask_b32 v49, v18, v22, s[44:45]
    v_max_f32 v56, v48, v49
    v_cndmask_b32 v28, v28, v29, s[40:41]
    v_cndmask_b32 v24, v24, v25, s[40:41]
    v_cndmask_b32 v50, v24, v28, s[42:43]
    v_cndmask_b32 v30, v30, v31, s[40:41]
    v_cndmask_b32 v26, v26, v27, s[40:41]
    v_cndmask_b32 v51, v26, v30, s[44:45]
    v_max_f32 v57, v50, v51
    v_cndmask_b32 v36, v36, v37, s[40:41]
    v_cndmask_b32 v32, v32, v33, s[40:41]
    v_cndmask_b32 v52, v32, v36, s[42:43]
    v_cndmask_b32 v52, v8, v52, s[48:49]
    v_cndmask_b32 v38, v38, v39, s[40:41]
    v_cndmask_b32 v34, v34, v35, s[40:41]
    v_cndmask_b32 v53, v34, v38, s[44:45]
    v_cndmask_b32 v53, v8, v53, s[38:39]
    v_max_f32 v58, v52, v53
    v_permlane32_swap_b32 v56, v57
    v_max_f32 v56, v56, v57
    v_cndmask_b32 v44, v44, v45, s[40:41]
    v_cndmask_b32 v40, v40, v41, s[40:41]
    v_cndmask_b32 v54, v40, v44, s[42:43]
    v_cndmask_b32 v54, v8, v54, s[48:49]
    v_cndmask_b32 v46, v46, v47, s[40:41]
    v_cndmask_b32 v42, v42, v43, s[40:41]
    v_cndmask_b32 v55, v42, v46, s[44:45]
    v_cndmask_b32 v55, v8, v55, s[38:39]
    v_max_f32 v59, v54, v55
    s_nop 1
    v_permlane32_swap_b32 v58, v59
    v_max_f32 v58, v58, v59
    s_nop 1
    v_permlane16_swap_b32 v56, v58
    v_max_f32 v57, v56, v58
    v_mul_f32 v56, s33, v57
    v_mul_f32 v58, s33, v57
    s_nop 1
    v_permlane16_swap_b32 v56, v58
    v_mov_b32 v57, v56
    v_mov_b32 v59, v58
    s_nop 0
    v_permlane32_swap_b32 v56, v57
    v_permlane32_swap_b32 v58, v59
    v_fma_f32 v48, v48, s33, -v56
    v_fma_f32 v49, v49, s33, -v56
    v_fma_f32 v50, v50, s33, -v57
    v_fma_f32 v51, v51, s33, -v57
    v_fma_f32 v52, v52, s33, -v58
    v_fma_f32 v53, v53, s33, -v58
    v_fma_f32 v54, v54, s33, -v59
    v_fma_f32 v55, v55, s33, -v59
    v_exp_f32 v48, v48
    v_exp_f32 v49, v49
    v_exp_f32 v50, v50
    v_exp_f32 v51, v51
    v_exp_f32 v52, v52
    v_exp_f32 v53, v53
    v_exp_f32 v54, v54
    v_exp_f32 v55, v55
    v_cvt_pk_bf16_f32 v56, v48, v49
    v_cvt_pk_bf16_f32 v57, v50, v51
    v_cvt_pk_bf16_f32 v58, v52, v53
    v_cvt_pk_bf16_f32 v59, v54, v55
    v_perm_b32 v64, v56, v56, v12
    v_perm_b32 v65, v56, v56, v13
    v_perm_b32 v66, v56, v56, v14
    v_perm_b32 v67, v56, v56, v15
    v_perm_b32 v68, v57, v57, v12
    v_perm_b32 v69, v57, v57, v13
    v_perm_b32 v70, v57, v57, v14
    v_perm_b32 v71, v57, v57, v15
    v_perm_b32 v72, v58, v58, v12
    v_perm_b32 v73, v58, v58, v13
    v_perm_b32 v74, v58, v58, v14
    v_perm_b32 v75, v58, v58, v15
    v_perm_b32 v76, v59, v59, v12
    v_perm_b32 v77, v59, v59, v13
    v_perm_b32 v78, v59, v59, v14
    v_perm_b32 v79, v59, v59, v15
    v_mfma_f32_16x16x32_bf16 v[80:83], v[236:239], v[64:67], 0
    v_mfma_f32_16x16x32_bf16 v[84:87], v[236:239], v[68:71], 0
    v_mfma_f32_16x16x32_bf16 v[88:91], v[236:239], v[72:75], 0
    v_mfma_f32_16x16x32_bf16 v[92:95], v[236:239], v[76:79], 0
    v_mfma_f32_16x16x32_bf16 v[16:19], v[180:183], v[64:67], 0
    v_mfma_f32_16x16x32_bf16 v[20:23], v[192:195], v[64:67], 0
    v_mfma_f32_16x16x32_bf16 v[24:27], v[186:189], v[68:71], 0
    v_mfma_f32_16x16x32_bf16 v[28:31], v[192:195], v[68:71], 0
    v_mfma_f32_16x16x32_bf16 v[32:35], v[178:181], v[72:75], 0
    v_mfma_f32_16x16x32_bf16 v[36:39], v[190:193], v[72:75], 0
    v_mfma_f32_16x16x32_bf16 v[40:43], v[184:187], v[76:79], 0
    v_mfma_f32_16x16x32_bf16 v[44:47], v[190:193], v[76:79], 0
    v_rcp_f32 v80, v80
    v_rcp_f32 v84, v84
    v_rcp_f32 v88, v88
    v_rcp_f32 v92, v92
    v_pk_mul_f32 v[16:17], v[16:17], v[80:81] op_sel_hi:[1,0]
    v_pk_mul_f32 v[18:19], v[18:19], v[80:81] op_sel_hi:[1,0]
    v_pk_mul_f32 v[20:21], v[20:21], v[80:81] op_sel_hi:[1,0]
    v_pk_mul_f32 v[24:25], v[24:25], v[84:85] op_sel_hi:[1,0]
    v_pk_mul_f32 v[26:27], v[26:27], v[84:85] op_sel_hi:[1,0]
    v_pk_mul_f32 v[30:31], v[30:31], v[84:85] op_sel_hi:[1,0]
    v_cvt_pk_bf16_f32 v220, v16, v17
    v_cvt_pk_bf16_f32 v221, v18, v19
    v_cvt_pk_bf16_f32 v224, v20, v21
    v_cvt_pk_bf16_f32 v222, v24, v25
    v_cvt_pk_bf16_f32 v223, v26, v27
    v_cvt_pk_bf16_f32 v225, v30, v31
    buffer_store_dwordx4 v[220:223], v5, s[4:7], s35 offen sc1
    buffer_store_dwordx2 v[224:225], v7, s[4:7], s35 offen sc1
    v_pk_mul_f32 v[32:33], v[32:33], v[88:89] op_sel_hi:[1,0]
    v_pk_mul_f32 v[34:35], v[34:35], v[88:89] op_sel_hi:[1,0]
    v_pk_mul_f32 v[36:37], v[36:37], v[88:89] op_sel_hi:[1,0]
    v_pk_mul_f32 v[40:41], v[40:41], v[92:93] op_sel_hi:[1,0]
    v_pk_mul_f32 v[42:43], v[42:43], v[92:93] op_sel_hi:[1,0]
    v_pk_mul_f32 v[46:47], v[46:47], v[92:93] op_sel_hi:[1,0]
    v_cvt_pk_bf16_f32 v228, v32, v33
    v_cvt_pk_bf16_f32 v229, v34, v35
    v_cvt_pk_bf16_f32 v232, v36, v37
    v_cvt_pk_bf16_f32 v230, v40, v41
    v_cvt_pk_bf16_f32 v231, v42, v43
    v_cvt_pk_bf16_f32 v233, v46, v47
    buffer_store_dwordx4 v[228:231], v4, s[4:7], s35 offen sc1
    buffer_store_dwordx2 v[232:233], v6, s[4:7], s35 offen sc1
    s_and_b32 s25, s2, 7
    s_lshr_b32 s26, s2, 3
    s_lshr_b32 s23, s25, 1
    s_lshl_b32 s23, s23, 3
    s_lshr_b32 s27, s26, 2
    s_add_u32 s23, s23, s27
    s_and_b32 s24, s25, 1
    s_lshl_b32 s24, s24, 2
    s_and_b32 s27, s26, 3
    s_add_u32 s24, s24, s27
    s_add_u32 s25, s23, s24
    s_and_b32 s25, s25, 3
    s_lshl_b32 s30, s23, 2
    s_add_u32 s30, s30, s20
    s_mul_i32 s29, s30, 18432
    s_add_u32 s29, s29, s21
    s_add_u32 s29, s29, 0x600000
    s_mul_i32 s34, s30, 18432
    s_add_u32 s34, s34, s21
    s_add_u32 s34, s34, 0x0
    s_lshl_b32 s35, s24, 11
    s_lshr_b32 s36, s24, 2
    s_lshl_b32 s36, s36, 10
    s_and_b32 s37, s24, 3
    s_lshl_b32 s37, s37, 8
    s_add_u32 s36, s36, s37
    s_add_u32 s36, s36, 16384
    v_bfe_u32 v2, v1, 4, 4
    v_lshrrev_b32 v3, 8, v1
    v_add_u32 v4, s35, v1
    v_lshlrev_b32 v5, 4, v2
    v_lshl_add_u32 v5, v3, 3, v5
    v_add_u32 v5, s36, v5
    v_cmp_gt_u32 s[40:41], 2, v3
    v_bfrev_b32 v6, 1
    v_add_u32 v12, 0, v1
    v_add_u32 v13, 36864, v1
    v_add_u32 v14, 73728, v1
    v_add_u32 v15, 110592, v1
    v_cndmask_b32 v5, v6, v5, s[40:41]
    buffer_load_dwordx4 v[208:211], v4, s[4:7], s34 offen offset:0 sc1
    buffer_load_dwordx4 v[212:215], v4, s[4:7], s34 offen offset:1024 sc1
    buffer_load_dwordx2 v[216:217], v5, s[4:7], s34 offen sc1
    s_add_u32 s34, s34, 0x300000
    s_lshl_b32 s39, s30, 10
    s_add_u32 s39, s39, s21
    s_lshl_b32 s42, s24, 7
    s_add_u32 s39, s39, s42
    s_add_u32 s39, s39, 0x1b20000
    v_cmp_eq_u32 vcc, 0, v3
    v_lshlrev_b32 v10, 3, v2
    v_mov_b32 v11, 0x3f803f80
    v_lshl_add_u32 v7, v3, 8, v10
    v_cndmask_b32 v10, v6, v10, vcc
    s_lshr_b32 s44, s23, 1
    s_lshl_b32 s52, s22, 7
    s_add_u32 s52, s52, s44
    s_lshl_b32 s52, s52, 8
    s_add_u32 s52, s52, 0x4508000
    s_add_u32 s52, s52, s4
    s_addc_u32 s53, s5, 0
    s_waitcnt vmcnt(3)
    s_barrier
    s_cmp_lg_u32 s20, 0
    s_cbranch_scc1 L_ns_d2
    s_mov_b32 s56, 1
    s_atomic_add s56, s[50:51], 0
L_ns_d2:
    s_cmp_lg_u32 s20, 0
    s_cbranch_scc1 L_pd_d2
    s_mov_b32 s60, 65536
L_poll_d2:
    s_mov_b32 s57, 0
    s_atomic_add s57, s[52:53], 0 glc
    s_waitcnt lgkmcnt(0)
    s_cmp_ge_u32 s57, 16
    s_cbranch_scc1 L_pd_d2
    s_sub_u32 s60, s60, 1
    s_cbranch_scc1 L_pd_d2
    s_sleep 2
    s_branch L_poll_d2
L_pd_d2:
    s_barrier
    s_mov_b32 s32, 0
    s_lshl_b32 s32, s32, 13
    s_add_u32 s32, s32, s29
    s_add_u32 s33, s32, 4096
    buffer_load_dwordx4 v[112:115], v1, s[4:7], s32 offen offset:0 sc1
    buffer_load_dwordx4 v[116:119], v1, s[4:7], s32 offen offset:1024 sc1
    buffer_load_dwordx4 v[120:123], v1, s[4:7], s32 offen offset:2048 sc1
    buffer_load_dwordx4 v[124:127], v1, s[4:7], s32 offen offset:3072 sc1
    buffer_load_dwordx4 v[128:131], v1, s[4:7], s33 offen offset:0 sc1
    buffer_load_dwordx4 v[132:135], v1, s[4:7], s33 offen offset:1024 sc1
    buffer_load_dwordx4 v[136:139], v1, s[4:7], s33 offen offset:2048 sc1
    buffer_load_dwordx4 v[140:143], v1, s[4:7], s33 offen offset:3072 sc1
    ds_read_b128 v[40:43], v12 offset:18432
    ds_read_b128 v[44:47], v12 offset:19456
    ds_read_b128 v[48:51], v12 offset:20480
    ds_read_b128 v[52:55], v12 offset:21504
    ds_read_b128 v[72:75], v12 offset:26624
    ds_read_b128 v[56:59], v12 offset:22528
    ds_read_b128 v[60:63], v12 offset:23552
    ds_read_b128 v[64:67], v12 offset:24576
    ds_read_b128 v[68:71], v12 offset:25600
    s_add_u32 s45, s29, 8192
    s_add_u32 s46, s29, 12288
    s_add_u32 s47, s29, 16384
    buffer_load_dwordx4 v[144:147], v1, s[4:7], s45 offen offset:0 sc1
    buffer_load_dwordx4 v[148:151], v1, s[4:7], s45 offen offset:1024 sc1
    s_lshl_b32 s42, s23, 3
    s_add_u32 s42, s42, s24
    s_lshl_b32 s42, s42, 2
    s_add_u32 s42, s42, s20
    s_lshl_b32 s42, s42, 8
    s_add_u32 s42, s42, s21
    s_add_u32 s42, s42, 0x1b40000
    v_mov_b32 v220, -1.0
    v_lshrrev_b32 v221, 2, v1
    buffer_store_dword v220, v221, s[4:7], s42 offen sc1
    s_lshl_b32 s50, s22, 7
    s_add_u32 s50, s50, s44
    s_lshl_b32 s50, s50, 8
    s_add_u32 s50, s50, 0x4509000
    s_add_u32 s50, s50, s4
    s_addc_u32 s51, s5, 0
    s_waitcnt vmcnt(11)
    v_lshlrev_b32 v16, 16, v208
    v_and_b32 v17, 0xffff0000, v208
    v_lshlrev_b32 v18, 16, v209
    v_and_b32 v19, 0xffff0000, v209
    v_lshlrev_b32 v20, 16, v210
    v_and_b32 v21, 0xffff0000, v210
    v_lshlrev_b32 v22, 16, v211
    v_and_b32 v23, 0xffff0000, v211
    v_lshlrev_b32 v24, 16, v212
    v_and_b32 v25, 0xffff0000, v212
    v_lshlrev_b32 v26, 16, v213
    v_and_b32 v27, 0xffff0000, v213
    v_lshlrev_b32 v28, 16, v214
    v_and_b32 v29, 0xffff0000, v214
    v_lshlrev_b32 v30, 16, v215
    v_and_b32 v31, 0xffff0000, v215
    v_lshlrev_b32 v32, 16, v216
    v_and_b32 v33, 0xffff0000, v216
    v_lshlrev_b32 v34, 16, v217
    v_and_b32 v35, 0xffff0000, v217
    s_waitcnt vmcnt(9) lgkmcnt(4)
    v_mfma_f32_16x16x32_bf16 v[16:19], v[40:43], v[112:115], v[16:19]
    ds_read_b128 v[76:79], v12 offset:27648
    v_mfma_f32_16x16x32_bf16 v[20:23], v[44:47], v[112:115], v[20:23]
    ds_read_b128 v[80:83], v12 offset:28672
    buffer_load_dwordx4 v[152:155], v1, s[4:7], s45 offen offset:2048 sc1
    v_mfma_f32_16x16x32_bf16 v[24:27], v[48:51], v[112:115], v[24:27]
    ds_read_b128 v[84:87], v12 offset:29696
    v_mfma_f32_16x16x32_bf16 v[28:31], v[52:55], v[112:115], v[28:31]
    ds_read_b128 v[88:91], v12 offset:30720
    v_mfma_f32_16x16x32_bf16 v[32:35], v[72:75], v[112:115], v[32:35]
    ds_read_b128 v[108:111], v12 offset:35840
    s_waitcnt lgkmcnt(5)
    buffer_load_dwordx4 v[156:159], v1, s[4:7], s45 offen offset:3072 sc1
    v_mfma_f32_16x16x32_bf16 v[16:19], v[56:59], v[116:119], v[16:19]
    ds_read_b128 v[92:95], v12 offset:31744
    v_mfma_f32_16x16x32_bf16 v[20:23], v[60:63], v[116:119], v[20:23]
    ds_read_b128 v[96:99], v12 offset:32768
    v_mfma_f32_16x16x32_bf16 v[24:27], v[64:67], v[116:119], v[24:27]
    ds_read_b128 v[100:103], v12 offset:33792
    buffer_load_dwordx4 v[160:163], v1, s[4:7], s46 offen offset:0 sc1
    v_mfma_f32_16x16x32_bf16 v[28:31], v[68:71], v[116:119], v[28:31]
    ds_read_b128 v[104:107], v12 offset:34816
    v_mfma_f32_16x16x32_bf16 v[36:39], v[72:75], v[116:119], 0
    s_waitcnt vmcnt(10) lgkmcnt(4)
    v_mfma_f32_16x16x32_bf16 v[16:19], v[76:79], v[120:123], v[16:19]
    ds_read_b128 v[40:43], v13 offset:18432
    v_mfma_f32_16x16x32_bf16 v[20:23], v[80:83], v[120:123], v[20:23]
    ds_read_b128 v[44:47], v13 offset:19456
    buffer_load_dwordx4 v[164:167], v1, s[4:7], s46 offen offset:1024 sc1
    v_mfma_f32_16x16x32_bf16 v[24:27], v[84:87], v[120:123], v[24:27]
    ds_read_b128 v[48:51], v13 offset:20480
    v_mfma_f32_16x16x32_bf16 v[28:31], v[88:91], v[120:123], v[28:31]
    ds_read_b128 v[52:55], v13 offset:21504
    v_mfma_f32_16x16x32_bf16 v[32:35], v[108:111], v[120:123], v[32:35]
    ds_read_b128 v[72:75], v13 offset:26624
    s_waitcnt lgkmcnt(5)
    buffer_load_dwordx4 v[168:171], v1, s[4:7], s46 offen offset:2048 sc1
    v_mfma_f32_16x16x32_bf16 v[16:19], v[92:95], v[124:127], v[16:19]
    ds_read_b128 v[56:59], v13 offset:22528
    v_mfma_f32_16x16x32_bf16 v[20:23], v[96:99], v[124:127], v[20:23]
    ds_read_b128 v[60:63], v13 offset:23552
    v_mfma_f32_16x16x32_bf16 v[24:27], v[100:103], v[124:127], v[24:27]
    ds_read_b128 v[64:67], v13 offset:24576
    buffer_load_dwordx4 v[172:175], v1, s[4:7], s46 offen offset:3072 sc1
    v_mfma_f32_16x16x32_bf16 v[28:31], v[104:107], v[124:127], v[28:31]
    ds_read_b128 v[68:71], v13 offset:25600
    v_mfma_f32_16x16x32_bf16 v[36:39], v[108:111], v[124:127], v[36:39]
    s_waitcnt vmcnt(11) lgkmcnt(4)
    v_mfma_f32_16x16x32_bf16 v[16:19], v[40:43], v[128:131], v[16:19]
    ds_read_b128 v[76:79], v13 offset:27648
    v_mfma_f32_16x16x32_bf16 v[20:23], v[44:47], v[128:131], v[20:23]
    ds_read_b128 v[80:83], v13 offset:28672
    buffer_load_dwordx2 v[176:177], v7, s[4:7], s47 offen offset:0 sc1
    v_mfma_f32_16x16x32_bf16 v[24:27], v[48:51], v[128:131], v[24:27]
    ds_read_b128 v[84:87], v13 offset:29696
    v_mfma_f32_16x16x32_bf16 v[28:31], v[52:55], v[128:131], v[28:31]
    ds_read_b128 v[88:91], v13 offset:30720
    v_mfma_f32_16x16x32_bf16 v[32:35], v[72:75], v[128:131], v[32:35]
    ds_read_b128 v[108:111], v13 offset:35840
    s_waitcnt lgkmcnt(5)
    buffer_load_dwordx2 v[178:179], v7, s[4:7], s47 offen offset:128 sc1
    v_mfma_f32_16x16x32_bf16 v[16:19], v[56:59], v[132:135], v[16:19]
    ds_read_b128 v[92:95], v13 offset:31744
    v_mfma_f32_16x16x32_bf16 v[20:23], v[60:63], v[132:135], v[20:23]
    ds_read_b128 v[96:99], v13 offset:32768
    v_mfma_f32_16x16x32_bf16 v[24:27], v[64:67], v[132:135], v[24:27]
    ds_read_b128 v[100:103], v13 offset:33792
    buffer_load_dwordx2 v[180:181], v7, s[4:7], s47 offen offset:1024 sc1
    v_mfma_f32_16x16x32_bf16 v[28:31], v[68:71], v[132:135], v[28:31]
    ds_read_b128 v[104:107], v13 offset:34816
    v_mfma_f32_16x16x32_bf16 v[36:39], v[72:75], v[132:135], v[36:39]
    s_waitcnt vmcnt(12) lgkmcnt(4)
    v_mfma_f32_16x16x32_bf16 v[16:19], v[76:79], v[136:139], v[16:19]
    ds_read_b128 v[40:43], v14 offset:18432
    v_mfma_f32_16x16x32_bf16 v[20:23], v[80:83], v[136:139], v[20:23]
    ds_read_b128 v[44:47], v14 offset:19456
    buffer_load_dwordx2 v[182:183], v7, s[4:7], s47 offen offset:1152 sc1
    v_mfma_f32_16x16x32_bf16 v[24:27], v[84:87], v[136:139], v[24:27]
    ds_read_b128 v[48:51], v14 offset:20480
    v_mfma_f32_16x16x32_bf16 v[28:31], v[88:91], v[136:139], v[28:31]
    ds_read_b128 v[52:55], v14 offset:21504
    v_mfma_f32_16x16x32_bf16 v[32:35], v[108:111], v[136:139], v[32:35]
    ds_read_b128 v[72:75], v14 offset:26624
    s_waitcnt lgkmcnt(5)
    v_mfma_f32_16x16x32_bf16 v[16:19], v[92:95], v[140:143], v[16:19]
    ds_read_b128 v[56:59], v14 offset:22528
    v_mfma_f32_16x16x32_bf16 v[20:23], v[96:99], v[140:143], v[20:23]
    ds_read_b128 v[60:63], v14 offset:23552
    v_mfma_f32_16x16x32_bf16 v[24:27], v[100:103], v[140:143], v[24:27]
    ds_read_b128 v[64:67], v14 offset:24576
    v_mfma_f32_16x16x32_bf16 v[28:31], v[104:107], v[140:143], v[28:31]
    ds_read_b128 v[68:71], v14 offset:25600
    v_mfma_f32_16x16x32_bf16 v[36:39], v[108:111], v[140:143], v[36:39]
    s_waitcnt vmcnt(11) lgkmcnt(4)
    v_mfma_f32_16x16x32_bf16 v[16:19], v[40:43], v[144:147], v[16:19]
    ds_read_b128 v[76:79], v14 offset:27648
    v_mfma_f32_16x16x32_bf16 v[20:23], v[44:47], v[144:147], v[20:23]
    ds_read_b128 v[80:83], v14 offset:28672
    v_mfma_f32_16x16x32_bf16 v[24:27], v[48:51], v[144:147], v[24:27]
    ds_read_b128 v[84:87], v14 offset:29696
    v_mfma_f32_16x16x32_bf16 v[28:31], v[52:55], v[144:147], v[28:31]
    ds_read_b128 v[88:91], v14 offset:30720
    v_mfma_f32_16x16x32_bf16 v[32:35], v[72:75], v[144:147], v[32:35]
    ds_read_b128 v[108:111], v14 offset:35840
    s_waitcnt lgkmcnt(5)
    v_mfma_f32_16x16x32_bf16 v[16:19], v[56:59], v[148:151], v[16:19]
    ds_read_b128 v[92:95], v14 offset:31744
    v_mfma_f32_16x16x32_bf16 v[20:23], v[60:63], v[148:151], v[20:23]
    ds_read_b128 v[96:99], v14 offset:32768
    v_mfma_f32_16x16x32_bf16 v[24:27], v[64:67], v[148:151], v[24:27]
    ds_read_b128 v[100:103], v14 offset:33792
    v_mfma_f32_16x16x32_bf16 v[28:31], v[68:71], v[148:151], v[28:31]
    ds_read_b128 v[104:107], v14 offset:34816
    v_mfma_f32_16x16x32_bf16 v[36:39], v[72:75], v[148:151], v[36:39]
    s_waitcnt vmcnt(8) lgkmcnt(4)
    v_mfma_f32_16x16x32_bf16 v[16:19], v[76:79], v[152:155], v[16:19]
    ds_read_b128 v[40:43], v15 offset:18432
    v_mfma_f32_16x16x32_bf16 v[20:23], v[80:83], v[152:155], v[20:23]
    ds_read_b128 v[44:47], v15 offset:19456
    v_mfma_f32_16x16x32_bf16 v[24:27], v[84:87], v[152:155], v[24:27]
    ds_read_b128 v[48:51], v15 offset:20480
    v_mfma_f32_16x16x32_bf16 v[28:31], v[88:91], v[152:155], v[28:31]
    ds_read_b128 v[52:55], v15 offset:21504
    v_mfma_f32_16x16x32_bf16 v[32:35], v[108:111], v[152:155], v[32:35]
    ds_read_b128 v[72:75], v15 offset:26624
    s_waitcnt lgkmcnt(5)
    v_mfma_f32_16x16x32_bf16 v[16:19], v[92:95], v[156:159], v[16:19]
    ds_read_b128 v[56:59], v15 offset:22528
    v_mfma_f32_16x16x32_bf16 v[20:23], v[96:99], v[156:159], v[20:23]
    ds_read_b128 v[60:63], v15 offset:23552
    v_mfma_f32_16x16x32_bf16 v[24:27], v[100:103], v[156:159], v[24:27]
    ds_read_b128 v[64:67], v15 offset:24576
    v_mfma_f32_16x16x32_bf16 v[28:31], v[104:107], v[156:159], v[28:31]
    ds_read_b128 v[68:71], v15 offset:25600
    v_mfma_f32_16x16x32_bf16 v[36:39], v[108:111], v[156:159], v[36:39]
    s_waitcnt vmcnt(6) lgkmcnt(4)
    v_mfma_f32_16x16x32_bf16 v[16:19], v[40:43], v[160:163], v[16:19]
    ds_read_b128 v[76:79], v15 offset:27648
    v_mfma_f32_16x16x32_bf16 v[20:23], v[44:47], v[160:163], v[20:23]
    ds_read_b128 v[80:83], v15 offset:28672
    v_mfma_f32_16x16x32_bf16 v[24:27], v[48:51], v[160:163], v[24:27]
    ds_read_b128 v[84:87], v15 offset:29696
    v_mfma_f32_16x16x32_bf16 v[28:31], v[52:55], v[160:163], v[28:31]
    ds_read_b128 v[88:91], v15 offset:30720
    v_mfma_f32_16x16x32_bf16 v[32:35], v[72:75], v[160:163], v[32:35]
    ds_read_b128 v[108:111], v15 offset:35840
    s_waitcnt lgkmcnt(5)
    v_mfma_f32_16x16x32_bf16 v[16:19], v[56:59], v[164:167], v[16:19]
    ds_read_b128 v[92:95], v15 offset:31744
    v_mfma_f32_16x16x32_bf16 v[20:23], v[60:63], v[164:167], v[20:23]
    ds_read_b128 v[96:99], v15 offset:32768
    v_mfma_f32_16x16x32_bf16 v[24:27], v[64:67], v[164:167], v[24:27]
    ds_read_b128 v[100:103], v15 offset:33792
    v_mfma_f32_16x16x32_bf16 v[28:31], v[68:71], v[164:167], v[28:31]
    ds_read_b128 v[104:107], v15 offset:34816
    v_mfma_f32_16x16x32_bf16 v[36:39], v[72:75], v[164:167], v[36:39]
    s_waitcnt vmcnt(4) lgkmcnt(4)
    v_mfma_f32_16x16x32_bf16 v[16:19], v[76:79], v[168:171], v[16:19]
    ds_read_b128 v[40:43], v15 offset:36864
    v_mfma_f32_16x16x32_bf16 v[20:23], v[80:83], v[168:171], v[20:23]
    ds_read_b128 v[44:47], v15 offset:37888
    v_mfma_f32_16x16x32_bf16 v[24:27], v[84:87], v[168:171], v[24:27]
    ds_read_b128 v[48:51], v15 offset:38912
    v_mfma_f32_16x16x32_bf16 v[28:31], v[88:91], v[168:171], v[28:31]
    ds_read_b128 v[52:55], v15 offset:39936
    v_mfma_f32_16x16x32_bf16 v[32:35], v[108:111], v[168:171], v[32:35]
    ds_read_b128 v[72:75], v15 offset:45056
    s_waitcnt lgkmcnt(5)
    v_mfma_f32_16x16x32_bf16 v[16:19], v[92:95], v[172:175], v[16:19]
    ds_read_b128 v[56:59], v15 offset:40960
    v_mfma_f32_16x16x32_bf16 v[20:23], v[96:99], v[172:175], v[20:23]
    ds_read_b128 v[60:63], v15 offset:41984
    v_mfma_f32_16x16x32_bf16 v[24:27], v[100:103], v[172:175], v[24:27]
    ds_read_b128 v[64:67], v15 offset:43008
    v_mfma_f32_16x16x32_bf16 v[28:31], v[104:107], v[172:175], v[28:31]
    ds_read_b128 v[68:71], v15 offset:44032
    v_mfma_f32_16x16x32_bf16 v[36:39], v[108:111], v[172:175], v[36:39]
    s_waitcnt vmcnt(0) lgkmcnt(4)
    v_mfma_f32_16x16x32_bf16 v[16:19], v[40:43], v[176:179], v[16:19]
    v_mfma_f32_16x16x32_bf16 v[20:23], v[44:47], v[176:179], v[20:23]
    v_mfma_f32_16x16x32_bf16 v[24:27], v[48:51], v[176:179], v[24:27]
    v_mfma_f32_16x16x32_bf16 v[28:31], v[52:55], v[176:179], v[28:31]
    v_mfma_f32_16x16x32_bf16 v[32:35], v[72:75], v[176:179], v[32:35]
    s_waitcnt lgkmcnt(0)
    v_mfma_f32_16x16x32_bf16 v[16:19], v[56:59], v[180:183], v[16:19]
    v_mfma_f32_16x16x32_bf16 v[20:23], v[60:63], v[180:183], v[20:23]
    v_mfma_f32_16x16x32_bf16 v[24:27], v[64:67], v[180:183], v[24:27]
    v_mfma_f32_16x16x32_bf16 v[28:31], v[68:71], v[180:183], v[28:31]
    v_mfma_f32_16x16x32_bf16 v[36:39], v[72:75], v[180:183], v[36:39]
    s_nop 3
    v_cvt_pk_bf16_f32 v208, v16, v17
    v_cvt_pk_bf16_f32 v209, v18, v19
    v_cvt_pk_bf16_f32 v210, v20, v21
    v_cvt_pk_bf16_f32 v211, v22, v23
    v_cvt_pk_bf16_f32 v212, v24, v25
    v_cvt_pk_bf16_f32 v213, v26, v27
    v_cvt_pk_bf16_f32 v214, v28, v29
    v_cvt_pk_bf16_f32 v215, v30, v31
    buffer_store_dwordx4 v[208:211], v4, s[4:7], s34 offen offset:0 sc1
    buffer_store_dwordx4 v[212:215], v4, s[4:7], s34 offen offset:1024 sc1
    v_permlane32_swap_b32 v36, v220
    v_permlane32_swap_b32 v37, v221
    v_permlane32_swap_b32 v38, v222
    v_permlane32_swap_b32 v39, v223
    v_pk_add_f32 v[32:33], v[32:33], v[220:221]
    v_pk_add_f32 v[34:35], v[34:35], v[222:223]
    v_cvt_pk_bf16_f32 v216, v32, v33
    v_cvt_pk_bf16_f32 v217, v34, v35
    buffer_store_dwordx2 v[216:217], v5, s[4:7], s34 offen sc1
    v_cndmask_b32 v222, 0, v216, s[40:41]
    v_cndmask_b32 v223, 0, v217, s[40:41]
    v_dot2_f32_bf16 v220, v208, v11, 0
    v_dot2_f32_bf16 v221, v208, v208, 0
    v_dot2_f32_bf16 v224, v209, v11, 0
    v_dot2_f32_bf16 v225, v209, v209, 0
    v_dot2_f32_bf16 v220, v210, v11, v220
    v_dot2_f32_bf16 v221, v210, v210, v221
    v_dot2_f32_bf16 v224, v211, v11, v224
    v_dot2_f32_bf16 v225, v211, v211, v225
    v_dot2_f32_bf16 v220, v212, v11, v220
    v_dot2_f32_bf16 v221, v212, v212, v221
    v_dot2_f32_bf16 v224, v213, v11, v224
    v_dot2_f32_bf16 v225, v213, v213, v225
    v_dot2_f32_bf16 v220, v214, v11, v220
    v_dot2_f32_bf16 v221, v214, v214, v221
    v_dot2_f32_bf16 v224, v215, v11, v224
    v_dot2_f32_bf16 v225, v215, v215, v225
    v_dot2_f32_bf16 v220, v222, v11, v220
    v_dot2_f32_bf16 v221, v222, v222, v221
    v_dot2_f32_bf16 v224, v223, v11, v224
    v_dot2_f32_bf16 v225, v223, v223, v225
    s_nop 2
    v_pk_add_f32 v[220:221], v[220:221], v[224:225]
    v_mov_b32 v222, v220
    v_mov_b32 v223, v221
    s_nop 1
    v_permlane32_swap_b32 v220, v222
    v_permlane32_swap_b32 v221, v223
    v_add_f32 v220, v220, v222
    v_add_f32 v221, v221, v223
    v_mov_b32 v222, v220
    v_mov_b32 v223, v221
    s_nop 1
    v_permlane16_swap_b32 v220, v222
    v_permlane16_swap_b32 v221, v223
    v_add_f32 v220, v220, v222
    v_add_f32 v221, v221, v223
    buffer_store_dwordx2 v[220:221], v10, s[4:7], s39 offen sc1
    s_and_b32 s25, s2, 7
    s_lshr_b32 s26, s2, 3
    s_and_b32 s23, s25, 1
    s_lshl_b32 s23, s23, 3
    s_and_b32 s27, s26, 7
    s_add_u32 s23, s23, s27
    s_lshr_b32 s24, s25, 1
    s_lshl_b32 s24, s24, 2
    s_lshr_b32 s27, s26, 3
    s_add_u32 s24, s24, s27
    s_add_u32 s28, s23, s24
    s_and_b32 s28, s28, 3
    s_lshl_b32 s30, s20, 12
    s_lshl_b32 s31, s23, 3
    s_lshl_b32 s33, s20, 1
    s_add_u32 s31, s31, s33
    s_lshl_b32 s32, s31, 10
    s_add_u32 s32, s32, s21
    s_add_u32 s32, s32, 0x1b20000
    v_add_u32 v2, 73728, v1
    s_add_u32 s33, s30, 18432
    v_add_u32 v3, s33, v1
    v_add_u32 v0, s33, v2
    s_lshr_b32 s34, s31, 1
    s_lshl_b32 s35, s34, 12
    s_add_u32 s35, s35, s21
    s_add_u32 s35, s35, 0x1b40000
    s_lshl_b32 s36, s24, 8
    s_add_u32 s36, s36, s35
    s_lshl_b32 s38, s24, 6
    s_add_u32 s38, s38, s34
    s_mul_i32 s38, s38, 9216
    s_add_u32 s38, s38, s21
    s_add_u32 s38, s38, 0x900000
    s_add_u32 s39, s38, 4096
    s_add_u32 s46, s38, 8192
    s_mov_b32 s40, 0xc0135761
    s_mov_b32 s42, 0x3d372713
    s_mov_b32 s44, 0x39e38e39
    s_mov_b32 s45, 0x3727c5ac
    v_lshrrev_b32 v4, 1, v1
    s_lshl_b32 s52, s22, 7
    s_add_u32 s52, s52, s23
    s_lshl_b32 s52, s52, 8
    s_add_u32 s52, s52, 0x4509000
    s_add_u32 s52, s52, s4
    s_addc_u32 s53, s5, 0
    s_waitcnt vmcnt(0)
    s_barrier
    s_cmp_lg_u32 s20, 0
    s_cbranch_scc1 L_ns_d3
    s_mov_b32 s56, 1
    s_atomic_add s56, s[50:51], 0
L_ns_d3:
    s_cmp_lg_u32 s20, 0
    s_cbranch_scc1 L_pd_d3
    s_mov_b32 s60, 65536
L_poll_d3:
    s_mov_b32 s57, 0
    s_atomic_add s57, s[52:53], 0 glc
    s_waitcnt lgkmcnt(0)
    s_cmp_ge_u32 s57, 16
    s_cbranch_scc1 L_pd_d3
    s_sub_u32 s60, s60, 1
    s_cbranch_scc1 L_pd_d3
    s_sleep 2
    s_branch L_poll_d3
L_pd_d3:
    s_barrier
    buffer_load_dwordx2 v[8:9], v4, s[4:7], s32 offen offset:0 sc1
    buffer_load_dwordx2 v[10:11], v4, s[4:7], s32 offen offset:512 sc1
    buffer_load_dwordx2 v[12:13], v4, s[4:7], s32 offen offset:1024 sc1
    buffer_load_dwordx2 v[14:15], v4, s[4:7], s32 offen offset:1536 sc1
    s_lshl_b32 s50, s22, 7
    s_add_u32 s50, s50, s23
    s_lshl_b32 s50, s50, 8
    s_add_u32 s50, s50, 0x450a000
    s_add_u32 s50, s50, s4
    s_addc_u32 s51, s5, 0
    s_barrier
    ds_read_b128 v[160:163], v3 offset:0
    ds_read_b128 v[164:167], v3 offset:2048
    ds_read_b128 v[168:171], v1 offset:0
    ds_read_b128 v[172:175], v1 offset:1024
    ds_read_b128 v[176:179], v1 offset:2048
    ds_read_b128 v[180:183], v1 offset:3072
    ds_read_b128 v[184:187], v1 offset:4096
    ds_read_b128 v[188:191], v1 offset:5120
    ds_read_b128 v[192:195], v1 offset:6144
    ds_read_b128 v[196:199], v1 offset:7168
    ds_read_b128 v[200:203], v1 offset:8192
    s_waitcnt lgkmcnt(5)
    v_mfma_f32_16x16x32_bf16 v[16:19], v[160:163], v[168:171], 0
    ds_read_b128 v[204:207], v3 offset:1024
    v_mfma_f32_16x16x32_bf16 v[20:23], v[164:167], v[168:171], 0
    ds_read_b128 v[208:211], v3 offset:3072
    v_mfma_f32_16x16x32_bf16 v[24:27], v[160:163], v[172:175], 0
    ds_read_b128 v[212:215], v1 offset:9216
    v_mfma_f32_16x16x32_bf16 v[28:31], v[164:167], v[172:175], 0
    ds_read_b128 v[216:219], v1 offset:10240
    v_mfma_f32_16x16x32_bf16 v[32:35], v[160:163], v[176:179], 0
    ds_read_b128 v[220:223], v1 offset:11264
    v_mfma_f32_16x16x32_bf16 v[36:39], v[164:167], v[176:179], 0
    ds_read_b128 v[224:227], v1 offset:12288
    v_mfma_f32_16x16x32_bf16 v[40:43], v[160:163], v[180:183], 0
    ds_read_b128 v[228:231], v1 offset:13312
    v_mfma_f32_16x16x32_bf16 v[44:47], v[164:167], v[180:183], 0
    ds_read_b128 v[232:235], v1 offset:14336
    s_waitcnt lgkmcnt(8)
    v_mfma_f32_16x16x32_bf16 v[48:51], v[160:163], v[184:187], 0
    ds_read_b128 v[236:239], v1 offset:15360
    v_mfma_f32_16x16x32_bf16 v[52:55], v[164:167], v[184:187], 0
    ds_read_b128 v[240:243], v1 offset:16384
    v_mfma_f32_16x16x32_bf16 v[56:59], v[160:163], v[188:191], 0
    ds_read_b128 v[244:247], v1 offset:17408
    v_mfma_f32_16x16x32_bf16 v[60:63], v[164:167], v[188:191], 0
    v_mfma_f32_16x16x32_bf16 v[64:67], v[160:163], v[192:195], 0
    v_mfma_f32_16x16x32_bf16 v[68:71], v[164:167], v[192:195], 0
    v_mfma_f32_16x16x32_bf16 v[72:75], v[160:163], v[196:199], 0
    v_mfma_f32_16x16x32_bf16 v[76:79], v[164:167], v[196:199], 0
    v_mfma_f32_16x16x32_bf16 v[80:83], v[160:163], v[200:203], 0
    v_mfma_f32_16x16x32_bf16 v[84:87], v[164:167], v[200:203], 0
    s_waitcnt lgkmcnt(0)
    s_barrier
    v_mfma_f32_16x16x32_bf16 v[16:19], v[204:207], v[212:215], v[16:19]
    ds_read_b128 v[160:163], v3 offset:36864
    v_mfma_f32_16x16x32_bf16 v[20:23], v[208:211], v[212:215], v[20:23]
    ds_read_b128 v[164:167], v3 offset:38912
    v_mfma_f32_16x16x32_bf16 v[24:27], v[204:207], v[216:219], v[24:27]
    ds_read_b128 v[168:171], v1 offset:36864
    v_mfma_f32_16x16x32_bf16 v[28:31], v[208:211], v[216:219], v[28:31]
    ds_read_b128 v[172:175], v1 offset:37888
    v_mfma_f32_16x16x32_bf16 v[32:35], v[204:207], v[220:223], v[32:35]
    ds_read_b128 v[176:179], v1 offset:38912
    v_mfma_f32_16x16x32_bf16 v[36:39], v[208:211], v[220:223], v[36:39]
    ds_read_b128 v[180:183], v1 offset:39936
    v_mfma_f32_16x16x32_bf16 v[40:43], v[204:207], v[224:227], v[40:43]
    ds_read_b128 v[184:187], v1 offset:40960
    v_mfma_f32_16x16x32_bf16 v[44:47], v[208:211], v[224:227], v[44:47]
    ds_read_b128 v[188:191], v1 offset:41984
    v_mfma_f32_16x16x32_bf16 v[48:51], v[204:207], v[228:231], v[48:51]
    ds_read_b128 v[192:195], v1 offset:43008
    v_mfma_f32_16x16x32_bf16 v[52:55], v[208:211], v[228:231], v[52:55]
    ds_read_b128 v[196:199], v1 offset:44032
    v_lshrrev_b32 v5, 8, v1
    v_mfma_f32_16x16x32_bf16 v[56:59], v[204:207], v[232:235], v[56:59]
    ds_read_b128 v[200:203], v1 offset:45056
    v_bfe_u32 v6, v1, 4, 4
    v_mfma_f32_16x16x32_bf16 v[60:63], v[208:211], v[232:235], v[60:63]
    v_lshlrev_b32 v7, 2, v6
    v_mfma_f32_16x16x32_bf16 v[64:67], v[204:207], v[236:239], v[64:67]
    s_lshl_b32 s33, s20, 8
    v_mfma_f32_16x16x32_bf16 v[68:71], v[208:211], v[236:239], v[68:71]
    s_add_u32 s33, s33, 147456
    v_mfma_f32_16x16x32_bf16 v[72:75], v[204:207], v[240:243], v[72:75]
    v_add_u32 v4, s33, v7
    v_mfma_f32_16x16x32_bf16 v[76:79], v[208:211], v[240:243], v[76:79]
    v_lshl_add_u32 v252, v5, 4, s33
    v_mfma_f32_16x16x32_bf16 v[80:83], v[204:207], v[244:247], v[80:83]
    v_add_u32 v7, 159744, v7
    v_mfma_f32_16x16x32_bf16 v[84:87], v[208:211], v[244:247], v[84:87]
    s_waitcnt vmcnt(0)
    v_add_f32 v248, v8, v10
    s_waitcnt lgkmcnt(5)
    v_mfma_f32_16x16x32_bf16 v[16:19], v[160:163], v[168:171], v[16:19]
    ds_read_b128 v[204:207], v3 offset:37888
    v_mfma_f32_16x16x32_bf16 v[20:23], v[164:167], v[168:171], v[20:23]
    ds_read_b128 v[208:211], v3 offset:39936
    v_mfma_f32_16x16x32_bf16 v[24:27], v[160:163], v[172:175], v[24:27]
    ds_read_b128 v[212:215], v1 offset:46080
    v_mfma_f32_16x16x32_bf16 v[28:31], v[164:167], v[172:175], v[28:31]
    ds_read_b128 v[216:219], v1 offset:47104
    v_mfma_f32_16x16x32_bf16 v[32:35], v[160:163], v[176:179], v[32:35]
    ds_read_b128 v[220:223], v1 offset:48128
    v_mfma_f32_16x16x32_bf16 v[36:39], v[164:167], v[176:179], v[36:39]
    ds_read_b128 v[224:227], v1 offset:49152
    v_mfma_f32_16x16x32_bf16 v[40:43], v[160:163], v[180:183], v[40:43]
    ds_read_b128 v[228:231], v1 offset:50176
    v_mfma_f32_16x16x32_bf16 v[44:47], v[164:167], v[180:183], v[44:47]
    ds_read_b128 v[232:235], v1 offset:51200
    s_waitcnt lgkmcnt(8)
    v_mfma_f32_16x16x32_bf16 v[48:51], v[160:163], v[184:187], v[48:51]
    ds_read_b128 v[236:239], v1 offset:52224
    v_mfma_f32_16x16x32_bf16 v[52:55], v[164:167], v[184:187], v[52:55]
    ds_read_b128 v[240:243], v1 offset:53248
    v_add_f32 v249, v9, v11
    v_mfma_f32_16x16x32_bf16 v[56:59], v[160:163], v[188:191], v[56:59]
    ds_read_b128 v[244:247], v1 offset:54272
    v_add_f32 v250, v12, v14
    v_mfma_f32_16x16x32_bf16 v[60:63], v[164:167], v[188:191], v[60:63]
    v_add_f32 v251, v13, v15
    v_mfma_f32_16x16x32_bf16 v[64:67], v[160:163], v[192:195], v[64:67]
    v_mov_b32 v8, v248
    v_mfma_f32_16x16x32_bf16 v[68:71], v[164:167], v[192:195], v[68:71]
    v_mov_b32 v9, v249
    v_mfma_f32_16x16x32_bf16 v[72:75], v[160:163], v[196:199], v[72:75]
    v_mov_b32 v12, v250
    v_mfma_f32_16x16x32_bf16 v[76:79], v[164:167], v[196:199], v[76:79]
    v_mov_b32 v13, v251
    v_mfma_f32_16x16x32_bf16 v[80:83], v[160:163], v[200:203], v[80:83]
    v_permlane32_swap_b32 v248, v8
    v_mfma_f32_16x16x32_bf16 v[84:87], v[164:167], v[200:203], v[84:87]
    v_permlane32_swap_b32 v249, v9
    v_permlane32_swap_b32 v250, v12
    s_waitcnt lgkmcnt(0)
    s_barrier
    v_mfma_f32_16x16x32_bf16 v[16:19], v[204:207], v[212:215], v[16:19]
    ds_read_b128 v[160:163], v0 offset:0
    v_mfma_f32_16x16x32_bf16 v[20:23], v[208:211], v[212:215], v[20:23]
    ds_read_b128 v[164:167], v0 offset:2048
    v_mfma_f32_16x16x32_bf16 v[24:27], v[204:207], v[216:219], v[24:27]
    ds_read_b128 v[168:171], v2 offset:0
    v_mfma_f32_16x16x32_bf16 v[28:31], v[208:211], v[216:219], v[28:31]
    ds_read_b128 v[172:175], v2 offset:1024
    v_mfma_f32_16x16x32_bf16 v[32:35], v[204:207], v[220:223], v[32:35]
    ds_read_b128 v[176:179], v2 offset:2048
    v_mfma_f32_16x16x32_bf16 v[36:39], v[208:211], v[220:223], v[36:39]
    ds_read_b128 v[180:183], v2 offset:3072
    v_mfma_f32_16x16x32_bf16 v[40:43], v[204:207], v[224:227], v[40:43]
    ds_read_b128 v[184:187], v2 offset:4096
    v_mfma_f32_16x16x32_bf16 v[44:47], v[208:211], v[224:227], v[44:47]
    ds_read_b128 v[188:191], v2 offset:5120
    v_mfma_f32_16x16x32_bf16 v[48:51], v[204:207], v[228:231], v[48:51]
    ds_read_b128 v[192:195], v2 offset:6144
    v_mfma_f32_16x16x32_bf16 v[52:55], v[208:211], v[228:231], v[52:55]
    ds_read_b128 v[196:199], v2 offset:7168
    v_permlane32_swap_b32 v251, v13
    v_mfma_f32_16x16x32_bf16 v[56:59], v[204:207], v[232:235], v[56:59]
    ds_read_b128 v[200:203], v2 offset:8192
    v_add_f32 v248, v248, v8
    v_mfma_f32_16x16x32_bf16 v[60:63], v[208:211], v[232:235], v[60:63]
    ds_read2_b32 v[128:129], v7 offset0:0 offset1:16
    v_add_f32 v249, v249, v9
    v_mfma_f32_16x16x32_bf16 v[64:67], v[204:207], v[236:239], v[64:67]
    ds_read2_b32 v[130:131], v7 offset0:32 offset1:48
    v_add_f32 v250, v250, v12
    v_mfma_f32_16x16x32_bf16 v[68:71], v[208:211], v[236:239], v[68:71]
    ds_read2_b32 v[132:133], v7 offset0:64 offset1:80
    v_add_f32 v251, v251, v13
    v_mfma_f32_16x16x32_bf16 v[72:75], v[204:207], v[240:243], v[72:75]
    ds_read2_b32 v[134:135], v7 offset0:96 offset1:112
    v_mov_b32 v8, v248
    v_mfma_f32_16x16x32_bf16 v[76:79], v[208:211], v[240:243], v[76:79]
    ds_read2_b32 v[136:137], v7 offset0:128 offset1:144
    v_mov_b32 v9, v249
    v_mfma_f32_16x16x32_bf16 v[80:83], v[204:207], v[244:247], v[80:83]
    v_mov_b32 v12, v250
    v_mfma_f32_16x16x32_bf16 v[84:87], v[208:211], v[244:247], v[84:87]
    v_mov_b32 v13, v251
    v_permlane16_swap_b32 v248, v8
    s_waitcnt lgkmcnt(10)
    v_mfma_f32_16x16x32_bf16 v[16:19], v[160:163], v[168:171], v[16:19]
    ds_read_b128 v[204:207], v0 offset:1024
    v_mfma_f32_16x16x32_bf16 v[20:23], v[164:167], v[168:171], v[20:23]
    ds_read_b128 v[208:211], v0 offset:3072
    v_mfma_f32_16x16x32_bf16 v[24:27], v[160:163], v[172:175], v[24:27]
    ds_read_b128 v[212:215], v2 offset:9216
    v_mfma_f32_16x16x32_bf16 v[28:31], v[164:167], v[172:175], v[28:31]
    ds_read_b128 v[216:219], v2 offset:10240
    v_mfma_f32_16x16x32_bf16 v[32:35], v[160:163], v[176:179], v[32:35]
    ds_read_b128 v[220:223], v2 offset:11264
    v_mfma_f32_16x16x32_bf16 v[36:39], v[164:167], v[176:179], v[36:39]
    ds_read_b128 v[224:227], v2 offset:12288
    v_mfma_f32_16x16x32_bf16 v[40:43], v[160:163], v[180:183], v[40:43]
    ds_read_b128 v[228:231], v2 offset:13312
    v_mfma_f32_16x16x32_bf16 v[44:47], v[164:167], v[180:183], v[44:47]
    ds_read_b128 v[232:235], v2 offset:14336
    s_waitcnt lgkmcnt(8)
    v_mfma_f32_16x16x32_bf16 v[48:51], v[160:163], v[184:187], v[48:51]
    ds_read_b128 v[236:239], v2 offset:15360
    v_mfma_f32_16x16x32_bf16 v[52:55], v[164:167], v[184:187], v[52:55]
    ds_read_b128 v[240:243], v2 offset:16384
    v_permlane16_swap_b32 v249, v9
    v_mfma_f32_16x16x32_bf16 v[56:59], v[160:163], v[188:191], v[56:59]
    ds_read_b128 v[244:247], v2 offset:17408
    v_permlane16_swap_b32 v250, v12
    v_mfma_f32_16x16x32_bf16 v[60:63], v[164:167], v[188:191], v[60:63]
    v_permlane16_swap_b32 v251, v13
    v_mfma_f32_16x16x32_bf16 v[64:67], v[160:163], v[192:195], v[64:67]
    v_add_f32 v248, v248, v8
    v_mfma_f32_16x16x32_bf16 v[68:71], v[164:167], v[192:195], v[68:71]
    v_add_f32 v249, v249, v9
    v_mfma_f32_16x16x32_bf16 v[72:75], v[160:163], v[196:199], v[72:75]
    v_add_f32 v250, v250, v12
    v_mfma_f32_16x16x32_bf16 v[76:79], v[164:167], v[196:199], v[76:79]
    v_add_f32 v251, v251, v13
    v_mfma_f32_16x16x32_bf16 v[80:83], v[160:163], v[200:203], v[80:83]
    v_mul_f32 v248, 0x3ae38e39, v248
    v_mfma_f32_16x16x32_bf16 v[84:87], v[164:167], v[200:203], v[84:87]
    v_mul_f32 v249, 0x3ae38e39, v249
    v_mul_f32 v250, 0x3ae38e39, v250
    s_waitcnt lgkmcnt(0)
    s_barrier
    v_mfma_f32_16x16x32_bf16 v[16:19], v[204:207], v[212:215], v[16:19]
    ds_read_b128 v[160:163], v0 offset:36864
    v_mfma_f32_16x16x32_bf16 v[20:23], v[208:211], v[212:215], v[20:23]
    ds_read_b128 v[164:167], v0 offset:38912
    v_mfma_f32_16x16x32_bf16 v[24:27], v[204:207], v[216:219], v[24:27]
    ds_read_b128 v[168:171], v2 offset:36864
    v_mfma_f32_16x16x32_bf16 v[28:31], v[208:211], v[216:219], v[28:31]
    ds_read_b128 v[172:175], v2 offset:37888
    v_mfma_f32_16x16x32_bf16 v[32:35], v[204:207], v[220:223], v[32:35]
    ds_read_b128 v[176:179], v2 offset:38912
    v_mfma_f32_16x16x32_bf16 v[36:39], v[208:211], v[220:223], v[36:39]
    ds_read_b128 v[180:183], v2 offset:39936
    v_mfma_f32_16x16x32_bf16 v[40:43], v[204:207], v[224:227], v[40:43]
    ds_read_b128 v[184:187], v2 offset:40960
    v_mfma_f32_16x16x32_bf16 v[44:47], v[208:211], v[224:227], v[44:47]
    ds_read_b128 v[188:191], v2 offset:41984
    v_mfma_f32_16x16x32_bf16 v[48:51], v[204:207], v[228:231], v[48:51]
    ds_read_b128 v[192:195], v2 offset:43008
    v_mfma_f32_16x16x32_bf16 v[52:55], v[208:211], v[228:231], v[52:55]
    ds_read_b128 v[196:199], v2 offset:44032
    v_mul_f32 v251, 0x3ae38e39, v251
    v_mfma_f32_16x16x32_bf16 v[56:59], v[204:207], v[232:235], v[56:59]
    ds_read_b128 v[200:203], v2 offset:45056
    v_fma_f32 v249, -v248, v248, v249
    v_mfma_f32_16x16x32_bf16 v[60:63], v[208:211], v[232:235], v[60:63]
    v_fma_f32 v251, -v250, v250, v251
    v_mfma_f32_16x16x32_bf16 v[64:67], v[204:207], v[236:239], v[64:67]
    v_max_f32 v249, 0, v249
    v_mfma_f32_16x16x32_bf16 v[68:71], v[208:211], v[236:239], v[68:71]
    v_max_f32 v251, 0, v251
    v_mfma_f32_16x16x32_bf16 v[72:75], v[204:207], v[240:243], v[72:75]
    v_add_f32 v249, 0x3727c5ac, v249
    v_mfma_f32_16x16x32_bf16 v[76:79], v[208:211], v[240:243], v[76:79]
    v_add_f32 v251, 0x3727c5ac, v251
    v_mfma_f32_16x16x32_bf16 v[80:83], v[204:207], v[244:247], v[80:83]
    v_rsq_f32 v249, v249
    v_mfma_f32_16x16x32_bf16 v[84:87], v[208:211], v[244:247], v[84:87]
    v_rsq_f32 v251, v251
    s_nop 0
    s_waitcnt lgkmcnt(5)
    v_mfma_f32_16x16x32_bf16 v[16:19], v[160:163], v[168:171], v[16:19]
    ds_read_b128 v[204:207], v0 offset:37888
    v_mfma_f32_16x16x32_bf16 v[20:23], v[164:167], v[168:171], v[20:23]
    ds_read_b128 v[208:211], v0 offset:39936
    v_mfma_f32_16x16x32_bf16 v[24:27], v[160:163], v[172:175], v[24:27]
    ds_read_b128 v[212:215], v2 offset:46080
    v_mfma_f32_16x16x32_bf16 v[28:31], v[164:167], v[172:175], v[28:31]
    ds_read_b128 v[216:219], v2 offset:47104
    v_mfma_f32_16x16x32_bf16 v[32:35], v[160:163], v[176:179], v[32:35]
    ds_read_b128 v[220:223], v2 offset:48128
    v_mfma_f32_16x16x32_bf16 v[36:39], v[164:167], v[176:179], v[36:39]
    ds_read_b128 v[224:227], v2 offset:49152
    v_mfma_f32_16x16x32_bf16 v[40:43], v[160:163], v[180:183], v[40:43]
    ds_read_b128 v[228:231], v2 offset:50176
    v_mfma_f32_16x16x32_bf16 v[44:47], v[164:167], v[180:183], v[44:47]
    ds_read_b128 v[232:235], v2 offset:51200
    s_waitcnt lgkmcnt(8)
    v_mfma_f32_16x16x32_bf16 v[48:51], v[160:163], v[184:187], v[48:51]
    ds_read_b128 v[236:239], v2 offset:52224
    v_mfma_f32_16x16x32_bf16 v[52:55], v[164:167], v[184:187], v[52:55]
    ds_read_b128 v[240:243], v2 offset:53248
    v_mfma_f32_16x16x32_bf16 v[56:59], v[160:163], v[188:191], v[56:59]
    ds_read_b128 v[244:247], v2 offset:54272
    v_mfma_f32_16x16x32_bf16 v[60:63], v[164:167], v[188:191], v[60:63]
    v_mfma_f32_16x16x32_bf16 v[64:67], v[160:163], v[192:195], v[64:67]
    v_mfma_f32_16x16x32_bf16 v[68:71], v[164:167], v[192:195], v[68:71]
    v_mfma_f32_16x16x32_bf16 v[72:75], v[160:163], v[196:199], v[72:75]
    v_mfma_f32_16x16x32_bf16 v[76:79], v[164:167], v[196:199], v[76:79]
    v_mfma_f32_16x16x32_bf16 v[80:83], v[160:163], v[200:203], v[80:83]
    v_mfma_f32_16x16x32_bf16 v[84:87], v[164:167], v[200:203], v[84:87]
    s_waitcnt lgkmcnt(0)
    s_barrier
    v_mfma_f32_16x16x32_bf16 v[16:19], v[204:207], v[212:215], v[16:19]
    ds_read_b128 v[160:163], v3 offset:0
    v_mfma_f32_16x16x32_bf16 v[20:23], v[208:211], v[212:215], v[20:23]
    ds_read_b128 v[164:167], v3 offset:2048
    v_mfma_f32_16x16x32_bf16 v[24:27], v[204:207], v[216:219], v[24:27]
    ds_read_b128 v[168:171], v1 offset:0
    v_mfma_f32_16x16x32_bf16 v[28:31], v[208:211], v[216:219], v[28:31]
    ds_read_b128 v[172:175], v1 offset:1024
    v_mfma_f32_16x16x32_bf16 v[32:35], v[204:207], v[220:223], v[32:35]
    ds_read_b128 v[176:179], v1 offset:2048
    v_mfma_f32_16x16x32_bf16 v[36:39], v[208:211], v[220:223], v[36:39]
    ds_read_b128 v[180:183], v1 offset:3072
    v_mfma_f32_16x16x32_bf16 v[40:43], v[204:207], v[224:227], v[40:43]
    ds_read_b128 v[184:187], v1 offset:4096
    v_mfma_f32_16x16x32_bf16 v[44:47], v[208:211], v[224:227], v[44:47]
    ds_read_b128 v[188:191], v1 offset:5120
    v_mfma_f32_16x16x32_bf16 v[48:51], v[204:207], v[228:231], v[48:51]
    ds_read_b128 v[192:195], v1 offset:6144
    v_mfma_f32_16x16x32_bf16 v[52:55], v[208:211], v[228:231], v[52:55]
    ds_read_b128 v[196:199], v1 offset:7168
    v_mfma_f32_16x16x32_bf16 v[56:59], v[204:207], v[232:235], v[56:59]
    ds_read_b128 v[200:203], v1 offset:8192
    v_mfma_f32_16x16x32_bf16 v[60:63], v[208:211], v[232:235], v[60:63]
    ds_write2_b32 v4, v248, v249 offset0:0 offset1:32
    v_mfma_f32_16x16x32_bf16 v[64:67], v[204:207], v[236:239], v[64:67]
    ds_write2_b32 v4, v250, v251 offset0:16 offset1:48
    v_mfma_f32_16x16x32_bf16 v[68:71], v[208:211], v[236:239], v[68:71]
    ds_read_b128 v[88:91], v252 offset:0
    v_mfma_f32_16x16x32_bf16 v[72:75], v[204:207], v[240:243], v[72:75]
    ds_read_b128 v[92:95], v252 offset:64
    v_mfma_f32_16x16x32_bf16 v[76:79], v[208:211], v[240:243], v[76:79]
    ds_read_b128 v[96:99], v252 offset:128
    v_mfma_f32_16x16x32_bf16 v[80:83], v[204:207], v[244:247], v[80:83]
    ds_read_b128 v[100:103], v252 offset:192
    v_mfma_f32_16x16x32_bf16 v[84:87], v[208:211], v[244:247], v[84:87]
    s_waitcnt lgkmcnt(11)
    v_mfma_f32_16x16x32_bf16 v[16:19], v[160:163], v[168:171], v[16:19]
    ds_read_b128 v[204:207], v3 offset:1024
    v_mfma_f32_16x16x32_bf16 v[20:23], v[164:167], v[168:171], v[20:23]
    ds_read_b128 v[208:211], v3 offset:3072
    v_mfma_f32_16x16x32_bf16 v[24:27], v[160:163], v[172:175], v[24:27]
    ds_read_b128 v[212:215], v1 offset:9216
    v_mfma_f32_16x16x32_bf16 v[28:31], v[164:167], v[172:175], v[28:31]
    ds_read_b128 v[216:219], v1 offset:10240
    v_mfma_f32_16x16x32_bf16 v[32:35], v[160:163], v[176:179], v[32:35]
    ds_read_b128 v[220:223], v1 offset:11264
    v_mfma_f32_16x16x32_bf16 v[36:39], v[164:167], v[176:179], v[36:39]
    ds_read_b128 v[224:227], v1 offset:12288
    v_mfma_f32_16x16x32_bf16 v[40:43], v[160:163], v[180:183], v[40:43]
    ds_read_b128 v[228:231], v1 offset:13312
    v_mfma_f32_16x16x32_bf16 v[44:47], v[164:167], v[180:183], v[44:47]
    ds_read_b128 v[232:235], v1 offset:14336
    s_waitcnt lgkmcnt(8)
    v_mfma_f32_16x16x32_bf16 v[48:51], v[160:163], v[184:187], v[48:51]
    ds_read_b128 v[236:239], v1 offset:15360
    v_mfma_f32_16x16x32_bf16 v[52:55], v[164:167], v[184:187], v[52:55]
    ds_read_b128 v[240:243], v1 offset:16384
    v_rcp_f32 v120, v96
    v_mfma_f32_16x16x32_bf16 v[56:59], v[160:163], v[188:191], v[56:59]
    ds_read_b128 v[244:247], v1 offset:17408
    v_mul_f32 v104, s40, v96
    v_mfma_f32_16x16x32_bf16 v[60:63], v[164:167], v[188:191], v[60:63]
    v_mul_f32 v112, v96, v96
    v_mfma_f32_16x16x32_bf16 v[64:67], v[160:163], v[192:195], v[64:67]
    v_rcp_f32 v121, v97
    v_mfma_f32_16x16x32_bf16 v[68:71], v[164:167], v[192:195], v[68:71]
    v_mul_f32 v105, s40, v97
    v_mfma_f32_16x16x32_bf16 v[72:75], v[160:163], v[196:199], v[72:75]
    v_mul_f32 v113, v97, v97
    v_mfma_f32_16x16x32_bf16 v[76:79], v[164:167], v[196:199], v[76:79]
    v_rcp_f32 v122, v98
    v_mfma_f32_16x16x32_bf16 v[80:83], v[160:163], v[200:203], v[80:83]
    v_mul_f32 v106, s40, v98
    v_mfma_f32_16x16x32_bf16 v[84:87], v[164:167], v[200:203], v[84:87]
    v_mul_f32 v114, v98, v98
    v_rcp_f32 v123, v99
    s_waitcnt lgkmcnt(0)
    s_barrier
    v_mfma_f32_16x16x32_bf16 v[16:19], v[204:207], v[212:215], v[16:19]
    ds_read_b128 v[160:163], v3 offset:36864
    v_mfma_f32_16x16x32_bf16 v[20:23], v[208:211], v[212:215], v[20:23]
    ds_read_b128 v[164:167], v3 offset:38912
    v_mfma_f32_16x16x32_bf16 v[24:27], v[204:207], v[216:219], v[24:27]
    ds_read_b128 v[168:171], v1 offset:36864
    v_mfma_f32_16x16x32_bf16 v[28:31], v[208:211], v[216:219], v[28:31]
    ds_read_b128 v[172:175], v1 offset:37888
    v_mfma_f32_16x16x32_bf16 v[32:35], v[204:207], v[220:223], v[32:35]
    ds_read_b128 v[176:179], v1 offset:38912
    v_mfma_f32_16x16x32_bf16 v[36:39], v[208:211], v[220:223], v[36:39]
    ds_read_b128 v[180:183], v1 offset:39936
    v_mfma_f32_16x16x32_bf16 v[40:43], v[204:207], v[224:227], v[40:43]
    ds_read_b128 v[184:187], v1 offset:40960
    v_mfma_f32_16x16x32_bf16 v[44:47], v[208:211], v[224:227], v[44:47]
    ds_read_b128 v[188:191], v1 offset:41984
    v_mfma_f32_16x16x32_bf16 v[48:51], v[204:207], v[228:231], v[48:51]
    ds_read_b128 v[192:195], v1 offset:43008
    v_mfma_f32_16x16x32_bf16 v[52:55], v[208:211], v[228:231], v[52:55]
    ds_read_b128 v[196:199], v1 offset:44032
    v_mul_f32 v107, s40, v99
    v_mfma_f32_16x16x32_bf16 v[56:59], v[204:207], v[232:235], v[56:59]
    ds_read_b128 v[200:203], v1 offset:45056
    v_mul_f32 v115, v99, v99
    v_mfma_f32_16x16x32_bf16 v[60:63], v[208:211], v[232:235], v[60:63]
    v_rcp_f32 v124, v100
    v_mfma_f32_16x16x32_bf16 v[64:67], v[204:207], v[236:239], v[64:67]
    v_mul_f32 v108, s40, v100
    v_mfma_f32_16x16x32_bf16 v[68:71], v[208:211], v[236:239], v[68:71]
    v_mul_f32 v116, v100, v100
    v_mfma_f32_16x16x32_bf16 v[72:75], v[204:207], v[240:243], v[72:75]
    v_rcp_f32 v125, v101
    v_mfma_f32_16x16x32_bf16 v[76:79], v[208:211], v[240:243], v[76:79]
    v_mul_f32 v109, s40, v101
    v_mfma_f32_16x16x32_bf16 v[80:83], v[204:207], v[244:247], v[80:83]
    v_mul_f32 v117, v101, v101
    v_mfma_f32_16x16x32_bf16 v[84:87], v[208:211], v[244:247], v[84:87]
    v_rcp_f32 v126, v102
    v_mul_f32 v110, s40, v102
    s_waitcnt lgkmcnt(5)
    v_mfma_f32_16x16x32_bf16 v[16:19], v[160:163], v[168:171], v[16:19]
    ds_read_b128 v[204:207], v3 offset:37888
    v_mfma_f32_16x16x32_bf16 v[20:23], v[164:167], v[168:171], v[20:23]
    ds_read_b128 v[208:211], v3 offset:39936
    v_mfma_f32_16x16x32_bf16 v[24:27], v[160:163], v[172:175], v[24:27]
    ds_read_b128 v[212:215], v1 offset:46080
    v_mfma_f32_16x16x32_bf16 v[28:31], v[164:167], v[172:175], v[28:31]
    ds_read_b128 v[216:219], v1 offset:47104
    v_mfma_f32_16x16x32_bf16 v[32:35], v[160:163], v[176:179], v[32:35]
    ds_read_b128 v[220:223], v1 offset:48128
    v_mfma_f32_16x16x32_bf16 v[36:39], v[164:167], v[176:179], v[36:39]
    ds_read_b128 v[224:227], v1 offset:49152
    v_mfma_f32_16x16x32_bf16 v[40:43], v[160:163], v[180:183], v[40:43]
    ds_read_b128 v[228:231], v1 offset:50176
    v_mfma_f32_16x16x32_bf16 v[44:47], v[164:167], v[180:183], v[44:47]
    ds_read_b128 v[232:235], v1 offset:51200
    s_waitcnt lgkmcnt(8)
    v_mfma_f32_16x16x32_bf16 v[48:51], v[160:163], v[184:187], v[48:51]
    ds_read_b128 v[236:239], v1 offset:52224
    v_mfma_f32_16x16x32_bf16 v[52:55], v[164:167], v[184:187], v[52:55]
    ds_read_b128 v[240:243], v1 offset:53248
    v_mul_f32 v118, v102, v102
    v_mfma_f32_16x16x32_bf16 v[56:59], v[160:163], v[188:191], v[56:59]
    ds_read_b128 v[244:247], v1 offset:54272
    v_rcp_f32 v127, v103
    v_mfma_f32_16x16x32_bf16 v[60:63], v[164:167], v[188:191], v[60:63]
    v_mul_f32 v111, s40, v103
    v_mfma_f32_16x16x32_bf16 v[64:67], v[160:163], v[192:195], v[64:67]
    v_mul_f32 v119, v103, v103
    v_mfma_f32_16x16x32_bf16 v[68:71], v[164:167], v[192:195], v[68:71]
    v_mul_f32 v112, s42, v112
    v_mfma_f32_16x16x32_bf16 v[72:75], v[160:163], v[196:199], v[72:75]
    v_mul_f32 v113, s42, v113
    v_mfma_f32_16x16x32_bf16 v[76:79], v[164:167], v[196:199], v[76:79]
    v_mul_f32 v114, s42, v114
    v_mfma_f32_16x16x32_bf16 v[80:83], v[160:163], v[200:203], v[80:83]
    v_mul_f32 v115, s42, v115
    v_mfma_f32_16x16x32_bf16 v[84:87], v[164:167], v[200:203], v[84:87]
    v_mul_f32 v116, s42, v116
    v_mul_f32 v117, s42, v117
    s_waitcnt lgkmcnt(0)
    s_barrier
    v_mfma_f32_16x16x32_bf16 v[16:19], v[204:207], v[212:215], v[16:19]
    ds_read_b128 v[160:163], v0 offset:0
    v_mfma_f32_16x16x32_bf16 v[20:23], v[208:211], v[212:215], v[20:23]
    ds_read_b128 v[164:167], v0 offset:2048
    v_mfma_f32_16x16x32_bf16 v[24:27], v[204:207], v[216:219], v[24:27]
    ds_read_b128 v[168:171], v2 offset:0
    v_mfma_f32_16x16x32_bf16 v[28:31], v[208:211], v[216:219], v[28:31]
    ds_read_b128 v[172:175], v2 offset:1024
    v_mfma_f32_16x16x32_bf16 v[32:35], v[204:207], v[220:223], v[32:35]
    ds_read_b128 v[176:179], v2 offset:2048
    v_mfma_f32_16x16x32_bf16 v[36:39], v[208:211], v[220:223], v[36:39]
    ds_read_b128 v[180:183], v2 offset:3072
    v_mfma_f32_16x16x32_bf16 v[40:43], v[204:207], v[224:227], v[40:43]
    ds_read_b128 v[184:187], v2 offset:4096
    v_mfma_f32_16x16x32_bf16 v[44:47], v[208:211], v[224:227], v[44:47]
    ds_read_b128 v[188:191], v2 offset:5120
    v_mfma_f32_16x16x32_bf16 v[48:51], v[204:207], v[228:231], v[48:51]
    ds_read_b128 v[192:195], v2 offset:6144
    v_mfma_f32_16x16x32_bf16 v[52:55], v[208:211], v[228:231], v[52:55]
    ds_read_b128 v[196:199], v2 offset:7168
    v_mul_f32 v118, s42, v118
    v_mfma_f32_16x16x32_bf16 v[56:59], v[204:207], v[232:235], v[56:59]
    ds_read_b128 v[200:203], v2 offset:8192
    v_mul_f32 v119, s42, v119
    v_mfma_f32_16x16x32_bf16 v[60:63], v[208:211], v[232:235], v[60:63]
    v_mul_f32 v112, v112, v104
    v_mfma_f32_16x16x32_bf16 v[64:67], v[204:207], v[236:239], v[64:67]
    v_mul_f32 v113, v113, v105
    v_mfma_f32_16x16x32_bf16 v[68:71], v[208:211], v[236:239], v[68:71]
    v_mul_f32 v114, v114, v106
    v_mfma_f32_16x16x32_bf16 v[72:75], v[204:207], v[240:243], v[72:75]
    v_mul_f32 v115, v115, v107
    v_mfma_f32_16x16x32_bf16 v[76:79], v[208:211], v[240:243], v[76:79]
    v_mul_f32 v116, v116, v108
    v_mfma_f32_16x16x32_bf16 v[80:83], v[204:207], v[244:247], v[80:83]
    v_mul_f32 v117, v117, v109
    v_mfma_f32_16x16x32_bf16 v[84:87], v[208:211], v[244:247], v[84:87]
    v_mul_f32 v118, v118, v110
    v_mul_f32 v119, v119, v111
    s_waitcnt lgkmcnt(5)
    v_mfma_f32_16x16x32_bf16 v[16:19], v[160:163], v[168:171], v[16:19]
    ds_read_b128 v[204:207], v0 offset:1024
    v_mfma_f32_16x16x32_bf16 v[20:23], v[164:167], v[168:171], v[20:23]
    ds_read_b128 v[208:211], v0 offset:3072
    v_mfma_f32_16x16x32_bf16 v[24:27], v[160:163], v[172:175], v[24:27]
    ds_read_b128 v[212:215], v2 offset:9216
    v_mfma_f32_16x16x32_bf16 v[28:31], v[164:167], v[172:175], v[28:31]
    ds_read_b128 v[216:219], v2 offset:10240
    v_mfma_f32_16x16x32_bf16 v[32:35], v[160:163], v[176:179], v[32:35]
    ds_read_b128 v[220:223], v2 offset:11264
    v_mfma_f32_16x16x32_bf16 v[36:39], v[164:167], v[176:179], v[36:39]
    ds_read_b128 v[224:227], v2 offset:12288
    v_mfma_f32_16x16x32_bf16 v[40:43], v[160:163], v[180:183], v[40:43]
    ds_read_b128 v[228:231], v2 offset:13312
    v_mfma_f32_16x16x32_bf16 v[44:47], v[164:167], v[180:183], v[44:47]
    ds_read_b128 v[232:235], v2 offset:14336
    s_waitcnt lgkmcnt(8)
    v_mfma_f32_16x16x32_bf16 v[48:51], v[160:163], v[184:187], v[48:51]
    ds_read_b128 v[236:239], v2 offset:15360
    v_mfma_f32_16x16x32_bf16 v[52:55], v[164:167], v[184:187], v[52:55]
    ds_read_b128 v[240:243], v2 offset:16384
    v_lshrrev_b32 v8, 2, v6
    v_mfma_f32_16x16x32_bf16 v[56:59], v[160:163], v[188:191], v[56:59]
    ds_read_b128 v[244:247], v2 offset:17408
    v_lshlrev_b32 v8, 4, v8
    v_mfma_f32_16x16x32_bf16 v[60:63], v[164:167], v[188:191], v[60:63]
    v_lshl_add_u32 v8, v5, 6, v8
    v_mfma_f32_16x16x32_bf16 v[64:67], v[160:163], v[192:195], v[64:67]
    v_and_b32 v9, 3, v6
    v_mfma_f32_16x16x32_bf16 v[68:71], v[164:167], v[192:195], v[68:71]
    v_cmp_eq_u32 vcc, 0, v9
    v_mfma_f32_16x16x32_bf16 v[72:75], v[160:163], v[196:199], v[72:75]
    v_bfrev_b32 v10, 1
    v_mfma_f32_16x16x32_bf16 v[76:79], v[164:167], v[196:199], v[76:79]
    v_lshlrev_b32 v9, 4, v9
    v_mfma_f32_16x16x32_bf16 v[80:83], v[160:163], v[200:203], v[80:83]
    v_cndmask_b32 v8, v10, v8, vcc
    v_mfma_f32_16x16x32_bf16 v[84:87], v[164:167], v[200:203], v[84:87]
    v_lshl_add_u32 v9, v5, 6, v9
    v_lshrrev_b32 v255, 2, v6
    s_waitcnt lgkmcnt(0)
    s_barrier
    v_mfma_f32_16x16x32_bf16 v[16:19], v[204:207], v[212:215], v[16:19]
    ds_read_b128 v[160:163], v0 offset:36864
    v_fma_f32 v52, -v92, v132, v52
    v_mfma_f32_16x16x32_bf16 v[20:23], v[208:211], v[212:215], v[20:23]
    ds_read_b128 v[164:167], v0 offset:38912
    v_fma_f32 v56, -v88, v133, v56
    v_mfma_f32_16x16x32_bf16 v[24:27], v[204:207], v[216:219], v[24:27]
    ds_read_b128 v[168:171], v2 offset:36864
    v_fma_f32 v60, -v92, v133, v60
    v_mfma_f32_16x16x32_bf16 v[28:31], v[208:211], v[216:219], v[28:31]
    ds_read_b128 v[172:175], v2 offset:37888
    v_fma_f32 v64, -v88, v134, v64
    v_mfma_f32_16x16x32_bf16 v[32:35], v[204:207], v[220:223], v[32:35]
    ds_read_b128 v[176:179], v2 offset:38912
    v_fma_f32 v68, -v92, v134, v68
    v_mfma_f32_16x16x32_bf16 v[36:39], v[208:211], v[220:223], v[36:39]
    ds_read_b128 v[180:183], v2 offset:39936
    v_fma_f32 v72, -v88, v135, v72
    v_mfma_f32_16x16x32_bf16 v[40:43], v[204:207], v[224:227], v[40:43]
    ds_read_b128 v[184:187], v2 offset:40960
    v_fma_f32 v76, -v92, v135, v76
    v_mfma_f32_16x16x32_bf16 v[44:47], v[208:211], v[224:227], v[44:47]
    ds_read_b128 v[188:191], v2 offset:41984
    v_fma_f32 v80, -v88, v136, v80
    v_mfma_f32_16x16x32_bf16 v[48:51], v[204:207], v[228:231], v[48:51]
    ds_read_b128 v[192:195], v2 offset:43008
    v_fma_f32 v84, -v92, v136, v84
    v_mfma_f32_16x16x32_bf16 v[52:55], v[208:211], v[228:231], v[52:55]
    ds_read_b128 v[196:199], v2 offset:44032
    v_lshl_add_u32 v255, v255, 8, v9
    v_fma_f32 v16, -v88, v128, v16
    v_mfma_f32_16x16x32_bf16 v[56:59], v[204:207], v[232:235], v[56:59]
    ds_read_b128 v[200:203], v2 offset:45056
    v_fma_f32 v20, -v92, v128, v20
    v_mfma_f32_16x16x32_bf16 v[60:63], v[208:211], v[232:235], v[60:63]
    v_fma_f32 v24, -v88, v129, v24
    v_mfma_f32_16x16x32_bf16 v[64:67], v[204:207], v[236:239], v[64:67]
    v_fma_f32 v28, -v92, v129, v28
    v_mfma_f32_16x16x32_bf16 v[68:71], v[208:211], v[236:239], v[68:71]
    v_fma_f32 v32, -v88, v130, v32
    v_mfma_f32_16x16x32_bf16 v[72:75], v[204:207], v[240:243], v[72:75]
    v_fma_f32 v36, -v92, v130, v36
    v_mfma_f32_16x16x32_bf16 v[76:79], v[208:211], v[240:243], v[76:79]
    v_fma_f32 v40, -v88, v131, v40
    v_mfma_f32_16x16x32_bf16 v[80:83], v[204:207], v[244:247], v[80:83]
    v_fma_f32 v44, -v92, v131, v44
    v_mfma_f32_16x16x32_bf16 v[84:87], v[208:211], v[244:247], v[84:87]
    v_fma_f32 v48, -v88, v132, v48
    s_waitcnt lgkmcnt(5)
    v_mfma_f32_16x16x32_bf16 v[16:19], v[160:163], v[168:171], v[16:19]
    ds_read_b128 v[204:207], v0 offset:37888
    v_fma_f32 v53, -v93, v132, v53
    v_mfma_f32_16x16x32_bf16 v[20:23], v[164:167], v[168:171], v[20:23]
    ds_read_b128 v[208:211], v0 offset:39936
    v_fma_f32 v57, -v89, v133, v57
    v_mfma_f32_16x16x32_bf16 v[24:27], v[160:163], v[172:175], v[24:27]
    ds_read_b128 v[212:215], v2 offset:46080
    v_fma_f32 v61, -v93, v133, v61
    v_mfma_f32_16x16x32_bf16 v[28:31], v[164:167], v[172:175], v[28:31]
    ds_read_b128 v[216:219], v2 offset:47104
    v_fma_f32 v65, -v89, v134, v65
    v_mfma_f32_16x16x32_bf16 v[32:35], v[160:163], v[176:179], v[32:35]
    ds_read_b128 v[220:223], v2 offset:48128
    v_fma_f32 v69, -v93, v134, v69
    v_mfma_f32_16x16x32_bf16 v[36:39], v[164:167], v[176:179], v[36:39]
    ds_read_b128 v[224:227], v2 offset:49152
    v_fma_f32 v73, -v89, v135, v73
    v_mfma_f32_16x16x32_bf16 v[40:43], v[160:163], v[180:183], v[40:43]
    ds_read_b128 v[228:231], v2 offset:50176
    v_fma_f32 v77, -v93, v135, v77
    v_mfma_f32_16x16x32_bf16 v[44:47], v[164:167], v[180:183], v[44:47]
    ds_read_b128 v[232:235], v2 offset:51200
    s_waitcnt lgkmcnt(8)
    v_fma_f32 v81, -v89, v136, v81
    v_mfma_f32_16x16x32_bf16 v[48:51], v[160:163], v[184:187], v[48:51]
    ds_read_b128 v[236:239], v2 offset:52224
    v_fma_f32 v85, -v93, v136, v85
    v_mfma_f32_16x16x32_bf16 v[52:55], v[164:167], v[184:187], v[52:55]
    ds_read_b128 v[240:243], v2 offset:53248
    v_fma_f32 v17, -v89, v128, v17
    v_mfma_f32_16x16x32_bf16 v[56:59], v[160:163], v[188:191], v[56:59]
    ds_read_b128 v[244:247], v2 offset:54272
    v_fma_f32 v21, -v93, v128, v21
    v_mfma_f32_16x16x32_bf16 v[60:63], v[164:167], v[188:191], v[60:63]
    v_fma_f32 v25, -v89, v129, v25
    v_mfma_f32_16x16x32_bf16 v[64:67], v[160:163], v[192:195], v[64:67]
    v_fma_f32 v29, -v93, v129, v29
    v_mfma_f32_16x16x32_bf16 v[68:71], v[164:167], v[192:195], v[68:71]
    v_fma_f32 v33, -v89, v130, v33
    v_mfma_f32_16x16x32_bf16 v[72:75], v[160:163], v[196:199], v[72:75]
    v_fma_f32 v37, -v93, v130, v37
    v_mfma_f32_16x16x32_bf16 v[76:79], v[164:167], v[196:199], v[76:79]
    v_fma_f32 v41, -v89, v131, v41
    v_mfma_f32_16x16x32_bf16 v[80:83], v[160:163], v[200:203], v[80:83]
    v_fma_f32 v45, -v93, v131, v45
    v_mfma_f32_16x16x32_bf16 v[84:87], v[164:167], v[200:203], v[84:87]
    v_fma_f32 v49, -v89, v132, v49
    s_waitcnt lgkmcnt(0)
    s_barrier
    v_mfma_f32_16x16x32_bf16 v[16:19], v[204:207], v[212:215], v[16:19]
    ds_read_b128 v[160:163], v3 offset:0
    v_fma_f32 v54, -v94, v132, v54
    v_mfma_f32_16x16x32_bf16 v[20:23], v[208:211], v[212:215], v[20:23]
    ds_read_b128 v[164:167], v3 offset:2048
    v_fma_f32 v58, -v90, v133, v58
    v_mfma_f32_16x16x32_bf16 v[24:27], v[204:207], v[216:219], v[24:27]
    ds_read_b128 v[168:171], v1 offset:0
    v_fma_f32 v62, -v94, v133, v62
    v_mfma_f32_16x16x32_bf16 v[28:31], v[208:211], v[216:219], v[28:31]
    ds_read_b128 v[172:175], v1 offset:1024
    v_fma_f32 v66, -v90, v134, v66
    v_mfma_f32_16x16x32_bf16 v[32:35], v[204:207], v[220:223], v[32:35]
    ds_read_b128 v[176:179], v1 offset:2048
    v_fma_f32 v70, -v94, v134, v70
    v_mfma_f32_16x16x32_bf16 v[36:39], v[208:211], v[220:223], v[36:39]
    ds_read_b128 v[180:183], v1 offset:3072
    v_fma_f32 v74, -v90, v135, v74
    v_mfma_f32_16x16x32_bf16 v[40:43], v[204:207], v[224:227], v[40:43]
    ds_read_b128 v[184:187], v1 offset:4096
    v_fma_f32 v78, -v94, v135, v78
    v_mfma_f32_16x16x32_bf16 v[44:47], v[208:211], v[224:227], v[44:47]
    ds_read_b128 v[188:191], v1 offset:5120
    v_fma_f32 v82, -v90, v136, v82
    v_mfma_f32_16x16x32_bf16 v[48:51], v[204:207], v[228:231], v[48:51]
    ds_read_b128 v[192:195], v1 offset:6144
    v_fma_f32 v86, -v94, v136, v86
    v_mfma_f32_16x16x32_bf16 v[52:55], v[208:211], v[228:231], v[52:55]
    ds_read_b128 v[196:199], v1 offset:7168
    v_fma_f32 v18, -v90, v128, v18
    v_mfma_f32_16x16x32_bf16 v[56:59], v[204:207], v[232:235], v[56:59]
    ds_read_b128 v[200:203], v1 offset:8192
    v_fma_f32 v22, -v94, v128, v22
    v_mfma_f32_16x16x32_bf16 v[60:63], v[208:211], v[232:235], v[60:63]
    v_fma_f32 v26, -v90, v129, v26
    v_mfma_f32_16x16x32_bf16 v[64:67], v[204:207], v[236:239], v[64:67]
    v_fma_f32 v30, -v94, v129, v30
    v_mfma_f32_16x16x32_bf16 v[68:71], v[208:211], v[236:239], v[68:71]
    v_fma_f32 v34, -v90, v130, v34
    v_mfma_f32_16x16x32_bf16 v[72:75], v[204:207], v[240:243], v[72:75]
    v_fma_f32 v38, -v94, v130, v38
    v_mfma_f32_16x16x32_bf16 v[76:79], v[208:211], v[240:243], v[76:79]
    v_fma_f32 v42, -v90, v131, v42
    v_mfma_f32_16x16x32_bf16 v[80:83], v[204:207], v[244:247], v[80:83]
    v_fma_f32 v46, -v94, v131, v46
    v_mfma_f32_16x16x32_bf16 v[84:87], v[208:211], v[244:247], v[84:87]
    v_fma_f32 v50, -v90, v132, v50
    s_waitcnt lgkmcnt(5)
    v_mfma_f32_16x16x32_bf16 v[16:19], v[160:163], v[168:171], v[16:19]
    ds_read_b128 v[204:207], v3 offset:1024
    v_fma_f32 v55, -v95, v132, v55
    v_mfma_f32_16x16x32_bf16 v[20:23], v[164:167], v[168:171], v[20:23]
    ds_read_b128 v[208:211], v3 offset:3072
    v_fma_f32 v59, -v91, v133, v59
    v_mfma_f32_16x16x32_bf16 v[24:27], v[160:163], v[172:175], v[24:27]
    ds_read_b128 v[212:215], v1 offset:9216
    v_fma_f32 v63, -v95, v133, v63
    v_mfma_f32_16x16x32_bf16 v[28:31], v[164:167], v[172:175], v[28:31]
    ds_read_b128 v[216:219], v1 offset:10240
    v_fma_f32 v67, -v91, v134, v67
    v_mfma_f32_16x16x32_bf16 v[32:35], v[160:163], v[176:179], v[32:35]
    ds_read_b128 v[220:223], v1 offset:11264
    v_fma_f32 v71, -v95, v134, v71
    v_mfma_f32_16x16x32_bf16 v[36:39], v[164:167], v[176:179], v[36:39]
    ds_read_b128 v[224:227], v1 offset:12288
    v_fma_f32 v75, -v91, v135, v75
    v_mfma_f32_16x16x32_bf16 v[40:43], v[160:163], v[180:183], v[40:43]
    ds_read_b128 v[228:231], v1 offset:13312
    v_fma_f32 v79, -v95, v135, v79
    v_mfma_f32_16x16x32_bf16 v[44:47], v[164:167], v[180:183], v[44:47]
    ds_read_b128 v[232:235], v1 offset:14336
    s_waitcnt lgkmcnt(8)
    v_fma_f32 v83, -v91, v136, v83
    v_mfma_f32_16x16x32_bf16 v[48:51], v[160:163], v[184:187], v[48:51]
    ds_read_b128 v[236:239], v1 offset:15360
    v_fma_f32 v87, -v95, v136, v87
    v_mfma_f32_16x16x32_bf16 v[52:55], v[164:167], v[184:187], v[52:55]
    ds_read_b128 v[240:243], v1 offset:16384
    v_fma_f32 v19, -v91, v128, v19
    v_mfma_f32_16x16x32_bf16 v[56:59], v[160:163], v[188:191], v[56:59]
    ds_read_b128 v[244:247], v1 offset:17408
    v_fma_f32 v23, -v95, v128, v23
    v_mfma_f32_16x16x32_bf16 v[60:63], v[164:167], v[188:191], v[60:63]
    v_fma_f32 v27, -v91, v129, v27
    v_mfma_f32_16x16x32_bf16 v[64:67], v[160:163], v[192:195], v[64:67]
    v_fma_f32 v31, -v95, v129, v31
    v_mfma_f32_16x16x32_bf16 v[68:71], v[164:167], v[192:195], v[68:71]
    v_fma_f32 v35, -v91, v130, v35
    v_mfma_f32_16x16x32_bf16 v[72:75], v[160:163], v[196:199], v[72:75]
    v_fma_f32 v39, -v95, v130, v39
    v_mfma_f32_16x16x32_bf16 v[76:79], v[164:167], v[196:199], v[76:79]
    v_fma_f32 v43, -v91, v131, v43
    v_mfma_f32_16x16x32_bf16 v[80:83], v[160:163], v[200:203], v[80:83]
    v_fma_f32 v47, -v95, v131, v47
    v_mfma_f32_16x16x32_bf16 v[84:87], v[164:167], v[200:203], v[84:87]
    v_fma_f32 v51, -v91, v132, v51
    s_waitcnt lgkmcnt(0)
    s_barrier
    v_mfma_f32_16x16x32_bf16 v[16:19], v[204:207], v[212:215], v[16:19]
    ds_read_b128 v[160:163], v3 offset:36864
    v_mfma_f32_16x16x32_bf16 v[20:23], v[208:211], v[212:215], v[20:23]
    ds_read_b128 v[164:167], v3 offset:38912
    v_mfma_f32_16x16x32_bf16 v[24:27], v[204:207], v[216:219], v[24:27]
    ds_read_b128 v[168:171], v1 offset:36864
    v_mfma_f32_16x16x32_bf16 v[28:31], v[208:211], v[216:219], v[28:31]
    ds_read_b128 v[172:175], v1 offset:37888
    v_mfma_f32_16x16x32_bf16 v[32:35], v[204:207], v[220:223], v[32:35]
    ds_read_b128 v[176:179], v1 offset:38912
    v_mfma_f32_16x16x32_bf16 v[36:39], v[208:211], v[220:223], v[36:39]
    ds_read_b128 v[180:183], v1 offset:39936
    v_mfma_f32_16x16x32_bf16 v[40:43], v[204:207], v[224:227], v[40:43]
    ds_read_b128 v[184:187], v1 offset:40960
    v_mfma_f32_16x16x32_bf16 v[44:47], v[208:211], v[224:227], v[44:47]
    ds_read_b128 v[188:191], v1 offset:41984
    v_mfma_f32_16x16x32_bf16 v[48:51], v[204:207], v[228:231], v[48:51]
    ds_read_b128 v[192:195], v1 offset:43008
    v_mfma_f32_16x16x32_bf16 v[52:55], v[208:211], v[228:231], v[52:55]
    ds_read_b128 v[196:199], v1 offset:44032
    v_mfma_f32_16x16x32_bf16 v[56:59], v[204:207], v[232:235], v[56:59]
    ds_read_b128 v[200:203], v1 offset:45056
    v_mfma_f32_16x16x32_bf16 v[60:63], v[208:211], v[232:235], v[60:63]
    v_mfma_f32_16x16x32_bf16 v[64:67], v[204:207], v[236:239], v[64:67]
    v_mfma_f32_16x16x32_bf16 v[68:71], v[208:211], v[236:239], v[68:71]
    v_mfma_f32_16x16x32_bf16 v[72:75], v[204:207], v[240:243], v[72:75]
    v_mfma_f32_16x16x32_bf16 v[76:79], v[208:211], v[240:243], v[76:79]
    v_mfma_f32_16x16x32_bf16 v[80:83], v[204:207], v[244:247], v[80:83]
    v_mfma_f32_16x16x32_bf16 v[84:87], v[208:211], v[244:247], v[84:87]
    v_pk_mul_f32 v[220:221], v[16:17], v[16:17]
    v_pk_mul_f32 v[222:223], v[18:19], v[18:19]
    v_pk_mul_f32 v[224:225], v[20:21], v[20:21]
    v_pk_mul_f32 v[226:227], v[22:23], v[22:23]
    v_pk_fma_f32 v[220:221], v[220:221], v[112:113], v[104:105]
    v_pk_fma_f32 v[222:223], v[222:223], v[114:115], v[106:107]
    v_pk_fma_f32 v[224:225], v[224:225], v[116:117], v[108:109]
    v_pk_fma_f32 v[226:227], v[226:227], v[118:119], v[110:111]
    v_pk_mul_f32 v[220:221], v[220:221], v[16:17]
    v_pk_mul_f32 v[222:223], v[222:223], v[18:19]
    v_pk_mul_f32 v[224:225], v[224:225], v[20:21]
    v_pk_mul_f32 v[226:227], v[226:227], v[22:23]
    v_exp_f32 v220, v220
    v_exp_f32 v221, v221
    v_exp_f32 v222, v222
    v_exp_f32 v223, v223
    v_exp_f32 v224, v224
    v_exp_f32 v225, v225
    v_exp_f32 v226, v226
    v_exp_f32 v227, v227
    v_pk_fma_f32 v[220:221], v[220:221], v[120:121], v[120:121]
    v_pk_fma_f32 v[222:223], v[222:223], v[122:123], v[122:123]
    v_pk_fma_f32 v[224:225], v[224:225], v[124:125], v[124:125]
    v_pk_fma_f32 v[226:227], v[226:227], v[126:127], v[126:127]
    v_rcp_f32 v220, v220
    v_rcp_f32 v221, v221
    v_rcp_f32 v222, v222
    v_rcp_f32 v223, v223
    v_rcp_f32 v224, v224
    v_rcp_f32 v225, v225
    v_rcp_f32 v226, v226
    v_rcp_f32 v227, v227
    v_pk_mul_f32 v[16:17], v[16:17], v[220:221]
    v_pk_mul_f32 v[18:19], v[18:19], v[222:223]
    v_pk_mul_f32 v[20:21], v[20:21], v[224:225]
    v_pk_mul_f32 v[22:23], v[22:23], v[226:227]
    v_pk_mul_f32 v[206:207], v[16:17], v[16:17]
    v_pk_mul_f32 v[210:211], v[18:19], v[18:19]
    v_pk_mul_f32 v[214:215], v[20:21], v[20:21]
    v_pk_mul_f32 v[218:219], v[22:23], v[22:23]
    v_pk_mul_f32 v[228:229], v[24:25], v[24:25]
    v_pk_mul_f32 v[230:231], v[26:27], v[26:27]
    v_pk_mul_f32 v[232:233], v[28:29], v[28:29]
    v_pk_mul_f32 v[234:235], v[30:31], v[30:31]
    v_pk_fma_f32 v[228:229], v[228:229], v[112:113], v[104:105]
    v_pk_fma_f32 v[230:231], v[230:231], v[114:115], v[106:107]
    v_pk_fma_f32 v[232:233], v[232:233], v[116:117], v[108:109]
    v_pk_fma_f32 v[234:235], v[234:235], v[118:119], v[110:111]
    v_pk_mul_f32 v[228:229], v[228:229], v[24:25]
    v_pk_mul_f32 v[230:231], v[230:231], v[26:27]
    v_pk_mul_f32 v[232:233], v[232:233], v[28:29]
    v_pk_mul_f32 v[234:235], v[234:235], v[30:31]
    v_exp_f32 v228, v228
    v_exp_f32 v229, v229
    v_exp_f32 v230, v230
    v_exp_f32 v231, v231
    v_exp_f32 v232, v232
    v_exp_f32 v233, v233
    v_exp_f32 v234, v234
    v_exp_f32 v235, v235
    v_pk_fma_f32 v[228:229], v[228:229], v[120:121], v[120:121]
    v_pk_fma_f32 v[230:231], v[230:231], v[122:123], v[122:123]
    v_pk_fma_f32 v[232:233], v[232:233], v[124:125], v[124:125]
    v_pk_fma_f32 v[234:235], v[234:235], v[126:127], v[126:127]
    v_rcp_f32 v228, v228
    v_rcp_f32 v229, v229
    v_rcp_f32 v230, v230
    v_rcp_f32 v231, v231
    v_rcp_f32 v232, v232
    v_rcp_f32 v233, v233
    v_rcp_f32 v234, v234
    v_rcp_f32 v235, v235
    v_pk_mul_f32 v[24:25], v[24:25], v[228:229]
    v_pk_mul_f32 v[26:27], v[26:27], v[230:231]
    v_pk_mul_f32 v[28:29], v[28:29], v[232:233]
    v_pk_mul_f32 v[30:31], v[30:31], v[234:235]
    v_pk_add_f32 v[204:205], v[16:17], v[24:25]
    v_pk_fma_f32 v[206:207], v[24:25], v[24:25], v[206:207]
    v_pk_add_f32 v[208:209], v[18:19], v[26:27]
    v_pk_fma_f32 v[210:211], v[26:27], v[26:27], v[210:211]
    v_pk_add_f32 v[212:213], v[20:21], v[28:29]
    v_pk_fma_f32 v[214:215], v[28:29], v[28:29], v[214:215]
    v_pk_add_f32 v[216:217], v[22:23], v[30:31]
    v_pk_fma_f32 v[218:219], v[30:31], v[30:31], v[218:219]
    v_pk_mul_f32 v[220:221], v[32:33], v[32:33]
    v_pk_mul_f32 v[222:223], v[34:35], v[34:35]
    v_pk_mul_f32 v[224:225], v[36:37], v[36:37]
    v_pk_mul_f32 v[226:227], v[38:39], v[38:39]
    v_pk_fma_f32 v[220:221], v[220:221], v[112:113], v[104:105]
    v_pk_fma_f32 v[222:223], v[222:223], v[114:115], v[106:107]
    v_pk_fma_f32 v[224:225], v[224:225], v[116:117], v[108:109]
    v_pk_fma_f32 v[226:227], v[226:227], v[118:119], v[110:111]
    v_pk_mul_f32 v[220:221], v[220:221], v[32:33]
    v_pk_mul_f32 v[222:223], v[222:223], v[34:35]
    v_pk_mul_f32 v[224:225], v[224:225], v[36:37]
    v_pk_mul_f32 v[226:227], v[226:227], v[38:39]
    v_exp_f32 v220, v220
    v_exp_f32 v221, v221
    v_exp_f32 v222, v222
    v_exp_f32 v223, v223
    v_exp_f32 v224, v224
    v_exp_f32 v225, v225
    v_exp_f32 v226, v226
    v_exp_f32 v227, v227
    v_pk_fma_f32 v[220:221], v[220:221], v[120:121], v[120:121]
    v_pk_fma_f32 v[222:223], v[222:223], v[122:123], v[122:123]
    v_pk_fma_f32 v[224:225], v[224:225], v[124:125], v[124:125]
    v_pk_fma_f32 v[226:227], v[226:227], v[126:127], v[126:127]
    v_rcp_f32 v220, v220
    v_rcp_f32 v221, v221
    v_rcp_f32 v222, v222
    v_rcp_f32 v223, v223
    v_rcp_f32 v224, v224
    v_rcp_f32 v225, v225
    v_rcp_f32 v226, v226
    v_rcp_f32 v227, v227
    v_pk_mul_f32 v[32:33], v[32:33], v[220:221]
    v_pk_mul_f32 v[34:35], v[34:35], v[222:223]
    v_pk_mul_f32 v[36:37], v[36:37], v[224:225]
    v_pk_mul_f32 v[38:39], v[38:39], v[226:227]
    v_pk_add_f32 v[204:205], v[204:205], v[32:33]
    v_pk_fma_f32 v[206:207], v[32:33], v[32:33], v[206:207]
    v_pk_add_f32 v[208:209], v[208:209], v[34:35]
    v_pk_fma_f32 v[210:211], v[34:35], v[34:35], v[210:211]
    v_pk_add_f32 v[212:213], v[212:213], v[36:37]
    v_pk_fma_f32 v[214:215], v[36:37], v[36:37], v[214:215]
    v_pk_add_f32 v[216:217], v[216:217], v[38:39]
    v_pk_fma_f32 v[218:219], v[38:39], v[38:39], v[218:219]
    v_pk_mul_f32 v[228:229], v[40:41], v[40:41]
    v_pk_mul_f32 v[230:231], v[42:43], v[42:43]
    v_pk_mul_f32 v[232:233], v[44:45], v[44:45]
    v_pk_mul_f32 v[234:235], v[46:47], v[46:47]
    v_pk_fma_f32 v[228:229], v[228:229], v[112:113], v[104:105]
    v_pk_fma_f32 v[230:231], v[230:231], v[114:115], v[106:107]
    v_pk_fma_f32 v[232:233], v[232:233], v[116:117], v[108:109]
    v_pk_fma_f32 v[234:235], v[234:235], v[118:119], v[110:111]
    v_pk_mul_f32 v[228:229], v[228:229], v[40:41]
    v_pk_mul_f32 v[230:231], v[230:231], v[42:43]
    v_pk_mul_f32 v[232:233], v[232:233], v[44:45]
    v_pk_mul_f32 v[234:235], v[234:235], v[46:47]
    v_exp_f32 v228, v228
    v_exp_f32 v229, v229
    v_exp_f32 v230, v230
    v_exp_f32 v231, v231
    v_exp_f32 v232, v232
    v_exp_f32 v233, v233
    v_exp_f32 v234, v234
    v_exp_f32 v235, v235
    v_pk_fma_f32 v[228:229], v[228:229], v[120:121], v[120:121]
    v_pk_fma_f32 v[230:231], v[230:231], v[122:123], v[122:123]
    v_pk_fma_f32 v[232:233], v[232:233], v[124:125], v[124:125]
    v_pk_fma_f32 v[234:235], v[234:235], v[126:127], v[126:127]
    v_rcp_f32 v228, v228
    v_rcp_f32 v229, v229
    v_rcp_f32 v230, v230
    v_rcp_f32 v231, v231
    v_rcp_f32 v232, v232
    v_rcp_f32 v233, v233
    v_rcp_f32 v234, v234
    v_rcp_f32 v235, v235
    v_pk_mul_f32 v[40:41], v[40:41], v[228:229]
    v_pk_mul_f32 v[42:43], v[42:43], v[230:231]
    v_pk_mul_f32 v[44:45], v[44:45], v[232:233]
    v_pk_mul_f32 v[46:47], v[46:47], v[234:235]
    v_pk_add_f32 v[204:205], v[204:205], v[40:41]
    v_pk_fma_f32 v[206:207], v[40:41], v[40:41], v[206:207]
    v_pk_add_f32 v[208:209], v[208:209], v[42:43]
    v_pk_fma_f32 v[210:211], v[42:43], v[42:43], v[210:211]
    v_pk_add_f32 v[212:213], v[212:213], v[44:45]
    v_pk_fma_f32 v[214:215], v[44:45], v[44:45], v[214:215]
    v_pk_add_f32 v[216:217], v[216:217], v[46:47]
    v_pk_fma_f32 v[218:219], v[46:47], v[46:47], v[218:219]
    v_pk_mul_f32 v[220:221], v[48:49], v[48:49]
    v_pk_mul_f32 v[222:223], v[50:51], v[50:51]
    v_pk_mul_f32 v[224:225], v[52:53], v[52:53]
    v_pk_mul_f32 v[226:227], v[54:55], v[54:55]
    v_pk_fma_f32 v[220:221], v[220:221], v[112:113], v[104:105]
    v_pk_fma_f32 v[222:223], v[222:223], v[114:115], v[106:107]
    v_pk_fma_f32 v[224:225], v[224:225], v[116:117], v[108:109]
    v_pk_fma_f32 v[226:227], v[226:227], v[118:119], v[110:111]
    v_pk_mul_f32 v[220:221], v[220:221], v[48:49]
    v_pk_mul_f32 v[222:223], v[222:223], v[50:51]
    v_pk_mul_f32 v[224:225], v[224:225], v[52:53]
    v_pk_mul_f32 v[226:227], v[226:227], v[54:55]
    v_exp_f32 v220, v220
    v_exp_f32 v221, v221
    v_exp_f32 v222, v222
    v_exp_f32 v223, v223
    v_exp_f32 v224, v224
    v_exp_f32 v225, v225
    v_exp_f32 v226, v226
    v_exp_f32 v227, v227
    v_pk_fma_f32 v[220:221], v[220:221], v[120:121], v[120:121]
    v_pk_fma_f32 v[222:223], v[222:223], v[122:123], v[122:123]
    v_pk_fma_f32 v[224:225], v[224:225], v[124:125], v[124:125]
    v_pk_fma_f32 v[226:227], v[226:227], v[126:127], v[126:127]
    v_rcp_f32 v220, v220
    v_rcp_f32 v221, v221
    v_rcp_f32 v222, v222
    v_rcp_f32 v223, v223
    v_rcp_f32 v224, v224
    v_rcp_f32 v225, v225
    v_rcp_f32 v226, v226
    v_rcp_f32 v227, v227
    v_pk_mul_f32 v[48:49], v[48:49], v[220:221]
    v_pk_mul_f32 v[50:51], v[50:51], v[222:223]
    v_pk_mul_f32 v[52:53], v[52:53], v[224:225]
    v_pk_mul_f32 v[54:55], v[54:55], v[226:227]
    v_pk_add_f32 v[204:205], v[204:205], v[48:49]
    v_pk_fma_f32 v[206:207], v[48:49], v[48:49], v[206:207]
    v_pk_add_f32 v[208:209], v[208:209], v[50:51]
    v_pk_fma_f32 v[210:211], v[50:51], v[50:51], v[210:211]
    v_pk_add_f32 v[212:213], v[212:213], v[52:53]
    v_pk_fma_f32 v[214:215], v[52:53], v[52:53], v[214:215]
    v_pk_add_f32 v[216:217], v[216:217], v[54:55]
    v_pk_fma_f32 v[218:219], v[54:55], v[54:55], v[218:219]
    v_pk_mul_f32 v[228:229], v[56:57], v[56:57]
    v_pk_mul_f32 v[230:231], v[58:59], v[58:59]
    v_pk_mul_f32 v[232:233], v[60:61], v[60:61]
    v_pk_mul_f32 v[234:235], v[62:63], v[62:63]
    v_pk_fma_f32 v[228:229], v[228:229], v[112:113], v[104:105]
    v_pk_fma_f32 v[230:231], v[230:231], v[114:115], v[106:107]
    v_pk_fma_f32 v[232:233], v[232:233], v[116:117], v[108:109]
    v_pk_fma_f32 v[234:235], v[234:235], v[118:119], v[110:111]
    v_pk_mul_f32 v[228:229], v[228:229], v[56:57]
    v_pk_mul_f32 v[230:231], v[230:231], v[58:59]
    v_pk_mul_f32 v[232:233], v[232:233], v[60:61]
    v_pk_mul_f32 v[234:235], v[234:235], v[62:63]
    v_exp_f32 v228, v228
    v_exp_f32 v229, v229
    v_exp_f32 v230, v230
    v_exp_f32 v231, v231
    v_exp_f32 v232, v232
    v_exp_f32 v233, v233
    v_exp_f32 v234, v234
    v_exp_f32 v235, v235
    v_pk_fma_f32 v[228:229], v[228:229], v[120:121], v[120:121]
    v_pk_fma_f32 v[230:231], v[230:231], v[122:123], v[122:123]
    v_pk_fma_f32 v[232:233], v[232:233], v[124:125], v[124:125]
    v_pk_fma_f32 v[234:235], v[234:235], v[126:127], v[126:127]
    v_rcp_f32 v228, v228
    v_rcp_f32 v229, v229
    v_rcp_f32 v230, v230
    v_rcp_f32 v231, v231
    v_rcp_f32 v232, v232
    v_rcp_f32 v233, v233
    v_rcp_f32 v234, v234
    v_rcp_f32 v235, v235
    v_pk_mul_f32 v[56:57], v[56:57], v[228:229]
    v_pk_mul_f32 v[58:59], v[58:59], v[230:231]
    v_pk_mul_f32 v[60:61], v[60:61], v[232:233]
    v_pk_mul_f32 v[62:63], v[62:63], v[234:235]
    v_pk_add_f32 v[204:205], v[204:205], v[56:57]
    v_pk_fma_f32 v[206:207], v[56:57], v[56:57], v[206:207]
    v_pk_add_f32 v[208:209], v[208:209], v[58:59]
    v_pk_fma_f32 v[210:211], v[58:59], v[58:59], v[210:211]
    v_pk_add_f32 v[212:213], v[212:213], v[60:61]
    v_pk_fma_f32 v[214:215], v[60:61], v[60:61], v[214:215]
    v_pk_add_f32 v[216:217], v[216:217], v[62:63]
    v_pk_fma_f32 v[218:219], v[62:63], v[62:63], v[218:219]
    v_pk_mul_f32 v[220:221], v[64:65], v[64:65]
    v_pk_mul_f32 v[222:223], v[66:67], v[66:67]
    v_pk_mul_f32 v[224:225], v[68:69], v[68:69]
    v_pk_mul_f32 v[226:227], v[70:71], v[70:71]
    v_pk_fma_f32 v[220:221], v[220:221], v[112:113], v[104:105]
    v_pk_fma_f32 v[222:223], v[222:223], v[114:115], v[106:107]
    v_pk_fma_f32 v[224:225], v[224:225], v[116:117], v[108:109]
    v_pk_fma_f32 v[226:227], v[226:227], v[118:119], v[110:111]
    v_pk_mul_f32 v[220:221], v[220:221], v[64:65]
    v_pk_mul_f32 v[222:223], v[222:223], v[66:67]
    v_pk_mul_f32 v[224:225], v[224:225], v[68:69]
    v_pk_mul_f32 v[226:227], v[226:227], v[70:71]
    v_exp_f32 v220, v220
    v_exp_f32 v221, v221
    v_exp_f32 v222, v222
    v_exp_f32 v223, v223
    v_exp_f32 v224, v224
    v_exp_f32 v225, v225
    v_exp_f32 v226, v226
    v_exp_f32 v227, v227
    v_pk_fma_f32 v[220:221], v[220:221], v[120:121], v[120:121]
    v_pk_fma_f32 v[222:223], v[222:223], v[122:123], v[122:123]
    v_pk_fma_f32 v[224:225], v[224:225], v[124:125], v[124:125]
    v_pk_fma_f32 v[226:227], v[226:227], v[126:127], v[126:127]
    v_rcp_f32 v220, v220
    v_rcp_f32 v221, v221
    v_rcp_f32 v222, v222
    v_rcp_f32 v223, v223
    v_rcp_f32 v224, v224
    v_rcp_f32 v225, v225
    v_rcp_f32 v226, v226
    v_rcp_f32 v227, v227
    v_pk_mul_f32 v[64:65], v[64:65], v[220:221]
    v_pk_mul_f32 v[66:67], v[66:67], v[222:223]
    v_pk_mul_f32 v[68:69], v[68:69], v[224:225]
    v_pk_mul_f32 v[70:71], v[70:71], v[226:227]
    v_pk_add_f32 v[204:205], v[204:205], v[64:65]
    v_pk_fma_f32 v[206:207], v[64:65], v[64:65], v[206:207]
    v_pk_add_f32 v[208:209], v[208:209], v[66:67]
    v_pk_fma_f32 v[210:211], v[66:67], v[66:67], v[210:211]
    v_pk_add_f32 v[212:213], v[212:213], v[68:69]
    v_pk_fma_f32 v[214:215], v[68:69], v[68:69], v[214:215]
    v_pk_add_f32 v[216:217], v[216:217], v[70:71]
    v_pk_fma_f32 v[218:219], v[70:71], v[70:71], v[218:219]
    v_pk_mul_f32 v[228:229], v[72:73], v[72:73]
    v_pk_mul_f32 v[230:231], v[74:75], v[74:75]
    v_pk_mul_f32 v[232:233], v[76:77], v[76:77]
    v_pk_mul_f32 v[234:235], v[78:79], v[78:79]
    v_pk_fma_f32 v[228:229], v[228:229], v[112:113], v[104:105]
    v_pk_fma_f32 v[230:231], v[230:231], v[114:115], v[106:107]
    v_pk_fma_f32 v[232:233], v[232:233], v[116:117], v[108:109]
    v_pk_fma_f32 v[234:235], v[234:235], v[118:119], v[110:111]
    v_pk_mul_f32 v[228:229], v[228:229], v[72:73]
    v_pk_mul_f32 v[230:231], v[230:231], v[74:75]
    v_pk_mul_f32 v[232:233], v[232:233], v[76:77]
    v_pk_mul_f32 v[234:235], v[234:235], v[78:79]
    v_exp_f32 v228, v228
    v_exp_f32 v229, v229
    v_exp_f32 v230, v230
    v_exp_f32 v231, v231
    v_exp_f32 v232, v232
    v_exp_f32 v233, v233
    v_exp_f32 v234, v234
    v_exp_f32 v235, v235
    v_pk_fma_f32 v[228:229], v[228:229], v[120:121], v[120:121]
    v_pk_fma_f32 v[230:231], v[230:231], v[122:123], v[122:123]
    v_pk_fma_f32 v[232:233], v[232:233], v[124:125], v[124:125]
    v_pk_fma_f32 v[234:235], v[234:235], v[126:127], v[126:127]
    v_rcp_f32 v228, v228
    v_rcp_f32 v229, v229
    v_rcp_f32 v230, v230
    v_rcp_f32 v231, v231
    v_rcp_f32 v232, v232
    v_rcp_f32 v233, v233
    v_rcp_f32 v234, v234
    v_rcp_f32 v235, v235
    v_pk_mul_f32 v[72:73], v[72:73], v[228:229]
    v_pk_mul_f32 v[74:75], v[74:75], v[230:231]
    v_pk_mul_f32 v[76:77], v[76:77], v[232:233]
    v_pk_mul_f32 v[78:79], v[78:79], v[234:235]
    v_pk_add_f32 v[204:205], v[204:205], v[72:73]
    v_pk_fma_f32 v[206:207], v[72:73], v[72:73], v[206:207]
    v_pk_add_f32 v[208:209], v[208:209], v[74:75]
    v_pk_fma_f32 v[210:211], v[74:75], v[74:75], v[210:211]
    v_pk_add_f32 v[212:213], v[212:213], v[76:77]
    v_pk_fma_f32 v[214:215], v[76:77], v[76:77], v[214:215]
    v_pk_add_f32 v[216:217], v[216:217], v[78:79]
    v_pk_fma_f32 v[218:219], v[78:79], v[78:79], v[218:219]
    v_pk_mul_f32 v[220:221], v[80:81], v[80:81]
    v_pk_mul_f32 v[222:223], v[82:83], v[82:83]
    v_pk_mul_f32 v[224:225], v[84:85], v[84:85]
    v_pk_mul_f32 v[226:227], v[86:87], v[86:87]
    v_pk_fma_f32 v[220:221], v[220:221], v[112:113], v[104:105]
    v_pk_fma_f32 v[222:223], v[222:223], v[114:115], v[106:107]
    v_pk_fma_f32 v[224:225], v[224:225], v[116:117], v[108:109]
    v_pk_fma_f32 v[226:227], v[226:227], v[118:119], v[110:111]
    v_pk_mul_f32 v[220:221], v[220:221], v[80:81]
    v_pk_mul_f32 v[222:223], v[222:223], v[82:83]
    v_pk_mul_f32 v[224:225], v[224:225], v[84:85]
    v_pk_mul_f32 v[226:227], v[226:227], v[86:87]
    v_exp_f32 v220, v220
    v_exp_f32 v221, v221
    v_exp_f32 v222, v222
    v_exp_f32 v223, v223
    v_exp_f32 v224, v224
    v_exp_f32 v225, v225
    v_exp_f32 v226, v226
    v_exp_f32 v227, v227
    v_pk_fma_f32 v[220:221], v[220:221], v[120:121], v[120:121]
    v_pk_fma_f32 v[222:223], v[222:223], v[122:123], v[122:123]
    v_pk_fma_f32 v[224:225], v[224:225], v[124:125], v[124:125]
    v_pk_fma_f32 v[226:227], v[226:227], v[126:127], v[126:127]
    v_rcp_f32 v220, v220
    v_rcp_f32 v221, v221
    v_rcp_f32 v222, v222
    v_rcp_f32 v223, v223
    v_rcp_f32 v224, v224
    v_rcp_f32 v225, v225
    v_rcp_f32 v226, v226
    v_rcp_f32 v227, v227
    v_pk_mul_f32 v[80:81], v[80:81], v[220:221]
    v_pk_mul_f32 v[82:83], v[82:83], v[222:223]
    v_pk_mul_f32 v[84:85], v[84:85], v[224:225]
    v_pk_mul_f32 v[86:87], v[86:87], v[226:227]
    v_pk_add_f32 v[204:205], v[204:205], v[80:81]
    v_pk_fma_f32 v[206:207], v[80:81], v[80:81], v[206:207]
    v_pk_add_f32 v[208:209], v[208:209], v[82:83]
    v_pk_fma_f32 v[210:211], v[82:83], v[82:83], v[210:211]
    v_pk_add_f32 v[212:213], v[212:213], v[84:85]
    v_pk_fma_f32 v[214:215], v[84:85], v[84:85], v[214:215]
    v_pk_add_f32 v[216:217], v[216:217], v[86:87]
    v_pk_fma_f32 v[218:219], v[86:87], v[86:87], v[218:219]
    v_add_f32_dpp v204, v204, v204 row_mirror row_mask:0xf bank_mask:0x3
    v_add_f32_dpp v205, v205, v205 row_mirror row_mask:0xf bank_mask:0x3
    v_add_f32_dpp v206, v206, v206 row_mirror row_mask:0xf bank_mask:0x3
    v_add_f32_dpp v207, v207, v207 row_mirror row_mask:0xf bank_mask:0x3
    v_add_f32_dpp v208, v208, v208 row_mirror row_mask:0xf bank_mask:0x3
    v_add_f32_dpp v209, v209, v209 row_mirror row_mask:0xf bank_mask:0x3
    v_add_f32_dpp v210, v210, v210 row_mirror row_mask:0xf bank_mask:0x3
    v_add_f32_dpp v211, v211, v211 row_mirror row_mask:0xf bank_mask:0x3
    v_add_f32_dpp v204, v212, v212 row_mirror row_mask:0xf bank_mask:0xc
    v_add_f32_dpp v205, v213, v213 row_mirror row_mask:0xf bank_mask:0xc
    v_add_f32_dpp v206, v214, v214 row_mirror row_mask:0xf bank_mask:0xc
    v_add_f32_dpp v207, v215, v215 row_mirror row_mask:0xf bank_mask:0xc
    v_add_f32_dpp v208, v216, v216 row_mirror row_mask:0xf bank_mask:0xc
    v_add_f32_dpp v209, v217, v217 row_mirror row_mask:0xf bank_mask:0xc
    v_add_f32_dpp v210, v218, v218 row_mirror row_mask:0xf bank_mask:0xc
    v_add_f32_dpp v211, v219, v219 row_mirror row_mask:0xf bank_mask:0xc
    v_add_f32_dpp v204, v204, v204 row_half_mirror row_mask:0xf bank_mask:0x5
    v_add_f32_dpp v205, v205, v205 row_half_mirror row_mask:0xf bank_mask:0x5
    v_add_f32_dpp v206, v206, v206 row_half_mirror row_mask:0xf bank_mask:0x5
    v_add_f32_dpp v207, v207, v207 row_half_mirror row_mask:0xf bank_mask:0x5
    v_add_f32_dpp v204, v208, v208 row_half_mirror row_mask:0xf bank_mask:0xa
    v_add_f32_dpp v205, v209, v209 row_half_mirror row_mask:0xf bank_mask:0xa
    v_add_f32_dpp v206, v210, v210 row_half_mirror row_mask:0xf bank_mask:0xa
    v_add_f32_dpp v207, v211, v211 row_half_mirror row_mask:0xf bank_mask:0xa
    v_add_f32_dpp v204, v204, v204 quad_perm:[1,0,3,2] row_mask:0xf bank_mask:0xf
    v_add_f32_dpp v205, v205, v205 quad_perm:[1,0,3,2] row_mask:0xf bank_mask:0xf
    v_add_f32_dpp v206, v206, v206 quad_perm:[1,0,3,2] row_mask:0xf bank_mask:0xf
    v_add_f32_dpp v207, v207, v207 quad_perm:[1,0,3,2] row_mask:0xf bank_mask:0xf
    v_add_f32_dpp v12, v204, v204 quad_perm:[2,3,0,1] row_mask:0xf bank_mask:0xf
    v_add_f32_dpp v14, v205, v205 quad_perm:[2,3,0,1] row_mask:0xf bank_mask:0xf
    v_add_f32_dpp v13, v206, v206 quad_perm:[2,3,0,1] row_mask:0xf bank_mask:0xf
    v_add_f32_dpp v15, v207, v207 quad_perm:[2,3,0,1] row_mask:0xf bank_mask:0xf
    buffer_store_dwordx4 v[12:15], v8, s[4:7], s36 offen sc1
    s_waitcnt lgkmcnt(5)
    v_mfma_f32_16x16x32_bf16 v[88:91], v[168:171], v[160:163], 0
    ds_read_b128 v[204:207], v3 offset:37888
    v_mfma_f32_16x16x32_bf16 v[92:95], v[168:171], v[164:167], 0
    ds_read_b128 v[208:211], v3 offset:39936
    v_mfma_f32_16x16x32_bf16 v[96:99], v[172:175], v[160:163], 0
    ds_read_b128 v[212:215], v1 offset:46080
    v_mfma_f32_16x16x32_bf16 v[100:103], v[172:175], v[164:167], 0
    ds_read_b128 v[216:219], v1 offset:47104
    v_mfma_f32_16x16x32_bf16 v[104:107], v[176:179], v[160:163], 0
    ds_read_b128 v[220:223], v1 offset:48128
    v_mfma_f32_16x16x32_bf16 v[108:111], v[176:179], v[164:167], 0
    ds_read_b128 v[224:227], v1 offset:49152
    v_mfma_f32_16x16x32_bf16 v[112:115], v[180:183], v[160:163], 0
    ds_read_b128 v[228:231], v1 offset:50176
    v_mfma_f32_16x16x32_bf16 v[116:119], v[180:183], v[164:167], 0
    ds_read_b128 v[232:235], v1 offset:51200
    s_waitcnt lgkmcnt(8)
    v_mfma_f32_16x16x32_bf16 v[120:123], v[184:187], v[160:163], 0
    ds_read_b128 v[236:239], v1 offset:52224
    v_mfma_f32_16x16x32_bf16 v[124:127], v[184:187], v[164:167], 0
    ds_read_b128 v[240:243], v1 offset:53248
    v_mfma_f32_16x16x32_bf16 v[128:131], v[188:191], v[160:163], 0
    ds_read_b128 v[244:247], v1 offset:54272
    v_mfma_f32_16x16x32_bf16 v[132:135], v[188:191], v[164:167], 0
    v_mfma_f32_16x16x32_bf16 v[136:139], v[192:195], v[160:163], 0
    v_lshrrev_b32 v255, 8, v1
    v_mfma_f32_16x16x32_bf16 v[140:143], v[192:195], v[164:167], 0
    v_lshl_add_u32 v255, v255, 6, s33
    v_mfma_f32_16x16x32_bf16 v[144:147], v[196:199], v[160:163], 0
    v_mfma_f32_16x16x32_bf16 v[148:151], v[196:199], v[164:167], 0
    v_mfma_f32_16x16x32_bf16 v[152:155], v[200:203], v[160:163], 0
    v_mfma_f32_16x16x32_bf16 v[156:159], v[200:203], v[164:167], 0
    s_waitcnt lgkmcnt(0)
    s_barrier
    v_mfma_f32_16x16x32_bf16 v[88:91], v[212:215], v[204:207], v[88:91]
    ds_read_b128 v[160:163], v0 offset:0
    v_mfma_f32_16x16x32_bf16 v[92:95], v[212:215], v[208:211], v[92:95]
    ds_read_b128 v[164:167], v0 offset:2048
    v_mfma_f32_16x16x32_bf16 v[96:99], v[216:219], v[204:207], v[96:99]
    ds_read_b128 v[168:171], v2 offset:0
    v_mfma_f32_16x16x32_bf16 v[100:103], v[216:219], v[208:211], v[100:103]
    ds_read_b128 v[172:175], v2 offset:1024
    v_mfma_f32_16x16x32_bf16 v[104:107], v[220:223], v[204:207], v[104:107]
    ds_read_b128 v[176:179], v2 offset:2048
    v_mfma_f32_16x16x32_bf16 v[108:111], v[220:223], v[208:211], v[108:111]
    ds_read_b128 v[180:183], v2 offset:3072
    v_mfma_f32_16x16x32_bf16 v[112:115], v[224:227], v[204:207], v[112:115]
    ds_read_b128 v[184:187], v2 offset:4096
    v_mfma_f32_16x16x32_bf16 v[116:119], v[224:227], v[208:211], v[116:119]
    ds_read_b128 v[188:191], v2 offset:5120
    v_mfma_f32_16x16x32_bf16 v[120:123], v[228:231], v[204:207], v[120:123]
    ds_read_b128 v[192:195], v2 offset:6144
    v_mfma_f32_16x16x32_bf16 v[124:127], v[228:231], v[208:211], v[124:127]
    ds_read_b128 v[196:199], v2 offset:7168
    v_mfma_f32_16x16x32_bf16 v[128:131], v[232:235], v[204:207], v[128:131]
    ds_read_b128 v[200:203], v2 offset:8192
    v_mfma_f32_16x16x32_bf16 v[132:135], v[232:235], v[208:211], v[132:135]
    v_mfma_f32_16x16x32_bf16 v[136:139], v[236:239], v[204:207], v[136:139]
    v_mfma_f32_16x16x32_bf16 v[140:143], v[236:239], v[208:211], v[140:143]
    v_mfma_f32_16x16x32_bf16 v[144:147], v[240:243], v[204:207], v[144:147]
    v_mfma_f32_16x16x32_bf16 v[148:151], v[240:243], v[208:211], v[148:151]
    v_mfma_f32_16x16x32_bf16 v[152:155], v[244:247], v[204:207], v[152:155]
    v_mfma_f32_16x16x32_bf16 v[156:159], v[244:247], v[208:211], v[156:159]
    s_waitcnt lgkmcnt(5)
    v_mfma_f32_16x16x32_bf16 v[88:91], v[168:171], v[160:163], v[88:91]
    ds_read_b128 v[204:207], v0 offset:1024
    v_mfma_f32_16x16x32_bf16 v[92:95], v[168:171], v[164:167], v[92:95]
    ds_read_b128 v[208:211], v0 offset:3072
    v_mfma_f32_16x16x32_bf16 v[96:99], v[172:175], v[160:163], v[96:99]
    ds_read_b128 v[212:215], v2 offset:9216
    v_mfma_f32_16x16x32_bf16 v[100:103], v[172:175], v[164:167], v[100:103]
    ds_read_b128 v[216:219], v2 offset:10240
    v_mfma_f32_16x16x32_bf16 v[104:107], v[176:179], v[160:163], v[104:107]
    ds_read_b128 v[220:223], v2 offset:11264
    v_mfma_f32_16x16x32_bf16 v[108:111], v[176:179], v[164:167], v[108:111]
    ds_read_b128 v[224:227], v2 offset:12288
    v_mfma_f32_16x16x32_bf16 v[112:115], v[180:183], v[160:163], v[112:115]
    ds_read_b128 v[228:231], v2 offset:13312
    v_mfma_f32_16x16x32_bf16 v[116:119], v[180:183], v[164:167], v[116:119]
    ds_read_b128 v[232:235], v2 offset:14336
    s_waitcnt lgkmcnt(8)
    v_mfma_f32_16x16x32_bf16 v[120:123], v[184:187], v[160:163], v[120:123]
    ds_read_b128 v[236:239], v2 offset:15360
    v_mfma_f32_16x16x32_bf16 v[124:127], v[184:187], v[164:167], v[124:127]
    ds_read_b128 v[240:243], v2 offset:16384
    v_mfma_f32_16x16x32_bf16 v[128:131], v[188:191], v[160:163], v[128:131]
    ds_read_b128 v[244:247], v2 offset:17408
    v_mfma_f32_16x16x32_bf16 v[132:135], v[188:191], v[164:167], v[132:135]
    v_mfma_f32_16x16x32_bf16 v[136:139], v[192:195], v[160:163], v[136:139]
    v_mfma_f32_16x16x32_bf16 v[140:143], v[192:195], v[164:167], v[140:143]
    v_mfma_f32_16x16x32_bf16 v[144:147], v[196:199], v[160:163], v[144:147]
    v_mfma_f32_16x16x32_bf16 v[148:151], v[196:199], v[164:167], v[148:151]
    v_mfma_f32_16x16x32_bf16 v[152:155], v[200:203], v[160:163], v[152:155]
    v_mfma_f32_16x16x32_bf16 v[156:159], v[200:203], v[164:167], v[156:159]
    s_waitcnt lgkmcnt(0)
    s_barrier
    v_mfma_f32_16x16x32_bf16 v[88:91], v[212:215], v[204:207], v[88:91]
    ds_read_b128 v[160:163], v0 offset:36864
    v_mfma_f32_16x16x32_bf16 v[92:95], v[212:215], v[208:211], v[92:95]
    ds_read_b128 v[164:167], v0 offset:38912
    v_mfma_f32_16x16x32_bf16 v[96:99], v[216:219], v[204:207], v[96:99]
    ds_read_b128 v[168:171], v2 offset:36864
    v_mfma_f32_16x16x32_bf16 v[100:103], v[216:219], v[208:211], v[100:103]
    ds_read_b128 v[172:175], v2 offset:37888
    v_mfma_f32_16x16x32_bf16 v[104:107], v[220:223], v[204:207], v[104:107]
    ds_read_b128 v[176:179], v2 offset:38912
    v_mfma_f32_16x16x32_bf16 v[108:111], v[220:223], v[208:211], v[108:111]
    ds_read_b128 v[180:183], v2 offset:39936
    v_mfma_f32_16x16x32_bf16 v[112:115], v[224:227], v[204:207], v[112:115]
    ds_read_b128 v[184:187], v2 offset:40960
    v_mfma_f32_16x16x32_bf16 v[116:119], v[224:227], v[208:211], v[116:119]
    ds_read_b128 v[188:191], v2 offset:41984
    v_mfma_f32_16x16x32_bf16 v[120:123], v[228:231], v[204:207], v[120:123]
    ds_read_b128 v[192:195], v2 offset:43008
    v_mfma_f32_16x16x32_bf16 v[124:127], v[228:231], v[208:211], v[124:127]
    ds_read_b128 v[196:199], v2 offset:44032
    v_mfma_f32_16x16x32_bf16 v[128:131], v[232:235], v[204:207], v[128:131]
    ds_read_b128 v[200:203], v2 offset:45056
    v_mfma_f32_16x16x32_bf16 v[132:135], v[232:235], v[208:211], v[132:135]
    v_mfma_f32_16x16x32_bf16 v[136:139], v[236:239], v[204:207], v[136:139]
    v_mfma_f32_16x16x32_bf16 v[140:143], v[236:239], v[208:211], v[140:143]
    v_mfma_f32_16x16x32_bf16 v[144:147], v[240:243], v[204:207], v[144:147]
    v_mfma_f32_16x16x32_bf16 v[148:151], v[240:243], v[208:211], v[148:151]
    v_mfma_f32_16x16x32_bf16 v[152:155], v[244:247], v[204:207], v[152:155]
    v_mfma_f32_16x16x32_bf16 v[156:159], v[244:247], v[208:211], v[156:159]
    s_waitcnt lgkmcnt(5)
    v_mfma_f32_16x16x32_bf16 v[88:91], v[168:171], v[160:163], v[88:91]
    ds_read_b128 v[204:207], v0 offset:37888
    v_mfma_f32_16x16x32_bf16 v[92:95], v[168:171], v[164:167], v[92:95]
    ds_read_b128 v[208:211], v0 offset:39936
    v_mfma_f32_16x16x32_bf16 v[96:99], v[172:175], v[160:163], v[96:99]
    ds_read_b128 v[212:215], v2 offset:46080
    v_mfma_f32_16x16x32_bf16 v[100:103], v[172:175], v[164:167], v[100:103]
    ds_read_b128 v[216:219], v2 offset:47104
    v_mfma_f32_16x16x32_bf16 v[104:107], v[176:179], v[160:163], v[104:107]
    ds_read_b128 v[220:223], v2 offset:48128
    v_mfma_f32_16x16x32_bf16 v[108:111], v[176:179], v[164:167], v[108:111]
    ds_read_b128 v[224:227], v2 offset:49152
    v_mfma_f32_16x16x32_bf16 v[112:115], v[180:183], v[160:163], v[112:115]
    ds_read_b128 v[228:231], v2 offset:50176
    v_mfma_f32_16x16x32_bf16 v[116:119], v[180:183], v[164:167], v[116:119]
    ds_read_b128 v[232:235], v2 offset:51200
    s_waitcnt lgkmcnt(8)
    v_mfma_f32_16x16x32_bf16 v[120:123], v[184:187], v[160:163], v[120:123]
    ds_read_b128 v[236:239], v2 offset:52224
    v_mfma_f32_16x16x32_bf16 v[124:127], v[184:187], v[164:167], v[124:127]
    ds_read_b128 v[240:243], v2 offset:53248
    v_mfma_f32_16x16x32_bf16 v[128:131], v[188:191], v[160:163], v[128:131]
    ds_read_b128 v[244:247], v2 offset:54272
    v_mfma_f32_16x16x32_bf16 v[132:135], v[188:191], v[164:167], v[132:135]
    v_mfma_f32_16x16x32_bf16 v[136:139], v[192:195], v[160:163], v[136:139]
    v_mfma_f32_16x16x32_bf16 v[140:143], v[192:195], v[164:167], v[140:143]
    v_mfma_f32_16x16x32_bf16 v[144:147], v[196:199], v[160:163], v[144:147]
    v_mfma_f32_16x16x32_bf16 v[148:151], v[196:199], v[164:167], v[148:151]
    v_mfma_f32_16x16x32_bf16 v[152:155], v[200:203], v[160:163], v[152:155]
    v_mfma_f32_16x16x32_bf16 v[156:159], v[200:203], v[164:167], v[156:159]
    s_waitcnt lgkmcnt(0)
    s_barrier
    v_mfma_f32_16x16x32_bf16 v[88:91], v[212:215], v[204:207], v[88:91]
    ds_read_b128 v[160:163], v3 offset:0
    v_mfma_f32_16x16x32_bf16 v[92:95], v[212:215], v[208:211], v[92:95]
    ds_read_b128 v[164:167], v3 offset:2048
    v_mfma_f32_16x16x32_bf16 v[96:99], v[216:219], v[204:207], v[96:99]
    ds_read_b128 v[168:171], v1 offset:0
    v_mfma_f32_16x16x32_bf16 v[100:103], v[216:219], v[208:211], v[100:103]
    ds_read_b128 v[172:175], v1 offset:1024
    v_mfma_f32_16x16x32_bf16 v[104:107], v[220:223], v[204:207], v[104:107]
    ds_read_b128 v[176:179], v1 offset:2048
    v_mfma_f32_16x16x32_bf16 v[108:111], v[220:223], v[208:211], v[108:111]
    ds_read_b128 v[180:183], v1 offset:3072
    v_mfma_f32_16x16x32_bf16 v[112:115], v[224:227], v[204:207], v[112:115]
    ds_read_b128 v[184:187], v1 offset:4096
    v_mfma_f32_16x16x32_bf16 v[116:119], v[224:227], v[208:211], v[116:119]
    ds_read_b128 v[188:191], v1 offset:5120
    v_mfma_f32_16x16x32_bf16 v[120:123], v[228:231], v[204:207], v[120:123]
    ds_read_b128 v[192:195], v1 offset:6144
    v_mfma_f32_16x16x32_bf16 v[124:127], v[228:231], v[208:211], v[124:127]
    ds_read_b128 v[196:199], v1 offset:7168
    v_mfma_f32_16x16x32_bf16 v[128:131], v[232:235], v[204:207], v[128:131]
    ds_read_b128 v[200:203], v1 offset:8192
    v_mfma_f32_16x16x32_bf16 v[132:135], v[232:235], v[208:211], v[132:135]
    v_mfma_f32_16x16x32_bf16 v[136:139], v[236:239], v[204:207], v[136:139]
    v_mfma_f32_16x16x32_bf16 v[140:143], v[236:239], v[208:211], v[140:143]
    v_mfma_f32_16x16x32_bf16 v[144:147], v[240:243], v[204:207], v[144:147]
    v_mfma_f32_16x16x32_bf16 v[148:151], v[240:243], v[208:211], v[148:151]
    v_mfma_f32_16x16x32_bf16 v[152:155], v[244:247], v[204:207], v[152:155]
    v_mfma_f32_16x16x32_bf16 v[156:159], v[244:247], v[208:211], v[156:159]
    s_waitcnt lgkmcnt(5)
    v_mfma_f32_16x16x32_bf16 v[88:91], v[168:171], v[160:163], v[88:91]
    ds_read_b128 v[204:207], v3 offset:1024
    v_mfma_f32_16x16x32_bf16 v[92:95], v[168:171], v[164:167], v[92:95]
    ds_read_b128 v[208:211], v3 offset:3072
    v_mfma_f32_16x16x32_bf16 v[96:99], v[172:175], v[160:163], v[96:99]
    ds_read_b128 v[212:215], v1 offset:9216
    v_mfma_f32_16x16x32_bf16 v[100:103], v[172:175], v[164:167], v[100:103]
    ds_read_b128 v[216:219], v1 offset:10240
    v_mfma_f32_16x16x32_bf16 v[104:107], v[176:179], v[160:163], v[104:107]
    ds_read_b128 v[220:223], v1 offset:11264
    v_mfma_f32_16x16x32_bf16 v[108:111], v[176:179], v[164:167], v[108:111]
    ds_read_b128 v[224:227], v1 offset:12288
    v_mfma_f32_16x16x32_bf16 v[112:115], v[180:183], v[160:163], v[112:115]
    ds_read_b128 v[228:231], v1 offset:13312
    v_mfma_f32_16x16x32_bf16 v[116:119], v[180:183], v[164:167], v[116:119]
    ds_read_b128 v[232:235], v1 offset:14336
    s_waitcnt lgkmcnt(8)
    v_mfma_f32_16x16x32_bf16 v[120:123], v[184:187], v[160:163], v[120:123]
    ds_read_b128 v[236:239], v1 offset:15360
    v_mfma_f32_16x16x32_bf16 v[124:127], v[184:187], v[164:167], v[124:127]
    ds_read_b128 v[240:243], v1 offset:16384
    v_mfma_f32_16x16x32_bf16 v[128:131], v[188:191], v[160:163], v[128:131]
    ds_read_b128 v[244:247], v1 offset:17408
    v_mfma_f32_16x16x32_bf16 v[132:135], v[188:191], v[164:167], v[132:135]
    v_mfma_f32_16x16x32_bf16 v[136:139], v[192:195], v[160:163], v[136:139]
    v_mfma_f32_16x16x32_bf16 v[140:143], v[192:195], v[164:167], v[140:143]
    v_mfma_f32_16x16x32_bf16 v[144:147], v[196:199], v[160:163], v[144:147]
    v_mfma_f32_16x16x32_bf16 v[148:151], v[196:199], v[164:167], v[148:151]
    v_mfma_f32_16x16x32_bf16 v[152:155], v[200:203], v[160:163], v[152:155]
    v_mfma_f32_16x16x32_bf16 v[156:159], v[200:203], v[164:167], v[156:159]
    s_waitcnt lgkmcnt(0)
    s_barrier
    v_mfma_f32_16x16x32_bf16 v[88:91], v[212:215], v[204:207], v[88:91]
    ds_read_b128 v[160:163], v3 offset:36864
    v_mfma_f32_16x16x32_bf16 v[92:95], v[212:215], v[208:211], v[92:95]
    ds_read_b128 v[164:167], v3 offset:38912
    v_mfma_f32_16x16x32_bf16 v[96:99], v[216:219], v[204:207], v[96:99]
    ds_read_b128 v[168:171], v1 offset:36864
    v_mfma_f32_16x16x32_bf16 v[100:103], v[216:219], v[208:211], v[100:103]
    ds_read_b128 v[172:175], v1 offset:37888
    v_mfma_f32_16x16x32_bf16 v[104:107], v[220:223], v[204:207], v[104:107]
    ds_read_b128 v[176:179], v1 offset:38912
    v_mfma_f32_16x16x32_bf16 v[108:111], v[220:223], v[208:211], v[108:111]
    ds_read_b128 v[180:183], v1 offset:39936
    v_mfma_f32_16x16x32_bf16 v[112:115], v[224:227], v[204:207], v[112:115]
    ds_read_b128 v[184:187], v1 offset:40960
    v_mfma_f32_16x16x32_bf16 v[116:119], v[224:227], v[208:211], v[116:119]
    ds_read_b128 v[188:191], v1 offset:41984
    v_mfma_f32_16x16x32_bf16 v[120:123], v[228:231], v[204:207], v[120:123]
    ds_read_b128 v[192:195], v1 offset:43008
    v_mfma_f32_16x16x32_bf16 v[124:127], v[228:231], v[208:211], v[124:127]
    ds_read_b128 v[196:199], v1 offset:44032
    v_mfma_f32_16x16x32_bf16 v[128:131], v[232:235], v[204:207], v[128:131]
    ds_read_b128 v[200:203], v1 offset:45056
    v_mfma_f32_16x16x32_bf16 v[132:135], v[232:235], v[208:211], v[132:135]
    ds_read_b128 v[4:7], v255 offset:1024
    v_mfma_f32_16x16x32_bf16 v[136:139], v[236:239], v[204:207], v[136:139]
    ds_read_b128 v[8:11], v255 offset:1040
    v_mfma_f32_16x16x32_bf16 v[140:143], v[236:239], v[208:211], v[140:143]
    ds_read_b128 v[12:15], v255 offset:1056
    v_mfma_f32_16x16x32_bf16 v[144:147], v[240:243], v[204:207], v[144:147]
    ds_read_b128 v[252:255], v255 offset:1072
    v_mfma_f32_16x16x32_bf16 v[148:151], v[240:243], v[208:211], v[148:151]
    v_mfma_f32_16x16x32_bf16 v[152:155], v[244:247], v[204:207], v[152:155]
    v_mfma_f32_16x16x32_bf16 v[156:159], v[244:247], v[208:211], v[156:159]
    s_waitcnt lgkmcnt(9)
    v_mfma_f32_16x16x32_bf16 v[88:91], v[168:171], v[160:163], v[88:91]
    ds_read_b128 v[204:207], v3 offset:37888
    v_mfma_f32_16x16x32_bf16 v[92:95], v[168:171], v[164:167], v[92:95]
    ds_read_b128 v[208:211], v3 offset:39936
    v_mfma_f32_16x16x32_bf16 v[96:99], v[172:175], v[160:163], v[96:99]
    ds_read_b128 v[212:215], v1 offset:46080
    v_mfma_f32_16x16x32_bf16 v[100:103], v[172:175], v[164:167], v[100:103]
    ds_read_b128 v[216:219], v1 offset:47104
    v_mfma_f32_16x16x32_bf16 v[104:107], v[176:179], v[160:163], v[104:107]
    ds_read_b128 v[220:223], v1 offset:48128
    v_mfma_f32_16x16x32_bf16 v[108:111], v[176:179], v[164:167], v[108:111]
    ds_read_b128 v[224:227], v1 offset:49152
    v_mfma_f32_16x16x32_bf16 v[112:115], v[180:183], v[160:163], v[112:115]
    ds_read_b128 v[228:231], v1 offset:50176
    v_mfma_f32_16x16x32_bf16 v[116:119], v[180:183], v[164:167], v[116:119]
    ds_read_b128 v[232:235], v1 offset:51200
    s_waitcnt lgkmcnt(8)
    v_mfma_f32_16x16x32_bf16 v[120:123], v[184:187], v[160:163], v[120:123]
    ds_read_b128 v[236:239], v1 offset:52224
    v_fma_f32 v16, v16, v4, -v6
    v_mfma_f32_16x16x32_bf16 v[124:127], v[184:187], v[164:167], v[124:127]
    ds_read_b128 v[240:243], v1 offset:53248
    v_fma_f32 v17, v17, v5, -v7
    v_mfma_f32_16x16x32_bf16 v[128:131], v[188:191], v[160:163], v[128:131]
    ds_read_b128 v[244:247], v1 offset:54272
    v_fma_f32 v18, v18, v8, -v10
    v_mfma_f32_16x16x32_bf16 v[132:135], v[188:191], v[164:167], v[132:135]
    v_fma_f32 v19, v19, v9, -v11
    v_fma_f32 v20, v20, v12, -v14
    v_mfma_f32_16x16x32_bf16 v[136:139], v[192:195], v[160:163], v[136:139]
    v_fma_f32 v21, v21, v13, -v15
    v_fma_f32 v22, v22, v252, -v254
    v_mfma_f32_16x16x32_bf16 v[140:143], v[192:195], v[164:167], v[140:143]
    v_fma_f32 v23, v23, v253, -v255
    v_cvt_pk_bf16_f32 v16, v16, v17
    v_mfma_f32_16x16x32_bf16 v[144:147], v[196:199], v[160:163], v[144:147]
    v_cvt_pk_bf16_f32 v17, v18, v19
    v_cvt_pk_bf16_f32 v18, v20, v21
    v_mfma_f32_16x16x32_bf16 v[148:151], v[196:199], v[164:167], v[148:151]
    v_cvt_pk_bf16_f32 v19, v22, v23
    v_fma_f32 v24, v24, v4, -v6
    v_mfma_f32_16x16x32_bf16 v[152:155], v[200:203], v[160:163], v[152:155]
    v_fma_f32 v25, v25, v5, -v7
    v_fma_f32 v26, v26, v8, -v10
    v_mfma_f32_16x16x32_bf16 v[156:159], v[200:203], v[164:167], v[156:159]
    v_fma_f32 v27, v27, v9, -v11
    s_waitcnt lgkmcnt(0)
    s_barrier
    v_mfma_f32_16x16x32_bf16 v[88:91], v[212:215], v[204:207], v[88:91]
    ds_read_b128 v[160:163], v0 offset:0
    v_mfma_f32_16x16x32_bf16 v[92:95], v[212:215], v[208:211], v[92:95]
    ds_read_b128 v[164:167], v0 offset:2048
    v_fma_f32 v28, v28, v12, -v14
    v_mfma_f32_16x16x32_bf16 v[96:99], v[216:219], v[204:207], v[96:99]
    ds_read_b128 v[168:171], v2 offset:0
    v_fma_f32 v29, v29, v13, -v15
    v_mfma_f32_16x16x32_bf16 v[100:103], v[216:219], v[208:211], v[100:103]
    ds_read_b128 v[172:175], v2 offset:1024
    v_fma_f32 v30, v30, v252, -v254
    v_mfma_f32_16x16x32_bf16 v[104:107], v[220:223], v[204:207], v[104:107]
    ds_read_b128 v[176:179], v2 offset:2048
    v_fma_f32 v31, v31, v253, -v255
    v_mfma_f32_16x16x32_bf16 v[108:111], v[220:223], v[208:211], v[108:111]
    ds_read_b128 v[180:183], v2 offset:3072
    v_permlane32_swap_b32 v16, v18
    v_mfma_f32_16x16x32_bf16 v[112:115], v[224:227], v[204:207], v[112:115]
    ds_read_b128 v[184:187], v2 offset:4096
    v_permlane32_swap_b32 v17, v19
    v_mfma_f32_16x16x32_bf16 v[116:119], v[224:227], v[208:211], v[116:119]
    ds_read_b128 v[188:191], v2 offset:5120
    v_mfma_f32_16x16x32_bf16 v[120:123], v[228:231], v[204:207], v[120:123]
    ds_read_b128 v[192:195], v2 offset:6144
    v_cvt_pk_bf16_f32 v24, v24, v25
    v_mfma_f32_16x16x32_bf16 v[124:127], v[228:231], v[208:211], v[124:127]
    ds_read_b128 v[196:199], v2 offset:7168
    v_cvt_pk_bf16_f32 v25, v26, v27
    v_mfma_f32_16x16x32_bf16 v[128:131], v[232:235], v[204:207], v[128:131]
    ds_read_b128 v[200:203], v2 offset:8192
    v_cvt_pk_bf16_f32 v26, v28, v29
    v_mfma_f32_16x16x32_bf16 v[132:135], v[232:235], v[208:211], v[132:135]
    v_cvt_pk_bf16_f32 v27, v30, v31
    v_permlane16_swap_b32 v16, v18
    v_mfma_f32_16x16x32_bf16 v[136:139], v[236:239], v[204:207], v[136:139]
    v_permlane16_swap_b32 v17, v19
    buffer_store_dwordx4 v[16:19], v1, s[4:7], s38 offen offset:0 sc1
    v_fma_f32 v32, v32, v4, -v6
    v_mfma_f32_16x16x32_bf16 v[140:143], v[236:239], v[208:211], v[140:143]
    v_fma_f32 v33, v33, v5, -v7
    v_fma_f32 v34, v34, v8, -v10
    v_mfma_f32_16x16x32_bf16 v[144:147], v[240:243], v[204:207], v[144:147]
    v_fma_f32 v35, v35, v9, -v11
    v_fma_f32 v36, v36, v12, -v14
    v_mfma_f32_16x16x32_bf16 v[148:151], v[240:243], v[208:211], v[148:151]
    v_fma_f32 v37, v37, v13, -v15
    v_fma_f32 v38, v38, v252, -v254
    v_mfma_f32_16x16x32_bf16 v[152:155], v[244:247], v[204:207], v[152:155]
    v_fma_f32 v39, v39, v253, -v255
    v_permlane32_swap_b32 v24, v26
    v_mfma_f32_16x16x32_bf16 v[156:159], v[244:247], v[208:211], v[156:159]
    v_permlane32_swap_b32 v25, v27
    s_waitcnt lgkmcnt(5)
    v_mfma_f32_16x16x32_bf16 v[88:91], v[168:171], v[160:163], v[88:91]
    ds_read_b128 v[204:207], v0 offset:1024
    v_mfma_f32_16x16x32_bf16 v[92:95], v[168:171], v[164:167], v[92:95]
    ds_read_b128 v[208:211], v0 offset:3072
    v_cvt_pk_bf16_f32 v32, v32, v33
    v_mfma_f32_16x16x32_bf16 v[96:99], v[172:175], v[160:163], v[96:99]
    ds_read_b128 v[212:215], v2 offset:9216
    v_cvt_pk_bf16_f32 v33, v34, v35
    v_mfma_f32_16x16x32_bf16 v[100:103], v[172:175], v[164:167], v[100:103]
    ds_read_b128 v[216:219], v2 offset:10240
    v_cvt_pk_bf16_f32 v34, v36, v37
    v_mfma_f32_16x16x32_bf16 v[104:107], v[176:179], v[160:163], v[104:107]
    ds_read_b128 v[220:223], v2 offset:11264
    v_cvt_pk_bf16_f32 v35, v38, v39
    v_mfma_f32_16x16x32_bf16 v[108:111], v[176:179], v[164:167], v[108:111]
    ds_read_b128 v[224:227], v2 offset:12288
    v_permlane16_swap_b32 v24, v26
    v_mfma_f32_16x16x32_bf16 v[112:115], v[180:183], v[160:163], v[112:115]
    ds_read_b128 v[228:231], v2 offset:13312
    v_permlane16_swap_b32 v25, v27
    buffer_store_dwordx4 v[24:27], v1, s[4:7], s38 offen offset:1024 sc1
    v_mfma_f32_16x16x32_bf16 v[116:119], v[180:183], v[164:167], v[116:119]
    ds_read_b128 v[232:235], v2 offset:14336
    s_waitcnt lgkmcnt(8)
    v_mfma_f32_16x16x32_bf16 v[120:123], v[184:187], v[160:163], v[120:123]
    ds_read_b128 v[236:239], v2 offset:15360
    v_fma_f32 v40, v40, v4, -v6
    v_mfma_f32_16x16x32_bf16 v[124:127], v[184:187], v[164:167], v[124:127]
    ds_read_b128 v[240:243], v2 offset:16384
    v_fma_f32 v41, v41, v5, -v7
    v_mfma_f32_16x16x32_bf16 v[128:131], v[188:191], v[160:163], v[128:131]
    ds_read_b128 v[244:247], v2 offset:17408
    v_fma_f32 v42, v42, v8, -v10
    v_mfma_f32_16x16x32_bf16 v[132:135], v[188:191], v[164:167], v[132:135]
    v_fma_f32 v43, v43, v9, -v11
    v_fma_f32 v44, v44, v12, -v14
    v_mfma_f32_16x16x32_bf16 v[136:139], v[192:195], v[160:163], v[136:139]
    v_fma_f32 v45, v45, v13, -v15
    v_fma_f32 v46, v46, v252, -v254
    v_mfma_f32_16x16x32_bf16 v[140:143], v[192:195], v[164:167], v[140:143]
    v_fma_f32 v47, v47, v253, -v255
    v_permlane32_swap_b32 v32, v34
    v_mfma_f32_16x16x32_bf16 v[144:147], v[196:199], v[160:163], v[144:147]
    v_permlane32_swap_b32 v33, v35
    v_cvt_pk_bf16_f32 v40, v40, v41
    v_mfma_f32_16x16x32_bf16 v[148:151], v[196:199], v[164:167], v[148:151]
    v_cvt_pk_bf16_f32 v41, v42, v43
    v_cvt_pk_bf16_f32 v42, v44, v45
    v_mfma_f32_16x16x32_bf16 v[152:155], v[200:203], v[160:163], v[152:155]
    v_cvt_pk_bf16_f32 v43, v46, v47
    v_permlane16_swap_b32 v32, v34
    v_mfma_f32_16x16x32_bf16 v[156:159], v[200:203], v[164:167], v[156:159]
    v_permlane16_swap_b32 v33, v35
    buffer_store_dwordx4 v[32:35], v1, s[4:7], s38 offen offset:2048 sc1
    s_waitcnt lgkmcnt(0)
    s_barrier
    v_mfma_f32_16x16x32_bf16 v[88:91], v[212:215], v[204:207], v[88:91]
    ds_read_b128 v[160:163], v0 offset:36864
    v_mfma_f32_16x16x32_bf16 v[92:95], v[212:215], v[208:211], v[92:95]
    ds_read_b128 v[164:167], v0 offset:38912
    v_fma_f32 v48, v48, v4, -v6
    v_mfma_f32_16x16x32_bf16 v[96:99], v[216:219], v[204:207], v[96:99]
    ds_read_b128 v[168:171], v2 offset:36864
    v_fma_f32 v49, v49, v5, -v7
    v_mfma_f32_16x16x32_bf16 v[100:103], v[216:219], v[208:211], v[100:103]
    ds_read_b128 v[172:175], v2 offset:37888
    v_fma_f32 v50, v50, v8, -v10
    v_mfma_f32_16x16x32_bf16 v[104:107], v[220:223], v[204:207], v[104:107]
    ds_read_b128 v[176:179], v2 offset:38912
    v_fma_f32 v51, v51, v9, -v11
    v_mfma_f32_16x16x32_bf16 v[108:111], v[220:223], v[208:211], v[108:111]
    ds_read_b128 v[180:183], v2 offset:39936
    v_fma_f32 v52, v52, v12, -v14
    v_mfma_f32_16x16x32_bf16 v[112:115], v[224:227], v[204:207], v[112:115]
    ds_read_b128 v[184:187], v2 offset:40960
    v_fma_f32 v53, v53, v13, -v15
    v_mfma_f32_16x16x32_bf16 v[116:119], v[224:227], v[208:211], v[116:119]
    ds_read_b128 v[188:191], v2 offset:41984
    v_mfma_f32_16x16x32_bf16 v[120:123], v[228:231], v[204:207], v[120:123]
    ds_read_b128 v[192:195], v2 offset:43008
    v_fma_f32 v54, v54, v252, -v254
    v_mfma_f32_16x16x32_bf16 v[124:127], v[228:231], v[208:211], v[124:127]
    ds_read_b128 v[196:199], v2 offset:44032
    v_fma_f32 v55, v55, v253, -v255
    v_mfma_f32_16x16x32_bf16 v[128:131], v[232:235], v[204:207], v[128:131]
    ds_read_b128 v[200:203], v2 offset:45056
    v_permlane32_swap_b32 v40, v42
    v_mfma_f32_16x16x32_bf16 v[132:135], v[232:235], v[208:211], v[132:135]
    v_permlane32_swap_b32 v41, v43
    v_cvt_pk_bf16_f32 v48, v48, v49
    v_mfma_f32_16x16x32_bf16 v[136:139], v[236:239], v[204:207], v[136:139]
    v_cvt_pk_bf16_f32 v49, v50, v51
    v_cvt_pk_bf16_f32 v50, v52, v53
    v_mfma_f32_16x16x32_bf16 v[140:143], v[236:239], v[208:211], v[140:143]
    v_cvt_pk_bf16_f32 v51, v54, v55
    v_permlane16_swap_b32 v40, v42
    v_mfma_f32_16x16x32_bf16 v[144:147], v[240:243], v[204:207], v[144:147]
    v_permlane16_swap_b32 v41, v43
    buffer_store_dwordx4 v[40:43], v1, s[4:7], s38 offen offset:3072 sc1
    v_fma_f32 v56, v56, v4, -v6
    v_mfma_f32_16x16x32_bf16 v[148:151], v[240:243], v[208:211], v[148:151]
    v_fma_f32 v57, v57, v5, -v7
    v_fma_f32 v58, v58, v8, -v10
    v_mfma_f32_16x16x32_bf16 v[152:155], v[244:247], v[204:207], v[152:155]
    v_fma_f32 v59, v59, v9, -v11
    v_fma_f32 v60, v60, v12, -v14
    v_mfma_f32_16x16x32_bf16 v[156:159], v[244:247], v[208:211], v[156:159]
    v_fma_f32 v61, v61, v13, -v15
    s_waitcnt lgkmcnt(5)
    v_mfma_f32_16x16x32_bf16 v[88:91], v[168:171], v[160:163], v[88:91]
    ds_read_b128 v[204:207], v0 offset:37888
    v_mfma_f32_16x16x32_bf16 v[92:95], v[168:171], v[164:167], v[92:95]
    ds_read_b128 v[208:211], v0 offset:39936
    v_fma_f32 v62, v62, v252, -v254
    v_mfma_f32_16x16x32_bf16 v[96:99], v[172:175], v[160:163], v[96:99]
    ds_read_b128 v[212:215], v2 offset:46080
    v_fma_f32 v63, v63, v253, -v255
    v_mfma_f32_16x16x32_bf16 v[100:103], v[172:175], v[164:167], v[100:103]
    ds_read_b128 v[216:219], v2 offset:47104
    v_permlane32_swap_b32 v48, v50
    v_mfma_f32_16x16x32_bf16 v[104:107], v[176:179], v[160:163], v[104:107]
    ds_read_b128 v[220:223], v2 offset:48128
    v_permlane32_swap_b32 v49, v51
    v_mfma_f32_16x16x32_bf16 v[108:111], v[176:179], v[164:167], v[108:111]
    ds_read_b128 v[224:227], v2 offset:49152
    v_cvt_pk_bf16_f32 v56, v56, v57
    v_mfma_f32_16x16x32_bf16 v[112:115], v[180:183], v[160:163], v[112:115]
    ds_read_b128 v[228:231], v2 offset:50176
    v_cvt_pk_bf16_f32 v57, v58, v59
    v_mfma_f32_16x16x32_bf16 v[116:119], v[180:183], v[164:167], v[116:119]
    ds_read_b128 v[232:235], v2 offset:51200
    s_waitcnt lgkmcnt(8)
    v_mfma_f32_16x16x32_bf16 v[120:123], v[184:187], v[160:163], v[120:123]
    ds_read_b128 v[236:239], v2 offset:52224
    v_cvt_pk_bf16_f32 v58, v60, v61
    v_mfma_f32_16x16x32_bf16 v[124:127], v[184:187], v[164:167], v[124:127]
    ds_read_b128 v[240:243], v2 offset:53248
    v_cvt_pk_bf16_f32 v59, v62, v63
    v_mfma_f32_16x16x32_bf16 v[128:131], v[188:191], v[160:163], v[128:131]
    ds_read_b128 v[244:247], v2 offset:54272
    v_permlane16_swap_b32 v48, v50
    v_mfma_f32_16x16x32_bf16 v[132:135], v[188:191], v[164:167], v[132:135]
    v_permlane16_swap_b32 v49, v51
    buffer_store_dwordx4 v[48:51], v1, s[4:7], s39 offen offset:0 sc1
    v_fma_f32 v64, v64, v4, -v6
    v_mfma_f32_16x16x32_bf16 v[136:139], v[192:195], v[160:163], v[136:139]
    v_fma_f32 v65, v65, v5, -v7
    v_fma_f32 v66, v66, v8, -v10
    v_mfma_f32_16x16x32_bf16 v[140:143], v[192:195], v[164:167], v[140:143]
    v_fma_f32 v67, v67, v9, -v11
    v_fma_f32 v68, v68, v12, -v14
    v_mfma_f32_16x16x32_bf16 v[144:147], v[196:199], v[160:163], v[144:147]
    v_fma_f32 v69, v69, v13, -v15
    v_fma_f32 v70, v70, v252, -v254
    v_mfma_f32_16x16x32_bf16 v[148:151], v[196:199], v[164:167], v[148:151]
    v_fma_f32 v71, v71, v253, -v255
    v_permlane32_swap_b32 v56, v58
    v_mfma_f32_16x16x32_bf16 v[152:155], v[200:203], v[160:163], v[152:155]
    v_permlane32_swap_b32 v57, v59
    v_cvt_pk_bf16_f32 v64, v64, v65
    v_mfma_f32_16x16x32_bf16 v[156:159], v[200:203], v[164:167], v[156:159]
    v_cvt_pk_bf16_f32 v65, v66, v67
    s_waitcnt lgkmcnt(0)
    s_barrier
    v_mfma_f32_16x16x32_bf16 v[88:91], v[212:215], v[204:207], v[88:91]
    ds_read_b128 v[160:163], v3 offset:0
    v_mfma_f32_16x16x32_bf16 v[92:95], v[212:215], v[208:211], v[92:95]
    ds_read_b128 v[164:167], v3 offset:2048
    v_cvt_pk_bf16_f32 v66, v68, v69
    v_mfma_f32_16x16x32_bf16 v[96:99], v[216:219], v[204:207], v[96:99]
    ds_read_b128 v[168:171], v1 offset:0
    v_cvt_pk_bf16_f32 v67, v70, v71
    v_mfma_f32_16x16x32_bf16 v[100:103], v[216:219], v[208:211], v[100:103]
    ds_read_b128 v[172:175], v1 offset:1024
    v_permlane16_swap_b32 v56, v58
    v_mfma_f32_16x16x32_bf16 v[104:107], v[220:223], v[204:207], v[104:107]
    ds_read_b128 v[176:179], v1 offset:2048
    v_permlane16_swap_b32 v57, v59
    buffer_store_dwordx4 v[56:59], v1, s[4:7], s39 offen offset:1024 sc1
    v_mfma_f32_16x16x32_bf16 v[108:111], v[220:223], v[208:211], v[108:111]
    ds_read_b128 v[180:183], v1 offset:3072
    v_fma_f32 v72, v72, v4, -v6
    v_mfma_f32_16x16x32_bf16 v[112:115], v[224:227], v[204:207], v[112:115]
    ds_read_b128 v[184:187], v1 offset:4096
    v_fma_f32 v73, v73, v5, -v7
    v_mfma_f32_16x16x32_bf16 v[116:119], v[224:227], v[208:211], v[116:119]
    ds_read_b128 v[188:191], v1 offset:5120
    v_mfma_f32_16x16x32_bf16 v[120:123], v[228:231], v[204:207], v[120:123]
    ds_read_b128 v[192:195], v1 offset:6144
    v_fma_f32 v74, v74, v8, -v10
    v_mfma_f32_16x16x32_bf16 v[124:127], v[228:231], v[208:211], v[124:127]
    ds_read_b128 v[196:199], v1 offset:7168
    v_fma_f32 v75, v75, v9, -v11
    v_mfma_f32_16x16x32_bf16 v[128:131], v[232:235], v[204:207], v[128:131]
    ds_read_b128 v[200:203], v1 offset:8192
    v_fma_f32 v76, v76, v12, -v14
    v_mfma_f32_16x16x32_bf16 v[132:135], v[232:235], v[208:211], v[132:135]
    v_fma_f32 v77, v77, v13, -v15
    v_fma_f32 v78, v78, v252, -v254
    v_mfma_f32_16x16x32_bf16 v[136:139], v[236:239], v[204:207], v[136:139]
    v_fma_f32 v79, v79, v253, -v255
    v_permlane32_swap_b32 v64, v66
    v_mfma_f32_16x16x32_bf16 v[140:143], v[236:239], v[208:211], v[140:143]
    v_permlane32_swap_b32 v65, v67
    v_cvt_pk_bf16_f32 v72, v72, v73
    v_mfma_f32_16x16x32_bf16 v[144:147], v[240:243], v[204:207], v[144:147]
    v_cvt_pk_bf16_f32 v73, v74, v75
    v_cvt_pk_bf16_f32 v74, v76, v77
    v_mfma_f32_16x16x32_bf16 v[148:151], v[240:243], v[208:211], v[148:151]
    v_cvt_pk_bf16_f32 v75, v78, v79
    v_permlane16_swap_b32 v64, v66
    v_mfma_f32_16x16x32_bf16 v[152:155], v[244:247], v[204:207], v[152:155]
    v_permlane16_swap_b32 v65, v67
    buffer_store_dwordx4 v[64:67], v1, s[4:7], s39 offen offset:2048 sc1
    v_fma_f32 v80, v80, v4, -v6
    v_mfma_f32_16x16x32_bf16 v[156:159], v[244:247], v[208:211], v[156:159]
    v_fma_f32 v81, v81, v5, -v7
    s_waitcnt lgkmcnt(5)
    v_mfma_f32_16x16x32_bf16 v[88:91], v[168:171], v[160:163], v[88:91]
    ds_read_b128 v[204:207], v3 offset:1024
    v_mfma_f32_16x16x32_bf16 v[92:95], v[168:171], v[164:167], v[92:95]
    ds_read_b128 v[208:211], v3 offset:3072
    v_fma_f32 v82, v82, v8, -v10
    v_mfma_f32_16x16x32_bf16 v[96:99], v[172:175], v[160:163], v[96:99]
    ds_read_b128 v[212:215], v1 offset:9216
    v_fma_f32 v83, v83, v9, -v11
    v_mfma_f32_16x16x32_bf16 v[100:103], v[172:175], v[164:167], v[100:103]
    ds_read_b128 v[216:219], v1 offset:10240
    v_fma_f32 v84, v84, v12, -v14
    v_mfma_f32_16x16x32_bf16 v[104:107], v[176:179], v[160:163], v[104:107]
    ds_read_b128 v[220:223], v1 offset:11264
    v_fma_f32 v85, v85, v13, -v15
    v_mfma_f32_16x16x32_bf16 v[108:111], v[176:179], v[164:167], v[108:111]
    ds_read_b128 v[224:227], v1 offset:12288
    v_fma_f32 v86, v86, v252, -v254
    v_mfma_f32_16x16x32_bf16 v[112:115], v[180:183], v[160:163], v[112:115]
    ds_read_b128 v[228:231], v1 offset:13312
    v_fma_f32 v87, v87, v253, -v255
    v_mfma_f32_16x16x32_bf16 v[116:119], v[180:183], v[164:167], v[116:119]
    ds_read_b128 v[232:235], v1 offset:14336
    s_waitcnt lgkmcnt(8)
    v_mfma_f32_16x16x32_bf16 v[120:123], v[184:187], v[160:163], v[120:123]
    ds_read_b128 v[236:239], v1 offset:15360
    v_permlane32_swap_b32 v72, v74
    v_mfma_f32_16x16x32_bf16 v[124:127], v[184:187], v[164:167], v[124:127]
    ds_read_b128 v[240:243], v1 offset:16384
    v_permlane32_swap_b32 v73, v75
    v_mfma_f32_16x16x32_bf16 v[128:131], v[188:191], v[160:163], v[128:131]
    ds_read_b128 v[244:247], v1 offset:17408
    v_cvt_pk_bf16_f32 v80, v80, v81
    v_mfma_f32_16x16x32_bf16 v[132:135], v[188:191], v[164:167], v[132:135]
    v_cvt_pk_bf16_f32 v81, v82, v83
    v_cvt_pk_bf16_f32 v82, v84, v85
    v_mfma_f32_16x16x32_bf16 v[136:139], v[192:195], v[160:163], v[136:139]
    v_cvt_pk_bf16_f32 v83, v86, v87
    v_permlane16_swap_b32 v72, v74
    v_mfma_f32_16x16x32_bf16 v[140:143], v[192:195], v[164:167], v[140:143]
    v_permlane16_swap_b32 v73, v75
    buffer_store_dwordx4 v[72:75], v1, s[4:7], s39 offen offset:3072 sc1
    s_nop 0
    v_mfma_f32_16x16x32_bf16 v[144:147], v[196:199], v[160:163], v[144:147]
    v_permlane32_swap_b32 v80, v82
    v_permlane32_swap_b32 v81, v83
    v_mfma_f32_16x16x32_bf16 v[148:151], v[196:199], v[164:167], v[148:151]
    s_nop 0
    v_permlane16_swap_b32 v80, v82
    v_mfma_f32_16x16x32_bf16 v[152:155], v[200:203], v[160:163], v[152:155]
    v_permlane16_swap_b32 v81, v83
    buffer_store_dwordx4 v[80:83], v1, s[4:7], s46 offen offset:0 sc1
    v_mul_f32 v4, s40, v249
    v_mfma_f32_16x16x32_bf16 v[156:159], v[200:203], v[164:167], v[156:159]
    v_mul_f32 v6, s40, v251
    s_waitcnt lgkmcnt(0)
    s_barrier
    v_mfma_f32_16x16x32_bf16 v[88:91], v[212:215], v[204:207], v[88:91]
    ds_read_b128 v[160:163], v3 offset:36864
    v_mfma_f32_16x16x32_bf16 v[92:95], v[212:215], v[208:211], v[92:95]
    ds_read_b128 v[164:167], v3 offset:38912
    v_mul_f32 v5, v249, v249
    v_mfma_f32_16x16x32_bf16 v[96:99], v[216:219], v[204:207], v[96:99]
    ds_read_b128 v[168:171], v1 offset:36864
    v_mul_f32 v7, v251, v251
    v_mfma_f32_16x16x32_bf16 v[100:103], v[216:219], v[208:211], v[100:103]
    ds_read_b128 v[172:175], v1 offset:37888
    v_rcp_f32 v249, v249
    v_mfma_f32_16x16x32_bf16 v[104:107], v[220:223], v[204:207], v[104:107]
    ds_read_b128 v[176:179], v1 offset:38912
    v_rcp_f32 v251, v251
    v_mfma_f32_16x16x32_bf16 v[108:111], v[220:223], v[208:211], v[108:111]
    ds_read_b128 v[180:183], v1 offset:39936
    v_mul_f32 v5, s42, v5
    v_mfma_f32_16x16x32_bf16 v[112:115], v[224:227], v[204:207], v[112:115]
    ds_read_b128 v[184:187], v1 offset:40960
    v_mul_f32 v7, s42, v7
    v_mfma_f32_16x16x32_bf16 v[116:119], v[224:227], v[208:211], v[116:119]
    ds_read_b128 v[188:191], v1 offset:41984
    v_mfma_f32_16x16x32_bf16 v[120:123], v[228:231], v[204:207], v[120:123]
    ds_read_b128 v[192:195], v1 offset:43008
    v_mul_f32 v5, v5, v4
    v_mfma_f32_16x16x32_bf16 v[124:127], v[228:231], v[208:211], v[124:127]
    ds_read_b128 v[196:199], v1 offset:44032
    v_mul_f32 v7, v7, v6
    v_mfma_f32_16x16x32_bf16 v[128:131], v[232:235], v[204:207], v[128:131]
    ds_read_b128 v[200:203], v1 offset:45056
    v_bfe_u32 v13, v1, 4, 4
    v_mfma_f32_16x16x32_bf16 v[132:135], v[232:235], v[208:211], v[132:135]
    v_lshrrev_b32 v8, 1, v13
    v_lshrrev_b32 v9, 8, v1
    v_mfma_f32_16x16x32_bf16 v[136:139], v[236:239], v[204:207], v[136:139]
    v_xor_b32 v8, v8, v9
    v_lshlrev_b32 v8, 4, v8
    v_mfma_f32_16x16x32_bf16 v[140:143], v[236:239], v[208:211], v[140:143]
    v_lshl_add_u32 v8, v13, 7, v8
    s_add_u32 s33, s30, 18432
    v_mfma_f32_16x16x32_bf16 v[144:147], v[240:243], v[204:207], v[144:147]
    v_add_u32 v8, s33, v8
    v_xor_b32 v9, 64, v8
    v_mfma_f32_16x16x32_bf16 v[148:151], v[240:243], v[208:211], v[148:151]
    v_add_u32 v10, 73728, v8
    v_add_u32 v11, 73728, v9
    v_mfma_f32_16x16x32_bf16 v[152:155], v[244:247], v[204:207], v[152:155]
    s_lshl_b32 s33, s20, 6
    s_add_u32 s33, s33, 161280
    v_mfma_f32_16x16x32_bf16 v[156:159], v[244:247], v[208:211], v[156:159]
    v_lshl_add_u32 v13, v13, 1, s33
    s_waitcnt lgkmcnt(5)
    v_mfma_f32_16x16x32_bf16 v[88:91], v[168:171], v[160:163], v[88:91]
    ds_read_b128 v[204:207], v3 offset:37888
    v_mfma_f32_16x16x32_bf16 v[92:95], v[168:171], v[164:167], v[92:95]
    ds_read_b128 v[208:211], v3 offset:39936
    v_mfma_f32_16x16x32_bf16 v[96:99], v[172:175], v[160:163], v[96:99]
    ds_read_b128 v[212:215], v1 offset:46080
    v_mfma_f32_16x16x32_bf16 v[100:103], v[172:175], v[164:167], v[100:103]
    ds_read_b128 v[216:219], v1 offset:47104
    v_mfma_f32_16x16x32_bf16 v[104:107], v[176:179], v[160:163], v[104:107]
    ds_read_b128 v[220:223], v1 offset:48128
    v_mfma_f32_16x16x32_bf16 v[108:111], v[176:179], v[164:167], v[108:111]
    ds_read_b128 v[224:227], v1 offset:49152
    v_mfma_f32_16x16x32_bf16 v[112:115], v[180:183], v[160:163], v[112:115]
    ds_read_b128 v[228:231], v1 offset:50176
    v_mfma_f32_16x16x32_bf16 v[116:119], v[180:183], v[164:167], v[116:119]
    ds_read_b128 v[232:235], v1 offset:51200
    s_waitcnt lgkmcnt(8)
    v_mfma_f32_16x16x32_bf16 v[120:123], v[184:187], v[160:163], v[120:123]
    ds_read_b128 v[236:239], v1 offset:52224
    v_mfma_f32_16x16x32_bf16 v[124:127], v[184:187], v[164:167], v[124:127]
    ds_read_b128 v[240:243], v1 offset:53248
    v_mfma_f32_16x16x32_bf16 v[128:131], v[188:191], v[160:163], v[128:131]
    ds_read_b128 v[244:247], v1 offset:54272
    v_mfma_f32_16x16x32_bf16 v[132:135], v[188:191], v[164:167], v[132:135]
    v_mfma_f32_16x16x32_bf16 v[136:139], v[192:195], v[160:163], v[136:139]
    v_lshrrev_b32 v0, 4, v1
    v_mfma_f32_16x16x32_bf16 v[140:143], v[192:195], v[164:167], v[140:143]
    v_and_b32 v0, 48, v0
    v_mfma_f32_16x16x32_bf16 v[144:147], v[196:199], v[160:163], v[144:147]
    v_add_u32 v0, 160320, v0
    v_mfma_f32_16x16x32_bf16 v[148:151], v[196:199], v[164:167], v[148:151]
    v_mfma_f32_16x16x32_bf16 v[152:155], v[200:203], v[160:163], v[152:155]
    v_mfma_f32_16x16x32_bf16 v[156:159], v[200:203], v[164:167], v[156:159]
    s_waitcnt lgkmcnt(0)
    s_waitcnt vmcnt(0)
    s_barrier
    v_mfma_f32_16x16x32_bf16 v[88:91], v[212:215], v[204:207], v[88:91]
    ds_read_b128 v[168:171], v0 offset:0
    v_mfma_f32_16x16x32_bf16 v[92:95], v[212:215], v[208:211], v[92:95]
    ds_read_b128 v[172:175], v0 offset:64
    v_mfma_f32_16x16x32_bf16 v[96:99], v[216:219], v[204:207], v[96:99]
    ds_read_b128 v[176:179], v0 offset:128
    v_mfma_f32_16x16x32_bf16 v[100:103], v[216:219], v[208:211], v[100:103]
    ds_read_b128 v[180:183], v0 offset:192
    v_mfma_f32_16x16x32_bf16 v[104:107], v[220:223], v[204:207], v[104:107]
    ds_read_b128 v[184:187], v0 offset:256
    v_mfma_f32_16x16x32_bf16 v[108:111], v[220:223], v[208:211], v[108:111]
    ds_read_b128 v[188:191], v0 offset:320
    v_mfma_f32_16x16x32_bf16 v[112:115], v[224:227], v[204:207], v[112:115]
    ds_read_b128 v[192:195], v0 offset:384
    v_mfma_f32_16x16x32_bf16 v[116:119], v[224:227], v[208:211], v[116:119]
    ds_read_b128 v[196:199], v0 offset:448
    v_mfma_f32_16x16x32_bf16 v[120:123], v[228:231], v[204:207], v[120:123]
    ds_read_b128 v[200:203], v0 offset:512
    v_mfma_f32_16x16x32_bf16 v[124:127], v[228:231], v[208:211], v[124:127]
    ds_read_u16 v12, v13
    v_mfma_f32_16x16x32_bf16 v[128:131], v[232:235], v[204:207], v[128:131]
    ds_read_u16 v252, v13 offset:32
    v_mfma_f32_16x16x32_bf16 v[132:135], v[232:235], v[208:211], v[132:135]
    v_mfma_f32_16x16x32_bf16 v[136:139], v[236:239], v[204:207], v[136:139]
    v_mfma_f32_16x16x32_bf16 v[140:143], v[236:239], v[208:211], v[140:143]
    v_mfma_f32_16x16x32_bf16 v[144:147], v[240:243], v[204:207], v[144:147]
    v_mfma_f32_16x16x32_bf16 v[148:151], v[240:243], v[208:211], v[148:151]
    v_mfma_f32_16x16x32_bf16 v[152:155], v[244:247], v[204:207], v[152:155]
    v_mfma_f32_16x16x32_bf16 v[156:159], v[244:247], v[208:211], v[156:159]
    s_waitcnt lgkmcnt(0)
    v_lshlrev_b32 v15, 16, v12
    v_lshlrev_b32 v255, 16, v252
    v_lshlrev_b32 v14, 16, v12
    v_lshlrev_b32 v254, 16, v252
    v_lshlrev_b32 v13, 16, v12
    v_lshlrev_b32 v253, 16, v252
    v_lshlrev_b32 v12, 16, v12
    v_lshlrev_b32 v252, 16, v252
    v_pk_fma_f32 v[88:89], v[248:249], v[168:169], v[88:89] op_sel_hi:[0,1,1] neg_lo:[1,0,0] neg_hi:[1,0,0]
    v_pk_fma_f32 v[90:91], v[248:249], v[170:171], v[90:91] op_sel_hi:[0,1,1] neg_lo:[1,0,0] neg_hi:[1,0,0]
    v_pk_fma_f32 v[92:93], v[250:251], v[168:169], v[92:93] op_sel_hi:[0,1,1] neg_lo:[1,0,0] neg_hi:[1,0,0]
    v_pk_fma_f32 v[94:95], v[250:251], v[170:171], v[94:95] op_sel_hi:[0,1,1] neg_lo:[1,0,0] neg_hi:[1,0,0]
    v_pk_fma_f32 v[96:97], v[248:249], v[172:173], v[96:97] op_sel_hi:[0,1,1] neg_lo:[1,0,0] neg_hi:[1,0,0]
    v_pk_fma_f32 v[98:99], v[248:249], v[174:175], v[98:99] op_sel_hi:[0,1,1] neg_lo:[1,0,0] neg_hi:[1,0,0]
    v_pk_fma_f32 v[100:101], v[250:251], v[172:173], v[100:101] op_sel_hi:[0,1,1] neg_lo:[1,0,0] neg_hi:[1,0,0]
    v_pk_fma_f32 v[102:103], v[250:251], v[174:175], v[102:103] op_sel_hi:[0,1,1] neg_lo:[1,0,0] neg_hi:[1,0,0]
    v_pk_fma_f32 v[104:105], v[248:249], v[176:177], v[104:105] op_sel_hi:[0,1,1] neg_lo:[1,0,0] neg_hi:[1,0,0]
    v_pk_fma_f32 v[106:107], v[248:249], v[178:179], v[106:107] op_sel_hi:[0,1,1] neg_lo:[1,0,0] neg_hi:[1,0,0]
    v_pk_fma_f32 v[108:109], v[250:251], v[176:177], v[108:109] op_sel_hi:[0,1,1] neg_lo:[1,0,0] neg_hi:[1,0,0]
    v_pk_fma_f32 v[110:111], v[250:251], v[178:179], v[110:111] op_sel_hi:[0,1,1] neg_lo:[1,0,0] neg_hi:[1,0,0]
    v_pk_fma_f32 v[112:113], v[248:249], v[180:181], v[112:113] op_sel_hi:[0,1,1] neg_lo:[1,0,0] neg_hi:[1,0,0]
    v_pk_fma_f32 v[114:115], v[248:249], v[182:183], v[114:115] op_sel_hi:[0,1,1] neg_lo:[1,0,0] neg_hi:[1,0,0]
    v_pk_fma_f32 v[116:117], v[250:251], v[180:181], v[116:117] op_sel_hi:[0,1,1] neg_lo:[1,0,0] neg_hi:[1,0,0]
    v_pk_fma_f32 v[118:119], v[250:251], v[182:183], v[118:119] op_sel_hi:[0,1,1] neg_lo:[1,0,0] neg_hi:[1,0,0]
    v_pk_fma_f32 v[120:121], v[248:249], v[184:185], v[120:121] op_sel_hi:[0,1,1] neg_lo:[1,0,0] neg_hi:[1,0,0]
    v_pk_fma_f32 v[122:123], v[248:249], v[186:187], v[122:123] op_sel_hi:[0,1,1] neg_lo:[1,0,0] neg_hi:[1,0,0]
    v_pk_fma_f32 v[124:125], v[250:251], v[184:185], v[124:125] op_sel_hi:[0,1,1] neg_lo:[1,0,0] neg_hi:[1,0,0]
    v_pk_fma_f32 v[126:127], v[250:251], v[186:187], v[126:127] op_sel_hi:[0,1,1] neg_lo:[1,0,0] neg_hi:[1,0,0]
    v_pk_fma_f32 v[128:129], v[248:249], v[188:189], v[128:129] op_sel_hi:[0,1,1] neg_lo:[1,0,0] neg_hi:[1,0,0]
    v_pk_fma_f32 v[130:131], v[248:249], v[190:191], v[130:131] op_sel_hi:[0,1,1] neg_lo:[1,0,0] neg_hi:[1,0,0]
    v_pk_fma_f32 v[132:133], v[250:251], v[188:189], v[132:133] op_sel_hi:[0,1,1] neg_lo:[1,0,0] neg_hi:[1,0,0]
    v_pk_fma_f32 v[134:135], v[250:251], v[190:191], v[134:135] op_sel_hi:[0,1,1] neg_lo:[1,0,0] neg_hi:[1,0,0]
    v_pk_fma_f32 v[136:137], v[248:249], v[192:193], v[136:137] op_sel_hi:[0,1,1] neg_lo:[1,0,0] neg_hi:[1,0,0]
    v_pk_fma_f32 v[138:139], v[248:249], v[194:195], v[138:139] op_sel_hi:[0,1,1] neg_lo:[1,0,0] neg_hi:[1,0,0]
    v_pk_fma_f32 v[140:141], v[250:251], v[192:193], v[140:141] op_sel_hi:[0,1,1] neg_lo:[1,0,0] neg_hi:[1,0,0]
    v_pk_fma_f32 v[142:143], v[250:251], v[194:195], v[142:143] op_sel_hi:[0,1,1] neg_lo:[1,0,0] neg_hi:[1,0,0]
    v_pk_fma_f32 v[144:145], v[248:249], v[196:197], v[144:145] op_sel_hi:[0,1,1] neg_lo:[1,0,0] neg_hi:[1,0,0]
    v_pk_fma_f32 v[146:147], v[248:249], v[198:199], v[146:147] op_sel_hi:[0,1,1] neg_lo:[1,0,0] neg_hi:[1,0,0]
    v_pk_fma_f32 v[148:149], v[250:251], v[196:197], v[148:149] op_sel_hi:[0,1,1] neg_lo:[1,0,0] neg_hi:[1,0,0]
    v_pk_fma_f32 v[150:151], v[250:251], v[198:199], v[150:151] op_sel_hi:[0,1,1] neg_lo:[1,0,0] neg_hi:[1,0,0]
    v_pk_fma_f32 v[152:153], v[248:249], v[200:201], v[152:153] op_sel_hi:[0,1,1] neg_lo:[1,0,0] neg_hi:[1,0,0]
    v_pk_fma_f32 v[154:155], v[248:249], v[202:203], v[154:155] op_sel_hi:[0,1,1] neg_lo:[1,0,0] neg_hi:[1,0,0]
    v_pk_fma_f32 v[156:157], v[250:251], v[200:201], v[156:157] op_sel_hi:[0,1,1] neg_lo:[1,0,0] neg_hi:[1,0,0]
    v_pk_fma_f32 v[158:159], v[250:251], v[202:203], v[158:159] op_sel_hi:[0,1,1] neg_lo:[1,0,0] neg_hi:[1,0,0]
    v_pk_mul_f32 v[204:205], v[88:89], v[88:89]
    v_pk_mul_f32 v[206:207], v[90:91], v[90:91]
    v_pk_mul_f32 v[208:209], v[92:93], v[92:93]
    v_pk_mul_f32 v[210:211], v[94:95], v[94:95]
    v_pk_fma_f32 v[204:205], v[204:205], v[4:5], v[4:5] op_sel:[0,1,0] op_sel_hi:[1,1,0]
    v_pk_fma_f32 v[206:207], v[206:207], v[4:5], v[4:5] op_sel:[0,1,0] op_sel_hi:[1,1,0]
    v_pk_fma_f32 v[208:209], v[208:209], v[6:7], v[6:7] op_sel:[0,1,0] op_sel_hi:[1,1,0]
    v_pk_fma_f32 v[210:211], v[210:211], v[6:7], v[6:7] op_sel:[0,1,0] op_sel_hi:[1,1,0]
    v_pk_mul_f32 v[204:205], v[204:205], v[88:89]
    v_pk_mul_f32 v[206:207], v[206:207], v[90:91]
    v_pk_mul_f32 v[208:209], v[208:209], v[92:93]
    v_pk_mul_f32 v[210:211], v[210:211], v[94:95]
    v_exp_f32 v204, v204
    v_exp_f32 v205, v205
    v_exp_f32 v206, v206
    v_exp_f32 v207, v207
    v_exp_f32 v208, v208
    v_exp_f32 v209, v209
    v_exp_f32 v210, v210
    v_exp_f32 v211, v211
    v_pk_fma_f32 v[204:205], v[204:205], v[248:249], v[248:249] op_sel:[0,1,1] op_sel_hi:[1,1,1]
    v_pk_fma_f32 v[206:207], v[206:207], v[248:249], v[248:249] op_sel:[0,1,1] op_sel_hi:[1,1,1]
    v_pk_fma_f32 v[208:209], v[208:209], v[250:251], v[250:251] op_sel:[0,1,1] op_sel_hi:[1,1,1]
    v_pk_fma_f32 v[210:211], v[210:211], v[250:251], v[250:251] op_sel:[0,1,1] op_sel_hi:[1,1,1]
    v_rcp_f32 v204, v204
    v_rcp_f32 v205, v205
    v_rcp_f32 v206, v206
    v_rcp_f32 v207, v207
    v_rcp_f32 v208, v208
    v_rcp_f32 v209, v209
    v_rcp_f32 v210, v210
    v_rcp_f32 v211, v211
    v_pk_mul_f32 v[88:89], v[88:89], v[204:205]
    v_pk_mul_f32 v[90:91], v[90:91], v[206:207]
    v_pk_mul_f32 v[92:93], v[92:93], v[208:209]
    v_pk_mul_f32 v[94:95], v[94:95], v[210:211]
    v_pk_mul_f32 v[212:213], v[96:97], v[96:97]
    v_pk_mul_f32 v[214:215], v[98:99], v[98:99]
    v_pk_mul_f32 v[216:217], v[100:101], v[100:101]
    v_pk_mul_f32 v[218:219], v[102:103], v[102:103]
    v_pk_fma_f32 v[212:213], v[212:213], v[4:5], v[4:5] op_sel:[0,1,0] op_sel_hi:[1,1,0]
    v_pk_fma_f32 v[214:215], v[214:215], v[4:5], v[4:5] op_sel:[0,1,0] op_sel_hi:[1,1,0]
    v_pk_fma_f32 v[216:217], v[216:217], v[6:7], v[6:7] op_sel:[0,1,0] op_sel_hi:[1,1,0]
    v_pk_fma_f32 v[218:219], v[218:219], v[6:7], v[6:7] op_sel:[0,1,0] op_sel_hi:[1,1,0]
    v_pk_mul_f32 v[212:213], v[212:213], v[96:97]
    v_pk_mul_f32 v[214:215], v[214:215], v[98:99]
    v_pk_mul_f32 v[216:217], v[216:217], v[100:101]
    v_pk_mul_f32 v[218:219], v[218:219], v[102:103]
    v_exp_f32 v212, v212
    v_exp_f32 v213, v213
    v_exp_f32 v214, v214
    v_exp_f32 v215, v215
    v_exp_f32 v216, v216
    v_exp_f32 v217, v217
    v_exp_f32 v218, v218
    v_exp_f32 v219, v219
    v_pk_fma_f32 v[212:213], v[212:213], v[248:249], v[248:249] op_sel:[0,1,1] op_sel_hi:[1,1,1]
    v_pk_fma_f32 v[214:215], v[214:215], v[248:249], v[248:249] op_sel:[0,1,1] op_sel_hi:[1,1,1]
    v_pk_fma_f32 v[216:217], v[216:217], v[250:251], v[250:251] op_sel:[0,1,1] op_sel_hi:[1,1,1]
    v_pk_fma_f32 v[218:219], v[218:219], v[250:251], v[250:251] op_sel:[0,1,1] op_sel_hi:[1,1,1]
    v_rcp_f32 v212, v212
    v_rcp_f32 v213, v213
    v_rcp_f32 v214, v214
    v_rcp_f32 v215, v215
    v_rcp_f32 v216, v216
    v_rcp_f32 v217, v217
    v_rcp_f32 v218, v218
    v_rcp_f32 v219, v219
    v_pk_mul_f32 v[96:97], v[96:97], v[212:213]
    v_pk_mul_f32 v[98:99], v[98:99], v[214:215]
    v_pk_mul_f32 v[100:101], v[100:101], v[216:217]
    v_pk_mul_f32 v[102:103], v[102:103], v[218:219]
    v_pk_mul_f32 v[204:205], v[104:105], v[104:105]
    v_pk_mul_f32 v[206:207], v[106:107], v[106:107]
    v_pk_mul_f32 v[208:209], v[108:109], v[108:109]
    v_pk_mul_f32 v[210:211], v[110:111], v[110:111]
    v_pk_fma_f32 v[204:205], v[204:205], v[4:5], v[4:5] op_sel:[0,1,0] op_sel_hi:[1,1,0]
    v_pk_fma_f32 v[206:207], v[206:207], v[4:5], v[4:5] op_sel:[0,1,0] op_sel_hi:[1,1,0]
    v_pk_fma_f32 v[208:209], v[208:209], v[6:7], v[6:7] op_sel:[0,1,0] op_sel_hi:[1,1,0]
    v_pk_fma_f32 v[210:211], v[210:211], v[6:7], v[6:7] op_sel:[0,1,0] op_sel_hi:[1,1,0]
    v_pk_mul_f32 v[204:205], v[204:205], v[104:105]
    v_pk_mul_f32 v[206:207], v[206:207], v[106:107]
    v_pk_mul_f32 v[208:209], v[208:209], v[108:109]
    v_pk_mul_f32 v[210:211], v[210:211], v[110:111]
    v_exp_f32 v204, v204
    v_exp_f32 v205, v205
    v_exp_f32 v206, v206
    v_exp_f32 v207, v207
    v_exp_f32 v208, v208
    v_exp_f32 v209, v209
    v_exp_f32 v210, v210
    v_exp_f32 v211, v211
    v_pk_fma_f32 v[204:205], v[204:205], v[248:249], v[248:249] op_sel:[0,1,1] op_sel_hi:[1,1,1]
    v_pk_fma_f32 v[206:207], v[206:207], v[248:249], v[248:249] op_sel:[0,1,1] op_sel_hi:[1,1,1]
    v_pk_fma_f32 v[208:209], v[208:209], v[250:251], v[250:251] op_sel:[0,1,1] op_sel_hi:[1,1,1]
    v_pk_fma_f32 v[210:211], v[210:211], v[250:251], v[250:251] op_sel:[0,1,1] op_sel_hi:[1,1,1]
    v_rcp_f32 v204, v204
    v_rcp_f32 v205, v205
    v_rcp_f32 v206, v206
    v_rcp_f32 v207, v207
    v_rcp_f32 v208, v208
    v_rcp_f32 v209, v209
    v_rcp_f32 v210, v210
    v_rcp_f32 v211, v211
    v_pk_mul_f32 v[104:105], v[104:105], v[204:205]
    v_pk_mul_f32 v[106:107], v[106:107], v[206:207]
    v_pk_mul_f32 v[108:109], v[108:109], v[208:209]
    v_pk_mul_f32 v[110:111], v[110:111], v[210:211]
    v_pk_mul_f32 v[212:213], v[112:113], v[112:113]
    v_pk_mul_f32 v[214:215], v[114:115], v[114:115]
    v_pk_mul_f32 v[216:217], v[116:117], v[116:117]
    v_pk_mul_f32 v[218:219], v[118:119], v[118:119]
    v_pk_fma_f32 v[212:213], v[212:213], v[4:5], v[4:5] op_sel:[0,1,0] op_sel_hi:[1,1,0]
    v_pk_fma_f32 v[214:215], v[214:215], v[4:5], v[4:5] op_sel:[0,1,0] op_sel_hi:[1,1,0]
    v_pk_fma_f32 v[216:217], v[216:217], v[6:7], v[6:7] op_sel:[0,1,0] op_sel_hi:[1,1,0]
    v_pk_fma_f32 v[218:219], v[218:219], v[6:7], v[6:7] op_sel:[0,1,0] op_sel_hi:[1,1,0]
    v_pk_mul_f32 v[212:213], v[212:213], v[112:113]
    v_pk_mul_f32 v[214:215], v[214:215], v[114:115]
    v_pk_mul_f32 v[216:217], v[216:217], v[116:117]
    v_pk_mul_f32 v[218:219], v[218:219], v[118:119]
    v_exp_f32 v212, v212
    v_exp_f32 v213, v213
    v_exp_f32 v214, v214
    v_exp_f32 v215, v215
    v_exp_f32 v216, v216
    v_exp_f32 v217, v217
    v_exp_f32 v218, v218
    v_exp_f32 v219, v219
    v_pk_fma_f32 v[212:213], v[212:213], v[248:249], v[248:249] op_sel:[0,1,1] op_sel_hi:[1,1,1]
    v_pk_fma_f32 v[214:215], v[214:215], v[248:249], v[248:249] op_sel:[0,1,1] op_sel_hi:[1,1,1]
    v_pk_fma_f32 v[216:217], v[216:217], v[250:251], v[250:251] op_sel:[0,1,1] op_sel_hi:[1,1,1]
    v_pk_fma_f32 v[218:219], v[218:219], v[250:251], v[250:251] op_sel:[0,1,1] op_sel_hi:[1,1,1]
    v_rcp_f32 v212, v212
    v_rcp_f32 v213, v213
    v_rcp_f32 v214, v214
    v_rcp_f32 v215, v215
    v_rcp_f32 v216, v216
    v_rcp_f32 v217, v217
    v_rcp_f32 v218, v218
    v_rcp_f32 v219, v219
    v_pk_mul_f32 v[112:113], v[112:113], v[212:213]
    v_pk_mul_f32 v[114:115], v[114:115], v[214:215]
    v_pk_mul_f32 v[116:117], v[116:117], v[216:217]
    v_pk_mul_f32 v[118:119], v[118:119], v[218:219]
    v_pk_mul_f32 v[204:205], v[120:121], v[120:121]
    v_pk_mul_f32 v[206:207], v[122:123], v[122:123]
    v_pk_mul_f32 v[208:209], v[124:125], v[124:125]
    v_pk_mul_f32 v[210:211], v[126:127], v[126:127]
    v_pk_fma_f32 v[204:205], v[204:205], v[4:5], v[4:5] op_sel:[0,1,0] op_sel_hi:[1,1,0]
    v_pk_fma_f32 v[206:207], v[206:207], v[4:5], v[4:5] op_sel:[0,1,0] op_sel_hi:[1,1,0]
    v_pk_fma_f32 v[208:209], v[208:209], v[6:7], v[6:7] op_sel:[0,1,0] op_sel_hi:[1,1,0]
    v_pk_fma_f32 v[210:211], v[210:211], v[6:7], v[6:7] op_sel:[0,1,0] op_sel_hi:[1,1,0]
    v_pk_mul_f32 v[204:205], v[204:205], v[120:121]
    v_pk_mul_f32 v[206:207], v[206:207], v[122:123]
    v_pk_mul_f32 v[208:209], v[208:209], v[124:125]
    v_pk_mul_f32 v[210:211], v[210:211], v[126:127]
    v_exp_f32 v204, v204
    v_exp_f32 v205, v205
    v_exp_f32 v206, v206
    v_exp_f32 v207, v207
    v_exp_f32 v208, v208
    v_exp_f32 v209, v209
    v_exp_f32 v210, v210
    v_exp_f32 v211, v211
    v_pk_fma_f32 v[204:205], v[204:205], v[248:249], v[248:249] op_sel:[0,1,1] op_sel_hi:[1,1,1]
    v_pk_fma_f32 v[206:207], v[206:207], v[248:249], v[248:249] op_sel:[0,1,1] op_sel_hi:[1,1,1]
    v_pk_fma_f32 v[208:209], v[208:209], v[250:251], v[250:251] op_sel:[0,1,1] op_sel_hi:[1,1,1]
    v_pk_fma_f32 v[210:211], v[210:211], v[250:251], v[250:251] op_sel:[0,1,1] op_sel_hi:[1,1,1]
    v_rcp_f32 v204, v204
    v_rcp_f32 v205, v205
    v_rcp_f32 v206, v206
    v_rcp_f32 v207, v207
    v_rcp_f32 v208, v208
    v_rcp_f32 v209, v209
    v_rcp_f32 v210, v210
    v_rcp_f32 v211, v211
    v_pk_mul_f32 v[120:121], v[120:121], v[204:205]
    v_pk_mul_f32 v[122:123], v[122:123], v[206:207]
    v_pk_mul_f32 v[124:125], v[124:125], v[208:209]
    v_pk_mul_f32 v[126:127], v[126:127], v[210:211]
    v_pk_mul_f32 v[212:213], v[128:129], v[128:129]
    v_pk_mul_f32 v[214:215], v[130:131], v[130:131]
    v_pk_mul_f32 v[216:217], v[132:133], v[132:133]
    v_pk_mul_f32 v[218:219], v[134:135], v[134:135]
    v_pk_fma_f32 v[212:213], v[212:213], v[4:5], v[4:5] op_sel:[0,1,0] op_sel_hi:[1,1,0]
    v_pk_fma_f32 v[214:215], v[214:215], v[4:5], v[4:5] op_sel:[0,1,0] op_sel_hi:[1,1,0]
    v_pk_fma_f32 v[216:217], v[216:217], v[6:7], v[6:7] op_sel:[0,1,0] op_sel_hi:[1,1,0]
    v_pk_fma_f32 v[218:219], v[218:219], v[6:7], v[6:7] op_sel:[0,1,0] op_sel_hi:[1,1,0]
    v_pk_mul_f32 v[212:213], v[212:213], v[128:129]
    v_pk_mul_f32 v[214:215], v[214:215], v[130:131]
    v_pk_mul_f32 v[216:217], v[216:217], v[132:133]
    v_pk_mul_f32 v[218:219], v[218:219], v[134:135]
    v_exp_f32 v212, v212
    v_exp_f32 v213, v213
    v_exp_f32 v214, v214
    v_exp_f32 v215, v215
    v_exp_f32 v216, v216
    v_exp_f32 v217, v217
    v_exp_f32 v218, v218
    v_exp_f32 v219, v219
    v_pk_fma_f32 v[212:213], v[212:213], v[248:249], v[248:249] op_sel:[0,1,1] op_sel_hi:[1,1,1]
    v_pk_fma_f32 v[214:215], v[214:215], v[248:249], v[248:249] op_sel:[0,1,1] op_sel_hi:[1,1,1]
    v_pk_fma_f32 v[216:217], v[216:217], v[250:251], v[250:251] op_sel:[0,1,1] op_sel_hi:[1,1,1]
    v_pk_fma_f32 v[218:219], v[218:219], v[250:251], v[250:251] op_sel:[0,1,1] op_sel_hi:[1,1,1]
    v_rcp_f32 v212, v212
    v_rcp_f32 v213, v213
    v_rcp_f32 v214, v214
    v_rcp_f32 v215, v215
    v_rcp_f32 v216, v216
    v_rcp_f32 v217, v217
    v_rcp_f32 v218, v218
    v_rcp_f32 v219, v219
    v_pk_mul_f32 v[128:129], v[128:129], v[212:213]
    v_pk_mul_f32 v[130:131], v[130:131], v[214:215]
    v_pk_mul_f32 v[132:133], v[132:133], v[216:217]
    v_pk_mul_f32 v[134:135], v[134:135], v[218:219]
    s_barrier
    ds_read_b128 v[160:163], v10 offset:0
    ds_read_b128 v[164:167], v10 offset:2048
    ds_read_b128 v[168:171], v2 offset:0
    ds_read_b128 v[172:175], v2 offset:1024
    ds_read_b128 v[176:179], v2 offset:2048
    ds_read_b128 v[180:183], v2 offset:3072
    ds_read_b128 v[184:187], v2 offset:4096
    ds_read_b128 v[188:191], v2 offset:5120
    ds_read_b128 v[192:195], v2 offset:6144
    ds_read_b128 v[196:199], v2 offset:7168
    ds_read_b128 v[200:203], v2 offset:8192
    v_pk_mul_f32 v[204:205], v[136:137], v[136:137]
    v_pk_mul_f32 v[206:207], v[138:139], v[138:139]
    v_pk_mul_f32 v[208:209], v[140:141], v[140:141]
    v_pk_mul_f32 v[210:211], v[142:143], v[142:143]
    v_pk_fma_f32 v[204:205], v[204:205], v[4:5], v[4:5] op_sel:[0,1,0] op_sel_hi:[1,1,0]
    v_pk_fma_f32 v[206:207], v[206:207], v[4:5], v[4:5] op_sel:[0,1,0] op_sel_hi:[1,1,0]
    v_pk_fma_f32 v[208:209], v[208:209], v[6:7], v[6:7] op_sel:[0,1,0] op_sel_hi:[1,1,0]
    v_pk_fma_f32 v[210:211], v[210:211], v[6:7], v[6:7] op_sel:[0,1,0] op_sel_hi:[1,1,0]
    v_pk_mul_f32 v[204:205], v[204:205], v[136:137]
    v_pk_mul_f32 v[206:207], v[206:207], v[138:139]
    v_pk_mul_f32 v[208:209], v[208:209], v[140:141]
    v_pk_mul_f32 v[210:211], v[210:211], v[142:143]
    v_exp_f32 v204, v204
    v_exp_f32 v205, v205
    v_exp_f32 v206, v206
    v_exp_f32 v207, v207
    v_exp_f32 v208, v208
    v_exp_f32 v209, v209
    v_exp_f32 v210, v210
    v_exp_f32 v211, v211
    v_pk_fma_f32 v[204:205], v[204:205], v[248:249], v[248:249] op_sel:[0,1,1] op_sel_hi:[1,1,1]
    v_pk_fma_f32 v[206:207], v[206:207], v[248:249], v[248:249] op_sel:[0,1,1] op_sel_hi:[1,1,1]
    v_pk_fma_f32 v[208:209], v[208:209], v[250:251], v[250:251] op_sel:[0,1,1] op_sel_hi:[1,1,1]
    v_pk_fma_f32 v[210:211], v[210:211], v[250:251], v[250:251] op_sel:[0,1,1] op_sel_hi:[1,1,1]
    v_rcp_f32 v204, v204
    v_rcp_f32 v205, v205
    v_rcp_f32 v206, v206
    v_rcp_f32 v207, v207
    v_rcp_f32 v208, v208
    v_rcp_f32 v209, v209
    v_rcp_f32 v210, v210
    v_rcp_f32 v211, v211
    v_pk_mul_f32 v[136:137], v[136:137], v[204:205]
    v_pk_mul_f32 v[138:139], v[138:139], v[206:207]
    v_pk_mul_f32 v[140:141], v[140:141], v[208:209]
    v_pk_mul_f32 v[142:143], v[142:143], v[210:211]
    s_waitcnt lgkmcnt(5)
    v_mfma_f32_16x16x32_bf16 v[16:19], v[168:171], v[160:163], v[12:15]
    ds_read_b128 v[204:207], v11 offset:0
    v_mfma_f32_16x16x32_bf16 v[20:23], v[168:171], v[164:167], v[252:255]
    ds_read_b128 v[208:211], v11 offset:2048
    v_mfma_f32_16x16x32_bf16 v[24:27], v[172:175], v[160:163], v[12:15]
    ds_read_b128 v[212:215], v2 offset:9216
    v_mfma_f32_16x16x32_bf16 v[28:31], v[172:175], v[164:167], v[252:255]
    ds_read_b128 v[216:219], v2 offset:10240
    v_mfma_f32_16x16x32_bf16 v[32:35], v[176:179], v[160:163], v[12:15]
    ds_read_b128 v[220:223], v2 offset:11264
    v_mfma_f32_16x16x32_bf16 v[36:39], v[176:179], v[164:167], v[252:255]
    ds_read_b128 v[224:227], v2 offset:12288
    v_mfma_f32_16x16x32_bf16 v[40:43], v[180:183], v[160:163], v[12:15]
    ds_read_b128 v[228:231], v2 offset:13312
    v_mfma_f32_16x16x32_bf16 v[44:47], v[180:183], v[164:167], v[252:255]
    ds_read_b128 v[232:235], v2 offset:14336
    s_waitcnt lgkmcnt(8)
    v_mfma_f32_16x16x32_bf16 v[48:51], v[184:187], v[160:163], v[12:15]
    ds_read_b128 v[236:239], v2 offset:15360
    v_mfma_f32_16x16x32_bf16 v[52:55], v[184:187], v[164:167], v[252:255]
    ds_read_b128 v[240:243], v2 offset:16384
    v_mfma_f32_16x16x32_bf16 v[56:59], v[188:191], v[160:163], v[12:15]
    ds_read_b128 v[244:247], v2 offset:17408
    v_mfma_f32_16x16x32_bf16 v[60:63], v[188:191], v[164:167], v[252:255]
    v_mfma_f32_16x16x32_bf16 v[64:67], v[192:195], v[160:163], v[12:15]
    v_mfma_f32_16x16x32_bf16 v[68:71], v[192:195], v[164:167], v[252:255]
    v_mfma_f32_16x16x32_bf16 v[72:75], v[196:199], v[160:163], v[12:15]
    v_mfma_f32_16x16x32_bf16 v[76:79], v[196:199], v[164:167], v[252:255]
    v_mfma_f32_16x16x32_bf16 v[80:83], v[200:203], v[160:163], v[12:15]
    v_mfma_f32_16x16x32_bf16 v[84:87], v[200:203], v[164:167], v[252:255]
    s_waitcnt lgkmcnt(0)
    s_barrier
    v_mfma_f32_16x16x32_bf16 v[16:19], v[212:215], v[204:207], v[16:19]
    ds_read_b128 v[160:163], v10 offset:36864
    v_mfma_f32_16x16x32_bf16 v[20:23], v[212:215], v[208:211], v[20:23]
    ds_read_b128 v[164:167], v10 offset:38912
    v_mfma_f32_16x16x32_bf16 v[24:27], v[216:219], v[204:207], v[24:27]
    ds_read_b128 v[168:171], v2 offset:36864
    v_mfma_f32_16x16x32_bf16 v[28:31], v[216:219], v[208:211], v[28:31]
    ds_read_b128 v[172:175], v2 offset:37888
    v_mul_f32 v12, v144, v144
    v_mfma_f32_16x16x32_bf16 v[32:35], v[220:223], v[204:207], v[32:35]
    ds_read_b128 v[176:179], v2 offset:38912
    v_mul_f32 v13, v145, v145
    v_mfma_f32_16x16x32_bf16 v[36:39], v[220:223], v[208:211], v[36:39]
    ds_read_b128 v[180:183], v2 offset:39936
    v_mul_f32 v14, v146, v146
    v_mfma_f32_16x16x32_bf16 v[40:43], v[224:227], v[204:207], v[40:43]
    ds_read_b128 v[184:187], v2 offset:40960
    v_mul_f32 v15, v147, v147
    v_mfma_f32_16x16x32_bf16 v[44:47], v[224:227], v[208:211], v[44:47]
    ds_read_b128 v[188:191], v2 offset:41984
    v_mfma_f32_16x16x32_bf16 v[48:51], v[228:231], v[204:207], v[48:51]
    ds_read_b128 v[192:195], v2 offset:43008
    v_mul_f32 v252, v148, v148
    v_mfma_f32_16x16x32_bf16 v[52:55], v[228:231], v[208:211], v[52:55]
    ds_read_b128 v[196:199], v2 offset:44032
    v_mul_f32 v253, v149, v149
    v_mfma_f32_16x16x32_bf16 v[56:59], v[232:235], v[204:207], v[56:59]
    ds_read_b128 v[200:203], v2 offset:45056
    v_mul_f32 v254, v150, v150
    v_mfma_f32_16x16x32_bf16 v[60:63], v[232:235], v[208:211], v[60:63]
    v_mul_f32 v255, v151, v151
    v_fma_f32 v12, v12, v5, v4
    v_mfma_f32_16x16x32_bf16 v[64:67], v[236:239], v[204:207], v[64:67]
    v_fma_f32 v13, v13, v5, v4
    v_fma_f32 v14, v14, v5, v4
    v_mfma_f32_16x16x32_bf16 v[68:71], v[236:239], v[208:211], v[68:71]
    v_fma_f32 v15, v15, v5, v4
    v_fma_f32 v252, v252, v7, v6
    v_mfma_f32_16x16x32_bf16 v[72:75], v[240:243], v[204:207], v[72:75]
    v_fma_f32 v253, v253, v7, v6
    v_fma_f32 v254, v254, v7, v6
    v_mfma_f32_16x16x32_bf16 v[76:79], v[240:243], v[208:211], v[76:79]
    v_fma_f32 v255, v255, v7, v6
    v_mul_f32 v12, v12, v144
    v_mfma_f32_16x16x32_bf16 v[80:83], v[244:247], v[204:207], v[80:83]
    v_mul_f32 v13, v13, v145
    v_mul_f32 v14, v14, v146
    v_mfma_f32_16x16x32_bf16 v[84:87], v[244:247], v[208:211], v[84:87]
    v_mul_f32 v15, v15, v147
    s_waitcnt lgkmcnt(5)
    v_mfma_f32_16x16x32_bf16 v[16:19], v[168:171], v[160:163], v[16:19]
    ds_read_b128 v[204:207], v11 offset:36864
    v_mfma_f32_16x16x32_bf16 v[20:23], v[168:171], v[164:167], v[20:23]
    ds_read_b128 v[208:211], v11 offset:38912
    v_mul_f32 v252, v252, v148
    v_mfma_f32_16x16x32_bf16 v[24:27], v[172:175], v[160:163], v[24:27]
    ds_read_b128 v[212:215], v2 offset:46080
    v_mul_f32 v253, v253, v149
    v_mfma_f32_16x16x32_bf16 v[28:31], v[172:175], v[164:167], v[28:31]
    ds_read_b128 v[216:219], v2 offset:47104
    v_mul_f32 v254, v254, v150
    v_mfma_f32_16x16x32_bf16 v[32:35], v[176:179], v[160:163], v[32:35]
    ds_read_b128 v[220:223], v2 offset:48128
    v_mul_f32 v255, v255, v151
    v_mfma_f32_16x16x32_bf16 v[36:39], v[176:179], v[164:167], v[36:39]
    ds_read_b128 v[224:227], v2 offset:49152
    v_exp_f32 v12, v12
    v_mfma_f32_16x16x32_bf16 v[40:43], v[180:183], v[160:163], v[40:43]
    ds_read_b128 v[228:231], v2 offset:50176
    v_exp_f32 v13, v13
    v_mfma_f32_16x16x32_bf16 v[44:47], v[180:183], v[164:167], v[44:47]
    ds_read_b128 v[232:235], v2 offset:51200
    s_waitcnt lgkmcnt(8)
    v_mfma_f32_16x16x32_bf16 v[48:51], v[184:187], v[160:163], v[48:51]
    ds_read_b128 v[236:239], v2 offset:52224
    v_exp_f32 v14, v14
    v_mfma_f32_16x16x32_bf16 v[52:55], v[184:187], v[164:167], v[52:55]
    ds_read_b128 v[240:243], v2 offset:53248
    v_exp_f32 v15, v15
    v_mfma_f32_16x16x32_bf16 v[56:59], v[188:191], v[160:163], v[56:59]
    ds_read_b128 v[244:247], v2 offset:54272
    v_exp_f32 v252, v252
    v_mfma_f32_16x16x32_bf16 v[60:63], v[188:191], v[164:167], v[60:63]
    v_exp_f32 v253, v253
    v_mfma_f32_16x16x32_bf16 v[64:67], v[192:195], v[160:163], v[64:67]
    v_exp_f32 v254, v254
    v_mfma_f32_16x16x32_bf16 v[68:71], v[192:195], v[164:167], v[68:71]
    v_exp_f32 v255, v255
    v_mfma_f32_16x16x32_bf16 v[72:75], v[196:199], v[160:163], v[72:75]
    v_fma_f32 v12, v12, v249, v249
    v_fma_f32 v13, v13, v249, v249
    v_mfma_f32_16x16x32_bf16 v[76:79], v[196:199], v[164:167], v[76:79]
    v_fma_f32 v14, v14, v249, v249
    v_fma_f32 v15, v15, v249, v249
    v_mfma_f32_16x16x32_bf16 v[80:83], v[200:203], v[160:163], v[80:83]
    v_fma_f32 v252, v252, v251, v251
    v_fma_f32 v253, v253, v251, v251
    v_mfma_f32_16x16x32_bf16 v[84:87], v[200:203], v[164:167], v[84:87]
    v_fma_f32 v254, v254, v251, v251
    s_waitcnt lgkmcnt(0)
    s_barrier
    v_mfma_f32_16x16x32_bf16 v[16:19], v[212:215], v[204:207], v[16:19]
    ds_read_b128 v[160:163], v8 offset:0
    v_mfma_f32_16x16x32_bf16 v[20:23], v[212:215], v[208:211], v[20:23]
    ds_read_b128 v[164:167], v8 offset:2048
    v_fma_f32 v255, v255, v251, v251
    v_mfma_f32_16x16x32_bf16 v[24:27], v[216:219], v[204:207], v[24:27]
    ds_read_b128 v[168:171], v1 offset:0
    v_rcp_f32 v12, v12
    v_mfma_f32_16x16x32_bf16 v[28:31], v[216:219], v[208:211], v[28:31]
    ds_read_b128 v[172:175], v1 offset:1024
    v_rcp_f32 v13, v13
    v_mfma_f32_16x16x32_bf16 v[32:35], v[220:223], v[204:207], v[32:35]
    ds_read_b128 v[176:179], v1 offset:2048
    v_rcp_f32 v14, v14
    v_mfma_f32_16x16x32_bf16 v[36:39], v[220:223], v[208:211], v[36:39]
    ds_read_b128 v[180:183], v1 offset:3072
    v_rcp_f32 v15, v15
    v_mfma_f32_16x16x32_bf16 v[40:43], v[224:227], v[204:207], v[40:43]
    ds_read_b128 v[184:187], v1 offset:4096
    v_rcp_f32 v252, v252
    v_mfma_f32_16x16x32_bf16 v[44:47], v[224:227], v[208:211], v[44:47]
    ds_read_b128 v[188:191], v1 offset:5120
    v_mfma_f32_16x16x32_bf16 v[48:51], v[228:231], v[204:207], v[48:51]
    ds_read_b128 v[192:195], v1 offset:6144
    v_rcp_f32 v253, v253
    v_mfma_f32_16x16x32_bf16 v[52:55], v[228:231], v[208:211], v[52:55]
    ds_read_b128 v[196:199], v1 offset:7168
    v_rcp_f32 v254, v254
    v_mfma_f32_16x16x32_bf16 v[56:59], v[232:235], v[204:207], v[56:59]
    ds_read_b128 v[200:203], v1 offset:8192
    v_rcp_f32 v255, v255
    v_mfma_f32_16x16x32_bf16 v[60:63], v[232:235], v[208:211], v[60:63]
    v_mul_f32 v144, v144, v12
    v_mul_f32 v145, v145, v13
    v_mfma_f32_16x16x32_bf16 v[64:67], v[236:239], v[204:207], v[64:67]
    v_mul_f32 v146, v146, v14
    v_mul_f32 v147, v147, v15
    v_mfma_f32_16x16x32_bf16 v[68:71], v[236:239], v[208:211], v[68:71]
    v_mul_f32 v148, v148, v252
    v_mul_f32 v149, v149, v253
    v_mfma_f32_16x16x32_bf16 v[72:75], v[240:243], v[204:207], v[72:75]
    v_mul_f32 v150, v150, v254
    v_mul_f32 v151, v151, v255
    v_mfma_f32_16x16x32_bf16 v[76:79], v[240:243], v[208:211], v[76:79]
    v_mul_f32 v12, v152, v152
    v_mul_f32 v13, v153, v153
    v_mfma_f32_16x16x32_bf16 v[80:83], v[244:247], v[204:207], v[80:83]
    v_mul_f32 v14, v154, v154
    v_mul_f32 v15, v155, v155
    v_mfma_f32_16x16x32_bf16 v[84:87], v[244:247], v[208:211], v[84:87]
    v_mul_f32 v252, v156, v156
    s_waitcnt lgkmcnt(5)
    v_mfma_f32_16x16x32_bf16 v[16:19], v[168:171], v[160:163], v[16:19]
    ds_read_b128 v[204:207], v9 offset:0
    v_mfma_f32_16x16x32_bf16 v[20:23], v[168:171], v[164:167], v[20:23]
    ds_read_b128 v[208:211], v9 offset:2048
    v_mul_f32 v253, v157, v157
    v_mfma_f32_16x16x32_bf16 v[24:27], v[172:175], v[160:163], v[24:27]
    ds_read_b128 v[212:215], v1 offset:9216
    v_mul_f32 v254, v158, v158
    v_mfma_f32_16x16x32_bf16 v[28:31], v[172:175], v[164:167], v[28:31]
    ds_read_b128 v[216:219], v1 offset:10240
    v_mul_f32 v255, v159, v159
    v_mfma_f32_16x16x32_bf16 v[32:35], v[176:179], v[160:163], v[32:35]
    ds_read_b128 v[220:223], v1 offset:11264
    v_fma_f32 v12, v12, v5, v4
    v_mfma_f32_16x16x32_bf16 v[36:39], v[176:179], v[164:167], v[36:39]
    ds_read_b128 v[224:227], v1 offset:12288
    v_fma_f32 v13, v13, v5, v4
    v_mfma_f32_16x16x32_bf16 v[40:43], v[180:183], v[160:163], v[40:43]
    ds_read_b128 v[228:231], v1 offset:13312
    v_fma_f32 v14, v14, v5, v4
    v_mfma_f32_16x16x32_bf16 v[44:47], v[180:183], v[164:167], v[44:47]
    ds_read_b128 v[232:235], v1 offset:14336
    s_waitcnt lgkmcnt(8)
    v_mfma_f32_16x16x32_bf16 v[48:51], v[184:187], v[160:163], v[48:51]
    ds_read_b128 v[236:239], v1 offset:15360
    v_fma_f32 v15, v15, v5, v4
    v_mfma_f32_16x16x32_bf16 v[52:55], v[184:187], v[164:167], v[52:55]
    ds_read_b128 v[240:243], v1 offset:16384
    v_fma_f32 v252, v252, v7, v6
    v_mfma_f32_16x16x32_bf16 v[56:59], v[188:191], v[160:163], v[56:59]
    ds_read_b128 v[244:247], v1 offset:17408
    v_fma_f32 v253, v253, v7, v6
    v_mfma_f32_16x16x32_bf16 v[60:63], v[188:191], v[164:167], v[60:63]
    v_fma_f32 v254, v254, v7, v6
    v_fma_f32 v255, v255, v7, v6
    v_mfma_f32_16x16x32_bf16 v[64:67], v[192:195], v[160:163], v[64:67]
    v_mul_f32 v12, v12, v152
    v_mul_f32 v13, v13, v153
    v_mfma_f32_16x16x32_bf16 v[68:71], v[192:195], v[164:167], v[68:71]
    v_mul_f32 v14, v14, v154
    v_mul_f32 v15, v15, v155
    v_mfma_f32_16x16x32_bf16 v[72:75], v[196:199], v[160:163], v[72:75]
    v_mul_f32 v252, v252, v156
    v_mul_f32 v253, v253, v157
    v_mfma_f32_16x16x32_bf16 v[76:79], v[196:199], v[164:167], v[76:79]
    v_mul_f32 v254, v254, v158
    v_mul_f32 v255, v255, v159
    v_mfma_f32_16x16x32_bf16 v[80:83], v[200:203], v[160:163], v[80:83]
    v_exp_f32 v12, v12
    v_mfma_f32_16x16x32_bf16 v[84:87], v[200:203], v[164:167], v[84:87]
    v_exp_f32 v13, v13
    s_waitcnt lgkmcnt(0)
    s_barrier
    v_mfma_f32_16x16x32_bf16 v[16:19], v[212:215], v[204:207], v[16:19]
    ds_read_b128 v[160:163], v8 offset:36864
    v_mfma_f32_16x16x32_bf16 v[20:23], v[212:215], v[208:211], v[20:23]
    ds_read_b128 v[164:167], v8 offset:38912
    v_exp_f32 v14, v14
    v_mfma_f32_16x16x32_bf16 v[24:27], v[216:219], v[204:207], v[24:27]
    ds_read_b128 v[168:171], v1 offset:36864
    v_exp_f32 v15, v15
    v_mfma_f32_16x16x32_bf16 v[28:31], v[216:219], v[208:211], v[28:31]
    ds_read_b128 v[172:175], v1 offset:37888
    v_exp_f32 v252, v252
    v_mfma_f32_16x16x32_bf16 v[32:35], v[220:223], v[204:207], v[32:35]
    ds_read_b128 v[176:179], v1 offset:38912
    v_exp_f32 v253, v253
    v_mfma_f32_16x16x32_bf16 v[36:39], v[220:223], v[208:211], v[36:39]
    ds_read_b128 v[180:183], v1 offset:39936
    v_exp_f32 v254, v254
    v_mfma_f32_16x16x32_bf16 v[40:43], v[224:227], v[204:207], v[40:43]
    ds_read_b128 v[184:187], v1 offset:40960
    v_exp_f32 v255, v255
    v_mfma_f32_16x16x32_bf16 v[44:47], v[224:227], v[208:211], v[44:47]
    ds_read_b128 v[188:191], v1 offset:41984
    v_mfma_f32_16x16x32_bf16 v[48:51], v[228:231], v[204:207], v[48:51]
    ds_read_b128 v[192:195], v1 offset:43008
    v_fma_f32 v12, v12, v249, v249
    v_mfma_f32_16x16x32_bf16 v[52:55], v[228:231], v[208:211], v[52:55]
    ds_read_b128 v[196:199], v1 offset:44032
    v_fma_f32 v13, v13, v249, v249
    v_mfma_f32_16x16x32_bf16 v[56:59], v[232:235], v[204:207], v[56:59]
    ds_read_b128 v[200:203], v1 offset:45056
    v_fma_f32 v14, v14, v249, v249
    v_mfma_f32_16x16x32_bf16 v[60:63], v[232:235], v[208:211], v[60:63]
    v_fma_f32 v15, v15, v249, v249
    v_fma_f32 v252, v252, v251, v251
    v_mfma_f32_16x16x32_bf16 v[64:67], v[236:239], v[204:207], v[64:67]
    v_fma_f32 v253, v253, v251, v251
    v_fma_f32 v254, v254, v251, v251
    v_mfma_f32_16x16x32_bf16 v[68:71], v[236:239], v[208:211], v[68:71]
    v_fma_f32 v255, v255, v251, v251
    v_rcp_f32 v12, v12
    v_mfma_f32_16x16x32_bf16 v[72:75], v[240:243], v[204:207], v[72:75]
    v_rcp_f32 v13, v13
    v_mfma_f32_16x16x32_bf16 v[76:79], v[240:243], v[208:211], v[76:79]
    v_rcp_f32 v14, v14
    v_mfma_f32_16x16x32_bf16 v[80:83], v[244:247], v[204:207], v[80:83]
    v_rcp_f32 v15, v15
    v_mfma_f32_16x16x32_bf16 v[84:87], v[244:247], v[208:211], v[84:87]
    v_rcp_f32 v252, v252
    s_waitcnt lgkmcnt(5)
    v_mfma_f32_16x16x32_bf16 v[16:19], v[168:171], v[160:163], v[16:19]
    ds_read_b128 v[204:207], v9 offset:36864
    v_mfma_f32_16x16x32_bf16 v[20:23], v[168:171], v[164:167], v[20:23]
    ds_read_b128 v[208:211], v9 offset:38912
    v_rcp_f32 v253, v253
    v_mfma_f32_16x16x32_bf16 v[24:27], v[172:175], v[160:163], v[24:27]
    ds_read_b128 v[212:215], v1 offset:46080
    v_rcp_f32 v254, v254
    v_mfma_f32_16x16x32_bf16 v[28:31], v[172:175], v[164:167], v[28:31]
    ds_read_b128 v[216:219], v1 offset:47104
    v_rcp_f32 v255, v255
    v_mfma_f32_16x16x32_bf16 v[32:35], v[176:179], v[160:163], v[32:35]
    ds_read_b128 v[220:223], v1 offset:48128
    v_mul_f32 v152, v152, v12
    v_mfma_f32_16x16x32_bf16 v[36:39], v[176:179], v[164:167], v[36:39]
    ds_read_b128 v[224:227], v1 offset:49152
    v_mul_f32 v153, v153, v13
    v_mfma_f32_16x16x32_bf16 v[40:43], v[180:183], v[160:163], v[40:43]
    ds_read_b128 v[228:231], v1 offset:50176
    v_mul_f32 v154, v154, v14
    v_mfma_f32_16x16x32_bf16 v[44:47], v[180:183], v[164:167], v[44:47]
    ds_read_b128 v[232:235], v1 offset:51200
    s_waitcnt lgkmcnt(8)
    v_mfma_f32_16x16x32_bf16 v[48:51], v[184:187], v[160:163], v[48:51]
    ds_read_b128 v[236:239], v1 offset:52224
    v_mul_f32 v155, v155, v15
    v_mfma_f32_16x16x32_bf16 v[52:55], v[184:187], v[164:167], v[52:55]
    ds_read_b128 v[240:243], v1 offset:53248
    v_mul_f32 v156, v156, v252
    v_mfma_f32_16x16x32_bf16 v[56:59], v[188:191], v[160:163], v[56:59]
    ds_read_b128 v[244:247], v1 offset:54272
    v_mul_f32 v157, v157, v253
    v_mfma_f32_16x16x32_bf16 v[60:63], v[188:191], v[164:167], v[60:63]
    v_mul_f32 v158, v158, v254
    v_mul_f32 v159, v159, v255
    v_mfma_f32_16x16x32_bf16 v[64:67], v[192:195], v[160:163], v[64:67]
    s_mul_i32 s36, s31, 73728
    s_add_u32 s36, s36, s21
    v_mfma_f32_16x16x32_bf16 v[68:71], v[192:195], v[164:167], v[68:71]
    s_lshl_b32 s34, s24, 12
    s_lshl_b32 s35, s24, 9
    v_mfma_f32_16x16x32_bf16 v[72:75], v[196:199], v[160:163], v[72:75]
    s_add_u32 s35, s35, 65536
    v_add_u32 v14, s34, v1
    v_mfma_f32_16x16x32_bf16 v[76:79], v[196:199], v[164:167], v[76:79]
    v_lshrrev_b32 v15, 1, v1
    v_add_u32 v15, s35, v15
    v_mfma_f32_16x16x32_bf16 v[80:83], v[200:203], v[160:163], v[80:83]
    s_add_u32 s39, s36, 0x1200000
    s_add_u32 s40, s36, 0x1212000
    v_mfma_f32_16x16x32_bf16 v[84:87], v[200:203], v[164:167], v[84:87]
    s_waitcnt lgkmcnt(0)
    s_barrier
    v_mfma_f32_16x16x32_bf16 v[16:19], v[212:215], v[204:207], v[16:19]
    ds_read_b128 v[160:163], v10 offset:0
    v_mfma_f32_16x16x32_bf16 v[20:23], v[212:215], v[208:211], v[20:23]
    ds_read_b128 v[164:167], v10 offset:2048
    v_mfma_f32_16x16x32_bf16 v[24:27], v[216:219], v[204:207], v[24:27]
    ds_read_b128 v[168:171], v2 offset:0
    v_mfma_f32_16x16x32_bf16 v[28:31], v[216:219], v[208:211], v[28:31]
    ds_read_b128 v[172:175], v2 offset:1024
    v_mfma_f32_16x16x32_bf16 v[32:35], v[220:223], v[204:207], v[32:35]
    ds_read_b128 v[176:179], v2 offset:2048
    v_mfma_f32_16x16x32_bf16 v[36:39], v[220:223], v[208:211], v[36:39]
    ds_read_b128 v[180:183], v2 offset:3072
    v_mfma_f32_16x16x32_bf16 v[40:43], v[224:227], v[204:207], v[40:43]
    ds_read_b128 v[184:187], v2 offset:4096
    v_mfma_f32_16x16x32_bf16 v[44:47], v[224:227], v[208:211], v[44:47]
    ds_read_b128 v[188:191], v2 offset:5120
    v_mfma_f32_16x16x32_bf16 v[48:51], v[228:231], v[204:207], v[48:51]
    ds_read_b128 v[192:195], v2 offset:6144
    v_mfma_f32_16x16x32_bf16 v[52:55], v[228:231], v[208:211], v[52:55]
    ds_read_b128 v[196:199], v2 offset:7168
    v_mfma_f32_16x16x32_bf16 v[56:59], v[232:235], v[204:207], v[56:59]
    ds_read_b128 v[200:203], v2 offset:8192
    v_mfma_f32_16x16x32_bf16 v[60:63], v[232:235], v[208:211], v[60:63]
    v_mfma_f32_16x16x32_bf16 v[64:67], v[236:239], v[204:207], v[64:67]
    v_mfma_f32_16x16x32_bf16 v[68:71], v[236:239], v[208:211], v[68:71]
    v_mfma_f32_16x16x32_bf16 v[72:75], v[240:243], v[204:207], v[72:75]
    v_mfma_f32_16x16x32_bf16 v[76:79], v[240:243], v[208:211], v[76:79]
    v_mfma_f32_16x16x32_bf16 v[80:83], v[244:247], v[204:207], v[80:83]
    v_mfma_f32_16x16x32_bf16 v[84:87], v[244:247], v[208:211], v[84:87]
    s_mov_b32 s41, 6
    .p2align 6
L_g_loop:
    s_waitcnt lgkmcnt(5)
    v_mfma_f32_16x16x32_bf16 v[16:19], v[168:171], v[160:163], v[16:19]
    ds_read_b128 v[204:207], v11 offset:0
    v_mfma_f32_16x16x32_bf16 v[20:23], v[168:171], v[164:167], v[20:23]
    ds_read_b128 v[208:211], v11 offset:2048
    v_mfma_f32_16x16x32_bf16 v[24:27], v[172:175], v[160:163], v[24:27]
    ds_read_b128 v[212:215], v2 offset:9216
    v_mfma_f32_16x16x32_bf16 v[28:31], v[172:175], v[164:167], v[28:31]
    ds_read_b128 v[216:219], v2 offset:10240
    v_mfma_f32_16x16x32_bf16 v[32:35], v[176:179], v[160:163], v[32:35]
    ds_read_b128 v[220:223], v2 offset:11264
    v_mfma_f32_16x16x32_bf16 v[36:39], v[176:179], v[164:167], v[36:39]
    ds_read_b128 v[224:227], v2 offset:12288
    v_mfma_f32_16x16x32_bf16 v[40:43], v[180:183], v[160:163], v[40:43]
    ds_read_b128 v[228:231], v2 offset:13312
    v_mfma_f32_16x16x32_bf16 v[44:47], v[180:183], v[164:167], v[44:47]
    ds_read_b128 v[232:235], v2 offset:14336
    s_waitcnt lgkmcnt(8)
    v_mfma_f32_16x16x32_bf16 v[48:51], v[184:187], v[160:163], v[48:51]
    ds_read_b128 v[236:239], v2 offset:15360
    v_mfma_f32_16x16x32_bf16 v[52:55], v[184:187], v[164:167], v[52:55]
    ds_read_b128 v[240:243], v2 offset:16384
    v_mfma_f32_16x16x32_bf16 v[56:59], v[188:191], v[160:163], v[56:59]
    ds_read_b128 v[244:247], v2 offset:17408
    v_mfma_f32_16x16x32_bf16 v[60:63], v[188:191], v[164:167], v[60:63]
    v_mfma_f32_16x16x32_bf16 v[64:67], v[192:195], v[160:163], v[64:67]
    v_mfma_f32_16x16x32_bf16 v[68:71], v[192:195], v[164:167], v[68:71]
    v_mfma_f32_16x16x32_bf16 v[72:75], v[196:199], v[160:163], v[72:75]
    v_mfma_f32_16x16x32_bf16 v[76:79], v[196:199], v[164:167], v[76:79]
    v_mfma_f32_16x16x32_bf16 v[80:83], v[200:203], v[160:163], v[80:83]
    v_mfma_f32_16x16x32_bf16 v[84:87], v[200:203], v[164:167], v[84:87]
    s_waitcnt lgkmcnt(0)
    s_barrier
    v_mfma_f32_16x16x32_bf16 v[16:19], v[212:215], v[204:207], v[16:19]
    ds_read_b128 v[160:163], v10 offset:36864
    v_mfma_f32_16x16x32_bf16 v[20:23], v[212:215], v[208:211], v[20:23]
    ds_read_b128 v[164:167], v10 offset:38912
    v_mfma_f32_16x16x32_bf16 v[24:27], v[216:219], v[204:207], v[24:27]
    ds_read_b128 v[168:171], v2 offset:36864
    v_mfma_f32_16x16x32_bf16 v[28:31], v[216:219], v[208:211], v[28:31]
    ds_read_b128 v[172:175], v2 offset:37888
    v_mfma_f32_16x16x32_bf16 v[32:35], v[220:223], v[204:207], v[32:35]
    ds_read_b128 v[176:179], v2 offset:38912
    v_mfma_f32_16x16x32_bf16 v[36:39], v[220:223], v[208:211], v[36:39]
    ds_read_b128 v[180:183], v2 offset:39936
    v_mfma_f32_16x16x32_bf16 v[40:43], v[224:227], v[204:207], v[40:43]
    ds_read_b128 v[184:187], v2 offset:40960
    v_mfma_f32_16x16x32_bf16 v[44:47], v[224:227], v[208:211], v[44:47]
    ds_read_b128 v[188:191], v2 offset:41984
    v_mfma_f32_16x16x32_bf16 v[48:51], v[228:231], v[204:207], v[48:51]
    ds_read_b128 v[192:195], v2 offset:43008
    v_mfma_f32_16x16x32_bf16 v[52:55], v[228:231], v[208:211], v[52:55]
    ds_read_b128 v[196:199], v2 offset:44032
    v_mfma_f32_16x16x32_bf16 v[56:59], v[232:235], v[204:207], v[56:59]
    ds_read_b128 v[200:203], v2 offset:45056
    v_mfma_f32_16x16x32_bf16 v[60:63], v[232:235], v[208:211], v[60:63]
    v_mfma_f32_16x16x32_bf16 v[64:67], v[236:239], v[204:207], v[64:67]
    v_mfma_f32_16x16x32_bf16 v[68:71], v[236:239], v[208:211], v[68:71]
    v_mfma_f32_16x16x32_bf16 v[72:75], v[240:243], v[204:207], v[72:75]
    v_mfma_f32_16x16x32_bf16 v[76:79], v[240:243], v[208:211], v[76:79]
    v_mfma_f32_16x16x32_bf16 v[80:83], v[244:247], v[204:207], v[80:83]
    v_mfma_f32_16x16x32_bf16 v[84:87], v[244:247], v[208:211], v[84:87]
    s_waitcnt lgkmcnt(5)
    v_mfma_f32_16x16x32_bf16 v[16:19], v[168:171], v[160:163], v[16:19]
    ds_read_b128 v[204:207], v11 offset:36864
    v_mfma_f32_16x16x32_bf16 v[20:23], v[168:171], v[164:167], v[20:23]
    ds_read_b128 v[208:211], v11 offset:38912
    v_mfma_f32_16x16x32_bf16 v[24:27], v[172:175], v[160:163], v[24:27]
    ds_read_b128 v[212:215], v2 offset:46080
    v_mfma_f32_16x16x32_bf16 v[28:31], v[172:175], v[164:167], v[28:31]
    ds_read_b128 v[216:219], v2 offset:47104
    v_mfma_f32_16x16x32_bf16 v[32:35], v[176:179], v[160:163], v[32:35]
    ds_read_b128 v[220:223], v2 offset:48128
    v_mfma_f32_16x16x32_bf16 v[36:39], v[176:179], v[164:167], v[36:39]
    ds_read_b128 v[224:227], v2 offset:49152
    v_mfma_f32_16x16x32_bf16 v[40:43], v[180:183], v[160:163], v[40:43]
    ds_read_b128 v[228:231], v2 offset:50176
    v_mfma_f32_16x16x32_bf16 v[44:47], v[180:183], v[164:167], v[44:47]
    ds_read_b128 v[232:235], v2 offset:51200
    s_waitcnt lgkmcnt(8)
    v_mfma_f32_16x16x32_bf16 v[48:51], v[184:187], v[160:163], v[48:51]
    ds_read_b128 v[236:239], v2 offset:52224
    v_mfma_f32_16x16x32_bf16 v[52:55], v[184:187], v[164:167], v[52:55]
    ds_read_b128 v[240:243], v2 offset:53248
    v_mfma_f32_16x16x32_bf16 v[56:59], v[188:191], v[160:163], v[56:59]
    ds_read_b128 v[244:247], v2 offset:54272
    v_mfma_f32_16x16x32_bf16 v[60:63], v[188:191], v[164:167], v[60:63]
    v_mfma_f32_16x16x32_bf16 v[64:67], v[192:195], v[160:163], v[64:67]
    v_mfma_f32_16x16x32_bf16 v[68:71], v[192:195], v[164:167], v[68:71]
    v_mfma_f32_16x16x32_bf16 v[72:75], v[196:199], v[160:163], v[72:75]
    v_mfma_f32_16x16x32_bf16 v[76:79], v[196:199], v[164:167], v[76:79]
    v_mfma_f32_16x16x32_bf16 v[80:83], v[200:203], v[160:163], v[80:83]
    v_mfma_f32_16x16x32_bf16 v[84:87], v[200:203], v[164:167], v[84:87]
    s_waitcnt lgkmcnt(0)
    s_barrier
    v_mfma_f32_16x16x32_bf16 v[16:19], v[212:215], v[204:207], v[16:19]
    ds_read_b128 v[160:163], v8 offset:0
    v_mfma_f32_16x16x32_bf16 v[20:23], v[212:215], v[208:211], v[20:23]
    ds_read_b128 v[164:167], v8 offset:2048
    v_mfma_f32_16x16x32_bf16 v[24:27], v[216:219], v[204:207], v[24:27]
    ds_read_b128 v[168:171], v1 offset:0
    v_mfma_f32_16x16x32_bf16 v[28:31], v[216:219], v[208:211], v[28:31]
    ds_read_b128 v[172:175], v1 offset:1024
    v_mfma_f32_16x16x32_bf16 v[32:35], v[220:223], v[204:207], v[32:35]
    ds_read_b128 v[176:179], v1 offset:2048
    v_mfma_f32_16x16x32_bf16 v[36:39], v[220:223], v[208:211], v[36:39]
    ds_read_b128 v[180:183], v1 offset:3072
    v_mfma_f32_16x16x32_bf16 v[40:43], v[224:227], v[204:207], v[40:43]
    ds_read_b128 v[184:187], v1 offset:4096
    v_mfma_f32_16x16x32_bf16 v[44:47], v[224:227], v[208:211], v[44:47]
    ds_read_b128 v[188:191], v1 offset:5120
    v_mfma_f32_16x16x32_bf16 v[48:51], v[228:231], v[204:207], v[48:51]
    ds_read_b128 v[192:195], v1 offset:6144
    v_mfma_f32_16x16x32_bf16 v[52:55], v[228:231], v[208:211], v[52:55]
    ds_read_b128 v[196:199], v1 offset:7168
    v_mfma_f32_16x16x32_bf16 v[56:59], v[232:235], v[204:207], v[56:59]
    ds_read_b128 v[200:203], v1 offset:8192
    v_mfma_f32_16x16x32_bf16 v[60:63], v[232:235], v[208:211], v[60:63]
    v_mfma_f32_16x16x32_bf16 v[64:67], v[236:239], v[204:207], v[64:67]
    v_mfma_f32_16x16x32_bf16 v[68:71], v[236:239], v[208:211], v[68:71]
    v_mfma_f32_16x16x32_bf16 v[72:75], v[240:243], v[204:207], v[72:75]
    v_mfma_f32_16x16x32_bf16 v[76:79], v[240:243], v[208:211], v[76:79]
    v_mfma_f32_16x16x32_bf16 v[80:83], v[244:247], v[204:207], v[80:83]
    v_mfma_f32_16x16x32_bf16 v[84:87], v[244:247], v[208:211], v[84:87]
    s_waitcnt lgkmcnt(5)
    v_mfma_f32_16x16x32_bf16 v[16:19], v[168:171], v[160:163], v[16:19]
    ds_read_b128 v[204:207], v9 offset:0
    v_mfma_f32_16x16x32_bf16 v[20:23], v[168:171], v[164:167], v[20:23]
    ds_read_b128 v[208:211], v9 offset:2048
    v_mfma_f32_16x16x32_bf16 v[24:27], v[172:175], v[160:163], v[24:27]
    ds_read_b128 v[212:215], v1 offset:9216
    v_mfma_f32_16x16x32_bf16 v[28:31], v[172:175], v[164:167], v[28:31]
    ds_read_b128 v[216:219], v1 offset:10240
    v_mfma_f32_16x16x32_bf16 v[32:35], v[176:179], v[160:163], v[32:35]
    ds_read_b128 v[220:223], v1 offset:11264
    v_mfma_f32_16x16x32_bf16 v[36:39], v[176:179], v[164:167], v[36:39]
    ds_read_b128 v[224:227], v1 offset:12288
    v_mfma_f32_16x16x32_bf16 v[40:43], v[180:183], v[160:163], v[40:43]
    ds_read_b128 v[228:231], v1 offset:13312
    v_mfma_f32_16x16x32_bf16 v[44:47], v[180:183], v[164:167], v[44:47]
    ds_read_b128 v[232:235], v1 offset:14336
    s_waitcnt lgkmcnt(8)
    v_mfma_f32_16x16x32_bf16 v[48:51], v[184:187], v[160:163], v[48:51]
    ds_read_b128 v[236:239], v1 offset:15360
    v_mfma_f32_16x16x32_bf16 v[52:55], v[184:187], v[164:167], v[52:55]
    ds_read_b128 v[240:243], v1 offset:16384
    v_mfma_f32_16x16x32_bf16 v[56:59], v[188:191], v[160:163], v[56:59]
    ds_read_b128 v[244:247], v1 offset:17408
    v_mfma_f32_16x16x32_bf16 v[60:63], v[188:191], v[164:167], v[60:63]
    v_mfma_f32_16x16x32_bf16 v[64:67], v[192:195], v[160:163], v[64:67]
    v_mfma_f32_16x16x32_bf16 v[68:71], v[192:195], v[164:167], v[68:71]
    v_mfma_f32_16x16x32_bf16 v[72:75], v[196:199], v[160:163], v[72:75]
    v_mfma_f32_16x16x32_bf16 v[76:79], v[196:199], v[164:167], v[76:79]
    v_mfma_f32_16x16x32_bf16 v[80:83], v[200:203], v[160:163], v[80:83]
    v_mfma_f32_16x16x32_bf16 v[84:87], v[200:203], v[164:167], v[84:87]
    s_waitcnt lgkmcnt(0)
    s_barrier
    v_mfma_f32_16x16x32_bf16 v[16:19], v[212:215], v[204:207], v[16:19]
    ds_read_b128 v[160:163], v8 offset:36864
    v_mfma_f32_16x16x32_bf16 v[20:23], v[212:215], v[208:211], v[20:23]
    ds_read_b128 v[164:167], v8 offset:38912
    v_mfma_f32_16x16x32_bf16 v[24:27], v[216:219], v[204:207], v[24:27]
    ds_read_b128 v[168:171], v1 offset:36864
    v_mfma_f32_16x16x32_bf16 v[28:31], v[216:219], v[208:211], v[28:31]
    ds_read_b128 v[172:175], v1 offset:37888
    v_mfma_f32_16x16x32_bf16 v[32:35], v[220:223], v[204:207], v[32:35]
    ds_read_b128 v[176:179], v1 offset:38912
    v_mfma_f32_16x16x32_bf16 v[36:39], v[220:223], v[208:211], v[36:39]
    ds_read_b128 v[180:183], v1 offset:39936
    v_mfma_f32_16x16x32_bf16 v[40:43], v[224:227], v[204:207], v[40:43]
    ds_read_b128 v[184:187], v1 offset:40960
    v_mfma_f32_16x16x32_bf16 v[44:47], v[224:227], v[208:211], v[44:47]
    ds_read_b128 v[188:191], v1 offset:41984
    v_mfma_f32_16x16x32_bf16 v[48:51], v[228:231], v[204:207], v[48:51]
    ds_read_b128 v[192:195], v1 offset:43008
    v_mfma_f32_16x16x32_bf16 v[52:55], v[228:231], v[208:211], v[52:55]
    ds_read_b128 v[196:199], v1 offset:44032
    v_mfma_f32_16x16x32_bf16 v[56:59], v[232:235], v[204:207], v[56:59]
    ds_read_b128 v[200:203], v1 offset:45056
    v_mfma_f32_16x16x32_bf16 v[60:63], v[232:235], v[208:211], v[60:63]
    v_mfma_f32_16x16x32_bf16 v[64:67], v[236:239], v[204:207], v[64:67]
    v_mfma_f32_16x16x32_bf16 v[68:71], v[236:239], v[208:211], v[68:71]
    v_mfma_f32_16x16x32_bf16 v[72:75], v[240:243], v[204:207], v[72:75]
    v_mfma_f32_16x16x32_bf16 v[76:79], v[240:243], v[208:211], v[76:79]
    v_mfma_f32_16x16x32_bf16 v[80:83], v[244:247], v[204:207], v[80:83]
    v_mfma_f32_16x16x32_bf16 v[84:87], v[244:247], v[208:211], v[84:87]
    s_waitcnt lgkmcnt(5)
    v_mfma_f32_16x16x32_bf16 v[16:19], v[168:171], v[160:163], v[16:19]
    ds_read_b128 v[204:207], v9 offset:36864
    v_mfma_f32_16x16x32_bf16 v[20:23], v[168:171], v[164:167], v[20:23]
    ds_read_b128 v[208:211], v9 offset:38912
    v_mfma_f32_16x16x32_bf16 v[24:27], v[172:175], v[160:163], v[24:27]
    ds_read_b128 v[212:215], v1 offset:46080
    v_mfma_f32_16x16x32_bf16 v[28:31], v[172:175], v[164:167], v[28:31]
    ds_read_b128 v[216:219], v1 offset:47104
    v_mfma_f32_16x16x32_bf16 v[32:35], v[176:179], v[160:163], v[32:35]
    ds_read_b128 v[220:223], v1 offset:48128
    v_mfma_f32_16x16x32_bf16 v[36:39], v[176:179], v[164:167], v[36:39]
    ds_read_b128 v[224:227], v1 offset:49152
    v_mfma_f32_16x16x32_bf16 v[40:43], v[180:183], v[160:163], v[40:43]
    ds_read_b128 v[228:231], v1 offset:50176
    v_mfma_f32_16x16x32_bf16 v[44:47], v[180:183], v[164:167], v[44:47]
    ds_read_b128 v[232:235], v1 offset:51200
    s_waitcnt lgkmcnt(8)
    v_mfma_f32_16x16x32_bf16 v[48:51], v[184:187], v[160:163], v[48:51]
    ds_read_b128 v[236:239], v1 offset:52224
    v_mfma_f32_16x16x32_bf16 v[52:55], v[184:187], v[164:167], v[52:55]
    ds_read_b128 v[240:243], v1 offset:53248
    v_mfma_f32_16x16x32_bf16 v[56:59], v[188:191], v[160:163], v[56:59]
    ds_read_b128 v[244:247], v1 offset:54272
    v_mfma_f32_16x16x32_bf16 v[60:63], v[188:191], v[164:167], v[60:63]
    v_mfma_f32_16x16x32_bf16 v[64:67], v[192:195], v[160:163], v[64:67]
    v_mfma_f32_16x16x32_bf16 v[68:71], v[192:195], v[164:167], v[68:71]
    v_mfma_f32_16x16x32_bf16 v[72:75], v[196:199], v[160:163], v[72:75]
    v_mfma_f32_16x16x32_bf16 v[76:79], v[196:199], v[164:167], v[76:79]
    v_mfma_f32_16x16x32_bf16 v[80:83], v[200:203], v[160:163], v[80:83]
    v_mfma_f32_16x16x32_bf16 v[84:87], v[200:203], v[164:167], v[84:87]
    s_waitcnt lgkmcnt(0)
    s_barrier
    v_mfma_f32_16x16x32_bf16 v[16:19], v[212:215], v[204:207], v[16:19]
    ds_read_b128 v[160:163], v10 offset:0
    v_mfma_f32_16x16x32_bf16 v[20:23], v[212:215], v[208:211], v[20:23]
    ds_read_b128 v[164:167], v10 offset:2048
    v_mfma_f32_16x16x32_bf16 v[24:27], v[216:219], v[204:207], v[24:27]
    ds_read_b128 v[168:171], v2 offset:0
    v_mfma_f32_16x16x32_bf16 v[28:31], v[216:219], v[208:211], v[28:31]
    ds_read_b128 v[172:175], v2 offset:1024
    v_mfma_f32_16x16x32_bf16 v[32:35], v[220:223], v[204:207], v[32:35]
    ds_read_b128 v[176:179], v2 offset:2048
    v_mfma_f32_16x16x32_bf16 v[36:39], v[220:223], v[208:211], v[36:39]
    ds_read_b128 v[180:183], v2 offset:3072
    v_mfma_f32_16x16x32_bf16 v[40:43], v[224:227], v[204:207], v[40:43]
    ds_read_b128 v[184:187], v2 offset:4096
    v_mfma_f32_16x16x32_bf16 v[44:47], v[224:227], v[208:211], v[44:47]
    ds_read_b128 v[188:191], v2 offset:5120
    v_mfma_f32_16x16x32_bf16 v[48:51], v[228:231], v[204:207], v[48:51]
    ds_read_b128 v[192:195], v2 offset:6144
    v_mfma_f32_16x16x32_bf16 v[52:55], v[228:231], v[208:211], v[52:55]
    ds_read_b128 v[196:199], v2 offset:7168
    v_mfma_f32_16x16x32_bf16 v[56:59], v[232:235], v[204:207], v[56:59]
    ds_read_b128 v[200:203], v2 offset:8192
    v_mfma_f32_16x16x32_bf16 v[60:63], v[232:235], v[208:211], v[60:63]
    v_mfma_f32_16x16x32_bf16 v[64:67], v[236:239], v[204:207], v[64:67]
    v_mfma_f32_16x16x32_bf16 v[68:71], v[236:239], v[208:211], v[68:71]
    v_mfma_f32_16x16x32_bf16 v[72:75], v[240:243], v[204:207], v[72:75]
    v_mfma_f32_16x16x32_bf16 v[76:79], v[240:243], v[208:211], v[76:79]
    v_mfma_f32_16x16x32_bf16 v[80:83], v[244:247], v[204:207], v[80:83]
    s_sub_u32 s41, s41, 1
    v_mfma_f32_16x16x32_bf16 v[84:87], v[244:247], v[208:211], v[84:87]
    s_cmp_lg_u32 s41, 0
    s_cbranch_scc1 L_g_loop
    s_waitcnt lgkmcnt(5)
    v_mfma_f32_16x16x32_bf16 v[16:19], v[168:171], v[160:163], v[16:19]
    ds_read_b128 v[204:207], v11 offset:0
    v_mfma_f32_16x16x32_bf16 v[20:23], v[168:171], v[164:167], v[20:23]
    ds_read_b128 v[208:211], v11 offset:2048
    v_mfma_f32_16x16x32_bf16 v[24:27], v[172:175], v[160:163], v[24:27]
    ds_read_b128 v[212:215], v2 offset:9216
    v_mfma_f32_16x16x32_bf16 v[28:31], v[172:175], v[164:167], v[28:31]
    ds_read_b128 v[216:219], v2 offset:10240
    v_mfma_f32_16x16x32_bf16 v[32:35], v[176:179], v[160:163], v[32:35]
    ds_read_b128 v[220:223], v2 offset:11264
    v_mfma_f32_16x16x32_bf16 v[36:39], v[176:179], v[164:167], v[36:39]
    ds_read_b128 v[224:227], v2 offset:12288
    v_mfma_f32_16x16x32_bf16 v[40:43], v[180:183], v[160:163], v[40:43]
    ds_read_b128 v[228:231], v2 offset:13312
    v_mfma_f32_16x16x32_bf16 v[44:47], v[180:183], v[164:167], v[44:47]
    ds_read_b128 v[232:235], v2 offset:14336
    s_waitcnt lgkmcnt(8)
    v_mfma_f32_16x16x32_bf16 v[48:51], v[184:187], v[160:163], v[48:51]
    ds_read_b128 v[236:239], v2 offset:15360
    v_mfma_f32_16x16x32_bf16 v[52:55], v[184:187], v[164:167], v[52:55]
    ds_read_b128 v[240:243], v2 offset:16384
    v_mfma_f32_16x16x32_bf16 v[56:59], v[188:191], v[160:163], v[56:59]
    ds_read_b128 v[244:247], v2 offset:17408
    v_mfma_f32_16x16x32_bf16 v[60:63], v[188:191], v[164:167], v[60:63]
    v_mfma_f32_16x16x32_bf16 v[64:67], v[192:195], v[160:163], v[64:67]
    v_mfma_f32_16x16x32_bf16 v[68:71], v[192:195], v[164:167], v[68:71]
    v_mfma_f32_16x16x32_bf16 v[72:75], v[196:199], v[160:163], v[72:75]
    v_mfma_f32_16x16x32_bf16 v[76:79], v[196:199], v[164:167], v[76:79]
    v_mfma_f32_16x16x32_bf16 v[80:83], v[200:203], v[160:163], v[80:83]
    v_mfma_f32_16x16x32_bf16 v[84:87], v[200:203], v[164:167], v[84:87]
    s_waitcnt lgkmcnt(0)
    s_barrier
    v_mfma_f32_16x16x32_bf16 v[16:19], v[212:215], v[204:207], v[16:19]
    ds_read_b128 v[160:163], v10 offset:36864
    v_mfma_f32_16x16x32_bf16 v[20:23], v[212:215], v[208:211], v[20:23]
    ds_read_b128 v[164:167], v10 offset:38912
    v_mfma_f32_16x16x32_bf16 v[24:27], v[216:219], v[204:207], v[24:27]
    ds_read_b128 v[168:171], v2 offset:36864
    v_mfma_f32_16x16x32_bf16 v[28:31], v[216:219], v[208:211], v[28:31]
    ds_read_b128 v[172:175], v2 offset:37888
    v_mfma_f32_16x16x32_bf16 v[32:35], v[220:223], v[204:207], v[32:35]
    ds_read_b128 v[176:179], v2 offset:38912
    v_mfma_f32_16x16x32_bf16 v[36:39], v[220:223], v[208:211], v[36:39]
    ds_read_b128 v[180:183], v2 offset:39936
    v_mfma_f32_16x16x32_bf16 v[40:43], v[224:227], v[204:207], v[40:43]
    ds_read_b128 v[184:187], v2 offset:40960
    v_mfma_f32_16x16x32_bf16 v[44:47], v[224:227], v[208:211], v[44:47]
    ds_read_b128 v[188:191], v2 offset:41984
    v_mfma_f32_16x16x32_bf16 v[48:51], v[228:231], v[204:207], v[48:51]
    ds_read_b128 v[192:195], v2 offset:43008
    v_mfma_f32_16x16x32_bf16 v[52:55], v[228:231], v[208:211], v[52:55]
    ds_read_b128 v[196:199], v2 offset:44032
    v_mfma_f32_16x16x32_bf16 v[56:59], v[232:235], v[204:207], v[56:59]
    ds_read_b128 v[200:203], v2 offset:45056
    v_mfma_f32_16x16x32_bf16 v[60:63], v[232:235], v[208:211], v[60:63]
    v_mfma_f32_16x16x32_bf16 v[64:67], v[236:239], v[204:207], v[64:67]
    v_mfma_f32_16x16x32_bf16 v[68:71], v[236:239], v[208:211], v[68:71]
    v_mfma_f32_16x16x32_bf16 v[72:75], v[240:243], v[204:207], v[72:75]
    v_mfma_f32_16x16x32_bf16 v[76:79], v[240:243], v[208:211], v[76:79]
    v_mfma_f32_16x16x32_bf16 v[80:83], v[244:247], v[204:207], v[80:83]
    v_mfma_f32_16x16x32_bf16 v[84:87], v[244:247], v[208:211], v[84:87]
    s_waitcnt lgkmcnt(5)
    v_mfma_f32_16x16x32_bf16 v[16:19], v[168:171], v[160:163], v[16:19]
    ds_read_b128 v[204:207], v11 offset:36864
    v_mfma_f32_16x16x32_bf16 v[20:23], v[168:171], v[164:167], v[20:23]
    ds_read_b128 v[208:211], v11 offset:38912
    v_mfma_f32_16x16x32_bf16 v[24:27], v[172:175], v[160:163], v[24:27]
    ds_read_b128 v[212:215], v2 offset:46080
    v_mfma_f32_16x16x32_bf16 v[28:31], v[172:175], v[164:167], v[28:31]
    ds_read_b128 v[216:219], v2 offset:47104
    v_mfma_f32_16x16x32_bf16 v[32:35], v[176:179], v[160:163], v[32:35]
    ds_read_b128 v[220:223], v2 offset:48128
    v_mfma_f32_16x16x32_bf16 v[36:39], v[176:179], v[164:167], v[36:39]
    ds_read_b128 v[224:227], v2 offset:49152
    v_mfma_f32_16x16x32_bf16 v[40:43], v[180:183], v[160:163], v[40:43]
    ds_read_b128 v[228:231], v2 offset:50176
    v_mfma_f32_16x16x32_bf16 v[44:47], v[180:183], v[164:167], v[44:47]
    ds_read_b128 v[232:235], v2 offset:51200
    s_waitcnt lgkmcnt(8)
    v_mfma_f32_16x16x32_bf16 v[48:51], v[184:187], v[160:163], v[48:51]
    ds_read_b128 v[236:239], v2 offset:52224
    v_mfma_f32_16x16x32_bf16 v[52:55], v[184:187], v[164:167], v[52:55]
    ds_read_b128 v[240:243], v2 offset:53248
    v_mfma_f32_16x16x32_bf16 v[56:59], v[188:191], v[160:163], v[56:59]
    ds_read_b128 v[244:247], v2 offset:54272
    v_mfma_f32_16x16x32_bf16 v[60:63], v[188:191], v[164:167], v[60:63]
    v_mfma_f32_16x16x32_bf16 v[64:67], v[192:195], v[160:163], v[64:67]
    v_mfma_f32_16x16x32_bf16 v[68:71], v[192:195], v[164:167], v[68:71]
    v_mfma_f32_16x16x32_bf16 v[72:75], v[196:199], v[160:163], v[72:75]
    v_mfma_f32_16x16x32_bf16 v[76:79], v[196:199], v[164:167], v[76:79]
    v_mfma_f32_16x16x32_bf16 v[80:83], v[200:203], v[160:163], v[80:83]
    v_mfma_f32_16x16x32_bf16 v[84:87], v[200:203], v[164:167], v[84:87]
    s_waitcnt lgkmcnt(0)
    s_barrier
    v_mfma_f32_16x16x32_bf16 v[16:19], v[212:215], v[204:207], v[16:19]
    ds_read_b128 v[160:163], v8 offset:0
    v_mfma_f32_16x16x32_bf16 v[20:23], v[212:215], v[208:211], v[20:23]
    ds_read_b128 v[164:167], v8 offset:2048
    v_mfma_f32_16x16x32_bf16 v[24:27], v[216:219], v[204:207], v[24:27]
    ds_read_b128 v[192:195], v1 offset:0
    v_mfma_f32_16x16x32_bf16 v[28:31], v[216:219], v[208:211], v[28:31]
    ds_read_b128 v[168:171], v9 offset:0
    v_mfma_f32_16x16x32_bf16 v[32:35], v[220:223], v[204:207], v[32:35]
    ds_read_b128 v[172:175], v9 offset:2048
    v_mfma_f32_16x16x32_bf16 v[36:39], v[220:223], v[208:211], v[36:39]
    ds_read_b128 v[176:179], v8 offset:36864
    v_mfma_f32_16x16x32_bf16 v[40:43], v[224:227], v[204:207], v[40:43]
    ds_read_b128 v[180:183], v8 offset:38912
    v_mfma_f32_16x16x32_bf16 v[44:47], v[224:227], v[208:211], v[44:47]
    ds_read_b128 v[184:187], v9 offset:36864
    v_mfma_f32_16x16x32_bf16 v[48:51], v[228:231], v[204:207], v[48:51]
    ds_read_b128 v[188:191], v9 offset:38912
    v_mfma_f32_16x16x32_bf16 v[52:55], v[228:231], v[208:211], v[52:55]
    ds_read_b128 v[196:199], v1 offset:9216
    v_mfma_f32_16x16x32_bf16 v[56:59], v[232:235], v[204:207], v[56:59]
    ds_read_b128 v[200:203], v1 offset:36864
    v_mfma_f32_16x16x32_bf16 v[60:63], v[232:235], v[208:211], v[60:63]
    v_mfma_f32_16x16x32_bf16 v[64:67], v[236:239], v[204:207], v[64:67]
    v_mfma_f32_16x16x32_bf16 v[68:71], v[236:239], v[208:211], v[68:71]
    v_mfma_f32_16x16x32_bf16 v[72:75], v[240:243], v[204:207], v[72:75]
    v_mfma_f32_16x16x32_bf16 v[76:79], v[240:243], v[208:211], v[76:79]
    v_mfma_f32_16x16x32_bf16 v[80:83], v[244:247], v[204:207], v[80:83]
    v_mfma_f32_16x16x32_bf16 v[84:87], v[244:247], v[208:211], v[84:87]
    s_waitcnt lgkmcnt(0)
    v_mfma_f32_16x16x32_bf16 v[16:19], v[192:195], v[160:163], v[16:19]
    ds_read_b128 v[204:207], v1 offset:46080
    v_mfma_f32_16x16x32_bf16 v[20:23], v[192:195], v[164:167], v[20:23]
    ds_read_b128 v[208:211], v1 offset:1024
    s_waitcnt lgkmcnt(3)
    v_mfma_f32_16x16x32_bf16 v[16:19], v[196:199], v[168:171], v[16:19]
    ds_read_b128 v[212:215], v1 offset:10240
    v_mfma_f32_16x16x32_bf16 v[20:23], v[196:199], v[172:175], v[20:23]
    ds_read_b128 v[216:219], v1 offset:37888
    s_waitcnt lgkmcnt(4)
    v_mfma_f32_16x16x32_bf16 v[16:19], v[200:203], v[176:179], v[16:19]
    ds_read_b128 v[220:223], v1 offset:47104
    v_mfma_f32_16x16x32_bf16 v[20:23], v[200:203], v[180:183], v[20:23]
    ds_read_b128 v[224:227], v1 offset:2048
    s_waitcnt lgkmcnt(5)
    v_mfma_f32_16x16x32_bf16 v[16:19], v[204:207], v[184:187], v[16:19]
    ds_read_b128 v[228:231], v1 offset:11264
    v_mfma_f32_16x16x32_bf16 v[20:23], v[204:207], v[188:191], v[20:23]
    ds_read_b128 v[232:235], v1 offset:38912
    s_waitcnt lgkmcnt(6)
    v_mfma_f32_16x16x32_bf16 v[24:27], v[208:211], v[160:163], v[24:27]
    ds_read_b128 v[236:239], v1 offset:48128
    v_mfma_f32_16x16x32_bf16 v[28:31], v[208:211], v[164:167], v[28:31]
    ds_read_b128 v[240:243], v1 offset:3072
    s_waitcnt lgkmcnt(7)
    v_mfma_f32_16x16x32_bf16 v[24:27], v[212:215], v[168:171], v[24:27]
    ds_read_b128 v[244:247], v1 offset:12288
    v_mfma_f32_16x16x32_bf16 v[28:31], v[212:215], v[172:175], v[28:31]
    s_waitcnt lgkmcnt(7)
    v_mfma_f32_16x16x32_bf16 v[24:27], v[216:219], v[176:179], v[24:27]
    ds_read_b128 v[192:195], v1 offset:39936
    v_mul_f32 v16, v16, v88
    v_mfma_f32_16x16x32_bf16 v[28:31], v[216:219], v[180:183], v[28:31]
    v_mul_f32 v17, v17, v89
    v_mul_f32 v18, v18, v90
    s_waitcnt lgkmcnt(7)
    v_mfma_f32_16x16x32_bf16 v[24:27], v[220:223], v[184:187], v[24:27]
    ds_read_b128 v[196:199], v1 offset:49152
    v_mul_f32 v19, v19, v91
    v_mfma_f32_16x16x32_bf16 v[28:31], v[220:223], v[188:191], v[28:31]
    v_cvt_pk_bf16_f32 v88, v16, v17
    v_cvt_pk_bf16_f32 v89, v18, v19
    s_waitcnt lgkmcnt(7)
    v_mfma_f32_16x16x32_bf16 v[32:35], v[224:227], v[160:163], v[32:35]
    ds_read_b128 v[200:203], v1 offset:4096
    v_mul_f32 v20, v20, v92
    v_mfma_f32_16x16x32_bf16 v[36:39], v[224:227], v[164:167], v[36:39]
    v_mul_f32 v21, v21, v93
    v_mul_f32 v22, v22, v94
    s_waitcnt lgkmcnt(7)
    v_mfma_f32_16x16x32_bf16 v[32:35], v[228:231], v[168:171], v[32:35]
    ds_read_b128 v[204:207], v1 offset:13312
    v_mul_f32 v23, v23, v95
    v_mfma_f32_16x16x32_bf16 v[36:39], v[228:231], v[172:175], v[36:39]
    v_cvt_pk_bf16_f32 v92, v20, v21
    v_cvt_pk_bf16_f32 v93, v22, v23
    s_waitcnt lgkmcnt(7)
    v_mfma_f32_16x16x32_bf16 v[32:35], v[232:235], v[176:179], v[32:35]
    ds_read_b128 v[208:211], v1 offset:40960
    v_mul_f32 v24, v24, v96
    v_mfma_f32_16x16x32_bf16 v[36:39], v[232:235], v[180:183], v[36:39]
    v_mul_f32 v25, v25, v97
    v_mul_f32 v26, v26, v98
    v_mul_f32 v27, v27, v99
    s_waitcnt lgkmcnt(7)
    v_mfma_f32_16x16x32_bf16 v[32:35], v[236:239], v[184:187], v[32:35]
    ds_read_b128 v[212:215], v1 offset:50176
    v_cvt_pk_bf16_f32 v90, v24, v25
    v_mfma_f32_16x16x32_bf16 v[36:39], v[236:239], v[188:191], v[36:39]
    v_cvt_pk_bf16_f32 v91, v26, v27
    buffer_store_dwordx4 v[88:91], v14, s[4:7], s39 offen offset:0 sc1
    s_waitcnt lgkmcnt(7)
    v_mfma_f32_16x16x32_bf16 v[40:43], v[240:243], v[160:163], v[40:43]
    ds_read_b128 v[216:219], v1 offset:5120
    v_mul_f32 v28, v28, v100
    v_mfma_f32_16x16x32_bf16 v[44:47], v[240:243], v[164:167], v[44:47]
    v_mul_f32 v29, v29, v101
    v_mul_f32 v30, v30, v102
    s_waitcnt lgkmcnt(7)
    v_mfma_f32_16x16x32_bf16 v[40:43], v[244:247], v[168:171], v[40:43]
    ds_read_b128 v[220:223], v1 offset:14336
    v_mul_f32 v31, v31, v103
    v_mfma_f32_16x16x32_bf16 v[44:47], v[244:247], v[172:175], v[44:47]
    v_cvt_pk_bf16_f32 v94, v28, v29
    v_cvt_pk_bf16_f32 v95, v30, v31
    s_waitcnt lgkmcnt(7)
    v_mfma_f32_16x16x32_bf16 v[40:43], v[192:195], v[176:179], v[40:43]
    ds_read_b128 v[224:227], v1 offset:41984
    buffer_store_dwordx4 v[92:95], v14, s[4:7], s40 offen offset:0 sc1
    v_mfma_f32_16x16x32_bf16 v[44:47], v[192:195], v[180:183], v[44:47]
    v_mul_f32 v32, v32, v104
    v_mul_f32 v33, v33, v105
    v_mul_f32 v34, v34, v106
    s_waitcnt lgkmcnt(7)
    v_mfma_f32_16x16x32_bf16 v[40:43], v[196:199], v[184:187], v[40:43]
    ds_read_b128 v[228:231], v1 offset:51200
    v_mul_f32 v35, v35, v107
    v_mfma_f32_16x16x32_bf16 v[44:47], v[196:199], v[188:191], v[44:47]
    v_cvt_pk_bf16_f32 v104, v32, v33
    v_cvt_pk_bf16_f32 v105, v34, v35
    s_waitcnt lgkmcnt(7)
    v_mfma_f32_16x16x32_bf16 v[48:51], v[200:203], v[160:163], v[48:51]
    ds_read_b128 v[232:235], v1 offset:6144
    v_mul_f32 v36, v36, v108
    v_mfma_f32_16x16x32_bf16 v[52:55], v[200:203], v[164:167], v[52:55]
    v_mul_f32 v37, v37, v109
    v_mul_f32 v38, v38, v110
    s_waitcnt lgkmcnt(7)
    v_mfma_f32_16x16x32_bf16 v[48:51], v[204:207], v[168:171], v[48:51]
    ds_read_b128 v[236:239], v1 offset:15360
    v_mul_f32 v39, v39, v111
    v_mfma_f32_16x16x32_bf16 v[52:55], v[204:207], v[172:175], v[52:55]
    v_cvt_pk_bf16_f32 v108, v36, v37
    v_cvt_pk_bf16_f32 v109, v38, v39
    s_waitcnt lgkmcnt(7)
    v_mfma_f32_16x16x32_bf16 v[48:51], v[208:211], v[176:179], v[48:51]
    ds_read_b128 v[240:243], v1 offset:43008
    v_mul_f32 v40, v40, v112
    v_mfma_f32_16x16x32_bf16 v[52:55], v[208:211], v[180:183], v[52:55]
    v_mul_f32 v41, v41, v113
    v_mul_f32 v42, v42, v114
    v_mul_f32 v43, v43, v115
    s_waitcnt lgkmcnt(7)
    v_mfma_f32_16x16x32_bf16 v[48:51], v[212:215], v[184:187], v[48:51]
    ds_read_b128 v[244:247], v1 offset:52224
    v_cvt_pk_bf16_f32 v106, v40, v41
    v_mfma_f32_16x16x32_bf16 v[52:55], v[212:215], v[188:191], v[52:55]
    v_cvt_pk_bf16_f32 v107, v42, v43
    buffer_store_dwordx4 v[104:107], v14, s[4:7], s39 offen offset:1024 sc1
    s_waitcnt lgkmcnt(7)
    v_mfma_f32_16x16x32_bf16 v[56:59], v[216:219], v[160:163], v[56:59]
    ds_read_b128 v[192:195], v1 offset:7168
    v_mul_f32 v44, v44, v116
    v_mfma_f32_16x16x32_bf16 v[60:63], v[216:219], v[164:167], v[60:63]
    v_mul_f32 v45, v45, v117
    v_mul_f32 v46, v46, v118
    s_waitcnt lgkmcnt(7)
    v_mfma_f32_16x16x32_bf16 v[56:59], v[220:223], v[168:171], v[56:59]
    ds_read_b128 v[196:199], v1 offset:16384
    v_mul_f32 v47, v47, v119
    v_mfma_f32_16x16x32_bf16 v[60:63], v[220:223], v[172:175], v[60:63]
    v_cvt_pk_bf16_f32 v110, v44, v45
    v_cvt_pk_bf16_f32 v111, v46, v47
    s_waitcnt lgkmcnt(7)
    v_mfma_f32_16x16x32_bf16 v[56:59], v[224:227], v[176:179], v[56:59]
    ds_read_b128 v[200:203], v1 offset:44032
    buffer_store_dwordx4 v[108:111], v14, s[4:7], s40 offen offset:1024 sc1
    v_mfma_f32_16x16x32_bf16 v[60:63], v[224:227], v[180:183], v[60:63]
    v_mul_f32 v48, v48, v120
    v_mul_f32 v49, v49, v121
    v_mul_f32 v50, v50, v122
    s_waitcnt lgkmcnt(7)
    v_mfma_f32_16x16x32_bf16 v[56:59], v[228:231], v[184:187], v[56:59]
    ds_read_b128 v[204:207], v1 offset:53248
    v_mul_f32 v51, v51, v123
    v_mfma_f32_16x16x32_bf16 v[60:63], v[228:231], v[188:191], v[60:63]
    v_cvt_pk_bf16_f32 v120, v48, v49
    v_cvt_pk_bf16_f32 v121, v50, v51
    s_waitcnt lgkmcnt(7)
    v_mfma_f32_16x16x32_bf16 v[64:67], v[232:235], v[160:163], v[64:67]
    ds_read_b128 v[208:211], v1 offset:8192
    v_mul_f32 v52, v52, v124
    v_mfma_f32_16x16x32_bf16 v[68:71], v[232:235], v[164:167], v[68:71]
    v_mul_f32 v53, v53, v125
    v_mul_f32 v54, v54, v126
    s_waitcnt lgkmcnt(7)
    v_mfma_f32_16x16x32_bf16 v[64:67], v[236:239], v[168:171], v[64:67]
    ds_read_b128 v[212:215], v1 offset:17408
    v_mul_f32 v55, v55, v127
    v_mfma_f32_16x16x32_bf16 v[68:71], v[236:239], v[172:175], v[68:71]
    v_cvt_pk_bf16_f32 v124, v52, v53
    v_cvt_pk_bf16_f32 v125, v54, v55
    s_waitcnt lgkmcnt(7)
    v_mfma_f32_16x16x32_bf16 v[64:67], v[240:243], v[176:179], v[64:67]
    ds_read_b128 v[216:219], v1 offset:45056
    v_mul_f32 v56, v56, v128
    v_mfma_f32_16x16x32_bf16 v[68:71], v[240:243], v[180:183], v[68:71]
    v_mul_f32 v57, v57, v129
    v_mul_f32 v58, v58, v130
    v_mul_f32 v59, v59, v131
    s_waitcnt lgkmcnt(7)
    v_mfma_f32_16x16x32_bf16 v[64:67], v[244:247], v[184:187], v[64:67]
    ds_read_b128 v[220:223], v1 offset:54272
    v_cvt_pk_bf16_f32 v122, v56, v57
    v_mfma_f32_16x16x32_bf16 v[68:71], v[244:247], v[188:191], v[68:71]
    v_cvt_pk_bf16_f32 v123, v58, v59
    buffer_store_dwordx4 v[120:123], v14, s[4:7], s39 offen offset:2048 sc1
    s_waitcnt lgkmcnt(7)
    v_mfma_f32_16x16x32_bf16 v[72:75], v[192:195], v[160:163], v[72:75]
    v_mul_f32 v60, v60, v132
    v_mul_f32 v61, v61, v133
    v_mfma_f32_16x16x32_bf16 v[76:79], v[192:195], v[164:167], v[76:79]
    v_mul_f32 v62, v62, v134
    v_mul_f32 v63, v63, v135
    s_waitcnt lgkmcnt(6)
    v_mfma_f32_16x16x32_bf16 v[72:75], v[196:199], v[168:171], v[72:75]
    v_cvt_pk_bf16_f32 v126, v60, v61
    v_cvt_pk_bf16_f32 v127, v62, v63
    v_mfma_f32_16x16x32_bf16 v[76:79], v[196:199], v[172:175], v[76:79]
    buffer_store_dwordx4 v[124:127], v14, s[4:7], s40 offen offset:2048 sc1
    s_waitcnt lgkmcnt(5)
    v_mfma_f32_16x16x32_bf16 v[72:75], v[200:203], v[176:179], v[72:75]
    v_mul_f32 v64, v64, v136
    v_mul_f32 v65, v65, v137
    v_mfma_f32_16x16x32_bf16 v[76:79], v[200:203], v[180:183], v[76:79]
    v_mul_f32 v66, v66, v138
    v_mul_f32 v67, v67, v139
    s_waitcnt lgkmcnt(4)
    v_mfma_f32_16x16x32_bf16 v[72:75], v[204:207], v[184:187], v[72:75]
    v_cvt_pk_bf16_f32 v136, v64, v65
    v_cvt_pk_bf16_f32 v137, v66, v67
    v_mfma_f32_16x16x32_bf16 v[76:79], v[204:207], v[188:191], v[76:79]
    v_mul_f32 v68, v68, v140
    v_mul_f32 v69, v69, v141
    s_waitcnt lgkmcnt(3)
    v_mfma_f32_16x16x32_bf16 v[80:83], v[208:211], v[160:163], v[80:83]
    v_mul_f32 v70, v70, v142
    v_mul_f32 v71, v71, v143
    v_mfma_f32_16x16x32_bf16 v[84:87], v[208:211], v[164:167], v[84:87]
    v_cvt_pk_bf16_f32 v140, v68, v69
    v_cvt_pk_bf16_f32 v141, v70, v71
    s_waitcnt lgkmcnt(2)
    v_mfma_f32_16x16x32_bf16 v[80:83], v[212:215], v[168:171], v[80:83]
    v_mfma_f32_16x16x32_bf16 v[84:87], v[212:215], v[172:175], v[84:87]
    s_waitcnt lgkmcnt(1)
    v_mfma_f32_16x16x32_bf16 v[80:83], v[216:219], v[176:179], v[80:83]
    v_mul_f32 v72, v72, v144
    v_mul_f32 v73, v73, v145
    v_mfma_f32_16x16x32_bf16 v[84:87], v[216:219], v[180:183], v[84:87]
    v_mul_f32 v74, v74, v146
    v_mul_f32 v75, v75, v147
    v_cvt_pk_bf16_f32 v138, v72, v73
    s_waitcnt lgkmcnt(0)
    v_mfma_f32_16x16x32_bf16 v[80:83], v[220:223], v[184:187], v[80:83]
    v_cvt_pk_bf16_f32 v139, v74, v75
    buffer_store_dwordx4 v[136:139], v14, s[4:7], s39 offen offset:3072 sc1
    v_mfma_f32_16x16x32_bf16 v[84:87], v[220:223], v[188:191], v[84:87]
    v_mul_f32 v76, v76, v148
    v_mul_f32 v77, v77, v149
    v_mul_f32 v78, v78, v150
    v_mul_f32 v79, v79, v151
    v_cvt_pk_bf16_f32 v142, v76, v77
    v_cvt_pk_bf16_f32 v143, v78, v79
    buffer_store_dwordx4 v[140:143], v14, s[4:7], s40 offen offset:3072 sc1
    s_nop 1
    v_mul_f32 v80, v80, v152
    v_mul_f32 v81, v81, v153
    v_mul_f32 v82, v82, v154
    v_mul_f32 v83, v83, v155
    v_cvt_pk_bf16_f32 v152, v80, v81
    v_cvt_pk_bf16_f32 v153, v82, v83
    buffer_store_dwordx2 v[152:153], v15, s[4:7], s39 offen sc1
    v_mul_f32 v84, v84, v156
    v_mul_f32 v85, v85, v157
    v_mul_f32 v86, v86, v158
    v_mul_f32 v87, v87, v159
    v_cvt_pk_bf16_f32 v156, v84, v85
    v_cvt_pk_bf16_f32 v157, v86, v87
    buffer_store_dwordx2 v[156:157], v15, s[4:7], s40 offen sc1
    s_barrier
    s_and_b32 s25, s2, 7
    s_lshr_b32 s26, s2, 3
    s_lshr_b32 s23, s25, 1
    s_lshl_b32 s23, s23, 3
    s_lshr_b32 s27, s26, 2
    s_add_u32 s23, s23, s27
    s_and_b32 s24, s25, 1
    s_lshl_b32 s24, s24, 2
    s_and_b32 s27, s26, 3
    s_add_u32 s24, s24, s27
    s_add_u32 s25, s23, s24
    s_and_b32 s25, s25, 3
    s_lshl_b32 s30, s23, 2
    s_add_u32 s30, s30, s20
    s_mul_i32 s29, s30, 73728
    s_add_u32 s29, s29, s21
    s_add_u32 s29, s29, 0x1200000
    s_mul_i32 s34, s30, 18432
    s_add_u32 s34, s34, s21
    s_add_u32 s34, s34, 0x300000
    s_lshl_b32 s35, s24, 11
    s_lshr_b32 s36, s24, 2
    s_lshl_b32 s36, s36, 10
    s_and_b32 s37, s24, 3
    s_lshl_b32 s37, s37, 8
    s_add_u32 s36, s36, s37
    s_add_u32 s36, s36, 16384
    v_bfe_u32 v2, v1, 4, 4
    v_lshrrev_b32 v3, 8, v1
    v_add_u32 v4, s35, v1
    v_lshlrev_b32 v5, 4, v2
    v_lshl_add_u32 v5, v3, 3, v5
    v_add_u32 v5, s36, v5
    v_cmp_gt_u32 s[40:41], 2, v3
    v_bfrev_b32 v6, 1
    v_add_u32 v12, 0, v1
    v_add_u32 v13, 36864, v1
    v_add_u32 v14, 73728, v1
    v_add_u32 v15, 110592, v1
    v_cndmask_b32 v5, v6, v5, s[40:41]
    buffer_load_dwordx4 v[208:211], v4, s[4:7], s34 offen offset:0 sc1
    buffer_load_dwordx4 v[212:215], v4, s[4:7], s34 offen offset:1024 sc1
    buffer_load_dwordx2 v[216:217], v5, s[4:7], s34 offen sc1
    s_add_u32 s34, s34, 0x1900000
    s_lshl_b32 s39, s30, 10
    s_add_u32 s39, s39, s21
    s_lshl_b32 s42, s24, 7
    s_add_u32 s39, s39, s42
    s_add_u32 s39, s39, 0x3700000
    v_cmp_eq_u32 vcc, 0, v3
    v_lshlrev_b32 v10, 3, v2
    v_mov_b32 v11, 0x3f803f80
    v_lshrrev_b32 v7, 1, v1
    v_cndmask_b32 v10, v6, v10, vcc
    s_cmp_eq_u32 s22, 0
    s_cbranch_scc1 L_p5_nf
    v_mul_u32_u24 v9, 1152, v2
    s_mul_i32 s34, s30, 18432
    s_mul_i32 s42, s24, 144
    s_add_u32 s34, s34, s42
    v_lshl_add_u32 v4, v3, 4, v9
    v_lshl_add_u32 v5, v3, 3, v9
    v_cndmask_b32 v5, v6, v5, s[40:41]
L_p5_nf:
    s_lshr_b32 s44, s23, 1
    s_lshl_b32 s52, s22, 7
    s_add_u32 s52, s52, s44
    s_lshl_b32 s52, s52, 8
    s_add_u32 s52, s52, 0x450a000
    s_add_u32 s52, s52, s4
    s_addc_u32 s53, s5, 0
    s_waitcnt vmcnt(3)
    s_barrier
    s_cmp_lg_u32 s20, 0
    s_cbranch_scc1 L_ns_d5
    s_mov_b32 s56, 1
    s_atomic_add s56, s[50:51], 0
L_ns_d5:
    s_cmp_lg_u32 s20, 0
    s_cbranch_scc1 L_pd_d5
    s_mov_b32 s60, 65536
L_poll_d5:
    s_mov_b32 s57, 0
    s_atomic_add s57, s[52:53], 0 glc
    s_waitcnt lgkmcnt(0)
    s_cmp_ge_u32 s57, 16
    s_cbranch_scc1 L_pd_d5
    s_sub_u32 s60, s60, 1
    s_cbranch_scc1 L_pd_d5
    s_sleep 2
    s_branch L_poll_d5
L_pd_d5:
    s_barrier
    s_mov_b32 s32, 0
    s_lshl_b32 s32, s32, 13
    s_add_u32 s32, s32, s29
    s_add_u32 s33, s32, 4096
    buffer_load_dwordx4 v[112:115], v1, s[4:7], s32 offen offset:0 sc1
    buffer_load_dwordx4 v[116:119], v1, s[4:7], s32 offen offset:1024 sc1
    buffer_load_dwordx4 v[120:123], v1, s[4:7], s32 offen offset:2048 sc1
    buffer_load_dwordx4 v[124:127], v1, s[4:7], s32 offen offset:3072 sc1
    buffer_load_dwordx4 v[128:131], v1, s[4:7], s33 offen offset:0 sc1
    buffer_load_dwordx4 v[132:135], v1, s[4:7], s33 offen offset:1024 sc1
    buffer_load_dwordx4 v[136:139], v1, s[4:7], s33 offen offset:2048 sc1
    buffer_load_dwordx4 v[140:143], v1, s[4:7], s33 offen offset:3072 sc1
    ds_read_b128 v[40:43], v14 offset:0
    ds_read_b128 v[44:47], v14 offset:1024
    ds_read_b128 v[48:51], v14 offset:2048
    ds_read_b128 v[52:55], v14 offset:3072
    ds_read_b128 v[72:75], v14 offset:8192
    ds_read_b128 v[56:59], v14 offset:4096
    ds_read_b128 v[60:63], v14 offset:5120
    ds_read_b128 v[64:67], v14 offset:6144
    ds_read_b128 v[68:71], v14 offset:7168
    s_mov_b32 s32, 1
    s_lshl_b32 s32, s32, 13
    s_add_u32 s32, s32, s29
    s_add_u32 s33, s32, 4096
    buffer_load_dwordx4 v[144:147], v1, s[4:7], s32 offen offset:0 sc1
    buffer_load_dwordx4 v[148:151], v1, s[4:7], s32 offen offset:1024 sc1
    buffer_load_dwordx4 v[152:155], v1, s[4:7], s32 offen offset:2048 sc1
    buffer_load_dwordx4 v[156:159], v1, s[4:7], s32 offen offset:3072 sc1
    buffer_load_dwordx4 v[160:163], v1, s[4:7], s33 offen offset:0 sc1
    buffer_load_dwordx4 v[164:167], v1, s[4:7], s33 offen offset:1024 sc1
    buffer_load_dwordx4 v[168:171], v1, s[4:7], s33 offen offset:2048 sc1
    buffer_load_dwordx4 v[172:175], v1, s[4:7], s33 offen offset:3072 sc1
    s_lshl_b32 s50, s22, 7
    s_add_u32 s50, s50, s44
    s_lshl_b32 s50, s50, 8
    s_add_u32 s50, s50, 0x450b000
    s_add_u32 s50, s50, s4
    s_addc_u32 s51, s5, 0
    s_waitcnt vmcnt(16)
    v_lshlrev_b32 v16, 16, v208
    v_and_b32 v17, 0xffff0000, v208
    v_lshlrev_b32 v18, 16, v209
    v_and_b32 v19, 0xffff0000, v209
    v_lshlrev_b32 v20, 16, v210
    v_and_b32 v21, 0xffff0000, v210
    v_lshlrev_b32 v22, 16, v211
    v_and_b32 v23, 0xffff0000, v211
    v_lshlrev_b32 v24, 16, v212
    v_and_b32 v25, 0xffff0000, v212
    v_lshlrev_b32 v26, 16, v213
    v_and_b32 v27, 0xffff0000, v213
    v_lshlrev_b32 v28, 16, v214
    v_and_b32 v29, 0xffff0000, v214
    v_lshlrev_b32 v30, 16, v215
    v_and_b32 v31, 0xffff0000, v215
    v_lshlrev_b32 v32, 16, v216
    v_and_b32 v33, 0xffff0000, v216
    v_lshlrev_b32 v34, 16, v217
    v_and_b32 v35, 0xffff0000, v217
    s_waitcnt vmcnt(14) lgkmcnt(4)
    v_mfma_f32_16x16x32_bf16 v[16:19], v[40:43], v[112:115], v[16:19]
    ds_read_b128 v[76:79], v14 offset:9216
    s_mov_b32 s32, 2
    s_lshl_b32 s32, s32, 13
    s_add_u32 s32, s32, s29
    s_add_u32 s33, s32, 4096
    v_mfma_f32_16x16x32_bf16 v[20:23], v[44:47], v[112:115], v[20:23]
    ds_read_b128 v[80:83], v14 offset:10240
    v_mfma_f32_16x16x32_bf16 v[24:27], v[48:51], v[112:115], v[24:27]
    ds_read_b128 v[84:87], v14 offset:11264
    buffer_load_dwordx4 v[176:179], v1, s[4:7], s32 offen offset:0 sc1
    v_mfma_f32_16x16x32_bf16 v[28:31], v[52:55], v[112:115], v[28:31]
    ds_read_b128 v[88:91], v14 offset:12288
    v_mfma_f32_16x16x32_bf16 v[32:35], v[72:75], v[112:115], v[32:35]
    ds_read_b128 v[108:111], v14 offset:17408
    s_waitcnt lgkmcnt(5)
    v_mfma_f32_16x16x32_bf16 v[16:19], v[56:59], v[116:119], v[16:19]
    ds_read_b128 v[92:95], v14 offset:13312
    v_mfma_f32_16x16x32_bf16 v[20:23], v[60:63], v[116:119], v[20:23]
    ds_read_b128 v[96:99], v14 offset:14336
    buffer_load_dwordx4 v[180:183], v1, s[4:7], s32 offen offset:1024 sc1
    v_mfma_f32_16x16x32_bf16 v[24:27], v[64:67], v[116:119], v[24:27]
    ds_read_b128 v[100:103], v14 offset:15360
    v_mfma_f32_16x16x32_bf16 v[28:31], v[68:71], v[116:119], v[28:31]
    ds_read_b128 v[104:107], v14 offset:16384
    v_mfma_f32_16x16x32_bf16 v[36:39], v[72:75], v[116:119], 0
    s_waitcnt vmcnt(14) lgkmcnt(4)
    v_mfma_f32_16x16x32_bf16 v[16:19], v[76:79], v[120:123], v[16:19]
    ds_read_b128 v[40:43], v14 offset:18432
    v_mfma_f32_16x16x32_bf16 v[20:23], v[80:83], v[120:123], v[20:23]
    ds_read_b128 v[44:47], v14 offset:19456
    v_mfma_f32_16x16x32_bf16 v[24:27], v[84:87], v[120:123], v[24:27]
    ds_read_b128 v[48:51], v14 offset:20480
    buffer_load_dwordx4 v[184:187], v1, s[4:7], s32 offen offset:2048 sc1
    v_mfma_f32_16x16x32_bf16 v[28:31], v[88:91], v[120:123], v[28:31]
    ds_read_b128 v[52:55], v14 offset:21504
    v_mfma_f32_16x16x32_bf16 v[32:35], v[108:111], v[120:123], v[32:35]
    ds_read_b128 v[72:75], v14 offset:26624
    s_waitcnt lgkmcnt(5)
    v_mfma_f32_16x16x32_bf16 v[16:19], v[92:95], v[124:127], v[16:19]
    ds_read_b128 v[56:59], v14 offset:22528
    v_mfma_f32_16x16x32_bf16 v[20:23], v[96:99], v[124:127], v[20:23]
    ds_read_b128 v[60:63], v14 offset:23552
    buffer_load_dwordx4 v[188:191], v1, s[4:7], s32 offen offset:3072 sc1
    v_mfma_f32_16x16x32_bf16 v[24:27], v[100:103], v[124:127], v[24:27]
    ds_read_b128 v[64:67], v14 offset:24576
    v_mfma_f32_16x16x32_bf16 v[28:31], v[104:107], v[124:127], v[28:31]
    ds_read_b128 v[68:71], v14 offset:25600
    v_mfma_f32_16x16x32_bf16 v[36:39], v[108:111], v[124:127], v[36:39]
    s_waitcnt vmcnt(14) lgkmcnt(4)
    v_mfma_f32_16x16x32_bf16 v[16:19], v[40:43], v[128:131], v[16:19]
    ds_read_b128 v[76:79], v14 offset:27648
    v_mfma_f32_16x16x32_bf16 v[20:23], v[44:47], v[128:131], v[20:23]
    ds_read_b128 v[80:83], v14 offset:28672
    v_mfma_f32_16x16x32_bf16 v[24:27], v[48:51], v[128:131], v[24:27]
    ds_read_b128 v[84:87], v14 offset:29696
    buffer_load_dwordx4 v[192:195], v1, s[4:7], s33 offen offset:0 sc1
    v_mfma_f32_16x16x32_bf16 v[28:31], v[52:55], v[128:131], v[28:31]
    ds_read_b128 v[88:91], v14 offset:30720
    v_mfma_f32_16x16x32_bf16 v[32:35], v[72:75], v[128:131], v[32:35]
    ds_read_b128 v[108:111], v14 offset:35840
    s_waitcnt lgkmcnt(5)
    v_mfma_f32_16x16x32_bf16 v[16:19], v[56:59], v[132:135], v[16:19]
    ds_read_b128 v[92:95], v14 offset:31744
    v_mfma_f32_16x16x32_bf16 v[20:23], v[60:63], v[132:135], v[20:23]
    ds_read_b128 v[96:99], v14 offset:32768
    buffer_load_dwordx4 v[196:199], v1, s[4:7], s33 offen offset:1024 sc1
    v_mfma_f32_16x16x32_bf16 v[24:27], v[64:67], v[132:135], v[24:27]
    ds_read_b128 v[100:103], v14 offset:33792
    v_mfma_f32_16x16x32_bf16 v[28:31], v[68:71], v[132:135], v[28:31]
    ds_read_b128 v[104:107], v14 offset:34816
    v_mfma_f32_16x16x32_bf16 v[36:39], v[72:75], v[132:135], v[36:39]
    s_waitcnt vmcnt(14) lgkmcnt(0)
    s_barrier
    v_mfma_f32_16x16x32_bf16 v[16:19], v[76:79], v[136:139], v[16:19]
    ds_read_b128 v[40:43], v15 offset:0
    v_mfma_f32_16x16x32_bf16 v[20:23], v[80:83], v[136:139], v[20:23]
    ds_read_b128 v[44:47], v15 offset:1024
    v_mfma_f32_16x16x32_bf16 v[24:27], v[84:87], v[136:139], v[24:27]
    ds_read_b128 v[48:51], v15 offset:2048
    buffer_load_dwordx4 v[200:203], v1, s[4:7], s33 offen offset:2048 sc1
    v_mfma_f32_16x16x32_bf16 v[28:31], v[88:91], v[136:139], v[28:31]
    ds_read_b128 v[52:55], v15 offset:3072
    v_mfma_f32_16x16x32_bf16 v[32:35], v[108:111], v[136:139], v[32:35]
    ds_read_b128 v[72:75], v15 offset:8192
    v_mfma_f32_16x16x32_bf16 v[16:19], v[92:95], v[140:143], v[16:19]
    ds_read_b128 v[56:59], v15 offset:4096
    v_mfma_f32_16x16x32_bf16 v[20:23], v[96:99], v[140:143], v[20:23]
    ds_read_b128 v[60:63], v15 offset:5120
    buffer_load_dwordx4 v[204:207], v1, s[4:7], s33 offen offset:3072 sc1
    v_mfma_f32_16x16x32_bf16 v[24:27], v[100:103], v[140:143], v[24:27]
    ds_read_b128 v[64:67], v15 offset:6144
    v_mfma_f32_16x16x32_bf16 v[28:31], v[104:107], v[140:143], v[28:31]
    ds_read_b128 v[68:71], v15 offset:7168
    v_mfma_f32_16x16x32_bf16 v[36:39], v[108:111], v[140:143], v[36:39]
    s_waitcnt vmcnt(14) lgkmcnt(4)
    v_mfma_f32_16x16x32_bf16 v[16:19], v[40:43], v[144:147], v[16:19]
    ds_read_b128 v[76:79], v15 offset:9216
    s_mov_b32 s32, 3
    s_lshl_b32 s32, s32, 13
    s_add_u32 s32, s32, s29
    s_add_u32 s33, s32, 4096
    v_mfma_f32_16x16x32_bf16 v[20:23], v[44:47], v[144:147], v[20:23]
    ds_read_b128 v[80:83], v15 offset:10240
    v_mfma_f32_16x16x32_bf16 v[24:27], v[48:51], v[144:147], v[24:27]
    ds_read_b128 v[84:87], v15 offset:11264
    buffer_load_dwordx4 v[112:115], v1, s[4:7], s32 offen offset:0 sc1
    v_mfma_f32_16x16x32_bf16 v[28:31], v[52:55], v[144:147], v[28:31]
    ds_read_b128 v[88:91], v15 offset:12288
    v_mfma_f32_16x16x32_bf16 v[32:35], v[72:75], v[144:147], v[32:35]
    ds_read_b128 v[108:111], v15 offset:17408
    s_waitcnt lgkmcnt(5)
    v_mfma_f32_16x16x32_bf16 v[16:19], v[56:59], v[148:151], v[16:19]
    ds_read_b128 v[92:95], v15 offset:13312
    v_mfma_f32_16x16x32_bf16 v[20:23], v[60:63], v[148:151], v[20:23]
    ds_read_b128 v[96:99], v15 offset:14336
    buffer_load_dwordx4 v[116:119], v1, s[4:7], s32 offen offset:1024 sc1
    v_mfma_f32_16x16x32_bf16 v[24:27], v[64:67], v[148:151], v[24:27]
    ds_read_b128 v[100:103], v15 offset:15360
    v_mfma_f32_16x16x32_bf16 v[28:31], v[68:71], v[148:151], v[28:31]
    ds_read_b128 v[104:107], v15 offset:16384
    v_mfma_f32_16x16x32_bf16 v[36:39], v[72:75], v[148:151], v[36:39]
    s_waitcnt vmcnt(14) lgkmcnt(4)
    v_mfma_f32_16x16x32_bf16 v[16:19], v[76:79], v[152:155], v[16:19]
    ds_read_b128 v[40:43], v15 offset:18432
    v_mfma_f32_16x16x32_bf16 v[20:23], v[80:83], v[152:155], v[20:23]
    ds_read_b128 v[44:47], v15 offset:19456
    v_mfma_f32_16x16x32_bf16 v[24:27], v[84:87], v[152:155], v[24:27]
    ds_read_b128 v[48:51], v15 offset:20480
    buffer_load_dwordx4 v[120:123], v1, s[4:7], s32 offen offset:2048 sc1
    v_mfma_f32_16x16x32_bf16 v[28:31], v[88:91], v[152:155], v[28:31]
    ds_read_b128 v[52:55], v15 offset:21504
    v_mfma_f32_16x16x32_bf16 v[32:35], v[108:111], v[152:155], v[32:35]
    ds_read_b128 v[72:75], v15 offset:26624
    s_waitcnt lgkmcnt(5)
    v_mfma_f32_16x16x32_bf16 v[16:19], v[92:95], v[156:159], v[16:19]
    ds_read_b128 v[56:59], v15 offset:22528
    v_mfma_f32_16x16x32_bf16 v[20:23], v[96:99], v[156:159], v[20:23]
    ds_read_b128 v[60:63], v15 offset:23552
    buffer_load_dwordx4 v[124:127], v1, s[4:7], s32 offen offset:3072 sc1
    v_mfma_f32_16x16x32_bf16 v[24:27], v[100:103], v[156:159], v[24:27]
    ds_read_b128 v[64:67], v15 offset:24576
    v_mfma_f32_16x16x32_bf16 v[28:31], v[104:107], v[156:159], v[28:31]
    ds_read_b128 v[68:71], v15 offset:25600
    v_mfma_f32_16x16x32_bf16 v[36:39], v[108:111], v[156:159], v[36:39]
    s_waitcnt vmcnt(14) lgkmcnt(4)
    v_mfma_f32_16x16x32_bf16 v[16:19], v[40:43], v[160:163], v[16:19]
    ds_read_b128 v[76:79], v15 offset:27648
    v_mfma_f32_16x16x32_bf16 v[20:23], v[44:47], v[160:163], v[20:23]
    ds_read_b128 v[80:83], v15 offset:28672
    v_mfma_f32_16x16x32_bf16 v[24:27], v[48:51], v[160:163], v[24:27]
    ds_read_b128 v[84:87], v15 offset:29696
    buffer_load_dwordx4 v[128:131], v1, s[4:7], s33 offen offset:0 sc1
    v_mfma_f32_16x16x32_bf16 v[28:31], v[52:55], v[160:163], v[28:31]
    ds_read_b128 v[88:91], v15 offset:30720
    v_mfma_f32_16x16x32_bf16 v[32:35], v[72:75], v[160:163], v[32:35]
    ds_read_b128 v[108:111], v15 offset:35840
    s_waitcnt lgkmcnt(5)
    v_mfma_f32_16x16x32_bf16 v[16:19], v[56:59], v[164:167], v[16:19]
    ds_read_b128 v[92:95], v15 offset:31744
    v_mfma_f32_16x16x32_bf16 v[20:23], v[60:63], v[164:167], v[20:23]
    ds_read_b128 v[96:99], v15 offset:32768
    buffer_load_dwordx4 v[132:135], v1, s[4:7], s33 offen offset:1024 sc1
    v_mfma_f32_16x16x32_bf16 v[24:27], v[64:67], v[164:167], v[24:27]
    ds_read_b128 v[100:103], v15 offset:33792
    v_mfma_f32_16x16x32_bf16 v[28:31], v[68:71], v[164:167], v[28:31]
    ds_read_b128 v[104:107], v15 offset:34816
    v_mfma_f32_16x16x32_bf16 v[36:39], v[72:75], v[164:167], v[36:39]
    s_waitcnt vmcnt(14) lgkmcnt(0)
    s_barrier
    v_mfma_f32_16x16x32_bf16 v[16:19], v[76:79], v[168:171], v[16:19]
    ds_read_b128 v[40:43], v12 offset:0
    v_mfma_f32_16x16x32_bf16 v[20:23], v[80:83], v[168:171], v[20:23]
    ds_read_b128 v[44:47], v12 offset:1024
    v_mfma_f32_16x16x32_bf16 v[24:27], v[84:87], v[168:171], v[24:27]
    ds_read_b128 v[48:51], v12 offset:2048
    buffer_load_dwordx4 v[136:139], v1, s[4:7], s33 offen offset:2048 sc1
    v_mfma_f32_16x16x32_bf16 v[28:31], v[88:91], v[168:171], v[28:31]
    ds_read_b128 v[52:55], v12 offset:3072
    v_mfma_f32_16x16x32_bf16 v[32:35], v[108:111], v[168:171], v[32:35]
    ds_read_b128 v[72:75], v12 offset:8192
    v_mfma_f32_16x16x32_bf16 v[16:19], v[92:95], v[172:175], v[16:19]
    ds_read_b128 v[56:59], v12 offset:4096
    v_mfma_f32_16x16x32_bf16 v[20:23], v[96:99], v[172:175], v[20:23]
    ds_read_b128 v[60:63], v12 offset:5120
    buffer_load_dwordx4 v[140:143], v1, s[4:7], s33 offen offset:3072 sc1
    v_mfma_f32_16x16x32_bf16 v[24:27], v[100:103], v[172:175], v[24:27]
    ds_read_b128 v[64:67], v12 offset:6144
    v_mfma_f32_16x16x32_bf16 v[28:31], v[104:107], v[172:175], v[28:31]
    ds_read_b128 v[68:71], v12 offset:7168
    v_mfma_f32_16x16x32_bf16 v[36:39], v[108:111], v[172:175], v[36:39]
    s_waitcnt vmcnt(14) lgkmcnt(4)
    v_mfma_f32_16x16x32_bf16 v[16:19], v[40:43], v[176:179], v[16:19]
    ds_read_b128 v[76:79], v12 offset:9216
    s_mov_b32 s32, 4
    s_lshl_b32 s32, s32, 13
    s_add_u32 s32, s32, s29
    s_add_u32 s33, s32, 4096
    v_mfma_f32_16x16x32_bf16 v[20:23], v[44:47], v[176:179], v[20:23]
    ds_read_b128 v[80:83], v12 offset:10240
    v_mfma_f32_16x16x32_bf16 v[24:27], v[48:51], v[176:179], v[24:27]
    ds_read_b128 v[84:87], v12 offset:11264
    buffer_load_dwordx4 v[144:147], v1, s[4:7], s32 offen offset:0 sc1
    v_mfma_f32_16x16x32_bf16 v[28:31], v[52:55], v[176:179], v[28:31]
    ds_read_b128 v[88:91], v12 offset:12288
    v_mfma_f32_16x16x32_bf16 v[32:35], v[72:75], v[176:179], v[32:35]
    ds_read_b128 v[108:111], v12 offset:17408
    s_waitcnt lgkmcnt(5)
    v_mfma_f32_16x16x32_bf16 v[16:19], v[56:59], v[180:183], v[16:19]
    ds_read_b128 v[92:95], v12 offset:13312
    v_mfma_f32_16x16x32_bf16 v[20:23], v[60:63], v[180:183], v[20:23]
    ds_read_b128 v[96:99], v12 offset:14336
    buffer_load_dwordx4 v[148:151], v1, s[4:7], s32 offen offset:1024 sc1
    v_mfma_f32_16x16x32_bf16 v[24:27], v[64:67], v[180:183], v[24:27]
    ds_read_b128 v[100:103], v12 offset:15360
    v_mfma_f32_16x16x32_bf16 v[28:31], v[68:71], v[180:183], v[28:31]
    ds_read_b128 v[104:107], v12 offset:16384
    v_mfma_f32_16x16x32_bf16 v[36:39], v[72:75], v[180:183], v[36:39]
    s_waitcnt vmcnt(14) lgkmcnt(4)
    v_mfma_f32_16x16x32_bf16 v[16:19], v[76:79], v[184:187], v[16:19]
    ds_read_b128 v[40:43], v12 offset:18432
    v_mfma_f32_16x16x32_bf16 v[20:23], v[80:83], v[184:187], v[20:23]
    ds_read_b128 v[44:47], v12 offset:19456
    v_mfma_f32_16x16x32_bf16 v[24:27], v[84:87], v[184:187], v[24:27]
    ds_read_b128 v[48:51], v12 offset:20480
    buffer_load_dwordx4 v[152:155], v1, s[4:7], s32 offen offset:2048 sc1
    v_mfma_f32_16x16x32_bf16 v[28:31], v[88:91], v[184:187], v[28:31]
    ds_read_b128 v[52:55], v12 offset:21504
    v_mfma_f32_16x16x32_bf16 v[32:35], v[108:111], v[184:187], v[32:35]
    ds_read_b128 v[72:75], v12 offset:26624
    s_waitcnt lgkmcnt(5)
    v_mfma_f32_16x16x32_bf16 v[16:19], v[92:95], v[188:191], v[16:19]
    ds_read_b128 v[56:59], v12 offset:22528
    v_mfma_f32_16x16x32_bf16 v[20:23], v[96:99], v[188:191], v[20:23]
    ds_read_b128 v[60:63], v12 offset:23552
    buffer_load_dwordx4 v[156:159], v1, s[4:7], s32 offen offset:3072 sc1
    v_mfma_f32_16x16x32_bf16 v[24:27], v[100:103], v[188:191], v[24:27]
    ds_read_b128 v[64:67], v12 offset:24576
    v_mfma_f32_16x16x32_bf16 v[28:31], v[104:107], v[188:191], v[28:31]
    ds_read_b128 v[68:71], v12 offset:25600
    v_mfma_f32_16x16x32_bf16 v[36:39], v[108:111], v[188:191], v[36:39]
    s_waitcnt vmcnt(14) lgkmcnt(4)
    v_mfma_f32_16x16x32_bf16 v[16:19], v[40:43], v[192:195], v[16:19]
    ds_read_b128 v[76:79], v12 offset:27648
    v_mfma_f32_16x16x32_bf16 v[20:23], v[44:47], v[192:195], v[20:23]
    ds_read_b128 v[80:83], v12 offset:28672
    v_mfma_f32_16x16x32_bf16 v[24:27], v[48:51], v[192:195], v[24:27]
    ds_read_b128 v[84:87], v12 offset:29696
    buffer_load_dwordx4 v[160:163], v1, s[4:7], s33 offen offset:0 sc1
    v_mfma_f32_16x16x32_bf16 v[28:31], v[52:55], v[192:195], v[28:31]
    ds_read_b128 v[88:91], v12 offset:30720
    v_mfma_f32_16x16x32_bf16 v[32:35], v[72:75], v[192:195], v[32:35]
    ds_read_b128 v[108:111], v12 offset:35840
    s_waitcnt lgkmcnt(5)
    v_mfma_f32_16x16x32_bf16 v[16:19], v[56:59], v[196:199], v[16:19]
    ds_read_b128 v[92:95], v12 offset:31744
    v_mfma_f32_16x16x32_bf16 v[20:23], v[60:63], v[196:199], v[20:23]
    ds_read_b128 v[96:99], v12 offset:32768
    buffer_load_dwordx4 v[164:167], v1, s[4:7], s33 offen offset:1024 sc1
    v_mfma_f32_16x16x32_bf16 v[24:27], v[64:67], v[196:199], v[24:27]
    ds_read_b128 v[100:103], v12 offset:33792
    v_mfma_f32_16x16x32_bf16 v[28:31], v[68:71], v[196:199], v[28:31]
    ds_read_b128 v[104:107], v12 offset:34816
    v_mfma_f32_16x16x32_bf16 v[36:39], v[72:75], v[196:199], v[36:39]
    s_waitcnt vmcnt(14) lgkmcnt(0)
    s_barrier
    v_mfma_f32_16x16x32_bf16 v[16:19], v[76:79], v[200:203], v[16:19]
    ds_read_b128 v[40:43], v13 offset:0
    v_mfma_f32_16x16x32_bf16 v[20:23], v[80:83], v[200:203], v[20:23]
    ds_read_b128 v[44:47], v13 offset:1024
    v_mfma_f32_16x16x32_bf16 v[24:27], v[84:87], v[200:203], v[24:27]
    ds_read_b128 v[48:51], v13 offset:2048
    buffer_load_dwordx4 v[168:171], v1, s[4:7], s33 offen offset:2048 sc1
    v_mfma_f32_16x16x32_bf16 v[28:31], v[88:91], v[200:203], v[28:31]
    ds_read_b128 v[52:55], v13 offset:3072
    v_mfma_f32_16x16x32_bf16 v[32:35], v[108:111], v[200:203], v[32:35]
    ds_read_b128 v[72:75], v13 offset:8192
    v_mfma_f32_16x16x32_bf16 v[16:19], v[92:95], v[204:207], v[16:19]
    ds_read_b128 v[56:59], v13 offset:4096
    v_mfma_f32_16x16x32_bf16 v[20:23], v[96:99], v[204:207], v[20:23]
    ds_read_b128 v[60:63], v13 offset:5120
    buffer_load_dwordx4 v[172:175], v1, s[4:7], s33 offen offset:3072 sc1
    v_mfma_f32_16x16x32_bf16 v[24:27], v[100:103], v[204:207], v[24:27]
    ds_read_b128 v[64:67], v13 offset:6144
    v_mfma_f32_16x16x32_bf16 v[28:31], v[104:107], v[204:207], v[28:31]
    ds_read_b128 v[68:71], v13 offset:7168
    v_mfma_f32_16x16x32_bf16 v[36:39], v[108:111], v[204:207], v[36:39]
    s_waitcnt vmcnt(14) lgkmcnt(4)
    v_mfma_f32_16x16x32_bf16 v[16:19], v[40:43], v[112:115], v[16:19]
    ds_read_b128 v[76:79], v13 offset:9216
    s_mov_b32 s32, 5
    s_lshl_b32 s32, s32, 13
    s_add_u32 s32, s32, s29
    s_add_u32 s33, s32, 4096
    v_mfma_f32_16x16x32_bf16 v[20:23], v[44:47], v[112:115], v[20:23]
    ds_read_b128 v[80:83], v13 offset:10240
    v_mfma_f32_16x16x32_bf16 v[24:27], v[48:51], v[112:115], v[24:27]
    ds_read_b128 v[84:87], v13 offset:11264
    buffer_load_dwordx4 v[176:179], v1, s[4:7], s32 offen offset:0 sc1
    v_mfma_f32_16x16x32_bf16 v[28:31], v[52:55], v[112:115], v[28:31]
    ds_read_b128 v[88:91], v13 offset:12288
    v_mfma_f32_16x16x32_bf16 v[32:35], v[72:75], v[112:115], v[32:35]
    ds_read_b128 v[108:111], v13 offset:17408
    s_waitcnt lgkmcnt(5)
    v_mfma_f32_16x16x32_bf16 v[16:19], v[56:59], v[116:119], v[16:19]
    ds_read_b128 v[92:95], v13 offset:13312
    v_mfma_f32_16x16x32_bf16 v[20:23], v[60:63], v[116:119], v[20:23]
    ds_read_b128 v[96:99], v13 offset:14336
    buffer_load_dwordx4 v[180:183], v1, s[4:7], s32 offen offset:1024 sc1
    v_mfma_f32_16x16x32_bf16 v[24:27], v[64:67], v[116:119], v[24:27]
    ds_read_b128 v[100:103], v13 offset:15360
    v_mfma_f32_16x16x32_bf16 v[28:31], v[68:71], v[116:119], v[28:31]
    ds_read_b128 v[104:107], v13 offset:16384
    v_mfma_f32_16x16x32_bf16 v[36:39], v[72:75], v[116:119], v[36:39]
    s_waitcnt vmcnt(14) lgkmcnt(4)
    v_mfma_f32_16x16x32_bf16 v[16:19], v[76:79], v[120:123], v[16:19]
    ds_read_b128 v[40:43], v13 offset:18432
    v_mfma_f32_16x16x32_bf16 v[20:23], v[80:83], v[120:123], v[20:23]
    ds_read_b128 v[44:47], v13 offset:19456
    v_mfma_f32_16x16x32_bf16 v[24:27], v[84:87], v[120:123], v[24:27]
    ds_read_b128 v[48:51], v13 offset:20480
    buffer_load_dwordx4 v[184:187], v1, s[4:7], s32 offen offset:2048 sc1
    v_mfma_f32_16x16x32_bf16 v[28:31], v[88:91], v[120:123], v[28:31]
    ds_read_b128 v[52:55], v13 offset:21504
    v_mfma_f32_16x16x32_bf16 v[32:35], v[108:111], v[120:123], v[32:35]
    ds_read_b128 v[72:75], v13 offset:26624
    s_waitcnt lgkmcnt(5)
    v_mfma_f32_16x16x32_bf16 v[16:19], v[92:95], v[124:127], v[16:19]
    ds_read_b128 v[56:59], v13 offset:22528
    v_mfma_f32_16x16x32_bf16 v[20:23], v[96:99], v[124:127], v[20:23]
    ds_read_b128 v[60:63], v13 offset:23552
    buffer_load_dwordx4 v[188:191], v1, s[4:7], s32 offen offset:3072 sc1
    v_mfma_f32_16x16x32_bf16 v[24:27], v[100:103], v[124:127], v[24:27]
    ds_read_b128 v[64:67], v13 offset:24576
    v_mfma_f32_16x16x32_bf16 v[28:31], v[104:107], v[124:127], v[28:31]
    ds_read_b128 v[68:71], v13 offset:25600
    v_mfma_f32_16x16x32_bf16 v[36:39], v[108:111], v[124:127], v[36:39]
    s_waitcnt vmcnt(14) lgkmcnt(4)
    v_mfma_f32_16x16x32_bf16 v[16:19], v[40:43], v[128:131], v[16:19]
    ds_read_b128 v[76:79], v13 offset:27648
    v_mfma_f32_16x16x32_bf16 v[20:23], v[44:47], v[128:131], v[20:23]
    ds_read_b128 v[80:83], v13 offset:28672
    v_mfma_f32_16x16x32_bf16 v[24:27], v[48:51], v[128:131], v[24:27]
    ds_read_b128 v[84:87], v13 offset:29696
    buffer_load_dwordx4 v[192:195], v1, s[4:7], s33 offen offset:0 sc1
    v_mfma_f32_16x16x32_bf16 v[28:31], v[52:55], v[128:131], v[28:31]
    ds_read_b128 v[88:91], v13 offset:30720
    v_mfma_f32_16x16x32_bf16 v[32:35], v[72:75], v[128:131], v[32:35]
    ds_read_b128 v[108:111], v13 offset:35840
    s_waitcnt lgkmcnt(5)
    v_mfma_f32_16x16x32_bf16 v[16:19], v[56:59], v[132:135], v[16:19]
    ds_read_b128 v[92:95], v13 offset:31744
    v_mfma_f32_16x16x32_bf16 v[20:23], v[60:63], v[132:135], v[20:23]
    ds_read_b128 v[96:99], v13 offset:32768
    buffer_load_dwordx4 v[196:199], v1, s[4:7], s33 offen offset:1024 sc1
    v_mfma_f32_16x16x32_bf16 v[24:27], v[64:67], v[132:135], v[24:27]
    ds_read_b128 v[100:103], v13 offset:33792
    v_mfma_f32_16x16x32_bf16 v[28:31], v[68:71], v[132:135], v[28:31]
    ds_read_b128 v[104:107], v13 offset:34816
    v_mfma_f32_16x16x32_bf16 v[36:39], v[72:75], v[132:135], v[36:39]
    s_waitcnt vmcnt(14) lgkmcnt(0)
    s_barrier
    v_mfma_f32_16x16x32_bf16 v[16:19], v[76:79], v[136:139], v[16:19]
    ds_read_b128 v[40:43], v14 offset:0
    v_mfma_f32_16x16x32_bf16 v[20:23], v[80:83], v[136:139], v[20:23]
    ds_read_b128 v[44:47], v14 offset:1024
    v_mfma_f32_16x16x32_bf16 v[24:27], v[84:87], v[136:139], v[24:27]
    ds_read_b128 v[48:51], v14 offset:2048
    buffer_load_dwordx4 v[200:203], v1, s[4:7], s33 offen offset:2048 sc1
    v_mfma_f32_16x16x32_bf16 v[28:31], v[88:91], v[136:139], v[28:31]
    ds_read_b128 v[52:55], v14 offset:3072
    v_mfma_f32_16x16x32_bf16 v[32:35], v[108:111], v[136:139], v[32:35]
    ds_read_b128 v[72:75], v14 offset:8192
    v_mfma_f32_16x16x32_bf16 v[16:19], v[92:95], v[140:143], v[16:19]
    ds_read_b128 v[56:59], v14 offset:4096
    v_mfma_f32_16x16x32_bf16 v[20:23], v[96:99], v[140:143], v[20:23]
    ds_read_b128 v[60:63], v14 offset:5120
    buffer_load_dwordx4 v[204:207], v1, s[4:7], s33 offen offset:3072 sc1
    v_mfma_f32_16x16x32_bf16 v[24:27], v[100:103], v[140:143], v[24:27]
    ds_read_b128 v[64:67], v14 offset:6144
    v_mfma_f32_16x16x32_bf16 v[28:31], v[104:107], v[140:143], v[28:31]
    ds_read_b128 v[68:71], v14 offset:7168
    v_mfma_f32_16x16x32_bf16 v[36:39], v[108:111], v[140:143], v[36:39]
    s_waitcnt vmcnt(14) lgkmcnt(4)
    v_mfma_f32_16x16x32_bf16 v[16:19], v[40:43], v[144:147], v[16:19]
    ds_read_b128 v[76:79], v14 offset:9216
    s_mov_b32 s32, 6
    s_lshl_b32 s32, s32, 13
    s_add_u32 s32, s32, s29
    s_add_u32 s33, s32, 4096
    v_mfma_f32_16x16x32_bf16 v[20:23], v[44:47], v[144:147], v[20:23]
    ds_read_b128 v[80:83], v14 offset:10240
    v_mfma_f32_16x16x32_bf16 v[24:27], v[48:51], v[144:147], v[24:27]
    ds_read_b128 v[84:87], v14 offset:11264
    buffer_load_dwordx4 v[112:115], v1, s[4:7], s32 offen offset:0 sc1
    v_mfma_f32_16x16x32_bf16 v[28:31], v[52:55], v[144:147], v[28:31]
    ds_read_b128 v[88:91], v14 offset:12288
    v_mfma_f32_16x16x32_bf16 v[32:35], v[72:75], v[144:147], v[32:35]
    ds_read_b128 v[108:111], v14 offset:17408
    s_waitcnt lgkmcnt(5)
    v_mfma_f32_16x16x32_bf16 v[16:19], v[56:59], v[148:151], v[16:19]
    ds_read_b128 v[92:95], v14 offset:13312
    v_mfma_f32_16x16x32_bf16 v[20:23], v[60:63], v[148:151], v[20:23]
    ds_read_b128 v[96:99], v14 offset:14336
    buffer_load_dwordx4 v[116:119], v1, s[4:7], s32 offen offset:1024 sc1
    v_mfma_f32_16x16x32_bf16 v[24:27], v[64:67], v[148:151], v[24:27]
    ds_read_b128 v[100:103], v14 offset:15360
    v_mfma_f32_16x16x32_bf16 v[28:31], v[68:71], v[148:151], v[28:31]
    ds_read_b128 v[104:107], v14 offset:16384
    v_mfma_f32_16x16x32_bf16 v[36:39], v[72:75], v[148:151], v[36:39]
    s_waitcnt vmcnt(14) lgkmcnt(4)
    v_mfma_f32_16x16x32_bf16 v[16:19], v[76:79], v[152:155], v[16:19]
    ds_read_b128 v[40:43], v14 offset:18432
    v_mfma_f32_16x16x32_bf16 v[20:23], v[80:83], v[152:155], v[20:23]
    ds_read_b128 v[44:47], v14 offset:19456
    v_mfma_f32_16x16x32_bf16 v[24:27], v[84:87], v[152:155], v[24:27]
    ds_read_b128 v[48:51], v14 offset:20480
    buffer_load_dwordx4 v[120:123], v1, s[4:7], s32 offen offset:2048 sc1
    v_mfma_f32_16x16x32_bf16 v[28:31], v[88:91], v[152:155], v[28:31]
    ds_read_b128 v[52:55], v14 offset:21504
    v_mfma_f32_16x16x32_bf16 v[32:35], v[108:111], v[152:155], v[32:35]
    ds_read_b128 v[72:75], v14 offset:26624
    s_waitcnt lgkmcnt(5)
    v_mfma_f32_16x16x32_bf16 v[16:19], v[92:95], v[156:159], v[16:19]
    ds_read_b128 v[56:59], v14 offset:22528
    v_mfma_f32_16x16x32_bf16 v[20:23], v[96:99], v[156:159], v[20:23]
    ds_read_b128 v[60:63], v14 offset:23552
    buffer_load_dwordx4 v[124:127], v1, s[4:7], s32 offen offset:3072 sc1
    v_mfma_f32_16x16x32_bf16 v[24:27], v[100:103], v[156:159], v[24:27]
    ds_read_b128 v[64:67], v14 offset:24576
    v_mfma_f32_16x16x32_bf16 v[28:31], v[104:107], v[156:159], v[28:31]
    ds_read_b128 v[68:71], v14 offset:25600
    v_mfma_f32_16x16x32_bf16 v[36:39], v[108:111], v[156:159], v[36:39]
    s_waitcnt vmcnt(14) lgkmcnt(4)
    v_mfma_f32_16x16x32_bf16 v[16:19], v[40:43], v[160:163], v[16:19]
    ds_read_b128 v[76:79], v14 offset:27648
    v_mfma_f32_16x16x32_bf16 v[20:23], v[44:47], v[160:163], v[20:23]
    ds_read_b128 v[80:83], v14 offset:28672
    v_mfma_f32_16x16x32_bf16 v[24:27], v[48:51], v[160:163], v[24:27]
    ds_read_b128 v[84:87], v14 offset:29696
    buffer_load_dwordx4 v[128:131], v1, s[4:7], s33 offen offset:0 sc1
    v_mfma_f32_16x16x32_bf16 v[28:31], v[52:55], v[160:163], v[28:31]
    ds_read_b128 v[88:91], v14 offset:30720
    v_mfma_f32_16x16x32_bf16 v[32:35], v[72:75], v[160:163], v[32:35]
    ds_read_b128 v[108:111], v14 offset:35840
    s_waitcnt lgkmcnt(5)
    v_mfma_f32_16x16x32_bf16 v[16:19], v[56:59], v[164:167], v[16:19]
    ds_read_b128 v[92:95], v14 offset:31744
    v_mfma_f32_16x16x32_bf16 v[20:23], v[60:63], v[164:167], v[20:23]
    ds_read_b128 v[96:99], v14 offset:32768
    buffer_load_dwordx4 v[132:135], v1, s[4:7], s33 offen offset:1024 sc1
    v_mfma_f32_16x16x32_bf16 v[24:27], v[64:67], v[164:167], v[24:27]
    ds_read_b128 v[100:103], v14 offset:33792
    v_mfma_f32_16x16x32_bf16 v[28:31], v[68:71], v[164:167], v[28:31]
    ds_read_b128 v[104:107], v14 offset:34816
    v_mfma_f32_16x16x32_bf16 v[36:39], v[72:75], v[164:167], v[36:39]
    s_waitcnt vmcnt(14) lgkmcnt(0)
    s_barrier
    v_mfma_f32_16x16x32_bf16 v[16:19], v[76:79], v[168:171], v[16:19]
    ds_read_b128 v[40:43], v15 offset:0
    v_mfma_f32_16x16x32_bf16 v[20:23], v[80:83], v[168:171], v[20:23]
    ds_read_b128 v[44:47], v15 offset:1024
    v_mfma_f32_16x16x32_bf16 v[24:27], v[84:87], v[168:171], v[24:27]
    ds_read_b128 v[48:51], v15 offset:2048
    buffer_load_dwordx4 v[136:139], v1, s[4:7], s33 offen offset:2048 sc1
    v_mfma_f32_16x16x32_bf16 v[28:31], v[88:91], v[168:171], v[28:31]
    ds_read_b128 v[52:55], v15 offset:3072
    v_mfma_f32_16x16x32_bf16 v[32:35], v[108:111], v[168:171], v[32:35]
    ds_read_b128 v[72:75], v15 offset:8192
    v_mfma_f32_16x16x32_bf16 v[16:19], v[92:95], v[172:175], v[16:19]
    ds_read_b128 v[56:59], v15 offset:4096
    v_mfma_f32_16x16x32_bf16 v[20:23], v[96:99], v[172:175], v[20:23]
    ds_read_b128 v[60:63], v15 offset:5120
    buffer_load_dwordx4 v[140:143], v1, s[4:7], s33 offen offset:3072 sc1
    v_mfma_f32_16x16x32_bf16 v[24:27], v[100:103], v[172:175], v[24:27]
    ds_read_b128 v[64:67], v15 offset:6144
    v_mfma_f32_16x16x32_bf16 v[28:31], v[104:107], v[172:175], v[28:31]
    ds_read_b128 v[68:71], v15 offset:7168
    v_mfma_f32_16x16x32_bf16 v[36:39], v[108:111], v[172:175], v[36:39]
    s_waitcnt vmcnt(14) lgkmcnt(4)
    v_mfma_f32_16x16x32_bf16 v[16:19], v[40:43], v[176:179], v[16:19]
    ds_read_b128 v[76:79], v15 offset:9216
    s_mov_b32 s32, 7
    s_lshl_b32 s32, s32, 13
    s_add_u32 s32, s32, s29
    s_add_u32 s33, s32, 4096
    v_mfma_f32_16x16x32_bf16 v[20:23], v[44:47], v[176:179], v[20:23]
    ds_read_b128 v[80:83], v15 offset:10240
    v_mfma_f32_16x16x32_bf16 v[24:27], v[48:51], v[176:179], v[24:27]
    ds_read_b128 v[84:87], v15 offset:11264
    buffer_load_dwordx4 v[144:147], v1, s[4:7], s32 offen offset:0 sc1
    v_mfma_f32_16x16x32_bf16 v[28:31], v[52:55], v[176:179], v[28:31]
    ds_read_b128 v[88:91], v15 offset:12288
    v_mfma_f32_16x16x32_bf16 v[32:35], v[72:75], v[176:179], v[32:35]
    ds_read_b128 v[108:111], v15 offset:17408
    s_waitcnt lgkmcnt(5)
    v_mfma_f32_16x16x32_bf16 v[16:19], v[56:59], v[180:183], v[16:19]
    ds_read_b128 v[92:95], v15 offset:13312
    v_mfma_f32_16x16x32_bf16 v[20:23], v[60:63], v[180:183], v[20:23]
    ds_read_b128 v[96:99], v15 offset:14336
    buffer_load_dwordx4 v[148:151], v1, s[4:7], s32 offen offset:1024 sc1
    v_mfma_f32_16x16x32_bf16 v[24:27], v[64:67], v[180:183], v[24:27]
    ds_read_b128 v[100:103], v15 offset:15360
    v_mfma_f32_16x16x32_bf16 v[28:31], v[68:71], v[180:183], v[28:31]
    ds_read_b128 v[104:107], v15 offset:16384
    v_mfma_f32_16x16x32_bf16 v[36:39], v[72:75], v[180:183], v[36:39]
    s_waitcnt vmcnt(14) lgkmcnt(4)
    v_mfma_f32_16x16x32_bf16 v[16:19], v[76:79], v[184:187], v[16:19]
    ds_read_b128 v[40:43], v15 offset:18432
    v_mfma_f32_16x16x32_bf16 v[20:23], v[80:83], v[184:187], v[20:23]
    ds_read_b128 v[44:47], v15 offset:19456
    v_mfma_f32_16x16x32_bf16 v[24:27], v[84:87], v[184:187], v[24:27]
    ds_read_b128 v[48:51], v15 offset:20480
    buffer_load_dwordx4 v[152:155], v1, s[4:7], s32 offen offset:2048 sc1
    v_mfma_f32_16x16x32_bf16 v[28:31], v[88:91], v[184:187], v[28:31]
    ds_read_b128 v[52:55], v15 offset:21504
    v_mfma_f32_16x16x32_bf16 v[32:35], v[108:111], v[184:187], v[32:35]
    ds_read_b128 v[72:75], v15 offset:26624
    s_waitcnt lgkmcnt(5)
    v_mfma_f32_16x16x32_bf16 v[16:19], v[92:95], v[188:191], v[16:19]
    ds_read_b128 v[56:59], v15 offset:22528
    v_mfma_f32_16x16x32_bf16 v[20:23], v[96:99], v[188:191], v[20:23]
    ds_read_b128 v[60:63], v15 offset:23552
    buffer_load_dwordx4 v[156:159], v1, s[4:7], s32 offen offset:3072 sc1
    v_mfma_f32_16x16x32_bf16 v[24:27], v[100:103], v[188:191], v[24:27]
    ds_read_b128 v[64:67], v15 offset:24576
    v_mfma_f32_16x16x32_bf16 v[28:31], v[104:107], v[188:191], v[28:31]
    ds_read_b128 v[68:71], v15 offset:25600
    v_mfma_f32_16x16x32_bf16 v[36:39], v[108:111], v[188:191], v[36:39]
    s_waitcnt vmcnt(14) lgkmcnt(4)
    v_mfma_f32_16x16x32_bf16 v[16:19], v[40:43], v[192:195], v[16:19]
    ds_read_b128 v[76:79], v15 offset:27648
    v_mfma_f32_16x16x32_bf16 v[20:23], v[44:47], v[192:195], v[20:23]
    ds_read_b128 v[80:83], v15 offset:28672
    v_mfma_f32_16x16x32_bf16 v[24:27], v[48:51], v[192:195], v[24:27]
    ds_read_b128 v[84:87], v15 offset:29696
    buffer_load_dwordx4 v[160:163], v1, s[4:7], s33 offen offset:0 sc1
    v_mfma_f32_16x16x32_bf16 v[28:31], v[52:55], v[192:195], v[28:31]
    ds_read_b128 v[88:91], v15 offset:30720
    v_mfma_f32_16x16x32_bf16 v[32:35], v[72:75], v[192:195], v[32:35]
    ds_read_b128 v[108:111], v15 offset:35840
    s_waitcnt lgkmcnt(5)
    v_mfma_f32_16x16x32_bf16 v[16:19], v[56:59], v[196:199], v[16:19]
    ds_read_b128 v[92:95], v15 offset:31744
    v_mfma_f32_16x16x32_bf16 v[20:23], v[60:63], v[196:199], v[20:23]
    ds_read_b128 v[96:99], v15 offset:32768
    buffer_load_dwordx4 v[164:167], v1, s[4:7], s33 offen offset:1024 sc1
    v_mfma_f32_16x16x32_bf16 v[24:27], v[64:67], v[196:199], v[24:27]
    ds_read_b128 v[100:103], v15 offset:33792
    v_mfma_f32_16x16x32_bf16 v[28:31], v[68:71], v[196:199], v[28:31]
    ds_read_b128 v[104:107], v15 offset:34816
    v_mfma_f32_16x16x32_bf16 v[36:39], v[72:75], v[196:199], v[36:39]
    s_waitcnt vmcnt(14) lgkmcnt(0)
    s_barrier
    v_mfma_f32_16x16x32_bf16 v[16:19], v[76:79], v[200:203], v[16:19]
    ds_read_b128 v[40:43], v12 offset:0
    v_mfma_f32_16x16x32_bf16 v[20:23], v[80:83], v[200:203], v[20:23]
    ds_read_b128 v[44:47], v12 offset:1024
    v_mfma_f32_16x16x32_bf16 v[24:27], v[84:87], v[200:203], v[24:27]
    ds_read_b128 v[48:51], v12 offset:2048
    buffer_load_dwordx4 v[168:171], v1, s[4:7], s33 offen offset:2048 sc1
    v_mfma_f32_16x16x32_bf16 v[28:31], v[88:91], v[200:203], v[28:31]
    ds_read_b128 v[52:55], v12 offset:3072
    v_mfma_f32_16x16x32_bf16 v[32:35], v[108:111], v[200:203], v[32:35]
    ds_read_b128 v[72:75], v12 offset:8192
    v_mfma_f32_16x16x32_bf16 v[16:19], v[92:95], v[204:207], v[16:19]
    ds_read_b128 v[56:59], v12 offset:4096
    v_mfma_f32_16x16x32_bf16 v[20:23], v[96:99], v[204:207], v[20:23]
    ds_read_b128 v[60:63], v12 offset:5120
    buffer_load_dwordx4 v[172:175], v1, s[4:7], s33 offen offset:3072 sc1
    v_mfma_f32_16x16x32_bf16 v[24:27], v[100:103], v[204:207], v[24:27]
    ds_read_b128 v[64:67], v12 offset:6144
    v_mfma_f32_16x16x32_bf16 v[28:31], v[104:107], v[204:207], v[28:31]
    ds_read_b128 v[68:71], v12 offset:7168
    v_mfma_f32_16x16x32_bf16 v[36:39], v[108:111], v[204:207], v[36:39]
    s_waitcnt vmcnt(14) lgkmcnt(4)
    v_mfma_f32_16x16x32_bf16 v[16:19], v[40:43], v[112:115], v[16:19]
    ds_read_b128 v[76:79], v12 offset:9216
    s_mov_b32 s32, 8
    s_lshl_b32 s32, s32, 13
    s_add_u32 s32, s32, s29
    s_add_u32 s33, s32, 4096
    v_mfma_f32_16x16x32_bf16 v[20:23], v[44:47], v[112:115], v[20:23]
    ds_read_b128 v[80:83], v12 offset:10240
    v_mfma_f32_16x16x32_bf16 v[24:27], v[48:51], v[112:115], v[24:27]
    ds_read_b128 v[84:87], v12 offset:11264
    buffer_load_dwordx2 v[176:177], v7, s[4:7], s32 offen offset:0 sc1
    v_mfma_f32_16x16x32_bf16 v[28:31], v[52:55], v[112:115], v[28:31]
    ds_read_b128 v[88:91], v12 offset:12288
    v_mfma_f32_16x16x32_bf16 v[32:35], v[72:75], v[112:115], v[32:35]
    ds_read_b128 v[108:111], v12 offset:17408
    s_waitcnt lgkmcnt(5)
    buffer_load_dwordx2 v[178:179], v7, s[4:7], s32 offen offset:512 sc1
    v_mfma_f32_16x16x32_bf16 v[16:19], v[56:59], v[116:119], v[16:19]
    ds_read_b128 v[92:95], v12 offset:13312
    v_mfma_f32_16x16x32_bf16 v[20:23], v[60:63], v[116:119], v[20:23]
    ds_read_b128 v[96:99], v12 offset:14336
    buffer_load_dwordx2 v[180:181], v7, s[4:7], s32 offen offset:1024 sc1
    v_mfma_f32_16x16x32_bf16 v[24:27], v[64:67], v[116:119], v[24:27]
    ds_read_b128 v[100:103], v12 offset:15360
    v_mfma_f32_16x16x32_bf16 v[28:31], v[68:71], v[116:119], v[28:31]
    ds_read_b128 v[104:107], v12 offset:16384
    buffer_load_dwordx2 v[182:183], v7, s[4:7], s32 offen offset:1536 sc1
    v_mfma_f32_16x16x32_bf16 v[36:39], v[72:75], v[116:119], v[36:39]
    s_waitcnt vmcnt(16) lgkmcnt(4)
    v_mfma_f32_16x16x32_bf16 v[16:19], v[76:79], v[120:123], v[16:19]
    ds_read_b128 v[40:43], v12 offset:18432
    v_mfma_f32_16x16x32_bf16 v[20:23], v[80:83], v[120:123], v[20:23]
    ds_read_b128 v[44:47], v12 offset:19456
    v_mfma_f32_16x16x32_bf16 v[24:27], v[84:87], v[120:123], v[24:27]
    ds_read_b128 v[48:51], v12 offset:20480
    buffer_load_dwordx2 v[184:185], v7, s[4:7], s32 offen offset:2048 sc1
    v_mfma_f32_16x16x32_bf16 v[28:31], v[88:91], v[120:123], v[28:31]
    ds_read_b128 v[52:55], v12 offset:21504
    v_mfma_f32_16x16x32_bf16 v[32:35], v[108:111], v[120:123], v[32:35]
    ds_read_b128 v[72:75], v12 offset:26624
    s_waitcnt lgkmcnt(5)
    buffer_load_dwordx2 v[186:187], v7, s[4:7], s32 offen offset:2560 sc1
    v_mfma_f32_16x16x32_bf16 v[16:19], v[92:95], v[124:127], v[16:19]
    ds_read_b128 v[56:59], v12 offset:22528
    v_mfma_f32_16x16x32_bf16 v[20:23], v[96:99], v[124:127], v[20:23]
    ds_read_b128 v[60:63], v12 offset:23552
    buffer_load_dwordx2 v[188:189], v7, s[4:7], s32 offen offset:3072 sc1
    v_mfma_f32_16x16x32_bf16 v[24:27], v[100:103], v[124:127], v[24:27]
    ds_read_b128 v[64:67], v12 offset:24576
    v_mfma_f32_16x16x32_bf16 v[28:31], v[104:107], v[124:127], v[28:31]
    ds_read_b128 v[68:71], v12 offset:25600
    buffer_load_dwordx2 v[190:191], v7, s[4:7], s32 offen offset:3584 sc1
    v_mfma_f32_16x16x32_bf16 v[36:39], v[108:111], v[124:127], v[36:39]
    s_waitcnt vmcnt(18) lgkmcnt(4)
    v_mfma_f32_16x16x32_bf16 v[16:19], v[40:43], v[128:131], v[16:19]
    ds_read_b128 v[76:79], v12 offset:27648
    v_mfma_f32_16x16x32_bf16 v[20:23], v[44:47], v[128:131], v[20:23]
    ds_read_b128 v[80:83], v12 offset:28672
    v_mfma_f32_16x16x32_bf16 v[24:27], v[48:51], v[128:131], v[24:27]
    ds_read_b128 v[84:87], v12 offset:29696
    buffer_load_dwordx2 v[192:193], v7, s[4:7], s33 offen offset:0 sc1
    v_mfma_f32_16x16x32_bf16 v[28:31], v[52:55], v[128:131], v[28:31]
    ds_read_b128 v[88:91], v12 offset:30720
    v_mfma_f32_16x16x32_bf16 v[32:35], v[72:75], v[128:131], v[32:35]
    ds_read_b128 v[108:111], v12 offset:35840
    s_waitcnt lgkmcnt(5)
    buffer_load_dwordx2 v[194:195], v7, s[4:7], s33 offen offset:512 sc1
    v_mfma_f32_16x16x32_bf16 v[16:19], v[56:59], v[132:135], v[16:19]
    ds_read_b128 v[92:95], v12 offset:31744
    v_mfma_f32_16x16x32_bf16 v[20:23], v[60:63], v[132:135], v[20:23]
    ds_read_b128 v[96:99], v12 offset:32768
    buffer_load_dwordx2 v[196:197], v7, s[4:7], s33 offen offset:1024 sc1
    v_mfma_f32_16x16x32_bf16 v[24:27], v[64:67], v[132:135], v[24:27]
    ds_read_b128 v[100:103], v12 offset:33792
    v_mfma_f32_16x16x32_bf16 v[28:31], v[68:71], v[132:135], v[28:31]
    ds_read_b128 v[104:107], v12 offset:34816
    buffer_load_dwordx2 v[198:199], v7, s[4:7], s33 offen offset:1536 sc1
    v_mfma_f32_16x16x32_bf16 v[36:39], v[72:75], v[132:135], v[36:39]
    s_waitcnt vmcnt(20) lgkmcnt(0)
    s_barrier
    v_mfma_f32_16x16x32_bf16 v[16:19], v[76:79], v[136:139], v[16:19]
    ds_read_b128 v[40:43], v13 offset:0
    v_mfma_f32_16x16x32_bf16 v[20:23], v[80:83], v[136:139], v[20:23]
    ds_read_b128 v[44:47], v13 offset:1024
    v_mfma_f32_16x16x32_bf16 v[24:27], v[84:87], v[136:139], v[24:27]
    ds_read_b128 v[48:51], v13 offset:2048
    buffer_load_dwordx2 v[200:201], v7, s[4:7], s33 offen offset:2048 sc1
    v_mfma_f32_16x16x32_bf16 v[28:31], v[88:91], v[136:139], v[28:31]
    ds_read_b128 v[52:55], v13 offset:3072
    v_mfma_f32_16x16x32_bf16 v[32:35], v[108:111], v[136:139], v[32:35]
    ds_read_b128 v[72:75], v13 offset:8192
    buffer_load_dwordx2 v[202:203], v7, s[4:7], s33 offen offset:2560 sc1
    v_mfma_f32_16x16x32_bf16 v[16:19], v[92:95], v[140:143], v[16:19]
    ds_read_b128 v[56:59], v13 offset:4096
    v_mfma_f32_16x16x32_bf16 v[20:23], v[96:99], v[140:143], v[20:23]
    ds_read_b128 v[60:63], v13 offset:5120
    buffer_load_dwordx2 v[204:205], v7, s[4:7], s33 offen offset:3072 sc1
    v_mfma_f32_16x16x32_bf16 v[24:27], v[100:103], v[140:143], v[24:27]
    ds_read_b128 v[64:67], v13 offset:6144
    v_mfma_f32_16x16x32_bf16 v[28:31], v[104:107], v[140:143], v[28:31]
    ds_read_b128 v[68:71], v13 offset:7168
    buffer_load_dwordx2 v[206:207], v7, s[4:7], s33 offen offset:3584 sc1
    v_mfma_f32_16x16x32_bf16 v[36:39], v[108:111], v[140:143], v[36:39]
    s_waitcnt vmcnt(22) lgkmcnt(4)
    v_mfma_f32_16x16x32_bf16 v[16:19], v[40:43], v[144:147], v[16:19]
    ds_read_b128 v[76:79], v13 offset:9216
    v_mfma_f32_16x16x32_bf16 v[20:23], v[44:47], v[144:147], v[20:23]
    ds_read_b128 v[80:83], v13 offset:10240
    v_mfma_f32_16x16x32_bf16 v[24:27], v[48:51], v[144:147], v[24:27]
    ds_read_b128 v[84:87], v13 offset:11264
    v_mfma_f32_16x16x32_bf16 v[28:31], v[52:55], v[144:147], v[28:31]
    ds_read_b128 v[88:91], v13 offset:12288
    v_mfma_f32_16x16x32_bf16 v[32:35], v[72:75], v[144:147], v[32:35]
    ds_read_b128 v[108:111], v13 offset:17408
    s_waitcnt lgkmcnt(5)
    v_mfma_f32_16x16x32_bf16 v[16:19], v[56:59], v[148:151], v[16:19]
    ds_read_b128 v[92:95], v13 offset:13312
    v_mfma_f32_16x16x32_bf16 v[20:23], v[60:63], v[148:151], v[20:23]
    ds_read_b128 v[96:99], v13 offset:14336
    v_mfma_f32_16x16x32_bf16 v[24:27], v[64:67], v[148:151], v[24:27]
    ds_read_b128 v[100:103], v13 offset:15360
    v_mfma_f32_16x16x32_bf16 v[28:31], v[68:71], v[148:151], v[28:31]
    ds_read_b128 v[104:107], v13 offset:16384
    v_mfma_f32_16x16x32_bf16 v[36:39], v[72:75], v[148:151], v[36:39]
    s_waitcnt vmcnt(20) lgkmcnt(4)
    v_mfma_f32_16x16x32_bf16 v[16:19], v[76:79], v[152:155], v[16:19]
    ds_read_b128 v[40:43], v13 offset:18432
    v_mfma_f32_16x16x32_bf16 v[20:23], v[80:83], v[152:155], v[20:23]
    ds_read_b128 v[44:47], v13 offset:19456
    v_mfma_f32_16x16x32_bf16 v[24:27], v[84:87], v[152:155], v[24:27]
    ds_read_b128 v[48:51], v13 offset:20480
    v_mfma_f32_16x16x32_bf16 v[28:31], v[88:91], v[152:155], v[28:31]
    ds_read_b128 v[52:55], v13 offset:21504
    v_mfma_f32_16x16x32_bf16 v[32:35], v[108:111], v[152:155], v[32:35]
    ds_read_b128 v[72:75], v13 offset:26624
    s_waitcnt lgkmcnt(5)
    v_mfma_f32_16x16x32_bf16 v[16:19], v[92:95], v[156:159], v[16:19]
    ds_read_b128 v[56:59], v13 offset:22528
    v_mfma_f32_16x16x32_bf16 v[20:23], v[96:99], v[156:159], v[20:23]
    ds_read_b128 v[60:63], v13 offset:23552
    v_mfma_f32_16x16x32_bf16 v[24:27], v[100:103], v[156:159], v[24:27]
    ds_read_b128 v[64:67], v13 offset:24576
    v_mfma_f32_16x16x32_bf16 v[28:31], v[104:107], v[156:159], v[28:31]
    ds_read_b128 v[68:71], v13 offset:25600
    v_mfma_f32_16x16x32_bf16 v[36:39], v[108:111], v[156:159], v[36:39]
    s_waitcnt vmcnt(18) lgkmcnt(4)
    v_mfma_f32_16x16x32_bf16 v[16:19], v[40:43], v[160:163], v[16:19]
    ds_read_b128 v[76:79], v13 offset:27648
    v_mfma_f32_16x16x32_bf16 v[20:23], v[44:47], v[160:163], v[20:23]
    ds_read_b128 v[80:83], v13 offset:28672
    v_mfma_f32_16x16x32_bf16 v[24:27], v[48:51], v[160:163], v[24:27]
    ds_read_b128 v[84:87], v13 offset:29696
    v_mfma_f32_16x16x32_bf16 v[28:31], v[52:55], v[160:163], v[28:31]
    ds_read_b128 v[88:91], v13 offset:30720
    v_mfma_f32_16x16x32_bf16 v[32:35], v[72:75], v[160:163], v[32:35]
    ds_read_b128 v[108:111], v13 offset:35840
    s_waitcnt lgkmcnt(5)
    v_mfma_f32_16x16x32_bf16 v[16:19], v[56:59], v[164:167], v[16:19]
    ds_read_b128 v[92:95], v13 offset:31744
    v_mfma_f32_16x16x32_bf16 v[20:23], v[60:63], v[164:167], v[20:23]
    ds_read_b128 v[96:99], v13 offset:32768
    v_mfma_f32_16x16x32_bf16 v[24:27], v[64:67], v[164:167], v[24:27]
    ds_read_b128 v[100:103], v13 offset:33792
    v_mfma_f32_16x16x32_bf16 v[28:31], v[68:71], v[164:167], v[28:31]
    ds_read_b128 v[104:107], v13 offset:34816
    v_mfma_f32_16x16x32_bf16 v[36:39], v[72:75], v[164:167], v[36:39]
    s_waitcnt vmcnt(16) lgkmcnt(0)
    s_barrier
    v_mfma_f32_16x16x32_bf16 v[16:19], v[76:79], v[168:171], v[16:19]
    ds_read_b128 v[40:43], v14 offset:0
    v_mfma_f32_16x16x32_bf16 v[20:23], v[80:83], v[168:171], v[20:23]
    ds_read_b128 v[44:47], v14 offset:1024
    v_mfma_f32_16x16x32_bf16 v[24:27], v[84:87], v[168:171], v[24:27]
    ds_read_b128 v[48:51], v14 offset:2048
    v_mfma_f32_16x16x32_bf16 v[28:31], v[88:91], v[168:171], v[28:31]
    ds_read_b128 v[52:55], v14 offset:3072
    v_mfma_f32_16x16x32_bf16 v[32:35], v[108:111], v[168:171], v[32:35]
    ds_read_b128 v[72:75], v14 offset:8192
    v_mfma_f32_16x16x32_bf16 v[16:19], v[92:95], v[172:175], v[16:19]
    ds_read_b128 v[56:59], v14 offset:4096
    v_mfma_f32_16x16x32_bf16 v[20:23], v[96:99], v[172:175], v[20:23]
    ds_read_b128 v[60:63], v14 offset:5120
    v_mfma_f32_16x16x32_bf16 v[24:27], v[100:103], v[172:175], v[24:27]
    ds_read_b128 v[64:67], v14 offset:6144
    v_mfma_f32_16x16x32_bf16 v[28:31], v[104:107], v[172:175], v[28:31]
    ds_read_b128 v[68:71], v14 offset:7168
    v_mfma_f32_16x16x32_bf16 v[36:39], v[108:111], v[172:175], v[36:39]
    s_waitcnt vmcnt(12) lgkmcnt(4)
    v_mfma_f32_16x16x32_bf16 v[16:19], v[40:43], v[176:179], v[16:19]
    ds_read_b128 v[76:79], v14 offset:9216
    v_mfma_f32_16x16x32_bf16 v[20:23], v[44:47], v[176:179], v[20:23]
    ds_read_b128 v[80:83], v14 offset:10240
    v_mfma_f32_16x16x32_bf16 v[24:27], v[48:51], v[176:179], v[24:27]
    ds_read_b128 v[84:87], v14 offset:11264
    v_mfma_f32_16x16x32_bf16 v[28:31], v[52:55], v[176:179], v[28:31]
    ds_read_b128 v[88:91], v14 offset:12288
    v_mfma_f32_16x16x32_bf16 v[32:35], v[72:75], v[176:179], v[32:35]
    ds_read_b128 v[108:111], v14 offset:17408
    s_waitcnt lgkmcnt(5)
    v_mfma_f32_16x16x32_bf16 v[16:19], v[56:59], v[180:183], v[16:19]
    ds_read_b128 v[92:95], v14 offset:13312
    v_mfma_f32_16x16x32_bf16 v[20:23], v[60:63], v[180:183], v[20:23]
    ds_read_b128 v[96:99], v14 offset:14336
    v_mfma_f32_16x16x32_bf16 v[24:27], v[64:67], v[180:183], v[24:27]
    ds_read_b128 v[100:103], v14 offset:15360
    v_mfma_f32_16x16x32_bf16 v[28:31], v[68:71], v[180:183], v[28:31]
    ds_read_b128 v[104:107], v14 offset:16384
    v_mfma_f32_16x16x32_bf16 v[36:39], v[72:75], v[180:183], v[36:39]
    s_waitcnt vmcnt(8) lgkmcnt(4)
    v_mfma_f32_16x16x32_bf16 v[16:19], v[76:79], v[184:187], v[16:19]
    ds_read_b128 v[40:43], v14 offset:18432
    v_mfma_f32_16x16x32_bf16 v[20:23], v[80:83], v[184:187], v[20:23]
    ds_read_b128 v[44:47], v14 offset:19456
    v_mfma_f32_16x16x32_bf16 v[24:27], v[84:87], v[184:187], v[24:27]
    ds_read_b128 v[48:51], v14 offset:20480
    v_mfma_f32_16x16x32_bf16 v[28:31], v[88:91], v[184:187], v[28:31]
    ds_read_b128 v[52:55], v14 offset:21504
    v_mfma_f32_16x16x32_bf16 v[32:35], v[108:111], v[184:187], v[32:35]
    ds_read_b128 v[72:75], v14 offset:26624
    s_waitcnt lgkmcnt(5)
    v_mfma_f32_16x16x32_bf16 v[16:19], v[92:95], v[188:191], v[16:19]
    ds_read_b128 v[56:59], v14 offset:22528
    v_mfma_f32_16x16x32_bf16 v[20:23], v[96:99], v[188:191], v[20:23]
    ds_read_b128 v[60:63], v14 offset:23552
    v_mfma_f32_16x16x32_bf16 v[24:27], v[100:103], v[188:191], v[24:27]
    ds_read_b128 v[64:67], v14 offset:24576
    v_mfma_f32_16x16x32_bf16 v[28:31], v[104:107], v[188:191], v[28:31]
    ds_read_b128 v[68:71], v14 offset:25600
    v_mfma_f32_16x16x32_bf16 v[36:39], v[108:111], v[188:191], v[36:39]
    s_waitcnt vmcnt(4) lgkmcnt(4)
    v_mfma_f32_16x16x32_bf16 v[16:19], v[40:43], v[192:195], v[16:19]
    ds_read_b128 v[76:79], v14 offset:27648
    v_mfma_f32_16x16x32_bf16 v[20:23], v[44:47], v[192:195], v[20:23]
    ds_read_b128 v[80:83], v14 offset:28672
    v_mfma_f32_16x16x32_bf16 v[24:27], v[48:51], v[192:195], v[24:27]
    ds_read_b128 v[84:87], v14 offset:29696
    v_mfma_f32_16x16x32_bf16 v[28:31], v[52:55], v[192:195], v[28:31]
    ds_read_b128 v[88:91], v14 offset:30720
    v_mfma_f32_16x16x32_bf16 v[32:35], v[72:75], v[192:195], v[32:35]
    ds_read_b128 v[108:111], v14 offset:35840
    s_waitcnt lgkmcnt(5)
    v_mfma_f32_16x16x32_bf16 v[16:19], v[56:59], v[196:199], v[16:19]
    ds_read_b128 v[92:95], v14 offset:31744
    v_mfma_f32_16x16x32_bf16 v[20:23], v[60:63], v[196:199], v[20:23]
    ds_read_b128 v[96:99], v14 offset:32768
    v_mfma_f32_16x16x32_bf16 v[24:27], v[64:67], v[196:199], v[24:27]
    ds_read_b128 v[100:103], v14 offset:33792
    v_mfma_f32_16x16x32_bf16 v[28:31], v[68:71], v[196:199], v[28:31]
    ds_read_b128 v[104:107], v14 offset:34816
    v_mfma_f32_16x16x32_bf16 v[36:39], v[72:75], v[196:199], v[36:39]
    s_waitcnt vmcnt(0) lgkmcnt(4)
    v_mfma_f32_16x16x32_bf16 v[16:19], v[76:79], v[200:203], v[16:19]
    v_mfma_f32_16x16x32_bf16 v[20:23], v[80:83], v[200:203], v[20:23]
    v_mfma_f32_16x16x32_bf16 v[24:27], v[84:87], v[200:203], v[24:27]
    v_mfma_f32_16x16x32_bf16 v[28:31], v[88:91], v[200:203], v[28:31]
    v_mfma_f32_16x16x32_bf16 v[32:35], v[108:111], v[200:203], v[32:35]
    s_waitcnt lgkmcnt(0)
    v_mfma_f32_16x16x32_bf16 v[16:19], v[92:95], v[204:207], v[16:19]
    v_mfma_f32_16x16x32_bf16 v[20:23], v[96:99], v[204:207], v[20:23]
    v_mfma_f32_16x16x32_bf16 v[24:27], v[100:103], v[204:207], v[24:27]
    v_mfma_f32_16x16x32_bf16 v[28:31], v[104:107], v[204:207], v[28:31]
    v_mfma_f32_16x16x32_bf16 v[36:39], v[108:111], v[204:207], v[36:39]
    s_nop 3
    v_cvt_pk_bf16_f32 v208, v16, v17
    v_cvt_pk_bf16_f32 v209, v18, v19
    v_cvt_pk_bf16_f32 v210, v20, v21
    v_cvt_pk_bf16_f32 v211, v22, v23
    v_cvt_pk_bf16_f32 v212, v24, v25
    v_cvt_pk_bf16_f32 v213, v26, v27
    v_cvt_pk_bf16_f32 v214, v28, v29
    v_cvt_pk_bf16_f32 v215, v30, v31
    s_cmp_eq_u32 s22, 1
    s_cbranch_scc1 L_fin_p5
    buffer_store_dwordx4 v[208:211], v4, s[4:7], s34 offen offset:0 sc1
    buffer_store_dwordx4 v[212:215], v4, s[4:7], s34 offen offset:1024 sc1
    v_permlane32_swap_b32 v36, v220
    v_permlane32_swap_b32 v37, v221
    v_permlane32_swap_b32 v38, v222
    v_permlane32_swap_b32 v39, v223
    v_pk_add_f32 v[32:33], v[32:33], v[220:221]
    v_pk_add_f32 v[34:35], v[34:35], v[222:223]
    v_cvt_pk_bf16_f32 v216, v32, v33
    v_cvt_pk_bf16_f32 v217, v34, v35
    buffer_store_dwordx2 v[216:217], v5, s[4:7], s34 offen sc1
    v_cndmask_b32 v222, 0, v216, s[40:41]
    v_cndmask_b32 v223, 0, v217, s[40:41]
    v_dot2_f32_bf16 v220, v208, v11, 0
    v_dot2_f32_bf16 v221, v208, v208, 0
    v_dot2_f32_bf16 v224, v209, v11, 0
    v_dot2_f32_bf16 v225, v209, v209, 0
    v_dot2_f32_bf16 v220, v210, v11, v220
    v_dot2_f32_bf16 v221, v210, v210, v221
    v_dot2_f32_bf16 v224, v211, v11, v224
    v_dot2_f32_bf16 v225, v211, v211, v225
    v_dot2_f32_bf16 v220, v212, v11, v220
    v_dot2_f32_bf16 v221, v212, v212, v221
    v_dot2_f32_bf16 v224, v213, v11, v224
    v_dot2_f32_bf16 v225, v213, v213, v225
    v_dot2_f32_bf16 v220, v214, v11, v220
    v_dot2_f32_bf16 v221, v214, v214, v221
    v_dot2_f32_bf16 v224, v215, v11, v224
    v_dot2_f32_bf16 v225, v215, v215, v225
    v_dot2_f32_bf16 v220, v222, v11, v220
    v_dot2_f32_bf16 v221, v222, v222, v221
    v_dot2_f32_bf16 v224, v223, v11, v224
    v_dot2_f32_bf16 v225, v223, v223, v225
    s_nop 2
    v_pk_add_f32 v[220:221], v[220:221], v[224:225]
    v_mov_b32 v222, v220
    v_mov_b32 v223, v221
    s_nop 1
    v_permlane32_swap_b32 v220, v222
    v_permlane32_swap_b32 v221, v223
    v_add_f32 v220, v220, v222
    v_add_f32 v221, v221, v223
    v_mov_b32 v222, v220
    v_mov_b32 v223, v221
    s_nop 1
    v_permlane16_swap_b32 v220, v222
    v_permlane16_swap_b32 v221, v223
    v_add_f32 v220, v220, v222
    v_add_f32 v221, v221, v223
    buffer_store_dwordx2 v[220:221], v10, s[4:7], s39 offen sc1
    s_barrier
    s_mov_b32 s22, 1
    s_mov_b32 s21, 0x1c00000
    s_branch L_m_cl
L_fin_p5:
    buffer_store_dwordx4 v[208:211], v4, s[16:19], s34 offen offset:0
    buffer_store_dwordx4 v[212:215], v4, s[16:19], s34 offen offset:64
    v_permlane32_swap_b32 v36, v220
    v_permlane32_swap_b32 v37, v221
    v_permlane32_swap_b32 v38, v222
    v_permlane32_swap_b32 v39, v223
    v_pk_add_f32 v[32:33], v[32:33], v[220:221]
    v_pk_add_f32 v[34:35], v[34:35], v[222:223]
    v_cvt_pk_bf16_f32 v216, v32, v33
    v_cvt_pk_bf16_f32 v217, v34, v35
    buffer_store_dwordx2 v[216:217], v5, s[16:19], s34 offen offset:128
    s_endpgm
L_m_l1:
    s_and_b32 s25, s2, 7
    s_lshr_b32 s26, s2, 3
    s_lshr_b32 s23, s25, 1
    s_lshl_b32 s23, s23, 2
    s_lshr_b32 s27, s26, 3
    s_add_u32 s23, s23, s27
    s_and_b32 s24, s25, 1
    s_lshl_b32 s24, s24, 3
    s_and_b32 s27, s26, 7
    s_add_u32 s24, s24, s27
    s_mul_i32 s29, s24, 129024
    s_lshl_b32 s30, s20, 12
    s_add_u32 s29, s29, s30
    s_add_u32 s29, s29, 0x3800000
    s_lshl_b32 s31, s23, 3
    s_max_u32 s31, s31, 1
    s_sub_u32 s31, s31, 1
    s_mul_i32 s31, s31, 18432
    s_add_u32 s31, s31, 0x0
    s_lshl_b32 s35, s20, 10
    s_and_b32 s36, s35, 1024
    v_and_b32 v70, 48, v1
    v_lshrrev_b32 v71, 8, v1
    v_lshl_add_u32 v70, v71, 6, v70
    v_bfe_u32 v71, v1, 6, 2
    v_lshl_add_u32 v70, v71, 8, v70
    s_barrier
    s_add_u32 m0, s35, 131072
    s_add_u32 s34, s31, s35
    s_add_u32 s34, s34, 0
    buffer_load_dwordx4 v1, s[4:7], s34 offen sc1 lds
    s_add_u32 m0, s30, 0
    s_add_u32 s34, s29, 0
    buffer_load_dwordx4 v70, s[4:7], s34 offen offset:0 lds
    buffer_load_dwordx4 v70, s[4:7], s34 offen offset:1024 lds
    buffer_load_dwordx4 v70, s[4:7], s34 offen offset:2048 lds
    buffer_load_dwordx4 v70, s[4:7], s34 offen offset:3072 lds
    s_add_u32 m0, s30, 16384
    s_add_u32 s34, s29, 16384
    buffer_load_dwordx4 v70, s[4:7], s34 offen offset:0 lds
    buffer_load_dwordx4 v70, s[4:7], s34 offen offset:1024 lds
    buffer_load_dwordx4 v70, s[4:7], s34 offen offset:2048 lds
    buffer_load_dwordx4 v70, s[4:7], s34 offen offset:3072 lds
    s_waitcnt vmcnt(4) lgkmcnt(0)
    s_barrier
    s_add_u32 m0, s35, 135168
    s_add_u32 s34, s31, s35
    s_add_u32 s34, s34, 4096
    buffer_load_dwordx4 v1, s[4:7], s34 offen sc1 lds
    s_add_u32 m0, s30, 32768
    s_add_u32 s34, s29, 32768
    buffer_load_dwordx4 v70, s[4:7], s34 offen offset:0 lds
    buffer_load_dwordx4 v70, s[4:7], s34 offen offset:1024 lds
    buffer_load_dwordx4 v70, s[4:7], s34 offen offset:2048 lds
    buffer_load_dwordx4 v70, s[4:7], s34 offen offset:3072 lds
    s_add_u32 m0, s30, 49152
    s_add_u32 s34, s29, 49152
    buffer_load_dwordx4 v70, s[4:7], s34 offen offset:0 lds
    buffer_load_dwordx4 v70, s[4:7], s34 offen offset:1024 lds
    buffer_load_dwordx4 v70, s[4:7], s34 offen offset:2048 lds
    buffer_load_dwordx4 v70, s[4:7], s34 offen offset:3072 lds
    s_cmp_lt_u32 s2, 144
    s_cbranch_scc1 L_p0_t1
    s_cmp_ge_u32 s2, 216
    s_cbranch_scc1 L_p0_t2
    ds_read_b64_tr_b16 v[16:17], v4 offset:0
    ds_read_b64_tr_b16 v[18:19], v4 offset:2048
    ds_read_b64_tr_b16 v[20:21], v4 offset:4096
    ds_read_b64_tr_b16 v[22:23], v4 offset:6144
    ds_read_b64_tr_b16 v[24:25], v4 offset:8192
    ds_read_b64_tr_b16 v[26:27], v4 offset:10240
    ds_read_b64_tr_b16 v[28:29], v4 offset:12288
    ds_read_b64_tr_b16 v[30:31], v4 offset:14336
    ds_read_b64_tr_b16 v[32:33], v4 offset:18432
    ds_read_b64_tr_b16 v[34:35], v4 offset:20480
    ds_read_b64_tr_b16 v[36:37], v4 offset:22528
    ds_read_b64_tr_b16 v[38:39], v4 offset:24576
    ds_read_b64_tr_b16 v[40:41], v4 offset:26624
    ds_read_b64_tr_b16 v[42:43], v4 offset:28672
    ds_read_b64_tr_b16 v[44:45], v4 offset:30720
    ds_read_b64_tr_b16 v[46:47], v4 offset:32768
    ds_read_b64_tr_b16 v[48:49], v5 offset:16384
    ds_read_b64_tr_b16 v[50:51], v5 offset:34816
    s_branch L_p0_t2
L_p0_t1:
    ds_read_b64_tr_b16 v[16:17], v4 offset:0
    ds_read_b64_tr_b16 v[18:19], v4 offset:512
    ds_read_b64_tr_b16 v[20:21], v4 offset:4096
    ds_read_b64_tr_b16 v[22:23], v4 offset:4608
    ds_read_b64_tr_b16 v[24:25], v4 offset:9216
    ds_read_b64_tr_b16 v[26:27], v4 offset:9728
    ds_read_b64_tr_b16 v[28:29], v4 offset:13312
    ds_read_b64_tr_b16 v[30:31], v4 offset:13824
    ds_read_b64_tr_b16 v[32:33], v4 offset:18432
    ds_read_b64_tr_b16 v[34:35], v4 offset:18944
    ds_read_b64_tr_b16 v[36:37], v4 offset:22528
    ds_read_b64_tr_b16 v[38:39], v4 offset:23040
    ds_read_b64_tr_b16 v[40:41], v4 offset:27648
    ds_read_b64_tr_b16 v[42:43], v4 offset:28160
    ds_read_b64_tr_b16 v[44:45], v4 offset:31744
    ds_read_b64_tr_b16 v[46:47], v4 offset:32256
    ds_read_b64_tr_b16 v[48:49], v5 offset:8192
    ds_read_b64_tr_b16 v[50:51], v5 offset:8704
L_p0_t2:
    s_waitcnt lgkmcnt(0)
    s_waitcnt vmcnt(9) lgkmcnt(0)
    s_barrier
    s_add_u32 m0, s35, 139264
    s_add_u32 s34, s31, s35
    s_add_u32 s34, s34, 8192
    buffer_load_dwordx4 v1, s[4:7], s34 offen sc1 lds
    v_lshrrev_b32 v60, 8, v1
    v_bfe_u32 v61, v1, 7, 1
    v_bfe_u32 v62, v1, 4, 3
    v_cmp_gt_u32 vcc, 3, v60
    v_mul_u32_u24 v61, 80, v61
    v_lshl_add_u32 v61, v62, 3, v61
    v_lshrrev_b32 v63, 1, v62
    v_and_b32 v62, 1, v62
    v_lshl_add_u32 v62, v62, 3, 64
    v_cndmask_b32 v60, v63, v60, vcc
    v_cndmask_b32 v61, v62, v61, vcc
    v_mul_u32_u24 v60, 2304, v60
    v_add_u32 v69, v60, v61
    v_lshrrev_b32 v68, 1, v1
    s_mul_i32 s34, s24, 144
    s_add_u32 s34, s34, 0x4400000
    buffer_load_dwordx2 v[60:61], v69, s[4:7], s34 offen
    s_mul_i32 s34, s24, 144
    s_add_u32 s34, s34, 0x4402000
    buffer_load_dwordx2 v[62:63], v69, s[4:7], s34 offen
    s_mul_i32 s34, s24, 144
    s_add_u32 s34, s34, 0x4404000
    buffer_load_dwordx2 v[64:65], v69, s[4:7], s34 offen
    s_mul_i32 s34, s24, 144
    s_add_u32 s34, s34, 0x4406000
    buffer_load_dwordx2 v[66:67], v69, s[4:7], s34 offen
    s_add_u32 m0, s30, 65536
    s_add_u32 s34, s29, 65536
    buffer_load_dwordx4 v70, s[4:7], s34 offen offset:0 lds
    buffer_load_dwordx4 v70, s[4:7], s34 offen offset:1024 lds
    buffer_load_dwordx4 v70, s[4:7], s34 offen offset:2048 lds
    buffer_load_dwordx4 v70, s[4:7], s34 offen offset:3072 lds
    s_waitcnt vmcnt(13) lgkmcnt(0)
    s_barrier
    s_add_u32 m0, s30, 81920
    s_add_u32 s34, s29, 81920
    buffer_load_dwordx4 v70, s[4:7], s34 offen offset:0 lds
    buffer_load_dwordx4 v70, s[4:7], s34 offen offset:1024 lds
    buffer_load_dwordx4 v70, s[4:7], s34 offen offset:2048 lds
    buffer_load_dwordx4 v70, s[4:7], s34 offen offset:3072 lds
    s_waitcnt vmcnt(13) lgkmcnt(0)
    s_barrier
    s_add_u32 m0, s35, 143360
    s_add_u32 s34, s31, s35
    s_add_u32 s34, s34, 12288
    buffer_load_dwordx4 v1, s[4:7], s34 offen sc1 lds
    s_add_u32 m0, s30, 98304
    s_add_u32 s34, s29, 98304
    buffer_load_dwordx4 v70, s[4:7], s34 offen offset:0 lds
    buffer_load_dwordx4 v70, s[4:7], s34 offen offset:1024 lds
    buffer_load_dwordx4 v70, s[4:7], s34 offen offset:2048 lds
    buffer_load_dwordx4 v70, s[4:7], s34 offen offset:3072 lds
    s_waitcnt vmcnt(13)
    v_add_f32 v60, v60, v62
    v_add_f32 v61, v61, v63
    v_add_f32 v64, v64, v66
    v_add_f32 v65, v65, v67
    v_add_f32 v60, v60, v64
    v_add_f32 v61, v61, v65
    v_cmp_gt_u32 vcc, 864, v1
    v_add_u32 v68, 161792, v68
    s_nop 0
    v_cndmask_b32 v60, 0, v60, vcc
    v_cndmask_b32 v61, 0, v61, vcc
    ds_write_b64 v68, v[60:61]
    s_waitcnt vmcnt(9) lgkmcnt(0)
    s_barrier
    s_add_u32 m0, s36, 147456
    s_add_u32 s34, s31, s36
    s_add_u32 s34, s34, 16384
    buffer_load_dwordx4 v1, s[4:7], s34 offen sc1 lds
    s_add_u32 m0, s30, 114688
    s_add_u32 s34, s29, 114688
    buffer_load_dwordx4 v70, s[4:7], s34 offen offset:0 lds
    buffer_load_dwordx4 v70, s[4:7], s34 offen offset:1024 lds
    buffer_load_dwordx4 v70, s[4:7], s34 offen offset:2048 lds
    buffer_load_dwordx4 v70, s[4:7], s34 offen offset:3072 lds
    s_waitcnt vmcnt(10) lgkmcnt(0)
    s_barrier
    buffer_store_dwordx4 v[16:19], v9, s[4:7], s37 offen sc1
    buffer_store_dwordx4 v[20:23], v10, s[4:7], s38 offen sc1
    buffer_store_dwordx4 v[24:27], v9, s[4:7], s39 offen sc1
    buffer_store_dwordx4 v[28:31], v10, s[4:7], s40 offen sc1
    s_waitcnt vmcnt(9) lgkmcnt(0)
    s_barrier
    buffer_store_dwordx4 v[32:35], v9, s[4:7], s41 offen sc1
    buffer_store_dwordx4 v[36:39], v10, s[4:7], s42 offen sc1
    buffer_store_dwordx4 v[40:43], v9, s[4:7], s43 offen sc1
    s_waitcnt vmcnt(7) lgkmcnt(0)
    s_barrier
    s_mov_b32 s46, 0x4502000
    v_mov_b32 v4, 0
    s_mov_b32 s60, 65536
L_poll_wo:
    buffer_load_dword v5, v4, s[4:7], s46 offen sc1
    s_waitcnt vmcnt(0)
    v_cmp_gt_u32 vcc, 18, v5
    s_sub_u32 s60, s60, 1
    s_cbranch_scc1 L_pd_wo
    s_cbranch_vccz L_pd_wo
    s_sleep 4
    s_branch L_poll_wo
L_pd_wo:
    buffer_store_dwordx4 v[44:47], v10, s[4:7], s47 offen sc1
    buffer_store_dwordx4 v[48:51], v14, s[4:7], s48 offen sc1
    v_dot2_f32_bf16 v12, v16, v11, 0
    v_dot2_f32_bf16 v13, v17, v11, 0
    v_dot2_f32_bf16 v12, v18, v11, v12
    v_dot2_f32_bf16 v13, v19, v11, v13
    v_dot2_f32_bf16 v12, v20, v11, v12
    v_dot2_f32_bf16 v13, v21, v11, v13
    v_dot2_f32_bf16 v12, v22, v11, v12
    v_dot2_f32_bf16 v13, v23, v11, v13
    v_dot2_f32_bf16 v12, v24, v11, v12
    v_dot2_f32_bf16 v13, v25, v11, v13
    v_dot2_f32_bf16 v12, v26, v11, v12
    v_dot2_f32_bf16 v13, v27, v11, v13
    v_dot2_f32_bf16 v12, v28, v11, v12
    v_dot2_f32_bf16 v13, v29, v11, v13
    v_dot2_f32_bf16 v12, v30, v11, v12
    v_dot2_f32_bf16 v13, v31, v11, v13
    v_dot2_f32_bf16 v12, v32, v11, v12
    v_dot2_f32_bf16 v13, v33, v11, v13
    v_dot2_f32_bf16 v12, v34, v11, v12
    v_dot2_f32_bf16 v13, v35, v11, v13
    v_dot2_f32_bf16 v12, v36, v11, v12
    v_dot2_f32_bf16 v13, v37, v11, v13
    v_dot2_f32_bf16 v12, v38, v11, v12
    v_dot2_f32_bf16 v13, v39, v11, v13
    v_dot2_f32_bf16 v12, v40, v11, v12
    v_dot2_f32_bf16 v13, v41, v11, v13
    v_dot2_f32_bf16 v12, v42, v11, v12
    v_dot2_f32_bf16 v13, v43, v11, v13
    v_dot2_f32_bf16 v12, v44, v11, v12
    v_dot2_f32_bf16 v13, v45, v11, v13
    v_dot2_f32_bf16 v12, v46, v11, v12
    v_dot2_f32_bf16 v13, v47, v11, v13
    v_dot2_f32_bf16 v12, v48, v11, v12
    v_dot2_f32_bf16 v13, v49, v11, v13
    v_dot2_f32_bf16 v12, v50, v11, v12
    v_dot2_f32_bf16 v13, v51, v11, v13
    s_nop 2
    v_add_f32 v12, v12, v13
    v_mov_b32 v13, v12
    s_nop 1
    v_permlane32_swap_b32 v12, v13
    v_add_f32 v12, v12, v13
    v_mov_b32 v13, v12
    s_nop 1
    v_permlane16_swap_b32 v12, v13
    v_add_f32 v12, v12, v13
    buffer_store_dword v12, v15, s[4:7], s49 offen sc1
    s_barrier
L_m_ll:
    s_and_b32 s25, s2, 7
    s_lshr_b32 s26, s2, 3
    s_lshr_b32 s23, s25, 1
    s_lshl_b32 s23, s23, 3
    s_lshr_b32 s27, s26, 2
    s_add_u32 s23, s23, s27
    s_and_b32 s24, s25, 1
    s_lshl_b32 s24, s24, 2
    s_and_b32 s27, s26, 3
    s_add_u32 s24, s24, s27
    s_add_u32 s25, s23, s24
    s_and_b32 s25, s25, 3
    s_mul_i32 s29, s24, 82944
    s_add_u32 s29, s29, 0x3a00000
    s_mul_i32 s30, s20, 36864
    s_mul_i32 s31, s20, 18432
    s_add_u32 s31, s31, s29
    s_add_u32 m0, s30, 18432
    s_add_u32 s33, s31, 0
    buffer_load_dwordx4 v1, s[4:7], s33 offen offset:0  lds
    buffer_load_dwordx4 v1, s[4:7], s33 offen offset:1024  lds
    buffer_load_dwordx4 v1, s[4:7], s33 offen offset:2048  lds
    buffer_load_dwordx4 v1, s[4:7], s33 offen offset:3072  lds
    s_add_u32 m0, s30, 22528
    s_add_u32 s33, s31, 4096
    buffer_load_dwordx4 v1, s[4:7], s33 offen offset:0  lds
    buffer_load_dwordx4 v1, s[4:7], s33 offen offset:1024  lds
    buffer_load_dwordx4 v1, s[4:7], s33 offen offset:2048  lds
    buffer_load_dwordx4 v1, s[4:7], s33 offen offset:3072  lds
    s_add_u32 m0, s30, 26624
    s_add_u32 s33, s31, 8192
    buffer_load_dwordx4 v1, s[4:7], s33 offen offset:0  lds
    buffer_load_dwordx4 v1, s[4:7], s33 offen offset:1024  lds
    buffer_load_dwordx4 v1, s[4:7], s33 offen offset:2048  lds
    buffer_load_dwordx4 v1, s[4:7], s33 offen offset:3072  lds
    s_add_u32 m0, s30, 30720
    s_add_u32 s33, s31, 12288
    buffer_load_dwordx4 v1, s[4:7], s33 offen offset:0  lds
    buffer_load_dwordx4 v1, s[4:7], s33 offen offset:1024  lds
    buffer_load_dwordx4 v1, s[4:7], s33 offen offset:2048  lds
    buffer_load_dwordx4 v1, s[4:7], s33 offen offset:3072  lds
    s_add_u32 m0, s30, 34816
    s_add_u32 s33, s31, 16384
    buffer_load_dwordx4 v1, s[4:7], s33 offen offset:0  lds
    buffer_load_dwordx4 v1, s[4:7], s33 offen offset:1024  lds
    s_mul_i32 s30, s20, 3072
    s_add_u32 s31, s30, s29
    s_waitcnt vmcnt(18)
    s_barrier
    s_add_u32 m0, s30, 147456
    s_add_u32 s33, s31, 73728
    buffer_load_dwordx4 v1, s[4:7], s33 offen offset:0  lds
    buffer_load_dwordx4 v1, s[4:7], s33 offen offset:1024  lds
    buffer_load_dwordx4 v1, s[4:7], s33 offen offset:2048  lds
    s_or_b32 s44, s20, s22
    s_cbranch_scc1 L_p2_ns
    s_and_b32 s44, s2, 15
    s_lshl_b32 s44, s44, 8
    s_add_u32 s44, s44, 0x4501000
    s_add_u32 s44, s44, s4
    s_addc_u32 s45, s5, 0
    s_mov_b32 s56, 1
    s_atomic_add s56, s[44:45], 0
L_p2_ns:
    s_waitcnt vmcnt(0)
    s_barrier
    s_and_b32 s25, s2, 7
    s_lshr_b32 s26, s2, 3
    s_and_b32 s23, s25, 1
    s_lshl_b32 s23, s23, 3
    s_and_b32 s27, s26, 7
    s_add_u32 s23, s23, s27
    s_lshr_b32 s24, s25, 1
    s_lshl_b32 s24, s24, 2
    s_lshr_b32 s27, s26, 3
    s_add_u32 s24, s24, s27
    s_add_u32 s28, s23, s24
    s_and_b32 s28, s28, 3
    s_lshl_b32 s30, s20, 12
    s_lshr_b32 s33, s20, 1
    s_mul_i32 s31, s33, 36864
    s_and_b32 s33, s20, 1
    s_lshl_b32 s33, s33, 10
    s_add_u32 s33, s33, 16384
    s_add_u32 s31, s31, s33
    s_sub_u32 s49, s33, s30
    s_mul_i32 s34, s24, 331776
    s_add_u32 s34, s34, s30
    s_add_u32 s34, s34, 0x3b00000
    s_lshl_b32 s35, s23, 3
    s_lshl_b32 s33, s20, 1
    s_add_u32 s35, s35, s33
    s_mul_i32 s35, s35, 18432
    s_add_u32 s35, s35, s21
    s_add_u32 s35, s35, 0x300000
    s_mul_i32 s36, s24, 589824
    s_add_u32 s36, s36, s30
    s_add_u32 s36, s36, s21
    s_add_u32 s36, s36, 0x900000
    v_add_u32 v2, 16384, v1
    s_add_u32 s33, s30, 18432
    v_add_u32 v6, s33, v1
    v_add_u32 v7, 73728, v6
    s_lshl_b32 s29, s23, 2
    s_add_u32 s29, s29, s20
    s_lshl_b32 s29, s29, 12
    s_add_u32 s29, s29, s21
    s_add_u32 s29, s29, 0x1b40000
    v_and_b32 v3, 48, v1
    v_lshrrev_b32 v8, 8, v1
    v_lshl_add_u32 v3, v8, 6, v3
    v_bfe_u32 v8, v1, 6, 2
    v_lshl_add_u32 v3, v8, 8, v3
    s_lshl_b32 s33, s23, 7
    s_lshl_b32 s37, s20, 5
    s_add_u32 s33, s33, s37
    v_lshrrev_b32 v8, 7, v1
    v_add_u32 v8, s33, v8
    v_lshlrev_b32 v8, 12, v8
    v_lshrrev_b32 v9, 8, v1
    v_bfe_u32 v10, v1, 4, 3
    v_xor_b32 v9, v9, v10
    v_lshl_add_u32 v8, v9, 4, v8
    v_xor_b32 v9, 64, v8
    v_add_u32 v9, 31744, v9
    v_add_u32 v10, 63488, v8
    v_add_u32 v11, 63488, v9
    s_cmp_eq_u32 s28, 0
    s_cselect_b32 s44, 4, 0
    s_cmp_eq_u32 s28, 1
    s_cselect_b32 s45, 5, 1
    s_cmp_eq_u32 s28, 2
    s_cselect_b32 s46, 6, 2
    s_cmp_eq_u32 s28, 3
    s_cselect_b32 s47, 7, 3
    s_lshl_b32 s33, s20, 4
    s_add_u32 s33, s33, s24
    s_lshl_b32 s54, s22, 7
    s_add_u32 s54, s54, s33
    s_lshl_b32 s54, s54, 8
    s_add_u32 s54, s54, 0x450c000
    s_add_u32 s54, s54, s4
    s_addc_u32 s55, s5, 0
    s_mov_b32 s33, 0x4501000
    v_and_b32 v4, 0xf0, v1
    v_lshlrev_b32 v4, 4, v4
    s_mov_b32 s60, 65536
L_poll_wr:
    buffer_load_dword v5, v4, s[4:7], s33 offen sc1
    s_waitcnt vmcnt(0)
    v_cmp_gt_u32 vcc, 16, v5
    s_sub_u32 s60, s60, 1
    s_cbranch_scc1 L_pd_wr
    s_cbranch_vccz L_pd_wr
    s_sleep 4
    s_branch L_poll_wr
L_pd_wr:
    s_min_u32 s33, s20, 2
    s_lshl_b32 s33, s33, 9
    v_lshrrev_b32 v4, 1, v1
    v_add_u32 v4, s33, v4
    s_lshl_b32 s51, s24, 12
    s_add_u32 s51, s51, 0x4410000
    buffer_load_dwordx2 v[60:61], v4, s[4:7], s51 offen offset:0
    buffer_load_dwordx2 v[62:63], v4, s[4:7], s51 offen offset:1152
    s_mov_b32 s48, 0
    s_mul_i32 s50, s48, 18432
    s_add_u32 s50, s50, s34
    s_add_u32 m0, s30, 0
    s_mov_b32 s53, s50
    buffer_load_dwordx4 v1, s[4:7], s50 offen offset:0  lds
    buffer_load_dwordx4 v1, s[4:7], s50 offen offset:1024  lds
    buffer_load_dwordx4 v1, s[4:7], s50 offen offset:2048  lds
    buffer_load_dwordx4 v1, s[4:7], s50 offen offset:3072  lds
    s_mov_b32 s48, 1
    s_mul_i32 s50, s48, 18432
    s_add_u32 s50, s50, s34
    s_cmp_ge_u32 s20, 2
    s_cselect_b32 s52, s50, s53
    s_add_u32 m0, s31, 0
    s_add_u32 s52, s52, s49
    buffer_load_dwordx4 v1, s[4:7], s52 offen  lds
    s_add_u32 m0, s30, 36864
    s_mov_b32 s53, s50
    buffer_load_dwordx4 v1, s[4:7], s50 offen offset:0  lds
    buffer_load_dwordx4 v1, s[4:7], s50 offen offset:1024  lds
    buffer_load_dwordx4 v1, s[4:7], s50 offen offset:2048  lds
    buffer_load_dwordx4 v1, s[4:7], s50 offen offset:3072  lds
    s_mov_b32 m0, 161280
    v_lshrrev_b32 v5, 2, v1
    s_lshl_b32 s33, s23, 8
    buffer_load_dword v5, s[12:15], s33 offen lds
    s_waitcnt vmcnt(10)
    v_add_u32 v4, 159744, v4
    v_add_f32 v60, v60, v62
    v_add_f32 v61, v61, v63
    ds_write_b64 v4, v[60:61]
    s_waitcnt lgkmcnt(0)
    s_barrier
    s_mov_b32 s48, 2
    s_mul_i32 s50, s48, 18432
    s_add_u32 s50, s50, s34
    s_add_u32 m0, s30, 73728
    s_mov_b32 s53, s50
    buffer_load_dwordx4 v1, s[4:7], s50 offen offset:0  lds
    buffer_load_dwordx4 v1, s[4:7], s50 offen offset:1024  lds
    buffer_load_dwordx4 v1, s[4:7], s50 offen offset:2048  lds
    buffer_load_dwordx4 v1, s[4:7], s50 offen offset:3072  lds
    s_mov_b32 s48, 3
    s_mul_i32 s50, s48, 18432
    s_add_u32 s50, s50, s34
    s_cmp_ge_u32 s20, 2
    s_cselect_b32 s52, s50, s53
    s_add_u32 m0, s31, 73728
    s_add_u32 s52, s52, s49
    buffer_load_dwordx4 v1, s[4:7], s52 offen  lds
    s_add_u32 m0, s30, 110592
    s_mov_b32 s53, s50
    buffer_load_dwordx4 v1, s[4:7], s50 offen offset:0  lds
    buffer_load_dwordx4 v1, s[4:7], s50 offen offset:1024  lds
    buffer_load_dwordx4 v1, s[4:7], s50 offen offset:2048  lds
    buffer_load_dwordx4 v1, s[4:7], s50 offen offset:3072  lds
    s_barrier
    s_add_u32 m0, s30, 18432
    s_add_u32 s51, s35, 0
    buffer_load_dwordx4 v1, s[4:7], s51 offen offset:0 sc1 lds
    buffer_load_dwordx4 v1, s[4:7], s51 offen offset:1024 sc1 lds
    buffer_load_dwordx4 v2, s[4:7], s51 offen offset:2048 sc1 lds
    buffer_load_dwordx4 v2, s[4:7], s51 offen offset:3072 sc1 lds
    s_add_u32 m0, s30, 55296
    s_add_u32 s51, s35, 2048
    buffer_load_dwordx4 v1, s[4:7], s51 offen offset:0 sc1 lds
    buffer_load_dwordx4 v1, s[4:7], s51 offen offset:1024 sc1 lds
    buffer_load_dwordx4 v2, s[4:7], s51 offen offset:2048 sc1 lds
    buffer_load_dwordx4 v2, s[4:7], s51 offen offset:3072 sc1 lds
    s_add_u32 m0, s30, 92160
    s_add_u32 s51, s35, 4096
    buffer_load_dwordx4 v1, s[4:7], s51 offen offset:0 sc1 lds
    buffer_load_dwordx4 v1, s[4:7], s51 offen offset:1024 sc1 lds
    buffer_load_dwordx4 v2, s[4:7], s51 offen offset:2048 sc1 lds
    buffer_load_dwordx4 v2, s[4:7], s51 offen offset:3072 sc1 lds
    s_waitcnt vmcnt(8)
    s_barrier
    s_add_u32 m0, s30, 129024
    s_add_u32 s51, s35, 6144
    buffer_load_dwordx4 v1, s[4:7], s51 offen offset:0 sc1 lds
    buffer_load_dwordx4 v1, s[4:7], s51 offen offset:1024 sc1 lds
    buffer_load_dwordx4 v2, s[4:7], s51 offen offset:2048 sc1 lds
    buffer_load_dwordx4 v2, s[4:7], s51 offen offset:3072 sc1 lds
    s_waitcnt vmcnt(8) lgkmcnt(0)
    s_barrier
    s_mov_b32 s48, 4
    s_mul_i32 s50, s48, 18432
    s_add_u32 s50, s50, s34
    s_add_u32 m0, s30, 0
    s_mov_b32 s53, s50
    buffer_load_dwordx4 v1, s[4:7], s50 offen offset:0  lds
    buffer_load_dwordx4 v1, s[4:7], s50 offen offset:1024  lds
    buffer_load_dwordx4 v1, s[4:7], s50 offen offset:2048  lds
    buffer_load_dwordx4 v1, s[4:7], s50 offen offset:3072  lds
    s_add_u32 m0, s30, 18432
    s_add_u32 s51, s35, 8192
    buffer_load_dwordx4 v1, s[4:7], s51 offen offset:0 sc1 lds
    buffer_load_dwordx4 v1, s[4:7], s51 offen offset:1024 sc1 lds
    buffer_load_dwordx4 v2, s[4:7], s51 offen offset:2048 sc1 lds
    buffer_load_dwordx4 v2, s[4:7], s51 offen offset:3072 sc1 lds
    s_waitcnt vmcnt(12) lgkmcnt(0)
    s_barrier
    s_mov_b32 s48, 5
    s_mul_i32 s50, s48, 18432
    s_add_u32 s50, s50, s34
    s_cmp_ge_u32 s20, 2
    s_cselect_b32 s52, s50, s53
    s_add_u32 m0, s31, 0
    s_add_u32 s52, s52, s49
    buffer_load_dwordx4 v1, s[4:7], s52 offen  lds
    s_add_u32 m0, s30, 36864
    s_mov_b32 s53, s50
    buffer_load_dwordx4 v1, s[4:7], s50 offen offset:0  lds
    buffer_load_dwordx4 v1, s[4:7], s50 offen offset:1024  lds
    buffer_load_dwordx4 v1, s[4:7], s50 offen offset:2048  lds
    buffer_load_dwordx4 v1, s[4:7], s50 offen offset:3072  lds
    s_add_u32 m0, s30, 55296
    s_add_u32 s51, s35, 10240
    buffer_load_dwordx4 v1, s[4:7], s51 offen offset:0 sc1 lds
    buffer_load_dwordx4 v1, s[4:7], s51 offen offset:1024 sc1 lds
    buffer_load_dwordx4 v2, s[4:7], s51 offen offset:2048 sc1 lds
    buffer_load_dwordx4 v2, s[4:7], s51 offen offset:3072 sc1 lds
    s_waitcnt vmcnt(17) lgkmcnt(0)
    s_barrier
    s_mov_b32 s48, 6
    s_mul_i32 s50, s48, 18432
    s_add_u32 s50, s50, s34
    s_add_u32 m0, s30, 73728
    s_mov_b32 s53, s50
    buffer_load_dwordx4 v1, s[4:7], s50 offen offset:0  lds
    buffer_load_dwordx4 v1, s[4:7], s50 offen offset:1024  lds
    buffer_load_dwordx4 v1, s[4:7], s50 offen offset:2048  lds
    buffer_load_dwordx4 v1, s[4:7], s50 offen offset:3072  lds
    s_add_u32 m0, s30, 92160
    s_add_u32 s51, s35, 12288
    buffer_load_dwordx4 v1, s[4:7], s51 offen offset:0 sc1 lds
    buffer_load_dwordx4 v1, s[4:7], s51 offen offset:1024 sc1 lds
    buffer_load_dwordx4 v2, s[4:7], s51 offen offset:2048 sc1 lds
    buffer_load_dwordx4 v2, s[4:7], s51 offen offset:3072 sc1 lds
    s_waitcnt vmcnt(16) lgkmcnt(0)
    s_barrier
    s_mov_b32 s48, 7
    s_mul_i32 s50, s48, 18432
    s_add_u32 s50, s50, s34
    s_cmp_ge_u32 s20, 2
    s_cselect_b32 s52, s50, s53
    s_add_u32 m0, s31, 73728
    s_add_u32 s52, s52, s49
    buffer_load_dwordx4 v1, s[4:7], s52 offen  lds
    s_add_u32 m0, s30, 110592
    s_mov_b32 s53, s50
    buffer_load_dwordx4 v1, s[4:7], s50 offen offset:0  lds
    buffer_load_dwordx4 v1, s[4:7], s50 offen offset:1024  lds
    buffer_load_dwordx4 v1, s[4:7], s50 offen offset:2048  lds
    buffer_load_dwordx4 v1, s[4:7], s50 offen offset:3072  lds
    s_add_u32 m0, s30, 129024
    s_add_u32 s51, s35, 14336
    buffer_load_dwordx4 v1, s[4:7], s51 offen offset:0 sc1 lds
    buffer_load_dwordx4 v1, s[4:7], s51 offen offset:1024 sc1 lds
    buffer_load_dwordx4 v2, s[4:7], s51 offen offset:2048 sc1 lds
    buffer_load_dwordx4 v2, s[4:7], s51 offen offset:3072 sc1 lds
    s_waitcnt vmcnt(17) lgkmcnt(0)
    s_barrier
    s_mov_b32 s48, 8
    s_mul_i32 s50, s48, 18432
    s_add_u32 s50, s50, s34
    s_add_u32 m0, s30, 0
    s_mov_b32 s53, s50
    buffer_load_dwordx4 v1, s[4:7], s50 offen offset:0  lds
    buffer_load_dwordx4 v1, s[4:7], s50 offen offset:1024  lds
    buffer_load_dwordx4 v1, s[4:7], s50 offen offset:2048  lds
    buffer_load_dwordx4 v1, s[4:7], s50 offen offset:3072  lds
    s_add_u32 m0, s30, 18432
    s_add_u32 s51, s35, 16384
    buffer_load_dwordx4 v1, s[4:7], s51 offen offset:0 sc1 lds
    buffer_load_dwordx4 v1, s[4:7], s51 offen offset:1024 sc1 lds
    buffer_load_dwordx4 v2, s[4:7], s51 offen offset:2048 sc1 lds
    buffer_load_dwordx4 v2, s[4:7], s51 offen offset:3072 sc1 lds
    s_waitcnt vmcnt(16) lgkmcnt(0)
    s_barrier
    s_mov_b32 s48, 5
    s_mul_i32 s50, s48, 18432
    s_add_u32 s50, s50, s34
    s_add_u32 s50, s50, 165888
    s_cmp_ge_u32 s20, 2
    s_cselect_b32 s52, s50, s53
    s_add_u32 m0, s31, 0
    s_add_u32 s52, s52, s49
    buffer_load_dwordx4 v1, s[4:7], s52 offen  lds
    s_add_u32 m0, s30, 36864
    s_mov_b32 s53, s50
    buffer_load_dwordx4 v1, s[4:7], s50 offen offset:0  lds
    buffer_load_dwordx4 v1, s[4:7], s50 offen offset:1024  lds
    buffer_load_dwordx4 v1, s[4:7], s50 offen offset:2048  lds
    buffer_load_dwordx4 v1, s[4:7], s50 offen offset:3072  lds
    s_waitcnt vmcnt(13) lgkmcnt(0)
    s_barrier
    s_mov_b32 s48, 6
    s_mul_i32 s50, s48, 18432
    s_add_u32 s50, s50, s34
    s_add_u32 s50, s50, 165888
    s_add_u32 m0, s30, 73728
    s_mov_b32 s53, s50
    buffer_load_dwordx4 v1, s[4:7], s50 offen offset:0  lds
    buffer_load_dwordx4 v1, s[4:7], s50 offen offset:1024  lds
    buffer_load_dwordx4 v1, s[4:7], s50 offen offset:2048  lds
    buffer_load_dwordx4 v1, s[4:7], s50 offen offset:3072  lds
    s_waitcnt vmcnt(8) lgkmcnt(0)
    s_barrier
    s_mov_b32 s48, 7
    s_mul_i32 s50, s48, 18432
    s_add_u32 s50, s50, s34
    s_add_u32 s50, s50, 165888
    s_cmp_ge_u32 s20, 2
    s_cselect_b32 s52, s50, s53
    s_add_u32 m0, s31, 73728
    s_add_u32 s52, s52, s49
    buffer_load_dwordx4 v1, s[4:7], s52 offen  lds
    s_add_u32 m0, s30, 110592
    s_mov_b32 s53, s50
    buffer_load_dwordx4 v1, s[4:7], s50 offen offset:0  lds
    buffer_load_dwordx4 v1, s[4:7], s50 offen offset:1024  lds
    buffer_load_dwordx4 v1, s[4:7], s50 offen offset:2048  lds
    buffer_load_dwordx4 v1, s[4:7], s50 offen offset:3072  lds
    s_waitcnt vmcnt(9) lgkmcnt(0)
    s_barrier
    s_mov_b32 s48, 8
    s_mul_i32 s50, s48, 18432
    s_add_u32 s50, s50, s34
    s_add_u32 s50, s50, 165888
    s_add_u32 m0, s30, 0
    s_mov_b32 s53, s50
    buffer_load_dwordx4 v1, s[4:7], s50 offen offset:0  lds
    buffer_load_dwordx4 v1, s[4:7], s50 offen offset:1024  lds
    buffer_load_dwordx4 v1, s[4:7], s50 offen offset:2048  lds
    buffer_load_dwordx4 v1, s[4:7], s50 offen offset:3072  lds
    s_waitcnt vmcnt(8) lgkmcnt(0)
    s_barrier
    s_mov_b32 s48, 0
    s_mul_i32 s50, s48, 18432
    s_add_u32 s50, s50, s34
    s_add_u32 s50, s50, 165888
    s_cmp_ge_u32 s20, 2
    s_cselect_b32 s52, s50, s53
    s_add_u32 m0, s31, 0
    s_add_u32 s52, s52, s49
    buffer_load_dwordx4 v1, s[4:7], s52 offen  lds
    s_add_u32 m0, s30, 36864
    s_mov_b32 s53, s50
    buffer_load_dwordx4 v1, s[4:7], s50 offen offset:0  lds
    buffer_load_dwordx4 v1, s[4:7], s50 offen offset:1024  lds
    buffer_load_dwordx4 v1, s[4:7], s50 offen offset:2048  lds
    buffer_load_dwordx4 v1, s[4:7], s50 offen offset:3072  lds
    s_add_u32 m0, s30, 55296
    s_add_u32 s51, s35, 0
    buffer_load_dwordx4 v1, s[4:7], s51 offen offset:0 sc1 lds
    buffer_load_dwordx4 v1, s[4:7], s51 offen offset:1024 sc1 lds
    buffer_load_dwordx4 v2, s[4:7], s51 offen offset:2048 sc1 lds
    buffer_load_dwordx4 v2, s[4:7], s51 offen offset:3072 sc1 lds
    s_waitcnt vmcnt(13) lgkmcnt(0)
    s_barrier
    buffer_load_dwordx4 v[72:75], v3, s[4:7], s29 offen offset:0 sc1
    buffer_load_dwordx4 v[76:79], v3, s[4:7], s29 offen offset:1024 sc1
    buffer_load_dwordx4 v[80:83], v3, s[4:7], s29 offen offset:2048 sc1
    buffer_load_dwordx4 v[84:87], v3, s[4:7], s29 offen offset:3072 sc1
    s_mov_b32 s48, 1
    s_mul_i32 s50, s48, 18432
    s_add_u32 s50, s50, s34
    s_add_u32 s50, s50, 165888
    s_add_u32 m0, s30, 73728
    s_mov_b32 s53, s50
    buffer_load_dwordx4 v1, s[4:7], s50 offen offset:0  lds
    buffer_load_dwordx4 v1, s[4:7], s50 offen offset:1024  lds
    buffer_load_dwordx4 v1, s[4:7], s50 offen offset:2048  lds
    buffer_load_dwordx4 v1, s[4:7], s50 offen offset:3072  lds
    s_add_u32 m0, s30, 92160
    s_add_u32 s51, s35, 2048
    buffer_load_dwordx4 v1, s[4:7], s51 offen offset:0 sc1 lds
    buffer_load_dwordx4 v1, s[4:7], s51 offen offset:1024 sc1 lds
    buffer_load_dwordx4 v2, s[4:7], s51 offen offset:2048 sc1 lds
    buffer_load_dwordx4 v2, s[4:7], s51 offen offset:3072 sc1 lds
    s_waitcnt vmcnt(20) lgkmcnt(0)
    s_barrier
    s_mov_b32 s48, 2
    s_mul_i32 s50, s48, 18432
    s_add_u32 s50, s50, s34
    s_add_u32 s50, s50, 165888
    s_cmp_ge_u32 s20, 2
    s_cselect_b32 s52, s50, s53
    s_add_u32 m0, s31, 73728
    s_add_u32 s52, s52, s49
    buffer_load_dwordx4 v1, s[4:7], s52 offen  lds
    s_add_u32 m0, s30, 110592
    s_mov_b32 s53, s50
    buffer_load_dwordx4 v1, s[4:7], s50 offen offset:0  lds
    buffer_load_dwordx4 v1, s[4:7], s50 offen offset:1024  lds
    buffer_load_dwordx4 v1, s[4:7], s50 offen offset:2048  lds
    buffer_load_dwordx4 v1, s[4:7], s50 offen offset:3072  lds
    s_add_u32 m0, s30, 129024
    s_add_u32 s51, s35, 4096
    buffer_load_dwordx4 v1, s[4:7], s51 offen offset:0 sc1 lds
    buffer_load_dwordx4 v1, s[4:7], s51 offen offset:1024 sc1 lds
    buffer_load_dwordx4 v2, s[4:7], s51 offen offset:2048 sc1 lds
    buffer_load_dwordx4 v2, s[4:7], s51 offen offset:3072 sc1 lds
    s_mov_b32 s60, 65536
    s_waitcnt vmcnt(17)
L_g_chk:
    v_or3_b32 v88, v73, v75, v77
    v_or3_b32 v89, v79, v81, v83
    v_or3_b32 v88, v85, v87, v88
    v_or_b32 v88, v88, v89
    v_cmp_gt_i32 vcc, 0, v88
    s_sub_u32 s60, s60, 1
    s_cbranch_scc1 L_g_ok
    s_cbranch_vccz L_g_ok
    buffer_load_dwordx4 v[72:75], v3, s[4:7], s29 offen offset:0 sc1
    buffer_load_dwordx4 v[76:79], v3, s[4:7], s29 offen offset:1024 sc1
    buffer_load_dwordx4 v[80:83], v3, s[4:7], s29 offen offset:2048 sc1
    buffer_load_dwordx4 v[84:87], v3, s[4:7], s29 offen offset:3072 sc1
    s_waitcnt vmcnt(0)
    s_branch L_g_chk
L_g_ok:
    v_add_f32 v72, v72, v76
    v_add_f32 v80, v80, v84
    v_add_f32 v73, v73, v77
    v_add_f32 v81, v81, v85
    v_add_f32 v74, v74, v78
    v_add_f32 v82, v82, v86
    v_add_f32 v75, v75, v79
    v_add_f32 v83, v83, v87
    v_add_f32 v72, v72, v80
    v_add_f32 v73, v73, v81
    v_add_f32 v74, v74, v82
    v_add_f32 v75, v75, v83
    v_add_f32_dpp v72, v72, v72 row_ror:4 row_mask:0xf bank_mask:0xf
    v_add_f32_dpp v73, v73, v73 row_ror:4 row_mask:0xf bank_mask:0xf
    v_add_f32_dpp v74, v74, v74 row_ror:4 row_mask:0xf bank_mask:0xf
    v_add_f32_dpp v75, v75, v75 row_ror:4 row_mask:0xf bank_mask:0xf
    v_add_f32_dpp v72, v72, v72 row_ror:8 row_mask:0xf bank_mask:0xf
    v_add_f32_dpp v73, v73, v73 row_ror:8 row_mask:0xf bank_mask:0xf
    v_add_f32_dpp v74, v74, v74 row_ror:8 row_mask:0xf bank_mask:0xf
    v_add_f32_dpp v75, v75, v75 row_ror:8 row_mask:0xf bank_mask:0xf
    v_mul_f32 v72, 0x39e38e39, v72
    v_mul_f32 v73, 0x39e38e39, v73
    v_mul_f32 v74, 0x39e38e39, v74
    v_mul_f32 v75, 0x39e38e39, v75
    v_fma_f32 v73, -v72, v72, v73
    v_fma_f32 v75, -v74, v74, v75
    v_max_f32 v73, 0, v73
    v_max_f32 v75, 0, v75
    v_add_f32 v73, 0x3727c5ac, v73
    v_add_f32 v75, 0x3727c5ac, v75
    v_rsq_f32 v76, v73
    v_rsq_f32 v77, v75
    v_and_b32 v88, 0xff, v3
    s_lshl_b32 s33, s20, 8
    s_add_u32 s33, s33, 148480
    v_add_u32 v88, s33, v88
    v_mul_f32 v78, v72, v76
    v_mul_f32 v79, v74, v77
    ds_write_b128 v88, v[76:79]
    s_waitcnt vmcnt(17) lgkmcnt(0)
    s_barrier
    s_mov_b32 s48, 3
    s_mul_i32 s50, s48, 18432
    s_add_u32 s50, s50, s34
    s_add_u32 s50, s50, 165888
    s_add_u32 m0, s30, 0
    s_mov_b32 s53, s50
    buffer_load_dwordx4 v1, s[4:7], s50 offen offset:0  lds
    buffer_load_dwordx4 v1, s[4:7], s50 offen offset:1024  lds
    buffer_load_dwordx4 v1, s[4:7], s50 offen offset:2048  lds
    buffer_load_dwordx4 v1, s[4:7], s50 offen offset:3072  lds
    s_add_u32 m0, s30, 18432
    s_add_u32 s51, s35, 6144
    buffer_load_dwordx4 v1, s[4:7], s51 offen offset:0 sc1 lds
    buffer_load_dwordx4 v1, s[4:7], s51 offen offset:1024 sc1 lds
    buffer_load_dwordx4 v2, s[4:7], s51 offen offset:2048 sc1 lds
    buffer_load_dwordx4 v2, s[4:7], s51 offen offset:3072 sc1 lds
    s_waitcnt vmcnt(16) lgkmcnt(0)
    s_barrier
    s_mov_b32 s48, 4
    s_mul_i32 s50, s48, 18432
    s_add_u32 s50, s50, s34
    s_add_u32 s50, s50, 165888
    s_cmp_ge_u32 s20, 2
    s_cselect_b32 s52, s50, s53
    s_add_u32 m0, s31, 0
    s_add_u32 s52, s52, s49
    buffer_load_dwordx4 v1, s[4:7], s52 offen  lds
    s_add_u32 m0, s30, 36864
    s_mov_b32 s53, s50
    buffer_load_dwordx4 v1, s[4:7], s50 offen offset:0  lds
    buffer_load_dwordx4 v1, s[4:7], s50 offen offset:1024  lds
    buffer_load_dwordx4 v1, s[4:7], s50 offen offset:2048  lds
    buffer_load_dwordx4 v1, s[4:7], s50 offen offset:3072  lds
    s_add_u32 m0, s30, 55296
    s_add_u32 s51, s35, 8192
    buffer_load_dwordx4 v1, s[4:7], s51 offen offset:0 sc1 lds
    buffer_load_dwordx4 v1, s[4:7], s51 offen offset:1024 sc1 lds
    buffer_load_dwordx4 v2, s[4:7], s51 offen offset:2048 sc1 lds
    buffer_load_dwordx4 v2, s[4:7], s51 offen offset:3072 sc1 lds
    s_waitcnt vmcnt(17) lgkmcnt(0)
    s_barrier
    s_waitcnt vmcnt(8) lgkmcnt(0)
    s_barrier
    s_waitcnt vmcnt(0) lgkmcnt(0)
    s_barrier
    s_barrier
    s_mov_b32 s56, 1
    s_atomic_add s56, s[54:55], 0
    s_add_u32 m0, s30, 92160
    s_lshl_b32 s51, s44, 7
    buffer_load_dwordx4 v8, s[8:11], s51 offen offset:0  lds
    buffer_load_dwordx4 v9, s[8:11], s51 offen offset:1024  lds
    buffer_load_dwordx4 v10, s[8:11], s51 offen offset:2048  lds
    buffer_load_dwordx4 v11, s[8:11], s51 offen offset:3072  lds
    s_add_u32 m0, s30, 129024
    s_lshl_b32 s51, s45, 7
    buffer_load_dwordx4 v8, s[8:11], s51 offen offset:0  lds
    buffer_load_dwordx4 v9, s[8:11], s51 offen offset:1024  lds
    buffer_load_dwordx4 v10, s[8:11], s51 offen offset:2048  lds
    buffer_load_dwordx4 v11, s[8:11], s51 offen offset:3072  lds
    s_add_u32 m0, s30, 18432
    s_lshl_b32 s51, s46, 7
    buffer_load_dwordx4 v8, s[8:11], s51 offen offset:0  lds
    buffer_load_dwordx4 v9, s[8:11], s51 offen offset:1024  lds
    buffer_load_dwordx4 v10, s[8:11], s51 offen offset:2048  lds
    buffer_load_dwordx4 v11, s[8:11], s51 offen offset:3072  lds
    s_and_b32 s40, s2, 7
    s_lshr_b32 s26, s2, 3
    s_lshr_b32 s38, s40, 1
    s_lshl_b32 s38, s38, 3
    s_lshr_b32 s27, s26, 2
    s_add_u32 s38, s38, s27
    s_and_b32 s39, s40, 1
    s_lshl_b32 s39, s39, 2
    s_and_b32 s27, s26, 3
    s_add_u32 s39, s39, s27
    s_add_u32 s40, s38, s39
    s_and_b32 s40, s40, 3
    s_mul_i32 s42, s20, 9216
    s_mul_i32 s43, s39, 331776
    s_add_u32 s43, s43, s42
    s_add_u32 s43, s43, 0x4100000
    s_mov_b32 s60, 65536
L_poll_z2:
    s_mov_b32 s57, 0
    s_atomic_add s57, s[54:55], 0 glc
    s_waitcnt lgkmcnt(0)
    s_cmp_ge_u32 s57, 16
    s_cbranch_scc1 L_pd_z2
    s_sub_u32 s60, s60, 1
    s_cbranch_scc1 L_pd_z2
    s_sleep 2
    s_branch L_poll_z2
L_pd_z2:
    s_mul_i32 s50, s44, 18432
    s_add_u32 s50, s50, s36
    s_add_u32 m0, s30, 73728
    s_mov_b32 s53, s50
    buffer_load_dwordx4 v1, s[4:7], s50 offen offset:0 sc1 lds
    buffer_load_dwordx4 v1, s[4:7], s50 offen offset:1024 sc1 lds
    buffer_load_dwordx4 v1, s[4:7], s50 offen offset:2048 sc1 lds
    buffer_load_dwordx4 v1, s[4:7], s50 offen offset:3072 sc1 lds
    s_mul_i32 s50, s45, 18432
    s_add_u32 s50, s50, s36
    s_cmp_ge_u32 s20, 2
    s_cselect_b32 s52, s50, s53
    s_add_u32 m0, s31, 73728
    s_add_u32 s52, s52, s49
    buffer_load_dwordx4 v1, s[4:7], s52 offen sc1 lds
    s_add_u32 m0, s30, 110592
    s_mov_b32 s53, s50
    buffer_load_dwordx4 v1, s[4:7], s50 offen offset:0 sc1 lds
    buffer_load_dwordx4 v1, s[4:7], s50 offen offset:1024 sc1 lds
    buffer_load_dwordx4 v1, s[4:7], s50 offen offset:2048 sc1 lds
    buffer_load_dwordx4 v1, s[4:7], s50 offen offset:3072 sc1 lds
    s_mul_i32 s50, s46, 18432
    s_add_u32 s50, s50, s36
    s_add_u32 m0, s30, 0
    s_mov_b32 s53, s50
    buffer_load_dwordx4 v1, s[4:7], s50 offen offset:0 sc1 lds
    buffer_load_dwordx4 v1, s[4:7], s50 offen offset:1024 sc1 lds
    buffer_load_dwordx4 v1, s[4:7], s50 offen offset:2048 sc1 lds
    buffer_load_dwordx4 v1, s[4:7], s50 offen offset:3072 sc1 lds
    s_waitcnt vmcnt(8)
    s_barrier
    s_add_u32 s44, s44, 4
    s_and_b32 s44, s44, 31
    s_add_u32 s45, s45, 4
    s_and_b32 s45, s45, 31
    s_add_u32 s46, s46, 4
    s_and_b32 s46, s46, 31
    s_mul_i32 s50, s47, 18432
    s_add_u32 s50, s50, s36
    s_cmp_ge_u32 s20, 2
    s_cselect_b32 s52, s50, s53
    s_add_u32 m0, s31, 0
    s_add_u32 s52, s52, s49
    buffer_load_dwordx4 v1, s[4:7], s52 offen sc1 lds
    s_add_u32 m0, s30, 36864
    s_mov_b32 s53, s50
    buffer_load_dwordx4 v1, s[4:7], s50 offen offset:0 sc1 lds
    buffer_load_dwordx4 v1, s[4:7], s50 offen offset:1024 sc1 lds
    buffer_load_dwordx4 v1, s[4:7], s50 offen offset:2048 sc1 lds
    buffer_load_dwordx4 v1, s[4:7], s50 offen offset:3072 sc1 lds
    s_add_u32 m0, s30, 55296
    s_lshl_b32 s51, s47, 7
    buffer_load_dwordx4 v8, s[8:11], s51 offen offset:0  lds
    buffer_load_dwordx4 v9, s[8:11], s51 offen offset:1024  lds
    buffer_load_dwordx4 v10, s[8:11], s51 offen offset:2048  lds
    buffer_load_dwordx4 v11, s[8:11], s51 offen offset:3072  lds
    s_add_u32 s47, s47, 4
    s_and_b32 s47, s47, 31
    s_waitcnt vmcnt(13)
    s_barrier
    s_mul_i32 s50, s44, 18432
    s_add_u32 s50, s50, s36
    s_add_u32 m0, s30, 73728
    s_mov_b32 s53, s50
    buffer_load_dwordx4 v1, s[4:7], s50 offen offset:0 sc1 lds
    buffer_load_dwordx4 v1, s[4:7], s50 offen offset:1024 sc1 lds
    buffer_load_dwordx4 v1, s[4:7], s50 offen offset:2048 sc1 lds
    buffer_load_dwordx4 v1, s[4:7], s50 offen offset:3072 sc1 lds
    s_add_u32 m0, s30, 92160
    s_lshl_b32 s51, s44, 7
    buffer_load_dwordx4 v8, s[8:11], s51 offen offset:0  lds
    buffer_load_dwordx4 v9, s[8:11], s51 offen offset:1024  lds
    buffer_load_dwordx4 v10, s[8:11], s51 offen offset:2048  lds
    buffer_load_dwordx4 v11, s[8:11], s51 offen offset:3072  lds
    s_add_u32 s44, s44, 4
    s_and_b32 s44, s44, 31
    s_waitcnt vmcnt(16)
    s_barrier
    s_mul_i32 s50, s45, 18432
    s_add_u32 s50, s50, s36
    s_cmp_ge_u32 s20, 2
    s_cselect_b32 s52, s50, s53
    s_add_u32 m0, s31, 73728
    s_add_u32 s52, s52, s49
    buffer_load_dwordx4 v1, s[4:7], s52 offen sc1 lds
    s_add_u32 m0, s30, 110592
    s_mov_b32 s53, s50
    buffer_load_dwordx4 v1, s[4:7], s50 offen offset:0 sc1 lds
    buffer_load_dwordx4 v1, s[4:7], s50 offen offset:1024 sc1 lds
    buffer_load_dwordx4 v1, s[4:7], s50 offen offset:2048 sc1 lds
    buffer_load_dwordx4 v1, s[4:7], s50 offen offset:3072 sc1 lds
    s_add_u32 m0, s30, 129024
    s_lshl_b32 s51, s45, 7
    buffer_load_dwordx4 v8, s[8:11], s51 offen offset:0  lds
    buffer_load_dwordx4 v9, s[8:11], s51 offen offset:1024  lds
    buffer_load_dwordx4 v10, s[8:11], s51 offen offset:2048  lds
    buffer_load_dwordx4 v11, s[8:11], s51 offen offset:3072  lds
    s_add_u32 s45, s45, 4
    s_and_b32 s45, s45, 31
    s_waitcnt vmcnt(17)
    s_barrier
    s_mul_i32 s50, s46, 18432
    s_add_u32 s50, s50, s36
    s_add_u32 m0, s30, 0
    s_mov_b32 s53, s50
    buffer_load_dwordx4 v1, s[4:7], s50 offen offset:0 sc1 lds
    buffer_load_dwordx4 v1, s[4:7], s50 offen offset:1024 sc1 lds
    buffer_load_dwordx4 v1, s[4:7], s50 offen offset:2048 sc1 lds
    buffer_load_dwordx4 v1, s[4:7], s50 offen offset:3072 sc1 lds
    s_add_u32 m0, s30, 18432
    s_lshl_b32 s51, s46, 7
    buffer_load_dwordx4 v8, s[8:11], s51 offen offset:0  lds
    buffer_load_dwordx4 v9, s[8:11], s51 offen offset:1024  lds
    buffer_load_dwordx4 v10, s[8:11], s51 offen offset:2048  lds
    buffer_load_dwordx4 v11, s[8:11], s51 offen offset:3072  lds
    s_add_u32 s46, s46, 4
    s_and_b32 s46, s46, 31
    s_waitcnt vmcnt(16)
    s_barrier
    s_mul_i32 s50, s47, 18432
    s_add_u32 s50, s50, s36
    s_cmp_ge_u32 s20, 2
    s_cselect_b32 s52, s50, s53
    s_add_u32 m0, s31, 0
    s_add_u32 s52, s52, s49
    buffer_load_dwordx4 v1, s[4:7], s52 offen sc1 lds
    s_add_u32 m0, s30, 36864
    s_mov_b32 s53, s50
    buffer_load_dwordx4 v1, s[4:7], s50 offen offset:0 sc1 lds
    buffer_load_dwordx4 v1, s[4:7], s50 offen offset:1024 sc1 lds
    buffer_load_dwordx4 v1, s[4:7], s50 offen offset:2048 sc1 lds
    buffer_load_dwordx4 v1, s[4:7], s50 offen offset:3072 sc1 lds
    s_add_u32 m0, s30, 55296
    s_lshl_b32 s51, s47, 7
    buffer_load_dwordx4 v8, s[8:11], s51 offen offset:0  lds
    buffer_load_dwordx4 v9, s[8:11], s51 offen offset:1024  lds
    buffer_load_dwordx4 v10, s[8:11], s51 offen offset:2048  lds
    buffer_load_dwordx4 v11, s[8:11], s51 offen offset:3072  lds
    s_add_u32 s47, s47, 4
    s_and_b32 s47, s47, 31
    s_mov_b32 s41, 6
L_g_ll:
    s_waitcnt vmcnt(17)
    s_barrier
    s_mul_i32 s50, s44, 18432
    s_add_u32 s50, s50, s36
    s_add_u32 m0, s30, 73728
    s_mov_b32 s53, s50
    buffer_load_dwordx4 v1, s[4:7], s50 offen offset:0 sc1 lds
    buffer_load_dwordx4 v1, s[4:7], s50 offen offset:1024 sc1 lds
    buffer_load_dwordx4 v1, s[4:7], s50 offen offset:2048 sc1 lds
    buffer_load_dwordx4 v1, s[4:7], s50 offen offset:3072 sc1 lds
    s_add_u32 m0, s30, 92160
    s_lshl_b32 s51, s44, 7
    buffer_load_dwordx4 v8, s[8:11], s51 offen offset:0  lds
    buffer_load_dwordx4 v9, s[8:11], s51 offen offset:1024  lds
    buffer_load_dwordx4 v10, s[8:11], s51 offen offset:2048  lds
    buffer_load_dwordx4 v11, s[8:11], s51 offen offset:3072  lds
    s_add_u32 s44, s44, 4
    s_and_b32 s44, s44, 31
    s_waitcnt vmcnt(16)
    s_barrier
    s_mul_i32 s50, s45, 18432
    s_add_u32 s50, s50, s36
    s_cmp_ge_u32 s20, 2
    s_cselect_b32 s52, s50, s53
    s_add_u32 m0, s31, 73728
    s_add_u32 s52, s52, s49
    buffer_load_dwordx4 v1, s[4:7], s52 offen sc1 lds
    s_add_u32 m0, s30, 110592
    s_mov_b32 s53, s50
    buffer_load_dwordx4 v1, s[4:7], s50 offen offset:0 sc1 lds
    buffer_load_dwordx4 v1, s[4:7], s50 offen offset:1024 sc1 lds
    buffer_load_dwordx4 v1, s[4:7], s50 offen offset:2048 sc1 lds
    buffer_load_dwordx4 v1, s[4:7], s50 offen offset:3072 sc1 lds
    s_add_u32 m0, s30, 129024
    s_lshl_b32 s51, s45, 7
    buffer_load_dwordx4 v8, s[8:11], s51 offen offset:0  lds
    buffer_load_dwordx4 v9, s[8:11], s51 offen offset:1024  lds
    buffer_load_dwordx4 v10, s[8:11], s51 offen offset:2048  lds
    buffer_load_dwordx4 v11, s[8:11], s51 offen offset:3072  lds
    s_add_u32 s45, s45, 4
    s_and_b32 s45, s45, 31
    s_waitcnt vmcnt(17)
    s_barrier
    s_mul_i32 s50, s46, 18432
    s_add_u32 s50, s50, s36
    s_add_u32 m0, s30, 0
    s_mov_b32 s53, s50
    buffer_load_dwordx4 v1, s[4:7], s50 offen offset:0 sc1 lds
    buffer_load_dwordx4 v1, s[4:7], s50 offen offset:1024 sc1 lds
    buffer_load_dwordx4 v1, s[4:7], s50 offen offset:2048 sc1 lds
    buffer_load_dwordx4 v1, s[4:7], s50 offen offset:3072 sc1 lds
    s_add_u32 m0, s30, 18432
    s_lshl_b32 s51, s46, 7
    buffer_load_dwordx4 v8, s[8:11], s51 offen offset:0  lds
    buffer_load_dwordx4 v9, s[8:11], s51 offen offset:1024  lds
    buffer_load_dwordx4 v10, s[8:11], s51 offen offset:2048  lds
    buffer_load_dwordx4 v11, s[8:11], s51 offen offset:3072  lds
    s_add_u32 s46, s46, 4
    s_and_b32 s46, s46, 31
    s_waitcnt vmcnt(16)
    s_barrier
    s_mul_i32 s50, s47, 18432
    s_add_u32 s50, s50, s36
    s_cmp_ge_u32 s20, 2
    s_cselect_b32 s52, s50, s53
    s_add_u32 m0, s31, 0
    s_add_u32 s52, s52, s49
    buffer_load_dwordx4 v1, s[4:7], s52 offen sc1 lds
    s_add_u32 m0, s30, 36864
    s_mov_b32 s53, s50
    buffer_load_dwordx4 v1, s[4:7], s50 offen offset:0 sc1 lds
    buffer_load_dwordx4 v1, s[4:7], s50 offen offset:1024 sc1 lds
    buffer_load_dwordx4 v1, s[4:7], s50 offen offset:2048 sc1 lds
    buffer_load_dwordx4 v1, s[4:7], s50 offen offset:3072 sc1 lds
    s_add_u32 m0, s30, 55296
    s_lshl_b32 s51, s47, 7
    buffer_load_dwordx4 v8, s[8:11], s51 offen offset:0  lds
    buffer_load_dwordx4 v9, s[8:11], s51 offen offset:1024  lds
    buffer_load_dwordx4 v10, s[8:11], s51 offen offset:2048  lds
    buffer_load_dwordx4 v11, s[8:11], s51 offen offset:3072  lds
    s_add_u32 s47, s47, 4
    s_and_b32 s47, s47, 31
    s_sub_u32 s41, s41, 1
    s_cmp_lg_u32 s41, 0
    s_cbranch_scc1 L_g_ll
    s_waitcnt vmcnt(17)
    s_barrier
    s_mov_b32 s32, 0
    s_mul_i32 s32, s32, 36864
    s_add_u32 s32, s32, s43
    s_add_u32 m0, s42, 73728
    s_add_u32 s33, s32, 0
    buffer_load_dwordx4 v1, s[4:7], s33 offen offset:0  lds
    buffer_load_dwordx4 v1, s[4:7], s33 offen offset:1024  lds
    buffer_load_dwordx4 v1, s[4:7], s33 offen offset:2048  lds
    buffer_load_dwordx4 v1, s[4:7], s33 offen offset:3072  lds
    s_add_u32 m0, s42, 77824
    s_add_u32 s33, s32, 4096
    buffer_load_dwordx4 v1, s[4:7], s33 offen offset:0  lds
    buffer_load_dwordx4 v1, s[4:7], s33 offen offset:1024  lds
    buffer_load_dwordx4 v1, s[4:7], s33 offen offset:2048  lds
    buffer_load_dwordx4 v1, s[4:7], s33 offen offset:3072  lds
    s_add_u32 m0, s42, 81920
    s_add_u32 s33, s32, 8192
    buffer_load_dwordx4 v1, s[4:7], s33 offen offset:0  lds
    s_waitcnt vmcnt(9)
    s_barrier
    s_mov_b32 s32, 1
    s_mul_i32 s32, s32, 36864
    s_add_u32 s32, s32, s43
    s_add_u32 m0, s42, 110592
    s_add_u32 s33, s32, 0
    buffer_load_dwordx4 v1, s[4:7], s33 offen offset:0  lds
    buffer_load_dwordx4 v1, s[4:7], s33 offen offset:1024  lds
    buffer_load_dwordx4 v1, s[4:7], s33 offen offset:2048  lds
    buffer_load_dwordx4 v1, s[4:7], s33 offen offset:3072  lds
    s_add_u32 m0, s42, 114688
    s_add_u32 s33, s32, 4096
    buffer_load_dwordx4 v1, s[4:7], s33 offen offset:0  lds
    buffer_load_dwordx4 v1, s[4:7], s33 offen offset:1024  lds
    buffer_load_dwordx4 v1, s[4:7], s33 offen offset:2048  lds
    buffer_load_dwordx4 v1, s[4:7], s33 offen offset:3072  lds
    s_add_u32 m0, s42, 118784
    s_add_u32 s33, s32, 8192
    buffer_load_dwordx4 v1, s[4:7], s33 offen offset:0  lds
    s_barrier
    s_mov_b32 s32, 2
    s_mul_i32 s32, s32, 36864
    s_add_u32 s32, s32, s43
    s_add_u32 m0, s42, 0
    s_add_u32 s33, s32, 0
    buffer_load_dwordx4 v1, s[4:7], s33 offen offset:0  lds
    buffer_load_dwordx4 v1, s[4:7], s33 offen offset:1024  lds
    buffer_load_dwordx4 v1, s[4:7], s33 offen offset:2048  lds
    buffer_load_dwordx4 v1, s[4:7], s33 offen offset:3072  lds
    s_add_u32 m0, s42, 4096
    s_add_u32 s33, s32, 4096
    buffer_load_dwordx4 v1, s[4:7], s33 offen offset:0  lds
    buffer_load_dwordx4 v1, s[4:7], s33 offen offset:1024  lds
    buffer_load_dwordx4 v1, s[4:7], s33 offen offset:2048  lds
    buffer_load_dwordx4 v1, s[4:7], s33 offen offset:3072  lds
    s_add_u32 m0, s42, 8192
    s_add_u32 s33, s32, 8192
    buffer_load_dwordx4 v1, s[4:7], s33 offen offset:0  lds
    s_mov_b32 s32, 3
    s_mul_i32 s32, s32, 36864
    s_add_u32 s32, s32, s43
    s_add_u32 m0, s42, 36864
    s_add_u32 s33, s32, 0
    buffer_load_dwordx4 v1, s[4:7], s33 offen offset:0  lds
    buffer_load_dwordx4 v1, s[4:7], s33 offen offset:1024  lds
    buffer_load_dwordx4 v1, s[4:7], s33 offen offset:2048  lds
    buffer_load_dwordx4 v1, s[4:7], s33 offen offset:3072  lds
    s_add_u32 m0, s42, 40960
    s_add_u32 s33, s32, 4096
    buffer_load_dwordx4 v1, s[4:7], s33 offen offset:0  lds
    buffer_load_dwordx4 v1, s[4:7], s33 offen offset:1024  lds
    buffer_load_dwordx4 v1, s[4:7], s33 offen offset:2048  lds
    buffer_load_dwordx4 v1, s[4:7], s33 offen offset:3072  lds
    s_add_u32 m0, s42, 45056
    s_add_u32 s33, s32, 8192
    buffer_load_dwordx4 v1, s[4:7], s33 offen offset:0  lds
    s_barrier
    s_mov_b32 s32, 4
    s_mul_i32 s32, s32, 36864
    s_add_u32 s32, s32, s43
    buffer_load_dwordx4 v[16:19], v1, s[4:7], s32 offen offset:0
    buffer_load_dwordx4 v[20:23], v1, s[4:7], s32 offen offset:1024
    buffer_load_dwordx4 v[24:27], v1, s[4:7], s32 offen offset:2048
    buffer_load_dwordx4 v[28:31], v1, s[4:7], s32 offen offset:3072
    s_add_u32 s32, s32, 4096
    buffer_load_dwordx4 v[32:35], v1, s[4:7], s32 offen offset:0
    buffer_load_dwordx4 v[36:39], v1, s[4:7], s32 offen offset:1024
    buffer_load_dwordx4 v[40:43], v1, s[4:7], s32 offen offset:2048
    buffer_load_dwordx4 v[44:47], v1, s[4:7], s32 offen offset:3072
    s_add_u32 s32, s32, 4096
    buffer_load_dwordx4 v[48:51], v1, s[4:7], s32 offen offset:0
    s_waitcnt vmcnt(36)
    s_barrier
    v_add_u32 v12, s42, v1
    v_add_u32 v13, 36864, v12
    v_add_u32 v14, 73728, v12
    v_add_u32 v15, 110592, v12
    s_waitcnt vmcnt(27) lgkmcnt(0)
    s_barrier
    s_waitcnt vmcnt(0)
    ds_write_b128 v14, v[16:19] offset:0
    ds_write_b128 v14, v[20:23] offset:1024
    ds_write_b128 v14, v[24:27] offset:2048
    ds_write_b128 v14, v[28:31] offset:3072
    ds_write_b128 v14, v[32:35] offset:4096
    ds_write_b128 v14, v[36:39] offset:5120
    ds_write_b128 v14, v[40:43] offset:6144
    ds_write_b128 v14, v[44:47] offset:7168
    ds_write_b128 v14, v[48:51] offset:8192
    s_waitcnt vmcnt(63) lgkmcnt(0)
    s_barrier
    s_mov_b32 s32, 5
    s_mul_i32 s32, s32, 36864
    s_add_u32 s32, s32, s43
    s_add_u32 m0, s42, 110592
    s_add_u32 s33, s32, 0
    buffer_load_dwordx4 v1, s[4:7], s33 offen offset:0  lds
    buffer_load_dwordx4 v1, s[4:7], s33 offen offset:1024  lds
    buffer_load_dwordx4 v1, s[4:7], s33 offen offset:2048  lds
    buffer_load_dwordx4 v1, s[4:7], s33 offen offset:3072  lds
    s_add_u32 m0, s42, 114688
    s_add_u32 s33, s32, 4096
    buffer_load_dwordx4 v1, s[4:7], s33 offen offset:0  lds
    buffer_load_dwordx4 v1, s[4:7], s33 offen offset:1024  lds
    buffer_load_dwordx4 v1, s[4:7], s33 offen offset:2048  lds
    buffer_load_dwordx4 v1, s[4:7], s33 offen offset:3072  lds
    s_add_u32 m0, s42, 118784
    s_add_u32 s33, s32, 8192
    buffer_load_dwordx4 v1, s[4:7], s33 offen offset:0  lds
    s_waitcnt vmcnt(63) lgkmcnt(0)
    s_barrier
    s_mov_b32 s32, 6
    s_mul_i32 s32, s32, 36864
    s_add_u32 s32, s32, s43
    s_add_u32 m0, s42, 0
    s_add_u32 s33, s32, 0
    buffer_load_dwordx4 v1, s[4:7], s33 offen offset:0  lds
    buffer_load_dwordx4 v1, s[4:7], s33 offen offset:1024  lds
    buffer_load_dwordx4 v1, s[4:7], s33 offen offset:2048  lds
    buffer_load_dwordx4 v1, s[4:7], s33 offen offset:3072  lds
    s_add_u32 m0, s42, 4096
    s_add_u32 s33, s32, 4096
    buffer_load_dwordx4 v1, s[4:7], s33 offen offset:0  lds
    buffer_load_dwordx4 v1, s[4:7], s33 offen offset:1024  lds
    buffer_load_dwordx4 v1, s[4:7], s33 offen offset:2048  lds
    buffer_load_dwordx4 v1, s[4:7], s33 offen offset:3072  lds
    s_add_u32 m0, s42, 8192
    s_add_u32 s33, s32, 8192
    buffer_load_dwordx4 v1, s[4:7], s33 offen offset:0  lds
    s_waitcnt vmcnt(63) lgkmcnt(0)
    s_barrier
    s_mov_b32 s32, 7
    s_mul_i32 s32, s32, 36864
    s_add_u32 s32, s32, s43
    s_add_u32 m0, s42, 36864
    s_add_u32 s33, s32, 0
    buffer_load_dwordx4 v1, s[4:7], s33 offen offset:0  lds
    buffer_load_dwordx4 v1, s[4:7], s33 offen offset:1024  lds
    buffer_load_dwordx4 v1, s[4:7], s33 offen offset:2048  lds
    buffer_load_dwordx4 v1, s[4:7], s33 offen offset:3072  lds
    s_add_u32 m0, s42, 40960
    s_add_u32 s33, s32, 4096
    buffer_load_dwordx4 v1, s[4:7], s33 offen offset:0  lds
    buffer_load_dwordx4 v1, s[4:7], s33 offen offset:1024  lds
    buffer_load_dwordx4 v1, s[4:7], s33 offen offset:2048  lds
    buffer_load_dwordx4 v1, s[4:7], s33 offen offset:3072  lds
    s_add_u32 m0, s42, 45056
    s_add_u32 s33, s32, 8192
    buffer_load_dwordx4 v1, s[4:7], s33 offen offset:0  lds
    s_waitcnt vmcnt(18) lgkmcnt(0)
    s_barrier
    s_mov_b32 s32, 8
    s_mul_i32 s32, s32, 36864
    s_add_u32 s32, s32, s43
    s_add_u32 m0, s42, 73728
    s_add_u32 s33, s32, 0
    buffer_load_dwordx4 v1, s[4:7], s33 offen offset:0  lds
    buffer_load_dwordx4 v1, s[4:7], s33 offen offset:1024  lds
    buffer_load_dwordx4 v1, s[4:7], s33 offen offset:2048  lds
    buffer_load_dwordx4 v1, s[4:7], s33 offen offset:3072  lds
    s_add_u32 m0, s42, 77824
    s_add_u32 s33, s32, 4096
    buffer_load_dwordx4 v1, s[4:7], s33 offen offset:0  lds
    buffer_load_dwordx4 v1, s[4:7], s33 offen offset:1024  lds
    buffer_load_dwordx4 v1, s[4:7], s33 offen offset:2048  lds
    buffer_load_dwordx4 v1, s[4:7], s33 offen offset:3072  lds
    s_add_u32 m0, s42, 81920
    s_add_u32 s33, s32, 8192
    buffer_load_dwordx4 v1, s[4:7], s33 offen offset:0  lds
    s_waitcnt vmcnt(18) lgkmcnt(0)
    s_barrier
    s_cmp_eq_u32 s22, 1
    s_cbranch_scc1 L_m_lfin
    s_and_b32 s25, s2, 7
    s_lshr_b32 s26, s2, 3
    s_lshr_b32 s23, s25, 1
    s_lshl_b32 s23, s23, 2
    s_lshr_b32 s27, s26, 3
    s_add_u32 s23, s23, s27
    s_and_b32 s24, s25, 1
    s_lshl_b32 s24, s24, 3
    s_and_b32 s27, s26, 7
    s_add_u32 s24, s24, s27
    s_mul_i32 s29, s24, 129024
    s_lshl_b32 s30, s20, 12
    s_add_u32 s29, s29, s30
    s_add_u32 s29, s29, 0x3800000
    s_lshl_b32 s31, s23, 3
    s_max_u32 s31, s31, 1
    s_sub_u32 s31, s31, 1
    s_mul_i32 s31, s31, 18432
    s_add_u32 s31, s31, 0x1c00000
    s_lshl_b32 s35, s20, 10
    s_and_b32 s36, s35, 1024
    v_and_b32 v70, 48, v1
    v_lshrrev_b32 v71, 8, v1
    v_lshl_add_u32 v70, v71, 6, v70
    v_bfe_u32 v71, v1, 6, 2
    v_lshl_add_u32 v70, v71, 8, v70
    s_waitcnt vmcnt(9) lgkmcnt(0)
    s_barrier
    s_add_u32 m0, s30, 0
    s_add_u32 s34, s29, 0
    buffer_load_dwordx4 v70, s[4:7], s34 offen offset:0 lds
    buffer_load_dwordx4 v70, s[4:7], s34 offen offset:1024 lds
    buffer_load_dwordx4 v70, s[4:7], s34 offen offset:2048 lds
    buffer_load_dwordx4 v70, s[4:7], s34 offen offset:3072 lds
    s_add_u32 m0, s30, 16384
    s_add_u32 s34, s29, 16384
    buffer_load_dwordx4 v70, s[4:7], s34 offen offset:0 lds
    buffer_load_dwordx4 v70, s[4:7], s34 offen offset:1024 lds
    buffer_load_dwordx4 v70, s[4:7], s34 offen offset:2048 lds
    buffer_load_dwordx4 v70, s[4:7], s34 offen offset:3072 lds
    s_waitcnt vmcnt(8) lgkmcnt(0)
    s_barrier
    s_barrier
    s_add_u32 m0, s30, 32768
    s_add_u32 s34, s29, 32768
    buffer_load_dwordx4 v70, s[4:7], s34 offen offset:0 lds
    buffer_load_dwordx4 v70, s[4:7], s34 offen offset:1024 lds
    buffer_load_dwordx4 v70, s[4:7], s34 offen offset:2048 lds
    buffer_load_dwordx4 v70, s[4:7], s34 offen offset:3072 lds
    s_add_u32 m0, s30, 114688
    s_add_u32 s34, s29, 114688
    buffer_load_dwordx4 v70, s[4:7], s34 offen offset:0 lds
    buffer_load_dwordx4 v70, s[4:7], s34 offen offset:1024 lds
    buffer_load_dwordx4 v70, s[4:7], s34 offen offset:2048 lds
    buffer_load_dwordx4 v70, s[4:7], s34 offen offset:3072 lds
    s_mov_b32 s22, 1
    s_mov_b32 s21, 0x1c00000
    s_barrier
    s_barrier
    s_add_u32 m0, s30, 49152
    s_add_u32 s34, s29, 49152
    buffer_load_dwordx4 v70, s[4:7], s34 offen offset:0 lds
    buffer_load_dwordx4 v70, s[4:7], s34 offen offset:1024 lds
    buffer_load_dwordx4 v70, s[4:7], s34 offen offset:2048 lds
    buffer_load_dwordx4 v70, s[4:7], s34 offen offset:3072 lds
    v_lshrrev_b32 v60, 8, v1
    v_bfe_u32 v61, v1, 7, 1
    v_bfe_u32 v62, v1, 4, 3
    v_cmp_gt_u32 vcc, 3, v60
    v_mul_u32_u24 v61, 80, v61
    v_lshl_add_u32 v61, v62, 3, v61
    v_lshrrev_b32 v63, 1, v62
    v_and_b32 v62, 1, v62
    v_lshl_add_u32 v62, v62, 3, 64
    v_cndmask_b32 v60, v63, v60, vcc
    v_cndmask_b32 v61, v62, v61, vcc
    v_mul_u32_u24 v60, 2304, v60
    v_add_u32 v69, v60, v61
    v_lshrrev_b32 v68, 1, v1
    s_mul_i32 s34, s24, 144
    s_add_u32 s34, s34, 0x4400000
    buffer_load_dwordx2 v[60:61], v69, s[4:7], s34 offen
    s_mul_i32 s34, s24, 144
    s_add_u32 s34, s34, 0x4402000
    buffer_load_dwordx2 v[62:63], v69, s[4:7], s34 offen
    s_mul_i32 s34, s24, 144
    s_add_u32 s34, s34, 0x4404000
    buffer_load_dwordx2 v[64:65], v69, s[4:7], s34 offen
    s_mul_i32 s34, s24, 144
    s_add_u32 s34, s34, 0x4406000
    buffer_load_dwordx2 v[66:67], v69, s[4:7], s34 offen
    s_add_u32 m0, s30, 65536
    s_add_u32 s34, s29, 65536
    buffer_load_dwordx4 v70, s[4:7], s34 offen offset:0 lds
    buffer_load_dwordx4 v70, s[4:7], s34 offen offset:1024 lds
    buffer_load_dwordx4 v70, s[4:7], s34 offen offset:2048 lds
    buffer_load_dwordx4 v70, s[4:7], s34 offen offset:3072 lds
    s_add_u32 m0, s30, 81920
    s_add_u32 s34, s29, 81920
    buffer_load_dwordx4 v70, s[4:7], s34 offen offset:0 lds
    buffer_load_dwordx4 v70, s[4:7], s34 offen offset:1024 lds
    buffer_load_dwordx4 v70, s[4:7], s34 offen offset:2048 lds
    buffer_load_dwordx4 v70, s[4:7], s34 offen offset:3072 lds
    s_barrier
    s_add_u32 m0, s35, 131072
    s_add_u32 s34, s31, s35
    s_add_u32 s34, s34, 0
    buffer_load_dwordx4 v1, s[4:7], s34 offen sc1 lds
    s_waitcnt vmcnt(29) lgkmcnt(0)
    s_barrier
    s_add_u32 m0, s35, 135168
    s_add_u32 s34, s31, s35
    s_add_u32 s34, s34, 4096
    buffer_load_dwordx4 v1, s[4:7], s34 offen sc1 lds
    s_add_u32 m0, s35, 139264
    s_add_u32 s34, s31, s35
    s_add_u32 s34, s34, 8192
    buffer_load_dwordx4 v1, s[4:7], s34 offen sc1 lds
    s_add_u32 m0, s35, 143360
    s_add_u32 s34, s31, s35
    s_add_u32 s34, s34, 12288
    buffer_load_dwordx4 v1, s[4:7], s34 offen sc1 lds
    s_add_u32 m0, s30, 98304
    s_add_u32 s34, s29, 98304
    buffer_load_dwordx4 v70, s[4:7], s34 offen offset:0 lds
    buffer_load_dwordx4 v70, s[4:7], s34 offen offset:1024 lds
    buffer_load_dwordx4 v70, s[4:7], s34 offen offset:2048 lds
    buffer_load_dwordx4 v70, s[4:7], s34 offen offset:3072 lds
    s_add_u32 m0, s36, 147456
    s_add_u32 s34, s31, s36
    s_add_u32 s34, s34, 16384
    buffer_load_dwordx4 v1, s[4:7], s34 offen sc1 lds
    s_waitcnt vmcnt(8) lgkmcnt(0)
    s_barrier
    s_waitcnt vmcnt(8) lgkmcnt(0)
    s_barrier
    s_waitcnt vmcnt(7) lgkmcnt(0)
    s_barrier
    v_add_f32 v60, v60, v62
    v_add_f32 v61, v61, v63
    v_add_f32 v64, v64, v66
    v_add_f32 v65, v65, v67
    v_add_f32 v60, v60, v64
    v_add_f32 v61, v61, v65
    v_cmp_gt_u32 vcc, 864, v1
    v_add_u32 v68, 161792, v68
    s_nop 0
    v_cndmask_b32 v60, 0, v60, vcc
    v_cndmask_b32 v61, 0, v61, vcc
    ds_write_b64 v68, v[60:61]
    s_waitcnt vmcnt(6) lgkmcnt(0)
    s_barrier
    s_waitcnt vmcnt(6) lgkmcnt(0)
    s_barrier
    s_waitcnt vmcnt(1) lgkmcnt(0)
    s_barrier
    s_waitcnt vmcnt(0) lgkmcnt(0)
    s_barrier
    s_barrier
    s_branch L_m_ll
L_m_lfin:
    s_waitcnt vmcnt(0) lgkmcnt(0)
    s_barrier
    s_barrier
L_end_m:
    s_endpgm

.section .rodata,"a"
.p2align 6
.amdhsa_kernel interleave_layers__sliding_local_dilated__mixer_gmlp__prompt_kernel
  .amdhsa_next_free_vgpr 256
  .amdhsa_next_free_sgpr 102
  .amdhsa_accum_offset 256
  .amdhsa_group_segment_fixed_size 0
  .amdhsa_kernarg_size 88
  .amdhsa_user_sgpr_count 2
  .amdhsa_user_sgpr_kernarg_segment_ptr 1
  .amdhsa_system_sgpr_workgroup_id_x 1
  .amdhsa_float_denorm_mode_32 3
.end_amdhsa_kernel
```

```asm
; @launch grid=(256,1,1) block=(512,1,1) lds=163840
.amdgcn_target "amdgcn-amd-amdhsa--gfx950"
.text
.globl interleave_layers__sliding_local_dilated__mixer_gmlp__prompt_kernel
.p2align 8
.type interleave_layers__sliding_local_dilated__mixer_gmlp__prompt_kernel,@function
interleave_layers__sliding_local_dilated__mixer_gmlp__prompt_kernel:
    s_cmp_ge_u32 s2, 256
    s_cbranch_scc1 L_end_m
    s_load_dwordx16 s[36:51], s[0:1], 0
    s_load_dwordx4 s[56:59], s[0:1], 64
    s_load_dwordx2 s[24:25], s[0:1], 80
    s_getpc_b64 s[26:27]
L_m_pc:
    s_sub_u32 s26, s26, L_m_pc-interleave_layers__sliding_local_dilated__mixer_gmlp__prompt_kernel
    s_subb_u32 s27, s27, 0
    v_lshlrev_b32 v4, 4, v0
    v_mov_b32 v5, s27
    v_add_co_u32 v6, vcc, s26, v4
    s_lshr_b32 s28, s2, 3
    s_lshl_b32 s28, s28, 11
    v_addc_co_u32 v7, vcc, 0, v5, vcc
    global_load_dwordx4 v[60:63], v[6:7], off
    v_lshl_add_u32 v4, v0, 2, s28
    v_min_u32 v4, L_end_m-interleave_layers__sliding_local_dilated__mixer_gmlp__prompt_kernel-4, v4
    v_add_co_u32 v6, vcc, s26, v4
    s_nop 1
    v_addc_co_u32 v7, vcc, 0, v5, vcc
    global_load_dword v64, v[6:7], off
    v_lshrrev_b32 v2, 6, v0
    v_and_b32 v1, 63, v0
    v_lshlrev_b32 v1, 4, v1
    v_readfirstlane_b32 s23, v2
    s_mov_b32 s22, 0
    s_mov_b32 s21, 0
    s_and_b32 s20, s23, 3
    s_waitcnt lgkmcnt(0)
    s_mov_b32 s4, s24
    s_mov_b32 s5, s25
    s_mov_b32 s6, 0x10000000
    s_mov_b32 s7, 0x20000
    s_mov_b32 s8, s46
    s_mov_b32 s9, s47
    s_mov_b32 s10, 0x800000
    s_mov_b32 s11, 0x20000
    s_mov_b32 s12, s48
    s_mov_b32 s13, s49
    s_mov_b32 s14, 0x1000
    s_mov_b32 s15, 0x20000
    s_mov_b32 s16, s56
    s_mov_b32 s17, s57
    s_mov_b32 s18, 0x240000
    s_mov_b32 s19, 0x20000
    s_cmp_ge_u32 s23, 4
    s_cbranch_scc1 L_ld_m
    v_bfe_u32 v2, v1, 4, 4
    v_lshrrev_b32 v3, 8, v1
    v_bfrev_b32 v6, 1
    v_mov_b32 v11, 0x3f803f80
    s_lshl_b32 s30, s20, 12
    s_and_b32 s29, s20, 1
    s_cmp_lt_u32 s2, 128
    s_cbranch_scc1 L_p0_x
    s_cmp_lt_u32 s2, 236
    s_cbranch_scc1 L_p0_wq
    s_cmp_lt_u32 s2, 254
    s_cbranch_scc1 L_p0_wo
    s_mov_b32 s46, 0
    s_mov_b32 s27, 0x800000
    s_barrier
    s_barrier
    s_branch L_p0_cd
L_p0_wo:
    s_mul_i32 s30, s20, 9216
    s_sub_u32 s26, s2, 236
    s_mul_i32 s28, s26, 57
    s_lshr_b32 s28, s28, 9
    s_mul_i32 s27, s28, 9
    s_sub_u32 s27, s26, s27
    s_mov_b32 s32, s40
    s_mov_b32 s33, s41
    s_mov_b32 s34, 0xa2000
    s_mov_b32 s35, 0x20000
    s_mul_i32 s29, s28, 331776
    s_lshl_b32 s31, s27, 7
    s_add_u32 s29, s29, s31
    s_mul_i32 s31, s20, 82944
    s_add_u32 s29, s29, s31
    v_lshrrev_b32 v4, 7, v1
    v_mul_u32_u24 v4, 1152, v4
    v_and_b32 v5, 0x70, v1
    v_add_u32 v4, v4, v5
    s_add_u32 m0, s30, 0
    s_add_u32 s31, s29, 0
    buffer_load_dwordx4 v4, s[32:35], s31 offen  lds
    s_add_u32 m0, s30, 1024
    s_add_u32 s31, s29, 9216
    buffer_load_dwordx4 v4, s[32:35], s31 offen  lds
    s_add_u32 m0, s30, 2048
    s_add_u32 s31, s29, 18432
    buffer_load_dwordx4 v4, s[32:35], s31 offen  lds
    s_add_u32 m0, s30, 3072
    s_add_u32 s31, s29, 27648
    buffer_load_dwordx4 v4, s[32:35], s31 offen  lds
    s_add_u32 m0, s30, 4096
    s_add_u32 s31, s29, 36864
    buffer_load_dwordx4 v4, s[32:35], s31 offen  lds
    s_add_u32 m0, s30, 5120
    s_add_u32 s31, s29, 46080
    buffer_load_dwordx4 v4, s[32:35], s31 offen  lds
    s_add_u32 m0, s30, 6144
    s_add_u32 s31, s29, 55296
    buffer_load_dwordx4 v4, s[32:35], s31 offen  lds
    s_add_u32 m0, s30, 7168
    s_add_u32 s31, s29, 64512
    buffer_load_dwordx4 v4, s[32:35], s31 offen  lds
    s_add_u32 m0, s30, 8192
    s_add_u32 s31, s29, 73728
    buffer_load_dwordx4 v4, s[32:35], s31 offen  lds
    s_barrier
    v_lshrrev_b32 v7, 2, v2
    v_and_b32 v8, 3, v2
    s_lshl_b32 s31, s20, 5
    s_add_u32 s31, s31, 0
    v_lshlrev_b32 v9, 7, v7
    v_lshl_add_u32 v9, v8, 3, v9
    v_add_u32 v9, s31, v9
    v_mul_u32_u24 v4, 512, v3
    v_add_u32 v4, v4, v9
    v_mul_u32_u24 v5, 9216, v3
    v_add_u32 v5, v5, v9
    s_lshl_b32 s31, s27, 2
    s_add_u32 s31, s31, s20
    v_lshl_add_u32 v7, s31, 2, v7
    v_lshlrev_b32 v8, 4, v8
    v_lshl_add_u32 v8, v3, 8, v8
    v_mul_u32_u24 v9, 57, v7
    v_lshrrev_b32 v9, 10, v9
    v_mul_u32_u24 v10, 18, v9
    v_sub_u32 v10, v7, v10
    v_lshrrev_b32 v12, 3, v10
    v_and_b32 v13, 1, v10
    v_lshl_add_u32 v12, v12, 1, v13
    v_bfe_u32 v14, v10, 1, 2
    v_cmp_gt_u32 vcc, 16, v10
    v_mul_u32_u24 v9, 82944, v9
    v_add_u32 v9, v9, v8
    v_cndmask_b32 v12, 8, v12, vcc
    v_cndmask_b32 v14, v13, v14, vcc
    v_mov_b32 v15, 0x1000
    v_mov_b32 v13, 0x80
    v_cndmask_b32 v15, v13, v15, vcc
    v_lshl_add_u32 v9, v12, 10, v9
    v_lshl_add_u32 v9, v14, 6, v9
    v_add_u32 v10, v9, v15
    s_and_b32 s31, s28, 1
    s_cmp_eq_u32 s31, 1
    s_cselect_b64 vcc, -1, 0
    v_cndmask_b32 v14, v9, v10, vcc
    s_mul_i32 s31, s28, 36864
    s_add_u32 s37, s31, 0x3a00000
    s_add_u32 s38, s31, 0x3a00000
    s_add_u32 s39, s31, 0x3a02400
    s_add_u32 s40, s31, 0x3a02400
    s_add_u32 s41, s31, 0x3a04800
    s_add_u32 s42, s31, 0x3a04800
    s_add_u32 s43, s31, 0x3a06c00
    s_add_u32 s47, s31, 0x3a06c00
    s_lshr_b32 s31, s28, 1
    s_mul_i32 s31, s31, 9216
    s_add_u32 s48, s31, 0x3a12000
    s_cmp_ge_u32 s26, 4
    s_cbranch_scc1 L_p0_n2
    s_lshl_b32 s31, s26, 2
    s_add_u32 s31, s31, s20
    s_lshl_b32 s31, s31, 12
    s_add_u32 s31, s31, 0x4508000
    v_and_b32 v56, 0x380, v1
    v_add_u32 v56, v56, v1
    v_mov_b32 v52, 0
    v_mov_b32 v53, 0
    v_mov_b32 v54, 0
    v_mov_b32 v55, 0
    buffer_store_dwordx4 v[52:55], v56, s[4:7], s31 offen offset:0 sc1
    buffer_store_dwordx4 v[52:55], v56, s[4:7], s31 offen offset:2048 sc1
L_p0_n2:
    s_waitcnt vmcnt(0)
    s_barrier
    ds_read_b64_tr_b16 v[16:17], v4 offset:0
    ds_read_b64_tr_b16 v[18:19], v4 offset:2560
    ds_read_b64_tr_b16 v[20:21], v4 offset:4608
    ds_read_b64_tr_b16 v[22:23], v4 offset:7168
    ds_read_b64_tr_b16 v[24:25], v4 offset:9216
    ds_read_b64_tr_b16 v[26:27], v4 offset:11776
    ds_read_b64_tr_b16 v[28:29], v4 offset:13824
    ds_read_b64_tr_b16 v[30:31], v4 offset:16384
    ds_read_b64_tr_b16 v[32:33], v4 offset:18432
    ds_read_b64_tr_b16 v[34:35], v4 offset:20992
    ds_read_b64_tr_b16 v[36:37], v4 offset:23040
    ds_read_b64_tr_b16 v[38:39], v4 offset:25600
    ds_read_b64_tr_b16 v[40:41], v4 offset:27648
    ds_read_b64_tr_b16 v[42:43], v4 offset:30208
    ds_read_b64_tr_b16 v[44:45], v4 offset:32256
    ds_read_b64_tr_b16 v[46:47], v4 offset:34816
    ds_read_b64_tr_b16 v[48:49], v5 offset:2048
    ds_read_b64_tr_b16 v[50:51], v5 offset:6656
    s_waitcnt lgkmcnt(15)
    s_mov_b32 s31, s37
    buffer_store_dwordx4 v[16:19], v9, s[4:7], s31 offen sc1
    s_waitcnt lgkmcnt(14)
    s_mov_b32 s31, s38
    buffer_store_dwordx4 v[20:23], v10, s[4:7], s31 offen sc1
    s_waitcnt lgkmcnt(12)
    s_mov_b32 s31, s39
    buffer_store_dwordx4 v[24:27], v9, s[4:7], s31 offen sc1
    s_waitcnt lgkmcnt(10)
    s_mov_b32 s31, s40
    buffer_store_dwordx4 v[28:31], v10, s[4:7], s31 offen sc1
    s_waitcnt lgkmcnt(8)
    s_mov_b32 s31, s41
    buffer_store_dwordx4 v[32:35], v9, s[4:7], s31 offen sc1
    s_waitcnt lgkmcnt(6)
    s_mov_b32 s31, s42
    buffer_store_dwordx4 v[36:39], v10, s[4:7], s31 offen sc1
    s_waitcnt lgkmcnt(4)
    s_mov_b32 s31, s43
    buffer_store_dwordx4 v[40:43], v9, s[4:7], s31 offen sc1
    s_waitcnt lgkmcnt(2)
    s_mov_b32 s31, s47
    buffer_store_dwordx4 v[44:47], v10, s[4:7], s31 offen sc1
    s_waitcnt lgkmcnt(0)
    s_mov_b32 s31, s48
    buffer_store_dwordx4 v[48:51], v14, s[4:7], s31 offen sc1
    s_mov_b32 s46, 1
    s_mov_b32 s27, 32
    s_branch L_p0_cd
L_p0_wq:
    s_mov_b32 s32, s38
    s_mov_b32 s33, s39
    s_mov_b32 s34, 0x1e6000
    s_mov_b32 s35, 0x20000
    s_sub_u32 s23, s2, 128
    s_mul_i32 s25, s23, 19
    s_lshr_b32 s25, s25, 9
    s_mul_i32 s24, s25, 27
    s_sub_u32 s24, s23, s24
    s_mul_i32 s26, s25, 497664
    s_lshl_b32 s31, s24, 7
    s_add_u32 s26, s26, s31
    v_lshrrev_b32 v4, 7, v1
    v_mul_u32_u24 v4, 3456, v4
    v_and_b32 v5, 0x70, v1
    v_add_u32 v4, v4, v5
    s_mul_i32 s31, s20, 110592
    s_add_u32 s27, s26, s31
    s_add_u32 m0, s30, 0
    s_add_u32 s31, s27, 0
    buffer_load_dwordx4 v4, s[32:35], s31 offen  lds
    s_add_u32 m0, s30, 1024
    s_add_u32 s31, s27, 27648
    buffer_load_dwordx4 v4, s[32:35], s31 offen  lds
    s_add_u32 m0, s30, 2048
    s_add_u32 s31, s27, 55296
    buffer_load_dwordx4 v4, s[32:35], s31 offen  lds
    s_add_u32 m0, s30, 3072
    s_add_u32 s31, s27, 82944
    buffer_load_dwordx4 v4, s[32:35], s31 offen  lds
    s_cmp_ge_u32 s20, 2
    s_cbranch_scc1 L_p0_q5
    s_lshl_b32 s31, s29, 10
    s_add_u32 m0, s31, 16384
    s_mul_i32 s31, s29, 27648
    s_add_u32 s31, s31, s26
    s_add_u32 s31, s31, 442368
    buffer_load_dwordx4 v4, s[32:35], s31 offen  lds
L_p0_q5:
    s_barrier
    v_lshrrev_b32 v7, 2, v2
    v_and_b32 v8, 3, v2
    s_lshl_b32 s31, s20, 5
    v_lshlrev_b32 v9, 7, v7
    v_lshl_add_u32 v9, v3, 3, v9
    v_add_u32 v9, s31, v9
    v_lshl_add_u32 v4, v8, 10, v9
    v_and_b32 v5, 1, v2
    v_mul_u32_u24 v5, 9216, v5
    v_add_u32 v5, v5, v9
    s_lshl_b32 s31, s24, 2
    s_add_u32 s31, s31, s20
    v_lshlrev_b32 v8, 4, v8
    v_lshl_add_u32 v8, v7, 8, v8
    v_lshl_add_u32 v7, s31, 2, v3
    v_mul_u32_u24 v9, 57, v7
    v_lshrrev_b32 v9, 13, v9
    v_mul_u32_u24 v10, 144, v9
    v_sub_u32 v10, v7, v10
    v_mul_u32_u24 v12, 57, v10
    v_lshrrev_b32 v12, 9, v12
    v_mul_u32_u24 v13, 9, v12
    v_sub_u32 v13, v10, v13
    v_cmp_lt_u32 s[36:37], 4, v13
    v_cmp_eq_u32 s[38:39], 4, v13
    v_cmp_eq_u32 s[40:41], 2, v9
    v_lshlrev_b32 v14, 1, v9
    v_add_u32 v15, 1, v14
    v_subrev_u32 v10, 5, v13
    v_cndmask_b32 v14, v14, v15, s[36:37]
    v_cndmask_b32 v13, v13, v10, s[36:37]
    v_cndmask_b32 v14, v14, 6, s[38:39]
    v_cndmask_b32 v13, v13, v9, s[38:39]
    s_and_b64 s[40:41], s[40:41], s[38:39]
    s_mov_b32 s31, 129024
    v_mul_lo_u32 v9, v12, s31
    v_add_u32 v9, v9, v8
    v_lshl_add_u32 v9, v14, 10, v9
    v_lshl_add_u32 v9, v13, 6, v9
    s_and_b32 s31, s25, 1
    v_lshrrev_b32 v8, 3, v2
    v_cmp_eq_u32 vcc, s31, v8
    v_add_u32 v15, 64, v9
    v_cndmask_b32 v15, v6, v15, s[40:41]
    v_cndmask_b32 v8, v6, v9, vcc
    v_lshlrev_b32 v10, 2, v2
    v_lshl_add_u32 v10, v7, 4, v10
    v_cmp_gt_u32 vcc, 4, v2
    s_lshl_b32 s45, s25, 13
    s_add_u32 s45, s45, 0x4400000
    v_cndmask_b32 v10, v6, v10, vcc
    s_mul_i32 s42, s25, 28672
    s_add_u32 s42, s42, 0x3800000
    s_lshr_b32 s44, s25, 1
    s_mul_i32 s44, s44, 7168
    s_add_u32 s44, s44, 0x381c000
    s_mul_i32 s26, s24, 29
    s_lshr_b32 s26, s26, 8
    s_mul_i32 s27, s26, 9
    s_sub_u32 s27, s24, s27
    s_lshl_b32 s27, s27, 4
    s_add_u32 s28, s27, 16
    v_lshrrev_b32 v254, 4, v1
    v_mul_u32_u24 v7, 9, v254
    v_add_u32 v255, 9, v7
    v_min_u32 v255, s28, v255
    v_max_u32 v7, s27, v7
    v_sub_u32 v255, v255, v7
    v_cmp_lt_i32 vcc, 0, v255
    v_lshlrev_b32 v254, 8, v254
    v_mov_b32 v14, 0x3f003f00
    v_cndmask_b32 v254, v6, v254, vcc
    s_cmp_eq_u64 s[40:41], 0
    s_cbranch_scc1 L_p0_np
    v_mov_b32 v52, 0
    v_mov_b32 v53, 0
    v_mov_b32 v54, 0
    v_mov_b32 v55, 0
    s_add_u32 s31, s42, 0
    buffer_store_dwordx4 v[52:55], v15, s[4:7], s31 offen sc1
    s_add_u32 s31, s42, 7168
    buffer_store_dwordx4 v[52:55], v15, s[4:7], s31 offen sc1
    s_add_u32 s31, s42, 14336
    buffer_store_dwordx4 v[52:55], v15, s[4:7], s31 offen sc1
    s_add_u32 s31, s42, 21504
    buffer_store_dwordx4 v[52:55], v15, s[4:7], s31 offen sc1
    s_mov_b32 s31, s44
    buffer_store_dwordx4 v[52:55], v15, s[4:7], s31 offen sc1
    s_waitcnt vmcnt(5)
    s_branch L_p0_n3
L_p0_np:
    s_waitcnt vmcnt(0)
L_p0_n3:
    s_barrier
    ds_read_b64_tr_b16 v[16:17], v4 offset:0
    ds_read_b64_tr_b16 v[18:19], v4 offset:512
    ds_read_b64_tr_b16 v[20:21], v4 offset:4096
    ds_read_b64_tr_b16 v[22:23], v4 offset:4608
    ds_read_b64_tr_b16 v[24:25], v4 offset:9216
    ds_read_b64_tr_b16 v[26:27], v4 offset:9728
    ds_read_b64_tr_b16 v[28:29], v4 offset:13312
    ds_read_b64_tr_b16 v[30:31], v4 offset:13824
    ds_read_b64_tr_b16 v[32:33], v5 offset:8192
    ds_read_b64_tr_b16 v[34:35], v5 offset:8704
    s_waitcnt lgkmcnt(8)
    s_add_u32 s31, s42, 0
    buffer_store_dwordx4 v[16:19], v9, s[4:7], s31 offen sc1
    s_waitcnt lgkmcnt(6)
    s_add_u32 s31, s42, 7168
    buffer_store_dwordx4 v[20:23], v9, s[4:7], s31 offen sc1
    s_waitcnt lgkmcnt(4)
    s_add_u32 s31, s42, 14336
    buffer_store_dwordx4 v[24:27], v9, s[4:7], s31 offen sc1
    s_waitcnt lgkmcnt(2)
    s_add_u32 s31, s42, 21504
    buffer_store_dwordx4 v[28:31], v9, s[4:7], s31 offen sc1
    s_waitcnt lgkmcnt(0)
    s_mov_b32 s31, s44
    buffer_store_dwordx4 v[32:35], v8, s[4:7], s31 offen sc1
    v_dot2_f32_bf16 v12, v16, v11, 0
    v_dot2_f32_bf16 v13, v17, v11, 0
    v_dot2_f32_bf16 v12, v18, v11, v12
    v_dot2_f32_bf16 v13, v19, v11, v13
    v_dot2_f32_bf16 v12, v20, v11, v12
    v_dot2_f32_bf16 v13, v21, v11, v13
    v_dot2_f32_bf16 v12, v22, v11, v12
    v_dot2_f32_bf16 v13, v23, v11, v13
    v_dot2_f32_bf16 v12, v24, v11, v12
    v_dot2_f32_bf16 v13, v25, v11, v13
    v_dot2_f32_bf16 v12, v26, v11, v12
    v_dot2_f32_bf16 v13, v27, v11, v13
    v_dot2_f32_bf16 v12, v28, v11, v12
    v_dot2_f32_bf16 v13, v29, v11, v13
    v_dot2_f32_bf16 v12, v30, v11, v12
    v_dot2_f32_bf16 v13, v31, v11, v13
    v_dot2_f32_bf16 v12, v32, v14, v12
    v_dot2_f32_bf16 v13, v33, v14, v13
    v_dot2_f32_bf16 v12, v34, v14, v12
    v_dot2_f32_bf16 v13, v35, v14, v13
    s_nop 2
    v_add_f32 v12, v12, v13
    s_nop 1
    v_add_f32_dpp v12, v12, v12 row_ror:4 row_mask:0xf bank_mask:0xf
    s_nop 1
    v_add_f32_dpp v12, v12, v12 row_ror:8 row_mask:0xf bank_mask:0xf
    buffer_store_dword v12, v10, s[4:7], s45 offen sc1
    s_branch L_p0_ce
L_p0_x:
    s_mov_b32 s32, s36
    s_mov_b32 s33, s37
    s_mov_b32 s34, 0x240000
    s_mov_b32 s35, 0x20000
    s_mul_i32 s26, s2, 18432
    s_mov_b32 m0, s30
    s_add_u32 s31, s26, s30
    buffer_load_dwordx4 v1, s[32:35], s31 offen offset:0  lds
    buffer_load_dwordx4 v1, s[32:35], s31 offen offset:1024  lds
    buffer_load_dwordx4 v1, s[32:35], s31 offen offset:2048  lds
    buffer_load_dwordx4 v1, s[32:35], s31 offen offset:3072  lds
    s_lshl_b32 s27, s29, 10
    s_add_u32 s27, s27, 16384
    s_mov_b32 m0, s27
    s_add_u32 s31, s26, s27
    buffer_load_dwordx4 v1, s[32:35], s31 offen  lds
    s_barrier
    s_mul_i32 s31, s20, 288
    v_mul_u32_u24 v7, 1152, v2
    v_lshl_add_u32 v4, v3, 4, v7
    v_add_u32 v4, s31, v4
    s_mul_i32 s31, s29, 576
    v_mul_u32_u24 v5, 144, v3
    v_add3_u32 v5, v5, v7, s31
    s_add_u32 s26, s26, 0x0
    s_add_u32 s42, s26, s30
    s_add_u32 s44, s26, s27
    s_lshl_b32 s45, s2, 10
    s_lshl_b32 s31, s20, 8
    s_add_u32 s45, s45, s31
    s_add_u32 s45, s45, 0x1b00000
    v_cmp_gt_u32 vcc, 2, v3
    v_lshrrev_b32 v10, 1, v1
    s_mov_b32 s46, 2
    v_cndmask_b32 v10, v6, v10, vcc
    s_lshr_b32 s27, s2, 3
    s_add_u32 s27, s27, 48
    s_waitcnt vmcnt(0)
    s_barrier
    ds_read_b128 v[16:19], v4 offset:0
    ds_read_b128 v[20:23], v4 offset:64
    ds_read_b128 v[24:27], v4 offset:144
    ds_read_b128 v[28:31], v4 offset:208
    ds_read_b128 v[32:35], v5 offset:128
    s_waitcnt lgkmcnt(4)
    buffer_store_dwordx4 v[16:19], v1, s[4:7], s42 offen offset:0 sc1
    s_waitcnt lgkmcnt(3)
    buffer_store_dwordx4 v[20:23], v1, s[4:7], s42 offen offset:1024 sc1
    s_waitcnt lgkmcnt(2)
    buffer_store_dwordx4 v[24:27], v1, s[4:7], s42 offen offset:2048 sc1
    s_waitcnt lgkmcnt(1)
    buffer_store_dwordx4 v[28:31], v1, s[4:7], s42 offen offset:3072 sc1
    v_dot2_f32_bf16 v12, v16, v11, 0
    v_dot2_f32_bf16 v13, v16, v16, 0
    v_dot2_f32_bf16 v12, v17, v11, v12
    v_dot2_f32_bf16 v13, v17, v17, v13
    v_dot2_f32_bf16 v12, v18, v11, v12
    v_dot2_f32_bf16 v13, v18, v18, v13
    v_dot2_f32_bf16 v12, v19, v11, v12
    v_dot2_f32_bf16 v13, v19, v19, v13
    v_dot2_f32_bf16 v12, v20, v11, v12
    v_dot2_f32_bf16 v13, v20, v20, v13
    v_dot2_f32_bf16 v12, v21, v11, v12
    v_dot2_f32_bf16 v13, v21, v21, v13
    v_dot2_f32_bf16 v12, v22, v11, v12
    v_dot2_f32_bf16 v13, v22, v22, v13
    v_dot2_f32_bf16 v12, v23, v11, v12
    v_dot2_f32_bf16 v13, v23, v23, v13
    v_dot2_f32_bf16 v12, v24, v11, v12
    v_dot2_f32_bf16 v13, v24, v24, v13
    v_dot2_f32_bf16 v12, v25, v11, v12
    v_dot2_f32_bf16 v13, v25, v25, v13
    v_dot2_f32_bf16 v12, v26, v11, v12
    v_dot2_f32_bf16 v13, v26, v26, v13
    v_dot2_f32_bf16 v12, v27, v11, v12
    v_dot2_f32_bf16 v13, v27, v27, v13
    v_dot2_f32_bf16 v12, v28, v11, v12
    v_dot2_f32_bf16 v13, v28, v28, v13
    v_dot2_f32_bf16 v12, v29, v11, v12
    v_dot2_f32_bf16 v13, v29, v29, v13
    v_dot2_f32_bf16 v12, v30, v11, v12
    v_dot2_f32_bf16 v13, v30, v30, v13
    v_dot2_f32_bf16 v12, v31, v11, v12
    v_dot2_f32_bf16 v13, v31, v31, v13
    s_waitcnt lgkmcnt(0)
    s_cmp_ge_u32 s20, 2
    s_cbranch_scc1 L_p0_xs
    buffer_store_dwordx4 v[32:35], v1, s[4:7], s44 offen sc1
    v_dot2_f32_bf16 v12, v32, v11, v12
    v_dot2_f32_bf16 v13, v32, v32, v13
    v_dot2_f32_bf16 v12, v33, v11, v12
    v_dot2_f32_bf16 v13, v33, v33, v13
    v_dot2_f32_bf16 v12, v34, v11, v12
    v_dot2_f32_bf16 v13, v34, v34, v13
    v_dot2_f32_bf16 v12, v35, v11, v12
    v_dot2_f32_bf16 v13, v35, v35, v13
L_p0_xs:
    s_nop 2
    v_mov_b32 v14, v12
    v_mov_b32 v15, v13
    s_nop 1
    v_permlane32_swap_b32 v12, v14
    v_permlane32_swap_b32 v13, v15
    v_add_f32 v12, v12, v14
    v_add_f32 v13, v13, v15
    buffer_store_dwordx2 v[12:13], v10, s[4:7], s45 offen sc1
L_p0_cd:
    v_cmp_eq_u32 vcc, 0, v1
    s_lshl_b32 s27, s27, 8
    v_mov_b32 v255, s46
    v_mov_b32 v254, s27
    v_cndmask_b32 v254, v6, v254, vcc
L_p0_ce:
    s_mov_b32 s48, s58
    s_mov_b32 s49, s59
    s_mov_b32 s50, 0x100
    s_mov_b32 s51, 0x20000
    v_mov_b32 v4, 0
    buffer_load_dword v246, v4, s[48:51], 0 offen sc1
    s_barrier
    s_branch L_m_cl
L_d1_first:
    v_cmp_gt_u32 vcc, 4, v246
    v_mov_b32 v4, 0
    s_mov_b32 s46, 0x4500000
    s_cbranch_vccz L_pd_dbg
    s_mov_b32 s60, 65536
L_poll_dbg:
    buffer_load_dword v5, v4, s[48:51], 0 offen sc1
    s_waitcnt vmcnt(0)
    v_cmp_gt_u32 vcc, 4, v5
    s_sub_u32 s60, s60, 1
    s_cbranch_scc1 L_pd_dbg
    s_cbranch_vccz L_pd_dbg
    s_sleep 4
    s_branch L_poll_dbg
L_pd_dbg:
    buffer_atomic_add v255, v254, s[4:7], s46 offen sc1
    s_branch L_ns_d1
L_ld_m:
    s_cmp_lg_u32 s2, 0
    s_cbranch_scc1 L_p0_nz
    s_lshl_b32 s31, s20, 12
    s_add_u32 s31, s31, 0x4500000
    v_and_b32 v56, 0x380, v1
    v_add_u32 v56, v56, v1
    v_mov_b32 v52, 0
    v_mov_b32 v53, 0
    v_mov_b32 v54, 0
    v_mov_b32 v55, 0
    buffer_store_dwordx4 v[52:55], v56, s[4:7], s31 offen offset:0 sc1
    buffer_store_dwordx4 v[52:55], v56, s[4:7], s31 offen offset:2048 sc1
    s_waitcnt vmcnt(0)
    s_mov_b32 s53, 1
    s_atomic_add s53, s[58:59], 0
L_p0_nz:
    v_bfe_u32 v2, v1, 4, 4
    v_lshrrev_b32 v3, 8, v1
    v_bfrev_b32 v6, 1
    v_mov_b32 v11, 0x3f803f80
    s_mul_i32 s30, s20, 9216
    s_cmp_lt_u32 s2, 144
    s_cbranch_scc1 L_p0_wi
    s_cmp_lt_u32 s2, 216
    s_cbranch_scc1 L_p0_wu
    v_mov_b32 v9, v6
    v_mov_b32 v10, v6
    v_mov_b32 v14, v6
    v_mov_b32 v15, v6
    s_mov_b32 s37, 0
    s_mov_b32 s38, 0
    s_mov_b32 s39, 0
    s_mov_b32 s40, 0
    s_mov_b32 s41, 0
    s_mov_b32 s42, 0
    s_mov_b32 s43, 0
    s_mov_b32 s47, 0
    s_mov_b32 s48, 0
    s_mov_b32 s49, 0
    s_barrier
    s_barrier
    s_barrier
    s_barrier
    s_barrier
    s_branch L_p0_ld
L_p0_wu:
    s_sub_u32 s26, s2, 144
    s_mul_i32 s28, s26, 57
    s_lshr_b32 s28, s28, 9
    s_mul_i32 s27, s28, 9
    s_sub_u32 s27, s26, s27
    s_mov_b32 s32, s50
    s_mov_b32 s33, s51
    s_mov_b32 s34, 0x288000
    s_mov_b32 s35, 0x20000
    s_mul_i32 s29, s28, 331776
    s_lshl_b32 s31, s27, 7
    s_add_u32 s29, s29, s31
    s_mul_i32 s31, s20, 82944
    s_add_u32 s29, s29, s31
    v_lshrrev_b32 v4, 7, v1
    v_mul_u32_u24 v4, 1152, v4
    v_and_b32 v5, 0x70, v1
    v_add_u32 v4, v4, v5
    s_barrier
    s_barrier
    s_barrier
    s_barrier
    s_barrier
    s_add_u32 m0, s30, 94208
    s_add_u32 s31, s29, 0
    buffer_load_dwordx4 v4, s[32:35], s31 offen  lds
    s_add_u32 m0, s30, 95232
    s_add_u32 s31, s29, 9216
    buffer_load_dwordx4 v4, s[32:35], s31 offen  lds
    s_add_u32 m0, s30, 96256
    s_add_u32 s31, s29, 18432
    buffer_load_dwordx4 v4, s[32:35], s31 offen  lds
    s_add_u32 m0, s30, 97280
    s_add_u32 s31, s29, 27648
    buffer_load_dwordx4 v4, s[32:35], s31 offen  lds
    s_add_u32 m0, s30, 98304
    s_add_u32 s31, s29, 36864
    buffer_load_dwordx4 v4, s[32:35], s31 offen  lds
    s_add_u32 m0, s30, 99328
    s_add_u32 s31, s29, 46080
    buffer_load_dwordx4 v4, s[32:35], s31 offen  lds
    s_add_u32 m0, s30, 100352
    s_add_u32 s31, s29, 55296
    buffer_load_dwordx4 v4, s[32:35], s31 offen  lds
    s_add_u32 m0, s30, 101376
    s_add_u32 s31, s29, 64512
    buffer_load_dwordx4 v4, s[32:35], s31 offen  lds
    s_add_u32 m0, s30, 102400
    s_add_u32 s31, s29, 73728
    buffer_load_dwordx4 v4, s[32:35], s31 offen  lds
    v_lshrrev_b32 v7, 2, v2
    v_and_b32 v8, 3, v2
    s_lshl_b32 s31, s20, 5
    s_add_u32 s31, s31, 94208
    v_lshlrev_b32 v9, 7, v7
    v_lshl_add_u32 v9, v8, 3, v9
    v_add_u32 v9, s31, v9
    v_mul_u32_u24 v4, 512, v3
    v_add_u32 v4, v4, v9
    v_mul_u32_u24 v5, 512, v3
    v_add_u32 v5, v5, v9
    s_lshl_b32 s31, s27, 2
    s_add_u32 s31, s31, s20
    v_lshl_add_u32 v7, s31, 2, v7
    v_lshlrev_b32 v8, 4, v8
    v_lshl_add_u32 v8, v3, 8, v8
    v_mul_u32_u24 v9, 57, v7
    v_lshrrev_b32 v9, 10, v9
    v_mul_u32_u24 v10, 18, v9
    v_sub_u32 v10, v7, v10
    v_lshrrev_b32 v12, 3, v10
    v_and_b32 v13, 1, v10
    v_lshl_add_u32 v12, v12, 1, v13
    v_bfe_u32 v14, v10, 1, 2
    v_cmp_gt_u32 vcc, 16, v10
    v_mul_u32_u24 v9, 331776, v9
    v_add_u32 v9, v9, v8
    v_cndmask_b32 v12, 8, v12, vcc
    v_cndmask_b32 v14, v13, v14, vcc
    v_mov_b32 v15, 0x1000
    v_mov_b32 v13, 0x80
    v_cndmask_b32 v15, v13, v15, vcc
    v_lshl_add_u32 v9, v12, 10, v9
    v_lshl_add_u32 v9, v14, 6, v9
    v_add_u32 v10, v9, v15
    s_and_b32 s31, s28, 1
    s_cmp_eq_u32 s31, 1
    s_cselect_b64 vcc, -1, 0
    v_cndmask_b32 v14, v9, v10, vcc
    s_mul_i32 s31, s28, 9216
    s_add_u32 s37, s31, 0x4100000
    s_add_u32 s38, s31, 0x4100000
    s_add_u32 s39, s31, 0x4112000
    s_add_u32 s40, s31, 0x4112000
    s_add_u32 s41, s31, 0x4124000
    s_add_u32 s42, s31, 0x4124000
    s_add_u32 s43, s31, 0x4136000
    s_add_u32 s47, s31, 0x4136000
    s_lshr_b32 s31, s28, 1
    s_mul_i32 s31, s31, 9216
    s_add_u32 s48, s31, 0x4148000
    v_mov_b32 v15, v6
    s_mov_b32 s49, 0
    s_branch L_p0_ld
L_p0_wi:
    s_mov_b32 s26, s2
    s_mul_i32 s28, s26, 57
    s_lshr_b32 s28, s28, 12
    s_mul_i32 s27, s28, 72
    s_sub_u32 s27, s26, s27
    s_mov_b32 s32, s44
    s_mov_b32 s33, s45
    s_mov_b32 s34, 0x510000
    s_mov_b32 s35, 0x20000
    s_mul_i32 s29, s28, 2654208
    s_lshl_b32 s31, s27, 7
    s_add_u32 s29, s29, s31
    s_mul_i32 s31, s20, 663552
    s_add_u32 s29, s29, s31
    v_lshrrev_b32 v4, 7, v1
    v_mul_u32_u24 v4, 9216, v4
    v_and_b32 v5, 0x70, v1
    v_add_u32 v4, v4, v5
    s_barrier
    s_barrier
    s_barrier
    s_barrier
    s_barrier
    s_add_u32 m0, s30, 94208
    s_add_u32 s31, s29, 0
    buffer_load_dwordx4 v4, s[32:35], s31 offen  lds
    s_add_u32 m0, s30, 95232
    s_add_u32 s31, s29, 73728
    buffer_load_dwordx4 v4, s[32:35], s31 offen  lds
    s_add_u32 m0, s30, 96256
    s_add_u32 s31, s29, 147456
    buffer_load_dwordx4 v4, s[32:35], s31 offen  lds
    s_add_u32 m0, s30, 97280
    s_add_u32 s31, s29, 221184
    buffer_load_dwordx4 v4, s[32:35], s31 offen  lds
    s_add_u32 m0, s30, 98304
    s_add_u32 s31, s29, 294912
    buffer_load_dwordx4 v4, s[32:35], s31 offen  lds
    s_add_u32 m0, s30, 99328
    s_add_u32 s31, s29, 368640
    buffer_load_dwordx4 v4, s[32:35], s31 offen  lds
    s_add_u32 m0, s30, 100352
    s_add_u32 s31, s29, 442368
    buffer_load_dwordx4 v4, s[32:35], s31 offen  lds
    s_add_u32 m0, s30, 101376
    s_add_u32 s31, s29, 516096
    buffer_load_dwordx4 v4, s[32:35], s31 offen  lds
    s_add_u32 m0, s30, 102400
    s_add_u32 s31, s29, 589824
    buffer_load_dwordx4 v4, s[32:35], s31 offen  lds
    v_lshrrev_b32 v7, 2, v2
    v_and_b32 v8, 3, v2
    s_lshl_b32 s31, s20, 5
    s_add_u32 s31, s31, 94208
    v_lshlrev_b32 v9, 7, v7
    v_lshl_add_u32 v9, v8, 3, v9
    v_add_u32 v9, s31, v9
    v_mul_u32_u24 v4, 1024, v3
    v_add_u32 v4, v4, v9
    v_mul_u32_u24 v5, 9216, v3
    v_add_u32 v5, v5, v9
    s_lshl_b32 s31, s27, 2
    s_add_u32 s31, s31, s20
    v_lshl_add_u32 v7, s31, 2, v7
    v_lshlrev_b32 v8, 4, v8
    v_lshl_add_u32 v8, v3, 8, v8
    s_cmp_lt_u32 s31, 144
    s_cselect_b32 s23, 1, 0
    s_cselect_b32 s24, 0, 144
    s_sub_u32 s26, s31, s24
    s_mul_i32 s25, s26, 57
    s_lshr_b32 s25, s25, 9
    s_mul_i32 s24, s25, 9
    s_sub_u32 s24, s26, s24
    s_lshl_b32 s26, s25, 1
    s_add_u32 s26, s26, s23
    s_mul_i32 s26, s26, 165888
    s_lshl_b32 s31, s24, 10
    s_add_u32 s26, s26, s31
    s_add_u32 s26, s26, 0x3b00000
    s_mul_i32 s31, s28, 9216
    s_add_u32 s48, s26, s31
    s_add_u32 s48, s48, 147456
    s_lshl_b32 s31, s31, 3
    s_add_u32 s26, s26, s31
    s_add_u32 s37, s26, 0
    s_add_u32 s38, s26, 9216
    s_add_u32 s39, s26, 18432
    s_add_u32 s40, s26, 27648
    s_add_u32 s41, s26, 36864
    s_add_u32 s42, s26, 46080
    s_add_u32 s43, s26, 55296
    s_add_u32 s47, s26, 64512
    s_lshl_b32 s49, s25, 12
    s_mul_i32 s31, s28, 1152
    s_add_u32 s49, s49, s31
    s_mul_i32 s31, s23, 576
    s_add_u32 s49, s49, s31
    s_lshl_b32 s31, s24, 6
    s_add_u32 s49, s49, s31
    s_add_u32 s49, s49, 0x4410000
    v_cmp_eq_u32 vcc, 0, v3
    v_lshlrev_b32 v15, 2, v2
    v_mov_b32 v9, v1
    v_mov_b32 v10, v1
    v_mov_b32 v14, v1
    v_cndmask_b32 v15, v6, v15, vcc
L_p0_ld:
    s_waitcnt lgkmcnt(0)
    s_branch L_m_l1
L_m_cl:
    s_and_b32 s25, s2, 7
    s_lshr_b32 s26, s2, 3
    s_lshr_b32 s23, s25, 1
    s_lshl_b32 s23, s23, 2
    s_lshr_b32 s27, s26, 3
    s_add_u32 s23, s23, s27
    s_and_b32 s24, s25, 1
    s_lshl_b32 s24, s24, 3
    s_and_b32 s27, s26, 7
    s_add_u32 s24, s24, s27
    s_lshl_b32 s30, s23, 3
    s_lshl_b32 s31, s20, 1
    s_add_u32 s31, s30, s31
    s_mul_i32 s29, s31, 18432
    s_add_u32 s29, s29, s21
    s_add_u32 s35, s29, 0x600000
    s_add_u32 s29, s29, 0x0
    s_max_u32 s30, s30, 1
    s_sub_u32 s30, s30, 1
    s_lshl_b32 s30, s30, 10
    s_add_u32 s30, s30, s21
    s_add_u32 s30, s30, 0x1b00000
    s_lshl_b32 s32, s31, 10
    s_add_u32 s32, s32, s21
    s_add_u32 s32, s32, 0x1b00000
    v_bfe_u32 v2, v1, 4, 4
    v_lshrrev_b32 v3, 8, v1
    s_lshl_b32 s33, s20, 2
    s_lshr_b32 s33, 0x3362, s33
    s_and_b32 s33, s33, 15
    s_min_u32 s34, s20, 1
    s_add_u32 s34, s34, 4
    s_lshl_b32 s36, s33, 10
    s_lshl_b32 s37, s34, 10
    v_add_u32 v247, 64512, v1
    v_add_u32 v248, 131072, v1
    v_add_u32 v249, s36, v1
    v_add_u32 v250, s36, v247
    v_add_u32 v251, s37, v1
    v_add_u32 v252, s37, v247
    v_add_u32 v253, 18432, v1
    v_lshrrev_b32 v0, 1, v1
    s_add_u32 s38, s29, 0
    s_add_u32 s39, s29, 4096
    s_add_u32 s40, s29, 8192
    s_add_u32 s41, s29, 12288
    s_add_u32 s42, s29, 16384
    s_max_u32 s44, s23, 1
    s_sub_u32 s44, s44, 1
    s_lshl_b32 s52, s22, 7
    s_add_u32 s52, s52, s23
    s_lshl_b32 s52, s52, 8
    s_add_u32 s52, s52, 0x4503000
    s_add_u32 s52, s52, s4
    s_addc_u32 s53, s5, 0
    s_lshl_b32 s54, s22, 7
    s_add_u32 s54, s54, s44
    s_lshl_b32 s54, s54, 8
    s_add_u32 s54, s54, 0x4503000
    s_add_u32 s54, s54, s4
    s_addc_u32 s55, s5, 0
    s_lshl_b32 s44, s24, 8
    s_add_u32 s44, s44, 0x4500000
    s_add_u32 s44, s44, s4
    s_addc_u32 s45, s5, 0
    s_waitcnt vmcnt(0)
    s_barrier
    s_cmp_lg_u32 s20, 0
    s_cbranch_scc1 L_ns_d1
    s_cmp_eq_u32 s22, 0
    s_cbranch_scc1 L_d1_first
    s_mov_b32 s56, 1
    s_atomic_add s56, s[50:51], 0
L_ns_d1:
    s_barrier
    s_cmp_lg_u32 s20, 0
    s_cbranch_scc1 L_pd_d1
    s_mov_b32 s60, 65536
L_poll_d1:
    s_mov_b32 s57, 0
    s_atomic_add s57, s[52:53], 0 glc
    s_mov_b32 s58, 0
    s_atomic_add s58, s[54:55], 0 glc
    s_mov_b32 s59, 0
    s_atomic_add s59, s[44:45], 0 glc
    s_waitcnt lgkmcnt(0)
    s_cmp_ge_u32 s59, 108
    s_cselect_b32 s59, 16, 0
    s_min_u32 s57, s57, s58
    s_min_u32 s57, s57, s59
    s_cmp_ge_u32 s57, 16
    s_cbranch_scc1 L_pd_d1
    s_sub_u32 s60, s60, 1
    s_cbranch_scc1 L_pd_d1
    s_sleep 2
    s_branch L_poll_d1
L_pd_d1:
    s_barrier
    buffer_load_dwordx4 v[160:163], v1, s[4:7], s38 offen offset:0 sc1
    buffer_load_dwordx4 v[164:167], v253, s[4:7], s38 offen offset:0 sc1
    buffer_load_dwordx4 v[168:171], v1, s[4:7], s38 offen offset:1024 sc1
    buffer_load_dwordx4 v[172:175], v253, s[4:7], s38 offen offset:1024 sc1
    buffer_load_dwordx4 v[176:179], v1, s[4:7], s38 offen offset:2048 sc1
    buffer_load_dwordx4 v[180:183], v253, s[4:7], s38 offen offset:2048 sc1
    buffer_load_dwordx4 v[184:187], v1, s[4:7], s38 offen offset:3072 sc1
    buffer_load_dwordx4 v[188:191], v253, s[4:7], s38 offen offset:3072 sc1
    s_barrier
    ds_read_b128 v[80:83], v1 offset:0
    ds_read_b128 v[84:87], v1 offset:1024
    ds_read_b128 v[88:91], v1 offset:2048
    ds_read_b128 v[92:95], v1 offset:3072
    ds_read_b128 v[96:99], v1 offset:4096
    ds_read_b128 v[100:103], v1 offset:5120
    ds_read_b128 v[104:107], v1 offset:6144
    buffer_load_dwordx2 v[4:5], v0, s[4:7], s30 offen offset:0 sc1
    buffer_load_dwordx2 v[6:7], v0, s[4:7], s30 offen offset:512 sc1
    buffer_load_dwordx2 v[8:9], v0, s[4:7], s32 offen offset:0 sc1
    buffer_load_dwordx2 v[10:11], v0, s[4:7], s32 offen offset:512 sc1
    buffer_load_dwordx2 v[12:13], v0, s[4:7], s32 offen offset:1024 sc1
    buffer_load_dwordx2 v[14:15], v0, s[4:7], s32 offen offset:1536 sc1
    s_lshl_b32 s50, s22, 7
    s_add_u32 s50, s50, s23
    s_lshl_b32 s50, s50, 8
    s_add_u32 s50, s50, 0x4508000
    s_add_u32 s50, s50, s4
    s_addc_u32 s51, s5, 0
    s_waitcnt vmcnt(12) lgkmcnt(3)
    v_mfma_f32_16x16x32_bf16 v[16:19], v[80:83], v[160:163], 0
    ds_read_b128 v[120:123], v1 offset:7168
    v_mfma_f32_16x16x32_bf16 v[44:47], v[80:83], v[164:167], 0
    ds_read_b128 v[124:127], v1 offset:8192
    v_mfma_f32_16x16x32_bf16 v[20:23], v[84:87], v[160:163], 0
    ds_read_b128 v[128:131], v1 offset:9216
    v_mfma_f32_16x16x32_bf16 v[48:51], v[84:87], v[164:167], 0
    ds_read_b128 v[132:135], v1 offset:10240
    v_mfma_f32_16x16x32_bf16 v[24:27], v[88:91], v[160:163], 0
    ds_read_b128 v[136:139], v1 offset:11264
    v_mfma_f32_16x16x32_bf16 v[52:55], v[88:91], v[164:167], 0
    ds_read_b128 v[140:143], v1 offset:12288
    v_mfma_f32_16x16x32_bf16 v[28:31], v[92:95], v[160:163], 0
    ds_read_b128 v[144:147], v1 offset:13312
    v_mfma_f32_16x16x32_bf16 v[56:59], v[92:95], v[164:167], 0
    s_waitcnt lgkmcnt(7)
    v_mfma_f32_16x16x32_bf16 v[32:35], v[160:163], v[96:99], 0
    v_mfma_f32_16x16x32_bf16 v[60:63], v[164:167], v[96:99], 0
    v_mfma_f32_16x16x32_bf16 v[36:39], v[160:163], v[100:103], 0
    buffer_load_dwordx4 v[192:195], v1, s[4:7], s39 offen offset:0 sc1
    v_mfma_f32_16x16x32_bf16 v[64:67], v[164:167], v[100:103], 0
    buffer_load_dwordx4 v[196:199], v253, s[4:7], s39 offen offset:0 sc1
    v_mfma_f32_16x16x32_bf16 v[40:43], v[104:107], v[160:163], 0
    buffer_load_dwordx4 v[200:203], v1, s[4:7], s39 offen offset:1024 sc1
    v_mfma_f32_16x16x32_bf16 v[68:71], v[104:107], v[164:167], 0
    buffer_load_dwordx4 v[204:207], v253, s[4:7], s39 offen offset:1024 sc1
    s_waitcnt vmcnt(14) lgkmcnt(3)
    s_barrier
    v_mfma_f32_16x16x32_bf16 v[16:19], v[120:123], v[168:171], v[16:19]
    ds_read_b128 v[80:83], v1 offset:14336
    v_mfma_f32_16x16x32_bf16 v[44:47], v[120:123], v[172:175], v[44:47]
    ds_read_b128 v[84:87], v1 offset:15360
    v_mfma_f32_16x16x32_bf16 v[20:23], v[124:127], v[168:171], v[20:23]
    ds_read_b128 v[88:91], v1 offset:16384
    v_mfma_f32_16x16x32_bf16 v[48:51], v[124:127], v[172:175], v[48:51]
    ds_read_b128 v[92:95], v1 offset:17408
    v_mfma_f32_16x16x32_bf16 v[24:27], v[128:131], v[168:171], v[24:27]
    ds_read_b128 v[96:99], v1 offset:18432
    v_mfma_f32_16x16x32_bf16 v[52:55], v[128:131], v[172:175], v[52:55]
    ds_read_b128 v[100:103], v1 offset:19456
    v_mfma_f32_16x16x32_bf16 v[28:31], v[132:135], v[168:171], v[28:31]
    ds_read_b128 v[104:107], v1 offset:20480
    v_mfma_f32_16x16x32_bf16 v[56:59], v[132:135], v[172:175], v[56:59]
    ds_read_b128 v[108:111], v248 offset:0
    s_waitcnt lgkmcnt(8)
    v_mfma_f32_16x16x32_bf16 v[32:35], v[168:171], v[136:139], v[32:35]
    ds_read_b128 v[112:115], v249 offset:0
    v_mfma_f32_16x16x32_bf16 v[60:63], v[172:175], v[136:139], v[60:63]
    ds_read_b128 v[116:119], v251 offset:0
    v_mfma_f32_16x16x32_bf16 v[36:39], v[168:171], v[140:143], v[36:39]
    buffer_load_dwordx4 v[160:163], v1, s[4:7], s39 offen offset:2048 sc1
    v_mfma_f32_16x16x32_bf16 v[64:67], v[172:175], v[140:143], v[64:67]
    buffer_load_dwordx4 v[164:167], v253, s[4:7], s39 offen offset:2048 sc1
    v_mfma_f32_16x16x32_bf16 v[40:43], v[144:147], v[168:171], v[40:43]
    v_mfma_f32_16x16x32_bf16 v[68:71], v[144:147], v[172:175], v[68:71]
    s_waitcnt vmcnt(6) lgkmcnt(6)
    v_mfma_f32_16x16x32_bf16 v[16:19], v[80:83], v[176:179], v[16:19]
    ds_read_b128 v[120:123], v1 offset:21504
    v_mfma_f32_16x16x32_bf16 v[44:47], v[80:83], v[180:183], v[44:47]
    ds_read_b128 v[124:127], v1 offset:22528
    v_add_f32 v240, v4, v6
    v_mfma_f32_16x16x32_bf16 v[20:23], v[84:87], v[176:179], v[20:23]
    ds_read_b128 v[128:131], v1 offset:23552
    v_add_f32 v241, v5, v7
    v_mfma_f32_16x16x32_bf16 v[48:51], v[84:87], v[180:183], v[48:51]
    ds_read_b128 v[132:135], v1 offset:24576
    v_add_f32 v242, v8, v10
    v_mfma_f32_16x16x32_bf16 v[24:27], v[88:91], v[176:179], v[24:27]
    ds_read_b128 v[136:139], v1 offset:25600
    v_add_f32 v243, v9, v11
    v_mfma_f32_16x16x32_bf16 v[52:55], v[88:91], v[180:183], v[52:55]
    ds_read_b128 v[140:143], v1 offset:26624
    v_add_f32 v244, v12, v14
    v_mfma_f32_16x16x32_bf16 v[28:31], v[92:95], v[176:179], v[28:31]
    ds_read_b128 v[144:147], v1 offset:27648
    v_add_f32 v245, v13, v15
    v_mfma_f32_16x16x32_bf16 v[56:59], v[92:95], v[180:183], v[56:59]
    ds_read_b128 v[148:151], v248 offset:1024
    s_waitcnt lgkmcnt(8)
    v_mfma_f32_16x16x32_bf16 v[32:35], v[176:179], v[96:99], v[32:35]
    ds_read_b128 v[152:155], v249 offset:7168
    v_mov_b32 v4, v240
    v_mfma_f32_16x16x32_bf16 v[60:63], v[180:183], v[96:99], v[60:63]
    ds_read_b128 v[156:159], v251 offset:7168
    v_mov_b32 v5, v241
    v_mfma_f32_16x16x32_bf16 v[36:39], v[176:179], v[100:103], v[36:39]
    buffer_load_dwordx4 v[168:171], v1, s[4:7], s39 offen offset:3072 sc1
    v_mfma_f32_16x16x32_bf16 v[64:67], v[180:183], v[100:103], v[64:67]
    buffer_load_dwordx4 v[172:175], v253, s[4:7], s39 offen offset:3072 sc1
    v_mfma_f32_16x16x32_bf16 v[40:43], v[104:107], v[176:179], v[40:43]
    v_mov_b32 v8, v242
    v_mfma_f32_16x16x32_bf16 v[68:71], v[104:107], v[180:183], v[68:71]
    v_mov_b32 v9, v243
    v_mfma_f32_16x16x32_bf16 v[72:75], v[112:115], v[108:111], 0
    v_mov_b32 v12, v244
    v_mov_b32 v13, v245
    v_mfma_f32_16x16x32_bf16 v[76:79], v[108:111], v[116:119], 0
    v_permlane32_swap_b32 v240, v4
    s_waitcnt vmcnt(8) lgkmcnt(6)
    s_barrier
    v_mfma_f32_16x16x32_bf16 v[16:19], v[120:123], v[184:187], v[16:19]
    ds_read_b128 v[80:83], v1 offset:28672
    v_mfma_f32_16x16x32_bf16 v[44:47], v[120:123], v[188:191], v[44:47]
    ds_read_b128 v[84:87], v1 offset:29696
    v_permlane32_swap_b32 v241, v5
    v_mfma_f32_16x16x32_bf16 v[20:23], v[124:127], v[184:187], v[20:23]
    ds_read_b128 v[88:91], v1 offset:30720
    v_permlane32_swap_b32 v242, v8
    v_mfma_f32_16x16x32_bf16 v[48:51], v[124:127], v[188:191], v[48:51]
    ds_read_b128 v[92:95], v1 offset:31744
    v_permlane32_swap_b32 v243, v9
    v_mfma_f32_16x16x32_bf16 v[24:27], v[128:131], v[184:187], v[24:27]
    ds_read_b128 v[96:99], v1 offset:32768
    v_permlane32_swap_b32 v244, v12
    v_mfma_f32_16x16x32_bf16 v[52:55], v[128:131], v[188:191], v[52:55]
    ds_read_b128 v[100:103], v1 offset:33792
    v_permlane32_swap_b32 v245, v13
    v_mfma_f32_16x16x32_bf16 v[28:31], v[132:135], v[184:187], v[28:31]
    ds_read_b128 v[104:107], v1 offset:34816
    v_add_f32 v240, v240, v4
    v_mfma_f32_16x16x32_bf16 v[56:59], v[132:135], v[188:191], v[56:59]
    ds_read_b128 v[108:111], v248 offset:2048
    s_waitcnt lgkmcnt(8)
    v_mfma_f32_16x16x32_bf16 v[32:35], v[184:187], v[136:139], v[32:35]
    ds_read_b128 v[112:115], v249 offset:14336
    v_add_f32 v241, v241, v5
    v_mfma_f32_16x16x32_bf16 v[60:63], v[188:191], v[136:139], v[60:63]
    ds_read_b128 v[116:119], v251 offset:14336
    v_add_f32 v242, v242, v8
    v_mfma_f32_16x16x32_bf16 v[36:39], v[184:187], v[140:143], v[36:39]
    buffer_load_dwordx4 v[176:179], v1, s[4:7], s40 offen offset:0 sc1
    v_mfma_f32_16x16x32_bf16 v[64:67], v[188:191], v[140:143], v[64:67]
    buffer_load_dwordx4 v[180:183], v253, s[4:7], s40 offen offset:0 sc1
    v_mfma_f32_16x16x32_bf16 v[40:43], v[144:147], v[184:187], v[40:43]
    v_add_f32 v243, v243, v9
    v_mfma_f32_16x16x32_bf16 v[68:71], v[144:147], v[188:191], v[68:71]
    v_add_f32 v244, v244, v12
    v_mfma_f32_16x16x32_bf16 v[72:75], v[152:155], v[148:151], v[72:75]
    v_add_f32 v245, v245, v13
    v_mov_b32 v4, v240
    v_mfma_f32_16x16x32_bf16 v[76:79], v[148:151], v[156:159], v[76:79]
    v_mov_b32 v5, v241
    s_waitcnt vmcnt(8) lgkmcnt(6)
    v_mfma_f32_16x16x32_bf16 v[16:19], v[80:83], v[192:195], v[16:19]
    ds_read_b128 v[120:123], v1 offset:35840
    v_mfma_f32_16x16x32_bf16 v[44:47], v[80:83], v[196:199], v[44:47]
    ds_read_b128 v[124:127], v1 offset:36864
    v_mov_b32 v8, v242
    v_mfma_f32_16x16x32_bf16 v[20:23], v[84:87], v[192:195], v[20:23]
    ds_read_b128 v[128:131], v1 offset:37888
    v_mov_b32 v9, v243
    v_mfma_f32_16x16x32_bf16 v[48:51], v[84:87], v[196:199], v[48:51]
    ds_read_b128 v[132:135], v1 offset:38912
    v_mov_b32 v12, v244
    v_mfma_f32_16x16x32_bf16 v[24:27], v[88:91], v[192:195], v[24:27]
    ds_read_b128 v[136:139], v1 offset:39936
    v_mov_b32 v13, v245
    v_mfma_f32_16x16x32_bf16 v[52:55], v[88:91], v[196:199], v[52:55]
    ds_read_b128 v[140:143], v1 offset:40960
    v_permlane16_swap_b32 v240, v4
    v_mfma_f32_16x16x32_bf16 v[28:31], v[92:95], v[192:195], v[28:31]
    ds_read_b128 v[144:147], v1 offset:41984
    v_permlane16_swap_b32 v241, v5
    v_mfma_f32_16x16x32_bf16 v[56:59], v[92:95], v[196:199], v[56:59]
    ds_read_b128 v[148:151], v248 offset:3072
    s_waitcnt lgkmcnt(8)
    v_mfma_f32_16x16x32_bf16 v[32:35], v[192:195], v[96:99], v[32:35]
    ds_read_b128 v[152:155], v249 offset:21504
    v_permlane16_swap_b32 v242, v8
    v_mfma_f32_16x16x32_bf16 v[60:63], v[196:199], v[96:99], v[60:63]
    ds_read_b128 v[156:159], v251 offset:21504
    v_permlane16_swap_b32 v243, v9
    v_mfma_f32_16x16x32_bf16 v[36:39], v[192:195], v[100:103], v[36:39]
    buffer_load_dwordx4 v[184:187], v1, s[4:7], s40 offen offset:1024 sc1
    v_mfma_f32_16x16x32_bf16 v[64:67], v[196:199], v[100:103], v[64:67]
    buffer_load_dwordx4 v[188:191], v253, s[4:7], s40 offen offset:1024 sc1
    v_mfma_f32_16x16x32_bf16 v[40:43], v[104:107], v[192:195], v[40:43]
    v_permlane16_swap_b32 v244, v12
    v_mfma_f32_16x16x32_bf16 v[68:71], v[104:107], v[196:199], v[68:71]
    v_permlane16_swap_b32 v245, v13
    v_mfma_f32_16x16x32_bf16 v[72:75], v[112:115], v[108:111], v[72:75]
    v_add_f32 v240, v240, v4
    v_add_f32 v241, v241, v5
    v_mfma_f32_16x16x32_bf16 v[76:79], v[108:111], v[116:119], v[76:79]
    v_add_f32 v242, v242, v8
    s_waitcnt vmcnt(8) lgkmcnt(6)
    s_barrier
    v_mfma_f32_16x16x32_bf16 v[16:19], v[120:123], v[200:203], v[16:19]
    ds_read_b128 v[80:83], v1 offset:43008
    v_mfma_f32_16x16x32_bf16 v[44:47], v[120:123], v[204:207], v[44:47]
    ds_read_b128 v[84:87], v1 offset:44032
    v_add_f32 v243, v243, v9
    v_mfma_f32_16x16x32_bf16 v[20:23], v[124:127], v[200:203], v[20:23]
    ds_read_b128 v[88:91], v1 offset:45056
    v_add_f32 v244, v244, v12
    v_mfma_f32_16x16x32_bf16 v[48:51], v[124:127], v[204:207], v[48:51]
    ds_read_b128 v[92:95], v1 offset:46080
    v_add_f32 v245, v245, v13
    v_mfma_f32_16x16x32_bf16 v[24:27], v[128:131], v[200:203], v[24:27]
    ds_read_b128 v[96:99], v1 offset:47104
    v_mul_f32 v240, 0x3ae38e39, v240
    v_mfma_f32_16x16x32_bf16 v[52:55], v[128:131], v[204:207], v[52:55]
    ds_read_b128 v[100:103], v1 offset:48128
    v_mul_f32 v241, 0x3ae38e39, v241
    v_mfma_f32_16x16x32_bf16 v[28:31], v[132:135], v[200:203], v[28:31]
    ds_read_b128 v[104:107], v1 offset:49152
    v_mul_f32 v242, 0x3ae38e39, v242
    v_mfma_f32_16x16x32_bf16 v[56:59], v[132:135], v[204:207], v[56:59]
    ds_read_b128 v[108:111], v248 offset:4096
    s_waitcnt lgkmcnt(8)
    v_mfma_f32_16x16x32_bf16 v[32:35], v[200:203], v[136:139], v[32:35]
    ds_read_b128 v[112:115], v249 offset:28672
    v_mul_f32 v243, 0x3ae38e39, v243
    v_mfma_f32_16x16x32_bf16 v[60:63], v[204:207], v[136:139], v[60:63]
    ds_read_b128 v[116:119], v251 offset:28672
    v_mul_f32 v244, 0x3ae38e39, v244
    v_mfma_f32_16x16x32_bf16 v[36:39], v[200:203], v[140:143], v[36:39]
    buffer_load_dwordx4 v[192:195], v1, s[4:7], s40 offen offset:2048 sc1
    v_mfma_f32_16x16x32_bf16 v[64:67], v[204:207], v[140:143], v[64:67]
    buffer_load_dwordx4 v[196:199], v253, s[4:7], s40 offen offset:2048 sc1
    v_mfma_f32_16x16x32_bf16 v[40:43], v[144:147], v[200:203], v[40:43]
    v_mul_f32 v245, 0x3ae38e39, v245
    v_mfma_f32_16x16x32_bf16 v[68:71], v[144:147], v[204:207], v[68:71]
    v_fma_f32 v241, -v240, v240, v241
    v_mfma_f32_16x16x32_bf16 v[72:75], v[152:155], v[148:151], v[72:75]
    v_fma_f32 v243, -v242, v242, v243
    v_fma_f32 v245, -v244, v244, v245
    v_mfma_f32_16x16x32_bf16 v[76:79], v[148:151], v[156:159], v[76:79]
    v_max_f32 v241, 0, v241
    s_waitcnt vmcnt(8) lgkmcnt(6)
    v_mfma_f32_16x16x32_bf16 v[16:19], v[80:83], v[160:163], v[16:19]
    ds_read_b128 v[120:123], v1 offset:50176
    v_mfma_f32_16x16x32_bf16 v[44:47], v[80:83], v[164:167], v[44:47]
    ds_read_b128 v[124:127], v1 offset:51200
    v_max_f32 v243, 0, v243
    v_mfma_f32_16x16x32_bf16 v[20:23], v[84:87], v[160:163], v[20:23]
    ds_read_b128 v[128:131], v1 offset:52224
    v_max_f32 v245, 0, v245
    v_mfma_f32_16x16x32_bf16 v[48:51], v[84:87], v[164:167], v[48:51]
    ds_read_b128 v[132:135], v1 offset:53248
    v_add_f32 v241, 0x3727c5ac, v241
    v_mfma_f32_16x16x32_bf16 v[24:27], v[88:91], v[160:163], v[24:27]
    ds_read_b128 v[136:139], v1 offset:54272
    v_add_f32 v243, 0x3727c5ac, v243
    v_mfma_f32_16x16x32_bf16 v[52:55], v[88:91], v[164:167], v[52:55]
    ds_read_b128 v[140:143], v1 offset:55296
    v_add_f32 v245, 0x3727c5ac, v245
    v_mfma_f32_16x16x32_bf16 v[28:31], v[92:95], v[160:163], v[28:31]
    ds_read_b128 v[144:147], v1 offset:56320
    v_rsq_f32 v241, v241
    v_mfma_f32_16x16x32_bf16 v[56:59], v[92:95], v[164:167], v[56:59]
    ds_read_b128 v[148:151], v248 offset:5120
    s_waitcnt lgkmcnt(8)
    v_mfma_f32_16x16x32_bf16 v[32:35], v[160:163], v[96:99], v[32:35]
    ds_read_b128 v[152:155], v249 offset:35840
    v_rsq_f32 v243, v243
    v_mfma_f32_16x16x32_bf16 v[60:63], v[164:167], v[96:99], v[60:63]
    ds_read_b128 v[156:159], v251 offset:35840
    v_rsq_f32 v245, v245
    v_mfma_f32_16x16x32_bf16 v[36:39], v[160:163], v[100:103], v[36:39]
    buffer_load_dwordx4 v[200:203], v1, s[4:7], s40 offen offset:3072 sc1
    v_mfma_f32_16x16x32_bf16 v[64:67], v[164:167], v[100:103], v[64:67]
    buffer_load_dwordx4 v[204:207], v253, s[4:7], s40 offen offset:3072 sc1
    v_mfma_f32_16x16x32_bf16 v[40:43], v[104:107], v[160:163], v[40:43]
    s_nop 0
    v_mfma_f32_16x16x32_bf16 v[68:71], v[104:107], v[164:167], v[68:71]
    v_lshlrev_b32 v255, 4, v3
    v_mfma_f32_16x16x32_bf16 v[72:75], v[112:115], v[108:111], v[72:75]
    v_add_u32 v236, 161792, v255
    s_lshl_b32 s36, s33, 6
    v_mfma_f32_16x16x32_bf16 v[76:79], v[108:111], v[116:119], v[76:79]
    v_add_u32 v237, s36, v236
    s_waitcnt vmcnt(8) lgkmcnt(6)
    v_mfma_f32_16x16x32_bf16 v[16:19], v[120:123], v[168:171], v[16:19]
    ds_read_b128 v[80:83], v1 offset:57344
    v_mfma_f32_16x16x32_bf16 v[44:47], v[120:123], v[172:175], v[44:47]
    ds_read_b128 v[84:87], v1 offset:58368
    v_lshlrev_b32 v254, 2, v2
    v_mfma_f32_16x16x32_bf16 v[20:23], v[124:127], v[168:171], v[20:23]
    ds_read_b128 v[88:91], v1 offset:59392
    v_add_u32 v238, 161792, v254
    v_mfma_f32_16x16x32_bf16 v[48:51], v[124:127], v[172:175], v[48:51]
    ds_read_b128 v[92:95], v1 offset:60416
    s_lshl_b32 s37, s34, 6
    v_mfma_f32_16x16x32_bf16 v[24:27], v[128:131], v[168:171], v[24:27]
    ds_read_b128 v[96:99], v1 offset:61440
    v_add_u32 v239, s37, v238
    v_mfma_f32_16x16x32_bf16 v[52:55], v[128:131], v[172:175], v[52:55]
    ds_read_b128 v[100:103], v1 offset:62464
    s_mul_i32 s36, s20, 3072
    v_mfma_f32_16x16x32_bf16 v[28:31], v[132:135], v[168:171], v[28:31]
    ds_read_b128 v[104:107], v1 offset:63488
    s_add_u32 s36, s36, 153600
    v_mfma_f32_16x16x32_bf16 v[56:59], v[132:135], v[172:175], v[56:59]
    ds_read_b128 v[108:111], v248 offset:6144
    s_waitcnt lgkmcnt(8)
    v_mfma_f32_16x16x32_bf16 v[32:35], v[168:171], v[136:139], v[32:35]
    ds_read_b128 v[112:115], v249 offset:43008
    v_add_u32 v254, s36, v254
    v_mfma_f32_16x16x32_bf16 v[60:63], v[172:175], v[136:139], v[60:63]
    ds_read_b128 v[116:119], v251 offset:43008
    v_add_u32 v255, s36, v255
    v_mfma_f32_16x16x32_bf16 v[36:39], v[168:171], v[140:143], v[36:39]
    buffer_load_dwordx4 v[160:163], v1, s[4:7], s41 offen offset:0 sc1
    v_mfma_f32_16x16x32_bf16 v[64:67], v[172:175], v[140:143], v[64:67]
    buffer_load_dwordx4 v[164:167], v253, s[4:7], s41 offen offset:0 sc1
    v_mfma_f32_16x16x32_bf16 v[40:43], v[144:147], v[168:171], v[40:43]
    v_mfma_f32_16x16x32_bf16 v[68:71], v[144:147], v[172:175], v[68:71]
    ds_write2_b32 v254, v240, v241 offset0:0 offset1:16
    v_mfma_f32_16x16x32_bf16 v[72:75], v[152:155], v[148:151], v[72:75]
    ds_write2_b32 v254, v242, v243 offset0:32 offset1:48
    v_mfma_f32_16x16x32_bf16 v[76:79], v[148:151], v[156:159], v[76:79]
    ds_write2_b32 v254, v244, v245 offset0:64 offset1:80
    s_waitcnt vmcnt(8) lgkmcnt(9)
    s_barrier
    v_mfma_f32_16x16x32_bf16 v[16:19], v[80:83], v[176:179], v[16:19]
    ds_read_b128 v[120:123], v247 offset:0
    v_mfma_f32_16x16x32_bf16 v[44:47], v[80:83], v[180:183], v[44:47]
    ds_read_b128 v[124:127], v247 offset:1024
    v_mfma_f32_16x16x32_bf16 v[20:23], v[84:87], v[176:179], v[20:23]
    ds_read_b128 v[128:131], v247 offset:2048
    v_mfma_f32_16x16x32_bf16 v[48:51], v[84:87], v[180:183], v[48:51]
    ds_read_b128 v[132:135], v247 offset:3072
    v_mfma_f32_16x16x32_bf16 v[24:27], v[88:91], v[176:179], v[24:27]
    ds_read_b128 v[136:139], v247 offset:4096
    v_mfma_f32_16x16x32_bf16 v[52:55], v[88:91], v[180:183], v[52:55]
    ds_read_b128 v[140:143], v247 offset:5120
    v_mfma_f32_16x16x32_bf16 v[28:31], v[92:95], v[176:179], v[28:31]
    ds_read_b128 v[144:147], v247 offset:6144
    v_mfma_f32_16x16x32_bf16 v[56:59], v[92:95], v[180:183], v[56:59]
    ds_read_b128 v[148:151], v248 offset:7168
    s_waitcnt lgkmcnt(8)
    v_mfma_f32_16x16x32_bf16 v[32:35], v[176:179], v[96:99], v[32:35]
    ds_read_b128 v[152:155], v249 offset:50176
    v_mfma_f32_16x16x32_bf16 v[60:63], v[180:183], v[96:99], v[60:63]
    ds_read_b128 v[156:159], v251 offset:50176
    v_mfma_f32_16x16x32_bf16 v[36:39], v[176:179], v[100:103], v[36:39]
    buffer_load_dwordx4 v[168:171], v1, s[4:7], s41 offen offset:1024 sc1
    ds_read_b128 v[208:211], v236 offset:0
    v_mfma_f32_16x16x32_bf16 v[64:67], v[180:183], v[100:103], v[64:67]
    buffer_load_dwordx4 v[172:175], v253, s[4:7], s41 offen offset:1024 sc1
    ds_read_b128 v[212:215], v236 offset:64
    v_mfma_f32_16x16x32_bf16 v[40:43], v[104:107], v[176:179], v[40:43]
    ds_read_b128 v[216:219], v236 offset:128
    v_mfma_f32_16x16x32_bf16 v[68:71], v[104:107], v[180:183], v[68:71]
    ds_read_b128 v[220:223], v236 offset:192
    v_mfma_f32_16x16x32_bf16 v[72:75], v[112:115], v[108:111], v[72:75]
    ds_read_b128 v[224:227], v236 offset:384
    v_mfma_f32_16x16x32_bf16 v[76:79], v[108:111], v[116:119], v[76:79]
    ds_read_b128 v[228:231], v237
    s_waitcnt vmcnt(8) lgkmcnt(12)
    v_mfma_f32_16x16x32_bf16 v[16:19], v[120:123], v[184:187], v[16:19]
    ds_read_b128 v[80:83], v247 offset:7168
    v_mfma_f32_16x16x32_bf16 v[44:47], v[120:123], v[188:191], v[44:47]
    ds_read_b128 v[84:87], v247 offset:8192
    v_mfma_f32_16x16x32_bf16 v[20:23], v[124:127], v[184:187], v[20:23]
    ds_read_b128 v[88:91], v247 offset:9216
    v_mfma_f32_16x16x32_bf16 v[48:51], v[124:127], v[188:191], v[48:51]
    ds_read_b128 v[92:95], v247 offset:10240
    v_mfma_f32_16x16x32_bf16 v[24:27], v[128:131], v[184:187], v[24:27]
    ds_read_b128 v[96:99], v247 offset:11264
    v_mfma_f32_16x16x32_bf16 v[52:55], v[128:131], v[188:191], v[52:55]
    ds_read_b128 v[100:103], v247 offset:12288
    v_mfma_f32_16x16x32_bf16 v[28:31], v[132:135], v[184:187], v[28:31]
    ds_read_b128 v[104:107], v247 offset:13312
    v_mfma_f32_16x16x32_bf16 v[56:59], v[132:135], v[188:191], v[56:59]
    ds_read_b128 v[108:111], v248 offset:8192
    s_waitcnt lgkmcnt(8)
    v_mfma_f32_16x16x32_bf16 v[32:35], v[184:187], v[136:139], v[32:35]
    ds_read_b128 v[112:115], v249 offset:57344
    v_mfma_f32_16x16x32_bf16 v[60:63], v[188:191], v[136:139], v[60:63]
    ds_read_b128 v[116:119], v251 offset:57344
    v_mfma_f32_16x16x32_bf16 v[36:39], v[184:187], v[140:143], v[36:39]
    buffer_load_dwordx4 v[176:179], v1, s[4:7], s41 offen offset:2048 sc1
    v_mfma_f32_16x16x32_bf16 v[64:67], v[188:191], v[140:143], v[64:67]
    buffer_load_dwordx4 v[180:183], v253, s[4:7], s41 offen offset:2048 sc1
    ds_read2_b32 v[232:233], v238 offset0:64 offset1:80
    v_mfma_f32_16x16x32_bf16 v[40:43], v[144:147], v[184:187], v[40:43]
    ds_read_b32 v234, v239
    v_mfma_f32_16x16x32_bf16 v[68:71], v[144:147], v[188:191], v[68:71]
    ds_read_b128 v[4:7], v255 offset:0
    v_mfma_f32_16x16x32_bf16 v[72:75], v[152:155], v[148:151], v[72:75]
    ds_read_b128 v[8:11], v255 offset:128
    v_mfma_f32_16x16x32_bf16 v[76:79], v[148:151], v[156:159], v[76:79]
    ds_read_b128 v[12:15], v255 offset:256
    s_waitcnt vmcnt(8) lgkmcnt(11)
    s_barrier
    v_mfma_f32_16x16x32_bf16 v[16:19], v[80:83], v[192:195], v[16:19]
    ds_read_b128 v[120:123], v247 offset:14336
    v_mfma_f32_16x16x32_bf16 v[44:47], v[80:83], v[196:199], v[44:47]
    ds_read_b128 v[124:127], v247 offset:15360
    v_mfma_f32_16x16x32_bf16 v[20:23], v[84:87], v[192:195], v[20:23]
    ds_read_b128 v[128:131], v247 offset:16384
    v_mfma_f32_16x16x32_bf16 v[48:51], v[84:87], v[196:199], v[48:51]
    ds_read_b128 v[132:135], v247 offset:17408
    v_mfma_f32_16x16x32_bf16 v[24:27], v[88:91], v[192:195], v[24:27]
    ds_read_b128 v[136:139], v247 offset:18432
    v_mfma_f32_16x16x32_bf16 v[52:55], v[88:91], v[196:199], v[52:55]
    ds_read_b128 v[140:143], v247 offset:19456
    v_mfma_f32_16x16x32_bf16 v[28:31], v[92:95], v[192:195], v[28:31]
    ds_read_b128 v[144:147], v247 offset:20480
    v_mfma_f32_16x16x32_bf16 v[56:59], v[92:95], v[196:199], v[56:59]
    ds_read_b128 v[148:151], v248 offset:9216
    s_waitcnt lgkmcnt(8)
    v_mfma_f32_16x16x32_bf16 v[32:35], v[192:195], v[96:99], v[32:35]
    ds_read_b128 v[152:155], v250 offset:0
    v_mfma_f32_16x16x32_bf16 v[60:63], v[196:199], v[96:99], v[60:63]
    ds_read_b128 v[156:159], v252 offset:0
    v_mfma_f32_16x16x32_bf16 v[36:39], v[192:195], v[100:103], v[36:39]
    buffer_load_dwordx4 v[184:187], v1, s[4:7], s41 offen offset:3072 sc1
    v_mfma_f32_16x16x32_bf16 v[64:67], v[196:199], v[100:103], v[64:67]
    buffer_load_dwordx4 v[188:191], v253, s[4:7], s41 offen offset:3072 sc1
    v_mfma_f32_16x16x32_bf16 v[40:43], v[104:107], v[192:195], v[40:43]
    v_mfma_f32_16x16x32_bf16 v[68:71], v[104:107], v[196:199], v[68:71]
    v_mfma_f32_16x16x32_bf16 v[72:75], v[112:115], v[108:111], v[72:75]
    v_mfma_f32_16x16x32_bf16 v[76:79], v[108:111], v[116:119], v[76:79]
    s_waitcnt vmcnt(8) lgkmcnt(6)
    v_mfma_f32_16x16x32_bf16 v[16:19], v[120:123], v[200:203], v[16:19]
    ds_read_b128 v[80:83], v247 offset:21504
    v_fma_f32 v32, -v8, v232, v32
    v_mfma_f32_16x16x32_bf16 v[44:47], v[120:123], v[204:207], v[44:47]
    ds_read_b128 v[84:87], v247 offset:22528
    v_fma_f32 v60, -v12, v232, v60
    v_mfma_f32_16x16x32_bf16 v[20:23], v[124:127], v[200:203], v[20:23]
    ds_read_b128 v[88:91], v247 offset:23552
    v_fma_f32 v36, -v8, v233, v36
    v_mfma_f32_16x16x32_bf16 v[48:51], v[124:127], v[204:207], v[48:51]
    ds_read_b128 v[92:95], v247 offset:24576
    v_fma_f32 v64, -v12, v233, v64
    v_mfma_f32_16x16x32_bf16 v[24:27], v[128:131], v[200:203], v[24:27]
    ds_read_b128 v[96:99], v247 offset:25600
    v_fma_f32 v40, -v242, v224, v40
    v_mfma_f32_16x16x32_bf16 v[52:55], v[128:131], v[204:207], v[52:55]
    ds_read_b128 v[100:103], v247 offset:26624
    v_fma_f32 v68, -v244, v224, v68
    v_mfma_f32_16x16x32_bf16 v[28:31], v[132:135], v[200:203], v[28:31]
    ds_read_b128 v[104:107], v247 offset:27648
    v_fma_f32 v72, -v240, v228, v72
    v_mfma_f32_16x16x32_bf16 v[56:59], v[132:135], v[204:207], v[56:59]
    ds_read_b128 v[108:111], v248 offset:10240
    s_waitcnt lgkmcnt(8)
    v_fma_f32 v76, -v4, v234, v76
    v_mfma_f32_16x16x32_bf16 v[32:35], v[200:203], v[136:139], v[32:35]
    ds_read_b128 v[112:115], v250 offset:7168
    v_fma_f32 v16, -v242, v208, v16
    v_mfma_f32_16x16x32_bf16 v[60:63], v[204:207], v[136:139], v[60:63]
    ds_read_b128 v[116:119], v252 offset:7168
    v_fma_f32 v44, -v244, v208, v44
    v_mfma_f32_16x16x32_bf16 v[36:39], v[200:203], v[140:143], v[36:39]
    buffer_load_dwordx4 v[192:195], v1, s[4:7], s42 offen offset:0 sc1
    v_fma_f32 v20, -v242, v212, v20
    v_mfma_f32_16x16x32_bf16 v[64:67], v[204:207], v[140:143], v[64:67]
    buffer_load_dwordx4 v[196:199], v253, s[4:7], s42 offen offset:0 sc1
    v_fma_f32 v48, -v244, v212, v48
    v_mfma_f32_16x16x32_bf16 v[40:43], v[144:147], v[200:203], v[40:43]
    v_fma_f32 v24, -v242, v216, v24
    v_mfma_f32_16x16x32_bf16 v[68:71], v[144:147], v[204:207], v[68:71]
    v_fma_f32 v52, -v244, v216, v52
    v_mfma_f32_16x16x32_bf16 v[72:75], v[152:155], v[148:151], v[72:75]
    v_fma_f32 v28, -v242, v220, v28
    v_mfma_f32_16x16x32_bf16 v[76:79], v[148:151], v[156:159], v[76:79]
    v_fma_f32 v56, -v244, v220, v56
    s_waitcnt vmcnt(8) lgkmcnt(6)
    s_barrier
    v_mfma_f32_16x16x32_bf16 v[16:19], v[80:83], v[160:163], v[16:19]
    ds_read_b128 v[120:123], v247 offset:28672
    v_fma_f32 v33, -v9, v232, v33
    v_mfma_f32_16x16x32_bf16 v[44:47], v[80:83], v[164:167], v[44:47]
    ds_read_b128 v[124:127], v247 offset:29696
    v_fma_f32 v61, -v13, v232, v61
    v_mfma_f32_16x16x32_bf16 v[20:23], v[84:87], v[160:163], v[20:23]
    ds_read_b128 v[128:131], v247 offset:30720
    v_fma_f32 v37, -v9, v233, v37
    v_mfma_f32_16x16x32_bf16 v[48:51], v[84:87], v[164:167], v[48:51]
    ds_read_b128 v[132:135], v247 offset:31744
    v_fma_f32 v65, -v13, v233, v65
    v_mfma_f32_16x16x32_bf16 v[24:27], v[88:91], v[160:163], v[24:27]
    ds_read_b128 v[136:139], v247 offset:32768
    v_fma_f32 v41, -v242, v225, v41
    v_mfma_f32_16x16x32_bf16 v[52:55], v[88:91], v[164:167], v[52:55]
    ds_read_b128 v[140:143], v247 offset:33792
    v_fma_f32 v69, -v244, v225, v69
    v_mfma_f32_16x16x32_bf16 v[28:31], v[92:95], v[160:163], v[28:31]
    ds_read_b128 v[144:147], v247 offset:34816
    v_fma_f32 v73, -v240, v229, v73
    v_mfma_f32_16x16x32_bf16 v[56:59], v[92:95], v[164:167], v[56:59]
    ds_read_b128 v[148:151], v248 offset:11264
    s_waitcnt lgkmcnt(8)
    v_fma_f32 v77, -v5, v234, v77
    v_mfma_f32_16x16x32_bf16 v[32:35], v[160:163], v[96:99], v[32:35]
    ds_read_b128 v[152:155], v250 offset:14336
    v_fma_f32 v17, -v242, v209, v17
    v_mfma_f32_16x16x32_bf16 v[60:63], v[164:167], v[96:99], v[60:63]
    ds_read_b128 v[156:159], v252 offset:14336
    v_fma_f32 v45, -v244, v209, v45
    v_mfma_f32_16x16x32_bf16 v[36:39], v[160:163], v[100:103], v[36:39]
    buffer_load_dwordx4 v[200:203], v1, s[4:7], s42 offen offset:1024 sc1
    v_fma_f32 v21, -v242, v213, v21
    v_mfma_f32_16x16x32_bf16 v[64:67], v[164:167], v[100:103], v[64:67]
    buffer_load_dwordx4 v[204:207], v253, s[4:7], s42 offen offset:1024 sc1
    v_fma_f32 v49, -v244, v213, v49
    v_mfma_f32_16x16x32_bf16 v[40:43], v[104:107], v[160:163], v[40:43]
    v_fma_f32 v25, -v242, v217, v25
    v_mfma_f32_16x16x32_bf16 v[68:71], v[104:107], v[164:167], v[68:71]
    v_fma_f32 v53, -v244, v217, v53
    v_mfma_f32_16x16x32_bf16 v[72:75], v[112:115], v[108:111], v[72:75]
    v_fma_f32 v29, -v242, v221, v29
    v_mfma_f32_16x16x32_bf16 v[76:79], v[108:111], v[116:119], v[76:79]
    v_fma_f32 v57, -v244, v221, v57
    s_waitcnt vmcnt(8) lgkmcnt(6)
    v_mfma_f32_16x16x32_bf16 v[16:19], v[120:123], v[168:171], v[16:19]
    ds_read_b128 v[80:83], v247 offset:35840
    v_fma_f32 v34, -v10, v232, v34
    v_mfma_f32_16x16x32_bf16 v[44:47], v[120:123], v[172:175], v[44:47]
    ds_read_b128 v[84:87], v247 offset:36864
    v_fma_f32 v62, -v14, v232, v62
    v_mfma_f32_16x16x32_bf16 v[20:23], v[124:127], v[168:171], v[20:23]
    ds_read_b128 v[88:91], v247 offset:37888
    v_fma_f32 v38, -v10, v233, v38
    v_mfma_f32_16x16x32_bf16 v[48:51], v[124:127], v[172:175], v[48:51]
    ds_read_b128 v[92:95], v247 offset:38912
    v_fma_f32 v66, -v14, v233, v66
    v_mfma_f32_16x16x32_bf16 v[24:27], v[128:131], v[168:171], v[24:27]
    ds_read_b128 v[96:99], v247 offset:39936
    v_fma_f32 v42, -v242, v226, v42
    v_mfma_f32_16x16x32_bf16 v[52:55], v[128:131], v[172:175], v[52:55]
    ds_read_b128 v[100:103], v247 offset:40960
    v_fma_f32 v70, -v244, v226, v70
    v_mfma_f32_16x16x32_bf16 v[28:31], v[132:135], v[168:171], v[28:31]
    ds_read_b128 v[104:107], v247 offset:41984
    v_fma_f32 v74, -v240, v230, v74
    v_mfma_f32_16x16x32_bf16 v[56:59], v[132:135], v[172:175], v[56:59]
    ds_read_b128 v[108:111], v248 offset:12288
    s_waitcnt lgkmcnt(8)
    v_fma_f32 v78, -v6, v234, v78
    v_mfma_f32_16x16x32_bf16 v[32:35], v[168:171], v[136:139], v[32:35]
    ds_read_b128 v[112:115], v250 offset:21504
    v_fma_f32 v18, -v242, v210, v18
    v_mfma_f32_16x16x32_bf16 v[60:63], v[172:175], v[136:139], v[60:63]
    ds_read_b128 v[116:119], v252 offset:21504
    v_fma_f32 v46, -v244, v210, v46
    v_mfma_f32_16x16x32_bf16 v[36:39], v[168:171], v[140:143], v[36:39]
    v_fma_f32 v22, -v242, v214, v22
    v_mfma_f32_16x16x32_bf16 v[64:67], v[172:175], v[140:143], v[64:67]
    v_fma_f32 v50, -v244, v214, v50
    v_mfma_f32_16x16x32_bf16 v[40:43], v[144:147], v[168:171], v[40:43]
    v_fma_f32 v26, -v242, v218, v26
    v_mfma_f32_16x16x32_bf16 v[68:71], v[144:147], v[172:175], v[68:71]
    v_fma_f32 v54, -v244, v218, v54
    v_mfma_f32_16x16x32_bf16 v[72:75], v[152:155], v[148:151], v[72:75]
    v_fma_f32 v30, -v242, v222, v30
    v_mfma_f32_16x16x32_bf16 v[76:79], v[148:151], v[156:159], v[76:79]
    v_fma_f32 v58, -v244, v222, v58
    s_waitcnt vmcnt(6) lgkmcnt(6)
    v_mfma_f32_16x16x32_bf16 v[16:19], v[80:83], v[176:179], v[16:19]
    ds_read_b128 v[120:123], v247 offset:43008
    v_fma_f32 v35, -v11, v232, v35
    v_mfma_f32_16x16x32_bf16 v[44:47], v[80:83], v[180:183], v[44:47]
    ds_read_b128 v[124:127], v247 offset:44032
    v_fma_f32 v63, -v15, v232, v63
    v_mfma_f32_16x16x32_bf16 v[20:23], v[84:87], v[176:179], v[20:23]
    ds_read_b128 v[128:131], v247 offset:45056
    v_fma_f32 v39, -v11, v233, v39
    v_mfma_f32_16x16x32_bf16 v[48:51], v[84:87], v[180:183], v[48:51]
    ds_read_b128 v[132:135], v247 offset:46080
    v_fma_f32 v67, -v15, v233, v67
    v_mfma_f32_16x16x32_bf16 v[24:27], v[88:91], v[176:179], v[24:27]
    ds_read_b128 v[136:139], v247 offset:47104
    v_fma_f32 v43, -v242, v227, v43
    v_mfma_f32_16x16x32_bf16 v[52:55], v[88:91], v[180:183], v[52:55]
    ds_read_b128 v[140:143], v247 offset:48128
    v_fma_f32 v71, -v244, v227, v71
    v_mfma_f32_16x16x32_bf16 v[28:31], v[92:95], v[176:179], v[28:31]
    ds_read_b128 v[144:147], v247 offset:49152
    v_fma_f32 v75, -v240, v231, v75
    v_mfma_f32_16x16x32_bf16 v[56:59], v[92:95], v[180:183], v[56:59]
    ds_read_b128 v[148:151], v248 offset:13312
    s_waitcnt lgkmcnt(8)
    v_fma_f32 v79, -v7, v234, v79
    v_mfma_f32_16x16x32_bf16 v[32:35], v[176:179], v[96:99], v[32:35]
    ds_read_b128 v[152:155], v250 offset:28672
    v_fma_f32 v19, -v242, v211, v19
    v_mfma_f32_16x16x32_bf16 v[60:63], v[180:183], v[96:99], v[60:63]
    ds_read_b128 v[156:159], v252 offset:28672
    v_fma_f32 v47, -v244, v211, v47
    v_mfma_f32_16x16x32_bf16 v[36:39], v[176:179], v[100:103], v[36:39]
    v_fma_f32 v23, -v242, v215, v23
    v_mfma_f32_16x16x32_bf16 v[64:67], v[180:183], v[100:103], v[64:67]
    v_fma_f32 v51, -v244, v215, v51
    v_mfma_f32_16x16x32_bf16 v[40:43], v[104:107], v[176:179], v[40:43]
    v_fma_f32 v27, -v242, v219, v27
    v_mfma_f32_16x16x32_bf16 v[68:71], v[104:107], v[180:183], v[68:71]
    v_fma_f32 v55, -v244, v219, v55
    v_mfma_f32_16x16x32_bf16 v[72:75], v[112:115], v[108:111], v[72:75]
    v_fma_f32 v31, -v242, v223, v31
    v_mfma_f32_16x16x32_bf16 v[76:79], v[108:111], v[116:119], v[76:79]
    v_fma_f32 v59, -v244, v223, v59
    s_waitcnt vmcnt(4) lgkmcnt(6)
    s_barrier
    v_mfma_f32_16x16x32_bf16 v[16:19], v[120:123], v[184:187], v[16:19]
    ds_read_b128 v[80:83], v247 offset:50176
    v_mfma_f32_16x16x32_bf16 v[44:47], v[120:123], v[188:191], v[44:47]
    ds_read_b128 v[84:87], v247 offset:51200
    v_and_b32 v4, 1, v2
    v_mfma_f32_16x16x32_bf16 v[20:23], v[124:127], v[184:187], v[20:23]
    ds_read_b128 v[88:91], v247 offset:52224
    v_lshl_add_u32 v5, v3, 2, v4
    v_mfma_f32_16x16x32_bf16 v[48:51], v[124:127], v[188:191], v[48:51]
    ds_read_b128 v[92:95], v247 offset:53248
    v_add_u32 v6, 2, v5
    v_mfma_f32_16x16x32_bf16 v[24:27], v[128:131], v[184:187], v[24:27]
    ds_read_b128 v[96:99], v247 offset:54272
    v_cmp_eq_u32 s[40:41], 1, v4
    v_mfma_f32_16x16x32_bf16 v[52:55], v[128:131], v[188:191], v[52:55]
    ds_read_b128 v[100:103], v247 offset:55296
    v_cmp_le_u32 s[42:43], v5, v2
    v_mfma_f32_16x16x32_bf16 v[28:31], v[132:135], v[184:187], v[28:31]
    ds_read_b128 v[104:107], v247 offset:56320
    v_cmp_le_u32 s[44:45], v6, v2
    v_mfma_f32_16x16x32_bf16 v[56:59], v[132:135], v[188:191], v[56:59]
    ds_read_b128 v[108:111], v248 offset:14336
    s_waitcnt lgkmcnt(8)
    v_mfma_f32_16x16x32_bf16 v[32:35], v[184:187], v[136:139], v[32:35]
    ds_read_b128 v[112:115], v250 offset:35840
    v_mov_b32 v4, 0x0c0c0100
    v_mfma_f32_16x16x32_bf16 v[60:63], v[188:191], v[136:139], v[60:63]
    ds_read_b128 v[116:119], v252 offset:35840
    v_mov_b32 v5, 0x01000c0c
    v_mfma_f32_16x16x32_bf16 v[36:39], v[184:187], v[140:143], v[36:39]
    v_mov_b32 v6, 0x0c0c0302
    v_mov_b32 v7, 0x03020c0c
    v_mfma_f32_16x16x32_bf16 v[64:67], v[188:191], v[140:143], v[64:67]
    v_mov_b32 v8, 0x0c0c0c0c
    v_cndmask_b32 v4, v4, v5, s[40:41]
    v_mfma_f32_16x16x32_bf16 v[40:43], v[144:147], v[184:187], v[40:43]
    v_cndmask_b32 v6, v6, v7, s[40:41]
    v_cndmask_b32 v12, v4, v8, s[42:43]
    v_mfma_f32_16x16x32_bf16 v[68:71], v[144:147], v[188:191], v[68:71]
    v_cndmask_b32 v13, v6, v8, s[44:45]
    v_cndmask_b32 v14, v8, v4, s[42:43]
    v_mfma_f32_16x16x32_bf16 v[72:75], v[152:155], v[148:151], v[72:75]
    v_cndmask_b32 v15, v8, v6, s[44:45]
    s_cmp_eq_u32 s31, 0
    v_mfma_f32_16x16x32_bf16 v[76:79], v[148:151], v[156:159], v[76:79]
    s_cselect_b64 s[48:49], s[42:43], -1
    s_cselect_b64 s[38:39], s[44:45], -1
    s_waitcnt vmcnt(2) lgkmcnt(6)
    v_mfma_f32_16x16x32_bf16 v[16:19], v[80:83], v[192:195], v[16:19]
    ds_read_b128 v[120:123], v247 offset:57344
    v_mfma_f32_16x16x32_bf16 v[44:47], v[80:83], v[196:199], v[44:47]
    ds_read_b128 v[124:127], v247 offset:58368
    s_mul_i32 s36, s20, 3072
    v_mfma_f32_16x16x32_bf16 v[20:23], v[84:87], v[192:195], v[20:23]
    ds_read_b128 v[128:131], v247 offset:59392
    s_add_u32 s36, s36, 149504
    v_mfma_f32_16x16x32_bf16 v[48:51], v[84:87], v[196:199], v[48:51]
    ds_read_b128 v[132:135], v247 offset:60416
    v_add_u32 v9, s36, v0
    v_mfma_f32_16x16x32_bf16 v[24:27], v[88:91], v[192:195], v[24:27]
    ds_read_b128 v[136:139], v247 offset:61440
    s_lshl_b32 s37, s20, 9
    v_mfma_f32_16x16x32_bf16 v[52:55], v[88:91], v[196:199], v[52:55]
    ds_read_b128 v[140:143], v247 offset:62464
    s_add_u32 s37, s37, 149504
    v_mfma_f32_16x16x32_bf16 v[28:31], v[92:95], v[192:195], v[28:31]
    ds_read_b128 v[144:147], v247 offset:63488
    v_add_u32 v10, s37, v0
    v_mfma_f32_16x16x32_bf16 v[56:59], v[92:95], v[196:199], v[56:59]
    ds_read_b128 v[148:151], v248 offset:15360
    s_waitcnt lgkmcnt(8)
    v_mfma_f32_16x16x32_bf16 v[32:35], v[192:195], v[96:99], v[32:35]
    ds_read_b128 v[152:155], v250 offset:43008
    v_lshlrev_b32 v4, 2, v3
    v_mfma_f32_16x16x32_bf16 v[60:63], v[196:199], v[96:99], v[60:63]
    ds_read_b128 v[156:159], v252 offset:43008
    v_sub_u32 v4, v2, v4
    v_mfma_f32_16x16x32_bf16 v[36:39], v[192:195], v[100:103], v[36:39]
    v_lshlrev_b32 v5, 4, v4
    v_lshrrev_b32 v4, 1, v4
    v_mfma_f32_16x16x32_bf16 v[64:67], v[196:199], v[100:103], v[64:67]
    v_mov_b32 v6, 0x3f80
    v_lshlrev_b32 v5, v5, v6
    v_mfma_f32_16x16x32_bf16 v[40:43], v[104:107], v[192:195], v[40:43]
    v_cmp_eq_u32 vcc, 0, v4
    v_cmp_eq_u32 s[46:47], 1, v4
    v_mfma_f32_16x16x32_bf16 v[68:71], v[104:107], v[196:199], v[68:71]
    ds_read_b128 v[208:211], v255 offset:64
    s_lshl_b32 s36, s24, 10
    v_add_u32 v4, s36, v1
    v_mfma_f32_16x16x32_bf16 v[72:75], v[112:115], v[108:111], v[72:75]
    ds_read_b128 v[212:215], v255 offset:192
    v_cndmask_b32 v234, 0, v5, vcc
    v_cndmask_b32 v235, 0, v5, s[46:47]
    v_mfma_f32_16x16x32_bf16 v[76:79], v[108:111], v[116:119], v[76:79]
    ds_read_b128 v[216:219], v255 offset:320
    v_add_u32 v5, 18432, v4
    s_lshl_b32 s36, s24, 7
    s_waitcnt vmcnt(0) lgkmcnt(9)
    v_mfma_f32_16x16x32_bf16 v[16:19], v[120:123], v[200:203], v[16:19]
    ds_read_b128 v[80:83], v248 offset:16384
    v_mfma_f32_16x16x32_bf16 v[44:47], v[120:123], v[204:207], v[44:47]
    ds_read_b128 v[84:87], v250 offset:50176
    s_add_u32 s36, s36, 16384
    v_mfma_f32_16x16x32_bf16 v[20:23], v[124:127], v[200:203], v[20:23]
    ds_read_b128 v[88:91], v252 offset:50176
    v_cmp_eq_u32 vcc, 2, v3
    v_mfma_f32_16x16x32_bf16 v[48:51], v[124:127], v[204:207], v[48:51]
    ds_read_b128 v[92:95], v248 offset:17408
    v_lshl_add_u32 v6, v2, 3, s36
    v_mfma_f32_16x16x32_bf16 v[24:27], v[128:131], v[200:203], v[24:27]
    ds_read_b128 v[96:99], v250 offset:57344
    v_bfrev_b32 v7, 1
    v_mfma_f32_16x16x32_bf16 v[52:55], v[128:131], v[204:207], v[52:55]
    ds_read_b128 v[100:103], v252 offset:57344
    v_cndmask_b32 v6, v7, v6, vcc
    v_mfma_f32_16x16x32_bf16 v[28:31], v[132:135], v[200:203], v[28:31]
    v_add_u32 v7, 18432, v6
    v_mov_b32 v106, 0
    v_mfma_f32_16x16x32_bf16 v[56:59], v[132:135], v[204:207], v[56:59]
    s_waitcnt lgkmcnt(6)
    v_mov_b32 v107, 0
    v_mfma_f32_16x16x32_bf16 v[32:35], v[200:203], v[136:139], v[32:35]
    v_mov_b32 v8, 0xf149f2ca
    v_mov_b32 v108, 0
    v_mfma_f32_16x16x32_bf16 v[60:63], v[204:207], v[136:139], v[60:63]
    s_mov_b32 s33, 0x3eae1a93
    v_mov_b32 v109, 0
    v_mfma_f32_16x16x32_bf16 v[36:39], v[200:203], v[140:143], v[36:39]
    v_mov_b32 v236, 0x3f803f80
    v_mov_b32 v237, 0x3f803f80
    v_mfma_f32_16x16x32_bf16 v[64:67], v[204:207], v[140:143], v[64:67]
    v_mov_b32 v238, 0x3f803f80
    v_mov_b32 v239, 0x3f803f80
    v_mfma_f32_16x16x32_bf16 v[40:43], v[144:147], v[200:203], v[40:43]
    v_mov_b32 v114, 0
    v_mfma_f32_16x16x32_bf16 v[68:71], v[144:147], v[204:207], v[68:71]
    v_mov_b32 v115, 0
    v_mfma_f32_16x16x32_bf16 v[72:75], v[152:155], v[148:151], v[72:75]
    v_mov_b32 v116, 0
    v_mfma_f32_16x16x32_bf16 v[76:79], v[148:151], v[156:159], v[76:79]
    v_mov_b32 v117, 0
    s_waitcnt lgkmcnt(0)
    v_mfma_f32_16x16x32_bf16 v[72:75], v[84:87], v[80:83], v[72:75]
    v_mfma_f32_16x16x32_bf16 v[76:79], v[80:83], v[88:91], v[76:79]
    v_mfma_f32_16x16x32_bf16 v[72:75], v[96:99], v[92:95], v[72:75]
    v_mfma_f32_16x16x32_bf16 v[76:79], v[92:95], v[100:103], v[76:79]
    v_pk_mul_f32 v[52:53], v[52:53], v[244:245] op_sel:[0,1] op_sel_hi:[1,1]
    v_pk_mul_f32 v[54:55], v[54:55], v[244:245] op_sel:[0,1] op_sel_hi:[1,1]
    v_pk_mul_f32 v[56:57], v[56:57], v[244:245] op_sel:[0,1] op_sel_hi:[1,1]
    v_pk_mul_f32 v[58:59], v[58:59], v[244:245] op_sel:[0,1] op_sel_hi:[1,1]
    v_pk_mul_f32 v[60:61], v[60:61], v[216:217]
    v_pk_mul_f32 v[62:63], v[62:63], v[218:219]
    v_pk_mul_f32 v[64:65], v[64:65], v[216:217]
    v_pk_mul_f32 v[66:67], v[66:67], v[218:219]
    v_pk_mul_f32 v[68:69], v[68:69], v[244:245] op_sel:[0,1] op_sel_hi:[1,1]
    v_pk_mul_f32 v[70:71], v[70:71], v[244:245] op_sel:[0,1] op_sel_hi:[1,1]
    v_pk_mul_f32 v[72:73], v[72:73], v[240:241] op_sel:[0,1] op_sel_hi:[1,1]
    v_pk_mul_f32 v[74:75], v[74:75], v[240:241] op_sel:[0,1] op_sel_hi:[1,1]
    v_pk_mul_f32 v[76:77], v[76:77], v[208:209]
    v_pk_mul_f32 v[78:79], v[78:79], v[210:211]
    v_cvt_pk_bf16_f32 v172, v52, v53
    v_cvt_pk_bf16_f32 v173, v54, v55
    v_cvt_pk_bf16_f32 v176, v56, v57
    v_cvt_pk_bf16_f32 v177, v58, v59
    v_cvt_pk_bf16_f32 v182, v60, v61
    v_cvt_pk_bf16_f32 v183, v62, v63
    v_cvt_pk_bf16_f32 v188, v64, v65
    v_cvt_pk_bf16_f32 v189, v66, v67
    v_cvt_pk_bf16_f32 v174, v68, v69
    v_cvt_pk_bf16_f32 v175, v70, v71
    v_cvt_pk_bf16_f32 v220, v72, v73
    v_cvt_pk_bf16_f32 v221, v74, v75
    v_cvt_pk_bf16_f32 v222, v76, v77
    v_cvt_pk_bf16_f32 v223, v78, v79
    s_cmp_eq_u32 s20, 3
    s_cbranch_scc1 L_a_nw
    ds_write2st64_b64 v9, v[172:173], v[174:175] offset0:6 offset1:7
    ds_write2st64_b64 v9, v[176:177], v[182:183] offset0:8 offset1:9
    ds_write_b64 v9, v[188:189] offset:5120
    ds_write2st64_b64 v10, v[220:221], v[222:223] offset0:0 offset1:3
L_a_nw:
    v_pk_mul_f32 v[24:25], v[24:25], v[242:243] op_sel:[0,1] op_sel_hi:[1,1]
    v_pk_mul_f32 v[26:27], v[26:27], v[242:243] op_sel:[0,1] op_sel_hi:[1,1]
    v_pk_mul_f32 v[28:29], v[28:29], v[242:243] op_sel:[0,1] op_sel_hi:[1,1]
    v_pk_mul_f32 v[30:31], v[30:31], v[242:243] op_sel:[0,1] op_sel_hi:[1,1]
    v_pk_mul_f32 v[32:33], v[32:33], v[212:213]
    v_pk_mul_f32 v[34:35], v[34:35], v[214:215]
    v_pk_mul_f32 v[36:37], v[36:37], v[212:213]
    v_pk_mul_f32 v[38:39], v[38:39], v[214:215]
    v_pk_mul_f32 v[40:41], v[40:41], v[242:243] op_sel:[0,1] op_sel_hi:[1,1]
    v_pk_mul_f32 v[42:43], v[42:43], v[242:243] op_sel:[0,1] op_sel_hi:[1,1]
    v_cvt_pk_bf16_f32 v166, v24, v25
    v_cvt_pk_bf16_f32 v167, v26, v27
    v_cvt_pk_bf16_f32 v170, v28, v29
    v_cvt_pk_bf16_f32 v171, v30, v31
    v_cvt_pk_bf16_f32 v180, v32, v33
    v_cvt_pk_bf16_f32 v181, v34, v35
    v_cvt_pk_bf16_f32 v186, v36, v37
    v_cvt_pk_bf16_f32 v187, v38, v39
    v_cvt_pk_bf16_f32 v168, v40, v41
    v_cvt_pk_bf16_f32 v169, v42, v43
    s_waitcnt lgkmcnt(0)
    s_barrier
    ds_read2st64_b64 v[160:163], v9 offset0:0 offset1:1
    ds_read_b64 v[164:165], v9 offset:1024
    ds_read_b64 v[178:179], v9 offset:1536
    ds_read_b64 v[184:185], v9 offset:2048
    v_mfma_f32_16x16x16_bf16 v[128:131], v[174:175], v[234:235], 0
    v_mfma_f32_16x16x16_bf16 v[124:127], v[168:169], v[234:235], 0
    v_pk_mul_f32 v[44:45], v[44:45], v[244:245] op_sel:[0,1] op_sel_hi:[1,1]
    v_pk_mul_f32 v[46:47], v[46:47], v[244:245] op_sel:[0,1] op_sel_hi:[1,1]
    v_pk_mul_f32 v[48:49], v[48:49], v[244:245] op_sel:[0,1] op_sel_hi:[1,1]
    v_pk_mul_f32 v[50:51], v[50:51], v[244:245] op_sel:[0,1] op_sel_hi:[1,1]
    v_pk_mul_f32 v[16:17], v[16:17], v[242:243] op_sel:[0,1] op_sel_hi:[1,1]
    v_pk_mul_f32 v[18:19], v[18:19], v[242:243] op_sel:[0,1] op_sel_hi:[1,1]
    v_pk_mul_f32 v[20:21], v[20:21], v[242:243] op_sel:[0,1] op_sel_hi:[1,1]
    v_pk_mul_f32 v[22:23], v[22:23], v[242:243] op_sel:[0,1] op_sel_hi:[1,1]
    v_cvt_pk_bf16_f32 v112, v44, v45
    v_cvt_pk_bf16_f32 v113, v46, v47
    v_cvt_pk_bf16_f32 v118, v48, v49
    v_cvt_pk_bf16_f32 v119, v50, v51
    v_cvt_pk_bf16_f32 v104, v16, v17
    v_cvt_pk_bf16_f32 v105, v18, v19
    v_cvt_pk_bf16_f32 v110, v20, v21
    v_cvt_pk_bf16_f32 v111, v22, v23
    v_permlane16_swap_b32 v114, v174
    v_permlane16_swap_b32 v117, v175
    v_permlane16_swap_b32 v106, v168
    v_permlane16_swap_b32 v109, v169
    s_waitcnt lgkmcnt(0)
    v_mfma_f32_16x16x16_bf16 v[120:123], v[162:163], v[234:235], 0
    v_mfma_f32_16x16x32_bf16 v[20:23], v[172:175], v[112:115], 0
    v_mfma_f32_16x16x32_bf16 v[16:19], v[166:169], v[112:115], 0
    v_mfma_f32_16x16x32_bf16 v[28:31], v[174:177], v[116:119], 0
    v_mfma_f32_16x16x32_bf16 v[24:27], v[168:171], v[116:119], 0
    v_mfma_f32_16x16x32_bf16 v[36:39], v[166:169], v[104:107], 0
    v_mfma_f32_16x16x32_bf16 v[32:35], v[160:163], v[104:107], 0
    v_mfma_f32_16x16x32_bf16 v[44:47], v[168:171], v[108:111], 0
    v_mfma_f32_16x16x32_bf16 v[40:43], v[162:165], v[108:111], 0
    v_cvt_pk_bf16_f32 v194, v128, v129
    v_cvt_pk_bf16_f32 v195, v130, v131
    v_cvt_pk_bf16_f32 v192, v124, v125
    v_cvt_pk_bf16_f32 v193, v126, v127
    v_cvt_pk_bf16_f32 v190, v120, v121
    v_cvt_pk_bf16_f32 v191, v122, v123
    v_cndmask_b32 v20, v20, v21, s[40:41]
    v_cndmask_b32 v16, v16, v17, s[40:41]
    v_cndmask_b32 v48, v16, v20, s[42:43]
    v_cndmask_b32 v22, v22, v23, s[40:41]
    v_cndmask_b32 v18, v18, v19, s[40:41]
    v_cndmask_b32 v49, v18, v22, s[44:45]
    v_max_f32 v56, v48, v49
    v_cndmask_b32 v28, v28, v29, s[40:41]
    v_cndmask_b32 v24, v24, v25, s[40:41]
    v_cndmask_b32 v50, v24, v28, s[42:43]
    v_cndmask_b32 v30, v30, v31, s[40:41]
    v_cndmask_b32 v26, v26, v27, s[40:41]
    v_cndmask_b32 v51, v26, v30, s[44:45]
    v_max_f32 v57, v50, v51
    v_cndmask_b32 v36, v36, v37, s[40:41]
    v_cndmask_b32 v32, v32, v33, s[40:41]
    v_cndmask_b32 v52, v32, v36, s[42:43]
    v_cndmask_b32 v52, v8, v52, s[48:49]
    v_cndmask_b32 v38, v38, v39, s[40:41]
    v_cndmask_b32 v34, v34, v35, s[40:41]
    v_cndmask_b32 v53, v34, v38, s[44:45]
    v_cndmask_b32 v53, v8, v53, s[38:39]
    v_max_f32 v58, v52, v53
    v_permlane32_swap_b32 v56, v57
    v_max_f32 v56, v56, v57
    v_cndmask_b32 v44, v44, v45, s[40:41]
    v_cndmask_b32 v40, v40, v41, s[40:41]
    v_cndmask_b32 v54, v40, v44, s[42:43]
    v_cndmask_b32 v54, v8, v54, s[48:49]
    v_cndmask_b32 v46, v46, v47, s[40:41]
    v_cndmask_b32 v42, v42, v43, s[40:41]
    v_cndmask_b32 v55, v42, v46, s[44:45]
    v_cndmask_b32 v55, v8, v55, s[38:39]
    v_max_f32 v59, v54, v55
    s_nop 1
    v_permlane32_swap_b32 v58, v59
    v_max_f32 v58, v58, v59
    s_nop 1
    v_permlane16_swap_b32 v56, v58
    v_max_f32 v57, v56, v58
    v_mul_f32 v56, s33, v57
    v_mul_f32 v58, s33, v57
    s_nop 1
    v_permlane16_swap_b32 v56, v58
    v_mov_b32 v57, v56
    v_mov_b32 v59, v58
    s_nop 0
    v_permlane32_swap_b32 v56, v57
    v_permlane32_swap_b32 v58, v59
    v_fma_f32 v48, v48, s33, -v56
    v_fma_f32 v49, v49, s33, -v56
    v_fma_f32 v50, v50, s33, -v57
    v_fma_f32 v51, v51, s33, -v57
    v_fma_f32 v52, v52, s33, -v58
    v_fma_f32 v53, v53, s33, -v58
    v_fma_f32 v54, v54, s33, -v59
    v_fma_f32 v55, v55, s33, -v59
    v_exp_f32 v48, v48
    v_exp_f32 v49, v49
    v_exp_f32 v50, v50
    v_exp_f32 v51, v51
    v_exp_f32 v52, v52
    v_exp_f32 v53, v53
    v_exp_f32 v54, v54
    v_exp_f32 v55, v55
    v_cvt_pk_bf16_f32 v56, v48, v49
    v_cvt_pk_bf16_f32 v57, v50, v51
    v_cvt_pk_bf16_f32 v58, v52, v53
    v_cvt_pk_bf16_f32 v59, v54, v55
    v_perm_b32 v64, v56, v56, v12
    v_perm_b32 v65, v56, v56, v13
    v_perm_b32 v66, v56, v56, v14
    v_perm_b32 v67, v56, v56, v15
    v_perm_b32 v68, v57, v57, v12
    v_perm_b32 v69, v57, v57, v13
    v_perm_b32 v70, v57, v57, v14
    v_perm_b32 v71, v57, v57, v15
    v_perm_b32 v72, v58, v58, v12
    v_perm_b32 v73, v58, v58, v13
    v_perm_b32 v74, v58, v58, v14
    v_perm_b32 v75, v58, v58, v15
    v_perm_b32 v76, v59, v59, v12
    v_perm_b32 v77, v59, v59, v13
    v_perm_b32 v78, v59, v59, v14
    v_perm_b32 v79, v59, v59, v15
    v_mfma_f32_16x16x32_bf16 v[80:83], v[236:239], v[64:67], 0
    v_mfma_f32_16x16x32_bf16 v[84:87], v[236:239], v[68:71], 0
    v_mfma_f32_16x16x32_bf16 v[88:91], v[236:239], v[72:75], 0
    v_mfma_f32_16x16x32_bf16 v[92:95], v[236:239], v[76:79], 0
    v_mfma_f32_16x16x32_bf16 v[16:19], v[180:183], v[64:67], 0
    v_mfma_f32_16x16x32_bf16 v[20:23], v[192:195], v[64:67], 0
    v_mfma_f32_16x16x32_bf16 v[24:27], v[186:189], v[68:71], 0
    v_mfma_f32_16x16x32_bf16 v[28:31], v[192:195], v[68:71], 0
    v_mfma_f32_16x16x32_bf16 v[32:35], v[178:181], v[72:75], 0
    v_mfma_f32_16x16x32_bf16 v[36:39], v[190:193], v[72:75], 0
    v_mfma_f32_16x16x32_bf16 v[40:43], v[184:187], v[76:79], 0
    v_mfma_f32_16x16x32_bf16 v[44:47], v[190:193], v[76:79], 0
    v_rcp_f32 v80, v80
    v_rcp_f32 v84, v84
    v_rcp_f32 v88, v88
    v_rcp_f32 v92, v92
    v_pk_mul_f32 v[16:17], v[16:17], v[80:81] op_sel_hi:[1,0]
    v_pk_mul_f32 v[18:19], v[18:19], v[80:81] op_sel_hi:[1,0]
    v_pk_mul_f32 v[20:21], v[20:21], v[80:81] op_sel_hi:[1,0]
    v_pk_mul_f32 v[24:25], v[24:25], v[84:85] op_sel_hi:[1,0]
    v_pk_mul_f32 v[26:27], v[26:27], v[84:85] op_sel_hi:[1,0]
    v_pk_mul_f32 v[30:31], v[30:31], v[84:85] op_sel_hi:[1,0]
    v_cvt_pk_bf16_f32 v220, v16, v17
    v_cvt_pk_bf16_f32 v221, v18, v19
    v_cvt_pk_bf16_f32 v224, v20, v21
    v_cvt_pk_bf16_f32 v222, v24, v25
    v_cvt_pk_bf16_f32 v223, v26, v27
    v_cvt_pk_bf16_f32 v225, v30, v31
    buffer_store_dwordx4 v[220:223], v5, s[4:7], s35 offen sc1
    buffer_store_dwordx2 v[224:225], v7, s[4:7], s35 offen sc1
    v_pk_mul_f32 v[32:33], v[32:33], v[88:89] op_sel_hi:[1,0]
    v_pk_mul_f32 v[34:35], v[34:35], v[88:89] op_sel_hi:[1,0]
    v_pk_mul_f32 v[36:37], v[36:37], v[88:89] op_sel_hi:[1,0]
    v_pk_mul_f32 v[40:41], v[40:41], v[92:93] op_sel_hi:[1,0]
    v_pk_mul_f32 v[42:43], v[42:43], v[92:93] op_sel_hi:[1,0]
    v_pk_mul_f32 v[46:47], v[46:47], v[92:93] op_sel_hi:[1,0]
    v_cvt_pk_bf16_f32 v228, v32, v33
    v_cvt_pk_bf16_f32 v229, v34, v35
    v_cvt_pk_bf16_f32 v232, v36, v37
    v_cvt_pk_bf16_f32 v230, v40, v41
    v_cvt_pk_bf16_f32 v231, v42, v43
    v_cvt_pk_bf16_f32 v233, v46, v47
    buffer_store_dwordx4 v[228:231], v4, s[4:7], s35 offen sc1
    buffer_store_dwordx2 v[232:233], v6, s[4:7], s35 offen sc1
    s_and_b32 s25, s2, 7
    s_lshr_b32 s26, s2, 3
    s_lshr_b32 s23, s25, 1
    s_lshl_b32 s23, s23, 3
    s_lshr_b32 s27, s26, 2
    s_add_u32 s23, s23, s27
    s_and_b32 s24, s25, 1
    s_lshl_b32 s24, s24, 2
    s_and_b32 s27, s26, 3
    s_add_u32 s24, s24, s27
    s_add_u32 s25, s23, s24
    s_and_b32 s25, s25, 3
    s_lshl_b32 s30, s23, 2
    s_add_u32 s30, s30, s20
    s_mul_i32 s29, s30, 18432
    s_add_u32 s29, s29, s21
    s_add_u32 s29, s29, 0x600000
    s_mul_i32 s34, s30, 18432
    s_add_u32 s34, s34, s21
    s_add_u32 s34, s34, 0x0
    s_lshl_b32 s35, s24, 11
    s_lshr_b32 s36, s24, 2
    s_lshl_b32 s36, s36, 10
    s_and_b32 s37, s24, 3
    s_lshl_b32 s37, s37, 8
    s_add_u32 s36, s36, s37
    s_add_u32 s36, s36, 16384
    v_bfe_u32 v2, v1, 4, 4
    v_lshrrev_b32 v3, 8, v1
    v_add_u32 v4, s35, v1
    v_lshlrev_b32 v5, 4, v2
    v_lshl_add_u32 v5, v3, 3, v5
    v_add_u32 v5, s36, v5
    v_cmp_gt_u32 s[40:41], 2, v3
    v_bfrev_b32 v6, 1
    v_add_u32 v12, 0, v1
    v_add_u32 v13, 36864, v1
    v_add_u32 v14, 73728, v1
    v_add_u32 v15, 110592, v1
    v_cndmask_b32 v5, v6, v5, s[40:41]
    buffer_load_dwordx4 v[208:211], v4, s[4:7], s34 offen offset:0 sc1
    buffer_load_dwordx4 v[212:215], v4, s[4:7], s34 offen offset:1024 sc1
    buffer_load_dwordx2 v[216:217], v5, s[4:7], s34 offen sc1
    s_add_u32 s34, s34, 0x300000
    s_lshl_b32 s39, s30, 10
    s_add_u32 s39, s39, s21
    s_lshl_b32 s42, s24, 7
    s_add_u32 s39, s39, s42
    s_add_u32 s39, s39, 0x1b20000
    v_cmp_eq_u32 vcc, 0, v3
    v_lshlrev_b32 v10, 3, v2
    v_mov_b32 v11, 0x3f803f80
    v_lshl_add_u32 v7, v3, 8, v10
    v_cndmask_b32 v10, v6, v10, vcc
    s_lshr_b32 s44, s23, 1
    s_lshl_b32 s52, s22, 7
    s_add_u32 s52, s52, s44
    s_lshl_b32 s52, s52, 8
    s_add_u32 s52, s52, 0x4508000
    s_add_u32 s52, s52, s4
    s_addc_u32 s53, s5, 0
    s_waitcnt vmcnt(3)
    s_barrier
    s_cmp_lg_u32 s20, 0
    s_cbranch_scc1 L_ns_d2
    s_mov_b32 s56, 1
    s_atomic_add s56, s[50:51], 0
L_ns_d2:
    s_cmp_lg_u32 s20, 0
    s_cbranch_scc1 L_pd_d2
    s_mov_b32 s60, 65536
L_poll_d2:
    s_mov_b32 s57, 0
    s_atomic_add s57, s[52:53], 0 glc
    s_waitcnt lgkmcnt(0)
    s_cmp_ge_u32 s57, 16
    s_cbranch_scc1 L_pd_d2
    s_sub_u32 s60, s60, 1
    s_cbranch_scc1 L_pd_d2
    s_sleep 2
    s_branch L_poll_d2
L_pd_d2:
    s_barrier
    s_mov_b32 s32, 0
    s_lshl_b32 s32, s32, 13
    s_add_u32 s32, s32, s29
    s_add_u32 s33, s32, 4096
    buffer_load_dwordx4 v[112:115], v1, s[4:7], s32 offen offset:0 sc1
    buffer_load_dwordx4 v[116:119], v1, s[4:7], s32 offen offset:1024 sc1
    buffer_load_dwordx4 v[120:123], v1, s[4:7], s32 offen offset:2048 sc1
    buffer_load_dwordx4 v[124:127], v1, s[4:7], s32 offen offset:3072 sc1
    buffer_load_dwordx4 v[128:131], v1, s[4:7], s33 offen offset:0 sc1
    buffer_load_dwordx4 v[132:135], v1, s[4:7], s33 offen offset:1024 sc1
    buffer_load_dwordx4 v[136:139], v1, s[4:7], s33 offen offset:2048 sc1
    buffer_load_dwordx4 v[140:143], v1, s[4:7], s33 offen offset:3072 sc1
    ds_read_b128 v[40:43], v12 offset:18432
    ds_read_b128 v[44:47], v12 offset:19456
    ds_read_b128 v[48:51], v12 offset:20480
    ds_read_b128 v[52:55], v12 offset:21504
    ds_read_b128 v[72:75], v12 offset:26624
    ds_read_b128 v[56:59], v12 offset:22528
    ds_read_b128 v[60:63], v12 offset:23552
    ds_read_b128 v[64:67], v12 offset:24576
    ds_read_b128 v[68:71], v12 offset:25600
    s_add_u32 s45, s29, 8192
    s_add_u32 s46, s29, 12288
    s_add_u32 s47, s29, 16384
    buffer_load_dwordx4 v[144:147], v1, s[4:7], s45 offen offset:0 sc1
    buffer_load_dwordx4 v[148:151], v1, s[4:7], s45 offen offset:1024 sc1
    s_lshl_b32 s42, s23, 3
    s_add_u32 s42, s42, s24
    s_lshl_b32 s42, s42, 2
    s_add_u32 s42, s42, s20
    s_lshl_b32 s42, s42, 8
    s_add_u32 s42, s42, s21
    s_add_u32 s42, s42, 0x1b40000
    v_mov_b32 v220, -1.0
    v_lshrrev_b32 v221, 2, v1
    buffer_store_dword v220, v221, s[4:7], s42 offen sc1
    s_lshl_b32 s50, s22, 7
    s_add_u32 s50, s50, s44
    s_lshl_b32 s50, s50, 8
    s_add_u32 s50, s50, 0x4509000
    s_add_u32 s50, s50, s4
    s_addc_u32 s51, s5, 0
    s_waitcnt vmcnt(11)
    v_lshlrev_b32 v16, 16, v208
    v_and_b32 v17, 0xffff0000, v208
    v_lshlrev_b32 v18, 16, v209
    v_and_b32 v19, 0xffff0000, v209
    v_lshlrev_b32 v20, 16, v210
    v_and_b32 v21, 0xffff0000, v210
    v_lshlrev_b32 v22, 16, v211
    v_and_b32 v23, 0xffff0000, v211
    v_lshlrev_b32 v24, 16, v212
    v_and_b32 v25, 0xffff0000, v212
    v_lshlrev_b32 v26, 16, v213
    v_and_b32 v27, 0xffff0000, v213
    v_lshlrev_b32 v28, 16, v214
    v_and_b32 v29, 0xffff0000, v214
    v_lshlrev_b32 v30, 16, v215
    v_and_b32 v31, 0xffff0000, v215
    v_lshlrev_b32 v32, 16, v216
    v_and_b32 v33, 0xffff0000, v216
    v_lshlrev_b32 v34, 16, v217
    v_and_b32 v35, 0xffff0000, v217
    s_waitcnt vmcnt(9) lgkmcnt(4)
    v_mfma_f32_16x16x32_bf16 v[16:19], v[40:43], v[112:115], v[16:19]
    ds_read_b128 v[76:79], v12 offset:27648
    v_mfma_f32_16x16x32_bf16 v[20:23], v[44:47], v[112:115], v[20:23]
    ds_read_b128 v[80:83], v12 offset:28672
    buffer_load_dwordx4 v[152:155], v1, s[4:7], s45 offen offset:2048 sc1
    v_mfma_f32_16x16x32_bf16 v[24:27], v[48:51], v[112:115], v[24:27]
    ds_read_b128 v[84:87], v12 offset:29696
    v_mfma_f32_16x16x32_bf16 v[28:31], v[52:55], v[112:115], v[28:31]
    ds_read_b128 v[88:91], v12 offset:30720
    v_mfma_f32_16x16x32_bf16 v[32:35], v[72:75], v[112:115], v[32:35]
    ds_read_b128 v[108:111], v12 offset:35840
    s_waitcnt lgkmcnt(5)
    buffer_load_dwordx4 v[156:159], v1, s[4:7], s45 offen offset:3072 sc1
    v_mfma_f32_16x16x32_bf16 v[16:19], v[56:59], v[116:119], v[16:19]
    ds_read_b128 v[92:95], v12 offset:31744
    v_mfma_f32_16x16x32_bf16 v[20:23], v[60:63], v[116:119], v[20:23]
    ds_read_b128 v[96:99], v12 offset:32768
    v_mfma_f32_16x16x32_bf16 v[24:27], v[64:67], v[116:119], v[24:27]
    ds_read_b128 v[100:103], v12 offset:33792
    buffer_load_dwordx4 v[160:163], v1, s[4:7], s46 offen offset:0 sc1
    v_mfma_f32_16x16x32_bf16 v[28:31], v[68:71], v[116:119], v[28:31]
    ds_read_b128 v[104:107], v12 offset:34816
    v_mfma_f32_16x16x32_bf16 v[36:39], v[72:75], v[116:119], 0
    s_waitcnt vmcnt(10) lgkmcnt(4)
    v_mfma_f32_16x16x32_bf16 v[16:19], v[76:79], v[120:123], v[16:19]
    ds_read_b128 v[40:43], v13 offset:18432
    v_mfma_f32_16x16x32_bf16 v[20:23], v[80:83], v[120:123], v[20:23]
    ds_read_b128 v[44:47], v13 offset:19456
    buffer_load_dwordx4 v[164:167], v1, s[4:7], s46 offen offset:1024 sc1
    v_mfma_f32_16x16x32_bf16 v[24:27], v[84:87], v[120:123], v[24:27]
    ds_read_b128 v[48:51], v13 offset:20480
    v_mfma_f32_16x16x32_bf16 v[28:31], v[88:91], v[120:123], v[28:31]
    ds_read_b128 v[52:55], v13 offset:21504
    v_mfma_f32_16x16x32_bf16 v[32:35], v[108:111], v[120:123], v[32:35]
    ds_read_b128 v[72:75], v13 offset:26624
    s_waitcnt lgkmcnt(5)
    buffer_load_dwordx4 v[168:171], v1, s[4:7], s46 offen offset:2048 sc1
    v_mfma_f32_16x16x32_bf16 v[16:19], v[92:95], v[124:127], v[16:19]
    ds_read_b128 v[56:59], v13 offset:22528
    v_mfma_f32_16x16x32_bf16 v[20:23], v[96:99], v[124:127], v[20:23]
    ds_read_b128 v[60:63], v13 offset:23552
    v_mfma_f32_16x16x32_bf16 v[24:27], v[100:103], v[124:127], v[24:27]
    ds_read_b128 v[64:67], v13 offset:24576
    buffer_load_dwordx4 v[172:175], v1, s[4:7], s46 offen offset:3072 sc1
    v_mfma_f32_16x16x32_bf16 v[28:31], v[104:107], v[124:127], v[28:31]
    ds_read_b128 v[68:71], v13 offset:25600
    v_mfma_f32_16x16x32_bf16 v[36:39], v[108:111], v[124:127], v[36:39]
    s_waitcnt vmcnt(11) lgkmcnt(4)
    v_mfma_f32_16x16x32_bf16 v[16:19], v[40:43], v[128:131], v[16:19]
    ds_read_b128 v[76:79], v13 offset:27648
    v_mfma_f32_16x16x32_bf16 v[20:23], v[44:47], v[128:131], v[20:23]
    ds_read_b128 v[80:83], v13 offset:28672
    buffer_load_dwordx2 v[176:177], v7, s[4:7], s47 offen offset:0 sc1
    v_mfma_f32_16x16x32_bf16 v[24:27], v[48:51], v[128:131], v[24:27]
    ds_read_b128 v[84:87], v13 offset:29696
    v_mfma_f32_16x16x32_bf16 v[28:31], v[52:55], v[128:131], v[28:31]
    ds_read_b128 v[88:91], v13 offset:30720
    v_mfma_f32_16x16x32_bf16 v[32:35], v[72:75], v[128:131], v[32:35]
    ds_read_b128 v[108:111], v13 offset:35840
    s_waitcnt lgkmcnt(5)
    buffer_load_dwordx2 v[178:179], v7, s[4:7], s47 offen offset:128 sc1
    v_mfma_f32_16x16x32_bf16 v[16:19], v[56:59], v[132:135], v[16:19]
    ds_read_b128 v[92:95], v13 offset:31744
    v_mfma_f32_16x16x32_bf16 v[20:23], v[60:63], v[132:135], v[20:23]
    ds_read_b128 v[96:99], v13 offset:32768
    v_mfma_f32_16x16x32_bf16 v[24:27], v[64:67], v[132:135], v[24:27]
    ds_read_b128 v[100:103], v13 offset:33792
    buffer_load_dwordx2 v[180:181], v7, s[4:7], s47 offen offset:1024 sc1
    v_mfma_f32_16x16x32_bf16 v[28:31], v[68:71], v[132:135], v[28:31]
    ds_read_b128 v[104:107], v13 offset:34816
    v_mfma_f32_16x16x32_bf16 v[36:39], v[72:75], v[132:135], v[36:39]
    s_waitcnt vmcnt(12) lgkmcnt(4)
    v_mfma_f32_16x16x32_bf16 v[16:19], v[76:79], v[136:139], v[16:19]
    ds_read_b128 v[40:43], v14 offset:18432
    v_mfma_f32_16x16x32_bf16 v[20:23], v[80:83], v[136:139], v[20:23]
    ds_read_b128 v[44:47], v14 offset:19456
    buffer_load_dwordx2 v[182:183], v7, s[4:7], s47 offen offset:1152 sc1
    v_mfma_f32_16x16x32_bf16 v[24:27], v[84:87], v[136:139], v[24:27]
    ds_read_b128 v[48:51], v14 offset:20480
    v_mfma_f32_16x16x32_bf16 v[28:31], v[88:91], v[136:139], v[28:31]
    ds_read_b128 v[52:55], v14 offset:21504
    v_mfma_f32_16x16x32_bf16 v[32:35], v[108:111], v[136:139], v[32:35]
    ds_read_b128 v[72:75], v14 offset:26624
    s_waitcnt lgkmcnt(5)
    v_mfma_f32_16x16x32_bf16 v[16:19], v[92:95], v[140:143], v[16:19]
    ds_read_b128 v[56:59], v14 offset:22528
    v_mfma_f32_16x16x32_bf16 v[20:23], v[96:99], v[140:143], v[20:23]
    ds_read_b128 v[60:63], v14 offset:23552
    v_mfma_f32_16x16x32_bf16 v[24:27], v[100:103], v[140:143], v[24:27]
    ds_read_b128 v[64:67], v14 offset:24576
    v_mfma_f32_16x16x32_bf16 v[28:31], v[104:107], v[140:143], v[28:31]
    ds_read_b128 v[68:71], v14 offset:25600
    v_mfma_f32_16x16x32_bf16 v[36:39], v[108:111], v[140:143], v[36:39]
    s_waitcnt vmcnt(11) lgkmcnt(4)
    v_mfma_f32_16x16x32_bf16 v[16:19], v[40:43], v[144:147], v[16:19]
    ds_read_b128 v[76:79], v14 offset:27648
    v_mfma_f32_16x16x32_bf16 v[20:23], v[44:47], v[144:147], v[20:23]
    ds_read_b128 v[80:83], v14 offset:28672
    v_mfma_f32_16x16x32_bf16 v[24:27], v[48:51], v[144:147], v[24:27]
    ds_read_b128 v[84:87], v14 offset:29696
    v_mfma_f32_16x16x32_bf16 v[28:31], v[52:55], v[144:147], v[28:31]
    ds_read_b128 v[88:91], v14 offset:30720
    v_mfma_f32_16x16x32_bf16 v[32:35], v[72:75], v[144:147], v[32:35]
    ds_read_b128 v[108:111], v14 offset:35840
    s_waitcnt lgkmcnt(5)
    v_mfma_f32_16x16x32_bf16 v[16:19], v[56:59], v[148:151], v[16:19]
    ds_read_b128 v[92:95], v14 offset:31744
    v_mfma_f32_16x16x32_bf16 v[20:23], v[60:63], v[148:151], v[20:23]
    ds_read_b128 v[96:99], v14 offset:32768
    v_mfma_f32_16x16x32_bf16 v[24:27], v[64:67], v[148:151], v[24:27]
    ds_read_b128 v[100:103], v14 offset:33792
    v_mfma_f32_16x16x32_bf16 v[28:31], v[68:71], v[148:151], v[28:31]
    ds_read_b128 v[104:107], v14 offset:34816
    v_mfma_f32_16x16x32_bf16 v[36:39], v[72:75], v[148:151], v[36:39]
    s_waitcnt vmcnt(8) lgkmcnt(4)
    v_mfma_f32_16x16x32_bf16 v[16:19], v[76:79], v[152:155], v[16:19]
    ds_read_b128 v[40:43], v15 offset:18432
    v_mfma_f32_16x16x32_bf16 v[20:23], v[80:83], v[152:155], v[20:23]
    ds_read_b128 v[44:47], v15 offset:19456
    v_mfma_f32_16x16x32_bf16 v[24:27], v[84:87], v[152:155], v[24:27]
    ds_read_b128 v[48:51], v15 offset:20480
    v_mfma_f32_16x16x32_bf16 v[28:31], v[88:91], v[152:155], v[28:31]
    ds_read_b128 v[52:55], v15 offset:21504
    v_mfma_f32_16x16x32_bf16 v[32:35], v[108:111], v[152:155], v[32:35]
    ds_read_b128 v[72:75], v15 offset:26624
    s_waitcnt lgkmcnt(5)
    v_mfma_f32_16x16x32_bf16 v[16:19], v[92:95], v[156:159], v[16:19]
    ds_read_b128 v[56:59], v15 offset:22528
    v_mfma_f32_16x16x32_bf16 v[20:23], v[96:99], v[156:159], v[20:23]
    ds_read_b128 v[60:63], v15 offset:23552
    v_mfma_f32_16x16x32_bf16 v[24:27], v[100:103], v[156:159], v[24:27]
    ds_read_b128 v[64:67], v15 offset:24576
    v_mfma_f32_16x16x32_bf16 v[28:31], v[104:107], v[156:159], v[28:31]
    ds_read_b128 v[68:71], v15 offset:25600
    v_mfma_f32_16x16x32_bf16 v[36:39], v[108:111], v[156:159], v[36:39]
    s_waitcnt vmcnt(6) lgkmcnt(4)
    v_mfma_f32_16x16x32_bf16 v[16:19], v[40:43], v[160:163], v[16:19]
    ds_read_b128 v[76:79], v15 offset:27648
    v_mfma_f32_16x16x32_bf16 v[20:23], v[44:47], v[160:163], v[20:23]
    ds_read_b128 v[80:83], v15 offset:28672
    v_mfma_f32_16x16x32_bf16 v[24:27], v[48:51], v[160:163], v[24:27]
    ds_read_b128 v[84:87], v15 offset:29696
    v_mfma_f32_16x16x32_bf16 v[28:31], v[52:55], v[160:163], v[28:31]
    ds_read_b128 v[88:91], v15 offset:30720
    v_mfma_f32_16x16x32_bf16 v[32:35], v[72:75], v[160:163], v[32:35]
    ds_read_b128 v[108:111], v15 offset:35840
    s_waitcnt lgkmcnt(5)
    v_mfma_f32_16x16x32_bf16 v[16:19], v[56:59], v[164:167], v[16:19]
    ds_read_b128 v[92:95], v15 offset:31744
    v_mfma_f32_16x16x32_bf16 v[20:23], v[60:63], v[164:167], v[20:23]
    ds_read_b128 v[96:99], v15 offset:32768
    v_mfma_f32_16x16x32_bf16 v[24:27], v[64:67], v[164:167], v[24:27]
    ds_read_b128 v[100:103], v15 offset:33792
    v_mfma_f32_16x16x32_bf16 v[28:31], v[68:71], v[164:167], v[28:31]
    ds_read_b128 v[104:107], v15 offset:34816
    v_mfma_f32_16x16x32_bf16 v[36:39], v[72:75], v[164:167], v[36:39]
    s_waitcnt vmcnt(4) lgkmcnt(4)
    v_mfma_f32_16x16x32_bf16 v[16:19], v[76:79], v[168:171], v[16:19]
    ds_read_b128 v[40:43], v15 offset:36864
    v_mfma_f32_16x16x32_bf16 v[20:23], v[80:83], v[168:171], v[20:23]
    ds_read_b128 v[44:47], v15 offset:37888
    v_mfma_f32_16x16x32_bf16 v[24:27], v[84:87], v[168:171], v[24:27]
    ds_read_b128 v[48:51], v15 offset:38912
    v_mfma_f32_16x16x32_bf16 v[28:31], v[88:91], v[168:171], v[28:31]
    ds_read_b128 v[52:55], v15 offset:39936
    v_mfma_f32_16x16x32_bf16 v[32:35], v[108:111], v[168:171], v[32:35]
    ds_read_b128 v[72:75], v15 offset:45056
    s_waitcnt lgkmcnt(5)
    v_mfma_f32_16x16x32_bf16 v[16:19], v[92:95], v[172:175], v[16:19]
    ds_read_b128 v[56:59], v15 offset:40960
    v_mfma_f32_16x16x32_bf16 v[20:23], v[96:99], v[172:175], v[20:23]
    ds_read_b128 v[60:63], v15 offset:41984
    v_mfma_f32_16x16x32_bf16 v[24:27], v[100:103], v[172:175], v[24:27]
    ds_read_b128 v[64:67], v15 offset:43008
    v_mfma_f32_16x16x32_bf16 v[28:31], v[104:107], v[172:175], v[28:31]
    ds_read_b128 v[68:71], v15 offset:44032
    v_mfma_f32_16x16x32_bf16 v[36:39], v[108:111], v[172:175], v[36:39]
    s_waitcnt vmcnt(0) lgkmcnt(4)
    v_mfma_f32_16x16x32_bf16 v[16:19], v[40:43], v[176:179], v[16:19]
    v_mfma_f32_16x16x32_bf16 v[20:23], v[44:47], v[176:179], v[20:23]
    v_mfma_f32_16x16x32_bf16 v[24:27], v[48:51], v[176:179], v[24:27]
    v_mfma_f32_16x16x32_bf16 v[28:31], v[52:55], v[176:179], v[28:31]
    v_mfma_f32_16x16x32_bf16 v[32:35], v[72:75], v[176:179], v[32:35]
    s_waitcnt lgkmcnt(0)
    v_mfma_f32_16x16x32_bf16 v[16:19], v[56:59], v[180:183], v[16:19]
    v_mfma_f32_16x16x32_bf16 v[20:23], v[60:63], v[180:183], v[20:23]
    v_mfma_f32_16x16x32_bf16 v[24:27], v[64:67], v[180:183], v[24:27]
    v_mfma_f32_16x16x32_bf16 v[28:31], v[68:71], v[180:183], v[28:31]
    v_mfma_f32_16x16x32_bf16 v[36:39], v[72:75], v[180:183], v[36:39]
    s_nop 3
    v_cvt_pk_bf16_f32 v208, v16, v17
    v_cvt_pk_bf16_f32 v209, v18, v19
    v_cvt_pk_bf16_f32 v210, v20, v21
    v_cvt_pk_bf16_f32 v211, v22, v23
    v_cvt_pk_bf16_f32 v212, v24, v25
    v_cvt_pk_bf16_f32 v213, v26, v27
    v_cvt_pk_bf16_f32 v214, v28, v29
    v_cvt_pk_bf16_f32 v215, v30, v31
    buffer_store_dwordx4 v[208:211], v4, s[4:7], s34 offen offset:0 sc1
    buffer_store_dwordx4 v[212:215], v4, s[4:7], s34 offen offset:1024 sc1
    v_permlane32_swap_b32 v36, v220
    v_permlane32_swap_b32 v37, v221
    v_permlane32_swap_b32 v38, v222
    v_permlane32_swap_b32 v39, v223
    v_pk_add_f32 v[32:33], v[32:33], v[220:221]
    v_pk_add_f32 v[34:35], v[34:35], v[222:223]
    v_cvt_pk_bf16_f32 v216, v32, v33
    v_cvt_pk_bf16_f32 v217, v34, v35
    buffer_store_dwordx2 v[216:217], v5, s[4:7], s34 offen sc1
    v_cndmask_b32 v222, 0, v216, s[40:41]
    v_cndmask_b32 v223, 0, v217, s[40:41]
    v_dot2_f32_bf16 v220, v208, v11, 0
    v_dot2_f32_bf16 v221, v208, v208, 0
    v_dot2_f32_bf16 v224, v209, v11, 0
    v_dot2_f32_bf16 v225, v209, v209, 0
    v_dot2_f32_bf16 v220, v210, v11, v220
    v_dot2_f32_bf16 v221, v210, v210, v221
    v_dot2_f32_bf16 v224, v211, v11, v224
    v_dot2_f32_bf16 v225, v211, v211, v225
    v_dot2_f32_bf16 v220, v212, v11, v220
    v_dot2_f32_bf16 v221, v212, v212, v221
    v_dot2_f32_bf16 v224, v213, v11, v224
    v_dot2_f32_bf16 v225, v213, v213, v225
    v_dot2_f32_bf16 v220, v214, v11, v220
    v_dot2_f32_bf16 v221, v214, v214, v221
    v_dot2_f32_bf16 v224, v215, v11, v224
    v_dot2_f32_bf16 v225, v215, v215, v225
    v_dot2_f32_bf16 v220, v222, v11, v220
    v_dot2_f32_bf16 v221, v222, v222, v221
    v_dot2_f32_bf16 v224, v223, v11, v224
    v_dot2_f32_bf16 v225, v223, v223, v225
    s_nop 2
    v_pk_add_f32 v[220:221], v[220:221], v[224:225]
    v_mov_b32 v222, v220
    v_mov_b32 v223, v221
    s_nop 1
    v_permlane32_swap_b32 v220, v222
    v_permlane32_swap_b32 v221, v223
    v_add_f32 v220, v220, v222
    v_add_f32 v221, v221, v223
    v_mov_b32 v222, v220
    v_mov_b32 v223, v221
    s_nop 1
    v_permlane16_swap_b32 v220, v222
    v_permlane16_swap_b32 v221, v223
    v_add_f32 v220, v220, v222
    v_add_f32 v221, v221, v223
    buffer_store_dwordx2 v[220:221], v10, s[4:7], s39 offen sc1
    s_and_b32 s25, s2, 7
    s_lshr_b32 s26, s2, 3
    s_and_b32 s23, s25, 1
    s_lshl_b32 s23, s23, 3
    s_and_b32 s27, s26, 7
    s_add_u32 s23, s23, s27
    s_lshr_b32 s24, s25, 1
    s_lshl_b32 s24, s24, 2
    s_lshr_b32 s27, s26, 3
    s_add_u32 s24, s24, s27
    s_add_u32 s28, s23, s24
    s_and_b32 s28, s28, 3
    s_lshl_b32 s30, s20, 12
    s_lshl_b32 s31, s23, 3
    s_lshl_b32 s33, s20, 1
    s_add_u32 s31, s31, s33
    s_lshl_b32 s32, s31, 10
    s_add_u32 s32, s32, s21
    s_add_u32 s32, s32, 0x1b20000
    v_add_u32 v2, 73728, v1
    s_add_u32 s33, s30, 18432
    v_add_u32 v3, s33, v1
    v_add_u32 v0, s33, v2
    s_lshr_b32 s34, s31, 1
    s_lshl_b32 s35, s34, 12
    s_add_u32 s35, s35, s21
    s_add_u32 s35, s35, 0x1b40000
    s_lshl_b32 s36, s24, 8
    s_add_u32 s36, s36, s35
    s_lshl_b32 s38, s24, 6
    s_add_u32 s38, s38, s34
    s_mul_i32 s38, s38, 9216
    s_add_u32 s38, s38, s21
    s_add_u32 s38, s38, 0x900000
    s_add_u32 s39, s38, 4096
    s_add_u32 s46, s38, 8192
    s_mov_b32 s40, 0xc0135761
    s_mov_b32 s42, 0x3d372713
    s_mov_b32 s44, 0x39e38e39
    s_mov_b32 s45, 0x3727c5ac
    v_lshrrev_b32 v4, 1, v1
    s_lshl_b32 s52, s22, 7
    s_add_u32 s52, s52, s23
    s_lshl_b32 s52, s52, 8
    s_add_u32 s52, s52, 0x4509000
    s_add_u32 s52, s52, s4
    s_addc_u32 s53, s5, 0
    s_waitcnt vmcnt(0)
    s_barrier
    s_cmp_lg_u32 s20, 0
    s_cbranch_scc1 L_ns_d3
    s_mov_b32 s56, 1
    s_atomic_add s56, s[50:51], 0
L_ns_d3:
    s_cmp_lg_u32 s20, 0
    s_cbranch_scc1 L_pd_d3
    s_mov_b32 s60, 65536
L_poll_d3:
    s_mov_b32 s57, 0
    s_atomic_add s57, s[52:53], 0 glc
    s_waitcnt lgkmcnt(0)
    s_cmp_ge_u32 s57, 16
    s_cbranch_scc1 L_pd_d3
    s_sub_u32 s60, s60, 1
    s_cbranch_scc1 L_pd_d3
    s_sleep 2
    s_branch L_poll_d3
L_pd_d3:
    s_barrier
    buffer_load_dwordx2 v[8:9], v4, s[4:7], s32 offen offset:0 sc1
    buffer_load_dwordx2 v[10:11], v4, s[4:7], s32 offen offset:512 sc1
    buffer_load_dwordx2 v[12:13], v4, s[4:7], s32 offen offset:1024 sc1
    buffer_load_dwordx2 v[14:15], v4, s[4:7], s32 offen offset:1536 sc1
    s_lshl_b32 s50, s22, 7
    s_add_u32 s50, s50, s23
    s_lshl_b32 s50, s50, 8
    s_add_u32 s50, s50, 0x450a000
    s_add_u32 s50, s50, s4
    s_addc_u32 s51, s5, 0
    s_barrier
    ds_read_b128 v[160:163], v3 offset:0
    ds_read_b128 v[164:167], v3 offset:2048
    ds_read_b128 v[168:171], v1 offset:0
    ds_read_b128 v[172:175], v1 offset:1024
    ds_read_b128 v[176:179], v1 offset:2048
    ds_read_b128 v[180:183], v1 offset:3072
    ds_read_b128 v[184:187], v1 offset:4096
    ds_read_b128 v[188:191], v1 offset:5120
    ds_read_b128 v[192:195], v1 offset:6144
    ds_read_b128 v[196:199], v1 offset:7168
    ds_read_b128 v[200:203], v1 offset:8192
    s_waitcnt lgkmcnt(5)
    v_mfma_f32_16x16x32_bf16 v[16:19], v[160:163], v[168:171], 0
    ds_read_b128 v[204:207], v3 offset:1024
    v_mfma_f32_16x16x32_bf16 v[20:23], v[164:167], v[168:171], 0
    ds_read_b128 v[208:211], v3 offset:3072
    v_mfma_f32_16x16x32_bf16 v[24:27], v[160:163], v[172:175], 0
    ds_read_b128 v[212:215], v1 offset:9216
    v_mfma_f32_16x16x32_bf16 v[28:31], v[164:167], v[172:175], 0
    ds_read_b128 v[216:219], v1 offset:10240
    v_mfma_f32_16x16x32_bf16 v[32:35], v[160:163], v[176:179], 0
    ds_read_b128 v[220:223], v1 offset:11264
    v_mfma_f32_16x16x32_bf16 v[36:39], v[164:167], v[176:179], 0
    ds_read_b128 v[224:227], v1 offset:12288
    v_mfma_f32_16x16x32_bf16 v[40:43], v[160:163], v[180:183], 0
    ds_read_b128 v[228:231], v1 offset:13312
    v_mfma_f32_16x16x32_bf16 v[44:47], v[164:167], v[180:183], 0
    ds_read_b128 v[232:235], v1 offset:14336
    s_waitcnt lgkmcnt(8)
    v_mfma_f32_16x16x32_bf16 v[48:51], v[160:163], v[184:187], 0
    ds_read_b128 v[236:239], v1 offset:15360
    v_mfma_f32_16x16x32_bf16 v[52:55], v[164:167], v[184:187], 0
    ds_read_b128 v[240:243], v1 offset:16384
    v_mfma_f32_16x16x32_bf16 v[56:59], v[160:163], v[188:191], 0
    ds_read_b128 v[244:247], v1 offset:17408
    v_mfma_f32_16x16x32_bf16 v[60:63], v[164:167], v[188:191], 0
    v_mfma_f32_16x16x32_bf16 v[64:67], v[160:163], v[192:195], 0
    v_mfma_f32_16x16x32_bf16 v[68:71], v[164:167], v[192:195], 0
    v_mfma_f32_16x16x32_bf16 v[72:75], v[160:163], v[196:199], 0
    v_mfma_f32_16x16x32_bf16 v[76:79], v[164:167], v[196:199], 0
    v_mfma_f32_16x16x32_bf16 v[80:83], v[160:163], v[200:203], 0
    v_mfma_f32_16x16x32_bf16 v[84:87], v[164:167], v[200:203], 0
    s_waitcnt lgkmcnt(0)
    s_barrier
    v_mfma_f32_16x16x32_bf16 v[16:19], v[204:207], v[212:215], v[16:19]
    ds_read_b128 v[160:163], v3 offset:36864
    v_mfma_f32_16x16x32_bf16 v[20:23], v[208:211], v[212:215], v[20:23]
    ds_read_b128 v[164:167], v3 offset:38912
    v_mfma_f32_16x16x32_bf16 v[24:27], v[204:207], v[216:219], v[24:27]
    ds_read_b128 v[168:171], v1 offset:36864
    v_mfma_f32_16x16x32_bf16 v[28:31], v[208:211], v[216:219], v[28:31]
    ds_read_b128 v[172:175], v1 offset:37888
    v_mfma_f32_16x16x32_bf16 v[32:35], v[204:207], v[220:223], v[32:35]
    ds_read_b128 v[176:179], v1 offset:38912
    v_mfma_f32_16x16x32_bf16 v[36:39], v[208:211], v[220:223], v[36:39]
    ds_read_b128 v[180:183], v1 offset:39936
    v_mfma_f32_16x16x32_bf16 v[40:43], v[204:207], v[224:227], v[40:43]
    ds_read_b128 v[184:187], v1 offset:40960
    v_mfma_f32_16x16x32_bf16 v[44:47], v[208:211], v[224:227], v[44:47]
    ds_read_b128 v[188:191], v1 offset:41984
    v_mfma_f32_16x16x32_bf16 v[48:51], v[204:207], v[228:231], v[48:51]
    ds_read_b128 v[192:195], v1 offset:43008
    v_mfma_f32_16x16x32_bf16 v[52:55], v[208:211], v[228:231], v[52:55]
    ds_read_b128 v[196:199], v1 offset:44032
    v_lshrrev_b32 v5, 8, v1
    v_mfma_f32_16x16x32_bf16 v[56:59], v[204:207], v[232:235], v[56:59]
    ds_read_b128 v[200:203], v1 offset:45056
    v_bfe_u32 v6, v1, 4, 4
    v_mfma_f32_16x16x32_bf16 v[60:63], v[208:211], v[232:235], v[60:63]
    v_lshlrev_b32 v7, 2, v6
    v_mfma_f32_16x16x32_bf16 v[64:67], v[204:207], v[236:239], v[64:67]
    s_lshl_b32 s33, s20, 8
    v_mfma_f32_16x16x32_bf16 v[68:71], v[208:211], v[236:239], v[68:71]
    s_add_u32 s33, s33, 147456
    v_mfma_f32_16x16x32_bf16 v[72:75], v[204:207], v[240:243], v[72:75]
    v_add_u32 v4, s33, v7
    v_mfma_f32_16x16x32_bf16 v[76:79], v[208:211], v[240:243], v[76:79]
    v_lshl_add_u32 v252, v5, 4, s33
    v_mfma_f32_16x16x32_bf16 v[80:83], v[204:207], v[244:247], v[80:83]
    v_add_u32 v7, 159744, v7
    v_mfma_f32_16x16x32_bf16 v[84:87], v[208:211], v[244:247], v[84:87]
    s_waitcnt vmcnt(0)
    v_add_f32 v248, v8, v10
    s_waitcnt lgkmcnt(5)
    v_mfma_f32_16x16x32_bf16 v[16:19], v[160:163], v[168:171], v[16:19]
    ds_read_b128 v[204:207], v3 offset:37888
    v_mfma_f32_16x16x32_bf16 v[20:23], v[164:167], v[168:171], v[20:23]
    ds_read_b128 v[208:211], v3 offset:39936
    v_mfma_f32_16x16x32_bf16 v[24:27], v[160:163], v[172:175], v[24:27]
    ds_read_b128 v[212:215], v1 offset:46080
    v_mfma_f32_16x16x32_bf16 v[28:31], v[164:167], v[172:175], v[28:31]
    ds_read_b128 v[216:219], v1 offset:47104
    v_mfma_f32_16x16x32_bf16 v[32:35], v[160:163], v[176:179], v[32:35]
    ds_read_b128 v[220:223], v1 offset:48128
    v_mfma_f32_16x16x32_bf16 v[36:39], v[164:167], v[176:179], v[36:39]
    ds_read_b128 v[224:227], v1 offset:49152
    v_mfma_f32_16x16x32_bf16 v[40:43], v[160:163], v[180:183], v[40:43]
    ds_read_b128 v[228:231], v1 offset:50176
    v_mfma_f32_16x16x32_bf16 v[44:47], v[164:167], v[180:183], v[44:47]
    ds_read_b128 v[232:235], v1 offset:51200
    s_waitcnt lgkmcnt(8)
    v_mfma_f32_16x16x32_bf16 v[48:51], v[160:163], v[184:187], v[48:51]
    ds_read_b128 v[236:239], v1 offset:52224
    v_mfma_f32_16x16x32_bf16 v[52:55], v[164:167], v[184:187], v[52:55]
    ds_read_b128 v[240:243], v1 offset:53248
    v_add_f32 v249, v9, v11
    v_mfma_f32_16x16x32_bf16 v[56:59], v[160:163], v[188:191], v[56:59]
    ds_read_b128 v[244:247], v1 offset:54272
    v_add_f32 v250, v12, v14
    v_mfma_f32_16x16x32_bf16 v[60:63], v[164:167], v[188:191], v[60:63]
    v_add_f32 v251, v13, v15
    v_mfma_f32_16x16x32_bf16 v[64:67], v[160:163], v[192:195], v[64:67]
    v_mov_b32 v8, v248
    v_mfma_f32_16x16x32_bf16 v[68:71], v[164:167], v[192:195], v[68:71]
    v_mov_b32 v9, v249
    v_mfma_f32_16x16x32_bf16 v[72:75], v[160:163], v[196:199], v[72:75]
    v_mov_b32 v12, v250
    v_mfma_f32_16x16x32_bf16 v[76:79], v[164:167], v[196:199], v[76:79]
    v_mov_b32 v13, v251
    v_mfma_f32_16x16x32_bf16 v[80:83], v[160:163], v[200:203], v[80:83]
    v_permlane32_swap_b32 v248, v8
    v_mfma_f32_16x16x32_bf16 v[84:87], v[164:167], v[200:203], v[84:87]
    v_permlane32_swap_b32 v249, v9
    v_permlane32_swap_b32 v250, v12
    s_waitcnt lgkmcnt(0)
    s_barrier
    v_mfma_f32_16x16x32_bf16 v[16:19], v[204:207], v[212:215], v[16:19]
    ds_read_b128 v[160:163], v0 offset:0
    v_mfma_f32_16x16x32_bf16 v[20:23], v[208:211], v[212:215], v[20:23]
    ds_read_b128 v[164:167], v0 offset:2048
    v_mfma_f32_16x16x32_bf16 v[24:27], v[204:207], v[216:219], v[24:27]
    ds_read_b128 v[168:171], v2 offset:0
    v_mfma_f32_16x16x32_bf16 v[28:31], v[208:211], v[216:219], v[28:31]
    ds_read_b128 v[172:175], v2 offset:1024
    v_mfma_f32_16x16x32_bf16 v[32:35], v[204:207], v[220:223], v[32:35]
    ds_read_b128 v[176:179], v2 offset:2048
    v_mfma_f32_16x16x32_bf16 v[36:39], v[208:211], v[220:223], v[36:39]
    ds_read_b128 v[180:183], v2 offset:3072
    v_mfma_f32_16x16x32_bf16 v[40:43], v[204:207], v[224:227], v[40:43]
    ds_read_b128 v[184:187], v2 offset:4096
    v_mfma_f32_16x16x32_bf16 v[44:47], v[208:211], v[224:227], v[44:47]
    ds_read_b128 v[188:191], v2 offset:5120
    v_mfma_f32_16x16x32_bf16 v[48:51], v[204:207], v[228:231], v[48:51]
    ds_read_b128 v[192:195], v2 offset:6144
    v_mfma_f32_16x16x32_bf16 v[52:55], v[208:211], v[228:231], v[52:55]
    ds_read_b128 v[196:199], v2 offset:7168
    v_permlane32_swap_b32 v251, v13
    v_mfma_f32_16x16x32_bf16 v[56:59], v[204:207], v[232:235], v[56:59]
    ds_read_b128 v[200:203], v2 offset:8192
    v_add_f32 v248, v248, v8
    v_mfma_f32_16x16x32_bf16 v[60:63], v[208:211], v[232:235], v[60:63]
    ds_read2_b32 v[128:129], v7 offset0:0 offset1:16
    v_add_f32 v249, v249, v9
    v_mfma_f32_16x16x32_bf16 v[64:67], v[204:207], v[236:239], v[64:67]
    ds_read2_b32 v[130:131], v7 offset0:32 offset1:48
    v_add_f32 v250, v250, v12
    v_mfma_f32_16x16x32_bf16 v[68:71], v[208:211], v[236:239], v[68:71]
    ds_read2_b32 v[132:133], v7 offset0:64 offset1:80
    v_add_f32 v251, v251, v13
    v_mfma_f32_16x16x32_bf16 v[72:75], v[204:207], v[240:243], v[72:75]
    ds_read2_b32 v[134:135], v7 offset0:96 offset1:112
    v_mov_b32 v8, v248
    v_mfma_f32_16x16x32_bf16 v[76:79], v[208:211], v[240:243], v[76:79]
    ds_read2_b32 v[136:137], v7 offset0:128 offset1:144
    v_mov_b32 v9, v249
    v_mfma_f32_16x16x32_bf16 v[80:83], v[204:207], v[244:247], v[80:83]
    v_mov_b32 v12, v250
    v_mfma_f32_16x16x32_bf16 v[84:87], v[208:211], v[244:247], v[84:87]
    v_mov_b32 v13, v251
    v_permlane16_swap_b32 v248, v8
    s_waitcnt lgkmcnt(10)
    v_mfma_f32_16x16x32_bf16 v[16:19], v[160:163], v[168:171], v[16:19]
    ds_read_b128 v[204:207], v0 offset:1024
    v_mfma_f32_16x16x32_bf16 v[20:23], v[164:167], v[168:171], v[20:23]
    ds_read_b128 v[208:211], v0 offset:3072
    v_mfma_f32_16x16x32_bf16 v[24:27], v[160:163], v[172:175], v[24:27]
    ds_read_b128 v[212:215], v2 offset:9216
    v_mfma_f32_16x16x32_bf16 v[28:31], v[164:167], v[172:175], v[28:31]
    ds_read_b128 v[216:219], v2 offset:10240
    v_mfma_f32_16x16x32_bf16 v[32:35], v[160:163], v[176:179], v[32:35]
    ds_read_b128 v[220:223], v2 offset:11264
    v_mfma_f32_16x16x32_bf16 v[36:39], v[164:167], v[176:179], v[36:39]
    ds_read_b128 v[224:227], v2 offset:12288
    v_mfma_f32_16x16x32_bf16 v[40:43], v[160:163], v[180:183], v[40:43]
    ds_read_b128 v[228:231], v2 offset:13312
    v_mfma_f32_16x16x32_bf16 v[44:47], v[164:167], v[180:183], v[44:47]
    ds_read_b128 v[232:235], v2 offset:14336
    s_waitcnt lgkmcnt(8)
    v_mfma_f32_16x16x32_bf16 v[48:51], v[160:163], v[184:187], v[48:51]
    ds_read_b128 v[236:239], v2 offset:15360
    v_mfma_f32_16x16x32_bf16 v[52:55], v[164:167], v[184:187], v[52:55]
    ds_read_b128 v[240:243], v2 offset:16384
    v_permlane16_swap_b32 v249, v9
    v_mfma_f32_16x16x32_bf16 v[56:59], v[160:163], v[188:191], v[56:59]
    ds_read_b128 v[244:247], v2 offset:17408
    v_permlane16_swap_b32 v250, v12
    v_mfma_f32_16x16x32_bf16 v[60:63], v[164:167], v[188:191], v[60:63]
    v_permlane16_swap_b32 v251, v13
    v_mfma_f32_16x16x32_bf16 v[64:67], v[160:163], v[192:195], v[64:67]
    v_add_f32 v248, v248, v8
    v_mfma_f32_16x16x32_bf16 v[68:71], v[164:167], v[192:195], v[68:71]
    v_add_f32 v249, v249, v9
    v_mfma_f32_16x16x32_bf16 v[72:75], v[160:163], v[196:199], v[72:75]
    v_add_f32 v250, v250, v12
    v_mfma_f32_16x16x32_bf16 v[76:79], v[164:167], v[196:199], v[76:79]
    v_add_f32 v251, v251, v13
    v_mfma_f32_16x16x32_bf16 v[80:83], v[160:163], v[200:203], v[80:83]
    v_mul_f32 v248, 0x3ae38e39, v248
    v_mfma_f32_16x16x32_bf16 v[84:87], v[164:167], v[200:203], v[84:87]
    v_mul_f32 v249, 0x3ae38e39, v249
    v_mul_f32 v250, 0x3ae38e39, v250
    s_waitcnt lgkmcnt(0)
    s_barrier
    v_mfma_f32_16x16x32_bf16 v[16:19], v[204:207], v[212:215], v[16:19]
    ds_read_b128 v[160:163], v0 offset:36864
    v_mfma_f32_16x16x32_bf16 v[20:23], v[208:211], v[212:215], v[20:23]
    ds_read_b128 v[164:167], v0 offset:38912
    v_mfma_f32_16x16x32_bf16 v[24:27], v[204:207], v[216:219], v[24:27]
    ds_read_b128 v[168:171], v2 offset:36864
    v_mfma_f32_16x16x32_bf16 v[28:31], v[208:211], v[216:219], v[28:31]
    ds_read_b128 v[172:175], v2 offset:37888
    v_mfma_f32_16x16x32_bf16 v[32:35], v[204:207], v[220:223], v[32:35]
    ds_read_b128 v[176:179], v2 offset:38912
    v_mfma_f32_16x16x32_bf16 v[36:39], v[208:211], v[220:223], v[36:39]
    ds_read_b128 v[180:183], v2 offset:39936
    v_mfma_f32_16x16x32_bf16 v[40:43], v[204:207], v[224:227], v[40:43]
    ds_read_b128 v[184:187], v2 offset:40960
    v_mfma_f32_16x16x32_bf16 v[44:47], v[208:211], v[224:227], v[44:47]
    ds_read_b128 v[188:191], v2 offset:41984
    v_mfma_f32_16x16x32_bf16 v[48:51], v[204:207], v[228:231], v[48:51]
    ds_read_b128 v[192:195], v2 offset:43008
    v_mfma_f32_16x16x32_bf16 v[52:55], v[208:211], v[228:231], v[52:55]
    ds_read_b128 v[196:199], v2 offset:44032
    v_mul_f32 v251, 0x3ae38e39, v251
    v_mfma_f32_16x16x32_bf16 v[56:59], v[204:207], v[232:235], v[56:59]
    ds_read_b128 v[200:203], v2 offset:45056
    v_fma_f32 v249, -v248, v248, v249
    v_mfma_f32_16x16x32_bf16 v[60:63], v[208:211], v[232:235], v[60:63]
    v_fma_f32 v251, -v250, v250, v251
    v_mfma_f32_16x16x32_bf16 v[64:67], v[204:207], v[236:239], v[64:67]
    v_max_f32 v249, 0, v249
    v_mfma_f32_16x16x32_bf16 v[68:71], v[208:211], v[236:239], v[68:71]
    v_max_f32 v251, 0, v251
    v_mfma_f32_16x16x32_bf16 v[72:75], v[204:207], v[240:243], v[72:75]
    v_add_f32 v249, 0x3727c5ac, v249
    v_mfma_f32_16x16x32_bf16 v[76:79], v[208:211], v[240:243], v[76:79]
    v_add_f32 v251, 0x3727c5ac, v251
    v_mfma_f32_16x16x32_bf16 v[80:83], v[204:207], v[244:247], v[80:83]
    v_rsq_f32 v249, v249
    v_mfma_f32_16x16x32_bf16 v[84:87], v[208:211], v[244:247], v[84:87]
    v_rsq_f32 v251, v251
    s_nop 0
    s_waitcnt lgkmcnt(5)
    v_mfma_f32_16x16x32_bf16 v[16:19], v[160:163], v[168:171], v[16:19]
    ds_read_b128 v[204:207], v0 offset:37888
    v_mfma_f32_16x16x32_bf16 v[20:23], v[164:167], v[168:171], v[20:23]
    ds_read_b128 v[208:211], v0 offset:39936
    v_mfma_f32_16x16x32_bf16 v[24:27], v[160:163], v[172:175], v[24:27]
    ds_read_b128 v[212:215], v2 offset:46080
    v_mfma_f32_16x16x32_bf16 v[28:31], v[164:167], v[172:175], v[28:31]
    ds_read_b128 v[216:219], v2 offset:47104
    v_mfma_f32_16x16x32_bf16 v[32:35], v[160:163], v[176:179], v[32:35]
    ds_read_b128 v[220:223], v2 offset:48128
    v_mfma_f32_16x16x32_bf16 v[36:39], v[164:167], v[176:179], v[36:39]
    ds_read_b128 v[224:227], v2 offset:49152
    v_mfma_f32_16x16x32_bf16 v[40:43], v[160:163], v[180:183], v[40:43]
    ds_read_b128 v[228:231], v2 offset:50176
    v_mfma_f32_16x16x32_bf16 v[44:47], v[164:167], v[180:183], v[44:47]
    ds_read_b128 v[232:235], v2 offset:51200
    s_waitcnt lgkmcnt(8)
    v_mfma_f32_16x16x32_bf16 v[48:51], v[160:163], v[184:187], v[48:51]
    ds_read_b128 v[236:239], v2 offset:52224
    v_mfma_f32_16x16x32_bf16 v[52:55], v[164:167], v[184:187], v[52:55]
    ds_read_b128 v[240:243], v2 offset:53248
    v_mfma_f32_16x16x32_bf16 v[56:59], v[160:163], v[188:191], v[56:59]
    ds_read_b128 v[244:247], v2 offset:54272
    v_mfma_f32_16x16x32_bf16 v[60:63], v[164:167], v[188:191], v[60:63]
    v_mfma_f32_16x16x32_bf16 v[64:67], v[160:163], v[192:195], v[64:67]
    v_mfma_f32_16x16x32_bf16 v[68:71], v[164:167], v[192:195], v[68:71]
    v_mfma_f32_16x16x32_bf16 v[72:75], v[160:163], v[196:199], v[72:75]
    v_mfma_f32_16x16x32_bf16 v[76:79], v[164:167], v[196:199], v[76:79]
    v_mfma_f32_16x16x32_bf16 v[80:83], v[160:163], v[200:203], v[80:83]
    v_mfma_f32_16x16x32_bf16 v[84:87], v[164:167], v[200:203], v[84:87]
    s_waitcnt lgkmcnt(0)
    s_barrier
    v_mfma_f32_16x16x32_bf16 v[16:19], v[204:207], v[212:215], v[16:19]
    ds_read_b128 v[160:163], v3 offset:0
    v_mfma_f32_16x16x32_bf16 v[20:23], v[208:211], v[212:215], v[20:23]
    ds_read_b128 v[164:167], v3 offset:2048
    v_mfma_f32_16x16x32_bf16 v[24:27], v[204:207], v[216:219], v[24:27]
    ds_read_b128 v[168:171], v1 offset:0
    v_mfma_f32_16x16x32_bf16 v[28:31], v[208:211], v[216:219], v[28:31]
    ds_read_b128 v[172:175], v1 offset:1024
    v_mfma_f32_16x16x32_bf16 v[32:35], v[204:207], v[220:223], v[32:35]
    ds_read_b128 v[176:179], v1 offset:2048
    v_mfma_f32_16x16x32_bf16 v[36:39], v[208:211], v[220:223], v[36:39]
    ds_read_b128 v[180:183], v1 offset:3072
    v_mfma_f32_16x16x32_bf16 v[40:43], v[204:207], v[224:227], v[40:43]
    ds_read_b128 v[184:187], v1 offset:4096
    v_mfma_f32_16x16x32_bf16 v[44:47], v[208:211], v[224:227], v[44:47]
    ds_read_b128 v[188:191], v1 offset:5120
    v_mfma_f32_16x16x32_bf16 v[48:51], v[204:207], v[228:231], v[48:51]
    ds_read_b128 v[192:195], v1 offset:6144
    v_mfma_f32_16x16x32_bf16 v[52:55], v[208:211], v[228:231], v[52:55]
    ds_read_b128 v[196:199], v1 offset:7168
    v_mfma_f32_16x16x32_bf16 v[56:59], v[204:207], v[232:235], v[56:59]
    ds_read_b128 v[200:203], v1 offset:8192
    v_mfma_f32_16x16x32_bf16 v[60:63], v[208:211], v[232:235], v[60:63]
    ds_write2_b32 v4, v248, v249 offset0:0 offset1:32
    v_mfma_f32_16x16x32_bf16 v[64:67], v[204:207], v[236:239], v[64:67]
    ds_write2_b32 v4, v250, v251 offset0:16 offset1:48
    v_mfma_f32_16x16x32_bf16 v[68:71], v[208:211], v[236:239], v[68:71]
    ds_read_b128 v[88:91], v252 offset:0
    v_mfma_f32_16x16x32_bf16 v[72:75], v[204:207], v[240:243], v[72:75]
    ds_read_b128 v[92:95], v252 offset:64
    v_mfma_f32_16x16x32_bf16 v[76:79], v[208:211], v[240:243], v[76:79]
    ds_read_b128 v[96:99], v252 offset:128
    v_mfma_f32_16x16x32_bf16 v[80:83], v[204:207], v[244:247], v[80:83]
    ds_read_b128 v[100:103], v252 offset:192
    v_mfma_f32_16x16x32_bf16 v[84:87], v[208:211], v[244:247], v[84:87]
    s_waitcnt lgkmcnt(11)
    v_mfma_f32_16x16x32_bf16 v[16:19], v[160:163], v[168:171], v[16:19]
    ds_read_b128 v[204:207], v3 offset:1024
    v_mfma_f32_16x16x32_bf16 v[20:23], v[164:167], v[168:171], v[20:23]
    ds_read_b128 v[208:211], v3 offset:3072
    v_mfma_f32_16x16x32_bf16 v[24:27], v[160:163], v[172:175], v[24:27]
    ds_read_b128 v[212:215], v1 offset:9216
    v_mfma_f32_16x16x32_bf16 v[28:31], v[164:167], v[172:175], v[28:31]
    ds_read_b128 v[216:219], v1 offset:10240
    v_mfma_f32_16x16x32_bf16 v[32:35], v[160:163], v[176:179], v[32:35]
    ds_read_b128 v[220:223], v1 offset:11264
    v_mfma_f32_16x16x32_bf16 v[36:39], v[164:167], v[176:179], v[36:39]
    ds_read_b128 v[224:227], v1 offset:12288
    v_mfma_f32_16x16x32_bf16 v[40:43], v[160:163], v[180:183], v[40:43]
    ds_read_b128 v[228:231], v1 offset:13312
    v_mfma_f32_16x16x32_bf16 v[44:47], v[164:167], v[180:183], v[44:47]
    ds_read_b128 v[232:235], v1 offset:14336
    s_waitcnt lgkmcnt(8)
    v_mfma_f32_16x16x32_bf16 v[48:51], v[160:163], v[184:187], v[48:51]
    ds_read_b128 v[236:239], v1 offset:15360
    v_mfma_f32_16x16x32_bf16 v[52:55], v[164:167], v[184:187], v[52:55]
    ds_read_b128 v[240:243], v1 offset:16384
    v_rcp_f32 v120, v96
    v_mfma_f32_16x16x32_bf16 v[56:59], v[160:163], v[188:191], v[56:59]
    ds_read_b128 v[244:247], v1 offset:17408
    v_mul_f32 v104, s40, v96
    v_mfma_f32_16x16x32_bf16 v[60:63], v[164:167], v[188:191], v[60:63]
    v_mul_f32 v112, v96, v96
    v_mfma_f32_16x16x32_bf16 v[64:67], v[160:163], v[192:195], v[64:67]
    v_rcp_f32 v121, v97
    v_mfma_f32_16x16x32_bf16 v[68:71], v[164:167], v[192:195], v[68:71]
    v_mul_f32 v105, s40, v97
    v_mfma_f32_16x16x32_bf16 v[72:75], v[160:163], v[196:199], v[72:75]
    v_mul_f32 v113, v97, v97
    v_mfma_f32_16x16x32_bf16 v[76:79], v[164:167], v[196:199], v[76:79]
    v_rcp_f32 v122, v98
    v_mfma_f32_16x16x32_bf16 v[80:83], v[160:163], v[200:203], v[80:83]
    v_mul_f32 v106, s40, v98
    v_mfma_f32_16x16x32_bf16 v[84:87], v[164:167], v[200:203], v[84:87]
    v_mul_f32 v114, v98, v98
    v_rcp_f32 v123, v99
    s_waitcnt lgkmcnt(0)
    s_barrier
    v_mfma_f32_16x16x32_bf16 v[16:19], v[204:207], v[212:215], v[16:19]
    ds_read_b128 v[160:163], v3 offset:36864
    v_mfma_f32_16x16x32_bf16 v[20:23], v[208:211], v[212:215], v[20:23]
    ds_read_b128 v[164:167], v3 offset:38912
    v_mfma_f32_16x16x32_bf16 v[24:27], v[204:207], v[216:219], v[24:27]
    ds_read_b128 v[168:171], v1 offset:36864
    v_mfma_f32_16x16x32_bf16 v[28:31], v[208:211], v[216:219], v[28:31]
    ds_read_b128 v[172:175], v1 offset:37888
    v_mfma_f32_16x16x32_bf16 v[32:35], v[204:207], v[220:223], v[32:35]
    ds_read_b128 v[176:179], v1 offset:38912
    v_mfma_f32_16x16x32_bf16 v[36:39], v[208:211], v[220:223], v[36:39]
    ds_read_b128 v[180:183], v1 offset:39936
    v_mfma_f32_16x16x32_bf16 v[40:43], v[204:207], v[224:227], v[40:43]
    ds_read_b128 v[184:187], v1 offset:40960
    v_mfma_f32_16x16x32_bf16 v[44:47], v[208:211], v[224:227], v[44:47]
    ds_read_b128 v[188:191], v1 offset:41984
    v_mfma_f32_16x16x32_bf16 v[48:51], v[204:207], v[228:231], v[48:51]
    ds_read_b128 v[192:195], v1 offset:43008
    v_mfma_f32_16x16x32_bf16 v[52:55], v[208:211], v[228:231], v[52:55]
    ds_read_b128 v[196:199], v1 offset:44032
    v_mul_f32 v107, s40, v99
    v_mfma_f32_16x16x32_bf16 v[56:59], v[204:207], v[232:235], v[56:59]
    ds_read_b128 v[200:203], v1 offset:45056
    v_mul_f32 v115, v99, v99
    v_mfma_f32_16x16x32_bf16 v[60:63], v[208:211], v[232:235], v[60:63]
    v_rcp_f32 v124, v100
    v_mfma_f32_16x16x32_bf16 v[64:67], v[204:207], v[236:239], v[64:67]
    v_mul_f32 v108, s40, v100
    v_mfma_f32_16x16x32_bf16 v[68:71], v[208:211], v[236:239], v[68:71]
    v_mul_f32 v116, v100, v100
    v_mfma_f32_16x16x32_bf16 v[72:75], v[204:207], v[240:243], v[72:75]
    v_rcp_f32 v125, v101
    v_mfma_f32_16x16x32_bf16 v[76:79], v[208:211], v[240:243], v[76:79]
    v_mul_f32 v109, s40, v101
    v_mfma_f32_16x16x32_bf16 v[80:83], v[204:207], v[244:247], v[80:83]
    v_mul_f32 v117, v101, v101
    v_mfma_f32_16x16x32_bf16 v[84:87], v[208:211], v[244:247], v[84:87]
    v_rcp_f32 v126, v102
    v_mul_f32 v110, s40, v102
    s_waitcnt lgkmcnt(5)
    v_mfma_f32_16x16x32_bf16 v[16:19], v[160:163], v[168:171], v[16:19]
    ds_read_b128 v[204:207], v3 offset:37888
    v_mfma_f32_16x16x32_bf16 v[20:23], v[164:167], v[168:171], v[20:23]
    ds_read_b128 v[208:211], v3 offset:39936
    v_mfma_f32_16x16x32_bf16 v[24:27], v[160:163], v[172:175], v[24:27]
    ds_read_b128 v[212:215], v1 offset:46080
    v_mfma_f32_16x16x32_bf16 v[28:31], v[164:167], v[172:175], v[28:31]
    ds_read_b128 v[216:219], v1 offset:47104
    v_mfma_f32_16x16x32_bf16 v[32:35], v[160:163], v[176:179], v[32:35]
    ds_read_b128 v[220:223], v1 offset:48128
    v_mfma_f32_16x16x32_bf16 v[36:39], v[164:167], v[176:179], v[36:39]
    ds_read_b128 v[224:227], v1 offset:49152
    v_mfma_f32_16x16x32_bf16 v[40:43], v[160:163], v[180:183], v[40:43]
    ds_read_b128 v[228:231], v1 offset:50176
    v_mfma_f32_16x16x32_bf16 v[44:47], v[164:167], v[180:183], v[44:47]
    ds_read_b128 v[232:235], v1 offset:51200
    s_waitcnt lgkmcnt(8)
    v_mfma_f32_16x16x32_bf16 v[48:51], v[160:163], v[184:187], v[48:51]
    ds_read_b128 v[236:239], v1 offset:52224
    v_mfma_f32_16x16x32_bf16 v[52:55], v[164:167], v[184:187], v[52:55]
    ds_read_b128 v[240:243], v1 offset:53248
    v_mul_f32 v118, v102, v102
    v_mfma_f32_16x16x32_bf16 v[56:59], v[160:163], v[188:191], v[56:59]
    ds_read_b128 v[244:247], v1 offset:54272
    v_rcp_f32 v127, v103
    v_mfma_f32_16x16x32_bf16 v[60:63], v[164:167], v[188:191], v[60:63]
    v_mul_f32 v111, s40, v103
    v_mfma_f32_16x16x32_bf16 v[64:67], v[160:163], v[192:195], v[64:67]
    v_mul_f32 v119, v103, v103
    v_mfma_f32_16x16x32_bf16 v[68:71], v[164:167], v[192:195], v[68:71]
    v_mul_f32 v112, s42, v112
    v_mfma_f32_16x16x32_bf16 v[72:75], v[160:163], v[196:199], v[72:75]
    v_mul_f32 v113, s42, v113
    v_mfma_f32_16x16x32_bf16 v[76:79], v[164:167], v[196:199], v[76:79]
    v_mul_f32 v114, s42, v114
    v_mfma_f32_16x16x32_bf16 v[80:83], v[160:163], v[200:203], v[80:83]
    v_mul_f32 v115, s42, v115
    v_mfma_f32_16x16x32_bf16 v[84:87], v[164:167], v[200:203], v[84:87]
    v_mul_f32 v116, s42, v116
    v_mul_f32 v117, s42, v117
    s_waitcnt lgkmcnt(0)
    s_barrier
    v_mfma_f32_16x16x32_bf16 v[16:19], v[204:207], v[212:215], v[16:19]
    ds_read_b128 v[160:163], v0 offset:0
    v_mfma_f32_16x16x32_bf16 v[20:23], v[208:211], v[212:215], v[20:23]
    ds_read_b128 v[164:167], v0 offset:2048
    v_mfma_f32_16x16x32_bf16 v[24:27], v[204:207], v[216:219], v[24:27]
    ds_read_b128 v[168:171], v2 offset:0
    v_mfma_f32_16x16x32_bf16 v[28:31], v[208:211], v[216:219], v[28:31]
    ds_read_b128 v[172:175], v2 offset:1024
    v_mfma_f32_16x16x32_bf16 v[32:35], v[204:207], v[220:223], v[32:35]
    ds_read_b128 v[176:179], v2 offset:2048
    v_mfma_f32_16x16x32_bf16 v[36:39], v[208:211], v[220:223], v[36:39]
    ds_read_b128 v[180:183], v2 offset:3072
    v_mfma_f32_16x16x32_bf16 v[40:43], v[204:207], v[224:227], v[40:43]
    ds_read_b128 v[184:187], v2 offset:4096
    v_mfma_f32_16x16x32_bf16 v[44:47], v[208:211], v[224:227], v[44:47]
    ds_read_b128 v[188:191], v2 offset:5120
    v_mfma_f32_16x16x32_bf16 v[48:51], v[204:207], v[228:231], v[48:51]
    ds_read_b128 v[192:195], v2 offset:6144
    v_mfma_f32_16x16x32_bf16 v[52:55], v[208:211], v[228:231], v[52:55]
    ds_read_b128 v[196:199], v2 offset:7168
    v_mul_f32 v118, s42, v118
    v_mfma_f32_16x16x32_bf16 v[56:59], v[204:207], v[232:235], v[56:59]
    ds_read_b128 v[200:203], v2 offset:8192
    v_mul_f32 v119, s42, v119
    v_mfma_f32_16x16x32_bf16 v[60:63], v[208:211], v[232:235], v[60:63]
    v_mul_f32 v112, v112, v104
    v_mfma_f32_16x16x32_bf16 v[64:67], v[204:207], v[236:239], v[64:67]
    v_mul_f32 v113, v113, v105
    v_mfma_f32_16x16x32_bf16 v[68:71], v[208:211], v[236:239], v[68:71]
    v_mul_f32 v114, v114, v106
    v_mfma_f32_16x16x32_bf16 v[72:75], v[204:207], v[240:243], v[72:75]
    v_mul_f32 v115, v115, v107
    v_mfma_f32_16x16x32_bf16 v[76:79], v[208:211], v[240:243], v[76:79]
    v_mul_f32 v116, v116, v108
    v_mfma_f32_16x16x32_bf16 v[80:83], v[204:207], v[244:247], v[80:83]
    v_mul_f32 v117, v117, v109
    v_mfma_f32_16x16x32_bf16 v[84:87], v[208:211], v[244:247], v[84:87]
    v_mul_f32 v118, v118, v110
    v_mul_f32 v119, v119, v111
    s_waitcnt lgkmcnt(5)
    v_mfma_f32_16x16x32_bf16 v[16:19], v[160:163], v[168:171], v[16:19]
    ds_read_b128 v[204:207], v0 offset:1024
    v_mfma_f32_16x16x32_bf16 v[20:23], v[164:167], v[168:171], v[20:23]
    ds_read_b128 v[208:211], v0 offset:3072
    v_mfma_f32_16x16x32_bf16 v[24:27], v[160:163], v[172:175], v[24:27]
    ds_read_b128 v[212:215], v2 offset:9216
    v_mfma_f32_16x16x32_bf16 v[28:31], v[164:167], v[172:175], v[28:31]
    ds_read_b128 v[216:219], v2 offset:10240
    v_mfma_f32_16x16x32_bf16 v[32:35], v[160:163], v[176:179], v[32:35]
    ds_read_b128 v[220:223], v2 offset:11264
    v_mfma_f32_16x16x32_bf16 v[36:39], v[164:167], v[176:179], v[36:39]
    ds_read_b128 v[224:227], v2 offset:12288
    v_mfma_f32_16x16x32_bf16 v[40:43], v[160:163], v[180:183], v[40:43]
    ds_read_b128 v[228:231], v2 offset:13312
    v_mfma_f32_16x16x32_bf16 v[44:47], v[164:167], v[180:183], v[44:47]
    ds_read_b128 v[232:235], v2 offset:14336
    s_waitcnt lgkmcnt(8)
    v_mfma_f32_16x16x32_bf16 v[48:51], v[160:163], v[184:187], v[48:51]
    ds_read_b128 v[236:239], v2 offset:15360
    v_mfma_f32_16x16x32_bf16 v[52:55], v[164:167], v[184:187], v[52:55]
    ds_read_b128 v[240:243], v2 offset:16384
    v_lshrrev_b32 v8, 2, v6
    v_mfma_f32_16x16x32_bf16 v[56:59], v[160:163], v[188:191], v[56:59]
    ds_read_b128 v[244:247], v2 offset:17408
    v_lshlrev_b32 v8, 4, v8
    v_mfma_f32_16x16x32_bf16 v[60:63], v[164:167], v[188:191], v[60:63]
    v_lshl_add_u32 v8, v5, 6, v8
    v_mfma_f32_16x16x32_bf16 v[64:67], v[160:163], v[192:195], v[64:67]
    v_and_b32 v9, 3, v6
    v_mfma_f32_16x16x32_bf16 v[68:71], v[164:167], v[192:195], v[68:71]
    v_cmp_eq_u32 vcc, 0, v9
    v_mfma_f32_16x16x32_bf16 v[72:75], v[160:163], v[196:199], v[72:75]
    v_bfrev_b32 v10, 1
    v_mfma_f32_16x16x32_bf16 v[76:79], v[164:167], v[196:199], v[76:79]
    v_lshlrev_b32 v9, 4, v9
    v_mfma_f32_16x16x32_bf16 v[80:83], v[160:163], v[200:203], v[80:83]
    v_cndmask_b32 v8, v10, v8, vcc
    v_mfma_f32_16x16x32_bf16 v[84:87], v[164:167], v[200:203], v[84:87]
    v_lshl_add_u32 v9, v5, 6, v9
    v_lshrrev_b32 v255, 2, v6
    s_waitcnt lgkmcnt(0)
    s_barrier
    v_mfma_f32_16x16x32_bf16 v[16:19], v[204:207], v[212:215], v[16:19]
    ds_read_b128 v[160:163], v0 offset:36864
    v_fma_f32 v52, -v92, v132, v52
    v_mfma_f32_16x16x32_bf16 v[20:23], v[208:211], v[212:215], v[20:23]
    ds_read_b128 v[164:167], v0 offset:38912
    v_fma_f32 v56, -v88, v133, v56
    v_mfma_f32_16x16x32_bf16 v[24:27], v[204:207], v[216:219], v[24:27]
    ds_read_b128 v[168:171], v2 offset:36864
    v_fma_f32 v60, -v92, v133, v60
    v_mfma_f32_16x16x32_bf16 v[28:31], v[208:211], v[216:219], v[28:31]
    ds_read_b128 v[172:175], v2 offset:37888
    v_fma_f32 v64, -v88, v134, v64
    v_mfma_f32_16x16x32_bf16 v[32:35], v[204:207], v[220:223], v[32:35]
    ds_read_b128 v[176:179], v2 offset:38912
    v_fma_f32 v68, -v92, v134, v68
    v_mfma_f32_16x16x32_bf16 v[36:39], v[208:211], v[220:223], v[36:39]
    ds_read_b128 v[180:183], v2 offset:39936
    v_fma_f32 v72, -v88, v135, v72
    v_mfma_f32_16x16x32_bf16 v[40:43], v[204:207], v[224:227], v[40:43]
    ds_read_b128 v[184:187], v2 offset:40960
    v_fma_f32 v76, -v92, v135, v76
    v_mfma_f32_16x16x32_bf16 v[44:47], v[208:211], v[224:227], v[44:47]
    ds_read_b128 v[188:191], v2 offset:41984
    v_fma_f32 v80, -v88, v136, v80
    v_mfma_f32_16x16x32_bf16 v[48:51], v[204:207], v[228:231], v[48:51]
    ds_read_b128 v[192:195], v2 offset:43008
    v_fma_f32 v84, -v92, v136, v84
    v_mfma_f32_16x16x32_bf16 v[52:55], v[208:211], v[228:231], v[52:55]
    ds_read_b128 v[196:199], v2 offset:44032
    v_lshl_add_u32 v255, v255, 8, v9
    v_fma_f32 v16, -v88, v128, v16
    v_mfma_f32_16x16x32_bf16 v[56:59], v[204:207], v[232:235], v[56:59]
    ds_read_b128 v[200:203], v2 offset:45056
    v_fma_f32 v20, -v92, v128, v20
    v_mfma_f32_16x16x32_bf16 v[60:63], v[208:211], v[232:235], v[60:63]
    v_fma_f32 v24, -v88, v129, v24
    v_mfma_f32_16x16x32_bf16 v[64:67], v[204:207], v[236:239], v[64:67]
    v_fma_f32 v28, -v92, v129, v28
    v_mfma_f32_16x16x32_bf16 v[68:71], v[208:211], v[236:239], v[68:71]
    v_fma_f32 v32, -v88, v130, v32
    v_mfma_f32_16x16x32_bf16 v[72:75], v[204:207], v[240:243], v[72:75]
    v_fma_f32 v36, -v92, v130, v36
    v_mfma_f32_16x16x32_bf16 v[76:79], v[208:211], v[240:243], v[76:79]
    v_fma_f32 v40, -v88, v131, v40
    v_mfma_f32_16x16x32_bf16 v[80:83], v[204:207], v[244:247], v[80:83]
    v_fma_f32 v44, -v92, v131, v44
    v_mfma_f32_16x16x32_bf16 v[84:87], v[208:211], v[244:247], v[84:87]
    v_fma_f32 v48, -v88, v132, v48
    s_waitcnt lgkmcnt(5)
    v_mfma_f32_16x16x32_bf16 v[16:19], v[160:163], v[168:171], v[16:19]
    ds_read_b128 v[204:207], v0 offset:37888
    v_fma_f32 v53, -v93, v132, v53
    v_mfma_f32_16x16x32_bf16 v[20:23], v[164:167], v[168:171], v[20:23]
    ds_read_b128 v[208:211], v0 offset:39936
    v_fma_f32 v57, -v89, v133, v57
    v_mfma_f32_16x16x32_bf16 v[24:27], v[160:163], v[172:175], v[24:27]
    ds_read_b128 v[212:215], v2 offset:46080
    v_fma_f32 v61, -v93, v133, v61
    v_mfma_f32_16x16x32_bf16 v[28:31], v[164:167], v[172:175], v[28:31]
    ds_read_b128 v[216:219], v2 offset:47104
    v_fma_f32 v65, -v89, v134, v65
    v_mfma_f32_16x16x32_bf16 v[32:35], v[160:163], v[176:179], v[32:35]
    ds_read_b128 v[220:223], v2 offset:48128
    v_fma_f32 v69, -v93, v134, v69
    v_mfma_f32_16x16x32_bf16 v[36:39], v[164:167], v[176:179], v[36:39]
    ds_read_b128 v[224:227], v2 offset:49152
    v_fma_f32 v73, -v89, v135, v73
    v_mfma_f32_16x16x32_bf16 v[40:43], v[160:163], v[180:183], v[40:43]
    ds_read_b128 v[228:231], v2 offset:50176
    v_fma_f32 v77, -v93, v135, v77
    v_mfma_f32_16x16x32_bf16 v[44:47], v[164:167], v[180:183], v[44:47]
    ds_read_b128 v[232:235], v2 offset:51200
    s_waitcnt lgkmcnt(8)
    v_fma_f32 v81, -v89, v136, v81
    v_mfma_f32_16x16x32_bf16 v[48:51], v[160:163], v[184:187], v[48:51]
    ds_read_b128 v[236:239], v2 offset:52224
    v_fma_f32 v85, -v93, v136, v85
    v_mfma_f32_16x16x32_bf16 v[52:55], v[164:167], v[184:187], v[52:55]
    ds_read_b128 v[240:243], v2 offset:53248
    v_fma_f32 v17, -v89, v128, v17
    v_mfma_f32_16x16x32_bf16 v[56:59], v[160:163], v[188:191], v[56:59]
    ds_read_b128 v[244:247], v2 offset:54272
    v_fma_f32 v21, -v93, v128, v21
    v_mfma_f32_16x16x32_bf16 v[60:63], v[164:167], v[188:191], v[60:63]
    v_fma_f32 v25, -v89, v129, v25
    v_mfma_f32_16x16x32_bf16 v[64:67], v[160:163], v[192:195], v[64:67]
    v_fma_f32 v29, -v93, v129, v29
    v_mfma_f32_16x16x32_bf16 v[68:71], v[164:167], v[192:195], v[68:71]
    v_fma_f32 v33, -v89, v130, v33
    v_mfma_f32_16x16x32_bf16 v[72:75], v[160:163], v[196:199], v[72:75]
    v_fma_f32 v37, -v93, v130, v37
    v_mfma_f32_16x16x32_bf16 v[76:79], v[164:167], v[196:199], v[76:79]
    v_fma_f32 v41, -v89, v131, v41
    v_mfma_f32_16x16x32_bf16 v[80:83], v[160:163], v[200:203], v[80:83]
    v_fma_f32 v45, -v93, v131, v45
    v_mfma_f32_16x16x32_bf16 v[84:87], v[164:167], v[200:203], v[84:87]
    v_fma_f32 v49, -v89, v132, v49
    s_waitcnt lgkmcnt(0)
    s_barrier
    v_mfma_f32_16x16x32_bf16 v[16:19], v[204:207], v[212:215], v[16:19]
    ds_read_b128 v[160:163], v3 offset:0
    v_fma_f32 v54, -v94, v132, v54
    v_mfma_f32_16x16x32_bf16 v[20:23], v[208:211], v[212:215], v[20:23]
    ds_read_b128 v[164:167], v3 offset:2048
    v_fma_f32 v58, -v90, v133, v58
    v_mfma_f32_16x16x32_bf16 v[24:27], v[204:207], v[216:219], v[24:27]
    ds_read_b128 v[168:171], v1 offset:0
    v_fma_f32 v62, -v94, v133, v62
    v_mfma_f32_16x16x32_bf16 v[28:31], v[208:211], v[216:219], v[28:31]
    ds_read_b128 v[172:175], v1 offset:1024
    v_fma_f32 v66, -v90, v134, v66
    v_mfma_f32_16x16x32_bf16 v[32:35], v[204:207], v[220:223], v[32:35]
    ds_read_b128 v[176:179], v1 offset:2048
    v_fma_f32 v70, -v94, v134, v70
    v_mfma_f32_16x16x32_bf16 v[36:39], v[208:211], v[220:223], v[36:39]
    ds_read_b128 v[180:183], v1 offset:3072
    v_fma_f32 v74, -v90, v135, v74
    v_mfma_f32_16x16x32_bf16 v[40:43], v[204:207], v[224:227], v[40:43]
    ds_read_b128 v[184:187], v1 offset:4096
    v_fma_f32 v78, -v94, v135, v78
    v_mfma_f32_16x16x32_bf16 v[44:47], v[208:211], v[224:227], v[44:47]
    ds_read_b128 v[188:191], v1 offset:5120
    v_fma_f32 v82, -v90, v136, v82
    v_mfma_f32_16x16x32_bf16 v[48:51], v[204:207], v[228:231], v[48:51]
    ds_read_b128 v[192:195], v1 offset:6144
    v_fma_f32 v86, -v94, v136, v86
    v_mfma_f32_16x16x32_bf16 v[52:55], v[208:211], v[228:231], v[52:55]
    ds_read_b128 v[196:199], v1 offset:7168
    v_fma_f32 v18, -v90, v128, v18
    v_mfma_f32_16x16x32_bf16 v[56:59], v[204:207], v[232:235], v[56:59]
    ds_read_b128 v[200:203], v1 offset:8192
    v_fma_f32 v22, -v94, v128, v22
    v_mfma_f32_16x16x32_bf16 v[60:63], v[208:211], v[232:235], v[60:63]
    v_fma_f32 v26, -v90, v129, v26
    v_mfma_f32_16x16x32_bf16 v[64:67], v[204:207], v[236:239], v[64:67]
    v_fma_f32 v30, -v94, v129, v30
    v_mfma_f32_16x16x32_bf16 v[68:71], v[208:211], v[236:239], v[68:71]
    v_fma_f32 v34, -v90, v130, v34
    v_mfma_f32_16x16x32_bf16 v[72:75], v[204:207], v[240:243], v[72:75]
    v_fma_f32 v38, -v94, v130, v38
    v_mfma_f32_16x16x32_bf16 v[76:79], v[208:211], v[240:243], v[76:79]
    v_fma_f32 v42, -v90, v131, v42
    v_mfma_f32_16x16x32_bf16 v[80:83], v[204:207], v[244:247], v[80:83]
    v_fma_f32 v46, -v94, v131, v46
    v_mfma_f32_16x16x32_bf16 v[84:87], v[208:211], v[244:247], v[84:87]
    v_fma_f32 v50, -v90, v132, v50
    s_waitcnt lgkmcnt(5)
    v_mfma_f32_16x16x32_bf16 v[16:19], v[160:163], v[168:171], v[16:19]
    ds_read_b128 v[204:207], v3 offset:1024
    v_fma_f32 v55, -v95, v132, v55
    v_mfma_f32_16x16x32_bf16 v[20:23], v[164:167], v[168:171], v[20:23]
    ds_read_b128 v[208:211], v3 offset:3072
    v_fma_f32 v59, -v91, v133, v59
    v_mfma_f32_16x16x32_bf16 v[24:27], v[160:163], v[172:175], v[24:27]
    ds_read_b128 v[212:215], v1 offset:9216
    v_fma_f32 v63, -v95, v133, v63
    v_mfma_f32_16x16x32_bf16 v[28:31], v[164:167], v[172:175], v[28:31]
    ds_read_b128 v[216:219], v1 offset:10240
    v_fma_f32 v67, -v91, v134, v67
    v_mfma_f32_16x16x32_bf16 v[32:35], v[160:163], v[176:179], v[32:35]
    ds_read_b128 v[220:223], v1 offset:11264
    v_fma_f32 v71, -v95, v134, v71
    v_mfma_f32_16x16x32_bf16 v[36:39], v[164:167], v[176:179], v[36:39]
    ds_read_b128 v[224:227], v1 offset:12288
    v_fma_f32 v75, -v91, v135, v75
    v_mfma_f32_16x16x32_bf16 v[40:43], v[160:163], v[180:183], v[40:43]
    ds_read_b128 v[228:231], v1 offset:13312
    v_fma_f32 v79, -v95, v135, v79
    v_mfma_f32_16x16x32_bf16 v[44:47], v[164:167], v[180:183], v[44:47]
    ds_read_b128 v[232:235], v1 offset:14336
    s_waitcnt lgkmcnt(8)
    v_fma_f32 v83, -v91, v136, v83
    v_mfma_f32_16x16x32_bf16 v[48:51], v[160:163], v[184:187], v[48:51]
    ds_read_b128 v[236:239], v1 offset:15360
    v_fma_f32 v87, -v95, v136, v87
    v_mfma_f32_16x16x32_bf16 v[52:55], v[164:167], v[184:187], v[52:55]
    ds_read_b128 v[240:243], v1 offset:16384
    v_fma_f32 v19, -v91, v128, v19
    v_mfma_f32_16x16x32_bf16 v[56:59], v[160:163], v[188:191], v[56:59]
    ds_read_b128 v[244:247], v1 offset:17408
    v_fma_f32 v23, -v95, v128, v23
    v_mfma_f32_16x16x32_bf16 v[60:63], v[164:167], v[188:191], v[60:63]
    v_fma_f32 v27, -v91, v129, v27
    v_mfma_f32_16x16x32_bf16 v[64:67], v[160:163], v[192:195], v[64:67]
    v_fma_f32 v31, -v95, v129, v31
    v_mfma_f32_16x16x32_bf16 v[68:71], v[164:167], v[192:195], v[68:71]
    v_fma_f32 v35, -v91, v130, v35
    v_mfma_f32_16x16x32_bf16 v[72:75], v[160:163], v[196:199], v[72:75]
    v_fma_f32 v39, -v95, v130, v39
    v_mfma_f32_16x16x32_bf16 v[76:79], v[164:167], v[196:199], v[76:79]
    v_fma_f32 v43, -v91, v131, v43
    v_mfma_f32_16x16x32_bf16 v[80:83], v[160:163], v[200:203], v[80:83]
    v_fma_f32 v47, -v95, v131, v47
    v_mfma_f32_16x16x32_bf16 v[84:87], v[164:167], v[200:203], v[84:87]
    v_fma_f32 v51, -v91, v132, v51
    s_waitcnt lgkmcnt(0)
    s_barrier
    v_mfma_f32_16x16x32_bf16 v[16:19], v[204:207], v[212:215], v[16:19]
    ds_read_b128 v[160:163], v3 offset:36864
    v_mfma_f32_16x16x32_bf16 v[20:23], v[208:211], v[212:215], v[20:23]
    ds_read_b128 v[164:167], v3 offset:38912
    v_mfma_f32_16x16x32_bf16 v[24:27], v[204:207], v[216:219], v[24:27]
    ds_read_b128 v[168:171], v1 offset:36864
    v_mfma_f32_16x16x32_bf16 v[28:31], v[208:211], v[216:219], v[28:31]
    ds_read_b128 v[172:175], v1 offset:37888
    v_mfma_f32_16x16x32_bf16 v[32:35], v[204:207], v[220:223], v[32:35]
    ds_read_b128 v[176:179], v1 offset:38912
    v_mfma_f32_16x16x32_bf16 v[36:39], v[208:211], v[220:223], v[36:39]
    ds_read_b128 v[180:183], v1 offset:39936
    v_mfma_f32_16x16x32_bf16 v[40:43], v[204:207], v[224:227], v[40:43]
    ds_read_b128 v[184:187], v1 offset:40960
    v_mfma_f32_16x16x32_bf16 v[44:47], v[208:211], v[224:227], v[44:47]
    ds_read_b128 v[188:191], v1 offset:41984
    v_mfma_f32_16x16x32_bf16 v[48:51], v[204:207], v[228:231], v[48:51]
    ds_read_b128 v[192:195], v1 offset:43008
    v_mfma_f32_16x16x32_bf16 v[52:55], v[208:211], v[228:231], v[52:55]
    ds_read_b128 v[196:199], v1 offset:44032
    v_mfma_f32_16x16x32_bf16 v[56:59], v[204:207], v[232:235], v[56:59]
    ds_read_b128 v[200:203], v1 offset:45056
    v_mfma_f32_16x16x32_bf16 v[60:63], v[208:211], v[232:235], v[60:63]
    v_mfma_f32_16x16x32_bf16 v[64:67], v[204:207], v[236:239], v[64:67]
    v_mfma_f32_16x16x32_bf16 v[68:71], v[208:211], v[236:239], v[68:71]
    v_mfma_f32_16x16x32_bf16 v[72:75], v[204:207], v[240:243], v[72:75]
    v_mfma_f32_16x16x32_bf16 v[76:79], v[208:211], v[240:243], v[76:79]
    v_mfma_f32_16x16x32_bf16 v[80:83], v[204:207], v[244:247], v[80:83]
    v_mfma_f32_16x16x32_bf16 v[84:87], v[208:211], v[244:247], v[84:87]
    v_pk_mul_f32 v[220:221], v[16:17], v[16:17]
    v_pk_mul_f32 v[222:223], v[18:19], v[18:19]
    v_pk_mul_f32 v[224:225], v[20:21], v[20:21]
    v_pk_mul_f32 v[226:227], v[22:23], v[22:23]
    v_pk_fma_f32 v[220:221], v[220:221], v[112:113], v[104:105]
    v_pk_fma_f32 v[222:223], v[222:223], v[114:115], v[106:107]
    v_pk_fma_f32 v[224:225], v[224:225], v[116:117], v[108:109]
    v_pk_fma_f32 v[226:227], v[226:227], v[118:119], v[110:111]
    v_pk_mul_f32 v[220:221], v[220:221], v[16:17]
    v_pk_mul_f32 v[222:223], v[222:223], v[18:19]
    v_pk_mul_f32 v[224:225], v[224:225], v[20:21]
    v_pk_mul_f32 v[226:227], v[226:227], v[22:23]
    v_exp_f32 v220, v220
    v_exp_f32 v221, v221
    v_exp_f32 v222, v222
    v_exp_f32 v223, v223
    v_exp_f32 v224, v224
    v_exp_f32 v225, v225
    v_exp_f32 v226, v226
    v_exp_f32 v227, v227
    v_pk_fma_f32 v[220:221], v[220:221], v[120:121], v[120:121]
    v_pk_fma_f32 v[222:223], v[222:223], v[122:123], v[122:123]
    v_pk_fma_f32 v[224:225], v[224:225], v[124:125], v[124:125]
    v_pk_fma_f32 v[226:227], v[226:227], v[126:127], v[126:127]
    v_rcp_f32 v220, v220
    v_rcp_f32 v221, v221
    v_rcp_f32 v222, v222
    v_rcp_f32 v223, v223
    v_rcp_f32 v224, v224
    v_rcp_f32 v225, v225
    v_rcp_f32 v226, v226
    v_rcp_f32 v227, v227
    v_pk_mul_f32 v[16:17], v[16:17], v[220:221]
    v_pk_mul_f32 v[18:19], v[18:19], v[222:223]
    v_pk_mul_f32 v[20:21], v[20:21], v[224:225]
    v_pk_mul_f32 v[22:23], v[22:23], v[226:227]
    v_pk_mul_f32 v[206:207], v[16:17], v[16:17]
    v_pk_mul_f32 v[210:211], v[18:19], v[18:19]
    v_pk_mul_f32 v[214:215], v[20:21], v[20:21]
    v_pk_mul_f32 v[218:219], v[22:23], v[22:23]
    v_pk_mul_f32 v[228:229], v[24:25], v[24:25]
    v_pk_mul_f32 v[230:231], v[26:27], v[26:27]
    v_pk_mul_f32 v[232:233], v[28:29], v[28:29]
    v_pk_mul_f32 v[234:235], v[30:31], v[30:31]
    v_pk_fma_f32 v[228:229], v[228:229], v[112:113], v[104:105]
    v_pk_fma_f32 v[230:231], v[230:231], v[114:115], v[106:107]
    v_pk_fma_f32 v[232:233], v[232:233], v[116:117], v[108:109]
    v_pk_fma_f32 v[234:235], v[234:235], v[118:119], v[110:111]
    v_pk_mul_f32 v[228:229], v[228:229], v[24:25]
    v_pk_mul_f32 v[230:231], v[230:231], v[26:27]
    v_pk_mul_f32 v[232:233], v[232:233], v[28:29]
    v_pk_mul_f32 v[234:235], v[234:235], v[30:31]
    v_exp_f32 v228, v228
    v_exp_f32 v229, v229
    v_exp_f32 v230, v230
    v_exp_f32 v231, v231
    v_exp_f32 v232, v232
    v_exp_f32 v233, v233
    v_exp_f32 v234, v234
    v_exp_f32 v235, v235
    v_pk_fma_f32 v[228:229], v[228:229], v[120:121], v[120:121]
    v_pk_fma_f32 v[230:231], v[230:231], v[122:123], v[122:123]
    v_pk_fma_f32 v[232:233], v[232:233], v[124:125], v[124:125]
    v_pk_fma_f32 v[234:235], v[234:235], v[126:127], v[126:127]
    v_rcp_f32 v228, v228
    v_rcp_f32 v229, v229
    v_rcp_f32 v230, v230
    v_rcp_f32 v231, v231
    v_rcp_f32 v232, v232
    v_rcp_f32 v233, v233
    v_rcp_f32 v234, v234
    v_rcp_f32 v235, v235
    v_pk_mul_f32 v[24:25], v[24:25], v[228:229]
    v_pk_mul_f32 v[26:27], v[26:27], v[230:231]
    v_pk_mul_f32 v[28:29], v[28:29], v[232:233]
    v_pk_mul_f32 v[30:31], v[30:31], v[234:235]
    v_pk_add_f32 v[204:205], v[16:17], v[24:25]
    v_pk_fma_f32 v[206:207], v[24:25], v[24:25], v[206:207]
    v_pk_add_f32 v[208:209], v[18:19], v[26:27]
    v_pk_fma_f32 v[210:211], v[26:27], v[26:27], v[210:211]
    v_pk_add_f32 v[212:213], v[20:21], v[28:29]
    v_pk_fma_f32 v[214:215], v[28:29], v[28:29], v[214:215]
    v_pk_add_f32 v[216:217], v[22:23], v[30:31]
    v_pk_fma_f32 v[218:219], v[30:31], v[30:31], v[218:219]
    v_pk_mul_f32 v[220:221], v[32:33], v[32:33]
    v_pk_mul_f32 v[222:223], v[34:35], v[34:35]
    v_pk_mul_f32 v[224:225], v[36:37], v[36:37]
    v_pk_mul_f32 v[226:227], v[38:39], v[38:39]
    v_pk_fma_f32 v[220:221], v[220:221], v[112:113], v[104:105]
    v_pk_fma_f32 v[222:223], v[222:223], v[114:115], v[106:107]
    v_pk_fma_f32 v[224:225], v[224:225], v[116:117], v[108:109]
    v_pk_fma_f32 v[226:227], v[226:227], v[118:119], v[110:111]
    v_pk_mul_f32 v[220:221], v[220:221], v[32:33]
    v_pk_mul_f32 v[222:223], v[222:223], v[34:35]
    v_pk_mul_f32 v[224:225], v[224:225], v[36:37]
    v_pk_mul_f32 v[226:227], v[226:227], v[38:39]
    v_exp_f32 v220, v220
    v_exp_f32 v221, v221
    v_exp_f32 v222, v222
    v_exp_f32 v223, v223
    v_exp_f32 v224, v224
    v_exp_f32 v225, v225
    v_exp_f32 v226, v226
    v_exp_f32 v227, v227
    v_pk_fma_f32 v[220:221], v[220:221], v[120:121], v[120:121]
    v_pk_fma_f32 v[222:223], v[222:223], v[122:123], v[122:123]
    v_pk_fma_f32 v[224:225], v[224:225], v[124:125], v[124:125]
    v_pk_fma_f32 v[226:227], v[226:227], v[126:127], v[126:127]
    v_rcp_f32 v220, v220
    v_rcp_f32 v221, v221
    v_rcp_f32 v222, v222
    v_rcp_f32 v223, v223
    v_rcp_f32 v224, v224
    v_rcp_f32 v225, v225
    v_rcp_f32 v226, v226
    v_rcp_f32 v227, v227
    v_pk_mul_f32 v[32:33], v[32:33], v[220:221]
    v_pk_mul_f32 v[34:35], v[34:35], v[222:223]
    v_pk_mul_f32 v[36:37], v[36:37], v[224:225]
    v_pk_mul_f32 v[38:39], v[38:39], v[226:227]
    v_pk_add_f32 v[204:205], v[204:205], v[32:33]
    v_pk_fma_f32 v[206:207], v[32:33], v[32:33], v[206:207]
    v_pk_add_f32 v[208:209], v[208:209], v[34:35]
    v_pk_fma_f32 v[210:211], v[34:35], v[34:35], v[210:211]
    v_pk_add_f32 v[212:213], v[212:213], v[36:37]
    v_pk_fma_f32 v[214:215], v[36:37], v[36:37], v[214:215]
    v_pk_add_f32 v[216:217], v[216:217], v[38:39]
    v_pk_fma_f32 v[218:219], v[38:39], v[38:39], v[218:219]
    v_pk_mul_f32 v[228:229], v[40:41], v[40:41]
    v_pk_mul_f32 v[230:231], v[42:43], v[42:43]
    v_pk_mul_f32 v[232:233], v[44:45], v[44:45]
    v_pk_mul_f32 v[234:235], v[46:47], v[46:47]
    v_pk_fma_f32 v[228:229], v[228:229], v[112:113], v[104:105]
    v_pk_fma_f32 v[230:231], v[230:231], v[114:115], v[106:107]
    v_pk_fma_f32 v[232:233], v[232:233], v[116:117], v[108:109]
    v_pk_fma_f32 v[234:235], v[234:235], v[118:119], v[110:111]
    v_pk_mul_f32 v[228:229], v[228:229], v[40:41]
    v_pk_mul_f32 v[230:231], v[230:231], v[42:43]
    v_pk_mul_f32 v[232:233], v[232:233], v[44:45]
    v_pk_mul_f32 v[234:235], v[234:235], v[46:47]
    v_exp_f32 v228, v228
    v_exp_f32 v229, v229
    v_exp_f32 v230, v230
    v_exp_f32 v231, v231
    v_exp_f32 v232, v232
    v_exp_f32 v233, v233
    v_exp_f32 v234, v234
    v_exp_f32 v235, v235
    v_pk_fma_f32 v[228:229], v[228:229], v[120:121], v[120:121]
    v_pk_fma_f32 v[230:231], v[230:231], v[122:123], v[122:123]
    v_pk_fma_f32 v[232:233], v[232:233], v[124:125], v[124:125]
    v_pk_fma_f32 v[234:235], v[234:235], v[126:127], v[126:127]
    v_rcp_f32 v228, v228
    v_rcp_f32 v229, v229
    v_rcp_f32 v230, v230
    v_rcp_f32 v231, v231
    v_rcp_f32 v232, v232
    v_rcp_f32 v233, v233
    v_rcp_f32 v234, v234
    v_rcp_f32 v235, v235
    v_pk_mul_f32 v[40:41], v[40:41], v[228:229]
    v_pk_mul_f32 v[42:43], v[42:43], v[230:231]
    v_pk_mul_f32 v[44:45], v[44:45], v[232:233]
    v_pk_mul_f32 v[46:47], v[46:47], v[234:235]
    v_pk_add_f32 v[204:205], v[204:205], v[40:41]
    v_pk_fma_f32 v[206:207], v[40:41], v[40:41], v[206:207]
    v_pk_add_f32 v[208:209], v[208:209], v[42:43]
    v_pk_fma_f32 v[210:211], v[42:43], v[42:43], v[210:211]
    v_pk_add_f32 v[212:213], v[212:213], v[44:45]
    v_pk_fma_f32 v[214:215], v[44:45], v[44:45], v[214:215]
    v_pk_add_f32 v[216:217], v[216:217], v[46:47]
    v_pk_fma_f32 v[218:219], v[46:47], v[46:47], v[218:219]
    v_pk_mul_f32 v[220:221], v[48:49], v[48:49]
    v_pk_mul_f32 v[222:223], v[50:51], v[50:51]
    v_pk_mul_f32 v[224:225], v[52:53], v[52:53]
    v_pk_mul_f32 v[226:227], v[54:55], v[54:55]
    v_pk_fma_f32 v[220:221], v[220:221], v[112:113], v[104:105]
    v_pk_fma_f32 v[222:223], v[222:223], v[114:115], v[106:107]
    v_pk_fma_f32 v[224:225], v[224:225], v[116:117], v[108:109]
    v_pk_fma_f32 v[226:227], v[226:227], v[118:119], v[110:111]
    v_pk_mul_f32 v[220:221], v[220:221], v[48:49]
    v_pk_mul_f32 v[222:223], v[222:223], v[50:51]
    v_pk_mul_f32 v[224:225], v[224:225], v[52:53]
    v_pk_mul_f32 v[226:227], v[226:227], v[54:55]
    v_exp_f32 v220, v220
    v_exp_f32 v221, v221
    v_exp_f32 v222, v222
    v_exp_f32 v223, v223
    v_exp_f32 v224, v224
    v_exp_f32 v225, v225
    v_exp_f32 v226, v226
    v_exp_f32 v227, v227
    v_pk_fma_f32 v[220:221], v[220:221], v[120:121], v[120:121]
    v_pk_fma_f32 v[222:223], v[222:223], v[122:123], v[122:123]
    v_pk_fma_f32 v[224:225], v[224:225], v[124:125], v[124:125]
    v_pk_fma_f32 v[226:227], v[226:227], v[126:127], v[126:127]
    v_rcp_f32 v220, v220
    v_rcp_f32 v221, v221
    v_rcp_f32 v222, v222
    v_rcp_f32 v223, v223
    v_rcp_f32 v224, v224
    v_rcp_f32 v225, v225
    v_rcp_f32 v226, v226
    v_rcp_f32 v227, v227
    v_pk_mul_f32 v[48:49], v[48:49], v[220:221]
    v_pk_mul_f32 v[50:51], v[50:51], v[222:223]
    v_pk_mul_f32 v[52:53], v[52:53], v[224:225]
    v_pk_mul_f32 v[54:55], v[54:55], v[226:227]
    v_pk_add_f32 v[204:205], v[204:205], v[48:49]
    v_pk_fma_f32 v[206:207], v[48:49], v[48:49], v[206:207]
    v_pk_add_f32 v[208:209], v[208:209], v[50:51]
    v_pk_fma_f32 v[210:211], v[50:51], v[50:51], v[210:211]
    v_pk_add_f32 v[212:213], v[212:213], v[52:53]
    v_pk_fma_f32 v[214:215], v[52:53], v[52:53], v[214:215]
    v_pk_add_f32 v[216:217], v[216:217], v[54:55]
    v_pk_fma_f32 v[218:219], v[54:55], v[54:55], v[218:219]
    v_pk_mul_f32 v[228:229], v[56:57], v[56:57]
    v_pk_mul_f32 v[230:231], v[58:59], v[58:59]
    v_pk_mul_f32 v[232:233], v[60:61], v[60:61]
    v_pk_mul_f32 v[234:235], v[62:63], v[62:63]
    v_pk_fma_f32 v[228:229], v[228:229], v[112:113], v[104:105]
    v_pk_fma_f32 v[230:231], v[230:231], v[114:115], v[106:107]
    v_pk_fma_f32 v[232:233], v[232:233], v[116:117], v[108:109]
    v_pk_fma_f32 v[234:235], v[234:235], v[118:119], v[110:111]
    v_pk_mul_f32 v[228:229], v[228:229], v[56:57]
    v_pk_mul_f32 v[230:231], v[230:231], v[58:59]
    v_pk_mul_f32 v[232:233], v[232:233], v[60:61]
    v_pk_mul_f32 v[234:235], v[234:235], v[62:63]
    v_exp_f32 v228, v228
    v_exp_f32 v229, v229
    v_exp_f32 v230, v230
    v_exp_f32 v231, v231
    v_exp_f32 v232, v232
    v_exp_f32 v233, v233
    v_exp_f32 v234, v234
    v_exp_f32 v235, v235
    v_pk_fma_f32 v[228:229], v[228:229], v[120:121], v[120:121]
    v_pk_fma_f32 v[230:231], v[230:231], v[122:123], v[122:123]
    v_pk_fma_f32 v[232:233], v[232:233], v[124:125], v[124:125]
    v_pk_fma_f32 v[234:235], v[234:235], v[126:127], v[126:127]
    v_rcp_f32 v228, v228
    v_rcp_f32 v229, v229
    v_rcp_f32 v230, v230
    v_rcp_f32 v231, v231
    v_rcp_f32 v232, v232
    v_rcp_f32 v233, v233
    v_rcp_f32 v234, v234
    v_rcp_f32 v235, v235
    v_pk_mul_f32 v[56:57], v[56:57], v[228:229]
    v_pk_mul_f32 v[58:59], v[58:59], v[230:231]
    v_pk_mul_f32 v[60:61], v[60:61], v[232:233]
    v_pk_mul_f32 v[62:63], v[62:63], v[234:235]
    v_pk_add_f32 v[204:205], v[204:205], v[56:57]
    v_pk_fma_f32 v[206:207], v[56:57], v[56:57], v[206:207]
    v_pk_add_f32 v[208:209], v[208:209], v[58:59]
    v_pk_fma_f32 v[210:211], v[58:59], v[58:59], v[210:211]
    v_pk_add_f32 v[212:213], v[212:213], v[60:61]
    v_pk_fma_f32 v[214:215], v[60:61], v[60:61], v[214:215]
    v_pk_add_f32 v[216:217], v[216:217], v[62:63]
    v_pk_fma_f32 v[218:219], v[62:63], v[62:63], v[218:219]
    v_pk_mul_f32 v[220:221], v[64:65], v[64:65]
    v_pk_mul_f32 v[222:223], v[66:67], v[66:67]
    v_pk_mul_f32 v[224:225], v[68:69], v[68:69]
    v_pk_mul_f32 v[226:227], v[70:71], v[70:71]
    v_pk_fma_f32 v[220:221], v[220:221], v[112:113], v[104:105]
    v_pk_fma_f32 v[222:223], v[222:223], v[114:115], v[106:107]
    v_pk_fma_f32 v[224:225], v[224:225], v[116:117], v[108:109]
    v_pk_fma_f32 v[226:227], v[226:227], v[118:119], v[110:111]
    v_pk_mul_f32 v[220:221], v[220:221], v[64:65]
    v_pk_mul_f32 v[222:223], v[222:223], v[66:67]
    v_pk_mul_f32 v[224:225], v[224:225], v[68:69]
    v_pk_mul_f32 v[226:227], v[226:227], v[70:71]
    v_exp_f32 v220, v220
    v_exp_f32 v221, v221
    v_exp_f32 v222, v222
    v_exp_f32 v223, v223
    v_exp_f32 v224, v224
    v_exp_f32 v225, v225
    v_exp_f32 v226, v226
    v_exp_f32 v227, v227
    v_pk_fma_f32 v[220:221], v[220:221], v[120:121], v[120:121]
    v_pk_fma_f32 v[222:223], v[222:223], v[122:123], v[122:123]
    v_pk_fma_f32 v[224:225], v[224:225], v[124:125], v[124:125]
    v_pk_fma_f32 v[226:227], v[226:227], v[126:127], v[126:127]
    v_rcp_f32 v220, v220
    v_rcp_f32 v221, v221
    v_rcp_f32 v222, v222
    v_rcp_f32 v223, v223
    v_rcp_f32 v224, v224
    v_rcp_f32 v225, v225
    v_rcp_f32 v226, v226
    v_rcp_f32 v227, v227
    v_pk_mul_f32 v[64:65], v[64:65], v[220:221]
    v_pk_mul_f32 v[66:67], v[66:67], v[222:223]
    v_pk_mul_f32 v[68:69], v[68:69], v[224:225]
    v_pk_mul_f32 v[70:71], v[70:71], v[226:227]
    v_pk_add_f32 v[204:205], v[204:205], v[64:65]
    v_pk_fma_f32 v[206:207], v[64:65], v[64:65], v[206:207]
    v_pk_add_f32 v[208:209], v[208:209], v[66:67]
    v_pk_fma_f32 v[210:211], v[66:67], v[66:67], v[210:211]
    v_pk_add_f32 v[212:213], v[212:213], v[68:69]
    v_pk_fma_f32 v[214:215], v[68:69], v[68:69], v[214:215]
    v_pk_add_f32 v[216:217], v[216:217], v[70:71]
    v_pk_fma_f32 v[218:219], v[70:71], v[70:71], v[218:219]
    v_pk_mul_f32 v[228:229], v[72:73], v[72:73]
    v_pk_mul_f32 v[230:231], v[74:75], v[74:75]
    v_pk_mul_f32 v[232:233], v[76:77], v[76:77]
    v_pk_mul_f32 v[234:235], v[78:79], v[78:79]
    v_pk_fma_f32 v[228:229], v[228:229], v[112:113], v[104:105]
    v_pk_fma_f32 v[230:231], v[230:231], v[114:115], v[106:107]
    v_pk_fma_f32 v[232:233], v[232:233], v[116:117], v[108:109]
    v_pk_fma_f32 v[234:235], v[234:235], v[118:119], v[110:111]
    v_pk_mul_f32 v[228:229], v[228:229], v[72:73]
    v_pk_mul_f32 v[230:231], v[230:231], v[74:75]
    v_pk_mul_f32 v[232:233], v[232:233], v[76:77]
    v_pk_mul_f32 v[234:235], v[234:235], v[78:79]
    v_exp_f32 v228, v228
    v_exp_f32 v229, v229
    v_exp_f32 v230, v230
    v_exp_f32 v231, v231
    v_exp_f32 v232, v232
    v_exp_f32 v233, v233
    v_exp_f32 v234, v234
    v_exp_f32 v235, v235
    v_pk_fma_f32 v[228:229], v[228:229], v[120:121], v[120:121]
    v_pk_fma_f32 v[230:231], v[230:231], v[122:123], v[122:123]
    v_pk_fma_f32 v[232:233], v[232:233], v[124:125], v[124:125]
    v_pk_fma_f32 v[234:235], v[234:235], v[126:127], v[126:127]
    v_rcp_f32 v228, v228
    v_rcp_f32 v229, v229
    v_rcp_f32 v230, v230
    v_rcp_f32 v231, v231
    v_rcp_f32 v232, v232
    v_rcp_f32 v233, v233
    v_rcp_f32 v234, v234
    v_rcp_f32 v235, v235
    v_pk_mul_f32 v[72:73], v[72:73], v[228:229]
    v_pk_mul_f32 v[74:75], v[74:75], v[230:231]
    v_pk_mul_f32 v[76:77], v[76:77], v[232:233]
    v_pk_mul_f32 v[78:79], v[78:79], v[234:235]
    v_pk_add_f32 v[204:205], v[204:205], v[72:73]
    v_pk_fma_f32 v[206:207], v[72:73], v[72:73], v[206:207]
    v_pk_add_f32 v[208:209], v[208:209], v[74:75]
    v_pk_fma_f32 v[210:211], v[74:75], v[74:75], v[210:211]
    v_pk_add_f32 v[212:213], v[212:213], v[76:77]
    v_pk_fma_f32 v[214:215], v[76:77], v[76:77], v[214:215]
    v_pk_add_f32 v[216:217], v[216:217], v[78:79]
    v_pk_fma_f32 v[218:219], v[78:79], v[78:79], v[218:219]
    v_pk_mul_f32 v[220:221], v[80:81], v[80:81]
    v_pk_mul_f32 v[222:223], v[82:83], v[82:83]
    v_pk_mul_f32 v[224:225], v[84:85], v[84:85]
    v_pk_mul_f32 v[226:227], v[86:87], v[86:87]
    v_pk_fma_f32 v[220:221], v[220:221], v[112:113], v[104:105]
    v_pk_fma_f32 v[222:223], v[222:223], v[114:115], v[106:107]
    v_pk_fma_f32 v[224:225], v[224:225], v[116:117], v[108:109]
    v_pk_fma_f32 v[226:227], v[226:227], v[118:119], v[110:111]
    v_pk_mul_f32 v[220:221], v[220:221], v[80:81]
    v_pk_mul_f32 v[222:223], v[222:223], v[82:83]
    v_pk_mul_f32 v[224:225], v[224:225], v[84:85]
    v_pk_mul_f32 v[226:227], v[226:227], v[86:87]
    v_exp_f32 v220, v220
    v_exp_f32 v221, v221
    v_exp_f32 v222, v222
    v_exp_f32 v223, v223
    v_exp_f32 v224, v224
    v_exp_f32 v225, v225
    v_exp_f32 v226, v226
    v_exp_f32 v227, v227
    v_pk_fma_f32 v[220:221], v[220:221], v[120:121], v[120:121]
    v_pk_fma_f32 v[222:223], v[222:223], v[122:123], v[122:123]
    v_pk_fma_f32 v[224:225], v[224:225], v[124:125], v[124:125]
    v_pk_fma_f32 v[226:227], v[226:227], v[126:127], v[126:127]
    v_rcp_f32 v220, v220
    v_rcp_f32 v221, v221
    v_rcp_f32 v222, v222
    v_rcp_f32 v223, v223
    v_rcp_f32 v224, v224
    v_rcp_f32 v225, v225
    v_rcp_f32 v226, v226
    v_rcp_f32 v227, v227
    v_pk_mul_f32 v[80:81], v[80:81], v[220:221]
    v_pk_mul_f32 v[82:83], v[82:83], v[222:223]
    v_pk_mul_f32 v[84:85], v[84:85], v[224:225]
    v_pk_mul_f32 v[86:87], v[86:87], v[226:227]
    v_pk_add_f32 v[204:205], v[204:205], v[80:81]
    v_pk_fma_f32 v[206:207], v[80:81], v[80:81], v[206:207]
    v_pk_add_f32 v[208:209], v[208:209], v[82:83]
    v_pk_fma_f32 v[210:211], v[82:83], v[82:83], v[210:211]
    v_pk_add_f32 v[212:213], v[212:213], v[84:85]
    v_pk_fma_f32 v[214:215], v[84:85], v[84:85], v[214:215]
    v_pk_add_f32 v[216:217], v[216:217], v[86:87]
    v_pk_fma_f32 v[218:219], v[86:87], v[86:87], v[218:219]
    v_add_f32_dpp v204, v204, v204 row_mirror row_mask:0xf bank_mask:0x3
    v_add_f32_dpp v205, v205, v205 row_mirror row_mask:0xf bank_mask:0x3
    v_add_f32_dpp v206, v206, v206 row_mirror row_mask:0xf bank_mask:0x3
    v_add_f32_dpp v207, v207, v207 row_mirror row_mask:0xf bank_mask:0x3
    v_add_f32_dpp v208, v208, v208 row_mirror row_mask:0xf bank_mask:0x3
    v_add_f32_dpp v209, v209, v209 row_mirror row_mask:0xf bank_mask:0x3
    v_add_f32_dpp v210, v210, v210 row_mirror row_mask:0xf bank_mask:0x3
    v_add_f32_dpp v211, v211, v211 row_mirror row_mask:0xf bank_mask:0x3
    v_add_f32_dpp v204, v212, v212 row_mirror row_mask:0xf bank_mask:0xc
    v_add_f32_dpp v205, v213, v213 row_mirror row_mask:0xf bank_mask:0xc
    v_add_f32_dpp v206, v214, v214 row_mirror row_mask:0xf bank_mask:0xc
    v_add_f32_dpp v207, v215, v215 row_mirror row_mask:0xf bank_mask:0xc
    v_add_f32_dpp v208, v216, v216 row_mirror row_mask:0xf bank_mask:0xc
    v_add_f32_dpp v209, v217, v217 row_mirror row_mask:0xf bank_mask:0xc
    v_add_f32_dpp v210, v218, v218 row_mirror row_mask:0xf bank_mask:0xc
    v_add_f32_dpp v211, v219, v219 row_mirror row_mask:0xf bank_mask:0xc
    v_add_f32_dpp v204, v204, v204 row_half_mirror row_mask:0xf bank_mask:0x5
    v_add_f32_dpp v205, v205, v205 row_half_mirror row_mask:0xf bank_mask:0x5
    v_add_f32_dpp v206, v206, v206 row_half_mirror row_mask:0xf bank_mask:0x5
    v_add_f32_dpp v207, v207, v207 row_half_mirror row_mask:0xf bank_mask:0x5
    v_add_f32_dpp v204, v208, v208 row_half_mirror row_mask:0xf bank_mask:0xa
    v_add_f32_dpp v205, v209, v209 row_half_mirror row_mask:0xf bank_mask:0xa
    v_add_f32_dpp v206, v210, v210 row_half_mirror row_mask:0xf bank_mask:0xa
    v_add_f32_dpp v207, v211, v211 row_half_mirror row_mask:0xf bank_mask:0xa
    v_add_f32_dpp v204, v204, v204 quad_perm:[1,0,3,2] row_mask:0xf bank_mask:0xf
    v_add_f32_dpp v205, v205, v205 quad_perm:[1,0,3,2] row_mask:0xf bank_mask:0xf
    v_add_f32_dpp v206, v206, v206 quad_perm:[1,0,3,2] row_mask:0xf bank_mask:0xf
    v_add_f32_dpp v207, v207, v207 quad_perm:[1,0,3,2] row_mask:0xf bank_mask:0xf
    v_add_f32_dpp v12, v204, v204 quad_perm:[2,3,0,1] row_mask:0xf bank_mask:0xf
    v_add_f32_dpp v14, v205, v205 quad_perm:[2,3,0,1] row_mask:0xf bank_mask:0xf
    v_add_f32_dpp v13, v206, v206 quad_perm:[2,3,0,1] row_mask:0xf bank_mask:0xf
    v_add_f32_dpp v15, v207, v207 quad_perm:[2,3,0,1] row_mask:0xf bank_mask:0xf
    buffer_store_dwordx4 v[12:15], v8, s[4:7], s36 offen sc1
    s_waitcnt lgkmcnt(5)
    v_mfma_f32_16x16x32_bf16 v[88:91], v[168:171], v[160:163], 0
    ds_read_b128 v[204:207], v3 offset:37888
    v_mfma_f32_16x16x32_bf16 v[92:95], v[168:171], v[164:167], 0
    ds_read_b128 v[208:211], v3 offset:39936
    v_mfma_f32_16x16x32_bf16 v[96:99], v[172:175], v[160:163], 0
    ds_read_b128 v[212:215], v1 offset:46080
    v_mfma_f32_16x16x32_bf16 v[100:103], v[172:175], v[164:167], 0
    ds_read_b128 v[216:219], v1 offset:47104
    v_mfma_f32_16x16x32_bf16 v[104:107], v[176:179], v[160:163], 0
    ds_read_b128 v[220:223], v1 offset:48128
    v_mfma_f32_16x16x32_bf16 v[108:111], v[176:179], v[164:167], 0
    ds_read_b128 v[224:227], v1 offset:49152
    v_mfma_f32_16x16x32_bf16 v[112:115], v[180:183], v[160:163], 0
    ds_read_b128 v[228:231], v1 offset:50176
    v_mfma_f32_16x16x32_bf16 v[116:119], v[180:183], v[164:167], 0
    ds_read_b128 v[232:235], v1 offset:51200
    s_waitcnt lgkmcnt(8)
    v_mfma_f32_16x16x32_bf16 v[120:123], v[184:187], v[160:163], 0
    ds_read_b128 v[236:239], v1 offset:52224
    v_mfma_f32_16x16x32_bf16 v[124:127], v[184:187], v[164:167], 0
    ds_read_b128 v[240:243], v1 offset:53248
    v_mfma_f32_16x16x32_bf16 v[128:131], v[188:191], v[160:163], 0
    ds_read_b128 v[244:247], v1 offset:54272
    v_mfma_f32_16x16x32_bf16 v[132:135], v[188:191], v[164:167], 0
    v_mfma_f32_16x16x32_bf16 v[136:139], v[192:195], v[160:163], 0
    v_lshrrev_b32 v255, 8, v1
    v_mfma_f32_16x16x32_bf16 v[140:143], v[192:195], v[164:167], 0
    v_lshl_add_u32 v255, v255, 6, s33
    v_mfma_f32_16x16x32_bf16 v[144:147], v[196:199], v[160:163], 0
    v_mfma_f32_16x16x32_bf16 v[148:151], v[196:199], v[164:167], 0
    v_mfma_f32_16x16x32_bf16 v[152:155], v[200:203], v[160:163], 0
    v_mfma_f32_16x16x32_bf16 v[156:159], v[200:203], v[164:167], 0
    s_waitcnt lgkmcnt(0)
    s_barrier
    v_mfma_f32_16x16x32_bf16 v[88:91], v[212:215], v[204:207], v[88:91]
    ds_read_b128 v[160:163], v0 offset:0
    v_mfma_f32_16x16x32_bf16 v[92:95], v[212:215], v[208:211], v[92:95]
    ds_read_b128 v[164:167], v0 offset:2048
    v_mfma_f32_16x16x32_bf16 v[96:99], v[216:219], v[204:207], v[96:99]
    ds_read_b128 v[168:171], v2 offset:0
    v_mfma_f32_16x16x32_bf16 v[100:103], v[216:219], v[208:211], v[100:103]
    ds_read_b128 v[172:175], v2 offset:1024
    v_mfma_f32_16x16x32_bf16 v[104:107], v[220:223], v[204:207], v[104:107]
    ds_read_b128 v[176:179], v2 offset:2048
    v_mfma_f32_16x16x32_bf16 v[108:111], v[220:223], v[208:211], v[108:111]
    ds_read_b128 v[180:183], v2 offset:3072
    v_mfma_f32_16x16x32_bf16 v[112:115], v[224:227], v[204:207], v[112:115]
    ds_read_b128 v[184:187], v2 offset:4096
    v_mfma_f32_16x16x32_bf16 v[116:119], v[224:227], v[208:211], v[116:119]
    ds_read_b128 v[188:191], v2 offset:5120
    v_mfma_f32_16x16x32_bf16 v[120:123], v[228:231], v[204:207], v[120:123]
    ds_read_b128 v[192:195], v2 offset:6144
    v_mfma_f32_16x16x32_bf16 v[124:127], v[228:231], v[208:211], v[124:127]
    ds_read_b128 v[196:199], v2 offset:7168
    v_mfma_f32_16x16x32_bf16 v[128:131], v[232:235], v[204:207], v[128:131]
    ds_read_b128 v[200:203], v2 offset:8192
    v_mfma_f32_16x16x32_bf16 v[132:135], v[232:235], v[208:211], v[132:135]
    v_mfma_f32_16x16x32_bf16 v[136:139], v[236:239], v[204:207], v[136:139]
    v_mfma_f32_16x16x32_bf16 v[140:143], v[236:239], v[208:211], v[140:143]
    v_mfma_f32_16x16x32_bf16 v[144:147], v[240:243], v[204:207], v[144:147]
    v_mfma_f32_16x16x32_bf16 v[148:151], v[240:243], v[208:211], v[148:151]
    v_mfma_f32_16x16x32_bf16 v[152:155], v[244:247], v[204:207], v[152:155]
    v_mfma_f32_16x16x32_bf16 v[156:159], v[244:247], v[208:211], v[156:159]
    s_waitcnt lgkmcnt(5)
    v_mfma_f32_16x16x32_bf16 v[88:91], v[168:171], v[160:163], v[88:91]
    ds_read_b128 v[204:207], v0 offset:1024
    v_mfma_f32_16x16x32_bf16 v[92:95], v[168:171], v[164:167], v[92:95]
    ds_read_b128 v[208:211], v0 offset:3072
    v_mfma_f32_16x16x32_bf16 v[96:99], v[172:175], v[160:163], v[96:99]
    ds_read_b128 v[212:215], v2 offset:9216
    v_mfma_f32_16x16x32_bf16 v[100:103], v[172:175], v[164:167], v[100:103]
    ds_read_b128 v[216:219], v2 offset:10240
    v_mfma_f32_16x16x32_bf16 v[104:107], v[176:179], v[160:163], v[104:107]
    ds_read_b128 v[220:223], v2 offset:11264
    v_mfma_f32_16x16x32_bf16 v[108:111], v[176:179], v[164:167], v[108:111]
    ds_read_b128 v[224:227], v2 offset:12288
    v_mfma_f32_16x16x32_bf16 v[112:115], v[180:183], v[160:163], v[112:115]
    ds_read_b128 v[228:231], v2 offset:13312
    v_mfma_f32_16x16x32_bf16 v[116:119], v[180:183], v[164:167], v[116:119]
    ds_read_b128 v[232:235], v2 offset:14336
    s_waitcnt lgkmcnt(8)
    v_mfma_f32_16x16x32_bf16 v[120:123], v[184:187], v[160:163], v[120:123]
    ds_read_b128 v[236:239], v2 offset:15360
    v_mfma_f32_16x16x32_bf16 v[124:127], v[184:187], v[164:167], v[124:127]
    ds_read_b128 v[240:243], v2 offset:16384
    v_mfma_f32_16x16x32_bf16 v[128:131], v[188:191], v[160:163], v[128:131]
    ds_read_b128 v[244:247], v2 offset:17408
    v_mfma_f32_16x16x32_bf16 v[132:135], v[188:191], v[164:167], v[132:135]
    v_mfma_f32_16x16x32_bf16 v[136:139], v[192:195], v[160:163], v[136:139]
    v_mfma_f32_16x16x32_bf16 v[140:143], v[192:195], v[164:167], v[140:143]
    v_mfma_f32_16x16x32_bf16 v[144:147], v[196:199], v[160:163], v[144:147]
    v_mfma_f32_16x16x32_bf16 v[148:151], v[196:199], v[164:167], v[148:151]
    v_mfma_f32_16x16x32_bf16 v[152:155], v[200:203], v[160:163], v[152:155]
    v_mfma_f32_16x16x32_bf16 v[156:159], v[200:203], v[164:167], v[156:159]
    s_waitcnt lgkmcnt(0)
    s_barrier
    v_mfma_f32_16x16x32_bf16 v[88:91], v[212:215], v[204:207], v[88:91]
    ds_read_b128 v[160:163], v0 offset:36864
    v_mfma_f32_16x16x32_bf16 v[92:95], v[212:215], v[208:211], v[92:95]
    ds_read_b128 v[164:167], v0 offset:38912
    v_mfma_f32_16x16x32_bf16 v[96:99], v[216:219], v[204:207], v[96:99]
    ds_read_b128 v[168:171], v2 offset:36864
    v_mfma_f32_16x16x32_bf16 v[100:103], v[216:219], v[208:211], v[100:103]
    ds_read_b128 v[172:175], v2 offset:37888
    v_mfma_f32_16x16x32_bf16 v[104:107], v[220:223], v[204:207], v[104:107]
    ds_read_b128 v[176:179], v2 offset:38912
    v_mfma_f32_16x16x32_bf16 v[108:111], v[220:223], v[208:211], v[108:111]
    ds_read_b128 v[180:183], v2 offset:39936
    v_mfma_f32_16x16x32_bf16 v[112:115], v[224:227], v[204:207], v[112:115]
    ds_read_b128 v[184:187], v2 offset:40960
    v_mfma_f32_16x16x32_bf16 v[116:119], v[224:227], v[208:211], v[116:119]
    ds_read_b128 v[188:191], v2 offset:41984
    v_mfma_f32_16x16x32_bf16 v[120:123], v[228:231], v[204:207], v[120:123]
    ds_read_b128 v[192:195], v2 offset:43008
    v_mfma_f32_16x16x32_bf16 v[124:127], v[228:231], v[208:211], v[124:127]
    ds_read_b128 v[196:199], v2 offset:44032
    v_mfma_f32_16x16x32_bf16 v[128:131], v[232:235], v[204:207], v[128:131]
    ds_read_b128 v[200:203], v2 offset:45056
    v_mfma_f32_16x16x32_bf16 v[132:135], v[232:235], v[208:211], v[132:135]
    v_mfma_f32_16x16x32_bf16 v[136:139], v[236:239], v[204:207], v[136:139]
    v_mfma_f32_16x16x32_bf16 v[140:143], v[236:239], v[208:211], v[140:143]
    v_mfma_f32_16x16x32_bf16 v[144:147], v[240:243], v[204:207], v[144:147]
    v_mfma_f32_16x16x32_bf16 v[148:151], v[240:243], v[208:211], v[148:151]
    v_mfma_f32_16x16x32_bf16 v[152:155], v[244:247], v[204:207], v[152:155]
    v_mfma_f32_16x16x32_bf16 v[156:159], v[244:247], v[208:211], v[156:159]
    s_waitcnt lgkmcnt(5)
    v_mfma_f32_16x16x32_bf16 v[88:91], v[168:171], v[160:163], v[88:91]
    ds_read_b128 v[204:207], v0 offset:37888
    v_mfma_f32_16x16x32_bf16 v[92:95], v[168:171], v[164:167], v[92:95]
    ds_read_b128 v[208:211], v0 offset:39936
    v_mfma_f32_16x16x32_bf16 v[96:99], v[172:175], v[160:163], v[96:99]
    ds_read_b128 v[212:215], v2 offset:46080
    v_mfma_f32_16x16x32_bf16 v[100:103], v[172:175], v[164:167], v[100:103]
    ds_read_b128 v[216:219], v2 offset:47104
    v_mfma_f32_16x16x32_bf16 v[104:107], v[176:179], v[160:163], v[104:107]
    ds_read_b128 v[220:223], v2 offset:48128
    v_mfma_f32_16x16x32_bf16 v[108:111], v[176:179], v[164:167], v[108:111]
    ds_read_b128 v[224:227], v2 offset:49152
    v_mfma_f32_16x16x32_bf16 v[112:115], v[180:183], v[160:163], v[112:115]
    ds_read_b128 v[228:231], v2 offset:50176
    v_mfma_f32_16x16x32_bf16 v[116:119], v[180:183], v[164:167], v[116:119]
    ds_read_b128 v[232:235], v2 offset:51200
    s_waitcnt lgkmcnt(8)
    v_mfma_f32_16x16x32_bf16 v[120:123], v[184:187], v[160:163], v[120:123]
    ds_read_b128 v[236:239], v2 offset:52224
    v_mfma_f32_16x16x32_bf16 v[124:127], v[184:187], v[164:167], v[124:127]
    ds_read_b128 v[240:243], v2 offset:53248
    v_mfma_f32_16x16x32_bf16 v[128:131], v[188:191], v[160:163], v[128:131]
    ds_read_b128 v[244:247], v2 offset:54272
    v_mfma_f32_16x16x32_bf16 v[132:135], v[188:191], v[164:167], v[132:135]
    v_mfma_f32_16x16x32_bf16 v[136:139], v[192:195], v[160:163], v[136:139]
    v_mfma_f32_16x16x32_bf16 v[140:143], v[192:195], v[164:167], v[140:143]
    v_mfma_f32_16x16x32_bf16 v[144:147], v[196:199], v[160:163], v[144:147]
    v_mfma_f32_16x16x32_bf16 v[148:151], v[196:199], v[164:167], v[148:151]
    v_mfma_f32_16x16x32_bf16 v[152:155], v[200:203], v[160:163], v[152:155]
    v_mfma_f32_16x16x32_bf16 v[156:159], v[200:203], v[164:167], v[156:159]
    s_waitcnt lgkmcnt(0)
    s_barrier
    v_mfma_f32_16x16x32_bf16 v[88:91], v[212:215], v[204:207], v[88:91]
    ds_read_b128 v[160:163], v3 offset:0
    v_mfma_f32_16x16x32_bf16 v[92:95], v[212:215], v[208:211], v[92:95]
    ds_read_b128 v[164:167], v3 offset:2048
    v_mfma_f32_16x16x32_bf16 v[96:99], v[216:219], v[204:207], v[96:99]
    ds_read_b128 v[168:171], v1 offset:0
    v_mfma_f32_16x16x32_bf16 v[100:103], v[216:219], v[208:211], v[100:103]
    ds_read_b128 v[172:175], v1 offset:1024
    v_mfma_f32_16x16x32_bf16 v[104:107], v[220:223], v[204:207], v[104:107]
    ds_read_b128 v[176:179], v1 offset:2048
    v_mfma_f32_16x16x32_bf16 v[108:111], v[220:223], v[208:211], v[108:111]
    ds_read_b128 v[180:183], v1 offset:3072
    v_mfma_f32_16x16x32_bf16 v[112:115], v[224:227], v[204:207], v[112:115]
    ds_read_b128 v[184:187], v1 offset:4096
    v_mfma_f32_16x16x32_bf16 v[116:119], v[224:227], v[208:211], v[116:119]
    ds_read_b128 v[188:191], v1 offset:5120
    v_mfma_f32_16x16x32_bf16 v[120:123], v[228:231], v[204:207], v[120:123]
    ds_read_b128 v[192:195], v1 offset:6144
    v_mfma_f32_16x16x32_bf16 v[124:127], v[228:231], v[208:211], v[124:127]
    ds_read_b128 v[196:199], v1 offset:7168
    v_mfma_f32_16x16x32_bf16 v[128:131], v[232:235], v[204:207], v[128:131]
    ds_read_b128 v[200:203], v1 offset:8192
    v_mfma_f32_16x16x32_bf16 v[132:135], v[232:235], v[208:211], v[132:135]
    v_mfma_f32_16x16x32_bf16 v[136:139], v[236:239], v[204:207], v[136:139]
    v_mfma_f32_16x16x32_bf16 v[140:143], v[236:239], v[208:211], v[140:143]
    v_mfma_f32_16x16x32_bf16 v[144:147], v[240:243], v[204:207], v[144:147]
    v_mfma_f32_16x16x32_bf16 v[148:151], v[240:243], v[208:211], v[148:151]
    v_mfma_f32_16x16x32_bf16 v[152:155], v[244:247], v[204:207], v[152:155]
    v_mfma_f32_16x16x32_bf16 v[156:159], v[244:247], v[208:211], v[156:159]
    s_waitcnt lgkmcnt(5)
    v_mfma_f32_16x16x32_bf16 v[88:91], v[168:171], v[160:163], v[88:91]
    ds_read_b128 v[204:207], v3 offset:1024
    v_mfma_f32_16x16x32_bf16 v[92:95], v[168:171], v[164:167], v[92:95]
    ds_read_b128 v[208:211], v3 offset:3072
    v_mfma_f32_16x16x32_bf16 v[96:99], v[172:175], v[160:163], v[96:99]
    ds_read_b128 v[212:215], v1 offset:9216
    v_mfma_f32_16x16x32_bf16 v[100:103], v[172:175], v[164:167], v[100:103]
    ds_read_b128 v[216:219], v1 offset:10240
    v_mfma_f32_16x16x32_bf16 v[104:107], v[176:179], v[160:163], v[104:107]
    ds_read_b128 v[220:223], v1 offset:11264
    v_mfma_f32_16x16x32_bf16 v[108:111], v[176:179], v[164:167], v[108:111]
    ds_read_b128 v[224:227], v1 offset:12288
    v_mfma_f32_16x16x32_bf16 v[112:115], v[180:183], v[160:163], v[112:115]
    ds_read_b128 v[228:231], v1 offset:13312
    v_mfma_f32_16x16x32_bf16 v[116:119], v[180:183], v[164:167], v[116:119]
    ds_read_b128 v[232:235], v1 offset:14336
    s_waitcnt lgkmcnt(8)
    v_mfma_f32_16x16x32_bf16 v[120:123], v[184:187], v[160:163], v[120:123]
    ds_read_b128 v[236:239], v1 offset:15360
    v_mfma_f32_16x16x32_bf16 v[124:127], v[184:187], v[164:167], v[124:127]
    ds_read_b128 v[240:243], v1 offset:16384
    v_mfma_f32_16x16x32_bf16 v[128:131], v[188:191], v[160:163], v[128:131]
    ds_read_b128 v[244:247], v1 offset:17408
    v_mfma_f32_16x16x32_bf16 v[132:135], v[188:191], v[164:167], v[132:135]
    v_mfma_f32_16x16x32_bf16 v[136:139], v[192:195], v[160:163], v[136:139]
    v_mfma_f32_16x16x32_bf16 v[140:143], v[192:195], v[164:167], v[140:143]
    v_mfma_f32_16x16x32_bf16 v[144:147], v[196:199], v[160:163], v[144:147]
    v_mfma_f32_16x16x32_bf16 v[148:151], v[196:199], v[164:167], v[148:151]
    v_mfma_f32_16x16x32_bf16 v[152:155], v[200:203], v[160:163], v[152:155]
    v_mfma_f32_16x16x32_bf16 v[156:159], v[200:203], v[164:167], v[156:159]
    s_waitcnt lgkmcnt(0)
    s_barrier
    v_mfma_f32_16x16x32_bf16 v[88:91], v[212:215], v[204:207], v[88:91]
    ds_read_b128 v[160:163], v3 offset:36864
    v_mfma_f32_16x16x32_bf16 v[92:95], v[212:215], v[208:211], v[92:95]
    ds_read_b128 v[164:167], v3 offset:38912
    v_mfma_f32_16x16x32_bf16 v[96:99], v[216:219], v[204:207], v[96:99]
    ds_read_b128 v[168:171], v1 offset:36864
    v_mfma_f32_16x16x32_bf16 v[100:103], v[216:219], v[208:211], v[100:103]
    ds_read_b128 v[172:175], v1 offset:37888
    v_mfma_f32_16x16x32_bf16 v[104:107], v[220:223], v[204:207], v[104:107]
    ds_read_b128 v[176:179], v1 offset:38912
    v_mfma_f32_16x16x32_bf16 v[108:111], v[220:223], v[208:211], v[108:111]
    ds_read_b128 v[180:183], v1 offset:39936
    v_mfma_f32_16x16x32_bf16 v[112:115], v[224:227], v[204:207], v[112:115]
    ds_read_b128 v[184:187], v1 offset:40960
    v_mfma_f32_16x16x32_bf16 v[116:119], v[224:227], v[208:211], v[116:119]
    ds_read_b128 v[188:191], v1 offset:41984
    v_mfma_f32_16x16x32_bf16 v[120:123], v[228:231], v[204:207], v[120:123]
    ds_read_b128 v[192:195], v1 offset:43008
    v_mfma_f32_16x16x32_bf16 v[124:127], v[228:231], v[208:211], v[124:127]
    ds_read_b128 v[196:199], v1 offset:44032
    v_mfma_f32_16x16x32_bf16 v[128:131], v[232:235], v[204:207], v[128:131]
    ds_read_b128 v[200:203], v1 offset:45056
    v_mfma_f32_16x16x32_bf16 v[132:135], v[232:235], v[208:211], v[132:135]
    ds_read_b128 v[4:7], v255 offset:1024
    v_mfma_f32_16x16x32_bf16 v[136:139], v[236:239], v[204:207], v[136:139]
    ds_read_b128 v[8:11], v255 offset:1040
    v_mfma_f32_16x16x32_bf16 v[140:143], v[236:239], v[208:211], v[140:143]
    ds_read_b128 v[12:15], v255 offset:1056
    v_mfma_f32_16x16x32_bf16 v[144:147], v[240:243], v[204:207], v[144:147]
    ds_read_b128 v[252:255], v255 offset:1072
    v_mfma_f32_16x16x32_bf16 v[148:151], v[240:243], v[208:211], v[148:151]
    v_mfma_f32_16x16x32_bf16 v[152:155], v[244:247], v[204:207], v[152:155]
    v_mfma_f32_16x16x32_bf16 v[156:159], v[244:247], v[208:211], v[156:159]
    s_waitcnt lgkmcnt(9)
    v_mfma_f32_16x16x32_bf16 v[88:91], v[168:171], v[160:163], v[88:91]
    ds_read_b128 v[204:207], v3 offset:37888
    v_mfma_f32_16x16x32_bf16 v[92:95], v[168:171], v[164:167], v[92:95]
    ds_read_b128 v[208:211], v3 offset:39936
    v_mfma_f32_16x16x32_bf16 v[96:99], v[172:175], v[160:163], v[96:99]
    ds_read_b128 v[212:215], v1 offset:46080
    v_mfma_f32_16x16x32_bf16 v[100:103], v[172:175], v[164:167], v[100:103]
    ds_read_b128 v[216:219], v1 offset:47104
    v_mfma_f32_16x16x32_bf16 v[104:107], v[176:179], v[160:163], v[104:107]
    ds_read_b128 v[220:223], v1 offset:48128
    v_mfma_f32_16x16x32_bf16 v[108:111], v[176:179], v[164:167], v[108:111]
    ds_read_b128 v[224:227], v1 offset:49152
    v_mfma_f32_16x16x32_bf16 v[112:115], v[180:183], v[160:163], v[112:115]
    ds_read_b128 v[228:231], v1 offset:50176
    v_mfma_f32_16x16x32_bf16 v[116:119], v[180:183], v[164:167], v[116:119]
    ds_read_b128 v[232:235], v1 offset:51200
    s_waitcnt lgkmcnt(8)
    v_mfma_f32_16x16x32_bf16 v[120:123], v[184:187], v[160:163], v[120:123]
    ds_read_b128 v[236:239], v1 offset:52224
    v_fma_f32 v16, v16, v4, -v6
    v_mfma_f32_16x16x32_bf16 v[124:127], v[184:187], v[164:167], v[124:127]
    ds_read_b128 v[240:243], v1 offset:53248
    v_fma_f32 v17, v17, v5, -v7
    v_mfma_f32_16x16x32_bf16 v[128:131], v[188:191], v[160:163], v[128:131]
    ds_read_b128 v[244:247], v1 offset:54272
    v_fma_f32 v18, v18, v8, -v10
    v_mfma_f32_16x16x32_bf16 v[132:135], v[188:191], v[164:167], v[132:135]
    v_fma_f32 v19, v19, v9, -v11
    v_fma_f32 v20, v20, v12, -v14
    v_mfma_f32_16x16x32_bf16 v[136:139], v[192:195], v[160:163], v[136:139]
    v_fma_f32 v21, v21, v13, -v15
    v_fma_f32 v22, v22, v252, -v254
    v_mfma_f32_16x16x32_bf16 v[140:143], v[192:195], v[164:167], v[140:143]
    v_fma_f32 v23, v23, v253, -v255
    v_cvt_pk_bf16_f32 v16, v16, v17
    v_mfma_f32_16x16x32_bf16 v[144:147], v[196:199], v[160:163], v[144:147]
    v_cvt_pk_bf16_f32 v17, v18, v19
    v_cvt_pk_bf16_f32 v18, v20, v21
    v_mfma_f32_16x16x32_bf16 v[148:151], v[196:199], v[164:167], v[148:151]
    v_cvt_pk_bf16_f32 v19, v22, v23
    v_fma_f32 v24, v24, v4, -v6
    v_mfma_f32_16x16x32_bf16 v[152:155], v[200:203], v[160:163], v[152:155]
    v_fma_f32 v25, v25, v5, -v7
    v_fma_f32 v26, v26, v8, -v10
    v_mfma_f32_16x16x32_bf16 v[156:159], v[200:203], v[164:167], v[156:159]
    v_fma_f32 v27, v27, v9, -v11
    s_waitcnt lgkmcnt(0)
    s_barrier
    v_mfma_f32_16x16x32_bf16 v[88:91], v[212:215], v[204:207], v[88:91]
    ds_read_b128 v[160:163], v0 offset:0
    v_mfma_f32_16x16x32_bf16 v[92:95], v[212:215], v[208:211], v[92:95]
    ds_read_b128 v[164:167], v0 offset:2048
    v_fma_f32 v28, v28, v12, -v14
    v_mfma_f32_16x16x32_bf16 v[96:99], v[216:219], v[204:207], v[96:99]
    ds_read_b128 v[168:171], v2 offset:0
    v_fma_f32 v29, v29, v13, -v15
    v_mfma_f32_16x16x32_bf16 v[100:103], v[216:219], v[208:211], v[100:103]
    ds_read_b128 v[172:175], v2 offset:1024
    v_fma_f32 v30, v30, v252, -v254
    v_mfma_f32_16x16x32_bf16 v[104:107], v[220:223], v[204:207], v[104:107]
    ds_read_b128 v[176:179], v2 offset:2048
    v_fma_f32 v31, v31, v253, -v255
    v_mfma_f32_16x16x32_bf16 v[108:111], v[220:223], v[208:211], v[108:111]
    ds_read_b128 v[180:183], v2 offset:3072
    v_permlane32_swap_b32 v16, v18
    v_mfma_f32_16x16x32_bf16 v[112:115], v[224:227], v[204:207], v[112:115]
    ds_read_b128 v[184:187], v2 offset:4096
    v_permlane32_swap_b32 v17, v19
    v_mfma_f32_16x16x32_bf16 v[116:119], v[224:227], v[208:211], v[116:119]
    ds_read_b128 v[188:191], v2 offset:5120
    v_mfma_f32_16x16x32_bf16 v[120:123], v[228:231], v[204:207], v[120:123]
    ds_read_b128 v[192:195], v2 offset:6144
    v_cvt_pk_bf16_f32 v24, v24, v25
    v_mfma_f32_16x16x32_bf16 v[124:127], v[228:231], v[208:211], v[124:127]
    ds_read_b128 v[196:199], v2 offset:7168
    v_cvt_pk_bf16_f32 v25, v26, v27
    v_mfma_f32_16x16x32_bf16 v[128:131], v[232:235], v[204:207], v[128:131]
    ds_read_b128 v[200:203], v2 offset:8192
    v_cvt_pk_bf16_f32 v26, v28, v29
    v_mfma_f32_16x16x32_bf16 v[132:135], v[232:235], v[208:211], v[132:135]
    v_cvt_pk_bf16_f32 v27, v30, v31
    v_permlane16_swap_b32 v16, v18
    v_mfma_f32_16x16x32_bf16 v[136:139], v[236:239], v[204:207], v[136:139]
    v_permlane16_swap_b32 v17, v19
    buffer_store_dwordx4 v[16:19], v1, s[4:7], s38 offen offset:0 sc1
    v_fma_f32 v32, v32, v4, -v6
    v_mfma_f32_16x16x32_bf16 v[140:143], v[236:239], v[208:211], v[140:143]
    v_fma_f32 v33, v33, v5, -v7
    v_fma_f32 v34, v34, v8, -v10
    v_mfma_f32_16x16x32_bf16 v[144:147], v[240:243], v[204:207], v[144:147]
    v_fma_f32 v35, v35, v9, -v11
    v_fma_f32 v36, v36, v12, -v14
    v_mfma_f32_16x16x32_bf16 v[148:151], v[240:243], v[208:211], v[148:151]
    v_fma_f32 v37, v37, v13, -v15
    v_fma_f32 v38, v38, v252, -v254
    v_mfma_f32_16x16x32_bf16 v[152:155], v[244:247], v[204:207], v[152:155]
    v_fma_f32 v39, v39, v253, -v255
    v_permlane32_swap_b32 v24, v26
    v_mfma_f32_16x16x32_bf16 v[156:159], v[244:247], v[208:211], v[156:159]
    v_permlane32_swap_b32 v25, v27
    s_waitcnt lgkmcnt(5)
    v_mfma_f32_16x16x32_bf16 v[88:91], v[168:171], v[160:163], v[88:91]
    ds_read_b128 v[204:207], v0 offset:1024
    v_mfma_f32_16x16x32_bf16 v[92:95], v[168:171], v[164:167], v[92:95]
    ds_read_b128 v[208:211], v0 offset:3072
    v_cvt_pk_bf16_f32 v32, v32, v33
    v_mfma_f32_16x16x32_bf16 v[96:99], v[172:175], v[160:163], v[96:99]
    ds_read_b128 v[212:215], v2 offset:9216
    v_cvt_pk_bf16_f32 v33, v34, v35
    v_mfma_f32_16x16x32_bf16 v[100:103], v[172:175], v[164:167], v[100:103]
    ds_read_b128 v[216:219], v2 offset:10240
    v_cvt_pk_bf16_f32 v34, v36, v37
    v_mfma_f32_16x16x32_bf16 v[104:107], v[176:179], v[160:163], v[104:107]
    ds_read_b128 v[220:223], v2 offset:11264
    v_cvt_pk_bf16_f32 v35, v38, v39
    v_mfma_f32_16x16x32_bf16 v[108:111], v[176:179], v[164:167], v[108:111]
    ds_read_b128 v[224:227], v2 offset:12288
    v_permlane16_swap_b32 v24, v26
    v_mfma_f32_16x16x32_bf16 v[112:115], v[180:183], v[160:163], v[112:115]
    ds_read_b128 v[228:231], v2 offset:13312
    v_permlane16_swap_b32 v25, v27
    buffer_store_dwordx4 v[24:27], v1, s[4:7], s38 offen offset:1024 sc1
    v_mfma_f32_16x16x32_bf16 v[116:119], v[180:183], v[164:167], v[116:119]
    ds_read_b128 v[232:235], v2 offset:14336
    s_waitcnt lgkmcnt(8)
    v_mfma_f32_16x16x32_bf16 v[120:123], v[184:187], v[160:163], v[120:123]
    ds_read_b128 v[236:239], v2 offset:15360
    v_fma_f32 v40, v40, v4, -v6
    v_mfma_f32_16x16x32_bf16 v[124:127], v[184:187], v[164:167], v[124:127]
    ds_read_b128 v[240:243], v2 offset:16384
    v_fma_f32 v41, v41, v5, -v7
    v_mfma_f32_16x16x32_bf16 v[128:131], v[188:191], v[160:163], v[128:131]
    ds_read_b128 v[244:247], v2 offset:17408
    v_fma_f32 v42, v42, v8, -v10
    v_mfma_f32_16x16x32_bf16 v[132:135], v[188:191], v[164:167], v[132:135]
    v_fma_f32 v43, v43, v9, -v11
    v_fma_f32 v44, v44, v12, -v14
    v_mfma_f32_16x16x32_bf16 v[136:139], v[192:195], v[160:163], v[136:139]
    v_fma_f32 v45, v45, v13, -v15
    v_fma_f32 v46, v46, v252, -v254
    v_mfma_f32_16x16x32_bf16 v[140:143], v[192:195], v[164:167], v[140:143]
    v_fma_f32 v47, v47, v253, -v255
    v_permlane32_swap_b32 v32, v34
    v_mfma_f32_16x16x32_bf16 v[144:147], v[196:199], v[160:163], v[144:147]
    v_permlane32_swap_b32 v33, v35
    v_cvt_pk_bf16_f32 v40, v40, v41
    v_mfma_f32_16x16x32_bf16 v[148:151], v[196:199], v[164:167], v[148:151]
    v_cvt_pk_bf16_f32 v41, v42, v43
    v_cvt_pk_bf16_f32 v42, v44, v45
    v_mfma_f32_16x16x32_bf16 v[152:155], v[200:203], v[160:163], v[152:155]
    v_cvt_pk_bf16_f32 v43, v46, v47
    v_permlane16_swap_b32 v32, v34
    v_mfma_f32_16x16x32_bf16 v[156:159], v[200:203], v[164:167], v[156:159]
    v_permlane16_swap_b32 v33, v35
    buffer_store_dwordx4 v[32:35], v1, s[4:7], s38 offen offset:2048 sc1
    s_waitcnt lgkmcnt(0)
    s_barrier
    v_mfma_f32_16x16x32_bf16 v[88:91], v[212:215], v[204:207], v[88:91]
    ds_read_b128 v[160:163], v0 offset:36864
    v_mfma_f32_16x16x32_bf16 v[92:95], v[212:215], v[208:211], v[92:95]
    ds_read_b128 v[164:167], v0 offset:38912
    v_fma_f32 v48, v48, v4, -v6
    v_mfma_f32_16x16x32_bf16 v[96:99], v[216:219], v[204:207], v[96:99]
    ds_read_b128 v[168:171], v2 offset:36864
    v_fma_f32 v49, v49, v5, -v7
    v_mfma_f32_16x16x32_bf16 v[100:103], v[216:219], v[208:211], v[100:103]
    ds_read_b128 v[172:175], v2 offset:37888
    v_fma_f32 v50, v50, v8, -v10
    v_mfma_f32_16x16x32_bf16 v[104:107], v[220:223], v[204:207], v[104:107]
    ds_read_b128 v[176:179], v2 offset:38912
    v_fma_f32 v51, v51, v9, -v11
    v_mfma_f32_16x16x32_bf16 v[108:111], v[220:223], v[208:211], v[108:111]
    ds_read_b128 v[180:183], v2 offset:39936
    v_fma_f32 v52, v52, v12, -v14
    v_mfma_f32_16x16x32_bf16 v[112:115], v[224:227], v[204:207], v[112:115]
    ds_read_b128 v[184:187], v2 offset:40960
    v_fma_f32 v53, v53, v13, -v15
    v_mfma_f32_16x16x32_bf16 v[116:119], v[224:227], v[208:211], v[116:119]
    ds_read_b128 v[188:191], v2 offset:41984
    v_mfma_f32_16x16x32_bf16 v[120:123], v[228:231], v[204:207], v[120:123]
    ds_read_b128 v[192:195], v2 offset:43008
    v_fma_f32 v54, v54, v252, -v254
    v_mfma_f32_16x16x32_bf16 v[124:127], v[228:231], v[208:211], v[124:127]
    ds_read_b128 v[196:199], v2 offset:44032
    v_fma_f32 v55, v55, v253, -v255
    v_mfma_f32_16x16x32_bf16 v[128:131], v[232:235], v[204:207], v[128:131]
    ds_read_b128 v[200:203], v2 offset:45056
    v_permlane32_swap_b32 v40, v42
    v_mfma_f32_16x16x32_bf16 v[132:135], v[232:235], v[208:211], v[132:135]
    v_permlane32_swap_b32 v41, v43
    v_cvt_pk_bf16_f32 v48, v48, v49
    v_mfma_f32_16x16x32_bf16 v[136:139], v[236:239], v[204:207], v[136:139]
    v_cvt_pk_bf16_f32 v49, v50, v51
    v_cvt_pk_bf16_f32 v50, v52, v53
    v_mfma_f32_16x16x32_bf16 v[140:143], v[236:239], v[208:211], v[140:143]
    v_cvt_pk_bf16_f32 v51, v54, v55
    v_permlane16_swap_b32 v40, v42
    v_mfma_f32_16x16x32_bf16 v[144:147], v[240:243], v[204:207], v[144:147]
    v_permlane16_swap_b32 v41, v43
    buffer_store_dwordx4 v[40:43], v1, s[4:7], s38 offen offset:3072 sc1
    v_fma_f32 v56, v56, v4, -v6
    v_mfma_f32_16x16x32_bf16 v[148:151], v[240:243], v[208:211], v[148:151]
    v_fma_f32 v57, v57, v5, -v7
    v_fma_f32 v58, v58, v8, -v10
    v_mfma_f32_16x16x32_bf16 v[152:155], v[244:247], v[204:207], v[152:155]
    v_fma_f32 v59, v59, v9, -v11
    v_fma_f32 v60, v60, v12, -v14
    v_mfma_f32_16x16x32_bf16 v[156:159], v[244:247], v[208:211], v[156:159]
    v_fma_f32 v61, v61, v13, -v15
    s_waitcnt lgkmcnt(5)
    v_mfma_f32_16x16x32_bf16 v[88:91], v[168:171], v[160:163], v[88:91]
    ds_read_b128 v[204:207], v0 offset:37888
    v_mfma_f32_16x16x32_bf16 v[92:95], v[168:171], v[164:167], v[92:95]
    ds_read_b128 v[208:211], v0 offset:39936
    v_fma_f32 v62, v62, v252, -v254
    v_mfma_f32_16x16x32_bf16 v[96:99], v[172:175], v[160:163], v[96:99]
    ds_read_b128 v[212:215], v2 offset:46080
    v_fma_f32 v63, v63, v253, -v255
    v_mfma_f32_16x16x32_bf16 v[100:103], v[172:175], v[164:167], v[100:103]
    ds_read_b128 v[216:219], v2 offset:47104
    v_permlane32_swap_b32 v48, v50
    v_mfma_f32_16x16x32_bf16 v[104:107], v[176:179], v[160:163], v[104:107]
    ds_read_b128 v[220:223], v2 offset:48128
    v_permlane32_swap_b32 v49, v51
    v_mfma_f32_16x16x32_bf16 v[108:111], v[176:179], v[164:167], v[108:111]
    ds_read_b128 v[224:227], v2 offset:49152
    v_cvt_pk_bf16_f32 v56, v56, v57
    v_mfma_f32_16x16x32_bf16 v[112:115], v[180:183], v[160:163], v[112:115]
    ds_read_b128 v[228:231], v2 offset:50176
    v_cvt_pk_bf16_f32 v57, v58, v59
    v_mfma_f32_16x16x32_bf16 v[116:119], v[180:183], v[164:167], v[116:119]
    ds_read_b128 v[232:235], v2 offset:51200
    s_waitcnt lgkmcnt(8)
    v_mfma_f32_16x16x32_bf16 v[120:123], v[184:187], v[160:163], v[120:123]
    ds_read_b128 v[236:239], v2 offset:52224
    v_cvt_pk_bf16_f32 v58, v60, v61
    v_mfma_f32_16x16x32_bf16 v[124:127], v[184:187], v[164:167], v[124:127]
    ds_read_b128 v[240:243], v2 offset:53248
    v_cvt_pk_bf16_f32 v59, v62, v63
    v_mfma_f32_16x16x32_bf16 v[128:131], v[188:191], v[160:163], v[128:131]
    ds_read_b128 v[244:247], v2 offset:54272
    v_permlane16_swap_b32 v48, v50
    v_mfma_f32_16x16x32_bf16 v[132:135], v[188:191], v[164:167], v[132:135]
    v_permlane16_swap_b32 v49, v51
    buffer_store_dwordx4 v[48:51], v1, s[4:7], s39 offen offset:0 sc1
    v_fma_f32 v64, v64, v4, -v6
    v_mfma_f32_16x16x32_bf16 v[136:139], v[192:195], v[160:163], v[136:139]
    v_fma_f32 v65, v65, v5, -v7
    v_fma_f32 v66, v66, v8, -v10
    v_mfma_f32_16x16x32_bf16 v[140:143], v[192:195], v[164:167], v[140:143]
    v_fma_f32 v67, v67, v9, -v11
    v_fma_f32 v68, v68, v12, -v14
    v_mfma_f32_16x16x32_bf16 v[144:147], v[196:199], v[160:163], v[144:147]
    v_fma_f32 v69, v69, v13, -v15
    v_fma_f32 v70, v70, v252, -v254
    v_mfma_f32_16x16x32_bf16 v[148:151], v[196:199], v[164:167], v[148:151]
    v_fma_f32 v71, v71, v253, -v255
    v_permlane32_swap_b32 v56, v58
    v_mfma_f32_16x16x32_bf16 v[152:155], v[200:203], v[160:163], v[152:155]
    v_permlane32_swap_b32 v57, v59
    v_cvt_pk_bf16_f32 v64, v64, v65
    v_mfma_f32_16x16x32_bf16 v[156:159], v[200:203], v[164:167], v[156:159]
    v_cvt_pk_bf16_f32 v65, v66, v67
    s_waitcnt lgkmcnt(0)
    s_barrier
    v_mfma_f32_16x16x32_bf16 v[88:91], v[212:215], v[204:207], v[88:91]
    ds_read_b128 v[160:163], v3 offset:0
    v_mfma_f32_16x16x32_bf16 v[92:95], v[212:215], v[208:211], v[92:95]
    ds_read_b128 v[164:167], v3 offset:2048
    v_cvt_pk_bf16_f32 v66, v68, v69
    v_mfma_f32_16x16x32_bf16 v[96:99], v[216:219], v[204:207], v[96:99]
    ds_read_b128 v[168:171], v1 offset:0
    v_cvt_pk_bf16_f32 v67, v70, v71
    v_mfma_f32_16x16x32_bf16 v[100:103], v[216:219], v[208:211], v[100:103]
    ds_read_b128 v[172:175], v1 offset:1024
    v_permlane16_swap_b32 v56, v58
    v_mfma_f32_16x16x32_bf16 v[104:107], v[220:223], v[204:207], v[104:107]
    ds_read_b128 v[176:179], v1 offset:2048
    v_permlane16_swap_b32 v57, v59
    buffer_store_dwordx4 v[56:59], v1, s[4:7], s39 offen offset:1024 sc1
    v_mfma_f32_16x16x32_bf16 v[108:111], v[220:223], v[208:211], v[108:111]
    ds_read_b128 v[180:183], v1 offset:3072
    v_fma_f32 v72, v72, v4, -v6
    v_mfma_f32_16x16x32_bf16 v[112:115], v[224:227], v[204:207], v[112:115]
    ds_read_b128 v[184:187], v1 offset:4096
    v_fma_f32 v73, v73, v5, -v7
    v_mfma_f32_16x16x32_bf16 v[116:119], v[224:227], v[208:211], v[116:119]
    ds_read_b128 v[188:191], v1 offset:5120
    v_mfma_f32_16x16x32_bf16 v[120:123], v[228:231], v[204:207], v[120:123]
    ds_read_b128 v[192:195], v1 offset:6144
    v_fma_f32 v74, v74, v8, -v10
    v_mfma_f32_16x16x32_bf16 v[124:127], v[228:231], v[208:211], v[124:127]
    ds_read_b128 v[196:199], v1 offset:7168
    v_fma_f32 v75, v75, v9, -v11
    v_mfma_f32_16x16x32_bf16 v[128:131], v[232:235], v[204:207], v[128:131]
    ds_read_b128 v[200:203], v1 offset:8192
    v_fma_f32 v76, v76, v12, -v14
    v_mfma_f32_16x16x32_bf16 v[132:135], v[232:235], v[208:211], v[132:135]
    v_fma_f32 v77, v77, v13, -v15
    v_fma_f32 v78, v78, v252, -v254
    v_mfma_f32_16x16x32_bf16 v[136:139], v[236:239], v[204:207], v[136:139]
    v_fma_f32 v79, v79, v253, -v255
    v_permlane32_swap_b32 v64, v66
    v_mfma_f32_16x16x32_bf16 v[140:143], v[236:239], v[208:211], v[140:143]
    v_permlane32_swap_b32 v65, v67
    v_cvt_pk_bf16_f32 v72, v72, v73
    v_mfma_f32_16x16x32_bf16 v[144:147], v[240:243], v[204:207], v[144:147]
    v_cvt_pk_bf16_f32 v73, v74, v75
    v_cvt_pk_bf16_f32 v74, v76, v77
    v_mfma_f32_16x16x32_bf16 v[148:151], v[240:243], v[208:211], v[148:151]
    v_cvt_pk_bf16_f32 v75, v78, v79
    v_permlane16_swap_b32 v64, v66
    v_mfma_f32_16x16x32_bf16 v[152:155], v[244:247], v[204:207], v[152:155]
    v_permlane16_swap_b32 v65, v67
    buffer_store_dwordx4 v[64:67], v1, s[4:7], s39 offen offset:2048 sc1
    v_fma_f32 v80, v80, v4, -v6
    v_mfma_f32_16x16x32_bf16 v[156:159], v[244:247], v[208:211], v[156:159]
    v_fma_f32 v81, v81, v5, -v7
    s_waitcnt lgkmcnt(5)
    v_mfma_f32_16x16x32_bf16 v[88:91], v[168:171], v[160:163], v[88:91]
    ds_read_b128 v[204:207], v3 offset:1024
    v_mfma_f32_16x16x32_bf16 v[92:95], v[168:171], v[164:167], v[92:95]
    ds_read_b128 v[208:211], v3 offset:3072
    v_fma_f32 v82, v82, v8, -v10
    v_mfma_f32_16x16x32_bf16 v[96:99], v[172:175], v[160:163], v[96:99]
    ds_read_b128 v[212:215], v1 offset:9216
    v_fma_f32 v83, v83, v9, -v11
    v_mfma_f32_16x16x32_bf16 v[100:103], v[172:175], v[164:167], v[100:103]
    ds_read_b128 v[216:219], v1 offset:10240
    v_fma_f32 v84, v84, v12, -v14
    v_mfma_f32_16x16x32_bf16 v[104:107], v[176:179], v[160:163], v[104:107]
    ds_read_b128 v[220:223], v1 offset:11264
    v_fma_f32 v85, v85, v13, -v15
    v_mfma_f32_16x16x32_bf16 v[108:111], v[176:179], v[164:167], v[108:111]
    ds_read_b128 v[224:227], v1 offset:12288
    v_fma_f32 v86, v86, v252, -v254
    v_mfma_f32_16x16x32_bf16 v[112:115], v[180:183], v[160:163], v[112:115]
    ds_read_b128 v[228:231], v1 offset:13312
    v_fma_f32 v87, v87, v253, -v255
    v_mfma_f32_16x16x32_bf16 v[116:119], v[180:183], v[164:167], v[116:119]
    ds_read_b128 v[232:235], v1 offset:14336
    s_waitcnt lgkmcnt(8)
    v_mfma_f32_16x16x32_bf16 v[120:123], v[184:187], v[160:163], v[120:123]
    ds_read_b128 v[236:239], v1 offset:15360
    v_permlane32_swap_b32 v72, v74
    v_mfma_f32_16x16x32_bf16 v[124:127], v[184:187], v[164:167], v[124:127]
    ds_read_b128 v[240:243], v1 offset:16384
    v_permlane32_swap_b32 v73, v75
    v_mfma_f32_16x16x32_bf16 v[128:131], v[188:191], v[160:163], v[128:131]
    ds_read_b128 v[244:247], v1 offset:17408
    v_cvt_pk_bf16_f32 v80, v80, v81
    v_mfma_f32_16x16x32_bf16 v[132:135], v[188:191], v[164:167], v[132:135]
    v_cvt_pk_bf16_f32 v81, v82, v83
    v_cvt_pk_bf16_f32 v82, v84, v85
    v_mfma_f32_16x16x32_bf16 v[136:139], v[192:195], v[160:163], v[136:139]
    v_cvt_pk_bf16_f32 v83, v86, v87
    v_permlane16_swap_b32 v72, v74
    v_mfma_f32_16x16x32_bf16 v[140:143], v[192:195], v[164:167], v[140:143]
    v_permlane16_swap_b32 v73, v75
    buffer_store_dwordx4 v[72:75], v1, s[4:7], s39 offen offset:3072 sc1
    s_nop 0
    v_mfma_f32_16x16x32_bf16 v[144:147], v[196:199], v[160:163], v[144:147]
    v_permlane32_swap_b32 v80, v82
    v_permlane32_swap_b32 v81, v83
    v_mfma_f32_16x16x32_bf16 v[148:151], v[196:199], v[164:167], v[148:151]
    s_nop 0
    v_permlane16_swap_b32 v80, v82
    v_mfma_f32_16x16x32_bf16 v[152:155], v[200:203], v[160:163], v[152:155]
    v_permlane16_swap_b32 v81, v83
    buffer_store_dwordx4 v[80:83], v1, s[4:7], s46 offen offset:0 sc1
    v_mul_f32 v4, s40, v249
    v_mfma_f32_16x16x32_bf16 v[156:159], v[200:203], v[164:167], v[156:159]
    v_mul_f32 v6, s40, v251
    s_waitcnt lgkmcnt(0)
    s_barrier
    v_mfma_f32_16x16x32_bf16 v[88:91], v[212:215], v[204:207], v[88:91]
    ds_read_b128 v[160:163], v3 offset:36864
    v_mfma_f32_16x16x32_bf16 v[92:95], v[212:215], v[208:211], v[92:95]
    ds_read_b128 v[164:167], v3 offset:38912
    v_mul_f32 v5, v249, v249
    v_mfma_f32_16x16x32_bf16 v[96:99], v[216:219], v[204:207], v[96:99]
    ds_read_b128 v[168:171], v1 offset:36864
    v_mul_f32 v7, v251, v251
    v_mfma_f32_16x16x32_bf16 v[100:103], v[216:219], v[208:211], v[100:103]
    ds_read_b128 v[172:175], v1 offset:37888
    v_rcp_f32 v249, v249
    v_mfma_f32_16x16x32_bf16 v[104:107], v[220:223], v[204:207], v[104:107]
    ds_read_b128 v[176:179], v1 offset:38912
    v_rcp_f32 v251, v251
    v_mfma_f32_16x16x32_bf16 v[108:111], v[220:223], v[208:211], v[108:111]
    ds_read_b128 v[180:183], v1 offset:39936
    v_mul_f32 v5, s42, v5
    v_mfma_f32_16x16x32_bf16 v[112:115], v[224:227], v[204:207], v[112:115]
    ds_read_b128 v[184:187], v1 offset:40960
    v_mul_f32 v7, s42, v7
    v_mfma_f32_16x16x32_bf16 v[116:119], v[224:227], v[208:211], v[116:119]
    ds_read_b128 v[188:191], v1 offset:41984
    v_mfma_f32_16x16x32_bf16 v[120:123], v[228:231], v[204:207], v[120:123]
    ds_read_b128 v[192:195], v1 offset:43008
    v_mul_f32 v5, v5, v4
    v_mfma_f32_16x16x32_bf16 v[124:127], v[228:231], v[208:211], v[124:127]
    ds_read_b128 v[196:199], v1 offset:44032
    v_mul_f32 v7, v7, v6
    v_mfma_f32_16x16x32_bf16 v[128:131], v[232:235], v[204:207], v[128:131]
    ds_read_b128 v[200:203], v1 offset:45056
    v_bfe_u32 v13, v1, 4, 4
    v_mfma_f32_16x16x32_bf16 v[132:135], v[232:235], v[208:211], v[132:135]
    v_lshrrev_b32 v8, 1, v13
    v_lshrrev_b32 v9, 8, v1
    v_mfma_f32_16x16x32_bf16 v[136:139], v[236:239], v[204:207], v[136:139]
    v_xor_b32 v8, v8, v9
    v_lshlrev_b32 v8, 4, v8
    v_mfma_f32_16x16x32_bf16 v[140:143], v[236:239], v[208:211], v[140:143]
    v_lshl_add_u32 v8, v13, 7, v8
    s_add_u32 s33, s30, 18432
    v_mfma_f32_16x16x32_bf16 v[144:147], v[240:243], v[204:207], v[144:147]
    v_add_u32 v8, s33, v8
    v_xor_b32 v9, 64, v8
    v_mfma_f32_16x16x32_bf16 v[148:151], v[240:243], v[208:211], v[148:151]
    v_add_u32 v10, 73728, v8
    v_add_u32 v11, 73728, v9
    v_mfma_f32_16x16x32_bf16 v[152:155], v[244:247], v[204:207], v[152:155]
    s_lshl_b32 s33, s20, 6
    s_add_u32 s33, s33, 161280
    v_mfma_f32_16x16x32_bf16 v[156:159], v[244:247], v[208:211], v[156:159]
    v_lshl_add_u32 v13, v13, 1, s33
    s_waitcnt lgkmcnt(5)
    v_mfma_f32_16x16x32_bf16 v[88:91], v[168:171], v[160:163], v[88:91]
    ds_read_b128 v[204:207], v3 offset:37888
    v_mfma_f32_16x16x32_bf16 v[92:95], v[168:171], v[164:167], v[92:95]
    ds_read_b128 v[208:211], v3 offset:39936
    v_mfma_f32_16x16x32_bf16 v[96:99], v[172:175], v[160:163], v[96:99]
    ds_read_b128 v[212:215], v1 offset:46080
    v_mfma_f32_16x16x32_bf16 v[100:103], v[172:175], v[164:167], v[100:103]
    ds_read_b128 v[216:219], v1 offset:47104
    v_mfma_f32_16x16x32_bf16 v[104:107], v[176:179], v[160:163], v[104:107]
    ds_read_b128 v[220:223], v1 offset:48128
    v_mfma_f32_16x16x32_bf16 v[108:111], v[176:179], v[164:167], v[108:111]
    ds_read_b128 v[224:227], v1 offset:49152
    v_mfma_f32_16x16x32_bf16 v[112:115], v[180:183], v[160:163], v[112:115]
    ds_read_b128 v[228:231], v1 offset:50176
    v_mfma_f32_16x16x32_bf16 v[116:119], v[180:183], v[164:167], v[116:119]
    ds_read_b128 v[232:235], v1 offset:51200
    s_waitcnt lgkmcnt(8)
    v_mfma_f32_16x16x32_bf16 v[120:123], v[184:187], v[160:163], v[120:123]
    ds_read_b128 v[236:239], v1 offset:52224
    v_mfma_f32_16x16x32_bf16 v[124:127], v[184:187], v[164:167], v[124:127]
    ds_read_b128 v[240:243], v1 offset:53248
    v_mfma_f32_16x16x32_bf16 v[128:131], v[188:191], v[160:163], v[128:131]
    ds_read_b128 v[244:247], v1 offset:54272
    v_mfma_f32_16x16x32_bf16 v[132:135], v[188:191], v[164:167], v[132:135]
    v_mfma_f32_16x16x32_bf16 v[136:139], v[192:195], v[160:163], v[136:139]
    v_lshrrev_b32 v0, 4, v1
    v_mfma_f32_16x16x32_bf16 v[140:143], v[192:195], v[164:167], v[140:143]
    v_and_b32 v0, 48, v0
    v_mfma_f32_16x16x32_bf16 v[144:147], v[196:199], v[160:163], v[144:147]
    v_add_u32 v0, 160320, v0
    v_mfma_f32_16x16x32_bf16 v[148:151], v[196:199], v[164:167], v[148:151]
    v_mfma_f32_16x16x32_bf16 v[152:155], v[200:203], v[160:163], v[152:155]
    v_mfma_f32_16x16x32_bf16 v[156:159], v[200:203], v[164:167], v[156:159]
    s_waitcnt lgkmcnt(0)
    s_waitcnt vmcnt(0)
    s_barrier
    v_mfma_f32_16x16x32_bf16 v[88:91], v[212:215], v[204:207], v[88:91]
    ds_read_b128 v[168:171], v0 offset:0
    v_mfma_f32_16x16x32_bf16 v[92:95], v[212:215], v[208:211], v[92:95]
    ds_read_b128 v[172:175], v0 offset:64
    v_mfma_f32_16x16x32_bf16 v[96:99], v[216:219], v[204:207], v[96:99]
    ds_read_b128 v[176:179], v0 offset:128
    v_mfma_f32_16x16x32_bf16 v[100:103], v[216:219], v[208:211], v[100:103]
    ds_read_b128 v[180:183], v0 offset:192
    v_mfma_f32_16x16x32_bf16 v[104:107], v[220:223], v[204:207], v[104:107]
    ds_read_b128 v[184:187], v0 offset:256
    v_mfma_f32_16x16x32_bf16 v[108:111], v[220:223], v[208:211], v[108:111]
    ds_read_b128 v[188:191], v0 offset:320
    v_mfma_f32_16x16x32_bf16 v[112:115], v[224:227], v[204:207], v[112:115]
    ds_read_b128 v[192:195], v0 offset:384
    v_mfma_f32_16x16x32_bf16 v[116:119], v[224:227], v[208:211], v[116:119]
    ds_read_b128 v[196:199], v0 offset:448
    v_mfma_f32_16x16x32_bf16 v[120:123], v[228:231], v[204:207], v[120:123]
    ds_read_b128 v[200:203], v0 offset:512
    v_mfma_f32_16x16x32_bf16 v[124:127], v[228:231], v[208:211], v[124:127]
    ds_read_u16 v12, v13
    v_mfma_f32_16x16x32_bf16 v[128:131], v[232:235], v[204:207], v[128:131]
    ds_read_u16 v252, v13 offset:32
    v_mfma_f32_16x16x32_bf16 v[132:135], v[232:235], v[208:211], v[132:135]
    v_mfma_f32_16x16x32_bf16 v[136:139], v[236:239], v[204:207], v[136:139]
    v_mfma_f32_16x16x32_bf16 v[140:143], v[236:239], v[208:211], v[140:143]
    v_mfma_f32_16x16x32_bf16 v[144:147], v[240:243], v[204:207], v[144:147]
    v_mfma_f32_16x16x32_bf16 v[148:151], v[240:243], v[208:211], v[148:151]
    v_mfma_f32_16x16x32_bf16 v[152:155], v[244:247], v[204:207], v[152:155]
    v_mfma_f32_16x16x32_bf16 v[156:159], v[244:247], v[208:211], v[156:159]
    s_waitcnt lgkmcnt(0)
    v_lshlrev_b32 v15, 16, v12
    v_lshlrev_b32 v255, 16, v252
    v_lshlrev_b32 v14, 16, v12
    v_lshlrev_b32 v254, 16, v252
    v_lshlrev_b32 v13, 16, v12
    v_lshlrev_b32 v253, 16, v252
    v_lshlrev_b32 v12, 16, v12
    v_lshlrev_b32 v252, 16, v252
    v_pk_fma_f32 v[88:89], v[248:249], v[168:169], v[88:89] op_sel_hi:[0,1,1] neg_lo:[1,0,0] neg_hi:[1,0,0]
    v_pk_fma_f32 v[90:91], v[248:249], v[170:171], v[90:91] op_sel_hi:[0,1,1] neg_lo:[1,0,0] neg_hi:[1,0,0]
    v_pk_fma_f32 v[92:93], v[250:251], v[168:169], v[92:93] op_sel_hi:[0,1,1] neg_lo:[1,0,0] neg_hi:[1,0,0]
    v_pk_fma_f32 v[94:95], v[250:251], v[170:171], v[94:95] op_sel_hi:[0,1,1] neg_lo:[1,0,0] neg_hi:[1,0,0]
    v_pk_fma_f32 v[96:97], v[248:249], v[172:173], v[96:97] op_sel_hi:[0,1,1] neg_lo:[1,0,0] neg_hi:[1,0,0]
    v_pk_fma_f32 v[98:99], v[248:249], v[174:175], v[98:99] op_sel_hi:[0,1,1] neg_lo:[1,0,0] neg_hi:[1,0,0]
    v_pk_fma_f32 v[100:101], v[250:251], v[172:173], v[100:101] op_sel_hi:[0,1,1] neg_lo:[1,0,0] neg_hi:[1,0,0]
    v_pk_fma_f32 v[102:103], v[250:251], v[174:175], v[102:103] op_sel_hi:[0,1,1] neg_lo:[1,0,0] neg_hi:[1,0,0]
    v_pk_fma_f32 v[104:105], v[248:249], v[176:177], v[104:105] op_sel_hi:[0,1,1] neg_lo:[1,0,0] neg_hi:[1,0,0]
    v_pk_fma_f32 v[106:107], v[248:249], v[178:179], v[106:107] op_sel_hi:[0,1,1] neg_lo:[1,0,0] neg_hi:[1,0,0]
    v_pk_fma_f32 v[108:109], v[250:251], v[176:177], v[108:109] op_sel_hi:[0,1,1] neg_lo:[1,0,0] neg_hi:[1,0,0]
    v_pk_fma_f32 v[110:111], v[250:251], v[178:179], v[110:111] op_sel_hi:[0,1,1] neg_lo:[1,0,0] neg_hi:[1,0,0]
    v_pk_fma_f32 v[112:113], v[248:249], v[180:181], v[112:113] op_sel_hi:[0,1,1] neg_lo:[1,0,0] neg_hi:[1,0,0]
    v_pk_fma_f32 v[114:115], v[248:249], v[182:183], v[114:115] op_sel_hi:[0,1,1] neg_lo:[1,0,0] neg_hi:[1,0,0]
    v_pk_fma_f32 v[116:117], v[250:251], v[180:181], v[116:117] op_sel_hi:[0,1,1] neg_lo:[1,0,0] neg_hi:[1,0,0]
    v_pk_fma_f32 v[118:119], v[250:251], v[182:183], v[118:119] op_sel_hi:[0,1,1] neg_lo:[1,0,0] neg_hi:[1,0,0]
    v_pk_fma_f32 v[120:121], v[248:249], v[184:185], v[120:121] op_sel_hi:[0,1,1] neg_lo:[1,0,0] neg_hi:[1,0,0]
    v_pk_fma_f32 v[122:123], v[248:249], v[186:187], v[122:123] op_sel_hi:[0,1,1] neg_lo:[1,0,0] neg_hi:[1,0,0]
    v_pk_fma_f32 v[124:125], v[250:251], v[184:185], v[124:125] op_sel_hi:[0,1,1] neg_lo:[1,0,0] neg_hi:[1,0,0]
    v_pk_fma_f32 v[126:127], v[250:251], v[186:187], v[126:127] op_sel_hi:[0,1,1] neg_lo:[1,0,0] neg_hi:[1,0,0]
    v_pk_fma_f32 v[128:129], v[248:249], v[188:189], v[128:129] op_sel_hi:[0,1,1] neg_lo:[1,0,0] neg_hi:[1,0,0]
    v_pk_fma_f32 v[130:131], v[248:249], v[190:191], v[130:131] op_sel_hi:[0,1,1] neg_lo:[1,0,0] neg_hi:[1,0,0]
    v_pk_fma_f32 v[132:133], v[250:251], v[188:189], v[132:133] op_sel_hi:[0,1,1] neg_lo:[1,0,0] neg_hi:[1,0,0]
    v_pk_fma_f32 v[134:135], v[250:251], v[190:191], v[134:135] op_sel_hi:[0,1,1] neg_lo:[1,0,0] neg_hi:[1,0,0]
    v_pk_fma_f32 v[136:137], v[248:249], v[192:193], v[136:137] op_sel_hi:[0,1,1] neg_lo:[1,0,0] neg_hi:[1,0,0]
    v_pk_fma_f32 v[138:139], v[248:249], v[194:195], v[138:139] op_sel_hi:[0,1,1] neg_lo:[1,0,0] neg_hi:[1,0,0]
    v_pk_fma_f32 v[140:141], v[250:251], v[192:193], v[140:141] op_sel_hi:[0,1,1] neg_lo:[1,0,0] neg_hi:[1,0,0]
    v_pk_fma_f32 v[142:143], v[250:251], v[194:195], v[142:143] op_sel_hi:[0,1,1] neg_lo:[1,0,0] neg_hi:[1,0,0]
    v_pk_fma_f32 v[144:145], v[248:249], v[196:197], v[144:145] op_sel_hi:[0,1,1] neg_lo:[1,0,0] neg_hi:[1,0,0]
    v_pk_fma_f32 v[146:147], v[248:249], v[198:199], v[146:147] op_sel_hi:[0,1,1] neg_lo:[1,0,0] neg_hi:[1,0,0]
    v_pk_fma_f32 v[148:149], v[250:251], v[196:197], v[148:149] op_sel_hi:[0,1,1] neg_lo:[1,0,0] neg_hi:[1,0,0]
    v_pk_fma_f32 v[150:151], v[250:251], v[198:199], v[150:151] op_sel_hi:[0,1,1] neg_lo:[1,0,0] neg_hi:[1,0,0]
    v_pk_fma_f32 v[152:153], v[248:249], v[200:201], v[152:153] op_sel_hi:[0,1,1] neg_lo:[1,0,0] neg_hi:[1,0,0]
    v_pk_fma_f32 v[154:155], v[248:249], v[202:203], v[154:155] op_sel_hi:[0,1,1] neg_lo:[1,0,0] neg_hi:[1,0,0]
    v_pk_fma_f32 v[156:157], v[250:251], v[200:201], v[156:157] op_sel_hi:[0,1,1] neg_lo:[1,0,0] neg_hi:[1,0,0]
    v_pk_fma_f32 v[158:159], v[250:251], v[202:203], v[158:159] op_sel_hi:[0,1,1] neg_lo:[1,0,0] neg_hi:[1,0,0]
    v_pk_mul_f32 v[204:205], v[88:89], v[88:89]
    v_pk_mul_f32 v[206:207], v[90:91], v[90:91]
    v_pk_mul_f32 v[208:209], v[92:93], v[92:93]
    v_pk_mul_f32 v[210:211], v[94:95], v[94:95]
    v_pk_fma_f32 v[204:205], v[204:205], v[4:5], v[4:5] op_sel:[0,1,0] op_sel_hi:[1,1,0]
    v_pk_fma_f32 v[206:207], v[206:207], v[4:5], v[4:5] op_sel:[0,1,0] op_sel_hi:[1,1,0]
    v_pk_fma_f32 v[208:209], v[208:209], v[6:7], v[6:7] op_sel:[0,1,0] op_sel_hi:[1,1,0]
    v_pk_fma_f32 v[210:211], v[210:211], v[6:7], v[6:7] op_sel:[0,1,0] op_sel_hi:[1,1,0]
    v_pk_mul_f32 v[204:205], v[204:205], v[88:89]
    v_pk_mul_f32 v[206:207], v[206:207], v[90:91]
    v_pk_mul_f32 v[208:209], v[208:209], v[92:93]
    v_pk_mul_f32 v[210:211], v[210:211], v[94:95]
    v_exp_f32 v204, v204
    v_exp_f32 v205, v205
    v_exp_f32 v206, v206
    v_exp_f32 v207, v207
    v_exp_f32 v208, v208
    v_exp_f32 v209, v209
    v_exp_f32 v210, v210
    v_exp_f32 v211, v211
    v_pk_fma_f32 v[204:205], v[204:205], v[248:249], v[248:249] op_sel:[0,1,1] op_sel_hi:[1,1,1]
    v_pk_fma_f32 v[206:207], v[206:207], v[248:249], v[248:249] op_sel:[0,1,1] op_sel_hi:[1,1,1]
    v_pk_fma_f32 v[208:209], v[208:209], v[250:251], v[250:251] op_sel:[0,1,1] op_sel_hi:[1,1,1]
    v_pk_fma_f32 v[210:211], v[210:211], v[250:251], v[250:251] op_sel:[0,1,1] op_sel_hi:[1,1,1]
    v_rcp_f32 v204, v204
    v_rcp_f32 v205, v205
    v_rcp_f32 v206, v206
    v_rcp_f32 v207, v207
    v_rcp_f32 v208, v208
    v_rcp_f32 v209, v209
    v_rcp_f32 v210, v210
    v_rcp_f32 v211, v211
    v_pk_mul_f32 v[88:89], v[88:89], v[204:205]
    v_pk_mul_f32 v[90:91], v[90:91], v[206:207]
    v_pk_mul_f32 v[92:93], v[92:93], v[208:209]
    v_pk_mul_f32 v[94:95], v[94:95], v[210:211]
    v_pk_mul_f32 v[212:213], v[96:97], v[96:97]
    v_pk_mul_f32 v[214:215], v[98:99], v[98:99]
    v_pk_mul_f32 v[216:217], v[100:101], v[100:101]
    v_pk_mul_f32 v[218:219], v[102:103], v[102:103]
    v_pk_fma_f32 v[212:213], v[212:213], v[4:5], v[4:5] op_sel:[0,1,0] op_sel_hi:[1,1,0]
    v_pk_fma_f32 v[214:215], v[214:215], v[4:5], v[4:5] op_sel:[0,1,0] op_sel_hi:[1,1,0]
    v_pk_fma_f32 v[216:217], v[216:217], v[6:7], v[6:7] op_sel:[0,1,0] op_sel_hi:[1,1,0]
    v_pk_fma_f32 v[218:219], v[218:219], v[6:7], v[6:7] op_sel:[0,1,0] op_sel_hi:[1,1,0]
    v_pk_mul_f32 v[212:213], v[212:213], v[96:97]
    v_pk_mul_f32 v[214:215], v[214:215], v[98:99]
    v_pk_mul_f32 v[216:217], v[216:217], v[100:101]
    v_pk_mul_f32 v[218:219], v[218:219], v[102:103]
    v_exp_f32 v212, v212
    v_exp_f32 v213, v213
    v_exp_f32 v214, v214
    v_exp_f32 v215, v215
    v_exp_f32 v216, v216
    v_exp_f32 v217, v217
    v_exp_f32 v218, v218
    v_exp_f32 v219, v219
    v_pk_fma_f32 v[212:213], v[212:213], v[248:249], v[248:249] op_sel:[0,1,1] op_sel_hi:[1,1,1]
    v_pk_fma_f32 v[214:215], v[214:215], v[248:249], v[248:249] op_sel:[0,1,1] op_sel_hi:[1,1,1]
    v_pk_fma_f32 v[216:217], v[216:217], v[250:251], v[250:251] op_sel:[0,1,1] op_sel_hi:[1,1,1]
    v_pk_fma_f32 v[218:219], v[218:219], v[250:251], v[250:251] op_sel:[0,1,1] op_sel_hi:[1,1,1]
    v_rcp_f32 v212, v212
    v_rcp_f32 v213, v213
    v_rcp_f32 v214, v214
    v_rcp_f32 v215, v215
    v_rcp_f32 v216, v216
    v_rcp_f32 v217, v217
    v_rcp_f32 v218, v218
    v_rcp_f32 v219, v219
    v_pk_mul_f32 v[96:97], v[96:97], v[212:213]
    v_pk_mul_f32 v[98:99], v[98:99], v[214:215]
    v_pk_mul_f32 v[100:101], v[100:101], v[216:217]
    v_pk_mul_f32 v[102:103], v[102:103], v[218:219]
    v_pk_mul_f32 v[204:205], v[104:105], v[104:105]
    v_pk_mul_f32 v[206:207], v[106:107], v[106:107]
    v_pk_mul_f32 v[208:209], v[108:109], v[108:109]
    v_pk_mul_f32 v[210:211], v[110:111], v[110:111]
    v_pk_fma_f32 v[204:205], v[204:205], v[4:5], v[4:5] op_sel:[0,1,0] op_sel_hi:[1,1,0]
    v_pk_fma_f32 v[206:207], v[206:207], v[4:5], v[4:5] op_sel:[0,1,0] op_sel_hi:[1,1,0]
    v_pk_fma_f32 v[208:209], v[208:209], v[6:7], v[6:7] op_sel:[0,1,0] op_sel_hi:[1,1,0]
    v_pk_fma_f32 v[210:211], v[210:211], v[6:7], v[6:7] op_sel:[0,1,0] op_sel_hi:[1,1,0]
    v_pk_mul_f32 v[204:205], v[204:205], v[104:105]
    v_pk_mul_f32 v[206:207], v[206:207], v[106:107]
    v_pk_mul_f32 v[208:209], v[208:209], v[108:109]
    v_pk_mul_f32 v[210:211], v[210:211], v[110:111]
    v_exp_f32 v204, v204
    v_exp_f32 v205, v205
    v_exp_f32 v206, v206
    v_exp_f32 v207, v207
    v_exp_f32 v208, v208
    v_exp_f32 v209, v209
    v_exp_f32 v210, v210
    v_exp_f32 v211, v211
    v_pk_fma_f32 v[204:205], v[204:205], v[248:249], v[248:249] op_sel:[0,1,1] op_sel_hi:[1,1,1]
    v_pk_fma_f32 v[206:207], v[206:207], v[248:249], v[248:249] op_sel:[0,1,1] op_sel_hi:[1,1,1]
    v_pk_fma_f32 v[208:209], v[208:209], v[250:251], v[250:251] op_sel:[0,1,1] op_sel_hi:[1,1,1]
    v_pk_fma_f32 v[210:211], v[210:211], v[250:251], v[250:251] op_sel:[0,1,1] op_sel_hi:[1,1,1]
    v_rcp_f32 v204, v204
    v_rcp_f32 v205, v205
    v_rcp_f32 v206, v206
    v_rcp_f32 v207, v207
    v_rcp_f32 v208, v208
    v_rcp_f32 v209, v209
    v_rcp_f32 v210, v210
    v_rcp_f32 v211, v211
    v_pk_mul_f32 v[104:105], v[104:105], v[204:205]
    v_pk_mul_f32 v[106:107], v[106:107], v[206:207]
    v_pk_mul_f32 v[108:109], v[108:109], v[208:209]
    v_pk_mul_f32 v[110:111], v[110:111], v[210:211]
    v_pk_mul_f32 v[212:213], v[112:113], v[112:113]
    v_pk_mul_f32 v[214:215], v[114:115], v[114:115]
    v_pk_mul_f32 v[216:217], v[116:117], v[116:117]
    v_pk_mul_f32 v[218:219], v[118:119], v[118:119]
    v_pk_fma_f32 v[212:213], v[212:213], v[4:5], v[4:5] op_sel:[0,1,0] op_sel_hi:[1,1,0]
    v_pk_fma_f32 v[214:215], v[214:215], v[4:5], v[4:5] op_sel:[0,1,0] op_sel_hi:[1,1,0]
    v_pk_fma_f32 v[216:217], v[216:217], v[6:7], v[6:7] op_sel:[0,1,0] op_sel_hi:[1,1,0]
    v_pk_fma_f32 v[218:219], v[218:219], v[6:7], v[6:7] op_sel:[0,1,0] op_sel_hi:[1,1,0]
    v_pk_mul_f32 v[212:213], v[212:213], v[112:113]
    v_pk_mul_f32 v[214:215], v[214:215], v[114:115]
    v_pk_mul_f32 v[216:217], v[216:217], v[116:117]
    v_pk_mul_f32 v[218:219], v[218:219], v[118:119]
    v_exp_f32 v212, v212
    v_exp_f32 v213, v213
    v_exp_f32 v214, v214
    v_exp_f32 v215, v215
    v_exp_f32 v216, v216
    v_exp_f32 v217, v217
    v_exp_f32 v218, v218
    v_exp_f32 v219, v219
    v_pk_fma_f32 v[212:213], v[212:213], v[248:249], v[248:249] op_sel:[0,1,1] op_sel_hi:[1,1,1]
    v_pk_fma_f32 v[214:215], v[214:215], v[248:249], v[248:249] op_sel:[0,1,1] op_sel_hi:[1,1,1]
    v_pk_fma_f32 v[216:217], v[216:217], v[250:251], v[250:251] op_sel:[0,1,1] op_sel_hi:[1,1,1]
    v_pk_fma_f32 v[218:219], v[218:219], v[250:251], v[250:251] op_sel:[0,1,1] op_sel_hi:[1,1,1]
    v_rcp_f32 v212, v212
    v_rcp_f32 v213, v213
    v_rcp_f32 v214, v214
    v_rcp_f32 v215, v215
    v_rcp_f32 v216, v216
    v_rcp_f32 v217, v217
    v_rcp_f32 v218, v218
    v_rcp_f32 v219, v219
    v_pk_mul_f32 v[112:113], v[112:113], v[212:213]
    v_pk_mul_f32 v[114:115], v[114:115], v[214:215]
    v_pk_mul_f32 v[116:117], v[116:117], v[216:217]
    v_pk_mul_f32 v[118:119], v[118:119], v[218:219]
    v_pk_mul_f32 v[204:205], v[120:121], v[120:121]
    v_pk_mul_f32 v[206:207], v[122:123], v[122:123]
    v_pk_mul_f32 v[208:209], v[124:125], v[124:125]
    v_pk_mul_f32 v[210:211], v[126:127], v[126:127]
    v_pk_fma_f32 v[204:205], v[204:205], v[4:5], v[4:5] op_sel:[0,1,0] op_sel_hi:[1,1,0]
    v_pk_fma_f32 v[206:207], v[206:207], v[4:5], v[4:5] op_sel:[0,1,0] op_sel_hi:[1,1,0]
    v_pk_fma_f32 v[208:209], v[208:209], v[6:7], v[6:7] op_sel:[0,1,0] op_sel_hi:[1,1,0]
    v_pk_fma_f32 v[210:211], v[210:211], v[6:7], v[6:7] op_sel:[0,1,0] op_sel_hi:[1,1,0]
    v_pk_mul_f32 v[204:205], v[204:205], v[120:121]
    v_pk_mul_f32 v[206:207], v[206:207], v[122:123]
    v_pk_mul_f32 v[208:209], v[208:209], v[124:125]
    v_pk_mul_f32 v[210:211], v[210:211], v[126:127]
    v_exp_f32 v204, v204
    v_exp_f32 v205, v205
    v_exp_f32 v206, v206
    v_exp_f32 v207, v207
    v_exp_f32 v208, v208
    v_exp_f32 v209, v209
    v_exp_f32 v210, v210
    v_exp_f32 v211, v211
    v_pk_fma_f32 v[204:205], v[204:205], v[248:249], v[248:249] op_sel:[0,1,1] op_sel_hi:[1,1,1]
    v_pk_fma_f32 v[206:207], v[206:207], v[248:249], v[248:249] op_sel:[0,1,1] op_sel_hi:[1,1,1]
    v_pk_fma_f32 v[208:209], v[208:209], v[250:251], v[250:251] op_sel:[0,1,1] op_sel_hi:[1,1,1]
    v_pk_fma_f32 v[210:211], v[210:211], v[250:251], v[250:251] op_sel:[0,1,1] op_sel_hi:[1,1,1]
    v_rcp_f32 v204, v204
    v_rcp_f32 v205, v205
    v_rcp_f32 v206, v206
    v_rcp_f32 v207, v207
    v_rcp_f32 v208, v208
    v_rcp_f32 v209, v209
    v_rcp_f32 v210, v210
    v_rcp_f32 v211, v211
    v_pk_mul_f32 v[120:121], v[120:121], v[204:205]
    v_pk_mul_f32 v[122:123], v[122:123], v[206:207]
    v_pk_mul_f32 v[124:125], v[124:125], v[208:209]
    v_pk_mul_f32 v[126:127], v[126:127], v[210:211]
    v_pk_mul_f32 v[212:213], v[128:129], v[128:129]
    v_pk_mul_f32 v[214:215], v[130:131], v[130:131]
    v_pk_mul_f32 v[216:217], v[132:133], v[132:133]
    v_pk_mul_f32 v[218:219], v[134:135], v[134:135]
    v_pk_fma_f32 v[212:213], v[212:213], v[4:5], v[4:5] op_sel:[0,1,0] op_sel_hi:[1,1,0]
    v_pk_fma_f32 v[214:215], v[214:215], v[4:5], v[4:5] op_sel:[0,1,0] op_sel_hi:[1,1,0]
    v_pk_fma_f32 v[216:217], v[216:217], v[6:7], v[6:7] op_sel:[0,1,0] op_sel_hi:[1,1,0]
    v_pk_fma_f32 v[218:219], v[218:219], v[6:7], v[6:7] op_sel:[0,1,0] op_sel_hi:[1,1,0]
    v_pk_mul_f32 v[212:213], v[212:213], v[128:129]
    v_pk_mul_f32 v[214:215], v[214:215], v[130:131]
    v_pk_mul_f32 v[216:217], v[216:217], v[132:133]
    v_pk_mul_f32 v[218:219], v[218:219], v[134:135]
    v_exp_f32 v212, v212
    v_exp_f32 v213, v213
    v_exp_f32 v214, v214
    v_exp_f32 v215, v215
    v_exp_f32 v216, v216
    v_exp_f32 v217, v217
    v_exp_f32 v218, v218
    v_exp_f32 v219, v219
    v_pk_fma_f32 v[212:213], v[212:213], v[248:249], v[248:249] op_sel:[0,1,1] op_sel_hi:[1,1,1]
    v_pk_fma_f32 v[214:215], v[214:215], v[248:249], v[248:249] op_sel:[0,1,1] op_sel_hi:[1,1,1]
    v_pk_fma_f32 v[216:217], v[216:217], v[250:251], v[250:251] op_sel:[0,1,1] op_sel_hi:[1,1,1]
    v_pk_fma_f32 v[218:219], v[218:219], v[250:251], v[250:251] op_sel:[0,1,1] op_sel_hi:[1,1,1]
    v_rcp_f32 v212, v212
    v_rcp_f32 v213, v213
    v_rcp_f32 v214, v214
    v_rcp_f32 v215, v215
    v_rcp_f32 v216, v216
    v_rcp_f32 v217, v217
    v_rcp_f32 v218, v218
    v_rcp_f32 v219, v219
    v_pk_mul_f32 v[128:129], v[128:129], v[212:213]
    v_pk_mul_f32 v[130:131], v[130:131], v[214:215]
    v_pk_mul_f32 v[132:133], v[132:133], v[216:217]
    v_pk_mul_f32 v[134:135], v[134:135], v[218:219]
    s_barrier
    ds_read_b128 v[160:163], v10 offset:0
    ds_read_b128 v[164:167], v10 offset:2048
    ds_read_b128 v[168:171], v2 offset:0
    ds_read_b128 v[172:175], v2 offset:1024
    ds_read_b128 v[176:179], v2 offset:2048
    ds_read_b128 v[180:183], v2 offset:3072
    ds_read_b128 v[184:187], v2 offset:4096
    ds_read_b128 v[188:191], v2 offset:5120
    ds_read_b128 v[192:195], v2 offset:6144
    ds_read_b128 v[196:199], v2 offset:7168
    ds_read_b128 v[200:203], v2 offset:8192
    v_pk_mul_f32 v[204:205], v[136:137], v[136:137]
    v_pk_mul_f32 v[206:207], v[138:139], v[138:139]
    v_pk_mul_f32 v[208:209], v[140:141], v[140:141]
    v_pk_mul_f32 v[210:211], v[142:143], v[142:143]
    v_pk_fma_f32 v[204:205], v[204:205], v[4:5], v[4:5] op_sel:[0,1,0] op_sel_hi:[1,1,0]
    v_pk_fma_f32 v[206:207], v[206:207], v[4:5], v[4:5] op_sel:[0,1,0] op_sel_hi:[1,1,0]
    v_pk_fma_f32 v[208:209], v[208:209], v[6:7], v[6:7] op_sel:[0,1,0] op_sel_hi:[1,1,0]
    v_pk_fma_f32 v[210:211], v[210:211], v[6:7], v[6:7] op_sel:[0,1,0] op_sel_hi:[1,1,0]
    v_pk_mul_f32 v[204:205], v[204:205], v[136:137]
    v_pk_mul_f32 v[206:207], v[206:207], v[138:139]
    v_pk_mul_f32 v[208:209], v[208:209], v[140:141]
    v_pk_mul_f32 v[210:211], v[210:211], v[142:143]
    v_exp_f32 v204, v204
    v_exp_f32 v205, v205
    v_exp_f32 v206, v206
    v_exp_f32 v207, v207
    v_exp_f32 v208, v208
    v_exp_f32 v209, v209
    v_exp_f32 v210, v210
    v_exp_f32 v211, v211
    v_pk_fma_f32 v[204:205], v[204:205], v[248:249], v[248:249] op_sel:[0,1,1] op_sel_hi:[1,1,1]
    v_pk_fma_f32 v[206:207], v[206:207], v[248:249], v[248:249] op_sel:[0,1,1] op_sel_hi:[1,1,1]
    v_pk_fma_f32 v[208:209], v[208:209], v[250:251], v[250:251] op_sel:[0,1,1] op_sel_hi:[1,1,1]
    v_pk_fma_f32 v[210:211], v[210:211], v[250:251], v[250:251] op_sel:[0,1,1] op_sel_hi:[1,1,1]
    v_rcp_f32 v204, v204
    v_rcp_f32 v205, v205
    v_rcp_f32 v206, v206
    v_rcp_f32 v207, v207
    v_rcp_f32 v208, v208
    v_rcp_f32 v209, v209
    v_rcp_f32 v210, v210
    v_rcp_f32 v211, v211
    v_pk_mul_f32 v[136:137], v[136:137], v[204:205]
    v_pk_mul_f32 v[138:139], v[138:139], v[206:207]
    v_pk_mul_f32 v[140:141], v[140:141], v[208:209]
    v_pk_mul_f32 v[142:143], v[142:143], v[210:211]
    s_waitcnt lgkmcnt(5)
    v_mfma_f32_16x16x32_bf16 v[16:19], v[168:171], v[160:163], v[12:15]
    ds_read_b128 v[204:207], v11 offset:0
    v_mfma_f32_16x16x32_bf16 v[20:23], v[168:171], v[164:167], v[252:255]
    ds_read_b128 v[208:211], v11 offset:2048
    v_mfma_f32_16x16x32_bf16 v[24:27], v[172:175], v[160:163], v[12:15]
    ds_read_b128 v[212:215], v2 offset:9216
    v_mfma_f32_16x16x32_bf16 v[28:31], v[172:175], v[164:167], v[252:255]
    ds_read_b128 v[216:219], v2 offset:10240
    v_mfma_f32_16x16x32_bf16 v[32:35], v[176:179], v[160:163], v[12:15]
    ds_read_b128 v[220:223], v2 offset:11264
    v_mfma_f32_16x16x32_bf16 v[36:39], v[176:179], v[164:167], v[252:255]
    ds_read_b128 v[224:227], v2 offset:12288
    v_mfma_f32_16x16x32_bf16 v[40:43], v[180:183], v[160:163], v[12:15]
    ds_read_b128 v[228:231], v2 offset:13312
    v_mfma_f32_16x16x32_bf16 v[44:47], v[180:183], v[164:167], v[252:255]
    ds_read_b128 v[232:235], v2 offset:14336
    s_waitcnt lgkmcnt(8)
    v_mfma_f32_16x16x32_bf16 v[48:51], v[184:187], v[160:163], v[12:15]
    ds_read_b128 v[236:239], v2 offset:15360
    v_mfma_f32_16x16x32_bf16 v[52:55], v[184:187], v[164:167], v[252:255]
    ds_read_b128 v[240:243], v2 offset:16384
    v_mfma_f32_16x16x32_bf16 v[56:59], v[188:191], v[160:163], v[12:15]
    ds_read_b128 v[244:247], v2 offset:17408
    v_mfma_f32_16x16x32_bf16 v[60:63], v[188:191], v[164:167], v[252:255]
    v_mfma_f32_16x16x32_bf16 v[64:67], v[192:195], v[160:163], v[12:15]
    v_mfma_f32_16x16x32_bf16 v[68:71], v[192:195], v[164:167], v[252:255]
    v_mfma_f32_16x16x32_bf16 v[72:75], v[196:199], v[160:163], v[12:15]
    v_mfma_f32_16x16x32_bf16 v[76:79], v[196:199], v[164:167], v[252:255]
    v_mfma_f32_16x16x32_bf16 v[80:83], v[200:203], v[160:163], v[12:15]
    v_mfma_f32_16x16x32_bf16 v[84:87], v[200:203], v[164:167], v[252:255]
    s_waitcnt lgkmcnt(0)
    s_barrier
    v_mfma_f32_16x16x32_bf16 v[16:19], v[212:215], v[204:207], v[16:19]
    ds_read_b128 v[160:163], v10 offset:36864
    v_mfma_f32_16x16x32_bf16 v[20:23], v[212:215], v[208:211], v[20:23]
    ds_read_b128 v[164:167], v10 offset:38912
    v_mfma_f32_16x16x32_bf16 v[24:27], v[216:219], v[204:207], v[24:27]
    ds_read_b128 v[168:171], v2 offset:36864
    v_mfma_f32_16x16x32_bf16 v[28:31], v[216:219], v[208:211], v[28:31]
    ds_read_b128 v[172:175], v2 offset:37888
    v_mul_f32 v12, v144, v144
    v_mfma_f32_16x16x32_bf16 v[32:35], v[220:223], v[204:207], v[32:35]
    ds_read_b128 v[176:179], v2 offset:38912
    v_mul_f32 v13, v145, v145
    v_mfma_f32_16x16x32_bf16 v[36:39], v[220:223], v[208:211], v[36:39]
    ds_read_b128 v[180:183], v2 offset:39936
    v_mul_f32 v14, v146, v146
    v_mfma_f32_16x16x32_bf16 v[40:43], v[224:227], v[204:207], v[40:43]
    ds_read_b128 v[184:187], v2 offset:40960
    v_mul_f32 v15, v147, v147
    v_mfma_f32_16x16x32_bf16 v[44:47], v[224:227], v[208:211], v[44:47]
    ds_read_b128 v[188:191], v2 offset:41984
    v_mfma_f32_16x16x32_bf16 v[48:51], v[228:231], v[204:207], v[48:51]
    ds_read_b128 v[192:195], v2 offset:43008
    v_mul_f32 v252, v148, v148
    v_mfma_f32_16x16x32_bf16 v[52:55], v[228:231], v[208:211], v[52:55]
    ds_read_b128 v[196:199], v2 offset:44032
    v_mul_f32 v253, v149, v149
    v_mfma_f32_16x16x32_bf16 v[56:59], v[232:235], v[204:207], v[56:59]
    ds_read_b128 v[200:203], v2 offset:45056
    v_mul_f32 v254, v150, v150
    v_mfma_f32_16x16x32_bf16 v[60:63], v[232:235], v[208:211], v[60:63]
    v_mul_f32 v255, v151, v151
    v_fma_f32 v12, v12, v5, v4
    v_mfma_f32_16x16x32_bf16 v[64:67], v[236:239], v[204:207], v[64:67]
    v_fma_f32 v13, v13, v5, v4
    v_fma_f32 v14, v14, v5, v4
    v_mfma_f32_16x16x32_bf16 v[68:71], v[236:239], v[208:211], v[68:71]
    v_fma_f32 v15, v15, v5, v4
    v_fma_f32 v252, v252, v7, v6
    v_mfma_f32_16x16x32_bf16 v[72:75], v[240:243], v[204:207], v[72:75]
    v_fma_f32 v253, v253, v7, v6
    v_fma_f32 v254, v254, v7, v6
    v_mfma_f32_16x16x32_bf16 v[76:79], v[240:243], v[208:211], v[76:79]
    v_fma_f32 v255, v255, v7, v6
    v_mul_f32 v12, v12, v144
    v_mfma_f32_16x16x32_bf16 v[80:83], v[244:247], v[204:207], v[80:83]
    v_mul_f32 v13, v13, v145
    v_mul_f32 v14, v14, v146
    v_mfma_f32_16x16x32_bf16 v[84:87], v[244:247], v[208:211], v[84:87]
    v_mul_f32 v15, v15, v147
    s_waitcnt lgkmcnt(5)
    v_mfma_f32_16x16x32_bf16 v[16:19], v[168:171], v[160:163], v[16:19]
    ds_read_b128 v[204:207], v11 offset:36864
    v_mfma_f32_16x16x32_bf16 v[20:23], v[168:171], v[164:167], v[20:23]
    ds_read_b128 v[208:211], v11 offset:38912
    v_mul_f32 v252, v252, v148
    v_mfma_f32_16x16x32_bf16 v[24:27], v[172:175], v[160:163], v[24:27]
    ds_read_b128 v[212:215], v2 offset:46080
    v_mul_f32 v253, v253, v149
    v_mfma_f32_16x16x32_bf16 v[28:31], v[172:175], v[164:167], v[28:31]
    ds_read_b128 v[216:219], v2 offset:47104
    v_mul_f32 v254, v254, v150
    v_mfma_f32_16x16x32_bf16 v[32:35], v[176:179], v[160:163], v[32:35]
    ds_read_b128 v[220:223], v2 offset:48128
    v_mul_f32 v255, v255, v151
    v_mfma_f32_16x16x32_bf16 v[36:39], v[176:179], v[164:167], v[36:39]
    ds_read_b128 v[224:227], v2 offset:49152
    v_exp_f32 v12, v12
    v_mfma_f32_16x16x32_bf16 v[40:43], v[180:183], v[160:163], v[40:43]
    ds_read_b128 v[228:231], v2 offset:50176
    v_exp_f32 v13, v13
    v_mfma_f32_16x16x32_bf16 v[44:47], v[180:183], v[164:167], v[44:47]
    ds_read_b128 v[232:235], v2 offset:51200
    s_waitcnt lgkmcnt(8)
    v_mfma_f32_16x16x32_bf16 v[48:51], v[184:187], v[160:163], v[48:51]
    ds_read_b128 v[236:239], v2 offset:52224
    v_exp_f32 v14, v14
    v_mfma_f32_16x16x32_bf16 v[52:55], v[184:187], v[164:167], v[52:55]
    ds_read_b128 v[240:243], v2 offset:53248
    v_exp_f32 v15, v15
    v_mfma_f32_16x16x32_bf16 v[56:59], v[188:191], v[160:163], v[56:59]
    ds_read_b128 v[244:247], v2 offset:54272
    v_exp_f32 v252, v252
    v_mfma_f32_16x16x32_bf16 v[60:63], v[188:191], v[164:167], v[60:63]
    v_exp_f32 v253, v253
    v_mfma_f32_16x16x32_bf16 v[64:67], v[192:195], v[160:163], v[64:67]
    v_exp_f32 v254, v254
    v_mfma_f32_16x16x32_bf16 v[68:71], v[192:195], v[164:167], v[68:71]
    v_exp_f32 v255, v255
    v_mfma_f32_16x16x32_bf16 v[72:75], v[196:199], v[160:163], v[72:75]
    v_fma_f32 v12, v12, v249, v249
    v_fma_f32 v13, v13, v249, v249
    v_mfma_f32_16x16x32_bf16 v[76:79], v[196:199], v[164:167], v[76:79]
    v_fma_f32 v14, v14, v249, v249
    v_fma_f32 v15, v15, v249, v249
    v_mfma_f32_16x16x32_bf16 v[80:83], v[200:203], v[160:163], v[80:83]
    v_fma_f32 v252, v252, v251, v251
    v_fma_f32 v253, v253, v251, v251
    v_mfma_f32_16x16x32_bf16 v[84:87], v[200:203], v[164:167], v[84:87]
    v_fma_f32 v254, v254, v251, v251
    s_waitcnt lgkmcnt(0)
    s_barrier
    v_mfma_f32_16x16x32_bf16 v[16:19], v[212:215], v[204:207], v[16:19]
    ds_read_b128 v[160:163], v8 offset:0
    v_mfma_f32_16x16x32_bf16 v[20:23], v[212:215], v[208:211], v[20:23]
    ds_read_b128 v[164:167], v8 offset:2048
    v_fma_f32 v255, v255, v251, v251
    v_mfma_f32_16x16x32_bf16 v[24:27], v[216:219], v[204:207], v[24:27]
    ds_read_b128 v[168:171], v1 offset:0
    v_rcp_f32 v12, v12
    v_mfma_f32_16x16x32_bf16 v[28:31], v[216:219], v[208:211], v[28:31]
    ds_read_b128 v[172:175], v1 offset:1024
    v_rcp_f32 v13, v13
    v_mfma_f32_16x16x32_bf16 v[32:35], v[220:223], v[204:207], v[32:35]
    ds_read_b128 v[176:179], v1 offset:2048
    v_rcp_f32 v14, v14
    v_mfma_f32_16x16x32_bf16 v[36:39], v[220:223], v[208:211], v[36:39]
    ds_read_b128 v[180:183], v1 offset:3072
    v_rcp_f32 v15, v15
    v_mfma_f32_16x16x32_bf16 v[40:43], v[224:227], v[204:207], v[40:43]
    ds_read_b128 v[184:187], v1 offset:4096
    v_rcp_f32 v252, v252
    v_mfma_f32_16x16x32_bf16 v[44:47], v[224:227], v[208:211], v[44:47]
    ds_read_b128 v[188:191], v1 offset:5120
    v_mfma_f32_16x16x32_bf16 v[48:51], v[228:231], v[204:207], v[48:51]
    ds_read_b128 v[192:195], v1 offset:6144
    v_rcp_f32 v253, v253
    v_mfma_f32_16x16x32_bf16 v[52:55], v[228:231], v[208:211], v[52:55]
    ds_read_b128 v[196:199], v1 offset:7168
    v_rcp_f32 v254, v254
    v_mfma_f32_16x16x32_bf16 v[56:59], v[232:235], v[204:207], v[56:59]
    ds_read_b128 v[200:203], v1 offset:8192
    v_rcp_f32 v255, v255
    v_mfma_f32_16x16x32_bf16 v[60:63], v[232:235], v[208:211], v[60:63]
    v_mul_f32 v144, v144, v12
    v_mul_f32 v145, v145, v13
    v_mfma_f32_16x16x32_bf16 v[64:67], v[236:239], v[204:207], v[64:67]
    v_mul_f32 v146, v146, v14
    v_mul_f32 v147, v147, v15
    v_mfma_f32_16x16x32_bf16 v[68:71], v[236:239], v[208:211], v[68:71]
    v_mul_f32 v148, v148, v252
    v_mul_f32 v149, v149, v253
    v_mfma_f32_16x16x32_bf16 v[72:75], v[240:243], v[204:207], v[72:75]
    v_mul_f32 v150, v150, v254
    v_mul_f32 v151, v151, v255
    v_mfma_f32_16x16x32_bf16 v[76:79], v[240:243], v[208:211], v[76:79]
    v_mul_f32 v12, v152, v152
    v_mul_f32 v13, v153, v153
    v_mfma_f32_16x16x32_bf16 v[80:83], v[244:247], v[204:207], v[80:83]
    v_mul_f32 v14, v154, v154
    v_mul_f32 v15, v155, v155
    v_mfma_f32_16x16x32_bf16 v[84:87], v[244:247], v[208:211], v[84:87]
    v_mul_f32 v252, v156, v156
    s_waitcnt lgkmcnt(5)
    v_mfma_f32_16x16x32_bf16 v[16:19], v[168:171], v[160:163], v[16:19]
    ds_read_b128 v[204:207], v9 offset:0
    v_mfma_f32_16x16x32_bf16 v[20:23], v[168:171], v[164:167], v[20:23]
    ds_read_b128 v[208:211], v9 offset:2048
    v_mul_f32 v253, v157, v157
    v_mfma_f32_16x16x32_bf16 v[24:27], v[172:175], v[160:163], v[24:27]
    ds_read_b128 v[212:215], v1 offset:9216
    v_mul_f32 v254, v158, v158
    v_mfma_f32_16x16x32_bf16 v[28:31], v[172:175], v[164:167], v[28:31]
    ds_read_b128 v[216:219], v1 offset:10240
    v_mul_f32 v255, v159, v159
    v_mfma_f32_16x16x32_bf16 v[32:35], v[176:179], v[160:163], v[32:35]
    ds_read_b128 v[220:223], v1 offset:11264
    v_fma_f32 v12, v12, v5, v4
    v_mfma_f32_16x16x32_bf16 v[36:39], v[176:179], v[164:167], v[36:39]
    ds_read_b128 v[224:227], v1 offset:12288
    v_fma_f32 v13, v13, v5, v4
    v_mfma_f32_16x16x32_bf16 v[40:43], v[180:183], v[160:163], v[40:43]
    ds_read_b128 v[228:231], v1 offset:13312
    v_fma_f32 v14, v14, v5, v4
    v_mfma_f32_16x16x32_bf16 v[44:47], v[180:183], v[164:167], v[44:47]
    ds_read_b128 v[232:235], v1 offset:14336
    s_waitcnt lgkmcnt(8)
    v_mfma_f32_16x16x32_bf16 v[48:51], v[184:187], v[160:163], v[48:51]
    ds_read_b128 v[236:239], v1 offset:15360
    v_fma_f32 v15, v15, v5, v4
    v_mfma_f32_16x16x32_bf16 v[52:55], v[184:187], v[164:167], v[52:55]
    ds_read_b128 v[240:243], v1 offset:16384
    v_fma_f32 v252, v252, v7, v6
    v_mfma_f32_16x16x32_bf16 v[56:59], v[188:191], v[160:163], v[56:59]
    ds_read_b128 v[244:247], v1 offset:17408
    v_fma_f32 v253, v253, v7, v6
    v_mfma_f32_16x16x32_bf16 v[60:63], v[188:191], v[164:167], v[60:63]
    v_fma_f32 v254, v254, v7, v6
    v_fma_f32 v255, v255, v7, v6
    v_mfma_f32_16x16x32_bf16 v[64:67], v[192:195], v[160:163], v[64:67]
    v_mul_f32 v12, v12, v152
    v_mul_f32 v13, v13, v153
    v_mfma_f32_16x16x32_bf16 v[68:71], v[192:195], v[164:167], v[68:71]
    v_mul_f32 v14, v14, v154
    v_mul_f32 v15, v15, v155
    v_mfma_f32_16x16x32_bf16 v[72:75], v[196:199], v[160:163], v[72:75]
    v_mul_f32 v252, v252, v156
    v_mul_f32 v253, v253, v157
    v_mfma_f32_16x16x32_bf16 v[76:79], v[196:199], v[164:167], v[76:79]
    v_mul_f32 v254, v254, v158
    v_mul_f32 v255, v255, v159
    v_mfma_f32_16x16x32_bf16 v[80:83], v[200:203], v[160:163], v[80:83]
    v_exp_f32 v12, v12
    v_mfma_f32_16x16x32_bf16 v[84:87], v[200:203], v[164:167], v[84:87]
    v_exp_f32 v13, v13
    s_waitcnt lgkmcnt(0)
    s_barrier
    v_mfma_f32_16x16x32_bf16 v[16:19], v[212:215], v[204:207], v[16:19]
    ds_read_b128 v[160:163], v8 offset:36864
    v_mfma_f32_16x16x32_bf16 v[20:23], v[212:215], v[208:211], v[20:23]
    ds_read_b128 v[164:167], v8 offset:38912
    v_exp_f32 v14, v14
    v_mfma_f32_16x16x32_bf16 v[24:27], v[216:219], v[204:207], v[24:27]
    ds_read_b128 v[168:171], v1 offset:36864
    v_exp_f32 v15, v15
    v_mfma_f32_16x16x32_bf16 v[28:31], v[216:219], v[208:211], v[28:31]
    ds_read_b128 v[172:175], v1 offset:37888
    v_exp_f32 v252, v252
    v_mfma_f32_16x16x32_bf16 v[32:35], v[220:223], v[204:207], v[32:35]
    ds_read_b128 v[176:179], v1 offset:38912
    v_exp_f32 v253, v253
    v_mfma_f32_16x16x32_bf16 v[36:39], v[220:223], v[208:211], v[36:39]
    ds_read_b128 v[180:183], v1 offset:39936
    v_exp_f32 v254, v254
    v_mfma_f32_16x16x32_bf16 v[40:43], v[224:227], v[204:207], v[40:43]
    ds_read_b128 v[184:187], v1 offset:40960
    v_exp_f32 v255, v255
    v_mfma_f32_16x16x32_bf16 v[44:47], v[224:227], v[208:211], v[44:47]
    ds_read_b128 v[188:191], v1 offset:41984
    v_mfma_f32_16x16x32_bf16 v[48:51], v[228:231], v[204:207], v[48:51]
    ds_read_b128 v[192:195], v1 offset:43008
    v_fma_f32 v12, v12, v249, v249
    v_mfma_f32_16x16x32_bf16 v[52:55], v[228:231], v[208:211], v[52:55]
    ds_read_b128 v[196:199], v1 offset:44032
    v_fma_f32 v13, v13, v249, v249
    v_mfma_f32_16x16x32_bf16 v[56:59], v[232:235], v[204:207], v[56:59]
    ds_read_b128 v[200:203], v1 offset:45056
    v_fma_f32 v14, v14, v249, v249
    v_mfma_f32_16x16x32_bf16 v[60:63], v[232:235], v[208:211], v[60:63]
    v_fma_f32 v15, v15, v249, v249
    v_fma_f32 v252, v252, v251, v251
    v_mfma_f32_16x16x32_bf16 v[64:67], v[236:239], v[204:207], v[64:67]
    v_fma_f32 v253, v253, v251, v251
    v_fma_f32 v254, v254, v251, v251
    v_mfma_f32_16x16x32_bf16 v[68:71], v[236:239], v[208:211], v[68:71]
    v_fma_f32 v255, v255, v251, v251
    v_rcp_f32 v12, v12
    v_mfma_f32_16x16x32_bf16 v[72:75], v[240:243], v[204:207], v[72:75]
    v_rcp_f32 v13, v13
    v_mfma_f32_16x16x32_bf16 v[76:79], v[240:243], v[208:211], v[76:79]
    v_rcp_f32 v14, v14
    v_mfma_f32_16x16x32_bf16 v[80:83], v[244:247], v[204:207], v[80:83]
    v_rcp_f32 v15, v15
    v_mfma_f32_16x16x32_bf16 v[84:87], v[244:247], v[208:211], v[84:87]
    v_rcp_f32 v252, v252
    s_waitcnt lgkmcnt(5)
    v_mfma_f32_16x16x32_bf16 v[16:19], v[168:171], v[160:163], v[16:19]
    ds_read_b128 v[204:207], v9 offset:36864
    v_mfma_f32_16x16x32_bf16 v[20:23], v[168:171], v[164:167], v[20:23]
    ds_read_b128 v[208:211], v9 offset:38912
    v_rcp_f32 v253, v253
    v_mfma_f32_16x16x32_bf16 v[24:27], v[172:175], v[160:163], v[24:27]
    ds_read_b128 v[212:215], v1 offset:46080
    v_rcp_f32 v254, v254
    v_mfma_f32_16x16x32_bf16 v[28:31], v[172:175], v[164:167], v[28:31]
    ds_read_b128 v[216:219], v1 offset:47104
    v_rcp_f32 v255, v255
    v_mfma_f32_16x16x32_bf16 v[32:35], v[176:179], v[160:163], v[32:35]
    ds_read_b128 v[220:223], v1 offset:48128
    v_mul_f32 v152, v152, v12
    v_mfma_f32_16x16x32_bf16 v[36:39], v[176:179], v[164:167], v[36:39]
    ds_read_b128 v[224:227], v1 offset:49152
    v_mul_f32 v153, v153, v13
    v_mfma_f32_16x16x32_bf16 v[40:43], v[180:183], v[160:163], v[40:43]
    ds_read_b128 v[228:231], v1 offset:50176
    v_mul_f32 v154, v154, v14
    v_mfma_f32_16x16x32_bf16 v[44:47], v[180:183], v[164:167], v[44:47]
    ds_read_b128 v[232:235], v1 offset:51200
    s_waitcnt lgkmcnt(8)
    v_mfma_f32_16x16x32_bf16 v[48:51], v[184:187], v[160:163], v[48:51]
    ds_read_b128 v[236:239], v1 offset:52224
    v_mul_f32 v155, v155, v15
    v_mfma_f32_16x16x32_bf16 v[52:55], v[184:187], v[164:167], v[52:55]
    ds_read_b128 v[240:243], v1 offset:53248
    v_mul_f32 v156, v156, v252
    v_mfma_f32_16x16x32_bf16 v[56:59], v[188:191], v[160:163], v[56:59]
    ds_read_b128 v[244:247], v1 offset:54272
    v_mul_f32 v157, v157, v253
    v_mfma_f32_16x16x32_bf16 v[60:63], v[188:191], v[164:167], v[60:63]
    v_mul_f32 v158, v158, v254
    v_mul_f32 v159, v159, v255
    v_mfma_f32_16x16x32_bf16 v[64:67], v[192:195], v[160:163], v[64:67]
    s_mul_i32 s36, s31, 73728
    s_add_u32 s36, s36, s21
    v_mfma_f32_16x16x32_bf16 v[68:71], v[192:195], v[164:167], v[68:71]
    s_lshl_b32 s34, s24, 10
    s_lshl_b32 s35, s24, 9
    v_mfma_f32_16x16x32_bf16 v[72:75], v[196:199], v[160:163], v[72:75]
    s_add_u32 s35, s35, 65536
    v_add_u32 v14, s34, v1
    v_mfma_f32_16x16x32_bf16 v[76:79], v[196:199], v[164:167], v[76:79]
    v_lshrrev_b32 v15, 1, v1
    v_add_u32 v15, s35, v15
    v_mfma_f32_16x16x32_bf16 v[80:83], v[200:203], v[160:163], v[80:83]
    s_add_u32 s39, s36, 0x1200000
    s_add_u32 s40, s36, 0x1212000
    v_mfma_f32_16x16x32_bf16 v[84:87], v[200:203], v[164:167], v[84:87]
    s_waitcnt lgkmcnt(0)
    s_barrier
    v_mfma_f32_16x16x32_bf16 v[16:19], v[212:215], v[204:207], v[16:19]
    ds_read_b128 v[160:163], v10 offset:0
    v_mfma_f32_16x16x32_bf16 v[20:23], v[212:215], v[208:211], v[20:23]
    ds_read_b128 v[164:167], v10 offset:2048
    v_mfma_f32_16x16x32_bf16 v[24:27], v[216:219], v[204:207], v[24:27]
    ds_read_b128 v[168:171], v2 offset:0
    v_mfma_f32_16x16x32_bf16 v[28:31], v[216:219], v[208:211], v[28:31]
    ds_read_b128 v[172:175], v2 offset:1024
    v_mfma_f32_16x16x32_bf16 v[32:35], v[220:223], v[204:207], v[32:35]
    ds_read_b128 v[176:179], v2 offset:2048
    v_mfma_f32_16x16x32_bf16 v[36:39], v[220:223], v[208:211], v[36:39]
    ds_read_b128 v[180:183], v2 offset:3072
    v_mfma_f32_16x16x32_bf16 v[40:43], v[224:227], v[204:207], v[40:43]
    ds_read_b128 v[184:187], v2 offset:4096
    v_mfma_f32_16x16x32_bf16 v[44:47], v[224:227], v[208:211], v[44:47]
    ds_read_b128 v[188:191], v2 offset:5120
    v_mfma_f32_16x16x32_bf16 v[48:51], v[228:231], v[204:207], v[48:51]
    ds_read_b128 v[192:195], v2 offset:6144
    v_mfma_f32_16x16x32_bf16 v[52:55], v[228:231], v[208:211], v[52:55]
    ds_read_b128 v[196:199], v2 offset:7168
    v_mfma_f32_16x16x32_bf16 v[56:59], v[232:235], v[204:207], v[56:59]
    ds_read_b128 v[200:203], v2 offset:8192
    v_mfma_f32_16x16x32_bf16 v[60:63], v[232:235], v[208:211], v[60:63]
    v_mfma_f32_16x16x32_bf16 v[64:67], v[236:239], v[204:207], v[64:67]
    v_mfma_f32_16x16x32_bf16 v[68:71], v[236:239], v[208:211], v[68:71]
    v_mfma_f32_16x16x32_bf16 v[72:75], v[240:243], v[204:207], v[72:75]
    v_mfma_f32_16x16x32_bf16 v[76:79], v[240:243], v[208:211], v[76:79]
    v_mfma_f32_16x16x32_bf16 v[80:83], v[244:247], v[204:207], v[80:83]
    v_mfma_f32_16x16x32_bf16 v[84:87], v[244:247], v[208:211], v[84:87]
    s_mov_b32 s41, 6
    .p2align 6
L_g_loop:
    s_waitcnt lgkmcnt(5)
    v_mfma_f32_16x16x32_bf16 v[16:19], v[168:171], v[160:163], v[16:19]
    ds_read_b128 v[204:207], v11 offset:0
    v_mfma_f32_16x16x32_bf16 v[20:23], v[168:171], v[164:167], v[20:23]
    ds_read_b128 v[208:211], v11 offset:2048
    v_mfma_f32_16x16x32_bf16 v[24:27], v[172:175], v[160:163], v[24:27]
    ds_read_b128 v[212:215], v2 offset:9216
    v_mfma_f32_16x16x32_bf16 v[28:31], v[172:175], v[164:167], v[28:31]
    ds_read_b128 v[216:219], v2 offset:10240
    v_mfma_f32_16x16x32_bf16 v[32:35], v[176:179], v[160:163], v[32:35]
    ds_read_b128 v[220:223], v2 offset:11264
    v_mfma_f32_16x16x32_bf16 v[36:39], v[176:179], v[164:167], v[36:39]
    ds_read_b128 v[224:227], v2 offset:12288
    v_mfma_f32_16x16x32_bf16 v[40:43], v[180:183], v[160:163], v[40:43]
    ds_read_b128 v[228:231], v2 offset:13312
    v_mfma_f32_16x16x32_bf16 v[44:47], v[180:183], v[164:167], v[44:47]
    ds_read_b128 v[232:235], v2 offset:14336
    s_waitcnt lgkmcnt(8)
    v_mfma_f32_16x16x32_bf16 v[48:51], v[184:187], v[160:163], v[48:51]
    ds_read_b128 v[236:239], v2 offset:15360
    v_mfma_f32_16x16x32_bf16 v[52:55], v[184:187], v[164:167], v[52:55]
    ds_read_b128 v[240:243], v2 offset:16384
    v_mfma_f32_16x16x32_bf16 v[56:59], v[188:191], v[160:163], v[56:59]
    ds_read_b128 v[244:247], v2 offset:17408
    v_mfma_f32_16x16x32_bf16 v[60:63], v[188:191], v[164:167], v[60:63]
    v_mfma_f32_16x16x32_bf16 v[64:67], v[192:195], v[160:163], v[64:67]
    v_mfma_f32_16x16x32_bf16 v[68:71], v[192:195], v[164:167], v[68:71]
    v_mfma_f32_16x16x32_bf16 v[72:75], v[196:199], v[160:163], v[72:75]
    v_mfma_f32_16x16x32_bf16 v[76:79], v[196:199], v[164:167], v[76:79]
    v_mfma_f32_16x16x32_bf16 v[80:83], v[200:203], v[160:163], v[80:83]
    v_mfma_f32_16x16x32_bf16 v[84:87], v[200:203], v[164:167], v[84:87]
    s_waitcnt lgkmcnt(0)
    s_barrier
    v_mfma_f32_16x16x32_bf16 v[16:19], v[212:215], v[204:207], v[16:19]
    ds_read_b128 v[160:163], v10 offset:36864
    v_mfma_f32_16x16x32_bf16 v[20:23], v[212:215], v[208:211], v[20:23]
    ds_read_b128 v[164:167], v10 offset:38912
    v_mfma_f32_16x16x32_bf16 v[24:27], v[216:219], v[204:207], v[24:27]
    ds_read_b128 v[168:171], v2 offset:36864
    v_mfma_f32_16x16x32_bf16 v[28:31], v[216:219], v[208:211], v[28:31]
    ds_read_b128 v[172:175], v2 offset:37888
    v_mfma_f32_16x16x32_bf16 v[32:35], v[220:223], v[204:207], v[32:35]
    ds_read_b128 v[176:179], v2 offset:38912
    v_mfma_f32_16x16x32_bf16 v[36:39], v[220:223], v[208:211], v[36:39]
    ds_read_b128 v[180:183], v2 offset:39936
    v_mfma_f32_16x16x32_bf16 v[40:43], v[224:227], v[204:207], v[40:43]
    ds_read_b128 v[184:187], v2 offset:40960
    v_mfma_f32_16x16x32_bf16 v[44:47], v[224:227], v[208:211], v[44:47]
    ds_read_b128 v[188:191], v2 offset:41984
    v_mfma_f32_16x16x32_bf16 v[48:51], v[228:231], v[204:207], v[48:51]
    ds_read_b128 v[192:195], v2 offset:43008
    v_mfma_f32_16x16x32_bf16 v[52:55], v[228:231], v[208:211], v[52:55]
    ds_read_b128 v[196:199], v2 offset:44032
    v_mfma_f32_16x16x32_bf16 v[56:59], v[232:235], v[204:207], v[56:59]
    ds_read_b128 v[200:203], v2 offset:45056
    v_mfma_f32_16x16x32_bf16 v[60:63], v[232:235], v[208:211], v[60:63]
    v_mfma_f32_16x16x32_bf16 v[64:67], v[236:239], v[204:207], v[64:67]
    v_mfma_f32_16x16x32_bf16 v[68:71], v[236:239], v[208:211], v[68:71]
    v_mfma_f32_16x16x32_bf16 v[72:75], v[240:243], v[204:207], v[72:75]
    v_mfma_f32_16x16x32_bf16 v[76:79], v[240:243], v[208:211], v[76:79]
    v_mfma_f32_16x16x32_bf16 v[80:83], v[244:247], v[204:207], v[80:83]
    v_mfma_f32_16x16x32_bf16 v[84:87], v[244:247], v[208:211], v[84:87]
    s_waitcnt lgkmcnt(5)
    v_mfma_f32_16x16x32_bf16 v[16:19], v[168:171], v[160:163], v[16:19]
    ds_read_b128 v[204:207], v11 offset:36864
    v_mfma_f32_16x16x32_bf16 v[20:23], v[168:171], v[164:167], v[20:23]
    ds_read_b128 v[208:211], v11 offset:38912
    v_mfma_f32_16x16x32_bf16 v[24:27], v[172:175], v[160:163], v[24:27]
    ds_read_b128 v[212:215], v2 offset:46080
    v_mfma_f32_16x16x32_bf16 v[28:31], v[172:175], v[164:167], v[28:31]
    ds_read_b128 v[216:219], v2 offset:47104
    v_mfma_f32_16x16x32_bf16 v[32:35], v[176:179], v[160:163], v[32:35]
    ds_read_b128 v[220:223], v2 offset:48128
    v_mfma_f32_16x16x32_bf16 v[36:39], v[176:179], v[164:167], v[36:39]
    ds_read_b128 v[224:227], v2 offset:49152
    v_mfma_f32_16x16x32_bf16 v[40:43], v[180:183], v[160:163], v[40:43]
    ds_read_b128 v[228:231], v2 offset:50176
    v_mfma_f32_16x16x32_bf16 v[44:47], v[180:183], v[164:167], v[44:47]
    ds_read_b128 v[232:235], v2 offset:51200
    s_waitcnt lgkmcnt(8)
    v_mfma_f32_16x16x32_bf16 v[48:51], v[184:187], v[160:163], v[48:51]
    ds_read_b128 v[236:239], v2 offset:52224
    v_mfma_f32_16x16x32_bf16 v[52:55], v[184:187], v[164:167], v[52:55]
    ds_read_b128 v[240:243], v2 offset:53248
    v_mfma_f32_16x16x32_bf16 v[56:59], v[188:191], v[160:163], v[56:59]
    ds_read_b128 v[244:247], v2 offset:54272
    v_mfma_f32_16x16x32_bf16 v[60:63], v[188:191], v[164:167], v[60:63]
    v_mfma_f32_16x16x32_bf16 v[64:67], v[192:195], v[160:163], v[64:67]
    v_mfma_f32_16x16x32_bf16 v[68:71], v[192:195], v[164:167], v[68:71]
    v_mfma_f32_16x16x32_bf16 v[72:75], v[196:199], v[160:163], v[72:75]
    v_mfma_f32_16x16x32_bf16 v[76:79], v[196:199], v[164:167], v[76:79]
    v_mfma_f32_16x16x32_bf16 v[80:83], v[200:203], v[160:163], v[80:83]
    v_mfma_f32_16x16x32_bf16 v[84:87], v[200:203], v[164:167], v[84:87]
    s_waitcnt lgkmcnt(0)
    s_barrier
    v_mfma_f32_16x16x32_bf16 v[16:19], v[212:215], v[204:207], v[16:19]
    ds_read_b128 v[160:163], v8 offset:0
    v_mfma_f32_16x16x32_bf16 v[20:23], v[212:215], v[208:211], v[20:23]
    ds_read_b128 v[164:167], v8 offset:2048
    v_mfma_f32_16x16x32_bf16 v[24:27], v[216:219], v[204:207], v[24:27]
    ds_read_b128 v[168:171], v1 offset:0
    v_mfma_f32_16x16x32_bf16 v[28:31], v[216:219], v[208:211], v[28:31]
    ds_read_b128 v[172:175], v1 offset:1024
    v_mfma_f32_16x16x32_bf16 v[32:35], v[220:223], v[204:207], v[32:35]
    ds_read_b128 v[176:179], v1 offset:2048
    v_mfma_f32_16x16x32_bf16 v[36:39], v[220:223], v[208:211], v[36:39]
    ds_read_b128 v[180:183], v1 offset:3072
    v_mfma_f32_16x16x32_bf16 v[40:43], v[224:227], v[204:207], v[40:43]
    ds_read_b128 v[184:187], v1 offset:4096
    v_mfma_f32_16x16x32_bf16 v[44:47], v[224:227], v[208:211], v[44:47]
    ds_read_b128 v[188:191], v1 offset:5120
    v_mfma_f32_16x16x32_bf16 v[48:51], v[228:231], v[204:207], v[48:51]
    ds_read_b128 v[192:195], v1 offset:6144
    v_mfma_f32_16x16x32_bf16 v[52:55], v[228:231], v[208:211], v[52:55]
    ds_read_b128 v[196:199], v1 offset:7168
    v_mfma_f32_16x16x32_bf16 v[56:59], v[232:235], v[204:207], v[56:59]
    ds_read_b128 v[200:203], v1 offset:8192
    v_mfma_f32_16x16x32_bf16 v[60:63], v[232:235], v[208:211], v[60:63]
    v_mfma_f32_16x16x32_bf16 v[64:67], v[236:239], v[204:207], v[64:67]
    v_mfma_f32_16x16x32_bf16 v[68:71], v[236:239], v[208:211], v[68:71]
    v_mfma_f32_16x16x32_bf16 v[72:75], v[240:243], v[204:207], v[72:75]
    v_mfma_f32_16x16x32_bf16 v[76:79], v[240:243], v[208:211], v[76:79]
    v_mfma_f32_16x16x32_bf16 v[80:83], v[244:247], v[204:207], v[80:83]
    v_mfma_f32_16x16x32_bf16 v[84:87], v[244:247], v[208:211], v[84:87]
    s_waitcnt lgkmcnt(5)
    v_mfma_f32_16x16x32_bf16 v[16:19], v[168:171], v[160:163], v[16:19]
    ds_read_b128 v[204:207], v9 offset:0
    v_mfma_f32_16x16x32_bf16 v[20:23], v[168:171], v[164:167], v[20:23]
    ds_read_b128 v[208:211], v9 offset:2048
    v_mfma_f32_16x16x32_bf16 v[24:27], v[172:175], v[160:163], v[24:27]
    ds_read_b128 v[212:215], v1 offset:9216
    v_mfma_f32_16x16x32_bf16 v[28:31], v[172:175], v[164:167], v[28:31]
    ds_read_b128 v[216:219], v1 offset:10240
    v_mfma_f32_16x16x32_bf16 v[32:35], v[176:179], v[160:163], v[32:35]
    ds_read_b128 v[220:223], v1 offset:11264
    v_mfma_f32_16x16x32_bf16 v[36:39], v[176:179], v[164:167], v[36:39]
    ds_read_b128 v[224:227], v1 offset:12288
    v_mfma_f32_16x16x32_bf16 v[40:43], v[180:183], v[160:163], v[40:43]
    ds_read_b128 v[228:231], v1 offset:13312
    v_mfma_f32_16x16x32_bf16 v[44:47], v[180:183], v[164:167], v[44:47]
    ds_read_b128 v[232:235], v1 offset:14336
    s_waitcnt lgkmcnt(8)
    v_mfma_f32_16x16x32_bf16 v[48:51], v[184:187], v[160:163], v[48:51]
    ds_read_b128 v[236:239], v1 offset:15360
    v_mfma_f32_16x16x32_bf16 v[52:55], v[184:187], v[164:167], v[52:55]
    ds_read_b128 v[240:243], v1 offset:16384
    v_mfma_f32_16x16x32_bf16 v[56:59], v[188:191], v[160:163], v[56:59]
    ds_read_b128 v[244:247], v1 offset:17408
    v_mfma_f32_16x16x32_bf16 v[60:63], v[188:191], v[164:167], v[60:63]
    v_mfma_f32_16x16x32_bf16 v[64:67], v[192:195], v[160:163], v[64:67]
    v_mfma_f32_16x16x32_bf16 v[68:71], v[192:195], v[164:167], v[68:71]
    v_mfma_f32_16x16x32_bf16 v[72:75], v[196:199], v[160:163], v[72:75]
    v_mfma_f32_16x16x32_bf16 v[76:79], v[196:199], v[164:167], v[76:79]
    v_mfma_f32_16x16x32_bf16 v[80:83], v[200:203], v[160:163], v[80:83]
    v_mfma_f32_16x16x32_bf16 v[84:87], v[200:203], v[164:167], v[84:87]
    s_waitcnt lgkmcnt(0)
    s_barrier
    v_mfma_f32_16x16x32_bf16 v[16:19], v[212:215], v[204:207], v[16:19]
    ds_read_b128 v[160:163], v8 offset:36864
    v_mfma_f32_16x16x32_bf16 v[20:23], v[212:215], v[208:211], v[20:23]
    ds_read_b128 v[164:167], v8 offset:38912
    v_mfma_f32_16x16x32_bf16 v[24:27], v[216:219], v[204:207], v[24:27]
    ds_read_b128 v[168:171], v1 offset:36864
    v_mfma_f32_16x16x32_bf16 v[28:31], v[216:219], v[208:211], v[28:31]
    ds_read_b128 v[172:175], v1 offset:37888
    v_mfma_f32_16x16x32_bf16 v[32:35], v[220:223], v[204:207], v[32:35]
    ds_read_b128 v[176:179], v1 offset:38912
    v_mfma_f32_16x16x32_bf16 v[36:39], v[220:223], v[208:211], v[36:39]
    ds_read_b128 v[180:183], v1 offset:39936
    v_mfma_f32_16x16x32_bf16 v[40:43], v[224:227], v[204:207], v[40:43]
    ds_read_b128 v[184:187], v1 offset:40960
    v_mfma_f32_16x16x32_bf16 v[44:47], v[224:227], v[208:211], v[44:47]
    ds_read_b128 v[188:191], v1 offset:41984
    v_mfma_f32_16x16x32_bf16 v[48:51], v[228:231], v[204:207], v[48:51]
    ds_read_b128 v[192:195], v1 offset:43008
    v_mfma_f32_16x16x32_bf16 v[52:55], v[228:231], v[208:211], v[52:55]
    ds_read_b128 v[196:199], v1 offset:44032
    v_mfma_f32_16x16x32_bf16 v[56:59], v[232:235], v[204:207], v[56:59]
    ds_read_b128 v[200:203], v1 offset:45056
    v_mfma_f32_16x16x32_bf16 v[60:63], v[232:235], v[208:211], v[60:63]
    v_mfma_f32_16x16x32_bf16 v[64:67], v[236:239], v[204:207], v[64:67]
    v_mfma_f32_16x16x32_bf16 v[68:71], v[236:239], v[208:211], v[68:71]
    v_mfma_f32_16x16x32_bf16 v[72:75], v[240:243], v[204:207], v[72:75]
    v_mfma_f32_16x16x32_bf16 v[76:79], v[240:243], v[208:211], v[76:79]
    v_mfma_f32_16x16x32_bf16 v[80:83], v[244:247], v[204:207], v[80:83]
    v_mfma_f32_16x16x32_bf16 v[84:87], v[244:247], v[208:211], v[84:87]
    s_waitcnt lgkmcnt(5)
    v_mfma_f32_16x16x32_bf16 v[16:19], v[168:171], v[160:163], v[16:19]
    ds_read_b128 v[204:207], v9 offset:36864
    v_mfma_f32_16x16x32_bf16 v[20:23], v[168:171], v[164:167], v[20:23]
    ds_read_b128 v[208:211], v9 offset:38912
    v_mfma_f32_16x16x32_bf16 v[24:27], v[172:175], v[160:163], v[24:27]
    ds_read_b128 v[212:215], v1 offset:46080
    v_mfma_f32_16x16x32_bf16 v[28:31], v[172:175], v[164:167], v[28:31]
    ds_read_b128 v[216:219], v1 offset:47104
    v_mfma_f32_16x16x32_bf16 v[32:35], v[176:179], v[160:163], v[32:35]
    ds_read_b128 v[220:223], v1 offset:48128
    v_mfma_f32_16x16x32_bf16 v[36:39], v[176:179], v[164:167], v[36:39]
    ds_read_b128 v[224:227], v1 offset:49152
    v_mfma_f32_16x16x32_bf16 v[40:43], v[180:183], v[160:163], v[40:43]
    ds_read_b128 v[228:231], v1 offset:50176
    v_mfma_f32_16x16x32_bf16 v[44:47], v[180:183], v[164:167], v[44:47]
    ds_read_b128 v[232:235], v1 offset:51200
    s_waitcnt lgkmcnt(8)
    v_mfma_f32_16x16x32_bf16 v[48:51], v[184:187], v[160:163], v[48:51]
    ds_read_b128 v[236:239], v1 offset:52224
    v_mfma_f32_16x16x32_bf16 v[52:55], v[184:187], v[164:167], v[52:55]
    ds_read_b128 v[240:243], v1 offset:53248
    v_mfma_f32_16x16x32_bf16 v[56:59], v[188:191], v[160:163], v[56:59]
    ds_read_b128 v[244:247], v1 offset:54272
    v_mfma_f32_16x16x32_bf16 v[60:63], v[188:191], v[164:167], v[60:63]
    v_mfma_f32_16x16x32_bf16 v[64:67], v[192:195], v[160:163], v[64:67]
    v_mfma_f32_16x16x32_bf16 v[68:71], v[192:195], v[164:167], v[68:71]
    v_mfma_f32_16x16x32_bf16 v[72:75], v[196:199], v[160:163], v[72:75]
    v_mfma_f32_16x16x32_bf16 v[76:79], v[196:199], v[164:167], v[76:79]
    v_mfma_f32_16x16x32_bf16 v[80:83], v[200:203], v[160:163], v[80:83]
    v_mfma_f32_16x16x32_bf16 v[84:87], v[200:203], v[164:167], v[84:87]
    s_waitcnt lgkmcnt(0)
    s_barrier
    v_mfma_f32_16x16x32_bf16 v[16:19], v[212:215], v[204:207], v[16:19]
    ds_read_b128 v[160:163], v10 offset:0
    v_mfma_f32_16x16x32_bf16 v[20:23], v[212:215], v[208:211], v[20:23]
    ds_read_b128 v[164:167], v10 offset:2048
    v_mfma_f32_16x16x32_bf16 v[24:27], v[216:219], v[204:207], v[24:27]
    ds_read_b128 v[168:171], v2 offset:0
    v_mfma_f32_16x16x32_bf16 v[28:31], v[216:219], v[208:211], v[28:31]
    ds_read_b128 v[172:175], v2 offset:1024
    v_mfma_f32_16x16x32_bf16 v[32:35], v[220:223], v[204:207], v[32:35]
    ds_read_b128 v[176:179], v2 offset:2048
    v_mfma_f32_16x16x32_bf16 v[36:39], v[220:223], v[208:211], v[36:39]
    ds_read_b128 v[180:183], v2 offset:3072
    v_mfma_f32_16x16x32_bf16 v[40:43], v[224:227], v[204:207], v[40:43]
    ds_read_b128 v[184:187], v2 offset:4096
    v_mfma_f32_16x16x32_bf16 v[44:47], v[224:227], v[208:211], v[44:47]
    ds_read_b128 v[188:191], v2 offset:5120
    v_mfma_f32_16x16x32_bf16 v[48:51], v[228:231], v[204:207], v[48:51]
    ds_read_b128 v[192:195], v2 offset:6144
    v_mfma_f32_16x16x32_bf16 v[52:55], v[228:231], v[208:211], v[52:55]
    ds_read_b128 v[196:199], v2 offset:7168
    v_mfma_f32_16x16x32_bf16 v[56:59], v[232:235], v[204:207], v[56:59]
    ds_read_b128 v[200:203], v2 offset:8192
    v_mfma_f32_16x16x32_bf16 v[60:63], v[232:235], v[208:211], v[60:63]
    v_mfma_f32_16x16x32_bf16 v[64:67], v[236:239], v[204:207], v[64:67]
    v_mfma_f32_16x16x32_bf16 v[68:71], v[236:239], v[208:211], v[68:71]
    v_mfma_f32_16x16x32_bf16 v[72:75], v[240:243], v[204:207], v[72:75]
    v_mfma_f32_16x16x32_bf16 v[76:79], v[240:243], v[208:211], v[76:79]
    v_mfma_f32_16x16x32_bf16 v[80:83], v[244:247], v[204:207], v[80:83]
    s_sub_u32 s41, s41, 1
    v_mfma_f32_16x16x32_bf16 v[84:87], v[244:247], v[208:211], v[84:87]
    s_cmp_lg_u32 s41, 0
    s_cbranch_scc1 L_g_loop
    s_waitcnt lgkmcnt(5)
    v_mfma_f32_16x16x32_bf16 v[16:19], v[168:171], v[160:163], v[16:19]
    ds_read_b128 v[204:207], v11 offset:0
    v_mfma_f32_16x16x32_bf16 v[20:23], v[168:171], v[164:167], v[20:23]
    ds_read_b128 v[208:211], v11 offset:2048
    v_mfma_f32_16x16x32_bf16 v[24:27], v[172:175], v[160:163], v[24:27]
    ds_read_b128 v[212:215], v2 offset:9216
    v_mfma_f32_16x16x32_bf16 v[28:31], v[172:175], v[164:167], v[28:31]
    ds_read_b128 v[216:219], v2 offset:10240
    v_mfma_f32_16x16x32_bf16 v[32:35], v[176:179], v[160:163], v[32:35]
    ds_read_b128 v[220:223], v2 offset:11264
    v_mfma_f32_16x16x32_bf16 v[36:39], v[176:179], v[164:167], v[36:39]
    ds_read_b128 v[224:227], v2 offset:12288
    v_mfma_f32_16x16x32_bf16 v[40:43], v[180:183], v[160:163], v[40:43]
    ds_read_b128 v[228:231], v2 offset:13312
    v_mfma_f32_16x16x32_bf16 v[44:47], v[180:183], v[164:167], v[44:47]
    ds_read_b128 v[232:235], v2 offset:14336
    s_waitcnt lgkmcnt(8)
    v_mfma_f32_16x16x32_bf16 v[48:51], v[184:187], v[160:163], v[48:51]
    ds_read_b128 v[236:239], v2 offset:15360
    v_mfma_f32_16x16x32_bf16 v[52:55], v[184:187], v[164:167], v[52:55]
    ds_read_b128 v[240:243], v2 offset:16384
    v_mfma_f32_16x16x32_bf16 v[56:59], v[188:191], v[160:163], v[56:59]
    ds_read_b128 v[244:247], v2 offset:17408
    v_mfma_f32_16x16x32_bf16 v[60:63], v[188:191], v[164:167], v[60:63]
    v_mfma_f32_16x16x32_bf16 v[64:67], v[192:195], v[160:163], v[64:67]
    v_mfma_f32_16x16x32_bf16 v[68:71], v[192:195], v[164:167], v[68:71]
    v_mfma_f32_16x16x32_bf16 v[72:75], v[196:199], v[160:163], v[72:75]
    v_mfma_f32_16x16x32_bf16 v[76:79], v[196:199], v[164:167], v[76:79]
    v_mfma_f32_16x16x32_bf16 v[80:83], v[200:203], v[160:163], v[80:83]
    v_mfma_f32_16x16x32_bf16 v[84:87], v[200:203], v[164:167], v[84:87]
    s_waitcnt lgkmcnt(0)
    s_barrier
    v_mfma_f32_16x16x32_bf16 v[16:19], v[212:215], v[204:207], v[16:19]
    ds_read_b128 v[160:163], v10 offset:36864
    v_mfma_f32_16x16x32_bf16 v[20:23], v[212:215], v[208:211], v[20:23]
    ds_read_b128 v[164:167], v10 offset:38912
    v_mfma_f32_16x16x32_bf16 v[24:27], v[216:219], v[204:207], v[24:27]
    ds_read_b128 v[168:171], v2 offset:36864
    v_mfma_f32_16x16x32_bf16 v[28:31], v[216:219], v[208:211], v[28:31]
    ds_read_b128 v[172:175], v2 offset:37888
    v_mfma_f32_16x16x32_bf16 v[32:35], v[220:223], v[204:207], v[32:35]
    ds_read_b128 v[176:179], v2 offset:38912
    v_mfma_f32_16x16x32_bf16 v[36:39], v[220:223], v[208:211], v[36:39]
    ds_read_b128 v[180:183], v2 offset:39936
    v_mfma_f32_16x16x32_bf16 v[40:43], v[224:227], v[204:207], v[40:43]
    ds_read_b128 v[184:187], v2 offset:40960
    v_mfma_f32_16x16x32_bf16 v[44:47], v[224:227], v[208:211], v[44:47]
    ds_read_b128 v[188:191], v2 offset:41984
    v_mfma_f32_16x16x32_bf16 v[48:51], v[228:231], v[204:207], v[48:51]
    ds_read_b128 v[192:195], v2 offset:43008
    v_mfma_f32_16x16x32_bf16 v[52:55], v[228:231], v[208:211], v[52:55]
    ds_read_b128 v[196:199], v2 offset:44032
    v_mfma_f32_16x16x32_bf16 v[56:59], v[232:235], v[204:207], v[56:59]
    ds_read_b128 v[200:203], v2 offset:45056
    v_mfma_f32_16x16x32_bf16 v[60:63], v[232:235], v[208:211], v[60:63]
    v_mfma_f32_16x16x32_bf16 v[64:67], v[236:239], v[204:207], v[64:67]
    v_mfma_f32_16x16x32_bf16 v[68:71], v[236:239], v[208:211], v[68:71]
    v_mfma_f32_16x16x32_bf16 v[72:75], v[240:243], v[204:207], v[72:75]
    v_mfma_f32_16x16x32_bf16 v[76:79], v[240:243], v[208:211], v[76:79]
    v_mfma_f32_16x16x32_bf16 v[80:83], v[244:247], v[204:207], v[80:83]
    v_mfma_f32_16x16x32_bf16 v[84:87], v[244:247], v[208:211], v[84:87]
    s_waitcnt lgkmcnt(5)
    v_mfma_f32_16x16x32_bf16 v[16:19], v[168:171], v[160:163], v[16:19]
    ds_read_b128 v[204:207], v11 offset:36864
    v_mfma_f32_16x16x32_bf16 v[20:23], v[168:171], v[164:167], v[20:23]
    ds_read_b128 v[208:211], v11 offset:38912
    v_mfma_f32_16x16x32_bf16 v[24:27], v[172:175], v[160:163], v[24:27]
    ds_read_b128 v[212:215], v2 offset:46080
    v_mfma_f32_16x16x32_bf16 v[28:31], v[172:175], v[164:167], v[28:31]
    ds_read_b128 v[216:219], v2 offset:47104
    v_mfma_f32_16x16x32_bf16 v[32:35], v[176:179], v[160:163], v[32:35]
    ds_read_b128 v[220:223], v2 offset:48128
    v_mfma_f32_16x16x32_bf16 v[36:39], v[176:179], v[164:167], v[36:39]
    ds_read_b128 v[224:227], v2 offset:49152
    v_mfma_f32_16x16x32_bf16 v[40:43], v[180:183], v[160:163], v[40:43]
    ds_read_b128 v[228:231], v2 offset:50176
    v_mfma_f32_16x16x32_bf16 v[44:47], v[180:183], v[164:167], v[44:47]
    ds_read_b128 v[232:235], v2 offset:51200
    s_waitcnt lgkmcnt(8)
    v_mfma_f32_16x16x32_bf16 v[48:51], v[184:187], v[160:163], v[48:51]
    ds_read_b128 v[236:239], v2 offset:52224
    v_mfma_f32_16x16x32_bf16 v[52:55], v[184:187], v[164:167], v[52:55]
    ds_read_b128 v[240:243], v2 offset:53248
    v_mfma_f32_16x16x32_bf16 v[56:59], v[188:191], v[160:163], v[56:59]
    ds_read_b128 v[244:247], v2 offset:54272
    v_mfma_f32_16x16x32_bf16 v[60:63], v[188:191], v[164:167], v[60:63]
    v_mfma_f32_16x16x32_bf16 v[64:67], v[192:195], v[160:163], v[64:67]
    v_mfma_f32_16x16x32_bf16 v[68:71], v[192:195], v[164:167], v[68:71]
    v_mfma_f32_16x16x32_bf16 v[72:75], v[196:199], v[160:163], v[72:75]
    v_mfma_f32_16x16x32_bf16 v[76:79], v[196:199], v[164:167], v[76:79]
    v_mfma_f32_16x16x32_bf16 v[80:83], v[200:203], v[160:163], v[80:83]
    v_mfma_f32_16x16x32_bf16 v[84:87], v[200:203], v[164:167], v[84:87]
    s_waitcnt lgkmcnt(0)
    s_barrier
    v_mfma_f32_16x16x32_bf16 v[16:19], v[212:215], v[204:207], v[16:19]
    ds_read_b128 v[160:163], v8 offset:0
    v_mfma_f32_16x16x32_bf16 v[20:23], v[212:215], v[208:211], v[20:23]
    ds_read_b128 v[164:167], v8 offset:2048
    v_mfma_f32_16x16x32_bf16 v[24:27], v[216:219], v[204:207], v[24:27]
    ds_read_b128 v[192:195], v1 offset:0
    v_mfma_f32_16x16x32_bf16 v[28:31], v[216:219], v[208:211], v[28:31]
    ds_read_b128 v[168:171], v9 offset:0
    v_mfma_f32_16x16x32_bf16 v[32:35], v[220:223], v[204:207], v[32:35]
    ds_read_b128 v[172:175], v9 offset:2048
    v_mfma_f32_16x16x32_bf16 v[36:39], v[220:223], v[208:211], v[36:39]
    ds_read_b128 v[176:179], v8 offset:36864
    v_mfma_f32_16x16x32_bf16 v[40:43], v[224:227], v[204:207], v[40:43]
    ds_read_b128 v[180:183], v8 offset:38912
    v_mfma_f32_16x16x32_bf16 v[44:47], v[224:227], v[208:211], v[44:47]
    ds_read_b128 v[184:187], v9 offset:36864
    v_mfma_f32_16x16x32_bf16 v[48:51], v[228:231], v[204:207], v[48:51]
    ds_read_b128 v[188:191], v9 offset:38912
    v_mfma_f32_16x16x32_bf16 v[52:55], v[228:231], v[208:211], v[52:55]
    ds_read_b128 v[196:199], v1 offset:9216
    v_mfma_f32_16x16x32_bf16 v[56:59], v[232:235], v[204:207], v[56:59]
    ds_read_b128 v[200:203], v1 offset:36864
    v_mfma_f32_16x16x32_bf16 v[60:63], v[232:235], v[208:211], v[60:63]
    v_mfma_f32_16x16x32_bf16 v[64:67], v[236:239], v[204:207], v[64:67]
    v_mfma_f32_16x16x32_bf16 v[68:71], v[236:239], v[208:211], v[68:71]
    v_mfma_f32_16x16x32_bf16 v[72:75], v[240:243], v[204:207], v[72:75]
    v_mfma_f32_16x16x32_bf16 v[76:79], v[240:243], v[208:211], v[76:79]
    v_mfma_f32_16x16x32_bf16 v[80:83], v[244:247], v[204:207], v[80:83]
    v_mfma_f32_16x16x32_bf16 v[84:87], v[244:247], v[208:211], v[84:87]
    s_waitcnt lgkmcnt(0)
    v_mfma_f32_16x16x32_bf16 v[16:19], v[192:195], v[160:163], v[16:19]
    ds_read_b128 v[204:207], v1 offset:46080
    v_mfma_f32_16x16x32_bf16 v[20:23], v[192:195], v[164:167], v[20:23]
    ds_read_b128 v[208:211], v1 offset:1024
    s_waitcnt lgkmcnt(3)
    v_mfma_f32_16x16x32_bf16 v[16:19], v[196:199], v[168:171], v[16:19]
    ds_read_b128 v[212:215], v1 offset:10240
    v_mfma_f32_16x16x32_bf16 v[20:23], v[196:199], v[172:175], v[20:23]
    ds_read_b128 v[216:219], v1 offset:37888
    s_waitcnt lgkmcnt(4)
    v_mfma_f32_16x16x32_bf16 v[16:19], v[200:203], v[176:179], v[16:19]
    ds_read_b128 v[220:223], v1 offset:47104
    v_mfma_f32_16x16x32_bf16 v[20:23], v[200:203], v[180:183], v[20:23]
    ds_read_b128 v[224:227], v1 offset:2048
    s_waitcnt lgkmcnt(5)
    v_mfma_f32_16x16x32_bf16 v[16:19], v[204:207], v[184:187], v[16:19]
    ds_read_b128 v[228:231], v1 offset:11264
    v_mfma_f32_16x16x32_bf16 v[20:23], v[204:207], v[188:191], v[20:23]
    ds_read_b128 v[232:235], v1 offset:38912
    s_waitcnt lgkmcnt(6)
    v_mfma_f32_16x16x32_bf16 v[24:27], v[208:211], v[160:163], v[24:27]
    ds_read_b128 v[236:239], v1 offset:48128
    v_mfma_f32_16x16x32_bf16 v[28:31], v[208:211], v[164:167], v[28:31]
    ds_read_b128 v[240:243], v1 offset:3072
    s_waitcnt lgkmcnt(7)
    v_mfma_f32_16x16x32_bf16 v[24:27], v[212:215], v[168:171], v[24:27]
    ds_read_b128 v[244:247], v1 offset:12288
    v_mfma_f32_16x16x32_bf16 v[28:31], v[212:215], v[172:175], v[28:31]
    s_waitcnt lgkmcnt(7)
    v_mfma_f32_16x16x32_bf16 v[24:27], v[216:219], v[176:179], v[24:27]
    ds_read_b128 v[192:195], v1 offset:39936
    v_mul_f32 v16, v16, v88
    v_mfma_f32_16x16x32_bf16 v[28:31], v[216:219], v[180:183], v[28:31]
    v_mul_f32 v17, v17, v89
    v_mul_f32 v18, v18, v90
    s_waitcnt lgkmcnt(7)
    v_mfma_f32_16x16x32_bf16 v[24:27], v[220:223], v[184:187], v[24:27]
    ds_read_b128 v[196:199], v1 offset:49152
    v_mul_f32 v19, v19, v91
    v_mfma_f32_16x16x32_bf16 v[28:31], v[220:223], v[188:191], v[28:31]
    v_cvt_pk_bf16_f32 v88, v16, v17
    v_cvt_pk_bf16_f32 v89, v18, v19
    s_waitcnt lgkmcnt(7)
    v_mfma_f32_16x16x32_bf16 v[32:35], v[224:227], v[160:163], v[32:35]
    ds_read_b128 v[200:203], v1 offset:4096
    v_mul_f32 v20, v20, v92
    v_mfma_f32_16x16x32_bf16 v[36:39], v[224:227], v[164:167], v[36:39]
    v_mul_f32 v21, v21, v93
    v_mul_f32 v22, v22, v94
    s_waitcnt lgkmcnt(7)
    v_mfma_f32_16x16x32_bf16 v[32:35], v[228:231], v[168:171], v[32:35]
    ds_read_b128 v[204:207], v1 offset:13312
    v_mul_f32 v23, v23, v95
    v_mfma_f32_16x16x32_bf16 v[36:39], v[228:231], v[172:175], v[36:39]
    v_cvt_pk_bf16_f32 v92, v20, v21
    v_cvt_pk_bf16_f32 v93, v22, v23
    s_waitcnt lgkmcnt(7)
    v_mfma_f32_16x16x32_bf16 v[32:35], v[232:235], v[176:179], v[32:35]
    ds_read_b128 v[208:211], v1 offset:40960
    v_mul_f32 v24, v24, v96
    v_mfma_f32_16x16x32_bf16 v[36:39], v[232:235], v[180:183], v[36:39]
    v_mul_f32 v25, v25, v97
    v_mul_f32 v26, v26, v98
    v_mul_f32 v27, v27, v99
    s_waitcnt lgkmcnt(7)
    v_mfma_f32_16x16x32_bf16 v[32:35], v[236:239], v[184:187], v[32:35]
    ds_read_b128 v[212:215], v1 offset:50176
    v_cvt_pk_bf16_f32 v90, v24, v25
    v_mfma_f32_16x16x32_bf16 v[36:39], v[236:239], v[188:191], v[36:39]
    v_cvt_pk_bf16_f32 v91, v26, v27
    buffer_store_dwordx4 v[88:91], v14, s[4:7], s39 offen sc1
    s_waitcnt lgkmcnt(7)
    v_mfma_f32_16x16x32_bf16 v[40:43], v[240:243], v[160:163], v[40:43]
    ds_read_b128 v[216:219], v1 offset:5120
    v_mul_f32 v28, v28, v100
    v_mfma_f32_16x16x32_bf16 v[44:47], v[240:243], v[164:167], v[44:47]
    v_mul_f32 v29, v29, v101
    v_mul_f32 v30, v30, v102
    s_waitcnt lgkmcnt(7)
    v_mfma_f32_16x16x32_bf16 v[40:43], v[244:247], v[168:171], v[40:43]
    ds_read_b128 v[220:223], v1 offset:14336
    v_mul_f32 v31, v31, v103
    v_mfma_f32_16x16x32_bf16 v[44:47], v[244:247], v[172:175], v[44:47]
    v_cvt_pk_bf16_f32 v94, v28, v29
    v_cvt_pk_bf16_f32 v95, v30, v31
    s_waitcnt lgkmcnt(7)
    v_mfma_f32_16x16x32_bf16 v[40:43], v[192:195], v[176:179], v[40:43]
    ds_read_b128 v[224:227], v1 offset:41984
    buffer_store_dwordx4 v[92:95], v14, s[4:7], s40 offen sc1
    v_mfma_f32_16x16x32_bf16 v[44:47], v[192:195], v[180:183], v[44:47]
    v_add_u32 v14, 16384, v14
    v_mul_f32 v32, v32, v104
    v_mul_f32 v33, v33, v105
    s_waitcnt lgkmcnt(7)
    v_mfma_f32_16x16x32_bf16 v[40:43], v[196:199], v[184:187], v[40:43]
    ds_read_b128 v[228:231], v1 offset:51200
    v_mul_f32 v34, v34, v106
    v_mfma_f32_16x16x32_bf16 v[44:47], v[196:199], v[188:191], v[44:47]
    v_mul_f32 v35, v35, v107
    v_cvt_pk_bf16_f32 v104, v32, v33
    s_waitcnt lgkmcnt(7)
    v_mfma_f32_16x16x32_bf16 v[48:51], v[200:203], v[160:163], v[48:51]
    ds_read_b128 v[232:235], v1 offset:6144
    v_cvt_pk_bf16_f32 v105, v34, v35
    v_mfma_f32_16x16x32_bf16 v[52:55], v[200:203], v[164:167], v[52:55]
    v_mul_f32 v36, v36, v108
    v_mul_f32 v37, v37, v109
    s_waitcnt lgkmcnt(7)
    v_mfma_f32_16x16x32_bf16 v[48:51], v[204:207], v[168:171], v[48:51]
    ds_read_b128 v[236:239], v1 offset:15360
    v_mul_f32 v38, v38, v110
    v_mfma_f32_16x16x32_bf16 v[52:55], v[204:207], v[172:175], v[52:55]
    v_mul_f32 v39, v39, v111
    v_cvt_pk_bf16_f32 v108, v36, v37
    s_waitcnt lgkmcnt(7)
    v_mfma_f32_16x16x32_bf16 v[48:51], v[208:211], v[176:179], v[48:51]
    ds_read_b128 v[240:243], v1 offset:43008
    v_cvt_pk_bf16_f32 v109, v38, v39
    v_mfma_f32_16x16x32_bf16 v[52:55], v[208:211], v[180:183], v[52:55]
    v_mul_f32 v40, v40, v112
    v_mul_f32 v41, v41, v113
    v_mul_f32 v42, v42, v114
    s_waitcnt lgkmcnt(7)
    v_mfma_f32_16x16x32_bf16 v[48:51], v[212:215], v[184:187], v[48:51]
    ds_read_b128 v[244:247], v1 offset:52224
    v_mul_f32 v43, v43, v115
    v_mfma_f32_16x16x32_bf16 v[52:55], v[212:215], v[188:191], v[52:55]
    v_cvt_pk_bf16_f32 v106, v40, v41
    v_cvt_pk_bf16_f32 v107, v42, v43
    s_waitcnt lgkmcnt(7)
    v_mfma_f32_16x16x32_bf16 v[56:59], v[216:219], v[160:163], v[56:59]
    ds_read_b128 v[192:195], v1 offset:7168
    buffer_store_dwordx4 v[104:107], v14, s[4:7], s39 offen sc1
    v_mfma_f32_16x16x32_bf16 v[60:63], v[216:219], v[164:167], v[60:63]
    v_mul_f32 v44, v44, v116
    v_mul_f32 v45, v45, v117
    s_waitcnt lgkmcnt(7)
    v_mfma_f32_16x16x32_bf16 v[56:59], v[220:223], v[168:171], v[56:59]
    ds_read_b128 v[196:199], v1 offset:16384
    v_mul_f32 v46, v46, v118
    v_mfma_f32_16x16x32_bf16 v[60:63], v[220:223], v[172:175], v[60:63]
    v_mul_f32 v47, v47, v119
    v_cvt_pk_bf16_f32 v110, v44, v45
    s_waitcnt lgkmcnt(7)
    v_mfma_f32_16x16x32_bf16 v[56:59], v[224:227], v[176:179], v[56:59]
    ds_read_b128 v[200:203], v1 offset:44032
    v_cvt_pk_bf16_f32 v111, v46, v47
    v_mfma_f32_16x16x32_bf16 v[60:63], v[224:227], v[180:183], v[60:63]
    buffer_store_dwordx4 v[108:111], v14, s[4:7], s40 offen sc1
    v_add_u32 v14, 16384, v14
    v_mul_f32 v48, v48, v120
    s_waitcnt lgkmcnt(7)
    v_mfma_f32_16x16x32_bf16 v[56:59], v[228:231], v[184:187], v[56:59]
    ds_read_b128 v[204:207], v1 offset:53248
    v_mul_f32 v49, v49, v121
    v_mfma_f32_16x16x32_bf16 v[60:63], v[228:231], v[188:191], v[60:63]
    v_mul_f32 v50, v50, v122
    v_mul_f32 v51, v51, v123
    s_waitcnt lgkmcnt(7)
    v_mfma_f32_16x16x32_bf16 v[64:67], v[232:235], v[160:163], v[64:67]
    ds_read_b128 v[208:211], v1 offset:8192
    v_cvt_pk_bf16_f32 v120, v48, v49
    v_mfma_f32_16x16x32_bf16 v[68:71], v[232:235], v[164:167], v[68:71]
    v_cvt_pk_bf16_f32 v121, v50, v51
    v_mul_f32 v52, v52, v124
    s_waitcnt lgkmcnt(7)
    v_mfma_f32_16x16x32_bf16 v[64:67], v[236:239], v[168:171], v[64:67]
    ds_read_b128 v[212:215], v1 offset:17408
    v_mul_f32 v53, v53, v125
    v_mfma_f32_16x16x32_bf16 v[68:71], v[236:239], v[172:175], v[68:71]
    v_mul_f32 v54, v54, v126
    v_mul_f32 v55, v55, v127
    s_waitcnt lgkmcnt(7)
    v_mfma_f32_16x16x32_bf16 v[64:67], v[240:243], v[176:179], v[64:67]
    ds_read_b128 v[216:219], v1 offset:45056
    v_cvt_pk_bf16_f32 v124, v52, v53
    v_mfma_f32_16x16x32_bf16 v[68:71], v[240:243], v[180:183], v[68:71]
    v_cvt_pk_bf16_f32 v125, v54, v55
    v_mul_f32 v56, v56, v128
    v_mul_f32 v57, v57, v129
    s_waitcnt lgkmcnt(7)
    v_mfma_f32_16x16x32_bf16 v[64:67], v[244:247], v[184:187], v[64:67]
    ds_read_b128 v[220:223], v1 offset:54272
    v_mul_f32 v58, v58, v130
    v_mfma_f32_16x16x32_bf16 v[68:71], v[244:247], v[188:191], v[68:71]
    v_mul_f32 v59, v59, v131
    v_cvt_pk_bf16_f32 v122, v56, v57
    v_cvt_pk_bf16_f32 v123, v58, v59
    s_waitcnt lgkmcnt(7)
    v_mfma_f32_16x16x32_bf16 v[72:75], v[192:195], v[160:163], v[72:75]
    buffer_store_dwordx4 v[120:123], v14, s[4:7], s39 offen sc1
    v_mul_f32 v60, v60, v132
    v_mfma_f32_16x16x32_bf16 v[76:79], v[192:195], v[164:167], v[76:79]
    v_mul_f32 v61, v61, v133
    v_mul_f32 v62, v62, v134
    s_waitcnt lgkmcnt(6)
    v_mfma_f32_16x16x32_bf16 v[72:75], v[196:199], v[168:171], v[72:75]
    v_mul_f32 v63, v63, v135
    v_cvt_pk_bf16_f32 v126, v60, v61
    v_mfma_f32_16x16x32_bf16 v[76:79], v[196:199], v[172:175], v[76:79]
    v_cvt_pk_bf16_f32 v127, v62, v63
    buffer_store_dwordx4 v[124:127], v14, s[4:7], s40 offen sc1
    s_waitcnt lgkmcnt(5)
    v_mfma_f32_16x16x32_bf16 v[72:75], v[200:203], v[176:179], v[72:75]
    v_add_u32 v14, 16384, v14
    v_mul_f32 v64, v64, v136
    v_mfma_f32_16x16x32_bf16 v[76:79], v[200:203], v[180:183], v[76:79]
    v_mul_f32 v65, v65, v137
    v_mul_f32 v66, v66, v138
    v_mul_f32 v67, v67, v139
    s_waitcnt lgkmcnt(4)
    v_mfma_f32_16x16x32_bf16 v[72:75], v[204:207], v[184:187], v[72:75]
    v_cvt_pk_bf16_f32 v136, v64, v65
    v_cvt_pk_bf16_f32 v137, v66, v67
    v_mfma_f32_16x16x32_bf16 v[76:79], v[204:207], v[188:191], v[76:79]
    v_mul_f32 v68, v68, v140
    v_mul_f32 v69, v69, v141
    s_waitcnt lgkmcnt(3)
    v_mfma_f32_16x16x32_bf16 v[80:83], v[208:211], v[160:163], v[80:83]
    v_mul_f32 v70, v70, v142
    v_mul_f32 v71, v71, v143
    v_mfma_f32_16x16x32_bf16 v[84:87], v[208:211], v[164:167], v[84:87]
    v_cvt_pk_bf16_f32 v140, v68, v69
    v_cvt_pk_bf16_f32 v141, v70, v71
    s_waitcnt lgkmcnt(2)
    v_mfma_f32_16x16x32_bf16 v[80:83], v[212:215], v[168:171], v[80:83]
    v_mfma_f32_16x16x32_bf16 v[84:87], v[212:215], v[172:175], v[84:87]
    s_waitcnt lgkmcnt(1)
    v_mfma_f32_16x16x32_bf16 v[80:83], v[216:219], v[176:179], v[80:83]
    v_mul_f32 v72, v72, v144
    v_mul_f32 v73, v73, v145
    v_mfma_f32_16x16x32_bf16 v[84:87], v[216:219], v[180:183], v[84:87]
    v_mul_f32 v74, v74, v146
    v_mul_f32 v75, v75, v147
    v_cvt_pk_bf16_f32 v138, v72, v73
    s_waitcnt lgkmcnt(0)
    v_mfma_f32_16x16x32_bf16 v[80:83], v[220:223], v[184:187], v[80:83]
    v_cvt_pk_bf16_f32 v139, v74, v75
    buffer_store_dwordx4 v[136:139], v14, s[4:7], s39 offen sc1
    v_mfma_f32_16x16x32_bf16 v[84:87], v[220:223], v[188:191], v[84:87]
    v_mul_f32 v76, v76, v148
    v_mul_f32 v77, v77, v149
    v_mul_f32 v78, v78, v150
    v_mul_f32 v79, v79, v151
    v_cvt_pk_bf16_f32 v142, v76, v77
    v_cvt_pk_bf16_f32 v143, v78, v79
    buffer_store_dwordx4 v[140:143], v14, s[4:7], s40 offen sc1
    s_nop 1
    v_mul_f32 v80, v80, v152
    v_mul_f32 v81, v81, v153
    v_mul_f32 v82, v82, v154
    v_mul_f32 v83, v83, v155
    v_cvt_pk_bf16_f32 v152, v80, v81
    v_cvt_pk_bf16_f32 v153, v82, v83
    buffer_store_dwordx2 v[152:153], v15, s[4:7], s39 offen sc1
    v_mul_f32 v84, v84, v156
    v_mul_f32 v85, v85, v157
    v_mul_f32 v86, v86, v158
    v_mul_f32 v87, v87, v159
    v_cvt_pk_bf16_f32 v156, v84, v85
    v_cvt_pk_bf16_f32 v157, v86, v87
    buffer_store_dwordx2 v[156:157], v15, s[4:7], s40 offen sc1
    s_barrier
    s_and_b32 s25, s2, 7
    s_lshr_b32 s26, s2, 3
    s_lshr_b32 s23, s25, 1
    s_lshl_b32 s23, s23, 3
    s_lshr_b32 s27, s26, 2
    s_add_u32 s23, s23, s27
    s_and_b32 s24, s25, 1
    s_lshl_b32 s24, s24, 2
    s_and_b32 s27, s26, 3
    s_add_u32 s24, s24, s27
    s_add_u32 s25, s23, s24
    s_and_b32 s25, s25, 3
    s_lshl_b32 s30, s23, 2
    s_add_u32 s30, s30, s20
    s_mul_i32 s29, s30, 73728
    s_add_u32 s29, s29, s21
    s_add_u32 s29, s29, 0x1200000
    s_mul_i32 s34, s30, 18432
    s_add_u32 s34, s34, s21
    s_add_u32 s34, s34, 0x300000
    s_lshl_b32 s35, s24, 11
    s_lshr_b32 s36, s24, 2
    s_lshl_b32 s36, s36, 10
    s_and_b32 s37, s24, 3
    s_lshl_b32 s37, s37, 8
    s_add_u32 s36, s36, s37
    s_add_u32 s36, s36, 16384
    v_bfe_u32 v2, v1, 4, 4
    v_lshrrev_b32 v3, 8, v1
    v_add_u32 v4, s35, v1
    v_lshlrev_b32 v5, 4, v2
    v_lshl_add_u32 v5, v3, 3, v5
    v_add_u32 v5, s36, v5
    v_cmp_gt_u32 s[40:41], 2, v3
    v_bfrev_b32 v6, 1
    v_add_u32 v12, 0, v1
    v_add_u32 v13, 36864, v1
    v_add_u32 v14, 73728, v1
    v_add_u32 v15, 110592, v1
    v_cndmask_b32 v5, v6, v5, s[40:41]
    buffer_load_dwordx4 v[208:211], v4, s[4:7], s34 offen offset:0 sc1
    buffer_load_dwordx4 v[212:215], v4, s[4:7], s34 offen offset:1024 sc1
    buffer_load_dwordx2 v[216:217], v5, s[4:7], s34 offen sc1
    s_add_u32 s34, s34, 0x1900000
    s_lshl_b32 s39, s30, 10
    s_add_u32 s39, s39, s21
    s_lshl_b32 s42, s24, 7
    s_add_u32 s39, s39, s42
    s_add_u32 s39, s39, 0x3700000
    v_cmp_eq_u32 vcc, 0, v3
    v_lshlrev_b32 v10, 3, v2
    v_mov_b32 v11, 0x3f803f80
    v_lshrrev_b32 v7, 1, v1
    v_cndmask_b32 v10, v6, v10, vcc
    s_cmp_eq_u32 s22, 0
    s_cbranch_scc1 L_p5_nf
    v_mul_u32_u24 v9, 1152, v2
    s_mul_i32 s34, s30, 18432
    s_mul_i32 s42, s24, 144
    s_add_u32 s34, s34, s42
    v_lshl_add_u32 v4, v3, 4, v9
    v_lshl_add_u32 v5, v3, 3, v9
    v_cndmask_b32 v5, v6, v5, s[40:41]
L_p5_nf:
    s_lshr_b32 s44, s23, 1
    s_lshl_b32 s52, s22, 7
    s_add_u32 s52, s52, s44
    s_lshl_b32 s52, s52, 8
    s_add_u32 s52, s52, 0x450a000
    s_add_u32 s52, s52, s4
    s_addc_u32 s53, s5, 0
    s_waitcnt vmcnt(3)
    s_barrier
    s_cmp_lg_u32 s20, 0
    s_cbranch_scc1 L_ns_d5
    s_mov_b32 s56, 1
    s_atomic_add s56, s[50:51], 0
L_ns_d5:
    s_cmp_lg_u32 s20, 0
    s_cbranch_scc1 L_pd_d5
    s_mov_b32 s60, 65536
L_poll_d5:
    s_mov_b32 s57, 0
    s_atomic_add s57, s[52:53], 0 glc
    s_waitcnt lgkmcnt(0)
    s_cmp_ge_u32 s57, 16
    s_cbranch_scc1 L_pd_d5
    s_sub_u32 s60, s60, 1
    s_cbranch_scc1 L_pd_d5
    s_sleep 2
    s_branch L_poll_d5
L_pd_d5:
    s_barrier
    s_mov_b32 s32, 0
    s_lshl_b32 s32, s32, 13
    s_add_u32 s32, s32, s29
    s_add_u32 s33, s32, 4096
    buffer_load_dwordx4 v[112:115], v1, s[4:7], s32 offen offset:0 sc1
    buffer_load_dwordx4 v[116:119], v1, s[4:7], s32 offen offset:1024 sc1
    buffer_load_dwordx4 v[120:123], v1, s[4:7], s32 offen offset:2048 sc1
    buffer_load_dwordx4 v[124:127], v1, s[4:7], s32 offen offset:3072 sc1
    buffer_load_dwordx4 v[128:131], v1, s[4:7], s33 offen offset:0 sc1
    buffer_load_dwordx4 v[132:135], v1, s[4:7], s33 offen offset:1024 sc1
    buffer_load_dwordx4 v[136:139], v1, s[4:7], s33 offen offset:2048 sc1
    buffer_load_dwordx4 v[140:143], v1, s[4:7], s33 offen offset:3072 sc1
    ds_read_b128 v[40:43], v14 offset:0
    ds_read_b128 v[44:47], v14 offset:1024
    ds_read_b128 v[48:51], v14 offset:2048
    ds_read_b128 v[52:55], v14 offset:3072
    ds_read_b128 v[72:75], v14 offset:8192
    ds_read_b128 v[56:59], v14 offset:4096
    ds_read_b128 v[60:63], v14 offset:5120
    ds_read_b128 v[64:67], v14 offset:6144
    ds_read_b128 v[68:71], v14 offset:7168
    s_mov_b32 s32, 1
    s_lshl_b32 s32, s32, 13
    s_add_u32 s32, s32, s29
    s_add_u32 s33, s32, 4096
    buffer_load_dwordx4 v[144:147], v1, s[4:7], s32 offen offset:0 sc1
    buffer_load_dwordx4 v[148:151], v1, s[4:7], s32 offen offset:1024 sc1
    buffer_load_dwordx4 v[152:155], v1, s[4:7], s32 offen offset:2048 sc1
    buffer_load_dwordx4 v[156:159], v1, s[4:7], s32 offen offset:3072 sc1
    buffer_load_dwordx4 v[160:163], v1, s[4:7], s33 offen offset:0 sc1
    buffer_load_dwordx4 v[164:167], v1, s[4:7], s33 offen offset:1024 sc1
    buffer_load_dwordx4 v[168:171], v1, s[4:7], s33 offen offset:2048 sc1
    buffer_load_dwordx4 v[172:175], v1, s[4:7], s33 offen offset:3072 sc1
    s_lshl_b32 s50, s22, 7
    s_add_u32 s50, s50, s44
    s_lshl_b32 s50, s50, 8
    s_add_u32 s50, s50, 0x450b000
    s_add_u32 s50, s50, s4
    s_addc_u32 s51, s5, 0
    s_waitcnt vmcnt(16)
    v_lshlrev_b32 v16, 16, v208
    v_and_b32 v17, 0xffff0000, v208
    v_lshlrev_b32 v18, 16, v209
    v_and_b32 v19, 0xffff0000, v209
    v_lshlrev_b32 v20, 16, v210
    v_and_b32 v21, 0xffff0000, v210
    v_lshlrev_b32 v22, 16, v211
    v_and_b32 v23, 0xffff0000, v211
    v_lshlrev_b32 v24, 16, v212
    v_and_b32 v25, 0xffff0000, v212
    v_lshlrev_b32 v26, 16, v213
    v_and_b32 v27, 0xffff0000, v213
    v_lshlrev_b32 v28, 16, v214
    v_and_b32 v29, 0xffff0000, v214
    v_lshlrev_b32 v30, 16, v215
    v_and_b32 v31, 0xffff0000, v215
    v_lshlrev_b32 v32, 16, v216
    v_and_b32 v33, 0xffff0000, v216
    v_lshlrev_b32 v34, 16, v217
    v_and_b32 v35, 0xffff0000, v217
    s_waitcnt vmcnt(14) lgkmcnt(4)
    v_mfma_f32_16x16x32_bf16 v[16:19], v[40:43], v[112:115], v[16:19]
    ds_read_b128 v[76:79], v14 offset:9216
    s_mov_b32 s32, 2
    s_lshl_b32 s32, s32, 13
    s_add_u32 s32, s32, s29
    s_add_u32 s33, s32, 4096
    v_mfma_f32_16x16x32_bf16 v[20:23], v[44:47], v[112:115], v[20:23]
    ds_read_b128 v[80:83], v14 offset:10240
    v_mfma_f32_16x16x32_bf16 v[24:27], v[48:51], v[112:115], v[24:27]
    ds_read_b128 v[84:87], v14 offset:11264
    buffer_load_dwordx4 v[176:179], v1, s[4:7], s32 offen offset:0 sc1
    v_mfma_f32_16x16x32_bf16 v[28:31], v[52:55], v[112:115], v[28:31]
    ds_read_b128 v[88:91], v14 offset:12288
    v_mfma_f32_16x16x32_bf16 v[32:35], v[72:75], v[112:115], v[32:35]
    ds_read_b128 v[108:111], v14 offset:17408
    s_waitcnt lgkmcnt(5)
    v_mfma_f32_16x16x32_bf16 v[16:19], v[56:59], v[116:119], v[16:19]
    ds_read_b128 v[92:95], v14 offset:13312
    v_mfma_f32_16x16x32_bf16 v[20:23], v[60:63], v[116:119], v[20:23]
    ds_read_b128 v[96:99], v14 offset:14336
    buffer_load_dwordx4 v[180:183], v1, s[4:7], s32 offen offset:1024 sc1
    v_mfma_f32_16x16x32_bf16 v[24:27], v[64:67], v[116:119], v[24:27]
    ds_read_b128 v[100:103], v14 offset:15360
    v_mfma_f32_16x16x32_bf16 v[28:31], v[68:71], v[116:119], v[28:31]
    ds_read_b128 v[104:107], v14 offset:16384
    v_mfma_f32_16x16x32_bf16 v[36:39], v[72:75], v[116:119], 0
    s_waitcnt vmcnt(14) lgkmcnt(4)
    v_mfma_f32_16x16x32_bf16 v[16:19], v[76:79], v[120:123], v[16:19]
    ds_read_b128 v[40:43], v14 offset:18432
    v_mfma_f32_16x16x32_bf16 v[20:23], v[80:83], v[120:123], v[20:23]
    ds_read_b128 v[44:47], v14 offset:19456
    v_mfma_f32_16x16x32_bf16 v[24:27], v[84:87], v[120:123], v[24:27]
    ds_read_b128 v[48:51], v14 offset:20480
    buffer_load_dwordx4 v[184:187], v1, s[4:7], s32 offen offset:2048 sc1
    v_mfma_f32_16x16x32_bf16 v[28:31], v[88:91], v[120:123], v[28:31]
    ds_read_b128 v[52:55], v14 offset:21504
    v_mfma_f32_16x16x32_bf16 v[32:35], v[108:111], v[120:123], v[32:35]
    ds_read_b128 v[72:75], v14 offset:26624
    s_waitcnt lgkmcnt(5)
    v_mfma_f32_16x16x32_bf16 v[16:19], v[92:95], v[124:127], v[16:19]
    ds_read_b128 v[56:59], v14 offset:22528
    v_mfma_f32_16x16x32_bf16 v[20:23], v[96:99], v[124:127], v[20:23]
    ds_read_b128 v[60:63], v14 offset:23552
    buffer_load_dwordx4 v[188:191], v1, s[4:7], s32 offen offset:3072 sc1
    v_mfma_f32_16x16x32_bf16 v[24:27], v[100:103], v[124:127], v[24:27]
    ds_read_b128 v[64:67], v14 offset:24576
    v_mfma_f32_16x16x32_bf16 v[28:31], v[104:107], v[124:127], v[28:31]
    ds_read_b128 v[68:71], v14 offset:25600
    v_mfma_f32_16x16x32_bf16 v[36:39], v[108:111], v[124:127], v[36:39]
    s_waitcnt vmcnt(14) lgkmcnt(4)
    v_mfma_f32_16x16x32_bf16 v[16:19], v[40:43], v[128:131], v[16:19]
    ds_read_b128 v[76:79], v14 offset:27648
    v_mfma_f32_16x16x32_bf16 v[20:23], v[44:47], v[128:131], v[20:23]
    ds_read_b128 v[80:83], v14 offset:28672
    v_mfma_f32_16x16x32_bf16 v[24:27], v[48:51], v[128:131], v[24:27]
    ds_read_b128 v[84:87], v14 offset:29696
    buffer_load_dwordx4 v[192:195], v1, s[4:7], s33 offen offset:0 sc1
    v_mfma_f32_16x16x32_bf16 v[28:31], v[52:55], v[128:131], v[28:31]
    ds_read_b128 v[88:91], v14 offset:30720
    v_mfma_f32_16x16x32_bf16 v[32:35], v[72:75], v[128:131], v[32:35]
    ds_read_b128 v[108:111], v14 offset:35840
    s_waitcnt lgkmcnt(5)
    v_mfma_f32_16x16x32_bf16 v[16:19], v[56:59], v[132:135], v[16:19]
    ds_read_b128 v[92:95], v14 offset:31744
    v_mfma_f32_16x16x32_bf16 v[20:23], v[60:63], v[132:135], v[20:23]
    ds_read_b128 v[96:99], v14 offset:32768
    buffer_load_dwordx4 v[196:199], v1, s[4:7], s33 offen offset:1024 sc1
    v_mfma_f32_16x16x32_bf16 v[24:27], v[64:67], v[132:135], v[24:27]
    ds_read_b128 v[100:103], v14 offset:33792
    v_mfma_f32_16x16x32_bf16 v[28:31], v[68:71], v[132:135], v[28:31]
    ds_read_b128 v[104:107], v14 offset:34816
    v_mfma_f32_16x16x32_bf16 v[36:39], v[72:75], v[132:135], v[36:39]
    s_waitcnt vmcnt(14) lgkmcnt(0)
    s_barrier
    v_mfma_f32_16x16x32_bf16 v[16:19], v[76:79], v[136:139], v[16:19]
    ds_read_b128 v[40:43], v15 offset:0
    v_mfma_f32_16x16x32_bf16 v[20:23], v[80:83], v[136:139], v[20:23]
    ds_read_b128 v[44:47], v15 offset:1024
    v_mfma_f32_16x16x32_bf16 v[24:27], v[84:87], v[136:139], v[24:27]
    ds_read_b128 v[48:51], v15 offset:2048
    buffer_load_dwordx4 v[200:203], v1, s[4:7], s33 offen offset:2048 sc1
    v_mfma_f32_16x16x32_bf16 v[28:31], v[88:91], v[136:139], v[28:31]
    ds_read_b128 v[52:55], v15 offset:3072
    v_mfma_f32_16x16x32_bf16 v[32:35], v[108:111], v[136:139], v[32:35]
    ds_read_b128 v[72:75], v15 offset:8192
    v_mfma_f32_16x16x32_bf16 v[16:19], v[92:95], v[140:143], v[16:19]
    ds_read_b128 v[56:59], v15 offset:4096
    v_mfma_f32_16x16x32_bf16 v[20:23], v[96:99], v[140:143], v[20:23]
    ds_read_b128 v[60:63], v15 offset:5120
    buffer_load_dwordx4 v[204:207], v1, s[4:7], s33 offen offset:3072 sc1
    v_mfma_f32_16x16x32_bf16 v[24:27], v[100:103], v[140:143], v[24:27]
    ds_read_b128 v[64:67], v15 offset:6144
    v_mfma_f32_16x16x32_bf16 v[28:31], v[104:107], v[140:143], v[28:31]
    ds_read_b128 v[68:71], v15 offset:7168
    v_mfma_f32_16x16x32_bf16 v[36:39], v[108:111], v[140:143], v[36:39]
    s_waitcnt vmcnt(14) lgkmcnt(4)
    v_mfma_f32_16x16x32_bf16 v[16:19], v[40:43], v[144:147], v[16:19]
    ds_read_b128 v[76:79], v15 offset:9216
    s_mov_b32 s32, 3
    s_lshl_b32 s32, s32, 13
    s_add_u32 s32, s32, s29
    s_add_u32 s33, s32, 4096
    v_mfma_f32_16x16x32_bf16 v[20:23], v[44:47], v[144:147], v[20:23]
    ds_read_b128 v[80:83], v15 offset:10240
    v_mfma_f32_16x16x32_bf16 v[24:27], v[48:51], v[144:147], v[24:27]
    ds_read_b128 v[84:87], v15 offset:11264
    buffer_load_dwordx4 v[112:115], v1, s[4:7], s32 offen offset:0 sc1
    v_mfma_f32_16x16x32_bf16 v[28:31], v[52:55], v[144:147], v[28:31]
    ds_read_b128 v[88:91], v15 offset:12288
    v_mfma_f32_16x16x32_bf16 v[32:35], v[72:75], v[144:147], v[32:35]
    ds_read_b128 v[108:111], v15 offset:17408
    s_waitcnt lgkmcnt(5)
    v_mfma_f32_16x16x32_bf16 v[16:19], v[56:59], v[148:151], v[16:19]
    ds_read_b128 v[92:95], v15 offset:13312
    v_mfma_f32_16x16x32_bf16 v[20:23], v[60:63], v[148:151], v[20:23]
    ds_read_b128 v[96:99], v15 offset:14336
    buffer_load_dwordx4 v[116:119], v1, s[4:7], s32 offen offset:1024 sc1
    v_mfma_f32_16x16x32_bf16 v[24:27], v[64:67], v[148:151], v[24:27]
    ds_read_b128 v[100:103], v15 offset:15360
    v_mfma_f32_16x16x32_bf16 v[28:31], v[68:71], v[148:151], v[28:31]
    ds_read_b128 v[104:107], v15 offset:16384
    v_mfma_f32_16x16x32_bf16 v[36:39], v[72:75], v[148:151], v[36:39]
    s_waitcnt vmcnt(14) lgkmcnt(4)
    v_mfma_f32_16x16x32_bf16 v[16:19], v[76:79], v[152:155], v[16:19]
    ds_read_b128 v[40:43], v15 offset:18432
    v_mfma_f32_16x16x32_bf16 v[20:23], v[80:83], v[152:155], v[20:23]
    ds_read_b128 v[44:47], v15 offset:19456
    v_mfma_f32_16x16x32_bf16 v[24:27], v[84:87], v[152:155], v[24:27]
    ds_read_b128 v[48:51], v15 offset:20480
    buffer_load_dwordx4 v[120:123], v1, s[4:7], s32 offen offset:2048 sc1
    v_mfma_f32_16x16x32_bf16 v[28:31], v[88:91], v[152:155], v[28:31]
    ds_read_b128 v[52:55], v15 offset:21504
    v_mfma_f32_16x16x32_bf16 v[32:35], v[108:111], v[152:155], v[32:35]
    ds_read_b128 v[72:75], v15 offset:26624
    s_waitcnt lgkmcnt(5)
    v_mfma_f32_16x16x32_bf16 v[16:19], v[92:95], v[156:159], v[16:19]
    ds_read_b128 v[56:59], v15 offset:22528
    v_mfma_f32_16x16x32_bf16 v[20:23], v[96:99], v[156:159], v[20:23]
    ds_read_b128 v[60:63], v15 offset:23552
    buffer_load_dwordx4 v[124:127], v1, s[4:7], s32 offen offset:3072 sc1
    v_mfma_f32_16x16x32_bf16 v[24:27], v[100:103], v[156:159], v[24:27]
    ds_read_b128 v[64:67], v15 offset:24576
    v_mfma_f32_16x16x32_bf16 v[28:31], v[104:107], v[156:159], v[28:31]
    ds_read_b128 v[68:71], v15 offset:25600
    v_mfma_f32_16x16x32_bf16 v[36:39], v[108:111], v[156:159], v[36:39]
    s_waitcnt vmcnt(14) lgkmcnt(4)
    v_mfma_f32_16x16x32_bf16 v[16:19], v[40:43], v[160:163], v[16:19]
    ds_read_b128 v[76:79], v15 offset:27648
    v_mfma_f32_16x16x32_bf16 v[20:23], v[44:47], v[160:163], v[20:23]
    ds_read_b128 v[80:83], v15 offset:28672
    v_mfma_f32_16x16x32_bf16 v[24:27], v[48:51], v[160:163], v[24:27]
    ds_read_b128 v[84:87], v15 offset:29696
    buffer_load_dwordx4 v[128:131], v1, s[4:7], s33 offen offset:0 sc1
    v_mfma_f32_16x16x32_bf16 v[28:31], v[52:55], v[160:163], v[28:31]
    ds_read_b128 v[88:91], v15 offset:30720
    v_mfma_f32_16x16x32_bf16 v[32:35], v[72:75], v[160:163], v[32:35]
    ds_read_b128 v[108:111], v15 offset:35840
    s_waitcnt lgkmcnt(5)
    v_mfma_f32_16x16x32_bf16 v[16:19], v[56:59], v[164:167], v[16:19]
    ds_read_b128 v[92:95], v15 offset:31744
    v_mfma_f32_16x16x32_bf16 v[20:23], v[60:63], v[164:167], v[20:23]
    ds_read_b128 v[96:99], v15 offset:32768
    buffer_load_dwordx4 v[132:135], v1, s[4:7], s33 offen offset:1024 sc1
    v_mfma_f32_16x16x32_bf16 v[24:27], v[64:67], v[164:167], v[24:27]
    ds_read_b128 v[100:103], v15 offset:33792
    v_mfma_f32_16x16x32_bf16 v[28:31], v[68:71], v[164:167], v[28:31]
    ds_read_b128 v[104:107], v15 offset:34816
    v_mfma_f32_16x16x32_bf16 v[36:39], v[72:75], v[164:167], v[36:39]
    s_waitcnt vmcnt(14) lgkmcnt(0)
    s_barrier
    v_mfma_f32_16x16x32_bf16 v[16:19], v[76:79], v[168:171], v[16:19]
    ds_read_b128 v[40:43], v12 offset:0
    v_mfma_f32_16x16x32_bf16 v[20:23], v[80:83], v[168:171], v[20:23]
    ds_read_b128 v[44:47], v12 offset:1024
    v_mfma_f32_16x16x32_bf16 v[24:27], v[84:87], v[168:171], v[24:27]
    ds_read_b128 v[48:51], v12 offset:2048
    buffer_load_dwordx4 v[136:139], v1, s[4:7], s33 offen offset:2048 sc1
    v_mfma_f32_16x16x32_bf16 v[28:31], v[88:91], v[168:171], v[28:31]
    ds_read_b128 v[52:55], v12 offset:3072
    v_mfma_f32_16x16x32_bf16 v[32:35], v[108:111], v[168:171], v[32:35]
    ds_read_b128 v[72:75], v12 offset:8192
    v_mfma_f32_16x16x32_bf16 v[16:19], v[92:95], v[172:175], v[16:19]
    ds_read_b128 v[56:59], v12 offset:4096
    v_mfma_f32_16x16x32_bf16 v[20:23], v[96:99], v[172:175], v[20:23]
    ds_read_b128 v[60:63], v12 offset:5120
    buffer_load_dwordx4 v[140:143], v1, s[4:7], s33 offen offset:3072 sc1
    v_mfma_f32_16x16x32_bf16 v[24:27], v[100:103], v[172:175], v[24:27]
    ds_read_b128 v[64:67], v12 offset:6144
    v_mfma_f32_16x16x32_bf16 v[28:31], v[104:107], v[172:175], v[28:31]
    ds_read_b128 v[68:71], v12 offset:7168
    v_mfma_f32_16x16x32_bf16 v[36:39], v[108:111], v[172:175], v[36:39]
    s_waitcnt vmcnt(14) lgkmcnt(4)
    v_mfma_f32_16x16x32_bf16 v[16:19], v[40:43], v[176:179], v[16:19]
    ds_read_b128 v[76:79], v12 offset:9216
    s_mov_b32 s32, 4
    s_lshl_b32 s32, s32, 13
    s_add_u32 s32, s32, s29
    s_add_u32 s33, s32, 4096
    v_mfma_f32_16x16x32_bf16 v[20:23], v[44:47], v[176:179], v[20:23]
    ds_read_b128 v[80:83], v12 offset:10240
    v_mfma_f32_16x16x32_bf16 v[24:27], v[48:51], v[176:179], v[24:27]
    ds_read_b128 v[84:87], v12 offset:11264
    buffer_load_dwordx4 v[144:147], v1, s[4:7], s32 offen offset:0 sc1
    v_mfma_f32_16x16x32_bf16 v[28:31], v[52:55], v[176:179], v[28:31]
    ds_read_b128 v[88:91], v12 offset:12288
    v_mfma_f32_16x16x32_bf16 v[32:35], v[72:75], v[176:179], v[32:35]
    ds_read_b128 v[108:111], v12 offset:17408
    s_waitcnt lgkmcnt(5)
    v_mfma_f32_16x16x32_bf16 v[16:19], v[56:59], v[180:183], v[16:19]
    ds_read_b128 v[92:95], v12 offset:13312
    v_mfma_f32_16x16x32_bf16 v[20:23], v[60:63], v[180:183], v[20:23]
    ds_read_b128 v[96:99], v12 offset:14336
    buffer_load_dwordx4 v[148:151], v1, s[4:7], s32 offen offset:1024 sc1
    v_mfma_f32_16x16x32_bf16 v[24:27], v[64:67], v[180:183], v[24:27]
    ds_read_b128 v[100:103], v12 offset:15360
    v_mfma_f32_16x16x32_bf16 v[28:31], v[68:71], v[180:183], v[28:31]
    ds_read_b128 v[104:107], v12 offset:16384
    v_mfma_f32_16x16x32_bf16 v[36:39], v[72:75], v[180:183], v[36:39]
    s_waitcnt vmcnt(14) lgkmcnt(4)
    v_mfma_f32_16x16x32_bf16 v[16:19], v[76:79], v[184:187], v[16:19]
    ds_read_b128 v[40:43], v12 offset:18432
    v_mfma_f32_16x16x32_bf16 v[20:23], v[80:83], v[184:187], v[20:23]
    ds_read_b128 v[44:47], v12 offset:19456
    v_mfma_f32_16x16x32_bf16 v[24:27], v[84:87], v[184:187], v[24:27]
    ds_read_b128 v[48:51], v12 offset:20480
    buffer_load_dwordx4 v[152:155], v1, s[4:7], s32 offen offset:2048 sc1
    v_mfma_f32_16x16x32_bf16 v[28:31], v[88:91], v[184:187], v[28:31]
    ds_read_b128 v[52:55], v12 offset:21504
    v_mfma_f32_16x16x32_bf16 v[32:35], v[108:111], v[184:187], v[32:35]
    ds_read_b128 v[72:75], v12 offset:26624
    s_waitcnt lgkmcnt(5)
    v_mfma_f32_16x16x32_bf16 v[16:19], v[92:95], v[188:191], v[16:19]
    ds_read_b128 v[56:59], v12 offset:22528
    v_mfma_f32_16x16x32_bf16 v[20:23], v[96:99], v[188:191], v[20:23]
    ds_read_b128 v[60:63], v12 offset:23552
    buffer_load_dwordx4 v[156:159], v1, s[4:7], s32 offen offset:3072 sc1
    v_mfma_f32_16x16x32_bf16 v[24:27], v[100:103], v[188:191], v[24:27]
    ds_read_b128 v[64:67], v12 offset:24576
    v_mfma_f32_16x16x32_bf16 v[28:31], v[104:107], v[188:191], v[28:31]
    ds_read_b128 v[68:71], v12 offset:25600
    v_mfma_f32_16x16x32_bf16 v[36:39], v[108:111], v[188:191], v[36:39]
    s_waitcnt vmcnt(14) lgkmcnt(4)
    v_mfma_f32_16x16x32_bf16 v[16:19], v[40:43], v[192:195], v[16:19]
    ds_read_b128 v[76:79], v12 offset:27648
    v_mfma_f32_16x16x32_bf16 v[20:23], v[44:47], v[192:195], v[20:23]
    ds_read_b128 v[80:83], v12 offset:28672
    v_mfma_f32_16x16x32_bf16 v[24:27], v[48:51], v[192:195], v[24:27]
    ds_read_b128 v[84:87], v12 offset:29696
    buffer_load_dwordx4 v[160:163], v1, s[4:7], s33 offen offset:0 sc1
    v_mfma_f32_16x16x32_bf16 v[28:31], v[52:55], v[192:195], v[28:31]
    ds_read_b128 v[88:91], v12 offset:30720
    v_mfma_f32_16x16x32_bf16 v[32:35], v[72:75], v[192:195], v[32:35]
    ds_read_b128 v[108:111], v12 offset:35840
    s_waitcnt lgkmcnt(5)
    v_mfma_f32_16x16x32_bf16 v[16:19], v[56:59], v[196:199], v[16:19]
    ds_read_b128 v[92:95], v12 offset:31744
    v_mfma_f32_16x16x32_bf16 v[20:23], v[60:63], v[196:199], v[20:23]
    ds_read_b128 v[96:99], v12 offset:32768
    buffer_load_dwordx4 v[164:167], v1, s[4:7], s33 offen offset:1024 sc1
    v_mfma_f32_16x16x32_bf16 v[24:27], v[64:67], v[196:199], v[24:27]
    ds_read_b128 v[100:103], v12 offset:33792
    v_mfma_f32_16x16x32_bf16 v[28:31], v[68:71], v[196:199], v[28:31]
    ds_read_b128 v[104:107], v12 offset:34816
    v_mfma_f32_16x16x32_bf16 v[36:39], v[72:75], v[196:199], v[36:39]
    s_waitcnt vmcnt(14) lgkmcnt(0)
    s_barrier
    v_mfma_f32_16x16x32_bf16 v[16:19], v[76:79], v[200:203], v[16:19]
    ds_read_b128 v[40:43], v13 offset:0
    v_mfma_f32_16x16x32_bf16 v[20:23], v[80:83], v[200:203], v[20:23]
    ds_read_b128 v[44:47], v13 offset:1024
    v_mfma_f32_16x16x32_bf16 v[24:27], v[84:87], v[200:203], v[24:27]
    ds_read_b128 v[48:51], v13 offset:2048
    buffer_load_dwordx4 v[168:171], v1, s[4:7], s33 offen offset:2048 sc1
    v_mfma_f32_16x16x32_bf16 v[28:31], v[88:91], v[200:203], v[28:31]
    ds_read_b128 v[52:55], v13 offset:3072
    v_mfma_f32_16x16x32_bf16 v[32:35], v[108:111], v[200:203], v[32:35]
    ds_read_b128 v[72:75], v13 offset:8192
    v_mfma_f32_16x16x32_bf16 v[16:19], v[92:95], v[204:207], v[16:19]
    ds_read_b128 v[56:59], v13 offset:4096
    v_mfma_f32_16x16x32_bf16 v[20:23], v[96:99], v[204:207], v[20:23]
    ds_read_b128 v[60:63], v13 offset:5120
    buffer_load_dwordx4 v[172:175], v1, s[4:7], s33 offen offset:3072 sc1
    v_mfma_f32_16x16x32_bf16 v[24:27], v[100:103], v[204:207], v[24:27]
    ds_read_b128 v[64:67], v13 offset:6144
    v_mfma_f32_16x16x32_bf16 v[28:31], v[104:107], v[204:207], v[28:31]
    ds_read_b128 v[68:71], v13 offset:7168
    v_mfma_f32_16x16x32_bf16 v[36:39], v[108:111], v[204:207], v[36:39]
    s_waitcnt vmcnt(14) lgkmcnt(4)
    v_mfma_f32_16x16x32_bf16 v[16:19], v[40:43], v[112:115], v[16:19]
    ds_read_b128 v[76:79], v13 offset:9216
    s_mov_b32 s32, 5
    s_lshl_b32 s32, s32, 13
    s_add_u32 s32, s32, s29
    s_add_u32 s33, s32, 4096
    v_mfma_f32_16x16x32_bf16 v[20:23], v[44:47], v[112:115], v[20:23]
    ds_read_b128 v[80:83], v13 offset:10240
    v_mfma_f32_16x16x32_bf16 v[24:27], v[48:51], v[112:115], v[24:27]
    ds_read_b128 v[84:87], v13 offset:11264
    buffer_load_dwordx4 v[176:179], v1, s[4:7], s32 offen offset:0 sc1
    v_mfma_f32_16x16x32_bf16 v[28:31], v[52:55], v[112:115], v[28:31]
    ds_read_b128 v[88:91], v13 offset:12288
    v_mfma_f32_16x16x32_bf16 v[32:35], v[72:75], v[112:115], v[32:35]
    ds_read_b128 v[108:111], v13 offset:17408
    s_waitcnt lgkmcnt(5)
    v_mfma_f32_16x16x32_bf16 v[16:19], v[56:59], v[116:119], v[16:19]
    ds_read_b128 v[92:95], v13 offset:13312
    v_mfma_f32_16x16x32_bf16 v[20:23], v[60:63], v[116:119], v[20:23]
    ds_read_b128 v[96:99], v13 offset:14336
    buffer_load_dwordx4 v[180:183], v1, s[4:7], s32 offen offset:1024 sc1
    v_mfma_f32_16x16x32_bf16 v[24:27], v[64:67], v[116:119], v[24:27]
    ds_read_b128 v[100:103], v13 offset:15360
    v_mfma_f32_16x16x32_bf16 v[28:31], v[68:71], v[116:119], v[28:31]
    ds_read_b128 v[104:107], v13 offset:16384
    v_mfma_f32_16x16x32_bf16 v[36:39], v[72:75], v[116:119], v[36:39]
    s_waitcnt vmcnt(14) lgkmcnt(4)
    v_mfma_f32_16x16x32_bf16 v[16:19], v[76:79], v[120:123], v[16:19]
    ds_read_b128 v[40:43], v13 offset:18432
    v_mfma_f32_16x16x32_bf16 v[20:23], v[80:83], v[120:123], v[20:23]
    ds_read_b128 v[44:47], v13 offset:19456
    v_mfma_f32_16x16x32_bf16 v[24:27], v[84:87], v[120:123], v[24:27]
    ds_read_b128 v[48:51], v13 offset:20480
    buffer_load_dwordx4 v[184:187], v1, s[4:7], s32 offen offset:2048 sc1
    v_mfma_f32_16x16x32_bf16 v[28:31], v[88:91], v[120:123], v[28:31]
    ds_read_b128 v[52:55], v13 offset:21504
    v_mfma_f32_16x16x32_bf16 v[32:35], v[108:111], v[120:123], v[32:35]
    ds_read_b128 v[72:75], v13 offset:26624
    s_waitcnt lgkmcnt(5)
    v_mfma_f32_16x16x32_bf16 v[16:19], v[92:95], v[124:127], v[16:19]
    ds_read_b128 v[56:59], v13 offset:22528
    v_mfma_f32_16x16x32_bf16 v[20:23], v[96:99], v[124:127], v[20:23]
    ds_read_b128 v[60:63], v13 offset:23552
    buffer_load_dwordx4 v[188:191], v1, s[4:7], s32 offen offset:3072 sc1
    v_mfma_f32_16x16x32_bf16 v[24:27], v[100:103], v[124:127], v[24:27]
    ds_read_b128 v[64:67], v13 offset:24576
    v_mfma_f32_16x16x32_bf16 v[28:31], v[104:107], v[124:127], v[28:31]
    ds_read_b128 v[68:71], v13 offset:25600
    v_mfma_f32_16x16x32_bf16 v[36:39], v[108:111], v[124:127], v[36:39]
    s_waitcnt vmcnt(14) lgkmcnt(4)
    v_mfma_f32_16x16x32_bf16 v[16:19], v[40:43], v[128:131], v[16:19]
    ds_read_b128 v[76:79], v13 offset:27648
    v_mfma_f32_16x16x32_bf16 v[20:23], v[44:47], v[128:131], v[20:23]
    ds_read_b128 v[80:83], v13 offset:28672
    v_mfma_f32_16x16x32_bf16 v[24:27], v[48:51], v[128:131], v[24:27]
    ds_read_b128 v[84:87], v13 offset:29696
    buffer_load_dwordx4 v[192:195], v1, s[4:7], s33 offen offset:0 sc1
    v_mfma_f32_16x16x32_bf16 v[28:31], v[52:55], v[128:131], v[28:31]
    ds_read_b128 v[88:91], v13 offset:30720
    v_mfma_f32_16x16x32_bf16 v[32:35], v[72:75], v[128:131], v[32:35]
    ds_read_b128 v[108:111], v13 offset:35840
    s_waitcnt lgkmcnt(5)
    v_mfma_f32_16x16x32_bf16 v[16:19], v[56:59], v[132:135], v[16:19]
    ds_read_b128 v[92:95], v13 offset:31744
    v_mfma_f32_16x16x32_bf16 v[20:23], v[60:63], v[132:135], v[20:23]
    ds_read_b128 v[96:99], v13 offset:32768
    buffer_load_dwordx4 v[196:199], v1, s[4:7], s33 offen offset:1024 sc1
    v_mfma_f32_16x16x32_bf16 v[24:27], v[64:67], v[132:135], v[24:27]
    ds_read_b128 v[100:103], v13 offset:33792
    v_mfma_f32_16x16x32_bf16 v[28:31], v[68:71], v[132:135], v[28:31]
    ds_read_b128 v[104:107], v13 offset:34816
    v_mfma_f32_16x16x32_bf16 v[36:39], v[72:75], v[132:135], v[36:39]
    s_waitcnt vmcnt(14) lgkmcnt(0)
    s_barrier
    v_mfma_f32_16x16x32_bf16 v[16:19], v[76:79], v[136:139], v[16:19]
    ds_read_b128 v[40:43], v14 offset:0
    v_mfma_f32_16x16x32_bf16 v[20:23], v[80:83], v[136:139], v[20:23]
    ds_read_b128 v[44:47], v14 offset:1024
    v_mfma_f32_16x16x32_bf16 v[24:27], v[84:87], v[136:139], v[24:27]
    ds_read_b128 v[48:51], v14 offset:2048
    buffer_load_dwordx4 v[200:203], v1, s[4:7], s33 offen offset:2048 sc1
    v_mfma_f32_16x16x32_bf16 v[28:31], v[88:91], v[136:139], v[28:31]
    ds_read_b128 v[52:55], v14 offset:3072
    v_mfma_f32_16x16x32_bf16 v[32:35], v[108:111], v[136:139], v[32:35]
    ds_read_b128 v[72:75], v14 offset:8192
    v_mfma_f32_16x16x32_bf16 v[16:19], v[92:95], v[140:143], v[16:19]
    ds_read_b128 v[56:59], v14 offset:4096
    v_mfma_f32_16x16x32_bf16 v[20:23], v[96:99], v[140:143], v[20:23]
    ds_read_b128 v[60:63], v14 offset:5120
    buffer_load_dwordx4 v[204:207], v1, s[4:7], s33 offen offset:3072 sc1
    v_mfma_f32_16x16x32_bf16 v[24:27], v[100:103], v[140:143], v[24:27]
    ds_read_b128 v[64:67], v14 offset:6144
    v_mfma_f32_16x16x32_bf16 v[28:31], v[104:107], v[140:143], v[28:31]
    ds_read_b128 v[68:71], v14 offset:7168
    v_mfma_f32_16x16x32_bf16 v[36:39], v[108:111], v[140:143], v[36:39]
    s_waitcnt vmcnt(14) lgkmcnt(4)
    v_mfma_f32_16x16x32_bf16 v[16:19], v[40:43], v[144:147], v[16:19]
    ds_read_b128 v[76:79], v14 offset:9216
    s_mov_b32 s32, 6
    s_lshl_b32 s32, s32, 13
    s_add_u32 s32, s32, s29
    s_add_u32 s33, s32, 4096
    v_mfma_f32_16x16x32_bf16 v[20:23], v[44:47], v[144:147], v[20:23]
    ds_read_b128 v[80:83], v14 offset:10240
    v_mfma_f32_16x16x32_bf16 v[24:27], v[48:51], v[144:147], v[24:27]
    ds_read_b128 v[84:87], v14 offset:11264
    buffer_load_dwordx4 v[112:115], v1, s[4:7], s32 offen offset:0 sc1
    v_mfma_f32_16x16x32_bf16 v[28:31], v[52:55], v[144:147], v[28:31]
    ds_read_b128 v[88:91], v14 offset:12288
    v_mfma_f32_16x16x32_bf16 v[32:35], v[72:75], v[144:147], v[32:35]
    ds_read_b128 v[108:111], v14 offset:17408
    s_waitcnt lgkmcnt(5)
    v_mfma_f32_16x16x32_bf16 v[16:19], v[56:59], v[148:151], v[16:19]
    ds_read_b128 v[92:95], v14 offset:13312
    v_mfma_f32_16x16x32_bf16 v[20:23], v[60:63], v[148:151], v[20:23]
    ds_read_b128 v[96:99], v14 offset:14336
    buffer_load_dwordx4 v[116:119], v1, s[4:7], s32 offen offset:1024 sc1
    v_mfma_f32_16x16x32_bf16 v[24:27], v[64:67], v[148:151], v[24:27]
    ds_read_b128 v[100:103], v14 offset:15360
    v_mfma_f32_16x16x32_bf16 v[28:31], v[68:71], v[148:151], v[28:31]
    ds_read_b128 v[104:107], v14 offset:16384
    v_mfma_f32_16x16x32_bf16 v[36:39], v[72:75], v[148:151], v[36:39]
    s_waitcnt vmcnt(14) lgkmcnt(4)
    v_mfma_f32_16x16x32_bf16 v[16:19], v[76:79], v[152:155], v[16:19]
    ds_read_b128 v[40:43], v14 offset:18432
    v_mfma_f32_16x16x32_bf16 v[20:23], v[80:83], v[152:155], v[20:23]
    ds_read_b128 v[44:47], v14 offset:19456
    v_mfma_f32_16x16x32_bf16 v[24:27], v[84:87], v[152:155], v[24:27]
    ds_read_b128 v[48:51], v14 offset:20480
    buffer_load_dwordx4 v[120:123], v1, s[4:7], s32 offen offset:2048 sc1
    v_mfma_f32_16x16x32_bf16 v[28:31], v[88:91], v[152:155], v[28:31]
    ds_read_b128 v[52:55], v14 offset:21504
    v_mfma_f32_16x16x32_bf16 v[32:35], v[108:111], v[152:155], v[32:35]
    ds_read_b128 v[72:75], v14 offset:26624
    s_waitcnt lgkmcnt(5)
    v_mfma_f32_16x16x32_bf16 v[16:19], v[92:95], v[156:159], v[16:19]
    ds_read_b128 v[56:59], v14 offset:22528
    v_mfma_f32_16x16x32_bf16 v[20:23], v[96:99], v[156:159], v[20:23]
    ds_read_b128 v[60:63], v14 offset:23552
    buffer_load_dwordx4 v[124:127], v1, s[4:7], s32 offen offset:3072 sc1
    v_mfma_f32_16x16x32_bf16 v[24:27], v[100:103], v[156:159], v[24:27]
    ds_read_b128 v[64:67], v14 offset:24576
    v_mfma_f32_16x16x32_bf16 v[28:31], v[104:107], v[156:159], v[28:31]
    ds_read_b128 v[68:71], v14 offset:25600
    v_mfma_f32_16x16x32_bf16 v[36:39], v[108:111], v[156:159], v[36:39]
    s_waitcnt vmcnt(14) lgkmcnt(4)
    v_mfma_f32_16x16x32_bf16 v[16:19], v[40:43], v[160:163], v[16:19]
    ds_read_b128 v[76:79], v14 offset:27648
    v_mfma_f32_16x16x32_bf16 v[20:23], v[44:47], v[160:163], v[20:23]
    ds_read_b128 v[80:83], v14 offset:28672
    v_mfma_f32_16x16x32_bf16 v[24:27], v[48:51], v[160:163], v[24:27]
    ds_read_b128 v[84:87], v14 offset:29696
    buffer_load_dwordx4 v[128:131], v1, s[4:7], s33 offen offset:0 sc1
    v_mfma_f32_16x16x32_bf16 v[28:31], v[52:55], v[160:163], v[28:31]
    ds_read_b128 v[88:91], v14 offset:30720
    v_mfma_f32_16x16x32_bf16 v[32:35], v[72:75], v[160:163], v[32:35]
    ds_read_b128 v[108:111], v14 offset:35840
    s_waitcnt lgkmcnt(5)
    v_mfma_f32_16x16x32_bf16 v[16:19], v[56:59], v[164:167], v[16:19]
    ds_read_b128 v[92:95], v14 offset:31744
    v_mfma_f32_16x16x32_bf16 v[20:23], v[60:63], v[164:167], v[20:23]
    ds_read_b128 v[96:99], v14 offset:32768
    buffer_load_dwordx4 v[132:135], v1, s[4:7], s33 offen offset:1024 sc1
    v_mfma_f32_16x16x32_bf16 v[24:27], v[64:67], v[164:167], v[24:27]
    ds_read_b128 v[100:103], v14 offset:33792
    v_mfma_f32_16x16x32_bf16 v[28:31], v[68:71], v[164:167], v[28:31]
    ds_read_b128 v[104:107], v14 offset:34816
    v_mfma_f32_16x16x32_bf16 v[36:39], v[72:75], v[164:167], v[36:39]
    s_waitcnt vmcnt(14) lgkmcnt(0)
    s_barrier
    v_mfma_f32_16x16x32_bf16 v[16:19], v[76:79], v[168:171], v[16:19]
    ds_read_b128 v[40:43], v15 offset:0
    v_mfma_f32_16x16x32_bf16 v[20:23], v[80:83], v[168:171], v[20:23]
    ds_read_b128 v[44:47], v15 offset:1024
    v_mfma_f32_16x16x32_bf16 v[24:27], v[84:87], v[168:171], v[24:27]
    ds_read_b128 v[48:51], v15 offset:2048
    buffer_load_dwordx4 v[136:139], v1, s[4:7], s33 offen offset:2048 sc1
    v_mfma_f32_16x16x32_bf16 v[28:31], v[88:91], v[168:171], v[28:31]
    ds_read_b128 v[52:55], v15 offset:3072
    v_mfma_f32_16x16x32_bf16 v[32:35], v[108:111], v[168:171], v[32:35]
    ds_read_b128 v[72:75], v15 offset:8192
    v_mfma_f32_16x16x32_bf16 v[16:19], v[92:95], v[172:175], v[16:19]
    ds_read_b128 v[56:59], v15 offset:4096
    v_mfma_f32_16x16x32_bf16 v[20:23], v[96:99], v[172:175], v[20:23]
    ds_read_b128 v[60:63], v15 offset:5120
    buffer_load_dwordx4 v[140:143], v1, s[4:7], s33 offen offset:3072 sc1
    v_mfma_f32_16x16x32_bf16 v[24:27], v[100:103], v[172:175], v[24:27]
    ds_read_b128 v[64:67], v15 offset:6144
    v_mfma_f32_16x16x32_bf16 v[28:31], v[104:107], v[172:175], v[28:31]
    ds_read_b128 v[68:71], v15 offset:7168
    v_mfma_f32_16x16x32_bf16 v[36:39], v[108:111], v[172:175], v[36:39]
    s_waitcnt vmcnt(14) lgkmcnt(4)
    v_mfma_f32_16x16x32_bf16 v[16:19], v[40:43], v[176:179], v[16:19]
    ds_read_b128 v[76:79], v15 offset:9216
    s_mov_b32 s32, 7
    s_lshl_b32 s32, s32, 13
    s_add_u32 s32, s32, s29
    s_add_u32 s33, s32, 4096
    v_mfma_f32_16x16x32_bf16 v[20:23], v[44:47], v[176:179], v[20:23]
    ds_read_b128 v[80:83], v15 offset:10240
    v_mfma_f32_16x16x32_bf16 v[24:27], v[48:51], v[176:179], v[24:27]
    ds_read_b128 v[84:87], v15 offset:11264
    buffer_load_dwordx4 v[144:147], v1, s[4:7], s32 offen offset:0 sc1
    v_mfma_f32_16x16x32_bf16 v[28:31], v[52:55], v[176:179], v[28:31]
    ds_read_b128 v[88:91], v15 offset:12288
    v_mfma_f32_16x16x32_bf16 v[32:35], v[72:75], v[176:179], v[32:35]
    ds_read_b128 v[108:111], v15 offset:17408
    s_waitcnt lgkmcnt(5)
    v_mfma_f32_16x16x32_bf16 v[16:19], v[56:59], v[180:183], v[16:19]
    ds_read_b128 v[92:95], v15 offset:13312
    v_mfma_f32_16x16x32_bf16 v[20:23], v[60:63], v[180:183], v[20:23]
    ds_read_b128 v[96:99], v15 offset:14336
    buffer_load_dwordx4 v[148:151], v1, s[4:7], s32 offen offset:1024 sc1
    v_mfma_f32_16x16x32_bf16 v[24:27], v[64:67], v[180:183], v[24:27]
    ds_read_b128 v[100:103], v15 offset:15360
    v_mfma_f32_16x16x32_bf16 v[28:31], v[68:71], v[180:183], v[28:31]
    ds_read_b128 v[104:107], v15 offset:16384
    v_mfma_f32_16x16x32_bf16 v[36:39], v[72:75], v[180:183], v[36:39]
    s_waitcnt vmcnt(14) lgkmcnt(4)
    v_mfma_f32_16x16x32_bf16 v[16:19], v[76:79], v[184:187], v[16:19]
    ds_read_b128 v[40:43], v15 offset:18432
    v_mfma_f32_16x16x32_bf16 v[20:23], v[80:83], v[184:187], v[20:23]
    ds_read_b128 v[44:47], v15 offset:19456
    v_mfma_f32_16x16x32_bf16 v[24:27], v[84:87], v[184:187], v[24:27]
    ds_read_b128 v[48:51], v15 offset:20480
    buffer_load_dwordx4 v[152:155], v1, s[4:7], s32 offen offset:2048 sc1
    v_mfma_f32_16x16x32_bf16 v[28:31], v[88:91], v[184:187], v[28:31]
    ds_read_b128 v[52:55], v15 offset:21504
    v_mfma_f32_16x16x32_bf16 v[32:35], v[108:111], v[184:187], v[32:35]
    ds_read_b128 v[72:75], v15 offset:26624
    s_waitcnt lgkmcnt(5)
    v_mfma_f32_16x16x32_bf16 v[16:19], v[92:95], v[188:191], v[16:19]
    ds_read_b128 v[56:59], v15 offset:22528
    v_mfma_f32_16x16x32_bf16 v[20:23], v[96:99], v[188:191], v[20:23]
    ds_read_b128 v[60:63], v15 offset:23552
    buffer_load_dwordx4 v[156:159], v1, s[4:7], s32 offen offset:3072 sc1
    v_mfma_f32_16x16x32_bf16 v[24:27], v[100:103], v[188:191], v[24:27]
    ds_read_b128 v[64:67], v15 offset:24576
    v_mfma_f32_16x16x32_bf16 v[28:31], v[104:107], v[188:191], v[28:31]
    ds_read_b128 v[68:71], v15 offset:25600
    v_mfma_f32_16x16x32_bf16 v[36:39], v[108:111], v[188:191], v[36:39]
    s_waitcnt vmcnt(14) lgkmcnt(4)
    v_mfma_f32_16x16x32_bf16 v[16:19], v[40:43], v[192:195], v[16:19]
    ds_read_b128 v[76:79], v15 offset:27648
    v_mfma_f32_16x16x32_bf16 v[20:23], v[44:47], v[192:195], v[20:23]
    ds_read_b128 v[80:83], v15 offset:28672
    v_mfma_f32_16x16x32_bf16 v[24:27], v[48:51], v[192:195], v[24:27]
    ds_read_b128 v[84:87], v15 offset:29696
    buffer_load_dwordx4 v[160:163], v1, s[4:7], s33 offen offset:0 sc1
    v_mfma_f32_16x16x32_bf16 v[28:31], v[52:55], v[192:195], v[28:31]
    ds_read_b128 v[88:91], v15 offset:30720
    v_mfma_f32_16x16x32_bf16 v[32:35], v[72:75], v[192:195], v[32:35]
    ds_read_b128 v[108:111], v15 offset:35840
    s_waitcnt lgkmcnt(5)
    v_mfma_f32_16x16x32_bf16 v[16:19], v[56:59], v[196:199], v[16:19]
    ds_read_b128 v[92:95], v15 offset:31744
    v_mfma_f32_16x16x32_bf16 v[20:23], v[60:63], v[196:199], v[20:23]
    ds_read_b128 v[96:99], v15 offset:32768
    buffer_load_dwordx4 v[164:167], v1, s[4:7], s33 offen offset:1024 sc1
    v_mfma_f32_16x16x32_bf16 v[24:27], v[64:67], v[196:199], v[24:27]
    ds_read_b128 v[100:103], v15 offset:33792
    v_mfma_f32_16x16x32_bf16 v[28:31], v[68:71], v[196:199], v[28:31]
    ds_read_b128 v[104:107], v15 offset:34816
    v_mfma_f32_16x16x32_bf16 v[36:39], v[72:75], v[196:199], v[36:39]
    s_waitcnt vmcnt(14) lgkmcnt(0)
    s_barrier
    v_mfma_f32_16x16x32_bf16 v[16:19], v[76:79], v[200:203], v[16:19]
    ds_read_b128 v[40:43], v12 offset:0
    v_mfma_f32_16x16x32_bf16 v[20:23], v[80:83], v[200:203], v[20:23]
    ds_read_b128 v[44:47], v12 offset:1024
    v_mfma_f32_16x16x32_bf16 v[24:27], v[84:87], v[200:203], v[24:27]
    ds_read_b128 v[48:51], v12 offset:2048
    buffer_load_dwordx4 v[168:171], v1, s[4:7], s33 offen offset:2048 sc1
    v_mfma_f32_16x16x32_bf16 v[28:31], v[88:91], v[200:203], v[28:31]
    ds_read_b128 v[52:55], v12 offset:3072
    v_mfma_f32_16x16x32_bf16 v[32:35], v[108:111], v[200:203], v[32:35]
    ds_read_b128 v[72:75], v12 offset:8192
    v_mfma_f32_16x16x32_bf16 v[16:19], v[92:95], v[204:207], v[16:19]
    ds_read_b128 v[56:59], v12 offset:4096
    v_mfma_f32_16x16x32_bf16 v[20:23], v[96:99], v[204:207], v[20:23]
    ds_read_b128 v[60:63], v12 offset:5120
    buffer_load_dwordx4 v[172:175], v1, s[4:7], s33 offen offset:3072 sc1
    v_mfma_f32_16x16x32_bf16 v[24:27], v[100:103], v[204:207], v[24:27]
    ds_read_b128 v[64:67], v12 offset:6144
    v_mfma_f32_16x16x32_bf16 v[28:31], v[104:107], v[204:207], v[28:31]
    ds_read_b128 v[68:71], v12 offset:7168
    v_mfma_f32_16x16x32_bf16 v[36:39], v[108:111], v[204:207], v[36:39]
    s_waitcnt vmcnt(14) lgkmcnt(4)
    v_mfma_f32_16x16x32_bf16 v[16:19], v[40:43], v[112:115], v[16:19]
    ds_read_b128 v[76:79], v12 offset:9216
    s_mov_b32 s32, 8
    s_lshl_b32 s32, s32, 13
    s_add_u32 s32, s32, s29
    s_add_u32 s33, s32, 4096
    v_mfma_f32_16x16x32_bf16 v[20:23], v[44:47], v[112:115], v[20:23]
    ds_read_b128 v[80:83], v12 offset:10240
    v_mfma_f32_16x16x32_bf16 v[24:27], v[48:51], v[112:115], v[24:27]
    ds_read_b128 v[84:87], v12 offset:11264
    buffer_load_dwordx2 v[176:177], v7, s[4:7], s32 offen offset:0 sc1
    v_mfma_f32_16x16x32_bf16 v[28:31], v[52:55], v[112:115], v[28:31]
    ds_read_b128 v[88:91], v12 offset:12288
    v_mfma_f32_16x16x32_bf16 v[32:35], v[72:75], v[112:115], v[32:35]
    ds_read_b128 v[108:111], v12 offset:17408
    s_waitcnt lgkmcnt(5)
    buffer_load_dwordx2 v[178:179], v7, s[4:7], s32 offen offset:512 sc1
    v_mfma_f32_16x16x32_bf16 v[16:19], v[56:59], v[116:119], v[16:19]
    ds_read_b128 v[92:95], v12 offset:13312
    v_mfma_f32_16x16x32_bf16 v[20:23], v[60:63], v[116:119], v[20:23]
    ds_read_b128 v[96:99], v12 offset:14336
    buffer_load_dwordx2 v[180:181], v7, s[4:7], s32 offen offset:1024 sc1
    v_mfma_f32_16x16x32_bf16 v[24:27], v[64:67], v[116:119], v[24:27]
    ds_read_b128 v[100:103], v12 offset:15360
    v_mfma_f32_16x16x32_bf16 v[28:31], v[68:71], v[116:119], v[28:31]
    ds_read_b128 v[104:107], v12 offset:16384
    buffer_load_dwordx2 v[182:183], v7, s[4:7], s32 offen offset:1536 sc1
    v_mfma_f32_16x16x32_bf16 v[36:39], v[72:75], v[116:119], v[36:39]
    s_waitcnt vmcnt(16) lgkmcnt(4)
    v_mfma_f32_16x16x32_bf16 v[16:19], v[76:79], v[120:123], v[16:19]
    ds_read_b128 v[40:43], v12 offset:18432
    v_mfma_f32_16x16x32_bf16 v[20:23], v[80:83], v[120:123], v[20:23]
    ds_read_b128 v[44:47], v12 offset:19456
    v_mfma_f32_16x16x32_bf16 v[24:27], v[84:87], v[120:123], v[24:27]
    ds_read_b128 v[48:51], v12 offset:20480
    buffer_load_dwordx2 v[184:185], v7, s[4:7], s32 offen offset:2048 sc1
    v_mfma_f32_16x16x32_bf16 v[28:31], v[88:91], v[120:123], v[28:31]
    ds_read_b128 v[52:55], v12 offset:21504
    v_mfma_f32_16x16x32_bf16 v[32:35], v[108:111], v[120:123], v[32:35]
    ds_read_b128 v[72:75], v12 offset:26624
    s_waitcnt lgkmcnt(5)
    buffer_load_dwordx2 v[186:187], v7, s[4:7], s32 offen offset:2560 sc1
    v_mfma_f32_16x16x32_bf16 v[16:19], v[92:95], v[124:127], v[16:19]
    ds_read_b128 v[56:59], v12 offset:22528
    v_mfma_f32_16x16x32_bf16 v[20:23], v[96:99], v[124:127], v[20:23]
    ds_read_b128 v[60:63], v12 offset:23552
    buffer_load_dwordx2 v[188:189], v7, s[4:7], s32 offen offset:3072 sc1
    v_mfma_f32_16x16x32_bf16 v[24:27], v[100:103], v[124:127], v[24:27]
    ds_read_b128 v[64:67], v12 offset:24576
    v_mfma_f32_16x16x32_bf16 v[28:31], v[104:107], v[124:127], v[28:31]
    ds_read_b128 v[68:71], v12 offset:25600
    buffer_load_dwordx2 v[190:191], v7, s[4:7], s32 offen offset:3584 sc1
    v_mfma_f32_16x16x32_bf16 v[36:39], v[108:111], v[124:127], v[36:39]
    s_waitcnt vmcnt(18) lgkmcnt(4)
    v_mfma_f32_16x16x32_bf16 v[16:19], v[40:43], v[128:131], v[16:19]
    ds_read_b128 v[76:79], v12 offset:27648
    v_mfma_f32_16x16x32_bf16 v[20:23], v[44:47], v[128:131], v[20:23]
    ds_read_b128 v[80:83], v12 offset:28672
    v_mfma_f32_16x16x32_bf16 v[24:27], v[48:51], v[128:131], v[24:27]
    ds_read_b128 v[84:87], v12 offset:29696
    buffer_load_dwordx2 v[192:193], v7, s[4:7], s33 offen offset:0 sc1
    v_mfma_f32_16x16x32_bf16 v[28:31], v[52:55], v[128:131], v[28:31]
    ds_read_b128 v[88:91], v12 offset:30720
    v_mfma_f32_16x16x32_bf16 v[32:35], v[72:75], v[128:131], v[32:35]
    ds_read_b128 v[108:111], v12 offset:35840
    s_waitcnt lgkmcnt(5)
    buffer_load_dwordx2 v[194:195], v7, s[4:7], s33 offen offset:512 sc1
    v_mfma_f32_16x16x32_bf16 v[16:19], v[56:59], v[132:135], v[16:19]
    ds_read_b128 v[92:95], v12 offset:31744
    v_mfma_f32_16x16x32_bf16 v[20:23], v[60:63], v[132:135], v[20:23]
    ds_read_b128 v[96:99], v12 offset:32768
    buffer_load_dwordx2 v[196:197], v7, s[4:7], s33 offen offset:1024 sc1
    v_mfma_f32_16x16x32_bf16 v[24:27], v[64:67], v[132:135], v[24:27]
    ds_read_b128 v[100:103], v12 offset:33792
    v_mfma_f32_16x16x32_bf16 v[28:31], v[68:71], v[132:135], v[28:31]
    ds_read_b128 v[104:107], v12 offset:34816
    buffer_load_dwordx2 v[198:199], v7, s[4:7], s33 offen offset:1536 sc1
    v_mfma_f32_16x16x32_bf16 v[36:39], v[72:75], v[132:135], v[36:39]
    s_waitcnt vmcnt(20) lgkmcnt(0)
    s_barrier
    v_mfma_f32_16x16x32_bf16 v[16:19], v[76:79], v[136:139], v[16:19]
    ds_read_b128 v[40:43], v13 offset:0
    v_mfma_f32_16x16x32_bf16 v[20:23], v[80:83], v[136:139], v[20:23]
    ds_read_b128 v[44:47], v13 offset:1024
    v_mfma_f32_16x16x32_bf16 v[24:27], v[84:87], v[136:139], v[24:27]
    ds_read_b128 v[48:51], v13 offset:2048
    buffer_load_dwordx2 v[200:201], v7, s[4:7], s33 offen offset:2048 sc1
    v_mfma_f32_16x16x32_bf16 v[28:31], v[88:91], v[136:139], v[28:31]
    ds_read_b128 v[52:55], v13 offset:3072
    v_mfma_f32_16x16x32_bf16 v[32:35], v[108:111], v[136:139], v[32:35]
    ds_read_b128 v[72:75], v13 offset:8192
    buffer_load_dwordx2 v[202:203], v7, s[4:7], s33 offen offset:2560 sc1
    v_mfma_f32_16x16x32_bf16 v[16:19], v[92:95], v[140:143], v[16:19]
    ds_read_b128 v[56:59], v13 offset:4096
    v_mfma_f32_16x16x32_bf16 v[20:23], v[96:99], v[140:143], v[20:23]
    ds_read_b128 v[60:63], v13 offset:5120
    buffer_load_dwordx2 v[204:205], v7, s[4:7], s33 offen offset:3072 sc1
    v_mfma_f32_16x16x32_bf16 v[24:27], v[100:103], v[140:143], v[24:27]
    ds_read_b128 v[64:67], v13 offset:6144
    v_mfma_f32_16x16x32_bf16 v[28:31], v[104:107], v[140:143], v[28:31]
    ds_read_b128 v[68:71], v13 offset:7168
    buffer_load_dwordx2 v[206:207], v7, s[4:7], s33 offen offset:3584 sc1
    v_mfma_f32_16x16x32_bf16 v[36:39], v[108:111], v[140:143], v[36:39]
    s_waitcnt vmcnt(22) lgkmcnt(4)
    v_mfma_f32_16x16x32_bf16 v[16:19], v[40:43], v[144:147], v[16:19]
    ds_read_b128 v[76:79], v13 offset:9216
    v_mfma_f32_16x16x32_bf16 v[20:23], v[44:47], v[144:147], v[20:23]
    ds_read_b128 v[80:83], v13 offset:10240
    v_mfma_f32_16x16x32_bf16 v[24:27], v[48:51], v[144:147], v[24:27]
    ds_read_b128 v[84:87], v13 offset:11264
    v_mfma_f32_16x16x32_bf16 v[28:31], v[52:55], v[144:147], v[28:31]
    ds_read_b128 v[88:91], v13 offset:12288
    v_mfma_f32_16x16x32_bf16 v[32:35], v[72:75], v[144:147], v[32:35]
    ds_read_b128 v[108:111], v13 offset:17408
    s_waitcnt lgkmcnt(5)
    v_mfma_f32_16x16x32_bf16 v[16:19], v[56:59], v[148:151], v[16:19]
    ds_read_b128 v[92:95], v13 offset:13312
    v_mfma_f32_16x16x32_bf16 v[20:23], v[60:63], v[148:151], v[20:23]
    ds_read_b128 v[96:99], v13 offset:14336
    v_mfma_f32_16x16x32_bf16 v[24:27], v[64:67], v[148:151], v[24:27]
    ds_read_b128 v[100:103], v13 offset:15360
    v_mfma_f32_16x16x32_bf16 v[28:31], v[68:71], v[148:151], v[28:31]
    ds_read_b128 v[104:107], v13 offset:16384
    v_mfma_f32_16x16x32_bf16 v[36:39], v[72:75], v[148:151], v[36:39]
    s_waitcnt vmcnt(20) lgkmcnt(4)
    v_mfma_f32_16x16x32_bf16 v[16:19], v[76:79], v[152:155], v[16:19]
    ds_read_b128 v[40:43], v13 offset:18432
    v_mfma_f32_16x16x32_bf16 v[20:23], v[80:83], v[152:155], v[20:23]
    ds_read_b128 v[44:47], v13 offset:19456
    v_mfma_f32_16x16x32_bf16 v[24:27], v[84:87], v[152:155], v[24:27]
    ds_read_b128 v[48:51], v13 offset:20480
    v_mfma_f32_16x16x32_bf16 v[28:31], v[88:91], v[152:155], v[28:31]
    ds_read_b128 v[52:55], v13 offset:21504
    v_mfma_f32_16x16x32_bf16 v[32:35], v[108:111], v[152:155], v[32:35]
    ds_read_b128 v[72:75], v13 offset:26624
    s_waitcnt lgkmcnt(5)
    v_mfma_f32_16x16x32_bf16 v[16:19], v[92:95], v[156:159], v[16:19]
    ds_read_b128 v[56:59], v13 offset:22528
    v_mfma_f32_16x16x32_bf16 v[20:23], v[96:99], v[156:159], v[20:23]
    ds_read_b128 v[60:63], v13 offset:23552
    v_mfma_f32_16x16x32_bf16 v[24:27], v[100:103], v[156:159], v[24:27]
    ds_read_b128 v[64:67], v13 offset:24576
    v_mfma_f32_16x16x32_bf16 v[28:31], v[104:107], v[156:159], v[28:31]
    ds_read_b128 v[68:71], v13 offset:25600
    v_mfma_f32_16x16x32_bf16 v[36:39], v[108:111], v[156:159], v[36:39]
    s_waitcnt vmcnt(18) lgkmcnt(4)
    v_mfma_f32_16x16x32_bf16 v[16:19], v[40:43], v[160:163], v[16:19]
    ds_read_b128 v[76:79], v13 offset:27648
    v_mfma_f32_16x16x32_bf16 v[20:23], v[44:47], v[160:163], v[20:23]
    ds_read_b128 v[80:83], v13 offset:28672
    v_mfma_f32_16x16x32_bf16 v[24:27], v[48:51], v[160:163], v[24:27]
    ds_read_b128 v[84:87], v13 offset:29696
    v_mfma_f32_16x16x32_bf16 v[28:31], v[52:55], v[160:163], v[28:31]
    ds_read_b128 v[88:91], v13 offset:30720
    v_mfma_f32_16x16x32_bf16 v[32:35], v[72:75], v[160:163], v[32:35]
    ds_read_b128 v[108:111], v13 offset:35840
    s_waitcnt lgkmcnt(5)
    v_mfma_f32_16x16x32_bf16 v[16:19], v[56:59], v[164:167], v[16:19]
    ds_read_b128 v[92:95], v13 offset:31744
    v_mfma_f32_16x16x32_bf16 v[20:23], v[60:63], v[164:167], v[20:23]
    ds_read_b128 v[96:99], v13 offset:32768
    v_mfma_f32_16x16x32_bf16 v[24:27], v[64:67], v[164:167], v[24:27]
    ds_read_b128 v[100:103], v13 offset:33792
    v_mfma_f32_16x16x32_bf16 v[28:31], v[68:71], v[164:167], v[28:31]
    ds_read_b128 v[104:107], v13 offset:34816
    v_mfma_f32_16x16x32_bf16 v[36:39], v[72:75], v[164:167], v[36:39]
    s_waitcnt vmcnt(16) lgkmcnt(0)
    s_barrier
    v_mfma_f32_16x16x32_bf16 v[16:19], v[76:79], v[168:171], v[16:19]
    ds_read_b128 v[40:43], v14 offset:0
    v_mfma_f32_16x16x32_bf16 v[20:23], v[80:83], v[168:171], v[20:23]
    ds_read_b128 v[44:47], v14 offset:1024
    v_mfma_f32_16x16x32_bf16 v[24:27], v[84:87], v[168:171], v[24:27]
    ds_read_b128 v[48:51], v14 offset:2048
    v_mfma_f32_16x16x32_bf16 v[28:31], v[88:91], v[168:171], v[28:31]
    ds_read_b128 v[52:55], v14 offset:3072
    v_mfma_f32_16x16x32_bf16 v[32:35], v[108:111], v[168:171], v[32:35]
    ds_read_b128 v[72:75], v14 offset:8192
    v_mfma_f32_16x16x32_bf16 v[16:19], v[92:95], v[172:175], v[16:19]
    ds_read_b128 v[56:59], v14 offset:4096
    v_mfma_f32_16x16x32_bf16 v[20:23], v[96:99], v[172:175], v[20:23]
    ds_read_b128 v[60:63], v14 offset:5120
    v_mfma_f32_16x16x32_bf16 v[24:27], v[100:103], v[172:175], v[24:27]
    ds_read_b128 v[64:67], v14 offset:6144
    v_mfma_f32_16x16x32_bf16 v[28:31], v[104:107], v[172:175], v[28:31]
    ds_read_b128 v[68:71], v14 offset:7168
    v_mfma_f32_16x16x32_bf16 v[36:39], v[108:111], v[172:175], v[36:39]
    s_waitcnt vmcnt(12) lgkmcnt(4)
    v_mfma_f32_16x16x32_bf16 v[16:19], v[40:43], v[176:179], v[16:19]
    ds_read_b128 v[76:79], v14 offset:9216
    v_mfma_f32_16x16x32_bf16 v[20:23], v[44:47], v[176:179], v[20:23]
    ds_read_b128 v[80:83], v14 offset:10240
    v_mfma_f32_16x16x32_bf16 v[24:27], v[48:51], v[176:179], v[24:27]
    ds_read_b128 v[84:87], v14 offset:11264
    v_mfma_f32_16x16x32_bf16 v[28:31], v[52:55], v[176:179], v[28:31]
    ds_read_b128 v[88:91], v14 offset:12288
    v_mfma_f32_16x16x32_bf16 v[32:35], v[72:75], v[176:179], v[32:35]
    ds_read_b128 v[108:111], v14 offset:17408
    s_waitcnt lgkmcnt(5)
    v_mfma_f32_16x16x32_bf16 v[16:19], v[56:59], v[180:183], v[16:19]
    ds_read_b128 v[92:95], v14 offset:13312
    v_mfma_f32_16x16x32_bf16 v[20:23], v[60:63], v[180:183], v[20:23]
    ds_read_b128 v[96:99], v14 offset:14336
    v_mfma_f32_16x16x32_bf16 v[24:27], v[64:67], v[180:183], v[24:27]
    ds_read_b128 v[100:103], v14 offset:15360
    v_mfma_f32_16x16x32_bf16 v[28:31], v[68:71], v[180:183], v[28:31]
    ds_read_b128 v[104:107], v14 offset:16384
    v_mfma_f32_16x16x32_bf16 v[36:39], v[72:75], v[180:183], v[36:39]
    s_waitcnt vmcnt(8) lgkmcnt(4)
    v_mfma_f32_16x16x32_bf16 v[16:19], v[76:79], v[184:187], v[16:19]
    ds_read_b128 v[40:43], v14 offset:18432
    v_mfma_f32_16x16x32_bf16 v[20:23], v[80:83], v[184:187], v[20:23]
    ds_read_b128 v[44:47], v14 offset:19456
    v_mfma_f32_16x16x32_bf16 v[24:27], v[84:87], v[184:187], v[24:27]
    ds_read_b128 v[48:51], v14 offset:20480
    v_mfma_f32_16x16x32_bf16 v[28:31], v[88:91], v[184:187], v[28:31]
    ds_read_b128 v[52:55], v14 offset:21504
    v_mfma_f32_16x16x32_bf16 v[32:35], v[108:111], v[184:187], v[32:35]
    ds_read_b128 v[72:75], v14 offset:26624
    s_waitcnt lgkmcnt(5)
    v_mfma_f32_16x16x32_bf16 v[16:19], v[92:95], v[188:191], v[16:19]
    ds_read_b128 v[56:59], v14 offset:22528
    v_mfma_f32_16x16x32_bf16 v[20:23], v[96:99], v[188:191], v[20:23]
    ds_read_b128 v[60:63], v14 offset:23552
    v_mfma_f32_16x16x32_bf16 v[24:27], v[100:103], v[188:191], v[24:27]
    ds_read_b128 v[64:67], v14 offset:24576
    v_mfma_f32_16x16x32_bf16 v[28:31], v[104:107], v[188:191], v[28:31]
    ds_read_b128 v[68:71], v14 offset:25600
    v_mfma_f32_16x16x32_bf16 v[36:39], v[108:111], v[188:191], v[36:39]
    s_waitcnt vmcnt(4) lgkmcnt(4)
    v_mfma_f32_16x16x32_bf16 v[16:19], v[40:43], v[192:195], v[16:19]
    ds_read_b128 v[76:79], v14 offset:27648
    v_mfma_f32_16x16x32_bf16 v[20:23], v[44:47], v[192:195], v[20:23]
    ds_read_b128 v[80:83], v14 offset:28672
    v_mfma_f32_16x16x32_bf16 v[24:27], v[48:51], v[192:195], v[24:27]
    ds_read_b128 v[84:87], v14 offset:29696
    v_mfma_f32_16x16x32_bf16 v[28:31], v[52:55], v[192:195], v[28:31]
    ds_read_b128 v[88:91], v14 offset:30720
    v_mfma_f32_16x16x32_bf16 v[32:35], v[72:75], v[192:195], v[32:35]
    ds_read_b128 v[108:111], v14 offset:35840
    s_waitcnt lgkmcnt(5)
    v_mfma_f32_16x16x32_bf16 v[16:19], v[56:59], v[196:199], v[16:19]
    ds_read_b128 v[92:95], v14 offset:31744
    v_mfma_f32_16x16x32_bf16 v[20:23], v[60:63], v[196:199], v[20:23]
    ds_read_b128 v[96:99], v14 offset:32768
    v_mfma_f32_16x16x32_bf16 v[24:27], v[64:67], v[196:199], v[24:27]
    ds_read_b128 v[100:103], v14 offset:33792
    v_mfma_f32_16x16x32_bf16 v[28:31], v[68:71], v[196:199], v[28:31]
    ds_read_b128 v[104:107], v14 offset:34816
    v_mfma_f32_16x16x32_bf16 v[36:39], v[72:75], v[196:199], v[36:39]
    s_waitcnt vmcnt(0) lgkmcnt(4)
    v_mfma_f32_16x16x32_bf16 v[16:19], v[76:79], v[200:203], v[16:19]
    v_mfma_f32_16x16x32_bf16 v[20:23], v[80:83], v[200:203], v[20:23]
    v_mfma_f32_16x16x32_bf16 v[24:27], v[84:87], v[200:203], v[24:27]
    v_mfma_f32_16x16x32_bf16 v[28:31], v[88:91], v[200:203], v[28:31]
    v_mfma_f32_16x16x32_bf16 v[32:35], v[108:111], v[200:203], v[32:35]
    s_waitcnt lgkmcnt(0)
    v_mfma_f32_16x16x32_bf16 v[16:19], v[92:95], v[204:207], v[16:19]
    v_mfma_f32_16x16x32_bf16 v[20:23], v[96:99], v[204:207], v[20:23]
    v_mfma_f32_16x16x32_bf16 v[24:27], v[100:103], v[204:207], v[24:27]
    v_mfma_f32_16x16x32_bf16 v[28:31], v[104:107], v[204:207], v[28:31]
    v_mfma_f32_16x16x32_bf16 v[36:39], v[108:111], v[204:207], v[36:39]
    s_nop 3
    v_cvt_pk_bf16_f32 v208, v16, v17
    v_cvt_pk_bf16_f32 v209, v18, v19
    v_cvt_pk_bf16_f32 v210, v20, v21
    v_cvt_pk_bf16_f32 v211, v22, v23
    v_cvt_pk_bf16_f32 v212, v24, v25
    v_cvt_pk_bf16_f32 v213, v26, v27
    v_cvt_pk_bf16_f32 v214, v28, v29
    v_cvt_pk_bf16_f32 v215, v30, v31
    s_cmp_eq_u32 s22, 1
    s_cbranch_scc1 L_fin_p5
    buffer_store_dwordx4 v[208:211], v4, s[4:7], s34 offen offset:0 sc1
    buffer_store_dwordx4 v[212:215], v4, s[4:7], s34 offen offset:1024 sc1
    v_permlane32_swap_b32 v36, v220
    v_permlane32_swap_b32 v37, v221
    v_permlane32_swap_b32 v38, v222
    v_permlane32_swap_b32 v39, v223
    v_pk_add_f32 v[32:33], v[32:33], v[220:221]
    v_pk_add_f32 v[34:35], v[34:35], v[222:223]
    v_cvt_pk_bf16_f32 v216, v32, v33
    v_cvt_pk_bf16_f32 v217, v34, v35
    buffer_store_dwordx2 v[216:217], v5, s[4:7], s34 offen sc1
    v_cndmask_b32 v222, 0, v216, s[40:41]
    v_cndmask_b32 v223, 0, v217, s[40:41]
    v_dot2_f32_bf16 v220, v208, v11, 0
    v_dot2_f32_bf16 v221, v208, v208, 0
    v_dot2_f32_bf16 v224, v209, v11, 0
    v_dot2_f32_bf16 v225, v209, v209, 0
    v_dot2_f32_bf16 v220, v210, v11, v220
    v_dot2_f32_bf16 v221, v210, v210, v221
    v_dot2_f32_bf16 v224, v211, v11, v224
    v_dot2_f32_bf16 v225, v211, v211, v225
    v_dot2_f32_bf16 v220, v212, v11, v220
    v_dot2_f32_bf16 v221, v212, v212, v221
    v_dot2_f32_bf16 v224, v213, v11, v224
    v_dot2_f32_bf16 v225, v213, v213, v225
    v_dot2_f32_bf16 v220, v214, v11, v220
    v_dot2_f32_bf16 v221, v214, v214, v221
    v_dot2_f32_bf16 v224, v215, v11, v224
    v_dot2_f32_bf16 v225, v215, v215, v225
    v_dot2_f32_bf16 v220, v222, v11, v220
    v_dot2_f32_bf16 v221, v222, v222, v221
    v_dot2_f32_bf16 v224, v223, v11, v224
    v_dot2_f32_bf16 v225, v223, v223, v225
    s_nop 2
    v_pk_add_f32 v[220:221], v[220:221], v[224:225]
    v_mov_b32 v222, v220
    v_mov_b32 v223, v221
    s_nop 1
    v_permlane32_swap_b32 v220, v222
    v_permlane32_swap_b32 v221, v223
    v_add_f32 v220, v220, v222
    v_add_f32 v221, v221, v223
    v_mov_b32 v222, v220
    v_mov_b32 v223, v221
    s_nop 1
    v_permlane16_swap_b32 v220, v222
    v_permlane16_swap_b32 v221, v223
    v_add_f32 v220, v220, v222
    v_add_f32 v221, v221, v223
    buffer_store_dwordx2 v[220:221], v10, s[4:7], s39 offen sc1
    s_barrier
    s_mov_b32 s22, 1
    s_mov_b32 s21, 0x1c00000
    s_branch L_m_cl
L_fin_p5:
    buffer_store_dwordx4 v[208:211], v4, s[16:19], s34 offen offset:0
    buffer_store_dwordx4 v[212:215], v4, s[16:19], s34 offen offset:64
    v_permlane32_swap_b32 v36, v220
    v_permlane32_swap_b32 v37, v221
    v_permlane32_swap_b32 v38, v222
    v_permlane32_swap_b32 v39, v223
    v_pk_add_f32 v[32:33], v[32:33], v[220:221]
    v_pk_add_f32 v[34:35], v[34:35], v[222:223]
    v_cvt_pk_bf16_f32 v216, v32, v33
    v_cvt_pk_bf16_f32 v217, v34, v35
    buffer_store_dwordx2 v[216:217], v5, s[16:19], s34 offen offset:128
    s_endpgm
L_m_l1:
    s_and_b32 s25, s2, 7
    s_lshr_b32 s26, s2, 3
    s_lshr_b32 s23, s25, 1
    s_lshl_b32 s23, s23, 2
    s_lshr_b32 s27, s26, 3
    s_add_u32 s23, s23, s27
    s_and_b32 s24, s25, 1
    s_lshl_b32 s24, s24, 3
    s_and_b32 s27, s26, 7
    s_add_u32 s24, s24, s27
    s_mul_i32 s29, s24, 129024
    s_lshl_b32 s30, s20, 12
    s_add_u32 s29, s29, s30
    s_add_u32 s29, s29, 0x3800000
    s_lshl_b32 s31, s23, 3
    s_max_u32 s31, s31, 1
    s_sub_u32 s31, s31, 1
    s_mul_i32 s31, s31, 18432
    s_add_u32 s31, s31, 0x0
    s_lshl_b32 s35, s20, 10
    s_and_b32 s36, s35, 1024
    s_barrier
    s_add_u32 m0, s35, 131072
    s_add_u32 s34, s31, s35
    s_add_u32 s34, s34, 0
    buffer_load_dwordx4 v1, s[4:7], s34 offen sc1 lds
    s_add_u32 m0, s30, 0
    s_add_u32 s34, s29, 0
    buffer_load_dwordx4 v1, s[4:7], s34 offen offset:0 sc1 lds
    buffer_load_dwordx4 v1, s[4:7], s34 offen offset:1024 sc1 lds
    buffer_load_dwordx4 v1, s[4:7], s34 offen offset:2048 sc1 lds
    buffer_load_dwordx4 v1, s[4:7], s34 offen offset:3072 sc1 lds
    s_add_u32 m0, s30, 16384
    s_add_u32 s34, s29, 16384
    buffer_load_dwordx4 v1, s[4:7], s34 offen offset:0 sc1 lds
    buffer_load_dwordx4 v1, s[4:7], s34 offen offset:1024 sc1 lds
    buffer_load_dwordx4 v1, s[4:7], s34 offen offset:2048 sc1 lds
    buffer_load_dwordx4 v1, s[4:7], s34 offen offset:3072 sc1 lds
    s_waitcnt vmcnt(4) lgkmcnt(0)
    s_barrier
    s_add_u32 m0, s35, 135168
    s_add_u32 s34, s31, s35
    s_add_u32 s34, s34, 4096
    buffer_load_dwordx4 v1, s[4:7], s34 offen sc1 lds
    s_add_u32 m0, s30, 32768
    s_add_u32 s34, s29, 32768
    buffer_load_dwordx4 v1, s[4:7], s34 offen offset:0 sc1 lds
    buffer_load_dwordx4 v1, s[4:7], s34 offen offset:1024 sc1 lds
    buffer_load_dwordx4 v1, s[4:7], s34 offen offset:2048 sc1 lds
    buffer_load_dwordx4 v1, s[4:7], s34 offen offset:3072 sc1 lds
    s_add_u32 m0, s30, 49152
    s_add_u32 s34, s29, 49152
    buffer_load_dwordx4 v1, s[4:7], s34 offen offset:0 sc1 lds
    buffer_load_dwordx4 v1, s[4:7], s34 offen offset:1024 sc1 lds
    buffer_load_dwordx4 v1, s[4:7], s34 offen offset:2048 sc1 lds
    buffer_load_dwordx4 v1, s[4:7], s34 offen offset:3072 sc1 lds
    s_cmp_lt_u32 s2, 144
    s_cbranch_scc1 L_p0_t1
    s_cmp_ge_u32 s2, 216
    s_cbranch_scc1 L_p0_t2
    ds_read_b64_tr_b16 v[16:17], v4 offset:0
    ds_read_b64_tr_b16 v[18:19], v4 offset:2048
    ds_read_b64_tr_b16 v[20:21], v4 offset:18432
    ds_read_b64_tr_b16 v[22:23], v4 offset:20480
    ds_read_b64_tr_b16 v[24:25], v4 offset:4096
    ds_read_b64_tr_b16 v[26:27], v4 offset:6144
    ds_read_b64_tr_b16 v[28:29], v4 offset:22528
    ds_read_b64_tr_b16 v[30:31], v4 offset:24576
    ds_read_b64_tr_b16 v[32:33], v4 offset:8192
    ds_read_b64_tr_b16 v[34:35], v4 offset:10240
    ds_read_b64_tr_b16 v[36:37], v4 offset:26624
    ds_read_b64_tr_b16 v[38:39], v4 offset:28672
    ds_read_b64_tr_b16 v[40:41], v4 offset:12288
    ds_read_b64_tr_b16 v[42:43], v4 offset:14336
    ds_read_b64_tr_b16 v[44:45], v4 offset:30720
    ds_read_b64_tr_b16 v[46:47], v4 offset:32768
    ds_read_b64_tr_b16 v[48:49], v5 offset:16384
    ds_read_b64_tr_b16 v[50:51], v5 offset:34816
    s_branch L_p0_t2
L_p0_t1:
    ds_read_b64_tr_b16 v[16:17], v4 offset:0
    ds_read_b64_tr_b16 v[18:19], v4 offset:512
    ds_read_b64_tr_b16 v[20:21], v4 offset:4096
    ds_read_b64_tr_b16 v[22:23], v4 offset:4608
    ds_read_b64_tr_b16 v[24:25], v4 offset:9216
    ds_read_b64_tr_b16 v[26:27], v4 offset:9728
    ds_read_b64_tr_b16 v[28:29], v4 offset:13312
    ds_read_b64_tr_b16 v[30:31], v4 offset:13824
    ds_read_b64_tr_b16 v[32:33], v4 offset:18432
    ds_read_b64_tr_b16 v[34:35], v4 offset:18944
    ds_read_b64_tr_b16 v[36:37], v4 offset:22528
    ds_read_b64_tr_b16 v[38:39], v4 offset:23040
    ds_read_b64_tr_b16 v[40:41], v4 offset:27648
    ds_read_b64_tr_b16 v[42:43], v4 offset:28160
    ds_read_b64_tr_b16 v[44:45], v4 offset:31744
    ds_read_b64_tr_b16 v[46:47], v4 offset:32256
    ds_read_b64_tr_b16 v[48:49], v5 offset:8192
    ds_read_b64_tr_b16 v[50:51], v5 offset:8704
L_p0_t2:
    s_waitcnt lgkmcnt(0)
    s_waitcnt vmcnt(9) lgkmcnt(0)
    s_barrier
    s_add_u32 m0, s35, 139264
    s_add_u32 s34, s31, s35
    s_add_u32 s34, s34, 8192
    buffer_load_dwordx4 v1, s[4:7], s34 offen sc1 lds
    v_lshrrev_b32 v60, 8, v1
    v_bfe_u32 v61, v1, 7, 1
    v_bfe_u32 v62, v1, 4, 3
    v_cmp_gt_u32 vcc, 3, v60
    v_mul_u32_u24 v61, 80, v61
    v_lshl_add_u32 v61, v62, 3, v61
    v_lshrrev_b32 v63, 1, v62
    v_and_b32 v62, 1, v62
    v_lshl_add_u32 v62, v62, 3, 64
    v_cndmask_b32 v60, v63, v60, vcc
    v_cndmask_b32 v61, v62, v61, vcc
    v_mul_u32_u24 v60, 2304, v60
    v_add_u32 v69, v60, v61
    v_lshrrev_b32 v68, 1, v1
    s_mul_i32 s34, s24, 144
    s_add_u32 s34, s34, 0x4400000
    buffer_load_dwordx2 v[60:61], v69, s[4:7], s34 offen sc1
    s_mul_i32 s34, s24, 144
    s_add_u32 s34, s34, 0x4402000
    buffer_load_dwordx2 v[62:63], v69, s[4:7], s34 offen sc1
    s_mul_i32 s34, s24, 144
    s_add_u32 s34, s34, 0x4404000
    buffer_load_dwordx2 v[64:65], v69, s[4:7], s34 offen sc1
    s_mul_i32 s34, s24, 144
    s_add_u32 s34, s34, 0x4406000
    buffer_load_dwordx2 v[66:67], v69, s[4:7], s34 offen sc1
    s_add_u32 m0, s30, 65536
    s_add_u32 s34, s29, 65536
    buffer_load_dwordx4 v1, s[4:7], s34 offen offset:0 sc1 lds
    buffer_load_dwordx4 v1, s[4:7], s34 offen offset:1024 sc1 lds
    buffer_load_dwordx4 v1, s[4:7], s34 offen offset:2048 sc1 lds
    buffer_load_dwordx4 v1, s[4:7], s34 offen offset:3072 sc1 lds
    s_waitcnt vmcnt(13) lgkmcnt(0)
    s_barrier
    s_add_u32 m0, s30, 81920
    s_add_u32 s34, s29, 81920
    buffer_load_dwordx4 v1, s[4:7], s34 offen offset:0 sc1 lds
    buffer_load_dwordx4 v1, s[4:7], s34 offen offset:1024 sc1 lds
    buffer_load_dwordx4 v1, s[4:7], s34 offen offset:2048 sc1 lds
    buffer_load_dwordx4 v1, s[4:7], s34 offen offset:3072 sc1 lds
    s_waitcnt vmcnt(13) lgkmcnt(0)
    s_barrier
    s_add_u32 m0, s35, 143360
    s_add_u32 s34, s31, s35
    s_add_u32 s34, s34, 12288
    buffer_load_dwordx4 v1, s[4:7], s34 offen sc1 lds
    s_add_u32 m0, s30, 98304
    s_add_u32 s34, s29, 98304
    buffer_load_dwordx4 v1, s[4:7], s34 offen offset:0 sc1 lds
    buffer_load_dwordx4 v1, s[4:7], s34 offen offset:1024 sc1 lds
    buffer_load_dwordx4 v1, s[4:7], s34 offen offset:2048 sc1 lds
    buffer_load_dwordx4 v1, s[4:7], s34 offen offset:3072 sc1 lds
    s_waitcnt vmcnt(13)
    v_add_f32 v60, v60, v62
    v_add_f32 v61, v61, v63
    v_add_f32 v64, v64, v66
    v_add_f32 v65, v65, v67
    v_add_f32 v60, v60, v64
    v_add_f32 v61, v61, v65
    v_cmp_gt_u32 vcc, 864, v1
    v_add_u32 v68, 161792, v68
    s_nop 0
    v_cndmask_b32 v60, 0, v60, vcc
    v_cndmask_b32 v61, 0, v61, vcc
    ds_write_b64 v68, v[60:61]
    s_waitcnt vmcnt(9) lgkmcnt(0)
    s_barrier
    s_add_u32 m0, s36, 147456
    s_add_u32 s34, s31, s36
    s_add_u32 s34, s34, 16384
    buffer_load_dwordx4 v1, s[4:7], s34 offen sc1 lds
    s_add_u32 m0, s30, 114688
    s_add_u32 s34, s29, 114688
    buffer_load_dwordx4 v1, s[4:7], s34 offen offset:0 sc1 lds
    buffer_load_dwordx4 v1, s[4:7], s34 offen offset:1024 sc1 lds
    buffer_load_dwordx4 v1, s[4:7], s34 offen offset:2048 sc1 lds
    buffer_load_dwordx4 v1, s[4:7], s34 offen offset:3072 sc1 lds
    s_waitcnt vmcnt(10) lgkmcnt(0)
    s_barrier
    buffer_store_dwordx4 v[16:19], v9, s[4:7], s37 offen sc1
    buffer_store_dwordx4 v[20:23], v10, s[4:7], s38 offen sc1
    buffer_store_dwordx4 v[24:27], v9, s[4:7], s39 offen sc1
    buffer_store_dwordx4 v[28:31], v10, s[4:7], s40 offen sc1
    s_waitcnt vmcnt(9) lgkmcnt(0)
    s_barrier
    buffer_store_dwordx4 v[32:35], v9, s[4:7], s41 offen sc1
    buffer_store_dwordx4 v[36:39], v10, s[4:7], s42 offen sc1
    buffer_store_dwordx4 v[40:43], v9, s[4:7], s43 offen sc1
    s_waitcnt vmcnt(7) lgkmcnt(0)
    s_barrier
    s_mov_b32 s46, 0x4502000
    v_mov_b32 v4, 0
    s_mov_b32 s60, 65536
L_poll_wo:
    buffer_load_dword v5, v4, s[4:7], s46 offen sc1
    s_waitcnt vmcnt(0)
    v_cmp_gt_u32 vcc, 18, v5
    s_sub_u32 s60, s60, 1
    s_cbranch_scc1 L_pd_wo
    s_cbranch_vccz L_pd_wo
    s_sleep 4
    s_branch L_poll_wo
L_pd_wo:
    buffer_store_dwordx4 v[44:47], v10, s[4:7], s47 offen sc1
    buffer_store_dwordx4 v[48:51], v14, s[4:7], s48 offen sc1
    v_dot2_f32_bf16 v12, v16, v11, 0
    v_dot2_f32_bf16 v13, v17, v11, 0
    v_dot2_f32_bf16 v12, v18, v11, v12
    v_dot2_f32_bf16 v13, v19, v11, v13
    v_dot2_f32_bf16 v12, v20, v11, v12
    v_dot2_f32_bf16 v13, v21, v11, v13
    v_dot2_f32_bf16 v12, v22, v11, v12
    v_dot2_f32_bf16 v13, v23, v11, v13
    v_dot2_f32_bf16 v12, v24, v11, v12
    v_dot2_f32_bf16 v13, v25, v11, v13
    v_dot2_f32_bf16 v12, v26, v11, v12
    v_dot2_f32_bf16 v13, v27, v11, v13
    v_dot2_f32_bf16 v12, v28, v11, v12
    v_dot2_f32_bf16 v13, v29, v11, v13
    v_dot2_f32_bf16 v12, v30, v11, v12
    v_dot2_f32_bf16 v13, v31, v11, v13
    v_dot2_f32_bf16 v12, v32, v11, v12
    v_dot2_f32_bf16 v13, v33, v11, v13
    v_dot2_f32_bf16 v12, v34, v11, v12
    v_dot2_f32_bf16 v13, v35, v11, v13
    v_dot2_f32_bf16 v12, v36, v11, v12
    v_dot2_f32_bf16 v13, v37, v11, v13
    v_dot2_f32_bf16 v12, v38, v11, v12
    v_dot2_f32_bf16 v13, v39, v11, v13
    v_dot2_f32_bf16 v12, v40, v11, v12
    v_dot2_f32_bf16 v13, v41, v11, v13
    v_dot2_f32_bf16 v12, v42, v11, v12
    v_dot2_f32_bf16 v13, v43, v11, v13
    v_dot2_f32_bf16 v12, v44, v11, v12
    v_dot2_f32_bf16 v13, v45, v11, v13
    v_dot2_f32_bf16 v12, v46, v11, v12
    v_dot2_f32_bf16 v13, v47, v11, v13
    v_dot2_f32_bf16 v12, v48, v11, v12
    v_dot2_f32_bf16 v13, v49, v11, v13
    v_dot2_f32_bf16 v12, v50, v11, v12
    v_dot2_f32_bf16 v13, v51, v11, v13
    s_nop 2
    v_add_f32 v12, v12, v13
    v_mov_b32 v13, v12
    s_nop 1
    v_permlane32_swap_b32 v12, v13
    v_add_f32 v12, v12, v13
    v_mov_b32 v13, v12
    s_nop 1
    v_permlane16_swap_b32 v12, v13
    v_add_f32 v12, v12, v13
    buffer_store_dword v12, v15, s[4:7], s49 offen sc1
    s_barrier
L_m_ll:
    s_and_b32 s25, s2, 7
    s_lshr_b32 s26, s2, 3
    s_lshr_b32 s23, s25, 1
    s_lshl_b32 s23, s23, 3
    s_lshr_b32 s27, s26, 2
    s_add_u32 s23, s23, s27
    s_and_b32 s24, s25, 1
    s_lshl_b32 s24, s24, 2
    s_and_b32 s27, s26, 3
    s_add_u32 s24, s24, s27
    s_add_u32 s25, s23, s24
    s_and_b32 s25, s25, 3
    s_mul_i32 s29, s24, 82944
    s_add_u32 s29, s29, 0x3a00000
    s_mul_i32 s30, s20, 36864
    s_mul_i32 s31, s20, 18432
    s_add_u32 s31, s31, s29
    s_add_u32 m0, s30, 18432
    s_add_u32 s33, s31, 0
    buffer_load_dwordx4 v1, s[4:7], s33 offen offset:0  sc1 lds
    buffer_load_dwordx4 v1, s[4:7], s33 offen offset:1024  sc1 lds
    buffer_load_dwordx4 v1, s[4:7], s33 offen offset:2048  sc1 lds
    buffer_load_dwordx4 v1, s[4:7], s33 offen offset:3072  sc1 lds
    s_add_u32 m0, s30, 22528
    s_add_u32 s33, s31, 4096
    buffer_load_dwordx4 v1, s[4:7], s33 offen offset:0  sc1 lds
    buffer_load_dwordx4 v1, s[4:7], s33 offen offset:1024  sc1 lds
    buffer_load_dwordx4 v1, s[4:7], s33 offen offset:2048  sc1 lds
    buffer_load_dwordx4 v1, s[4:7], s33 offen offset:3072  sc1 lds
    s_add_u32 m0, s30, 26624
    s_add_u32 s33, s31, 8192
    buffer_load_dwordx4 v1, s[4:7], s33 offen offset:0  sc1 lds
    buffer_load_dwordx4 v1, s[4:7], s33 offen offset:1024  sc1 lds
    buffer_load_dwordx4 v1, s[4:7], s33 offen offset:2048  sc1 lds
    buffer_load_dwordx4 v1, s[4:7], s33 offen offset:3072  sc1 lds
    s_add_u32 m0, s30, 30720
    s_add_u32 s33, s31, 12288
    buffer_load_dwordx4 v1, s[4:7], s33 offen offset:0  sc1 lds
    buffer_load_dwordx4 v1, s[4:7], s33 offen offset:1024  sc1 lds
    buffer_load_dwordx4 v1, s[4:7], s33 offen offset:2048  sc1 lds
    buffer_load_dwordx4 v1, s[4:7], s33 offen offset:3072  sc1 lds
    s_add_u32 m0, s30, 34816
    s_add_u32 s33, s31, 16384
    buffer_load_dwordx4 v1, s[4:7], s33 offen offset:0  sc1 lds
    buffer_load_dwordx4 v1, s[4:7], s33 offen offset:1024  sc1 lds
    s_mul_i32 s30, s20, 3072
    s_add_u32 s31, s30, s29
    s_waitcnt vmcnt(18)
    s_barrier
    s_add_u32 m0, s30, 147456
    s_add_u32 s33, s31, 73728
    buffer_load_dwordx4 v1, s[4:7], s33 offen offset:0  sc1 lds
    buffer_load_dwordx4 v1, s[4:7], s33 offen offset:1024  sc1 lds
    buffer_load_dwordx4 v1, s[4:7], s33 offen offset:2048  sc1 lds
    s_or_b32 s44, s20, s22
    s_cbranch_scc1 L_p2_ns
    s_and_b32 s44, s2, 15
    s_lshl_b32 s44, s44, 8
    s_add_u32 s44, s44, 0x4501000
    s_add_u32 s44, s44, s4
    s_addc_u32 s45, s5, 0
    s_mov_b32 s56, 1
    s_atomic_add s56, s[44:45], 0
L_p2_ns:
    s_waitcnt vmcnt(0)
    s_barrier
    s_and_b32 s25, s2, 7
    s_lshr_b32 s26, s2, 3
    s_and_b32 s23, s25, 1
    s_lshl_b32 s23, s23, 3
    s_and_b32 s27, s26, 7
    s_add_u32 s23, s23, s27
    s_lshr_b32 s24, s25, 1
    s_lshl_b32 s24, s24, 2
    s_lshr_b32 s27, s26, 3
    s_add_u32 s24, s24, s27
    s_add_u32 s28, s23, s24
    s_and_b32 s28, s28, 3
    s_lshl_b32 s30, s20, 12
    s_lshr_b32 s33, s20, 1
    s_mul_i32 s31, s33, 36864
    s_and_b32 s33, s20, 1
    s_lshl_b32 s33, s33, 10
    s_add_u32 s33, s33, 16384
    s_add_u32 s31, s31, s33
    s_sub_u32 s49, s33, s30
    s_mul_i32 s34, s24, 331776
    s_add_u32 s34, s34, s30
    s_add_u32 s34, s34, 0x3b00000
    s_lshl_b32 s35, s23, 3
    s_lshl_b32 s33, s20, 1
    s_add_u32 s35, s35, s33
    s_mul_i32 s35, s35, 18432
    s_add_u32 s35, s35, s21
    s_add_u32 s35, s35, 0x300000
    s_mul_i32 s36, s24, 589824
    s_add_u32 s36, s36, s30
    s_add_u32 s36, s36, s21
    s_add_u32 s36, s36, 0x900000
    v_add_u32 v2, 16384, v1
    s_add_u32 s33, s30, 18432
    v_add_u32 v6, s33, v1
    v_add_u32 v7, 73728, v6
    s_lshl_b32 s29, s23, 2
    s_add_u32 s29, s29, s20
    s_lshl_b32 s29, s29, 12
    s_add_u32 s29, s29, s21
    s_add_u32 s29, s29, 0x1b40000
    v_and_b32 v3, 48, v1
    v_lshrrev_b32 v8, 8, v1
    v_lshl_add_u32 v3, v8, 6, v3
    v_bfe_u32 v8, v1, 6, 2
    v_lshl_add_u32 v3, v8, 8, v3
    s_lshl_b32 s33, s23, 7
    s_lshl_b32 s37, s20, 5
    s_add_u32 s33, s33, s37
    v_lshrrev_b32 v8, 7, v1
    v_add_u32 v8, s33, v8
    v_lshlrev_b32 v8, 12, v8
    v_lshrrev_b32 v9, 8, v1
    v_bfe_u32 v10, v1, 4, 3
    v_xor_b32 v9, v9, v10
    v_lshl_add_u32 v8, v9, 4, v8
    v_xor_b32 v9, 64, v8
    v_add_u32 v9, 31744, v9
    v_add_u32 v10, 63488, v8
    v_add_u32 v11, 63488, v9
    s_cmp_eq_u32 s28, 0
    s_cselect_b32 s44, 4, 0
    s_cmp_eq_u32 s28, 1
    s_cselect_b32 s45, 5, 1
    s_cmp_eq_u32 s28, 2
    s_cselect_b32 s46, 6, 2
    s_cmp_eq_u32 s28, 3
    s_cselect_b32 s47, 7, 3
    s_lshl_b32 s33, s20, 4
    s_add_u32 s33, s33, s24
    s_lshl_b32 s54, s22, 7
    s_add_u32 s54, s54, s33
    s_lshl_b32 s54, s54, 8
    s_add_u32 s54, s54, 0x450c000
    s_add_u32 s54, s54, s4
    s_addc_u32 s55, s5, 0
    s_mov_b32 s33, 0x4501000
    v_and_b32 v4, 0xf0, v1
    v_lshlrev_b32 v4, 4, v4
    s_mov_b32 s60, 65536
L_poll_wr:
    buffer_load_dword v5, v4, s[4:7], s33 offen sc1
    s_waitcnt vmcnt(0)
    v_cmp_gt_u32 vcc, 16, v5
    s_sub_u32 s60, s60, 1
    s_cbranch_scc1 L_pd_wr
    s_cbranch_vccz L_pd_wr
    s_sleep 4
    s_branch L_poll_wr
L_pd_wr:
    s_min_u32 s33, s20, 2
    s_lshl_b32 s33, s33, 9
    v_lshrrev_b32 v4, 1, v1
    v_add_u32 v4, s33, v4
    s_lshl_b32 s51, s24, 12
    s_add_u32 s51, s51, 0x4410000
    buffer_load_dwordx2 v[60:61], v4, s[4:7], s51 offen offset:0 sc1
    buffer_load_dwordx2 v[62:63], v4, s[4:7], s51 offen offset:1152 sc1
    s_mov_b32 s48, 0
    s_mul_i32 s50, s48, 18432
    s_add_u32 s50, s50, s34
    s_add_u32 m0, s30, 0
    s_mov_b32 s53, s50
    buffer_load_dwordx4 v1, s[4:7], s50 offen offset:0  sc1 lds
    buffer_load_dwordx4 v1, s[4:7], s50 offen offset:1024  sc1 lds
    buffer_load_dwordx4 v1, s[4:7], s50 offen offset:2048  sc1 lds
    buffer_load_dwordx4 v1, s[4:7], s50 offen offset:3072  sc1 lds
    s_mov_b32 s48, 1
    s_mul_i32 s50, s48, 18432
    s_add_u32 s50, s50, s34
    s_cmp_ge_u32 s20, 2
    s_cselect_b32 s52, s50, s53
    s_add_u32 m0, s31, 0
    s_add_u32 s52, s52, s49
    buffer_load_dwordx4 v1, s[4:7], s52 offen  sc1 lds
    s_add_u32 m0, s30, 36864
    s_mov_b32 s53, s50
    buffer_load_dwordx4 v1, s[4:7], s50 offen offset:0  sc1 lds
    buffer_load_dwordx4 v1, s[4:7], s50 offen offset:1024  sc1 lds
    buffer_load_dwordx4 v1, s[4:7], s50 offen offset:2048  sc1 lds
    buffer_load_dwordx4 v1, s[4:7], s50 offen offset:3072  sc1 lds
    s_mov_b32 m0, 161280
    v_lshrrev_b32 v5, 2, v1
    s_lshl_b32 s33, s23, 8
    buffer_load_dword v5, s[12:15], s33 offen lds
    s_waitcnt vmcnt(10)
    v_add_u32 v4, 159744, v4
    v_add_f32 v60, v60, v62
    v_add_f32 v61, v61, v63
    ds_write_b64 v4, v[60:61]
    s_waitcnt lgkmcnt(0)
    s_barrier
    s_mov_b32 s48, 2
    s_mul_i32 s50, s48, 18432
    s_add_u32 s50, s50, s34
    s_add_u32 m0, s30, 73728
    s_mov_b32 s53, s50
    buffer_load_dwordx4 v1, s[4:7], s50 offen offset:0  sc1 lds
    buffer_load_dwordx4 v1, s[4:7], s50 offen offset:1024  sc1 lds
    buffer_load_dwordx4 v1, s[4:7], s50 offen offset:2048  sc1 lds
    buffer_load_dwordx4 v1, s[4:7], s50 offen offset:3072  sc1 lds
    s_mov_b32 s48, 3
    s_mul_i32 s50, s48, 18432
    s_add_u32 s50, s50, s34
    s_cmp_ge_u32 s20, 2
    s_cselect_b32 s52, s50, s53
    s_add_u32 m0, s31, 73728
    s_add_u32 s52, s52, s49
    buffer_load_dwordx4 v1, s[4:7], s52 offen  sc1 lds
    s_add_u32 m0, s30, 110592
    s_mov_b32 s53, s50
    buffer_load_dwordx4 v1, s[4:7], s50 offen offset:0  sc1 lds
    buffer_load_dwordx4 v1, s[4:7], s50 offen offset:1024  sc1 lds
    buffer_load_dwordx4 v1, s[4:7], s50 offen offset:2048  sc1 lds
    buffer_load_dwordx4 v1, s[4:7], s50 offen offset:3072  sc1 lds
    s_barrier
    s_add_u32 m0, s30, 18432
    s_add_u32 s51, s35, 0
    buffer_load_dwordx4 v1, s[4:7], s51 offen offset:0 sc1 lds
    buffer_load_dwordx4 v1, s[4:7], s51 offen offset:1024 sc1 lds
    buffer_load_dwordx4 v2, s[4:7], s51 offen offset:2048 sc1 lds
    buffer_load_dwordx4 v2, s[4:7], s51 offen offset:3072 sc1 lds
    s_add_u32 m0, s30, 55296
    s_add_u32 s51, s35, 2048
    buffer_load_dwordx4 v1, s[4:7], s51 offen offset:0 sc1 lds
    buffer_load_dwordx4 v1, s[4:7], s51 offen offset:1024 sc1 lds
    buffer_load_dwordx4 v2, s[4:7], s51 offen offset:2048 sc1 lds
    buffer_load_dwordx4 v2, s[4:7], s51 offen offset:3072 sc1 lds
    s_add_u32 m0, s30, 92160
    s_add_u32 s51, s35, 4096
    buffer_load_dwordx4 v1, s[4:7], s51 offen offset:0 sc1 lds
    buffer_load_dwordx4 v1, s[4:7], s51 offen offset:1024 sc1 lds
    buffer_load_dwordx4 v2, s[4:7], s51 offen offset:2048 sc1 lds
    buffer_load_dwordx4 v2, s[4:7], s51 offen offset:3072 sc1 lds
    s_waitcnt vmcnt(8)
    s_barrier
    s_add_u32 m0, s30, 129024
    s_add_u32 s51, s35, 6144
    buffer_load_dwordx4 v1, s[4:7], s51 offen offset:0 sc1 lds
    buffer_load_dwordx4 v1, s[4:7], s51 offen offset:1024 sc1 lds
    buffer_load_dwordx4 v2, s[4:7], s51 offen offset:2048 sc1 lds
    buffer_load_dwordx4 v2, s[4:7], s51 offen offset:3072 sc1 lds
    s_waitcnt vmcnt(8) lgkmcnt(0)
    s_barrier
    s_mov_b32 s48, 4
    s_mul_i32 s50, s48, 18432
    s_add_u32 s50, s50, s34
    s_add_u32 m0, s30, 0
    s_mov_b32 s53, s50
    buffer_load_dwordx4 v1, s[4:7], s50 offen offset:0  sc1 lds
    buffer_load_dwordx4 v1, s[4:7], s50 offen offset:1024  sc1 lds
    buffer_load_dwordx4 v1, s[4:7], s50 offen offset:2048  sc1 lds
    buffer_load_dwordx4 v1, s[4:7], s50 offen offset:3072  sc1 lds
    s_add_u32 m0, s30, 18432
    s_add_u32 s51, s35, 8192
    buffer_load_dwordx4 v1, s[4:7], s51 offen offset:0 sc1 lds
    buffer_load_dwordx4 v1, s[4:7], s51 offen offset:1024 sc1 lds
    buffer_load_dwordx4 v2, s[4:7], s51 offen offset:2048 sc1 lds
    buffer_load_dwordx4 v2, s[4:7], s51 offen offset:3072 sc1 lds
    s_waitcnt vmcnt(12) lgkmcnt(0)
    s_barrier
    s_mov_b32 s48, 5
    s_mul_i32 s50, s48, 18432
    s_add_u32 s50, s50, s34
    s_cmp_ge_u32 s20, 2
    s_cselect_b32 s52, s50, s53
    s_add_u32 m0, s31, 0
    s_add_u32 s52, s52, s49
    buffer_load_dwordx4 v1, s[4:7], s52 offen  sc1 lds
    s_add_u32 m0, s30, 36864
    s_mov_b32 s53, s50
    buffer_load_dwordx4 v1, s[4:7], s50 offen offset:0  sc1 lds
    buffer_load_dwordx4 v1, s[4:7], s50 offen offset:1024  sc1 lds
    buffer_load_dwordx4 v1, s[4:7], s50 offen offset:2048  sc1 lds
    buffer_load_dwordx4 v1, s[4:7], s50 offen offset:3072  sc1 lds
    s_add_u32 m0, s30, 55296
    s_add_u32 s51, s35, 10240
    buffer_load_dwordx4 v1, s[4:7], s51 offen offset:0 sc1 lds
    buffer_load_dwordx4 v1, s[4:7], s51 offen offset:1024 sc1 lds
    buffer_load_dwordx4 v2, s[4:7], s51 offen offset:2048 sc1 lds
    buffer_load_dwordx4 v2, s[4:7], s51 offen offset:3072 sc1 lds
    s_waitcnt vmcnt(17) lgkmcnt(0)
    s_barrier
    s_mov_b32 s48, 6
    s_mul_i32 s50, s48, 18432
    s_add_u32 s50, s50, s34
    s_add_u32 m0, s30, 73728
    s_mov_b32 s53, s50
    buffer_load_dwordx4 v1, s[4:7], s50 offen offset:0  sc1 lds
    buffer_load_dwordx4 v1, s[4:7], s50 offen offset:1024  sc1 lds
    buffer_load_dwordx4 v1, s[4:7], s50 offen offset:2048  sc1 lds
    buffer_load_dwordx4 v1, s[4:7], s50 offen offset:3072  sc1 lds
    s_add_u32 m0, s30, 92160
    s_add_u32 s51, s35, 12288
    buffer_load_dwordx4 v1, s[4:7], s51 offen offset:0 sc1 lds
    buffer_load_dwordx4 v1, s[4:7], s51 offen offset:1024 sc1 lds
    buffer_load_dwordx4 v2, s[4:7], s51 offen offset:2048 sc1 lds
    buffer_load_dwordx4 v2, s[4:7], s51 offen offset:3072 sc1 lds
    s_waitcnt vmcnt(16) lgkmcnt(0)
    s_barrier
    s_mov_b32 s48, 7
    s_mul_i32 s50, s48, 18432
    s_add_u32 s50, s50, s34
    s_cmp_ge_u32 s20, 2
    s_cselect_b32 s52, s50, s53
    s_add_u32 m0, s31, 73728
    s_add_u32 s52, s52, s49
    buffer_load_dwordx4 v1, s[4:7], s52 offen  sc1 lds
    s_add_u32 m0, s30, 110592
    s_mov_b32 s53, s50
    buffer_load_dwordx4 v1, s[4:7], s50 offen offset:0  sc1 lds
    buffer_load_dwordx4 v1, s[4:7], s50 offen offset:1024  sc1 lds
    buffer_load_dwordx4 v1, s[4:7], s50 offen offset:2048  sc1 lds
    buffer_load_dwordx4 v1, s[4:7], s50 offen offset:3072  sc1 lds
    s_add_u32 m0, s30, 129024
    s_add_u32 s51, s35, 14336
    buffer_load_dwordx4 v1, s[4:7], s51 offen offset:0 sc1 lds
    buffer_load_dwordx4 v1, s[4:7], s51 offen offset:1024 sc1 lds
    buffer_load_dwordx4 v2, s[4:7], s51 offen offset:2048 sc1 lds
    buffer_load_dwordx4 v2, s[4:7], s51 offen offset:3072 sc1 lds
    s_waitcnt vmcnt(17) lgkmcnt(0)
    s_barrier
    s_mov_b32 s48, 8
    s_mul_i32 s50, s48, 18432
    s_add_u32 s50, s50, s34
    s_add_u32 m0, s30, 0
    s_mov_b32 s53, s50
    buffer_load_dwordx4 v1, s[4:7], s50 offen offset:0  sc1 lds
    buffer_load_dwordx4 v1, s[4:7], s50 offen offset:1024  sc1 lds
    buffer_load_dwordx4 v1, s[4:7], s50 offen offset:2048  sc1 lds
    buffer_load_dwordx4 v1, s[4:7], s50 offen offset:3072  sc1 lds
    s_add_u32 m0, s30, 18432
    s_add_u32 s51, s35, 16384
    buffer_load_dwordx4 v1, s[4:7], s51 offen offset:0 sc1 lds
    buffer_load_dwordx4 v1, s[4:7], s51 offen offset:1024 sc1 lds
    buffer_load_dwordx4 v2, s[4:7], s51 offen offset:2048 sc1 lds
    buffer_load_dwordx4 v2, s[4:7], s51 offen offset:3072 sc1 lds
    s_waitcnt vmcnt(16) lgkmcnt(0)
    s_barrier
    s_mov_b32 s48, 5
    s_mul_i32 s50, s48, 18432
    s_add_u32 s50, s50, s34
    s_add_u32 s50, s50, 165888
    s_cmp_ge_u32 s20, 2
    s_cselect_b32 s52, s50, s53
    s_add_u32 m0, s31, 0
    s_add_u32 s52, s52, s49
    buffer_load_dwordx4 v1, s[4:7], s52 offen  sc1 lds
    s_add_u32 m0, s30, 36864
    s_mov_b32 s53, s50
    buffer_load_dwordx4 v1, s[4:7], s50 offen offset:0  sc1 lds
    buffer_load_dwordx4 v1, s[4:7], s50 offen offset:1024  sc1 lds
    buffer_load_dwordx4 v1, s[4:7], s50 offen offset:2048  sc1 lds
    buffer_load_dwordx4 v1, s[4:7], s50 offen offset:3072  sc1 lds
    s_waitcnt vmcnt(13) lgkmcnt(0)
    s_barrier
    s_waitcnt vmcnt(4) lgkmcnt(0)
    s_barrier
    s_waitcnt vmcnt(0) lgkmcnt(0)
    s_barrier
    s_mov_b32 s48, 6
    s_mul_i32 s50, s48, 18432
    s_add_u32 s50, s50, s34
    s_add_u32 s50, s50, 165888
    s_add_u32 m0, s30, 73728
    s_mov_b32 s53, s50
    buffer_load_dwordx4 v1, s[4:7], s50 offen offset:0  sc1 lds
    buffer_load_dwordx4 v1, s[4:7], s50 offen offset:1024  sc1 lds
    buffer_load_dwordx4 v1, s[4:7], s50 offen offset:2048  sc1 lds
    buffer_load_dwordx4 v1, s[4:7], s50 offen offset:3072  sc1 lds
    s_mov_b32 s48, 7
    s_mul_i32 s50, s48, 18432
    s_add_u32 s50, s50, s34
    s_add_u32 s50, s50, 165888
    s_cmp_ge_u32 s20, 2
    s_cselect_b32 s52, s50, s53
    s_add_u32 m0, s31, 73728
    s_add_u32 s52, s52, s49
    buffer_load_dwordx4 v1, s[4:7], s52 offen  sc1 lds
    s_add_u32 m0, s30, 110592
    s_mov_b32 s53, s50
    buffer_load_dwordx4 v1, s[4:7], s50 offen offset:0  sc1 lds
    buffer_load_dwordx4 v1, s[4:7], s50 offen offset:1024  sc1 lds
    buffer_load_dwordx4 v1, s[4:7], s50 offen offset:2048  sc1 lds
    buffer_load_dwordx4 v1, s[4:7], s50 offen offset:3072  sc1 lds
    s_mov_b32 s48, 8
    s_mul_i32 s50, s48, 18432
    s_add_u32 s50, s50, s34
    s_add_u32 s50, s50, 165888
    s_add_u32 m0, s30, 0
    s_mov_b32 s53, s50
    buffer_load_dwordx4 v1, s[4:7], s50 offen offset:0  sc1 lds
    buffer_load_dwordx4 v1, s[4:7], s50 offen offset:1024  sc1 lds
    buffer_load_dwordx4 v1, s[4:7], s50 offen offset:2048  sc1 lds
    buffer_load_dwordx4 v1, s[4:7], s50 offen offset:3072  sc1 lds
    s_waitcnt vmcnt(8) lgkmcnt(0)
    s_barrier
    s_mov_b32 s48, 0
    s_mul_i32 s50, s48, 18432
    s_add_u32 s50, s50, s34
    s_add_u32 s50, s50, 165888
    s_cmp_ge_u32 s20, 2
    s_cselect_b32 s52, s50, s53
    s_add_u32 m0, s31, 0
    s_add_u32 s52, s52, s49
    buffer_load_dwordx4 v1, s[4:7], s52 offen  sc1 lds
    s_add_u32 m0, s30, 36864
    s_mov_b32 s53, s50
    buffer_load_dwordx4 v1, s[4:7], s50 offen offset:0  sc1 lds
    buffer_load_dwordx4 v1, s[4:7], s50 offen offset:1024  sc1 lds
    buffer_load_dwordx4 v1, s[4:7], s50 offen offset:2048  sc1 lds
    buffer_load_dwordx4 v1, s[4:7], s50 offen offset:3072  sc1 lds
    s_add_u32 m0, s30, 55296
    s_add_u32 s51, s35, 0
    buffer_load_dwordx4 v1, s[4:7], s51 offen offset:0 sc1 lds
    buffer_load_dwordx4 v1, s[4:7], s51 offen offset:1024 sc1 lds
    buffer_load_dwordx4 v2, s[4:7], s51 offen offset:2048 sc1 lds
    buffer_load_dwordx4 v2, s[4:7], s51 offen offset:3072 sc1 lds
    s_waitcnt vmcnt(13) lgkmcnt(0)
    s_barrier
    buffer_load_dwordx4 v[72:75], v3, s[4:7], s29 offen offset:0 sc1
    buffer_load_dwordx4 v[76:79], v3, s[4:7], s29 offen offset:1024 sc1
    buffer_load_dwordx4 v[80:83], v3, s[4:7], s29 offen offset:2048 sc1
    buffer_load_dwordx4 v[84:87], v3, s[4:7], s29 offen offset:3072 sc1
    s_mov_b32 s48, 1
    s_mul_i32 s50, s48, 18432
    s_add_u32 s50, s50, s34
    s_add_u32 s50, s50, 165888
    s_add_u32 m0, s30, 73728
    s_mov_b32 s53, s50
    buffer_load_dwordx4 v1, s[4:7], s50 offen offset:0  sc1 lds
    buffer_load_dwordx4 v1, s[4:7], s50 offen offset:1024  sc1 lds
    buffer_load_dwordx4 v1, s[4:7], s50 offen offset:2048  sc1 lds
    buffer_load_dwordx4 v1, s[4:7], s50 offen offset:3072  sc1 lds
    s_add_u32 m0, s30, 92160
    s_add_u32 s51, s35, 2048
    buffer_load_dwordx4 v1, s[4:7], s51 offen offset:0 sc1 lds
    buffer_load_dwordx4 v1, s[4:7], s51 offen offset:1024 sc1 lds
    buffer_load_dwordx4 v2, s[4:7], s51 offen offset:2048 sc1 lds
    buffer_load_dwordx4 v2, s[4:7], s51 offen offset:3072 sc1 lds
    s_waitcnt vmcnt(20) lgkmcnt(0)
    s_barrier
    s_mov_b32 s48, 2
    s_mul_i32 s50, s48, 18432
    s_add_u32 s50, s50, s34
    s_add_u32 s50, s50, 165888
    s_cmp_ge_u32 s20, 2
    s_cselect_b32 s52, s50, s53
    s_add_u32 m0, s31, 73728
    s_add_u32 s52, s52, s49
    buffer_load_dwordx4 v1, s[4:7], s52 offen  sc1 lds
    s_add_u32 m0, s30, 110592
    s_mov_b32 s53, s50
    buffer_load_dwordx4 v1, s[4:7], s50 offen offset:0  sc1 lds
    buffer_load_dwordx4 v1, s[4:7], s50 offen offset:1024  sc1 lds
    buffer_load_dwordx4 v1, s[4:7], s50 offen offset:2048  sc1 lds
    buffer_load_dwordx4 v1, s[4:7], s50 offen offset:3072  sc1 lds
    s_add_u32 m0, s30, 129024
    s_add_u32 s51, s35, 4096
    buffer_load_dwordx4 v1, s[4:7], s51 offen offset:0 sc1 lds
    buffer_load_dwordx4 v1, s[4:7], s51 offen offset:1024 sc1 lds
    buffer_load_dwordx4 v2, s[4:7], s51 offen offset:2048 sc1 lds
    buffer_load_dwordx4 v2, s[4:7], s51 offen offset:3072 sc1 lds
    s_mov_b32 s60, 65536
    s_waitcnt vmcnt(17)
L_g_chk:
    v_or3_b32 v88, v73, v75, v77
    v_or3_b32 v89, v79, v81, v83
    v_or3_b32 v88, v85, v87, v88
    v_or_b32 v88, v88, v89
    v_cmp_gt_i32 vcc, 0, v88
    s_sub_u32 s60, s60, 1
    s_cbranch_scc1 L_g_ok
    s_cbranch_vccz L_g_ok
    buffer_load_dwordx4 v[72:75], v3, s[4:7], s29 offen offset:0 sc1
    buffer_load_dwordx4 v[76:79], v3, s[4:7], s29 offen offset:1024 sc1
    buffer_load_dwordx4 v[80:83], v3, s[4:7], s29 offen offset:2048 sc1
    buffer_load_dwordx4 v[84:87], v3, s[4:7], s29 offen offset:3072 sc1
    s_waitcnt vmcnt(0)
    s_branch L_g_chk
L_g_ok:
    v_add_f32 v72, v72, v76
    v_add_f32 v80, v80, v84
    v_add_f32 v73, v73, v77
    v_add_f32 v81, v81, v85
    v_add_f32 v74, v74, v78
    v_add_f32 v82, v82, v86
    v_add_f32 v75, v75, v79
    v_add_f32 v83, v83, v87
    v_add_f32 v72, v72, v80
    v_add_f32 v73, v73, v81
    v_add_f32 v74, v74, v82
    v_add_f32 v75, v75, v83
    v_add_f32_dpp v72, v72, v72 row_ror:4 row_mask:0xf bank_mask:0xf
    v_add_f32_dpp v73, v73, v73 row_ror:4 row_mask:0xf bank_mask:0xf
    v_add_f32_dpp v74, v74, v74 row_ror:4 row_mask:0xf bank_mask:0xf
    v_add_f32_dpp v75, v75, v75 row_ror:4 row_mask:0xf bank_mask:0xf
    v_add_f32_dpp v72, v72, v72 row_ror:8 row_mask:0xf bank_mask:0xf
    v_add_f32_dpp v73, v73, v73 row_ror:8 row_mask:0xf bank_mask:0xf
    v_add_f32_dpp v74, v74, v74 row_ror:8 row_mask:0xf bank_mask:0xf
    v_add_f32_dpp v75, v75, v75 row_ror:8 row_mask:0xf bank_mask:0xf
    v_mul_f32 v72, 0x39e38e39, v72
    v_mul_f32 v73, 0x39e38e39, v73
    v_mul_f32 v74, 0x39e38e39, v74
    v_mul_f32 v75, 0x39e38e39, v75
    v_fma_f32 v73, -v72, v72, v73
    v_fma_f32 v75, -v74, v74, v75
    v_max_f32 v73, 0, v73
    v_max_f32 v75, 0, v75
    v_add_f32 v73, 0x3727c5ac, v73
    v_add_f32 v75, 0x3727c5ac, v75
    v_rsq_f32 v76, v73
    v_rsq_f32 v77, v75
    v_and_b32 v88, 0xff, v3
    s_lshl_b32 s33, s20, 8
    s_add_u32 s33, s33, 148480
    v_add_u32 v88, s33, v88
    v_mul_f32 v78, v72, v76
    v_mul_f32 v79, v74, v77
    ds_write_b128 v88, v[76:79]
    s_waitcnt vmcnt(17) lgkmcnt(0)
    s_barrier
    s_mov_b32 s48, 3
    s_mul_i32 s50, s48, 18432
    s_add_u32 s50, s50, s34
    s_add_u32 s50, s50, 165888
    s_add_u32 m0, s30, 0
    s_mov_b32 s53, s50
    buffer_load_dwordx4 v1, s[4:7], s50 offen offset:0  sc1 lds
    buffer_load_dwordx4 v1, s[4:7], s50 offen offset:1024  sc1 lds
    buffer_load_dwordx4 v1, s[4:7], s50 offen offset:2048  sc1 lds
    buffer_load_dwordx4 v1, s[4:7], s50 offen offset:3072  sc1 lds
    s_add_u32 m0, s30, 18432
    s_add_u32 s51, s35, 6144
    buffer_load_dwordx4 v1, s[4:7], s51 offen offset:0 sc1 lds
    buffer_load_dwordx4 v1, s[4:7], s51 offen offset:1024 sc1 lds
    buffer_load_dwordx4 v2, s[4:7], s51 offen offset:2048 sc1 lds
    buffer_load_dwordx4 v2, s[4:7], s51 offen offset:3072 sc1 lds
    s_waitcnt vmcnt(16) lgkmcnt(0)
    s_barrier
    s_mov_b32 s48, 4
    s_mul_i32 s50, s48, 18432
    s_add_u32 s50, s50, s34
    s_add_u32 s50, s50, 165888
    s_cmp_ge_u32 s20, 2
    s_cselect_b32 s52, s50, s53
    s_add_u32 m0, s31, 0
    s_add_u32 s52, s52, s49
    buffer_load_dwordx4 v1, s[4:7], s52 offen  sc1 lds
    s_add_u32 m0, s30, 36864
    s_mov_b32 s53, s50
    buffer_load_dwordx4 v1, s[4:7], s50 offen offset:0  sc1 lds
    buffer_load_dwordx4 v1, s[4:7], s50 offen offset:1024  sc1 lds
    buffer_load_dwordx4 v1, s[4:7], s50 offen offset:2048  sc1 lds
    buffer_load_dwordx4 v1, s[4:7], s50 offen offset:3072  sc1 lds
    s_add_u32 m0, s30, 55296
    s_add_u32 s51, s35, 8192
    buffer_load_dwordx4 v1, s[4:7], s51 offen offset:0 sc1 lds
    buffer_load_dwordx4 v1, s[4:7], s51 offen offset:1024 sc1 lds
    buffer_load_dwordx4 v2, s[4:7], s51 offen offset:2048 sc1 lds
    buffer_load_dwordx4 v2, s[4:7], s51 offen offset:3072 sc1 lds
    s_waitcnt vmcnt(17) lgkmcnt(0)
    s_barrier
    s_waitcnt vmcnt(8) lgkmcnt(0)
    s_barrier
    s_waitcnt vmcnt(0) lgkmcnt(0)
    s_barrier
    s_barrier
    s_mov_b32 s56, 1
    s_atomic_add s56, s[54:55], 0
    s_add_u32 m0, s30, 92160
    s_lshl_b32 s51, s44, 7
    buffer_load_dwordx4 v8, s[8:11], s51 offen offset:0  lds
    buffer_load_dwordx4 v9, s[8:11], s51 offen offset:1024  lds
    buffer_load_dwordx4 v10, s[8:11], s51 offen offset:2048  lds
    buffer_load_dwordx4 v11, s[8:11], s51 offen offset:3072  lds
    s_add_u32 m0, s30, 129024
    s_lshl_b32 s51, s45, 7
    buffer_load_dwordx4 v8, s[8:11], s51 offen offset:0  lds
    buffer_load_dwordx4 v9, s[8:11], s51 offen offset:1024  lds
    buffer_load_dwordx4 v10, s[8:11], s51 offen offset:2048  lds
    buffer_load_dwordx4 v11, s[8:11], s51 offen offset:3072  lds
    s_add_u32 m0, s30, 18432
    s_lshl_b32 s51, s46, 7
    buffer_load_dwordx4 v8, s[8:11], s51 offen offset:0  lds
    buffer_load_dwordx4 v9, s[8:11], s51 offen offset:1024  lds
    buffer_load_dwordx4 v10, s[8:11], s51 offen offset:2048  lds
    buffer_load_dwordx4 v11, s[8:11], s51 offen offset:3072  lds
    s_and_b32 s40, s2, 7
    s_lshr_b32 s26, s2, 3
    s_lshr_b32 s38, s40, 1
    s_lshl_b32 s38, s38, 3
    s_lshr_b32 s27, s26, 2
    s_add_u32 s38, s38, s27
    s_and_b32 s39, s40, 1
    s_lshl_b32 s39, s39, 2
    s_and_b32 s27, s26, 3
    s_add_u32 s39, s39, s27
    s_add_u32 s40, s38, s39
    s_and_b32 s40, s40, 3
    s_mul_i32 s42, s20, 9216
    s_mul_i32 s43, s39, 331776
    s_add_u32 s43, s43, s42
    s_add_u32 s43, s43, 0x4100000
    s_mov_b32 s60, 65536
L_poll_z2:
    s_mov_b32 s57, 0
    s_atomic_add s57, s[54:55], 0 glc
    s_waitcnt lgkmcnt(0)
    s_cmp_ge_u32 s57, 16
    s_cbranch_scc1 L_pd_z2
    s_sub_u32 s60, s60, 1
    s_cbranch_scc1 L_pd_z2
    s_sleep 2
    s_branch L_poll_z2
L_pd_z2:
    s_mul_i32 s50, s44, 18432
    s_add_u32 s50, s50, s36
    s_add_u32 m0, s30, 73728
    s_mov_b32 s53, s50
    buffer_load_dwordx4 v1, s[4:7], s50 offen offset:0 sc1 lds
    buffer_load_dwordx4 v1, s[4:7], s50 offen offset:1024 sc1 lds
    buffer_load_dwordx4 v1, s[4:7], s50 offen offset:2048 sc1 lds
    buffer_load_dwordx4 v1, s[4:7], s50 offen offset:3072 sc1 lds
    s_mul_i32 s50, s45, 18432
    s_add_u32 s50, s50, s36
    s_cmp_ge_u32 s20, 2
    s_cselect_b32 s52, s50, s53
    s_add_u32 m0, s31, 73728
    s_add_u32 s52, s52, s49
    buffer_load_dwordx4 v1, s[4:7], s52 offen sc1 lds
    s_add_u32 m0, s30, 110592
    s_mov_b32 s53, s50
    buffer_load_dwordx4 v1, s[4:7], s50 offen offset:0 sc1 lds
    buffer_load_dwordx4 v1, s[4:7], s50 offen offset:1024 sc1 lds
    buffer_load_dwordx4 v1, s[4:7], s50 offen offset:2048 sc1 lds
    buffer_load_dwordx4 v1, s[4:7], s50 offen offset:3072 sc1 lds
    s_mul_i32 s50, s46, 18432
    s_add_u32 s50, s50, s36
    s_add_u32 m0, s30, 0
    s_mov_b32 s53, s50
    buffer_load_dwordx4 v1, s[4:7], s50 offen offset:0 sc1 lds
    buffer_load_dwordx4 v1, s[4:7], s50 offen offset:1024 sc1 lds
    buffer_load_dwordx4 v1, s[4:7], s50 offen offset:2048 sc1 lds
    buffer_load_dwordx4 v1, s[4:7], s50 offen offset:3072 sc1 lds
    s_waitcnt vmcnt(8)
    s_barrier
    s_add_u32 s44, s44, 4
    s_and_b32 s44, s44, 31
    s_add_u32 s45, s45, 4
    s_and_b32 s45, s45, 31
    s_add_u32 s46, s46, 4
    s_and_b32 s46, s46, 31
    s_mul_i32 s50, s47, 18432
    s_add_u32 s50, s50, s36
    s_cmp_ge_u32 s20, 2
    s_cselect_b32 s52, s50, s53
    s_add_u32 m0, s31, 0
    s_add_u32 s52, s52, s49
    buffer_load_dwordx4 v1, s[4:7], s52 offen sc1 lds
    s_add_u32 m0, s30, 36864
    s_mov_b32 s53, s50
    buffer_load_dwordx4 v1, s[4:7], s50 offen offset:0 sc1 lds
    buffer_load_dwordx4 v1, s[4:7], s50 offen offset:1024 sc1 lds
    buffer_load_dwordx4 v1, s[4:7], s50 offen offset:2048 sc1 lds
    buffer_load_dwordx4 v1, s[4:7], s50 offen offset:3072 sc1 lds
    s_add_u32 m0, s30, 55296
    s_lshl_b32 s51, s47, 7
    buffer_load_dwordx4 v8, s[8:11], s51 offen offset:0  lds
    buffer_load_dwordx4 v9, s[8:11], s51 offen offset:1024  lds
    buffer_load_dwordx4 v10, s[8:11], s51 offen offset:2048  lds
    buffer_load_dwordx4 v11, s[8:11], s51 offen offset:3072  lds
    s_add_u32 s47, s47, 4
    s_and_b32 s47, s47, 31
    s_waitcnt vmcnt(13)
    s_barrier
    s_mul_i32 s50, s44, 18432
    s_add_u32 s50, s50, s36
    s_add_u32 m0, s30, 73728
    s_mov_b32 s53, s50
    buffer_load_dwordx4 v1, s[4:7], s50 offen offset:0 sc1 lds
    buffer_load_dwordx4 v1, s[4:7], s50 offen offset:1024 sc1 lds
    buffer_load_dwordx4 v1, s[4:7], s50 offen offset:2048 sc1 lds
    buffer_load_dwordx4 v1, s[4:7], s50 offen offset:3072 sc1 lds
    s_add_u32 m0, s30, 92160
    s_lshl_b32 s51, s44, 7
    buffer_load_dwordx4 v8, s[8:11], s51 offen offset:0  lds
    buffer_load_dwordx4 v9, s[8:11], s51 offen offset:1024  lds
    buffer_load_dwordx4 v10, s[8:11], s51 offen offset:2048  lds
    buffer_load_dwordx4 v11, s[8:11], s51 offen offset:3072  lds
    s_add_u32 s44, s44, 4
    s_and_b32 s44, s44, 31
    s_waitcnt vmcnt(16)
    s_barrier
    s_mul_i32 s50, s45, 18432
    s_add_u32 s50, s50, s36
    s_cmp_ge_u32 s20, 2
    s_cselect_b32 s52, s50, s53
    s_add_u32 m0, s31, 73728
    s_add_u32 s52, s52, s49
    buffer_load_dwordx4 v1, s[4:7], s52 offen sc1 lds
    s_add_u32 m0, s30, 110592
    s_mov_b32 s53, s50
    buffer_load_dwordx4 v1, s[4:7], s50 offen offset:0 sc1 lds
    buffer_load_dwordx4 v1, s[4:7], s50 offen offset:1024 sc1 lds
    buffer_load_dwordx4 v1, s[4:7], s50 offen offset:2048 sc1 lds
    buffer_load_dwordx4 v1, s[4:7], s50 offen offset:3072 sc1 lds
    s_add_u32 m0, s30, 129024
    s_lshl_b32 s51, s45, 7
    buffer_load_dwordx4 v8, s[8:11], s51 offen offset:0  lds
    buffer_load_dwordx4 v9, s[8:11], s51 offen offset:1024  lds
    buffer_load_dwordx4 v10, s[8:11], s51 offen offset:2048  lds
    buffer_load_dwordx4 v11, s[8:11], s51 offen offset:3072  lds
    s_add_u32 s45, s45, 4
    s_and_b32 s45, s45, 31
    s_waitcnt vmcnt(17)
    s_barrier
    s_mul_i32 s50, s46, 18432
    s_add_u32 s50, s50, s36
    s_add_u32 m0, s30, 0
    s_mov_b32 s53, s50
    buffer_load_dwordx4 v1, s[4:7], s50 offen offset:0 sc1 lds
    buffer_load_dwordx4 v1, s[4:7], s50 offen offset:1024 sc1 lds
    buffer_load_dwordx4 v1, s[4:7], s50 offen offset:2048 sc1 lds
    buffer_load_dwordx4 v1, s[4:7], s50 offen offset:3072 sc1 lds
    s_add_u32 m0, s30, 18432
    s_lshl_b32 s51, s46, 7
    buffer_load_dwordx4 v8, s[8:11], s51 offen offset:0  lds
    buffer_load_dwordx4 v9, s[8:11], s51 offen offset:1024  lds
    buffer_load_dwordx4 v10, s[8:11], s51 offen offset:2048  lds
    buffer_load_dwordx4 v11, s[8:11], s51 offen offset:3072  lds
    s_add_u32 s46, s46, 4
    s_and_b32 s46, s46, 31
    s_waitcnt vmcnt(16)
    s_barrier
    s_mul_i32 s50, s47, 18432
    s_add_u32 s50, s50, s36
    s_cmp_ge_u32 s20, 2
    s_cselect_b32 s52, s50, s53
    s_add_u32 m0, s31, 0
    s_add_u32 s52, s52, s49
    buffer_load_dwordx4 v1, s[4:7], s52 offen sc1 lds
    s_add_u32 m0, s30, 36864
    s_mov_b32 s53, s50
    buffer_load_dwordx4 v1, s[4:7], s50 offen offset:0 sc1 lds
    buffer_load_dwordx4 v1, s[4:7], s50 offen offset:1024 sc1 lds
    buffer_load_dwordx4 v1, s[4:7], s50 offen offset:2048 sc1 lds
    buffer_load_dwordx4 v1, s[4:7], s50 offen offset:3072 sc1 lds
    s_add_u32 m0, s30, 55296
    s_lshl_b32 s51, s47, 7
    buffer_load_dwordx4 v8, s[8:11], s51 offen offset:0  lds
    buffer_load_dwordx4 v9, s[8:11], s51 offen offset:1024  lds
    buffer_load_dwordx4 v10, s[8:11], s51 offen offset:2048  lds
    buffer_load_dwordx4 v11, s[8:11], s51 offen offset:3072  lds
    s_add_u32 s47, s47, 4
    s_and_b32 s47, s47, 31
    s_mov_b32 s41, 6
L_g_ll:
    s_waitcnt vmcnt(17)
    s_barrier
    s_mul_i32 s50, s44, 18432
    s_add_u32 s50, s50, s36
    s_add_u32 m0, s30, 73728
    s_mov_b32 s53, s50
    buffer_load_dwordx4 v1, s[4:7], s50 offen offset:0 sc1 lds
    buffer_load_dwordx4 v1, s[4:7], s50 offen offset:1024 sc1 lds
    buffer_load_dwordx4 v1, s[4:7], s50 offen offset:2048 sc1 lds
    buffer_load_dwordx4 v1, s[4:7], s50 offen offset:3072 sc1 lds
    s_add_u32 m0, s30, 92160
    s_lshl_b32 s51, s44, 7
    buffer_load_dwordx4 v8, s[8:11], s51 offen offset:0  lds
    buffer_load_dwordx4 v9, s[8:11], s51 offen offset:1024  lds
    buffer_load_dwordx4 v10, s[8:11], s51 offen offset:2048  lds
    buffer_load_dwordx4 v11, s[8:11], s51 offen offset:3072  lds
    s_add_u32 s44, s44, 4
    s_and_b32 s44, s44, 31
    s_waitcnt vmcnt(16)
    s_barrier
    s_mul_i32 s50, s45, 18432
    s_add_u32 s50, s50, s36
    s_cmp_ge_u32 s20, 2
    s_cselect_b32 s52, s50, s53
    s_add_u32 m0, s31, 73728
    s_add_u32 s52, s52, s49
    buffer_load_dwordx4 v1, s[4:7], s52 offen sc1 lds
    s_add_u32 m0, s30, 110592
    s_mov_b32 s53, s50
    buffer_load_dwordx4 v1, s[4:7], s50 offen offset:0 sc1 lds
    buffer_load_dwordx4 v1, s[4:7], s50 offen offset:1024 sc1 lds
    buffer_load_dwordx4 v1, s[4:7], s50 offen offset:2048 sc1 lds
    buffer_load_dwordx4 v1, s[4:7], s50 offen offset:3072 sc1 lds
    s_add_u32 m0, s30, 129024
    s_lshl_b32 s51, s45, 7
    buffer_load_dwordx4 v8, s[8:11], s51 offen offset:0  lds
    buffer_load_dwordx4 v9, s[8:11], s51 offen offset:1024  lds
    buffer_load_dwordx4 v10, s[8:11], s51 offen offset:2048  lds
    buffer_load_dwordx4 v11, s[8:11], s51 offen offset:3072  lds
    s_add_u32 s45, s45, 4
    s_and_b32 s45, s45, 31
    s_waitcnt vmcnt(17)
    s_barrier
    s_mul_i32 s50, s46, 18432
    s_add_u32 s50, s50, s36
    s_add_u32 m0, s30, 0
    s_mov_b32 s53, s50
    buffer_load_dwordx4 v1, s[4:7], s50 offen offset:0 sc1 lds
    buffer_load_dwordx4 v1, s[4:7], s50 offen offset:1024 sc1 lds
    buffer_load_dwordx4 v1, s[4:7], s50 offen offset:2048 sc1 lds
    buffer_load_dwordx4 v1, s[4:7], s50 offen offset:3072 sc1 lds
    s_add_u32 m0, s30, 18432
    s_lshl_b32 s51, s46, 7
    buffer_load_dwordx4 v8, s[8:11], s51 offen offset:0  lds
    buffer_load_dwordx4 v9, s[8:11], s51 offen offset:1024  lds
    buffer_load_dwordx4 v10, s[8:11], s51 offen offset:2048  lds
    buffer_load_dwordx4 v11, s[8:11], s51 offen offset:3072  lds
    s_add_u32 s46, s46, 4
    s_and_b32 s46, s46, 31
    s_waitcnt vmcnt(16)
    s_barrier
    s_mul_i32 s50, s47, 18432
    s_add_u32 s50, s50, s36
    s_cmp_ge_u32 s20, 2
    s_cselect_b32 s52, s50, s53
    s_add_u32 m0, s31, 0
    s_add_u32 s52, s52, s49
    buffer_load_dwordx4 v1, s[4:7], s52 offen sc1 lds
    s_add_u32 m0, s30, 36864
    s_mov_b32 s53, s50
    buffer_load_dwordx4 v1, s[4:7], s50 offen offset:0 sc1 lds
    buffer_load_dwordx4 v1, s[4:7], s50 offen offset:1024 sc1 lds
    buffer_load_dwordx4 v1, s[4:7], s50 offen offset:2048 sc1 lds
    buffer_load_dwordx4 v1, s[4:7], s50 offen offset:3072 sc1 lds
    s_add_u32 m0, s30, 55296
    s_lshl_b32 s51, s47, 7
    buffer_load_dwordx4 v8, s[8:11], s51 offen offset:0  lds
    buffer_load_dwordx4 v9, s[8:11], s51 offen offset:1024  lds
    buffer_load_dwordx4 v10, s[8:11], s51 offen offset:2048  lds
    buffer_load_dwordx4 v11, s[8:11], s51 offen offset:3072  lds
    s_add_u32 s47, s47, 4
    s_and_b32 s47, s47, 31
    s_sub_u32 s41, s41, 1
    s_cmp_lg_u32 s41, 0
    s_cbranch_scc1 L_g_ll
    s_waitcnt vmcnt(17)
    s_barrier
    s_mov_b32 s32, 0
    s_mul_i32 s32, s32, 36864
    s_add_u32 s32, s32, s43
    s_add_u32 m0, s42, 73728
    s_add_u32 s33, s32, 0
    buffer_load_dwordx4 v1, s[4:7], s33 offen offset:0  sc1 lds
    buffer_load_dwordx4 v1, s[4:7], s33 offen offset:1024  sc1 lds
    buffer_load_dwordx4 v1, s[4:7], s33 offen offset:2048  sc1 lds
    buffer_load_dwordx4 v1, s[4:7], s33 offen offset:3072  sc1 lds
    s_add_u32 m0, s42, 77824
    s_add_u32 s33, s32, 4096
    buffer_load_dwordx4 v1, s[4:7], s33 offen offset:0  sc1 lds
    buffer_load_dwordx4 v1, s[4:7], s33 offen offset:1024  sc1 lds
    buffer_load_dwordx4 v1, s[4:7], s33 offen offset:2048  sc1 lds
    buffer_load_dwordx4 v1, s[4:7], s33 offen offset:3072  sc1 lds
    s_add_u32 m0, s42, 81920
    s_add_u32 s33, s32, 8192
    buffer_load_dwordx4 v1, s[4:7], s33 offen offset:0  sc1 lds
    s_waitcnt vmcnt(9)
    s_barrier
    s_mov_b32 s32, 1
    s_mul_i32 s32, s32, 36864
    s_add_u32 s32, s32, s43
    s_add_u32 m0, s42, 110592
    s_add_u32 s33, s32, 0
    buffer_load_dwordx4 v1, s[4:7], s33 offen offset:0  sc1 lds
    buffer_load_dwordx4 v1, s[4:7], s33 offen offset:1024  sc1 lds
    buffer_load_dwordx4 v1, s[4:7], s33 offen offset:2048  sc1 lds
    buffer_load_dwordx4 v1, s[4:7], s33 offen offset:3072  sc1 lds
    s_add_u32 m0, s42, 114688
    s_add_u32 s33, s32, 4096
    buffer_load_dwordx4 v1, s[4:7], s33 offen offset:0  sc1 lds
    buffer_load_dwordx4 v1, s[4:7], s33 offen offset:1024  sc1 lds
    buffer_load_dwordx4 v1, s[4:7], s33 offen offset:2048  sc1 lds
    buffer_load_dwordx4 v1, s[4:7], s33 offen offset:3072  sc1 lds
    s_add_u32 m0, s42, 118784
    s_add_u32 s33, s32, 8192
    buffer_load_dwordx4 v1, s[4:7], s33 offen offset:0  sc1 lds
    s_barrier
    s_mov_b32 s32, 2
    s_mul_i32 s32, s32, 36864
    s_add_u32 s32, s32, s43
    s_add_u32 m0, s42, 0
    s_add_u32 s33, s32, 0
    buffer_load_dwordx4 v1, s[4:7], s33 offen offset:0  sc1 lds
    buffer_load_dwordx4 v1, s[4:7], s33 offen offset:1024  sc1 lds
    buffer_load_dwordx4 v1, s[4:7], s33 offen offset:2048  sc1 lds
    buffer_load_dwordx4 v1, s[4:7], s33 offen offset:3072  sc1 lds
    s_add_u32 m0, s42, 4096
    s_add_u32 s33, s32, 4096
    buffer_load_dwordx4 v1, s[4:7], s33 offen offset:0  sc1 lds
    buffer_load_dwordx4 v1, s[4:7], s33 offen offset:1024  sc1 lds
    buffer_load_dwordx4 v1, s[4:7], s33 offen offset:2048  sc1 lds
    buffer_load_dwordx4 v1, s[4:7], s33 offen offset:3072  sc1 lds
    s_add_u32 m0, s42, 8192
    s_add_u32 s33, s32, 8192
    buffer_load_dwordx4 v1, s[4:7], s33 offen offset:0  sc1 lds
    s_mov_b32 s32, 3
    s_mul_i32 s32, s32, 36864
    s_add_u32 s32, s32, s43
    s_add_u32 m0, s42, 36864
    s_add_u32 s33, s32, 0
    buffer_load_dwordx4 v1, s[4:7], s33 offen offset:0  sc1 lds
    buffer_load_dwordx4 v1, s[4:7], s33 offen offset:1024  sc1 lds
    buffer_load_dwordx4 v1, s[4:7], s33 offen offset:2048  sc1 lds
    buffer_load_dwordx4 v1, s[4:7], s33 offen offset:3072  sc1 lds
    s_add_u32 m0, s42, 40960
    s_add_u32 s33, s32, 4096
    buffer_load_dwordx4 v1, s[4:7], s33 offen offset:0  sc1 lds
    buffer_load_dwordx4 v1, s[4:7], s33 offen offset:1024  sc1 lds
    buffer_load_dwordx4 v1, s[4:7], s33 offen offset:2048  sc1 lds
    buffer_load_dwordx4 v1, s[4:7], s33 offen offset:3072  sc1 lds
    s_add_u32 m0, s42, 45056
    s_add_u32 s33, s32, 8192
    buffer_load_dwordx4 v1, s[4:7], s33 offen offset:0  sc1 lds
    s_barrier
    s_mov_b32 s32, 4
    s_mul_i32 s32, s32, 36864
    s_add_u32 s32, s32, s43
    buffer_load_dwordx4 v[16:19], v1, s[4:7], s32 offen offset:0 sc1
    buffer_load_dwordx4 v[20:23], v1, s[4:7], s32 offen offset:1024 sc1
    buffer_load_dwordx4 v[24:27], v1, s[4:7], s32 offen offset:2048 sc1
    buffer_load_dwordx4 v[28:31], v1, s[4:7], s32 offen offset:3072 sc1
    s_add_u32 s32, s32, 4096
    buffer_load_dwordx4 v[32:35], v1, s[4:7], s32 offen offset:0 sc1
    buffer_load_dwordx4 v[36:39], v1, s[4:7], s32 offen offset:1024 sc1
    buffer_load_dwordx4 v[40:43], v1, s[4:7], s32 offen offset:2048 sc1
    buffer_load_dwordx4 v[44:47], v1, s[4:7], s32 offen offset:3072 sc1
    s_add_u32 s32, s32, 4096
    buffer_load_dwordx4 v[48:51], v1, s[4:7], s32 offen offset:0 sc1
    s_waitcnt vmcnt(36)
    s_barrier
    v_add_u32 v12, s42, v1
    v_add_u32 v13, 36864, v12
    v_add_u32 v14, 73728, v12
    v_add_u32 v15, 110592, v12
    s_waitcnt vmcnt(27) lgkmcnt(0)
    s_barrier
    s_waitcnt vmcnt(0)
    ds_write_b128 v14, v[16:19] offset:0
    ds_write_b128 v14, v[20:23] offset:1024
    ds_write_b128 v14, v[24:27] offset:2048
    ds_write_b128 v14, v[28:31] offset:3072
    ds_write_b128 v14, v[32:35] offset:4096
    ds_write_b128 v14, v[36:39] offset:5120
    ds_write_b128 v14, v[40:43] offset:6144
    ds_write_b128 v14, v[44:47] offset:7168
    ds_write_b128 v14, v[48:51] offset:8192
    s_waitcnt vmcnt(63) lgkmcnt(0)
    s_barrier
    s_mov_b32 s32, 5
    s_mul_i32 s32, s32, 36864
    s_add_u32 s32, s32, s43
    s_add_u32 m0, s42, 110592
    s_add_u32 s33, s32, 0
    buffer_load_dwordx4 v1, s[4:7], s33 offen offset:0  sc1 lds
    buffer_load_dwordx4 v1, s[4:7], s33 offen offset:1024  sc1 lds
    buffer_load_dwordx4 v1, s[4:7], s33 offen offset:2048  sc1 lds
    buffer_load_dwordx4 v1, s[4:7], s33 offen offset:3072  sc1 lds
    s_add_u32 m0, s42, 114688
    s_add_u32 s33, s32, 4096
    buffer_load_dwordx4 v1, s[4:7], s33 offen offset:0  sc1 lds
    buffer_load_dwordx4 v1, s[4:7], s33 offen offset:1024  sc1 lds
    buffer_load_dwordx4 v1, s[4:7], s33 offen offset:2048  sc1 lds
    buffer_load_dwordx4 v1, s[4:7], s33 offen offset:3072  sc1 lds
    s_add_u32 m0, s42, 118784
    s_add_u32 s33, s32, 8192
    buffer_load_dwordx4 v1, s[4:7], s33 offen offset:0  sc1 lds
    s_waitcnt vmcnt(63) lgkmcnt(0)
    s_barrier
    s_mov_b32 s32, 6
    s_mul_i32 s32, s32, 36864
    s_add_u32 s32, s32, s43
    s_add_u32 m0, s42, 0
    s_add_u32 s33, s32, 0
    buffer_load_dwordx4 v1, s[4:7], s33 offen offset:0  sc1 lds
    buffer_load_dwordx4 v1, s[4:7], s33 offen offset:1024  sc1 lds
    buffer_load_dwordx4 v1, s[4:7], s33 offen offset:2048  sc1 lds
    buffer_load_dwordx4 v1, s[4:7], s33 offen offset:3072  sc1 lds
    s_add_u32 m0, s42, 4096
    s_add_u32 s33, s32, 4096
    buffer_load_dwordx4 v1, s[4:7], s33 offen offset:0  sc1 lds
    buffer_load_dwordx4 v1, s[4:7], s33 offen offset:1024  sc1 lds
    buffer_load_dwordx4 v1, s[4:7], s33 offen offset:2048  sc1 lds
    buffer_load_dwordx4 v1, s[4:7], s33 offen offset:3072  sc1 lds
    s_add_u32 m0, s42, 8192
    s_add_u32 s33, s32, 8192
    buffer_load_dwordx4 v1, s[4:7], s33 offen offset:0  sc1 lds
    s_waitcnt vmcnt(63) lgkmcnt(0)
    s_barrier
    s_mov_b32 s32, 7
    s_mul_i32 s32, s32, 36864
    s_add_u32 s32, s32, s43
    s_add_u32 m0, s42, 36864
    s_add_u32 s33, s32, 0
    buffer_load_dwordx4 v1, s[4:7], s33 offen offset:0  sc1 lds
    buffer_load_dwordx4 v1, s[4:7], s33 offen offset:1024  sc1 lds
    buffer_load_dwordx4 v1, s[4:7], s33 offen offset:2048  sc1 lds
    buffer_load_dwordx4 v1, s[4:7], s33 offen offset:3072  sc1 lds
    s_add_u32 m0, s42, 40960
    s_add_u32 s33, s32, 4096
    buffer_load_dwordx4 v1, s[4:7], s33 offen offset:0  sc1 lds
    buffer_load_dwordx4 v1, s[4:7], s33 offen offset:1024  sc1 lds
    buffer_load_dwordx4 v1, s[4:7], s33 offen offset:2048  sc1 lds
    buffer_load_dwordx4 v1, s[4:7], s33 offen offset:3072  sc1 lds
    s_add_u32 m0, s42, 45056
    s_add_u32 s33, s32, 8192
    buffer_load_dwordx4 v1, s[4:7], s33 offen offset:0  sc1 lds
    s_waitcnt vmcnt(18) lgkmcnt(0)
    s_barrier
    s_mov_b32 s32, 8
    s_mul_i32 s32, s32, 36864
    s_add_u32 s32, s32, s43
    s_add_u32 m0, s42, 73728
    s_add_u32 s33, s32, 0
    buffer_load_dwordx4 v1, s[4:7], s33 offen offset:0  sc1 lds
    buffer_load_dwordx4 v1, s[4:7], s33 offen offset:1024  sc1 lds
    buffer_load_dwordx4 v1, s[4:7], s33 offen offset:2048  sc1 lds
    buffer_load_dwordx4 v1, s[4:7], s33 offen offset:3072  sc1 lds
    s_add_u32 m0, s42, 77824
    s_add_u32 s33, s32, 4096
    buffer_load_dwordx4 v1, s[4:7], s33 offen offset:0  sc1 lds
    buffer_load_dwordx4 v1, s[4:7], s33 offen offset:1024  sc1 lds
    buffer_load_dwordx4 v1, s[4:7], s33 offen offset:2048  sc1 lds
    buffer_load_dwordx4 v1, s[4:7], s33 offen offset:3072  sc1 lds
    s_add_u32 m0, s42, 81920
    s_add_u32 s33, s32, 8192
    buffer_load_dwordx4 v1, s[4:7], s33 offen offset:0  sc1 lds
    s_waitcnt vmcnt(18) lgkmcnt(0)
    s_barrier
    s_cmp_eq_u32 s22, 1
    s_cbranch_scc1 L_m_lfin
    s_and_b32 s25, s2, 7
    s_lshr_b32 s26, s2, 3
    s_lshr_b32 s23, s25, 1
    s_lshl_b32 s23, s23, 2
    s_lshr_b32 s27, s26, 3
    s_add_u32 s23, s23, s27
    s_and_b32 s24, s25, 1
    s_lshl_b32 s24, s24, 3
    s_and_b32 s27, s26, 7
    s_add_u32 s24, s24, s27
    s_mul_i32 s29, s24, 129024
    s_lshl_b32 s30, s20, 12
    s_add_u32 s29, s29, s30
    s_add_u32 s29, s29, 0x3800000
    s_lshl_b32 s31, s23, 3
    s_max_u32 s31, s31, 1
    s_sub_u32 s31, s31, 1
    s_mul_i32 s31, s31, 18432
    s_add_u32 s31, s31, 0x1c00000
    s_lshl_b32 s35, s20, 10
    s_and_b32 s36, s35, 1024
    s_waitcnt vmcnt(9) lgkmcnt(0)
    s_barrier
    s_add_u32 m0, s30, 0
    s_add_u32 s34, s29, 0
    buffer_load_dwordx4 v1, s[4:7], s34 offen offset:0 sc1 lds
    buffer_load_dwordx4 v1, s[4:7], s34 offen offset:1024 sc1 lds
    buffer_load_dwordx4 v1, s[4:7], s34 offen offset:2048 sc1 lds
    buffer_load_dwordx4 v1, s[4:7], s34 offen offset:3072 sc1 lds
    s_add_u32 m0, s30, 16384
    s_add_u32 s34, s29, 16384
    buffer_load_dwordx4 v1, s[4:7], s34 offen offset:0 sc1 lds
    buffer_load_dwordx4 v1, s[4:7], s34 offen offset:1024 sc1 lds
    buffer_load_dwordx4 v1, s[4:7], s34 offen offset:2048 sc1 lds
    buffer_load_dwordx4 v1, s[4:7], s34 offen offset:3072 sc1 lds
    s_waitcnt vmcnt(8) lgkmcnt(0)
    s_barrier
    s_barrier
    s_add_u32 m0, s30, 32768
    s_add_u32 s34, s29, 32768
    buffer_load_dwordx4 v1, s[4:7], s34 offen offset:0 sc1 lds
    buffer_load_dwordx4 v1, s[4:7], s34 offen offset:1024 sc1 lds
    buffer_load_dwordx4 v1, s[4:7], s34 offen offset:2048 sc1 lds
    buffer_load_dwordx4 v1, s[4:7], s34 offen offset:3072 sc1 lds
    s_add_u32 m0, s30, 114688
    s_add_u32 s34, s29, 114688
    buffer_load_dwordx4 v1, s[4:7], s34 offen offset:0 sc1 lds
    buffer_load_dwordx4 v1, s[4:7], s34 offen offset:1024 sc1 lds
    buffer_load_dwordx4 v1, s[4:7], s34 offen offset:2048 sc1 lds
    buffer_load_dwordx4 v1, s[4:7], s34 offen offset:3072 sc1 lds
    s_mov_b32 s22, 1
    s_mov_b32 s21, 0x1c00000
    s_barrier
    s_barrier
    s_add_u32 m0, s30, 49152
    s_add_u32 s34, s29, 49152
    buffer_load_dwordx4 v1, s[4:7], s34 offen offset:0 sc1 lds
    buffer_load_dwordx4 v1, s[4:7], s34 offen offset:1024 sc1 lds
    buffer_load_dwordx4 v1, s[4:7], s34 offen offset:2048 sc1 lds
    buffer_load_dwordx4 v1, s[4:7], s34 offen offset:3072 sc1 lds
    v_lshrrev_b32 v60, 8, v1
    v_bfe_u32 v61, v1, 7, 1
    v_bfe_u32 v62, v1, 4, 3
    v_cmp_gt_u32 vcc, 3, v60
    v_mul_u32_u24 v61, 80, v61
    v_lshl_add_u32 v61, v62, 3, v61
    v_lshrrev_b32 v63, 1, v62
    v_and_b32 v62, 1, v62
    v_lshl_add_u32 v62, v62, 3, 64
    v_cndmask_b32 v60, v63, v60, vcc
    v_cndmask_b32 v61, v62, v61, vcc
    v_mul_u32_u24 v60, 2304, v60
    v_add_u32 v69, v60, v61
    v_lshrrev_b32 v68, 1, v1
    s_mul_i32 s34, s24, 144
    s_add_u32 s34, s34, 0x4400000
    buffer_load_dwordx2 v[60:61], v69, s[4:7], s34 offen sc1
    s_mul_i32 s34, s24, 144
    s_add_u32 s34, s34, 0x4402000
    buffer_load_dwordx2 v[62:63], v69, s[4:7], s34 offen sc1
    s_mul_i32 s34, s24, 144
    s_add_u32 s34, s34, 0x4404000
    buffer_load_dwordx2 v[64:65], v69, s[4:7], s34 offen sc1
    s_mul_i32 s34, s24, 144
    s_add_u32 s34, s34, 0x4406000
    buffer_load_dwordx2 v[66:67], v69, s[4:7], s34 offen sc1
    s_add_u32 m0, s30, 65536
    s_add_u32 s34, s29, 65536
    buffer_load_dwordx4 v1, s[4:7], s34 offen offset:0 sc1 lds
    buffer_load_dwordx4 v1, s[4:7], s34 offen offset:1024 sc1 lds
    buffer_load_dwordx4 v1, s[4:7], s34 offen offset:2048 sc1 lds
    buffer_load_dwordx4 v1, s[4:7], s34 offen offset:3072 sc1 lds
    s_add_u32 m0, s30, 81920
    s_add_u32 s34, s29, 81920
    buffer_load_dwordx4 v1, s[4:7], s34 offen offset:0 sc1 lds
    buffer_load_dwordx4 v1, s[4:7], s34 offen offset:1024 sc1 lds
    buffer_load_dwordx4 v1, s[4:7], s34 offen offset:2048 sc1 lds
    buffer_load_dwordx4 v1, s[4:7], s34 offen offset:3072 sc1 lds
    s_barrier
    s_add_u32 m0, s35, 131072
    s_add_u32 s34, s31, s35
    s_add_u32 s34, s34, 0
    buffer_load_dwordx4 v1, s[4:7], s34 offen sc1 lds
    s_waitcnt vmcnt(29) lgkmcnt(0)
    s_barrier
    s_add_u32 m0, s35, 135168
    s_add_u32 s34, s31, s35
    s_add_u32 s34, s34, 4096
    buffer_load_dwordx4 v1, s[4:7], s34 offen sc1 lds
    s_add_u32 m0, s35, 139264
    s_add_u32 s34, s31, s35
    s_add_u32 s34, s34, 8192
    buffer_load_dwordx4 v1, s[4:7], s34 offen sc1 lds
    s_add_u32 m0, s35, 143360
    s_add_u32 s34, s31, s35
    s_add_u32 s34, s34, 12288
    buffer_load_dwordx4 v1, s[4:7], s34 offen sc1 lds
    s_add_u32 m0, s30, 98304
    s_add_u32 s34, s29, 98304
    buffer_load_dwordx4 v1, s[4:7], s34 offen offset:0 sc1 lds
    buffer_load_dwordx4 v1, s[4:7], s34 offen offset:1024 sc1 lds
    buffer_load_dwordx4 v1, s[4:7], s34 offen offset:2048 sc1 lds
    buffer_load_dwordx4 v1, s[4:7], s34 offen offset:3072 sc1 lds
    s_add_u32 m0, s36, 147456
    s_add_u32 s34, s31, s36
    s_add_u32 s34, s34, 16384
    buffer_load_dwordx4 v1, s[4:7], s34 offen sc1 lds
    s_waitcnt vmcnt(8) lgkmcnt(0)
    s_barrier
    s_waitcnt vmcnt(8) lgkmcnt(0)
    s_barrier
    s_waitcnt vmcnt(7) lgkmcnt(0)
    s_barrier
    v_add_f32 v60, v60, v62
    v_add_f32 v61, v61, v63
    v_add_f32 v64, v64, v66
    v_add_f32 v65, v65, v67
    v_add_f32 v60, v60, v64
    v_add_f32 v61, v61, v65
    v_cmp_gt_u32 vcc, 864, v1
    v_add_u32 v68, 161792, v68
    s_nop 0
    v_cndmask_b32 v60, 0, v60, vcc
    v_cndmask_b32 v61, 0, v61, vcc
    ds_write_b64 v68, v[60:61]
    s_waitcnt vmcnt(6) lgkmcnt(0)
    s_barrier
    s_waitcnt vmcnt(6) lgkmcnt(0)
    s_barrier
    s_waitcnt vmcnt(1) lgkmcnt(0)
    s_barrier
    s_waitcnt vmcnt(0) lgkmcnt(0)
    s_barrier
    s_barrier
    s_branch L_m_ll
L_m_lfin:
    s_waitcnt vmcnt(0) lgkmcnt(0)
    s_barrier
    s_barrier
L_end_m:
    s_endpgm

.section .rodata,"a"
.p2align 6
.amdhsa_kernel interleave_layers__sliding_local_dilated__mixer_gmlp__prompt_kernel
  .amdhsa_next_free_vgpr 256
  .amdhsa_next_free_sgpr 102
  .amdhsa_accum_offset 256
  .amdhsa_group_segment_fixed_size 0
  .amdhsa_kernarg_size 88
  .amdhsa_user_sgpr_count 2
  .amdhsa_user_sgpr_kernarg_segment_ptr 1
  .amdhsa_system_sgpr_workgroup_id_x 1
  .amdhsa_float_denorm_mode_32 3
.end_amdhsa_kernel
```

```asm
; @launch grid=(256,1,1) block=(512,1,1) lds=163840
.amdgcn_target "amdgcn-amd-amdhsa--gfx950"
.text
.globl interleave_layers__sliding_local_dilated__mixer_gmlp__prompt_kernel
.p2align 8
.type interleave_layers__sliding_local_dilated__mixer_gmlp__prompt_kernel,@function
interleave_layers__sliding_local_dilated__mixer_gmlp__prompt_kernel:
    s_cmp_ge_u32 s2, 256
    s_cbranch_scc1 L_end_m
    s_load_dwordx16 s[36:51], s[0:1], 0
    s_load_dwordx4 s[56:59], s[0:1], 64
    s_load_dwordx2 s[24:25], s[0:1], 80
    s_getpc_b64 s[26:27]
L_m_pc:
    s_sub_u32 s26, s26, L_m_pc-interleave_layers__sliding_local_dilated__mixer_gmlp__prompt_kernel
    s_subb_u32 s27, s27, 0
    v_lshlrev_b32 v4, 4, v0
    v_mov_b32 v5, s27
    v_add_co_u32 v6, vcc, s26, v4
    s_lshr_b32 s28, s2, 3
    s_lshl_b32 s28, s28, 11
    v_addc_co_u32 v7, vcc, 0, v5, vcc
    global_load_dwordx4 v[60:63], v[6:7], off
    v_lshl_add_u32 v4, v0, 2, s28
    v_min_u32 v4, L_end_m-interleave_layers__sliding_local_dilated__mixer_gmlp__prompt_kernel-4, v4
    v_add_co_u32 v6, vcc, s26, v4
    s_nop 1
    v_addc_co_u32 v7, vcc, 0, v5, vcc
    global_load_dword v64, v[6:7], off
    v_lshrrev_b32 v2, 6, v0
    v_and_b32 v1, 63, v0
    v_lshlrev_b32 v1, 4, v1
    v_readfirstlane_b32 s23, v2
    s_mov_b32 s22, 0
    s_mov_b32 s21, 0
    s_and_b32 s20, s23, 3
    s_waitcnt lgkmcnt(0)
    s_mov_b32 s4, s24
    s_mov_b32 s5, s25
    s_mov_b32 s6, 0x10000000
    s_mov_b32 s7, 0x20000
    s_mov_b32 s8, s46
    s_mov_b32 s9, s47
    s_mov_b32 s10, 0x800000
    s_mov_b32 s11, 0x20000
    s_mov_b32 s12, s48
    s_mov_b32 s13, s49
    s_mov_b32 s14, 0x1000
    s_mov_b32 s15, 0x20000
    s_mov_b32 s16, s56
    s_mov_b32 s17, s57
    s_mov_b32 s18, 0x240000
    s_mov_b32 s19, 0x20000
    s_cmp_ge_u32 s23, 4
    s_cbranch_scc1 L_ld_m
    v_mov_b32 v2, 163808
    v_mov_b32 v4, 0
    v_mov_b32 v5, 0
    ds_write2_b64 v2, v[4:5], v[4:5] offset0:0 offset1:1
    s_waitcnt lgkmcnt(0)
    v_bfe_u32 v2, v1, 4, 4
    v_lshrrev_b32 v3, 8, v1
    v_bfrev_b32 v6, 1
    v_mov_b32 v11, 0x3f803f80
    s_lshl_b32 s30, s20, 12
    s_and_b32 s29, s20, 1
    s_cmp_lt_u32 s2, 128
    s_cbranch_scc1 L_p0_x
    s_cmp_lt_u32 s2, 236
    s_cbranch_scc1 L_p0_wq
    s_cmp_lt_u32 s2, 254
    s_cbranch_scc1 L_p0_wo
    s_mov_b32 s46, 0
    s_mov_b32 s27, 0x800000
    s_barrier
    s_barrier
    s_branch L_p0_cd
L_p0_wo:
    s_mul_i32 s30, s20, 9216
    s_sub_u32 s26, s2, 236
    s_mul_i32 s28, s26, 57
    s_lshr_b32 s28, s28, 9
    s_mul_i32 s27, s28, 9
    s_sub_u32 s27, s26, s27
    s_mov_b32 s32, s40
    s_mov_b32 s33, s41
    s_mov_b32 s34, 0xa2000
    s_mov_b32 s35, 0x20000
    s_mul_i32 s29, s28, 331776
    s_lshl_b32 s31, s27, 7
    s_add_u32 s29, s29, s31
    s_mul_i32 s31, s20, 82944
    s_add_u32 s29, s29, s31
    v_lshrrev_b32 v4, 7, v1
    v_mul_u32_u24 v4, 1152, v4
    v_and_b32 v5, 0x70, v1
    v_add_u32 v4, v4, v5
    s_add_u32 m0, s30, 0
    s_add_u32 s31, s29, 0
    buffer_load_dwordx4 v4, s[32:35], s31 offen  lds
    s_add_u32 m0, s30, 1024
    s_add_u32 s31, s29, 9216
    buffer_load_dwordx4 v4, s[32:35], s31 offen  lds
    s_add_u32 m0, s30, 2048
    s_add_u32 s31, s29, 18432
    buffer_load_dwordx4 v4, s[32:35], s31 offen  lds
    s_add_u32 m0, s30, 3072
    s_add_u32 s31, s29, 27648
    buffer_load_dwordx4 v4, s[32:35], s31 offen  lds
    s_add_u32 m0, s30, 4096
    s_add_u32 s31, s29, 36864
    buffer_load_dwordx4 v4, s[32:35], s31 offen  lds
    s_add_u32 m0, s30, 5120
    s_add_u32 s31, s29, 46080
    buffer_load_dwordx4 v4, s[32:35], s31 offen  lds
    s_add_u32 m0, s30, 6144
    s_add_u32 s31, s29, 55296
    buffer_load_dwordx4 v4, s[32:35], s31 offen  lds
    s_add_u32 m0, s30, 7168
    s_add_u32 s31, s29, 64512
    buffer_load_dwordx4 v4, s[32:35], s31 offen  lds
    s_add_u32 m0, s30, 8192
    s_add_u32 s31, s29, 73728
    buffer_load_dwordx4 v4, s[32:35], s31 offen  lds
    s_barrier
    v_lshrrev_b32 v7, 2, v2
    v_and_b32 v8, 3, v2
    s_lshl_b32 s31, s20, 5
    s_add_u32 s31, s31, 0
    v_lshlrev_b32 v9, 7, v7
    v_lshl_add_u32 v9, v8, 3, v9
    v_add_u32 v9, s31, v9
    v_mul_u32_u24 v4, 512, v3
    v_add_u32 v4, v4, v9
    v_mul_u32_u24 v5, 9216, v3
    v_add_u32 v5, v5, v9
    s_lshl_b32 s31, s27, 2
    s_add_u32 s31, s31, s20
    v_lshl_add_u32 v7, s31, 2, v7
    v_lshlrev_b32 v8, 4, v8
    v_lshl_add_u32 v8, v3, 8, v8
    v_mul_u32_u24 v9, 57, v7
    v_lshrrev_b32 v9, 10, v9
    v_mul_u32_u24 v10, 18, v9
    v_sub_u32 v10, v7, v10
    v_lshrrev_b32 v12, 3, v10
    v_and_b32 v13, 1, v10
    v_lshl_add_u32 v12, v12, 1, v13
    v_bfe_u32 v14, v10, 1, 2
    v_cmp_gt_u32 vcc, 16, v10
    v_mul_u32_u24 v9, 82944, v9
    v_add_u32 v9, v9, v8
    v_cndmask_b32 v12, 8, v12, vcc
    v_cndmask_b32 v14, v13, v14, vcc
    v_mov_b32 v15, 0x1000
    v_mov_b32 v13, 0x80
    v_cndmask_b32 v15, v13, v15, vcc
    v_lshl_add_u32 v9, v12, 10, v9
    v_lshl_add_u32 v9, v14, 6, v9
    v_add_u32 v10, v9, v15
    s_and_b32 s31, s28, 1
    s_cmp_eq_u32 s31, 1
    s_cselect_b64 vcc, -1, 0
    v_cndmask_b32 v14, v9, v10, vcc
    s_mul_i32 s31, s28, 36864
    s_add_u32 s37, s31, 0x3a00000
    s_add_u32 s38, s31, 0x3a00000
    s_add_u32 s39, s31, 0x3a02400
    s_add_u32 s40, s31, 0x3a02400
    s_add_u32 s41, s31, 0x3a04800
    s_add_u32 s42, s31, 0x3a04800
    s_add_u32 s43, s31, 0x3a06c00
    s_add_u32 s47, s31, 0x3a06c00
    s_lshr_b32 s31, s28, 1
    s_mul_i32 s31, s31, 9216
    s_add_u32 s48, s31, 0x3a12000
    s_cmp_ge_u32 s26, 4
    s_cbranch_scc1 L_p0_n2
    s_lshl_b32 s31, s26, 2
    s_add_u32 s31, s31, s20
    s_lshl_b32 s31, s31, 12
    s_add_u32 s31, s31, 0x4508000
    v_and_b32 v56, 0x380, v1
    v_add_u32 v56, v56, v1
    v_mov_b32 v52, 0
    v_mov_b32 v53, 0
    v_mov_b32 v54, 0
    v_mov_b32 v55, 0
    buffer_store_dwordx4 v[52:55], v56, s[4:7], s31 offen offset:0 sc1
    buffer_store_dwordx4 v[52:55], v56, s[4:7], s31 offen offset:2048 sc1
L_p0_n2:
    s_waitcnt vmcnt(0)
    s_barrier
    ds_read_b64_tr_b16 v[16:17], v4 offset:0
    ds_read_b64_tr_b16 v[18:19], v4 offset:2560
    ds_read_b64_tr_b16 v[20:21], v4 offset:4608
    ds_read_b64_tr_b16 v[22:23], v4 offset:7168
    ds_read_b64_tr_b16 v[24:25], v4 offset:9216
    ds_read_b64_tr_b16 v[26:27], v4 offset:11776
    ds_read_b64_tr_b16 v[28:29], v4 offset:13824
    ds_read_b64_tr_b16 v[30:31], v4 offset:16384
    ds_read_b64_tr_b16 v[32:33], v4 offset:18432
    ds_read_b64_tr_b16 v[34:35], v4 offset:20992
    ds_read_b64_tr_b16 v[36:37], v4 offset:23040
    ds_read_b64_tr_b16 v[38:39], v4 offset:25600
    ds_read_b64_tr_b16 v[40:41], v4 offset:27648
    ds_read_b64_tr_b16 v[42:43], v4 offset:30208
    ds_read_b64_tr_b16 v[44:45], v4 offset:32256
    ds_read_b64_tr_b16 v[46:47], v4 offset:34816
    ds_read_b64_tr_b16 v[48:49], v5 offset:2048
    ds_read_b64_tr_b16 v[50:51], v5 offset:6656
    s_waitcnt lgkmcnt(15)
    s_mov_b32 s31, s37
    buffer_store_dwordx4 v[16:19], v9, s[4:7], s31 offen sc1
    s_waitcnt lgkmcnt(14)
    s_mov_b32 s31, s38
    buffer_store_dwordx4 v[20:23], v10, s[4:7], s31 offen sc1
    s_waitcnt lgkmcnt(12)
    s_mov_b32 s31, s39
    buffer_store_dwordx4 v[24:27], v9, s[4:7], s31 offen sc1
    s_waitcnt lgkmcnt(10)
    s_mov_b32 s31, s40
    buffer_store_dwordx4 v[28:31], v10, s[4:7], s31 offen sc1
    s_waitcnt lgkmcnt(8)
    s_mov_b32 s31, s41
    buffer_store_dwordx4 v[32:35], v9, s[4:7], s31 offen sc1
    s_waitcnt lgkmcnt(6)
    s_mov_b32 s31, s42
    buffer_store_dwordx4 v[36:39], v10, s[4:7], s31 offen sc1
    s_waitcnt lgkmcnt(4)
    s_mov_b32 s31, s43
    buffer_store_dwordx4 v[40:43], v9, s[4:7], s31 offen sc1
    s_waitcnt lgkmcnt(2)
    s_mov_b32 s31, s47
    buffer_store_dwordx4 v[44:47], v10, s[4:7], s31 offen sc1
    s_waitcnt lgkmcnt(0)
    s_mov_b32 s31, s48
    buffer_store_dwordx4 v[48:51], v14, s[4:7], s31 offen sc1
    s_mov_b32 s46, 1
    s_mov_b32 s27, 32
    s_branch L_p0_cd
L_p0_wq:
    s_mov_b32 s32, s38
    s_mov_b32 s33, s39
    s_mov_b32 s34, 0x1e6000
    s_mov_b32 s35, 0x20000
    s_sub_u32 s23, s2, 128
    s_mul_i32 s25, s23, 19
    s_lshr_b32 s25, s25, 9
    s_mul_i32 s24, s25, 27
    s_sub_u32 s24, s23, s24
    s_mul_i32 s26, s25, 497664
    s_lshl_b32 s31, s24, 7
    s_add_u32 s26, s26, s31
    v_lshrrev_b32 v4, 7, v1
    v_mul_u32_u24 v4, 3456, v4
    v_and_b32 v5, 0x70, v1
    v_add_u32 v4, v4, v5
    s_mul_i32 s31, s20, 110592
    s_add_u32 s27, s26, s31
    s_add_u32 m0, s30, 0
    s_add_u32 s31, s27, 0
    buffer_load_dwordx4 v4, s[32:35], s31 offen  lds
    s_add_u32 m0, s30, 1024
    s_add_u32 s31, s27, 27648
    buffer_load_dwordx4 v4, s[32:35], s31 offen  lds
    s_add_u32 m0, s30, 2048
    s_add_u32 s31, s27, 55296
    buffer_load_dwordx4 v4, s[32:35], s31 offen  lds
    s_add_u32 m0, s30, 3072
    s_add_u32 s31, s27, 82944
    buffer_load_dwordx4 v4, s[32:35], s31 offen  lds
    s_cmp_ge_u32 s20, 2
    s_cbranch_scc1 L_p0_q5
    s_lshl_b32 s31, s29, 10
    s_add_u32 m0, s31, 16384
    s_mul_i32 s31, s29, 27648
    s_add_u32 s31, s31, s26
    s_add_u32 s31, s31, 442368
    buffer_load_dwordx4 v4, s[32:35], s31 offen  lds
L_p0_q5:
    s_barrier
    v_lshrrev_b32 v7, 2, v2
    v_and_b32 v8, 3, v2
    s_lshl_b32 s31, s20, 5
    v_lshlrev_b32 v9, 7, v7
    v_lshl_add_u32 v9, v3, 3, v9
    v_add_u32 v9, s31, v9
    v_lshl_add_u32 v4, v8, 10, v9
    v_and_b32 v5, 1, v2
    v_mul_u32_u24 v5, 9216, v5
    v_add_u32 v5, v5, v9
    s_lshl_b32 s31, s24, 2
    s_add_u32 s31, s31, s20
    v_lshlrev_b32 v8, 4, v8
    v_lshl_add_u32 v8, v7, 8, v8
    v_lshl_add_u32 v7, s31, 2, v3
    v_mul_u32_u24 v9, 57, v7
    v_lshrrev_b32 v9, 13, v9
    v_mul_u32_u24 v10, 144, v9
    v_sub_u32 v10, v7, v10
    v_mul_u32_u24 v12, 57, v10
    v_lshrrev_b32 v12, 9, v12
    v_mul_u32_u24 v13, 9, v12
    v_sub_u32 v13, v10, v13
    v_cmp_lt_u32 s[36:37], 4, v13
    v_cmp_eq_u32 s[38:39], 4, v13
    v_cmp_eq_u32 s[40:41], 2, v9
    v_lshlrev_b32 v14, 1, v9
    v_add_u32 v15, 1, v14
    v_subrev_u32 v10, 5, v13
    v_cndmask_b32 v14, v14, v15, s[36:37]
    v_cndmask_b32 v13, v13, v10, s[36:37]
    v_cndmask_b32 v14, v14, 6, s[38:39]
    v_cndmask_b32 v13, v13, v9, s[38:39]
    s_and_b64 s[40:41], s[40:41], s[38:39]
    s_mov_b32 s31, 129024
    v_mul_lo_u32 v9, v12, s31
    v_add_u32 v9, v9, v8
    v_lshl_add_u32 v9, v14, 10, v9
    v_lshl_add_u32 v9, v13, 6, v9
    s_and_b32 s31, s25, 1
    v_lshrrev_b32 v8, 3, v2
    v_cmp_eq_u32 vcc, s31, v8
    v_add_u32 v15, 64, v9
    v_cndmask_b32 v15, v6, v15, s[40:41]
    v_cndmask_b32 v8, v6, v9, vcc
    v_lshlrev_b32 v10, 2, v2
    v_lshl_add_u32 v10, v7, 4, v10
    v_cmp_gt_u32 vcc, 4, v2
    s_lshl_b32 s45, s25, 13
    s_add_u32 s45, s45, 0x4400000
    v_cndmask_b32 v10, v6, v10, vcc
    s_mul_i32 s42, s25, 28672
    s_add_u32 s42, s42, 0x3800000
    s_lshr_b32 s44, s25, 1
    s_mul_i32 s44, s44, 7168
    s_add_u32 s44, s44, 0x381c000
    s_mul_i32 s26, s24, 29
    s_lshr_b32 s26, s26, 8
    s_mul_i32 s27, s26, 9
    s_sub_u32 s27, s24, s27
    s_lshl_b32 s27, s27, 4
    s_add_u32 s28, s27, 16
    v_lshrrev_b32 v254, 4, v1
    v_mul_u32_u24 v7, 9, v254
    v_add_u32 v255, 9, v7
    v_min_u32 v255, s28, v255
    v_max_u32 v7, s27, v7
    v_sub_u32 v255, v255, v7
    v_cmp_lt_i32 vcc, 0, v255
    v_lshlrev_b32 v254, 8, v254
    v_mov_b32 v14, 0x3f003f00
    v_cndmask_b32 v254, v6, v254, vcc
    s_cmp_eq_u64 s[40:41], 0
    s_cbranch_scc1 L_p0_np
    v_mov_b32 v52, 0
    v_mov_b32 v53, 0
    v_mov_b32 v54, 0
    v_mov_b32 v55, 0
    s_add_u32 s31, s42, 0
    buffer_store_dwordx4 v[52:55], v15, s[4:7], s31 offen sc1
    s_add_u32 s31, s42, 7168
    buffer_store_dwordx4 v[52:55], v15, s[4:7], s31 offen sc1
    s_add_u32 s31, s42, 14336
    buffer_store_dwordx4 v[52:55], v15, s[4:7], s31 offen sc1
    s_add_u32 s31, s42, 21504
    buffer_store_dwordx4 v[52:55], v15, s[4:7], s31 offen sc1
    s_mov_b32 s31, s44
    buffer_store_dwordx4 v[52:55], v15, s[4:7], s31 offen sc1
    s_waitcnt vmcnt(5)
    s_branch L_p0_n3
L_p0_np:
    s_waitcnt vmcnt(0)
L_p0_n3:
    s_barrier
    ds_read_b64_tr_b16 v[16:17], v4 offset:0
    ds_read_b64_tr_b16 v[18:19], v4 offset:512
    ds_read_b64_tr_b16 v[20:21], v4 offset:4096
    ds_read_b64_tr_b16 v[22:23], v4 offset:4608
    ds_read_b64_tr_b16 v[24:25], v4 offset:9216
    ds_read_b64_tr_b16 v[26:27], v4 offset:9728
    ds_read_b64_tr_b16 v[28:29], v4 offset:13312
    ds_read_b64_tr_b16 v[30:31], v4 offset:13824
    ds_read_b64_tr_b16 v[32:33], v5 offset:8192
    ds_read_b64_tr_b16 v[34:35], v5 offset:8704
    s_waitcnt lgkmcnt(8)
    s_add_u32 s31, s42, 0
    buffer_store_dwordx4 v[16:19], v9, s[4:7], s31 offen sc1
    s_waitcnt lgkmcnt(6)
    s_add_u32 s31, s42, 7168
    buffer_store_dwordx4 v[20:23], v9, s[4:7], s31 offen sc1
    s_waitcnt lgkmcnt(4)
    s_add_u32 s31, s42, 14336
    buffer_store_dwordx4 v[24:27], v9, s[4:7], s31 offen sc1
    s_waitcnt lgkmcnt(2)
    s_add_u32 s31, s42, 21504
    buffer_store_dwordx4 v[28:31], v9, s[4:7], s31 offen sc1
    s_waitcnt lgkmcnt(0)
    s_mov_b32 s31, s44
    buffer_store_dwordx4 v[32:35], v8, s[4:7], s31 offen sc1
    v_dot2_f32_bf16 v12, v16, v11, 0
    v_dot2_f32_bf16 v13, v17, v11, 0
    v_dot2_f32_bf16 v12, v18, v11, v12
    v_dot2_f32_bf16 v13, v19, v11, v13
    v_dot2_f32_bf16 v12, v20, v11, v12
    v_dot2_f32_bf16 v13, v21, v11, v13
    v_dot2_f32_bf16 v12, v22, v11, v12
    v_dot2_f32_bf16 v13, v23, v11, v13
    v_dot2_f32_bf16 v12, v24, v11, v12
    v_dot2_f32_bf16 v13, v25, v11, v13
    v_dot2_f32_bf16 v12, v26, v11, v12
    v_dot2_f32_bf16 v13, v27, v11, v13
    v_dot2_f32_bf16 v12, v28, v11, v12
    v_dot2_f32_bf16 v13, v29, v11, v13
    v_dot2_f32_bf16 v12, v30, v11, v12
    v_dot2_f32_bf16 v13, v31, v11, v13
    v_dot2_f32_bf16 v12, v32, v14, v12
    v_dot2_f32_bf16 v13, v33, v14, v13
    v_dot2_f32_bf16 v12, v34, v14, v12
    v_dot2_f32_bf16 v13, v35, v14, v13
    s_nop 2
    v_add_f32 v12, v12, v13
    s_nop 1
    v_add_f32_dpp v12, v12, v12 row_ror:4 row_mask:0xf bank_mask:0xf
    s_nop 1
    v_add_f32_dpp v12, v12, v12 row_ror:8 row_mask:0xf bank_mask:0xf
    buffer_store_dword v12, v10, s[4:7], s45 offen sc1
    s_branch L_p0_ce
L_p0_x:
    s_mov_b32 s32, s36
    s_mov_b32 s33, s37
    s_mov_b32 s34, 0x240000
    s_mov_b32 s35, 0x20000
    s_mul_i32 s26, s2, 18432
    s_mov_b32 m0, s30
    s_add_u32 s31, s26, s30
    buffer_load_dwordx4 v1, s[32:35], s31 offen offset:0  lds
    buffer_load_dwordx4 v1, s[32:35], s31 offen offset:1024  lds
    buffer_load_dwordx4 v1, s[32:35], s31 offen offset:2048  lds
    buffer_load_dwordx4 v1, s[32:35], s31 offen offset:3072  lds
    s_lshl_b32 s27, s29, 10
    s_add_u32 s27, s27, 16384
    s_mov_b32 m0, s27
    s_add_u32 s31, s26, s27
    buffer_load_dwordx4 v1, s[32:35], s31 offen  lds
    s_barrier
    s_mul_i32 s31, s20, 288
    v_mul_u32_u24 v7, 1152, v2
    v_lshl_add_u32 v4, v3, 4, v7
    v_add_u32 v4, s31, v4
    s_mul_i32 s31, s29, 576
    v_mul_u32_u24 v5, 144, v3
    v_add3_u32 v5, v5, v7, s31
    s_add_u32 s26, s26, 0x0
    s_add_u32 s42, s26, s30
    s_add_u32 s44, s26, s27
    s_lshl_b32 s45, s2, 10
    s_lshl_b32 s31, s20, 8
    s_add_u32 s45, s45, s31
    s_add_u32 s45, s45, 0x1b00000
    v_cmp_gt_u32 vcc, 2, v3
    v_lshrrev_b32 v10, 1, v1
    s_mov_b32 s46, 2
    v_cndmask_b32 v10, v6, v10, vcc
    s_lshr_b32 s27, s2, 3
    s_add_u32 s27, s27, 48
    s_waitcnt vmcnt(0)
    s_barrier
    ds_read_b128 v[16:19], v4 offset:0
    ds_read_b128 v[20:23], v4 offset:64
    ds_read_b128 v[24:27], v4 offset:144
    ds_read_b128 v[28:31], v4 offset:208
    ds_read_b128 v[32:35], v5 offset:128
    s_waitcnt lgkmcnt(4)
    buffer_store_dwordx4 v[16:19], v1, s[4:7], s42 offen offset:0 sc1
    s_waitcnt lgkmcnt(3)
    buffer_store_dwordx4 v[20:23], v1, s[4:7], s42 offen offset:1024 sc1
    s_waitcnt lgkmcnt(2)
    buffer_store_dwordx4 v[24:27], v1, s[4:7], s42 offen offset:2048 sc1
    s_waitcnt lgkmcnt(1)
    buffer_store_dwordx4 v[28:31], v1, s[4:7], s42 offen offset:3072 sc1
    v_dot2_f32_bf16 v12, v16, v11, 0
    v_dot2_f32_bf16 v13, v16, v16, 0
    v_dot2_f32_bf16 v12, v17, v11, v12
    v_dot2_f32_bf16 v13, v17, v17, v13
    v_dot2_f32_bf16 v12, v18, v11, v12
    v_dot2_f32_bf16 v13, v18, v18, v13
    v_dot2_f32_bf16 v12, v19, v11, v12
    v_dot2_f32_bf16 v13, v19, v19, v13
    v_dot2_f32_bf16 v12, v20, v11, v12
    v_dot2_f32_bf16 v13, v20, v20, v13
    v_dot2_f32_bf16 v12, v21, v11, v12
    v_dot2_f32_bf16 v13, v21, v21, v13
    v_dot2_f32_bf16 v12, v22, v11, v12
    v_dot2_f32_bf16 v13, v22, v22, v13
    v_dot2_f32_bf16 v12, v23, v11, v12
    v_dot2_f32_bf16 v13, v23, v23, v13
    v_dot2_f32_bf16 v12, v24, v11, v12
    v_dot2_f32_bf16 v13, v24, v24, v13
    v_dot2_f32_bf16 v12, v25, v11, v12
    v_dot2_f32_bf16 v13, v25, v25, v13
    v_dot2_f32_bf16 v12, v26, v11, v12
    v_dot2_f32_bf16 v13, v26, v26, v13
    v_dot2_f32_bf16 v12, v27, v11, v12
    v_dot2_f32_bf16 v13, v27, v27, v13
    v_dot2_f32_bf16 v12, v28, v11, v12
    v_dot2_f32_bf16 v13, v28, v28, v13
    v_dot2_f32_bf16 v12, v29, v11, v12
    v_dot2_f32_bf16 v13, v29, v29, v13
    v_dot2_f32_bf16 v12, v30, v11, v12
    v_dot2_f32_bf16 v13, v30, v30, v13
    v_dot2_f32_bf16 v12, v31, v11, v12
    v_dot2_f32_bf16 v13, v31, v31, v13
    s_waitcnt lgkmcnt(0)
    s_cmp_ge_u32 s20, 2
    s_cbranch_scc1 L_p0_xs
    buffer_store_dwordx4 v[32:35], v1, s[4:7], s44 offen sc1
    v_dot2_f32_bf16 v12, v32, v11, v12
    v_dot2_f32_bf16 v13, v32, v32, v13
    v_dot2_f32_bf16 v12, v33, v11, v12
    v_dot2_f32_bf16 v13, v33, v33, v13
    v_dot2_f32_bf16 v12, v34, v11, v12
    v_dot2_f32_bf16 v13, v34, v34, v13
    v_dot2_f32_bf16 v12, v35, v11, v12
    v_dot2_f32_bf16 v13, v35, v35, v13
L_p0_xs:
    s_nop 2
    v_mov_b32 v14, v12
    v_mov_b32 v15, v13
    s_nop 1
    v_permlane32_swap_b32 v12, v14
    v_permlane32_swap_b32 v13, v15
    v_add_f32 v12, v12, v14
    v_add_f32 v13, v13, v15
    buffer_store_dwordx2 v[12:13], v10, s[4:7], s45 offen sc1
L_p0_cd:
    v_cmp_eq_u32 vcc, 0, v1
    s_lshl_b32 s27, s27, 8
    v_mov_b32 v255, s46
    v_mov_b32 v254, s27
    v_cndmask_b32 v254, v6, v254, vcc
L_p0_ce:
    s_mov_b32 s48, s58
    s_mov_b32 s49, s59
    s_mov_b32 s50, 0x100
    s_mov_b32 s51, 0x20000
    v_mov_b32 v4, 0
    buffer_load_dword v246, v4, s[48:51], 0 offen sc1
    s_barrier
    s_branch L_m_cl
L_d1_first:
    v_cmp_gt_u32 vcc, 4, v246
    v_mov_b32 v4, 0
    s_mov_b32 s46, 0x4500000
    s_cbranch_vccz L_pd_dbg
    s_mov_b32 s60, 65536
L_poll_dbg:
    buffer_load_dword v5, v4, s[48:51], 0 offen sc1
    s_waitcnt vmcnt(0)
    v_cmp_gt_u32 vcc, 4, v5
    s_sub_u32 s60, s60, 1
    s_cbranch_scc1 L_pd_dbg
    s_cbranch_vccz L_pd_dbg
    s_sleep 4
    s_branch L_poll_dbg
L_pd_dbg:
    buffer_atomic_add v255, v254, s[4:7], s46 offen sc1
    s_branch L_ns_d1
L_ld_m:
    s_cmp_lg_u32 s2, 0
    s_cbranch_scc1 L_p0_nz
    s_lshl_b32 s31, s20, 12
    s_add_u32 s31, s31, 0x4500000
    v_and_b32 v56, 0x380, v1
    v_add_u32 v56, v56, v1
    v_mov_b32 v52, 0
    v_mov_b32 v53, 0
    v_mov_b32 v54, 0
    v_mov_b32 v55, 0
    buffer_store_dwordx4 v[52:55], v56, s[4:7], s31 offen offset:0 sc1
    buffer_store_dwordx4 v[52:55], v56, s[4:7], s31 offen offset:2048 sc1
    s_waitcnt vmcnt(0)
    s_mov_b32 s53, 1
    s_atomic_add s53, s[58:59], 0
L_p0_nz:
    v_bfe_u32 v2, v1, 4, 4
    v_lshrrev_b32 v3, 8, v1
    v_bfrev_b32 v6, 1
    v_mov_b32 v11, 0x3f803f80
    s_mul_i32 s30, s20, 9216
    s_cmp_lt_u32 s2, 144
    s_cbranch_scc1 L_p0_wi
    s_cmp_lt_u32 s2, 216
    s_cbranch_scc1 L_p0_wu
    v_mov_b32 v9, v6
    v_mov_b32 v10, v6
    v_mov_b32 v14, v6
    v_mov_b32 v15, v6
    s_mov_b32 s37, 0
    s_mov_b32 s38, 0
    s_mov_b32 s39, 0
    s_mov_b32 s40, 0
    s_mov_b32 s41, 0
    s_mov_b32 s42, 0
    s_mov_b32 s43, 0
    s_mov_b32 s47, 0
    s_mov_b32 s48, 0
    s_mov_b32 s49, 0
    s_barrier
    s_barrier
    s_barrier
    s_barrier
    s_barrier
    s_branch L_p0_ld
L_p0_wu:
    s_sub_u32 s26, s2, 144
    s_mul_i32 s28, s26, 57
    s_lshr_b32 s28, s28, 9
    s_mul_i32 s27, s28, 9
    s_sub_u32 s27, s26, s27
    s_mov_b32 s32, s50
    s_mov_b32 s33, s51
    s_mov_b32 s34, 0x288000
    s_mov_b32 s35, 0x20000
    s_mul_i32 s29, s28, 331776
    s_lshl_b32 s31, s27, 7
    s_add_u32 s29, s29, s31
    s_mul_i32 s31, s20, 82944
    s_add_u32 s29, s29, s31
    v_lshrrev_b32 v4, 7, v1
    v_mul_u32_u24 v4, 1152, v4
    v_and_b32 v5, 0x70, v1
    v_add_u32 v4, v4, v5
    s_barrier
    s_barrier
    s_barrier
    s_barrier
    s_barrier
    s_add_u32 m0, s30, 94208
    s_add_u32 s31, s29, 0
    buffer_load_dwordx4 v4, s[32:35], s31 offen  lds
    s_add_u32 m0, s30, 95232
    s_add_u32 s31, s29, 9216
    buffer_load_dwordx4 v4, s[32:35], s31 offen  lds
    s_add_u32 m0, s30, 96256
    s_add_u32 s31, s29, 18432
    buffer_load_dwordx4 v4, s[32:35], s31 offen  lds
    s_add_u32 m0, s30, 97280
    s_add_u32 s31, s29, 27648
    buffer_load_dwordx4 v4, s[32:35], s31 offen  lds
    s_add_u32 m0, s30, 98304
    s_add_u32 s31, s29, 36864
    buffer_load_dwordx4 v4, s[32:35], s31 offen  lds
    s_add_u32 m0, s30, 99328
    s_add_u32 s31, s29, 46080
    buffer_load_dwordx4 v4, s[32:35], s31 offen  lds
    s_add_u32 m0, s30, 100352
    s_add_u32 s31, s29, 55296
    buffer_load_dwordx4 v4, s[32:35], s31 offen  lds
    s_add_u32 m0, s30, 101376
    s_add_u32 s31, s29, 64512
    buffer_load_dwordx4 v4, s[32:35], s31 offen  lds
    s_add_u32 m0, s30, 102400
    s_add_u32 s31, s29, 73728
    buffer_load_dwordx4 v4, s[32:35], s31 offen  lds
    v_lshrrev_b32 v7, 2, v2
    v_and_b32 v8, 3, v2
    s_lshl_b32 s31, s20, 5
    s_add_u32 s31, s31, 94208
    v_lshlrev_b32 v9, 7, v7
    v_lshl_add_u32 v9, v8, 3, v9
    v_add_u32 v9, s31, v9
    v_mul_u32_u24 v4, 512, v3
    v_add_u32 v4, v4, v9
    v_mul_u32_u24 v5, 512, v3
    v_add_u32 v5, v5, v9
    s_lshl_b32 s31, s27, 2
    s_add_u32 s31, s31, s20
    v_lshl_add_u32 v7, s31, 2, v7
    v_lshlrev_b32 v8, 4, v8
    v_lshl_add_u32 v8, v3, 8, v8
    v_mul_u32_u24 v9, 57, v7
    v_lshrrev_b32 v9, 10, v9
    v_mul_u32_u24 v10, 18, v9
    v_sub_u32 v10, v7, v10
    v_lshrrev_b32 v12, 3, v10
    v_and_b32 v13, 1, v10
    v_lshl_add_u32 v12, v12, 1, v13
    v_bfe_u32 v14, v10, 1, 2
    v_cmp_gt_u32 vcc, 16, v10
    v_mul_u32_u24 v9, 331776, v9
    v_add_u32 v9, v9, v8
    v_cndmask_b32 v12, 8, v12, vcc
    v_cndmask_b32 v14, v13, v14, vcc
    v_mov_b32 v15, 0x1000
    v_mov_b32 v13, 0x80
    v_cndmask_b32 v15, v13, v15, vcc
    v_lshl_add_u32 v9, v12, 10, v9
    v_lshl_add_u32 v9, v14, 6, v9
    v_add_u32 v10, v9, v15
    s_and_b32 s31, s28, 1
    s_cmp_eq_u32 s31, 1
    s_cselect_b64 vcc, -1, 0
    v_cndmask_b32 v14, v9, v10, vcc
    s_mul_i32 s31, s28, 9216
    s_add_u32 s37, s31, 0x4100000
    s_add_u32 s38, s31, 0x4100000
    s_add_u32 s39, s31, 0x4112000
    s_add_u32 s40, s31, 0x4112000
    s_add_u32 s41, s31, 0x4124000
    s_add_u32 s42, s31, 0x4124000
    s_add_u32 s43, s31, 0x4136000
    s_add_u32 s47, s31, 0x4136000
    s_lshr_b32 s31, s28, 1
    s_mul_i32 s31, s31, 9216
    s_add_u32 s48, s31, 0x4148000
    v_mov_b32 v15, v6
    s_mov_b32 s49, 0
    s_branch L_p0_ld
L_p0_wi:
    s_mov_b32 s26, s2
    s_mul_i32 s28, s26, 57
    s_lshr_b32 s28, s28, 12
    s_mul_i32 s27, s28, 72
    s_sub_u32 s27, s26, s27
    s_mov_b32 s32, s44
    s_mov_b32 s33, s45
    s_mov_b32 s34, 0x510000
    s_mov_b32 s35, 0x20000
    s_mul_i32 s29, s28, 2654208
    s_lshl_b32 s31, s27, 7
    s_add_u32 s29, s29, s31
    s_mul_i32 s31, s20, 663552
    s_add_u32 s29, s29, s31
    v_lshrrev_b32 v4, 7, v1
    v_mul_u32_u24 v4, 9216, v4
    v_and_b32 v5, 0x70, v1
    v_add_u32 v4, v4, v5
    s_barrier
    s_barrier
    s_barrier
    s_barrier
    s_barrier
    s_add_u32 m0, s30, 94208
    s_add_u32 s31, s29, 0
    buffer_load_dwordx4 v4, s[32:35], s31 offen  lds
    s_add_u32 m0, s30, 95232
    s_add_u32 s31, s29, 73728
    buffer_load_dwordx4 v4, s[32:35], s31 offen  lds
    s_add_u32 m0, s30, 96256
    s_add_u32 s31, s29, 147456
    buffer_load_dwordx4 v4, s[32:35], s31 offen  lds
    s_add_u32 m0, s30, 97280
    s_add_u32 s31, s29, 221184
    buffer_load_dwordx4 v4, s[32:35], s31 offen  lds
    s_add_u32 m0, s30, 98304
    s_add_u32 s31, s29, 294912
    buffer_load_dwordx4 v4, s[32:35], s31 offen  lds
    s_add_u32 m0, s30, 99328
    s_add_u32 s31, s29, 368640
    buffer_load_dwordx4 v4, s[32:35], s31 offen  lds
    s_add_u32 m0, s30, 100352
    s_add_u32 s31, s29, 442368
    buffer_load_dwordx4 v4, s[32:35], s31 offen  lds
    s_add_u32 m0, s30, 101376
    s_add_u32 s31, s29, 516096
    buffer_load_dwordx4 v4, s[32:35], s31 offen  lds
    s_add_u32 m0, s30, 102400
    s_add_u32 s31, s29, 589824
    buffer_load_dwordx4 v4, s[32:35], s31 offen  lds
    v_lshrrev_b32 v7, 2, v2
    v_and_b32 v8, 3, v2
    s_lshl_b32 s31, s20, 5
    s_add_u32 s31, s31, 94208
    v_lshlrev_b32 v9, 7, v7
    v_lshl_add_u32 v9, v8, 3, v9
    v_add_u32 v9, s31, v9
    v_mul_u32_u24 v4, 1024, v3
    v_add_u32 v4, v4, v9
    v_mul_u32_u24 v5, 9216, v3
    v_add_u32 v5, v5, v9
    s_lshl_b32 s31, s27, 2
    s_add_u32 s31, s31, s20
    v_lshl_add_u32 v7, s31, 2, v7
    v_lshlrev_b32 v8, 4, v8
    v_lshl_add_u32 v8, v3, 8, v8
    s_cmp_lt_u32 s31, 144
    s_cselect_b32 s23, 1, 0
    s_cselect_b32 s24, 0, 144
    s_sub_u32 s26, s31, s24
    s_mul_i32 s25, s26, 57
    s_lshr_b32 s25, s25, 9
    s_mul_i32 s24, s25, 9
    s_sub_u32 s24, s26, s24
    s_lshl_b32 s26, s25, 1
    s_add_u32 s26, s26, s23
    s_mul_i32 s26, s26, 165888
    s_lshl_b32 s31, s24, 10
    s_add_u32 s26, s26, s31
    s_add_u32 s26, s26, 0x3b00000
    s_mul_i32 s31, s28, 9216
    s_add_u32 s48, s26, s31
    s_add_u32 s48, s48, 147456
    s_lshl_b32 s31, s31, 3
    s_add_u32 s26, s26, s31
    s_add_u32 s37, s26, 0
    s_add_u32 s38, s26, 9216
    s_add_u32 s39, s26, 18432
    s_add_u32 s40, s26, 27648
    s_add_u32 s41, s26, 36864
    s_add_u32 s42, s26, 46080
    s_add_u32 s43, s26, 55296
    s_add_u32 s47, s26, 64512
    s_lshl_b32 s49, s25, 12
    s_mul_i32 s31, s28, 1152
    s_add_u32 s49, s49, s31
    s_mul_i32 s31, s23, 576
    s_add_u32 s49, s49, s31
    s_lshl_b32 s31, s24, 6
    s_add_u32 s49, s49, s31
    s_add_u32 s49, s49, 0x4410000
    v_cmp_eq_u32 vcc, 0, v3
    v_lshlrev_b32 v15, 2, v2
    v_mov_b32 v9, v1
    v_mov_b32 v10, v1
    v_mov_b32 v14, v1
    v_cndmask_b32 v15, v6, v15, vcc
L_p0_ld:
    s_waitcnt lgkmcnt(0)
    s_branch L_m_l1
L_m_cl:
    s_and_b32 s25, s2, 7
    s_lshr_b32 s26, s2, 3
    s_lshr_b32 s23, s25, 1
    s_lshl_b32 s23, s23, 2
    s_lshr_b32 s27, s26, 3
    s_add_u32 s23, s23, s27
    s_and_b32 s24, s25, 1
    s_lshl_b32 s24, s24, 3
    s_and_b32 s27, s26, 7
    s_add_u32 s24, s24, s27
    s_lshl_b32 s30, s23, 3
    s_lshl_b32 s31, s20, 1
    s_add_u32 s31, s30, s31
    s_mul_i32 s29, s31, 18432
    s_add_u32 s29, s29, s21
    s_add_u32 s35, s29, 0x600000
    s_add_u32 s29, s29, 0x0
    s_max_u32 s30, s30, 1
    s_sub_u32 s30, s30, 1
    s_lshl_b32 s30, s30, 10
    s_add_u32 s30, s30, s21
    s_add_u32 s30, s30, 0x1b00000
    s_lshl_b32 s32, s31, 10
    s_add_u32 s32, s32, s21
    s_add_u32 s32, s32, 0x1b00000
    v_bfe_u32 v2, v1, 4, 4
    v_lshrrev_b32 v3, 8, v1
    s_lshl_b32 s33, s20, 2
    s_lshr_b32 s33, 0x3362, s33
    s_and_b32 s33, s33, 15
    s_min_u32 s34, s20, 1
    s_add_u32 s34, s34, 4
    s_lshl_b32 s36, s33, 10
    s_lshl_b32 s37, s34, 10
    v_add_u32 v247, 64512, v1
    v_add_u32 v248, 131072, v1
    v_add_u32 v249, s36, v1
    v_add_u32 v250, s36, v247
    v_add_u32 v251, s37, v1
    v_add_u32 v252, s37, v247
    v_add_u32 v253, 18432, v1
    v_lshrrev_b32 v0, 1, v1
    s_add_u32 s38, s29, 0
    s_add_u32 s39, s29, 4096
    s_add_u32 s40, s29, 8192
    s_add_u32 s41, s29, 12288
    s_add_u32 s42, s29, 16384
    s_max_u32 s44, s23, 1
    s_sub_u32 s44, s44, 1
    s_lshl_b32 s52, s22, 7
    s_add_u32 s52, s52, s23
    s_lshl_b32 s52, s52, 8
    s_add_u32 s52, s52, 0x4503000
    s_add_u32 s52, s52, s4
    s_addc_u32 s53, s5, 0
    s_lshl_b32 s54, s22, 7
    s_add_u32 s54, s54, s44
    s_lshl_b32 s54, s54, 8
    s_add_u32 s54, s54, 0x4503000
    s_add_u32 s54, s54, s4
    s_addc_u32 s55, s5, 0
    s_lshl_b32 s44, s24, 8
    s_add_u32 s44, s44, 0x4500000
    s_add_u32 s44, s44, s4
    s_addc_u32 s45, s5, 0
    s_waitcnt vmcnt(0)
    s_barrier
    s_cmp_lg_u32 s20, 0
    s_cbranch_scc1 L_ns_d1
    s_cmp_eq_u32 s22, 0
    s_cbranch_scc1 L_d1_first
    s_mov_b32 s56, 1
    s_atomic_add s56, s[50:51], 0
L_ns_d1:
    s_barrier
    s_cmp_lg_u32 s20, 0
    s_cbranch_scc1 L_pd_d1
    s_mov_b32 s60, 65536
L_poll_d1:
    s_mov_b32 s57, 0
    s_atomic_add s57, s[52:53], 0 glc
    s_mov_b32 s58, 0
    s_atomic_add s58, s[54:55], 0 glc
    s_mov_b32 s59, 0
    s_atomic_add s59, s[44:45], 0 glc
    s_waitcnt lgkmcnt(0)
    s_cmp_ge_u32 s59, 108
    s_cselect_b32 s59, 16, 0
    s_min_u32 s57, s57, s58
    s_min_u32 s57, s57, s59
    s_cmp_ge_u32 s57, 16
    s_cbranch_scc1 L_pd_d1
    s_sub_u32 s60, s60, 1
    s_cbranch_scc1 L_pd_d1
    s_sleep 2
    s_branch L_poll_d1
L_pd_d1:
    s_barrier
    buffer_load_dwordx4 v[160:163], v1, s[4:7], s38 offen offset:0 sc1
    buffer_load_dwordx4 v[164:167], v253, s[4:7], s38 offen offset:0 sc1
    buffer_load_dwordx4 v[168:171], v1, s[4:7], s38 offen offset:1024 sc1
    buffer_load_dwordx4 v[172:175], v253, s[4:7], s38 offen offset:1024 sc1
    buffer_load_dwordx4 v[176:179], v1, s[4:7], s38 offen offset:2048 sc1
    buffer_load_dwordx4 v[180:183], v253, s[4:7], s38 offen offset:2048 sc1
    buffer_load_dwordx4 v[184:187], v1, s[4:7], s38 offen offset:3072 sc1
    buffer_load_dwordx4 v[188:191], v253, s[4:7], s38 offen offset:3072 sc1
    s_barrier
    ds_read_b128 v[80:83], v1 offset:0
    ds_read_b128 v[84:87], v1 offset:1024
    ds_read_b128 v[88:91], v1 offset:2048
    ds_read_b128 v[92:95], v1 offset:3072
    ds_read_b128 v[96:99], v1 offset:4096
    ds_read_b128 v[100:103], v1 offset:5120
    ds_read_b128 v[104:107], v1 offset:6144
    buffer_load_dwordx2 v[4:5], v0, s[4:7], s30 offen offset:0 sc1
    buffer_load_dwordx2 v[6:7], v0, s[4:7], s30 offen offset:512 sc1
    buffer_load_dwordx2 v[8:9], v0, s[4:7], s32 offen offset:0 sc1
    buffer_load_dwordx2 v[10:11], v0, s[4:7], s32 offen offset:512 sc1
    buffer_load_dwordx2 v[12:13], v0, s[4:7], s32 offen offset:1024 sc1
    buffer_load_dwordx2 v[14:15], v0, s[4:7], s32 offen offset:1536 sc1
    s_lshl_b32 s50, s22, 7
    s_add_u32 s50, s50, s23
    s_lshl_b32 s50, s50, 8
    s_add_u32 s50, s50, 0x4508000
    s_add_u32 s50, s50, s4
    s_addc_u32 s51, s5, 0
    s_waitcnt vmcnt(12) lgkmcnt(3)
    v_mfma_f32_16x16x32_bf16 v[16:19], v[80:83], v[160:163], 0
    ds_read_b128 v[120:123], v1 offset:7168
    v_mfma_f32_16x16x32_bf16 v[44:47], v[80:83], v[164:167], 0
    ds_read_b128 v[124:127], v1 offset:8192
    v_mfma_f32_16x16x32_bf16 v[20:23], v[84:87], v[160:163], 0
    ds_read_b128 v[128:131], v1 offset:9216
    v_mfma_f32_16x16x32_bf16 v[48:51], v[84:87], v[164:167], 0
    ds_read_b128 v[132:135], v1 offset:10240
    v_mfma_f32_16x16x32_bf16 v[24:27], v[88:91], v[160:163], 0
    ds_read_b128 v[136:139], v1 offset:11264
    v_mfma_f32_16x16x32_bf16 v[52:55], v[88:91], v[164:167], 0
    ds_read_b128 v[140:143], v1 offset:12288
    v_mfma_f32_16x16x32_bf16 v[28:31], v[92:95], v[160:163], 0
    ds_read_b128 v[144:147], v1 offset:13312
    v_mfma_f32_16x16x32_bf16 v[56:59], v[92:95], v[164:167], 0
    s_waitcnt lgkmcnt(7)
    v_mfma_f32_16x16x32_bf16 v[32:35], v[160:163], v[96:99], 0
    v_mfma_f32_16x16x32_bf16 v[60:63], v[164:167], v[96:99], 0
    v_mfma_f32_16x16x32_bf16 v[36:39], v[160:163], v[100:103], 0
    buffer_load_dwordx4 v[192:195], v1, s[4:7], s39 offen offset:0 sc1
    v_mfma_f32_16x16x32_bf16 v[64:67], v[164:167], v[100:103], 0
    buffer_load_dwordx4 v[196:199], v253, s[4:7], s39 offen offset:0 sc1
    v_mfma_f32_16x16x32_bf16 v[40:43], v[104:107], v[160:163], 0
    buffer_load_dwordx4 v[200:203], v1, s[4:7], s39 offen offset:1024 sc1
    v_mfma_f32_16x16x32_bf16 v[68:71], v[104:107], v[164:167], 0
    buffer_load_dwordx4 v[204:207], v253, s[4:7], s39 offen offset:1024 sc1
    s_waitcnt vmcnt(14) lgkmcnt(3)
    s_barrier
    v_mfma_f32_16x16x32_bf16 v[16:19], v[120:123], v[168:171], v[16:19]
    ds_read_b128 v[80:83], v1 offset:14336
    v_mfma_f32_16x16x32_bf16 v[44:47], v[120:123], v[172:175], v[44:47]
    ds_read_b128 v[84:87], v1 offset:15360
    v_mfma_f32_16x16x32_bf16 v[20:23], v[124:127], v[168:171], v[20:23]
    ds_read_b128 v[88:91], v1 offset:16384
    v_mfma_f32_16x16x32_bf16 v[48:51], v[124:127], v[172:175], v[48:51]
    ds_read_b128 v[92:95], v1 offset:17408
    v_mfma_f32_16x16x32_bf16 v[24:27], v[128:131], v[168:171], v[24:27]
    ds_read_b128 v[96:99], v1 offset:18432
    v_mfma_f32_16x16x32_bf16 v[52:55], v[128:131], v[172:175], v[52:55]
    ds_read_b128 v[100:103], v1 offset:19456
    v_mfma_f32_16x16x32_bf16 v[28:31], v[132:135], v[168:171], v[28:31]
    ds_read_b128 v[104:107], v1 offset:20480
    v_mfma_f32_16x16x32_bf16 v[56:59], v[132:135], v[172:175], v[56:59]
    ds_read_b128 v[108:111], v248 offset:0
    s_waitcnt lgkmcnt(8)
    v_mfma_f32_16x16x32_bf16 v[32:35], v[168:171], v[136:139], v[32:35]
    ds_read_b128 v[112:115], v249 offset:0
    v_mfma_f32_16x16x32_bf16 v[60:63], v[172:175], v[136:139], v[60:63]
    ds_read_b128 v[116:119], v251 offset:0
    v_mfma_f32_16x16x32_bf16 v[36:39], v[168:171], v[140:143], v[36:39]
    buffer_load_dwordx4 v[160:163], v1, s[4:7], s39 offen offset:2048 sc1
    v_mfma_f32_16x16x32_bf16 v[64:67], v[172:175], v[140:143], v[64:67]
    buffer_load_dwordx4 v[164:167], v253, s[4:7], s39 offen offset:2048 sc1
    v_mfma_f32_16x16x32_bf16 v[40:43], v[144:147], v[168:171], v[40:43]
    v_mfma_f32_16x16x32_bf16 v[68:71], v[144:147], v[172:175], v[68:71]
    s_waitcnt vmcnt(6) lgkmcnt(6)
    v_mfma_f32_16x16x32_bf16 v[16:19], v[80:83], v[176:179], v[16:19]
    ds_read_b128 v[120:123], v1 offset:21504
    v_mfma_f32_16x16x32_bf16 v[44:47], v[80:83], v[180:183], v[44:47]
    ds_read_b128 v[124:127], v1 offset:22528
    v_add_f32 v240, v4, v6
    v_mfma_f32_16x16x32_bf16 v[20:23], v[84:87], v[176:179], v[20:23]
    ds_read_b128 v[128:131], v1 offset:23552
    v_add_f32 v241, v5, v7
    v_mfma_f32_16x16x32_bf16 v[48:51], v[84:87], v[180:183], v[48:51]
    ds_read_b128 v[132:135], v1 offset:24576
    v_add_f32 v242, v8, v10
    v_mfma_f32_16x16x32_bf16 v[24:27], v[88:91], v[176:179], v[24:27]
    ds_read_b128 v[136:139], v1 offset:25600
    v_add_f32 v243, v9, v11
    v_mfma_f32_16x16x32_bf16 v[52:55], v[88:91], v[180:183], v[52:55]
    ds_read_b128 v[140:143], v1 offset:26624
    v_add_f32 v244, v12, v14
    v_mfma_f32_16x16x32_bf16 v[28:31], v[92:95], v[176:179], v[28:31]
    ds_read_b128 v[144:147], v1 offset:27648
    v_add_f32 v245, v13, v15
    v_mfma_f32_16x16x32_bf16 v[56:59], v[92:95], v[180:183], v[56:59]
    ds_read_b128 v[148:151], v248 offset:1024
    s_waitcnt lgkmcnt(8)
    v_mfma_f32_16x16x32_bf16 v[32:35], v[176:179], v[96:99], v[32:35]
    ds_read_b128 v[152:155], v249 offset:7168
    v_mov_b32 v4, v240
    v_mfma_f32_16x16x32_bf16 v[60:63], v[180:183], v[96:99], v[60:63]
    ds_read_b128 v[156:159], v251 offset:7168
    v_mov_b32 v5, v241
    v_mfma_f32_16x16x32_bf16 v[36:39], v[176:179], v[100:103], v[36:39]
    buffer_load_dwordx4 v[168:171], v1, s[4:7], s39 offen offset:3072 sc1
    v_mfma_f32_16x16x32_bf16 v[64:67], v[180:183], v[100:103], v[64:67]
    buffer_load_dwordx4 v[172:175], v253, s[4:7], s39 offen offset:3072 sc1
    v_mfma_f32_16x16x32_bf16 v[40:43], v[104:107], v[176:179], v[40:43]
    v_mov_b32 v8, v242
    v_mfma_f32_16x16x32_bf16 v[68:71], v[104:107], v[180:183], v[68:71]
    v_mov_b32 v9, v243
    v_mfma_f32_16x16x32_bf16 v[72:75], v[112:115], v[108:111], 0
    v_mov_b32 v12, v244
    v_mov_b32 v13, v245
    v_mfma_f32_16x16x32_bf16 v[76:79], v[108:111], v[116:119], 0
    v_permlane32_swap_b32 v240, v4
    s_waitcnt vmcnt(8) lgkmcnt(6)
    s_barrier
    v_mfma_f32_16x16x32_bf16 v[16:19], v[120:123], v[184:187], v[16:19]
    ds_read_b128 v[80:83], v1 offset:28672
    v_mfma_f32_16x16x32_bf16 v[44:47], v[120:123], v[188:191], v[44:47]
    ds_read_b128 v[84:87], v1 offset:29696
    v_permlane32_swap_b32 v241, v5
    v_mfma_f32_16x16x32_bf16 v[20:23], v[124:127], v[184:187], v[20:23]
    ds_read_b128 v[88:91], v1 offset:30720
    v_permlane32_swap_b32 v242, v8
    v_mfma_f32_16x16x32_bf16 v[48:51], v[124:127], v[188:191], v[48:51]
    ds_read_b128 v[92:95], v1 offset:31744
    v_permlane32_swap_b32 v243, v9
    v_mfma_f32_16x16x32_bf16 v[24:27], v[128:131], v[184:187], v[24:27]
    ds_read_b128 v[96:99], v1 offset:32768
    v_permlane32_swap_b32 v244, v12
    v_mfma_f32_16x16x32_bf16 v[52:55], v[128:131], v[188:191], v[52:55]
    ds_read_b128 v[100:103], v1 offset:33792
    v_permlane32_swap_b32 v245, v13
    v_mfma_f32_16x16x32_bf16 v[28:31], v[132:135], v[184:187], v[28:31]
    ds_read_b128 v[104:107], v1 offset:34816
    v_add_f32 v240, v240, v4
    v_mfma_f32_16x16x32_bf16 v[56:59], v[132:135], v[188:191], v[56:59]
    ds_read_b128 v[108:111], v248 offset:2048
    s_waitcnt lgkmcnt(8)
    v_mfma_f32_16x16x32_bf16 v[32:35], v[184:187], v[136:139], v[32:35]
    ds_read_b128 v[112:115], v249 offset:14336
    v_add_f32 v241, v241, v5
    v_mfma_f32_16x16x32_bf16 v[60:63], v[188:191], v[136:139], v[60:63]
    ds_read_b128 v[116:119], v251 offset:14336
    v_add_f32 v242, v242, v8
    v_mfma_f32_16x16x32_bf16 v[36:39], v[184:187], v[140:143], v[36:39]
    buffer_load_dwordx4 v[176:179], v1, s[4:7], s40 offen offset:0 sc1
    v_mfma_f32_16x16x32_bf16 v[64:67], v[188:191], v[140:143], v[64:67]
    buffer_load_dwordx4 v[180:183], v253, s[4:7], s40 offen offset:0 sc1
    v_mfma_f32_16x16x32_bf16 v[40:43], v[144:147], v[184:187], v[40:43]
    v_add_f32 v243, v243, v9
    v_mfma_f32_16x16x32_bf16 v[68:71], v[144:147], v[188:191], v[68:71]
    v_add_f32 v244, v244, v12
    v_mfma_f32_16x16x32_bf16 v[72:75], v[152:155], v[148:151], v[72:75]
    v_add_f32 v245, v245, v13
    v_mov_b32 v4, v240
    v_mfma_f32_16x16x32_bf16 v[76:79], v[148:151], v[156:159], v[76:79]
    v_mov_b32 v5, v241
    s_waitcnt vmcnt(8) lgkmcnt(6)
    v_mfma_f32_16x16x32_bf16 v[16:19], v[80:83], v[192:195], v[16:19]
    ds_read_b128 v[120:123], v1 offset:35840
    v_mfma_f32_16x16x32_bf16 v[44:47], v[80:83], v[196:199], v[44:47]
    ds_read_b128 v[124:127], v1 offset:36864
    v_mov_b32 v8, v242
    v_mfma_f32_16x16x32_bf16 v[20:23], v[84:87], v[192:195], v[20:23]
    ds_read_b128 v[128:131], v1 offset:37888
    v_mov_b32 v9, v243
    v_mfma_f32_16x16x32_bf16 v[48:51], v[84:87], v[196:199], v[48:51]
    ds_read_b128 v[132:135], v1 offset:38912
    v_mov_b32 v12, v244
    v_mfma_f32_16x16x32_bf16 v[24:27], v[88:91], v[192:195], v[24:27]
    ds_read_b128 v[136:139], v1 offset:39936
    v_mov_b32 v13, v245
    v_mfma_f32_16x16x32_bf16 v[52:55], v[88:91], v[196:199], v[52:55]
    ds_read_b128 v[140:143], v1 offset:40960
    v_permlane16_swap_b32 v240, v4
    v_mfma_f32_16x16x32_bf16 v[28:31], v[92:95], v[192:195], v[28:31]
    ds_read_b128 v[144:147], v1 offset:41984
    v_permlane16_swap_b32 v241, v5
    v_mfma_f32_16x16x32_bf16 v[56:59], v[92:95], v[196:199], v[56:59]
    ds_read_b128 v[148:151], v248 offset:3072
    s_waitcnt lgkmcnt(8)
    v_mfma_f32_16x16x32_bf16 v[32:35], v[192:195], v[96:99], v[32:35]
    ds_read_b128 v[152:155], v249 offset:21504
    v_permlane16_swap_b32 v242, v8
    v_mfma_f32_16x16x32_bf16 v[60:63], v[196:199], v[96:99], v[60:63]
    ds_read_b128 v[156:159], v251 offset:21504
    v_permlane16_swap_b32 v243, v9
    v_mfma_f32_16x16x32_bf16 v[36:39], v[192:195], v[100:103], v[36:39]
    buffer_load_dwordx4 v[184:187], v1, s[4:7], s40 offen offset:1024 sc1
    v_mfma_f32_16x16x32_bf16 v[64:67], v[196:199], v[100:103], v[64:67]
    buffer_load_dwordx4 v[188:191], v253, s[4:7], s40 offen offset:1024 sc1
    v_mfma_f32_16x16x32_bf16 v[40:43], v[104:107], v[192:195], v[40:43]
    v_permlane16_swap_b32 v244, v12
    v_mfma_f32_16x16x32_bf16 v[68:71], v[104:107], v[196:199], v[68:71]
    v_permlane16_swap_b32 v245, v13
    v_mfma_f32_16x16x32_bf16 v[72:75], v[112:115], v[108:111], v[72:75]
    v_add_f32 v240, v240, v4
    v_add_f32 v241, v241, v5
    v_mfma_f32_16x16x32_bf16 v[76:79], v[108:111], v[116:119], v[76:79]
    v_add_f32 v242, v242, v8
    s_waitcnt vmcnt(8) lgkmcnt(6)
    s_barrier
    v_mfma_f32_16x16x32_bf16 v[16:19], v[120:123], v[200:203], v[16:19]
    ds_read_b128 v[80:83], v1 offset:43008
    v_mfma_f32_16x16x32_bf16 v[44:47], v[120:123], v[204:207], v[44:47]
    ds_read_b128 v[84:87], v1 offset:44032
    v_add_f32 v243, v243, v9
    v_mfma_f32_16x16x32_bf16 v[20:23], v[124:127], v[200:203], v[20:23]
    ds_read_b128 v[88:91], v1 offset:45056
    v_add_f32 v244, v244, v12
    v_mfma_f32_16x16x32_bf16 v[48:51], v[124:127], v[204:207], v[48:51]
    ds_read_b128 v[92:95], v1 offset:46080
    v_add_f32 v245, v245, v13
    v_mfma_f32_16x16x32_bf16 v[24:27], v[128:131], v[200:203], v[24:27]
    ds_read_b128 v[96:99], v1 offset:47104
    v_mul_f32 v240, 0x3ae38e39, v240
    v_mfma_f32_16x16x32_bf16 v[52:55], v[128:131], v[204:207], v[52:55]
    ds_read_b128 v[100:103], v1 offset:48128
    v_mul_f32 v241, 0x3ae38e39, v241
    v_mfma_f32_16x16x32_bf16 v[28:31], v[132:135], v[200:203], v[28:31]
    ds_read_b128 v[104:107], v1 offset:49152
    v_mul_f32 v242, 0x3ae38e39, v242
    v_mfma_f32_16x16x32_bf16 v[56:59], v[132:135], v[204:207], v[56:59]
    ds_read_b128 v[108:111], v248 offset:4096
    s_waitcnt lgkmcnt(8)
    v_mfma_f32_16x16x32_bf16 v[32:35], v[200:203], v[136:139], v[32:35]
    ds_read_b128 v[112:115], v249 offset:28672
    v_mul_f32 v243, 0x3ae38e39, v243
    v_mfma_f32_16x16x32_bf16 v[60:63], v[204:207], v[136:139], v[60:63]
    ds_read_b128 v[116:119], v251 offset:28672
    v_mul_f32 v244, 0x3ae38e39, v244
    v_mfma_f32_16x16x32_bf16 v[36:39], v[200:203], v[140:143], v[36:39]
    buffer_load_dwordx4 v[192:195], v1, s[4:7], s40 offen offset:2048 sc1
    v_mfma_f32_16x16x32_bf16 v[64:67], v[204:207], v[140:143], v[64:67]
    buffer_load_dwordx4 v[196:199], v253, s[4:7], s40 offen offset:2048 sc1
    v_mfma_f32_16x16x32_bf16 v[40:43], v[144:147], v[200:203], v[40:43]
    v_mul_f32 v245, 0x3ae38e39, v245
    v_mfma_f32_16x16x32_bf16 v[68:71], v[144:147], v[204:207], v[68:71]
    v_fma_f32 v241, -v240, v240, v241
    v_mfma_f32_16x16x32_bf16 v[72:75], v[152:155], v[148:151], v[72:75]
    v_fma_f32 v243, -v242, v242, v243
    v_fma_f32 v245, -v244, v244, v245
    v_mfma_f32_16x16x32_bf16 v[76:79], v[148:151], v[156:159], v[76:79]
    v_max_f32 v241, 0, v241
    s_waitcnt vmcnt(8) lgkmcnt(6)
    v_mfma_f32_16x16x32_bf16 v[16:19], v[80:83], v[160:163], v[16:19]
    ds_read_b128 v[120:123], v1 offset:50176
    v_mfma_f32_16x16x32_bf16 v[44:47], v[80:83], v[164:167], v[44:47]
    ds_read_b128 v[124:127], v1 offset:51200
    v_max_f32 v243, 0, v243
    v_mfma_f32_16x16x32_bf16 v[20:23], v[84:87], v[160:163], v[20:23]
    ds_read_b128 v[128:131], v1 offset:52224
    v_max_f32 v245, 0, v245
    v_mfma_f32_16x16x32_bf16 v[48:51], v[84:87], v[164:167], v[48:51]
    ds_read_b128 v[132:135], v1 offset:53248
    v_add_f32 v241, 0x3727c5ac, v241
    v_mfma_f32_16x16x32_bf16 v[24:27], v[88:91], v[160:163], v[24:27]
    ds_read_b128 v[136:139], v1 offset:54272
    v_add_f32 v243, 0x3727c5ac, v243
    v_mfma_f32_16x16x32_bf16 v[52:55], v[88:91], v[164:167], v[52:55]
    ds_read_b128 v[140:143], v1 offset:55296
    v_add_f32 v245, 0x3727c5ac, v245
    v_mfma_f32_16x16x32_bf16 v[28:31], v[92:95], v[160:163], v[28:31]
    ds_read_b128 v[144:147], v1 offset:56320
    v_rsq_f32 v241, v241
    v_mfma_f32_16x16x32_bf16 v[56:59], v[92:95], v[164:167], v[56:59]
    ds_read_b128 v[148:151], v248 offset:5120
    s_waitcnt lgkmcnt(8)
    v_mfma_f32_16x16x32_bf16 v[32:35], v[160:163], v[96:99], v[32:35]
    ds_read_b128 v[152:155], v249 offset:35840
    v_rsq_f32 v243, v243
    v_mfma_f32_16x16x32_bf16 v[60:63], v[164:167], v[96:99], v[60:63]
    ds_read_b128 v[156:159], v251 offset:35840
    v_rsq_f32 v245, v245
    v_mfma_f32_16x16x32_bf16 v[36:39], v[160:163], v[100:103], v[36:39]
    buffer_load_dwordx4 v[200:203], v1, s[4:7], s40 offen offset:3072 sc1
    v_mfma_f32_16x16x32_bf16 v[64:67], v[164:167], v[100:103], v[64:67]
    buffer_load_dwordx4 v[204:207], v253, s[4:7], s40 offen offset:3072 sc1
    v_mfma_f32_16x16x32_bf16 v[40:43], v[104:107], v[160:163], v[40:43]
    s_nop 0
    v_mfma_f32_16x16x32_bf16 v[68:71], v[104:107], v[164:167], v[68:71]
    v_lshlrev_b32 v255, 4, v3
    v_mfma_f32_16x16x32_bf16 v[72:75], v[112:115], v[108:111], v[72:75]
    v_add_u32 v236, 161792, v255
    s_lshl_b32 s36, s33, 6
    v_mfma_f32_16x16x32_bf16 v[76:79], v[108:111], v[116:119], v[76:79]
    v_add_u32 v237, s36, v236
    s_waitcnt vmcnt(8) lgkmcnt(6)
    v_mfma_f32_16x16x32_bf16 v[16:19], v[120:123], v[168:171], v[16:19]
    ds_read_b128 v[80:83], v1 offset:57344
    v_mfma_f32_16x16x32_bf16 v[44:47], v[120:123], v[172:175], v[44:47]
    ds_read_b128 v[84:87], v1 offset:58368
    v_lshlrev_b32 v254, 2, v2
    v_mfma_f32_16x16x32_bf16 v[20:23], v[124:127], v[168:171], v[20:23]
    ds_read_b128 v[88:91], v1 offset:59392
    v_add_u32 v238, 161792, v254
    v_mfma_f32_16x16x32_bf16 v[48:51], v[124:127], v[172:175], v[48:51]
    ds_read_b128 v[92:95], v1 offset:60416
    s_lshl_b32 s37, s34, 6
    v_mfma_f32_16x16x32_bf16 v[24:27], v[128:131], v[168:171], v[24:27]
    ds_read_b128 v[96:99], v1 offset:61440
    v_add_u32 v239, s37, v238
    v_mfma_f32_16x16x32_bf16 v[52:55], v[128:131], v[172:175], v[52:55]
    ds_read_b128 v[100:103], v1 offset:62464
    s_mul_i32 s36, s20, 3072
    v_mfma_f32_16x16x32_bf16 v[28:31], v[132:135], v[168:171], v[28:31]
    ds_read_b128 v[104:107], v1 offset:63488
    s_add_u32 s36, s36, 153600
    v_mfma_f32_16x16x32_bf16 v[56:59], v[132:135], v[172:175], v[56:59]
    ds_read_b128 v[108:111], v248 offset:6144
    s_waitcnt lgkmcnt(8)
    v_mfma_f32_16x16x32_bf16 v[32:35], v[168:171], v[136:139], v[32:35]
    ds_read_b128 v[112:115], v249 offset:43008
    v_add_u32 v254, s36, v254
    v_mfma_f32_16x16x32_bf16 v[60:63], v[172:175], v[136:139], v[60:63]
    ds_read_b128 v[116:119], v251 offset:43008
    v_add_u32 v255, s36, v255
    v_mfma_f32_16x16x32_bf16 v[36:39], v[168:171], v[140:143], v[36:39]
    buffer_load_dwordx4 v[160:163], v1, s[4:7], s41 offen offset:0 sc1
    v_mfma_f32_16x16x32_bf16 v[64:67], v[172:175], v[140:143], v[64:67]
    buffer_load_dwordx4 v[164:167], v253, s[4:7], s41 offen offset:0 sc1
    v_mfma_f32_16x16x32_bf16 v[40:43], v[144:147], v[168:171], v[40:43]
    v_mfma_f32_16x16x32_bf16 v[68:71], v[144:147], v[172:175], v[68:71]
    ds_write2_b32 v254, v240, v241 offset0:0 offset1:16
    v_mfma_f32_16x16x32_bf16 v[72:75], v[152:155], v[148:151], v[72:75]
    ds_write2_b32 v254, v242, v243 offset0:32 offset1:48
    v_mfma_f32_16x16x32_bf16 v[76:79], v[148:151], v[156:159], v[76:79]
    ds_write2_b32 v254, v244, v245 offset0:64 offset1:80
    s_waitcnt vmcnt(8) lgkmcnt(9)
    s_barrier
    v_mfma_f32_16x16x32_bf16 v[16:19], v[80:83], v[176:179], v[16:19]
    ds_read_b128 v[120:123], v247 offset:0
    v_mfma_f32_16x16x32_bf16 v[44:47], v[80:83], v[180:183], v[44:47]
    ds_read_b128 v[124:127], v247 offset:1024
    v_mfma_f32_16x16x32_bf16 v[20:23], v[84:87], v[176:179], v[20:23]
    ds_read_b128 v[128:131], v247 offset:2048
    v_mfma_f32_16x16x32_bf16 v[48:51], v[84:87], v[180:183], v[48:51]
    ds_read_b128 v[132:135], v247 offset:3072
    v_mfma_f32_16x16x32_bf16 v[24:27], v[88:91], v[176:179], v[24:27]
    ds_read_b128 v[136:139], v247 offset:4096
    v_mfma_f32_16x16x32_bf16 v[52:55], v[88:91], v[180:183], v[52:55]
    ds_read_b128 v[140:143], v247 offset:5120
    v_mfma_f32_16x16x32_bf16 v[28:31], v[92:95], v[176:179], v[28:31]
    ds_read_b128 v[144:147], v247 offset:6144
    v_mfma_f32_16x16x32_bf16 v[56:59], v[92:95], v[180:183], v[56:59]
    ds_read_b128 v[148:151], v248 offset:7168
    s_waitcnt lgkmcnt(8)
    v_mfma_f32_16x16x32_bf16 v[32:35], v[176:179], v[96:99], v[32:35]
    ds_read_b128 v[152:155], v249 offset:50176
    v_mfma_f32_16x16x32_bf16 v[60:63], v[180:183], v[96:99], v[60:63]
    ds_read_b128 v[156:159], v251 offset:50176
    v_mfma_f32_16x16x32_bf16 v[36:39], v[176:179], v[100:103], v[36:39]
    buffer_load_dwordx4 v[168:171], v1, s[4:7], s41 offen offset:1024 sc1
    ds_read_b128 v[208:211], v236 offset:0
    v_mfma_f32_16x16x32_bf16 v[64:67], v[180:183], v[100:103], v[64:67]
    buffer_load_dwordx4 v[172:175], v253, s[4:7], s41 offen offset:1024 sc1
    ds_read_b128 v[212:215], v236 offset:64
    v_mfma_f32_16x16x32_bf16 v[40:43], v[104:107], v[176:179], v[40:43]
    ds_read_b128 v[216:219], v236 offset:128
    v_mfma_f32_16x16x32_bf16 v[68:71], v[104:107], v[180:183], v[68:71]
    ds_read_b128 v[220:223], v236 offset:192
    v_mfma_f32_16x16x32_bf16 v[72:75], v[112:115], v[108:111], v[72:75]
    ds_read_b128 v[224:227], v236 offset:384
    v_mfma_f32_16x16x32_bf16 v[76:79], v[108:111], v[116:119], v[76:79]
    ds_read_b128 v[228:231], v237
    s_waitcnt vmcnt(8) lgkmcnt(12)
    v_mfma_f32_16x16x32_bf16 v[16:19], v[120:123], v[184:187], v[16:19]
    ds_read_b128 v[80:83], v247 offset:7168
    v_mfma_f32_16x16x32_bf16 v[44:47], v[120:123], v[188:191], v[44:47]
    ds_read_b128 v[84:87], v247 offset:8192
    v_mfma_f32_16x16x32_bf16 v[20:23], v[124:127], v[184:187], v[20:23]
    ds_read_b128 v[88:91], v247 offset:9216
    v_mfma_f32_16x16x32_bf16 v[48:51], v[124:127], v[188:191], v[48:51]
    ds_read_b128 v[92:95], v247 offset:10240
    v_mfma_f32_16x16x32_bf16 v[24:27], v[128:131], v[184:187], v[24:27]
    ds_read_b128 v[96:99], v247 offset:11264
    v_mfma_f32_16x16x32_bf16 v[52:55], v[128:131], v[188:191], v[52:55]
    ds_read_b128 v[100:103], v247 offset:12288
    v_mfma_f32_16x16x32_bf16 v[28:31], v[132:135], v[184:187], v[28:31]
    ds_read_b128 v[104:107], v247 offset:13312
    v_mfma_f32_16x16x32_bf16 v[56:59], v[132:135], v[188:191], v[56:59]
    ds_read_b128 v[108:111], v248 offset:8192
    s_waitcnt lgkmcnt(8)
    v_mfma_f32_16x16x32_bf16 v[32:35], v[184:187], v[136:139], v[32:35]
    ds_read_b128 v[112:115], v249 offset:57344
    v_mfma_f32_16x16x32_bf16 v[60:63], v[188:191], v[136:139], v[60:63]
    ds_read_b128 v[116:119], v251 offset:57344
    v_mfma_f32_16x16x32_bf16 v[36:39], v[184:187], v[140:143], v[36:39]
    buffer_load_dwordx4 v[176:179], v1, s[4:7], s41 offen offset:2048 sc1
    v_mfma_f32_16x16x32_bf16 v[64:67], v[188:191], v[140:143], v[64:67]
    buffer_load_dwordx4 v[180:183], v253, s[4:7], s41 offen offset:2048 sc1
    ds_read2_b32 v[232:233], v238 offset0:64 offset1:80
    v_mfma_f32_16x16x32_bf16 v[40:43], v[144:147], v[184:187], v[40:43]
    ds_read_b32 v234, v239
    v_mfma_f32_16x16x32_bf16 v[68:71], v[144:147], v[188:191], v[68:71]
    ds_read_b128 v[4:7], v255 offset:0
    v_mfma_f32_16x16x32_bf16 v[72:75], v[152:155], v[148:151], v[72:75]
    ds_read_b128 v[8:11], v255 offset:128
    v_mfma_f32_16x16x32_bf16 v[76:79], v[148:151], v[156:159], v[76:79]
    ds_read_b128 v[12:15], v255 offset:256
    s_waitcnt vmcnt(8) lgkmcnt(11)
    s_barrier
    v_mfma_f32_16x16x32_bf16 v[16:19], v[80:83], v[192:195], v[16:19]
    ds_read_b128 v[120:123], v247 offset:14336
    v_mfma_f32_16x16x32_bf16 v[44:47], v[80:83], v[196:199], v[44:47]
    ds_read_b128 v[124:127], v247 offset:15360
    v_mfma_f32_16x16x32_bf16 v[20:23], v[84:87], v[192:195], v[20:23]
    ds_read_b128 v[128:131], v247 offset:16384
    v_mfma_f32_16x16x32_bf16 v[48:51], v[84:87], v[196:199], v[48:51]
    ds_read_b128 v[132:135], v247 offset:17408
    v_mfma_f32_16x16x32_bf16 v[24:27], v[88:91], v[192:195], v[24:27]
    ds_read_b128 v[136:139], v247 offset:18432
    v_mfma_f32_16x16x32_bf16 v[52:55], v[88:91], v[196:199], v[52:55]
    ds_read_b128 v[140:143], v247 offset:19456
    v_mfma_f32_16x16x32_bf16 v[28:31], v[92:95], v[192:195], v[28:31]
    ds_read_b128 v[144:147], v247 offset:20480
    v_mfma_f32_16x16x32_bf16 v[56:59], v[92:95], v[196:199], v[56:59]
    ds_read_b128 v[148:151], v248 offset:9216
    s_waitcnt lgkmcnt(8)
    v_mfma_f32_16x16x32_bf16 v[32:35], v[192:195], v[96:99], v[32:35]
    ds_read_b128 v[152:155], v250 offset:0
    v_mfma_f32_16x16x32_bf16 v[60:63], v[196:199], v[96:99], v[60:63]
    ds_read_b128 v[156:159], v252 offset:0
    v_mfma_f32_16x16x32_bf16 v[36:39], v[192:195], v[100:103], v[36:39]
    buffer_load_dwordx4 v[184:187], v1, s[4:7], s41 offen offset:3072 sc1
    v_mfma_f32_16x16x32_bf16 v[64:67], v[196:199], v[100:103], v[64:67]
    buffer_load_dwordx4 v[188:191], v253, s[4:7], s41 offen offset:3072 sc1
    v_mfma_f32_16x16x32_bf16 v[40:43], v[104:107], v[192:195], v[40:43]
    v_mfma_f32_16x16x32_bf16 v[68:71], v[104:107], v[196:199], v[68:71]
    v_mfma_f32_16x16x32_bf16 v[72:75], v[112:115], v[108:111], v[72:75]
    v_mfma_f32_16x16x32_bf16 v[76:79], v[108:111], v[116:119], v[76:79]
    s_waitcnt vmcnt(8) lgkmcnt(6)
    v_mfma_f32_16x16x32_bf16 v[16:19], v[120:123], v[200:203], v[16:19]
    ds_read_b128 v[80:83], v247 offset:21504
    v_fma_f32 v32, -v8, v232, v32
    v_mfma_f32_16x16x32_bf16 v[44:47], v[120:123], v[204:207], v[44:47]
    ds_read_b128 v[84:87], v247 offset:22528
    v_fma_f32 v60, -v12, v232, v60
    v_mfma_f32_16x16x32_bf16 v[20:23], v[124:127], v[200:203], v[20:23]
    ds_read_b128 v[88:91], v247 offset:23552
    v_fma_f32 v36, -v8, v233, v36
    v_mfma_f32_16x16x32_bf16 v[48:51], v[124:127], v[204:207], v[48:51]
    ds_read_b128 v[92:95], v247 offset:24576
    v_fma_f32 v64, -v12, v233, v64
    v_mfma_f32_16x16x32_bf16 v[24:27], v[128:131], v[200:203], v[24:27]
    ds_read_b128 v[96:99], v247 offset:25600
    v_fma_f32 v40, -v242, v224, v40
    v_mfma_f32_16x16x32_bf16 v[52:55], v[128:131], v[204:207], v[52:55]
    ds_read_b128 v[100:103], v247 offset:26624
    v_fma_f32 v68, -v244, v224, v68
    v_mfma_f32_16x16x32_bf16 v[28:31], v[132:135], v[200:203], v[28:31]
    ds_read_b128 v[104:107], v247 offset:27648
    v_fma_f32 v72, -v240, v228, v72
    v_mfma_f32_16x16x32_bf16 v[56:59], v[132:135], v[204:207], v[56:59]
    ds_read_b128 v[108:111], v248 offset:10240
    s_waitcnt lgkmcnt(8)
    v_fma_f32 v76, -v4, v234, v76
    v_mfma_f32_16x16x32_bf16 v[32:35], v[200:203], v[136:139], v[32:35]
    ds_read_b128 v[112:115], v250 offset:7168
    v_fma_f32 v16, -v242, v208, v16
    v_mfma_f32_16x16x32_bf16 v[60:63], v[204:207], v[136:139], v[60:63]
    ds_read_b128 v[116:119], v252 offset:7168
    v_fma_f32 v44, -v244, v208, v44
    v_mfma_f32_16x16x32_bf16 v[36:39], v[200:203], v[140:143], v[36:39]
    buffer_load_dwordx4 v[192:195], v1, s[4:7], s42 offen offset:0 sc1
    v_fma_f32 v20, -v242, v212, v20
    v_mfma_f32_16x16x32_bf16 v[64:67], v[204:207], v[140:143], v[64:67]
    buffer_load_dwordx4 v[196:199], v253, s[4:7], s42 offen offset:0 sc1
    v_fma_f32 v48, -v244, v212, v48
    v_mfma_f32_16x16x32_bf16 v[40:43], v[144:147], v[200:203], v[40:43]
    v_fma_f32 v24, -v242, v216, v24
    v_mfma_f32_16x16x32_bf16 v[68:71], v[144:147], v[204:207], v[68:71]
    v_fma_f32 v52, -v244, v216, v52
    v_mfma_f32_16x16x32_bf16 v[72:75], v[152:155], v[148:151], v[72:75]
    v_fma_f32 v28, -v242, v220, v28
    v_mfma_f32_16x16x32_bf16 v[76:79], v[148:151], v[156:159], v[76:79]
    v_fma_f32 v56, -v244, v220, v56
    s_waitcnt vmcnt(8) lgkmcnt(6)
    s_barrier
    v_mfma_f32_16x16x32_bf16 v[16:19], v[80:83], v[160:163], v[16:19]
    ds_read_b128 v[120:123], v247 offset:28672
    v_fma_f32 v33, -v9, v232, v33
    v_mfma_f32_16x16x32_bf16 v[44:47], v[80:83], v[164:167], v[44:47]
    ds_read_b128 v[124:127], v247 offset:29696
    v_fma_f32 v61, -v13, v232, v61
    v_mfma_f32_16x16x32_bf16 v[20:23], v[84:87], v[160:163], v[20:23]
    ds_read_b128 v[128:131], v247 offset:30720
    v_fma_f32 v37, -v9, v233, v37
    v_mfma_f32_16x16x32_bf16 v[48:51], v[84:87], v[164:167], v[48:51]
    ds_read_b128 v[132:135], v247 offset:31744
    v_fma_f32 v65, -v13, v233, v65
    v_mfma_f32_16x16x32_bf16 v[24:27], v[88:91], v[160:163], v[24:27]
    ds_read_b128 v[136:139], v247 offset:32768
    v_fma_f32 v41, -v242, v225, v41
    v_mfma_f32_16x16x32_bf16 v[52:55], v[88:91], v[164:167], v[52:55]
    ds_read_b128 v[140:143], v247 offset:33792
    v_fma_f32 v69, -v244, v225, v69
    v_mfma_f32_16x16x32_bf16 v[28:31], v[92:95], v[160:163], v[28:31]
    ds_read_b128 v[144:147], v247 offset:34816
    v_fma_f32 v73, -v240, v229, v73
    v_mfma_f32_16x16x32_bf16 v[56:59], v[92:95], v[164:167], v[56:59]
    ds_read_b128 v[148:151], v248 offset:11264
    s_waitcnt lgkmcnt(8)
    v_fma_f32 v77, -v5, v234, v77
    v_mfma_f32_16x16x32_bf16 v[32:35], v[160:163], v[96:99], v[32:35]
    ds_read_b128 v[152:155], v250 offset:14336
    v_fma_f32 v17, -v242, v209, v17
    v_mfma_f32_16x16x32_bf16 v[60:63], v[164:167], v[96:99], v[60:63]
    ds_read_b128 v[156:159], v252 offset:14336
    v_fma_f32 v45, -v244, v209, v45
    v_mfma_f32_16x16x32_bf16 v[36:39], v[160:163], v[100:103], v[36:39]
    buffer_load_dwordx4 v[200:203], v1, s[4:7], s42 offen offset:1024 sc1
    v_fma_f32 v21, -v242, v213, v21
    v_mfma_f32_16x16x32_bf16 v[64:67], v[164:167], v[100:103], v[64:67]
    buffer_load_dwordx4 v[204:207], v253, s[4:7], s42 offen offset:1024 sc1
    v_fma_f32 v49, -v244, v213, v49
    v_mfma_f32_16x16x32_bf16 v[40:43], v[104:107], v[160:163], v[40:43]
    v_fma_f32 v25, -v242, v217, v25
    v_mfma_f32_16x16x32_bf16 v[68:71], v[104:107], v[164:167], v[68:71]
    v_fma_f32 v53, -v244, v217, v53
    v_mfma_f32_16x16x32_bf16 v[72:75], v[112:115], v[108:111], v[72:75]
    v_fma_f32 v29, -v242, v221, v29
    v_mfma_f32_16x16x32_bf16 v[76:79], v[108:111], v[116:119], v[76:79]
    v_fma_f32 v57, -v244, v221, v57
    s_waitcnt vmcnt(8) lgkmcnt(6)
    v_mfma_f32_16x16x32_bf16 v[16:19], v[120:123], v[168:171], v[16:19]
    ds_read_b128 v[80:83], v247 offset:35840
    v_fma_f32 v34, -v10, v232, v34
    v_mfma_f32_16x16x32_bf16 v[44:47], v[120:123], v[172:175], v[44:47]
    ds_read_b128 v[84:87], v247 offset:36864
    v_fma_f32 v62, -v14, v232, v62
    v_mfma_f32_16x16x32_bf16 v[20:23], v[124:127], v[168:171], v[20:23]
    ds_read_b128 v[88:91], v247 offset:37888
    v_fma_f32 v38, -v10, v233, v38
    v_mfma_f32_16x16x32_bf16 v[48:51], v[124:127], v[172:175], v[48:51]
    ds_read_b128 v[92:95], v247 offset:38912
    v_fma_f32 v66, -v14, v233, v66
    v_mfma_f32_16x16x32_bf16 v[24:27], v[128:131], v[168:171], v[24:27]
    ds_read_b128 v[96:99], v247 offset:39936
    v_fma_f32 v42, -v242, v226, v42
    v_mfma_f32_16x16x32_bf16 v[52:55], v[128:131], v[172:175], v[52:55]
    ds_read_b128 v[100:103], v247 offset:40960
    v_fma_f32 v70, -v244, v226, v70
    v_mfma_f32_16x16x32_bf16 v[28:31], v[132:135], v[168:171], v[28:31]
    ds_read_b128 v[104:107], v247 offset:41984
    v_fma_f32 v74, -v240, v230, v74
    v_mfma_f32_16x16x32_bf16 v[56:59], v[132:135], v[172:175], v[56:59]
    ds_read_b128 v[108:111], v248 offset:12288
    s_waitcnt lgkmcnt(8)
    v_fma_f32 v78, -v6, v234, v78
    v_mfma_f32_16x16x32_bf16 v[32:35], v[168:171], v[136:139], v[32:35]
    ds_read_b128 v[112:115], v250 offset:21504
    v_fma_f32 v18, -v242, v210, v18
    v_mfma_f32_16x16x32_bf16 v[60:63], v[172:175], v[136:139], v[60:63]
    ds_read_b128 v[116:119], v252 offset:21504
    v_fma_f32 v46, -v244, v210, v46
    v_mfma_f32_16x16x32_bf16 v[36:39], v[168:171], v[140:143], v[36:39]
    v_fma_f32 v22, -v242, v214, v22
    v_mfma_f32_16x16x32_bf16 v[64:67], v[172:175], v[140:143], v[64:67]
    v_fma_f32 v50, -v244, v214, v50
    v_mfma_f32_16x16x32_bf16 v[40:43], v[144:147], v[168:171], v[40:43]
    v_fma_f32 v26, -v242, v218, v26
    v_mfma_f32_16x16x32_bf16 v[68:71], v[144:147], v[172:175], v[68:71]
    v_fma_f32 v54, -v244, v218, v54
    v_mfma_f32_16x16x32_bf16 v[72:75], v[152:155], v[148:151], v[72:75]
    v_fma_f32 v30, -v242, v222, v30
    v_mfma_f32_16x16x32_bf16 v[76:79], v[148:151], v[156:159], v[76:79]
    v_fma_f32 v58, -v244, v222, v58
    s_waitcnt vmcnt(6) lgkmcnt(6)
    v_mfma_f32_16x16x32_bf16 v[16:19], v[80:83], v[176:179], v[16:19]
    ds_read_b128 v[120:123], v247 offset:43008
    v_fma_f32 v35, -v11, v232, v35
    v_mfma_f32_16x16x32_bf16 v[44:47], v[80:83], v[180:183], v[44:47]
    ds_read_b128 v[124:127], v247 offset:44032
    v_fma_f32 v63, -v15, v232, v63
    v_mfma_f32_16x16x32_bf16 v[20:23], v[84:87], v[176:179], v[20:23]
    ds_read_b128 v[128:131], v247 offset:45056
    v_fma_f32 v39, -v11, v233, v39
    v_mfma_f32_16x16x32_bf16 v[48:51], v[84:87], v[180:183], v[48:51]
    ds_read_b128 v[132:135], v247 offset:46080
    v_fma_f32 v67, -v15, v233, v67
    v_mfma_f32_16x16x32_bf16 v[24:27], v[88:91], v[176:179], v[24:27]
    ds_read_b128 v[136:139], v247 offset:47104
    v_fma_f32 v43, -v242, v227, v43
    v_mfma_f32_16x16x32_bf16 v[52:55], v[88:91], v[180:183], v[52:55]
    ds_read_b128 v[140:143], v247 offset:48128
    v_fma_f32 v71, -v244, v227, v71
    v_mfma_f32_16x16x32_bf16 v[28:31], v[92:95], v[176:179], v[28:31]
    ds_read_b128 v[144:147], v247 offset:49152
    v_fma_f32 v75, -v240, v231, v75
    v_mfma_f32_16x16x32_bf16 v[56:59], v[92:95], v[180:183], v[56:59]
    ds_read_b128 v[148:151], v248 offset:13312
    s_waitcnt lgkmcnt(8)
    v_fma_f32 v79, -v7, v234, v79
    v_mfma_f32_16x16x32_bf16 v[32:35], v[176:179], v[96:99], v[32:35]
    ds_read_b128 v[152:155], v250 offset:28672
    v_fma_f32 v19, -v242, v211, v19
    v_mfma_f32_16x16x32_bf16 v[60:63], v[180:183], v[96:99], v[60:63]
    ds_read_b128 v[156:159], v252 offset:28672
    v_fma_f32 v47, -v244, v211, v47
    v_mfma_f32_16x16x32_bf16 v[36:39], v[176:179], v[100:103], v[36:39]
    v_fma_f32 v23, -v242, v215, v23
    v_mfma_f32_16x16x32_bf16 v[64:67], v[180:183], v[100:103], v[64:67]
    v_fma_f32 v51, -v244, v215, v51
    v_mfma_f32_16x16x32_bf16 v[40:43], v[104:107], v[176:179], v[40:43]
    v_fma_f32 v27, -v242, v219, v27
    v_mfma_f32_16x16x32_bf16 v[68:71], v[104:107], v[180:183], v[68:71]
    v_fma_f32 v55, -v244, v219, v55
    v_mfma_f32_16x16x32_bf16 v[72:75], v[112:115], v[108:111], v[72:75]
    v_fma_f32 v31, -v242, v223, v31
    v_mfma_f32_16x16x32_bf16 v[76:79], v[108:111], v[116:119], v[76:79]
    v_fma_f32 v59, -v244, v223, v59
    s_waitcnt vmcnt(4) lgkmcnt(6)
    s_barrier
    v_mfma_f32_16x16x32_bf16 v[16:19], v[120:123], v[184:187], v[16:19]
    ds_read_b128 v[80:83], v247 offset:50176
    v_mfma_f32_16x16x32_bf16 v[44:47], v[120:123], v[188:191], v[44:47]
    ds_read_b128 v[84:87], v247 offset:51200
    v_and_b32 v4, 1, v2
    v_mfma_f32_16x16x32_bf16 v[20:23], v[124:127], v[184:187], v[20:23]
    ds_read_b128 v[88:91], v247 offset:52224
    v_lshl_add_u32 v5, v3, 2, v4
    v_mfma_f32_16x16x32_bf16 v[48:51], v[124:127], v[188:191], v[48:51]
    ds_read_b128 v[92:95], v247 offset:53248
    v_add_u32 v6, 2, v5
    v_mfma_f32_16x16x32_bf16 v[24:27], v[128:131], v[184:187], v[24:27]
    ds_read_b128 v[96:99], v247 offset:54272
    v_cmp_eq_u32 s[40:41], 1, v4
    v_mfma_f32_16x16x32_bf16 v[52:55], v[128:131], v[188:191], v[52:55]
    ds_read_b128 v[100:103], v247 offset:55296
    v_cmp_le_u32 s[42:43], v5, v2
    v_mfma_f32_16x16x32_bf16 v[28:31], v[132:135], v[184:187], v[28:31]
    ds_read_b128 v[104:107], v247 offset:56320
    v_cmp_le_u32 s[44:45], v6, v2
    v_mfma_f32_16x16x32_bf16 v[56:59], v[132:135], v[188:191], v[56:59]
    ds_read_b128 v[108:111], v248 offset:14336
    s_waitcnt lgkmcnt(8)
    v_mfma_f32_16x16x32_bf16 v[32:35], v[184:187], v[136:139], v[32:35]
    ds_read_b128 v[112:115], v250 offset:35840
    v_mov_b32 v4, 0x0c0c0100
    v_mfma_f32_16x16x32_bf16 v[60:63], v[188:191], v[136:139], v[60:63]
    ds_read_b128 v[116:119], v252 offset:35840
    v_mov_b32 v5, 0x01000c0c
    v_mfma_f32_16x16x32_bf16 v[36:39], v[184:187], v[140:143], v[36:39]
    v_mov_b32 v6, 0x0c0c0302
    v_mov_b32 v7, 0x03020c0c
    v_mfma_f32_16x16x32_bf16 v[64:67], v[188:191], v[140:143], v[64:67]
    v_mov_b32 v8, 0x0c0c0c0c
    v_cndmask_b32 v4, v4, v5, s[40:41]
    v_mfma_f32_16x16x32_bf16 v[40:43], v[144:147], v[184:187], v[40:43]
    v_cndmask_b32 v6, v6, v7, s[40:41]
    v_cndmask_b32 v12, v4, v8, s[42:43]
    v_mfma_f32_16x16x32_bf16 v[68:71], v[144:147], v[188:191], v[68:71]
    v_cndmask_b32 v13, v6, v8, s[44:45]
    v_cndmask_b32 v14, v8, v4, s[42:43]
    v_mfma_f32_16x16x32_bf16 v[72:75], v[152:155], v[148:151], v[72:75]
    v_cndmask_b32 v15, v8, v6, s[44:45]
    s_cmp_eq_u32 s31, 0
    v_mfma_f32_16x16x32_bf16 v[76:79], v[148:151], v[156:159], v[76:79]
    s_cselect_b64 s[48:49], s[42:43], -1
    s_cselect_b64 s[38:39], s[44:45], -1
    s_waitcnt vmcnt(2) lgkmcnt(6)
    v_mfma_f32_16x16x32_bf16 v[16:19], v[80:83], v[192:195], v[16:19]
    ds_read_b128 v[120:123], v247 offset:57344
    v_mfma_f32_16x16x32_bf16 v[44:47], v[80:83], v[196:199], v[44:47]
    ds_read_b128 v[124:127], v247 offset:58368
    s_mul_i32 s36, s20, 3072
    v_mfma_f32_16x16x32_bf16 v[20:23], v[84:87], v[192:195], v[20:23]
    ds_read_b128 v[128:131], v247 offset:59392
    s_add_u32 s36, s36, 149504
    v_mfma_f32_16x16x32_bf16 v[48:51], v[84:87], v[196:199], v[48:51]
    ds_read_b128 v[132:135], v247 offset:60416
    v_add_u32 v9, s36, v0
    v_mfma_f32_16x16x32_bf16 v[24:27], v[88:91], v[192:195], v[24:27]
    ds_read_b128 v[136:139], v247 offset:61440
    s_lshl_b32 s37, s20, 9
    v_mfma_f32_16x16x32_bf16 v[52:55], v[88:91], v[196:199], v[52:55]
    ds_read_b128 v[140:143], v247 offset:62464
    s_add_u32 s37, s37, 149504
    v_mfma_f32_16x16x32_bf16 v[28:31], v[92:95], v[192:195], v[28:31]
    ds_read_b128 v[144:147], v247 offset:63488
    v_add_u32 v10, s37, v0
    v_mfma_f32_16x16x32_bf16 v[56:59], v[92:95], v[196:199], v[56:59]
    ds_read_b128 v[148:151], v248 offset:15360
    s_waitcnt lgkmcnt(8)
    v_mfma_f32_16x16x32_bf16 v[32:35], v[192:195], v[96:99], v[32:35]
    ds_read_b128 v[152:155], v250 offset:43008
    v_lshlrev_b32 v4, 2, v3
    v_mfma_f32_16x16x32_bf16 v[60:63], v[196:199], v[96:99], v[60:63]
    ds_read_b128 v[156:159], v252 offset:43008
    v_sub_u32 v4, v2, v4
    v_mfma_f32_16x16x32_bf16 v[36:39], v[192:195], v[100:103], v[36:39]
    v_lshlrev_b32 v5, 4, v4
    v_lshrrev_b32 v4, 1, v4
    v_mfma_f32_16x16x32_bf16 v[64:67], v[196:199], v[100:103], v[64:67]
    v_mov_b32 v6, 0x3f80
    v_lshlrev_b32 v5, v5, v6
    v_mfma_f32_16x16x32_bf16 v[40:43], v[104:107], v[192:195], v[40:43]
    v_cmp_eq_u32 vcc, 0, v4
    v_cmp_eq_u32 s[46:47], 1, v4
    v_mfma_f32_16x16x32_bf16 v[68:71], v[104:107], v[196:199], v[68:71]
    ds_read_b128 v[208:211], v255 offset:64
    s_lshl_b32 s36, s24, 10
    v_add_u32 v4, s36, v1
    v_mfma_f32_16x16x32_bf16 v[72:75], v[112:115], v[108:111], v[72:75]
    ds_read_b128 v[212:215], v255 offset:192
    v_cndmask_b32 v234, 0, v5, vcc
    v_cndmask_b32 v235, 0, v5, s[46:47]
    v_mfma_f32_16x16x32_bf16 v[76:79], v[108:111], v[116:119], v[76:79]
    ds_read_b128 v[216:219], v255 offset:320
    v_add_u32 v5, 18432, v4
    s_lshl_b32 s36, s24, 7
    s_waitcnt vmcnt(0) lgkmcnt(9)
    v_mfma_f32_16x16x32_bf16 v[16:19], v[120:123], v[200:203], v[16:19]
    ds_read_b128 v[80:83], v248 offset:16384
    v_mfma_f32_16x16x32_bf16 v[44:47], v[120:123], v[204:207], v[44:47]
    ds_read_b128 v[84:87], v250 offset:50176
    s_add_u32 s36, s36, 16384
    v_mfma_f32_16x16x32_bf16 v[20:23], v[124:127], v[200:203], v[20:23]
    ds_read_b128 v[88:91], v252 offset:50176
    v_cmp_eq_u32 vcc, 2, v3
    v_mfma_f32_16x16x32_bf16 v[48:51], v[124:127], v[204:207], v[48:51]
    ds_read_b128 v[92:95], v248 offset:17408
    v_lshl_add_u32 v6, v2, 3, s36
    v_mfma_f32_16x16x32_bf16 v[24:27], v[128:131], v[200:203], v[24:27]
    ds_read_b128 v[96:99], v250 offset:57344
    v_bfrev_b32 v7, 1
    v_mfma_f32_16x16x32_bf16 v[52:55], v[128:131], v[204:207], v[52:55]
    ds_read_b128 v[100:103], v252 offset:57344
    v_cndmask_b32 v6, v7, v6, vcc
    v_mfma_f32_16x16x32_bf16 v[28:31], v[132:135], v[200:203], v[28:31]
    v_add_u32 v7, 18432, v6
    v_mov_b32 v106, 0
    v_mfma_f32_16x16x32_bf16 v[56:59], v[132:135], v[204:207], v[56:59]
    s_waitcnt lgkmcnt(6)
    v_mov_b32 v107, 0
    v_mfma_f32_16x16x32_bf16 v[32:35], v[200:203], v[136:139], v[32:35]
    v_mov_b32 v8, 0xf149f2ca
    v_mov_b32 v108, 0
    v_mfma_f32_16x16x32_bf16 v[60:63], v[204:207], v[136:139], v[60:63]
    s_mov_b32 s33, 0x3eae1a93
    v_mov_b32 v109, 0
    v_mfma_f32_16x16x32_bf16 v[36:39], v[200:203], v[140:143], v[36:39]
    v_mov_b32 v236, 0x3f803f80
    v_mov_b32 v237, 0x3f803f80
    v_mfma_f32_16x16x32_bf16 v[64:67], v[204:207], v[140:143], v[64:67]
    v_mov_b32 v238, 0x3f803f80
    v_mov_b32 v239, 0x3f803f80
    v_mfma_f32_16x16x32_bf16 v[40:43], v[144:147], v[200:203], v[40:43]
    v_mov_b32 v114, 0
    v_mfma_f32_16x16x32_bf16 v[68:71], v[144:147], v[204:207], v[68:71]
    v_mov_b32 v115, 0
    v_mfma_f32_16x16x32_bf16 v[72:75], v[152:155], v[148:151], v[72:75]
    v_mov_b32 v116, 0
    v_mfma_f32_16x16x32_bf16 v[76:79], v[148:151], v[156:159], v[76:79]
    v_mov_b32 v117, 0
    s_waitcnt lgkmcnt(0)
    v_mfma_f32_16x16x32_bf16 v[72:75], v[84:87], v[80:83], v[72:75]
    v_mfma_f32_16x16x32_bf16 v[76:79], v[80:83], v[88:91], v[76:79]
    v_mfma_f32_16x16x32_bf16 v[72:75], v[96:99], v[92:95], v[72:75]
    v_mfma_f32_16x16x32_bf16 v[76:79], v[92:95], v[100:103], v[76:79]
    v_pk_mul_f32 v[52:53], v[52:53], v[244:245] op_sel:[0,1] op_sel_hi:[1,1]
    v_pk_mul_f32 v[54:55], v[54:55], v[244:245] op_sel:[0,1] op_sel_hi:[1,1]
    v_pk_mul_f32 v[56:57], v[56:57], v[244:245] op_sel:[0,1] op_sel_hi:[1,1]
    v_pk_mul_f32 v[58:59], v[58:59], v[244:245] op_sel:[0,1] op_sel_hi:[1,1]
    v_pk_mul_f32 v[60:61], v[60:61], v[216:217]
    v_pk_mul_f32 v[62:63], v[62:63], v[218:219]
    v_pk_mul_f32 v[64:65], v[64:65], v[216:217]
    v_pk_mul_f32 v[66:67], v[66:67], v[218:219]
    v_pk_mul_f32 v[68:69], v[68:69], v[244:245] op_sel:[0,1] op_sel_hi:[1,1]
    v_pk_mul_f32 v[70:71], v[70:71], v[244:245] op_sel:[0,1] op_sel_hi:[1,1]
    v_pk_mul_f32 v[72:73], v[72:73], v[240:241] op_sel:[0,1] op_sel_hi:[1,1]
    v_pk_mul_f32 v[74:75], v[74:75], v[240:241] op_sel:[0,1] op_sel_hi:[1,1]
    v_pk_mul_f32 v[76:77], v[76:77], v[208:209]
    v_pk_mul_f32 v[78:79], v[78:79], v[210:211]
    v_cvt_pk_bf16_f32 v172, v52, v53
    v_cvt_pk_bf16_f32 v173, v54, v55
    v_cvt_pk_bf16_f32 v176, v56, v57
    v_cvt_pk_bf16_f32 v177, v58, v59
    v_cvt_pk_bf16_f32 v182, v60, v61
    v_cvt_pk_bf16_f32 v183, v62, v63
    v_cvt_pk_bf16_f32 v188, v64, v65
    v_cvt_pk_bf16_f32 v189, v66, v67
    v_cvt_pk_bf16_f32 v174, v68, v69
    v_cvt_pk_bf16_f32 v175, v70, v71
    v_cvt_pk_bf16_f32 v220, v72, v73
    v_cvt_pk_bf16_f32 v221, v74, v75
    v_cvt_pk_bf16_f32 v222, v76, v77
    v_cvt_pk_bf16_f32 v223, v78, v79
    s_cmp_eq_u32 s20, 3
    s_cbranch_scc1 L_a_nw
    ds_write2st64_b64 v9, v[172:173], v[174:175] offset0:6 offset1:7
    ds_write2st64_b64 v9, v[176:177], v[182:183] offset0:8 offset1:9
    ds_write_b64 v9, v[188:189] offset:5120
    ds_write2st64_b64 v10, v[220:221], v[222:223] offset0:0 offset1:3
L_a_nw:
    v_pk_mul_f32 v[24:25], v[24:25], v[242:243] op_sel:[0,1] op_sel_hi:[1,1]
    v_pk_mul_f32 v[26:27], v[26:27], v[242:243] op_sel:[0,1] op_sel_hi:[1,1]
    v_pk_mul_f32 v[28:29], v[28:29], v[242:243] op_sel:[0,1] op_sel_hi:[1,1]
    v_pk_mul_f32 v[30:31], v[30:31], v[242:243] op_sel:[0,1] op_sel_hi:[1,1]
    v_pk_mul_f32 v[32:33], v[32:33], v[212:213]
    v_pk_mul_f32 v[34:35], v[34:35], v[214:215]
    v_pk_mul_f32 v[36:37], v[36:37], v[212:213]
    v_pk_mul_f32 v[38:39], v[38:39], v[214:215]
    v_pk_mul_f32 v[40:41], v[40:41], v[242:243] op_sel:[0,1] op_sel_hi:[1,1]
    v_pk_mul_f32 v[42:43], v[42:43], v[242:243] op_sel:[0,1] op_sel_hi:[1,1]
    v_cvt_pk_bf16_f32 v166, v24, v25
    v_cvt_pk_bf16_f32 v167, v26, v27
    v_cvt_pk_bf16_f32 v170, v28, v29
    v_cvt_pk_bf16_f32 v171, v30, v31
    v_cvt_pk_bf16_f32 v180, v32, v33
    v_cvt_pk_bf16_f32 v181, v34, v35
    v_cvt_pk_bf16_f32 v186, v36, v37
    v_cvt_pk_bf16_f32 v187, v38, v39
    v_cvt_pk_bf16_f32 v168, v40, v41
    v_cvt_pk_bf16_f32 v169, v42, v43
    s_waitcnt lgkmcnt(0)
    s_barrier
    ds_read2st64_b64 v[160:163], v9 offset0:0 offset1:1
    ds_read_b64 v[164:165], v9 offset:1024
    ds_read_b64 v[178:179], v9 offset:1536
    ds_read_b64 v[184:185], v9 offset:2048
    v_mfma_f32_16x16x16_bf16 v[128:131], v[174:175], v[234:235], 0
    v_mfma_f32_16x16x16_bf16 v[124:127], v[168:169], v[234:235], 0
    v_pk_mul_f32 v[44:45], v[44:45], v[244:245] op_sel:[0,1] op_sel_hi:[1,1]
    v_pk_mul_f32 v[46:47], v[46:47], v[244:245] op_sel:[0,1] op_sel_hi:[1,1]
    v_pk_mul_f32 v[48:49], v[48:49], v[244:245] op_sel:[0,1] op_sel_hi:[1,1]
    v_pk_mul_f32 v[50:51], v[50:51], v[244:245] op_sel:[0,1] op_sel_hi:[1,1]
    v_pk_mul_f32 v[16:17], v[16:17], v[242:243] op_sel:[0,1] op_sel_hi:[1,1]
    v_pk_mul_f32 v[18:19], v[18:19], v[242:243] op_sel:[0,1] op_sel_hi:[1,1]
    v_pk_mul_f32 v[20:21], v[20:21], v[242:243] op_sel:[0,1] op_sel_hi:[1,1]
    v_pk_mul_f32 v[22:23], v[22:23], v[242:243] op_sel:[0,1] op_sel_hi:[1,1]
    v_cvt_pk_bf16_f32 v112, v44, v45
    v_cvt_pk_bf16_f32 v113, v46, v47
    v_cvt_pk_bf16_f32 v118, v48, v49
    v_cvt_pk_bf16_f32 v119, v50, v51
    v_cvt_pk_bf16_f32 v104, v16, v17
    v_cvt_pk_bf16_f32 v105, v18, v19
    v_cvt_pk_bf16_f32 v110, v20, v21
    v_cvt_pk_bf16_f32 v111, v22, v23
    v_permlane16_swap_b32 v114, v174
    v_permlane16_swap_b32 v117, v175
    v_permlane16_swap_b32 v106, v168
    v_permlane16_swap_b32 v109, v169
    s_waitcnt lgkmcnt(0)
    v_mfma_f32_16x16x16_bf16 v[120:123], v[162:163], v[234:235], 0
    v_mfma_f32_16x16x32_bf16 v[20:23], v[172:175], v[112:115], 0
    v_mfma_f32_16x16x32_bf16 v[16:19], v[166:169], v[112:115], 0
    v_mfma_f32_16x16x32_bf16 v[28:31], v[174:177], v[116:119], 0
    v_mfma_f32_16x16x32_bf16 v[24:27], v[168:171], v[116:119], 0
    v_mfma_f32_16x16x32_bf16 v[36:39], v[166:169], v[104:107], 0
    v_mfma_f32_16x16x32_bf16 v[32:35], v[160:163], v[104:107], 0
    v_mfma_f32_16x16x32_bf16 v[44:47], v[168:171], v[108:111], 0
    v_mfma_f32_16x16x32_bf16 v[40:43], v[162:165], v[108:111], 0
    v_cvt_pk_bf16_f32 v194, v128, v129
    v_cvt_pk_bf16_f32 v195, v130, v131
    v_cvt_pk_bf16_f32 v192, v124, v125
    v_cvt_pk_bf16_f32 v193, v126, v127
    v_cvt_pk_bf16_f32 v190, v120, v121
    v_cvt_pk_bf16_f32 v191, v122, v123
    v_cndmask_b32 v20, v20, v21, s[40:41]
    v_cndmask_b32 v16, v16, v17, s[40:41]
    v_cndmask_b32 v48, v16, v20, s[42:43]
    v_cndmask_b32 v22, v22, v23, s[40:41]
    v_cndmask_b32 v18, v18, v19, s[40:41]
    v_cndmask_b32 v49, v18, v22, s[44:45]
    v_max_f32 v56, v48, v49
    v_cndmask_b32 v28, v28, v29, s[40:41]
    v_cndmask_b32 v24, v24, v25, s[40:41]
    v_cndmask_b32 v50, v24, v28, s[42:43]
    v_cndmask_b32 v30, v30, v31, s[40:41]
    v_cndmask_b32 v26, v26, v27, s[40:41]
    v_cndmask_b32 v51, v26, v30, s[44:45]
    v_max_f32 v57, v50, v51
    v_cndmask_b32 v36, v36, v37, s[40:41]
    v_cndmask_b32 v32, v32, v33, s[40:41]
    v_cndmask_b32 v52, v32, v36, s[42:43]
    v_cndmask_b32 v52, v8, v52, s[48:49]
    v_cndmask_b32 v38, v38, v39, s[40:41]
    v_cndmask_b32 v34, v34, v35, s[40:41]
    v_cndmask_b32 v53, v34, v38, s[44:45]
    v_cndmask_b32 v53, v8, v53, s[38:39]
    v_max_f32 v58, v52, v53
    v_permlane32_swap_b32 v56, v57
    v_max_f32 v56, v56, v57
    v_cndmask_b32 v44, v44, v45, s[40:41]
    v_cndmask_b32 v40, v40, v41, s[40:41]
    v_cndmask_b32 v54, v40, v44, s[42:43]
    v_cndmask_b32 v54, v8, v54, s[48:49]
    v_cndmask_b32 v46, v46, v47, s[40:41]
    v_cndmask_b32 v42, v42, v43, s[40:41]
    v_cndmask_b32 v55, v42, v46, s[44:45]
    v_cndmask_b32 v55, v8, v55, s[38:39]
    v_max_f32 v59, v54, v55
    s_nop 1
    v_permlane32_swap_b32 v58, v59
    v_max_f32 v58, v58, v59
    s_nop 1
    v_permlane16_swap_b32 v56, v58
    v_max_f32 v57, v56, v58
    v_mul_f32 v56, s33, v57
    v_mul_f32 v58, s33, v57
    s_nop 1
    v_permlane16_swap_b32 v56, v58
    v_mov_b32 v57, v56
    v_mov_b32 v59, v58
    s_nop 0
    v_permlane32_swap_b32 v56, v57
    v_permlane32_swap_b32 v58, v59
    v_fma_f32 v48, v48, s33, -v56
    v_fma_f32 v49, v49, s33, -v56
    v_fma_f32 v50, v50, s33, -v57
    v_fma_f32 v51, v51, s33, -v57
    v_fma_f32 v52, v52, s33, -v58
    v_fma_f32 v53, v53, s33, -v58
    v_fma_f32 v54, v54, s33, -v59
    v_fma_f32 v55, v55, s33, -v59
    v_exp_f32 v48, v48
    v_exp_f32 v49, v49
    v_exp_f32 v50, v50
    v_exp_f32 v51, v51
    v_exp_f32 v52, v52
    v_exp_f32 v53, v53
    v_exp_f32 v54, v54
    v_exp_f32 v55, v55
    v_cvt_pk_bf16_f32 v56, v48, v49
    v_cvt_pk_bf16_f32 v57, v50, v51
    v_cvt_pk_bf16_f32 v58, v52, v53
    v_cvt_pk_bf16_f32 v59, v54, v55
    v_perm_b32 v64, v56, v56, v12
    v_perm_b32 v65, v56, v56, v13
    v_perm_b32 v66, v56, v56, v14
    v_perm_b32 v67, v56, v56, v15
    v_perm_b32 v68, v57, v57, v12
    v_perm_b32 v69, v57, v57, v13
    v_perm_b32 v70, v57, v57, v14
    v_perm_b32 v71, v57, v57, v15
    v_perm_b32 v72, v58, v58, v12
    v_perm_b32 v73, v58, v58, v13
    v_perm_b32 v74, v58, v58, v14
    v_perm_b32 v75, v58, v58, v15
    v_perm_b32 v76, v59, v59, v12
    v_perm_b32 v77, v59, v59, v13
    v_perm_b32 v78, v59, v59, v14
    v_perm_b32 v79, v59, v59, v15
    v_mfma_f32_16x16x32_bf16 v[80:83], v[236:239], v[64:67], 0
    v_mfma_f32_16x16x32_bf16 v[84:87], v[236:239], v[68:71], 0
    v_mfma_f32_16x16x32_bf16 v[88:91], v[236:239], v[72:75], 0
    v_mfma_f32_16x16x32_bf16 v[92:95], v[236:239], v[76:79], 0
    v_mfma_f32_16x16x32_bf16 v[16:19], v[180:183], v[64:67], 0
    v_mfma_f32_16x16x32_bf16 v[20:23], v[192:195], v[64:67], 0
    v_mfma_f32_16x16x32_bf16 v[24:27], v[186:189], v[68:71], 0
    v_mfma_f32_16x16x32_bf16 v[28:31], v[192:195], v[68:71], 0
    v_mfma_f32_16x16x32_bf16 v[32:35], v[178:181], v[72:75], 0
    v_mfma_f32_16x16x32_bf16 v[36:39], v[190:193], v[72:75], 0
    v_mfma_f32_16x16x32_bf16 v[40:43], v[184:187], v[76:79], 0
    v_mfma_f32_16x16x32_bf16 v[44:47], v[190:193], v[76:79], 0
    v_rcp_f32 v80, v80
    v_rcp_f32 v84, v84
    v_rcp_f32 v88, v88
    v_rcp_f32 v92, v92
    v_pk_mul_f32 v[16:17], v[16:17], v[80:81] op_sel_hi:[1,0]
    v_pk_mul_f32 v[18:19], v[18:19], v[80:81] op_sel_hi:[1,0]
    v_pk_mul_f32 v[20:21], v[20:21], v[80:81] op_sel_hi:[1,0]
    v_pk_mul_f32 v[24:25], v[24:25], v[84:85] op_sel_hi:[1,0]
    v_pk_mul_f32 v[26:27], v[26:27], v[84:85] op_sel_hi:[1,0]
    v_pk_mul_f32 v[30:31], v[30:31], v[84:85] op_sel_hi:[1,0]
    v_cvt_pk_bf16_f32 v220, v16, v17
    v_cvt_pk_bf16_f32 v221, v18, v19
    v_cvt_pk_bf16_f32 v224, v20, v21
    v_cvt_pk_bf16_f32 v222, v24, v25
    v_cvt_pk_bf16_f32 v223, v26, v27
    v_cvt_pk_bf16_f32 v225, v30, v31
    buffer_store_dwordx4 v[220:223], v5, s[4:7], s35 offen sc1
    buffer_store_dwordx2 v[224:225], v7, s[4:7], s35 offen sc1
    v_pk_mul_f32 v[32:33], v[32:33], v[88:89] op_sel_hi:[1,0]
    v_pk_mul_f32 v[34:35], v[34:35], v[88:89] op_sel_hi:[1,0]
    v_pk_mul_f32 v[36:37], v[36:37], v[88:89] op_sel_hi:[1,0]
    v_pk_mul_f32 v[40:41], v[40:41], v[92:93] op_sel_hi:[1,0]
    v_pk_mul_f32 v[42:43], v[42:43], v[92:93] op_sel_hi:[1,0]
    v_pk_mul_f32 v[46:47], v[46:47], v[92:93] op_sel_hi:[1,0]
    v_cvt_pk_bf16_f32 v228, v32, v33
    v_cvt_pk_bf16_f32 v229, v34, v35
    v_cvt_pk_bf16_f32 v232, v36, v37
    v_cvt_pk_bf16_f32 v230, v40, v41
    v_cvt_pk_bf16_f32 v231, v42, v43
    v_cvt_pk_bf16_f32 v233, v46, v47
    buffer_store_dwordx4 v[228:231], v4, s[4:7], s35 offen sc1
    buffer_store_dwordx2 v[232:233], v6, s[4:7], s35 offen sc1
    s_and_b32 s25, s2, 7
    s_lshr_b32 s26, s2, 3
    s_lshr_b32 s23, s25, 1
    s_lshl_b32 s23, s23, 3
    s_lshr_b32 s27, s26, 2
    s_add_u32 s23, s23, s27
    s_and_b32 s24, s25, 1
    s_lshl_b32 s24, s24, 2
    s_and_b32 s27, s26, 3
    s_add_u32 s24, s24, s27
    s_add_u32 s25, s23, s24
    s_and_b32 s25, s25, 3
    s_lshl_b32 s30, s23, 2
    s_add_u32 s30, s30, s20
    s_mul_i32 s29, s30, 18432
    s_add_u32 s29, s29, s21
    s_add_u32 s29, s29, 0x600000
    s_mul_i32 s34, s30, 18432
    s_add_u32 s34, s34, s21
    s_add_u32 s34, s34, 0x0
    s_lshl_b32 s35, s24, 11
    s_lshr_b32 s36, s24, 2
    s_lshl_b32 s36, s36, 10
    s_and_b32 s37, s24, 3
    s_lshl_b32 s37, s37, 8
    s_add_u32 s36, s36, s37
    s_add_u32 s36, s36, 16384
    v_bfe_u32 v2, v1, 4, 4
    v_lshrrev_b32 v3, 8, v1
    v_add_u32 v4, s35, v1
    v_lshlrev_b32 v5, 4, v2
    v_lshl_add_u32 v5, v3, 3, v5
    v_add_u32 v5, s36, v5
    v_cmp_gt_u32 s[40:41], 2, v3
    v_bfrev_b32 v6, 1
    v_add_u32 v12, 0, v1
    v_add_u32 v13, 36864, v1
    v_add_u32 v14, 73728, v1
    v_add_u32 v15, 110592, v1
    v_cndmask_b32 v5, v6, v5, s[40:41]
    buffer_load_dwordx4 v[208:211], v4, s[4:7], s34 offen offset:0 sc1
    buffer_load_dwordx4 v[212:215], v4, s[4:7], s34 offen offset:1024 sc1
    buffer_load_dwordx2 v[216:217], v5, s[4:7], s34 offen sc1
    s_add_u32 s34, s34, 0x300000
    s_lshl_b32 s39, s30, 10
    s_add_u32 s39, s39, s21
    s_lshl_b32 s42, s24, 7
    s_add_u32 s39, s39, s42
    s_add_u32 s39, s39, 0x1b20000
    v_cmp_eq_u32 vcc, 0, v3
    v_lshlrev_b32 v10, 3, v2
    v_mov_b32 v11, 0x3f803f80
    v_lshl_add_u32 v7, v3, 8, v10
    v_cndmask_b32 v10, v6, v10, vcc
    s_lshr_b32 s44, s23, 1
    s_lshl_b32 s52, s22, 7
    s_add_u32 s52, s52, s44
    s_lshl_b32 s52, s52, 8
    s_add_u32 s52, s52, 0x4508000
    s_add_u32 s52, s52, s4
    s_addc_u32 s53, s5, 0
    s_waitcnt vmcnt(3)
    s_barrier
    s_cmp_lg_u32 s20, 0
    s_cbranch_scc1 L_ns_d2
    s_mov_b32 s56, 1
    s_atomic_add s56, s[50:51], 0
L_ns_d2:
    s_cmp_lg_u32 s20, 0
    s_cbranch_scc1 L_pd_d2
    s_mov_b32 s60, 65536
L_poll_d2:
    s_mov_b32 s57, 0
    s_atomic_add s57, s[52:53], 0 glc
    s_waitcnt lgkmcnt(0)
    s_cmp_ge_u32 s57, 16
    s_cbranch_scc1 L_pd_d2
    s_sub_u32 s60, s60, 1
    s_cbranch_scc1 L_pd_d2
    s_sleep 2
    s_branch L_poll_d2
L_pd_d2:
    s_barrier
    s_mov_b32 s32, 0
    s_lshl_b32 s32, s32, 13
    s_add_u32 s32, s32, s29
    s_add_u32 s33, s32, 4096
    buffer_load_dwordx4 v[112:115], v1, s[4:7], s32 offen offset:0 sc1
    buffer_load_dwordx4 v[116:119], v1, s[4:7], s32 offen offset:1024 sc1
    buffer_load_dwordx4 v[120:123], v1, s[4:7], s32 offen offset:2048 sc1
    buffer_load_dwordx4 v[124:127], v1, s[4:7], s32 offen offset:3072 sc1
    buffer_load_dwordx4 v[128:131], v1, s[4:7], s33 offen offset:0 sc1
    buffer_load_dwordx4 v[132:135], v1, s[4:7], s33 offen offset:1024 sc1
    buffer_load_dwordx4 v[136:139], v1, s[4:7], s33 offen offset:2048 sc1
    buffer_load_dwordx4 v[140:143], v1, s[4:7], s33 offen offset:3072 sc1
    ds_read_b128 v[40:43], v12 offset:18432
    ds_read_b128 v[44:47], v12 offset:19456
    ds_read_b128 v[48:51], v12 offset:20480
    ds_read_b128 v[52:55], v12 offset:21504
    ds_read_b128 v[72:75], v12 offset:26624
    ds_read_b128 v[56:59], v12 offset:22528
    ds_read_b128 v[60:63], v12 offset:23552
    ds_read_b128 v[64:67], v12 offset:24576
    ds_read_b128 v[68:71], v12 offset:25600
    s_add_u32 s45, s29, 8192
    s_add_u32 s46, s29, 12288
    s_add_u32 s47, s29, 16384
    buffer_load_dwordx4 v[144:147], v1, s[4:7], s45 offen offset:0 sc1
    buffer_load_dwordx4 v[148:151], v1, s[4:7], s45 offen offset:1024 sc1
    s_lshl_b32 s42, s23, 3
    s_add_u32 s42, s42, s24
    s_lshl_b32 s42, s42, 2
    s_add_u32 s42, s42, s20
    s_lshl_b32 s42, s42, 8
    s_add_u32 s42, s42, s21
    s_add_u32 s42, s42, 0x1b40000
    v_mov_b32 v220, -1.0
    v_lshrrev_b32 v221, 2, v1
    buffer_store_dword v220, v221, s[4:7], s42 offen sc1
    s_lshl_b32 s50, s22, 7
    s_add_u32 s50, s50, s44
    s_lshl_b32 s50, s50, 8
    s_add_u32 s50, s50, 0x4509000
    s_add_u32 s50, s50, s4
    s_addc_u32 s51, s5, 0
    s_waitcnt vmcnt(11)
    v_lshlrev_b32 v16, 16, v208
    v_and_b32 v17, 0xffff0000, v208
    v_lshlrev_b32 v18, 16, v209
    v_and_b32 v19, 0xffff0000, v209
    v_lshlrev_b32 v20, 16, v210
    v_and_b32 v21, 0xffff0000, v210
    v_lshlrev_b32 v22, 16, v211
    v_and_b32 v23, 0xffff0000, v211
    v_lshlrev_b32 v24, 16, v212
    v_and_b32 v25, 0xffff0000, v212
    v_lshlrev_b32 v26, 16, v213
    v_and_b32 v27, 0xffff0000, v213
    v_lshlrev_b32 v28, 16, v214
    v_and_b32 v29, 0xffff0000, v214
    v_lshlrev_b32 v30, 16, v215
    v_and_b32 v31, 0xffff0000, v215
    v_lshlrev_b32 v32, 16, v216
    v_and_b32 v33, 0xffff0000, v216
    v_lshlrev_b32 v34, 16, v217
    v_and_b32 v35, 0xffff0000, v217
    s_waitcnt vmcnt(9) lgkmcnt(4)
    v_mfma_f32_16x16x32_bf16 v[16:19], v[40:43], v[112:115], v[16:19]
    ds_read_b128 v[76:79], v12 offset:27648
    v_mfma_f32_16x16x32_bf16 v[20:23], v[44:47], v[112:115], v[20:23]
    ds_read_b128 v[80:83], v12 offset:28672
    buffer_load_dwordx4 v[152:155], v1, s[4:7], s45 offen offset:2048 sc1
    v_mfma_f32_16x16x32_bf16 v[24:27], v[48:51], v[112:115], v[24:27]
    ds_read_b128 v[84:87], v12 offset:29696
    v_mfma_f32_16x16x32_bf16 v[28:31], v[52:55], v[112:115], v[28:31]
    ds_read_b128 v[88:91], v12 offset:30720
    v_mfma_f32_16x16x32_bf16 v[32:35], v[72:75], v[112:115], v[32:35]
    ds_read_b128 v[108:111], v12 offset:35840
    s_waitcnt lgkmcnt(5)
    buffer_load_dwordx4 v[156:159], v1, s[4:7], s45 offen offset:3072 sc1
    v_mfma_f32_16x16x32_bf16 v[16:19], v[56:59], v[116:119], v[16:19]
    ds_read_b128 v[92:95], v12 offset:31744
    v_mfma_f32_16x16x32_bf16 v[20:23], v[60:63], v[116:119], v[20:23]
    ds_read_b128 v[96:99], v12 offset:32768
    v_mfma_f32_16x16x32_bf16 v[24:27], v[64:67], v[116:119], v[24:27]
    ds_read_b128 v[100:103], v12 offset:33792
    buffer_load_dwordx4 v[160:163], v1, s[4:7], s46 offen offset:0 sc1
    v_mfma_f32_16x16x32_bf16 v[28:31], v[68:71], v[116:119], v[28:31]
    ds_read_b128 v[104:107], v12 offset:34816
    v_mfma_f32_16x16x32_bf16 v[36:39], v[72:75], v[116:119], 0
    s_waitcnt vmcnt(10) lgkmcnt(4)
    v_mfma_f32_16x16x32_bf16 v[16:19], v[76:79], v[120:123], v[16:19]
    ds_read_b128 v[40:43], v13 offset:18432
    v_mfma_f32_16x16x32_bf16 v[20:23], v[80:83], v[120:123], v[20:23]
    ds_read_b128 v[44:47], v13 offset:19456
    buffer_load_dwordx4 v[164:167], v1, s[4:7], s46 offen offset:1024 sc1
    v_mfma_f32_16x16x32_bf16 v[24:27], v[84:87], v[120:123], v[24:27]
    ds_read_b128 v[48:51], v13 offset:20480
    v_mfma_f32_16x16x32_bf16 v[28:31], v[88:91], v[120:123], v[28:31]
    ds_read_b128 v[52:55], v13 offset:21504
    v_mfma_f32_16x16x32_bf16 v[32:35], v[108:111], v[120:123], v[32:35]
    ds_read_b128 v[72:75], v13 offset:26624
    s_waitcnt lgkmcnt(5)
    buffer_load_dwordx4 v[168:171], v1, s[4:7], s46 offen offset:2048 sc1
    v_mfma_f32_16x16x32_bf16 v[16:19], v[92:95], v[124:127], v[16:19]
    ds_read_b128 v[56:59], v13 offset:22528
    v_mfma_f32_16x16x32_bf16 v[20:23], v[96:99], v[124:127], v[20:23]
    ds_read_b128 v[60:63], v13 offset:23552
    v_mfma_f32_16x16x32_bf16 v[24:27], v[100:103], v[124:127], v[24:27]
    ds_read_b128 v[64:67], v13 offset:24576
    buffer_load_dwordx4 v[172:175], v1, s[4:7], s46 offen offset:3072 sc1
    v_mfma_f32_16x16x32_bf16 v[28:31], v[104:107], v[124:127], v[28:31]
    ds_read_b128 v[68:71], v13 offset:25600
    v_mfma_f32_16x16x32_bf16 v[36:39], v[108:111], v[124:127], v[36:39]
    s_waitcnt vmcnt(11) lgkmcnt(4)
    v_mfma_f32_16x16x32_bf16 v[16:19], v[40:43], v[128:131], v[16:19]
    ds_read_b128 v[76:79], v13 offset:27648
    v_mfma_f32_16x16x32_bf16 v[20:23], v[44:47], v[128:131], v[20:23]
    ds_read_b128 v[80:83], v13 offset:28672
    buffer_load_dwordx2 v[176:177], v7, s[4:7], s47 offen offset:0 sc1
    v_mfma_f32_16x16x32_bf16 v[24:27], v[48:51], v[128:131], v[24:27]
    ds_read_b128 v[84:87], v13 offset:29696
    v_mfma_f32_16x16x32_bf16 v[28:31], v[52:55], v[128:131], v[28:31]
    ds_read_b128 v[88:91], v13 offset:30720
    v_mfma_f32_16x16x32_bf16 v[32:35], v[72:75], v[128:131], v[32:35]
    ds_read_b128 v[108:111], v13 offset:35840
    s_waitcnt lgkmcnt(5)
    buffer_load_dwordx2 v[178:179], v7, s[4:7], s47 offen offset:128 sc1
    v_mfma_f32_16x16x32_bf16 v[16:19], v[56:59], v[132:135], v[16:19]
    ds_read_b128 v[92:95], v13 offset:31744
    v_mfma_f32_16x16x32_bf16 v[20:23], v[60:63], v[132:135], v[20:23]
    ds_read_b128 v[96:99], v13 offset:32768
    v_mfma_f32_16x16x32_bf16 v[24:27], v[64:67], v[132:135], v[24:27]
    ds_read_b128 v[100:103], v13 offset:33792
    buffer_load_dwordx2 v[180:181], v7, s[4:7], s47 offen offset:1024 sc1
    v_mfma_f32_16x16x32_bf16 v[28:31], v[68:71], v[132:135], v[28:31]
    ds_read_b128 v[104:107], v13 offset:34816
    v_mfma_f32_16x16x32_bf16 v[36:39], v[72:75], v[132:135], v[36:39]
    s_waitcnt vmcnt(12) lgkmcnt(4)
    v_mfma_f32_16x16x32_bf16 v[16:19], v[76:79], v[136:139], v[16:19]
    ds_read_b128 v[40:43], v14 offset:18432
    v_mfma_f32_16x16x32_bf16 v[20:23], v[80:83], v[136:139], v[20:23]
    ds_read_b128 v[44:47], v14 offset:19456
    buffer_load_dwordx2 v[182:183], v7, s[4:7], s47 offen offset:1152 sc1
    v_mfma_f32_16x16x32_bf16 v[24:27], v[84:87], v[136:139], v[24:27]
    ds_read_b128 v[48:51], v14 offset:20480
    v_mfma_f32_16x16x32_bf16 v[28:31], v[88:91], v[136:139], v[28:31]
    ds_read_b128 v[52:55], v14 offset:21504
    v_mfma_f32_16x16x32_bf16 v[32:35], v[108:111], v[136:139], v[32:35]
    ds_read_b128 v[72:75], v14 offset:26624
    s_waitcnt lgkmcnt(5)
    v_mfma_f32_16x16x32_bf16 v[16:19], v[92:95], v[140:143], v[16:19]
    ds_read_b128 v[56:59], v14 offset:22528
    v_mfma_f32_16x16x32_bf16 v[20:23], v[96:99], v[140:143], v[20:23]
    ds_read_b128 v[60:63], v14 offset:23552
    v_mfma_f32_16x16x32_bf16 v[24:27], v[100:103], v[140:143], v[24:27]
    ds_read_b128 v[64:67], v14 offset:24576
    v_mfma_f32_16x16x32_bf16 v[28:31], v[104:107], v[140:143], v[28:31]
    ds_read_b128 v[68:71], v14 offset:25600
    v_mfma_f32_16x16x32_bf16 v[36:39], v[108:111], v[140:143], v[36:39]
    s_waitcnt vmcnt(11) lgkmcnt(4)
    v_mfma_f32_16x16x32_bf16 v[16:19], v[40:43], v[144:147], v[16:19]
    ds_read_b128 v[76:79], v14 offset:27648
    v_mfma_f32_16x16x32_bf16 v[20:23], v[44:47], v[144:147], v[20:23]
    ds_read_b128 v[80:83], v14 offset:28672
    v_mfma_f32_16x16x32_bf16 v[24:27], v[48:51], v[144:147], v[24:27]
    ds_read_b128 v[84:87], v14 offset:29696
    v_mfma_f32_16x16x32_bf16 v[28:31], v[52:55], v[144:147], v[28:31]
    ds_read_b128 v[88:91], v14 offset:30720
    v_mfma_f32_16x16x32_bf16 v[32:35], v[72:75], v[144:147], v[32:35]
    ds_read_b128 v[108:111], v14 offset:35840
    s_waitcnt lgkmcnt(5)
    v_mfma_f32_16x16x32_bf16 v[16:19], v[56:59], v[148:151], v[16:19]
    ds_read_b128 v[92:95], v14 offset:31744
    v_mfma_f32_16x16x32_bf16 v[20:23], v[60:63], v[148:151], v[20:23]
    ds_read_b128 v[96:99], v14 offset:32768
    v_mfma_f32_16x16x32_bf16 v[24:27], v[64:67], v[148:151], v[24:27]
    ds_read_b128 v[100:103], v14 offset:33792
    v_mfma_f32_16x16x32_bf16 v[28:31], v[68:71], v[148:151], v[28:31]
    ds_read_b128 v[104:107], v14 offset:34816
    v_mfma_f32_16x16x32_bf16 v[36:39], v[72:75], v[148:151], v[36:39]
    s_waitcnt vmcnt(8) lgkmcnt(4)
    v_mfma_f32_16x16x32_bf16 v[16:19], v[76:79], v[152:155], v[16:19]
    ds_read_b128 v[40:43], v15 offset:18432
    v_mfma_f32_16x16x32_bf16 v[20:23], v[80:83], v[152:155], v[20:23]
    ds_read_b128 v[44:47], v15 offset:19456
    v_mfma_f32_16x16x32_bf16 v[24:27], v[84:87], v[152:155], v[24:27]
    ds_read_b128 v[48:51], v15 offset:20480
    v_mfma_f32_16x16x32_bf16 v[28:31], v[88:91], v[152:155], v[28:31]
    ds_read_b128 v[52:55], v15 offset:21504
    v_mfma_f32_16x16x32_bf16 v[32:35], v[108:111], v[152:155], v[32:35]
    ds_read_b128 v[72:75], v15 offset:26624
    s_waitcnt lgkmcnt(5)
    v_mfma_f32_16x16x32_bf16 v[16:19], v[92:95], v[156:159], v[16:19]
    ds_read_b128 v[56:59], v15 offset:22528
    v_mfma_f32_16x16x32_bf16 v[20:23], v[96:99], v[156:159], v[20:23]
    ds_read_b128 v[60:63], v15 offset:23552
    v_mfma_f32_16x16x32_bf16 v[24:27], v[100:103], v[156:159], v[24:27]
    ds_read_b128 v[64:67], v15 offset:24576
    v_mfma_f32_16x16x32_bf16 v[28:31], v[104:107], v[156:159], v[28:31]
    ds_read_b128 v[68:71], v15 offset:25600
    v_mfma_f32_16x16x32_bf16 v[36:39], v[108:111], v[156:159], v[36:39]
    s_waitcnt vmcnt(6) lgkmcnt(4)
    v_mfma_f32_16x16x32_bf16 v[16:19], v[40:43], v[160:163], v[16:19]
    ds_read_b128 v[76:79], v15 offset:27648
    v_mfma_f32_16x16x32_bf16 v[20:23], v[44:47], v[160:163], v[20:23]
    ds_read_b128 v[80:83], v15 offset:28672
    v_mfma_f32_16x16x32_bf16 v[24:27], v[48:51], v[160:163], v[24:27]
    ds_read_b128 v[84:87], v15 offset:29696
    v_mfma_f32_16x16x32_bf16 v[28:31], v[52:55], v[160:163], v[28:31]
    ds_read_b128 v[88:91], v15 offset:30720
    v_mfma_f32_16x16x32_bf16 v[32:35], v[72:75], v[160:163], v[32:35]
    ds_read_b128 v[108:111], v15 offset:35840
    s_waitcnt lgkmcnt(5)
    v_mfma_f32_16x16x32_bf16 v[16:19], v[56:59], v[164:167], v[16:19]
    ds_read_b128 v[92:95], v15 offset:31744
    v_mfma_f32_16x16x32_bf16 v[20:23], v[60:63], v[164:167], v[20:23]
    ds_read_b128 v[96:99], v15 offset:32768
    v_mfma_f32_16x16x32_bf16 v[24:27], v[64:67], v[164:167], v[24:27]
    ds_read_b128 v[100:103], v15 offset:33792
    v_mfma_f32_16x16x32_bf16 v[28:31], v[68:71], v[164:167], v[28:31]
    ds_read_b128 v[104:107], v15 offset:34816
    v_mfma_f32_16x16x32_bf16 v[36:39], v[72:75], v[164:167], v[36:39]
    s_waitcnt vmcnt(4) lgkmcnt(4)
    v_mfma_f32_16x16x32_bf16 v[16:19], v[76:79], v[168:171], v[16:19]
    ds_read_b128 v[40:43], v15 offset:36864
    v_mfma_f32_16x16x32_bf16 v[20:23], v[80:83], v[168:171], v[20:23]
    ds_read_b128 v[44:47], v15 offset:37888
    v_mfma_f32_16x16x32_bf16 v[24:27], v[84:87], v[168:171], v[24:27]
    ds_read_b128 v[48:51], v15 offset:38912
    v_mfma_f32_16x16x32_bf16 v[28:31], v[88:91], v[168:171], v[28:31]
    ds_read_b128 v[52:55], v15 offset:39936
    v_mfma_f32_16x16x32_bf16 v[32:35], v[108:111], v[168:171], v[32:35]
    ds_read_b128 v[72:75], v15 offset:45056
    s_waitcnt lgkmcnt(5)
    v_mfma_f32_16x16x32_bf16 v[16:19], v[92:95], v[172:175], v[16:19]
    ds_read_b128 v[56:59], v15 offset:40960
    v_mfma_f32_16x16x32_bf16 v[20:23], v[96:99], v[172:175], v[20:23]
    ds_read_b128 v[60:63], v15 offset:41984
    v_mfma_f32_16x16x32_bf16 v[24:27], v[100:103], v[172:175], v[24:27]
    ds_read_b128 v[64:67], v15 offset:43008
    v_mfma_f32_16x16x32_bf16 v[28:31], v[104:107], v[172:175], v[28:31]
    ds_read_b128 v[68:71], v15 offset:44032
    v_mfma_f32_16x16x32_bf16 v[36:39], v[108:111], v[172:175], v[36:39]
    s_waitcnt vmcnt(0) lgkmcnt(4)
    v_mfma_f32_16x16x32_bf16 v[16:19], v[40:43], v[176:179], v[16:19]
    v_mfma_f32_16x16x32_bf16 v[20:23], v[44:47], v[176:179], v[20:23]
    v_mfma_f32_16x16x32_bf16 v[24:27], v[48:51], v[176:179], v[24:27]
    v_mfma_f32_16x16x32_bf16 v[28:31], v[52:55], v[176:179], v[28:31]
    v_mfma_f32_16x16x32_bf16 v[32:35], v[72:75], v[176:179], v[32:35]
    s_waitcnt lgkmcnt(0)
    v_mfma_f32_16x16x32_bf16 v[16:19], v[56:59], v[180:183], v[16:19]
    v_mfma_f32_16x16x32_bf16 v[20:23], v[60:63], v[180:183], v[20:23]
    v_mfma_f32_16x16x32_bf16 v[24:27], v[64:67], v[180:183], v[24:27]
    v_mfma_f32_16x16x32_bf16 v[28:31], v[68:71], v[180:183], v[28:31]
    v_mfma_f32_16x16x32_bf16 v[36:39], v[72:75], v[180:183], v[36:39]
    s_nop 3
    v_cvt_pk_bf16_f32 v208, v16, v17
    v_cvt_pk_bf16_f32 v209, v18, v19
    v_cvt_pk_bf16_f32 v210, v20, v21
    v_cvt_pk_bf16_f32 v211, v22, v23
    v_cvt_pk_bf16_f32 v212, v24, v25
    v_cvt_pk_bf16_f32 v213, v26, v27
    v_cvt_pk_bf16_f32 v214, v28, v29
    v_cvt_pk_bf16_f32 v215, v30, v31
    buffer_store_dwordx4 v[208:211], v4, s[4:7], s34 offen offset:0 sc1
    buffer_store_dwordx4 v[212:215], v4, s[4:7], s34 offen offset:1024 sc1
    v_permlane32_swap_b32 v36, v220
    v_permlane32_swap_b32 v37, v221
    v_permlane32_swap_b32 v38, v222
    v_permlane32_swap_b32 v39, v223
    v_pk_add_f32 v[32:33], v[32:33], v[220:221]
    v_pk_add_f32 v[34:35], v[34:35], v[222:223]
    v_cvt_pk_bf16_f32 v216, v32, v33
    v_cvt_pk_bf16_f32 v217, v34, v35
    buffer_store_dwordx2 v[216:217], v5, s[4:7], s34 offen sc1
    v_cndmask_b32 v222, 0, v216, s[40:41]
    v_cndmask_b32 v223, 0, v217, s[40:41]
    v_dot2_f32_bf16 v220, v208, v11, 0
    v_dot2_f32_bf16 v221, v208, v208, 0
    v_dot2_f32_bf16 v224, v209, v11, 0
    v_dot2_f32_bf16 v225, v209, v209, 0
    v_dot2_f32_bf16 v220, v210, v11, v220
    v_dot2_f32_bf16 v221, v210, v210, v221
    v_dot2_f32_bf16 v224, v211, v11, v224
    v_dot2_f32_bf16 v225, v211, v211, v225
    v_dot2_f32_bf16 v220, v212, v11, v220
    v_dot2_f32_bf16 v221, v212, v212, v221
    v_dot2_f32_bf16 v224, v213, v11, v224
    v_dot2_f32_bf16 v225, v213, v213, v225
    v_dot2_f32_bf16 v220, v214, v11, v220
    v_dot2_f32_bf16 v221, v214, v214, v221
    v_dot2_f32_bf16 v224, v215, v11, v224
    v_dot2_f32_bf16 v225, v215, v215, v225
    v_dot2_f32_bf16 v220, v222, v11, v220
    v_dot2_f32_bf16 v221, v222, v222, v221
    v_dot2_f32_bf16 v224, v223, v11, v224
    v_dot2_f32_bf16 v225, v223, v223, v225
    s_nop 2
    v_pk_add_f32 v[220:221], v[220:221], v[224:225]
    v_mov_b32 v222, v220
    v_mov_b32 v223, v221
    s_nop 1
    v_permlane32_swap_b32 v220, v222
    v_permlane32_swap_b32 v221, v223
    v_add_f32 v220, v220, v222
    v_add_f32 v221, v221, v223
    v_mov_b32 v222, v220
    v_mov_b32 v223, v221
    s_nop 1
    v_permlane16_swap_b32 v220, v222
    v_permlane16_swap_b32 v221, v223
    v_add_f32 v220, v220, v222
    v_add_f32 v221, v221, v223
    buffer_store_dwordx2 v[220:221], v10, s[4:7], s39 offen sc1
    s_and_b32 s25, s2, 7
    s_lshr_b32 s26, s2, 3
    s_and_b32 s23, s25, 1
    s_lshl_b32 s23, s23, 3
    s_and_b32 s27, s26, 7
    s_add_u32 s23, s23, s27
    s_lshr_b32 s24, s25, 1
    s_lshl_b32 s24, s24, 2
    s_lshr_b32 s27, s26, 3
    s_add_u32 s24, s24, s27
    s_add_u32 s28, s23, s24
    s_and_b32 s28, s28, 3
    s_lshl_b32 s30, s20, 12
    s_lshl_b32 s31, s23, 3
    s_lshl_b32 s33, s20, 1
    s_add_u32 s31, s31, s33
    s_lshl_b32 s32, s31, 10
    s_add_u32 s32, s32, s21
    s_add_u32 s32, s32, 0x1b20000
    v_add_u32 v2, 73728, v1
    s_add_u32 s33, s30, 18432
    v_add_u32 v3, s33, v1
    v_add_u32 v0, s33, v2
    s_lshr_b32 s34, s31, 1
    s_lshl_b32 s35, s34, 12
    s_add_u32 s35, s35, s21
    s_add_u32 s35, s35, 0x1b40000
    s_lshl_b32 s36, s24, 8
    s_add_u32 s36, s36, s35
    s_lshl_b32 s38, s24, 6
    s_add_u32 s38, s38, s34
    s_mul_i32 s38, s38, 9216
    s_add_u32 s38, s38, s21
    s_add_u32 s38, s38, 0x900000
    s_add_u32 s39, s38, 4096
    s_add_u32 s46, s38, 8192
    s_mov_b32 s40, 0xc0135761
    s_mov_b32 s42, 0x3d372713
    s_mov_b32 s44, 0x39e38e39
    s_mov_b32 s45, 0x3727c5ac
    v_lshrrev_b32 v4, 1, v1
    s_lshl_b32 s52, s22, 7
    s_add_u32 s52, s52, s23
    s_lshl_b32 s52, s52, 8
    s_add_u32 s52, s52, 0x4509000
    s_add_u32 s52, s52, s4
    s_addc_u32 s53, s5, 0
    s_waitcnt vmcnt(0)
    s_barrier
    s_cmp_lg_u32 s20, 0
    s_cbranch_scc1 L_ns_d3
    s_mov_b32 s56, 1
    s_atomic_add s56, s[50:51], 0
L_ns_d3:
    s_cmp_lg_u32 s20, 0
    s_cbranch_scc1 L_pd_d3
    s_mov_b32 s60, 65536
L_poll_d3:
    s_mov_b32 s57, 0
    s_atomic_add s57, s[52:53], 0 glc
    s_waitcnt lgkmcnt(0)
    s_cmp_ge_u32 s57, 16
    s_cbranch_scc1 L_pd_d3
    s_sub_u32 s60, s60, 1
    s_cbranch_scc1 L_pd_d3
    s_sleep 2
    s_branch L_poll_d3
L_pd_d3:
    s_barrier
    buffer_load_dwordx2 v[8:9], v4, s[4:7], s32 offen offset:0 sc1
    buffer_load_dwordx2 v[10:11], v4, s[4:7], s32 offen offset:512 sc1
    buffer_load_dwordx2 v[12:13], v4, s[4:7], s32 offen offset:1024 sc1
    buffer_load_dwordx2 v[14:15], v4, s[4:7], s32 offen offset:1536 sc1
    s_lshl_b32 s50, s22, 7
    s_add_u32 s50, s50, s23
    s_lshl_b32 s50, s50, 8
    s_add_u32 s50, s50, 0x450a000
    s_add_u32 s50, s50, s4
    s_addc_u32 s51, s5, 0
    s_barrier
    ds_read_b128 v[160:163], v3 offset:0
    ds_read_b128 v[164:167], v3 offset:2048
    ds_read_b128 v[168:171], v1 offset:0
    ds_read_b128 v[172:175], v1 offset:1024
    ds_read_b128 v[176:179], v1 offset:2048
    ds_read_b128 v[180:183], v1 offset:3072
    ds_read_b128 v[184:187], v1 offset:4096
    ds_read_b128 v[188:191], v1 offset:5120
    ds_read_b128 v[192:195], v1 offset:6144
    ds_read_b128 v[196:199], v1 offset:7168
    ds_read_b128 v[200:203], v1 offset:8192
    s_waitcnt lgkmcnt(5)
    v_mfma_f32_16x16x32_bf16 v[16:19], v[160:163], v[168:171], 0
    ds_read_b128 v[204:207], v3 offset:1024
    v_mfma_f32_16x16x32_bf16 v[20:23], v[164:167], v[168:171], 0
    ds_read_b128 v[208:211], v3 offset:3072
    v_mfma_f32_16x16x32_bf16 v[24:27], v[160:163], v[172:175], 0
    ds_read_b128 v[212:215], v1 offset:9216
    v_mfma_f32_16x16x32_bf16 v[28:31], v[164:167], v[172:175], 0
    ds_read_b128 v[216:219], v1 offset:10240
    v_mfma_f32_16x16x32_bf16 v[32:35], v[160:163], v[176:179], 0
    ds_read_b128 v[220:223], v1 offset:11264
    v_mfma_f32_16x16x32_bf16 v[36:39], v[164:167], v[176:179], 0
    ds_read_b128 v[224:227], v1 offset:12288
    v_mfma_f32_16x16x32_bf16 v[40:43], v[160:163], v[180:183], 0
    ds_read_b128 v[228:231], v1 offset:13312
    v_mfma_f32_16x16x32_bf16 v[44:47], v[164:167], v[180:183], 0
    ds_read_b128 v[232:235], v1 offset:14336
    s_waitcnt lgkmcnt(8)
    v_mfma_f32_16x16x32_bf16 v[48:51], v[160:163], v[184:187], 0
    ds_read_b128 v[236:239], v1 offset:15360
    v_mfma_f32_16x16x32_bf16 v[52:55], v[164:167], v[184:187], 0
    ds_read_b128 v[240:243], v1 offset:16384
    v_mfma_f32_16x16x32_bf16 v[56:59], v[160:163], v[188:191], 0
    ds_read_b128 v[244:247], v1 offset:17408
    v_mfma_f32_16x16x32_bf16 v[60:63], v[164:167], v[188:191], 0
    v_mfma_f32_16x16x32_bf16 v[64:67], v[160:163], v[192:195], 0
    v_mfma_f32_16x16x32_bf16 v[68:71], v[164:167], v[192:195], 0
    v_mfma_f32_16x16x32_bf16 v[72:75], v[160:163], v[196:199], 0
    v_mfma_f32_16x16x32_bf16 v[76:79], v[164:167], v[196:199], 0
    v_mfma_f32_16x16x32_bf16 v[80:83], v[160:163], v[200:203], 0
    v_mfma_f32_16x16x32_bf16 v[84:87], v[164:167], v[200:203], 0
    s_waitcnt lgkmcnt(0)
    s_barrier
    v_mfma_f32_16x16x32_bf16 v[16:19], v[204:207], v[212:215], v[16:19]
    ds_read_b128 v[160:163], v3 offset:36864
    v_mfma_f32_16x16x32_bf16 v[20:23], v[208:211], v[212:215], v[20:23]
    ds_read_b128 v[164:167], v3 offset:38912
    v_mfma_f32_16x16x32_bf16 v[24:27], v[204:207], v[216:219], v[24:27]
    ds_read_b128 v[168:171], v1 offset:36864
    v_mfma_f32_16x16x32_bf16 v[28:31], v[208:211], v[216:219], v[28:31]
    ds_read_b128 v[172:175], v1 offset:37888
    v_mfma_f32_16x16x32_bf16 v[32:35], v[204:207], v[220:223], v[32:35]
    ds_read_b128 v[176:179], v1 offset:38912
    v_mfma_f32_16x16x32_bf16 v[36:39], v[208:211], v[220:223], v[36:39]
    ds_read_b128 v[180:183], v1 offset:39936
    v_mfma_f32_16x16x32_bf16 v[40:43], v[204:207], v[224:227], v[40:43]
    ds_read_b128 v[184:187], v1 offset:40960
    v_mfma_f32_16x16x32_bf16 v[44:47], v[208:211], v[224:227], v[44:47]
    ds_read_b128 v[188:191], v1 offset:41984
    v_mfma_f32_16x16x32_bf16 v[48:51], v[204:207], v[228:231], v[48:51]
    ds_read_b128 v[192:195], v1 offset:43008
    v_mfma_f32_16x16x32_bf16 v[52:55], v[208:211], v[228:231], v[52:55]
    ds_read_b128 v[196:199], v1 offset:44032
    v_lshrrev_b32 v5, 8, v1
    v_mfma_f32_16x16x32_bf16 v[56:59], v[204:207], v[232:235], v[56:59]
    ds_read_b128 v[200:203], v1 offset:45056
    v_bfe_u32 v6, v1, 4, 4
    v_mfma_f32_16x16x32_bf16 v[60:63], v[208:211], v[232:235], v[60:63]
    v_lshlrev_b32 v7, 2, v6
    v_mfma_f32_16x16x32_bf16 v[64:67], v[204:207], v[236:239], v[64:67]
    s_lshl_b32 s33, s20, 8
    v_mfma_f32_16x16x32_bf16 v[68:71], v[208:211], v[236:239], v[68:71]
    s_add_u32 s33, s33, 147456
    v_mfma_f32_16x16x32_bf16 v[72:75], v[204:207], v[240:243], v[72:75]
    v_add_u32 v4, s33, v7
    v_mfma_f32_16x16x32_bf16 v[76:79], v[208:211], v[240:243], v[76:79]
    v_lshl_add_u32 v252, v5, 4, s33
    v_mfma_f32_16x16x32_bf16 v[80:83], v[204:207], v[244:247], v[80:83]
    v_add_u32 v7, 159744, v7
    v_mfma_f32_16x16x32_bf16 v[84:87], v[208:211], v[244:247], v[84:87]
    s_waitcnt vmcnt(0)
    v_add_f32 v248, v8, v10
    s_waitcnt lgkmcnt(5)
    v_mfma_f32_16x16x32_bf16 v[16:19], v[160:163], v[168:171], v[16:19]
    ds_read_b128 v[204:207], v3 offset:37888
    v_mfma_f32_16x16x32_bf16 v[20:23], v[164:167], v[168:171], v[20:23]
    ds_read_b128 v[208:211], v3 offset:39936
    v_mfma_f32_16x16x32_bf16 v[24:27], v[160:163], v[172:175], v[24:27]
    ds_read_b128 v[212:215], v1 offset:46080
    v_mfma_f32_16x16x32_bf16 v[28:31], v[164:167], v[172:175], v[28:31]
    ds_read_b128 v[216:219], v1 offset:47104
    v_mfma_f32_16x16x32_bf16 v[32:35], v[160:163], v[176:179], v[32:35]
    ds_read_b128 v[220:223], v1 offset:48128
    v_mfma_f32_16x16x32_bf16 v[36:39], v[164:167], v[176:179], v[36:39]
    ds_read_b128 v[224:227], v1 offset:49152
    v_mfma_f32_16x16x32_bf16 v[40:43], v[160:163], v[180:183], v[40:43]
    ds_read_b128 v[228:231], v1 offset:50176
    v_mfma_f32_16x16x32_bf16 v[44:47], v[164:167], v[180:183], v[44:47]
    ds_read_b128 v[232:235], v1 offset:51200
    s_waitcnt lgkmcnt(8)
    v_mfma_f32_16x16x32_bf16 v[48:51], v[160:163], v[184:187], v[48:51]
    ds_read_b128 v[236:239], v1 offset:52224
    v_mfma_f32_16x16x32_bf16 v[52:55], v[164:167], v[184:187], v[52:55]
    ds_read_b128 v[240:243], v1 offset:53248
    v_add_f32 v249, v9, v11
    v_mfma_f32_16x16x32_bf16 v[56:59], v[160:163], v[188:191], v[56:59]
    ds_read_b128 v[244:247], v1 offset:54272
    v_add_f32 v250, v12, v14
    v_mfma_f32_16x16x32_bf16 v[60:63], v[164:167], v[188:191], v[60:63]
    v_add_f32 v251, v13, v15
    v_mfma_f32_16x16x32_bf16 v[64:67], v[160:163], v[192:195], v[64:67]
    v_mov_b32 v8, v248
    v_mfma_f32_16x16x32_bf16 v[68:71], v[164:167], v[192:195], v[68:71]
    v_mov_b32 v9, v249
    v_mfma_f32_16x16x32_bf16 v[72:75], v[160:163], v[196:199], v[72:75]
    v_mov_b32 v12, v250
    v_mfma_f32_16x16x32_bf16 v[76:79], v[164:167], v[196:199], v[76:79]
    v_mov_b32 v13, v251
    v_mfma_f32_16x16x32_bf16 v[80:83], v[160:163], v[200:203], v[80:83]
    v_permlane32_swap_b32 v248, v8
    v_mfma_f32_16x16x32_bf16 v[84:87], v[164:167], v[200:203], v[84:87]
    v_permlane32_swap_b32 v249, v9
    v_permlane32_swap_b32 v250, v12
    s_waitcnt lgkmcnt(0)
    s_barrier
    v_mfma_f32_16x16x32_bf16 v[16:19], v[204:207], v[212:215], v[16:19]
    ds_read_b128 v[160:163], v0 offset:0
    v_mfma_f32_16x16x32_bf16 v[20:23], v[208:211], v[212:215], v[20:23]
    ds_read_b128 v[164:167], v0 offset:2048
    v_mfma_f32_16x16x32_bf16 v[24:27], v[204:207], v[216:219], v[24:27]
    ds_read_b128 v[168:171], v2 offset:0
    v_mfma_f32_16x16x32_bf16 v[28:31], v[208:211], v[216:219], v[28:31]
    ds_read_b128 v[172:175], v2 offset:1024
    v_mfma_f32_16x16x32_bf16 v[32:35], v[204:207], v[220:223], v[32:35]
    ds_read_b128 v[176:179], v2 offset:2048
    v_mfma_f32_16x16x32_bf16 v[36:39], v[208:211], v[220:223], v[36:39]
    ds_read_b128 v[180:183], v2 offset:3072
    v_mfma_f32_16x16x32_bf16 v[40:43], v[204:207], v[224:227], v[40:43]
    ds_read_b128 v[184:187], v2 offset:4096
    v_mfma_f32_16x16x32_bf16 v[44:47], v[208:211], v[224:227], v[44:47]
    ds_read_b128 v[188:191], v2 offset:5120
    v_mfma_f32_16x16x32_bf16 v[48:51], v[204:207], v[228:231], v[48:51]
    ds_read_b128 v[192:195], v2 offset:6144
    v_mfma_f32_16x16x32_bf16 v[52:55], v[208:211], v[228:231], v[52:55]
    ds_read_b128 v[196:199], v2 offset:7168
    v_permlane32_swap_b32 v251, v13
    v_mfma_f32_16x16x32_bf16 v[56:59], v[204:207], v[232:235], v[56:59]
    ds_read_b128 v[200:203], v2 offset:8192
    v_add_f32 v248, v248, v8
    v_mfma_f32_16x16x32_bf16 v[60:63], v[208:211], v[232:235], v[60:63]
    ds_read2_b32 v[128:129], v7 offset0:0 offset1:16
    v_add_f32 v249, v249, v9
    v_mfma_f32_16x16x32_bf16 v[64:67], v[204:207], v[236:239], v[64:67]
    ds_read2_b32 v[130:131], v7 offset0:32 offset1:48
    v_add_f32 v250, v250, v12
    v_mfma_f32_16x16x32_bf16 v[68:71], v[208:211], v[236:239], v[68:71]
    ds_read2_b32 v[132:133], v7 offset0:64 offset1:80
    v_add_f32 v251, v251, v13
    v_mfma_f32_16x16x32_bf16 v[72:75], v[204:207], v[240:243], v[72:75]
    ds_read2_b32 v[134:135], v7 offset0:96 offset1:112
    v_mov_b32 v8, v248
    v_mfma_f32_16x16x32_bf16 v[76:79], v[208:211], v[240:243], v[76:79]
    ds_read2_b32 v[136:137], v7 offset0:128 offset1:144
    v_mov_b32 v9, v249
    v_mfma_f32_16x16x32_bf16 v[80:83], v[204:207], v[244:247], v[80:83]
    v_mov_b32 v12, v250
    v_mfma_f32_16x16x32_bf16 v[84:87], v[208:211], v[244:247], v[84:87]
    v_mov_b32 v13, v251
    v_permlane16_swap_b32 v248, v8
    s_waitcnt lgkmcnt(10)
    v_mfma_f32_16x16x32_bf16 v[16:19], v[160:163], v[168:171], v[16:19]
    ds_read_b128 v[204:207], v0 offset:1024
    v_mfma_f32_16x16x32_bf16 v[20:23], v[164:167], v[168:171], v[20:23]
    ds_read_b128 v[208:211], v0 offset:3072
    v_mfma_f32_16x16x32_bf16 v[24:27], v[160:163], v[172:175], v[24:27]
    ds_read_b128 v[212:215], v2 offset:9216
    v_mfma_f32_16x16x32_bf16 v[28:31], v[164:167], v[172:175], v[28:31]
    ds_read_b128 v[216:219], v2 offset:10240
    v_mfma_f32_16x16x32_bf16 v[32:35], v[160:163], v[176:179], v[32:35]
    ds_read_b128 v[220:223], v2 offset:11264
    v_mfma_f32_16x16x32_bf16 v[36:39], v[164:167], v[176:179], v[36:39]
    ds_read_b128 v[224:227], v2 offset:12288
    v_mfma_f32_16x16x32_bf16 v[40:43], v[160:163], v[180:183], v[40:43]
    ds_read_b128 v[228:231], v2 offset:13312
    v_mfma_f32_16x16x32_bf16 v[44:47], v[164:167], v[180:183], v[44:47]
    ds_read_b128 v[232:235], v2 offset:14336
    s_waitcnt lgkmcnt(8)
    v_mfma_f32_16x16x32_bf16 v[48:51], v[160:163], v[184:187], v[48:51]
    ds_read_b128 v[236:239], v2 offset:15360
    v_mfma_f32_16x16x32_bf16 v[52:55], v[164:167], v[184:187], v[52:55]
    ds_read_b128 v[240:243], v2 offset:16384
    v_permlane16_swap_b32 v249, v9
    v_mfma_f32_16x16x32_bf16 v[56:59], v[160:163], v[188:191], v[56:59]
    ds_read_b128 v[244:247], v2 offset:17408
    v_permlane16_swap_b32 v250, v12
    v_mfma_f32_16x16x32_bf16 v[60:63], v[164:167], v[188:191], v[60:63]
    v_permlane16_swap_b32 v251, v13
    v_mfma_f32_16x16x32_bf16 v[64:67], v[160:163], v[192:195], v[64:67]
    v_add_f32 v248, v248, v8
    v_mfma_f32_16x16x32_bf16 v[68:71], v[164:167], v[192:195], v[68:71]
    v_add_f32 v249, v249, v9
    v_mfma_f32_16x16x32_bf16 v[72:75], v[160:163], v[196:199], v[72:75]
    v_add_f32 v250, v250, v12
    v_mfma_f32_16x16x32_bf16 v[76:79], v[164:167], v[196:199], v[76:79]
    v_add_f32 v251, v251, v13
    v_mfma_f32_16x16x32_bf16 v[80:83], v[160:163], v[200:203], v[80:83]
    v_mul_f32 v248, 0x3ae38e39, v248
    v_mfma_f32_16x16x32_bf16 v[84:87], v[164:167], v[200:203], v[84:87]
    v_mul_f32 v249, 0x3ae38e39, v249
    v_mul_f32 v250, 0x3ae38e39, v250
    s_waitcnt lgkmcnt(0)
    s_barrier
    v_mfma_f32_16x16x32_bf16 v[16:19], v[204:207], v[212:215], v[16:19]
    ds_read_b128 v[160:163], v0 offset:36864
    v_mfma_f32_16x16x32_bf16 v[20:23], v[208:211], v[212:215], v[20:23]
    ds_read_b128 v[164:167], v0 offset:38912
    v_mfma_f32_16x16x32_bf16 v[24:27], v[204:207], v[216:219], v[24:27]
    ds_read_b128 v[168:171], v2 offset:36864
    v_mfma_f32_16x16x32_bf16 v[28:31], v[208:211], v[216:219], v[28:31]
    ds_read_b128 v[172:175], v2 offset:37888
    v_mfma_f32_16x16x32_bf16 v[32:35], v[204:207], v[220:223], v[32:35]
    ds_read_b128 v[176:179], v2 offset:38912
    v_mfma_f32_16x16x32_bf16 v[36:39], v[208:211], v[220:223], v[36:39]
    ds_read_b128 v[180:183], v2 offset:39936
    v_mfma_f32_16x16x32_bf16 v[40:43], v[204:207], v[224:227], v[40:43]
    ds_read_b128 v[184:187], v2 offset:40960
    v_mfma_f32_16x16x32_bf16 v[44:47], v[208:211], v[224:227], v[44:47]
    ds_read_b128 v[188:191], v2 offset:41984
    v_mfma_f32_16x16x32_bf16 v[48:51], v[204:207], v[228:231], v[48:51]
    ds_read_b128 v[192:195], v2 offset:43008
    v_mfma_f32_16x16x32_bf16 v[52:55], v[208:211], v[228:231], v[52:55]
    ds_read_b128 v[196:199], v2 offset:44032
    v_mul_f32 v251, 0x3ae38e39, v251
    v_mfma_f32_16x16x32_bf16 v[56:59], v[204:207], v[232:235], v[56:59]
    ds_read_b128 v[200:203], v2 offset:45056
    v_fma_f32 v249, -v248, v248, v249
    v_mfma_f32_16x16x32_bf16 v[60:63], v[208:211], v[232:235], v[60:63]
    v_fma_f32 v251, -v250, v250, v251
    v_mfma_f32_16x16x32_bf16 v[64:67], v[204:207], v[236:239], v[64:67]
    v_max_f32 v249, 0, v249
    v_mfma_f32_16x16x32_bf16 v[68:71], v[208:211], v[236:239], v[68:71]
    v_max_f32 v251, 0, v251
    v_mfma_f32_16x16x32_bf16 v[72:75], v[204:207], v[240:243], v[72:75]
    v_add_f32 v249, 0x3727c5ac, v249
    v_mfma_f32_16x16x32_bf16 v[76:79], v[208:211], v[240:243], v[76:79]
    v_add_f32 v251, 0x3727c5ac, v251
    v_mfma_f32_16x16x32_bf16 v[80:83], v[204:207], v[244:247], v[80:83]
    v_rsq_f32 v249, v249
    v_mfma_f32_16x16x32_bf16 v[84:87], v[208:211], v[244:247], v[84:87]
    v_rsq_f32 v251, v251
    s_nop 0
    s_waitcnt lgkmcnt(5)
    v_mfma_f32_16x16x32_bf16 v[16:19], v[160:163], v[168:171], v[16:19]
    ds_read_b128 v[204:207], v0 offset:37888
    v_mfma_f32_16x16x32_bf16 v[20:23], v[164:167], v[168:171], v[20:23]
    ds_read_b128 v[208:211], v0 offset:39936
    v_mfma_f32_16x16x32_bf16 v[24:27], v[160:163], v[172:175], v[24:27]
    ds_read_b128 v[212:215], v2 offset:46080
    v_mfma_f32_16x16x32_bf16 v[28:31], v[164:167], v[172:175], v[28:31]
    ds_read_b128 v[216:219], v2 offset:47104
    v_mfma_f32_16x16x32_bf16 v[32:35], v[160:163], v[176:179], v[32:35]
    ds_read_b128 v[220:223], v2 offset:48128
    v_mfma_f32_16x16x32_bf16 v[36:39], v[164:167], v[176:179], v[36:39]
    ds_read_b128 v[224:227], v2 offset:49152
    v_mfma_f32_16x16x32_bf16 v[40:43], v[160:163], v[180:183], v[40:43]
    ds_read_b128 v[228:231], v2 offset:50176
    v_mfma_f32_16x16x32_bf16 v[44:47], v[164:167], v[180:183], v[44:47]
    ds_read_b128 v[232:235], v2 offset:51200
    s_waitcnt lgkmcnt(8)
    v_mfma_f32_16x16x32_bf16 v[48:51], v[160:163], v[184:187], v[48:51]
    ds_read_b128 v[236:239], v2 offset:52224
    v_mfma_f32_16x16x32_bf16 v[52:55], v[164:167], v[184:187], v[52:55]
    ds_read_b128 v[240:243], v2 offset:53248
    v_mfma_f32_16x16x32_bf16 v[56:59], v[160:163], v[188:191], v[56:59]
    ds_read_b128 v[244:247], v2 offset:54272
    v_mfma_f32_16x16x32_bf16 v[60:63], v[164:167], v[188:191], v[60:63]
    v_mfma_f32_16x16x32_bf16 v[64:67], v[160:163], v[192:195], v[64:67]
    v_mfma_f32_16x16x32_bf16 v[68:71], v[164:167], v[192:195], v[68:71]
    v_mfma_f32_16x16x32_bf16 v[72:75], v[160:163], v[196:199], v[72:75]
    v_mfma_f32_16x16x32_bf16 v[76:79], v[164:167], v[196:199], v[76:79]
    v_mfma_f32_16x16x32_bf16 v[80:83], v[160:163], v[200:203], v[80:83]
    v_mfma_f32_16x16x32_bf16 v[84:87], v[164:167], v[200:203], v[84:87]
    s_waitcnt lgkmcnt(0)
    s_barrier
    v_mfma_f32_16x16x32_bf16 v[16:19], v[204:207], v[212:215], v[16:19]
    ds_read_b128 v[160:163], v3 offset:0
    v_mfma_f32_16x16x32_bf16 v[20:23], v[208:211], v[212:215], v[20:23]
    ds_read_b128 v[164:167], v3 offset:2048
    v_mfma_f32_16x16x32_bf16 v[24:27], v[204:207], v[216:219], v[24:27]
    ds_read_b128 v[168:171], v1 offset:0
    v_mfma_f32_16x16x32_bf16 v[28:31], v[208:211], v[216:219], v[28:31]
    ds_read_b128 v[172:175], v1 offset:1024
    v_mfma_f32_16x16x32_bf16 v[32:35], v[204:207], v[220:223], v[32:35]
    ds_read_b128 v[176:179], v1 offset:2048
    v_mfma_f32_16x16x32_bf16 v[36:39], v[208:211], v[220:223], v[36:39]
    ds_read_b128 v[180:183], v1 offset:3072
    v_mfma_f32_16x16x32_bf16 v[40:43], v[204:207], v[224:227], v[40:43]
    ds_read_b128 v[184:187], v1 offset:4096
    v_mfma_f32_16x16x32_bf16 v[44:47], v[208:211], v[224:227], v[44:47]
    ds_read_b128 v[188:191], v1 offset:5120
    v_mfma_f32_16x16x32_bf16 v[48:51], v[204:207], v[228:231], v[48:51]
    ds_read_b128 v[192:195], v1 offset:6144
    v_mfma_f32_16x16x32_bf16 v[52:55], v[208:211], v[228:231], v[52:55]
    ds_read_b128 v[196:199], v1 offset:7168
    v_mfma_f32_16x16x32_bf16 v[56:59], v[204:207], v[232:235], v[56:59]
    ds_read_b128 v[200:203], v1 offset:8192
    v_mfma_f32_16x16x32_bf16 v[60:63], v[208:211], v[232:235], v[60:63]
    ds_write2_b32 v4, v248, v249 offset0:0 offset1:32
    v_mfma_f32_16x16x32_bf16 v[64:67], v[204:207], v[236:239], v[64:67]
    ds_write2_b32 v4, v250, v251 offset0:16 offset1:48
    v_mfma_f32_16x16x32_bf16 v[68:71], v[208:211], v[236:239], v[68:71]
    ds_read_b128 v[88:91], v252 offset:0
    v_mfma_f32_16x16x32_bf16 v[72:75], v[204:207], v[240:243], v[72:75]
    ds_read_b128 v[92:95], v252 offset:64
    v_mfma_f32_16x16x32_bf16 v[76:79], v[208:211], v[240:243], v[76:79]
    ds_read_b128 v[96:99], v252 offset:128
    v_mfma_f32_16x16x32_bf16 v[80:83], v[204:207], v[244:247], v[80:83]
    ds_read_b128 v[100:103], v252 offset:192
    v_mfma_f32_16x16x32_bf16 v[84:87], v[208:211], v[244:247], v[84:87]
    s_waitcnt lgkmcnt(11)
    v_mfma_f32_16x16x32_bf16 v[16:19], v[160:163], v[168:171], v[16:19]
    ds_read_b128 v[204:207], v3 offset:1024
    v_mfma_f32_16x16x32_bf16 v[20:23], v[164:167], v[168:171], v[20:23]
    ds_read_b128 v[208:211], v3 offset:3072
    v_mfma_f32_16x16x32_bf16 v[24:27], v[160:163], v[172:175], v[24:27]
    ds_read_b128 v[212:215], v1 offset:9216
    v_mfma_f32_16x16x32_bf16 v[28:31], v[164:167], v[172:175], v[28:31]
    ds_read_b128 v[216:219], v1 offset:10240
    v_mfma_f32_16x16x32_bf16 v[32:35], v[160:163], v[176:179], v[32:35]
    ds_read_b128 v[220:223], v1 offset:11264
    v_mfma_f32_16x16x32_bf16 v[36:39], v[164:167], v[176:179], v[36:39]
    ds_read_b128 v[224:227], v1 offset:12288
    v_mfma_f32_16x16x32_bf16 v[40:43], v[160:163], v[180:183], v[40:43]
    ds_read_b128 v[228:231], v1 offset:13312
    v_mfma_f32_16x16x32_bf16 v[44:47], v[164:167], v[180:183], v[44:47]
    ds_read_b128 v[232:235], v1 offset:14336
    s_waitcnt lgkmcnt(8)
    v_mfma_f32_16x16x32_bf16 v[48:51], v[160:163], v[184:187], v[48:51]
    ds_read_b128 v[236:239], v1 offset:15360
    v_mfma_f32_16x16x32_bf16 v[52:55], v[164:167], v[184:187], v[52:55]
    ds_read_b128 v[240:243], v1 offset:16384
    v_rcp_f32 v120, v96
    v_mfma_f32_16x16x32_bf16 v[56:59], v[160:163], v[188:191], v[56:59]
    ds_read_b128 v[244:247], v1 offset:17408
    v_mul_f32 v104, s40, v96
    v_mfma_f32_16x16x32_bf16 v[60:63], v[164:167], v[188:191], v[60:63]
    v_mul_f32 v112, v96, v96
    v_mfma_f32_16x16x32_bf16 v[64:67], v[160:163], v[192:195], v[64:67]
    v_rcp_f32 v121, v97
    v_mfma_f32_16x16x32_bf16 v[68:71], v[164:167], v[192:195], v[68:71]
    v_mul_f32 v105, s40, v97
    v_mfma_f32_16x16x32_bf16 v[72:75], v[160:163], v[196:199], v[72:75]
    v_mul_f32 v113, v97, v97
    v_mfma_f32_16x16x32_bf16 v[76:79], v[164:167], v[196:199], v[76:79]
    v_rcp_f32 v122, v98
    v_mfma_f32_16x16x32_bf16 v[80:83], v[160:163], v[200:203], v[80:83]
    v_mul_f32 v106, s40, v98
    v_mfma_f32_16x16x32_bf16 v[84:87], v[164:167], v[200:203], v[84:87]
    v_mul_f32 v114, v98, v98
    v_rcp_f32 v123, v99
    s_waitcnt lgkmcnt(0)
    s_barrier
    v_mfma_f32_16x16x32_bf16 v[16:19], v[204:207], v[212:215], v[16:19]
    ds_read_b128 v[160:163], v3 offset:36864
    v_mfma_f32_16x16x32_bf16 v[20:23], v[208:211], v[212:215], v[20:23]
    ds_read_b128 v[164:167], v3 offset:38912
    v_mfma_f32_16x16x32_bf16 v[24:27], v[204:207], v[216:219], v[24:27]
    ds_read_b128 v[168:171], v1 offset:36864
    v_mfma_f32_16x16x32_bf16 v[28:31], v[208:211], v[216:219], v[28:31]
    ds_read_b128 v[172:175], v1 offset:37888
    v_mfma_f32_16x16x32_bf16 v[32:35], v[204:207], v[220:223], v[32:35]
    ds_read_b128 v[176:179], v1 offset:38912
    v_mfma_f32_16x16x32_bf16 v[36:39], v[208:211], v[220:223], v[36:39]
    ds_read_b128 v[180:183], v1 offset:39936
    v_mfma_f32_16x16x32_bf16 v[40:43], v[204:207], v[224:227], v[40:43]
    ds_read_b128 v[184:187], v1 offset:40960
    v_mfma_f32_16x16x32_bf16 v[44:47], v[208:211], v[224:227], v[44:47]
    ds_read_b128 v[188:191], v1 offset:41984
    v_mfma_f32_16x16x32_bf16 v[48:51], v[204:207], v[228:231], v[48:51]
    ds_read_b128 v[192:195], v1 offset:43008
    v_mfma_f32_16x16x32_bf16 v[52:55], v[208:211], v[228:231], v[52:55]
    ds_read_b128 v[196:199], v1 offset:44032
    v_mul_f32 v107, s40, v99
    v_mfma_f32_16x16x32_bf16 v[56:59], v[204:207], v[232:235], v[56:59]
    ds_read_b128 v[200:203], v1 offset:45056
    v_mul_f32 v115, v99, v99
    v_mfma_f32_16x16x32_bf16 v[60:63], v[208:211], v[232:235], v[60:63]
    v_rcp_f32 v124, v100
    v_mfma_f32_16x16x32_bf16 v[64:67], v[204:207], v[236:239], v[64:67]
    v_mul_f32 v108, s40, v100
    v_mfma_f32_16x16x32_bf16 v[68:71], v[208:211], v[236:239], v[68:71]
    v_mul_f32 v116, v100, v100
    v_mfma_f32_16x16x32_bf16 v[72:75], v[204:207], v[240:243], v[72:75]
    v_rcp_f32 v125, v101
    v_mfma_f32_16x16x32_bf16 v[76:79], v[208:211], v[240:243], v[76:79]
    v_mul_f32 v109, s40, v101
    v_mfma_f32_16x16x32_bf16 v[80:83], v[204:207], v[244:247], v[80:83]
    v_mul_f32 v117, v101, v101
    v_mfma_f32_16x16x32_bf16 v[84:87], v[208:211], v[244:247], v[84:87]
    v_rcp_f32 v126, v102
    v_mul_f32 v110, s40, v102
    s_waitcnt lgkmcnt(5)
    v_mfma_f32_16x16x32_bf16 v[16:19], v[160:163], v[168:171], v[16:19]
    ds_read_b128 v[204:207], v3 offset:37888
    v_mfma_f32_16x16x32_bf16 v[20:23], v[164:167], v[168:171], v[20:23]
    ds_read_b128 v[208:211], v3 offset:39936
    v_mfma_f32_16x16x32_bf16 v[24:27], v[160:163], v[172:175], v[24:27]
    ds_read_b128 v[212:215], v1 offset:46080
    v_mfma_f32_16x16x32_bf16 v[28:31], v[164:167], v[172:175], v[28:31]
    ds_read_b128 v[216:219], v1 offset:47104
    v_mfma_f32_16x16x32_bf16 v[32:35], v[160:163], v[176:179], v[32:35]
    ds_read_b128 v[220:223], v1 offset:48128
    v_mfma_f32_16x16x32_bf16 v[36:39], v[164:167], v[176:179], v[36:39]
    ds_read_b128 v[224:227], v1 offset:49152
    v_mfma_f32_16x16x32_bf16 v[40:43], v[160:163], v[180:183], v[40:43]
    ds_read_b128 v[228:231], v1 offset:50176
    v_mfma_f32_16x16x32_bf16 v[44:47], v[164:167], v[180:183], v[44:47]
    ds_read_b128 v[232:235], v1 offset:51200
    s_waitcnt lgkmcnt(8)
    v_mfma_f32_16x16x32_bf16 v[48:51], v[160:163], v[184:187], v[48:51]
    ds_read_b128 v[236:239], v1 offset:52224
    v_mfma_f32_16x16x32_bf16 v[52:55], v[164:167], v[184:187], v[52:55]
    ds_read_b128 v[240:243], v1 offset:53248
    v_mul_f32 v118, v102, v102
    v_mfma_f32_16x16x32_bf16 v[56:59], v[160:163], v[188:191], v[56:59]
    ds_read_b128 v[244:247], v1 offset:54272
    v_rcp_f32 v127, v103
    v_mfma_f32_16x16x32_bf16 v[60:63], v[164:167], v[188:191], v[60:63]
    v_mul_f32 v111, s40, v103
    v_mfma_f32_16x16x32_bf16 v[64:67], v[160:163], v[192:195], v[64:67]
    v_mul_f32 v119, v103, v103
    v_mfma_f32_16x16x32_bf16 v[68:71], v[164:167], v[192:195], v[68:71]
    v_mul_f32 v112, s42, v112
    v_mfma_f32_16x16x32_bf16 v[72:75], v[160:163], v[196:199], v[72:75]
    v_mul_f32 v113, s42, v113
    v_mfma_f32_16x16x32_bf16 v[76:79], v[164:167], v[196:199], v[76:79]
    v_mul_f32 v114, s42, v114
    v_mfma_f32_16x16x32_bf16 v[80:83], v[160:163], v[200:203], v[80:83]
    v_mul_f32 v115, s42, v115
    v_mfma_f32_16x16x32_bf16 v[84:87], v[164:167], v[200:203], v[84:87]
    v_mul_f32 v116, s42, v116
    v_mul_f32 v117, s42, v117
    s_waitcnt lgkmcnt(0)
    s_barrier
    v_mfma_f32_16x16x32_bf16 v[16:19], v[204:207], v[212:215], v[16:19]
    ds_read_b128 v[160:163], v0 offset:0
    v_mfma_f32_16x16x32_bf16 v[20:23], v[208:211], v[212:215], v[20:23]
    ds_read_b128 v[164:167], v0 offset:2048
    v_mfma_f32_16x16x32_bf16 v[24:27], v[204:207], v[216:219], v[24:27]
    ds_read_b128 v[168:171], v2 offset:0
    v_mfma_f32_16x16x32_bf16 v[28:31], v[208:211], v[216:219], v[28:31]
    ds_read_b128 v[172:175], v2 offset:1024
    v_mfma_f32_16x16x32_bf16 v[32:35], v[204:207], v[220:223], v[32:35]
    ds_read_b128 v[176:179], v2 offset:2048
    v_mfma_f32_16x16x32_bf16 v[36:39], v[208:211], v[220:223], v[36:39]
    ds_read_b128 v[180:183], v2 offset:3072
    v_mfma_f32_16x16x32_bf16 v[40:43], v[204:207], v[224:227], v[40:43]
    ds_read_b128 v[184:187], v2 offset:4096
    v_mfma_f32_16x16x32_bf16 v[44:47], v[208:211], v[224:227], v[44:47]
    ds_read_b128 v[188:191], v2 offset:5120
    v_mfma_f32_16x16x32_bf16 v[48:51], v[204:207], v[228:231], v[48:51]
    ds_read_b128 v[192:195], v2 offset:6144
    v_mfma_f32_16x16x32_bf16 v[52:55], v[208:211], v[228:231], v[52:55]
    ds_read_b128 v[196:199], v2 offset:7168
    v_mul_f32 v118, s42, v118
    v_mfma_f32_16x16x32_bf16 v[56:59], v[204:207], v[232:235], v[56:59]
    ds_read_b128 v[200:203], v2 offset:8192
    v_mul_f32 v119, s42, v119
    v_mfma_f32_16x16x32_bf16 v[60:63], v[208:211], v[232:235], v[60:63]
    v_mul_f32 v112, v112, v104
    v_mfma_f32_16x16x32_bf16 v[64:67], v[204:207], v[236:239], v[64:67]
    v_mul_f32 v113, v113, v105
    v_mfma_f32_16x16x32_bf16 v[68:71], v[208:211], v[236:239], v[68:71]
    v_mul_f32 v114, v114, v106
    v_mfma_f32_16x16x32_bf16 v[72:75], v[204:207], v[240:243], v[72:75]
    v_mul_f32 v115, v115, v107
    v_mfma_f32_16x16x32_bf16 v[76:79], v[208:211], v[240:243], v[76:79]
    v_mul_f32 v116, v116, v108
    v_mfma_f32_16x16x32_bf16 v[80:83], v[204:207], v[244:247], v[80:83]
    v_mul_f32 v117, v117, v109
    v_mfma_f32_16x16x32_bf16 v[84:87], v[208:211], v[244:247], v[84:87]
    v_mul_f32 v118, v118, v110
    v_mul_f32 v119, v119, v111
    s_waitcnt lgkmcnt(5)
    v_mfma_f32_16x16x32_bf16 v[16:19], v[160:163], v[168:171], v[16:19]
    ds_read_b128 v[204:207], v0 offset:1024
    v_mfma_f32_16x16x32_bf16 v[20:23], v[164:167], v[168:171], v[20:23]
    ds_read_b128 v[208:211], v0 offset:3072
    v_mfma_f32_16x16x32_bf16 v[24:27], v[160:163], v[172:175], v[24:27]
    ds_read_b128 v[212:215], v2 offset:9216
    v_mfma_f32_16x16x32_bf16 v[28:31], v[164:167], v[172:175], v[28:31]
    ds_read_b128 v[216:219], v2 offset:10240
    v_mfma_f32_16x16x32_bf16 v[32:35], v[160:163], v[176:179], v[32:35]
    ds_read_b128 v[220:223], v2 offset:11264
    v_mfma_f32_16x16x32_bf16 v[36:39], v[164:167], v[176:179], v[36:39]
    ds_read_b128 v[224:227], v2 offset:12288
    v_mfma_f32_16x16x32_bf16 v[40:43], v[160:163], v[180:183], v[40:43]
    ds_read_b128 v[228:231], v2 offset:13312
    v_mfma_f32_16x16x32_bf16 v[44:47], v[164:167], v[180:183], v[44:47]
    ds_read_b128 v[232:235], v2 offset:14336
    s_waitcnt lgkmcnt(8)
    v_mfma_f32_16x16x32_bf16 v[48:51], v[160:163], v[184:187], v[48:51]
    ds_read_b128 v[236:239], v2 offset:15360
    v_mfma_f32_16x16x32_bf16 v[52:55], v[164:167], v[184:187], v[52:55]
    ds_read_b128 v[240:243], v2 offset:16384
    v_lshrrev_b32 v8, 2, v6
    v_mfma_f32_16x16x32_bf16 v[56:59], v[160:163], v[188:191], v[56:59]
    ds_read_b128 v[244:247], v2 offset:17408
    v_lshlrev_b32 v8, 4, v8
    v_mfma_f32_16x16x32_bf16 v[60:63], v[164:167], v[188:191], v[60:63]
    v_lshl_add_u32 v8, v5, 6, v8
    v_mfma_f32_16x16x32_bf16 v[64:67], v[160:163], v[192:195], v[64:67]
    v_and_b32 v9, 3, v6
    v_mfma_f32_16x16x32_bf16 v[68:71], v[164:167], v[192:195], v[68:71]
    v_cmp_eq_u32 vcc, 0, v9
    v_mfma_f32_16x16x32_bf16 v[72:75], v[160:163], v[196:199], v[72:75]
    v_bfrev_b32 v10, 1
    v_mfma_f32_16x16x32_bf16 v[76:79], v[164:167], v[196:199], v[76:79]
    v_lshlrev_b32 v9, 4, v9
    v_mfma_f32_16x16x32_bf16 v[80:83], v[160:163], v[200:203], v[80:83]
    v_cndmask_b32 v8, v10, v8, vcc
    v_mfma_f32_16x16x32_bf16 v[84:87], v[164:167], v[200:203], v[84:87]
    v_lshl_add_u32 v9, v5, 6, v9
    v_lshrrev_b32 v255, 2, v6
    s_waitcnt lgkmcnt(0)
    s_barrier
    v_mfma_f32_16x16x32_bf16 v[16:19], v[204:207], v[212:215], v[16:19]
    ds_read_b128 v[160:163], v0 offset:36864
    v_fma_f32 v52, -v92, v132, v52
    v_mfma_f32_16x16x32_bf16 v[20:23], v[208:211], v[212:215], v[20:23]
    ds_read_b128 v[164:167], v0 offset:38912
    v_fma_f32 v56, -v88, v133, v56
    v_mfma_f32_16x16x32_bf16 v[24:27], v[204:207], v[216:219], v[24:27]
    ds_read_b128 v[168:171], v2 offset:36864
    v_fma_f32 v60, -v92, v133, v60
    v_mfma_f32_16x16x32_bf16 v[28:31], v[208:211], v[216:219], v[28:31]
    ds_read_b128 v[172:175], v2 offset:37888
    v_fma_f32 v64, -v88, v134, v64
    v_mfma_f32_16x16x32_bf16 v[32:35], v[204:207], v[220:223], v[32:35]
    ds_read_b128 v[176:179], v2 offset:38912
    v_fma_f32 v68, -v92, v134, v68
    v_mfma_f32_16x16x32_bf16 v[36:39], v[208:211], v[220:223], v[36:39]
    ds_read_b128 v[180:183], v2 offset:39936
    v_fma_f32 v72, -v88, v135, v72
    v_mfma_f32_16x16x32_bf16 v[40:43], v[204:207], v[224:227], v[40:43]
    ds_read_b128 v[184:187], v2 offset:40960
    v_fma_f32 v76, -v92, v135, v76
    v_mfma_f32_16x16x32_bf16 v[44:47], v[208:211], v[224:227], v[44:47]
    ds_read_b128 v[188:191], v2 offset:41984
    v_fma_f32 v80, -v88, v136, v80
    v_mfma_f32_16x16x32_bf16 v[48:51], v[204:207], v[228:231], v[48:51]
    ds_read_b128 v[192:195], v2 offset:43008
    v_fma_f32 v84, -v92, v136, v84
    v_mfma_f32_16x16x32_bf16 v[52:55], v[208:211], v[228:231], v[52:55]
    ds_read_b128 v[196:199], v2 offset:44032
    v_lshl_add_u32 v255, v255, 8, v9
    v_fma_f32 v16, -v88, v128, v16
    v_mfma_f32_16x16x32_bf16 v[56:59], v[204:207], v[232:235], v[56:59]
    ds_read_b128 v[200:203], v2 offset:45056
    v_fma_f32 v20, -v92, v128, v20
    v_mfma_f32_16x16x32_bf16 v[60:63], v[208:211], v[232:235], v[60:63]
    v_fma_f32 v24, -v88, v129, v24
    v_mfma_f32_16x16x32_bf16 v[64:67], v[204:207], v[236:239], v[64:67]
    v_fma_f32 v28, -v92, v129, v28
    v_mfma_f32_16x16x32_bf16 v[68:71], v[208:211], v[236:239], v[68:71]
    v_fma_f32 v32, -v88, v130, v32
    v_mfma_f32_16x16x32_bf16 v[72:75], v[204:207], v[240:243], v[72:75]
    v_fma_f32 v36, -v92, v130, v36
    v_mfma_f32_16x16x32_bf16 v[76:79], v[208:211], v[240:243], v[76:79]
    v_fma_f32 v40, -v88, v131, v40
    v_mfma_f32_16x16x32_bf16 v[80:83], v[204:207], v[244:247], v[80:83]
    v_fma_f32 v44, -v92, v131, v44
    v_mfma_f32_16x16x32_bf16 v[84:87], v[208:211], v[244:247], v[84:87]
    v_fma_f32 v48, -v88, v132, v48
    s_waitcnt lgkmcnt(5)
    v_mfma_f32_16x16x32_bf16 v[16:19], v[160:163], v[168:171], v[16:19]
    ds_read_b128 v[204:207], v0 offset:37888
    v_fma_f32 v53, -v93, v132, v53
    v_mfma_f32_16x16x32_bf16 v[20:23], v[164:167], v[168:171], v[20:23]
    ds_read_b128 v[208:211], v0 offset:39936
    v_fma_f32 v57, -v89, v133, v57
    v_mfma_f32_16x16x32_bf16 v[24:27], v[160:163], v[172:175], v[24:27]
    ds_read_b128 v[212:215], v2 offset:46080
    v_fma_f32 v61, -v93, v133, v61
    v_mfma_f32_16x16x32_bf16 v[28:31], v[164:167], v[172:175], v[28:31]
    ds_read_b128 v[216:219], v2 offset:47104
    v_fma_f32 v65, -v89, v134, v65
    v_mfma_f32_16x16x32_bf16 v[32:35], v[160:163], v[176:179], v[32:35]
    ds_read_b128 v[220:223], v2 offset:48128
    v_fma_f32 v69, -v93, v134, v69
    v_mfma_f32_16x16x32_bf16 v[36:39], v[164:167], v[176:179], v[36:39]
    ds_read_b128 v[224:227], v2 offset:49152
    v_fma_f32 v73, -v89, v135, v73
    v_mfma_f32_16x16x32_bf16 v[40:43], v[160:163], v[180:183], v[40:43]
    ds_read_b128 v[228:231], v2 offset:50176
    v_fma_f32 v77, -v93, v135, v77
    v_mfma_f32_16x16x32_bf16 v[44:47], v[164:167], v[180:183], v[44:47]
    ds_read_b128 v[232:235], v2 offset:51200
    s_waitcnt lgkmcnt(8)
    v_fma_f32 v81, -v89, v136, v81
    v_mfma_f32_16x16x32_bf16 v[48:51], v[160:163], v[184:187], v[48:51]
    ds_read_b128 v[236:239], v2 offset:52224
    v_fma_f32 v85, -v93, v136, v85
    v_mfma_f32_16x16x32_bf16 v[52:55], v[164:167], v[184:187], v[52:55]
    ds_read_b128 v[240:243], v2 offset:53248
    v_fma_f32 v17, -v89, v128, v17
    v_mfma_f32_16x16x32_bf16 v[56:59], v[160:163], v[188:191], v[56:59]
    ds_read_b128 v[244:247], v2 offset:54272
    v_fma_f32 v21, -v93, v128, v21
    v_mfma_f32_16x16x32_bf16 v[60:63], v[164:167], v[188:191], v[60:63]
    v_fma_f32 v25, -v89, v129, v25
    v_mfma_f32_16x16x32_bf16 v[64:67], v[160:163], v[192:195], v[64:67]
    v_fma_f32 v29, -v93, v129, v29
    v_mfma_f32_16x16x32_bf16 v[68:71], v[164:167], v[192:195], v[68:71]
    v_fma_f32 v33, -v89, v130, v33
    v_mfma_f32_16x16x32_bf16 v[72:75], v[160:163], v[196:199], v[72:75]
    v_fma_f32 v37, -v93, v130, v37
    v_mfma_f32_16x16x32_bf16 v[76:79], v[164:167], v[196:199], v[76:79]
    v_fma_f32 v41, -v89, v131, v41
    v_mfma_f32_16x16x32_bf16 v[80:83], v[160:163], v[200:203], v[80:83]
    v_fma_f32 v45, -v93, v131, v45
    v_mfma_f32_16x16x32_bf16 v[84:87], v[164:167], v[200:203], v[84:87]
    v_fma_f32 v49, -v89, v132, v49
    s_waitcnt lgkmcnt(0)
    s_barrier
    v_mfma_f32_16x16x32_bf16 v[16:19], v[204:207], v[212:215], v[16:19]
    ds_read_b128 v[160:163], v3 offset:0
    v_fma_f32 v54, -v94, v132, v54
    v_mfma_f32_16x16x32_bf16 v[20:23], v[208:211], v[212:215], v[20:23]
    ds_read_b128 v[164:167], v3 offset:2048
    v_fma_f32 v58, -v90, v133, v58
    v_mfma_f32_16x16x32_bf16 v[24:27], v[204:207], v[216:219], v[24:27]
    ds_read_b128 v[168:171], v1 offset:0
    v_fma_f32 v62, -v94, v133, v62
    v_mfma_f32_16x16x32_bf16 v[28:31], v[208:211], v[216:219], v[28:31]
    ds_read_b128 v[172:175], v1 offset:1024
    v_fma_f32 v66, -v90, v134, v66
    v_mfma_f32_16x16x32_bf16 v[32:35], v[204:207], v[220:223], v[32:35]
    ds_read_b128 v[176:179], v1 offset:2048
    v_fma_f32 v70, -v94, v134, v70
    v_mfma_f32_16x16x32_bf16 v[36:39], v[208:211], v[220:223], v[36:39]
    ds_read_b128 v[180:183], v1 offset:3072
    v_fma_f32 v74, -v90, v135, v74
    v_mfma_f32_16x16x32_bf16 v[40:43], v[204:207], v[224:227], v[40:43]
    ds_read_b128 v[184:187], v1 offset:4096
    v_fma_f32 v78, -v94, v135, v78
    v_mfma_f32_16x16x32_bf16 v[44:47], v[208:211], v[224:227], v[44:47]
    ds_read_b128 v[188:191], v1 offset:5120
    v_fma_f32 v82, -v90, v136, v82
    v_mfma_f32_16x16x32_bf16 v[48:51], v[204:207], v[228:231], v[48:51]
    ds_read_b128 v[192:195], v1 offset:6144
    v_fma_f32 v86, -v94, v136, v86
    v_mfma_f32_16x16x32_bf16 v[52:55], v[208:211], v[228:231], v[52:55]
    ds_read_b128 v[196:199], v1 offset:7168
    v_fma_f32 v18, -v90, v128, v18
    v_mfma_f32_16x16x32_bf16 v[56:59], v[204:207], v[232:235], v[56:59]
    ds_read_b128 v[200:203], v1 offset:8192
    v_fma_f32 v22, -v94, v128, v22
    v_mfma_f32_16x16x32_bf16 v[60:63], v[208:211], v[232:235], v[60:63]
    v_fma_f32 v26, -v90, v129, v26
    v_mfma_f32_16x16x32_bf16 v[64:67], v[204:207], v[236:239], v[64:67]
    v_fma_f32 v30, -v94, v129, v30
    v_mfma_f32_16x16x32_bf16 v[68:71], v[208:211], v[236:239], v[68:71]
    v_fma_f32 v34, -v90, v130, v34
    v_mfma_f32_16x16x32_bf16 v[72:75], v[204:207], v[240:243], v[72:75]
    v_fma_f32 v38, -v94, v130, v38
    v_mfma_f32_16x16x32_bf16 v[76:79], v[208:211], v[240:243], v[76:79]
    v_fma_f32 v42, -v90, v131, v42
    v_mfma_f32_16x16x32_bf16 v[80:83], v[204:207], v[244:247], v[80:83]
    v_fma_f32 v46, -v94, v131, v46
    v_mfma_f32_16x16x32_bf16 v[84:87], v[208:211], v[244:247], v[84:87]
    v_fma_f32 v50, -v90, v132, v50
    s_waitcnt lgkmcnt(5)
    v_mfma_f32_16x16x32_bf16 v[16:19], v[160:163], v[168:171], v[16:19]
    ds_read_b128 v[204:207], v3 offset:1024
    v_fma_f32 v55, -v95, v132, v55
    v_mfma_f32_16x16x32_bf16 v[20:23], v[164:167], v[168:171], v[20:23]
    ds_read_b128 v[208:211], v3 offset:3072
    v_fma_f32 v59, -v91, v133, v59
    v_mfma_f32_16x16x32_bf16 v[24:27], v[160:163], v[172:175], v[24:27]
    ds_read_b128 v[212:215], v1 offset:9216
    v_fma_f32 v63, -v95, v133, v63
    v_mfma_f32_16x16x32_bf16 v[28:31], v[164:167], v[172:175], v[28:31]
    ds_read_b128 v[216:219], v1 offset:10240
    v_fma_f32 v67, -v91, v134, v67
    v_mfma_f32_16x16x32_bf16 v[32:35], v[160:163], v[176:179], v[32:35]
    ds_read_b128 v[220:223], v1 offset:11264
    v_fma_f32 v71, -v95, v134, v71
    v_mfma_f32_16x16x32_bf16 v[36:39], v[164:167], v[176:179], v[36:39]
    ds_read_b128 v[224:227], v1 offset:12288
    v_fma_f32 v75, -v91, v135, v75
    v_mfma_f32_16x16x32_bf16 v[40:43], v[160:163], v[180:183], v[40:43]
    ds_read_b128 v[228:231], v1 offset:13312
    v_fma_f32 v79, -v95, v135, v79
    v_mfma_f32_16x16x32_bf16 v[44:47], v[164:167], v[180:183], v[44:47]
    ds_read_b128 v[232:235], v1 offset:14336
    s_waitcnt lgkmcnt(8)
    v_fma_f32 v83, -v91, v136, v83
    v_mfma_f32_16x16x32_bf16 v[48:51], v[160:163], v[184:187], v[48:51]
    ds_read_b128 v[236:239], v1 offset:15360
    v_fma_f32 v87, -v95, v136, v87
    v_mfma_f32_16x16x32_bf16 v[52:55], v[164:167], v[184:187], v[52:55]
    ds_read_b128 v[240:243], v1 offset:16384
    v_fma_f32 v19, -v91, v128, v19
    v_mfma_f32_16x16x32_bf16 v[56:59], v[160:163], v[188:191], v[56:59]
    ds_read_b128 v[244:247], v1 offset:17408
    v_fma_f32 v23, -v95, v128, v23
    v_mfma_f32_16x16x32_bf16 v[60:63], v[164:167], v[188:191], v[60:63]
    v_fma_f32 v27, -v91, v129, v27
    v_mfma_f32_16x16x32_bf16 v[64:67], v[160:163], v[192:195], v[64:67]
    v_fma_f32 v31, -v95, v129, v31
    v_mfma_f32_16x16x32_bf16 v[68:71], v[164:167], v[192:195], v[68:71]
    v_fma_f32 v35, -v91, v130, v35
    v_mfma_f32_16x16x32_bf16 v[72:75], v[160:163], v[196:199], v[72:75]
    v_fma_f32 v39, -v95, v130, v39
    v_mfma_f32_16x16x32_bf16 v[76:79], v[164:167], v[196:199], v[76:79]
    v_fma_f32 v43, -v91, v131, v43
    v_mfma_f32_16x16x32_bf16 v[80:83], v[160:163], v[200:203], v[80:83]
    v_fma_f32 v47, -v95, v131, v47
    v_mfma_f32_16x16x32_bf16 v[84:87], v[164:167], v[200:203], v[84:87]
    v_fma_f32 v51, -v91, v132, v51
    s_waitcnt lgkmcnt(0)
    s_barrier
    v_mfma_f32_16x16x32_bf16 v[16:19], v[204:207], v[212:215], v[16:19]
    ds_read_b128 v[160:163], v3 offset:36864
    v_mfma_f32_16x16x32_bf16 v[20:23], v[208:211], v[212:215], v[20:23]
    ds_read_b128 v[164:167], v3 offset:38912
    v_mfma_f32_16x16x32_bf16 v[24:27], v[204:207], v[216:219], v[24:27]
    ds_read_b128 v[168:171], v1 offset:36864
    v_mfma_f32_16x16x32_bf16 v[28:31], v[208:211], v[216:219], v[28:31]
    ds_read_b128 v[172:175], v1 offset:37888
    v_mfma_f32_16x16x32_bf16 v[32:35], v[204:207], v[220:223], v[32:35]
    ds_read_b128 v[176:179], v1 offset:38912
    v_mfma_f32_16x16x32_bf16 v[36:39], v[208:211], v[220:223], v[36:39]
    ds_read_b128 v[180:183], v1 offset:39936
    v_mfma_f32_16x16x32_bf16 v[40:43], v[204:207], v[224:227], v[40:43]
    ds_read_b128 v[184:187], v1 offset:40960
    v_mfma_f32_16x16x32_bf16 v[44:47], v[208:211], v[224:227], v[44:47]
    ds_read_b128 v[188:191], v1 offset:41984
    v_mfma_f32_16x16x32_bf16 v[48:51], v[204:207], v[228:231], v[48:51]
    ds_read_b128 v[192:195], v1 offset:43008
    v_mfma_f32_16x16x32_bf16 v[52:55], v[208:211], v[228:231], v[52:55]
    ds_read_b128 v[196:199], v1 offset:44032
    v_mfma_f32_16x16x32_bf16 v[56:59], v[204:207], v[232:235], v[56:59]
    ds_read_b128 v[200:203], v1 offset:45056
    v_mfma_f32_16x16x32_bf16 v[60:63], v[208:211], v[232:235], v[60:63]
    v_mfma_f32_16x16x32_bf16 v[64:67], v[204:207], v[236:239], v[64:67]
    v_mfma_f32_16x16x32_bf16 v[68:71], v[208:211], v[236:239], v[68:71]
    v_mfma_f32_16x16x32_bf16 v[72:75], v[204:207], v[240:243], v[72:75]
    v_mfma_f32_16x16x32_bf16 v[76:79], v[208:211], v[240:243], v[76:79]
    v_mfma_f32_16x16x32_bf16 v[80:83], v[204:207], v[244:247], v[80:83]
    v_mfma_f32_16x16x32_bf16 v[84:87], v[208:211], v[244:247], v[84:87]
    v_pk_mul_f32 v[220:221], v[16:17], v[16:17]
    v_pk_mul_f32 v[222:223], v[18:19], v[18:19]
    v_pk_mul_f32 v[224:225], v[20:21], v[20:21]
    v_pk_mul_f32 v[226:227], v[22:23], v[22:23]
    v_pk_fma_f32 v[220:221], v[220:221], v[112:113], v[104:105]
    v_pk_fma_f32 v[222:223], v[222:223], v[114:115], v[106:107]
    v_pk_fma_f32 v[224:225], v[224:225], v[116:117], v[108:109]
    v_pk_fma_f32 v[226:227], v[226:227], v[118:119], v[110:111]
    v_pk_mul_f32 v[220:221], v[220:221], v[16:17]
    v_pk_mul_f32 v[222:223], v[222:223], v[18:19]
    v_pk_mul_f32 v[224:225], v[224:225], v[20:21]
    v_pk_mul_f32 v[226:227], v[226:227], v[22:23]
    v_exp_f32 v220, v220
    v_exp_f32 v221, v221
    v_exp_f32 v222, v222
    v_exp_f32 v223, v223
    v_exp_f32 v224, v224
    v_exp_f32 v225, v225
    v_exp_f32 v226, v226
    v_exp_f32 v227, v227
    v_pk_fma_f32 v[220:221], v[220:221], v[120:121], v[120:121]
    v_pk_fma_f32 v[222:223], v[222:223], v[122:123], v[122:123]
    v_pk_fma_f32 v[224:225], v[224:225], v[124:125], v[124:125]
    v_pk_fma_f32 v[226:227], v[226:227], v[126:127], v[126:127]
    v_rcp_f32 v220, v220
    v_rcp_f32 v221, v221
    v_rcp_f32 v222, v222
    v_rcp_f32 v223, v223
    v_rcp_f32 v224, v224
    v_rcp_f32 v225, v225
    v_rcp_f32 v226, v226
    v_rcp_f32 v227, v227
    v_pk_mul_f32 v[16:17], v[16:17], v[220:221]
    v_pk_mul_f32 v[18:19], v[18:19], v[222:223]
    v_pk_mul_f32 v[20:21], v[20:21], v[224:225]
    v_pk_mul_f32 v[22:23], v[22:23], v[226:227]
    v_pk_mul_f32 v[206:207], v[16:17], v[16:17]
    v_pk_mul_f32 v[210:211], v[18:19], v[18:19]
    v_pk_mul_f32 v[214:215], v[20:21], v[20:21]
    v_pk_mul_f32 v[218:219], v[22:23], v[22:23]
    v_pk_mul_f32 v[228:229], v[24:25], v[24:25]
    v_pk_mul_f32 v[230:231], v[26:27], v[26:27]
    v_pk_mul_f32 v[232:233], v[28:29], v[28:29]
    v_pk_mul_f32 v[234:235], v[30:31], v[30:31]
    v_pk_fma_f32 v[228:229], v[228:229], v[112:113], v[104:105]
    v_pk_fma_f32 v[230:231], v[230:231], v[114:115], v[106:107]
    v_pk_fma_f32 v[232:233], v[232:233], v[116:117], v[108:109]
    v_pk_fma_f32 v[234:235], v[234:235], v[118:119], v[110:111]
    v_pk_mul_f32 v[228:229], v[228:229], v[24:25]
    v_pk_mul_f32 v[230:231], v[230:231], v[26:27]
    v_pk_mul_f32 v[232:233], v[232:233], v[28:29]
    v_pk_mul_f32 v[234:235], v[234:235], v[30:31]
    v_exp_f32 v228, v228
    v_exp_f32 v229, v229
    v_exp_f32 v230, v230
    v_exp_f32 v231, v231
    v_exp_f32 v232, v232
    v_exp_f32 v233, v233
    v_exp_f32 v234, v234
    v_exp_f32 v235, v235
    v_pk_fma_f32 v[228:229], v[228:229], v[120:121], v[120:121]
    v_pk_fma_f32 v[230:231], v[230:231], v[122:123], v[122:123]
    v_pk_fma_f32 v[232:233], v[232:233], v[124:125], v[124:125]
    v_pk_fma_f32 v[234:235], v[234:235], v[126:127], v[126:127]
    v_rcp_f32 v228, v228
    v_rcp_f32 v229, v229
    v_rcp_f32 v230, v230
    v_rcp_f32 v231, v231
    v_rcp_f32 v232, v232
    v_rcp_f32 v233, v233
    v_rcp_f32 v234, v234
    v_rcp_f32 v235, v235
    v_pk_mul_f32 v[24:25], v[24:25], v[228:229]
    v_pk_mul_f32 v[26:27], v[26:27], v[230:231]
    v_pk_mul_f32 v[28:29], v[28:29], v[232:233]
    v_pk_mul_f32 v[30:31], v[30:31], v[234:235]
    v_pk_add_f32 v[204:205], v[16:17], v[24:25]
    v_pk_fma_f32 v[206:207], v[24:25], v[24:25], v[206:207]
    v_pk_add_f32 v[208:209], v[18:19], v[26:27]
    v_pk_fma_f32 v[210:211], v[26:27], v[26:27], v[210:211]
    v_pk_add_f32 v[212:213], v[20:21], v[28:29]
    v_pk_fma_f32 v[214:215], v[28:29], v[28:29], v[214:215]
    v_pk_add_f32 v[216:217], v[22:23], v[30:31]
    v_pk_fma_f32 v[218:219], v[30:31], v[30:31], v[218:219]
    v_pk_mul_f32 v[220:221], v[32:33], v[32:33]
    v_pk_mul_f32 v[222:223], v[34:35], v[34:35]
    v_pk_mul_f32 v[224:225], v[36:37], v[36:37]
    v_pk_mul_f32 v[226:227], v[38:39], v[38:39]
    v_pk_fma_f32 v[220:221], v[220:221], v[112:113], v[104:105]
    v_pk_fma_f32 v[222:223], v[222:223], v[114:115], v[106:107]
    v_pk_fma_f32 v[224:225], v[224:225], v[116:117], v[108:109]
    v_pk_fma_f32 v[226:227], v[226:227], v[118:119], v[110:111]
    v_pk_mul_f32 v[220:221], v[220:221], v[32:33]
    v_pk_mul_f32 v[222:223], v[222:223], v[34:35]
    v_pk_mul_f32 v[224:225], v[224:225], v[36:37]
    v_pk_mul_f32 v[226:227], v[226:227], v[38:39]
    v_exp_f32 v220, v220
    v_exp_f32 v221, v221
    v_exp_f32 v222, v222
    v_exp_f32 v223, v223
    v_exp_f32 v224, v224
    v_exp_f32 v225, v225
    v_exp_f32 v226, v226
    v_exp_f32 v227, v227
    v_pk_fma_f32 v[220:221], v[220:221], v[120:121], v[120:121]
    v_pk_fma_f32 v[222:223], v[222:223], v[122:123], v[122:123]
    v_pk_fma_f32 v[224:225], v[224:225], v[124:125], v[124:125]
    v_pk_fma_f32 v[226:227], v[226:227], v[126:127], v[126:127]
    v_rcp_f32 v220, v220
    v_rcp_f32 v221, v221
    v_rcp_f32 v222, v222
    v_rcp_f32 v223, v223
    v_rcp_f32 v224, v224
    v_rcp_f32 v225, v225
    v_rcp_f32 v226, v226
    v_rcp_f32 v227, v227
    v_pk_mul_f32 v[32:33], v[32:33], v[220:221]
    v_pk_mul_f32 v[34:35], v[34:35], v[222:223]
    v_pk_mul_f32 v[36:37], v[36:37], v[224:225]
    v_pk_mul_f32 v[38:39], v[38:39], v[226:227]
    v_pk_add_f32 v[204:205], v[204:205], v[32:33]
    v_pk_fma_f32 v[206:207], v[32:33], v[32:33], v[206:207]
    v_pk_add_f32 v[208:209], v[208:209], v[34:35]
    v_pk_fma_f32 v[210:211], v[34:35], v[34:35], v[210:211]
    v_pk_add_f32 v[212:213], v[212:213], v[36:37]
    v_pk_fma_f32 v[214:215], v[36:37], v[36:37], v[214:215]
    v_pk_add_f32 v[216:217], v[216:217], v[38:39]
    v_pk_fma_f32 v[218:219], v[38:39], v[38:39], v[218:219]
    v_pk_mul_f32 v[228:229], v[40:41], v[40:41]
    v_pk_mul_f32 v[230:231], v[42:43], v[42:43]
    v_pk_mul_f32 v[232:233], v[44:45], v[44:45]
    v_pk_mul_f32 v[234:235], v[46:47], v[46:47]
    v_pk_fma_f32 v[228:229], v[228:229], v[112:113], v[104:105]
    v_pk_fma_f32 v[230:231], v[230:231], v[114:115], v[106:107]
    v_pk_fma_f32 v[232:233], v[232:233], v[116:117], v[108:109]
    v_pk_fma_f32 v[234:235], v[234:235], v[118:119], v[110:111]
    v_pk_mul_f32 v[228:229], v[228:229], v[40:41]
    v_pk_mul_f32 v[230:231], v[230:231], v[42:43]
    v_pk_mul_f32 v[232:233], v[232:233], v[44:45]
    v_pk_mul_f32 v[234:235], v[234:235], v[46:47]
    v_exp_f32 v228, v228
    v_exp_f32 v229, v229
    v_exp_f32 v230, v230
    v_exp_f32 v231, v231
    v_exp_f32 v232, v232
    v_exp_f32 v233, v233
    v_exp_f32 v234, v234
    v_exp_f32 v235, v235
    v_pk_fma_f32 v[228:229], v[228:229], v[120:121], v[120:121]
    v_pk_fma_f32 v[230:231], v[230:231], v[122:123], v[122:123]
    v_pk_fma_f32 v[232:233], v[232:233], v[124:125], v[124:125]
    v_pk_fma_f32 v[234:235], v[234:235], v[126:127], v[126:127]
    v_rcp_f32 v228, v228
    v_rcp_f32 v229, v229
    v_rcp_f32 v230, v230
    v_rcp_f32 v231, v231
    v_rcp_f32 v232, v232
    v_rcp_f32 v233, v233
    v_rcp_f32 v234, v234
    v_rcp_f32 v235, v235
    v_pk_mul_f32 v[40:41], v[40:41], v[228:229]
    v_pk_mul_f32 v[42:43], v[42:43], v[230:231]
    v_pk_mul_f32 v[44:45], v[44:45], v[232:233]
    v_pk_mul_f32 v[46:47], v[46:47], v[234:235]
    v_pk_add_f32 v[204:205], v[204:205], v[40:41]
    v_pk_fma_f32 v[206:207], v[40:41], v[40:41], v[206:207]
    v_pk_add_f32 v[208:209], v[208:209], v[42:43]
    v_pk_fma_f32 v[210:211], v[42:43], v[42:43], v[210:211]
    v_pk_add_f32 v[212:213], v[212:213], v[44:45]
    v_pk_fma_f32 v[214:215], v[44:45], v[44:45], v[214:215]
    v_pk_add_f32 v[216:217], v[216:217], v[46:47]
    v_pk_fma_f32 v[218:219], v[46:47], v[46:47], v[218:219]
    v_pk_mul_f32 v[220:221], v[48:49], v[48:49]
    v_pk_mul_f32 v[222:223], v[50:51], v[50:51]
    v_pk_mul_f32 v[224:225], v[52:53], v[52:53]
    v_pk_mul_f32 v[226:227], v[54:55], v[54:55]
    v_pk_fma_f32 v[220:221], v[220:221], v[112:113], v[104:105]
    v_pk_fma_f32 v[222:223], v[222:223], v[114:115], v[106:107]
    v_pk_fma_f32 v[224:225], v[224:225], v[116:117], v[108:109]
    v_pk_fma_f32 v[226:227], v[226:227], v[118:119], v[110:111]
    v_pk_mul_f32 v[220:221], v[220:221], v[48:49]
    v_pk_mul_f32 v[222:223], v[222:223], v[50:51]
    v_pk_mul_f32 v[224:225], v[224:225], v[52:53]
    v_pk_mul_f32 v[226:227], v[226:227], v[54:55]
    v_exp_f32 v220, v220
    v_exp_f32 v221, v221
    v_exp_f32 v222, v222
    v_exp_f32 v223, v223
    v_exp_f32 v224, v224
    v_exp_f32 v225, v225
    v_exp_f32 v226, v226
    v_exp_f32 v227, v227
    v_pk_fma_f32 v[220:221], v[220:221], v[120:121], v[120:121]
    v_pk_fma_f32 v[222:223], v[222:223], v[122:123], v[122:123]
    v_pk_fma_f32 v[224:225], v[224:225], v[124:125], v[124:125]
    v_pk_fma_f32 v[226:227], v[226:227], v[126:127], v[126:127]
    v_rcp_f32 v220, v220
    v_rcp_f32 v221, v221
    v_rcp_f32 v222, v222
    v_rcp_f32 v223, v223
    v_rcp_f32 v224, v224
    v_rcp_f32 v225, v225
    v_rcp_f32 v226, v226
    v_rcp_f32 v227, v227
    v_pk_mul_f32 v[48:49], v[48:49], v[220:221]
    v_pk_mul_f32 v[50:51], v[50:51], v[222:223]
    v_pk_mul_f32 v[52:53], v[52:53], v[224:225]
    v_pk_mul_f32 v[54:55], v[54:55], v[226:227]
    v_pk_add_f32 v[204:205], v[204:205], v[48:49]
    v_pk_fma_f32 v[206:207], v[48:49], v[48:49], v[206:207]
    v_pk_add_f32 v[208:209], v[208:209], v[50:51]
    v_pk_fma_f32 v[210:211], v[50:51], v[50:51], v[210:211]
    v_pk_add_f32 v[212:213], v[212:213], v[52:53]
    v_pk_fma_f32 v[214:215], v[52:53], v[52:53], v[214:215]
    v_pk_add_f32 v[216:217], v[216:217], v[54:55]
    v_pk_fma_f32 v[218:219], v[54:55], v[54:55], v[218:219]
    v_pk_mul_f32 v[228:229], v[56:57], v[56:57]
    v_pk_mul_f32 v[230:231], v[58:59], v[58:59]
    v_pk_mul_f32 v[232:233], v[60:61], v[60:61]
    v_pk_mul_f32 v[234:235], v[62:63], v[62:63]
    v_pk_fma_f32 v[228:229], v[228:229], v[112:113], v[104:105]
    v_pk_fma_f32 v[230:231], v[230:231], v[114:115], v[106:107]
    v_pk_fma_f32 v[232:233], v[232:233], v[116:117], v[108:109]
    v_pk_fma_f32 v[234:235], v[234:235], v[118:119], v[110:111]
    v_pk_mul_f32 v[228:229], v[228:229], v[56:57]
    v_pk_mul_f32 v[230:231], v[230:231], v[58:59]
    v_pk_mul_f32 v[232:233], v[232:233], v[60:61]
    v_pk_mul_f32 v[234:235], v[234:235], v[62:63]
    v_exp_f32 v228, v228
    v_exp_f32 v229, v229
    v_exp_f32 v230, v230
    v_exp_f32 v231, v231
    v_exp_f32 v232, v232
    v_exp_f32 v233, v233
    v_exp_f32 v234, v234
    v_exp_f32 v235, v235
    v_pk_fma_f32 v[228:229], v[228:229], v[120:121], v[120:121]
    v_pk_fma_f32 v[230:231], v[230:231], v[122:123], v[122:123]
    v_pk_fma_f32 v[232:233], v[232:233], v[124:125], v[124:125]
    v_pk_fma_f32 v[234:235], v[234:235], v[126:127], v[126:127]
    v_rcp_f32 v228, v228
    v_rcp_f32 v229, v229
    v_rcp_f32 v230, v230
    v_rcp_f32 v231, v231
    v_rcp_f32 v232, v232
    v_rcp_f32 v233, v233
    v_rcp_f32 v234, v234
    v_rcp_f32 v235, v235
    v_pk_mul_f32 v[56:57], v[56:57], v[228:229]
    v_pk_mul_f32 v[58:59], v[58:59], v[230:231]
    v_pk_mul_f32 v[60:61], v[60:61], v[232:233]
    v_pk_mul_f32 v[62:63], v[62:63], v[234:235]
    v_pk_add_f32 v[204:205], v[204:205], v[56:57]
    v_pk_fma_f32 v[206:207], v[56:57], v[56:57], v[206:207]
    v_pk_add_f32 v[208:209], v[208:209], v[58:59]
    v_pk_fma_f32 v[210:211], v[58:59], v[58:59], v[210:211]
    v_pk_add_f32 v[212:213], v[212:213], v[60:61]
    v_pk_fma_f32 v[214:215], v[60:61], v[60:61], v[214:215]
    v_pk_add_f32 v[216:217], v[216:217], v[62:63]
    v_pk_fma_f32 v[218:219], v[62:63], v[62:63], v[218:219]
    v_pk_mul_f32 v[220:221], v[64:65], v[64:65]
    v_pk_mul_f32 v[222:223], v[66:67], v[66:67]
    v_pk_mul_f32 v[224:225], v[68:69], v[68:69]
    v_pk_mul_f32 v[226:227], v[70:71], v[70:71]
    v_pk_fma_f32 v[220:221], v[220:221], v[112:113], v[104:105]
    v_pk_fma_f32 v[222:223], v[222:223], v[114:115], v[106:107]
    v_pk_fma_f32 v[224:225], v[224:225], v[116:117], v[108:109]
    v_pk_fma_f32 v[226:227], v[226:227], v[118:119], v[110:111]
    v_pk_mul_f32 v[220:221], v[220:221], v[64:65]
    v_pk_mul_f32 v[222:223], v[222:223], v[66:67]
    v_pk_mul_f32 v[224:225], v[224:225], v[68:69]
    v_pk_mul_f32 v[226:227], v[226:227], v[70:71]
    v_exp_f32 v220, v220
    v_exp_f32 v221, v221
    v_exp_f32 v222, v222
    v_exp_f32 v223, v223
    v_exp_f32 v224, v224
    v_exp_f32 v225, v225
    v_exp_f32 v226, v226
    v_exp_f32 v227, v227
    v_pk_fma_f32 v[220:221], v[220:221], v[120:121], v[120:121]
    v_pk_fma_f32 v[222:223], v[222:223], v[122:123], v[122:123]
    v_pk_fma_f32 v[224:225], v[224:225], v[124:125], v[124:125]
    v_pk_fma_f32 v[226:227], v[226:227], v[126:127], v[126:127]
    v_rcp_f32 v220, v220
    v_rcp_f32 v221, v221
    v_rcp_f32 v222, v222
    v_rcp_f32 v223, v223
    v_rcp_f32 v224, v224
    v_rcp_f32 v225, v225
    v_rcp_f32 v226, v226
    v_rcp_f32 v227, v227
    v_pk_mul_f32 v[64:65], v[64:65], v[220:221]
    v_pk_mul_f32 v[66:67], v[66:67], v[222:223]
    v_pk_mul_f32 v[68:69], v[68:69], v[224:225]
    v_pk_mul_f32 v[70:71], v[70:71], v[226:227]
    v_pk_add_f32 v[204:205], v[204:205], v[64:65]
    v_pk_fma_f32 v[206:207], v[64:65], v[64:65], v[206:207]
    v_pk_add_f32 v[208:209], v[208:209], v[66:67]
    v_pk_fma_f32 v[210:211], v[66:67], v[66:67], v[210:211]
    v_pk_add_f32 v[212:213], v[212:213], v[68:69]
    v_pk_fma_f32 v[214:215], v[68:69], v[68:69], v[214:215]
    v_pk_add_f32 v[216:217], v[216:217], v[70:71]
    v_pk_fma_f32 v[218:219], v[70:71], v[70:71], v[218:219]
    v_pk_mul_f32 v[228:229], v[72:73], v[72:73]
    v_pk_mul_f32 v[230:231], v[74:75], v[74:75]
    v_pk_mul_f32 v[232:233], v[76:77], v[76:77]
    v_pk_mul_f32 v[234:235], v[78:79], v[78:79]
    v_pk_fma_f32 v[228:229], v[228:229], v[112:113], v[104:105]
    v_pk_fma_f32 v[230:231], v[230:231], v[114:115], v[106:107]
    v_pk_fma_f32 v[232:233], v[232:233], v[116:117], v[108:109]
    v_pk_fma_f32 v[234:235], v[234:235], v[118:119], v[110:111]
    v_pk_mul_f32 v[228:229], v[228:229], v[72:73]
    v_pk_mul_f32 v[230:231], v[230:231], v[74:75]
    v_pk_mul_f32 v[232:233], v[232:233], v[76:77]
    v_pk_mul_f32 v[234:235], v[234:235], v[78:79]
    v_exp_f32 v228, v228
    v_exp_f32 v229, v229
    v_exp_f32 v230, v230
    v_exp_f32 v231, v231
    v_exp_f32 v232, v232
    v_exp_f32 v233, v233
    v_exp_f32 v234, v234
    v_exp_f32 v235, v235
    v_pk_fma_f32 v[228:229], v[228:229], v[120:121], v[120:121]
    v_pk_fma_f32 v[230:231], v[230:231], v[122:123], v[122:123]
    v_pk_fma_f32 v[232:233], v[232:233], v[124:125], v[124:125]
    v_pk_fma_f32 v[234:235], v[234:235], v[126:127], v[126:127]
    v_rcp_f32 v228, v228
    v_rcp_f32 v229, v229
    v_rcp_f32 v230, v230
    v_rcp_f32 v231, v231
    v_rcp_f32 v232, v232
    v_rcp_f32 v233, v233
    v_rcp_f32 v234, v234
    v_rcp_f32 v235, v235
    v_pk_mul_f32 v[72:73], v[72:73], v[228:229]
    v_pk_mul_f32 v[74:75], v[74:75], v[230:231]
    v_pk_mul_f32 v[76:77], v[76:77], v[232:233]
    v_pk_mul_f32 v[78:79], v[78:79], v[234:235]
    v_pk_add_f32 v[204:205], v[204:205], v[72:73]
    v_pk_fma_f32 v[206:207], v[72:73], v[72:73], v[206:207]
    v_pk_add_f32 v[208:209], v[208:209], v[74:75]
    v_pk_fma_f32 v[210:211], v[74:75], v[74:75], v[210:211]
    v_pk_add_f32 v[212:213], v[212:213], v[76:77]
    v_pk_fma_f32 v[214:215], v[76:77], v[76:77], v[214:215]
    v_pk_add_f32 v[216:217], v[216:217], v[78:79]
    v_pk_fma_f32 v[218:219], v[78:79], v[78:79], v[218:219]
    v_pk_mul_f32 v[220:221], v[80:81], v[80:81]
    v_pk_mul_f32 v[222:223], v[82:83], v[82:83]
    v_pk_mul_f32 v[224:225], v[84:85], v[84:85]
    v_pk_mul_f32 v[226:227], v[86:87], v[86:87]
    v_pk_fma_f32 v[220:221], v[220:221], v[112:113], v[104:105]
    v_pk_fma_f32 v[222:223], v[222:223], v[114:115], v[106:107]
    v_pk_fma_f32 v[224:225], v[224:225], v[116:117], v[108:109]
    v_pk_fma_f32 v[226:227], v[226:227], v[118:119], v[110:111]
    v_pk_mul_f32 v[220:221], v[220:221], v[80:81]
    v_pk_mul_f32 v[222:223], v[222:223], v[82:83]
    v_pk_mul_f32 v[224:225], v[224:225], v[84:85]
    v_pk_mul_f32 v[226:227], v[226:227], v[86:87]
    v_exp_f32 v220, v220
    v_exp_f32 v221, v221
    v_exp_f32 v222, v222
    v_exp_f32 v223, v223
    v_exp_f32 v224, v224
    v_exp_f32 v225, v225
    v_exp_f32 v226, v226
    v_exp_f32 v227, v227
    v_pk_fma_f32 v[220:221], v[220:221], v[120:121], v[120:121]
    v_pk_fma_f32 v[222:223], v[222:223], v[122:123], v[122:123]
    v_pk_fma_f32 v[224:225], v[224:225], v[124:125], v[124:125]
    v_pk_fma_f32 v[226:227], v[226:227], v[126:127], v[126:127]
    v_rcp_f32 v220, v220
    v_rcp_f32 v221, v221
    v_rcp_f32 v222, v222
    v_rcp_f32 v223, v223
    v_rcp_f32 v224, v224
    v_rcp_f32 v225, v225
    v_rcp_f32 v226, v226
    v_rcp_f32 v227, v227
    v_pk_mul_f32 v[80:81], v[80:81], v[220:221]
    v_pk_mul_f32 v[82:83], v[82:83], v[222:223]
    v_pk_mul_f32 v[84:85], v[84:85], v[224:225]
    v_pk_mul_f32 v[86:87], v[86:87], v[226:227]
    v_pk_add_f32 v[204:205], v[204:205], v[80:81]
    v_pk_fma_f32 v[206:207], v[80:81], v[80:81], v[206:207]
    v_pk_add_f32 v[208:209], v[208:209], v[82:83]
    v_pk_fma_f32 v[210:211], v[82:83], v[82:83], v[210:211]
    v_pk_add_f32 v[212:213], v[212:213], v[84:85]
    v_pk_fma_f32 v[214:215], v[84:85], v[84:85], v[214:215]
    v_pk_add_f32 v[216:217], v[216:217], v[86:87]
    v_pk_fma_f32 v[218:219], v[86:87], v[86:87], v[218:219]
    v_add_f32_dpp v204, v204, v204 row_mirror row_mask:0xf bank_mask:0x3
    v_add_f32_dpp v205, v205, v205 row_mirror row_mask:0xf bank_mask:0x3
    v_add_f32_dpp v206, v206, v206 row_mirror row_mask:0xf bank_mask:0x3
    v_add_f32_dpp v207, v207, v207 row_mirror row_mask:0xf bank_mask:0x3
    v_add_f32_dpp v208, v208, v208 row_mirror row_mask:0xf bank_mask:0x3
    v_add_f32_dpp v209, v209, v209 row_mirror row_mask:0xf bank_mask:0x3
    v_add_f32_dpp v210, v210, v210 row_mirror row_mask:0xf bank_mask:0x3
    v_add_f32_dpp v211, v211, v211 row_mirror row_mask:0xf bank_mask:0x3
    v_add_f32_dpp v204, v212, v212 row_mirror row_mask:0xf bank_mask:0xc
    v_add_f32_dpp v205, v213, v213 row_mirror row_mask:0xf bank_mask:0xc
    v_add_f32_dpp v206, v214, v214 row_mirror row_mask:0xf bank_mask:0xc
    v_add_f32_dpp v207, v215, v215 row_mirror row_mask:0xf bank_mask:0xc
    v_add_f32_dpp v208, v216, v216 row_mirror row_mask:0xf bank_mask:0xc
    v_add_f32_dpp v209, v217, v217 row_mirror row_mask:0xf bank_mask:0xc
    v_add_f32_dpp v210, v218, v218 row_mirror row_mask:0xf bank_mask:0xc
    v_add_f32_dpp v211, v219, v219 row_mirror row_mask:0xf bank_mask:0xc
    v_add_f32_dpp v204, v204, v204 row_half_mirror row_mask:0xf bank_mask:0x5
    v_add_f32_dpp v205, v205, v205 row_half_mirror row_mask:0xf bank_mask:0x5
    v_add_f32_dpp v206, v206, v206 row_half_mirror row_mask:0xf bank_mask:0x5
    v_add_f32_dpp v207, v207, v207 row_half_mirror row_mask:0xf bank_mask:0x5
    v_add_f32_dpp v204, v208, v208 row_half_mirror row_mask:0xf bank_mask:0xa
    v_add_f32_dpp v205, v209, v209 row_half_mirror row_mask:0xf bank_mask:0xa
    v_add_f32_dpp v206, v210, v210 row_half_mirror row_mask:0xf bank_mask:0xa
    v_add_f32_dpp v207, v211, v211 row_half_mirror row_mask:0xf bank_mask:0xa
    v_add_f32_dpp v204, v204, v204 quad_perm:[1,0,3,2] row_mask:0xf bank_mask:0xf
    v_add_f32_dpp v205, v205, v205 quad_perm:[1,0,3,2] row_mask:0xf bank_mask:0xf
    v_add_f32_dpp v206, v206, v206 quad_perm:[1,0,3,2] row_mask:0xf bank_mask:0xf
    v_add_f32_dpp v207, v207, v207 quad_perm:[1,0,3,2] row_mask:0xf bank_mask:0xf
    v_add_f32_dpp v12, v204, v204 quad_perm:[2,3,0,1] row_mask:0xf bank_mask:0xf
    v_add_f32_dpp v14, v205, v205 quad_perm:[2,3,0,1] row_mask:0xf bank_mask:0xf
    v_add_f32_dpp v13, v206, v206 quad_perm:[2,3,0,1] row_mask:0xf bank_mask:0xf
    v_add_f32_dpp v15, v207, v207 quad_perm:[2,3,0,1] row_mask:0xf bank_mask:0xf
    buffer_store_dwordx4 v[12:15], v8, s[4:7], s36 offen sc1
    s_waitcnt lgkmcnt(5)
    v_mfma_f32_16x16x32_bf16 v[88:91], v[168:171], v[160:163], 0
    ds_read_b128 v[204:207], v3 offset:37888
    v_mfma_f32_16x16x32_bf16 v[92:95], v[168:171], v[164:167], 0
    ds_read_b128 v[208:211], v3 offset:39936
    v_mfma_f32_16x16x32_bf16 v[96:99], v[172:175], v[160:163], 0
    ds_read_b128 v[212:215], v1 offset:46080
    v_mfma_f32_16x16x32_bf16 v[100:103], v[172:175], v[164:167], 0
    ds_read_b128 v[216:219], v1 offset:47104
    v_mfma_f32_16x16x32_bf16 v[104:107], v[176:179], v[160:163], 0
    ds_read_b128 v[220:223], v1 offset:48128
    v_mfma_f32_16x16x32_bf16 v[108:111], v[176:179], v[164:167], 0
    ds_read_b128 v[224:227], v1 offset:49152
    v_mfma_f32_16x16x32_bf16 v[112:115], v[180:183], v[160:163], 0
    ds_read_b128 v[228:231], v1 offset:50176
    v_mfma_f32_16x16x32_bf16 v[116:119], v[180:183], v[164:167], 0
    ds_read_b128 v[232:235], v1 offset:51200
    s_waitcnt lgkmcnt(8)
    v_mfma_f32_16x16x32_bf16 v[120:123], v[184:187], v[160:163], 0
    ds_read_b128 v[236:239], v1 offset:52224
    v_mfma_f32_16x16x32_bf16 v[124:127], v[184:187], v[164:167], 0
    ds_read_b128 v[240:243], v1 offset:53248
    v_mfma_f32_16x16x32_bf16 v[128:131], v[188:191], v[160:163], 0
    ds_read_b128 v[244:247], v1 offset:54272
    v_mfma_f32_16x16x32_bf16 v[132:135], v[188:191], v[164:167], 0
    v_mfma_f32_16x16x32_bf16 v[136:139], v[192:195], v[160:163], 0
    v_lshrrev_b32 v255, 8, v1
    v_mfma_f32_16x16x32_bf16 v[140:143], v[192:195], v[164:167], 0
    v_lshl_add_u32 v255, v255, 6, s33
    v_mfma_f32_16x16x32_bf16 v[144:147], v[196:199], v[160:163], 0
    v_mfma_f32_16x16x32_bf16 v[148:151], v[196:199], v[164:167], 0
    v_mfma_f32_16x16x32_bf16 v[152:155], v[200:203], v[160:163], 0
    v_mfma_f32_16x16x32_bf16 v[156:159], v[200:203], v[164:167], 0
    s_waitcnt lgkmcnt(0)
    s_barrier
    v_mfma_f32_16x16x32_bf16 v[88:91], v[212:215], v[204:207], v[88:91]
    ds_read_b128 v[160:163], v0 offset:0
    v_mfma_f32_16x16x32_bf16 v[92:95], v[212:215], v[208:211], v[92:95]
    ds_read_b128 v[164:167], v0 offset:2048
    v_mfma_f32_16x16x32_bf16 v[96:99], v[216:219], v[204:207], v[96:99]
    ds_read_b128 v[168:171], v2 offset:0
    v_mfma_f32_16x16x32_bf16 v[100:103], v[216:219], v[208:211], v[100:103]
    ds_read_b128 v[172:175], v2 offset:1024
    v_mfma_f32_16x16x32_bf16 v[104:107], v[220:223], v[204:207], v[104:107]
    ds_read_b128 v[176:179], v2 offset:2048
    v_mfma_f32_16x16x32_bf16 v[108:111], v[220:223], v[208:211], v[108:111]
    ds_read_b128 v[180:183], v2 offset:3072
    v_mfma_f32_16x16x32_bf16 v[112:115], v[224:227], v[204:207], v[112:115]
    ds_read_b128 v[184:187], v2 offset:4096
    v_mfma_f32_16x16x32_bf16 v[116:119], v[224:227], v[208:211], v[116:119]
    ds_read_b128 v[188:191], v2 offset:5120
    v_mfma_f32_16x16x32_bf16 v[120:123], v[228:231], v[204:207], v[120:123]
    ds_read_b128 v[192:195], v2 offset:6144
    v_mfma_f32_16x16x32_bf16 v[124:127], v[228:231], v[208:211], v[124:127]
    ds_read_b128 v[196:199], v2 offset:7168
    v_mfma_f32_16x16x32_bf16 v[128:131], v[232:235], v[204:207], v[128:131]
    ds_read_b128 v[200:203], v2 offset:8192
    v_mfma_f32_16x16x32_bf16 v[132:135], v[232:235], v[208:211], v[132:135]
    v_mfma_f32_16x16x32_bf16 v[136:139], v[236:239], v[204:207], v[136:139]
    v_mfma_f32_16x16x32_bf16 v[140:143], v[236:239], v[208:211], v[140:143]
    v_mfma_f32_16x16x32_bf16 v[144:147], v[240:243], v[204:207], v[144:147]
    v_mfma_f32_16x16x32_bf16 v[148:151], v[240:243], v[208:211], v[148:151]
    v_mfma_f32_16x16x32_bf16 v[152:155], v[244:247], v[204:207], v[152:155]
    v_mfma_f32_16x16x32_bf16 v[156:159], v[244:247], v[208:211], v[156:159]
    s_waitcnt lgkmcnt(5)
    v_mfma_f32_16x16x32_bf16 v[88:91], v[168:171], v[160:163], v[88:91]
    ds_read_b128 v[204:207], v0 offset:1024
    v_mfma_f32_16x16x32_bf16 v[92:95], v[168:171], v[164:167], v[92:95]
    ds_read_b128 v[208:211], v0 offset:3072
    v_mfma_f32_16x16x32_bf16 v[96:99], v[172:175], v[160:163], v[96:99]
    ds_read_b128 v[212:215], v2 offset:9216
    v_mfma_f32_16x16x32_bf16 v[100:103], v[172:175], v[164:167], v[100:103]
    ds_read_b128 v[216:219], v2 offset:10240
    v_mfma_f32_16x16x32_bf16 v[104:107], v[176:179], v[160:163], v[104:107]
    ds_read_b128 v[220:223], v2 offset:11264
    v_mfma_f32_16x16x32_bf16 v[108:111], v[176:179], v[164:167], v[108:111]
    ds_read_b128 v[224:227], v2 offset:12288
    v_mfma_f32_16x16x32_bf16 v[112:115], v[180:183], v[160:163], v[112:115]
    ds_read_b128 v[228:231], v2 offset:13312
    v_mfma_f32_16x16x32_bf16 v[116:119], v[180:183], v[164:167], v[116:119]
    ds_read_b128 v[232:235], v2 offset:14336
    s_waitcnt lgkmcnt(8)
    v_mfma_f32_16x16x32_bf16 v[120:123], v[184:187], v[160:163], v[120:123]
    ds_read_b128 v[236:239], v2 offset:15360
    v_mfma_f32_16x16x32_bf16 v[124:127], v[184:187], v[164:167], v[124:127]
    ds_read_b128 v[240:243], v2 offset:16384
    v_mfma_f32_16x16x32_bf16 v[128:131], v[188:191], v[160:163], v[128:131]
    ds_read_b128 v[244:247], v2 offset:17408
    v_mfma_f32_16x16x32_bf16 v[132:135], v[188:191], v[164:167], v[132:135]
    v_mfma_f32_16x16x32_bf16 v[136:139], v[192:195], v[160:163], v[136:139]
    v_mfma_f32_16x16x32_bf16 v[140:143], v[192:195], v[164:167], v[140:143]
    v_mfma_f32_16x16x32_bf16 v[144:147], v[196:199], v[160:163], v[144:147]
    v_mfma_f32_16x16x32_bf16 v[148:151], v[196:199], v[164:167], v[148:151]
    v_mfma_f32_16x16x32_bf16 v[152:155], v[200:203], v[160:163], v[152:155]
    v_mfma_f32_16x16x32_bf16 v[156:159], v[200:203], v[164:167], v[156:159]
    s_waitcnt lgkmcnt(0)
    s_barrier
    v_mfma_f32_16x16x32_bf16 v[88:91], v[212:215], v[204:207], v[88:91]
    ds_read_b128 v[160:163], v0 offset:36864
    v_mfma_f32_16x16x32_bf16 v[92:95], v[212:215], v[208:211], v[92:95]
    ds_read_b128 v[164:167], v0 offset:38912
    v_mfma_f32_16x16x32_bf16 v[96:99], v[216:219], v[204:207], v[96:99]
    ds_read_b128 v[168:171], v2 offset:36864
    v_mfma_f32_16x16x32_bf16 v[100:103], v[216:219], v[208:211], v[100:103]
    ds_read_b128 v[172:175], v2 offset:37888
    v_mfma_f32_16x16x32_bf16 v[104:107], v[220:223], v[204:207], v[104:107]
    ds_read_b128 v[176:179], v2 offset:38912
    v_mfma_f32_16x16x32_bf16 v[108:111], v[220:223], v[208:211], v[108:111]
    ds_read_b128 v[180:183], v2 offset:39936
    v_mfma_f32_16x16x32_bf16 v[112:115], v[224:227], v[204:207], v[112:115]
    ds_read_b128 v[184:187], v2 offset:40960
    v_mfma_f32_16x16x32_bf16 v[116:119], v[224:227], v[208:211], v[116:119]
    ds_read_b128 v[188:191], v2 offset:41984
    v_mfma_f32_16x16x32_bf16 v[120:123], v[228:231], v[204:207], v[120:123]
    ds_read_b128 v[192:195], v2 offset:43008
    v_mfma_f32_16x16x32_bf16 v[124:127], v[228:231], v[208:211], v[124:127]
    ds_read_b128 v[196:199], v2 offset:44032
    v_mfma_f32_16x16x32_bf16 v[128:131], v[232:235], v[204:207], v[128:131]
    ds_read_b128 v[200:203], v2 offset:45056
    v_mfma_f32_16x16x32_bf16 v[132:135], v[232:235], v[208:211], v[132:135]
    v_mfma_f32_16x16x32_bf16 v[136:139], v[236:239], v[204:207], v[136:139]
    v_mfma_f32_16x16x32_bf16 v[140:143], v[236:239], v[208:211], v[140:143]
    v_mfma_f32_16x16x32_bf16 v[144:147], v[240:243], v[204:207], v[144:147]
    v_mfma_f32_16x16x32_bf16 v[148:151], v[240:243], v[208:211], v[148:151]
    v_mfma_f32_16x16x32_bf16 v[152:155], v[244:247], v[204:207], v[152:155]
    v_mfma_f32_16x16x32_bf16 v[156:159], v[244:247], v[208:211], v[156:159]
    s_waitcnt lgkmcnt(5)
    v_mfma_f32_16x16x32_bf16 v[88:91], v[168:171], v[160:163], v[88:91]
    ds_read_b128 v[204:207], v0 offset:37888
    v_mfma_f32_16x16x32_bf16 v[92:95], v[168:171], v[164:167], v[92:95]
    ds_read_b128 v[208:211], v0 offset:39936
    v_mfma_f32_16x16x32_bf16 v[96:99], v[172:175], v[160:163], v[96:99]
    ds_read_b128 v[212:215], v2 offset:46080
    v_mfma_f32_16x16x32_bf16 v[100:103], v[172:175], v[164:167], v[100:103]
    ds_read_b128 v[216:219], v2 offset:47104
    v_mfma_f32_16x16x32_bf16 v[104:107], v[176:179], v[160:163], v[104:107]
    ds_read_b128 v[220:223], v2 offset:48128
    v_mfma_f32_16x16x32_bf16 v[108:111], v[176:179], v[164:167], v[108:111]
    ds_read_b128 v[224:227], v2 offset:49152
    v_mfma_f32_16x16x32_bf16 v[112:115], v[180:183], v[160:163], v[112:115]
    ds_read_b128 v[228:231], v2 offset:50176
    v_mfma_f32_16x16x32_bf16 v[116:119], v[180:183], v[164:167], v[116:119]
    ds_read_b128 v[232:235], v2 offset:51200
    s_waitcnt lgkmcnt(8)
    v_mfma_f32_16x16x32_bf16 v[120:123], v[184:187], v[160:163], v[120:123]
    ds_read_b128 v[236:239], v2 offset:52224
    v_mfma_f32_16x16x32_bf16 v[124:127], v[184:187], v[164:167], v[124:127]
    ds_read_b128 v[240:243], v2 offset:53248
    v_mfma_f32_16x16x32_bf16 v[128:131], v[188:191], v[160:163], v[128:131]
    ds_read_b128 v[244:247], v2 offset:54272
    v_mfma_f32_16x16x32_bf16 v[132:135], v[188:191], v[164:167], v[132:135]
    v_mfma_f32_16x16x32_bf16 v[136:139], v[192:195], v[160:163], v[136:139]
    v_mfma_f32_16x16x32_bf16 v[140:143], v[192:195], v[164:167], v[140:143]
    v_mfma_f32_16x16x32_bf16 v[144:147], v[196:199], v[160:163], v[144:147]
    v_mfma_f32_16x16x32_bf16 v[148:151], v[196:199], v[164:167], v[148:151]
    v_mfma_f32_16x16x32_bf16 v[152:155], v[200:203], v[160:163], v[152:155]
    v_mfma_f32_16x16x32_bf16 v[156:159], v[200:203], v[164:167], v[156:159]
    s_waitcnt lgkmcnt(0)
    s_barrier
    v_mfma_f32_16x16x32_bf16 v[88:91], v[212:215], v[204:207], v[88:91]
    ds_read_b128 v[160:163], v3 offset:0
    v_mfma_f32_16x16x32_bf16 v[92:95], v[212:215], v[208:211], v[92:95]
    ds_read_b128 v[164:167], v3 offset:2048
    v_mfma_f32_16x16x32_bf16 v[96:99], v[216:219], v[204:207], v[96:99]
    ds_read_b128 v[168:171], v1 offset:0
    v_mfma_f32_16x16x32_bf16 v[100:103], v[216:219], v[208:211], v[100:103]
    ds_read_b128 v[172:175], v1 offset:1024
    v_mfma_f32_16x16x32_bf16 v[104:107], v[220:223], v[204:207], v[104:107]
    ds_read_b128 v[176:179], v1 offset:2048
    v_mfma_f32_16x16x32_bf16 v[108:111], v[220:223], v[208:211], v[108:111]
    ds_read_b128 v[180:183], v1 offset:3072
    v_mfma_f32_16x16x32_bf16 v[112:115], v[224:227], v[204:207], v[112:115]
    ds_read_b128 v[184:187], v1 offset:4096
    v_mfma_f32_16x16x32_bf16 v[116:119], v[224:227], v[208:211], v[116:119]
    ds_read_b128 v[188:191], v1 offset:5120
    v_mfma_f32_16x16x32_bf16 v[120:123], v[228:231], v[204:207], v[120:123]
    ds_read_b128 v[192:195], v1 offset:6144
    v_mfma_f32_16x16x32_bf16 v[124:127], v[228:231], v[208:211], v[124:127]
    ds_read_b128 v[196:199], v1 offset:7168
    v_mfma_f32_16x16x32_bf16 v[128:131], v[232:235], v[204:207], v[128:131]
    ds_read_b128 v[200:203], v1 offset:8192
    v_mfma_f32_16x16x32_bf16 v[132:135], v[232:235], v[208:211], v[132:135]
    v_mfma_f32_16x16x32_bf16 v[136:139], v[236:239], v[204:207], v[136:139]
    v_mfma_f32_16x16x32_bf16 v[140:143], v[236:239], v[208:211], v[140:143]
    v_mfma_f32_16x16x32_bf16 v[144:147], v[240:243], v[204:207], v[144:147]
    v_mfma_f32_16x16x32_bf16 v[148:151], v[240:243], v[208:211], v[148:151]
    v_mfma_f32_16x16x32_bf16 v[152:155], v[244:247], v[204:207], v[152:155]
    v_mfma_f32_16x16x32_bf16 v[156:159], v[244:247], v[208:211], v[156:159]
    s_waitcnt lgkmcnt(5)
    v_mfma_f32_16x16x32_bf16 v[88:91], v[168:171], v[160:163], v[88:91]
    ds_read_b128 v[204:207], v3 offset:1024
    v_mfma_f32_16x16x32_bf16 v[92:95], v[168:171], v[164:167], v[92:95]
    ds_read_b128 v[208:211], v3 offset:3072
    v_mfma_f32_16x16x32_bf16 v[96:99], v[172:175], v[160:163], v[96:99]
    ds_read_b128 v[212:215], v1 offset:9216
    v_mfma_f32_16x16x32_bf16 v[100:103], v[172:175], v[164:167], v[100:103]
    ds_read_b128 v[216:219], v1 offset:10240
    v_mfma_f32_16x16x32_bf16 v[104:107], v[176:179], v[160:163], v[104:107]
    ds_read_b128 v[220:223], v1 offset:11264
    v_mfma_f32_16x16x32_bf16 v[108:111], v[176:179], v[164:167], v[108:111]
    ds_read_b128 v[224:227], v1 offset:12288
    v_mfma_f32_16x16x32_bf16 v[112:115], v[180:183], v[160:163], v[112:115]
    ds_read_b128 v[228:231], v1 offset:13312
    v_mfma_f32_16x16x32_bf16 v[116:119], v[180:183], v[164:167], v[116:119]
    ds_read_b128 v[232:235], v1 offset:14336
    s_waitcnt lgkmcnt(8)
    v_mfma_f32_16x16x32_bf16 v[120:123], v[184:187], v[160:163], v[120:123]
    ds_read_b128 v[236:239], v1 offset:15360
    v_mfma_f32_16x16x32_bf16 v[124:127], v[184:187], v[164:167], v[124:127]
    ds_read_b128 v[240:243], v1 offset:16384
    v_mfma_f32_16x16x32_bf16 v[128:131], v[188:191], v[160:163], v[128:131]
    ds_read_b128 v[244:247], v1 offset:17408
    v_mfma_f32_16x16x32_bf16 v[132:135], v[188:191], v[164:167], v[132:135]
    v_mfma_f32_16x16x32_bf16 v[136:139], v[192:195], v[160:163], v[136:139]
    v_mfma_f32_16x16x32_bf16 v[140:143], v[192:195], v[164:167], v[140:143]
    v_mfma_f32_16x16x32_bf16 v[144:147], v[196:199], v[160:163], v[144:147]
    v_mfma_f32_16x16x32_bf16 v[148:151], v[196:199], v[164:167], v[148:151]
    v_mfma_f32_16x16x32_bf16 v[152:155], v[200:203], v[160:163], v[152:155]
    v_mfma_f32_16x16x32_bf16 v[156:159], v[200:203], v[164:167], v[156:159]
    s_waitcnt lgkmcnt(0)
    s_barrier
    v_mfma_f32_16x16x32_bf16 v[88:91], v[212:215], v[204:207], v[88:91]
    ds_read_b128 v[160:163], v3 offset:36864
    v_mfma_f32_16x16x32_bf16 v[92:95], v[212:215], v[208:211], v[92:95]
    ds_read_b128 v[164:167], v3 offset:38912
    v_mfma_f32_16x16x32_bf16 v[96:99], v[216:219], v[204:207], v[96:99]
    ds_read_b128 v[168:171], v1 offset:36864
    v_mfma_f32_16x16x32_bf16 v[100:103], v[216:219], v[208:211], v[100:103]
    ds_read_b128 v[172:175], v1 offset:37888
    v_mfma_f32_16x16x32_bf16 v[104:107], v[220:223], v[204:207], v[104:107]
    ds_read_b128 v[176:179], v1 offset:38912
    v_mfma_f32_16x16x32_bf16 v[108:111], v[220:223], v[208:211], v[108:111]
    ds_read_b128 v[180:183], v1 offset:39936
    v_mfma_f32_16x16x32_bf16 v[112:115], v[224:227], v[204:207], v[112:115]
    ds_read_b128 v[184:187], v1 offset:40960
    v_mfma_f32_16x16x32_bf16 v[116:119], v[224:227], v[208:211], v[116:119]
    ds_read_b128 v[188:191], v1 offset:41984
    v_mfma_f32_16x16x32_bf16 v[120:123], v[228:231], v[204:207], v[120:123]
    ds_read_b128 v[192:195], v1 offset:43008
    v_mfma_f32_16x16x32_bf16 v[124:127], v[228:231], v[208:211], v[124:127]
    ds_read_b128 v[196:199], v1 offset:44032
    v_mfma_f32_16x16x32_bf16 v[128:131], v[232:235], v[204:207], v[128:131]
    ds_read_b128 v[200:203], v1 offset:45056
    v_mfma_f32_16x16x32_bf16 v[132:135], v[232:235], v[208:211], v[132:135]
    ds_read_b128 v[4:7], v255 offset:1024
    v_mfma_f32_16x16x32_bf16 v[136:139], v[236:239], v[204:207], v[136:139]
    ds_read_b128 v[8:11], v255 offset:1040
    v_mfma_f32_16x16x32_bf16 v[140:143], v[236:239], v[208:211], v[140:143]
    ds_read_b128 v[12:15], v255 offset:1056
    v_mfma_f32_16x16x32_bf16 v[144:147], v[240:243], v[204:207], v[144:147]
    ds_read_b128 v[252:255], v255 offset:1072
    v_mfma_f32_16x16x32_bf16 v[148:151], v[240:243], v[208:211], v[148:151]
    v_mfma_f32_16x16x32_bf16 v[152:155], v[244:247], v[204:207], v[152:155]
    v_mfma_f32_16x16x32_bf16 v[156:159], v[244:247], v[208:211], v[156:159]
    s_waitcnt lgkmcnt(9)
    v_mfma_f32_16x16x32_bf16 v[88:91], v[168:171], v[160:163], v[88:91]
    ds_read_b128 v[204:207], v3 offset:37888
    v_mfma_f32_16x16x32_bf16 v[92:95], v[168:171], v[164:167], v[92:95]
    ds_read_b128 v[208:211], v3 offset:39936
    v_mfma_f32_16x16x32_bf16 v[96:99], v[172:175], v[160:163], v[96:99]
    ds_read_b128 v[212:215], v1 offset:46080
    v_mfma_f32_16x16x32_bf16 v[100:103], v[172:175], v[164:167], v[100:103]
    ds_read_b128 v[216:219], v1 offset:47104
    v_mfma_f32_16x16x32_bf16 v[104:107], v[176:179], v[160:163], v[104:107]
    ds_read_b128 v[220:223], v1 offset:48128
    v_mfma_f32_16x16x32_bf16 v[108:111], v[176:179], v[164:167], v[108:111]
    ds_read_b128 v[224:227], v1 offset:49152
    v_mfma_f32_16x16x32_bf16 v[112:115], v[180:183], v[160:163], v[112:115]
    ds_read_b128 v[228:231], v1 offset:50176
    v_mfma_f32_16x16x32_bf16 v[116:119], v[180:183], v[164:167], v[116:119]
    ds_read_b128 v[232:235], v1 offset:51200
    s_waitcnt lgkmcnt(8)
    v_mfma_f32_16x16x32_bf16 v[120:123], v[184:187], v[160:163], v[120:123]
    ds_read_b128 v[236:239], v1 offset:52224
    v_fma_f32 v16, v16, v4, -v6
    v_mfma_f32_16x16x32_bf16 v[124:127], v[184:187], v[164:167], v[124:127]
    ds_read_b128 v[240:243], v1 offset:53248
    v_fma_f32 v17, v17, v5, -v7
    v_mfma_f32_16x16x32_bf16 v[128:131], v[188:191], v[160:163], v[128:131]
    ds_read_b128 v[244:247], v1 offset:54272
    v_fma_f32 v18, v18, v8, -v10
    v_mfma_f32_16x16x32_bf16 v[132:135], v[188:191], v[164:167], v[132:135]
    v_fma_f32 v19, v19, v9, -v11
    v_fma_f32 v20, v20, v12, -v14
    v_mfma_f32_16x16x32_bf16 v[136:139], v[192:195], v[160:163], v[136:139]
    v_fma_f32 v21, v21, v13, -v15
    v_fma_f32 v22, v22, v252, -v254
    v_mfma_f32_16x16x32_bf16 v[140:143], v[192:195], v[164:167], v[140:143]
    v_fma_f32 v23, v23, v253, -v255
    v_cvt_pk_bf16_f32 v16, v16, v17
    v_mfma_f32_16x16x32_bf16 v[144:147], v[196:199], v[160:163], v[144:147]
    v_cvt_pk_bf16_f32 v17, v18, v19
    v_cvt_pk_bf16_f32 v18, v20, v21
    v_mfma_f32_16x16x32_bf16 v[148:151], v[196:199], v[164:167], v[148:151]
    v_cvt_pk_bf16_f32 v19, v22, v23
    v_fma_f32 v24, v24, v4, -v6
    v_mfma_f32_16x16x32_bf16 v[152:155], v[200:203], v[160:163], v[152:155]
    v_fma_f32 v25, v25, v5, -v7
    v_fma_f32 v26, v26, v8, -v10
    v_mfma_f32_16x16x32_bf16 v[156:159], v[200:203], v[164:167], v[156:159]
    v_fma_f32 v27, v27, v9, -v11
    s_waitcnt lgkmcnt(0)
    s_barrier
    v_mfma_f32_16x16x32_bf16 v[88:91], v[212:215], v[204:207], v[88:91]
    ds_read_b128 v[160:163], v0 offset:0
    v_mfma_f32_16x16x32_bf16 v[92:95], v[212:215], v[208:211], v[92:95]
    ds_read_b128 v[164:167], v0 offset:2048
    v_fma_f32 v28, v28, v12, -v14
    v_mfma_f32_16x16x32_bf16 v[96:99], v[216:219], v[204:207], v[96:99]
    ds_read_b128 v[168:171], v2 offset:0
    v_fma_f32 v29, v29, v13, -v15
    v_mfma_f32_16x16x32_bf16 v[100:103], v[216:219], v[208:211], v[100:103]
    ds_read_b128 v[172:175], v2 offset:1024
    v_fma_f32 v30, v30, v252, -v254
    v_mfma_f32_16x16x32_bf16 v[104:107], v[220:223], v[204:207], v[104:107]
    ds_read_b128 v[176:179], v2 offset:2048
    v_fma_f32 v31, v31, v253, -v255
    v_mfma_f32_16x16x32_bf16 v[108:111], v[220:223], v[208:211], v[108:111]
    ds_read_b128 v[180:183], v2 offset:3072
    v_permlane32_swap_b32 v16, v18
    v_mfma_f32_16x16x32_bf16 v[112:115], v[224:227], v[204:207], v[112:115]
    ds_read_b128 v[184:187], v2 offset:4096
    v_permlane32_swap_b32 v17, v19
    v_mfma_f32_16x16x32_bf16 v[116:119], v[224:227], v[208:211], v[116:119]
    ds_read_b128 v[188:191], v2 offset:5120
    v_mfma_f32_16x16x32_bf16 v[120:123], v[228:231], v[204:207], v[120:123]
    ds_read_b128 v[192:195], v2 offset:6144
    v_cvt_pk_bf16_f32 v24, v24, v25
    v_mfma_f32_16x16x32_bf16 v[124:127], v[228:231], v[208:211], v[124:127]
    ds_read_b128 v[196:199], v2 offset:7168
    v_cvt_pk_bf16_f32 v25, v26, v27
    v_mfma_f32_16x16x32_bf16 v[128:131], v[232:235], v[204:207], v[128:131]
    ds_read_b128 v[200:203], v2 offset:8192
    v_cvt_pk_bf16_f32 v26, v28, v29
    v_mfma_f32_16x16x32_bf16 v[132:135], v[232:235], v[208:211], v[132:135]
    v_cvt_pk_bf16_f32 v27, v30, v31
    v_permlane16_swap_b32 v16, v18
    v_mfma_f32_16x16x32_bf16 v[136:139], v[236:239], v[204:207], v[136:139]
    v_permlane16_swap_b32 v17, v19
    buffer_store_dwordx4 v[16:19], v1, s[4:7], s38 offen offset:0 sc1
    v_fma_f32 v32, v32, v4, -v6
    v_mfma_f32_16x16x32_bf16 v[140:143], v[236:239], v[208:211], v[140:143]
    v_fma_f32 v33, v33, v5, -v7
    v_fma_f32 v34, v34, v8, -v10
    v_mfma_f32_16x16x32_bf16 v[144:147], v[240:243], v[204:207], v[144:147]
    v_fma_f32 v35, v35, v9, -v11
    v_fma_f32 v36, v36, v12, -v14
    v_mfma_f32_16x16x32_bf16 v[148:151], v[240:243], v[208:211], v[148:151]
    v_fma_f32 v37, v37, v13, -v15
    v_fma_f32 v38, v38, v252, -v254
    v_mfma_f32_16x16x32_bf16 v[152:155], v[244:247], v[204:207], v[152:155]
    v_fma_f32 v39, v39, v253, -v255
    v_permlane32_swap_b32 v24, v26
    v_mfma_f32_16x16x32_bf16 v[156:159], v[244:247], v[208:211], v[156:159]
    v_permlane32_swap_b32 v25, v27
    s_waitcnt lgkmcnt(5)
    v_mfma_f32_16x16x32_bf16 v[88:91], v[168:171], v[160:163], v[88:91]
    ds_read_b128 v[204:207], v0 offset:1024
    v_mfma_f32_16x16x32_bf16 v[92:95], v[168:171], v[164:167], v[92:95]
    ds_read_b128 v[208:211], v0 offset:3072
    v_cvt_pk_bf16_f32 v32, v32, v33
    v_mfma_f32_16x16x32_bf16 v[96:99], v[172:175], v[160:163], v[96:99]
    ds_read_b128 v[212:215], v2 offset:9216
    v_cvt_pk_bf16_f32 v33, v34, v35
    v_mfma_f32_16x16x32_bf16 v[100:103], v[172:175], v[164:167], v[100:103]
    ds_read_b128 v[216:219], v2 offset:10240
    v_cvt_pk_bf16_f32 v34, v36, v37
    v_mfma_f32_16x16x32_bf16 v[104:107], v[176:179], v[160:163], v[104:107]
    ds_read_b128 v[220:223], v2 offset:11264
    v_cvt_pk_bf16_f32 v35, v38, v39
    v_mfma_f32_16x16x32_bf16 v[108:111], v[176:179], v[164:167], v[108:111]
    ds_read_b128 v[224:227], v2 offset:12288
    v_permlane16_swap_b32 v24, v26
    v_mfma_f32_16x16x32_bf16 v[112:115], v[180:183], v[160:163], v[112:115]
    ds_read_b128 v[228:231], v2 offset:13312
    v_permlane16_swap_b32 v25, v27
    buffer_store_dwordx4 v[24:27], v1, s[4:7], s38 offen offset:1024 sc1
    v_mfma_f32_16x16x32_bf16 v[116:119], v[180:183], v[164:167], v[116:119]
    ds_read_b128 v[232:235], v2 offset:14336
    s_waitcnt lgkmcnt(8)
    v_mfma_f32_16x16x32_bf16 v[120:123], v[184:187], v[160:163], v[120:123]
    ds_read_b128 v[236:239], v2 offset:15360
    v_fma_f32 v40, v40, v4, -v6
    v_mfma_f32_16x16x32_bf16 v[124:127], v[184:187], v[164:167], v[124:127]
    ds_read_b128 v[240:243], v2 offset:16384
    v_fma_f32 v41, v41, v5, -v7
    v_mfma_f32_16x16x32_bf16 v[128:131], v[188:191], v[160:163], v[128:131]
    ds_read_b128 v[244:247], v2 offset:17408
    v_fma_f32 v42, v42, v8, -v10
    v_mfma_f32_16x16x32_bf16 v[132:135], v[188:191], v[164:167], v[132:135]
    v_fma_f32 v43, v43, v9, -v11
    v_fma_f32 v44, v44, v12, -v14
    v_mfma_f32_16x16x32_bf16 v[136:139], v[192:195], v[160:163], v[136:139]
    v_fma_f32 v45, v45, v13, -v15
    v_fma_f32 v46, v46, v252, -v254
    v_mfma_f32_16x16x32_bf16 v[140:143], v[192:195], v[164:167], v[140:143]
    v_fma_f32 v47, v47, v253, -v255
    v_permlane32_swap_b32 v32, v34
    v_mfma_f32_16x16x32_bf16 v[144:147], v[196:199], v[160:163], v[144:147]
    v_permlane32_swap_b32 v33, v35
    v_cvt_pk_bf16_f32 v40, v40, v41
    v_mfma_f32_16x16x32_bf16 v[148:151], v[196:199], v[164:167], v[148:151]
    v_cvt_pk_bf16_f32 v41, v42, v43
    v_cvt_pk_bf16_f32 v42, v44, v45
    v_mfma_f32_16x16x32_bf16 v[152:155], v[200:203], v[160:163], v[152:155]
    v_cvt_pk_bf16_f32 v43, v46, v47
    v_permlane16_swap_b32 v32, v34
    v_mfma_f32_16x16x32_bf16 v[156:159], v[200:203], v[164:167], v[156:159]
    v_permlane16_swap_b32 v33, v35
    buffer_store_dwordx4 v[32:35], v1, s[4:7], s38 offen offset:2048 sc1
    s_waitcnt lgkmcnt(0)
    s_barrier
    v_mfma_f32_16x16x32_bf16 v[88:91], v[212:215], v[204:207], v[88:91]
    ds_read_b128 v[160:163], v0 offset:36864
    v_mfma_f32_16x16x32_bf16 v[92:95], v[212:215], v[208:211], v[92:95]
    ds_read_b128 v[164:167], v0 offset:38912
    v_fma_f32 v48, v48, v4, -v6
    v_mfma_f32_16x16x32_bf16 v[96:99], v[216:219], v[204:207], v[96:99]
    ds_read_b128 v[168:171], v2 offset:36864
    v_fma_f32 v49, v49, v5, -v7
    v_mfma_f32_16x16x32_bf16 v[100:103], v[216:219], v[208:211], v[100:103]
    ds_read_b128 v[172:175], v2 offset:37888
    v_fma_f32 v50, v50, v8, -v10
    v_mfma_f32_16x16x32_bf16 v[104:107], v[220:223], v[204:207], v[104:107]
    ds_read_b128 v[176:179], v2 offset:38912
    v_fma_f32 v51, v51, v9, -v11
    v_mfma_f32_16x16x32_bf16 v[108:111], v[220:223], v[208:211], v[108:111]
    ds_read_b128 v[180:183], v2 offset:39936
    v_fma_f32 v52, v52, v12, -v14
    v_mfma_f32_16x16x32_bf16 v[112:115], v[224:227], v[204:207], v[112:115]
    ds_read_b128 v[184:187], v2 offset:40960
    v_fma_f32 v53, v53, v13, -v15
    v_mfma_f32_16x16x32_bf16 v[116:119], v[224:227], v[208:211], v[116:119]
    ds_read_b128 v[188:191], v2 offset:41984
    v_mfma_f32_16x16x32_bf16 v[120:123], v[228:231], v[204:207], v[120:123]
    ds_read_b128 v[192:195], v2 offset:43008
    v_fma_f32 v54, v54, v252, -v254
    v_mfma_f32_16x16x32_bf16 v[124:127], v[228:231], v[208:211], v[124:127]
    ds_read_b128 v[196:199], v2 offset:44032
    v_fma_f32 v55, v55, v253, -v255
    v_mfma_f32_16x16x32_bf16 v[128:131], v[232:235], v[204:207], v[128:131]
    ds_read_b128 v[200:203], v2 offset:45056
    v_permlane32_swap_b32 v40, v42
    v_mfma_f32_16x16x32_bf16 v[132:135], v[232:235], v[208:211], v[132:135]
    v_permlane32_swap_b32 v41, v43
    v_cvt_pk_bf16_f32 v48, v48, v49
    v_mfma_f32_16x16x32_bf16 v[136:139], v[236:239], v[204:207], v[136:139]
    v_cvt_pk_bf16_f32 v49, v50, v51
    v_cvt_pk_bf16_f32 v50, v52, v53
    v_mfma_f32_16x16x32_bf16 v[140:143], v[236:239], v[208:211], v[140:143]
    v_cvt_pk_bf16_f32 v51, v54, v55
    v_permlane16_swap_b32 v40, v42
    v_mfma_f32_16x16x32_bf16 v[144:147], v[240:243], v[204:207], v[144:147]
    v_permlane16_swap_b32 v41, v43
    buffer_store_dwordx4 v[40:43], v1, s[4:7], s38 offen offset:3072 sc1
    v_fma_f32 v56, v56, v4, -v6
    v_mfma_f32_16x16x32_bf16 v[148:151], v[240:243], v[208:211], v[148:151]
    v_fma_f32 v57, v57, v5, -v7
    v_fma_f32 v58, v58, v8, -v10
    v_mfma_f32_16x16x32_bf16 v[152:155], v[244:247], v[204:207], v[152:155]
    v_fma_f32 v59, v59, v9, -v11
    v_fma_f32 v60, v60, v12, -v14
    v_mfma_f32_16x16x32_bf16 v[156:159], v[244:247], v[208:211], v[156:159]
    v_fma_f32 v61, v61, v13, -v15
    s_waitcnt lgkmcnt(5)
    v_mfma_f32_16x16x32_bf16 v[88:91], v[168:171], v[160:163], v[88:91]
    ds_read_b128 v[204:207], v0 offset:37888
    v_mfma_f32_16x16x32_bf16 v[92:95], v[168:171], v[164:167], v[92:95]
    ds_read_b128 v[208:211], v0 offset:39936
    v_fma_f32 v62, v62, v252, -v254
    v_mfma_f32_16x16x32_bf16 v[96:99], v[172:175], v[160:163], v[96:99]
    ds_read_b128 v[212:215], v2 offset:46080
    v_fma_f32 v63, v63, v253, -v255
    v_mfma_f32_16x16x32_bf16 v[100:103], v[172:175], v[164:167], v[100:103]
    ds_read_b128 v[216:219], v2 offset:47104
    v_permlane32_swap_b32 v48, v50
    v_mfma_f32_16x16x32_bf16 v[104:107], v[176:179], v[160:163], v[104:107]
    ds_read_b128 v[220:223], v2 offset:48128
    v_permlane32_swap_b32 v49, v51
    v_mfma_f32_16x16x32_bf16 v[108:111], v[176:179], v[164:167], v[108:111]
    ds_read_b128 v[224:227], v2 offset:49152
    v_cvt_pk_bf16_f32 v56, v56, v57
    v_mfma_f32_16x16x32_bf16 v[112:115], v[180:183], v[160:163], v[112:115]
    ds_read_b128 v[228:231], v2 offset:50176
    v_cvt_pk_bf16_f32 v57, v58, v59
    v_mfma_f32_16x16x32_bf16 v[116:119], v[180:183], v[164:167], v[116:119]
    ds_read_b128 v[232:235], v2 offset:51200
    s_waitcnt lgkmcnt(8)
    v_mfma_f32_16x16x32_bf16 v[120:123], v[184:187], v[160:163], v[120:123]
    ds_read_b128 v[236:239], v2 offset:52224
    v_cvt_pk_bf16_f32 v58, v60, v61
    v_mfma_f32_16x16x32_bf16 v[124:127], v[184:187], v[164:167], v[124:127]
    ds_read_b128 v[240:243], v2 offset:53248
    v_cvt_pk_bf16_f32 v59, v62, v63
    v_mfma_f32_16x16x32_bf16 v[128:131], v[188:191], v[160:163], v[128:131]
    ds_read_b128 v[244:247], v2 offset:54272
    v_permlane16_swap_b32 v48, v50
    v_mfma_f32_16x16x32_bf16 v[132:135], v[188:191], v[164:167], v[132:135]
    v_permlane16_swap_b32 v49, v51
    buffer_store_dwordx4 v[48:51], v1, s[4:7], s39 offen offset:0 sc1
    v_fma_f32 v64, v64, v4, -v6
    v_mfma_f32_16x16x32_bf16 v[136:139], v[192:195], v[160:163], v[136:139]
    v_fma_f32 v65, v65, v5, -v7
    v_fma_f32 v66, v66, v8, -v10
    v_mfma_f32_16x16x32_bf16 v[140:143], v[192:195], v[164:167], v[140:143]
    v_fma_f32 v67, v67, v9, -v11
    v_fma_f32 v68, v68, v12, -v14
    v_mfma_f32_16x16x32_bf16 v[144:147], v[196:199], v[160:163], v[144:147]
    v_fma_f32 v69, v69, v13, -v15
    v_fma_f32 v70, v70, v252, -v254
    v_mfma_f32_16x16x32_bf16 v[148:151], v[196:199], v[164:167], v[148:151]
    v_fma_f32 v71, v71, v253, -v255
    v_permlane32_swap_b32 v56, v58
    v_mfma_f32_16x16x32_bf16 v[152:155], v[200:203], v[160:163], v[152:155]
    v_permlane32_swap_b32 v57, v59
    v_cvt_pk_bf16_f32 v64, v64, v65
    v_mfma_f32_16x16x32_bf16 v[156:159], v[200:203], v[164:167], v[156:159]
    v_cvt_pk_bf16_f32 v65, v66, v67
    s_waitcnt lgkmcnt(0)
    s_barrier
    v_mfma_f32_16x16x32_bf16 v[88:91], v[212:215], v[204:207], v[88:91]
    ds_read_b128 v[160:163], v3 offset:0
    v_mfma_f32_16x16x32_bf16 v[92:95], v[212:215], v[208:211], v[92:95]
    ds_read_b128 v[164:167], v3 offset:2048
    v_cvt_pk_bf16_f32 v66, v68, v69
    v_mfma_f32_16x16x32_bf16 v[96:99], v[216:219], v[204:207], v[96:99]
    ds_read_b128 v[168:171], v1 offset:0
    v_cvt_pk_bf16_f32 v67, v70, v71
    v_mfma_f32_16x16x32_bf16 v[100:103], v[216:219], v[208:211], v[100:103]
    ds_read_b128 v[172:175], v1 offset:1024
    v_permlane16_swap_b32 v56, v58
    v_mfma_f32_16x16x32_bf16 v[104:107], v[220:223], v[204:207], v[104:107]
    ds_read_b128 v[176:179], v1 offset:2048
    v_permlane16_swap_b32 v57, v59
    buffer_store_dwordx4 v[56:59], v1, s[4:7], s39 offen offset:1024 sc1
    v_mfma_f32_16x16x32_bf16 v[108:111], v[220:223], v[208:211], v[108:111]
    ds_read_b128 v[180:183], v1 offset:3072
    v_fma_f32 v72, v72, v4, -v6
    v_mfma_f32_16x16x32_bf16 v[112:115], v[224:227], v[204:207], v[112:115]
    ds_read_b128 v[184:187], v1 offset:4096
    v_fma_f32 v73, v73, v5, -v7
    v_mfma_f32_16x16x32_bf16 v[116:119], v[224:227], v[208:211], v[116:119]
    ds_read_b128 v[188:191], v1 offset:5120
    v_mfma_f32_16x16x32_bf16 v[120:123], v[228:231], v[204:207], v[120:123]
    ds_read_b128 v[192:195], v1 offset:6144
    v_fma_f32 v74, v74, v8, -v10
    v_mfma_f32_16x16x32_bf16 v[124:127], v[228:231], v[208:211], v[124:127]
    ds_read_b128 v[196:199], v1 offset:7168
    v_fma_f32 v75, v75, v9, -v11
    v_mfma_f32_16x16x32_bf16 v[128:131], v[232:235], v[204:207], v[128:131]
    ds_read_b128 v[200:203], v1 offset:8192
    v_fma_f32 v76, v76, v12, -v14
    v_mfma_f32_16x16x32_bf16 v[132:135], v[232:235], v[208:211], v[132:135]
    v_fma_f32 v77, v77, v13, -v15
    v_fma_f32 v78, v78, v252, -v254
    v_mfma_f32_16x16x32_bf16 v[136:139], v[236:239], v[204:207], v[136:139]
    v_fma_f32 v79, v79, v253, -v255
    v_permlane32_swap_b32 v64, v66
    v_mfma_f32_16x16x32_bf16 v[140:143], v[236:239], v[208:211], v[140:143]
    v_permlane32_swap_b32 v65, v67
    v_cvt_pk_bf16_f32 v72, v72, v73
    v_mfma_f32_16x16x32_bf16 v[144:147], v[240:243], v[204:207], v[144:147]
    v_cvt_pk_bf16_f32 v73, v74, v75
    v_cvt_pk_bf16_f32 v74, v76, v77
    v_mfma_f32_16x16x32_bf16 v[148:151], v[240:243], v[208:211], v[148:151]
    v_cvt_pk_bf16_f32 v75, v78, v79
    v_permlane16_swap_b32 v64, v66
    v_mfma_f32_16x16x32_bf16 v[152:155], v[244:247], v[204:207], v[152:155]
    v_permlane16_swap_b32 v65, v67
    buffer_store_dwordx4 v[64:67], v1, s[4:7], s39 offen offset:2048 sc1
    v_fma_f32 v80, v80, v4, -v6
    v_mfma_f32_16x16x32_bf16 v[156:159], v[244:247], v[208:211], v[156:159]
    v_fma_f32 v81, v81, v5, -v7
    s_waitcnt lgkmcnt(5)
    v_mfma_f32_16x16x32_bf16 v[88:91], v[168:171], v[160:163], v[88:91]
    ds_read_b128 v[204:207], v3 offset:1024
    v_mfma_f32_16x16x32_bf16 v[92:95], v[168:171], v[164:167], v[92:95]
    ds_read_b128 v[208:211], v3 offset:3072
    v_fma_f32 v82, v82, v8, -v10
    v_mfma_f32_16x16x32_bf16 v[96:99], v[172:175], v[160:163], v[96:99]
    ds_read_b128 v[212:215], v1 offset:9216
    v_fma_f32 v83, v83, v9, -v11
    v_mfma_f32_16x16x32_bf16 v[100:103], v[172:175], v[164:167], v[100:103]
    ds_read_b128 v[216:219], v1 offset:10240
    v_fma_f32 v84, v84, v12, -v14
    v_mfma_f32_16x16x32_bf16 v[104:107], v[176:179], v[160:163], v[104:107]
    ds_read_b128 v[220:223], v1 offset:11264
    v_fma_f32 v85, v85, v13, -v15
    v_mfma_f32_16x16x32_bf16 v[108:111], v[176:179], v[164:167], v[108:111]
    ds_read_b128 v[224:227], v1 offset:12288
    v_fma_f32 v86, v86, v252, -v254
    v_mfma_f32_16x16x32_bf16 v[112:115], v[180:183], v[160:163], v[112:115]
    ds_read_b128 v[228:231], v1 offset:13312
    v_fma_f32 v87, v87, v253, -v255
    v_mfma_f32_16x16x32_bf16 v[116:119], v[180:183], v[164:167], v[116:119]
    ds_read_b128 v[232:235], v1 offset:14336
    s_waitcnt lgkmcnt(8)
    v_mfma_f32_16x16x32_bf16 v[120:123], v[184:187], v[160:163], v[120:123]
    ds_read_b128 v[236:239], v1 offset:15360
    v_permlane32_swap_b32 v72, v74
    v_mfma_f32_16x16x32_bf16 v[124:127], v[184:187], v[164:167], v[124:127]
    ds_read_b128 v[240:243], v1 offset:16384
    v_permlane32_swap_b32 v73, v75
    v_mfma_f32_16x16x32_bf16 v[128:131], v[188:191], v[160:163], v[128:131]
    ds_read_b128 v[244:247], v1 offset:17408
    v_cvt_pk_bf16_f32 v80, v80, v81
    v_mfma_f32_16x16x32_bf16 v[132:135], v[188:191], v[164:167], v[132:135]
    v_cvt_pk_bf16_f32 v81, v82, v83
    v_cvt_pk_bf16_f32 v82, v84, v85
    v_mfma_f32_16x16x32_bf16 v[136:139], v[192:195], v[160:163], v[136:139]
    v_cvt_pk_bf16_f32 v83, v86, v87
    v_permlane16_swap_b32 v72, v74
    v_mfma_f32_16x16x32_bf16 v[140:143], v[192:195], v[164:167], v[140:143]
    v_permlane16_swap_b32 v73, v75
    buffer_store_dwordx4 v[72:75], v1, s[4:7], s39 offen offset:3072 sc1
    s_nop 0
    v_mfma_f32_16x16x32_bf16 v[144:147], v[196:199], v[160:163], v[144:147]
    v_permlane32_swap_b32 v80, v82
    v_permlane32_swap_b32 v81, v83
    v_mfma_f32_16x16x32_bf16 v[148:151], v[196:199], v[164:167], v[148:151]
    s_nop 0
    v_permlane16_swap_b32 v80, v82
    v_mfma_f32_16x16x32_bf16 v[152:155], v[200:203], v[160:163], v[152:155]
    v_permlane16_swap_b32 v81, v83
    buffer_store_dwordx4 v[80:83], v1, s[4:7], s46 offen offset:0 sc1
    v_mul_f32 v4, s40, v249
    v_mfma_f32_16x16x32_bf16 v[156:159], v[200:203], v[164:167], v[156:159]
    v_mul_f32 v6, s40, v251
    s_waitcnt lgkmcnt(0)
    s_barrier
    v_mfma_f32_16x16x32_bf16 v[88:91], v[212:215], v[204:207], v[88:91]
    ds_read_b128 v[160:163], v3 offset:36864
    v_mfma_f32_16x16x32_bf16 v[92:95], v[212:215], v[208:211], v[92:95]
    ds_read_b128 v[164:167], v3 offset:38912
    v_mul_f32 v5, v249, v249
    v_mfma_f32_16x16x32_bf16 v[96:99], v[216:219], v[204:207], v[96:99]
    ds_read_b128 v[168:171], v1 offset:36864
    v_mul_f32 v7, v251, v251
    v_mfma_f32_16x16x32_bf16 v[100:103], v[216:219], v[208:211], v[100:103]
    ds_read_b128 v[172:175], v1 offset:37888
    v_rcp_f32 v249, v249
    v_mfma_f32_16x16x32_bf16 v[104:107], v[220:223], v[204:207], v[104:107]
    ds_read_b128 v[176:179], v1 offset:38912
    v_rcp_f32 v251, v251
    v_mfma_f32_16x16x32_bf16 v[108:111], v[220:223], v[208:211], v[108:111]
    ds_read_b128 v[180:183], v1 offset:39936
    v_mul_f32 v5, s42, v5
    v_mfma_f32_16x16x32_bf16 v[112:115], v[224:227], v[204:207], v[112:115]
    ds_read_b128 v[184:187], v1 offset:40960
    v_mul_f32 v7, s42, v7
    v_mfma_f32_16x16x32_bf16 v[116:119], v[224:227], v[208:211], v[116:119]
    ds_read_b128 v[188:191], v1 offset:41984
    v_mfma_f32_16x16x32_bf16 v[120:123], v[228:231], v[204:207], v[120:123]
    ds_read_b128 v[192:195], v1 offset:43008
    v_mul_f32 v5, v5, v4
    v_mfma_f32_16x16x32_bf16 v[124:127], v[228:231], v[208:211], v[124:127]
    ds_read_b128 v[196:199], v1 offset:44032
    v_mul_f32 v7, v7, v6
    v_mfma_f32_16x16x32_bf16 v[128:131], v[232:235], v[204:207], v[128:131]
    ds_read_b128 v[200:203], v1 offset:45056
    v_bfe_u32 v13, v1, 4, 4
    v_mfma_f32_16x16x32_bf16 v[132:135], v[232:235], v[208:211], v[132:135]
    v_lshrrev_b32 v8, 1, v13
    v_lshrrev_b32 v9, 8, v1
    v_mfma_f32_16x16x32_bf16 v[136:139], v[236:239], v[204:207], v[136:139]
    v_xor_b32 v8, v8, v9
    v_lshlrev_b32 v8, 4, v8
    v_mfma_f32_16x16x32_bf16 v[140:143], v[236:239], v[208:211], v[140:143]
    v_lshl_add_u32 v8, v13, 7, v8
    s_add_u32 s33, s30, 18432
    v_mfma_f32_16x16x32_bf16 v[144:147], v[240:243], v[204:207], v[144:147]
    v_add_u32 v8, s33, v8
    v_xor_b32 v9, 64, v8
    v_mfma_f32_16x16x32_bf16 v[148:151], v[240:243], v[208:211], v[148:151]
    v_add_u32 v10, 73728, v8
    v_add_u32 v11, 73728, v9
    v_mfma_f32_16x16x32_bf16 v[152:155], v[244:247], v[204:207], v[152:155]
    s_lshl_b32 s33, s20, 6
    s_add_u32 s33, s33, 161280
    v_mfma_f32_16x16x32_bf16 v[156:159], v[244:247], v[208:211], v[156:159]
    v_lshl_add_u32 v13, v13, 1, s33
    s_waitcnt lgkmcnt(5)
    v_mfma_f32_16x16x32_bf16 v[88:91], v[168:171], v[160:163], v[88:91]
    ds_read_b128 v[204:207], v3 offset:37888
    v_mfma_f32_16x16x32_bf16 v[92:95], v[168:171], v[164:167], v[92:95]
    ds_read_b128 v[208:211], v3 offset:39936
    v_mfma_f32_16x16x32_bf16 v[96:99], v[172:175], v[160:163], v[96:99]
    ds_read_b128 v[212:215], v1 offset:46080
    v_mfma_f32_16x16x32_bf16 v[100:103], v[172:175], v[164:167], v[100:103]
    ds_read_b128 v[216:219], v1 offset:47104
    v_mfma_f32_16x16x32_bf16 v[104:107], v[176:179], v[160:163], v[104:107]
    ds_read_b128 v[220:223], v1 offset:48128
    v_mfma_f32_16x16x32_bf16 v[108:111], v[176:179], v[164:167], v[108:111]
    ds_read_b128 v[224:227], v1 offset:49152
    v_mfma_f32_16x16x32_bf16 v[112:115], v[180:183], v[160:163], v[112:115]
    ds_read_b128 v[228:231], v1 offset:50176
    v_mfma_f32_16x16x32_bf16 v[116:119], v[180:183], v[164:167], v[116:119]
    ds_read_b128 v[232:235], v1 offset:51200
    s_waitcnt lgkmcnt(8)
    v_mfma_f32_16x16x32_bf16 v[120:123], v[184:187], v[160:163], v[120:123]
    ds_read_b128 v[236:239], v1 offset:52224
    v_mfma_f32_16x16x32_bf16 v[124:127], v[184:187], v[164:167], v[124:127]
    ds_read_b128 v[240:243], v1 offset:53248
    v_mfma_f32_16x16x32_bf16 v[128:131], v[188:191], v[160:163], v[128:131]
    ds_read_b128 v[244:247], v1 offset:54272
    v_mfma_f32_16x16x32_bf16 v[132:135], v[188:191], v[164:167], v[132:135]
    v_mfma_f32_16x16x32_bf16 v[136:139], v[192:195], v[160:163], v[136:139]
    v_lshrrev_b32 v0, 4, v1
    v_mfma_f32_16x16x32_bf16 v[140:143], v[192:195], v[164:167], v[140:143]
    v_and_b32 v0, 48, v0
    v_mfma_f32_16x16x32_bf16 v[144:147], v[196:199], v[160:163], v[144:147]
    v_add_u32 v0, 160320, v0
    v_mfma_f32_16x16x32_bf16 v[148:151], v[196:199], v[164:167], v[148:151]
    v_mfma_f32_16x16x32_bf16 v[152:155], v[200:203], v[160:163], v[152:155]
    v_mfma_f32_16x16x32_bf16 v[156:159], v[200:203], v[164:167], v[156:159]
    s_waitcnt lgkmcnt(0)
    s_waitcnt vmcnt(0)
    s_barrier
    v_mfma_f32_16x16x32_bf16 v[88:91], v[212:215], v[204:207], v[88:91]
    ds_read_b128 v[168:171], v0 offset:0
    v_mfma_f32_16x16x32_bf16 v[92:95], v[212:215], v[208:211], v[92:95]
    ds_read_b128 v[172:175], v0 offset:64
    v_mfma_f32_16x16x32_bf16 v[96:99], v[216:219], v[204:207], v[96:99]
    ds_read_b128 v[176:179], v0 offset:128
    v_mfma_f32_16x16x32_bf16 v[100:103], v[216:219], v[208:211], v[100:103]
    ds_read_b128 v[180:183], v0 offset:192
    v_mfma_f32_16x16x32_bf16 v[104:107], v[220:223], v[204:207], v[104:107]
    ds_read_b128 v[184:187], v0 offset:256
    v_mfma_f32_16x16x32_bf16 v[108:111], v[220:223], v[208:211], v[108:111]
    ds_read_b128 v[188:191], v0 offset:320
    v_mfma_f32_16x16x32_bf16 v[112:115], v[224:227], v[204:207], v[112:115]
    ds_read_b128 v[192:195], v0 offset:384
    v_mfma_f32_16x16x32_bf16 v[116:119], v[224:227], v[208:211], v[116:119]
    ds_read_b128 v[196:199], v0 offset:448
    v_mfma_f32_16x16x32_bf16 v[120:123], v[228:231], v[204:207], v[120:123]
    ds_read_b128 v[200:203], v0 offset:512
    v_mfma_f32_16x16x32_bf16 v[124:127], v[228:231], v[208:211], v[124:127]
    ds_read_u16 v12, v13
    v_mfma_f32_16x16x32_bf16 v[128:131], v[232:235], v[204:207], v[128:131]
    ds_read_u16 v252, v13 offset:32
    v_mfma_f32_16x16x32_bf16 v[132:135], v[232:235], v[208:211], v[132:135]
    v_mfma_f32_16x16x32_bf16 v[136:139], v[236:239], v[204:207], v[136:139]
    v_mfma_f32_16x16x32_bf16 v[140:143], v[236:239], v[208:211], v[140:143]
    v_mfma_f32_16x16x32_bf16 v[144:147], v[240:243], v[204:207], v[144:147]
    v_mfma_f32_16x16x32_bf16 v[148:151], v[240:243], v[208:211], v[148:151]
    v_mfma_f32_16x16x32_bf16 v[152:155], v[244:247], v[204:207], v[152:155]
    v_mfma_f32_16x16x32_bf16 v[156:159], v[244:247], v[208:211], v[156:159]
    s_waitcnt lgkmcnt(0)
    v_lshlrev_b32 v15, 16, v12
    v_lshlrev_b32 v255, 16, v252
    v_lshlrev_b32 v14, 16, v12
    v_lshlrev_b32 v254, 16, v252
    v_lshlrev_b32 v13, 16, v12
    v_lshlrev_b32 v253, 16, v252
    v_lshlrev_b32 v12, 16, v12
    v_lshlrev_b32 v252, 16, v252
    v_pk_fma_f32 v[88:89], v[248:249], v[168:169], v[88:89] op_sel_hi:[0,1,1] neg_lo:[1,0,0] neg_hi:[1,0,0]
    v_pk_fma_f32 v[90:91], v[248:249], v[170:171], v[90:91] op_sel_hi:[0,1,1] neg_lo:[1,0,0] neg_hi:[1,0,0]
    v_pk_fma_f32 v[92:93], v[250:251], v[168:169], v[92:93] op_sel_hi:[0,1,1] neg_lo:[1,0,0] neg_hi:[1,0,0]
    v_pk_fma_f32 v[94:95], v[250:251], v[170:171], v[94:95] op_sel_hi:[0,1,1] neg_lo:[1,0,0] neg_hi:[1,0,0]
    v_pk_fma_f32 v[96:97], v[248:249], v[172:173], v[96:97] op_sel_hi:[0,1,1] neg_lo:[1,0,0] neg_hi:[1,0,0]
    v_pk_fma_f32 v[98:99], v[248:249], v[174:175], v[98:99] op_sel_hi:[0,1,1] neg_lo:[1,0,0] neg_hi:[1,0,0]
    v_pk_fma_f32 v[100:101], v[250:251], v[172:173], v[100:101] op_sel_hi:[0,1,1] neg_lo:[1,0,0] neg_hi:[1,0,0]
    v_pk_fma_f32 v[102:103], v[250:251], v[174:175], v[102:103] op_sel_hi:[0,1,1] neg_lo:[1,0,0] neg_hi:[1,0,0]
    v_pk_fma_f32 v[104:105], v[248:249], v[176:177], v[104:105] op_sel_hi:[0,1,1] neg_lo:[1,0,0] neg_hi:[1,0,0]
    v_pk_fma_f32 v[106:107], v[248:249], v[178:179], v[106:107] op_sel_hi:[0,1,1] neg_lo:[1,0,0] neg_hi:[1,0,0]
    v_pk_fma_f32 v[108:109], v[250:251], v[176:177], v[108:109] op_sel_hi:[0,1,1] neg_lo:[1,0,0] neg_hi:[1,0,0]
    v_pk_fma_f32 v[110:111], v[250:251], v[178:179], v[110:111] op_sel_hi:[0,1,1] neg_lo:[1,0,0] neg_hi:[1,0,0]
    v_pk_fma_f32 v[112:113], v[248:249], v[180:181], v[112:113] op_sel_hi:[0,1,1] neg_lo:[1,0,0] neg_hi:[1,0,0]
    v_pk_fma_f32 v[114:115], v[248:249], v[182:183], v[114:115] op_sel_hi:[0,1,1] neg_lo:[1,0,0] neg_hi:[1,0,0]
    v_pk_fma_f32 v[116:117], v[250:251], v[180:181], v[116:117] op_sel_hi:[0,1,1] neg_lo:[1,0,0] neg_hi:[1,0,0]
    v_pk_fma_f32 v[118:119], v[250:251], v[182:183], v[118:119] op_sel_hi:[0,1,1] neg_lo:[1,0,0] neg_hi:[1,0,0]
    v_pk_fma_f32 v[120:121], v[248:249], v[184:185], v[120:121] op_sel_hi:[0,1,1] neg_lo:[1,0,0] neg_hi:[1,0,0]
    v_pk_fma_f32 v[122:123], v[248:249], v[186:187], v[122:123] op_sel_hi:[0,1,1] neg_lo:[1,0,0] neg_hi:[1,0,0]
    v_pk_fma_f32 v[124:125], v[250:251], v[184:185], v[124:125] op_sel_hi:[0,1,1] neg_lo:[1,0,0] neg_hi:[1,0,0]
    v_pk_fma_f32 v[126:127], v[250:251], v[186:187], v[126:127] op_sel_hi:[0,1,1] neg_lo:[1,0,0] neg_hi:[1,0,0]
    v_pk_fma_f32 v[128:129], v[248:249], v[188:189], v[128:129] op_sel_hi:[0,1,1] neg_lo:[1,0,0] neg_hi:[1,0,0]
    v_pk_fma_f32 v[130:131], v[248:249], v[190:191], v[130:131] op_sel_hi:[0,1,1] neg_lo:[1,0,0] neg_hi:[1,0,0]
    v_pk_fma_f32 v[132:133], v[250:251], v[188:189], v[132:133] op_sel_hi:[0,1,1] neg_lo:[1,0,0] neg_hi:[1,0,0]
    v_pk_fma_f32 v[134:135], v[250:251], v[190:191], v[134:135] op_sel_hi:[0,1,1] neg_lo:[1,0,0] neg_hi:[1,0,0]
    v_pk_fma_f32 v[136:137], v[248:249], v[192:193], v[136:137] op_sel_hi:[0,1,1] neg_lo:[1,0,0] neg_hi:[1,0,0]
    v_pk_fma_f32 v[138:139], v[248:249], v[194:195], v[138:139] op_sel_hi:[0,1,1] neg_lo:[1,0,0] neg_hi:[1,0,0]
    v_pk_fma_f32 v[140:141], v[250:251], v[192:193], v[140:141] op_sel_hi:[0,1,1] neg_lo:[1,0,0] neg_hi:[1,0,0]
    v_pk_fma_f32 v[142:143], v[250:251], v[194:195], v[142:143] op_sel_hi:[0,1,1] neg_lo:[1,0,0] neg_hi:[1,0,0]
    v_pk_fma_f32 v[144:145], v[248:249], v[196:197], v[144:145] op_sel_hi:[0,1,1] neg_lo:[1,0,0] neg_hi:[1,0,0]
    v_pk_fma_f32 v[146:147], v[248:249], v[198:199], v[146:147] op_sel_hi:[0,1,1] neg_lo:[1,0,0] neg_hi:[1,0,0]
    v_pk_fma_f32 v[148:149], v[250:251], v[196:197], v[148:149] op_sel_hi:[0,1,1] neg_lo:[1,0,0] neg_hi:[1,0,0]
    v_pk_fma_f32 v[150:151], v[250:251], v[198:199], v[150:151] op_sel_hi:[0,1,1] neg_lo:[1,0,0] neg_hi:[1,0,0]
    v_pk_fma_f32 v[152:153], v[248:249], v[200:201], v[152:153] op_sel_hi:[0,1,1] neg_lo:[1,0,0] neg_hi:[1,0,0]
    v_pk_fma_f32 v[154:155], v[248:249], v[202:203], v[154:155] op_sel_hi:[0,1,1] neg_lo:[1,0,0] neg_hi:[1,0,0]
    v_pk_fma_f32 v[156:157], v[250:251], v[200:201], v[156:157] op_sel_hi:[0,1,1] neg_lo:[1,0,0] neg_hi:[1,0,0]
    v_pk_fma_f32 v[158:159], v[250:251], v[202:203], v[158:159] op_sel_hi:[0,1,1] neg_lo:[1,0,0] neg_hi:[1,0,0]
    v_pk_mul_f32 v[204:205], v[88:89], v[88:89]
    v_pk_mul_f32 v[206:207], v[90:91], v[90:91]
    v_pk_mul_f32 v[208:209], v[92:93], v[92:93]
    v_pk_mul_f32 v[210:211], v[94:95], v[94:95]
    v_pk_fma_f32 v[204:205], v[204:205], v[4:5], v[4:5] op_sel:[0,1,0] op_sel_hi:[1,1,0]
    v_pk_fma_f32 v[206:207], v[206:207], v[4:5], v[4:5] op_sel:[0,1,0] op_sel_hi:[1,1,0]
    v_pk_fma_f32 v[208:209], v[208:209], v[6:7], v[6:7] op_sel:[0,1,0] op_sel_hi:[1,1,0]
    v_pk_fma_f32 v[210:211], v[210:211], v[6:7], v[6:7] op_sel:[0,1,0] op_sel_hi:[1,1,0]
    v_pk_mul_f32 v[204:205], v[204:205], v[88:89]
    v_pk_mul_f32 v[206:207], v[206:207], v[90:91]
    v_pk_mul_f32 v[208:209], v[208:209], v[92:93]
    v_pk_mul_f32 v[210:211], v[210:211], v[94:95]
    v_exp_f32 v204, v204
    v_exp_f32 v205, v205
    v_exp_f32 v206, v206
    v_exp_f32 v207, v207
    v_exp_f32 v208, v208
    v_exp_f32 v209, v209
    v_exp_f32 v210, v210
    v_exp_f32 v211, v211
    v_pk_fma_f32 v[204:205], v[204:205], v[248:249], v[248:249] op_sel:[0,1,1] op_sel_hi:[1,1,1]
    v_pk_fma_f32 v[206:207], v[206:207], v[248:249], v[248:249] op_sel:[0,1,1] op_sel_hi:[1,1,1]
    v_pk_fma_f32 v[208:209], v[208:209], v[250:251], v[250:251] op_sel:[0,1,1] op_sel_hi:[1,1,1]
    v_pk_fma_f32 v[210:211], v[210:211], v[250:251], v[250:251] op_sel:[0,1,1] op_sel_hi:[1,1,1]
    v_rcp_f32 v204, v204
    v_rcp_f32 v205, v205
    v_rcp_f32 v206, v206
    v_rcp_f32 v207, v207
    v_rcp_f32 v208, v208
    v_rcp_f32 v209, v209
    v_rcp_f32 v210, v210
    v_rcp_f32 v211, v211
    v_pk_mul_f32 v[88:89], v[88:89], v[204:205]
    v_pk_mul_f32 v[90:91], v[90:91], v[206:207]
    v_pk_mul_f32 v[92:93], v[92:93], v[208:209]
    v_pk_mul_f32 v[94:95], v[94:95], v[210:211]
    v_pk_mul_f32 v[212:213], v[96:97], v[96:97]
    v_pk_mul_f32 v[214:215], v[98:99], v[98:99]
    v_pk_mul_f32 v[216:217], v[100:101], v[100:101]
    v_pk_mul_f32 v[218:219], v[102:103], v[102:103]
    v_pk_fma_f32 v[212:213], v[212:213], v[4:5], v[4:5] op_sel:[0,1,0] op_sel_hi:[1,1,0]
    v_pk_fma_f32 v[214:215], v[214:215], v[4:5], v[4:5] op_sel:[0,1,0] op_sel_hi:[1,1,0]
    v_pk_fma_f32 v[216:217], v[216:217], v[6:7], v[6:7] op_sel:[0,1,0] op_sel_hi:[1,1,0]
    v_pk_fma_f32 v[218:219], v[218:219], v[6:7], v[6:7] op_sel:[0,1,0] op_sel_hi:[1,1,0]
    v_pk_mul_f32 v[212:213], v[212:213], v[96:97]
    v_pk_mul_f32 v[214:215], v[214:215], v[98:99]
    v_pk_mul_f32 v[216:217], v[216:217], v[100:101]
    v_pk_mul_f32 v[218:219], v[218:219], v[102:103]
    v_exp_f32 v212, v212
    v_exp_f32 v213, v213
    v_exp_f32 v214, v214
    v_exp_f32 v215, v215
    v_exp_f32 v216, v216
    v_exp_f32 v217, v217
    v_exp_f32 v218, v218
    v_exp_f32 v219, v219
    v_pk_fma_f32 v[212:213], v[212:213], v[248:249], v[248:249] op_sel:[0,1,1] op_sel_hi:[1,1,1]
    v_pk_fma_f32 v[214:215], v[214:215], v[248:249], v[248:249] op_sel:[0,1,1] op_sel_hi:[1,1,1]
    v_pk_fma_f32 v[216:217], v[216:217], v[250:251], v[250:251] op_sel:[0,1,1] op_sel_hi:[1,1,1]
    v_pk_fma_f32 v[218:219], v[218:219], v[250:251], v[250:251] op_sel:[0,1,1] op_sel_hi:[1,1,1]
    v_rcp_f32 v212, v212
    v_rcp_f32 v213, v213
    v_rcp_f32 v214, v214
    v_rcp_f32 v215, v215
    v_rcp_f32 v216, v216
    v_rcp_f32 v217, v217
    v_rcp_f32 v218, v218
    v_rcp_f32 v219, v219
    v_pk_mul_f32 v[96:97], v[96:97], v[212:213]
    v_pk_mul_f32 v[98:99], v[98:99], v[214:215]
    v_pk_mul_f32 v[100:101], v[100:101], v[216:217]
    v_pk_mul_f32 v[102:103], v[102:103], v[218:219]
    v_pk_mul_f32 v[204:205], v[104:105], v[104:105]
    v_pk_mul_f32 v[206:207], v[106:107], v[106:107]
    v_pk_mul_f32 v[208:209], v[108:109], v[108:109]
    v_pk_mul_f32 v[210:211], v[110:111], v[110:111]
    v_pk_fma_f32 v[204:205], v[204:205], v[4:5], v[4:5] op_sel:[0,1,0] op_sel_hi:[1,1,0]
    v_pk_fma_f32 v[206:207], v[206:207], v[4:5], v[4:5] op_sel:[0,1,0] op_sel_hi:[1,1,0]
    v_pk_fma_f32 v[208:209], v[208:209], v[6:7], v[6:7] op_sel:[0,1,0] op_sel_hi:[1,1,0]
    v_pk_fma_f32 v[210:211], v[210:211], v[6:7], v[6:7] op_sel:[0,1,0] op_sel_hi:[1,1,0]
    v_pk_mul_f32 v[204:205], v[204:205], v[104:105]
    v_pk_mul_f32 v[206:207], v[206:207], v[106:107]
    v_pk_mul_f32 v[208:209], v[208:209], v[108:109]
    v_pk_mul_f32 v[210:211], v[210:211], v[110:111]
    v_exp_f32 v204, v204
    v_exp_f32 v205, v205
    v_exp_f32 v206, v206
    v_exp_f32 v207, v207
    v_exp_f32 v208, v208
    v_exp_f32 v209, v209
    v_exp_f32 v210, v210
    v_exp_f32 v211, v211
    v_pk_fma_f32 v[204:205], v[204:205], v[248:249], v[248:249] op_sel:[0,1,1] op_sel_hi:[1,1,1]
    v_pk_fma_f32 v[206:207], v[206:207], v[248:249], v[248:249] op_sel:[0,1,1] op_sel_hi:[1,1,1]
    v_pk_fma_f32 v[208:209], v[208:209], v[250:251], v[250:251] op_sel:[0,1,1] op_sel_hi:[1,1,1]
    v_pk_fma_f32 v[210:211], v[210:211], v[250:251], v[250:251] op_sel:[0,1,1] op_sel_hi:[1,1,1]
    v_rcp_f32 v204, v204
    v_rcp_f32 v205, v205
    v_rcp_f32 v206, v206
    v_rcp_f32 v207, v207
    v_rcp_f32 v208, v208
    v_rcp_f32 v209, v209
    v_rcp_f32 v210, v210
    v_rcp_f32 v211, v211
    v_pk_mul_f32 v[104:105], v[104:105], v[204:205]
    v_pk_mul_f32 v[106:107], v[106:107], v[206:207]
    v_pk_mul_f32 v[108:109], v[108:109], v[208:209]
    v_pk_mul_f32 v[110:111], v[110:111], v[210:211]
    v_pk_mul_f32 v[212:213], v[112:113], v[112:113]
    v_pk_mul_f32 v[214:215], v[114:115], v[114:115]
    v_pk_mul_f32 v[216:217], v[116:117], v[116:117]
    v_pk_mul_f32 v[218:219], v[118:119], v[118:119]
    v_pk_fma_f32 v[212:213], v[212:213], v[4:5], v[4:5] op_sel:[0,1,0] op_sel_hi:[1,1,0]
    v_pk_fma_f32 v[214:215], v[214:215], v[4:5], v[4:5] op_sel:[0,1,0] op_sel_hi:[1,1,0]
    v_pk_fma_f32 v[216:217], v[216:217], v[6:7], v[6:7] op_sel:[0,1,0] op_sel_hi:[1,1,0]
    v_pk_fma_f32 v[218:219], v[218:219], v[6:7], v[6:7] op_sel:[0,1,0] op_sel_hi:[1,1,0]
    v_pk_mul_f32 v[212:213], v[212:213], v[112:113]
    v_pk_mul_f32 v[214:215], v[214:215], v[114:115]
    v_pk_mul_f32 v[216:217], v[216:217], v[116:117]
    v_pk_mul_f32 v[218:219], v[218:219], v[118:119]
    v_exp_f32 v212, v212
    v_exp_f32 v213, v213
    v_exp_f32 v214, v214
    v_exp_f32 v215, v215
    v_exp_f32 v216, v216
    v_exp_f32 v217, v217
    v_exp_f32 v218, v218
    v_exp_f32 v219, v219
    v_pk_fma_f32 v[212:213], v[212:213], v[248:249], v[248:249] op_sel:[0,1,1] op_sel_hi:[1,1,1]
    v_pk_fma_f32 v[214:215], v[214:215], v[248:249], v[248:249] op_sel:[0,1,1] op_sel_hi:[1,1,1]
    v_pk_fma_f32 v[216:217], v[216:217], v[250:251], v[250:251] op_sel:[0,1,1] op_sel_hi:[1,1,1]
    v_pk_fma_f32 v[218:219], v[218:219], v[250:251], v[250:251] op_sel:[0,1,1] op_sel_hi:[1,1,1]
    v_rcp_f32 v212, v212
    v_rcp_f32 v213, v213
    v_rcp_f32 v214, v214
    v_rcp_f32 v215, v215
    v_rcp_f32 v216, v216
    v_rcp_f32 v217, v217
    v_rcp_f32 v218, v218
    v_rcp_f32 v219, v219
    v_pk_mul_f32 v[112:113], v[112:113], v[212:213]
    v_pk_mul_f32 v[114:115], v[114:115], v[214:215]
    v_pk_mul_f32 v[116:117], v[116:117], v[216:217]
    v_pk_mul_f32 v[118:119], v[118:119], v[218:219]
    v_pk_mul_f32 v[204:205], v[120:121], v[120:121]
    v_pk_mul_f32 v[206:207], v[122:123], v[122:123]
    v_pk_mul_f32 v[208:209], v[124:125], v[124:125]
    v_pk_mul_f32 v[210:211], v[126:127], v[126:127]
    v_pk_fma_f32 v[204:205], v[204:205], v[4:5], v[4:5] op_sel:[0,1,0] op_sel_hi:[1,1,0]
    v_pk_fma_f32 v[206:207], v[206:207], v[4:5], v[4:5] op_sel:[0,1,0] op_sel_hi:[1,1,0]
    v_pk_fma_f32 v[208:209], v[208:209], v[6:7], v[6:7] op_sel:[0,1,0] op_sel_hi:[1,1,0]
    v_pk_fma_f32 v[210:211], v[210:211], v[6:7], v[6:7] op_sel:[0,1,0] op_sel_hi:[1,1,0]
    v_pk_mul_f32 v[204:205], v[204:205], v[120:121]
    v_pk_mul_f32 v[206:207], v[206:207], v[122:123]
    v_pk_mul_f32 v[208:209], v[208:209], v[124:125]
    v_pk_mul_f32 v[210:211], v[210:211], v[126:127]
    v_exp_f32 v204, v204
    v_exp_f32 v205, v205
    v_exp_f32 v206, v206
    v_exp_f32 v207, v207
    v_exp_f32 v208, v208
    v_exp_f32 v209, v209
    v_exp_f32 v210, v210
    v_exp_f32 v211, v211
    v_pk_fma_f32 v[204:205], v[204:205], v[248:249], v[248:249] op_sel:[0,1,1] op_sel_hi:[1,1,1]
    v_pk_fma_f32 v[206:207], v[206:207], v[248:249], v[248:249] op_sel:[0,1,1] op_sel_hi:[1,1,1]
    v_pk_fma_f32 v[208:209], v[208:209], v[250:251], v[250:251] op_sel:[0,1,1] op_sel_hi:[1,1,1]
    v_pk_fma_f32 v[210:211], v[210:211], v[250:251], v[250:251] op_sel:[0,1,1] op_sel_hi:[1,1,1]
    v_rcp_f32 v204, v204
    v_rcp_f32 v205, v205
    v_rcp_f32 v206, v206
    v_rcp_f32 v207, v207
    v_rcp_f32 v208, v208
    v_rcp_f32 v209, v209
    v_rcp_f32 v210, v210
    v_rcp_f32 v211, v211
    v_pk_mul_f32 v[120:121], v[120:121], v[204:205]
    v_pk_mul_f32 v[122:123], v[122:123], v[206:207]
    v_pk_mul_f32 v[124:125], v[124:125], v[208:209]
    v_pk_mul_f32 v[126:127], v[126:127], v[210:211]
    v_pk_mul_f32 v[212:213], v[128:129], v[128:129]
    v_pk_mul_f32 v[214:215], v[130:131], v[130:131]
    v_pk_mul_f32 v[216:217], v[132:133], v[132:133]
    v_pk_mul_f32 v[218:219], v[134:135], v[134:135]
    v_pk_fma_f32 v[212:213], v[212:213], v[4:5], v[4:5] op_sel:[0,1,0] op_sel_hi:[1,1,0]
    v_pk_fma_f32 v[214:215], v[214:215], v[4:5], v[4:5] op_sel:[0,1,0] op_sel_hi:[1,1,0]
    v_pk_fma_f32 v[216:217], v[216:217], v[6:7], v[6:7] op_sel:[0,1,0] op_sel_hi:[1,1,0]
    v_pk_fma_f32 v[218:219], v[218:219], v[6:7], v[6:7] op_sel:[0,1,0] op_sel_hi:[1,1,0]
    v_pk_mul_f32 v[212:213], v[212:213], v[128:129]
    v_pk_mul_f32 v[214:215], v[214:215], v[130:131]
    v_pk_mul_f32 v[216:217], v[216:217], v[132:133]
    v_pk_mul_f32 v[218:219], v[218:219], v[134:135]
    v_exp_f32 v212, v212
    v_exp_f32 v213, v213
    v_exp_f32 v214, v214
    v_exp_f32 v215, v215
    v_exp_f32 v216, v216
    v_exp_f32 v217, v217
    v_exp_f32 v218, v218
    v_exp_f32 v219, v219
    v_pk_fma_f32 v[212:213], v[212:213], v[248:249], v[248:249] op_sel:[0,1,1] op_sel_hi:[1,1,1]
    v_pk_fma_f32 v[214:215], v[214:215], v[248:249], v[248:249] op_sel:[0,1,1] op_sel_hi:[1,1,1]
    v_pk_fma_f32 v[216:217], v[216:217], v[250:251], v[250:251] op_sel:[0,1,1] op_sel_hi:[1,1,1]
    v_pk_fma_f32 v[218:219], v[218:219], v[250:251], v[250:251] op_sel:[0,1,1] op_sel_hi:[1,1,1]
    v_rcp_f32 v212, v212
    v_rcp_f32 v213, v213
    v_rcp_f32 v214, v214
    v_rcp_f32 v215, v215
    v_rcp_f32 v216, v216
    v_rcp_f32 v217, v217
    v_rcp_f32 v218, v218
    v_rcp_f32 v219, v219
    v_pk_mul_f32 v[128:129], v[128:129], v[212:213]
    v_pk_mul_f32 v[130:131], v[130:131], v[214:215]
    v_pk_mul_f32 v[132:133], v[132:133], v[216:217]
    v_pk_mul_f32 v[134:135], v[134:135], v[218:219]
    s_barrier
    ds_read_b128 v[160:163], v10 offset:0
    ds_read_b128 v[164:167], v10 offset:2048
    ds_read_b128 v[168:171], v2 offset:0
    ds_read_b128 v[172:175], v2 offset:1024
    ds_read_b128 v[176:179], v2 offset:2048
    ds_read_b128 v[180:183], v2 offset:3072
    ds_read_b128 v[184:187], v2 offset:4096
    ds_read_b128 v[188:191], v2 offset:5120
    ds_read_b128 v[192:195], v2 offset:6144
    ds_read_b128 v[196:199], v2 offset:7168
    ds_read_b128 v[200:203], v2 offset:8192
    v_pk_mul_f32 v[204:205], v[136:137], v[136:137]
    v_pk_mul_f32 v[206:207], v[138:139], v[138:139]
    v_pk_mul_f32 v[208:209], v[140:141], v[140:141]
    v_pk_mul_f32 v[210:211], v[142:143], v[142:143]
    v_pk_fma_f32 v[204:205], v[204:205], v[4:5], v[4:5] op_sel:[0,1,0] op_sel_hi:[1,1,0]
    v_pk_fma_f32 v[206:207], v[206:207], v[4:5], v[4:5] op_sel:[0,1,0] op_sel_hi:[1,1,0]
    v_pk_fma_f32 v[208:209], v[208:209], v[6:7], v[6:7] op_sel:[0,1,0] op_sel_hi:[1,1,0]
    v_pk_fma_f32 v[210:211], v[210:211], v[6:7], v[6:7] op_sel:[0,1,0] op_sel_hi:[1,1,0]
    v_pk_mul_f32 v[204:205], v[204:205], v[136:137]
    v_pk_mul_f32 v[206:207], v[206:207], v[138:139]
    v_pk_mul_f32 v[208:209], v[208:209], v[140:141]
    v_pk_mul_f32 v[210:211], v[210:211], v[142:143]
    v_exp_f32 v204, v204
    v_exp_f32 v205, v205
    v_exp_f32 v206, v206
    v_exp_f32 v207, v207
    v_exp_f32 v208, v208
    v_exp_f32 v209, v209
    v_exp_f32 v210, v210
    v_exp_f32 v211, v211
    v_pk_fma_f32 v[204:205], v[204:205], v[248:249], v[248:249] op_sel:[0,1,1] op_sel_hi:[1,1,1]
    v_pk_fma_f32 v[206:207], v[206:207], v[248:249], v[248:249] op_sel:[0,1,1] op_sel_hi:[1,1,1]
    v_pk_fma_f32 v[208:209], v[208:209], v[250:251], v[250:251] op_sel:[0,1,1] op_sel_hi:[1,1,1]
    v_pk_fma_f32 v[210:211], v[210:211], v[250:251], v[250:251] op_sel:[0,1,1] op_sel_hi:[1,1,1]
    v_rcp_f32 v204, v204
    v_rcp_f32 v205, v205
    v_rcp_f32 v206, v206
    v_rcp_f32 v207, v207
    v_rcp_f32 v208, v208
    v_rcp_f32 v209, v209
    v_rcp_f32 v210, v210
    v_rcp_f32 v211, v211
    v_pk_mul_f32 v[136:137], v[136:137], v[204:205]
    v_pk_mul_f32 v[138:139], v[138:139], v[206:207]
    v_pk_mul_f32 v[140:141], v[140:141], v[208:209]
    v_pk_mul_f32 v[142:143], v[142:143], v[210:211]
    s_waitcnt lgkmcnt(5)
    v_mfma_f32_16x16x32_bf16 v[16:19], v[168:171], v[160:163], v[12:15]
    ds_read_b128 v[204:207], v11 offset:0
    v_mfma_f32_16x16x32_bf16 v[20:23], v[168:171], v[164:167], v[252:255]
    ds_read_b128 v[208:211], v11 offset:2048
    v_mfma_f32_16x16x32_bf16 v[24:27], v[172:175], v[160:163], v[12:15]
    ds_read_b128 v[212:215], v2 offset:9216
    v_mfma_f32_16x16x32_bf16 v[28:31], v[172:175], v[164:167], v[252:255]
    ds_read_b128 v[216:219], v2 offset:10240
    v_mfma_f32_16x16x32_bf16 v[32:35], v[176:179], v[160:163], v[12:15]
    ds_read_b128 v[220:223], v2 offset:11264
    v_mfma_f32_16x16x32_bf16 v[36:39], v[176:179], v[164:167], v[252:255]
    ds_read_b128 v[224:227], v2 offset:12288
    v_mfma_f32_16x16x32_bf16 v[40:43], v[180:183], v[160:163], v[12:15]
    ds_read_b128 v[228:231], v2 offset:13312
    v_mfma_f32_16x16x32_bf16 v[44:47], v[180:183], v[164:167], v[252:255]
    ds_read_b128 v[232:235], v2 offset:14336
    s_waitcnt lgkmcnt(8)
    v_mfma_f32_16x16x32_bf16 v[48:51], v[184:187], v[160:163], v[12:15]
    ds_read_b128 v[236:239], v2 offset:15360
    v_mfma_f32_16x16x32_bf16 v[52:55], v[184:187], v[164:167], v[252:255]
    ds_read_b128 v[240:243], v2 offset:16384
    v_mfma_f32_16x16x32_bf16 v[56:59], v[188:191], v[160:163], v[12:15]
    ds_read_b128 v[244:247], v2 offset:17408
    v_mfma_f32_16x16x32_bf16 v[60:63], v[188:191], v[164:167], v[252:255]
    v_mfma_f32_16x16x32_bf16 v[64:67], v[192:195], v[160:163], v[12:15]
    v_mfma_f32_16x16x32_bf16 v[68:71], v[192:195], v[164:167], v[252:255]
    v_mfma_f32_16x16x32_bf16 v[72:75], v[196:199], v[160:163], v[12:15]
    v_mfma_f32_16x16x32_bf16 v[76:79], v[196:199], v[164:167], v[252:255]
    v_mfma_f32_16x16x32_bf16 v[80:83], v[200:203], v[160:163], v[12:15]
    v_mfma_f32_16x16x32_bf16 v[84:87], v[200:203], v[164:167], v[252:255]
    s_waitcnt lgkmcnt(0)
    s_barrier
    v_mfma_f32_16x16x32_bf16 v[16:19], v[212:215], v[204:207], v[16:19]
    ds_read_b128 v[160:163], v10 offset:36864
    v_mfma_f32_16x16x32_bf16 v[20:23], v[212:215], v[208:211], v[20:23]
    ds_read_b128 v[164:167], v10 offset:38912
    v_mfma_f32_16x16x32_bf16 v[24:27], v[216:219], v[204:207], v[24:27]
    ds_read_b128 v[168:171], v2 offset:36864
    v_mfma_f32_16x16x32_bf16 v[28:31], v[216:219], v[208:211], v[28:31]
    ds_read_b128 v[172:175], v2 offset:37888
    v_mul_f32 v12, v144, v144
    v_mfma_f32_16x16x32_bf16 v[32:35], v[220:223], v[204:207], v[32:35]
    ds_read_b128 v[176:179], v2 offset:38912
    v_mul_f32 v13, v145, v145
    v_mfma_f32_16x16x32_bf16 v[36:39], v[220:223], v[208:211], v[36:39]
    ds_read_b128 v[180:183], v2 offset:39936
    v_mul_f32 v14, v146, v146
    v_mfma_f32_16x16x32_bf16 v[40:43], v[224:227], v[204:207], v[40:43]
    ds_read_b128 v[184:187], v2 offset:40960
    v_mul_f32 v15, v147, v147
    v_mfma_f32_16x16x32_bf16 v[44:47], v[224:227], v[208:211], v[44:47]
    ds_read_b128 v[188:191], v2 offset:41984
    v_mfma_f32_16x16x32_bf16 v[48:51], v[228:231], v[204:207], v[48:51]
    ds_read_b128 v[192:195], v2 offset:43008
    v_mul_f32 v252, v148, v148
    v_mfma_f32_16x16x32_bf16 v[52:55], v[228:231], v[208:211], v[52:55]
    ds_read_b128 v[196:199], v2 offset:44032
    v_mul_f32 v253, v149, v149
    v_mfma_f32_16x16x32_bf16 v[56:59], v[232:235], v[204:207], v[56:59]
    ds_read_b128 v[200:203], v2 offset:45056
    v_mul_f32 v254, v150, v150
    v_mfma_f32_16x16x32_bf16 v[60:63], v[232:235], v[208:211], v[60:63]
    v_mul_f32 v255, v151, v151
    v_fma_f32 v12, v12, v5, v4
    v_mfma_f32_16x16x32_bf16 v[64:67], v[236:239], v[204:207], v[64:67]
    v_fma_f32 v13, v13, v5, v4
    v_fma_f32 v14, v14, v5, v4
    v_mfma_f32_16x16x32_bf16 v[68:71], v[236:239], v[208:211], v[68:71]
    v_fma_f32 v15, v15, v5, v4
    v_fma_f32 v252, v252, v7, v6
    v_mfma_f32_16x16x32_bf16 v[72:75], v[240:243], v[204:207], v[72:75]
    v_fma_f32 v253, v253, v7, v6
    v_fma_f32 v254, v254, v7, v6
    v_mfma_f32_16x16x32_bf16 v[76:79], v[240:243], v[208:211], v[76:79]
    v_fma_f32 v255, v255, v7, v6
    v_mul_f32 v12, v12, v144
    v_mfma_f32_16x16x32_bf16 v[80:83], v[244:247], v[204:207], v[80:83]
    v_mul_f32 v13, v13, v145
    v_mul_f32 v14, v14, v146
    v_mfma_f32_16x16x32_bf16 v[84:87], v[244:247], v[208:211], v[84:87]
    v_mul_f32 v15, v15, v147
    s_waitcnt lgkmcnt(5)
    v_mfma_f32_16x16x32_bf16 v[16:19], v[168:171], v[160:163], v[16:19]
    ds_read_b128 v[204:207], v11 offset:36864
    v_mfma_f32_16x16x32_bf16 v[20:23], v[168:171], v[164:167], v[20:23]
    ds_read_b128 v[208:211], v11 offset:38912
    v_mul_f32 v252, v252, v148
    v_mfma_f32_16x16x32_bf16 v[24:27], v[172:175], v[160:163], v[24:27]
    ds_read_b128 v[212:215], v2 offset:46080
    v_mul_f32 v253, v253, v149
    v_mfma_f32_16x16x32_bf16 v[28:31], v[172:175], v[164:167], v[28:31]
    ds_read_b128 v[216:219], v2 offset:47104
    v_mul_f32 v254, v254, v150
    v_mfma_f32_16x16x32_bf16 v[32:35], v[176:179], v[160:163], v[32:35]
    ds_read_b128 v[220:223], v2 offset:48128
    v_mul_f32 v255, v255, v151
    v_mfma_f32_16x16x32_bf16 v[36:39], v[176:179], v[164:167], v[36:39]
    ds_read_b128 v[224:227], v2 offset:49152
    v_exp_f32 v12, v12
    v_mfma_f32_16x16x32_bf16 v[40:43], v[180:183], v[160:163], v[40:43]
    ds_read_b128 v[228:231], v2 offset:50176
    v_exp_f32 v13, v13
    v_mfma_f32_16x16x32_bf16 v[44:47], v[180:183], v[164:167], v[44:47]
    ds_read_b128 v[232:235], v2 offset:51200
    s_waitcnt lgkmcnt(8)
    v_mfma_f32_16x16x32_bf16 v[48:51], v[184:187], v[160:163], v[48:51]
    ds_read_b128 v[236:239], v2 offset:52224
    v_exp_f32 v14, v14
    v_mfma_f32_16x16x32_bf16 v[52:55], v[184:187], v[164:167], v[52:55]
    ds_read_b128 v[240:243], v2 offset:53248
    v_exp_f32 v15, v15
    v_mfma_f32_16x16x32_bf16 v[56:59], v[188:191], v[160:163], v[56:59]
    ds_read_b128 v[244:247], v2 offset:54272
    v_exp_f32 v252, v252
    v_mfma_f32_16x16x32_bf16 v[60:63], v[188:191], v[164:167], v[60:63]
    v_exp_f32 v253, v253
    v_mfma_f32_16x16x32_bf16 v[64:67], v[192:195], v[160:163], v[64:67]
    v_exp_f32 v254, v254
    v_mfma_f32_16x16x32_bf16 v[68:71], v[192:195], v[164:167], v[68:71]
    v_exp_f32 v255, v255
    v_mfma_f32_16x16x32_bf16 v[72:75], v[196:199], v[160:163], v[72:75]
    v_fma_f32 v12, v12, v249, v249
    v_fma_f32 v13, v13, v249, v249
    v_mfma_f32_16x16x32_bf16 v[76:79], v[196:199], v[164:167], v[76:79]
    v_fma_f32 v14, v14, v249, v249
    v_fma_f32 v15, v15, v249, v249
    v_mfma_f32_16x16x32_bf16 v[80:83], v[200:203], v[160:163], v[80:83]
    v_fma_f32 v252, v252, v251, v251
    v_fma_f32 v253, v253, v251, v251
    v_mfma_f32_16x16x32_bf16 v[84:87], v[200:203], v[164:167], v[84:87]
    v_fma_f32 v254, v254, v251, v251
    s_waitcnt lgkmcnt(0)
    s_barrier
    v_mfma_f32_16x16x32_bf16 v[16:19], v[212:215], v[204:207], v[16:19]
    ds_read_b128 v[160:163], v8 offset:0
    v_mfma_f32_16x16x32_bf16 v[20:23], v[212:215], v[208:211], v[20:23]
    ds_read_b128 v[164:167], v8 offset:2048
    v_fma_f32 v255, v255, v251, v251
    v_mfma_f32_16x16x32_bf16 v[24:27], v[216:219], v[204:207], v[24:27]
    ds_read_b128 v[168:171], v1 offset:0
    v_rcp_f32 v12, v12
    v_mfma_f32_16x16x32_bf16 v[28:31], v[216:219], v[208:211], v[28:31]
    ds_read_b128 v[172:175], v1 offset:1024
    v_rcp_f32 v13, v13
    v_mfma_f32_16x16x32_bf16 v[32:35], v[220:223], v[204:207], v[32:35]
    ds_read_b128 v[176:179], v1 offset:2048
    v_rcp_f32 v14, v14
    v_mfma_f32_16x16x32_bf16 v[36:39], v[220:223], v[208:211], v[36:39]
    ds_read_b128 v[180:183], v1 offset:3072
    v_rcp_f32 v15, v15
    v_mfma_f32_16x16x32_bf16 v[40:43], v[224:227], v[204:207], v[40:43]
    ds_read_b128 v[184:187], v1 offset:4096
    v_rcp_f32 v252, v252
    v_mfma_f32_16x16x32_bf16 v[44:47], v[224:227], v[208:211], v[44:47]
    ds_read_b128 v[188:191], v1 offset:5120
    v_mfma_f32_16x16x32_bf16 v[48:51], v[228:231], v[204:207], v[48:51]
    ds_read_b128 v[192:195], v1 offset:6144
    v_rcp_f32 v253, v253
    v_mfma_f32_16x16x32_bf16 v[52:55], v[228:231], v[208:211], v[52:55]
    ds_read_b128 v[196:199], v1 offset:7168
    v_rcp_f32 v254, v254
    v_mfma_f32_16x16x32_bf16 v[56:59], v[232:235], v[204:207], v[56:59]
    ds_read_b128 v[200:203], v1 offset:8192
    v_rcp_f32 v255, v255
    v_mfma_f32_16x16x32_bf16 v[60:63], v[232:235], v[208:211], v[60:63]
    v_mul_f32 v144, v144, v12
    v_mul_f32 v145, v145, v13
    v_mfma_f32_16x16x32_bf16 v[64:67], v[236:239], v[204:207], v[64:67]
    v_mul_f32 v146, v146, v14
    v_mul_f32 v147, v147, v15
    v_mfma_f32_16x16x32_bf16 v[68:71], v[236:239], v[208:211], v[68:71]
    v_mul_f32 v148, v148, v252
    v_mul_f32 v149, v149, v253
    v_mfma_f32_16x16x32_bf16 v[72:75], v[240:243], v[204:207], v[72:75]
    v_mul_f32 v150, v150, v254
    v_mul_f32 v151, v151, v255
    v_mfma_f32_16x16x32_bf16 v[76:79], v[240:243], v[208:211], v[76:79]
    v_mul_f32 v12, v152, v152
    v_mul_f32 v13, v153, v153
    v_mfma_f32_16x16x32_bf16 v[80:83], v[244:247], v[204:207], v[80:83]
    v_mul_f32 v14, v154, v154
    v_mul_f32 v15, v155, v155
    v_mfma_f32_16x16x32_bf16 v[84:87], v[244:247], v[208:211], v[84:87]
    v_mul_f32 v252, v156, v156
    s_waitcnt lgkmcnt(5)
    v_mfma_f32_16x16x32_bf16 v[16:19], v[168:171], v[160:163], v[16:19]
    ds_read_b128 v[204:207], v9 offset:0
    v_mfma_f32_16x16x32_bf16 v[20:23], v[168:171], v[164:167], v[20:23]
    ds_read_b128 v[208:211], v9 offset:2048
    v_mul_f32 v253, v157, v157
    v_mfma_f32_16x16x32_bf16 v[24:27], v[172:175], v[160:163], v[24:27]
    ds_read_b128 v[212:215], v1 offset:9216
    v_mul_f32 v254, v158, v158
    v_mfma_f32_16x16x32_bf16 v[28:31], v[172:175], v[164:167], v[28:31]
    ds_read_b128 v[216:219], v1 offset:10240
    v_mul_f32 v255, v159, v159
    v_mfma_f32_16x16x32_bf16 v[32:35], v[176:179], v[160:163], v[32:35]
    ds_read_b128 v[220:223], v1 offset:11264
    v_fma_f32 v12, v12, v5, v4
    v_mfma_f32_16x16x32_bf16 v[36:39], v[176:179], v[164:167], v[36:39]
    ds_read_b128 v[224:227], v1 offset:12288
    v_fma_f32 v13, v13, v5, v4
    v_mfma_f32_16x16x32_bf16 v[40:43], v[180:183], v[160:163], v[40:43]
    ds_read_b128 v[228:231], v1 offset:13312
    v_fma_f32 v14, v14, v5, v4
    v_mfma_f32_16x16x32_bf16 v[44:47], v[180:183], v[164:167], v[44:47]
    ds_read_b128 v[232:235], v1 offset:14336
    s_waitcnt lgkmcnt(8)
    v_mfma_f32_16x16x32_bf16 v[48:51], v[184:187], v[160:163], v[48:51]
    ds_read_b128 v[236:239], v1 offset:15360
    v_fma_f32 v15, v15, v5, v4
    v_mfma_f32_16x16x32_bf16 v[52:55], v[184:187], v[164:167], v[52:55]
    ds_read_b128 v[240:243], v1 offset:16384
    v_fma_f32 v252, v252, v7, v6
    v_mfma_f32_16x16x32_bf16 v[56:59], v[188:191], v[160:163], v[56:59]
    ds_read_b128 v[244:247], v1 offset:17408
    v_fma_f32 v253, v253, v7, v6
    v_mfma_f32_16x16x32_bf16 v[60:63], v[188:191], v[164:167], v[60:63]
    v_fma_f32 v254, v254, v7, v6
    v_fma_f32 v255, v255, v7, v6
    v_mfma_f32_16x16x32_bf16 v[64:67], v[192:195], v[160:163], v[64:67]
    v_mul_f32 v12, v12, v152
    v_mul_f32 v13, v13, v153
    v_mfma_f32_16x16x32_bf16 v[68:71], v[192:195], v[164:167], v[68:71]
    v_mul_f32 v14, v14, v154
    v_mul_f32 v15, v15, v155
    v_mfma_f32_16x16x32_bf16 v[72:75], v[196:199], v[160:163], v[72:75]
    v_mul_f32 v252, v252, v156
    v_mul_f32 v253, v253, v157
    v_mfma_f32_16x16x32_bf16 v[76:79], v[196:199], v[164:167], v[76:79]
    v_mul_f32 v254, v254, v158
    v_mul_f32 v255, v255, v159
    v_mfma_f32_16x16x32_bf16 v[80:83], v[200:203], v[160:163], v[80:83]
    v_exp_f32 v12, v12
    v_mfma_f32_16x16x32_bf16 v[84:87], v[200:203], v[164:167], v[84:87]
    v_exp_f32 v13, v13
    s_waitcnt lgkmcnt(0)
    s_barrier
    v_mfma_f32_16x16x32_bf16 v[16:19], v[212:215], v[204:207], v[16:19]
    ds_read_b128 v[160:163], v8 offset:36864
    v_mfma_f32_16x16x32_bf16 v[20:23], v[212:215], v[208:211], v[20:23]
    ds_read_b128 v[164:167], v8 offset:38912
    v_exp_f32 v14, v14
    v_mfma_f32_16x16x32_bf16 v[24:27], v[216:219], v[204:207], v[24:27]
    ds_read_b128 v[168:171], v1 offset:36864
    v_exp_f32 v15, v15
    v_mfma_f32_16x16x32_bf16 v[28:31], v[216:219], v[208:211], v[28:31]
    ds_read_b128 v[172:175], v1 offset:37888
    v_exp_f32 v252, v252
    v_mfma_f32_16x16x32_bf16 v[32:35], v[220:223], v[204:207], v[32:35]
    ds_read_b128 v[176:179], v1 offset:38912
    v_exp_f32 v253, v253
    v_mfma_f32_16x16x32_bf16 v[36:39], v[220:223], v[208:211], v[36:39]
    ds_read_b128 v[180:183], v1 offset:39936
    v_exp_f32 v254, v254
    v_mfma_f32_16x16x32_bf16 v[40:43], v[224:227], v[204:207], v[40:43]
    ds_read_b128 v[184:187], v1 offset:40960
    v_exp_f32 v255, v255
    v_mfma_f32_16x16x32_bf16 v[44:47], v[224:227], v[208:211], v[44:47]
    ds_read_b128 v[188:191], v1 offset:41984
    v_mfma_f32_16x16x32_bf16 v[48:51], v[228:231], v[204:207], v[48:51]
    ds_read_b128 v[192:195], v1 offset:43008
    v_fma_f32 v12, v12, v249, v249
    v_mfma_f32_16x16x32_bf16 v[52:55], v[228:231], v[208:211], v[52:55]
    ds_read_b128 v[196:199], v1 offset:44032
    v_fma_f32 v13, v13, v249, v249
    v_mfma_f32_16x16x32_bf16 v[56:59], v[232:235], v[204:207], v[56:59]
    ds_read_b128 v[200:203], v1 offset:45056
    v_fma_f32 v14, v14, v249, v249
    v_mfma_f32_16x16x32_bf16 v[60:63], v[232:235], v[208:211], v[60:63]
    v_fma_f32 v15, v15, v249, v249
    v_fma_f32 v252, v252, v251, v251
    v_mfma_f32_16x16x32_bf16 v[64:67], v[236:239], v[204:207], v[64:67]
    v_fma_f32 v253, v253, v251, v251
    v_fma_f32 v254, v254, v251, v251
    v_mfma_f32_16x16x32_bf16 v[68:71], v[236:239], v[208:211], v[68:71]
    v_fma_f32 v255, v255, v251, v251
    v_rcp_f32 v12, v12
    v_mfma_f32_16x16x32_bf16 v[72:75], v[240:243], v[204:207], v[72:75]
    v_rcp_f32 v13, v13
    v_mfma_f32_16x16x32_bf16 v[76:79], v[240:243], v[208:211], v[76:79]
    v_rcp_f32 v14, v14
    v_mfma_f32_16x16x32_bf16 v[80:83], v[244:247], v[204:207], v[80:83]
    v_rcp_f32 v15, v15
    v_mfma_f32_16x16x32_bf16 v[84:87], v[244:247], v[208:211], v[84:87]
    v_rcp_f32 v252, v252
    s_waitcnt lgkmcnt(5)
    v_mfma_f32_16x16x32_bf16 v[16:19], v[168:171], v[160:163], v[16:19]
    ds_read_b128 v[204:207], v9 offset:36864
    v_mfma_f32_16x16x32_bf16 v[20:23], v[168:171], v[164:167], v[20:23]
    ds_read_b128 v[208:211], v9 offset:38912
    v_rcp_f32 v253, v253
    v_mfma_f32_16x16x32_bf16 v[24:27], v[172:175], v[160:163], v[24:27]
    ds_read_b128 v[212:215], v1 offset:46080
    v_rcp_f32 v254, v254
    v_mfma_f32_16x16x32_bf16 v[28:31], v[172:175], v[164:167], v[28:31]
    ds_read_b128 v[216:219], v1 offset:47104
    v_rcp_f32 v255, v255
    v_mfma_f32_16x16x32_bf16 v[32:35], v[176:179], v[160:163], v[32:35]
    ds_read_b128 v[220:223], v1 offset:48128
    v_mul_f32 v152, v152, v12
    v_mfma_f32_16x16x32_bf16 v[36:39], v[176:179], v[164:167], v[36:39]
    ds_read_b128 v[224:227], v1 offset:49152
    v_mul_f32 v153, v153, v13
    v_mfma_f32_16x16x32_bf16 v[40:43], v[180:183], v[160:163], v[40:43]
    ds_read_b128 v[228:231], v1 offset:50176
    v_mul_f32 v154, v154, v14
    v_mfma_f32_16x16x32_bf16 v[44:47], v[180:183], v[164:167], v[44:47]
    ds_read_b128 v[232:235], v1 offset:51200
    s_waitcnt lgkmcnt(8)
    v_mfma_f32_16x16x32_bf16 v[48:51], v[184:187], v[160:163], v[48:51]
    ds_read_b128 v[236:239], v1 offset:52224
    v_mul_f32 v155, v155, v15
    v_mfma_f32_16x16x32_bf16 v[52:55], v[184:187], v[164:167], v[52:55]
    ds_read_b128 v[240:243], v1 offset:53248
    v_mul_f32 v156, v156, v252
    v_mfma_f32_16x16x32_bf16 v[56:59], v[188:191], v[160:163], v[56:59]
    ds_read_b128 v[244:247], v1 offset:54272
    v_mul_f32 v157, v157, v253
    v_mfma_f32_16x16x32_bf16 v[60:63], v[188:191], v[164:167], v[60:63]
    v_mul_f32 v158, v158, v254
    v_mul_f32 v159, v159, v255
    v_mfma_f32_16x16x32_bf16 v[64:67], v[192:195], v[160:163], v[64:67]
    s_mul_i32 s36, s31, 73728
    s_add_u32 s36, s36, s21
    v_mfma_f32_16x16x32_bf16 v[68:71], v[192:195], v[164:167], v[68:71]
    s_lshl_b32 s34, s24, 10
    s_lshl_b32 s35, s24, 9
    v_mfma_f32_16x16x32_bf16 v[72:75], v[196:199], v[160:163], v[72:75]
    s_add_u32 s35, s35, 65536
    v_add_u32 v14, s34, v1
    v_mfma_f32_16x16x32_bf16 v[76:79], v[196:199], v[164:167], v[76:79]
    v_lshrrev_b32 v15, 1, v1
    v_add_u32 v15, s35, v15
    v_mfma_f32_16x16x32_bf16 v[80:83], v[200:203], v[160:163], v[80:83]
    s_add_u32 s39, s36, 0x1200000
    s_add_u32 s40, s36, 0x1212000
    v_mfma_f32_16x16x32_bf16 v[84:87], v[200:203], v[164:167], v[84:87]
    s_waitcnt lgkmcnt(0)
    s_barrier
    v_mfma_f32_16x16x32_bf16 v[16:19], v[212:215], v[204:207], v[16:19]
    ds_read_b128 v[160:163], v10 offset:0
    v_mfma_f32_16x16x32_bf16 v[20:23], v[212:215], v[208:211], v[20:23]
    ds_read_b128 v[164:167], v10 offset:2048
    v_mfma_f32_16x16x32_bf16 v[24:27], v[216:219], v[204:207], v[24:27]
    ds_read_b128 v[168:171], v2 offset:0
    v_mfma_f32_16x16x32_bf16 v[28:31], v[216:219], v[208:211], v[28:31]
    ds_read_b128 v[172:175], v2 offset:1024
    v_mfma_f32_16x16x32_bf16 v[32:35], v[220:223], v[204:207], v[32:35]
    ds_read_b128 v[176:179], v2 offset:2048
    v_mfma_f32_16x16x32_bf16 v[36:39], v[220:223], v[208:211], v[36:39]
    ds_read_b128 v[180:183], v2 offset:3072
    v_mfma_f32_16x16x32_bf16 v[40:43], v[224:227], v[204:207], v[40:43]
    ds_read_b128 v[184:187], v2 offset:4096
    v_mfma_f32_16x16x32_bf16 v[44:47], v[224:227], v[208:211], v[44:47]
    ds_read_b128 v[188:191], v2 offset:5120
    v_mfma_f32_16x16x32_bf16 v[48:51], v[228:231], v[204:207], v[48:51]
    ds_read_b128 v[192:195], v2 offset:6144
    v_mfma_f32_16x16x32_bf16 v[52:55], v[228:231], v[208:211], v[52:55]
    ds_read_b128 v[196:199], v2 offset:7168
    v_mfma_f32_16x16x32_bf16 v[56:59], v[232:235], v[204:207], v[56:59]
    ds_read_b128 v[200:203], v2 offset:8192
    v_mfma_f32_16x16x32_bf16 v[60:63], v[232:235], v[208:211], v[60:63]
    v_mfma_f32_16x16x32_bf16 v[64:67], v[236:239], v[204:207], v[64:67]
    v_mfma_f32_16x16x32_bf16 v[68:71], v[236:239], v[208:211], v[68:71]
    v_mfma_f32_16x16x32_bf16 v[72:75], v[240:243], v[204:207], v[72:75]
    v_mfma_f32_16x16x32_bf16 v[76:79], v[240:243], v[208:211], v[76:79]
    v_mfma_f32_16x16x32_bf16 v[80:83], v[244:247], v[204:207], v[80:83]
    v_mfma_f32_16x16x32_bf16 v[84:87], v[244:247], v[208:211], v[84:87]
    s_mov_b32 s41, 6
    .p2align 6
L_g_loop:
    s_waitcnt lgkmcnt(5)
    v_mfma_f32_16x16x32_bf16 v[16:19], v[168:171], v[160:163], v[16:19]
    ds_read_b128 v[204:207], v11 offset:0
    v_mfma_f32_16x16x32_bf16 v[20:23], v[168:171], v[164:167], v[20:23]
    ds_read_b128 v[208:211], v11 offset:2048
    v_mfma_f32_16x16x32_bf16 v[24:27], v[172:175], v[160:163], v[24:27]
    ds_read_b128 v[212:215], v2 offset:9216
    v_mfma_f32_16x16x32_bf16 v[28:31], v[172:175], v[164:167], v[28:31]
    ds_read_b128 v[216:219], v2 offset:10240
    v_mfma_f32_16x16x32_bf16 v[32:35], v[176:179], v[160:163], v[32:35]
    ds_read_b128 v[220:223], v2 offset:11264
    v_mfma_f32_16x16x32_bf16 v[36:39], v[176:179], v[164:167], v[36:39]
    ds_read_b128 v[224:227], v2 offset:12288
    v_mfma_f32_16x16x32_bf16 v[40:43], v[180:183], v[160:163], v[40:43]
    ds_read_b128 v[228:231], v2 offset:13312
    v_mfma_f32_16x16x32_bf16 v[44:47], v[180:183], v[164:167], v[44:47]
    ds_read_b128 v[232:235], v2 offset:14336
    s_waitcnt lgkmcnt(8)
    v_mfma_f32_16x16x32_bf16 v[48:51], v[184:187], v[160:163], v[48:51]
    ds_read_b128 v[236:239], v2 offset:15360
    v_mfma_f32_16x16x32_bf16 v[52:55], v[184:187], v[164:167], v[52:55]
    ds_read_b128 v[240:243], v2 offset:16384
    v_mfma_f32_16x16x32_bf16 v[56:59], v[188:191], v[160:163], v[56:59]
    ds_read_b128 v[244:247], v2 offset:17408
    v_mfma_f32_16x16x32_bf16 v[60:63], v[188:191], v[164:167], v[60:63]
    v_mfma_f32_16x16x32_bf16 v[64:67], v[192:195], v[160:163], v[64:67]
    v_mfma_f32_16x16x32_bf16 v[68:71], v[192:195], v[164:167], v[68:71]
    v_mfma_f32_16x16x32_bf16 v[72:75], v[196:199], v[160:163], v[72:75]
    v_mfma_f32_16x16x32_bf16 v[76:79], v[196:199], v[164:167], v[76:79]
    v_mfma_f32_16x16x32_bf16 v[80:83], v[200:203], v[160:163], v[80:83]
    v_mfma_f32_16x16x32_bf16 v[84:87], v[200:203], v[164:167], v[84:87]
    s_waitcnt lgkmcnt(0)
    s_barrier
    v_mfma_f32_16x16x32_bf16 v[16:19], v[212:215], v[204:207], v[16:19]
    ds_read_b128 v[160:163], v10 offset:36864
    v_mfma_f32_16x16x32_bf16 v[20:23], v[212:215], v[208:211], v[20:23]
    ds_read_b128 v[164:167], v10 offset:38912
    v_mfma_f32_16x16x32_bf16 v[24:27], v[216:219], v[204:207], v[24:27]
    ds_read_b128 v[168:171], v2 offset:36864
    v_mfma_f32_16x16x32_bf16 v[28:31], v[216:219], v[208:211], v[28:31]
    ds_read_b128 v[172:175], v2 offset:37888
    v_mfma_f32_16x16x32_bf16 v[32:35], v[220:223], v[204:207], v[32:35]
    ds_read_b128 v[176:179], v2 offset:38912
    v_mfma_f32_16x16x32_bf16 v[36:39], v[220:223], v[208:211], v[36:39]
    ds_read_b128 v[180:183], v2 offset:39936
    v_mfma_f32_16x16x32_bf16 v[40:43], v[224:227], v[204:207], v[40:43]
    ds_read_b128 v[184:187], v2 offset:40960
    v_mfma_f32_16x16x32_bf16 v[44:47], v[224:227], v[208:211], v[44:47]
    ds_read_b128 v[188:191], v2 offset:41984
    v_mfma_f32_16x16x32_bf16 v[48:51], v[228:231], v[204:207], v[48:51]
    ds_read_b128 v[192:195], v2 offset:43008
    v_mfma_f32_16x16x32_bf16 v[52:55], v[228:231], v[208:211], v[52:55]
    ds_read_b128 v[196:199], v2 offset:44032
    v_mfma_f32_16x16x32_bf16 v[56:59], v[232:235], v[204:207], v[56:59]
    ds_read_b128 v[200:203], v2 offset:45056
    v_mfma_f32_16x16x32_bf16 v[60:63], v[232:235], v[208:211], v[60:63]
    v_mfma_f32_16x16x32_bf16 v[64:67], v[236:239], v[204:207], v[64:67]
    v_mfma_f32_16x16x32_bf16 v[68:71], v[236:239], v[208:211], v[68:71]
    v_mfma_f32_16x16x32_bf16 v[72:75], v[240:243], v[204:207], v[72:75]
    v_mfma_f32_16x16x32_bf16 v[76:79], v[240:243], v[208:211], v[76:79]
    v_mfma_f32_16x16x32_bf16 v[80:83], v[244:247], v[204:207], v[80:83]
    v_mfma_f32_16x16x32_bf16 v[84:87], v[244:247], v[208:211], v[84:87]
    s_waitcnt lgkmcnt(5)
    v_mfma_f32_16x16x32_bf16 v[16:19], v[168:171], v[160:163], v[16:19]
    ds_read_b128 v[204:207], v11 offset:36864
    v_mfma_f32_16x16x32_bf16 v[20:23], v[168:171], v[164:167], v[20:23]
    ds_read_b128 v[208:211], v11 offset:38912
    v_mfma_f32_16x16x32_bf16 v[24:27], v[172:175], v[160:163], v[24:27]
    ds_read_b128 v[212:215], v2 offset:46080
    v_mfma_f32_16x16x32_bf16 v[28:31], v[172:175], v[164:167], v[28:31]
    ds_read_b128 v[216:219], v2 offset:47104
    v_mfma_f32_16x16x32_bf16 v[32:35], v[176:179], v[160:163], v[32:35]
    ds_read_b128 v[220:223], v2 offset:48128
    v_mfma_f32_16x16x32_bf16 v[36:39], v[176:179], v[164:167], v[36:39]
    ds_read_b128 v[224:227], v2 offset:49152
    v_mfma_f32_16x16x32_bf16 v[40:43], v[180:183], v[160:163], v[40:43]
    ds_read_b128 v[228:231], v2 offset:50176
    v_mfma_f32_16x16x32_bf16 v[44:47], v[180:183], v[164:167], v[44:47]
    ds_read_b128 v[232:235], v2 offset:51200
    s_waitcnt lgkmcnt(8)
    v_mfma_f32_16x16x32_bf16 v[48:51], v[184:187], v[160:163], v[48:51]
    ds_read_b128 v[236:239], v2 offset:52224
    v_mfma_f32_16x16x32_bf16 v[52:55], v[184:187], v[164:167], v[52:55]
    ds_read_b128 v[240:243], v2 offset:53248
    v_mfma_f32_16x16x32_bf16 v[56:59], v[188:191], v[160:163], v[56:59]
    ds_read_b128 v[244:247], v2 offset:54272
    v_mfma_f32_16x16x32_bf16 v[60:63], v[188:191], v[164:167], v[60:63]
    v_mfma_f32_16x16x32_bf16 v[64:67], v[192:195], v[160:163], v[64:67]
    v_mfma_f32_16x16x32_bf16 v[68:71], v[192:195], v[164:167], v[68:71]
    v_mfma_f32_16x16x32_bf16 v[72:75], v[196:199], v[160:163], v[72:75]
    v_mfma_f32_16x16x32_bf16 v[76:79], v[196:199], v[164:167], v[76:79]
    v_mfma_f32_16x16x32_bf16 v[80:83], v[200:203], v[160:163], v[80:83]
    v_mfma_f32_16x16x32_bf16 v[84:87], v[200:203], v[164:167], v[84:87]
    s_waitcnt lgkmcnt(0)
    s_barrier
    v_mfma_f32_16x16x32_bf16 v[16:19], v[212:215], v[204:207], v[16:19]
    ds_read_b128 v[160:163], v8 offset:0
    v_mfma_f32_16x16x32_bf16 v[20:23], v[212:215], v[208:211], v[20:23]
    ds_read_b128 v[164:167], v8 offset:2048
    v_mfma_f32_16x16x32_bf16 v[24:27], v[216:219], v[204:207], v[24:27]
    ds_read_b128 v[168:171], v1 offset:0
    v_mfma_f32_16x16x32_bf16 v[28:31], v[216:219], v[208:211], v[28:31]
    ds_read_b128 v[172:175], v1 offset:1024
    v_mfma_f32_16x16x32_bf16 v[32:35], v[220:223], v[204:207], v[32:35]
    ds_read_b128 v[176:179], v1 offset:2048
    v_mfma_f32_16x16x32_bf16 v[36:39], v[220:223], v[208:211], v[36:39]
    ds_read_b128 v[180:183], v1 offset:3072
    v_mfma_f32_16x16x32_bf16 v[40:43], v[224:227], v[204:207], v[40:43]
    ds_read_b128 v[184:187], v1 offset:4096
    v_mfma_f32_16x16x32_bf16 v[44:47], v[224:227], v[208:211], v[44:47]
    ds_read_b128 v[188:191], v1 offset:5120
    v_mfma_f32_16x16x32_bf16 v[48:51], v[228:231], v[204:207], v[48:51]
    ds_read_b128 v[192:195], v1 offset:6144
    v_mfma_f32_16x16x32_bf16 v[52:55], v[228:231], v[208:211], v[52:55]
    ds_read_b128 v[196:199], v1 offset:7168
    v_mfma_f32_16x16x32_bf16 v[56:59], v[232:235], v[204:207], v[56:59]
    ds_read_b128 v[200:203], v1 offset:8192
    v_mfma_f32_16x16x32_bf16 v[60:63], v[232:235], v[208:211], v[60:63]
    v_mfma_f32_16x16x32_bf16 v[64:67], v[236:239], v[204:207], v[64:67]
    v_mfma_f32_16x16x32_bf16 v[68:71], v[236:239], v[208:211], v[68:71]
    v_mfma_f32_16x16x32_bf16 v[72:75], v[240:243], v[204:207], v[72:75]
    v_mfma_f32_16x16x32_bf16 v[76:79], v[240:243], v[208:211], v[76:79]
    v_mfma_f32_16x16x32_bf16 v[80:83], v[244:247], v[204:207], v[80:83]
    v_mfma_f32_16x16x32_bf16 v[84:87], v[244:247], v[208:211], v[84:87]
    s_waitcnt lgkmcnt(5)
    v_mfma_f32_16x16x32_bf16 v[16:19], v[168:171], v[160:163], v[16:19]
    ds_read_b128 v[204:207], v9 offset:0
    v_mfma_f32_16x16x32_bf16 v[20:23], v[168:171], v[164:167], v[20:23]
    ds_read_b128 v[208:211], v9 offset:2048
    v_mfma_f32_16x16x32_bf16 v[24:27], v[172:175], v[160:163], v[24:27]
    ds_read_b128 v[212:215], v1 offset:9216
    v_mfma_f32_16x16x32_bf16 v[28:31], v[172:175], v[164:167], v[28:31]
    ds_read_b128 v[216:219], v1 offset:10240
    v_mfma_f32_16x16x32_bf16 v[32:35], v[176:179], v[160:163], v[32:35]
    ds_read_b128 v[220:223], v1 offset:11264
    v_mfma_f32_16x16x32_bf16 v[36:39], v[176:179], v[164:167], v[36:39]
    ds_read_b128 v[224:227], v1 offset:12288
    v_mfma_f32_16x16x32_bf16 v[40:43], v[180:183], v[160:163], v[40:43]
    ds_read_b128 v[228:231], v1 offset:13312
    v_mfma_f32_16x16x32_bf16 v[44:47], v[180:183], v[164:167], v[44:47]
    ds_read_b128 v[232:235], v1 offset:14336
    s_waitcnt lgkmcnt(8)
    v_mfma_f32_16x16x32_bf16 v[48:51], v[184:187], v[160:163], v[48:51]
    ds_read_b128 v[236:239], v1 offset:15360
    v_mfma_f32_16x16x32_bf16 v[52:55], v[184:187], v[164:167], v[52:55]
    ds_read_b128 v[240:243], v1 offset:16384
    v_mfma_f32_16x16x32_bf16 v[56:59], v[188:191], v[160:163], v[56:59]
    ds_read_b128 v[244:247], v1 offset:17408
    v_mfma_f32_16x16x32_bf16 v[60:63], v[188:191], v[164:167], v[60:63]
    v_mfma_f32_16x16x32_bf16 v[64:67], v[192:195], v[160:163], v[64:67]
    v_mfma_f32_16x16x32_bf16 v[68:71], v[192:195], v[164:167], v[68:71]
    v_mfma_f32_16x16x32_bf16 v[72:75], v[196:199], v[160:163], v[72:75]
    v_mfma_f32_16x16x32_bf16 v[76:79], v[196:199], v[164:167], v[76:79]
    v_mfma_f32_16x16x32_bf16 v[80:83], v[200:203], v[160:163], v[80:83]
    v_mfma_f32_16x16x32_bf16 v[84:87], v[200:203], v[164:167], v[84:87]
    s_waitcnt lgkmcnt(0)
    s_barrier
    v_mfma_f32_16x16x32_bf16 v[16:19], v[212:215], v[204:207], v[16:19]
    ds_read_b128 v[160:163], v8 offset:36864
    v_mfma_f32_16x16x32_bf16 v[20:23], v[212:215], v[208:211], v[20:23]
    ds_read_b128 v[164:167], v8 offset:38912
    v_mfma_f32_16x16x32_bf16 v[24:27], v[216:219], v[204:207], v[24:27]
    ds_read_b128 v[168:171], v1 offset:36864
    v_mfma_f32_16x16x32_bf16 v[28:31], v[216:219], v[208:211], v[28:31]
    ds_read_b128 v[172:175], v1 offset:37888
    v_mfma_f32_16x16x32_bf16 v[32:35], v[220:223], v[204:207], v[32:35]
    ds_read_b128 v[176:179], v1 offset:38912
    v_mfma_f32_16x16x32_bf16 v[36:39], v[220:223], v[208:211], v[36:39]
    ds_read_b128 v[180:183], v1 offset:39936
    v_mfma_f32_16x16x32_bf16 v[40:43], v[224:227], v[204:207], v[40:43]
    ds_read_b128 v[184:187], v1 offset:40960
    v_mfma_f32_16x16x32_bf16 v[44:47], v[224:227], v[208:211], v[44:47]
    ds_read_b128 v[188:191], v1 offset:41984
    v_mfma_f32_16x16x32_bf16 v[48:51], v[228:231], v[204:207], v[48:51]
    ds_read_b128 v[192:195], v1 offset:43008
    v_mfma_f32_16x16x32_bf16 v[52:55], v[228:231], v[208:211], v[52:55]
    ds_read_b128 v[196:199], v1 offset:44032
    v_mfma_f32_16x16x32_bf16 v[56:59], v[232:235], v[204:207], v[56:59]
    ds_read_b128 v[200:203], v1 offset:45056
    v_mfma_f32_16x16x32_bf16 v[60:63], v[232:235], v[208:211], v[60:63]
    v_mfma_f32_16x16x32_bf16 v[64:67], v[236:239], v[204:207], v[64:67]
    v_mfma_f32_16x16x32_bf16 v[68:71], v[236:239], v[208:211], v[68:71]
    v_mfma_f32_16x16x32_bf16 v[72:75], v[240:243], v[204:207], v[72:75]
    v_mfma_f32_16x16x32_bf16 v[76:79], v[240:243], v[208:211], v[76:79]
    v_mfma_f32_16x16x32_bf16 v[80:83], v[244:247], v[204:207], v[80:83]
    v_mfma_f32_16x16x32_bf16 v[84:87], v[244:247], v[208:211], v[84:87]
    s_waitcnt lgkmcnt(5)
    v_mfma_f32_16x16x32_bf16 v[16:19], v[168:171], v[160:163], v[16:19]
    ds_read_b128 v[204:207], v9 offset:36864
    v_mfma_f32_16x16x32_bf16 v[20:23], v[168:171], v[164:167], v[20:23]
    ds_read_b128 v[208:211], v9 offset:38912
    v_mfma_f32_16x16x32_bf16 v[24:27], v[172:175], v[160:163], v[24:27]
    ds_read_b128 v[212:215], v1 offset:46080
    v_mfma_f32_16x16x32_bf16 v[28:31], v[172:175], v[164:167], v[28:31]
    ds_read_b128 v[216:219], v1 offset:47104
    v_mfma_f32_16x16x32_bf16 v[32:35], v[176:179], v[160:163], v[32:35]
    ds_read_b128 v[220:223], v1 offset:48128
    v_mfma_f32_16x16x32_bf16 v[36:39], v[176:179], v[164:167], v[36:39]
    ds_read_b128 v[224:227], v1 offset:49152
    v_mfma_f32_16x16x32_bf16 v[40:43], v[180:183], v[160:163], v[40:43]
    ds_read_b128 v[228:231], v1 offset:50176
    v_mfma_f32_16x16x32_bf16 v[44:47], v[180:183], v[164:167], v[44:47]
    ds_read_b128 v[232:235], v1 offset:51200
    s_waitcnt lgkmcnt(8)
    v_mfma_f32_16x16x32_bf16 v[48:51], v[184:187], v[160:163], v[48:51]
    ds_read_b128 v[236:239], v1 offset:52224
    v_mfma_f32_16x16x32_bf16 v[52:55], v[184:187], v[164:167], v[52:55]
    ds_read_b128 v[240:243], v1 offset:53248
    v_mfma_f32_16x16x32_bf16 v[56:59], v[188:191], v[160:163], v[56:59]
    ds_read_b128 v[244:247], v1 offset:54272
    v_mfma_f32_16x16x32_bf16 v[60:63], v[188:191], v[164:167], v[60:63]
    v_mfma_f32_16x16x32_bf16 v[64:67], v[192:195], v[160:163], v[64:67]
    v_mfma_f32_16x16x32_bf16 v[68:71], v[192:195], v[164:167], v[68:71]
    v_mfma_f32_16x16x32_bf16 v[72:75], v[196:199], v[160:163], v[72:75]
    v_mfma_f32_16x16x32_bf16 v[76:79], v[196:199], v[164:167], v[76:79]
    v_mfma_f32_16x16x32_bf16 v[80:83], v[200:203], v[160:163], v[80:83]
    v_mfma_f32_16x16x32_bf16 v[84:87], v[200:203], v[164:167], v[84:87]
    s_waitcnt lgkmcnt(0)
    s_barrier
    v_mfma_f32_16x16x32_bf16 v[16:19], v[212:215], v[204:207], v[16:19]
    ds_read_b128 v[160:163], v10 offset:0
    v_mfma_f32_16x16x32_bf16 v[20:23], v[212:215], v[208:211], v[20:23]
    ds_read_b128 v[164:167], v10 offset:2048
    v_mfma_f32_16x16x32_bf16 v[24:27], v[216:219], v[204:207], v[24:27]
    ds_read_b128 v[168:171], v2 offset:0
    v_mfma_f32_16x16x32_bf16 v[28:31], v[216:219], v[208:211], v[28:31]
    ds_read_b128 v[172:175], v2 offset:1024
    v_mfma_f32_16x16x32_bf16 v[32:35], v[220:223], v[204:207], v[32:35]
    ds_read_b128 v[176:179], v2 offset:2048
    v_mfma_f32_16x16x32_bf16 v[36:39], v[220:223], v[208:211], v[36:39]
    ds_read_b128 v[180:183], v2 offset:3072
    v_mfma_f32_16x16x32_bf16 v[40:43], v[224:227], v[204:207], v[40:43]
    ds_read_b128 v[184:187], v2 offset:4096
    v_mfma_f32_16x16x32_bf16 v[44:47], v[224:227], v[208:211], v[44:47]
    ds_read_b128 v[188:191], v2 offset:5120
    v_mfma_f32_16x16x32_bf16 v[48:51], v[228:231], v[204:207], v[48:51]
    ds_read_b128 v[192:195], v2 offset:6144
    v_mfma_f32_16x16x32_bf16 v[52:55], v[228:231], v[208:211], v[52:55]
    ds_read_b128 v[196:199], v2 offset:7168
    v_mfma_f32_16x16x32_bf16 v[56:59], v[232:235], v[204:207], v[56:59]
    ds_read_b128 v[200:203], v2 offset:8192
    v_mfma_f32_16x16x32_bf16 v[60:63], v[232:235], v[208:211], v[60:63]
    v_mfma_f32_16x16x32_bf16 v[64:67], v[236:239], v[204:207], v[64:67]
    v_mfma_f32_16x16x32_bf16 v[68:71], v[236:239], v[208:211], v[68:71]
    v_mfma_f32_16x16x32_bf16 v[72:75], v[240:243], v[204:207], v[72:75]
    v_mfma_f32_16x16x32_bf16 v[76:79], v[240:243], v[208:211], v[76:79]
    v_mfma_f32_16x16x32_bf16 v[80:83], v[244:247], v[204:207], v[80:83]
    s_sub_u32 s41, s41, 1
    v_mfma_f32_16x16x32_bf16 v[84:87], v[244:247], v[208:211], v[84:87]
    s_cmp_lg_u32 s41, 0
    s_cbranch_scc1 L_g_loop
    s_waitcnt lgkmcnt(5)
    v_mfma_f32_16x16x32_bf16 v[16:19], v[168:171], v[160:163], v[16:19]
    ds_read_b128 v[204:207], v11 offset:0
    v_mfma_f32_16x16x32_bf16 v[20:23], v[168:171], v[164:167], v[20:23]
    ds_read_b128 v[208:211], v11 offset:2048
    v_mfma_f32_16x16x32_bf16 v[24:27], v[172:175], v[160:163], v[24:27]
    ds_read_b128 v[212:215], v2 offset:9216
    v_mfma_f32_16x16x32_bf16 v[28:31], v[172:175], v[164:167], v[28:31]
    ds_read_b128 v[216:219], v2 offset:10240
    v_mfma_f32_16x16x32_bf16 v[32:35], v[176:179], v[160:163], v[32:35]
    ds_read_b128 v[220:223], v2 offset:11264
    v_mfma_f32_16x16x32_bf16 v[36:39], v[176:179], v[164:167], v[36:39]
    ds_read_b128 v[224:227], v2 offset:12288
    v_mfma_f32_16x16x32_bf16 v[40:43], v[180:183], v[160:163], v[40:43]
    ds_read_b128 v[228:231], v2 offset:13312
    v_mfma_f32_16x16x32_bf16 v[44:47], v[180:183], v[164:167], v[44:47]
    ds_read_b128 v[232:235], v2 offset:14336
    s_waitcnt lgkmcnt(8)
    v_mfma_f32_16x16x32_bf16 v[48:51], v[184:187], v[160:163], v[48:51]
    ds_read_b128 v[236:239], v2 offset:15360
    v_mfma_f32_16x16x32_bf16 v[52:55], v[184:187], v[164:167], v[52:55]
    ds_read_b128 v[240:243], v2 offset:16384
    v_mfma_f32_16x16x32_bf16 v[56:59], v[188:191], v[160:163], v[56:59]
    ds_read_b128 v[244:247], v2 offset:17408
    v_mfma_f32_16x16x32_bf16 v[60:63], v[188:191], v[164:167], v[60:63]
    v_mfma_f32_16x16x32_bf16 v[64:67], v[192:195], v[160:163], v[64:67]
    v_mfma_f32_16x16x32_bf16 v[68:71], v[192:195], v[164:167], v[68:71]
    v_mfma_f32_16x16x32_bf16 v[72:75], v[196:199], v[160:163], v[72:75]
    v_mfma_f32_16x16x32_bf16 v[76:79], v[196:199], v[164:167], v[76:79]
    v_mfma_f32_16x16x32_bf16 v[80:83], v[200:203], v[160:163], v[80:83]
    v_mfma_f32_16x16x32_bf16 v[84:87], v[200:203], v[164:167], v[84:87]
    s_waitcnt lgkmcnt(0)
    s_barrier
    v_mfma_f32_16x16x32_bf16 v[16:19], v[212:215], v[204:207], v[16:19]
    ds_read_b128 v[160:163], v10 offset:36864
    v_mfma_f32_16x16x32_bf16 v[20:23], v[212:215], v[208:211], v[20:23]
    ds_read_b128 v[164:167], v10 offset:38912
    v_mfma_f32_16x16x32_bf16 v[24:27], v[216:219], v[204:207], v[24:27]
    ds_read_b128 v[168:171], v2 offset:36864
    v_mfma_f32_16x16x32_bf16 v[28:31], v[216:219], v[208:211], v[28:31]
    ds_read_b128 v[172:175], v2 offset:37888
    v_mfma_f32_16x16x32_bf16 v[32:35], v[220:223], v[204:207], v[32:35]
    ds_read_b128 v[176:179], v2 offset:38912
    v_mfma_f32_16x16x32_bf16 v[36:39], v[220:223], v[208:211], v[36:39]
    ds_read_b128 v[180:183], v2 offset:39936
    v_mfma_f32_16x16x32_bf16 v[40:43], v[224:227], v[204:207], v[40:43]
    ds_read_b128 v[184:187], v2 offset:40960
    v_mfma_f32_16x16x32_bf16 v[44:47], v[224:227], v[208:211], v[44:47]
    ds_read_b128 v[188:191], v2 offset:41984
    v_mfma_f32_16x16x32_bf16 v[48:51], v[228:231], v[204:207], v[48:51]
    ds_read_b128 v[192:195], v2 offset:43008
    v_mfma_f32_16x16x32_bf16 v[52:55], v[228:231], v[208:211], v[52:55]
    ds_read_b128 v[196:199], v2 offset:44032
    v_mfma_f32_16x16x32_bf16 v[56:59], v[232:235], v[204:207], v[56:59]
    ds_read_b128 v[200:203], v2 offset:45056
    v_mfma_f32_16x16x32_bf16 v[60:63], v[232:235], v[208:211], v[60:63]
    v_mfma_f32_16x16x32_bf16 v[64:67], v[236:239], v[204:207], v[64:67]
    v_mfma_f32_16x16x32_bf16 v[68:71], v[236:239], v[208:211], v[68:71]
    v_mfma_f32_16x16x32_bf16 v[72:75], v[240:243], v[204:207], v[72:75]
    v_mfma_f32_16x16x32_bf16 v[76:79], v[240:243], v[208:211], v[76:79]
    v_mfma_f32_16x16x32_bf16 v[80:83], v[244:247], v[204:207], v[80:83]
    v_mfma_f32_16x16x32_bf16 v[84:87], v[244:247], v[208:211], v[84:87]
    s_waitcnt lgkmcnt(5)
    v_mfma_f32_16x16x32_bf16 v[16:19], v[168:171], v[160:163], v[16:19]
    ds_read_b128 v[204:207], v11 offset:36864
    v_mfma_f32_16x16x32_bf16 v[20:23], v[168:171], v[164:167], v[20:23]
    ds_read_b128 v[208:211], v11 offset:38912
    v_mfma_f32_16x16x32_bf16 v[24:27], v[172:175], v[160:163], v[24:27]
    ds_read_b128 v[212:215], v2 offset:46080
    v_mfma_f32_16x16x32_bf16 v[28:31], v[172:175], v[164:167], v[28:31]
    ds_read_b128 v[216:219], v2 offset:47104
    v_mfma_f32_16x16x32_bf16 v[32:35], v[176:179], v[160:163], v[32:35]
    ds_read_b128 v[220:223], v2 offset:48128
    v_mfma_f32_16x16x32_bf16 v[36:39], v[176:179], v[164:167], v[36:39]
    ds_read_b128 v[224:227], v2 offset:49152
    v_mfma_f32_16x16x32_bf16 v[40:43], v[180:183], v[160:163], v[40:43]
    ds_read_b128 v[228:231], v2 offset:50176
    v_mfma_f32_16x16x32_bf16 v[44:47], v[180:183], v[164:167], v[44:47]
    ds_read_b128 v[232:235], v2 offset:51200
    s_waitcnt lgkmcnt(8)
    v_mfma_f32_16x16x32_bf16 v[48:51], v[184:187], v[160:163], v[48:51]
    ds_read_b128 v[236:239], v2 offset:52224
    v_mfma_f32_16x16x32_bf16 v[52:55], v[184:187], v[164:167], v[52:55]
    ds_read_b128 v[240:243], v2 offset:53248
    v_mfma_f32_16x16x32_bf16 v[56:59], v[188:191], v[160:163], v[56:59]
    ds_read_b128 v[244:247], v2 offset:54272
    v_mfma_f32_16x16x32_bf16 v[60:63], v[188:191], v[164:167], v[60:63]
    v_mfma_f32_16x16x32_bf16 v[64:67], v[192:195], v[160:163], v[64:67]
    v_mfma_f32_16x16x32_bf16 v[68:71], v[192:195], v[164:167], v[68:71]
    v_mfma_f32_16x16x32_bf16 v[72:75], v[196:199], v[160:163], v[72:75]
    v_mfma_f32_16x16x32_bf16 v[76:79], v[196:199], v[164:167], v[76:79]
    v_mfma_f32_16x16x32_bf16 v[80:83], v[200:203], v[160:163], v[80:83]
    v_mfma_f32_16x16x32_bf16 v[84:87], v[200:203], v[164:167], v[84:87]
    s_waitcnt lgkmcnt(0)
    s_barrier
    v_mfma_f32_16x16x32_bf16 v[16:19], v[212:215], v[204:207], v[16:19]
    ds_read_b128 v[160:163], v8 offset:0
    v_mfma_f32_16x16x32_bf16 v[20:23], v[212:215], v[208:211], v[20:23]
    ds_read_b128 v[164:167], v8 offset:2048
    v_mfma_f32_16x16x32_bf16 v[24:27], v[216:219], v[204:207], v[24:27]
    ds_read_b128 v[192:195], v1 offset:0
    v_mfma_f32_16x16x32_bf16 v[28:31], v[216:219], v[208:211], v[28:31]
    ds_read_b128 v[168:171], v9 offset:0
    v_mfma_f32_16x16x32_bf16 v[32:35], v[220:223], v[204:207], v[32:35]
    ds_read_b128 v[172:175], v9 offset:2048
    v_mfma_f32_16x16x32_bf16 v[36:39], v[220:223], v[208:211], v[36:39]
    ds_read_b128 v[176:179], v8 offset:36864
    v_mfma_f32_16x16x32_bf16 v[40:43], v[224:227], v[204:207], v[40:43]
    ds_read_b128 v[180:183], v8 offset:38912
    v_mfma_f32_16x16x32_bf16 v[44:47], v[224:227], v[208:211], v[44:47]
    ds_read_b128 v[184:187], v9 offset:36864
    v_mfma_f32_16x16x32_bf16 v[48:51], v[228:231], v[204:207], v[48:51]
    ds_read_b128 v[188:191], v9 offset:38912
    v_mfma_f32_16x16x32_bf16 v[52:55], v[228:231], v[208:211], v[52:55]
    ds_read_b128 v[196:199], v1 offset:9216
    v_mfma_f32_16x16x32_bf16 v[56:59], v[232:235], v[204:207], v[56:59]
    ds_read_b128 v[200:203], v1 offset:36864
    v_mfma_f32_16x16x32_bf16 v[60:63], v[232:235], v[208:211], v[60:63]
    v_mfma_f32_16x16x32_bf16 v[64:67], v[236:239], v[204:207], v[64:67]
    v_mfma_f32_16x16x32_bf16 v[68:71], v[236:239], v[208:211], v[68:71]
    v_mfma_f32_16x16x32_bf16 v[72:75], v[240:243], v[204:207], v[72:75]
    v_mfma_f32_16x16x32_bf16 v[76:79], v[240:243], v[208:211], v[76:79]
    v_mfma_f32_16x16x32_bf16 v[80:83], v[244:247], v[204:207], v[80:83]
    v_mfma_f32_16x16x32_bf16 v[84:87], v[244:247], v[208:211], v[84:87]
    s_waitcnt lgkmcnt(0)
    v_mfma_f32_16x16x32_bf16 v[16:19], v[192:195], v[160:163], v[16:19]
    ds_read_b128 v[204:207], v1 offset:46080
    v_mfma_f32_16x16x32_bf16 v[20:23], v[192:195], v[164:167], v[20:23]
    ds_read_b128 v[208:211], v1 offset:1024
    s_waitcnt lgkmcnt(3)
    v_mfma_f32_16x16x32_bf16 v[16:19], v[196:199], v[168:171], v[16:19]
    ds_read_b128 v[212:215], v1 offset:10240
    v_mfma_f32_16x16x32_bf16 v[20:23], v[196:199], v[172:175], v[20:23]
    ds_read_b128 v[216:219], v1 offset:37888
    s_waitcnt lgkmcnt(4)
    v_mfma_f32_16x16x32_bf16 v[16:19], v[200:203], v[176:179], v[16:19]
    ds_read_b128 v[220:223], v1 offset:47104
    v_mfma_f32_16x16x32_bf16 v[20:23], v[200:203], v[180:183], v[20:23]
    ds_read_b128 v[224:227], v1 offset:2048
    s_waitcnt lgkmcnt(5)
    v_mfma_f32_16x16x32_bf16 v[16:19], v[204:207], v[184:187], v[16:19]
    ds_read_b128 v[228:231], v1 offset:11264
    v_mfma_f32_16x16x32_bf16 v[20:23], v[204:207], v[188:191], v[20:23]
    ds_read_b128 v[232:235], v1 offset:38912
    s_waitcnt lgkmcnt(6)
    v_mfma_f32_16x16x32_bf16 v[24:27], v[208:211], v[160:163], v[24:27]
    ds_read_b128 v[236:239], v1 offset:48128
    v_mfma_f32_16x16x32_bf16 v[28:31], v[208:211], v[164:167], v[28:31]
    ds_read_b128 v[240:243], v1 offset:3072
    s_waitcnt lgkmcnt(7)
    v_mfma_f32_16x16x32_bf16 v[24:27], v[212:215], v[168:171], v[24:27]
    ds_read_b128 v[244:247], v1 offset:12288
    v_mfma_f32_16x16x32_bf16 v[28:31], v[212:215], v[172:175], v[28:31]
    s_waitcnt lgkmcnt(7)
    v_mfma_f32_16x16x32_bf16 v[24:27], v[216:219], v[176:179], v[24:27]
    ds_read_b128 v[192:195], v1 offset:39936
    v_mul_f32 v16, v16, v88
    v_mfma_f32_16x16x32_bf16 v[28:31], v[216:219], v[180:183], v[28:31]
    v_mul_f32 v17, v17, v89
    v_mul_f32 v18, v18, v90
    s_waitcnt lgkmcnt(7)
    v_mfma_f32_16x16x32_bf16 v[24:27], v[220:223], v[184:187], v[24:27]
    ds_read_b128 v[196:199], v1 offset:49152
    v_mul_f32 v19, v19, v91
    v_mfma_f32_16x16x32_bf16 v[28:31], v[220:223], v[188:191], v[28:31]
    v_cvt_pk_bf16_f32 v88, v16, v17
    v_cvt_pk_bf16_f32 v89, v18, v19
    s_waitcnt lgkmcnt(7)
    v_mfma_f32_16x16x32_bf16 v[32:35], v[224:227], v[160:163], v[32:35]
    ds_read_b128 v[200:203], v1 offset:4096
    v_mul_f32 v20, v20, v92
    v_mfma_f32_16x16x32_bf16 v[36:39], v[224:227], v[164:167], v[36:39]
    v_mul_f32 v21, v21, v93
    v_mul_f32 v22, v22, v94
    s_waitcnt lgkmcnt(7)
    v_mfma_f32_16x16x32_bf16 v[32:35], v[228:231], v[168:171], v[32:35]
    ds_read_b128 v[204:207], v1 offset:13312
    v_mul_f32 v23, v23, v95
    v_mfma_f32_16x16x32_bf16 v[36:39], v[228:231], v[172:175], v[36:39]
    v_cvt_pk_bf16_f32 v92, v20, v21
    v_cvt_pk_bf16_f32 v93, v22, v23
    s_waitcnt lgkmcnt(7)
    v_mfma_f32_16x16x32_bf16 v[32:35], v[232:235], v[176:179], v[32:35]
    ds_read_b128 v[208:211], v1 offset:40960
    v_mul_f32 v24, v24, v96
    v_mfma_f32_16x16x32_bf16 v[36:39], v[232:235], v[180:183], v[36:39]
    v_mul_f32 v25, v25, v97
    v_mul_f32 v26, v26, v98
    v_mul_f32 v27, v27, v99
    s_waitcnt lgkmcnt(7)
    v_mfma_f32_16x16x32_bf16 v[32:35], v[236:239], v[184:187], v[32:35]
    ds_read_b128 v[212:215], v1 offset:50176
    v_cvt_pk_bf16_f32 v90, v24, v25
    v_mfma_f32_16x16x32_bf16 v[36:39], v[236:239], v[188:191], v[36:39]
    v_cvt_pk_bf16_f32 v91, v26, v27
    buffer_store_dwordx4 v[88:91], v14, s[4:7], s39 offen sc1
    s_waitcnt lgkmcnt(7)
    v_mfma_f32_16x16x32_bf16 v[40:43], v[240:243], v[160:163], v[40:43]
    ds_read_b128 v[216:219], v1 offset:5120
    v_mul_f32 v28, v28, v100
    v_mfma_f32_16x16x32_bf16 v[44:47], v[240:243], v[164:167], v[44:47]
    v_mul_f32 v29, v29, v101
    v_mul_f32 v30, v30, v102
    s_waitcnt lgkmcnt(7)
    v_mfma_f32_16x16x32_bf16 v[40:43], v[244:247], v[168:171], v[40:43]
    ds_read_b128 v[220:223], v1 offset:14336
    v_mul_f32 v31, v31, v103
    v_mfma_f32_16x16x32_bf16 v[44:47], v[244:247], v[172:175], v[44:47]
    v_cvt_pk_bf16_f32 v94, v28, v29
    v_cvt_pk_bf16_f32 v95, v30, v31
    s_waitcnt lgkmcnt(7)
    v_mfma_f32_16x16x32_bf16 v[40:43], v[192:195], v[176:179], v[40:43]
    ds_read_b128 v[224:227], v1 offset:41984
    buffer_store_dwordx4 v[92:95], v14, s[4:7], s40 offen sc1
    v_mfma_f32_16x16x32_bf16 v[44:47], v[192:195], v[180:183], v[44:47]
    v_add_u32 v14, 16384, v14
    v_mul_f32 v32, v32, v104
    v_mul_f32 v33, v33, v105
    s_waitcnt lgkmcnt(7)
    v_mfma_f32_16x16x32_bf16 v[40:43], v[196:199], v[184:187], v[40:43]
    ds_read_b128 v[228:231], v1 offset:51200
    v_mul_f32 v34, v34, v106
    v_mfma_f32_16x16x32_bf16 v[44:47], v[196:199], v[188:191], v[44:47]
    v_mul_f32 v35, v35, v107
    v_cvt_pk_bf16_f32 v104, v32, v33
    s_waitcnt lgkmcnt(7)
    v_mfma_f32_16x16x32_bf16 v[48:51], v[200:203], v[160:163], v[48:51]
    ds_read_b128 v[232:235], v1 offset:6144
    v_cvt_pk_bf16_f32 v105, v34, v35
    v_mfma_f32_16x16x32_bf16 v[52:55], v[200:203], v[164:167], v[52:55]
    v_mul_f32 v36, v36, v108
    v_mul_f32 v37, v37, v109
    s_waitcnt lgkmcnt(7)
    v_mfma_f32_16x16x32_bf16 v[48:51], v[204:207], v[168:171], v[48:51]
    ds_read_b128 v[236:239], v1 offset:15360
    v_mul_f32 v38, v38, v110
    v_mfma_f32_16x16x32_bf16 v[52:55], v[204:207], v[172:175], v[52:55]
    v_mul_f32 v39, v39, v111
    v_cvt_pk_bf16_f32 v108, v36, v37
    s_waitcnt lgkmcnt(7)
    v_mfma_f32_16x16x32_bf16 v[48:51], v[208:211], v[176:179], v[48:51]
    ds_read_b128 v[240:243], v1 offset:43008
    v_cvt_pk_bf16_f32 v109, v38, v39
    v_mfma_f32_16x16x32_bf16 v[52:55], v[208:211], v[180:183], v[52:55]
    v_mul_f32 v40, v40, v112
    v_mul_f32 v41, v41, v113
    v_mul_f32 v42, v42, v114
    s_waitcnt lgkmcnt(7)
    v_mfma_f32_16x16x32_bf16 v[48:51], v[212:215], v[184:187], v[48:51]
    ds_read_b128 v[244:247], v1 offset:52224
    v_mul_f32 v43, v43, v115
    v_mfma_f32_16x16x32_bf16 v[52:55], v[212:215], v[188:191], v[52:55]
    v_cvt_pk_bf16_f32 v106, v40, v41
    v_cvt_pk_bf16_f32 v107, v42, v43
    s_waitcnt lgkmcnt(7)
    v_mfma_f32_16x16x32_bf16 v[56:59], v[216:219], v[160:163], v[56:59]
    ds_read_b128 v[192:195], v1 offset:7168
    buffer_store_dwordx4 v[104:107], v14, s[4:7], s39 offen sc1
    v_mfma_f32_16x16x32_bf16 v[60:63], v[216:219], v[164:167], v[60:63]
    v_mul_f32 v44, v44, v116
    v_mul_f32 v45, v45, v117
    s_waitcnt lgkmcnt(7)
    v_mfma_f32_16x16x32_bf16 v[56:59], v[220:223], v[168:171], v[56:59]
    ds_read_b128 v[196:199], v1 offset:16384
    v_mul_f32 v46, v46, v118
    v_mfma_f32_16x16x32_bf16 v[60:63], v[220:223], v[172:175], v[60:63]
    v_mul_f32 v47, v47, v119
    v_cvt_pk_bf16_f32 v110, v44, v45
    s_waitcnt lgkmcnt(7)
    v_mfma_f32_16x16x32_bf16 v[56:59], v[224:227], v[176:179], v[56:59]
    ds_read_b128 v[200:203], v1 offset:44032
    v_cvt_pk_bf16_f32 v111, v46, v47
    v_mfma_f32_16x16x32_bf16 v[60:63], v[224:227], v[180:183], v[60:63]
    buffer_store_dwordx4 v[108:111], v14, s[4:7], s40 offen sc1
    v_add_u32 v14, 16384, v14
    v_mul_f32 v48, v48, v120
    s_waitcnt lgkmcnt(7)
    v_mfma_f32_16x16x32_bf16 v[56:59], v[228:231], v[184:187], v[56:59]
    ds_read_b128 v[204:207], v1 offset:53248
    v_mul_f32 v49, v49, v121
    v_mfma_f32_16x16x32_bf16 v[60:63], v[228:231], v[188:191], v[60:63]
    v_mul_f32 v50, v50, v122
    v_mul_f32 v51, v51, v123
    s_waitcnt lgkmcnt(7)
    v_mfma_f32_16x16x32_bf16 v[64:67], v[232:235], v[160:163], v[64:67]
    ds_read_b128 v[208:211], v1 offset:8192
    v_cvt_pk_bf16_f32 v120, v48, v49
    v_mfma_f32_16x16x32_bf16 v[68:71], v[232:235], v[164:167], v[68:71]
    v_cvt_pk_bf16_f32 v121, v50, v51
    v_mul_f32 v52, v52, v124
    s_waitcnt lgkmcnt(7)
    v_mfma_f32_16x16x32_bf16 v[64:67], v[236:239], v[168:171], v[64:67]
    ds_read_b128 v[212:215], v1 offset:17408
    v_mul_f32 v53, v53, v125
    v_mfma_f32_16x16x32_bf16 v[68:71], v[236:239], v[172:175], v[68:71]
    v_mul_f32 v54, v54, v126
    v_mul_f32 v55, v55, v127
    s_waitcnt lgkmcnt(7)
    v_mfma_f32_16x16x32_bf16 v[64:67], v[240:243], v[176:179], v[64:67]
    ds_read_b128 v[216:219], v1 offset:45056
    v_cvt_pk_bf16_f32 v124, v52, v53
    v_mfma_f32_16x16x32_bf16 v[68:71], v[240:243], v[180:183], v[68:71]
    v_cvt_pk_bf16_f32 v125, v54, v55
    v_mul_f32 v56, v56, v128
    v_mul_f32 v57, v57, v129
    s_waitcnt lgkmcnt(7)
    v_mfma_f32_16x16x32_bf16 v[64:67], v[244:247], v[184:187], v[64:67]
    ds_read_b128 v[220:223], v1 offset:54272
    v_mul_f32 v58, v58, v130
    v_mfma_f32_16x16x32_bf16 v[68:71], v[244:247], v[188:191], v[68:71]
    v_mul_f32 v59, v59, v131
    v_cvt_pk_bf16_f32 v122, v56, v57
    v_cvt_pk_bf16_f32 v123, v58, v59
    s_waitcnt lgkmcnt(7)
    v_mfma_f32_16x16x32_bf16 v[72:75], v[192:195], v[160:163], v[72:75]
    buffer_store_dwordx4 v[120:123], v14, s[4:7], s39 offen sc1
    v_mul_f32 v60, v60, v132
    v_mfma_f32_16x16x32_bf16 v[76:79], v[192:195], v[164:167], v[76:79]
    v_mul_f32 v61, v61, v133
    v_mul_f32 v62, v62, v134
    s_waitcnt lgkmcnt(6)
    v_mfma_f32_16x16x32_bf16 v[72:75], v[196:199], v[168:171], v[72:75]
    v_mul_f32 v63, v63, v135
    v_cvt_pk_bf16_f32 v126, v60, v61
    v_mfma_f32_16x16x32_bf16 v[76:79], v[196:199], v[172:175], v[76:79]
    v_cvt_pk_bf16_f32 v127, v62, v63
    buffer_store_dwordx4 v[124:127], v14, s[4:7], s40 offen sc1
    s_waitcnt lgkmcnt(5)
    v_mfma_f32_16x16x32_bf16 v[72:75], v[200:203], v[176:179], v[72:75]
    v_add_u32 v14, 16384, v14
    v_mul_f32 v64, v64, v136
    v_mfma_f32_16x16x32_bf16 v[76:79], v[200:203], v[180:183], v[76:79]
    v_mul_f32 v65, v65, v137
    v_mul_f32 v66, v66, v138
    v_mul_f32 v67, v67, v139
    s_waitcnt lgkmcnt(4)
    v_mfma_f32_16x16x32_bf16 v[72:75], v[204:207], v[184:187], v[72:75]
    v_cvt_pk_bf16_f32 v136, v64, v65
    v_cvt_pk_bf16_f32 v137, v66, v67
    v_mfma_f32_16x16x32_bf16 v[76:79], v[204:207], v[188:191], v[76:79]
    v_mul_f32 v68, v68, v140
    v_mul_f32 v69, v69, v141
    s_waitcnt lgkmcnt(3)
    v_mfma_f32_16x16x32_bf16 v[80:83], v[208:211], v[160:163], v[80:83]
    v_mul_f32 v70, v70, v142
    v_mul_f32 v71, v71, v143
    v_mfma_f32_16x16x32_bf16 v[84:87], v[208:211], v[164:167], v[84:87]
    v_cvt_pk_bf16_f32 v140, v68, v69
    v_cvt_pk_bf16_f32 v141, v70, v71
    s_waitcnt lgkmcnt(2)
    v_mfma_f32_16x16x32_bf16 v[80:83], v[212:215], v[168:171], v[80:83]
    v_mfma_f32_16x16x32_bf16 v[84:87], v[212:215], v[172:175], v[84:87]
    s_waitcnt lgkmcnt(1)
    v_mfma_f32_16x16x32_bf16 v[80:83], v[216:219], v[176:179], v[80:83]
    v_mul_f32 v72, v72, v144
    v_mul_f32 v73, v73, v145
    v_mfma_f32_16x16x32_bf16 v[84:87], v[216:219], v[180:183], v[84:87]
    v_mul_f32 v74, v74, v146
    v_mul_f32 v75, v75, v147
    v_cvt_pk_bf16_f32 v138, v72, v73
    s_waitcnt lgkmcnt(0)
    v_mfma_f32_16x16x32_bf16 v[80:83], v[220:223], v[184:187], v[80:83]
    v_cvt_pk_bf16_f32 v139, v74, v75
    buffer_store_dwordx4 v[136:139], v14, s[4:7], s39 offen sc1
    v_mfma_f32_16x16x32_bf16 v[84:87], v[220:223], v[188:191], v[84:87]
    v_mul_f32 v76, v76, v148
    v_mul_f32 v77, v77, v149
    v_mul_f32 v78, v78, v150
    v_mul_f32 v79, v79, v151
    v_cvt_pk_bf16_f32 v142, v76, v77
    v_cvt_pk_bf16_f32 v143, v78, v79
    buffer_store_dwordx4 v[140:143], v14, s[4:7], s40 offen sc1
    s_nop 1
    v_mul_f32 v80, v80, v152
    v_mul_f32 v81, v81, v153
    v_mul_f32 v82, v82, v154
    v_mul_f32 v83, v83, v155
    v_cvt_pk_bf16_f32 v152, v80, v81
    v_cvt_pk_bf16_f32 v153, v82, v83
    buffer_store_dwordx2 v[152:153], v15, s[4:7], s39 offen sc1
    v_mul_f32 v84, v84, v156
    v_mul_f32 v85, v85, v157
    v_mul_f32 v86, v86, v158
    v_mul_f32 v87, v87, v159
    v_cvt_pk_bf16_f32 v156, v84, v85
    v_cvt_pk_bf16_f32 v157, v86, v87
    buffer_store_dwordx2 v[156:157], v15, s[4:7], s40 offen sc1
    s_and_b32 s25, s2, 7
    s_lshr_b32 s26, s2, 3
    s_lshr_b32 s23, s25, 1
    s_lshl_b32 s23, s23, 3
    s_lshr_b32 s27, s26, 2
    s_add_u32 s23, s23, s27
    s_and_b32 s24, s25, 1
    s_lshl_b32 s24, s24, 2
    s_and_b32 s27, s26, 3
    s_add_u32 s24, s24, s27
    s_add_u32 s25, s23, s24
    s_and_b32 s25, s25, 3
    s_lshl_b32 s30, s23, 2
    s_add_u32 s30, s30, s20
    s_and_b32 s31, s20, 1
    s_mul_i32 s34, s30, 18432
    s_add_u32 s34, s34, s21
    s_add_u32 s34, s34, 0x300000
    s_lshl_b32 s35, s24, 11
    s_lshr_b32 s36, s24, 2
    s_lshl_b32 s36, s36, 10
    s_and_b32 s37, s24, 3
    s_lshl_b32 s37, s37, 8
    s_add_u32 s36, s36, s37
    s_add_u32 s36, s36, 16384
    v_bfe_u32 v2, v1, 4, 4
    v_lshrrev_b32 v3, 8, v1
    v_add_u32 v4, s35, v1
    v_lshrrev_b32 v0, 1, v3
    v_and_b32 v9, 1, v3
    v_cmp_eq_u32 s[40:41], s31, v0
    v_bfrev_b32 v6, 1
    v_lshlrev_b32 v5, 4, v2
    v_lshl_add_u32 v5, v9, 3, v5
    v_add_u32 v5, s36, v5
    v_cndmask_b32 v5, v6, v5, s[40:41]
    buffer_load_dwordx4 v[220:223], v4, s[4:7], s34 offen offset:0 sc1
    buffer_load_dwordx4 v[224:227], v4, s[4:7], s34 offen offset:1024 sc1
    buffer_load_dwordx2 v[228:229], v5, s[4:7], s34 offen sc1
    s_and_b32 s29, s30, 0xfffe
    s_mul_i32 s29, s29, 73728
    s_add_u32 s29, s29, s21
    s_lshl_b32 s37, s31, 10
    s_add_u32 s29, s29, s37
    s_add_u32 s29, s29, 0x1200000
    s_mul_i32 s37, s31, 73728
    s_sub_u32 s38, 73728, s37
    v_lshlrev_b32 v10, 3, v2
    v_lshrrev_b32 v7, 1, v1
    v_add_u32 v16, s37, v1
    v_add_u32 v17, s38, v1
    v_add_u32 v18, s37, v7
    v_add_u32 v19, s38, v7
    s_lshl_b32 s37, s31, 12
    v_add_u32 v20, 0, v1
    v_add_u32 v12, s37, v20
    v_add_u32 v21, 36864, v1
    v_add_u32 v13, s37, v21
    v_add_u32 v22, 73728, v1
    v_add_u32 v14, s37, v22
    v_add_u32 v23, 110592, v1
    v_add_u32 v15, s37, v23
    s_add_u32 s34, s34, 0x1900000
    s_lshl_b32 s39, s30, 10
    s_add_u32 s39, s39, s21
    s_lshl_b32 s42, s24, 7
    s_add_u32 s39, s39, s42
    s_add_u32 s39, s39, 0x3700000
    v_cmp_eq_u32 vcc, 0, v3
    v_mov_b32 v11, 0x3f803f80
    s_lshr_b32 s44, s23, 1
    v_cndmask_b32 v10, v6, v10, vcc
    s_cmp_eq_u32 s22, 0
    s_cbranch_scc1 L_p5_nf
    v_mul_u32_u24 v8, 1152, v2
    s_mul_i32 s34, s30, 18432
    s_mul_i32 s42, s24, 144
    s_add_u32 s34, s34, s42
    v_lshl_add_u32 v4, v3, 4, v8
    v_lshl_add_u32 v5, v9, 3, v8
    v_cndmask_b32 v5, v6, v5, s[40:41]
L_p5_nf:
    s_lshl_b32 s52, s22, 7
    s_add_u32 s52, s52, s44
    s_lshl_b32 s52, s52, 8
    s_add_u32 s52, s52, 0x450a000
    s_add_u32 s52, s52, s4
    s_addc_u32 s53, s5, 0
    s_waitcnt vmcnt(3)
    s_barrier
    s_cmp_lg_u32 s20, 0
    s_cbranch_scc1 L_ns_d5
    s_mov_b32 s56, 1
    s_atomic_add s56, s[50:51], 0
L_ns_d5:
    s_mul_i32 s37, s20, 4608
    s_add_u32 s37, s37, 131072
    s_xor_b32 s38, s20, 1
    s_mul_i32 s42, s38, 4608
    s_add_u32 s42, s42, 131072
    v_and_b32 v0, 0x1ff, v1
    v_add_u32 v2, s37, v1
    v_add_u32 v3, s37, v0
    v_add_u32 v7, s42, v1
    v_add_u32 v8, s42, v0
    s_lshl_b32 s37, s20, 2
    s_add_u32 s37, s37, 163808
    s_xor_b32 s38, s37, 4
    v_mov_b32 v0, s37
    v_mov_b32 v6, s38
    s_lshl_b32 s43, s22, 1
    s_add_u32 s43, s43, 2
    v_mov_b32 v9, s43
    s_cmp_lg_u32 s20, 0
    s_cbranch_scc1 L_pd_d5
    s_mov_b32 s60, 65536
L_poll_d5:
    s_mov_b32 s57, 0
    s_atomic_add s57, s[52:53], 0 glc
    s_waitcnt lgkmcnt(0)
    s_cmp_ge_u32 s57, 16
    s_cbranch_scc1 L_pd_d5
    s_sub_u32 s60, s60, 1
    s_cbranch_scc1 L_pd_d5
    s_sleep 2
    s_branch L_poll_d5
L_pd_d5:
    s_barrier
    s_mov_b32 s32, 0
    s_lshl_b32 s32, s32, 13
    s_add_u32 s32, s32, s29
    s_add_u32 s33, s32, 4096
    buffer_load_dwordx4 v[124:127], v16, s[4:7], s32 offen offset:0 sc1
    buffer_load_dwordx4 v[128:131], v17, s[4:7], s32 offen offset:0 sc1
    buffer_load_dwordx4 v[132:135], v16, s[4:7], s32 offen offset:2048 sc1
    buffer_load_dwordx4 v[136:139], v17, s[4:7], s32 offen offset:2048 sc1
    buffer_load_dwordx4 v[140:143], v16, s[4:7], s33 offen offset:0 sc1
    buffer_load_dwordx4 v[144:147], v17, s[4:7], s33 offen offset:0 sc1
    buffer_load_dwordx4 v[148:151], v16, s[4:7], s33 offen offset:2048 sc1
    buffer_load_dwordx4 v[152:155], v17, s[4:7], s33 offen offset:2048 sc1
    ds_read_b128 v[64:67], v14 offset:0
    ds_read_b128 v[68:71], v14 offset:1024
    ds_read_b128 v[72:75], v14 offset:2048
    ds_read_b128 v[76:79], v14 offset:3072
    ds_read_b128 v[80:83], v22 offset:8192
    ds_read_b128 v[84:87], v14 offset:9216
    ds_read_b128 v[88:91], v14 offset:10240
    ds_read_b128 v[92:95], v14 offset:11264
    ds_read_b128 v[96:99], v14 offset:12288
    ds_read_b128 v[100:103], v22 offset:17408
    s_add_u32 s45, s29, 8192
    s_add_u32 s46, s29, 12288
    buffer_load_dwordx4 v[156:159], v16, s[4:7], s45 offen offset:0 sc1
    buffer_load_dwordx4 v[160:163], v17, s[4:7], s45 offen offset:0 sc1
    s_lshl_b32 s50, s22, 7
    s_add_u32 s50, s50, s44
    s_lshl_b32 s50, s50, 8
    s_add_u32 s50, s50, 0x450b000
    s_add_u32 s50, s50, s4
    s_addc_u32 s51, s5, 0
    s_waitcnt vmcnt(10)
    v_lshlrev_b32 v24, 16, v220
    v_and_b32 v25, 0xffff0000, v220
    v_lshlrev_b32 v26, 16, v221
    v_and_b32 v27, 0xffff0000, v221
    v_lshlrev_b32 v28, 16, v222
    v_and_b32 v29, 0xffff0000, v222
    v_lshlrev_b32 v30, 16, v223
    v_and_b32 v31, 0xffff0000, v223
    v_lshlrev_b32 v32, 16, v224
    v_and_b32 v33, 0xffff0000, v224
    v_lshlrev_b32 v34, 16, v225
    v_and_b32 v35, 0xffff0000, v225
    v_lshlrev_b32 v36, 16, v226
    v_and_b32 v37, 0xffff0000, v226
    v_lshlrev_b32 v38, 16, v227
    v_and_b32 v39, 0xffff0000, v227
    v_lshlrev_b32 v40, 16, v228
    v_and_b32 v41, 0xffff0000, v228
    v_lshlrev_b32 v42, 16, v229
    v_and_b32 v43, 0xffff0000, v229
    s_waitcnt vmcnt(8) lgkmcnt(5)
    v_mfma_f32_16x16x32_bf16 v[44:47], v[64:67], v[128:131], 0
    ds_read_b128 v[104:107], v14 offset:18432
    s_mov_b32 s32, 2
    s_lshl_b32 s32, s32, 13
    s_add_u32 s32, s32, s29
    s_add_u32 s33, s32, 4096
    v_mfma_f32_16x16x32_bf16 v[24:27], v[64:67], v[124:127], v[24:27]
    ds_read_b128 v[108:111], v14 offset:19456
    buffer_load_dwordx4 v[164:167], v16, s[4:7], s45 offen offset:2048 sc1
    v_mfma_f32_16x16x32_bf16 v[48:51], v[68:71], v[128:131], 0
    ds_read_b128 v[112:115], v14 offset:20480
    v_mfma_f32_16x16x32_bf16 v[28:31], v[68:71], v[124:127], v[28:31]
    ds_read_b128 v[116:119], v14 offset:21504
    buffer_load_dwordx4 v[168:171], v17, s[4:7], s45 offen offset:2048 sc1
    v_mfma_f32_16x16x32_bf16 v[52:55], v[72:75], v[128:131], 0
    ds_read_b128 v[120:123], v22 offset:26624
    v_mfma_f32_16x16x32_bf16 v[32:35], v[72:75], v[124:127], v[32:35]
    buffer_load_dwordx4 v[188:191], v16, s[4:7], s32 offen offset:0 sc1
    v_mfma_f32_16x16x32_bf16 v[56:59], v[76:79], v[128:131], 0
    v_mfma_f32_16x16x32_bf16 v[36:39], v[76:79], v[124:127], v[36:39]
    buffer_load_dwordx4 v[192:195], v17, s[4:7], s32 offen offset:0 sc1
    v_mfma_f32_16x16x32_bf16 v[60:63], v[80:83], v[128:131], 0
    v_mfma_f32_16x16x32_bf16 v[40:43], v[80:83], v[124:127], v[40:43]
    s_waitcnt vmcnt(10) lgkmcnt(5)
    v_mfma_f32_16x16x32_bf16 v[44:47], v[84:87], v[136:139], v[44:47]
    ds_read_b128 v[64:67], v14 offset:27648
    v_mfma_f32_16x16x32_bf16 v[24:27], v[84:87], v[132:135], v[24:27]
    ds_read_b128 v[68:71], v14 offset:28672
    buffer_load_dwordx4 v[172:175], v16, s[4:7], s46 offen offset:0 sc1
    v_mfma_f32_16x16x32_bf16 v[48:51], v[88:91], v[136:139], v[48:51]
    ds_read_b128 v[72:75], v14 offset:29696
    v_mfma_f32_16x16x32_bf16 v[28:31], v[88:91], v[132:135], v[28:31]
    ds_read_b128 v[76:79], v14 offset:30720
    buffer_load_dwordx4 v[176:179], v17, s[4:7], s46 offen offset:0 sc1
    v_mfma_f32_16x16x32_bf16 v[52:55], v[92:95], v[136:139], v[52:55]
    ds_read_b128 v[80:83], v22 offset:35840
    v_mfma_f32_16x16x32_bf16 v[32:35], v[92:95], v[132:135], v[32:35]
    buffer_load_dwordx4 v[196:199], v16, s[4:7], s32 offen offset:2048 sc1
    v_mfma_f32_16x16x32_bf16 v[56:59], v[96:99], v[136:139], v[56:59]
    v_mfma_f32_16x16x32_bf16 v[36:39], v[96:99], v[132:135], v[36:39]
    buffer_load_dwordx4 v[200:203], v17, s[4:7], s32 offen offset:2048 sc1
    v_mfma_f32_16x16x32_bf16 v[60:63], v[100:103], v[136:139], v[60:63]
    v_mfma_f32_16x16x32_bf16 v[40:43], v[100:103], v[132:135], v[40:43]
    s_waitcnt vmcnt(12) lgkmcnt(0)
    s_barrier
    v_mfma_f32_16x16x32_bf16 v[44:47], v[104:107], v[144:147], v[44:47]
    ds_read_b128 v[84:87], v15 offset:0
    v_mfma_f32_16x16x32_bf16 v[24:27], v[104:107], v[140:143], v[24:27]
    ds_read_b128 v[88:91], v15 offset:1024
    buffer_load_dwordx4 v[180:183], v16, s[4:7], s46 offen offset:2048 sc1
    v_mfma_f32_16x16x32_bf16 v[48:51], v[108:111], v[144:147], v[48:51]
    ds_read_b128 v[92:95], v15 offset:2048
    v_mfma_f32_16x16x32_bf16 v[28:31], v[108:111], v[140:143], v[28:31]
    ds_read_b128 v[96:99], v15 offset:3072
    buffer_load_dwordx4 v[184:187], v17, s[4:7], s46 offen offset:2048 sc1
    v_mfma_f32_16x16x32_bf16 v[52:55], v[112:115], v[144:147], v[52:55]
    ds_read_b128 v[100:103], v23 offset:8192
    v_mfma_f32_16x16x32_bf16 v[32:35], v[112:115], v[140:143], v[32:35]
    buffer_load_dwordx4 v[204:207], v16, s[4:7], s33 offen offset:0 sc1
    v_mfma_f32_16x16x32_bf16 v[56:59], v[116:119], v[144:147], v[56:59]
    v_mfma_f32_16x16x32_bf16 v[36:39], v[116:119], v[140:143], v[36:39]
    buffer_load_dwordx4 v[208:211], v17, s[4:7], s33 offen offset:0 sc1
    v_mfma_f32_16x16x32_bf16 v[60:63], v[120:123], v[144:147], v[60:63]
    v_mfma_f32_16x16x32_bf16 v[40:43], v[120:123], v[140:143], v[40:43]
    s_waitcnt vmcnt(14) lgkmcnt(5)
    v_mfma_f32_16x16x32_bf16 v[44:47], v[64:67], v[152:155], v[44:47]
    ds_read_b128 v[104:107], v15 offset:9216
    v_mfma_f32_16x16x32_bf16 v[24:27], v[64:67], v[148:151], v[24:27]
    ds_read_b128 v[108:111], v15 offset:10240
    v_mfma_f32_16x16x32_bf16 v[48:51], v[68:71], v[152:155], v[48:51]
    ds_read_b128 v[112:115], v15 offset:11264
    v_mfma_f32_16x16x32_bf16 v[28:31], v[68:71], v[148:151], v[28:31]
    ds_read_b128 v[116:119], v15 offset:12288
    v_mfma_f32_16x16x32_bf16 v[52:55], v[72:75], v[152:155], v[52:55]
    ds_read_b128 v[120:123], v23 offset:17408
    v_mfma_f32_16x16x32_bf16 v[32:35], v[72:75], v[148:151], v[32:35]
    buffer_load_dwordx4 v[212:215], v16, s[4:7], s33 offen offset:2048 sc1
    v_mfma_f32_16x16x32_bf16 v[56:59], v[76:79], v[152:155], v[56:59]
    v_mfma_f32_16x16x32_bf16 v[36:39], v[76:79], v[148:151], v[36:39]
    buffer_load_dwordx4 v[216:219], v17, s[4:7], s33 offen offset:2048 sc1
    v_mfma_f32_16x16x32_bf16 v[60:63], v[80:83], v[152:155], v[60:63]
    v_mfma_f32_16x16x32_bf16 v[40:43], v[80:83], v[148:151], v[40:43]
    s_waitcnt vmcnt(14) lgkmcnt(5)
    v_mfma_f32_16x16x32_bf16 v[44:47], v[84:87], v[160:163], v[44:47]
    ds_read_b128 v[64:67], v15 offset:18432
    s_mov_b32 s32, 3
    s_lshl_b32 s32, s32, 13
    s_add_u32 s32, s32, s29
    s_add_u32 s33, s32, 4096
    v_mfma_f32_16x16x32_bf16 v[24:27], v[84:87], v[156:159], v[24:27]
    ds_read_b128 v[68:71], v15 offset:19456
    v_mfma_f32_16x16x32_bf16 v[48:51], v[88:91], v[160:163], v[48:51]
    ds_read_b128 v[72:75], v15 offset:20480
    v_mfma_f32_16x16x32_bf16 v[28:31], v[88:91], v[156:159], v[28:31]
    ds_read_b128 v[76:79], v15 offset:21504
    v_mfma_f32_16x16x32_bf16 v[52:55], v[92:95], v[160:163], v[52:55]
    ds_read_b128 v[80:83], v23 offset:26624
    v_mfma_f32_16x16x32_bf16 v[32:35], v[92:95], v[156:159], v[32:35]
    buffer_load_dwordx4 v[124:127], v16, s[4:7], s32 offen offset:0 sc1
    v_mfma_f32_16x16x32_bf16 v[56:59], v[96:99], v[160:163], v[56:59]
    v_mfma_f32_16x16x32_bf16 v[36:39], v[96:99], v[156:159], v[36:39]
    buffer_load_dwordx4 v[128:131], v17, s[4:7], s32 offen offset:0 sc1
    v_mfma_f32_16x16x32_bf16 v[60:63], v[100:103], v[160:163], v[60:63]
    v_mfma_f32_16x16x32_bf16 v[40:43], v[100:103], v[156:159], v[40:43]
    s_waitcnt vmcnt(14) lgkmcnt(5)
    v_mfma_f32_16x16x32_bf16 v[44:47], v[104:107], v[168:171], v[44:47]
    ds_read_b128 v[84:87], v15 offset:27648
    v_mfma_f32_16x16x32_bf16 v[24:27], v[104:107], v[164:167], v[24:27]
    ds_read_b128 v[88:91], v15 offset:28672
    v_mfma_f32_16x16x32_bf16 v[48:51], v[108:111], v[168:171], v[48:51]
    ds_read_b128 v[92:95], v15 offset:29696
    v_mfma_f32_16x16x32_bf16 v[28:31], v[108:111], v[164:167], v[28:31]
    ds_read_b128 v[96:99], v15 offset:30720
    v_mfma_f32_16x16x32_bf16 v[52:55], v[112:115], v[168:171], v[52:55]
    ds_read_b128 v[100:103], v23 offset:35840
    v_mfma_f32_16x16x32_bf16 v[32:35], v[112:115], v[164:167], v[32:35]
    buffer_load_dwordx4 v[132:135], v16, s[4:7], s32 offen offset:2048 sc1
    v_mfma_f32_16x16x32_bf16 v[56:59], v[116:119], v[168:171], v[56:59]
    v_mfma_f32_16x16x32_bf16 v[36:39], v[116:119], v[164:167], v[36:39]
    buffer_load_dwordx4 v[136:139], v17, s[4:7], s32 offen offset:2048 sc1
    v_mfma_f32_16x16x32_bf16 v[60:63], v[120:123], v[168:171], v[60:63]
    v_mfma_f32_16x16x32_bf16 v[40:43], v[120:123], v[164:167], v[40:43]
    s_waitcnt vmcnt(12) lgkmcnt(0)
    s_barrier
    v_mfma_f32_16x16x32_bf16 v[44:47], v[64:67], v[176:179], v[44:47]
    ds_read_b128 v[104:107], v12 offset:0
    v_mfma_f32_16x16x32_bf16 v[24:27], v[64:67], v[172:175], v[24:27]
    ds_read_b128 v[108:111], v12 offset:1024
    v_mfma_f32_16x16x32_bf16 v[48:51], v[68:71], v[176:179], v[48:51]
    ds_read_b128 v[112:115], v12 offset:2048
    v_mfma_f32_16x16x32_bf16 v[28:31], v[68:71], v[172:175], v[28:31]
    ds_read_b128 v[116:119], v12 offset:3072
    v_mfma_f32_16x16x32_bf16 v[52:55], v[72:75], v[176:179], v[52:55]
    ds_read_b128 v[120:123], v20 offset:8192
    v_mfma_f32_16x16x32_bf16 v[32:35], v[72:75], v[172:175], v[32:35]
    buffer_load_dwordx4 v[140:143], v16, s[4:7], s33 offen offset:0 sc1
    v_mfma_f32_16x16x32_bf16 v[56:59], v[76:79], v[176:179], v[56:59]
    v_mfma_f32_16x16x32_bf16 v[36:39], v[76:79], v[172:175], v[36:39]
    buffer_load_dwordx4 v[144:147], v17, s[4:7], s33 offen offset:0 sc1
    v_mfma_f32_16x16x32_bf16 v[60:63], v[80:83], v[176:179], v[60:63]
    v_mfma_f32_16x16x32_bf16 v[40:43], v[80:83], v[172:175], v[40:43]
    s_waitcnt vmcnt(10) lgkmcnt(5)
    v_mfma_f32_16x16x32_bf16 v[44:47], v[84:87], v[184:187], v[44:47]
    ds_read_b128 v[64:67], v12 offset:9216
    v_mfma_f32_16x16x32_bf16 v[24:27], v[84:87], v[180:183], v[24:27]
    ds_read_b128 v[68:71], v12 offset:10240
    v_mfma_f32_16x16x32_bf16 v[48:51], v[88:91], v[184:187], v[48:51]
    ds_read_b128 v[72:75], v12 offset:11264
    v_mfma_f32_16x16x32_bf16 v[28:31], v[88:91], v[180:183], v[28:31]
    ds_read_b128 v[76:79], v12 offset:12288
    v_mfma_f32_16x16x32_bf16 v[52:55], v[92:95], v[184:187], v[52:55]
    ds_read_b128 v[80:83], v20 offset:17408
    v_mfma_f32_16x16x32_bf16 v[32:35], v[92:95], v[180:183], v[32:35]
    buffer_load_dwordx4 v[148:151], v16, s[4:7], s33 offen offset:2048 sc1
    v_mfma_f32_16x16x32_bf16 v[56:59], v[96:99], v[184:187], v[56:59]
    v_mfma_f32_16x16x32_bf16 v[36:39], v[96:99], v[180:183], v[36:39]
    buffer_load_dwordx4 v[152:155], v17, s[4:7], s33 offen offset:2048 sc1
    v_mfma_f32_16x16x32_bf16 v[60:63], v[100:103], v[184:187], v[60:63]
    v_mfma_f32_16x16x32_bf16 v[40:43], v[100:103], v[180:183], v[40:43]
    s_waitcnt vmcnt(12) lgkmcnt(5)
    v_mfma_f32_16x16x32_bf16 v[44:47], v[104:107], v[192:195], v[44:47]
    ds_read_b128 v[84:87], v12 offset:18432
    s_mov_b32 s32, 4
    s_lshl_b32 s32, s32, 13
    s_add_u32 s32, s32, s29
    s_add_u32 s33, s32, 4096
    v_mfma_f32_16x16x32_bf16 v[24:27], v[104:107], v[188:191], v[24:27]
    ds_read_b128 v[88:91], v12 offset:19456
    v_mfma_f32_16x16x32_bf16 v[48:51], v[108:111], v[192:195], v[48:51]
    ds_read_b128 v[92:95], v12 offset:20480
    v_mfma_f32_16x16x32_bf16 v[28:31], v[108:111], v[188:191], v[28:31]
    ds_read_b128 v[96:99], v12 offset:21504
    v_mfma_f32_16x16x32_bf16 v[52:55], v[112:115], v[192:195], v[52:55]
    ds_read_b128 v[100:103], v20 offset:26624
    v_mfma_f32_16x16x32_bf16 v[32:35], v[112:115], v[188:191], v[32:35]
    buffer_load_dwordx4 v[156:159], v16, s[4:7], s32 offen offset:0 sc1
    v_mfma_f32_16x16x32_bf16 v[56:59], v[116:119], v[192:195], v[56:59]
    v_mfma_f32_16x16x32_bf16 v[36:39], v[116:119], v[188:191], v[36:39]
    buffer_load_dwordx4 v[160:163], v17, s[4:7], s32 offen offset:0 sc1
    v_mfma_f32_16x16x32_bf16 v[60:63], v[120:123], v[192:195], v[60:63]
    v_mfma_f32_16x16x32_bf16 v[40:43], v[120:123], v[188:191], v[40:43]
    s_waitcnt vmcnt(14) lgkmcnt(5)
    v_mfma_f32_16x16x32_bf16 v[44:47], v[64:67], v[200:203], v[44:47]
    ds_read_b128 v[104:107], v12 offset:27648
    v_mfma_f32_16x16x32_bf16 v[24:27], v[64:67], v[196:199], v[24:27]
    ds_read_b128 v[108:111], v12 offset:28672
    v_mfma_f32_16x16x32_bf16 v[48:51], v[68:71], v[200:203], v[48:51]
    ds_read_b128 v[112:115], v12 offset:29696
    v_mfma_f32_16x16x32_bf16 v[28:31], v[68:71], v[196:199], v[28:31]
    ds_read_b128 v[116:119], v12 offset:30720
    v_mfma_f32_16x16x32_bf16 v[52:55], v[72:75], v[200:203], v[52:55]
    ds_read_b128 v[120:123], v20 offset:35840
    v_mfma_f32_16x16x32_bf16 v[32:35], v[72:75], v[196:199], v[32:35]
    buffer_load_dwordx4 v[164:167], v16, s[4:7], s32 offen offset:2048 sc1
    v_mfma_f32_16x16x32_bf16 v[56:59], v[76:79], v[200:203], v[56:59]
    v_mfma_f32_16x16x32_bf16 v[36:39], v[76:79], v[196:199], v[36:39]
    buffer_load_dwordx4 v[168:171], v17, s[4:7], s32 offen offset:2048 sc1
    v_mfma_f32_16x16x32_bf16 v[60:63], v[80:83], v[200:203], v[60:63]
    v_mfma_f32_16x16x32_bf16 v[40:43], v[80:83], v[196:199], v[40:43]
    s_waitcnt vmcnt(14) lgkmcnt(0)
    s_barrier
    v_mfma_f32_16x16x32_bf16 v[44:47], v[84:87], v[208:211], v[44:47]
    ds_read_b128 v[64:67], v13 offset:0
    v_mfma_f32_16x16x32_bf16 v[24:27], v[84:87], v[204:207], v[24:27]
    ds_read_b128 v[68:71], v13 offset:1024
    v_mfma_f32_16x16x32_bf16 v[48:51], v[88:91], v[208:211], v[48:51]
    ds_read_b128 v[72:75], v13 offset:2048
    v_mfma_f32_16x16x32_bf16 v[28:31], v[88:91], v[204:207], v[28:31]
    ds_read_b128 v[76:79], v13 offset:3072
    v_mfma_f32_16x16x32_bf16 v[52:55], v[92:95], v[208:211], v[52:55]
    ds_read_b128 v[80:83], v21 offset:8192
    v_mfma_f32_16x16x32_bf16 v[32:35], v[92:95], v[204:207], v[32:35]
    buffer_load_dwordx4 v[172:175], v16, s[4:7], s33 offen offset:0 sc1
    v_mfma_f32_16x16x32_bf16 v[56:59], v[96:99], v[208:211], v[56:59]
    v_mfma_f32_16x16x32_bf16 v[36:39], v[96:99], v[204:207], v[36:39]
    buffer_load_dwordx4 v[176:179], v17, s[4:7], s33 offen offset:0 sc1
    v_mfma_f32_16x16x32_bf16 v[60:63], v[100:103], v[208:211], v[60:63]
    v_mfma_f32_16x16x32_bf16 v[40:43], v[100:103], v[204:207], v[40:43]
    s_waitcnt vmcnt(14) lgkmcnt(5)
    v_mfma_f32_16x16x32_bf16 v[44:47], v[104:107], v[216:219], v[44:47]
    ds_read_b128 v[84:87], v13 offset:9216
    v_mfma_f32_16x16x32_bf16 v[24:27], v[104:107], v[212:215], v[24:27]
    ds_read_b128 v[88:91], v13 offset:10240
    v_mfma_f32_16x16x32_bf16 v[48:51], v[108:111], v[216:219], v[48:51]
    ds_read_b128 v[92:95], v13 offset:11264
    v_mfma_f32_16x16x32_bf16 v[28:31], v[108:111], v[212:215], v[28:31]
    ds_read_b128 v[96:99], v13 offset:12288
    v_mfma_f32_16x16x32_bf16 v[52:55], v[112:115], v[216:219], v[52:55]
    ds_read_b128 v[100:103], v21 offset:17408
    v_mfma_f32_16x16x32_bf16 v[32:35], v[112:115], v[212:215], v[32:35]
    buffer_load_dwordx4 v[180:183], v16, s[4:7], s33 offen offset:2048 sc1
    v_mfma_f32_16x16x32_bf16 v[56:59], v[116:119], v[216:219], v[56:59]
    v_mfma_f32_16x16x32_bf16 v[36:39], v[116:119], v[212:215], v[36:39]
    buffer_load_dwordx4 v[184:187], v17, s[4:7], s33 offen offset:2048 sc1
    v_mfma_f32_16x16x32_bf16 v[60:63], v[120:123], v[216:219], v[60:63]
    v_mfma_f32_16x16x32_bf16 v[40:43], v[120:123], v[212:215], v[40:43]
    s_waitcnt vmcnt(14) lgkmcnt(5)
    v_mfma_f32_16x16x32_bf16 v[44:47], v[64:67], v[128:131], v[44:47]
    ds_read_b128 v[104:107], v13 offset:18432
    s_mov_b32 s32, 5
    s_lshl_b32 s32, s32, 13
    s_add_u32 s32, s32, s29
    s_add_u32 s33, s32, 4096
    v_mfma_f32_16x16x32_bf16 v[24:27], v[64:67], v[124:127], v[24:27]
    ds_read_b128 v[108:111], v13 offset:19456
    v_mfma_f32_16x16x32_bf16 v[48:51], v[68:71], v[128:131], v[48:51]
    ds_read_b128 v[112:115], v13 offset:20480
    v_mfma_f32_16x16x32_bf16 v[28:31], v[68:71], v[124:127], v[28:31]
    ds_read_b128 v[116:119], v13 offset:21504
    v_mfma_f32_16x16x32_bf16 v[52:55], v[72:75], v[128:131], v[52:55]
    ds_read_b128 v[120:123], v21 offset:26624
    v_mfma_f32_16x16x32_bf16 v[32:35], v[72:75], v[124:127], v[32:35]
    buffer_load_dwordx4 v[188:191], v16, s[4:7], s32 offen offset:0 sc1
    v_mfma_f32_16x16x32_bf16 v[56:59], v[76:79], v[128:131], v[56:59]
    v_mfma_f32_16x16x32_bf16 v[36:39], v[76:79], v[124:127], v[36:39]
    buffer_load_dwordx4 v[192:195], v17, s[4:7], s32 offen offset:0 sc1
    v_mfma_f32_16x16x32_bf16 v[60:63], v[80:83], v[128:131], v[60:63]
    v_mfma_f32_16x16x32_bf16 v[40:43], v[80:83], v[124:127], v[40:43]
    s_waitcnt vmcnt(14) lgkmcnt(5)
    v_mfma_f32_16x16x32_bf16 v[44:47], v[84:87], v[136:139], v[44:47]
    ds_read_b128 v[64:67], v13 offset:27648
    v_mfma_f32_16x16x32_bf16 v[24:27], v[84:87], v[132:135], v[24:27]
    ds_read_b128 v[68:71], v13 offset:28672
    v_mfma_f32_16x16x32_bf16 v[48:51], v[88:91], v[136:139], v[48:51]
    ds_read_b128 v[72:75], v13 offset:29696
    v_mfma_f32_16x16x32_bf16 v[28:31], v[88:91], v[132:135], v[28:31]
    ds_read_b128 v[76:79], v13 offset:30720
    v_mfma_f32_16x16x32_bf16 v[52:55], v[92:95], v[136:139], v[52:55]
    ds_read_b128 v[80:83], v21 offset:35840
    v_mfma_f32_16x16x32_bf16 v[32:35], v[92:95], v[132:135], v[32:35]
    buffer_load_dwordx4 v[196:199], v16, s[4:7], s32 offen offset:2048 sc1
    v_mfma_f32_16x16x32_bf16 v[56:59], v[96:99], v[136:139], v[56:59]
    v_mfma_f32_16x16x32_bf16 v[36:39], v[96:99], v[132:135], v[36:39]
    buffer_load_dwordx4 v[200:203], v17, s[4:7], s32 offen offset:2048 sc1
    v_mfma_f32_16x16x32_bf16 v[60:63], v[100:103], v[136:139], v[60:63]
    v_mfma_f32_16x16x32_bf16 v[40:43], v[100:103], v[132:135], v[40:43]
    s_waitcnt vmcnt(14) lgkmcnt(0)
    s_barrier
    v_mfma_f32_16x16x32_bf16 v[44:47], v[104:107], v[144:147], v[44:47]
    ds_read_b128 v[84:87], v14 offset:0
    v_mfma_f32_16x16x32_bf16 v[24:27], v[104:107], v[140:143], v[24:27]
    ds_read_b128 v[88:91], v14 offset:1024
    v_mfma_f32_16x16x32_bf16 v[48:51], v[108:111], v[144:147], v[48:51]
    ds_read_b128 v[92:95], v14 offset:2048
    v_mfma_f32_16x16x32_bf16 v[28:31], v[108:111], v[140:143], v[28:31]
    ds_read_b128 v[96:99], v14 offset:3072
    v_mfma_f32_16x16x32_bf16 v[52:55], v[112:115], v[144:147], v[52:55]
    ds_read_b128 v[100:103], v22 offset:8192
    v_mfma_f32_16x16x32_bf16 v[32:35], v[112:115], v[140:143], v[32:35]
    buffer_load_dwordx4 v[204:207], v16, s[4:7], s33 offen offset:0 sc1
    v_mfma_f32_16x16x32_bf16 v[56:59], v[116:119], v[144:147], v[56:59]
    v_mfma_f32_16x16x32_bf16 v[36:39], v[116:119], v[140:143], v[36:39]
    buffer_load_dwordx4 v[208:211], v17, s[4:7], s33 offen offset:0 sc1
    v_mfma_f32_16x16x32_bf16 v[60:63], v[120:123], v[144:147], v[60:63]
    v_mfma_f32_16x16x32_bf16 v[40:43], v[120:123], v[140:143], v[40:43]
    s_waitcnt vmcnt(14) lgkmcnt(5)
    v_mfma_f32_16x16x32_bf16 v[44:47], v[64:67], v[152:155], v[44:47]
    ds_read_b128 v[104:107], v14 offset:9216
    v_mfma_f32_16x16x32_bf16 v[24:27], v[64:67], v[148:151], v[24:27]
    ds_read_b128 v[108:111], v14 offset:10240
    v_mfma_f32_16x16x32_bf16 v[48:51], v[68:71], v[152:155], v[48:51]
    ds_read_b128 v[112:115], v14 offset:11264
    v_mfma_f32_16x16x32_bf16 v[28:31], v[68:71], v[148:151], v[28:31]
    ds_read_b128 v[116:119], v14 offset:12288
    v_mfma_f32_16x16x32_bf16 v[52:55], v[72:75], v[152:155], v[52:55]
    ds_read_b128 v[120:123], v22 offset:17408
    v_mfma_f32_16x16x32_bf16 v[32:35], v[72:75], v[148:151], v[32:35]
    buffer_load_dwordx4 v[212:215], v16, s[4:7], s33 offen offset:2048 sc1
    v_mfma_f32_16x16x32_bf16 v[56:59], v[76:79], v[152:155], v[56:59]
    v_mfma_f32_16x16x32_bf16 v[36:39], v[76:79], v[148:151], v[36:39]
    buffer_load_dwordx4 v[216:219], v17, s[4:7], s33 offen offset:2048 sc1
    v_mfma_f32_16x16x32_bf16 v[60:63], v[80:83], v[152:155], v[60:63]
    v_mfma_f32_16x16x32_bf16 v[40:43], v[80:83], v[148:151], v[40:43]
    s_waitcnt vmcnt(14) lgkmcnt(5)
    v_mfma_f32_16x16x32_bf16 v[44:47], v[84:87], v[160:163], v[44:47]
    ds_read_b128 v[64:67], v14 offset:18432
    s_mov_b32 s32, 6
    s_lshl_b32 s32, s32, 13
    s_add_u32 s32, s32, s29
    s_add_u32 s33, s32, 4096
    v_mfma_f32_16x16x32_bf16 v[24:27], v[84:87], v[156:159], v[24:27]
    ds_read_b128 v[68:71], v14 offset:19456
    v_mfma_f32_16x16x32_bf16 v[48:51], v[88:91], v[160:163], v[48:51]
    ds_read_b128 v[72:75], v14 offset:20480
    v_mfma_f32_16x16x32_bf16 v[28:31], v[88:91], v[156:159], v[28:31]
    ds_read_b128 v[76:79], v14 offset:21504
    v_mfma_f32_16x16x32_bf16 v[52:55], v[92:95], v[160:163], v[52:55]
    ds_read_b128 v[80:83], v22 offset:26624
    v_mfma_f32_16x16x32_bf16 v[32:35], v[92:95], v[156:159], v[32:35]
    buffer_load_dwordx4 v[124:127], v16, s[4:7], s32 offen offset:0 sc1
    v_mfma_f32_16x16x32_bf16 v[56:59], v[96:99], v[160:163], v[56:59]
    v_mfma_f32_16x16x32_bf16 v[36:39], v[96:99], v[156:159], v[36:39]
    buffer_load_dwordx4 v[128:131], v17, s[4:7], s32 offen offset:0 sc1
    v_mfma_f32_16x16x32_bf16 v[60:63], v[100:103], v[160:163], v[60:63]
    v_mfma_f32_16x16x32_bf16 v[40:43], v[100:103], v[156:159], v[40:43]
    s_waitcnt vmcnt(14) lgkmcnt(5)
    v_mfma_f32_16x16x32_bf16 v[44:47], v[104:107], v[168:171], v[44:47]
    ds_read_b128 v[84:87], v14 offset:27648
    v_mfma_f32_16x16x32_bf16 v[24:27], v[104:107], v[164:167], v[24:27]
    ds_read_b128 v[88:91], v14 offset:28672
    v_mfma_f32_16x16x32_bf16 v[48:51], v[108:111], v[168:171], v[48:51]
    ds_read_b128 v[92:95], v14 offset:29696
    v_mfma_f32_16x16x32_bf16 v[28:31], v[108:111], v[164:167], v[28:31]
    ds_read_b128 v[96:99], v14 offset:30720
    v_mfma_f32_16x16x32_bf16 v[52:55], v[112:115], v[168:171], v[52:55]
    ds_read_b128 v[100:103], v22 offset:35840
    v_mfma_f32_16x16x32_bf16 v[32:35], v[112:115], v[164:167], v[32:35]
    buffer_load_dwordx4 v[132:135], v16, s[4:7], s32 offen offset:2048 sc1
    v_mfma_f32_16x16x32_bf16 v[56:59], v[116:119], v[168:171], v[56:59]
    v_mfma_f32_16x16x32_bf16 v[36:39], v[116:119], v[164:167], v[36:39]
    buffer_load_dwordx4 v[136:139], v17, s[4:7], s32 offen offset:2048 sc1
    v_mfma_f32_16x16x32_bf16 v[60:63], v[120:123], v[168:171], v[60:63]
    v_mfma_f32_16x16x32_bf16 v[40:43], v[120:123], v[164:167], v[40:43]
    s_waitcnt vmcnt(14) lgkmcnt(0)
    s_barrier
    v_mfma_f32_16x16x32_bf16 v[44:47], v[64:67], v[176:179], v[44:47]
    ds_read_b128 v[104:107], v15 offset:0
    v_mfma_f32_16x16x32_bf16 v[24:27], v[64:67], v[172:175], v[24:27]
    ds_read_b128 v[108:111], v15 offset:1024
    v_mfma_f32_16x16x32_bf16 v[48:51], v[68:71], v[176:179], v[48:51]
    ds_read_b128 v[112:115], v15 offset:2048
    v_mfma_f32_16x16x32_bf16 v[28:31], v[68:71], v[172:175], v[28:31]
    ds_read_b128 v[116:119], v15 offset:3072
    v_mfma_f32_16x16x32_bf16 v[52:55], v[72:75], v[176:179], v[52:55]
    ds_read_b128 v[120:123], v23 offset:8192
    v_mfma_f32_16x16x32_bf16 v[32:35], v[72:75], v[172:175], v[32:35]
    buffer_load_dwordx4 v[140:143], v16, s[4:7], s33 offen offset:0 sc1
    v_mfma_f32_16x16x32_bf16 v[56:59], v[76:79], v[176:179], v[56:59]
    v_mfma_f32_16x16x32_bf16 v[36:39], v[76:79], v[172:175], v[36:39]
    buffer_load_dwordx4 v[144:147], v17, s[4:7], s33 offen offset:0 sc1
    v_mfma_f32_16x16x32_bf16 v[60:63], v[80:83], v[176:179], v[60:63]
    v_mfma_f32_16x16x32_bf16 v[40:43], v[80:83], v[172:175], v[40:43]
    s_waitcnt vmcnt(14) lgkmcnt(5)
    v_mfma_f32_16x16x32_bf16 v[44:47], v[84:87], v[184:187], v[44:47]
    ds_read_b128 v[64:67], v15 offset:9216
    v_mfma_f32_16x16x32_bf16 v[24:27], v[84:87], v[180:183], v[24:27]
    ds_read_b128 v[68:71], v15 offset:10240
    v_mfma_f32_16x16x32_bf16 v[48:51], v[88:91], v[184:187], v[48:51]
    ds_read_b128 v[72:75], v15 offset:11264
    v_mfma_f32_16x16x32_bf16 v[28:31], v[88:91], v[180:183], v[28:31]
    ds_read_b128 v[76:79], v15 offset:12288
    v_mfma_f32_16x16x32_bf16 v[52:55], v[92:95], v[184:187], v[52:55]
    ds_read_b128 v[80:83], v23 offset:17408
    v_mfma_f32_16x16x32_bf16 v[32:35], v[92:95], v[180:183], v[32:35]
    buffer_load_dwordx4 v[148:151], v16, s[4:7], s33 offen offset:2048 sc1
    v_mfma_f32_16x16x32_bf16 v[56:59], v[96:99], v[184:187], v[56:59]
    v_mfma_f32_16x16x32_bf16 v[36:39], v[96:99], v[180:183], v[36:39]
    buffer_load_dwordx4 v[152:155], v17, s[4:7], s33 offen offset:2048 sc1
    v_mfma_f32_16x16x32_bf16 v[60:63], v[100:103], v[184:187], v[60:63]
    v_mfma_f32_16x16x32_bf16 v[40:43], v[100:103], v[180:183], v[40:43]
    s_waitcnt vmcnt(14) lgkmcnt(5)
    v_mfma_f32_16x16x32_bf16 v[44:47], v[104:107], v[192:195], v[44:47]
    ds_read_b128 v[84:87], v15 offset:18432
    s_mov_b32 s32, 7
    s_lshl_b32 s32, s32, 13
    s_add_u32 s32, s32, s29
    s_add_u32 s33, s32, 4096
    v_mfma_f32_16x16x32_bf16 v[24:27], v[104:107], v[188:191], v[24:27]
    ds_read_b128 v[88:91], v15 offset:19456
    v_mfma_f32_16x16x32_bf16 v[48:51], v[108:111], v[192:195], v[48:51]
    ds_read_b128 v[92:95], v15 offset:20480
    v_mfma_f32_16x16x32_bf16 v[28:31], v[108:111], v[188:191], v[28:31]
    ds_read_b128 v[96:99], v15 offset:21504
    v_mfma_f32_16x16x32_bf16 v[52:55], v[112:115], v[192:195], v[52:55]
    ds_read_b128 v[100:103], v23 offset:26624
    v_mfma_f32_16x16x32_bf16 v[32:35], v[112:115], v[188:191], v[32:35]
    buffer_load_dwordx4 v[156:159], v16, s[4:7], s32 offen offset:0 sc1
    v_mfma_f32_16x16x32_bf16 v[56:59], v[116:119], v[192:195], v[56:59]
    v_mfma_f32_16x16x32_bf16 v[36:39], v[116:119], v[188:191], v[36:39]
    buffer_load_dwordx4 v[160:163], v17, s[4:7], s32 offen offset:0 sc1
    v_mfma_f32_16x16x32_bf16 v[60:63], v[120:123], v[192:195], v[60:63]
    v_mfma_f32_16x16x32_bf16 v[40:43], v[120:123], v[188:191], v[40:43]
    s_waitcnt vmcnt(14) lgkmcnt(5)
    v_mfma_f32_16x16x32_bf16 v[44:47], v[64:67], v[200:203], v[44:47]
    ds_read_b128 v[104:107], v15 offset:27648
    v_mfma_f32_16x16x32_bf16 v[24:27], v[64:67], v[196:199], v[24:27]
    ds_read_b128 v[108:111], v15 offset:28672
    v_mfma_f32_16x16x32_bf16 v[48:51], v[68:71], v[200:203], v[48:51]
    ds_read_b128 v[112:115], v15 offset:29696
    v_mfma_f32_16x16x32_bf16 v[28:31], v[68:71], v[196:199], v[28:31]
    ds_read_b128 v[116:119], v15 offset:30720
    v_mfma_f32_16x16x32_bf16 v[52:55], v[72:75], v[200:203], v[52:55]
    ds_read_b128 v[120:123], v23 offset:35840
    v_mfma_f32_16x16x32_bf16 v[32:35], v[72:75], v[196:199], v[32:35]
    buffer_load_dwordx4 v[164:167], v16, s[4:7], s32 offen offset:2048 sc1
    v_mfma_f32_16x16x32_bf16 v[56:59], v[76:79], v[200:203], v[56:59]
    v_mfma_f32_16x16x32_bf16 v[36:39], v[76:79], v[196:199], v[36:39]
    buffer_load_dwordx4 v[168:171], v17, s[4:7], s32 offen offset:2048 sc1
    v_mfma_f32_16x16x32_bf16 v[60:63], v[80:83], v[200:203], v[60:63]
    v_mfma_f32_16x16x32_bf16 v[40:43], v[80:83], v[196:199], v[40:43]
    s_waitcnt vmcnt(14) lgkmcnt(0)
    s_barrier
    v_mfma_f32_16x16x32_bf16 v[44:47], v[84:87], v[208:211], v[44:47]
    ds_read_b128 v[64:67], v12 offset:0
    v_mfma_f32_16x16x32_bf16 v[24:27], v[84:87], v[204:207], v[24:27]
    ds_read_b128 v[68:71], v12 offset:1024
    v_mfma_f32_16x16x32_bf16 v[48:51], v[88:91], v[208:211], v[48:51]
    ds_read_b128 v[72:75], v12 offset:2048
    v_mfma_f32_16x16x32_bf16 v[28:31], v[88:91], v[204:207], v[28:31]
    ds_read_b128 v[76:79], v12 offset:3072
    v_mfma_f32_16x16x32_bf16 v[52:55], v[92:95], v[208:211], v[52:55]
    ds_read_b128 v[80:83], v20 offset:8192
    v_mfma_f32_16x16x32_bf16 v[32:35], v[92:95], v[204:207], v[32:35]
    buffer_load_dwordx4 v[172:175], v16, s[4:7], s33 offen offset:0 sc1
    v_mfma_f32_16x16x32_bf16 v[56:59], v[96:99], v[208:211], v[56:59]
    v_mfma_f32_16x16x32_bf16 v[36:39], v[96:99], v[204:207], v[36:39]
    buffer_load_dwordx4 v[176:179], v17, s[4:7], s33 offen offset:0 sc1
    v_mfma_f32_16x16x32_bf16 v[60:63], v[100:103], v[208:211], v[60:63]
    v_mfma_f32_16x16x32_bf16 v[40:43], v[100:103], v[204:207], v[40:43]
    s_waitcnt vmcnt(14) lgkmcnt(5)
    v_mfma_f32_16x16x32_bf16 v[44:47], v[104:107], v[216:219], v[44:47]
    ds_read_b128 v[84:87], v12 offset:9216
    v_mfma_f32_16x16x32_bf16 v[24:27], v[104:107], v[212:215], v[24:27]
    ds_read_b128 v[88:91], v12 offset:10240
    v_mfma_f32_16x16x32_bf16 v[48:51], v[108:111], v[216:219], v[48:51]
    ds_read_b128 v[92:95], v12 offset:11264
    v_mfma_f32_16x16x32_bf16 v[28:31], v[108:111], v[212:215], v[28:31]
    ds_read_b128 v[96:99], v12 offset:12288
    v_mfma_f32_16x16x32_bf16 v[52:55], v[112:115], v[216:219], v[52:55]
    ds_read_b128 v[100:103], v20 offset:17408
    v_mfma_f32_16x16x32_bf16 v[32:35], v[112:115], v[212:215], v[32:35]
    buffer_load_dwordx4 v[180:183], v16, s[4:7], s33 offen offset:2048 sc1
    v_mfma_f32_16x16x32_bf16 v[56:59], v[116:119], v[216:219], v[56:59]
    v_mfma_f32_16x16x32_bf16 v[36:39], v[116:119], v[212:215], v[36:39]
    buffer_load_dwordx4 v[184:187], v17, s[4:7], s33 offen offset:2048 sc1
    v_mfma_f32_16x16x32_bf16 v[60:63], v[120:123], v[216:219], v[60:63]
    v_mfma_f32_16x16x32_bf16 v[40:43], v[120:123], v[212:215], v[40:43]
    s_waitcnt vmcnt(14) lgkmcnt(5)
    v_mfma_f32_16x16x32_bf16 v[44:47], v[64:67], v[128:131], v[44:47]
    ds_read_b128 v[104:107], v12 offset:18432
    s_mov_b32 s32, 8
    s_lshl_b32 s32, s32, 13
    s_add_u32 s32, s32, s29
    s_add_u32 s33, s32, 4096
    v_mfma_f32_16x16x32_bf16 v[24:27], v[64:67], v[124:127], v[24:27]
    ds_read_b128 v[108:111], v12 offset:19456
    v_mfma_f32_16x16x32_bf16 v[48:51], v[68:71], v[128:131], v[48:51]
    ds_read_b128 v[112:115], v12 offset:20480
    v_mfma_f32_16x16x32_bf16 v[28:31], v[68:71], v[124:127], v[28:31]
    ds_read_b128 v[116:119], v12 offset:21504
    v_mfma_f32_16x16x32_bf16 v[52:55], v[72:75], v[128:131], v[52:55]
    ds_read_b128 v[120:123], v20 offset:26624
    v_mfma_f32_16x16x32_bf16 v[32:35], v[72:75], v[124:127], v[32:35]
    buffer_load_dwordx2 v[188:189], v18, s[4:7], s32 offen offset:0 sc1
    v_mfma_f32_16x16x32_bf16 v[56:59], v[76:79], v[128:131], v[56:59]
    buffer_load_dwordx2 v[190:191], v18, s[4:7], s32 offen offset:512 sc1
    v_mfma_f32_16x16x32_bf16 v[36:39], v[76:79], v[124:127], v[36:39]
    buffer_load_dwordx2 v[192:193], v19, s[4:7], s32 offen offset:0 sc1
    v_mfma_f32_16x16x32_bf16 v[60:63], v[80:83], v[128:131], v[60:63]
    buffer_load_dwordx2 v[194:195], v19, s[4:7], s32 offen offset:512 sc1
    v_mfma_f32_16x16x32_bf16 v[40:43], v[80:83], v[124:127], v[40:43]
    s_waitcnt vmcnt(16) lgkmcnt(5)
    v_mfma_f32_16x16x32_bf16 v[44:47], v[84:87], v[136:139], v[44:47]
    ds_read_b128 v[64:67], v12 offset:27648
    v_mfma_f32_16x16x32_bf16 v[24:27], v[84:87], v[132:135], v[24:27]
    ds_read_b128 v[68:71], v12 offset:28672
    v_mfma_f32_16x16x32_bf16 v[48:51], v[88:91], v[136:139], v[48:51]
    ds_read_b128 v[72:75], v12 offset:29696
    v_mfma_f32_16x16x32_bf16 v[28:31], v[88:91], v[132:135], v[28:31]
    ds_read_b128 v[76:79], v12 offset:30720
    v_mfma_f32_16x16x32_bf16 v[52:55], v[92:95], v[136:139], v[52:55]
    ds_read_b128 v[80:83], v20 offset:35840
    v_mfma_f32_16x16x32_bf16 v[32:35], v[92:95], v[132:135], v[32:35]
    buffer_load_dwordx2 v[196:197], v18, s[4:7], s32 offen offset:2048 sc1
    v_mfma_f32_16x16x32_bf16 v[56:59], v[96:99], v[136:139], v[56:59]
    buffer_load_dwordx2 v[198:199], v18, s[4:7], s32 offen offset:2560 sc1
    v_mfma_f32_16x16x32_bf16 v[36:39], v[96:99], v[132:135], v[36:39]
    buffer_load_dwordx2 v[200:201], v19, s[4:7], s32 offen offset:2048 sc1
    v_mfma_f32_16x16x32_bf16 v[60:63], v[100:103], v[136:139], v[60:63]
    buffer_load_dwordx2 v[202:203], v19, s[4:7], s32 offen offset:2560 sc1
    v_mfma_f32_16x16x32_bf16 v[40:43], v[100:103], v[132:135], v[40:43]
    s_waitcnt vmcnt(18) lgkmcnt(0)
    s_barrier
    v_mfma_f32_16x16x32_bf16 v[44:47], v[104:107], v[144:147], v[44:47]
    ds_read_b128 v[84:87], v13 offset:0
    v_mfma_f32_16x16x32_bf16 v[24:27], v[104:107], v[140:143], v[24:27]
    ds_read_b128 v[88:91], v13 offset:1024
    v_mfma_f32_16x16x32_bf16 v[48:51], v[108:111], v[144:147], v[48:51]
    ds_read_b128 v[92:95], v13 offset:2048
    v_mfma_f32_16x16x32_bf16 v[28:31], v[108:111], v[140:143], v[28:31]
    ds_read_b128 v[96:99], v13 offset:3072
    v_mfma_f32_16x16x32_bf16 v[52:55], v[112:115], v[144:147], v[52:55]
    ds_read_b128 v[100:103], v21 offset:8192
    v_mfma_f32_16x16x32_bf16 v[32:35], v[112:115], v[140:143], v[32:35]
    buffer_load_dwordx2 v[204:205], v18, s[4:7], s33 offen offset:0 sc1
    v_mfma_f32_16x16x32_bf16 v[56:59], v[116:119], v[144:147], v[56:59]
    buffer_load_dwordx2 v[206:207], v18, s[4:7], s33 offen offset:512 sc1
    v_mfma_f32_16x16x32_bf16 v[36:39], v[116:119], v[140:143], v[36:39]
    buffer_load_dwordx2 v[208:209], v19, s[4:7], s33 offen offset:0 sc1
    v_mfma_f32_16x16x32_bf16 v[60:63], v[120:123], v[144:147], v[60:63]
    buffer_load_dwordx2 v[210:211], v19, s[4:7], s33 offen offset:512 sc1
    v_mfma_f32_16x16x32_bf16 v[40:43], v[120:123], v[140:143], v[40:43]
    s_waitcnt vmcnt(20) lgkmcnt(5)
    v_mfma_f32_16x16x32_bf16 v[44:47], v[64:67], v[152:155], v[44:47]
    ds_read_b128 v[104:107], v13 offset:9216
    v_mfma_f32_16x16x32_bf16 v[24:27], v[64:67], v[148:151], v[24:27]
    ds_read_b128 v[108:111], v13 offset:10240
    v_mfma_f32_16x16x32_bf16 v[48:51], v[68:71], v[152:155], v[48:51]
    ds_read_b128 v[112:115], v13 offset:11264
    v_mfma_f32_16x16x32_bf16 v[28:31], v[68:71], v[148:151], v[28:31]
    ds_read_b128 v[116:119], v13 offset:12288
    v_mfma_f32_16x16x32_bf16 v[52:55], v[72:75], v[152:155], v[52:55]
    ds_read_b128 v[120:123], v21 offset:17408
    v_mfma_f32_16x16x32_bf16 v[32:35], v[72:75], v[148:151], v[32:35]
    buffer_load_dwordx2 v[212:213], v18, s[4:7], s33 offen offset:2048 sc1
    v_mfma_f32_16x16x32_bf16 v[56:59], v[76:79], v[152:155], v[56:59]
    buffer_load_dwordx2 v[214:215], v18, s[4:7], s33 offen offset:2560 sc1
    v_mfma_f32_16x16x32_bf16 v[36:39], v[76:79], v[148:151], v[36:39]
    buffer_load_dwordx2 v[216:217], v19, s[4:7], s33 offen offset:2048 sc1
    v_mfma_f32_16x16x32_bf16 v[60:63], v[80:83], v[152:155], v[60:63]
    buffer_load_dwordx2 v[218:219], v19, s[4:7], s33 offen offset:2560 sc1
    v_mfma_f32_16x16x32_bf16 v[40:43], v[80:83], v[148:151], v[40:43]
    s_waitcnt vmcnt(22) lgkmcnt(5)
    v_mfma_f32_16x16x32_bf16 v[44:47], v[84:87], v[160:163], v[44:47]
    ds_read_b128 v[64:67], v13 offset:18432
    v_mfma_f32_16x16x32_bf16 v[24:27], v[84:87], v[156:159], v[24:27]
    ds_read_b128 v[68:71], v13 offset:19456
    v_mfma_f32_16x16x32_bf16 v[48:51], v[88:91], v[160:163], v[48:51]
    ds_read_b128 v[72:75], v13 offset:20480
    v_mfma_f32_16x16x32_bf16 v[28:31], v[88:91], v[156:159], v[28:31]
    ds_read_b128 v[76:79], v13 offset:21504
    v_mfma_f32_16x16x32_bf16 v[52:55], v[92:95], v[160:163], v[52:55]
    ds_read_b128 v[80:83], v21 offset:26624
    v_mfma_f32_16x16x32_bf16 v[32:35], v[92:95], v[156:159], v[32:35]
    v_mfma_f32_16x16x32_bf16 v[56:59], v[96:99], v[160:163], v[56:59]
    v_mfma_f32_16x16x32_bf16 v[36:39], v[96:99], v[156:159], v[36:39]
    v_mfma_f32_16x16x32_bf16 v[60:63], v[100:103], v[160:163], v[60:63]
    v_mfma_f32_16x16x32_bf16 v[40:43], v[100:103], v[156:159], v[40:43]
    s_waitcnt vmcnt(20) lgkmcnt(5)
    v_mfma_f32_16x16x32_bf16 v[44:47], v[104:107], v[168:171], v[44:47]
    ds_read_b128 v[84:87], v13 offset:27648
    v_mfma_f32_16x16x32_bf16 v[24:27], v[104:107], v[164:167], v[24:27]
    ds_read_b128 v[88:91], v13 offset:28672
    v_mfma_f32_16x16x32_bf16 v[48:51], v[108:111], v[168:171], v[48:51]
    ds_read_b128 v[92:95], v13 offset:29696
    v_mfma_f32_16x16x32_bf16 v[28:31], v[108:111], v[164:167], v[28:31]
    ds_read_b128 v[96:99], v13 offset:30720
    v_mfma_f32_16x16x32_bf16 v[52:55], v[112:115], v[168:171], v[52:55]
    ds_read_b128 v[100:103], v21 offset:35840
    v_mfma_f32_16x16x32_bf16 v[32:35], v[112:115], v[164:167], v[32:35]
    v_mfma_f32_16x16x32_bf16 v[56:59], v[116:119], v[168:171], v[56:59]
    v_mfma_f32_16x16x32_bf16 v[36:39], v[116:119], v[164:167], v[36:39]
    v_mfma_f32_16x16x32_bf16 v[60:63], v[120:123], v[168:171], v[60:63]
    v_mfma_f32_16x16x32_bf16 v[40:43], v[120:123], v[164:167], v[40:43]
    s_waitcnt vmcnt(18) lgkmcnt(0)
    s_barrier
    v_mfma_f32_16x16x32_bf16 v[44:47], v[64:67], v[176:179], v[44:47]
    ds_read_b128 v[104:107], v14 offset:0
    v_mfma_f32_16x16x32_bf16 v[24:27], v[64:67], v[172:175], v[24:27]
    ds_read_b128 v[108:111], v14 offset:1024
    v_mfma_f32_16x16x32_bf16 v[48:51], v[68:71], v[176:179], v[48:51]
    ds_read_b128 v[112:115], v14 offset:2048
    v_mfma_f32_16x16x32_bf16 v[28:31], v[68:71], v[172:175], v[28:31]
    ds_read_b128 v[116:119], v14 offset:3072
    v_mfma_f32_16x16x32_bf16 v[52:55], v[72:75], v[176:179], v[52:55]
    ds_read_b128 v[120:123], v22 offset:8192
    v_mfma_f32_16x16x32_bf16 v[32:35], v[72:75], v[172:175], v[32:35]
    v_mfma_f32_16x16x32_bf16 v[56:59], v[76:79], v[176:179], v[56:59]
    v_mfma_f32_16x16x32_bf16 v[36:39], v[76:79], v[172:175], v[36:39]
    v_mfma_f32_16x16x32_bf16 v[60:63], v[80:83], v[176:179], v[60:63]
    v_mfma_f32_16x16x32_bf16 v[40:43], v[80:83], v[172:175], v[40:43]
    s_waitcnt vmcnt(16) lgkmcnt(5)
    v_mfma_f32_16x16x32_bf16 v[44:47], v[84:87], v[184:187], v[44:47]
    ds_read_b128 v[64:67], v14 offset:9216
    v_mfma_f32_16x16x32_bf16 v[24:27], v[84:87], v[180:183], v[24:27]
    ds_read_b128 v[68:71], v14 offset:10240
    v_mfma_f32_16x16x32_bf16 v[48:51], v[88:91], v[184:187], v[48:51]
    ds_read_b128 v[72:75], v14 offset:11264
    v_mfma_f32_16x16x32_bf16 v[28:31], v[88:91], v[180:183], v[28:31]
    ds_read_b128 v[76:79], v14 offset:12288
    v_mfma_f32_16x16x32_bf16 v[52:55], v[92:95], v[184:187], v[52:55]
    ds_read_b128 v[80:83], v22 offset:17408
    v_mfma_f32_16x16x32_bf16 v[32:35], v[92:95], v[180:183], v[32:35]
    v_mfma_f32_16x16x32_bf16 v[56:59], v[96:99], v[184:187], v[56:59]
    v_mfma_f32_16x16x32_bf16 v[36:39], v[96:99], v[180:183], v[36:39]
    v_mfma_f32_16x16x32_bf16 v[60:63], v[100:103], v[184:187], v[60:63]
    v_mfma_f32_16x16x32_bf16 v[40:43], v[100:103], v[180:183], v[40:43]
    s_waitcnt vmcnt(12) lgkmcnt(5)
    v_mfma_f32_16x16x32_bf16 v[44:47], v[104:107], v[192:195], v[44:47]
    ds_read_b128 v[84:87], v14 offset:18432
    v_mfma_f32_16x16x32_bf16 v[24:27], v[104:107], v[188:191], v[24:27]
    ds_read_b128 v[88:91], v14 offset:19456
    v_mfma_f32_16x16x32_bf16 v[48:51], v[108:111], v[192:195], v[48:51]
    ds_read_b128 v[92:95], v14 offset:20480
    v_mfma_f32_16x16x32_bf16 v[28:31], v[108:111], v[188:191], v[28:31]
    ds_read_b128 v[96:99], v14 offset:21504
    v_mfma_f32_16x16x32_bf16 v[52:55], v[112:115], v[192:195], v[52:55]
    ds_read_b128 v[100:103], v22 offset:26624
    v_mfma_f32_16x16x32_bf16 v[32:35], v[112:115], v[188:191], v[32:35]
    v_mfma_f32_16x16x32_bf16 v[56:59], v[116:119], v[192:195], v[56:59]
    v_mfma_f32_16x16x32_bf16 v[36:39], v[116:119], v[188:191], v[36:39]
    v_mfma_f32_16x16x32_bf16 v[60:63], v[120:123], v[192:195], v[60:63]
    v_mfma_f32_16x16x32_bf16 v[40:43], v[120:123], v[188:191], v[40:43]
    s_waitcnt vmcnt(8) lgkmcnt(5)
    v_mfma_f32_16x16x32_bf16 v[44:47], v[64:67], v[200:203], v[44:47]
    ds_read_b128 v[104:107], v14 offset:27648
    v_mfma_f32_16x16x32_bf16 v[24:27], v[64:67], v[196:199], v[24:27]
    ds_read_b128 v[108:111], v14 offset:28672
    v_mfma_f32_16x16x32_bf16 v[48:51], v[68:71], v[200:203], v[48:51]
    ds_read_b128 v[112:115], v14 offset:29696
    v_mfma_f32_16x16x32_bf16 v[28:31], v[68:71], v[196:199], v[28:31]
    ds_read_b128 v[116:119], v14 offset:30720
    v_mfma_f32_16x16x32_bf16 v[52:55], v[72:75], v[200:203], v[52:55]
    ds_read_b128 v[120:123], v22 offset:35840
    v_mfma_f32_16x16x32_bf16 v[32:35], v[72:75], v[196:199], v[32:35]
    v_mfma_f32_16x16x32_bf16 v[56:59], v[76:79], v[200:203], v[56:59]
    v_mfma_f32_16x16x32_bf16 v[36:39], v[76:79], v[196:199], v[36:39]
    v_mfma_f32_16x16x32_bf16 v[60:63], v[80:83], v[200:203], v[60:63]
    v_mfma_f32_16x16x32_bf16 v[40:43], v[80:83], v[196:199], v[40:43]
    s_waitcnt vmcnt(4) lgkmcnt(5)
    v_mfma_f32_16x16x32_bf16 v[44:47], v[84:87], v[208:211], v[44:47]
    v_mfma_f32_16x16x32_bf16 v[48:51], v[88:91], v[208:211], v[48:51]
    v_mfma_f32_16x16x32_bf16 v[52:55], v[92:95], v[208:211], v[52:55]
    v_mfma_f32_16x16x32_bf16 v[56:59], v[96:99], v[208:211], v[56:59]
    v_mfma_f32_16x16x32_bf16 v[60:63], v[100:103], v[208:211], v[60:63]
    s_waitcnt vmcnt(0) lgkmcnt(0)
    v_mfma_f32_16x16x32_bf16 v[44:47], v[104:107], v[216:219], v[44:47]
    v_mfma_f32_16x16x32_bf16 v[48:51], v[108:111], v[216:219], v[48:51]
    v_mfma_f32_16x16x32_bf16 v[52:55], v[112:115], v[216:219], v[52:55]
    v_mfma_f32_16x16x32_bf16 v[56:59], v[116:119], v[216:219], v[56:59]
    v_mfma_f32_16x16x32_bf16 v[60:63], v[120:123], v[216:219], v[60:63]
    v_mfma_f32_16x16x32_bf16 v[24:27], v[84:87], v[204:207], v[24:27]
    v_mfma_f32_16x16x32_bf16 v[28:31], v[88:91], v[204:207], v[28:31]
    v_mfma_f32_16x16x32_bf16 v[32:35], v[92:95], v[204:207], v[32:35]
    v_mfma_f32_16x16x32_bf16 v[36:39], v[96:99], v[204:207], v[36:39]
    ds_write_b128 v2, v[44:47] offset:0
    v_mfma_f32_16x16x32_bf16 v[40:43], v[100:103], v[204:207], v[40:43]
    ds_write_b128 v2, v[48:51] offset:1024
    v_mfma_f32_16x16x32_bf16 v[24:27], v[104:107], v[212:215], v[24:27]
    v_mfma_f32_16x16x32_bf16 v[28:31], v[108:111], v[212:215], v[28:31]
    ds_write_b128 v2, v[52:55] offset:2048
    v_mfma_f32_16x16x32_bf16 v[32:35], v[112:115], v[212:215], v[32:35]
    ds_write_b128 v2, v[56:59] offset:3072
    v_mfma_f32_16x16x32_bf16 v[36:39], v[116:119], v[212:215], v[36:39]
    v_mfma_f32_16x16x32_bf16 v[40:43], v[120:123], v[212:215], v[40:43]
    s_mov_b64 exec, s[40:41]
    ds_write_b128 v3, v[60:63] offset:4096
    s_mov_b64 exec, -1
    ds_write_b32 v0, v9
    s_mov_b32 s60, 1048576
L_px_p5:
    ds_read_b32 v232, v6
    ds_read_b128 v[64:67], v7 offset:0
    ds_read_b128 v[68:71], v7 offset:1024
    ds_read_b128 v[72:75], v7 offset:2048
    ds_read_b128 v[76:79], v7 offset:3072
    ds_read_b128 v[80:83], v8 offset:4096
    s_waitcnt lgkmcnt(5)
    v_cmp_ne_u32 vcc, s43, v232
    s_sub_u32 s60, s60, 1
    s_cbranch_scc1 L_py_p5
    s_cbranch_vccnz L_px_p5
L_py_p5:
    s_waitcnt lgkmcnt(4)
    v_pk_add_f32 v[24:25], v[24:25], v[64:65]
    v_pk_add_f32 v[26:27], v[26:27], v[66:67]
    v_cvt_pk_bf16_f32 v220, v24, v25
    v_cvt_pk_bf16_f32 v221, v26, v27
    s_waitcnt lgkmcnt(3)
    v_pk_add_f32 v[28:29], v[28:29], v[68:69]
    v_pk_add_f32 v[30:31], v[30:31], v[70:71]
    v_cvt_pk_bf16_f32 v222, v28, v29
    v_cvt_pk_bf16_f32 v223, v30, v31
    s_waitcnt lgkmcnt(2)
    v_pk_add_f32 v[32:33], v[32:33], v[72:73]
    v_pk_add_f32 v[34:35], v[34:35], v[74:75]
    v_cvt_pk_bf16_f32 v224, v32, v33
    v_cvt_pk_bf16_f32 v225, v34, v35
    s_waitcnt lgkmcnt(1)
    v_pk_add_f32 v[36:37], v[36:37], v[76:77]
    v_pk_add_f32 v[38:39], v[38:39], v[78:79]
    v_cvt_pk_bf16_f32 v226, v36, v37
    v_cvt_pk_bf16_f32 v227, v38, v39
    s_waitcnt lgkmcnt(0)
    v_pk_add_f32 v[40:41], v[40:41], v[80:81]
    v_pk_add_f32 v[42:43], v[42:43], v[82:83]
    v_cvt_pk_bf16_f32 v228, v40, v41
    v_cvt_pk_bf16_f32 v229, v42, v43
    s_cmp_eq_u32 s22, 1
    s_cbranch_scc1 L_fin_p5
    buffer_store_dwordx4 v[220:223], v4, s[4:7], s34 offen offset:0 sc1
    buffer_store_dwordx4 v[224:227], v4, s[4:7], s34 offen offset:1024 sc1
    buffer_store_dwordx2 v[228:229], v5, s[4:7], s34 offen sc1
    v_cndmask_b32 v234, 0, v228, s[40:41]
    v_cndmask_b32 v235, 0, v229, s[40:41]
    v_dot2_f32_bf16 v232, v220, v11, 0
    v_dot2_f32_bf16 v233, v220, v220, 0
    v_dot2_f32_bf16 v232, v221, v11, v232
    v_dot2_f32_bf16 v233, v221, v221, v233
    v_dot2_f32_bf16 v232, v222, v11, v232
    v_dot2_f32_bf16 v233, v222, v222, v233
    v_dot2_f32_bf16 v232, v223, v11, v232
    v_dot2_f32_bf16 v233, v223, v223, v233
    v_dot2_f32_bf16 v232, v224, v11, v232
    v_dot2_f32_bf16 v233, v224, v224, v233
    v_dot2_f32_bf16 v232, v225, v11, v232
    v_dot2_f32_bf16 v233, v225, v225, v233
    v_dot2_f32_bf16 v232, v226, v11, v232
    v_dot2_f32_bf16 v233, v226, v226, v233
    v_dot2_f32_bf16 v232, v227, v11, v232
    v_dot2_f32_bf16 v233, v227, v227, v233
    v_dot2_f32_bf16 v232, v234, v11, v232
    v_dot2_f32_bf16 v233, v234, v234, v233
    v_dot2_f32_bf16 v232, v235, v11, v232
    v_dot2_f32_bf16 v233, v235, v235, v233
    s_nop 2
    v_mov_b32 v234, v232
    v_mov_b32 v235, v233
    s_nop 1
    v_permlane32_swap_b32 v232, v234
    v_permlane32_swap_b32 v233, v235
    v_add_f32 v232, v232, v234
    v_add_f32 v233, v233, v235
    v_mov_b32 v234, v232
    v_mov_b32 v235, v233
    s_nop 1
    v_permlane16_swap_b32 v232, v234
    v_permlane16_swap_b32 v233, v235
    v_add_f32 v232, v232, v234
    v_add_f32 v233, v233, v235
    buffer_store_dwordx2 v[232:233], v10, s[4:7], s39 offen sc1
    s_barrier
    s_mov_b32 s22, 1
    s_mov_b32 s21, 0x1c00000
    s_branch L_m_cl
L_fin_p5:
    buffer_store_dwordx4 v[220:223], v4, s[16:19], s34 offen offset:0
    buffer_store_dwordx4 v[224:227], v4, s[16:19], s34 offen offset:64
    buffer_store_dwordx2 v[228:229], v5, s[16:19], s34 offen offset:128
    s_endpgm
L_m_l1:
    s_and_b32 s25, s2, 7
    s_lshr_b32 s26, s2, 3
    s_lshr_b32 s23, s25, 1
    s_lshl_b32 s23, s23, 2
    s_lshr_b32 s27, s26, 3
    s_add_u32 s23, s23, s27
    s_and_b32 s24, s25, 1
    s_lshl_b32 s24, s24, 3
    s_and_b32 s27, s26, 7
    s_add_u32 s24, s24, s27
    s_mul_i32 s29, s24, 129024
    s_lshl_b32 s30, s20, 12
    s_add_u32 s29, s29, s30
    s_add_u32 s29, s29, 0x3800000
    s_lshl_b32 s31, s23, 3
    s_max_u32 s31, s31, 1
    s_sub_u32 s31, s31, 1
    s_mul_i32 s31, s31, 18432
    s_add_u32 s31, s31, 0x0
    s_lshl_b32 s35, s20, 10
    s_and_b32 s36, s35, 1024
    s_barrier
    s_add_u32 m0, s35, 131072
    s_add_u32 s34, s31, s35
    s_add_u32 s34, s34, 0
    buffer_load_dwordx4 v1, s[4:7], s34 offen sc1 lds
    s_add_u32 m0, s30, 0
    s_add_u32 s34, s29, 0
    buffer_load_dwordx4 v1, s[4:7], s34 offen offset:0 sc1 lds
    buffer_load_dwordx4 v1, s[4:7], s34 offen offset:1024 sc1 lds
    buffer_load_dwordx4 v1, s[4:7], s34 offen offset:2048 sc1 lds
    buffer_load_dwordx4 v1, s[4:7], s34 offen offset:3072 sc1 lds
    s_add_u32 m0, s30, 16384
    s_add_u32 s34, s29, 16384
    buffer_load_dwordx4 v1, s[4:7], s34 offen offset:0 sc1 lds
    buffer_load_dwordx4 v1, s[4:7], s34 offen offset:1024 sc1 lds
    buffer_load_dwordx4 v1, s[4:7], s34 offen offset:2048 sc1 lds
    buffer_load_dwordx4 v1, s[4:7], s34 offen offset:3072 sc1 lds
    s_waitcnt vmcnt(4) lgkmcnt(0)
    s_barrier
    s_add_u32 m0, s35, 135168
    s_add_u32 s34, s31, s35
    s_add_u32 s34, s34, 4096
    buffer_load_dwordx4 v1, s[4:7], s34 offen sc1 lds
    s_add_u32 m0, s30, 32768
    s_add_u32 s34, s29, 32768
    buffer_load_dwordx4 v1, s[4:7], s34 offen offset:0 sc1 lds
    buffer_load_dwordx4 v1, s[4:7], s34 offen offset:1024 sc1 lds
    buffer_load_dwordx4 v1, s[4:7], s34 offen offset:2048 sc1 lds
    buffer_load_dwordx4 v1, s[4:7], s34 offen offset:3072 sc1 lds
    s_add_u32 m0, s30, 49152
    s_add_u32 s34, s29, 49152
    buffer_load_dwordx4 v1, s[4:7], s34 offen offset:0 sc1 lds
    buffer_load_dwordx4 v1, s[4:7], s34 offen offset:1024 sc1 lds
    buffer_load_dwordx4 v1, s[4:7], s34 offen offset:2048 sc1 lds
    buffer_load_dwordx4 v1, s[4:7], s34 offen offset:3072 sc1 lds
    s_cmp_lt_u32 s2, 144
    s_cbranch_scc1 L_p0_t1
    s_cmp_ge_u32 s2, 216
    s_cbranch_scc1 L_p0_t2
    ds_read_b64_tr_b16 v[16:17], v4 offset:0
    ds_read_b64_tr_b16 v[18:19], v4 offset:2048
    ds_read_b64_tr_b16 v[20:21], v4 offset:18432
    ds_read_b64_tr_b16 v[22:23], v4 offset:20480
    ds_read_b64_tr_b16 v[24:25], v4 offset:4096
    ds_read_b64_tr_b16 v[26:27], v4 offset:6144
    ds_read_b64_tr_b16 v[28:29], v4 offset:22528
    ds_read_b64_tr_b16 v[30:31], v4 offset:24576
    ds_read_b64_tr_b16 v[32:33], v4 offset:8192
    ds_read_b64_tr_b16 v[34:35], v4 offset:10240
    ds_read_b64_tr_b16 v[36:37], v4 offset:26624
    ds_read_b64_tr_b16 v[38:39], v4 offset:28672
    ds_read_b64_tr_b16 v[40:41], v4 offset:12288
    ds_read_b64_tr_b16 v[42:43], v4 offset:14336
    ds_read_b64_tr_b16 v[44:45], v4 offset:30720
    ds_read_b64_tr_b16 v[46:47], v4 offset:32768
    ds_read_b64_tr_b16 v[48:49], v5 offset:16384
    ds_read_b64_tr_b16 v[50:51], v5 offset:34816
    s_branch L_p0_t2
L_p0_t1:
    ds_read_b64_tr_b16 v[16:17], v4 offset:0
    ds_read_b64_tr_b16 v[18:19], v4 offset:512
    ds_read_b64_tr_b16 v[20:21], v4 offset:4096
    ds_read_b64_tr_b16 v[22:23], v4 offset:4608
    ds_read_b64_tr_b16 v[24:25], v4 offset:9216
    ds_read_b64_tr_b16 v[26:27], v4 offset:9728
    ds_read_b64_tr_b16 v[28:29], v4 offset:13312
    ds_read_b64_tr_b16 v[30:31], v4 offset:13824
    ds_read_b64_tr_b16 v[32:33], v4 offset:18432
    ds_read_b64_tr_b16 v[34:35], v4 offset:18944
    ds_read_b64_tr_b16 v[36:37], v4 offset:22528
    ds_read_b64_tr_b16 v[38:39], v4 offset:23040
    ds_read_b64_tr_b16 v[40:41], v4 offset:27648
    ds_read_b64_tr_b16 v[42:43], v4 offset:28160
    ds_read_b64_tr_b16 v[44:45], v4 offset:31744
    ds_read_b64_tr_b16 v[46:47], v4 offset:32256
    ds_read_b64_tr_b16 v[48:49], v5 offset:8192
    ds_read_b64_tr_b16 v[50:51], v5 offset:8704
L_p0_t2:
    s_waitcnt lgkmcnt(0)
    s_waitcnt vmcnt(9) lgkmcnt(0)
    s_barrier
    s_add_u32 m0, s35, 139264
    s_add_u32 s34, s31, s35
    s_add_u32 s34, s34, 8192
    buffer_load_dwordx4 v1, s[4:7], s34 offen sc1 lds
    v_lshrrev_b32 v2, 8, v1
    v_bfe_u32 v3, v1, 7, 1
    v_bfe_u32 v4, v1, 4, 3
    v_cmp_gt_u32 vcc, 3, v2
    v_mul_u32_u24 v3, 80, v3
    v_lshl_add_u32 v3, v4, 3, v3
    v_lshrrev_b32 v5, 1, v4
    v_and_b32 v4, 1, v4
    v_lshl_add_u32 v4, v4, 3, 64
    v_cndmask_b32 v2, v5, v2, vcc
    v_cndmask_b32 v3, v4, v3, vcc
    v_mul_u32_u24 v2, 2304, v2
    v_add_u32 v0, v2, v3
    v_lshrrev_b32 v8, 1, v1
    s_mul_i32 s34, s24, 144
    s_add_u32 s34, s34, 0x4400000
    buffer_load_dwordx2 v[2:3], v0, s[4:7], s34 offen sc1
    s_mul_i32 s34, s24, 144
    s_add_u32 s34, s34, 0x4402000
    buffer_load_dwordx2 v[4:5], v0, s[4:7], s34 offen sc1
    s_mul_i32 s34, s24, 144
    s_add_u32 s34, s34, 0x4404000
    buffer_load_dwordx2 v[6:7], v0, s[4:7], s34 offen sc1
    s_mul_i32 s34, s24, 144
    s_add_u32 s34, s34, 0x4406000
    buffer_load_dwordx2 v[12:13], v0, s[4:7], s34 offen sc1
    s_add_u32 m0, s30, 65536
    s_add_u32 s34, s29, 65536
    buffer_load_dwordx4 v1, s[4:7], s34 offen offset:0 sc1 lds
    buffer_load_dwordx4 v1, s[4:7], s34 offen offset:1024 sc1 lds
    buffer_load_dwordx4 v1, s[4:7], s34 offen offset:2048 sc1 lds
    buffer_load_dwordx4 v1, s[4:7], s34 offen offset:3072 sc1 lds
    s_waitcnt vmcnt(13) lgkmcnt(0)
    s_barrier
    s_add_u32 m0, s30, 81920
    s_add_u32 s34, s29, 81920
    buffer_load_dwordx4 v1, s[4:7], s34 offen offset:0 sc1 lds
    buffer_load_dwordx4 v1, s[4:7], s34 offen offset:1024 sc1 lds
    buffer_load_dwordx4 v1, s[4:7], s34 offen offset:2048 sc1 lds
    buffer_load_dwordx4 v1, s[4:7], s34 offen offset:3072 sc1 lds
    s_waitcnt vmcnt(13) lgkmcnt(0)
    s_barrier
    s_add_u32 m0, s35, 143360
    s_add_u32 s34, s31, s35
    s_add_u32 s34, s34, 12288
    buffer_load_dwordx4 v1, s[4:7], s34 offen sc1 lds
    s_add_u32 m0, s30, 98304
    s_add_u32 s34, s29, 98304
    buffer_load_dwordx4 v1, s[4:7], s34 offen offset:0 sc1 lds
    buffer_load_dwordx4 v1, s[4:7], s34 offen offset:1024 sc1 lds
    buffer_load_dwordx4 v1, s[4:7], s34 offen offset:2048 sc1 lds
    buffer_load_dwordx4 v1, s[4:7], s34 offen offset:3072 sc1 lds
    s_waitcnt vmcnt(13)
    v_add_f32 v2, v2, v4
    v_add_f32 v3, v3, v5
    v_add_f32 v6, v6, v12
    v_add_f32 v7, v7, v13
    v_add_f32 v2, v2, v6
    v_add_f32 v3, v3, v7
    v_cmp_gt_u32 vcc, 864, v1
    v_add_u32 v8, 161792, v8
    s_nop 0
    v_cndmask_b32 v2, 0, v2, vcc
    v_cndmask_b32 v3, 0, v3, vcc
    ds_write_b64 v8, v[2:3]
    s_waitcnt vmcnt(9) lgkmcnt(0)
    s_barrier
    s_add_u32 m0, s36, 147456
    s_add_u32 s34, s31, s36
    s_add_u32 s34, s34, 16384
    buffer_load_dwordx4 v1, s[4:7], s34 offen sc1 lds
    s_add_u32 m0, s30, 114688
    s_add_u32 s34, s29, 114688
    buffer_load_dwordx4 v1, s[4:7], s34 offen offset:0 sc1 lds
    buffer_load_dwordx4 v1, s[4:7], s34 offen offset:1024 sc1 lds
    buffer_load_dwordx4 v1, s[4:7], s34 offen offset:2048 sc1 lds
    buffer_load_dwordx4 v1, s[4:7], s34 offen offset:3072 sc1 lds
    s_waitcnt vmcnt(10) lgkmcnt(0)
    s_barrier
    buffer_store_dwordx4 v[16:19], v9, s[4:7], s37 offen sc1
    buffer_store_dwordx4 v[20:23], v10, s[4:7], s38 offen sc1
    buffer_store_dwordx4 v[24:27], v9, s[4:7], s39 offen sc1
    buffer_store_dwordx4 v[28:31], v10, s[4:7], s40 offen sc1
    s_waitcnt vmcnt(9) lgkmcnt(0)
    s_barrier
    buffer_store_dwordx4 v[32:35], v9, s[4:7], s41 offen sc1
    buffer_store_dwordx4 v[36:39], v10, s[4:7], s42 offen sc1
    buffer_store_dwordx4 v[40:43], v9, s[4:7], s43 offen sc1
    s_waitcnt vmcnt(7) lgkmcnt(0)
    s_barrier
    s_mov_b32 s46, 0x4502000
    v_mov_b32 v4, 0
    s_mov_b32 s60, 65536
L_poll_wo:
    buffer_load_dword v5, v4, s[4:7], s46 offen sc1
    s_waitcnt vmcnt(0)
    v_cmp_gt_u32 vcc, 18, v5
    s_sub_u32 s60, s60, 1
    s_cbranch_scc1 L_pd_wo
    s_cbranch_vccz L_pd_wo
    s_sleep 4
    s_branch L_poll_wo
L_pd_wo:
    buffer_store_dwordx4 v[44:47], v10, s[4:7], s47 offen sc1
    buffer_store_dwordx4 v[48:51], v14, s[4:7], s48 offen sc1
    v_dot2_f32_bf16 v12, v16, v11, 0
    v_dot2_f32_bf16 v13, v17, v11, 0
    v_dot2_f32_bf16 v12, v18, v11, v12
    v_dot2_f32_bf16 v13, v19, v11, v13
    v_dot2_f32_bf16 v12, v20, v11, v12
    v_dot2_f32_bf16 v13, v21, v11, v13
    v_dot2_f32_bf16 v12, v22, v11, v12
    v_dot2_f32_bf16 v13, v23, v11, v13
    v_dot2_f32_bf16 v12, v24, v11, v12
    v_dot2_f32_bf16 v13, v25, v11, v13
    v_dot2_f32_bf16 v12, v26, v11, v12
    v_dot2_f32_bf16 v13, v27, v11, v13
    v_dot2_f32_bf16 v12, v28, v11, v12
    v_dot2_f32_bf16 v13, v29, v11, v13
    v_dot2_f32_bf16 v12, v30, v11, v12
    v_dot2_f32_bf16 v13, v31, v11, v13
    v_dot2_f32_bf16 v12, v32, v11, v12
    v_dot2_f32_bf16 v13, v33, v11, v13
    v_dot2_f32_bf16 v12, v34, v11, v12
    v_dot2_f32_bf16 v13, v35, v11, v13
    v_dot2_f32_bf16 v12, v36, v11, v12
    v_dot2_f32_bf16 v13, v37, v11, v13
    v_dot2_f32_bf16 v12, v38, v11, v12
    v_dot2_f32_bf16 v13, v39, v11, v13
    v_dot2_f32_bf16 v12, v40, v11, v12
    v_dot2_f32_bf16 v13, v41, v11, v13
    v_dot2_f32_bf16 v12, v42, v11, v12
    v_dot2_f32_bf16 v13, v43, v11, v13
    v_dot2_f32_bf16 v12, v44, v11, v12
    v_dot2_f32_bf16 v13, v45, v11, v13
    v_dot2_f32_bf16 v12, v46, v11, v12
    v_dot2_f32_bf16 v13, v47, v11, v13
    v_dot2_f32_bf16 v12, v48, v11, v12
    v_dot2_f32_bf16 v13, v49, v11, v13
    v_dot2_f32_bf16 v12, v50, v11, v12
    v_dot2_f32_bf16 v13, v51, v11, v13
    s_nop 2
    v_add_f32 v12, v12, v13
    v_mov_b32 v13, v12
    s_nop 1
    v_permlane32_swap_b32 v12, v13
    v_add_f32 v12, v12, v13
    v_mov_b32 v13, v12
    s_nop 1
    v_permlane16_swap_b32 v12, v13
    v_add_f32 v12, v12, v13
    buffer_store_dword v12, v15, s[4:7], s49 offen sc1
    s_barrier
L_m_ll:
    s_and_b32 s25, s2, 7
    s_lshr_b32 s26, s2, 3
    s_lshr_b32 s23, s25, 1
    s_lshl_b32 s23, s23, 3
    s_lshr_b32 s27, s26, 2
    s_add_u32 s23, s23, s27
    s_and_b32 s24, s25, 1
    s_lshl_b32 s24, s24, 2
    s_and_b32 s27, s26, 3
    s_add_u32 s24, s24, s27
    s_add_u32 s25, s23, s24
    s_and_b32 s25, s25, 3
    s_mul_i32 s29, s24, 82944
    s_add_u32 s29, s29, 0x3a00000
    s_mul_i32 s30, s20, 36864
    s_mul_i32 s31, s20, 18432
    s_add_u32 s31, s31, s29
    s_add_u32 m0, s30, 18432
    s_add_u32 s33, s31, 0
    buffer_load_dwordx4 v1, s[4:7], s33 offen offset:0  sc1 lds
    buffer_load_dwordx4 v1, s[4:7], s33 offen offset:1024  sc1 lds
    buffer_load_dwordx4 v1, s[4:7], s33 offen offset:2048  sc1 lds
    buffer_load_dwordx4 v1, s[4:7], s33 offen offset:3072  sc1 lds
    s_add_u32 m0, s30, 22528
    s_add_u32 s33, s31, 4096
    buffer_load_dwordx4 v1, s[4:7], s33 offen offset:0  sc1 lds
    buffer_load_dwordx4 v1, s[4:7], s33 offen offset:1024  sc1 lds
    buffer_load_dwordx4 v1, s[4:7], s33 offen offset:2048  sc1 lds
    buffer_load_dwordx4 v1, s[4:7], s33 offen offset:3072  sc1 lds
    s_add_u32 m0, s30, 26624
    s_add_u32 s33, s31, 8192
    buffer_load_dwordx4 v1, s[4:7], s33 offen offset:0  sc1 lds
    buffer_load_dwordx4 v1, s[4:7], s33 offen offset:1024  sc1 lds
    buffer_load_dwordx4 v1, s[4:7], s33 offen offset:2048  sc1 lds
    buffer_load_dwordx4 v1, s[4:7], s33 offen offset:3072  sc1 lds
    s_add_u32 m0, s30, 30720
    s_add_u32 s33, s31, 12288
    buffer_load_dwordx4 v1, s[4:7], s33 offen offset:0  sc1 lds
    buffer_load_dwordx4 v1, s[4:7], s33 offen offset:1024  sc1 lds
    buffer_load_dwordx4 v1, s[4:7], s33 offen offset:2048  sc1 lds
    buffer_load_dwordx4 v1, s[4:7], s33 offen offset:3072  sc1 lds
    s_add_u32 m0, s30, 34816
    s_add_u32 s33, s31, 16384
    buffer_load_dwordx4 v1, s[4:7], s33 offen offset:0  sc1 lds
    buffer_load_dwordx4 v1, s[4:7], s33 offen offset:1024  sc1 lds
    s_mul_i32 s30, s20, 3072
    s_add_u32 s31, s30, s29
    s_waitcnt vmcnt(18)
    s_barrier
    s_add_u32 m0, s30, 147456
    s_add_u32 s33, s31, 73728
    buffer_load_dwordx4 v1, s[4:7], s33 offen offset:0  sc1 lds
    buffer_load_dwordx4 v1, s[4:7], s33 offen offset:1024  sc1 lds
    buffer_load_dwordx4 v1, s[4:7], s33 offen offset:2048  sc1 lds
    s_or_b32 s44, s20, s22
    s_cbranch_scc1 L_p2_ns
    s_and_b32 s44, s2, 15
    s_lshl_b32 s44, s44, 8
    s_add_u32 s44, s44, 0x4501000
    s_add_u32 s44, s44, s4
    s_addc_u32 s45, s5, 0
    s_mov_b32 s56, 1
    s_atomic_add s56, s[44:45], 0
L_p2_ns:
    s_waitcnt vmcnt(0)
    s_barrier
    s_and_b32 s25, s2, 7
    s_lshr_b32 s26, s2, 3
    s_and_b32 s23, s25, 1
    s_lshl_b32 s23, s23, 3
    s_and_b32 s27, s26, 7
    s_add_u32 s23, s23, s27
    s_lshr_b32 s24, s25, 1
    s_lshl_b32 s24, s24, 2
    s_lshr_b32 s27, s26, 3
    s_add_u32 s24, s24, s27
    s_add_u32 s28, s23, s24
    s_and_b32 s28, s28, 3
    s_lshl_b32 s30, s20, 12
    s_lshr_b32 s33, s20, 1
    s_mul_i32 s31, s33, 36864
    s_and_b32 s33, s20, 1
    s_lshl_b32 s33, s33, 10
    s_add_u32 s33, s33, 16384
    s_add_u32 s31, s31, s33
    s_sub_u32 s49, s33, s30
    s_mul_i32 s34, s24, 331776
    s_add_u32 s34, s34, s30
    s_add_u32 s34, s34, 0x3b00000
    s_lshl_b32 s35, s23, 3
    s_lshl_b32 s33, s20, 1
    s_add_u32 s35, s35, s33
    s_mul_i32 s35, s35, 18432
    s_add_u32 s35, s35, s21
    s_add_u32 s35, s35, 0x300000
    s_mul_i32 s36, s24, 589824
    s_add_u32 s36, s36, s30
    s_add_u32 s36, s36, s21
    s_add_u32 s36, s36, 0x900000
    v_add_u32 v2, 16384, v1
    s_add_u32 s33, s30, 18432
    v_add_u32 v6, s33, v1
    v_add_u32 v7, 73728, v6
    s_lshl_b32 s29, s23, 2
    s_add_u32 s29, s29, s20
    s_lshl_b32 s29, s29, 12
    s_add_u32 s29, s29, s21
    s_add_u32 s29, s29, 0x1b40000
    v_and_b32 v3, 48, v1
    v_lshrrev_b32 v8, 8, v1
    v_lshl_add_u32 v3, v8, 6, v3
    v_bfe_u32 v8, v1, 6, 2
    v_lshl_add_u32 v3, v8, 8, v3
    s_lshl_b32 s33, s23, 7
    s_lshl_b32 s37, s20, 5
    s_add_u32 s33, s33, s37
    v_lshrrev_b32 v8, 7, v1
    v_add_u32 v8, s33, v8
    v_lshlrev_b32 v8, 12, v8
    v_lshrrev_b32 v9, 8, v1
    v_bfe_u32 v10, v1, 4, 3
    v_xor_b32 v9, v9, v10
    v_lshl_add_u32 v8, v9, 4, v8
    v_xor_b32 v9, 64, v8
    v_add_u32 v9, 31744, v9
    v_add_u32 v10, 63488, v8
    v_add_u32 v11, 63488, v9
    s_cmp_eq_u32 s28, 0
    s_cselect_b32 s44, 4, 0
    s_cmp_eq_u32 s28, 1
    s_cselect_b32 s45, 5, 1
    s_cmp_eq_u32 s28, 2
    s_cselect_b32 s46, 6, 2
    s_cmp_eq_u32 s28, 3
    s_cselect_b32 s47, 7, 3
    s_lshl_b32 s33, s20, 4
    s_add_u32 s33, s33, s24
    s_lshl_b32 s54, s22, 7
    s_add_u32 s54, s54, s33
    s_lshl_b32 s54, s54, 8
    s_add_u32 s54, s54, 0x450c000
    s_add_u32 s54, s54, s4
    s_addc_u32 s55, s5, 0
    s_mov_b32 s33, 0x4501000
    v_and_b32 v4, 0xf0, v1
    v_lshlrev_b32 v4, 4, v4
    s_mov_b32 s60, 65536
L_poll_wr:
    buffer_load_dword v5, v4, s[4:7], s33 offen sc1
    s_waitcnt vmcnt(0)
    v_cmp_gt_u32 vcc, 16, v5
    s_sub_u32 s60, s60, 1
    s_cbranch_scc1 L_pd_wr
    s_cbranch_vccz L_pd_wr
    s_sleep 4
    s_branch L_poll_wr
L_pd_wr:
    s_min_u32 s33, s20, 2
    s_lshl_b32 s33, s33, 9
    v_lshrrev_b32 v4, 1, v1
    v_add_u32 v4, s33, v4
    s_lshl_b32 s51, s24, 12
    s_add_u32 s51, s51, 0x4410000
    buffer_load_dwordx2 v[16:17], v4, s[4:7], s51 offen offset:0 sc1
    buffer_load_dwordx2 v[18:19], v4, s[4:7], s51 offen offset:1152 sc1
    s_mov_b32 s48, 0
    s_mul_i32 s50, s48, 18432
    s_add_u32 s50, s50, s34
    s_add_u32 m0, s30, 0
    s_mov_b32 s53, s50
    buffer_load_dwordx4 v1, s[4:7], s50 offen offset:0  sc1 lds
    buffer_load_dwordx4 v1, s[4:7], s50 offen offset:1024  sc1 lds
    buffer_load_dwordx4 v1, s[4:7], s50 offen offset:2048  sc1 lds
    buffer_load_dwordx4 v1, s[4:7], s50 offen offset:3072  sc1 lds
    s_mov_b32 s48, 1
    s_mul_i32 s50, s48, 18432
    s_add_u32 s50, s50, s34
    s_cmp_ge_u32 s20, 2
    s_cselect_b32 s52, s50, s53
    s_add_u32 m0, s31, 0
    s_add_u32 s52, s52, s49
    buffer_load_dwordx4 v1, s[4:7], s52 offen  sc1 lds
    s_add_u32 m0, s30, 36864
    s_mov_b32 s53, s50
    buffer_load_dwordx4 v1, s[4:7], s50 offen offset:0  sc1 lds
    buffer_load_dwordx4 v1, s[4:7], s50 offen offset:1024  sc1 lds
    buffer_load_dwordx4 v1, s[4:7], s50 offen offset:2048  sc1 lds
    buffer_load_dwordx4 v1, s[4:7], s50 offen offset:3072  sc1 lds
    s_mov_b32 m0, 161280
    v_lshrrev_b32 v5, 2, v1
    s_lshl_b32 s33, s23, 8
    buffer_load_dword v5, s[12:15], s33 offen lds
    s_waitcnt vmcnt(10)
    v_add_u32 v4, 159744, v4
    v_add_f32 v16, v16, v18
    v_add_f32 v17, v17, v19
    ds_write_b64 v4, v[16:17]
    s_waitcnt lgkmcnt(0)
    s_barrier
    s_mov_b32 s48, 2
    s_mul_i32 s50, s48, 18432
    s_add_u32 s50, s50, s34
    s_add_u32 m0, s30, 73728
    s_mov_b32 s53, s50
    buffer_load_dwordx4 v1, s[4:7], s50 offen offset:0  sc1 lds
    buffer_load_dwordx4 v1, s[4:7], s50 offen offset:1024  sc1 lds
    buffer_load_dwordx4 v1, s[4:7], s50 offen offset:2048  sc1 lds
    buffer_load_dwordx4 v1, s[4:7], s50 offen offset:3072  sc1 lds
    s_mov_b32 s48, 3
    s_mul_i32 s50, s48, 18432
    s_add_u32 s50, s50, s34
    s_cmp_ge_u32 s20, 2
    s_cselect_b32 s52, s50, s53
    s_add_u32 m0, s31, 73728
    s_add_u32 s52, s52, s49
    buffer_load_dwordx4 v1, s[4:7], s52 offen  sc1 lds
    s_add_u32 m0, s30, 110592
    s_mov_b32 s53, s50
    buffer_load_dwordx4 v1, s[4:7], s50 offen offset:0  sc1 lds
    buffer_load_dwordx4 v1, s[4:7], s50 offen offset:1024  sc1 lds
    buffer_load_dwordx4 v1, s[4:7], s50 offen offset:2048  sc1 lds
    buffer_load_dwordx4 v1, s[4:7], s50 offen offset:3072  sc1 lds
    s_barrier
    s_add_u32 m0, s30, 18432
    s_add_u32 s51, s35, 0
    buffer_load_dwordx4 v1, s[4:7], s51 offen offset:0 sc1 lds
    buffer_load_dwordx4 v1, s[4:7], s51 offen offset:1024 sc1 lds
    buffer_load_dwordx4 v2, s[4:7], s51 offen offset:2048 sc1 lds
    buffer_load_dwordx4 v2, s[4:7], s51 offen offset:3072 sc1 lds
    s_add_u32 m0, s30, 55296
    s_add_u32 s51, s35, 2048
    buffer_load_dwordx4 v1, s[4:7], s51 offen offset:0 sc1 lds
    buffer_load_dwordx4 v1, s[4:7], s51 offen offset:1024 sc1 lds
    buffer_load_dwordx4 v2, s[4:7], s51 offen offset:2048 sc1 lds
    buffer_load_dwordx4 v2, s[4:7], s51 offen offset:3072 sc1 lds
    s_add_u32 m0, s30, 92160
    s_add_u32 s51, s35, 4096
    buffer_load_dwordx4 v1, s[4:7], s51 offen offset:0 sc1 lds
    buffer_load_dwordx4 v1, s[4:7], s51 offen offset:1024 sc1 lds
    buffer_load_dwordx4 v2, s[4:7], s51 offen offset:2048 sc1 lds
    buffer_load_dwordx4 v2, s[4:7], s51 offen offset:3072 sc1 lds
    s_waitcnt vmcnt(8)
    s_barrier
    s_add_u32 m0, s30, 129024
    s_add_u32 s51, s35, 6144
    buffer_load_dwordx4 v1, s[4:7], s51 offen offset:0 sc1 lds
    buffer_load_dwordx4 v1, s[4:7], s51 offen offset:1024 sc1 lds
    buffer_load_dwordx4 v2, s[4:7], s51 offen offset:2048 sc1 lds
    buffer_load_dwordx4 v2, s[4:7], s51 offen offset:3072 sc1 lds
    s_and_b32 s40, s2, 7
    s_lshr_b32 s26, s2, 3
    s_lshr_b32 s38, s40, 1
    s_lshl_b32 s38, s38, 3
    s_lshr_b32 s27, s26, 2
    s_add_u32 s38, s38, s27
    s_and_b32 s39, s40, 1
    s_lshl_b32 s39, s39, 2
    s_and_b32 s27, s26, 3
    s_add_u32 s39, s39, s27
    s_add_u32 s40, s38, s39
    s_and_b32 s40, s40, 3
    s_mul_i32 s42, s20, 9216
    s_mul_i32 s43, s39, 331776
    s_add_u32 s43, s43, s42
    s_add_u32 s43, s43, 0x4100000
    s_waitcnt vmcnt(8) lgkmcnt(0)
    s_barrier
    s_mov_b32 s48, 4
    s_mul_i32 s50, s48, 18432
    s_add_u32 s50, s50, s34
    s_add_u32 m0, s30, 0
    s_mov_b32 s53, s50
    buffer_load_dwordx4 v1, s[4:7], s50 offen offset:0  sc1 lds
    buffer_load_dwordx4 v1, s[4:7], s50 offen offset:1024  sc1 lds
    buffer_load_dwordx4 v1, s[4:7], s50 offen offset:2048  sc1 lds
    buffer_load_dwordx4 v1, s[4:7], s50 offen offset:3072  sc1 lds
    s_add_u32 m0, s30, 18432
    s_add_u32 s51, s35, 8192
    buffer_load_dwordx4 v1, s[4:7], s51 offen offset:0 sc1 lds
    buffer_load_dwordx4 v1, s[4:7], s51 offen offset:1024 sc1 lds
    buffer_load_dwordx4 v2, s[4:7], s51 offen offset:2048 sc1 lds
    buffer_load_dwordx4 v2, s[4:7], s51 offen offset:3072 sc1 lds
    s_waitcnt vmcnt(12) lgkmcnt(0)
    s_barrier
    s_mov_b32 s48, 5
    s_mul_i32 s50, s48, 18432
    s_add_u32 s50, s50, s34
    s_cmp_ge_u32 s20, 2
    s_cselect_b32 s52, s50, s53
    s_add_u32 m0, s31, 0
    s_add_u32 s52, s52, s49
    buffer_load_dwordx4 v1, s[4:7], s52 offen  sc1 lds
    s_add_u32 m0, s30, 36864
    s_mov_b32 s53, s50
    buffer_load_dwordx4 v1, s[4:7], s50 offen offset:0  sc1 lds
    buffer_load_dwordx4 v1, s[4:7], s50 offen offset:1024  sc1 lds
    buffer_load_dwordx4 v1, s[4:7], s50 offen offset:2048  sc1 lds
    buffer_load_dwordx4 v1, s[4:7], s50 offen offset:3072  sc1 lds
    s_add_u32 m0, s30, 55296
    s_add_u32 s51, s35, 10240
    buffer_load_dwordx4 v1, s[4:7], s51 offen offset:0 sc1 lds
    buffer_load_dwordx4 v1, s[4:7], s51 offen offset:1024 sc1 lds
    buffer_load_dwordx4 v2, s[4:7], s51 offen offset:2048 sc1 lds
    buffer_load_dwordx4 v2, s[4:7], s51 offen offset:3072 sc1 lds
    s_waitcnt vmcnt(17) lgkmcnt(0)
    s_barrier
    s_mov_b32 s48, 6
    s_mul_i32 s50, s48, 18432
    s_add_u32 s50, s50, s34
    s_add_u32 m0, s30, 73728
    s_mov_b32 s53, s50
    buffer_load_dwordx4 v1, s[4:7], s50 offen offset:0  sc1 lds
    buffer_load_dwordx4 v1, s[4:7], s50 offen offset:1024  sc1 lds
    buffer_load_dwordx4 v1, s[4:7], s50 offen offset:2048  sc1 lds
    buffer_load_dwordx4 v1, s[4:7], s50 offen offset:3072  sc1 lds
    s_add_u32 m0, s30, 92160
    s_add_u32 s51, s35, 12288
    buffer_load_dwordx4 v1, s[4:7], s51 offen offset:0 sc1 lds
    buffer_load_dwordx4 v1, s[4:7], s51 offen offset:1024 sc1 lds
    buffer_load_dwordx4 v2, s[4:7], s51 offen offset:2048 sc1 lds
    buffer_load_dwordx4 v2, s[4:7], s51 offen offset:3072 sc1 lds
    s_waitcnt vmcnt(16) lgkmcnt(0)
    s_barrier
    s_mov_b32 s48, 7
    s_mul_i32 s50, s48, 18432
    s_add_u32 s50, s50, s34
    s_cmp_ge_u32 s20, 2
    s_cselect_b32 s52, s50, s53
    s_add_u32 m0, s31, 73728
    s_add_u32 s52, s52, s49
    buffer_load_dwordx4 v1, s[4:7], s52 offen  sc1 lds
    s_add_u32 m0, s30, 110592
    s_mov_b32 s53, s50
    buffer_load_dwordx4 v1, s[4:7], s50 offen offset:0  sc1 lds
    buffer_load_dwordx4 v1, s[4:7], s50 offen offset:1024  sc1 lds
    buffer_load_dwordx4 v1, s[4:7], s50 offen offset:2048  sc1 lds
    buffer_load_dwordx4 v1, s[4:7], s50 offen offset:3072  sc1 lds
    s_add_u32 m0, s30, 129024
    s_add_u32 s51, s35, 14336
    buffer_load_dwordx4 v1, s[4:7], s51 offen offset:0 sc1 lds
    buffer_load_dwordx4 v1, s[4:7], s51 offen offset:1024 sc1 lds
    buffer_load_dwordx4 v2, s[4:7], s51 offen offset:2048 sc1 lds
    buffer_load_dwordx4 v2, s[4:7], s51 offen offset:3072 sc1 lds
    s_waitcnt vmcnt(17) lgkmcnt(0)
    s_barrier
    s_mov_b32 s48, 8
    s_mul_i32 s50, s48, 18432
    s_add_u32 s50, s50, s34
    s_add_u32 m0, s30, 0
    s_mov_b32 s53, s50
    buffer_load_dwordx4 v1, s[4:7], s50 offen offset:0  sc1 lds
    buffer_load_dwordx4 v1, s[4:7], s50 offen offset:1024  sc1 lds
    buffer_load_dwordx4 v1, s[4:7], s50 offen offset:2048  sc1 lds
    buffer_load_dwordx4 v1, s[4:7], s50 offen offset:3072  sc1 lds
    s_add_u32 m0, s30, 18432
    s_add_u32 s51, s35, 16384
    buffer_load_dwordx4 v1, s[4:7], s51 offen offset:0 sc1 lds
    buffer_load_dwordx4 v1, s[4:7], s51 offen offset:1024 sc1 lds
    buffer_load_dwordx4 v2, s[4:7], s51 offen offset:2048 sc1 lds
    buffer_load_dwordx4 v2, s[4:7], s51 offen offset:3072 sc1 lds
    s_waitcnt vmcnt(16) lgkmcnt(0)
    s_barrier
    s_mov_b32 s48, 5
    s_mul_i32 s50, s48, 18432
    s_add_u32 s50, s50, s34
    s_add_u32 s50, s50, 165888
    s_cmp_ge_u32 s20, 2
    s_cselect_b32 s52, s50, s53
    s_add_u32 m0, s31, 0
    s_add_u32 s52, s52, s49
    buffer_load_dwordx4 v1, s[4:7], s52 offen  sc1 lds
    s_add_u32 m0, s30, 36864
    s_mov_b32 s53, s50
    buffer_load_dwordx4 v1, s[4:7], s50 offen offset:0  sc1 lds
    buffer_load_dwordx4 v1, s[4:7], s50 offen offset:1024  sc1 lds
    buffer_load_dwordx4 v1, s[4:7], s50 offen offset:2048  sc1 lds
    buffer_load_dwordx4 v1, s[4:7], s50 offen offset:3072  sc1 lds
    s_cmp_lg_u32 s22, 0
    s_cbranch_scc1 L_p5_k6
    s_add_u32 s32, s43, 294912
    buffer_load_dwordx4 v[220:223], v1, s[4:7], s32 offen offset:0 sc1
    buffer_load_dwordx4 v[224:227], v1, s[4:7], s32 offen offset:1024 sc1
    buffer_load_dwordx4 v[228:231], v1, s[4:7], s32 offen offset:2048 sc1
    buffer_load_dwordx4 v[232:235], v1, s[4:7], s32 offen offset:3072 sc1
    s_add_u32 s32, s43, 299008
    buffer_load_dwordx4 v[236:239], v1, s[4:7], s32 offen offset:0 sc1
L_p5_k6:
    s_waitcnt vmcnt(18) lgkmcnt(0)
    s_cmp_eq_u32 s22, 0
    s_cbranch_scc1 L_wv_909
    s_waitcnt vmcnt(13)
L_wv_909:
    s_barrier
    s_mov_b32 s48, 6
    s_mul_i32 s50, s48, 18432
    s_add_u32 s50, s50, s34
    s_add_u32 s50, s50, 165888
    s_add_u32 m0, s30, 73728
    s_mov_b32 s53, s50
    buffer_load_dwordx4 v1, s[4:7], s50 offen offset:0  sc1 lds
    buffer_load_dwordx4 v1, s[4:7], s50 offen offset:1024  sc1 lds
    buffer_load_dwordx4 v1, s[4:7], s50 offen offset:2048  sc1 lds
    buffer_load_dwordx4 v1, s[4:7], s50 offen offset:3072  sc1 lds
    s_cmp_lg_u32 s22, 0
    s_cbranch_scc1 L_p5_k7
    s_add_u32 s32, s43, 299008
    buffer_load_dwordx4 v[240:243], v1, s[4:7], s32 offen offset:1024 sc1
    buffer_load_dwordx4 v[244:247], v1, s[4:7], s32 offen offset:2048 sc1
    buffer_load_dwordx4 v[248:251], v1, s[4:7], s32 offen offset:3072 sc1
    s_add_u32 s32, s43, 303104
    buffer_load_dwordx4 v[252:255], v1, s[4:7], s32 offen offset:0 sc1
    s_add_u32 s32, s43, 258048
    buffer_load_dwordx4 v[184:187], v1, s[4:7], s32 offen offset:0 sc1
L_p5_k7:
    s_waitcnt vmcnt(18) lgkmcnt(0)
    s_cmp_eq_u32 s22, 0
    s_cbranch_scc1 L_wv_936
    s_waitcnt vmcnt(8)
L_wv_936:
    s_barrier
    s_mov_b32 s48, 7
    s_mul_i32 s50, s48, 18432
    s_add_u32 s50, s50, s34
    s_add_u32 s50, s50, 165888
    s_cmp_ge_u32 s20, 2
    s_cselect_b32 s52, s50, s53
    s_add_u32 m0, s31, 73728
    s_add_u32 s52, s52, s49
    buffer_load_dwordx4 v1, s[4:7], s52 offen  sc1 lds
    s_add_u32 m0, s30, 110592
    s_mov_b32 s53, s50
    buffer_load_dwordx4 v1, s[4:7], s50 offen offset:0  sc1 lds
    buffer_load_dwordx4 v1, s[4:7], s50 offen offset:1024  sc1 lds
    buffer_load_dwordx4 v1, s[4:7], s50 offen offset:2048  sc1 lds
    buffer_load_dwordx4 v1, s[4:7], s50 offen offset:3072  sc1 lds
    s_cmp_lg_u32 s22, 0
    s_cbranch_scc1 L_p5_k8
    s_add_u32 s32, s43, 258048
    buffer_load_dwordx4 v[188:191], v1, s[4:7], s32 offen offset:1024 sc1
    buffer_load_dwordx4 v[192:195], v1, s[4:7], s32 offen offset:2048 sc1
    buffer_load_dwordx4 v[196:199], v1, s[4:7], s32 offen offset:3072 sc1
    s_add_u32 s32, s43, 262144
    buffer_load_dwordx4 v[200:203], v1, s[4:7], s32 offen offset:0 sc1
    buffer_load_dwordx4 v[204:207], v1, s[4:7], s32 offen offset:1024 sc1
L_p5_k8:
    s_waitcnt vmcnt(24) lgkmcnt(0)
    s_cmp_eq_u32 s22, 0
    s_cbranch_scc1 L_wv_967
    s_waitcnt vmcnt(9)
L_wv_967:
    s_barrier
    s_mov_b32 s48, 8
    s_mul_i32 s50, s48, 18432
    s_add_u32 s50, s50, s34
    s_add_u32 s50, s50, 165888
    s_add_u32 m0, s30, 0
    s_mov_b32 s53, s50
    buffer_load_dwordx4 v1, s[4:7], s50 offen offset:0  sc1 lds
    buffer_load_dwordx4 v1, s[4:7], s50 offen offset:1024  sc1 lds
    buffer_load_dwordx4 v1, s[4:7], s50 offen offset:2048  sc1 lds
    buffer_load_dwordx4 v1, s[4:7], s50 offen offset:3072  sc1 lds
    s_cmp_lg_u32 s22, 0
    s_cbranch_scc1 L_p5_k9
    s_add_u32 s32, s43, 262144
    buffer_load_dwordx4 v[208:211], v1, s[4:7], s32 offen offset:2048 sc1
    buffer_load_dwordx4 v[212:215], v1, s[4:7], s32 offen offset:3072 sc1
    s_add_u32 s32, s43, 266240
    buffer_load_dwordx4 v[216:219], v1, s[4:7], s32 offen offset:0 sc1
    s_add_u32 s32, s43, 221184
    buffer_load_dwordx4 v[148:151], v1, s[4:7], s32 offen offset:0 sc1
    buffer_load_dwordx4 v[152:155], v1, s[4:7], s32 offen offset:1024 sc1
    buffer_load_dwordx4 v[156:159], v1, s[4:7], s32 offen offset:2048 sc1
    buffer_load_dwordx4 v[160:163], v1, s[4:7], s32 offen offset:3072 sc1
    s_add_u32 s32, s43, 225280
    buffer_load_dwordx4 v[164:167], v1, s[4:7], s32 offen offset:0 sc1
    buffer_load_dwordx4 v[168:171], v1, s[4:7], s32 offen offset:1024 sc1
    buffer_load_dwordx4 v[172:175], v1, s[4:7], s32 offen offset:2048 sc1
    buffer_load_dwordx4 v[176:179], v1, s[4:7], s32 offen offset:3072 sc1
    s_add_u32 s32, s43, 229376
    buffer_load_dwordx4 v[180:183], v1, s[4:7], s32 offen offset:0 sc1
    s_add_u32 s32, s43, 184320
    buffer_load_dwordx4 v[112:115], v1, s[4:7], s32 offen offset:0 sc1
    buffer_load_dwordx4 v[116:119], v1, s[4:7], s32 offen offset:1024 sc1
    buffer_load_dwordx4 v[120:123], v1, s[4:7], s32 offen offset:2048 sc1
    buffer_load_dwordx4 v[124:127], v1, s[4:7], s32 offen offset:3072 sc1
    s_add_u32 s32, s43, 188416
    buffer_load_dwordx4 v[128:131], v1, s[4:7], s32 offen offset:0 sc1
    buffer_load_dwordx4 v[132:135], v1, s[4:7], s32 offen offset:1024 sc1
    buffer_load_dwordx4 v[136:139], v1, s[4:7], s32 offen offset:2048 sc1
    buffer_load_dwordx4 v[140:143], v1, s[4:7], s32 offen offset:3072 sc1
    s_add_u32 s32, s43, 192512
    buffer_load_dwordx4 v[144:147], v1, s[4:7], s32 offen offset:0 sc1
    s_add_u32 s32, s43, 147456
    buffer_load_dwordx4 v[76:79], v1, s[4:7], s32 offen offset:0 sc1
    buffer_load_dwordx4 v[80:83], v1, s[4:7], s32 offen offset:1024 sc1
    buffer_load_dwordx4 v[84:87], v1, s[4:7], s32 offen offset:2048 sc1
    buffer_load_dwordx4 v[88:91], v1, s[4:7], s32 offen offset:3072 sc1
    s_add_u32 s32, s43, 151552
    buffer_load_dwordx4 v[92:95], v1, s[4:7], s32 offen offset:0 sc1
    buffer_load_dwordx4 v[96:99], v1, s[4:7], s32 offen offset:1024 sc1
    buffer_load_dwordx4 v[100:103], v1, s[4:7], s32 offen offset:2048 sc1
    buffer_load_dwordx4 v[104:107], v1, s[4:7], s32 offen offset:3072 sc1
    s_add_u32 s32, s43, 155648
    buffer_load_dwordx4 v[108:111], v1, s[4:7], s32 offen offset:0 sc1
L_p5_k9:
    s_waitcnt vmcnt(43) lgkmcnt(0)
    s_cmp_eq_u32 s22, 0
    s_cbranch_scc1 L_wv_1027
    s_waitcnt vmcnt(8)
L_wv_1027:
    s_barrier
    s_mov_b32 s48, 0
    s_mul_i32 s50, s48, 18432
    s_add_u32 s50, s50, s34
    s_add_u32 s50, s50, 165888
    s_cmp_ge_u32 s20, 2
    s_cselect_b32 s52, s50, s53
    s_add_u32 m0, s31, 0
    s_add_u32 s52, s52, s49
    buffer_load_dwordx4 v1, s[4:7], s52 offen  sc1 lds
    s_add_u32 m0, s30, 36864
    s_mov_b32 s53, s50
    buffer_load_dwordx4 v1, s[4:7], s50 offen offset:0  sc1 lds
    buffer_load_dwordx4 v1, s[4:7], s50 offen offset:1024  sc1 lds
    buffer_load_dwordx4 v1, s[4:7], s50 offen offset:2048  sc1 lds
    buffer_load_dwordx4 v1, s[4:7], s50 offen offset:3072  sc1 lds
    s_add_u32 m0, s30, 55296
    s_add_u32 s51, s35, 0
    buffer_load_dwordx4 v1, s[4:7], s51 offen offset:0 sc1 lds
    buffer_load_dwordx4 v1, s[4:7], s51 offen offset:1024 sc1 lds
    buffer_load_dwordx4 v2, s[4:7], s51 offen offset:2048 sc1 lds
    buffer_load_dwordx4 v2, s[4:7], s51 offen offset:3072 sc1 lds
    s_waitcnt vmcnt(48) lgkmcnt(0)
    s_cmp_eq_u32 s22, 0
    s_cbranch_scc1 L_wv_1054
    s_waitcnt vmcnt(13)
L_wv_1054:
    s_barrier
    buffer_load_dwordx4 v[16:19], v3, s[4:7], s29 offen offset:0 sc1
    buffer_load_dwordx4 v[20:23], v3, s[4:7], s29 offen offset:1024 sc1
    buffer_load_dwordx4 v[24:27], v3, s[4:7], s29 offen offset:2048 sc1
    buffer_load_dwordx4 v[28:31], v3, s[4:7], s29 offen offset:3072 sc1
    s_mov_b32 s48, 1
    s_mul_i32 s50, s48, 18432
    s_add_u32 s50, s50, s34
    s_add_u32 s50, s50, 165888
    s_add_u32 m0, s30, 73728
    s_mov_b32 s53, s50
    buffer_load_dwordx4 v1, s[4:7], s50 offen offset:0  sc1 lds
    buffer_load_dwordx4 v1, s[4:7], s50 offen offset:1024  sc1 lds
    buffer_load_dwordx4 v1, s[4:7], s50 offen offset:2048  sc1 lds
    buffer_load_dwordx4 v1, s[4:7], s50 offen offset:3072  sc1 lds
    s_add_u32 m0, s30, 92160
    s_add_u32 s51, s35, 2048
    buffer_load_dwordx4 v1, s[4:7], s51 offen offset:0 sc1 lds
    buffer_load_dwordx4 v1, s[4:7], s51 offen offset:1024 sc1 lds
    buffer_load_dwordx4 v2, s[4:7], s51 offen offset:2048 sc1 lds
    buffer_load_dwordx4 v2, s[4:7], s51 offen offset:3072 sc1 lds
    s_waitcnt vmcnt(20) lgkmcnt(0)
    s_barrier
    s_mov_b32 s48, 2
    s_mul_i32 s50, s48, 18432
    s_add_u32 s50, s50, s34
    s_add_u32 s50, s50, 165888
    s_cmp_ge_u32 s20, 2
    s_cselect_b32 s52, s50, s53
    s_add_u32 m0, s31, 73728
    s_add_u32 s52, s52, s49
    buffer_load_dwordx4 v1, s[4:7], s52 offen  sc1 lds
    s_add_u32 m0, s30, 110592
    s_mov_b32 s53, s50
    buffer_load_dwordx4 v1, s[4:7], s50 offen offset:0  sc1 lds
    buffer_load_dwordx4 v1, s[4:7], s50 offen offset:1024  sc1 lds
    buffer_load_dwordx4 v1, s[4:7], s50 offen offset:2048  sc1 lds
    buffer_load_dwordx4 v1, s[4:7], s50 offen offset:3072  sc1 lds
    s_add_u32 m0, s30, 129024
    s_add_u32 s51, s35, 4096
    buffer_load_dwordx4 v1, s[4:7], s51 offen offset:0 sc1 lds
    buffer_load_dwordx4 v1, s[4:7], s51 offen offset:1024 sc1 lds
    buffer_load_dwordx4 v2, s[4:7], s51 offen offset:2048 sc1 lds
    buffer_load_dwordx4 v2, s[4:7], s51 offen offset:3072 sc1 lds
    s_mov_b32 s60, 65536
    s_waitcnt vmcnt(17)
L_g_chk:
    v_or3_b32 v32, v17, v19, v21
    v_or3_b32 v33, v23, v25, v27
    v_or3_b32 v32, v29, v31, v32
    v_or_b32 v32, v32, v33
    v_cmp_gt_i32 vcc, 0, v32
    s_sub_u32 s60, s60, 1
    s_cbranch_scc1 L_g_ok
    s_cbranch_vccz L_g_ok
    buffer_load_dwordx4 v[16:19], v3, s[4:7], s29 offen offset:0 sc1
    buffer_load_dwordx4 v[20:23], v3, s[4:7], s29 offen offset:1024 sc1
    buffer_load_dwordx4 v[24:27], v3, s[4:7], s29 offen offset:2048 sc1
    buffer_load_dwordx4 v[28:31], v3, s[4:7], s29 offen offset:3072 sc1
    s_waitcnt vmcnt(0)
    s_branch L_g_chk
L_g_ok:
    v_add_f32 v16, v16, v20
    v_add_f32 v24, v24, v28
    v_add_f32 v17, v17, v21
    v_add_f32 v25, v25, v29
    v_add_f32 v18, v18, v22
    v_add_f32 v26, v26, v30
    v_add_f32 v19, v19, v23
    v_add_f32 v27, v27, v31
    v_add_f32 v16, v16, v24
    v_add_f32 v17, v17, v25
    v_add_f32 v18, v18, v26
    v_add_f32 v19, v19, v27
    v_add_f32_dpp v16, v16, v16 row_ror:4 row_mask:0xf bank_mask:0xf
    v_add_f32_dpp v17, v17, v17 row_ror:4 row_mask:0xf bank_mask:0xf
    v_add_f32_dpp v18, v18, v18 row_ror:4 row_mask:0xf bank_mask:0xf
    v_add_f32_dpp v19, v19, v19 row_ror:4 row_mask:0xf bank_mask:0xf
    v_add_f32_dpp v16, v16, v16 row_ror:8 row_mask:0xf bank_mask:0xf
    v_add_f32_dpp v17, v17, v17 row_ror:8 row_mask:0xf bank_mask:0xf
    v_add_f32_dpp v18, v18, v18 row_ror:8 row_mask:0xf bank_mask:0xf
    v_add_f32_dpp v19, v19, v19 row_ror:8 row_mask:0xf bank_mask:0xf
    v_mul_f32 v16, 0x39e38e39, v16
    v_mul_f32 v17, 0x39e38e39, v17
    v_mul_f32 v18, 0x39e38e39, v18
    v_mul_f32 v19, 0x39e38e39, v19
    v_fma_f32 v17, -v16, v16, v17
    v_fma_f32 v19, -v18, v18, v19
    v_max_f32 v17, 0, v17
    v_max_f32 v19, 0, v19
    v_add_f32 v17, 0x3727c5ac, v17
    v_add_f32 v19, 0x3727c5ac, v19
    v_rsq_f32 v20, v17
    v_rsq_f32 v21, v19
    v_and_b32 v32, 0xff, v3
    s_lshl_b32 s33, s20, 8
    s_add_u32 s33, s33, 148480
    v_add_u32 v32, s33, v32
    v_mul_f32 v22, v16, v20
    v_mul_f32 v23, v18, v21
    ds_write_b128 v32, v[20:23]
    s_waitcnt vmcnt(17) lgkmcnt(0)
    s_barrier
    s_mov_b32 s48, 3
    s_mul_i32 s50, s48, 18432
    s_add_u32 s50, s50, s34
    s_add_u32 s50, s50, 165888
    s_add_u32 m0, s30, 0
    s_mov_b32 s53, s50
    buffer_load_dwordx4 v1, s[4:7], s50 offen offset:0  sc1 lds
    buffer_load_dwordx4 v1, s[4:7], s50 offen offset:1024  sc1 lds
    buffer_load_dwordx4 v1, s[4:7], s50 offen offset:2048  sc1 lds
    buffer_load_dwordx4 v1, s[4:7], s50 offen offset:3072  sc1 lds
    s_add_u32 m0, s30, 18432
    s_add_u32 s51, s35, 6144
    buffer_load_dwordx4 v1, s[4:7], s51 offen offset:0 sc1 lds
    buffer_load_dwordx4 v1, s[4:7], s51 offen offset:1024 sc1 lds
    buffer_load_dwordx4 v2, s[4:7], s51 offen offset:2048 sc1 lds
    buffer_load_dwordx4 v2, s[4:7], s51 offen offset:3072 sc1 lds
    s_waitcnt vmcnt(16) lgkmcnt(0)
    s_barrier
    s_mov_b32 s48, 4
    s_mul_i32 s50, s48, 18432
    s_add_u32 s50, s50, s34
    s_add_u32 s50, s50, 165888
    s_cmp_ge_u32 s20, 2
    s_cselect_b32 s52, s50, s53
    s_add_u32 m0, s31, 0
    s_add_u32 s52, s52, s49
    buffer_load_dwordx4 v1, s[4:7], s52 offen  sc1 lds
    s_add_u32 m0, s30, 36864
    s_mov_b32 s53, s50
    buffer_load_dwordx4 v1, s[4:7], s50 offen offset:0  sc1 lds
    buffer_load_dwordx4 v1, s[4:7], s50 offen offset:1024  sc1 lds
    buffer_load_dwordx4 v1, s[4:7], s50 offen offset:2048  sc1 lds
    buffer_load_dwordx4 v1, s[4:7], s50 offen offset:3072  sc1 lds
    s_add_u32 m0, s30, 55296
    s_add_u32 s51, s35, 8192
    buffer_load_dwordx4 v1, s[4:7], s51 offen offset:0 sc1 lds
    buffer_load_dwordx4 v1, s[4:7], s51 offen offset:1024 sc1 lds
    buffer_load_dwordx4 v2, s[4:7], s51 offen offset:2048 sc1 lds
    buffer_load_dwordx4 v2, s[4:7], s51 offen offset:3072 sc1 lds
    s_waitcnt vmcnt(17) lgkmcnt(0)
    s_barrier
    s_waitcnt vmcnt(8) lgkmcnt(0)
    s_barrier
    s_waitcnt vmcnt(0) lgkmcnt(0)
    s_barrier
    s_barrier
    s_mov_b32 s56, 1
    s_atomic_add s56, s[54:55], 0
    s_add_u32 m0, s30, 92160
    s_lshl_b32 s51, s44, 7
    buffer_load_dwordx4 v8, s[8:11], s51 offen offset:0  lds
    buffer_load_dwordx4 v9, s[8:11], s51 offen offset:1024  lds
    buffer_load_dwordx4 v10, s[8:11], s51 offen offset:2048  lds
    buffer_load_dwordx4 v11, s[8:11], s51 offen offset:3072  lds
    s_add_u32 m0, s30, 129024
    s_lshl_b32 s51, s45, 7
    buffer_load_dwordx4 v8, s[8:11], s51 offen offset:0  lds
    buffer_load_dwordx4 v9, s[8:11], s51 offen offset:1024  lds
    buffer_load_dwordx4 v10, s[8:11], s51 offen offset:2048  lds
    buffer_load_dwordx4 v11, s[8:11], s51 offen offset:3072  lds
    s_add_u32 m0, s30, 18432
    s_lshl_b32 s51, s46, 7
    buffer_load_dwordx4 v8, s[8:11], s51 offen offset:0  lds
    buffer_load_dwordx4 v9, s[8:11], s51 offen offset:1024  lds
    buffer_load_dwordx4 v10, s[8:11], s51 offen offset:2048  lds
    buffer_load_dwordx4 v11, s[8:11], s51 offen offset:3072  lds
    s_mov_b32 s60, 65536
L_poll_z2:
    s_mov_b32 s57, 0
    s_atomic_add s57, s[54:55], 0 glc
    s_waitcnt lgkmcnt(0)
    s_cmp_ge_u32 s57, 16
    s_cbranch_scc1 L_pd_z2
    s_sub_u32 s60, s60, 1
    s_cbranch_scc1 L_pd_z2
    s_sleep 2
    s_branch L_poll_z2
L_pd_z2:
    s_mul_i32 s50, s44, 18432
    s_add_u32 s50, s50, s36
    s_add_u32 m0, s30, 73728
    s_mov_b32 s53, s50
    buffer_load_dwordx4 v1, s[4:7], s50 offen offset:0 sc1 lds
    buffer_load_dwordx4 v1, s[4:7], s50 offen offset:1024 sc1 lds
    buffer_load_dwordx4 v1, s[4:7], s50 offen offset:2048 sc1 lds
    buffer_load_dwordx4 v1, s[4:7], s50 offen offset:3072 sc1 lds
    s_mul_i32 s50, s45, 18432
    s_add_u32 s50, s50, s36
    s_cmp_ge_u32 s20, 2
    s_cselect_b32 s52, s50, s53
    s_add_u32 m0, s31, 73728
    s_add_u32 s52, s52, s49
    buffer_load_dwordx4 v1, s[4:7], s52 offen sc1 lds
    s_add_u32 m0, s30, 110592
    s_mov_b32 s53, s50
    buffer_load_dwordx4 v1, s[4:7], s50 offen offset:0 sc1 lds
    buffer_load_dwordx4 v1, s[4:7], s50 offen offset:1024 sc1 lds
    buffer_load_dwordx4 v1, s[4:7], s50 offen offset:2048 sc1 lds
    buffer_load_dwordx4 v1, s[4:7], s50 offen offset:3072 sc1 lds
    s_mul_i32 s50, s46, 18432
    s_add_u32 s50, s50, s36
    s_add_u32 m0, s30, 0
    s_mov_b32 s53, s50
    buffer_load_dwordx4 v1, s[4:7], s50 offen offset:0 sc1 lds
    buffer_load_dwordx4 v1, s[4:7], s50 offen offset:1024 sc1 lds
    buffer_load_dwordx4 v1, s[4:7], s50 offen offset:2048 sc1 lds
    buffer_load_dwordx4 v1, s[4:7], s50 offen offset:3072 sc1 lds
    s_waitcnt vmcnt(8)
    s_barrier
    s_add_u32 s44, s44, 4
    s_and_b32 s44, s44, 31
    s_add_u32 s45, s45, 4
    s_and_b32 s45, s45, 31
    s_add_u32 s46, s46, 4
    s_and_b32 s46, s46, 31
    s_mul_i32 s50, s47, 18432
    s_add_u32 s50, s50, s36
    s_cmp_ge_u32 s20, 2
    s_cselect_b32 s52, s50, s53
    s_add_u32 m0, s31, 0
    s_add_u32 s52, s52, s49
    buffer_load_dwordx4 v1, s[4:7], s52 offen sc1 lds
    s_add_u32 m0, s30, 36864
    s_mov_b32 s53, s50
    buffer_load_dwordx4 v1, s[4:7], s50 offen offset:0 sc1 lds
    buffer_load_dwordx4 v1, s[4:7], s50 offen offset:1024 sc1 lds
    buffer_load_dwordx4 v1, s[4:7], s50 offen offset:2048 sc1 lds
    buffer_load_dwordx4 v1, s[4:7], s50 offen offset:3072 sc1 lds
    s_add_u32 m0, s30, 55296
    s_lshl_b32 s51, s47, 7
    buffer_load_dwordx4 v8, s[8:11], s51 offen offset:0  lds
    buffer_load_dwordx4 v9, s[8:11], s51 offen offset:1024  lds
    buffer_load_dwordx4 v10, s[8:11], s51 offen offset:2048  lds
    buffer_load_dwordx4 v11, s[8:11], s51 offen offset:3072  lds
    s_add_u32 s47, s47, 4
    s_and_b32 s47, s47, 31
    s_waitcnt vmcnt(13)
    s_barrier
    s_mul_i32 s50, s44, 18432
    s_add_u32 s50, s50, s36
    s_add_u32 m0, s30, 73728
    s_mov_b32 s53, s50
    buffer_load_dwordx4 v1, s[4:7], s50 offen offset:0 sc1 lds
    buffer_load_dwordx4 v1, s[4:7], s50 offen offset:1024 sc1 lds
    buffer_load_dwordx4 v1, s[4:7], s50 offen offset:2048 sc1 lds
    buffer_load_dwordx4 v1, s[4:7], s50 offen offset:3072 sc1 lds
    s_add_u32 m0, s30, 92160
    s_lshl_b32 s51, s44, 7
    buffer_load_dwordx4 v8, s[8:11], s51 offen offset:0  lds
    buffer_load_dwordx4 v9, s[8:11], s51 offen offset:1024  lds
    buffer_load_dwordx4 v10, s[8:11], s51 offen offset:2048  lds
    buffer_load_dwordx4 v11, s[8:11], s51 offen offset:3072  lds
    s_add_u32 s44, s44, 4
    s_and_b32 s44, s44, 31
    s_waitcnt vmcnt(16)
    s_barrier
    s_mul_i32 s50, s45, 18432
    s_add_u32 s50, s50, s36
    s_cmp_ge_u32 s20, 2
    s_cselect_b32 s52, s50, s53
    s_add_u32 m0, s31, 73728
    s_add_u32 s52, s52, s49
    buffer_load_dwordx4 v1, s[4:7], s52 offen sc1 lds
    s_add_u32 m0, s30, 110592
    s_mov_b32 s53, s50
    buffer_load_dwordx4 v1, s[4:7], s50 offen offset:0 sc1 lds
    buffer_load_dwordx4 v1, s[4:7], s50 offen offset:1024 sc1 lds
    buffer_load_dwordx4 v1, s[4:7], s50 offen offset:2048 sc1 lds
    buffer_load_dwordx4 v1, s[4:7], s50 offen offset:3072 sc1 lds
    s_add_u32 m0, s30, 129024
    s_lshl_b32 s51, s45, 7
    buffer_load_dwordx4 v8, s[8:11], s51 offen offset:0  lds
    buffer_load_dwordx4 v9, s[8:11], s51 offen offset:1024  lds
    buffer_load_dwordx4 v10, s[8:11], s51 offen offset:2048  lds
    buffer_load_dwordx4 v11, s[8:11], s51 offen offset:3072  lds
    s_add_u32 s45, s45, 4
    s_and_b32 s45, s45, 31
    s_waitcnt vmcnt(17)
    s_barrier
    s_mul_i32 s50, s46, 18432
    s_add_u32 s50, s50, s36
    s_add_u32 m0, s30, 0
    s_mov_b32 s53, s50
    buffer_load_dwordx4 v1, s[4:7], s50 offen offset:0 sc1 lds
    buffer_load_dwordx4 v1, s[4:7], s50 offen offset:1024 sc1 lds
    buffer_load_dwordx4 v1, s[4:7], s50 offen offset:2048 sc1 lds
    buffer_load_dwordx4 v1, s[4:7], s50 offen offset:3072 sc1 lds
    s_add_u32 m0, s30, 18432
    s_lshl_b32 s51, s46, 7
    buffer_load_dwordx4 v8, s[8:11], s51 offen offset:0  lds
    buffer_load_dwordx4 v9, s[8:11], s51 offen offset:1024  lds
    buffer_load_dwordx4 v10, s[8:11], s51 offen offset:2048  lds
    buffer_load_dwordx4 v11, s[8:11], s51 offen offset:3072  lds
    s_add_u32 s46, s46, 4
    s_and_b32 s46, s46, 31
    s_waitcnt vmcnt(16)
    s_barrier
    s_mul_i32 s50, s47, 18432
    s_add_u32 s50, s50, s36
    s_cmp_ge_u32 s20, 2
    s_cselect_b32 s52, s50, s53
    s_add_u32 m0, s31, 0
    s_add_u32 s52, s52, s49
    buffer_load_dwordx4 v1, s[4:7], s52 offen sc1 lds
    s_add_u32 m0, s30, 36864
    s_mov_b32 s53, s50
    buffer_load_dwordx4 v1, s[4:7], s50 offen offset:0 sc1 lds
    buffer_load_dwordx4 v1, s[4:7], s50 offen offset:1024 sc1 lds
    buffer_load_dwordx4 v1, s[4:7], s50 offen offset:2048 sc1 lds
    buffer_load_dwordx4 v1, s[4:7], s50 offen offset:3072 sc1 lds
    s_add_u32 m0, s30, 55296
    s_lshl_b32 s51, s47, 7
    buffer_load_dwordx4 v8, s[8:11], s51 offen offset:0  lds
    buffer_load_dwordx4 v9, s[8:11], s51 offen offset:1024  lds
    buffer_load_dwordx4 v10, s[8:11], s51 offen offset:2048  lds
    buffer_load_dwordx4 v11, s[8:11], s51 offen offset:3072  lds
    s_add_u32 s47, s47, 4
    s_and_b32 s47, s47, 31
    s_mov_b32 s41, 6
L_g_ll:
    s_waitcnt vmcnt(17)
    s_barrier
    s_mul_i32 s50, s44, 18432
    s_add_u32 s50, s50, s36
    s_add_u32 m0, s30, 73728
    s_mov_b32 s53, s50
    buffer_load_dwordx4 v1, s[4:7], s50 offen offset:0 sc1 lds
    buffer_load_dwordx4 v1, s[4:7], s50 offen offset:1024 sc1 lds
    buffer_load_dwordx4 v1, s[4:7], s50 offen offset:2048 sc1 lds
    buffer_load_dwordx4 v1, s[4:7], s50 offen offset:3072 sc1 lds
    s_add_u32 m0, s30, 92160
    s_lshl_b32 s51, s44, 7
    buffer_load_dwordx4 v8, s[8:11], s51 offen offset:0  lds
    buffer_load_dwordx4 v9, s[8:11], s51 offen offset:1024  lds
    buffer_load_dwordx4 v10, s[8:11], s51 offen offset:2048  lds
    buffer_load_dwordx4 v11, s[8:11], s51 offen offset:3072  lds
    s_add_u32 s44, s44, 4
    s_and_b32 s44, s44, 31
    s_waitcnt vmcnt(16)
    s_barrier
    s_mul_i32 s50, s45, 18432
    s_add_u32 s50, s50, s36
    s_cmp_ge_u32 s20, 2
    s_cselect_b32 s52, s50, s53
    s_add_u32 m0, s31, 73728
    s_add_u32 s52, s52, s49
    buffer_load_dwordx4 v1, s[4:7], s52 offen sc1 lds
    s_add_u32 m0, s30, 110592
    s_mov_b32 s53, s50
    buffer_load_dwordx4 v1, s[4:7], s50 offen offset:0 sc1 lds
    buffer_load_dwordx4 v1, s[4:7], s50 offen offset:1024 sc1 lds
    buffer_load_dwordx4 v1, s[4:7], s50 offen offset:2048 sc1 lds
    buffer_load_dwordx4 v1, s[4:7], s50 offen offset:3072 sc1 lds
    s_add_u32 m0, s30, 129024
    s_lshl_b32 s51, s45, 7
    buffer_load_dwordx4 v8, s[8:11], s51 offen offset:0  lds
    buffer_load_dwordx4 v9, s[8:11], s51 offen offset:1024  lds
    buffer_load_dwordx4 v10, s[8:11], s51 offen offset:2048  lds
    buffer_load_dwordx4 v11, s[8:11], s51 offen offset:3072  lds
    s_add_u32 s45, s45, 4
    s_and_b32 s45, s45, 31
    s_waitcnt vmcnt(17)
    s_barrier
    s_mul_i32 s50, s46, 18432
    s_add_u32 s50, s50, s36
    s_add_u32 m0, s30, 0
    s_mov_b32 s53, s50
    buffer_load_dwordx4 v1, s[4:7], s50 offen offset:0 sc1 lds
    buffer_load_dwordx4 v1, s[4:7], s50 offen offset:1024 sc1 lds
    buffer_load_dwordx4 v1, s[4:7], s50 offen offset:2048 sc1 lds
    buffer_load_dwordx4 v1, s[4:7], s50 offen offset:3072 sc1 lds
    s_add_u32 m0, s30, 18432
    s_lshl_b32 s51, s46, 7
    buffer_load_dwordx4 v8, s[8:11], s51 offen offset:0  lds
    buffer_load_dwordx4 v9, s[8:11], s51 offen offset:1024  lds
    buffer_load_dwordx4 v10, s[8:11], s51 offen offset:2048  lds
    buffer_load_dwordx4 v11, s[8:11], s51 offen offset:3072  lds
    s_add_u32 s46, s46, 4
    s_and_b32 s46, s46, 31
    s_waitcnt vmcnt(16)
    s_barrier
    s_mul_i32 s50, s47, 18432
    s_add_u32 s50, s50, s36
    s_cmp_ge_u32 s20, 2
    s_cselect_b32 s52, s50, s53
    s_add_u32 m0, s31, 0
    s_add_u32 s52, s52, s49
    buffer_load_dwordx4 v1, s[4:7], s52 offen sc1 lds
    s_add_u32 m0, s30, 36864
    s_mov_b32 s53, s50
    buffer_load_dwordx4 v1, s[4:7], s50 offen offset:0 sc1 lds
    buffer_load_dwordx4 v1, s[4:7], s50 offen offset:1024 sc1 lds
    buffer_load_dwordx4 v1, s[4:7], s50 offen offset:2048 sc1 lds
    buffer_load_dwordx4 v1, s[4:7], s50 offen offset:3072 sc1 lds
    s_add_u32 m0, s30, 55296
    s_lshl_b32 s51, s47, 7
    buffer_load_dwordx4 v8, s[8:11], s51 offen offset:0  lds
    buffer_load_dwordx4 v9, s[8:11], s51 offen offset:1024  lds
    buffer_load_dwordx4 v10, s[8:11], s51 offen offset:2048  lds
    buffer_load_dwordx4 v11, s[8:11], s51 offen offset:3072  lds
    s_add_u32 s47, s47, 4
    s_and_b32 s47, s47, 31
    s_sub_u32 s41, s41, 1
    s_cmp_lg_u32 s41, 0
    s_cbranch_scc1 L_g_ll
    s_waitcnt vmcnt(17)
    s_barrier
    s_mov_b32 s32, 0
    s_mul_i32 s32, s32, 36864
    s_add_u32 s32, s32, s43
    s_add_u32 m0, s42, 73728
    s_add_u32 s33, s32, 0
    buffer_load_dwordx4 v1, s[4:7], s33 offen offset:0  sc1 lds
    buffer_load_dwordx4 v1, s[4:7], s33 offen offset:1024  sc1 lds
    buffer_load_dwordx4 v1, s[4:7], s33 offen offset:2048  sc1 lds
    buffer_load_dwordx4 v1, s[4:7], s33 offen offset:3072  sc1 lds
    s_add_u32 m0, s42, 77824
    s_add_u32 s33, s32, 4096
    buffer_load_dwordx4 v1, s[4:7], s33 offen offset:0  sc1 lds
    buffer_load_dwordx4 v1, s[4:7], s33 offen offset:1024  sc1 lds
    buffer_load_dwordx4 v1, s[4:7], s33 offen offset:2048  sc1 lds
    buffer_load_dwordx4 v1, s[4:7], s33 offen offset:3072  sc1 lds
    s_add_u32 m0, s42, 81920
    s_add_u32 s33, s32, 8192
    buffer_load_dwordx4 v1, s[4:7], s33 offen offset:0  sc1 lds
    s_waitcnt vmcnt(9)
    s_barrier
    s_mov_b32 s32, 1
    s_mul_i32 s32, s32, 36864
    s_add_u32 s32, s32, s43
    s_add_u32 m0, s42, 110592
    s_add_u32 s33, s32, 0
    buffer_load_dwordx4 v1, s[4:7], s33 offen offset:0  sc1 lds
    buffer_load_dwordx4 v1, s[4:7], s33 offen offset:1024  sc1 lds
    buffer_load_dwordx4 v1, s[4:7], s33 offen offset:2048  sc1 lds
    buffer_load_dwordx4 v1, s[4:7], s33 offen offset:3072  sc1 lds
    s_add_u32 m0, s42, 114688
    s_add_u32 s33, s32, 4096
    buffer_load_dwordx4 v1, s[4:7], s33 offen offset:0  sc1 lds
    buffer_load_dwordx4 v1, s[4:7], s33 offen offset:1024  sc1 lds
    buffer_load_dwordx4 v1, s[4:7], s33 offen offset:2048  sc1 lds
    buffer_load_dwordx4 v1, s[4:7], s33 offen offset:3072  sc1 lds
    s_add_u32 m0, s42, 118784
    s_add_u32 s33, s32, 8192
    buffer_load_dwordx4 v1, s[4:7], s33 offen offset:0  sc1 lds
    s_barrier
    s_mov_b32 s32, 2
    s_mul_i32 s32, s32, 36864
    s_add_u32 s32, s32, s43
    s_add_u32 m0, s42, 0
    s_add_u32 s33, s32, 0
    buffer_load_dwordx4 v1, s[4:7], s33 offen offset:0  sc1 lds
    buffer_load_dwordx4 v1, s[4:7], s33 offen offset:1024  sc1 lds
    buffer_load_dwordx4 v1, s[4:7], s33 offen offset:2048  sc1 lds
    buffer_load_dwordx4 v1, s[4:7], s33 offen offset:3072  sc1 lds
    s_add_u32 m0, s42, 4096
    s_add_u32 s33, s32, 4096
    buffer_load_dwordx4 v1, s[4:7], s33 offen offset:0  sc1 lds
    buffer_load_dwordx4 v1, s[4:7], s33 offen offset:1024  sc1 lds
    buffer_load_dwordx4 v1, s[4:7], s33 offen offset:2048  sc1 lds
    buffer_load_dwordx4 v1, s[4:7], s33 offen offset:3072  sc1 lds
    s_add_u32 m0, s42, 8192
    s_add_u32 s33, s32, 8192
    buffer_load_dwordx4 v1, s[4:7], s33 offen offset:0  sc1 lds
    s_mov_b32 s32, 3
    s_mul_i32 s32, s32, 36864
    s_add_u32 s32, s32, s43
    s_add_u32 m0, s42, 36864
    s_add_u32 s33, s32, 0
    buffer_load_dwordx4 v1, s[4:7], s33 offen offset:0  sc1 lds
    buffer_load_dwordx4 v1, s[4:7], s33 offen offset:1024  sc1 lds
    buffer_load_dwordx4 v1, s[4:7], s33 offen offset:2048  sc1 lds
    buffer_load_dwordx4 v1, s[4:7], s33 offen offset:3072  sc1 lds
    s_add_u32 m0, s42, 40960
    s_add_u32 s33, s32, 4096
    buffer_load_dwordx4 v1, s[4:7], s33 offen offset:0  sc1 lds
    buffer_load_dwordx4 v1, s[4:7], s33 offen offset:1024  sc1 lds
    buffer_load_dwordx4 v1, s[4:7], s33 offen offset:2048  sc1 lds
    buffer_load_dwordx4 v1, s[4:7], s33 offen offset:3072  sc1 lds
    s_add_u32 m0, s42, 45056
    s_add_u32 s33, s32, 8192
    buffer_load_dwordx4 v1, s[4:7], s33 offen offset:0  sc1 lds
    s_waitcnt vmcnt(27) lgkmcnt(0)
    s_barrier
    v_add_u32 v12, s42, v1
    v_add_u32 v13, 36864, v12
    v_add_u32 v14, 73728, v12
    v_add_u32 v15, 110592, v12
    s_waitcnt vmcnt(18) lgkmcnt(15)
    s_barrier
    ds_write_b128 v14, v[76:79] offset:0
    ds_write_b128 v14, v[80:83] offset:1024
    ds_write_b128 v14, v[84:87] offset:2048
    ds_write_b128 v14, v[88:91] offset:3072
    ds_write_b128 v14, v[92:95] offset:4096
    ds_write_b128 v14, v[96:99] offset:5120
    ds_write_b128 v14, v[100:103] offset:6144
    s_waitcnt vmcnt(9) lgkmcnt(15)
    s_barrier
    ds_write_b128 v14, v[104:107] offset:7168
    ds_write_b128 v14, v[108:111] offset:8192
    ds_write_b128 v15, v[112:115] offset:0
    ds_write_b128 v15, v[116:119] offset:1024
    ds_write_b128 v15, v[120:123] offset:2048
    ds_write_b128 v15, v[124:127] offset:3072
    ds_write_b128 v15, v[128:131] offset:4096
    s_waitcnt vmcnt(0) lgkmcnt(15)
    s_barrier
    ds_write_b128 v15, v[132:135] offset:5120
    ds_write_b128 v15, v[136:139] offset:6144
    ds_write_b128 v15, v[140:143] offset:7168
    ds_write_b128 v15, v[144:147] offset:8192
    ds_write_b128 v12, v[148:151] offset:0
    ds_write_b128 v12, v[152:155] offset:1024
    ds_write_b128 v12, v[156:159] offset:2048
    s_waitcnt vmcnt(63) lgkmcnt(12)
    s_barrier
    ds_write_b128 v12, v[160:163] offset:3072
    ds_write_b128 v12, v[164:167] offset:4096
    ds_write_b128 v12, v[168:171] offset:5120
    ds_write_b128 v12, v[172:175] offset:6144
    ds_write_b128 v12, v[176:179] offset:7168
    ds_write_b128 v12, v[180:183] offset:8192
    s_waitcnt vmcnt(63) lgkmcnt(9)
    s_barrier
    ds_write_b128 v13, v[184:187] offset:0
    ds_write_b128 v13, v[188:191] offset:1024
    ds_write_b128 v13, v[192:195] offset:2048
    ds_write_b128 v13, v[196:199] offset:3072
    ds_write_b128 v13, v[200:203] offset:4096
    ds_write_b128 v13, v[204:207] offset:5120
    s_waitcnt vmcnt(63) lgkmcnt(6)
    s_barrier
    s_and_b32 s25, s2, 7
    s_lshr_b32 s26, s2, 3
    s_lshr_b32 s23, s25, 1
    s_lshl_b32 s23, s23, 2
    s_lshr_b32 s27, s26, 3
    s_add_u32 s23, s23, s27
    s_and_b32 s24, s25, 1
    s_lshl_b32 s24, s24, 3
    s_and_b32 s27, s26, 7
    s_add_u32 s24, s24, s27
    s_mul_i32 s29, s24, 129024
    s_lshl_b32 s30, s20, 12
    s_add_u32 s29, s29, s30
    s_add_u32 s29, s29, 0x3800000
    s_lshl_b32 s31, s23, 3
    s_max_u32 s31, s31, 1
    s_sub_u32 s31, s31, 1
    s_mul_i32 s31, s31, 18432
    s_add_u32 s31, s31, 0x1c00000
    s_lshl_b32 s35, s20, 10
    s_and_b32 s36, s35, 1024
    ds_write_b128 v13, v[208:211] offset:6144
    ds_write_b128 v13, v[212:215] offset:7168
    ds_write_b128 v13, v[216:219] offset:8192
    ds_write_b128 v14, v[220:223] offset:0
    ds_write_b128 v14, v[224:227] offset:1024
    ds_write_b128 v14, v[228:231] offset:2048
    s_waitcnt vmcnt(63) lgkmcnt(3)
    s_barrier
    s_cmp_eq_u32 s22, 1
    s_cbranch_scc1 L_m_t7
    s_add_u32 m0, s30, 0
    s_add_u32 s34, s29, 0
    buffer_load_dwordx4 v1, s[4:7], s34 offen offset:0 sc1 lds
    buffer_load_dwordx4 v1, s[4:7], s34 offen offset:1024 sc1 lds
    buffer_load_dwordx4 v1, s[4:7], s34 offen offset:2048 sc1 lds
    buffer_load_dwordx4 v1, s[4:7], s34 offen offset:3072 sc1 lds
    s_add_u32 m0, s30, 16384
    s_add_u32 s34, s29, 16384
    buffer_load_dwordx4 v1, s[4:7], s34 offen offset:0 sc1 lds
    buffer_load_dwordx4 v1, s[4:7], s34 offen offset:1024 sc1 lds
    buffer_load_dwordx4 v1, s[4:7], s34 offen offset:2048 sc1 lds
    buffer_load_dwordx4 v1, s[4:7], s34 offen offset:3072 sc1 lds
L_m_t7:
    ds_write_b128 v14, v[232:235] offset:3072
    ds_write_b128 v14, v[236:239] offset:4096
    ds_write_b128 v14, v[240:243] offset:5120
    ds_write_b128 v14, v[244:247] offset:6144
    ds_write_b128 v14, v[248:251] offset:7168
    ds_write_b128 v14, v[252:255] offset:8192
    s_waitcnt vmcnt(63) lgkmcnt(0)
    s_barrier
    s_cmp_eq_u32 s22, 1
    s_cbranch_scc1 L_m_lfin
    s_barrier
    s_add_u32 m0, s30, 32768
    s_add_u32 s34, s29, 32768
    buffer_load_dwordx4 v1, s[4:7], s34 offen offset:0 sc1 lds
    buffer_load_dwordx4 v1, s[4:7], s34 offen offset:1024 sc1 lds
    buffer_load_dwordx4 v1, s[4:7], s34 offen offset:2048 sc1 lds
    buffer_load_dwordx4 v1, s[4:7], s34 offen offset:3072 sc1 lds
    s_add_u32 m0, s30, 114688
    s_add_u32 s34, s29, 114688
    buffer_load_dwordx4 v1, s[4:7], s34 offen offset:0 sc1 lds
    buffer_load_dwordx4 v1, s[4:7], s34 offen offset:1024 sc1 lds
    buffer_load_dwordx4 v1, s[4:7], s34 offen offset:2048 sc1 lds
    buffer_load_dwordx4 v1, s[4:7], s34 offen offset:3072 sc1 lds
    s_mov_b32 s22, 1
    s_mov_b32 s21, 0x1c00000
    s_barrier
    s_barrier
    s_add_u32 m0, s30, 49152
    s_add_u32 s34, s29, 49152
    buffer_load_dwordx4 v1, s[4:7], s34 offen offset:0 sc1 lds
    buffer_load_dwordx4 v1, s[4:7], s34 offen offset:1024 sc1 lds
    buffer_load_dwordx4 v1, s[4:7], s34 offen offset:2048 sc1 lds
    buffer_load_dwordx4 v1, s[4:7], s34 offen offset:3072 sc1 lds
    v_lshrrev_b32 v2, 8, v1
    v_bfe_u32 v3, v1, 7, 1
    v_bfe_u32 v4, v1, 4, 3
    v_cmp_gt_u32 vcc, 3, v2
    v_mul_u32_u24 v3, 80, v3
    v_lshl_add_u32 v3, v4, 3, v3
    v_lshrrev_b32 v5, 1, v4
    v_and_b32 v4, 1, v4
    v_lshl_add_u32 v4, v4, 3, 64
    v_cndmask_b32 v2, v5, v2, vcc
    v_cndmask_b32 v3, v4, v3, vcc
    v_mul_u32_u24 v2, 2304, v2
    v_add_u32 v0, v2, v3
    v_lshrrev_b32 v8, 1, v1
    s_mul_i32 s34, s24, 144
    s_add_u32 s34, s34, 0x4400000
    buffer_load_dwordx2 v[2:3], v0, s[4:7], s34 offen sc1
    s_mul_i32 s34, s24, 144
    s_add_u32 s34, s34, 0x4402000
    buffer_load_dwordx2 v[4:5], v0, s[4:7], s34 offen sc1
    s_mul_i32 s34, s24, 144
    s_add_u32 s34, s34, 0x4404000
    buffer_load_dwordx2 v[6:7], v0, s[4:7], s34 offen sc1
    s_mul_i32 s34, s24, 144
    s_add_u32 s34, s34, 0x4406000
    buffer_load_dwordx2 v[12:13], v0, s[4:7], s34 offen sc1
    s_add_u32 m0, s30, 65536
    s_add_u32 s34, s29, 65536
    buffer_load_dwordx4 v1, s[4:7], s34 offen offset:0 sc1 lds
    buffer_load_dwordx4 v1, s[4:7], s34 offen offset:1024 sc1 lds
    buffer_load_dwordx4 v1, s[4:7], s34 offen offset:2048 sc1 lds
    buffer_load_dwordx4 v1, s[4:7], s34 offen offset:3072 sc1 lds
    s_add_u32 m0, s30, 81920
    s_add_u32 s34, s29, 81920
    buffer_load_dwordx4 v1, s[4:7], s34 offen offset:0 sc1 lds
    buffer_load_dwordx4 v1, s[4:7], s34 offen offset:1024 sc1 lds
    buffer_load_dwordx4 v1, s[4:7], s34 offen offset:2048 sc1 lds
    buffer_load_dwordx4 v1, s[4:7], s34 offen offset:3072 sc1 lds
    s_barrier
    s_add_u32 m0, s35, 131072
    s_add_u32 s34, s31, s35
    s_add_u32 s34, s34, 0
    buffer_load_dwordx4 v1, s[4:7], s34 offen sc1 lds
    s_waitcnt vmcnt(29) lgkmcnt(0)
    s_barrier
    s_add_u32 m0, s35, 135168
    s_add_u32 s34, s31, s35
    s_add_u32 s34, s34, 4096
    buffer_load_dwordx4 v1, s[4:7], s34 offen sc1 lds
    s_add_u32 m0, s35, 139264
    s_add_u32 s34, s31, s35
    s_add_u32 s34, s34, 8192
    buffer_load_dwordx4 v1, s[4:7], s34 offen sc1 lds
    s_add_u32 m0, s35, 143360
    s_add_u32 s34, s31, s35
    s_add_u32 s34, s34, 12288
    buffer_load_dwordx4 v1, s[4:7], s34 offen sc1 lds
    s_add_u32 m0, s30, 98304
    s_add_u32 s34, s29, 98304
    buffer_load_dwordx4 v1, s[4:7], s34 offen offset:0 sc1 lds
    buffer_load_dwordx4 v1, s[4:7], s34 offen offset:1024 sc1 lds
    buffer_load_dwordx4 v1, s[4:7], s34 offen offset:2048 sc1 lds
    buffer_load_dwordx4 v1, s[4:7], s34 offen offset:3072 sc1 lds
    s_add_u32 m0, s36, 147456
    s_add_u32 s34, s31, s36
    s_add_u32 s34, s34, 16384
    buffer_load_dwordx4 v1, s[4:7], s34 offen sc1 lds
    s_waitcnt vmcnt(8) lgkmcnt(0)
    s_barrier
    s_waitcnt vmcnt(8) lgkmcnt(0)
    s_barrier
    s_waitcnt vmcnt(7) lgkmcnt(0)
    s_barrier
    v_add_f32 v2, v2, v4
    v_add_f32 v3, v3, v5
    v_add_f32 v6, v6, v12
    v_add_f32 v7, v7, v13
    v_add_f32 v2, v2, v6
    v_add_f32 v3, v3, v7
    v_cmp_gt_u32 vcc, 864, v1
    v_add_u32 v8, 161792, v8
    s_nop 0
    v_cndmask_b32 v2, 0, v2, vcc
    v_cndmask_b32 v3, 0, v3, vcc
    ds_write_b64 v8, v[2:3]
    s_waitcnt vmcnt(6) lgkmcnt(0)
    s_barrier
    s_waitcnt vmcnt(6) lgkmcnt(0)
    s_barrier
    s_waitcnt vmcnt(1) lgkmcnt(0)
    s_barrier
    s_waitcnt vmcnt(0) lgkmcnt(0)
    s_barrier
    s_barrier
    s_branch L_m_ll
L_m_lfin:
L_end_m:
    s_endpgm

.section .rodata,"a"
.p2align 6
.amdhsa_kernel interleave_layers__sliding_local_dilated__mixer_gmlp__prompt_kernel
  .amdhsa_next_free_vgpr 256
  .amdhsa_next_free_sgpr 102
  .amdhsa_accum_offset 256
  .amdhsa_group_segment_fixed_size 0
  .amdhsa_kernarg_size 88
  .amdhsa_user_sgpr_count 2
  .amdhsa_user_sgpr_kernarg_segment_ptr 1
  .amdhsa_system_sgpr_workgroup_id_x 1
  .amdhsa_float_denorm_mode_32 3
.end_amdhsa_kernel
```

```asm
; @launch grid=(256,1,1) block=(512,1,1) lds=163840
.amdgcn_target "amdgcn-amd-amdhsa--gfx950"
.text
.globl interleave_layers__sliding_local_dilated__mixer_gmlp__prompt_kernel
.p2align 8
.type interleave_layers__sliding_local_dilated__mixer_gmlp__prompt_kernel,@function
interleave_layers__sliding_local_dilated__mixer_gmlp__prompt_kernel:
    s_cmp_ge_u32 s2, 256
    s_cbranch_scc1 L_end_m
    s_load_dwordx16 s[36:51], s[0:1], 0
    s_load_dwordx4 s[56:59], s[0:1], 64
    s_load_dwordx2 s[24:25], s[0:1], 80
    s_getpc_b64 s[26:27]
L_m_pc:
    s_sub_u32 s26, s26, L_m_pc-interleave_layers__sliding_local_dilated__mixer_gmlp__prompt_kernel
    s_subb_u32 s27, s27, 0
    v_lshlrev_b32 v4, 4, v0
    v_mov_b32 v5, s27
    v_add_co_u32 v6, vcc, s26, v4
    s_lshr_b32 s28, s2, 3
    s_lshl_b32 s28, s28, 11
    v_addc_co_u32 v7, vcc, 0, v5, vcc
    global_load_dwordx4 v[60:63], v[6:7], off
    v_lshl_add_u32 v4, v0, 2, s28
    v_min_u32 v4, L_end_m-interleave_layers__sliding_local_dilated__mixer_gmlp__prompt_kernel-4, v4
    v_add_co_u32 v6, vcc, s26, v4
    s_nop 1
    v_addc_co_u32 v7, vcc, 0, v5, vcc
    global_load_dword v64, v[6:7], off
    v_lshrrev_b32 v2, 6, v0
    v_and_b32 v1, 63, v0
    v_lshlrev_b32 v1, 4, v1
    v_readfirstlane_b32 s23, v2
    s_mov_b32 s22, 0
    s_mov_b32 s21, 0
    s_and_b32 s20, s23, 3
    s_waitcnt lgkmcnt(0)
    s_mov_b32 s4, s24
    s_mov_b32 s5, s25
    s_mov_b32 s6, 0x10000000
    s_mov_b32 s7, 0x20000
    s_mov_b32 s8, s46
    s_mov_b32 s9, s47
    s_mov_b32 s10, 0x800000
    s_mov_b32 s11, 0x20000
    s_mov_b32 s12, s48
    s_mov_b32 s13, s49
    s_mov_b32 s14, 0x1000
    s_mov_b32 s15, 0x20000
    s_mov_b32 s16, s56
    s_mov_b32 s17, s57
    s_mov_b32 s18, 0x240000
    s_mov_b32 s19, 0x20000
    s_cmp_ge_u32 s23, 4
    s_cbranch_scc1 L_ld_m
    v_mov_b32 v2, 163808
    v_mov_b32 v4, 0
    v_mov_b32 v5, 0
    ds_write2_b64 v2, v[4:5], v[4:5] offset0:0 offset1:1
    s_waitcnt lgkmcnt(0)
    v_bfe_u32 v2, v1, 4, 4
    v_lshrrev_b32 v3, 8, v1
    v_bfrev_b32 v6, 1
    v_mov_b32 v11, 0x3f803f80
    s_lshl_b32 s30, s20, 12
    s_and_b32 s29, s20, 1
    s_cmp_lt_u32 s2, 128
    s_cbranch_scc1 L_p0_x
    s_cmp_lt_u32 s2, 236
    s_cbranch_scc1 L_p0_wq
    s_cmp_lt_u32 s2, 254
    s_cbranch_scc1 L_p0_wo
    s_mov_b32 s46, 0
    s_mov_b32 s27, 0x800000
    s_barrier
    s_barrier
    s_branch L_p0_cd
L_p0_wo:
    s_mul_i32 s30, s20, 9216
    s_sub_u32 s26, s2, 236
    s_mul_i32 s28, s26, 57
    s_lshr_b32 s28, s28, 9
    s_mul_i32 s27, s28, 9
    s_sub_u32 s27, s26, s27
    s_mov_b32 s32, s40
    s_mov_b32 s33, s41
    s_mov_b32 s34, 0xa2000
    s_mov_b32 s35, 0x20000
    s_mul_i32 s29, s28, 331776
    s_lshl_b32 s31, s27, 7
    s_add_u32 s29, s29, s31
    s_mul_i32 s31, s20, 82944
    s_add_u32 s29, s29, s31
    s_mul_i32 s30, s20, 9216
    v_lshrrev_b32 v4, 7, v1
    v_mul_u32_u24 v4, 1152, v4
    v_and_b32 v5, 0x70, v1
    v_add_u32 v4, v4, v5
    s_add_u32 m0, s30, 0
    s_add_u32 s31, s29, 0
    buffer_load_dwordx4 v4, s[32:35], s31 offen  lds
    s_add_u32 m0, s30, 1024
    s_add_u32 s31, s29, 9216
    buffer_load_dwordx4 v4, s[32:35], s31 offen  lds
    s_add_u32 m0, s30, 2048
    s_add_u32 s31, s29, 18432
    buffer_load_dwordx4 v4, s[32:35], s31 offen  lds
    s_add_u32 m0, s30, 3072
    s_add_u32 s31, s29, 27648
    buffer_load_dwordx4 v4, s[32:35], s31 offen  lds
    s_add_u32 m0, s30, 4096
    s_add_u32 s31, s29, 36864
    buffer_load_dwordx4 v4, s[32:35], s31 offen  lds
    s_add_u32 m0, s30, 5120
    s_add_u32 s31, s29, 46080
    buffer_load_dwordx4 v4, s[32:35], s31 offen  lds
    s_add_u32 m0, s30, 6144
    s_add_u32 s31, s29, 55296
    buffer_load_dwordx4 v4, s[32:35], s31 offen  lds
    s_add_u32 m0, s30, 7168
    s_add_u32 s31, s29, 64512
    buffer_load_dwordx4 v4, s[32:35], s31 offen  lds
    s_add_u32 m0, s30, 8192
    s_add_u32 s31, s29, 73728
    buffer_load_dwordx4 v4, s[32:35], s31 offen  lds
    s_barrier
    v_lshrrev_b32 v7, 2, v2
    v_and_b32 v8, 3, v2
    v_bfe_u32 v9, v1, 7, 0
    v_xor_b32 v9, s20, v9
    v_lshlrev_b32 v9, 5, v9
    v_lshl_add_u32 v9, v7, 7, v9
    v_lshl_add_u32 v9, v8, 3, v9
    v_add_u32 v9, 0, v9
    v_mul_u32_u24 v4, 512, v3
    v_add_u32 v4, v4, v9
    v_mul_u32_u24 v5, 9216, v3
    v_add_u32 v5, v5, v9
    s_lshl_b32 s31, s27, 2
    s_add_u32 s31, s31, s20
    v_lshl_add_u32 v7, s31, 2, v7
    v_lshlrev_b32 v8, 4, v8
    v_lshl_add_u32 v8, v3, 8, v8
    v_mul_u32_u24 v9, 57, v7
    v_lshrrev_b32 v9, 10, v9
    v_mul_u32_u24 v10, 18, v9
    v_sub_u32 v10, v7, v10
    v_lshrrev_b32 v12, 3, v10
    v_and_b32 v13, 1, v10
    v_lshl_add_u32 v12, v12, 1, v13
    v_bfe_u32 v14, v10, 1, 2
    v_cmp_gt_u32 vcc, 16, v10
    v_mul_u32_u24 v9, 82944, v9
    v_add_u32 v9, v9, v8
    v_cndmask_b32 v12, 8, v12, vcc
    v_cndmask_b32 v14, v13, v14, vcc
    v_mov_b32 v15, 0x1000
    v_mov_b32 v13, 0x80
    v_cndmask_b32 v15, v13, v15, vcc
    v_lshl_add_u32 v9, v12, 10, v9
    v_lshl_add_u32 v9, v14, 6, v9
    v_add_u32 v10, v9, v15
    s_and_b32 s31, s28, 1
    s_cmp_eq_u32 s31, 1
    s_cselect_b64 vcc, -1, 0
    v_cndmask_b32 v14, v9, v10, vcc
    s_mul_i32 s31, s28, 36864
    s_add_u32 s37, s31, 0x3a00000
    s_add_u32 s38, s31, 0x3a00000
    s_add_u32 s39, s31, 0x3a02400
    s_add_u32 s40, s31, 0x3a02400
    s_add_u32 s41, s31, 0x3a04800
    s_add_u32 s42, s31, 0x3a04800
    s_add_u32 s43, s31, 0x3a06c00
    s_add_u32 s47, s31, 0x3a06c00
    s_lshr_b32 s31, s28, 1
    s_mul_i32 s31, s31, 9216
    s_add_u32 s48, s31, 0x3a12000
    s_cmp_ge_u32 s26, 4
    s_cbranch_scc1 L_p0_n2
    s_lshl_b32 s31, s26, 2
    s_add_u32 s31, s31, s20
    s_lshl_b32 s31, s31, 12
    s_add_u32 s31, s31, 0x4508000
    v_and_b32 v56, 0x380, v1
    v_add_u32 v56, v56, v1
    v_mov_b32 v52, 0
    v_mov_b32 v53, 0
    v_mov_b32 v54, 0
    v_mov_b32 v55, 0
    buffer_store_dwordx4 v[52:55], v56, s[4:7], s31 offen offset:0 sc1
    buffer_store_dwordx4 v[52:55], v56, s[4:7], s31 offen offset:2048 sc1
L_p0_n2:
    s_waitcnt vmcnt(0)
    s_barrier
    ds_read_b64_tr_b16 v[16:17], v4 offset:0
    ds_read_b64_tr_b16 v[18:19], v4 offset:2560
    ds_read_b64_tr_b16 v[20:21], v4 offset:4608
    ds_read_b64_tr_b16 v[22:23], v4 offset:7168
    ds_read_b64_tr_b16 v[24:25], v4 offset:9216
    ds_read_b64_tr_b16 v[26:27], v4 offset:11776
    ds_read_b64_tr_b16 v[28:29], v4 offset:13824
    ds_read_b64_tr_b16 v[30:31], v4 offset:16384
    ds_read_b64_tr_b16 v[32:33], v4 offset:18432
    ds_read_b64_tr_b16 v[34:35], v4 offset:20992
    ds_read_b64_tr_b16 v[36:37], v4 offset:23040
    ds_read_b64_tr_b16 v[38:39], v4 offset:25600
    ds_read_b64_tr_b16 v[40:41], v4 offset:27648
    ds_read_b64_tr_b16 v[42:43], v4 offset:30208
    ds_read_b64_tr_b16 v[44:45], v4 offset:32256
    ds_read_b64_tr_b16 v[46:47], v4 offset:34816
    ds_read_b64_tr_b16 v[48:49], v5 offset:2048
    ds_read_b64_tr_b16 v[50:51], v5 offset:6656
    s_waitcnt lgkmcnt(15)
    s_mov_b32 s31, s37
    buffer_store_dwordx4 v[16:19], v9, s[4:7], s31 offen sc1
    s_waitcnt lgkmcnt(14)
    s_mov_b32 s31, s38
    buffer_store_dwordx4 v[20:23], v10, s[4:7], s31 offen sc1
    s_waitcnt lgkmcnt(12)
    s_mov_b32 s31, s39
    buffer_store_dwordx4 v[24:27], v9, s[4:7], s31 offen sc1
    s_waitcnt lgkmcnt(10)
    s_mov_b32 s31, s40
    buffer_store_dwordx4 v[28:31], v10, s[4:7], s31 offen sc1
    s_waitcnt lgkmcnt(8)
    s_mov_b32 s31, s41
    buffer_store_dwordx4 v[32:35], v9, s[4:7], s31 offen sc1
    s_waitcnt lgkmcnt(6)
    s_mov_b32 s31, s42
    buffer_store_dwordx4 v[36:39], v10, s[4:7], s31 offen sc1
    s_waitcnt lgkmcnt(4)
    s_mov_b32 s31, s43
    buffer_store_dwordx4 v[40:43], v9, s[4:7], s31 offen sc1
    s_waitcnt lgkmcnt(2)
    s_mov_b32 s31, s47
    buffer_store_dwordx4 v[44:47], v10, s[4:7], s31 offen sc1
    s_waitcnt lgkmcnt(0)
    s_mov_b32 s31, s48
    buffer_store_dwordx4 v[48:51], v14, s[4:7], s31 offen sc1
    s_mov_b32 s46, 1
    s_mov_b32 s27, 32
    s_branch L_p0_cd
L_p0_wq:
    s_mov_b32 s32, s38
    s_mov_b32 s33, s39
    s_mov_b32 s34, 0x1e6000
    s_mov_b32 s35, 0x20000
    s_sub_u32 s23, s2, 128
    s_mul_i32 s25, s23, 19
    s_lshr_b32 s25, s25, 9
    s_mul_i32 s24, s25, 27
    s_sub_u32 s24, s23, s24
    s_mul_i32 s26, s25, 497664
    s_lshl_b32 s31, s24, 7
    s_add_u32 s26, s26, s31
    v_lshrrev_b32 v4, 7, v1
    v_mul_u32_u24 v4, 3456, v4
    v_lshrrev_b32 v5, 4, v1
    v_and_b32 v5, 16, v5
    v_xor_b32 v5, v5, v1
    v_and_b32 v5, 0x70, v5
    v_add_u32 v4, v4, v5
    s_mul_i32 s31, s20, 110592
    s_add_u32 s27, s26, s31
    s_mul_i32 s30, s20, 4224
    s_add_u32 m0, s30, 0
    s_add_u32 s31, s27, 0
    buffer_load_dwordx4 v4, s[32:35], s31 offen  lds
    s_add_u32 m0, s30, 1056
    s_add_u32 s31, s27, 27648
    buffer_load_dwordx4 v4, s[32:35], s31 offen  lds
    s_add_u32 m0, s30, 2112
    s_add_u32 s31, s27, 55296
    buffer_load_dwordx4 v4, s[32:35], s31 offen  lds
    s_add_u32 m0, s30, 3168
    s_add_u32 s31, s27, 82944
    buffer_load_dwordx4 v4, s[32:35], s31 offen  lds
    s_cmp_ge_u32 s20, 2
    s_cbranch_scc1 L_p0_q5
    s_mul_i32 s31, s29, 1056
    s_add_u32 m0, s31, 16896
    s_mul_i32 s31, s29, 27648
    s_add_u32 s31, s31, s26
    s_add_u32 s31, s31, 442368
    buffer_load_dwordx4 v4, s[32:35], s31 offen  lds
L_p0_q5:
    s_barrier
    v_lshrrev_b32 v7, 2, v2
    v_and_b32 v8, 3, v2
    s_lshl_b32 s31, s20, 5
    v_and_b32 v9, 2, v7
    v_xor_b32 v9, v9, v3
    v_lshlrev_b32 v9, 3, v9
    v_lshl_add_u32 v9, v7, 7, v9
    v_add_u32 v9, s31, v9
    v_mul_u32_u24 v4, 1056, v8
    v_add_u32 v4, v4, v9
    v_and_b32 v5, 1, v2
    v_mul_u32_u24 v5, 9504, v5
    v_add_u32 v5, v5, v9
    s_lshl_b32 s31, s24, 2
    s_add_u32 s31, s31, s20
    v_lshlrev_b32 v8, 4, v8
    v_lshl_add_u32 v8, v7, 8, v8
    v_lshl_add_u32 v7, s31, 2, v3
    v_mul_u32_u24 v9, 57, v7
    v_lshrrev_b32 v9, 13, v9
    v_mul_u32_u24 v10, 144, v9
    v_sub_u32 v10, v7, v10
    v_mul_u32_u24 v12, 57, v10
    v_lshrrev_b32 v12, 9, v12
    v_mul_u32_u24 v13, 9, v12
    v_sub_u32 v13, v10, v13
    v_cmp_lt_u32 s[36:37], 4, v13
    v_cmp_eq_u32 s[38:39], 4, v13
    v_cmp_eq_u32 s[40:41], 2, v9
    v_lshlrev_b32 v14, 1, v9
    v_add_u32 v15, 1, v14
    v_subrev_u32 v10, 5, v13
    v_cndmask_b32 v14, v14, v15, s[36:37]
    v_cndmask_b32 v13, v13, v10, s[36:37]
    v_cndmask_b32 v14, v14, 6, s[38:39]
    v_cndmask_b32 v13, v13, v9, s[38:39]
    s_and_b64 s[40:41], s[40:41], s[38:39]
    s_mov_b32 s31, 129024
    v_mul_lo_u32 v9, v12, s31
    v_add_u32 v9, v9, v8
    v_lshl_add_u32 v9, v14, 10, v9
    v_lshl_add_u32 v9, v13, 6, v9
    s_and_b32 s31, s25, 1
    v_lshrrev_b32 v8, 3, v2
    v_cmp_eq_u32 vcc, s31, v8
    v_add_u32 v15, 64, v9
    v_cndmask_b32 v15, v6, v15, s[40:41]
    v_cndmask_b32 v8, v6, v9, vcc
    v_lshlrev_b32 v10, 2, v2
    v_lshl_add_u32 v10, v7, 4, v10
    v_cmp_gt_u32 vcc, 4, v2
    s_lshl_b32 s45, s25, 13
    s_add_u32 s45, s45, 0x4400000
    v_cndmask_b32 v10, v6, v10, vcc
    s_mul_i32 s42, s25, 28672
    s_add_u32 s42, s42, 0x3800000
    s_lshr_b32 s44, s25, 1
    s_mul_i32 s44, s44, 7168
    s_add_u32 s44, s44, 0x381c000
    s_mul_i32 s26, s24, 29
    s_lshr_b32 s26, s26, 8
    s_mul_i32 s27, s26, 9
    s_sub_u32 s27, s24, s27
    s_lshl_b32 s27, s27, 4
    s_add_u32 s28, s27, 16
    v_lshrrev_b32 v254, 4, v1
    v_mul_u32_u24 v7, 9, v254
    v_add_u32 v255, 9, v7
    v_min_u32 v255, s28, v255
    v_max_u32 v7, s27, v7
    v_sub_u32 v255, v255, v7
    v_cmp_lt_i32 vcc, 0, v255
    v_lshlrev_b32 v254, 8, v254
    v_mov_b32 v14, 0x3f003f00
    v_cndmask_b32 v254, v6, v254, vcc
    s_cmp_eq_u64 s[40:41], 0
    s_cbranch_scc1 L_p0_np
    v_mov_b32 v52, 0
    v_mov_b32 v53, 0
    v_mov_b32 v54, 0
    v_mov_b32 v55, 0
    s_add_u32 s31, s42, 0
    buffer_store_dwordx4 v[52:55], v15, s[4:7], s31 offen sc1
    s_add_u32 s31, s42, 7168
    buffer_store_dwordx4 v[52:55], v15, s[4:7], s31 offen sc1
    s_add_u32 s31, s42, 14336
    buffer_store_dwordx4 v[52:55], v15, s[4:7], s31 offen sc1
    s_add_u32 s31, s42, 21504
    buffer_store_dwordx4 v[52:55], v15, s[4:7], s31 offen sc1
    s_mov_b32 s31, s44
    buffer_store_dwordx4 v[52:55], v15, s[4:7], s31 offen sc1
    s_waitcnt vmcnt(5)
    s_branch L_p0_n3
L_p0_np:
    s_waitcnt vmcnt(0)
L_p0_n3:
    s_barrier
    ds_read_b64_tr_b16 v[16:17], v4 offset:0
    ds_read_b64_tr_b16 v[18:19], v4 offset:512
    ds_read_b64_tr_b16 v[20:21], v4 offset:4224
    ds_read_b64_tr_b16 v[22:23], v4 offset:4736
    ds_read_b64_tr_b16 v[24:25], v4 offset:9504
    ds_read_b64_tr_b16 v[26:27], v4 offset:10016
    ds_read_b64_tr_b16 v[28:29], v4 offset:13728
    ds_read_b64_tr_b16 v[30:31], v4 offset:14240
    ds_read_b64_tr_b16 v[32:33], v5 offset:8448
    ds_read_b64_tr_b16 v[34:35], v5 offset:8960
    s_waitcnt lgkmcnt(8)
    s_add_u32 s31, s42, 0
    buffer_store_dwordx4 v[16:19], v9, s[4:7], s31 offen sc1
    s_waitcnt lgkmcnt(6)
    s_add_u32 s31, s42, 7168
    buffer_store_dwordx4 v[20:23], v9, s[4:7], s31 offen sc1
    s_waitcnt lgkmcnt(4)
    s_add_u32 s31, s42, 14336
    buffer_store_dwordx4 v[24:27], v9, s[4:7], s31 offen sc1
    s_waitcnt lgkmcnt(2)
    s_add_u32 s31, s42, 21504
    buffer_store_dwordx4 v[28:31], v9, s[4:7], s31 offen sc1
    s_waitcnt lgkmcnt(0)
    s_mov_b32 s31, s44
    buffer_store_dwordx4 v[32:35], v8, s[4:7], s31 offen sc1
    v_dot2_f32_bf16 v12, v16, v11, 0
    v_dot2_f32_bf16 v13, v17, v11, 0
    v_dot2_f32_bf16 v12, v18, v11, v12
    v_dot2_f32_bf16 v13, v19, v11, v13
    v_dot2_f32_bf16 v12, v20, v11, v12
    v_dot2_f32_bf16 v13, v21, v11, v13
    v_dot2_f32_bf16 v12, v22, v11, v12
    v_dot2_f32_bf16 v13, v23, v11, v13
    v_dot2_f32_bf16 v12, v24, v11, v12
    v_dot2_f32_bf16 v13, v25, v11, v13
    v_dot2_f32_bf16 v12, v26, v11, v12
    v_dot2_f32_bf16 v13, v27, v11, v13
    v_dot2_f32_bf16 v12, v28, v11, v12
    v_dot2_f32_bf16 v13, v29, v11, v13
    v_dot2_f32_bf16 v12, v30, v11, v12
    v_dot2_f32_bf16 v13, v31, v11, v13
    v_dot2_f32_bf16 v12, v32, v14, v12
    v_dot2_f32_bf16 v13, v33, v14, v13
    v_dot2_f32_bf16 v12, v34, v14, v12
    v_dot2_f32_bf16 v13, v35, v14, v13
    s_nop 2
    v_add_f32 v12, v12, v13
    s_nop 1
    v_add_f32_dpp v12, v12, v12 row_ror:4 row_mask:0xf bank_mask:0xf
    s_nop 1
    v_add_f32_dpp v12, v12, v12 row_ror:8 row_mask:0xf bank_mask:0xf
    buffer_store_dword v12, v10, s[4:7], s45 offen sc1
    s_branch L_p0_ce
L_p0_x:
    s_mov_b32 s32, s36
    s_mov_b32 s33, s37
    s_mov_b32 s34, 0x240000
    s_mov_b32 s35, 0x20000
    s_mul_i32 s26, s2, 18432
    s_mul_i32 s31, s20, 288
    s_add_u32 s28, s26, s31
    v_lshrrev_b32 v4, 6, v1
    v_mul_u32_u24 v4, 1152, v4
    v_and_b32 v5, 48, v1
    v_add_u32 v4, v4, v5
    s_add_u32 m0, s30, 0
    s_add_u32 s31, s28, 0
    buffer_load_dwordx4 v4, s[32:35], s31 offen  lds
    s_add_u32 m0, s30, 1024
    s_add_u32 s31, s28, 64
    buffer_load_dwordx4 v4, s[32:35], s31 offen  lds
    s_add_u32 m0, s30, 2048
    s_add_u32 s31, s28, 144
    buffer_load_dwordx4 v4, s[32:35], s31 offen  lds
    s_add_u32 m0, s30, 3072
    s_add_u32 s31, s28, 208
    buffer_load_dwordx4 v4, s[32:35], s31 offen  lds
    s_mul_i32 s31, s29, 576
    s_add_u32 s31, s31, s26
    v_mul_u32_u24 v7, 1152, v2
    v_mul_u32_u24 v5, 144, v3
    v_add_u32 v5, v5, v7
    buffer_load_dwordx4 v[32:35], v5, s[32:35], s31 offen offset:128
    s_lshl_b32 s27, s29, 10
    s_add_u32 s27, s27, 16384
    s_barrier
    s_barrier
    v_lshlrev_b32 v4, 6, v2
    v_lshl_add_u32 v4, v3, 4, v4
    v_add_u32 v4, s30, v4
    s_add_u32 s26, s26, 0x0
    s_add_u32 s42, s26, s30
    s_add_u32 s44, s26, s27
    s_lshl_b32 s45, s2, 10
    s_lshl_b32 s31, s20, 8
    s_add_u32 s45, s45, s31
    s_add_u32 s45, s45, 0x1b00000
    v_cmp_gt_u32 vcc, 2, v3
    v_lshrrev_b32 v10, 1, v1
    s_mov_b32 s46, 2
    v_cndmask_b32 v10, v6, v10, vcc
    s_lshr_b32 s27, s2, 3
    s_add_u32 s27, s27, 48
    s_waitcnt vmcnt(0)
    ds_read_b128 v[16:19], v4 offset:0
    ds_read_b128 v[20:23], v4 offset:1024
    ds_read_b128 v[24:27], v4 offset:2048
    ds_read_b128 v[28:31], v4 offset:3072
    s_waitcnt lgkmcnt(3)
    buffer_store_dwordx4 v[16:19], v1, s[4:7], s42 offen offset:0 sc1
    s_waitcnt lgkmcnt(2)
    buffer_store_dwordx4 v[20:23], v1, s[4:7], s42 offen offset:1024 sc1
    s_waitcnt lgkmcnt(1)
    buffer_store_dwordx4 v[24:27], v1, s[4:7], s42 offen offset:2048 sc1
    s_waitcnt lgkmcnt(0)
    buffer_store_dwordx4 v[28:31], v1, s[4:7], s42 offen offset:3072 sc1
    v_dot2_f32_bf16 v12, v16, v11, 0
    v_dot2_f32_bf16 v13, v16, v16, 0
    v_dot2_f32_bf16 v12, v17, v11, v12
    v_dot2_f32_bf16 v13, v17, v17, v13
    v_dot2_f32_bf16 v12, v18, v11, v12
    v_dot2_f32_bf16 v13, v18, v18, v13
    v_dot2_f32_bf16 v12, v19, v11, v12
    v_dot2_f32_bf16 v13, v19, v19, v13
    v_dot2_f32_bf16 v12, v20, v11, v12
    v_dot2_f32_bf16 v13, v20, v20, v13
    v_dot2_f32_bf16 v12, v21, v11, v12
    v_dot2_f32_bf16 v13, v21, v21, v13
    v_dot2_f32_bf16 v12, v22, v11, v12
    v_dot2_f32_bf16 v13, v22, v22, v13
    v_dot2_f32_bf16 v12, v23, v11, v12
    v_dot2_f32_bf16 v13, v23, v23, v13
    v_dot2_f32_bf16 v12, v24, v11, v12
    v_dot2_f32_bf16 v13, v24, v24, v13
    v_dot2_f32_bf16 v12, v25, v11, v12
    v_dot2_f32_bf16 v13, v25, v25, v13
    v_dot2_f32_bf16 v12, v26, v11, v12
    v_dot2_f32_bf16 v13, v26, v26, v13
    v_dot2_f32_bf16 v12, v27, v11, v12
    v_dot2_f32_bf16 v13, v27, v27, v13
    v_dot2_f32_bf16 v12, v28, v11, v12
    v_dot2_f32_bf16 v13, v28, v28, v13
    v_dot2_f32_bf16 v12, v29, v11, v12
    v_dot2_f32_bf16 v13, v29, v29, v13
    v_dot2_f32_bf16 v12, v30, v11, v12
    v_dot2_f32_bf16 v13, v30, v30, v13
    v_dot2_f32_bf16 v12, v31, v11, v12
    v_dot2_f32_bf16 v13, v31, v31, v13
    s_waitcnt lgkmcnt(0)
    s_cmp_ge_u32 s20, 2
    s_cbranch_scc1 L_p0_xs
    buffer_store_dwordx4 v[32:35], v1, s[4:7], s44 offen sc1
    v_dot2_f32_bf16 v12, v32, v11, v12
    v_dot2_f32_bf16 v13, v32, v32, v13
    v_dot2_f32_bf16 v12, v33, v11, v12
    v_dot2_f32_bf16 v13, v33, v33, v13
    v_dot2_f32_bf16 v12, v34, v11, v12
    v_dot2_f32_bf16 v13, v34, v34, v13
    v_dot2_f32_bf16 v12, v35, v11, v12
    v_dot2_f32_bf16 v13, v35, v35, v13
L_p0_xs:
    s_nop 2
    v_mov_b32 v14, v12
    v_mov_b32 v15, v13
    s_nop 1
    v_permlane32_swap_b32 v12, v14
    v_permlane32_swap_b32 v13, v15
    v_add_f32 v12, v12, v14
    v_add_f32 v13, v13, v15
    buffer_store_dwordx2 v[12:13], v10, s[4:7], s45 offen sc1
L_p0_cd:
    v_cmp_eq_u32 vcc, 0, v1
    s_lshl_b32 s27, s27, 8
    v_mov_b32 v255, s46
    v_mov_b32 v254, s27
    v_cndmask_b32 v254, v6, v254, vcc
L_p0_ce:
    s_mov_b32 s48, s58
    s_mov_b32 s49, s59
    s_mov_b32 s50, 0x100
    s_mov_b32 s51, 0x20000
    v_mov_b32 v4, 0
    buffer_load_dword v246, v4, s[48:51], 0 offen sc1
    s_barrier
    s_branch L_m_cl
L_d1_first:
    v_cmp_gt_u32 vcc, 4, v246
    v_mov_b32 v4, 0
    s_mov_b32 s46, 0x4500000
    s_cbranch_vccz L_pd_dbg
    s_mov_b32 s60, 65536
L_poll_dbg:
    buffer_load_dword v5, v4, s[48:51], 0 offen sc1
    s_waitcnt vmcnt(0)
    v_cmp_gt_u32 vcc, 4, v5
    s_sub_u32 s60, s60, 1
    s_cbranch_scc1 L_pd_dbg
    s_cbranch_vccz L_pd_dbg
    s_sleep 4
    s_branch L_poll_dbg
L_pd_dbg:
    buffer_atomic_add v255, v254, s[4:7], s46 offen sc1
    s_branch L_ns_d1
L_ld_m:
    s_cmp_lg_u32 s2, 0
    s_cbranch_scc1 L_p0_nz
    s_lshl_b32 s31, s20, 12
    s_add_u32 s31, s31, 0x4500000
    v_and_b32 v56, 0x380, v1
    v_add_u32 v56, v56, v1
    v_mov_b32 v52, 0
    v_mov_b32 v53, 0
    v_mov_b32 v54, 0
    v_mov_b32 v55, 0
    buffer_store_dwordx4 v[52:55], v56, s[4:7], s31 offen offset:0 sc1
    buffer_store_dwordx4 v[52:55], v56, s[4:7], s31 offen offset:2048 sc1
    s_waitcnt vmcnt(0)
    s_mov_b32 s53, 1
    s_atomic_add s53, s[58:59], 0
L_p0_nz:
    v_bfe_u32 v2, v1, 4, 4
    v_lshrrev_b32 v3, 8, v1
    v_bfrev_b32 v6, 1
    v_mov_b32 v11, 0x3f803f80
    s_mul_i32 s30, s20, 9216
    s_cmp_lt_u32 s2, 144
    s_cbranch_scc1 L_p0_wi
    s_cmp_lt_u32 s2, 216
    s_cbranch_scc1 L_p0_wu
    v_mov_b32 v9, v6
    v_mov_b32 v10, v6
    v_mov_b32 v14, v6
    v_mov_b32 v15, v6
    s_mov_b32 s37, 0
    s_mov_b32 s38, 0
    s_mov_b32 s39, 0
    s_mov_b32 s40, 0
    s_mov_b32 s41, 0
    s_mov_b32 s42, 0
    s_mov_b32 s43, 0
    s_mov_b32 s47, 0
    s_mov_b32 s48, 0
    s_mov_b32 s49, 0
    s_barrier
    s_barrier
    s_barrier
    s_barrier
    s_barrier
    s_branch L_p0_ld
L_p0_wu:
    s_sub_u32 s26, s2, 144
    s_mul_i32 s28, s26, 57
    s_lshr_b32 s28, s28, 9
    s_mul_i32 s27, s28, 9
    s_sub_u32 s27, s26, s27
    s_mov_b32 s32, s50
    s_mov_b32 s33, s51
    s_mov_b32 s34, 0x288000
    s_mov_b32 s35, 0x20000
    s_mul_i32 s29, s28, 331776
    s_lshl_b32 s31, s27, 7
    s_add_u32 s29, s29, s31
    s_mul_i32 s31, s20, 82944
    s_add_u32 s29, s29, s31
    s_mul_i32 s30, s20, 9216
    v_lshrrev_b32 v4, 7, v1
    v_mul_u32_u24 v4, 1152, v4
    v_and_b32 v5, 0x70, v1
    v_bfe_u32 v7, v1, 8, 2
    v_lshlrev_b32 v7, 5, v7
    v_xor_b32 v5, v5, v7
    v_add_u32 v4, v4, v5
    s_barrier
    s_barrier
    s_barrier
    s_barrier
    s_barrier
    s_add_u32 m0, s30, 91904
    s_add_u32 s31, s29, 0
    buffer_load_dwordx4 v4, s[32:35], s31 offen  lds
    s_add_u32 m0, s30, 92928
    s_add_u32 s31, s29, 9216
    buffer_load_dwordx4 v4, s[32:35], s31 offen  lds
    s_add_u32 m0, s30, 93952
    s_add_u32 s31, s29, 18432
    buffer_load_dwordx4 v4, s[32:35], s31 offen  lds
    s_add_u32 m0, s30, 94976
    s_add_u32 s31, s29, 27648
    buffer_load_dwordx4 v4, s[32:35], s31 offen  lds
    s_add_u32 m0, s30, 96000
    s_add_u32 s31, s29, 36864
    buffer_load_dwordx4 v4, s[32:35], s31 offen  lds
    s_add_u32 m0, s30, 97024
    s_add_u32 s31, s29, 46080
    buffer_load_dwordx4 v4, s[32:35], s31 offen  lds
    s_add_u32 m0, s30, 98048
    s_add_u32 s31, s29, 55296
    buffer_load_dwordx4 v4, s[32:35], s31 offen  lds
    s_add_u32 m0, s30, 99072
    s_add_u32 s31, s29, 64512
    buffer_load_dwordx4 v4, s[32:35], s31 offen  lds
    s_add_u32 m0, s30, 100096
    s_add_u32 s31, s29, 73728
    buffer_load_dwordx4 v4, s[32:35], s31 offen  lds
    v_lshrrev_b32 v7, 2, v2
    v_and_b32 v8, 3, v2
    v_bfe_u32 v9, v1, 7, 2
    v_xor_b32 v9, s20, v9
    v_lshlrev_b32 v9, 5, v9
    v_lshl_add_u32 v9, v7, 7, v9
    v_lshl_add_u32 v9, v8, 3, v9
    v_add_u32 v9, 91904, v9
    v_mul_u32_u24 v4, 512, v3
    v_add_u32 v4, v4, v9
    v_mul_u32_u24 v5, 512, v3
    v_add_u32 v5, v5, v9
    s_lshl_b32 s31, s27, 2
    s_add_u32 s31, s31, s20
    v_lshl_add_u32 v7, s31, 2, v7
    v_lshlrev_b32 v8, 4, v8
    v_lshl_add_u32 v8, v3, 8, v8
    v_mul_u32_u24 v9, 57, v7
    v_lshrrev_b32 v9, 10, v9
    v_mul_u32_u24 v10, 18, v9
    v_sub_u32 v10, v7, v10
    v_lshrrev_b32 v12, 3, v10
    v_and_b32 v13, 1, v10
    v_lshl_add_u32 v12, v12, 1, v13
    v_bfe_u32 v14, v10, 1, 2
    v_cmp_gt_u32 vcc, 16, v10
    v_mul_u32_u24 v9, 331776, v9
    v_add_u32 v9, v9, v8
    v_cndmask_b32 v12, 8, v12, vcc
    v_cndmask_b32 v14, v13, v14, vcc
    v_mov_b32 v15, 0x1000
    v_mov_b32 v13, 0x80
    v_cndmask_b32 v15, v13, v15, vcc
    v_lshl_add_u32 v9, v12, 10, v9
    v_lshl_add_u32 v9, v14, 6, v9
    v_add_u32 v10, v9, v15
    s_and_b32 s31, s28, 1
    s_cmp_eq_u32 s31, 1
    s_cselect_b64 vcc, -1, 0
    v_cndmask_b32 v14, v9, v10, vcc
    s_mul_i32 s31, s28, 9216
    s_add_u32 s37, s31, 0x4100000
    s_add_u32 s38, s31, 0x4100000
    s_add_u32 s39, s31, 0x4112000
    s_add_u32 s40, s31, 0x4112000
    s_add_u32 s41, s31, 0x4124000
    s_add_u32 s42, s31, 0x4124000
    s_add_u32 s43, s31, 0x4136000
    s_add_u32 s47, s31, 0x4136000
    s_lshr_b32 s31, s28, 1
    s_mul_i32 s31, s31, 9216
    s_add_u32 s48, s31, 0x4148000
    v_mov_b32 v15, v6
    s_mov_b32 s49, 0
    s_branch L_p0_ld
L_p0_wi:
    s_mov_b32 s26, s2
    s_mul_i32 s28, s26, 57
    s_lshr_b32 s28, s28, 12
    s_mul_i32 s27, s28, 72
    s_sub_u32 s27, s26, s27
    s_mov_b32 s32, s44
    s_mov_b32 s33, s45
    s_mov_b32 s34, 0x510000
    s_mov_b32 s35, 0x20000
    s_mul_i32 s29, s28, 2654208
    s_lshl_b32 s31, s27, 7
    s_add_u32 s29, s29, s31
    s_mul_i32 s31, s20, 663552
    s_add_u32 s29, s29, s31
    s_mul_i32 s30, s20, 9792
    v_lshrrev_b32 v4, 7, v1
    v_mul_u32_u24 v4, 9216, v4
    v_and_b32 v5, 0x70, v1
    v_bfe_u32 v7, v1, 8, 1
    v_lshlrev_b32 v7, 5, v7
    v_xor_b32 v5, v5, v7
    v_add_u32 v4, v4, v5
    s_barrier
    s_barrier
    s_barrier
    s_barrier
    s_barrier
    s_add_u32 m0, s30, 91904
    s_add_u32 s31, s29, 0
    buffer_load_dwordx4 v4, s[32:35], s31 offen  lds
    s_add_u32 m0, s30, 92992
    s_add_u32 s31, s29, 73728
    buffer_load_dwordx4 v4, s[32:35], s31 offen  lds
    s_add_u32 m0, s30, 94080
    s_add_u32 s31, s29, 147456
    buffer_load_dwordx4 v4, s[32:35], s31 offen  lds
    s_add_u32 m0, s30, 95168
    s_add_u32 s31, s29, 221184
    buffer_load_dwordx4 v4, s[32:35], s31 offen  lds
    s_add_u32 m0, s30, 96256
    s_add_u32 s31, s29, 294912
    buffer_load_dwordx4 v4, s[32:35], s31 offen  lds
    s_add_u32 m0, s30, 97344
    s_add_u32 s31, s29, 368640
    buffer_load_dwordx4 v4, s[32:35], s31 offen  lds
    s_add_u32 m0, s30, 98432
    s_add_u32 s31, s29, 442368
    buffer_load_dwordx4 v4, s[32:35], s31 offen  lds
    s_add_u32 m0, s30, 99520
    s_add_u32 s31, s29, 516096
    buffer_load_dwordx4 v4, s[32:35], s31 offen  lds
    s_add_u32 m0, s30, 100608
    s_add_u32 s31, s29, 589824
    buffer_load_dwordx4 v4, s[32:35], s31 offen  lds
    v_lshrrev_b32 v7, 2, v2
    v_and_b32 v8, 3, v2
    v_bfe_u32 v9, v1, 7, 1
    v_xor_b32 v9, s20, v9
    v_lshlrev_b32 v9, 5, v9
    v_lshl_add_u32 v9, v7, 7, v9
    v_lshl_add_u32 v9, v8, 3, v9
    v_add_u32 v9, 91904, v9
    v_mul_u32_u24 v4, 1088, v3
    v_add_u32 v4, v4, v9
    v_mul_u32_u24 v5, 9792, v3
    v_add_u32 v5, v5, v9
    s_lshl_b32 s31, s27, 2
    s_add_u32 s31, s31, s20
    v_lshl_add_u32 v7, s31, 2, v7
    v_lshlrev_b32 v8, 4, v8
    v_lshl_add_u32 v8, v3, 8, v8
    s_cmp_lt_u32 s31, 144
    s_cselect_b32 s23, 1, 0
    s_cselect_b32 s24, 0, 144
    s_sub_u32 s26, s31, s24
    s_mul_i32 s25, s26, 57
    s_lshr_b32 s25, s25, 9
    s_mul_i32 s24, s25, 9
    s_sub_u32 s24, s26, s24
    s_lshl_b32 s26, s25, 1
    s_add_u32 s26, s26, s23
    s_mul_i32 s26, s26, 165888
    s_lshl_b32 s31, s24, 10
    s_add_u32 s26, s26, s31
    s_add_u32 s26, s26, 0x3b00000
    s_mul_i32 s31, s28, 9216
    s_add_u32 s48, s26, s31
    s_add_u32 s48, s48, 147456
    s_lshl_b32 s31, s31, 3
    s_add_u32 s26, s26, s31
    s_add_u32 s37, s26, 0
    s_add_u32 s38, s26, 9216
    s_add_u32 s39, s26, 18432
    s_add_u32 s40, s26, 27648
    s_add_u32 s41, s26, 36864
    s_add_u32 s42, s26, 46080
    s_add_u32 s43, s26, 55296
    s_add_u32 s47, s26, 64512
    s_lshl_b32 s49, s25, 12
    s_mul_i32 s31, s28, 1152
    s_add_u32 s49, s49, s31
    s_mul_i32 s31, s23, 576
    s_add_u32 s49, s49, s31
    s_lshl_b32 s31, s24, 6
    s_add_u32 s49, s49, s31
    s_add_u32 s49, s49, 0x4410000
    v_cmp_eq_u32 vcc, 0, v3
    v_lshlrev_b32 v15, 2, v2
    v_mov_b32 v9, v1
    v_mov_b32 v10, v1
    v_mov_b32 v14, v1
    v_cndmask_b32 v15, v6, v15, vcc
L_p0_ld:
    s_waitcnt lgkmcnt(0)
    s_branch L_m_l1
L_m_cl:
    s_and_b32 s25, s2, 7
    s_lshr_b32 s26, s2, 3
    s_lshr_b32 s23, s25, 1
    s_lshl_b32 s23, s23, 2
    s_lshr_b32 s27, s26, 3
    s_add_u32 s23, s23, s27
    s_and_b32 s24, s25, 1
    s_lshl_b32 s24, s24, 3
    s_and_b32 s27, s26, 7
    s_add_u32 s24, s24, s27
    s_lshl_b32 s30, s23, 3
    s_lshl_b32 s31, s20, 1
    s_add_u32 s31, s30, s31
    s_mul_i32 s29, s31, 18432
    s_add_u32 s29, s29, s21
    s_add_u32 s35, s29, 0x600000
    s_add_u32 s29, s29, 0x0
    s_max_u32 s30, s30, 1
    s_sub_u32 s30, s30, 1
    s_lshl_b32 s30, s30, 10
    s_add_u32 s30, s30, s21
    s_add_u32 s30, s30, 0x1b00000
    s_lshl_b32 s32, s31, 10
    s_add_u32 s32, s32, s21
    s_add_u32 s32, s32, 0x1b00000
    v_bfe_u32 v2, v1, 4, 4
    v_lshrrev_b32 v3, 8, v1
    s_lshl_b32 s33, s20, 2
    s_lshr_b32 s33, 0x3362, s33
    s_and_b32 s33, s33, 15
    s_min_u32 s34, s20, 1
    s_add_u32 s34, s34, 4
    s_lshl_b32 s36, s33, 10
    s_lshl_b32 s37, s34, 10
    v_add_u32 v247, 64512, v1
    v_add_u32 v248, 131072, v1
    v_add_u32 v249, s36, v1
    v_add_u32 v250, s36, v247
    v_add_u32 v251, s37, v1
    v_add_u32 v252, s37, v247
    v_add_u32 v253, 18432, v1
    v_lshrrev_b32 v0, 1, v1
    s_add_u32 s38, s29, 0
    s_add_u32 s39, s29, 4096
    s_add_u32 s40, s29, 8192
    s_add_u32 s41, s29, 12288
    s_add_u32 s42, s29, 16384
    s_max_u32 s44, s23, 1
    s_sub_u32 s44, s44, 1
    s_lshl_b32 s52, s22, 7
    s_add_u32 s52, s52, s23
    s_lshl_b32 s52, s52, 8
    s_add_u32 s52, s52, 0x4503000
    s_add_u32 s52, s52, s4
    s_addc_u32 s53, s5, 0
    s_lshl_b32 s54, s22, 7
    s_add_u32 s54, s54, s44
    s_lshl_b32 s54, s54, 8
    s_add_u32 s54, s54, 0x4503000
    s_add_u32 s54, s54, s4
    s_addc_u32 s55, s5, 0
    s_lshl_b32 s44, s24, 8
    s_add_u32 s44, s44, 0x4500000
    s_add_u32 s44, s44, s4
    s_addc_u32 s45, s5, 0
    s_waitcnt vmcnt(0)
    s_barrier
    s_cmp_lg_u32 s20, 0
    s_cbranch_scc1 L_ns_d1
    s_cmp_eq_u32 s22, 0
    s_cbranch_scc1 L_d1_first
    s_mov_b32 s56, 1
    s_atomic_add s56, s[50:51], 0
L_ns_d1:
    s_barrier
    s_cmp_lg_u32 s20, 0
    s_cbranch_scc1 L_pd_d1
    s_mov_b32 s60, 65536
L_poll_d1:
    s_mov_b32 s57, 0
    s_atomic_add s57, s[52:53], 0 glc
    s_mov_b32 s58, 0
    s_atomic_add s58, s[54:55], 0 glc
    s_mov_b32 s59, 0
    s_atomic_add s59, s[44:45], 0 glc
    s_waitcnt lgkmcnt(0)
    s_cmp_ge_u32 s59, 108
    s_cselect_b32 s59, 16, 0
    s_min_u32 s57, s57, s58
    s_min_u32 s57, s57, s59
    s_cmp_ge_u32 s57, 16
    s_cbranch_scc1 L_pd_d1
    s_sub_u32 s60, s60, 1
    s_cbranch_scc1 L_pd_d1
    s_sleep 2
    s_branch L_poll_d1
L_pd_d1:
    s_barrier
    buffer_load_dwordx4 v[160:163], v1, s[4:7], s38 offen offset:0 sc1
    buffer_load_dwordx4 v[164:167], v253, s[4:7], s38 offen offset:0 sc1
    buffer_load_dwordx4 v[168:171], v1, s[4:7], s38 offen offset:1024 sc1
    buffer_load_dwordx4 v[172:175], v253, s[4:7], s38 offen offset:1024 sc1
    buffer_load_dwordx4 v[176:179], v1, s[4:7], s38 offen offset:2048 sc1
    buffer_load_dwordx4 v[180:183], v253, s[4:7], s38 offen offset:2048 sc1
    buffer_load_dwordx4 v[184:187], v1, s[4:7], s38 offen offset:3072 sc1
    buffer_load_dwordx4 v[188:191], v253, s[4:7], s38 offen offset:3072 sc1
    s_barrier
    ds_read_b128 v[80:83], v1 offset:0
    ds_read_b128 v[84:87], v1 offset:1024
    ds_read_b128 v[88:91], v1 offset:2048
    ds_read_b128 v[92:95], v1 offset:3072
    ds_read_b128 v[96:99], v1 offset:4096
    ds_read_b128 v[100:103], v1 offset:5120
    ds_read_b128 v[104:107], v1 offset:6144
    buffer_load_dwordx2 v[4:5], v0, s[4:7], s30 offen offset:0 sc1
    buffer_load_dwordx2 v[6:7], v0, s[4:7], s30 offen offset:512 sc1
    buffer_load_dwordx2 v[8:9], v0, s[4:7], s32 offen offset:0 sc1
    buffer_load_dwordx2 v[10:11], v0, s[4:7], s32 offen offset:512 sc1
    buffer_load_dwordx2 v[12:13], v0, s[4:7], s32 offen offset:1024 sc1
    buffer_load_dwordx2 v[14:15], v0, s[4:7], s32 offen offset:1536 sc1
    s_lshl_b32 s50, s22, 7
    s_add_u32 s50, s50, s23
    s_lshl_b32 s50, s50, 8
    s_add_u32 s50, s50, 0x4508000
    s_add_u32 s50, s50, s4
    s_addc_u32 s51, s5, 0
    s_waitcnt vmcnt(12) lgkmcnt(3)
    v_mfma_f32_16x16x32_bf16 v[16:19], v[80:83], v[160:163], 0
    ds_read_b128 v[120:123], v1 offset:7168
    v_mfma_f32_16x16x32_bf16 v[44:47], v[80:83], v[164:167], 0
    ds_read_b128 v[124:127], v1 offset:8192
    v_mfma_f32_16x16x32_bf16 v[20:23], v[84:87], v[160:163], 0
    ds_read_b128 v[128:131], v1 offset:9216
    v_mfma_f32_16x16x32_bf16 v[48:51], v[84:87], v[164:167], 0
    ds_read_b128 v[132:135], v1 offset:10240
    v_mfma_f32_16x16x32_bf16 v[24:27], v[88:91], v[160:163], 0
    ds_read_b128 v[136:139], v1 offset:11264
    v_mfma_f32_16x16x32_bf16 v[52:55], v[88:91], v[164:167], 0
    ds_read_b128 v[140:143], v1 offset:12288
    v_mfma_f32_16x16x32_bf16 v[28:31], v[92:95], v[160:163], 0
    ds_read_b128 v[144:147], v1 offset:13312
    v_mfma_f32_16x16x32_bf16 v[56:59], v[92:95], v[164:167], 0
    s_waitcnt lgkmcnt(7)
    v_mfma_f32_16x16x32_bf16 v[32:35], v[160:163], v[96:99], 0
    v_mfma_f32_16x16x32_bf16 v[60:63], v[164:167], v[96:99], 0
    v_mfma_f32_16x16x32_bf16 v[36:39], v[160:163], v[100:103], 0
    buffer_load_dwordx4 v[192:195], v1, s[4:7], s39 offen offset:0 sc1
    v_mfma_f32_16x16x32_bf16 v[64:67], v[164:167], v[100:103], 0
    buffer_load_dwordx4 v[196:199], v253, s[4:7], s39 offen offset:0 sc1
    v_mfma_f32_16x16x32_bf16 v[40:43], v[104:107], v[160:163], 0
    buffer_load_dwordx4 v[200:203], v1, s[4:7], s39 offen offset:1024 sc1
    v_mfma_f32_16x16x32_bf16 v[68:71], v[104:107], v[164:167], 0
    buffer_load_dwordx4 v[204:207], v253, s[4:7], s39 offen offset:1024 sc1
    s_waitcnt vmcnt(14) lgkmcnt(3)
    s_barrier
    v_mfma_f32_16x16x32_bf16 v[16:19], v[120:123], v[168:171], v[16:19]
    ds_read_b128 v[80:83], v1 offset:14336
    v_mfma_f32_16x16x32_bf16 v[44:47], v[120:123], v[172:175], v[44:47]
    ds_read_b128 v[84:87], v1 offset:15360
    v_mfma_f32_16x16x32_bf16 v[20:23], v[124:127], v[168:171], v[20:23]
    ds_read_b128 v[88:91], v1 offset:16384
    v_mfma_f32_16x16x32_bf16 v[48:51], v[124:127], v[172:175], v[48:51]
    ds_read_b128 v[92:95], v1 offset:17408
    v_mfma_f32_16x16x32_bf16 v[24:27], v[128:131], v[168:171], v[24:27]
    ds_read_b128 v[96:99], v1 offset:18432
    v_mfma_f32_16x16x32_bf16 v[52:55], v[128:131], v[172:175], v[52:55]
    ds_read_b128 v[100:103], v1 offset:19456
    v_mfma_f32_16x16x32_bf16 v[28:31], v[132:135], v[168:171], v[28:31]
    ds_read_b128 v[104:107], v1 offset:20480
    v_mfma_f32_16x16x32_bf16 v[56:59], v[132:135], v[172:175], v[56:59]
    ds_read_b128 v[108:111], v248 offset:0
    s_waitcnt lgkmcnt(8)
    v_mfma_f32_16x16x32_bf16 v[32:35], v[168:171], v[136:139], v[32:35]
    ds_read_b128 v[112:115], v249 offset:0
    v_mfma_f32_16x16x32_bf16 v[60:63], v[172:175], v[136:139], v[60:63]
    ds_read_b128 v[116:119], v251 offset:0
    v_mfma_f32_16x16x32_bf16 v[36:39], v[168:171], v[140:143], v[36:39]
    buffer_load_dwordx4 v[160:163], v1, s[4:7], s39 offen offset:2048 sc1
    v_mfma_f32_16x16x32_bf16 v[64:67], v[172:175], v[140:143], v[64:67]
    buffer_load_dwordx4 v[164:167], v253, s[4:7], s39 offen offset:2048 sc1
    v_mfma_f32_16x16x32_bf16 v[40:43], v[144:147], v[168:171], v[40:43]
    v_mfma_f32_16x16x32_bf16 v[68:71], v[144:147], v[172:175], v[68:71]
    s_waitcnt vmcnt(6) lgkmcnt(6)
    v_mfma_f32_16x16x32_bf16 v[16:19], v[80:83], v[176:179], v[16:19]
    ds_read_b128 v[120:123], v1 offset:21504
    v_mfma_f32_16x16x32_bf16 v[44:47], v[80:83], v[180:183], v[44:47]
    ds_read_b128 v[124:127], v1 offset:22528
    v_add_f32 v240, v4, v6
    v_mfma_f32_16x16x32_bf16 v[20:23], v[84:87], v[176:179], v[20:23]
    ds_read_b128 v[128:131], v1 offset:23552
    v_add_f32 v241, v5, v7
    v_mfma_f32_16x16x32_bf16 v[48:51], v[84:87], v[180:183], v[48:51]
    ds_read_b128 v[132:135], v1 offset:24576
    v_add_f32 v242, v8, v10
    v_mfma_f32_16x16x32_bf16 v[24:27], v[88:91], v[176:179], v[24:27]
    ds_read_b128 v[136:139], v1 offset:25600
    v_add_f32 v243, v9, v11
    v_mfma_f32_16x16x32_bf16 v[52:55], v[88:91], v[180:183], v[52:55]
    ds_read_b128 v[140:143], v1 offset:26624
    v_add_f32 v244, v12, v14
    v_mfma_f32_16x16x32_bf16 v[28:31], v[92:95], v[176:179], v[28:31]
    ds_read_b128 v[144:147], v1 offset:27648
    v_add_f32 v245, v13, v15
    v_mfma_f32_16x16x32_bf16 v[56:59], v[92:95], v[180:183], v[56:59]
    ds_read_b128 v[148:151], v248 offset:1024
    s_waitcnt lgkmcnt(8)
    v_mfma_f32_16x16x32_bf16 v[32:35], v[176:179], v[96:99], v[32:35]
    ds_read_b128 v[152:155], v249 offset:7168
    v_mov_b32 v4, v240
    v_mfma_f32_16x16x32_bf16 v[60:63], v[180:183], v[96:99], v[60:63]
    ds_read_b128 v[156:159], v251 offset:7168
    v_mov_b32 v5, v241
    v_mfma_f32_16x16x32_bf16 v[36:39], v[176:179], v[100:103], v[36:39]
    buffer_load_dwordx4 v[168:171], v1, s[4:7], s39 offen offset:3072 sc1
    v_mfma_f32_16x16x32_bf16 v[64:67], v[180:183], v[100:103], v[64:67]
    buffer_load_dwordx4 v[172:175], v253, s[4:7], s39 offen offset:3072 sc1
    v_mfma_f32_16x16x32_bf16 v[40:43], v[104:107], v[176:179], v[40:43]
    v_mov_b32 v8, v242
    v_mfma_f32_16x16x32_bf16 v[68:71], v[104:107], v[180:183], v[68:71]
    v_mov_b32 v9, v243
    v_mfma_f32_16x16x32_bf16 v[72:75], v[112:115], v[108:111], 0
    v_mov_b32 v12, v244
    v_mov_b32 v13, v245
    v_mfma_f32_16x16x32_bf16 v[76:79], v[108:111], v[116:119], 0
    v_permlane32_swap_b32 v240, v4
    s_waitcnt vmcnt(8) lgkmcnt(6)
    s_barrier
    v_mfma_f32_16x16x32_bf16 v[16:19], v[120:123], v[184:187], v[16:19]
    ds_read_b128 v[80:83], v1 offset:28672
    v_mfma_f32_16x16x32_bf16 v[44:47], v[120:123], v[188:191], v[44:47]
    ds_read_b128 v[84:87], v1 offset:29696
    v_permlane32_swap_b32 v241, v5
    v_mfma_f32_16x16x32_bf16 v[20:23], v[124:127], v[184:187], v[20:23]
    ds_read_b128 v[88:91], v1 offset:30720
    v_permlane32_swap_b32 v242, v8
    v_mfma_f32_16x16x32_bf16 v[48:51], v[124:127], v[188:191], v[48:51]
    ds_read_b128 v[92:95], v1 offset:31744
    v_permlane32_swap_b32 v243, v9
    v_mfma_f32_16x16x32_bf16 v[24:27], v[128:131], v[184:187], v[24:27]
    ds_read_b128 v[96:99], v1 offset:32768
    v_permlane32_swap_b32 v244, v12
    v_mfma_f32_16x16x32_bf16 v[52:55], v[128:131], v[188:191], v[52:55]
    ds_read_b128 v[100:103], v1 offset:33792
    v_permlane32_swap_b32 v245, v13
    v_mfma_f32_16x16x32_bf16 v[28:31], v[132:135], v[184:187], v[28:31]
    ds_read_b128 v[104:107], v1 offset:34816
    v_add_f32 v240, v240, v4
    v_mfma_f32_16x16x32_bf16 v[56:59], v[132:135], v[188:191], v[56:59]
    ds_read_b128 v[108:111], v248 offset:2048
    s_waitcnt lgkmcnt(8)
    v_mfma_f32_16x16x32_bf16 v[32:35], v[184:187], v[136:139], v[32:35]
    ds_read_b128 v[112:115], v249 offset:14336
    v_add_f32 v241, v241, v5
    v_mfma_f32_16x16x32_bf16 v[60:63], v[188:191], v[136:139], v[60:63]
    ds_read_b128 v[116:119], v251 offset:14336
    v_add_f32 v242, v242, v8
    v_mfma_f32_16x16x32_bf16 v[36:39], v[184:187], v[140:143], v[36:39]
    buffer_load_dwordx4 v[176:179], v1, s[4:7], s40 offen offset:0 sc1
    v_mfma_f32_16x16x32_bf16 v[64:67], v[188:191], v[140:143], v[64:67]
    buffer_load_dwordx4 v[180:183], v253, s[4:7], s40 offen offset:0 sc1
    v_mfma_f32_16x16x32_bf16 v[40:43], v[144:147], v[184:187], v[40:43]
    v_add_f32 v243, v243, v9
    v_mfma_f32_16x16x32_bf16 v[68:71], v[144:147], v[188:191], v[68:71]
    v_add_f32 v244, v244, v12
    v_mfma_f32_16x16x32_bf16 v[72:75], v[152:155], v[148:151], v[72:75]
    v_add_f32 v245, v245, v13
    v_mov_b32 v4, v240
    v_mfma_f32_16x16x32_bf16 v[76:79], v[148:151], v[156:159], v[76:79]
    v_mov_b32 v5, v241
    s_waitcnt vmcnt(8) lgkmcnt(6)
    v_mfma_f32_16x16x32_bf16 v[16:19], v[80:83], v[192:195], v[16:19]
    ds_read_b128 v[120:123], v1 offset:35840
    v_mfma_f32_16x16x32_bf16 v[44:47], v[80:83], v[196:199], v[44:47]
    ds_read_b128 v[124:127], v1 offset:36864
    v_mov_b32 v8, v242
    v_mfma_f32_16x16x32_bf16 v[20:23], v[84:87], v[192:195], v[20:23]
    ds_read_b128 v[128:131], v1 offset:37888
    v_mov_b32 v9, v243
    v_mfma_f32_16x16x32_bf16 v[48:51], v[84:87], v[196:199], v[48:51]
    ds_read_b128 v[132:135], v1 offset:38912
    v_mov_b32 v12, v244
    v_mfma_f32_16x16x32_bf16 v[24:27], v[88:91], v[192:195], v[24:27]
    ds_read_b128 v[136:139], v1 offset:39936
    v_mov_b32 v13, v245
    v_mfma_f32_16x16x32_bf16 v[52:55], v[88:91], v[196:199], v[52:55]
    ds_read_b128 v[140:143], v1 offset:40960
    v_permlane16_swap_b32 v240, v4
    v_mfma_f32_16x16x32_bf16 v[28:31], v[92:95], v[192:195], v[28:31]
    ds_read_b128 v[144:147], v1 offset:41984
    v_permlane16_swap_b32 v241, v5
    v_mfma_f32_16x16x32_bf16 v[56:59], v[92:95], v[196:199], v[56:59]
    ds_read_b128 v[148:151], v248 offset:3072
    s_waitcnt lgkmcnt(8)
    v_mfma_f32_16x16x32_bf16 v[32:35], v[192:195], v[96:99], v[32:35]
    ds_read_b128 v[152:155], v249 offset:21504
    v_permlane16_swap_b32 v242, v8
    v_mfma_f32_16x16x32_bf16 v[60:63], v[196:199], v[96:99], v[60:63]
    ds_read_b128 v[156:159], v251 offset:21504
    v_permlane16_swap_b32 v243, v9
    v_mfma_f32_16x16x32_bf16 v[36:39], v[192:195], v[100:103], v[36:39]
    buffer_load_dwordx4 v[184:187], v1, s[4:7], s40 offen offset:1024 sc1
    v_mfma_f32_16x16x32_bf16 v[64:67], v[196:199], v[100:103], v[64:67]
    buffer_load_dwordx4 v[188:191], v253, s[4:7], s40 offen offset:1024 sc1
    v_mfma_f32_16x16x32_bf16 v[40:43], v[104:107], v[192:195], v[40:43]
    v_permlane16_swap_b32 v244, v12
    v_mfma_f32_16x16x32_bf16 v[68:71], v[104:107], v[196:199], v[68:71]
    v_permlane16_swap_b32 v245, v13
    v_mfma_f32_16x16x32_bf16 v[72:75], v[112:115], v[108:111], v[72:75]
    v_add_f32 v240, v240, v4
    v_add_f32 v241, v241, v5
    v_mfma_f32_16x16x32_bf16 v[76:79], v[108:111], v[116:119], v[76:79]
    v_add_f32 v242, v242, v8
    s_waitcnt vmcnt(8) lgkmcnt(6)
    s_barrier
    v_mfma_f32_16x16x32_bf16 v[16:19], v[120:123], v[200:203], v[16:19]
    ds_read_b128 v[80:83], v1 offset:43008
    v_mfma_f32_16x16x32_bf16 v[44:47], v[120:123], v[204:207], v[44:47]
    ds_read_b128 v[84:87], v1 offset:44032
    v_add_f32 v243, v243, v9
    v_mfma_f32_16x16x32_bf16 v[20:23], v[124:127], v[200:203], v[20:23]
    ds_read_b128 v[88:91], v1 offset:45056
    v_add_f32 v244, v244, v12
    v_mfma_f32_16x16x32_bf16 v[48:51], v[124:127], v[204:207], v[48:51]
    ds_read_b128 v[92:95], v1 offset:46080
    v_add_f32 v245, v245, v13
    v_mfma_f32_16x16x32_bf16 v[24:27], v[128:131], v[200:203], v[24:27]
    ds_read_b128 v[96:99], v1 offset:47104
    v_mul_f32 v240, 0x3ae38e39, v240
    v_mfma_f32_16x16x32_bf16 v[52:55], v[128:131], v[204:207], v[52:55]
    ds_read_b128 v[100:103], v1 offset:48128
    v_mul_f32 v241, 0x3ae38e39, v241
    v_mfma_f32_16x16x32_bf16 v[28:31], v[132:135], v[200:203], v[28:31]
    ds_read_b128 v[104:107], v1 offset:49152
    v_mul_f32 v242, 0x3ae38e39, v242
    v_mfma_f32_16x16x32_bf16 v[56:59], v[132:135], v[204:207], v[56:59]
    ds_read_b128 v[108:111], v248 offset:4096
    s_waitcnt lgkmcnt(8)
    v_mfma_f32_16x16x32_bf16 v[32:35], v[200:203], v[136:139], v[32:35]
    ds_read_b128 v[112:115], v249 offset:28672
    v_mul_f32 v243, 0x3ae38e39, v243
    v_mfma_f32_16x16x32_bf16 v[60:63], v[204:207], v[136:139], v[60:63]
    ds_read_b128 v[116:119], v251 offset:28672
    v_mul_f32 v244, 0x3ae38e39, v244
    v_mfma_f32_16x16x32_bf16 v[36:39], v[200:203], v[140:143], v[36:39]
    buffer_load_dwordx4 v[192:195], v1, s[4:7], s40 offen offset:2048 sc1
    v_mfma_f32_16x16x32_bf16 v[64:67], v[204:207], v[140:143], v[64:67]
    buffer_load_dwordx4 v[196:199], v253, s[4:7], s40 offen offset:2048 sc1
    v_mfma_f32_16x16x32_bf16 v[40:43], v[144:147], v[200:203], v[40:43]
    v_mul_f32 v245, 0x3ae38e39, v245
    v_mfma_f32_16x16x32_bf16 v[68:71], v[144:147], v[204:207], v[68:71]
    v_fma_f32 v241, -v240, v240, v241
    v_mfma_f32_16x16x32_bf16 v[72:75], v[152:155], v[148:151], v[72:75]
    v_fma_f32 v243, -v242, v242, v243
    v_fma_f32 v245, -v244, v244, v245
    v_mfma_f32_16x16x32_bf16 v[76:79], v[148:151], v[156:159], v[76:79]
    v_max_f32 v241, 0, v241
    s_waitcnt vmcnt(8) lgkmcnt(6)
    v_mfma_f32_16x16x32_bf16 v[16:19], v[80:83], v[160:163], v[16:19]
    ds_read_b128 v[120:123], v1 offset:50176
    v_mfma_f32_16x16x32_bf16 v[44:47], v[80:83], v[164:167], v[44:47]
    ds_read_b128 v[124:127], v1 offset:51200
    v_max_f32 v243, 0, v243
    v_mfma_f32_16x16x32_bf16 v[20:23], v[84:87], v[160:163], v[20:23]
    ds_read_b128 v[128:131], v1 offset:52224
    v_max_f32 v245, 0, v245
    v_mfma_f32_16x16x32_bf16 v[48:51], v[84:87], v[164:167], v[48:51]
    ds_read_b128 v[132:135], v1 offset:53248
    v_add_f32 v241, 0x3727c5ac, v241
    v_mfma_f32_16x16x32_bf16 v[24:27], v[88:91], v[160:163], v[24:27]
    ds_read_b128 v[136:139], v1 offset:54272
    v_add_f32 v243, 0x3727c5ac, v243
    v_mfma_f32_16x16x32_bf16 v[52:55], v[88:91], v[164:167], v[52:55]
    ds_read_b128 v[140:143], v1 offset:55296
    v_add_f32 v245, 0x3727c5ac, v245
    v_mfma_f32_16x16x32_bf16 v[28:31], v[92:95], v[160:163], v[28:31]
    ds_read_b128 v[144:147], v1 offset:56320
    v_rsq_f32 v241, v241
    v_mfma_f32_16x16x32_bf16 v[56:59], v[92:95], v[164:167], v[56:59]
    ds_read_b128 v[148:151], v248 offset:5120
    s_waitcnt lgkmcnt(8)
    v_mfma_f32_16x16x32_bf16 v[32:35], v[160:163], v[96:99], v[32:35]
    ds_read_b128 v[152:155], v249 offset:35840
    v_rsq_f32 v243, v243
    v_mfma_f32_16x16x32_bf16 v[60:63], v[164:167], v[96:99], v[60:63]
    ds_read_b128 v[156:159], v251 offset:35840
    v_rsq_f32 v245, v245
    v_mfma_f32_16x16x32_bf16 v[36:39], v[160:163], v[100:103], v[36:39]
    buffer_load_dwordx4 v[200:203], v1, s[4:7], s40 offen offset:3072 sc1
    v_mfma_f32_16x16x32_bf16 v[64:67], v[164:167], v[100:103], v[64:67]
    buffer_load_dwordx4 v[204:207], v253, s[4:7], s40 offen offset:3072 sc1
    v_mfma_f32_16x16x32_bf16 v[40:43], v[104:107], v[160:163], v[40:43]
    s_nop 0
    v_mfma_f32_16x16x32_bf16 v[68:71], v[104:107], v[164:167], v[68:71]
    v_lshlrev_b32 v255, 4, v3
    v_mfma_f32_16x16x32_bf16 v[72:75], v[112:115], v[108:111], v[72:75]
    v_add_u32 v236, 161792, v255
    s_lshl_b32 s36, s33, 6
    v_mfma_f32_16x16x32_bf16 v[76:79], v[108:111], v[116:119], v[76:79]
    v_add_u32 v237, s36, v236
    s_waitcnt vmcnt(8) lgkmcnt(6)
    v_mfma_f32_16x16x32_bf16 v[16:19], v[120:123], v[168:171], v[16:19]
    ds_read_b128 v[80:83], v1 offset:57344
    v_mfma_f32_16x16x32_bf16 v[44:47], v[120:123], v[172:175], v[44:47]
    ds_read_b128 v[84:87], v1 offset:58368
    v_lshlrev_b32 v254, 2, v2
    v_mfma_f32_16x16x32_bf16 v[20:23], v[124:127], v[168:171], v[20:23]
    ds_read_b128 v[88:91], v1 offset:59392
    v_add_u32 v238, 161792, v254
    v_mfma_f32_16x16x32_bf16 v[48:51], v[124:127], v[172:175], v[48:51]
    ds_read_b128 v[92:95], v1 offset:60416
    s_lshl_b32 s37, s34, 6
    v_mfma_f32_16x16x32_bf16 v[24:27], v[128:131], v[168:171], v[24:27]
    ds_read_b128 v[96:99], v1 offset:61440
    v_add_u32 v239, s37, v238
    v_mfma_f32_16x16x32_bf16 v[52:55], v[128:131], v[172:175], v[52:55]
    ds_read_b128 v[100:103], v1 offset:62464
    s_mul_i32 s36, s20, 3072
    v_mfma_f32_16x16x32_bf16 v[28:31], v[132:135], v[168:171], v[28:31]
    ds_read_b128 v[104:107], v1 offset:63488
    s_add_u32 s36, s36, 153600
    v_mfma_f32_16x16x32_bf16 v[56:59], v[132:135], v[172:175], v[56:59]
    ds_read_b128 v[108:111], v248 offset:6144
    s_waitcnt lgkmcnt(8)
    v_mfma_f32_16x16x32_bf16 v[32:35], v[168:171], v[136:139], v[32:35]
    ds_read_b128 v[112:115], v249 offset:43008
    v_add_u32 v254, s36, v254
    v_mfma_f32_16x16x32_bf16 v[60:63], v[172:175], v[136:139], v[60:63]
    ds_read_b128 v[116:119], v251 offset:43008
    v_add_u32 v255, s36, v255
    v_mfma_f32_16x16x32_bf16 v[36:39], v[168:171], v[140:143], v[36:39]
    buffer_load_dwordx4 v[160:163], v1, s[4:7], s41 offen offset:0 sc1
    v_mfma_f32_16x16x32_bf16 v[64:67], v[172:175], v[140:143], v[64:67]
    buffer_load_dwordx4 v[164:167], v253, s[4:7], s41 offen offset:0 sc1
    v_mfma_f32_16x16x32_bf16 v[40:43], v[144:147], v[168:171], v[40:43]
    v_mfma_f32_16x16x32_bf16 v[68:71], v[144:147], v[172:175], v[68:71]
    ds_write2_b32 v254, v240, v241 offset0:0 offset1:16
    v_mfma_f32_16x16x32_bf16 v[72:75], v[152:155], v[148:151], v[72:75]
    ds_write2_b32 v254, v242, v243 offset0:32 offset1:48
    v_mfma_f32_16x16x32_bf16 v[76:79], v[148:151], v[156:159], v[76:79]
    ds_write2_b32 v254, v244, v245 offset0:64 offset1:80
    s_waitcnt vmcnt(8) lgkmcnt(9)
    s_barrier
    v_mfma_f32_16x16x32_bf16 v[16:19], v[80:83], v[176:179], v[16:19]
    ds_read_b128 v[120:123], v247 offset:0
    v_mfma_f32_16x16x32_bf16 v[44:47], v[80:83], v[180:183], v[44:47]
    ds_read_b128 v[124:127], v247 offset:1024
    v_mfma_f32_16x16x32_bf16 v[20:23], v[84:87], v[176:179], v[20:23]
    ds_read_b128 v[128:131], v247 offset:2048
    v_mfma_f32_16x16x32_bf16 v[48:51], v[84:87], v[180:183], v[48:51]
    ds_read_b128 v[132:135], v247 offset:3072
    v_mfma_f32_16x16x32_bf16 v[24:27], v[88:91], v[176:179], v[24:27]
    ds_read_b128 v[136:139], v247 offset:4096
    v_mfma_f32_16x16x32_bf16 v[52:55], v[88:91], v[180:183], v[52:55]
    ds_read_b128 v[140:143], v247 offset:5120
    v_mfma_f32_16x16x32_bf16 v[28:31], v[92:95], v[176:179], v[28:31]
    ds_read_b128 v[144:147], v247 offset:6144
    v_mfma_f32_16x16x32_bf16 v[56:59], v[92:95], v[180:183], v[56:59]
    ds_read_b128 v[148:151], v248 offset:7168
    s_waitcnt lgkmcnt(8)
    v_mfma_f32_16x16x32_bf16 v[32:35], v[176:179], v[96:99], v[32:35]
    ds_read_b128 v[152:155], v249 offset:50176
    v_mfma_f32_16x16x32_bf16 v[60:63], v[180:183], v[96:99], v[60:63]
    ds_read_b128 v[156:159], v251 offset:50176
    v_mfma_f32_16x16x32_bf16 v[36:39], v[176:179], v[100:103], v[36:39]
    buffer_load_dwordx4 v[168:171], v1, s[4:7], s41 offen offset:1024 sc1
    ds_read_b128 v[208:211], v236 offset:0
    v_mfma_f32_16x16x32_bf16 v[64:67], v[180:183], v[100:103], v[64:67]
    buffer_load_dwordx4 v[172:175], v253, s[4:7], s41 offen offset:1024 sc1
    ds_read_b128 v[212:215], v236 offset:64
    v_mfma_f32_16x16x32_bf16 v[40:43], v[104:107], v[176:179], v[40:43]
    ds_read_b128 v[216:219], v236 offset:128
    v_mfma_f32_16x16x32_bf16 v[68:71], v[104:107], v[180:183], v[68:71]
    ds_read_b128 v[220:223], v236 offset:192
    v_mfma_f32_16x16x32_bf16 v[72:75], v[112:115], v[108:111], v[72:75]
    ds_read_b128 v[224:227], v236 offset:384
    v_mfma_f32_16x16x32_bf16 v[76:79], v[108:111], v[116:119], v[76:79]
    ds_read_b128 v[228:231], v237
    s_waitcnt vmcnt(8) lgkmcnt(12)
    v_mfma_f32_16x16x32_bf16 v[16:19], v[120:123], v[184:187], v[16:19]
    ds_read_b128 v[80:83], v247 offset:7168
    v_mfma_f32_16x16x32_bf16 v[44:47], v[120:123], v[188:191], v[44:47]
    ds_read_b128 v[84:87], v247 offset:8192
    v_mfma_f32_16x16x32_bf16 v[20:23], v[124:127], v[184:187], v[20:23]
    ds_read_b128 v[88:91], v247 offset:9216
    v_mfma_f32_16x16x32_bf16 v[48:51], v[124:127], v[188:191], v[48:51]
    ds_read_b128 v[92:95], v247 offset:10240
    v_mfma_f32_16x16x32_bf16 v[24:27], v[128:131], v[184:187], v[24:27]
    ds_read_b128 v[96:99], v247 offset:11264
    v_mfma_f32_16x16x32_bf16 v[52:55], v[128:131], v[188:191], v[52:55]
    ds_read_b128 v[100:103], v247 offset:12288
    v_mfma_f32_16x16x32_bf16 v[28:31], v[132:135], v[184:187], v[28:31]
    ds_read_b128 v[104:107], v247 offset:13312
    v_mfma_f32_16x16x32_bf16 v[56:59], v[132:135], v[188:191], v[56:59]
    ds_read_b128 v[108:111], v248 offset:8192
    s_waitcnt lgkmcnt(8)
    v_mfma_f32_16x16x32_bf16 v[32:35], v[184:187], v[136:139], v[32:35]
    ds_read_b128 v[112:115], v249 offset:57344
    v_mfma_f32_16x16x32_bf16 v[60:63], v[188:191], v[136:139], v[60:63]
    ds_read_b128 v[116:119], v251 offset:57344
    v_mfma_f32_16x16x32_bf16 v[36:39], v[184:187], v[140:143], v[36:39]
    buffer_load_dwordx4 v[176:179], v1, s[4:7], s41 offen offset:2048 sc1
    v_mfma_f32_16x16x32_bf16 v[64:67], v[188:191], v[140:143], v[64:67]
    buffer_load_dwordx4 v[180:183], v253, s[4:7], s41 offen offset:2048 sc1
    ds_read2_b32 v[232:233], v238 offset0:64 offset1:80
    v_mfma_f32_16x16x32_bf16 v[40:43], v[144:147], v[184:187], v[40:43]
    ds_read_b32 v234, v239
    v_mfma_f32_16x16x32_bf16 v[68:71], v[144:147], v[188:191], v[68:71]
    ds_read_b128 v[4:7], v255 offset:0
    v_mfma_f32_16x16x32_bf16 v[72:75], v[152:155], v[148:151], v[72:75]
    ds_read_b128 v[8:11], v255 offset:128
    v_mfma_f32_16x16x32_bf16 v[76:79], v[148:151], v[156:159], v[76:79]
    ds_read_b128 v[12:15], v255 offset:256
    s_waitcnt vmcnt(8) lgkmcnt(11)
    s_barrier
    v_mfma_f32_16x16x32_bf16 v[16:19], v[80:83], v[192:195], v[16:19]
    ds_read_b128 v[120:123], v247 offset:14336
    v_mfma_f32_16x16x32_bf16 v[44:47], v[80:83], v[196:199], v[44:47]
    ds_read_b128 v[124:127], v247 offset:15360
    v_mfma_f32_16x16x32_bf16 v[20:23], v[84:87], v[192:195], v[20:23]
    ds_read_b128 v[128:131], v247 offset:16384
    v_mfma_f32_16x16x32_bf16 v[48:51], v[84:87], v[196:199], v[48:51]
    ds_read_b128 v[132:135], v247 offset:17408
    v_mfma_f32_16x16x32_bf16 v[24:27], v[88:91], v[192:195], v[24:27]
    ds_read_b128 v[136:139], v247 offset:18432
    v_mfma_f32_16x16x32_bf16 v[52:55], v[88:91], v[196:199], v[52:55]
    ds_read_b128 v[140:143], v247 offset:19456
    v_mfma_f32_16x16x32_bf16 v[28:31], v[92:95], v[192:195], v[28:31]
    ds_read_b128 v[144:147], v247 offset:20480
    v_mfma_f32_16x16x32_bf16 v[56:59], v[92:95], v[196:199], v[56:59]
    ds_read_b128 v[148:151], v248 offset:9216
    s_waitcnt lgkmcnt(8)
    v_mfma_f32_16x16x32_bf16 v[32:35], v[192:195], v[96:99], v[32:35]
    ds_read_b128 v[152:155], v250 offset:0
    v_mfma_f32_16x16x32_bf16 v[60:63], v[196:199], v[96:99], v[60:63]
    ds_read_b128 v[156:159], v252 offset:0
    v_mfma_f32_16x16x32_bf16 v[36:39], v[192:195], v[100:103], v[36:39]
    buffer_load_dwordx4 v[184:187], v1, s[4:7], s41 offen offset:3072 sc1
    v_mfma_f32_16x16x32_bf16 v[64:67], v[196:199], v[100:103], v[64:67]
    buffer_load_dwordx4 v[188:191], v253, s[4:7], s41 offen offset:3072 sc1
    v_mfma_f32_16x16x32_bf16 v[40:43], v[104:107], v[192:195], v[40:43]
    v_mfma_f32_16x16x32_bf16 v[68:71], v[104:107], v[196:199], v[68:71]
    v_mfma_f32_16x16x32_bf16 v[72:75], v[112:115], v[108:111], v[72:75]
    v_mfma_f32_16x16x32_bf16 v[76:79], v[108:111], v[116:119], v[76:79]
    s_waitcnt vmcnt(8) lgkmcnt(6)
    v_mfma_f32_16x16x32_bf16 v[16:19], v[120:123], v[200:203], v[16:19]
    ds_read_b128 v[80:83], v247 offset:21504
    v_fma_f32 v32, -v8, v232, v32
    v_mfma_f32_16x16x32_bf16 v[44:47], v[120:123], v[204:207], v[44:47]
    ds_read_b128 v[84:87], v247 offset:22528
    v_fma_f32 v60, -v12, v232, v60
    v_mfma_f32_16x16x32_bf16 v[20:23], v[124:127], v[200:203], v[20:23]
    ds_read_b128 v[88:91], v247 offset:23552
    v_fma_f32 v36, -v8, v233, v36
    v_mfma_f32_16x16x32_bf16 v[48:51], v[124:127], v[204:207], v[48:51]
    ds_read_b128 v[92:95], v247 offset:24576
    v_fma_f32 v64, -v12, v233, v64
    v_mfma_f32_16x16x32_bf16 v[24:27], v[128:131], v[200:203], v[24:27]
    ds_read_b128 v[96:99], v247 offset:25600
    v_fma_f32 v40, -v242, v224, v40
    v_mfma_f32_16x16x32_bf16 v[52:55], v[128:131], v[204:207], v[52:55]
    ds_read_b128 v[100:103], v247 offset:26624
    v_fma_f32 v68, -v244, v224, v68
    v_mfma_f32_16x16x32_bf16 v[28:31], v[132:135], v[200:203], v[28:31]
    ds_read_b128 v[104:107], v247 offset:27648
    v_fma_f32 v72, -v240, v228, v72
    v_mfma_f32_16x16x32_bf16 v[56:59], v[132:135], v[204:207], v[56:59]
    ds_read_b128 v[108:111], v248 offset:10240
    s_waitcnt lgkmcnt(8)
    v_fma_f32 v76, -v4, v234, v76
    v_mfma_f32_16x16x32_bf16 v[32:35], v[200:203], v[136:139], v[32:35]
    ds_read_b128 v[112:115], v250 offset:7168
    v_fma_f32 v16, -v242, v208, v16
    v_mfma_f32_16x16x32_bf16 v[60:63], v[204:207], v[136:139], v[60:63]
    ds_read_b128 v[116:119], v252 offset:7168
    v_fma_f32 v44, -v244, v208, v44
    v_mfma_f32_16x16x32_bf16 v[36:39], v[200:203], v[140:143], v[36:39]
    buffer_load_dwordx4 v[192:195], v1, s[4:7], s42 offen offset:0 sc1
    v_fma_f32 v20, -v242, v212, v20
    v_mfma_f32_16x16x32_bf16 v[64:67], v[204:207], v[140:143], v[64:67]
    buffer_load_dwordx4 v[196:199], v253, s[4:7], s42 offen offset:0 sc1
    v_fma_f32 v48, -v244, v212, v48
    v_mfma_f32_16x16x32_bf16 v[40:43], v[144:147], v[200:203], v[40:43]
    v_fma_f32 v24, -v242, v216, v24
    v_mfma_f32_16x16x32_bf16 v[68:71], v[144:147], v[204:207], v[68:71]
    v_fma_f32 v52, -v244, v216, v52
    v_mfma_f32_16x16x32_bf16 v[72:75], v[152:155], v[148:151], v[72:75]
    v_fma_f32 v28, -v242, v220, v28
    v_mfma_f32_16x16x32_bf16 v[76:79], v[148:151], v[156:159], v[76:79]
    v_fma_f32 v56, -v244, v220, v56
    s_waitcnt vmcnt(8) lgkmcnt(6)
    s_barrier
    v_mfma_f32_16x16x32_bf16 v[16:19], v[80:83], v[160:163], v[16:19]
    ds_read_b128 v[120:123], v247 offset:28672
    v_fma_f32 v33, -v9, v232, v33
    v_mfma_f32_16x16x32_bf16 v[44:47], v[80:83], v[164:167], v[44:47]
    ds_read_b128 v[124:127], v247 offset:29696
    v_fma_f32 v61, -v13, v232, v61
    v_mfma_f32_16x16x32_bf16 v[20:23], v[84:87], v[160:163], v[20:23]
    ds_read_b128 v[128:131], v247 offset:30720
    v_fma_f32 v37, -v9, v233, v37
    v_mfma_f32_16x16x32_bf16 v[48:51], v[84:87], v[164:167], v[48:51]
    ds_read_b128 v[132:135], v247 offset:31744
    v_fma_f32 v65, -v13, v233, v65
    v_mfma_f32_16x16x32_bf16 v[24:27], v[88:91], v[160:163], v[24:27]
    ds_read_b128 v[136:139], v247 offset:32768
    v_fma_f32 v41, -v242, v225, v41
    v_mfma_f32_16x16x32_bf16 v[52:55], v[88:91], v[164:167], v[52:55]
    ds_read_b128 v[140:143], v247 offset:33792
    v_fma_f32 v69, -v244, v225, v69
    v_mfma_f32_16x16x32_bf16 v[28:31], v[92:95], v[160:163], v[28:31]
    ds_read_b128 v[144:147], v247 offset:34816
    v_fma_f32 v73, -v240, v229, v73
    v_mfma_f32_16x16x32_bf16 v[56:59], v[92:95], v[164:167], v[56:59]
    ds_read_b128 v[148:151], v248 offset:11264
    s_waitcnt lgkmcnt(8)
    v_fma_f32 v77, -v5, v234, v77
    v_mfma_f32_16x16x32_bf16 v[32:35], v[160:163], v[96:99], v[32:35]
    ds_read_b128 v[152:155], v250 offset:14336
    v_fma_f32 v17, -v242, v209, v17
    v_mfma_f32_16x16x32_bf16 v[60:63], v[164:167], v[96:99], v[60:63]
    ds_read_b128 v[156:159], v252 offset:14336
    v_fma_f32 v45, -v244, v209, v45
    v_mfma_f32_16x16x32_bf16 v[36:39], v[160:163], v[100:103], v[36:39]
    buffer_load_dwordx4 v[200:203], v1, s[4:7], s42 offen offset:1024 sc1
    v_fma_f32 v21, -v242, v213, v21
    v_mfma_f32_16x16x32_bf16 v[64:67], v[164:167], v[100:103], v[64:67]
    buffer_load_dwordx4 v[204:207], v253, s[4:7], s42 offen offset:1024 sc1
    v_fma_f32 v49, -v244, v213, v49
    v_mfma_f32_16x16x32_bf16 v[40:43], v[104:107], v[160:163], v[40:43]
    v_fma_f32 v25, -v242, v217, v25
    v_mfma_f32_16x16x32_bf16 v[68:71], v[104:107], v[164:167], v[68:71]
    v_fma_f32 v53, -v244, v217, v53
    v_mfma_f32_16x16x32_bf16 v[72:75], v[112:115], v[108:111], v[72:75]
    v_fma_f32 v29, -v242, v221, v29
    v_mfma_f32_16x16x32_bf16 v[76:79], v[108:111], v[116:119], v[76:79]
    v_fma_f32 v57, -v244, v221, v57
    s_waitcnt vmcnt(8) lgkmcnt(6)
    v_mfma_f32_16x16x32_bf16 v[16:19], v[120:123], v[168:171], v[16:19]
    ds_read_b128 v[80:83], v247 offset:35840
    v_fma_f32 v34, -v10, v232, v34
    v_mfma_f32_16x16x32_bf16 v[44:47], v[120:123], v[172:175], v[44:47]
    ds_read_b128 v[84:87], v247 offset:36864
    v_fma_f32 v62, -v14, v232, v62
    v_mfma_f32_16x16x32_bf16 v[20:23], v[124:127], v[168:171], v[20:23]
    ds_read_b128 v[88:91], v247 offset:37888
    v_fma_f32 v38, -v10, v233, v38
    v_mfma_f32_16x16x32_bf16 v[48:51], v[124:127], v[172:175], v[48:51]
    ds_read_b128 v[92:95], v247 offset:38912
    v_fma_f32 v66, -v14, v233, v66
    v_mfma_f32_16x16x32_bf16 v[24:27], v[128:131], v[168:171], v[24:27]
    ds_read_b128 v[96:99], v247 offset:39936
    v_fma_f32 v42, -v242, v226, v42
    v_mfma_f32_16x16x32_bf16 v[52:55], v[128:131], v[172:175], v[52:55]
    ds_read_b128 v[100:103], v247 offset:40960
    v_fma_f32 v70, -v244, v226, v70
    v_mfma_f32_16x16x32_bf16 v[28:31], v[132:135], v[168:171], v[28:31]
    ds_read_b128 v[104:107], v247 offset:41984
    v_fma_f32 v74, -v240, v230, v74
    v_mfma_f32_16x16x32_bf16 v[56:59], v[132:135], v[172:175], v[56:59]
    ds_read_b128 v[108:111], v248 offset:12288
    s_waitcnt lgkmcnt(8)
    v_fma_f32 v78, -v6, v234, v78
    v_mfma_f32_16x16x32_bf16 v[32:35], v[168:171], v[136:139], v[32:35]
    ds_read_b128 v[112:115], v250 offset:21504
    v_fma_f32 v18, -v242, v210, v18
    v_mfma_f32_16x16x32_bf16 v[60:63], v[172:175], v[136:139], v[60:63]
    ds_read_b128 v[116:119], v252 offset:21504
    v_fma_f32 v46, -v244, v210, v46
    v_mfma_f32_16x16x32_bf16 v[36:39], v[168:171], v[140:143], v[36:39]
    v_fma_f32 v22, -v242, v214, v22
    v_mfma_f32_16x16x32_bf16 v[64:67], v[172:175], v[140:143], v[64:67]
    v_fma_f32 v50, -v244, v214, v50
    v_mfma_f32_16x16x32_bf16 v[40:43], v[144:147], v[168:171], v[40:43]
    v_fma_f32 v26, -v242, v218, v26
    v_mfma_f32_16x16x32_bf16 v[68:71], v[144:147], v[172:175], v[68:71]
    v_fma_f32 v54, -v244, v218, v54
    v_mfma_f32_16x16x32_bf16 v[72:75], v[152:155], v[148:151], v[72:75]
    v_fma_f32 v30, -v242, v222, v30
    v_mfma_f32_16x16x32_bf16 v[76:79], v[148:151], v[156:159], v[76:79]
    v_fma_f32 v58, -v244, v222, v58
    s_waitcnt vmcnt(6) lgkmcnt(6)
    v_mfma_f32_16x16x32_bf16 v[16:19], v[80:83], v[176:179], v[16:19]
    ds_read_b128 v[120:123], v247 offset:43008
    v_fma_f32 v35, -v11, v232, v35
    v_mfma_f32_16x16x32_bf16 v[44:47], v[80:83], v[180:183], v[44:47]
    ds_read_b128 v[124:127], v247 offset:44032
    v_fma_f32 v63, -v15, v232, v63
    v_mfma_f32_16x16x32_bf16 v[20:23], v[84:87], v[176:179], v[20:23]
    ds_read_b128 v[128:131], v247 offset:45056
    v_fma_f32 v39, -v11, v233, v39
    v_mfma_f32_16x16x32_bf16 v[48:51], v[84:87], v[180:183], v[48:51]
    ds_read_b128 v[132:135], v247 offset:46080
    v_fma_f32 v67, -v15, v233, v67
    v_mfma_f32_16x16x32_bf16 v[24:27], v[88:91], v[176:179], v[24:27]
    ds_read_b128 v[136:139], v247 offset:47104
    v_fma_f32 v43, -v242, v227, v43
    v_mfma_f32_16x16x32_bf16 v[52:55], v[88:91], v[180:183], v[52:55]
    ds_read_b128 v[140:143], v247 offset:48128
    v_fma_f32 v71, -v244, v227, v71
    v_mfma_f32_16x16x32_bf16 v[28:31], v[92:95], v[176:179], v[28:31]
    ds_read_b128 v[144:147], v247 offset:49152
    v_fma_f32 v75, -v240, v231, v75
    v_mfma_f32_16x16x32_bf16 v[56:59], v[92:95], v[180:183], v[56:59]
    ds_read_b128 v[148:151], v248 offset:13312
    s_waitcnt lgkmcnt(8)
    v_fma_f32 v79, -v7, v234, v79
    v_mfma_f32_16x16x32_bf16 v[32:35], v[176:179], v[96:99], v[32:35]
    ds_read_b128 v[152:155], v250 offset:28672
    v_fma_f32 v19, -v242, v211, v19
    v_mfma_f32_16x16x32_bf16 v[60:63], v[180:183], v[96:99], v[60:63]
    ds_read_b128 v[156:159], v252 offset:28672
    v_fma_f32 v47, -v244, v211, v47
    v_mfma_f32_16x16x32_bf16 v[36:39], v[176:179], v[100:103], v[36:39]
    v_fma_f32 v23, -v242, v215, v23
    v_mfma_f32_16x16x32_bf16 v[64:67], v[180:183], v[100:103], v[64:67]
    v_fma_f32 v51, -v244, v215, v51
    v_mfma_f32_16x16x32_bf16 v[40:43], v[104:107], v[176:179], v[40:43]
    v_fma_f32 v27, -v242, v219, v27
    v_mfma_f32_16x16x32_bf16 v[68:71], v[104:107], v[180:183], v[68:71]
    v_fma_f32 v55, -v244, v219, v55
    v_mfma_f32_16x16x32_bf16 v[72:75], v[112:115], v[108:111], v[72:75]
    v_fma_f32 v31, -v242, v223, v31
    v_mfma_f32_16x16x32_bf16 v[76:79], v[108:111], v[116:119], v[76:79]
    v_fma_f32 v59, -v244, v223, v59
    s_waitcnt vmcnt(4) lgkmcnt(6)
    s_barrier
    v_mfma_f32_16x16x32_bf16 v[16:19], v[120:123], v[184:187], v[16:19]
    ds_read_b128 v[80:83], v247 offset:50176
    v_mfma_f32_16x16x32_bf16 v[44:47], v[120:123], v[188:191], v[44:47]
    ds_read_b128 v[84:87], v247 offset:51200
    v_and_b32 v4, 1, v2
    v_mfma_f32_16x16x32_bf16 v[20:23], v[124:127], v[184:187], v[20:23]
    ds_read_b128 v[88:91], v247 offset:52224
    v_lshl_add_u32 v5, v3, 2, v4
    v_mfma_f32_16x16x32_bf16 v[48:51], v[124:127], v[188:191], v[48:51]
    ds_read_b128 v[92:95], v247 offset:53248
    v_add_u32 v6, 2, v5
    v_mfma_f32_16x16x32_bf16 v[24:27], v[128:131], v[184:187], v[24:27]
    ds_read_b128 v[96:99], v247 offset:54272
    v_cmp_eq_u32 s[40:41], 1, v4
    v_mfma_f32_16x16x32_bf16 v[52:55], v[128:131], v[188:191], v[52:55]
    ds_read_b128 v[100:103], v247 offset:55296
    v_cmp_le_u32 s[42:43], v5, v2
    v_mfma_f32_16x16x32_bf16 v[28:31], v[132:135], v[184:187], v[28:31]
    ds_read_b128 v[104:107], v247 offset:56320
    v_cmp_le_u32 s[44:45], v6, v2
    v_mfma_f32_16x16x32_bf16 v[56:59], v[132:135], v[188:191], v[56:59]
    ds_read_b128 v[108:111], v248 offset:14336
    s_waitcnt lgkmcnt(8)
    v_mfma_f32_16x16x32_bf16 v[32:35], v[184:187], v[136:139], v[32:35]
    ds_read_b128 v[112:115], v250 offset:35840
    v_mov_b32 v4, 0x0c0c0100
    v_mfma_f32_16x16x32_bf16 v[60:63], v[188:191], v[136:139], v[60:63]
    ds_read_b128 v[116:119], v252 offset:35840
    v_mov_b32 v5, 0x01000c0c
    v_mfma_f32_16x16x32_bf16 v[36:39], v[184:187], v[140:143], v[36:39]
    v_mov_b32 v6, 0x0c0c0302
    v_mov_b32 v7, 0x03020c0c
    v_mfma_f32_16x16x32_bf16 v[64:67], v[188:191], v[140:143], v[64:67]
    v_mov_b32 v8, 0x0c0c0c0c
    v_cndmask_b32 v4, v4, v5, s[40:41]
    v_mfma_f32_16x16x32_bf16 v[40:43], v[144:147], v[184:187], v[40:43]
    v_cndmask_b32 v6, v6, v7, s[40:41]
    v_cndmask_b32 v12, v4, v8, s[42:43]
    v_mfma_f32_16x16x32_bf16 v[68:71], v[144:147], v[188:191], v[68:71]
    v_cndmask_b32 v13, v6, v8, s[44:45]
    v_cndmask_b32 v14, v8, v4, s[42:43]
    v_mfma_f32_16x16x32_bf16 v[72:75], v[152:155], v[148:151], v[72:75]
    v_cndmask_b32 v15, v8, v6, s[44:45]
    s_cmp_eq_u32 s31, 0
    v_mfma_f32_16x16x32_bf16 v[76:79], v[148:151], v[156:159], v[76:79]
    s_cselect_b64 s[48:49], s[42:43], -1
    s_cselect_b64 s[38:39], s[44:45], -1
    s_waitcnt vmcnt(2) lgkmcnt(6)
    v_mfma_f32_16x16x32_bf16 v[16:19], v[80:83], v[192:195], v[16:19]
    ds_read_b128 v[120:123], v247 offset:57344
    v_mfma_f32_16x16x32_bf16 v[44:47], v[80:83], v[196:199], v[44:47]
    ds_read_b128 v[124:127], v247 offset:58368
    s_mul_i32 s36, s20, 3072
    v_mfma_f32_16x16x32_bf16 v[20:23], v[84:87], v[192:195], v[20:23]
    ds_read_b128 v[128:131], v247 offset:59392
    s_add_u32 s36, s36, 149504
    v_mfma_f32_16x16x32_bf16 v[48:51], v[84:87], v[196:199], v[48:51]
    ds_read_b128 v[132:135], v247 offset:60416
    v_add_u32 v9, s36, v0
    v_mfma_f32_16x16x32_bf16 v[24:27], v[88:91], v[192:195], v[24:27]
    ds_read_b128 v[136:139], v247 offset:61440
    s_lshl_b32 s37, s20, 9
    v_mfma_f32_16x16x32_bf16 v[52:55], v[88:91], v[196:199], v[52:55]
    ds_read_b128 v[140:143], v247 offset:62464
    s_add_u32 s37, s37, 149504
    v_mfma_f32_16x16x32_bf16 v[28:31], v[92:95], v[192:195], v[28:31]
    ds_read_b128 v[144:147], v247 offset:63488
    v_add_u32 v10, s37, v0
    v_mfma_f32_16x16x32_bf16 v[56:59], v[92:95], v[196:199], v[56:59]
    ds_read_b128 v[148:151], v248 offset:15360
    s_waitcnt lgkmcnt(8)
    v_mfma_f32_16x16x32_bf16 v[32:35], v[192:195], v[96:99], v[32:35]
    ds_read_b128 v[152:155], v250 offset:43008
    v_lshlrev_b32 v4, 2, v3
    v_mfma_f32_16x16x32_bf16 v[60:63], v[196:199], v[96:99], v[60:63]
    ds_read_b128 v[156:159], v252 offset:43008
    v_sub_u32 v4, v2, v4
    v_mfma_f32_16x16x32_bf16 v[36:39], v[192:195], v[100:103], v[36:39]
    v_lshlrev_b32 v5, 4, v4
    v_lshrrev_b32 v4, 1, v4
    v_mfma_f32_16x16x32_bf16 v[64:67], v[196:199], v[100:103], v[64:67]
    v_mov_b32 v6, 0x3f80
    v_lshlrev_b32 v5, v5, v6
    v_mfma_f32_16x16x32_bf16 v[40:43], v[104:107], v[192:195], v[40:43]
    v_cmp_eq_u32 vcc, 0, v4
    v_cmp_eq_u32 s[46:47], 1, v4
    v_mfma_f32_16x16x32_bf16 v[68:71], v[104:107], v[196:199], v[68:71]
    ds_read_b128 v[208:211], v255 offset:64
    s_lshl_b32 s36, s24, 10
    v_add_u32 v4, s36, v1
    v_mfma_f32_16x16x32_bf16 v[72:75], v[112:115], v[108:111], v[72:75]
    ds_read_b128 v[212:215], v255 offset:192
    v_cndmask_b32 v234, 0, v5, vcc
    v_cndmask_b32 v235, 0, v5, s[46:47]
    v_mfma_f32_16x16x32_bf16 v[76:79], v[108:111], v[116:119], v[76:79]
    ds_read_b128 v[216:219], v255 offset:320
    v_add_u32 v5, 18432, v4
    s_lshl_b32 s36, s24, 7
    s_waitcnt vmcnt(0) lgkmcnt(9)
    v_mfma_f32_16x16x32_bf16 v[16:19], v[120:123], v[200:203], v[16:19]
    ds_read_b128 v[80:83], v248 offset:16384
    v_mfma_f32_16x16x32_bf16 v[44:47], v[120:123], v[204:207], v[44:47]
    ds_read_b128 v[84:87], v250 offset:50176
    s_add_u32 s36, s36, 16384
    v_mfma_f32_16x16x32_bf16 v[20:23], v[124:127], v[200:203], v[20:23]
    ds_read_b128 v[88:91], v252 offset:50176
    v_cmp_eq_u32 vcc, 2, v3
    v_mfma_f32_16x16x32_bf16 v[48:51], v[124:127], v[204:207], v[48:51]
    ds_read_b128 v[92:95], v248 offset:17408
    v_lshl_add_u32 v6, v2, 3, s36
    v_mfma_f32_16x16x32_bf16 v[24:27], v[128:131], v[200:203], v[24:27]
    ds_read_b128 v[96:99], v250 offset:57344
    v_bfrev_b32 v7, 1
    v_mfma_f32_16x16x32_bf16 v[52:55], v[128:131], v[204:207], v[52:55]
    ds_read_b128 v[100:103], v252 offset:57344
    v_cndmask_b32 v6, v7, v6, vcc
    v_mfma_f32_16x16x32_bf16 v[28:31], v[132:135], v[200:203], v[28:31]
    v_add_u32 v7, 18432, v6
    v_mov_b32 v106, 0
    v_mfma_f32_16x16x32_bf16 v[56:59], v[132:135], v[204:207], v[56:59]
    s_waitcnt lgkmcnt(6)
    v_mov_b32 v107, 0
    v_mfma_f32_16x16x32_bf16 v[32:35], v[200:203], v[136:139], v[32:35]
    v_mov_b32 v8, 0xf149f2ca
    v_mov_b32 v108, 0
    v_mfma_f32_16x16x32_bf16 v[60:63], v[204:207], v[136:139], v[60:63]
    s_mov_b32 s33, 0x3eae1a93
    v_mov_b32 v109, 0
    v_mfma_f32_16x16x32_bf16 v[36:39], v[200:203], v[140:143], v[36:39]
    v_mov_b32 v236, 0x3f803f80
    v_mov_b32 v237, 0x3f803f80
    v_mfma_f32_16x16x32_bf16 v[64:67], v[204:207], v[140:143], v[64:67]
    v_mov_b32 v238, 0x3f803f80
    v_mov_b32 v239, 0x3f803f80
    v_mfma_f32_16x16x32_bf16 v[40:43], v[144:147], v[200:203], v[40:43]
    v_mov_b32 v114, 0
    v_mfma_f32_16x16x32_bf16 v[68:71], v[144:147], v[204:207], v[68:71]
    v_mov_b32 v115, 0
    v_mfma_f32_16x16x32_bf16 v[72:75], v[152:155], v[148:151], v[72:75]
    v_mov_b32 v116, 0
    v_mfma_f32_16x16x32_bf16 v[76:79], v[148:151], v[156:159], v[76:79]
    v_mov_b32 v117, 0
    s_waitcnt lgkmcnt(0)
    v_mfma_f32_16x16x32_bf16 v[72:75], v[84:87], v[80:83], v[72:75]
    v_mfma_f32_16x16x32_bf16 v[76:79], v[80:83], v[88:91], v[76:79]
    v_mfma_f32_16x16x32_bf16 v[72:75], v[96:99], v[92:95], v[72:75]
    v_mfma_f32_16x16x32_bf16 v[76:79], v[92:95], v[100:103], v[76:79]
    v_pk_mul_f32 v[52:53], v[52:53], v[244:245] op_sel:[0,1] op_sel_hi:[1,1]
    v_pk_mul_f32 v[54:55], v[54:55], v[244:245] op_sel:[0,1] op_sel_hi:[1,1]
    v_pk_mul_f32 v[56:57], v[56:57], v[244:245] op_sel:[0,1] op_sel_hi:[1,1]
    v_pk_mul_f32 v[58:59], v[58:59], v[244:245] op_sel:[0,1] op_sel_hi:[1,1]
    v_pk_mul_f32 v[60:61], v[60:61], v[216:217]
    v_pk_mul_f32 v[62:63], v[62:63], v[218:219]
    v_pk_mul_f32 v[64:65], v[64:65], v[216:217]
    v_pk_mul_f32 v[66:67], v[66:67], v[218:219]
    v_pk_mul_f32 v[68:69], v[68:69], v[244:245] op_sel:[0,1] op_sel_hi:[1,1]
    v_pk_mul_f32 v[70:71], v[70:71], v[244:245] op_sel:[0,1] op_sel_hi:[1,1]
    v_pk_mul_f32 v[72:73], v[72:73], v[240:241] op_sel:[0,1] op_sel_hi:[1,1]
    v_pk_mul_f32 v[74:75], v[74:75], v[240:241] op_sel:[0,1] op_sel_hi:[1,1]
    v_pk_mul_f32 v[76:77], v[76:77], v[208:209]
    v_pk_mul_f32 v[78:79], v[78:79], v[210:211]
    v_cvt_pk_bf16_f32 v172, v52, v53
    v_cvt_pk_bf16_f32 v173, v54, v55
    v_cvt_pk_bf16_f32 v176, v56, v57
    v_cvt_pk_bf16_f32 v177, v58, v59
    v_cvt_pk_bf16_f32 v182, v60, v61
    v_cvt_pk_bf16_f32 v183, v62, v63
    v_cvt_pk_bf16_f32 v188, v64, v65
    v_cvt_pk_bf16_f32 v189, v66, v67
    v_cvt_pk_bf16_f32 v174, v68, v69
    v_cvt_pk_bf16_f32 v175, v70, v71
    v_cvt_pk_bf16_f32 v220, v72, v73
    v_cvt_pk_bf16_f32 v221, v74, v75
    v_cvt_pk_bf16_f32 v222, v76, v77
    v_cvt_pk_bf16_f32 v223, v78, v79
    s_cmp_eq_u32 s20, 3
    s_cbranch_scc1 L_a_nw
    ds_write2st64_b64 v9, v[172:173], v[174:175] offset0:6 offset1:7
    ds_write2st64_b64 v9, v[176:177], v[182:183] offset0:8 offset1:9
    ds_write_b64 v9, v[188:189] offset:5120
    ds_write2st64_b64 v10, v[220:221], v[222:223] offset0:0 offset1:3
L_a_nw:
    v_pk_mul_f32 v[24:25], v[24:25], v[242:243] op_sel:[0,1] op_sel_hi:[1,1]
    v_pk_mul_f32 v[26:27], v[26:27], v[242:243] op_sel:[0,1] op_sel_hi:[1,1]
    v_pk_mul_f32 v[28:29], v[28:29], v[242:243] op_sel:[0,1] op_sel_hi:[1,1]
    v_pk_mul_f32 v[30:31], v[30:31], v[242:243] op_sel:[0,1] op_sel_hi:[1,1]
    v_pk_mul_f32 v[32:33], v[32:33], v[212:213]
    v_pk_mul_f32 v[34:35], v[34:35], v[214:215]
    v_pk_mul_f32 v[36:37], v[36:37], v[212:213]
    v_pk_mul_f32 v[38:39], v[38:39], v[214:215]
    v_pk_mul_f32 v[40:41], v[40:41], v[242:243] op_sel:[0,1] op_sel_hi:[1,1]
    v_pk_mul_f32 v[42:43], v[42:43], v[242:243] op_sel:[0,1] op_sel_hi:[1,1]
    v_cvt_pk_bf16_f32 v166, v24, v25
    v_cvt_pk_bf16_f32 v167, v26, v27
    v_cvt_pk_bf16_f32 v170, v28, v29
    v_cvt_pk_bf16_f32 v171, v30, v31
    v_cvt_pk_bf16_f32 v180, v32, v33
    v_cvt_pk_bf16_f32 v181, v34, v35
    v_cvt_pk_bf16_f32 v186, v36, v37
    v_cvt_pk_bf16_f32 v187, v38, v39
    v_cvt_pk_bf16_f32 v168, v40, v41
    v_cvt_pk_bf16_f32 v169, v42, v43
    s_waitcnt lgkmcnt(0)
    s_barrier
    ds_read2st64_b64 v[160:163], v9 offset0:0 offset1:1
    ds_read_b64 v[164:165], v9 offset:1024
    ds_read_b64 v[178:179], v9 offset:1536
    ds_read_b64 v[184:185], v9 offset:2048
    v_mfma_f32_16x16x16_bf16 v[128:131], v[174:175], v[234:235], 0
    v_mfma_f32_16x16x16_bf16 v[124:127], v[168:169], v[234:235], 0
    v_pk_mul_f32 v[44:45], v[44:45], v[244:245] op_sel:[0,1] op_sel_hi:[1,1]
    v_pk_mul_f32 v[46:47], v[46:47], v[244:245] op_sel:[0,1] op_sel_hi:[1,1]
    v_pk_mul_f32 v[48:49], v[48:49], v[244:245] op_sel:[0,1] op_sel_hi:[1,1]
    v_pk_mul_f32 v[50:51], v[50:51], v[244:245] op_sel:[0,1] op_sel_hi:[1,1]
    v_pk_mul_f32 v[16:17], v[16:17], v[242:243] op_sel:[0,1] op_sel_hi:[1,1]
    v_pk_mul_f32 v[18:19], v[18:19], v[242:243] op_sel:[0,1] op_sel_hi:[1,1]
    v_pk_mul_f32 v[20:21], v[20:21], v[242:243] op_sel:[0,1] op_sel_hi:[1,1]
    v_pk_mul_f32 v[22:23], v[22:23], v[242:243] op_sel:[0,1] op_sel_hi:[1,1]
    v_cvt_pk_bf16_f32 v112, v44, v45
    v_cvt_pk_bf16_f32 v113, v46, v47
    v_cvt_pk_bf16_f32 v118, v48, v49
    v_cvt_pk_bf16_f32 v119, v50, v51
    v_cvt_pk_bf16_f32 v104, v16, v17
    v_cvt_pk_bf16_f32 v105, v18, v19
    v_cvt_pk_bf16_f32 v110, v20, v21
    v_cvt_pk_bf16_f32 v111, v22, v23
    v_permlane16_swap_b32 v114, v174
    v_permlane16_swap_b32 v117, v175
    v_permlane16_swap_b32 v106, v168
    v_permlane16_swap_b32 v109, v169
    s_waitcnt lgkmcnt(0)
    v_mfma_f32_16x16x16_bf16 v[120:123], v[162:163], v[234:235], 0
    v_mfma_f32_16x16x32_bf16 v[20:23], v[172:175], v[112:115], 0
    v_mfma_f32_16x16x32_bf16 v[16:19], v[166:169], v[112:115], 0
    v_mfma_f32_16x16x32_bf16 v[28:31], v[174:177], v[116:119], 0
    v_mfma_f32_16x16x32_bf16 v[24:27], v[168:171], v[116:119], 0
    v_mfma_f32_16x16x32_bf16 v[36:39], v[166:169], v[104:107], 0
    v_mfma_f32_16x16x32_bf16 v[32:35], v[160:163], v[104:107], 0
    v_mfma_f32_16x16x32_bf16 v[44:47], v[168:171], v[108:111], 0
    v_mfma_f32_16x16x32_bf16 v[40:43], v[162:165], v[108:111], 0
    v_cvt_pk_bf16_f32 v194, v128, v129
    v_cvt_pk_bf16_f32 v195, v130, v131
    v_cvt_pk_bf16_f32 v192, v124, v125
    v_cvt_pk_bf16_f32 v193, v126, v127
    v_cvt_pk_bf16_f32 v190, v120, v121
    v_cvt_pk_bf16_f32 v191, v122, v123
    v_cndmask_b32 v20, v20, v21, s[40:41]
    v_cndmask_b32 v16, v16, v17, s[40:41]
    v_cndmask_b32 v48, v16, v20, s[42:43]
    v_cndmask_b32 v22, v22, v23, s[40:41]
    v_cndmask_b32 v18, v18, v19, s[40:41]
    v_cndmask_b32 v49, v18, v22, s[44:45]
    v_max_f32 v56, v48, v49
    v_cndmask_b32 v28, v28, v29, s[40:41]
    v_cndmask_b32 v24, v24, v25, s[40:41]
    v_cndmask_b32 v50, v24, v28, s[42:43]
    v_cndmask_b32 v30, v30, v31, s[40:41]
    v_cndmask_b32 v26, v26, v27, s[40:41]
    v_cndmask_b32 v51, v26, v30, s[44:45]
    v_max_f32 v57, v50, v51
    v_cndmask_b32 v36, v36, v37, s[40:41]
    v_cndmask_b32 v32, v32, v33, s[40:41]
    v_cndmask_b32 v52, v32, v36, s[42:43]
    v_cndmask_b32 v52, v8, v52, s[48:49]
    v_cndmask_b32 v38, v38, v39, s[40:41]
    v_cndmask_b32 v34, v34, v35, s[40:41]
    v_cndmask_b32 v53, v34, v38, s[44:45]
    v_cndmask_b32 v53, v8, v53, s[38:39]
    v_max_f32 v58, v52, v53
    v_permlane32_swap_b32 v56, v57
    v_max_f32 v56, v56, v57
    v_cndmask_b32 v44, v44, v45, s[40:41]
    v_cndmask_b32 v40, v40, v41, s[40:41]
    v_cndmask_b32 v54, v40, v44, s[42:43]
    v_cndmask_b32 v54, v8, v54, s[48:49]
    v_cndmask_b32 v46, v46, v47, s[40:41]
    v_cndmask_b32 v42, v42, v43, s[40:41]
    v_cndmask_b32 v55, v42, v46, s[44:45]
    v_cndmask_b32 v55, v8, v55, s[38:39]
    v_max_f32 v59, v54, v55
    s_nop 1
    v_permlane32_swap_b32 v58, v59
    v_max_f32 v58, v58, v59
    s_nop 1
    v_permlane16_swap_b32 v56, v58
    v_max_f32 v57, v56, v58
    v_mul_f32 v56, s33, v57
    v_mul_f32 v58, s33, v57
    s_nop 1
    v_permlane16_swap_b32 v56, v58
    v_mov_b32 v57, v56
    v_mov_b32 v59, v58
    s_nop 0
    v_permlane32_swap_b32 v56, v57
    v_permlane32_swap_b32 v58, v59
    v_fma_f32 v48, v48, s33, -v56
    v_fma_f32 v49, v49, s33, -v56
    v_fma_f32 v50, v50, s33, -v57
    v_fma_f32 v51, v51, s33, -v57
    v_fma_f32 v52, v52, s33, -v58
    v_fma_f32 v53, v53, s33, -v58
    v_fma_f32 v54, v54, s33, -v59
    v_fma_f32 v55, v55, s33, -v59
    v_exp_f32 v48, v48
    v_exp_f32 v49, v49
    v_exp_f32 v50, v50
    v_exp_f32 v51, v51
    v_exp_f32 v52, v52
    v_exp_f32 v53, v53
    v_exp_f32 v54, v54
    v_exp_f32 v55, v55
    v_cvt_pk_bf16_f32 v56, v48, v49
    v_cvt_pk_bf16_f32 v57, v50, v51
    v_cvt_pk_bf16_f32 v58, v52, v53
    v_cvt_pk_bf16_f32 v59, v54, v55
    v_perm_b32 v64, v56, v56, v12
    v_perm_b32 v65, v56, v56, v13
    v_perm_b32 v66, v56, v56, v14
    v_perm_b32 v67, v56, v56, v15
    v_perm_b32 v68, v57, v57, v12
    v_perm_b32 v69, v57, v57, v13
    v_perm_b32 v70, v57, v57, v14
    v_perm_b32 v71, v57, v57, v15
    v_perm_b32 v72, v58, v58, v12
    v_perm_b32 v73, v58, v58, v13
    v_perm_b32 v74, v58, v58, v14
    v_perm_b32 v75, v58, v58, v15
    v_perm_b32 v76, v59, v59, v12
    v_perm_b32 v77, v59, v59, v13
    v_perm_b32 v78, v59, v59, v14
    v_perm_b32 v79, v59, v59, v15
    v_mfma_f32_16x16x32_bf16 v[80:83], v[236:239], v[64:67], 0
    v_mfma_f32_16x16x32_bf16 v[84:87], v[236:239], v[68:71], 0
    v_mfma_f32_16x16x32_bf16 v[88:91], v[236:239], v[72:75], 0
    v_mfma_f32_16x16x32_bf16 v[92:95], v[236:239], v[76:79], 0
    v_mfma_f32_16x16x32_bf16 v[16:19], v[180:183], v[64:67], 0
    v_mfma_f32_16x16x32_bf16 v[20:23], v[192:195], v[64:67], 0
    v_mfma_f32_16x16x32_bf16 v[24:27], v[186:189], v[68:71], 0
    v_mfma_f32_16x16x32_bf16 v[28:31], v[192:195], v[68:71], 0
    v_mfma_f32_16x16x32_bf16 v[32:35], v[178:181], v[72:75], 0
    v_mfma_f32_16x16x32_bf16 v[36:39], v[190:193], v[72:75], 0
    v_mfma_f32_16x16x32_bf16 v[40:43], v[184:187], v[76:79], 0
    v_mfma_f32_16x16x32_bf16 v[44:47], v[190:193], v[76:79], 0
    v_rcp_f32 v80, v80
    v_rcp_f32 v84, v84
    v_rcp_f32 v88, v88
    v_rcp_f32 v92, v92
    v_pk_mul_f32 v[16:17], v[16:17], v[80:81] op_sel_hi:[1,0]
    v_pk_mul_f32 v[18:19], v[18:19], v[80:81] op_sel_hi:[1,0]
    v_pk_mul_f32 v[20:21], v[20:21], v[80:81] op_sel_hi:[1,0]
    v_pk_mul_f32 v[24:25], v[24:25], v[84:85] op_sel_hi:[1,0]
    v_pk_mul_f32 v[26:27], v[26:27], v[84:85] op_sel_hi:[1,0]
    v_pk_mul_f32 v[30:31], v[30:31], v[84:85] op_sel_hi:[1,0]
    v_cvt_pk_bf16_f32 v220, v16, v17
    v_cvt_pk_bf16_f32 v221, v18, v19
    v_cvt_pk_bf16_f32 v224, v20, v21
    v_cvt_pk_bf16_f32 v222, v24, v25
    v_cvt_pk_bf16_f32 v223, v26, v27
    v_cvt_pk_bf16_f32 v225, v30, v31
    buffer_store_dwordx4 v[220:223], v5, s[4:7], s35 offen sc1
    buffer_store_dwordx2 v[224:225], v7, s[4:7], s35 offen sc1
    v_pk_mul_f32 v[32:33], v[32:33], v[88:89] op_sel_hi:[1,0]
    v_pk_mul_f32 v[34:35], v[34:35], v[88:89] op_sel_hi:[1,0]
    v_pk_mul_f32 v[36:37], v[36:37], v[88:89] op_sel_hi:[1,0]
    v_pk_mul_f32 v[40:41], v[40:41], v[92:93] op_sel_hi:[1,0]
    v_pk_mul_f32 v[42:43], v[42:43], v[92:93] op_sel_hi:[1,0]
    v_pk_mul_f32 v[46:47], v[46:47], v[92:93] op_sel_hi:[1,0]
    v_cvt_pk_bf16_f32 v228, v32, v33
    v_cvt_pk_bf16_f32 v229, v34, v35
    v_cvt_pk_bf16_f32 v232, v36, v37
    v_cvt_pk_bf16_f32 v230, v40, v41
    v_cvt_pk_bf16_f32 v231, v42, v43
    v_cvt_pk_bf16_f32 v233, v46, v47
    buffer_store_dwordx4 v[228:231], v4, s[4:7], s35 offen sc1
    buffer_store_dwordx2 v[232:233], v6, s[4:7], s35 offen sc1
    s_and_b32 s25, s2, 7
    s_lshr_b32 s26, s2, 3
    s_lshr_b32 s23, s25, 1
    s_lshl_b32 s23, s23, 3
    s_lshr_b32 s27, s26, 2
    s_add_u32 s23, s23, s27
    s_and_b32 s24, s25, 1
    s_lshl_b32 s24, s24, 2
    s_and_b32 s27, s26, 3
    s_add_u32 s24, s24, s27
    s_add_u32 s25, s23, s24
    s_and_b32 s25, s25, 3
    s_lshl_b32 s30, s23, 2
    s_add_u32 s30, s30, s20
    s_mul_i32 s29, s30, 18432
    s_add_u32 s29, s29, s21
    s_add_u32 s29, s29, 0x600000
    s_mul_i32 s34, s30, 18432
    s_add_u32 s34, s34, s21
    s_add_u32 s34, s34, 0x0
    s_lshl_b32 s35, s24, 11
    s_lshr_b32 s36, s24, 2
    s_lshl_b32 s36, s36, 10
    s_and_b32 s37, s24, 3
    s_lshl_b32 s37, s37, 8
    s_add_u32 s36, s36, s37
    s_add_u32 s36, s36, 16384
    v_bfe_u32 v2, v1, 4, 4
    v_lshrrev_b32 v3, 8, v1
    v_add_u32 v4, s35, v1
    v_lshlrev_b32 v5, 4, v2
    v_lshl_add_u32 v5, v3, 3, v5
    v_add_u32 v5, s36, v5
    v_cmp_gt_u32 s[40:41], 2, v3
    v_bfrev_b32 v6, 1
    v_add_u32 v12, 0, v1
    v_add_u32 v13, 36864, v1
    v_add_u32 v14, 73728, v1
    v_add_u32 v15, 110592, v1
    v_cndmask_b32 v5, v6, v5, s[40:41]
    buffer_load_dwordx4 v[208:211], v4, s[4:7], s34 offen offset:0 sc1
    buffer_load_dwordx4 v[212:215], v4, s[4:7], s34 offen offset:1024 sc1
    buffer_load_dwordx2 v[216:217], v5, s[4:7], s34 offen sc1
    s_add_u32 s34, s34, 0x300000
    s_lshl_b32 s39, s30, 10
    s_add_u32 s39, s39, s21
    s_lshl_b32 s42, s24, 7
    s_add_u32 s39, s39, s42
    s_add_u32 s39, s39, 0x1b20000
    v_cmp_eq_u32 vcc, 0, v3
    v_lshlrev_b32 v10, 3, v2
    v_mov_b32 v11, 0x3f803f80
    v_lshl_add_u32 v7, v3, 8, v10
    v_cndmask_b32 v10, v6, v10, vcc
    s_lshr_b32 s44, s23, 1
    s_lshl_b32 s52, s22, 7
    s_add_u32 s52, s52, s44
    s_lshl_b32 s52, s52, 8
    s_add_u32 s52, s52, 0x4508000
    s_add_u32 s52, s52, s4
    s_addc_u32 s53, s5, 0
    s_waitcnt vmcnt(3)
    s_barrier
    s_cmp_lg_u32 s20, 0
    s_cbranch_scc1 L_ns_d2
    s_mov_b32 s56, 1
    s_atomic_add s56, s[50:51], 0
L_ns_d2:
    s_cmp_lg_u32 s20, 0
    s_cbranch_scc1 L_pd_d2
    s_mov_b32 s60, 65536
L_poll_d2:
    s_mov_b32 s57, 0
    s_atomic_add s57, s[52:53], 0 glc
    s_waitcnt lgkmcnt(0)
    s_cmp_ge_u32 s57, 16
    s_cbranch_scc1 L_pd_d2
    s_sub_u32 s60, s60, 1
    s_cbranch_scc1 L_pd_d2
    s_sleep 2
    s_branch L_poll_d2
L_pd_d2:
    s_barrier
    s_mov_b32 s32, 0
    s_lshl_b32 s32, s32, 13
    s_add_u32 s32, s32, s29
    s_add_u32 s33, s32, 4096
    buffer_load_dwordx4 v[112:115], v1, s[4:7], s32 offen offset:0 sc1
    buffer_load_dwordx4 v[116:119], v1, s[4:7], s32 offen offset:1024 sc1
    buffer_load_dwordx4 v[120:123], v1, s[4:7], s32 offen offset:2048 sc1
    buffer_load_dwordx4 v[124:127], v1, s[4:7], s32 offen offset:3072 sc1
    buffer_load_dwordx4 v[128:131], v1, s[4:7], s33 offen offset:0 sc1
    buffer_load_dwordx4 v[132:135], v1, s[4:7], s33 offen offset:1024 sc1
    buffer_load_dwordx4 v[136:139], v1, s[4:7], s33 offen offset:2048 sc1
    buffer_load_dwordx4 v[140:143], v1, s[4:7], s33 offen offset:3072 sc1
    ds_read_b128 v[40:43], v12 offset:18432
    ds_read_b128 v[44:47], v12 offset:19456
    ds_read_b128 v[48:51], v12 offset:20480
    ds_read_b128 v[52:55], v12 offset:21504
    ds_read_b128 v[72:75], v12 offset:26624
    ds_read_b128 v[56:59], v12 offset:22528
    ds_read_b128 v[60:63], v12 offset:23552
    ds_read_b128 v[64:67], v12 offset:24576
    ds_read_b128 v[68:71], v12 offset:25600
    s_add_u32 s45, s29, 8192
    s_add_u32 s46, s29, 12288
    s_add_u32 s47, s29, 16384
    buffer_load_dwordx4 v[144:147], v1, s[4:7], s45 offen offset:0 sc1
    buffer_load_dwordx4 v[148:151], v1, s[4:7], s45 offen offset:1024 sc1
    s_lshl_b32 s42, s23, 3
    s_add_u32 s42, s42, s24
    s_lshl_b32 s42, s42, 2
    s_add_u32 s42, s42, s20
    s_lshl_b32 s42, s42, 8
    s_add_u32 s42, s42, s21
    s_add_u32 s42, s42, 0x1b40000
    v_mov_b32 v220, -1.0
    v_lshrrev_b32 v221, 2, v1
    buffer_store_dword v220, v221, s[4:7], s42 offen sc1
    s_lshl_b32 s50, s22, 7
    s_add_u32 s50, s50, s44
    s_lshl_b32 s50, s50, 8
    s_add_u32 s50, s50, 0x4509000
    s_add_u32 s50, s50, s4
    s_addc_u32 s51, s5, 0
    s_waitcnt vmcnt(11)
    v_lshlrev_b32 v16, 16, v208
    v_and_b32 v17, 0xffff0000, v208
    v_lshlrev_b32 v18, 16, v209
    v_and_b32 v19, 0xffff0000, v209
    v_lshlrev_b32 v20, 16, v210
    v_and_b32 v21, 0xffff0000, v210
    v_lshlrev_b32 v22, 16, v211
    v_and_b32 v23, 0xffff0000, v211
    v_lshlrev_b32 v24, 16, v212
    v_and_b32 v25, 0xffff0000, v212
    v_lshlrev_b32 v26, 16, v213
    v_and_b32 v27, 0xffff0000, v213
    v_lshlrev_b32 v28, 16, v214
    v_and_b32 v29, 0xffff0000, v214
    v_lshlrev_b32 v30, 16, v215
    v_and_b32 v31, 0xffff0000, v215
    v_lshlrev_b32 v32, 16, v216
    v_and_b32 v33, 0xffff0000, v216
    v_lshlrev_b32 v34, 16, v217
    v_and_b32 v35, 0xffff0000, v217
    s_waitcnt vmcnt(9) lgkmcnt(4)
    v_mfma_f32_16x16x32_bf16 v[16:19], v[40:43], v[112:115], v[16:19]
    ds_read_b128 v[76:79], v12 offset:27648
    v_mfma_f32_16x16x32_bf16 v[20:23], v[44:47], v[112:115], v[20:23]
    ds_read_b128 v[80:83], v12 offset:28672
    buffer_load_dwordx4 v[152:155], v1, s[4:7], s45 offen offset:2048 sc1
    v_mfma_f32_16x16x32_bf16 v[24:27], v[48:51], v[112:115], v[24:27]
    ds_read_b128 v[84:87], v12 offset:29696
    v_mfma_f32_16x16x32_bf16 v[28:31], v[52:55], v[112:115], v[28:31]
    ds_read_b128 v[88:91], v12 offset:30720
    v_mfma_f32_16x16x32_bf16 v[32:35], v[72:75], v[112:115], v[32:35]
    ds_read_b128 v[108:111], v12 offset:35840
    s_waitcnt lgkmcnt(5)
    buffer_load_dwordx4 v[156:159], v1, s[4:7], s45 offen offset:3072 sc1
    v_mfma_f32_16x16x32_bf16 v[16:19], v[56:59], v[116:119], v[16:19]
    ds_read_b128 v[92:95], v12 offset:31744
    v_mfma_f32_16x16x32_bf16 v[20:23], v[60:63], v[116:119], v[20:23]
    ds_read_b128 v[96:99], v12 offset:32768
    v_mfma_f32_16x16x32_bf16 v[24:27], v[64:67], v[116:119], v[24:27]
    ds_read_b128 v[100:103], v12 offset:33792
    buffer_load_dwordx4 v[160:163], v1, s[4:7], s46 offen offset:0 sc1
    v_mfma_f32_16x16x32_bf16 v[28:31], v[68:71], v[116:119], v[28:31]
    ds_read_b128 v[104:107], v12 offset:34816
    v_mfma_f32_16x16x32_bf16 v[36:39], v[72:75], v[116:119], 0
    s_waitcnt vmcnt(10) lgkmcnt(4)
    v_mfma_f32_16x16x32_bf16 v[16:19], v[76:79], v[120:123], v[16:19]
    ds_read_b128 v[40:43], v13 offset:18432
    v_mfma_f32_16x16x32_bf16 v[20:23], v[80:83], v[120:123], v[20:23]
    ds_read_b128 v[44:47], v13 offset:19456
    buffer_load_dwordx4 v[164:167], v1, s[4:7], s46 offen offset:1024 sc1
    v_mfma_f32_16x16x32_bf16 v[24:27], v[84:87], v[120:123], v[24:27]
    ds_read_b128 v[48:51], v13 offset:20480
    v_mfma_f32_16x16x32_bf16 v[28:31], v[88:91], v[120:123], v[28:31]
    ds_read_b128 v[52:55], v13 offset:21504
    v_mfma_f32_16x16x32_bf16 v[32:35], v[108:111], v[120:123], v[32:35]
    ds_read_b128 v[72:75], v13 offset:26624
    s_waitcnt lgkmcnt(5)
    buffer_load_dwordx4 v[168:171], v1, s[4:7], s46 offen offset:2048 sc1
    v_mfma_f32_16x16x32_bf16 v[16:19], v[92:95], v[124:127], v[16:19]
    ds_read_b128 v[56:59], v13 offset:22528
    v_mfma_f32_16x16x32_bf16 v[20:23], v[96:99], v[124:127], v[20:23]
    ds_read_b128 v[60:63], v13 offset:23552
    v_mfma_f32_16x16x32_bf16 v[24:27], v[100:103], v[124:127], v[24:27]
    ds_read_b128 v[64:67], v13 offset:24576
    buffer_load_dwordx4 v[172:175], v1, s[4:7], s46 offen offset:3072 sc1
    v_mfma_f32_16x16x32_bf16 v[28:31], v[104:107], v[124:127], v[28:31]
    ds_read_b128 v[68:71], v13 offset:25600
    v_mfma_f32_16x16x32_bf16 v[36:39], v[108:111], v[124:127], v[36:39]
    s_waitcnt vmcnt(11) lgkmcnt(4)
    v_mfma_f32_16x16x32_bf16 v[16:19], v[40:43], v[128:131], v[16:19]
    ds_read_b128 v[76:79], v13 offset:27648
    v_mfma_f32_16x16x32_bf16 v[20:23], v[44:47], v[128:131], v[20:23]
    ds_read_b128 v[80:83], v13 offset:28672
    buffer_load_dwordx2 v[176:177], v7, s[4:7], s47 offen offset:0 sc1
    v_mfma_f32_16x16x32_bf16 v[24:27], v[48:51], v[128:131], v[24:27]
    ds_read_b128 v[84:87], v13 offset:29696
    v_mfma_f32_16x16x32_bf16 v[28:31], v[52:55], v[128:131], v[28:31]
    ds_read_b128 v[88:91], v13 offset:30720
    v_mfma_f32_16x16x32_bf16 v[32:35], v[72:75], v[128:131], v[32:35]
    ds_read_b128 v[108:111], v13 offset:35840
    s_waitcnt lgkmcnt(5)
    buffer_load_dwordx2 v[178:179], v7, s[4:7], s47 offen offset:128 sc1
    v_mfma_f32_16x16x32_bf16 v[16:19], v[56:59], v[132:135], v[16:19]
    ds_read_b128 v[92:95], v13 offset:31744
    v_mfma_f32_16x16x32_bf16 v[20:23], v[60:63], v[132:135], v[20:23]
    ds_read_b128 v[96:99], v13 offset:32768
    v_mfma_f32_16x16x32_bf16 v[24:27], v[64:67], v[132:135], v[24:27]
    ds_read_b128 v[100:103], v13 offset:33792
    buffer_load_dwordx2 v[180:181], v7, s[4:7], s47 offen offset:1024 sc1
    v_mfma_f32_16x16x32_bf16 v[28:31], v[68:71], v[132:135], v[28:31]
    ds_read_b128 v[104:107], v13 offset:34816
    v_mfma_f32_16x16x32_bf16 v[36:39], v[72:75], v[132:135], v[36:39]
    s_waitcnt vmcnt(12) lgkmcnt(4)
    v_mfma_f32_16x16x32_bf16 v[16:19], v[76:79], v[136:139], v[16:19]
    ds_read_b128 v[40:43], v14 offset:18432
    v_mfma_f32_16x16x32_bf16 v[20:23], v[80:83], v[136:139], v[20:23]
    ds_read_b128 v[44:47], v14 offset:19456
    buffer_load_dwordx2 v[182:183], v7, s[4:7], s47 offen offset:1152 sc1
    v_mfma_f32_16x16x32_bf16 v[24:27], v[84:87], v[136:139], v[24:27]
    ds_read_b128 v[48:51], v14 offset:20480
    v_mfma_f32_16x16x32_bf16 v[28:31], v[88:91], v[136:139], v[28:31]
    ds_read_b128 v[52:55], v14 offset:21504
    v_mfma_f32_16x16x32_bf16 v[32:35], v[108:111], v[136:139], v[32:35]
    ds_read_b128 v[72:75], v14 offset:26624
    s_waitcnt lgkmcnt(5)
    v_mfma_f32_16x16x32_bf16 v[16:19], v[92:95], v[140:143], v[16:19]
    ds_read_b128 v[56:59], v14 offset:22528
    v_mfma_f32_16x16x32_bf16 v[20:23], v[96:99], v[140:143], v[20:23]
    ds_read_b128 v[60:63], v14 offset:23552
    v_mfma_f32_16x16x32_bf16 v[24:27], v[100:103], v[140:143], v[24:27]
    ds_read_b128 v[64:67], v14 offset:24576
    v_mfma_f32_16x16x32_bf16 v[28:31], v[104:107], v[140:143], v[28:31]
    ds_read_b128 v[68:71], v14 offset:25600
    v_mfma_f32_16x16x32_bf16 v[36:39], v[108:111], v[140:143], v[36:39]
    s_waitcnt vmcnt(11) lgkmcnt(4)
    v_mfma_f32_16x16x32_bf16 v[16:19], v[40:43], v[144:147], v[16:19]
    ds_read_b128 v[76:79], v14 offset:27648
    v_mfma_f32_16x16x32_bf16 v[20:23], v[44:47], v[144:147], v[20:23]
    ds_read_b128 v[80:83], v14 offset:28672
    v_mfma_f32_16x16x32_bf16 v[24:27], v[48:51], v[144:147], v[24:27]
    ds_read_b128 v[84:87], v14 offset:29696
    v_mfma_f32_16x16x32_bf16 v[28:31], v[52:55], v[144:147], v[28:31]
    ds_read_b128 v[88:91], v14 offset:30720
    v_mfma_f32_16x16x32_bf16 v[32:35], v[72:75], v[144:147], v[32:35]
    ds_read_b128 v[108:111], v14 offset:35840
    s_waitcnt lgkmcnt(5)
    v_mfma_f32_16x16x32_bf16 v[16:19], v[56:59], v[148:151], v[16:19]
    ds_read_b128 v[92:95], v14 offset:31744
    v_mfma_f32_16x16x32_bf16 v[20:23], v[60:63], v[148:151], v[20:23]
    ds_read_b128 v[96:99], v14 offset:32768
    v_mfma_f32_16x16x32_bf16 v[24:27], v[64:67], v[148:151], v[24:27]
    ds_read_b128 v[100:103], v14 offset:33792
    v_mfma_f32_16x16x32_bf16 v[28:31], v[68:71], v[148:151], v[28:31]
    ds_read_b128 v[104:107], v14 offset:34816
    v_mfma_f32_16x16x32_bf16 v[36:39], v[72:75], v[148:151], v[36:39]
    s_waitcnt vmcnt(8) lgkmcnt(4)
    v_mfma_f32_16x16x32_bf16 v[16:19], v[76:79], v[152:155], v[16:19]
    ds_read_b128 v[40:43], v15 offset:18432
    v_mfma_f32_16x16x32_bf16 v[20:23], v[80:83], v[152:155], v[20:23]
    ds_read_b128 v[44:47], v15 offset:19456
    v_mfma_f32_16x16x32_bf16 v[24:27], v[84:87], v[152:155], v[24:27]
    ds_read_b128 v[48:51], v15 offset:20480
    v_mfma_f32_16x16x32_bf16 v[28:31], v[88:91], v[152:155], v[28:31]
    ds_read_b128 v[52:55], v15 offset:21504
    v_mfma_f32_16x16x32_bf16 v[32:35], v[108:111], v[152:155], v[32:35]
    ds_read_b128 v[72:75], v15 offset:26624
    s_waitcnt lgkmcnt(5)
    v_mfma_f32_16x16x32_bf16 v[16:19], v[92:95], v[156:159], v[16:19]
    ds_read_b128 v[56:59], v15 offset:22528
    v_mfma_f32_16x16x32_bf16 v[20:23], v[96:99], v[156:159], v[20:23]
    ds_read_b128 v[60:63], v15 offset:23552
    v_mfma_f32_16x16x32_bf16 v[24:27], v[100:103], v[156:159], v[24:27]
    ds_read_b128 v[64:67], v15 offset:24576
    v_mfma_f32_16x16x32_bf16 v[28:31], v[104:107], v[156:159], v[28:31]
    ds_read_b128 v[68:71], v15 offset:25600
    v_mfma_f32_16x16x32_bf16 v[36:39], v[108:111], v[156:159], v[36:39]
    s_waitcnt vmcnt(6) lgkmcnt(4)
    v_mfma_f32_16x16x32_bf16 v[16:19], v[40:43], v[160:163], v[16:19]
    ds_read_b128 v[76:79], v15 offset:27648
    v_mfma_f32_16x16x32_bf16 v[20:23], v[44:47], v[160:163], v[20:23]
    ds_read_b128 v[80:83], v15 offset:28672
    v_mfma_f32_16x16x32_bf16 v[24:27], v[48:51], v[160:163], v[24:27]
    ds_read_b128 v[84:87], v15 offset:29696
    v_mfma_f32_16x16x32_bf16 v[28:31], v[52:55], v[160:163], v[28:31]
    ds_read_b128 v[88:91], v15 offset:30720
    v_mfma_f32_16x16x32_bf16 v[32:35], v[72:75], v[160:163], v[32:35]
    ds_read_b128 v[108:111], v15 offset:35840
    s_waitcnt lgkmcnt(5)
    v_mfma_f32_16x16x32_bf16 v[16:19], v[56:59], v[164:167], v[16:19]
    ds_read_b128 v[92:95], v15 offset:31744
    v_mfma_f32_16x16x32_bf16 v[20:23], v[60:63], v[164:167], v[20:23]
    ds_read_b128 v[96:99], v15 offset:32768
    v_mfma_f32_16x16x32_bf16 v[24:27], v[64:67], v[164:167], v[24:27]
    ds_read_b128 v[100:103], v15 offset:33792
    v_mfma_f32_16x16x32_bf16 v[28:31], v[68:71], v[164:167], v[28:31]
    ds_read_b128 v[104:107], v15 offset:34816
    v_mfma_f32_16x16x32_bf16 v[36:39], v[72:75], v[164:167], v[36:39]
    s_waitcnt vmcnt(4) lgkmcnt(4)
    v_mfma_f32_16x16x32_bf16 v[16:19], v[76:79], v[168:171], v[16:19]
    ds_read_b128 v[40:43], v15 offset:36864
    v_mfma_f32_16x16x32_bf16 v[20:23], v[80:83], v[168:171], v[20:23]
    ds_read_b128 v[44:47], v15 offset:37888
    v_mfma_f32_16x16x32_bf16 v[24:27], v[84:87], v[168:171], v[24:27]
    ds_read_b128 v[48:51], v15 offset:38912
    v_mfma_f32_16x16x32_bf16 v[28:31], v[88:91], v[168:171], v[28:31]
    ds_read_b128 v[52:55], v15 offset:39936
    v_mfma_f32_16x16x32_bf16 v[32:35], v[108:111], v[168:171], v[32:35]
    ds_read_b128 v[72:75], v15 offset:45056
    s_waitcnt lgkmcnt(5)
    v_mfma_f32_16x16x32_bf16 v[16:19], v[92:95], v[172:175], v[16:19]
    ds_read_b128 v[56:59], v15 offset:40960
    v_mfma_f32_16x16x32_bf16 v[20:23], v[96:99], v[172:175], v[20:23]
    ds_read_b128 v[60:63], v15 offset:41984
    v_mfma_f32_16x16x32_bf16 v[24:27], v[100:103], v[172:175], v[24:27]
    ds_read_b128 v[64:67], v15 offset:43008
    v_mfma_f32_16x16x32_bf16 v[28:31], v[104:107], v[172:175], v[28:31]
    ds_read_b128 v[68:71], v15 offset:44032
    v_mfma_f32_16x16x32_bf16 v[36:39], v[108:111], v[172:175], v[36:39]
    s_waitcnt vmcnt(0) lgkmcnt(4)
    v_mfma_f32_16x16x32_bf16 v[16:19], v[40:43], v[176:179], v[16:19]
    v_mfma_f32_16x16x32_bf16 v[20:23], v[44:47], v[176:179], v[20:23]
    v_mfma_f32_16x16x32_bf16 v[24:27], v[48:51], v[176:179], v[24:27]
    v_mfma_f32_16x16x32_bf16 v[28:31], v[52:55], v[176:179], v[28:31]
    v_mfma_f32_16x16x32_bf16 v[32:35], v[72:75], v[176:179], v[32:35]
    s_waitcnt lgkmcnt(0)
    v_mfma_f32_16x16x32_bf16 v[16:19], v[56:59], v[180:183], v[16:19]
    v_mfma_f32_16x16x32_bf16 v[20:23], v[60:63], v[180:183], v[20:23]
    v_mfma_f32_16x16x32_bf16 v[24:27], v[64:67], v[180:183], v[24:27]
    v_mfma_f32_16x16x32_bf16 v[28:31], v[68:71], v[180:183], v[28:31]
    v_mfma_f32_16x16x32_bf16 v[36:39], v[72:75], v[180:183], v[36:39]
    s_nop 3
    v_cvt_pk_bf16_f32 v208, v16, v17
    v_cvt_pk_bf16_f32 v209, v18, v19
    v_cvt_pk_bf16_f32 v210, v20, v21
    v_cvt_pk_bf16_f32 v211, v22, v23
    v_cvt_pk_bf16_f32 v212, v24, v25
    v_cvt_pk_bf16_f32 v213, v26, v27
    v_cvt_pk_bf16_f32 v214, v28, v29
    v_cvt_pk_bf16_f32 v215, v30, v31
    buffer_store_dwordx4 v[208:211], v4, s[4:7], s34 offen offset:0 sc1
    buffer_store_dwordx4 v[212:215], v4, s[4:7], s34 offen offset:1024 sc1
    v_permlane32_swap_b32 v36, v220
    v_permlane32_swap_b32 v37, v221
    v_permlane32_swap_b32 v38, v222
    v_permlane32_swap_b32 v39, v223
    v_pk_add_f32 v[32:33], v[32:33], v[220:221]
    v_pk_add_f32 v[34:35], v[34:35], v[222:223]
    v_cvt_pk_bf16_f32 v216, v32, v33
    v_cvt_pk_bf16_f32 v217, v34, v35
    buffer_store_dwordx2 v[216:217], v5, s[4:7], s34 offen sc1
    v_cndmask_b32 v222, 0, v216, s[40:41]
    v_cndmask_b32 v223, 0, v217, s[40:41]
    v_dot2_f32_bf16 v220, v208, v11, 0
    v_dot2_f32_bf16 v221, v208, v208, 0
    v_dot2_f32_bf16 v224, v209, v11, 0
    v_dot2_f32_bf16 v225, v209, v209, 0
    v_dot2_f32_bf16 v220, v210, v11, v220
    v_dot2_f32_bf16 v221, v210, v210, v221
    v_dot2_f32_bf16 v224, v211, v11, v224
    v_dot2_f32_bf16 v225, v211, v211, v225
    v_dot2_f32_bf16 v220, v212, v11, v220
    v_dot2_f32_bf16 v221, v212, v212, v221
    v_dot2_f32_bf16 v224, v213, v11, v224
    v_dot2_f32_bf16 v225, v213, v213, v225
    v_dot2_f32_bf16 v220, v214, v11, v220
    v_dot2_f32_bf16 v221, v214, v214, v221
    v_dot2_f32_bf16 v224, v215, v11, v224
    v_dot2_f32_bf16 v225, v215, v215, v225
    v_dot2_f32_bf16 v220, v222, v11, v220
    v_dot2_f32_bf16 v221, v222, v222, v221
    v_dot2_f32_bf16 v224, v223, v11, v224
    v_dot2_f32_bf16 v225, v223, v223, v225
    s_nop 2
    v_pk_add_f32 v[220:221], v[220:221], v[224:225]
    v_mov_b32 v222, v220
    v_mov_b32 v223, v221
    s_nop 1
    v_permlane32_swap_b32 v220, v222
    v_permlane32_swap_b32 v221, v223
    v_add_f32 v220, v220, v222
    v_add_f32 v221, v221, v223
    v_mov_b32 v222, v220
    v_mov_b32 v223, v221
    s_nop 1
    v_permlane16_swap_b32 v220, v222
    v_permlane16_swap_b32 v221, v223
    v_add_f32 v220, v220, v222
    v_add_f32 v221, v221, v223
    buffer_store_dwordx2 v[220:221], v10, s[4:7], s39 offen sc1
    s_and_b32 s25, s2, 7
    s_lshr_b32 s26, s2, 3
    s_and_b32 s23, s25, 1
    s_lshl_b32 s23, s23, 3
    s_and_b32 s27, s26, 7
    s_add_u32 s23, s23, s27
    s_lshr_b32 s24, s25, 1
    s_lshl_b32 s24, s24, 2
    s_lshr_b32 s27, s26, 3
    s_add_u32 s24, s24, s27
    s_add_u32 s28, s23, s24
    s_and_b32 s28, s28, 3
    s_lshl_b32 s30, s20, 12
    s_lshl_b32 s31, s23, 3
    s_lshl_b32 s33, s20, 1
    s_add_u32 s31, s31, s33
    s_lshl_b32 s32, s31, 10
    s_add_u32 s32, s32, s21
    s_add_u32 s32, s32, 0x1b20000
    v_add_u32 v2, 73728, v1
    s_add_u32 s33, s30, 18432
    v_add_u32 v3, s33, v1
    v_add_u32 v0, s33, v2
    s_lshr_b32 s34, s31, 1
    s_lshl_b32 s35, s34, 12
    s_add_u32 s35, s35, s21
    s_add_u32 s35, s35, 0x1b40000
    s_lshl_b32 s36, s24, 8
    s_add_u32 s36, s36, s35
    s_lshl_b32 s38, s24, 6
    s_add_u32 s38, s38, s34
    s_mul_i32 s38, s38, 9216
    s_add_u32 s38, s38, s21
    s_add_u32 s38, s38, 0x900000
    s_add_u32 s39, s38, 4096
    s_add_u32 s46, s38, 8192
    s_mov_b32 s40, 0xc0135761
    s_mov_b32 s42, 0x3d372713
    s_mov_b32 s44, 0x39e38e39
    s_mov_b32 s45, 0x3727c5ac
    v_lshrrev_b32 v4, 1, v1
    s_lshl_b32 s52, s22, 7
    s_add_u32 s52, s52, s23
    s_lshl_b32 s52, s52, 8
    s_add_u32 s52, s52, 0x4509000
    s_add_u32 s52, s52, s4
    s_addc_u32 s53, s5, 0
    s_waitcnt vmcnt(0)
    s_barrier
    s_cmp_lg_u32 s20, 0
    s_cbranch_scc1 L_ns_d3
    s_mov_b32 s56, 1
    s_atomic_add s56, s[50:51], 0
L_ns_d3:
    s_cmp_lg_u32 s20, 0
    s_cbranch_scc1 L_pd_d3
    s_mov_b32 s60, 65536
L_poll_d3:
    s_mov_b32 s57, 0
    s_atomic_add s57, s[52:53], 0 glc
    s_waitcnt lgkmcnt(0)
    s_cmp_ge_u32 s57, 16
    s_cbranch_scc1 L_pd_d3
    s_sub_u32 s60, s60, 1
    s_cbranch_scc1 L_pd_d3
    s_sleep 2
    s_branch L_poll_d3
L_pd_d3:
    s_barrier
    buffer_load_dwordx2 v[8:9], v4, s[4:7], s32 offen offset:0 sc1
    buffer_load_dwordx2 v[10:11], v4, s[4:7], s32 offen offset:512 sc1
    buffer_load_dwordx2 v[12:13], v4, s[4:7], s32 offen offset:1024 sc1
    buffer_load_dwordx2 v[14:15], v4, s[4:7], s32 offen offset:1536 sc1
    s_lshl_b32 s50, s22, 7
    s_add_u32 s50, s50, s23
    s_lshl_b32 s50, s50, 8
    s_add_u32 s50, s50, 0x450a000
    s_add_u32 s50, s50, s4
    s_addc_u32 s51, s5, 0
    s_barrier
    ds_read_b128 v[160:163], v3 offset:0
    ds_read_b128 v[164:167], v3 offset:2048
    ds_read_b128 v[168:171], v1 offset:0
    ds_read_b128 v[172:175], v1 offset:1024
    ds_read_b128 v[176:179], v1 offset:2048
    ds_read_b128 v[180:183], v1 offset:3072
    ds_read_b128 v[184:187], v1 offset:4096
    ds_read_b128 v[188:191], v1 offset:5120
    ds_read_b128 v[192:195], v1 offset:6144
    ds_read_b128 v[196:199], v1 offset:7168
    ds_read_b128 v[200:203], v1 offset:8192
    s_waitcnt lgkmcnt(5)
    v_mfma_f32_16x16x32_bf16 v[16:19], v[160:163], v[168:171], 0
    ds_read_b128 v[204:207], v3 offset:1024
    v_mfma_f32_16x16x32_bf16 v[20:23], v[164:167], v[168:171], 0
    ds_read_b128 v[208:211], v3 offset:3072
    v_mfma_f32_16x16x32_bf16 v[24:27], v[160:163], v[172:175], 0
    ds_read_b128 v[212:215], v1 offset:9216
    v_mfma_f32_16x16x32_bf16 v[28:31], v[164:167], v[172:175], 0
    ds_read_b128 v[216:219], v1 offset:10240
    v_mfma_f32_16x16x32_bf16 v[32:35], v[160:163], v[176:179], 0
    ds_read_b128 v[220:223], v1 offset:11264
    v_mfma_f32_16x16x32_bf16 v[36:39], v[164:167], v[176:179], 0
    ds_read_b128 v[224:227], v1 offset:12288
    v_mfma_f32_16x16x32_bf16 v[40:43], v[160:163], v[180:183], 0
    ds_read_b128 v[228:231], v1 offset:13312
    v_mfma_f32_16x16x32_bf16 v[44:47], v[164:167], v[180:183], 0
    ds_read_b128 v[232:235], v1 offset:14336
    s_waitcnt lgkmcnt(8)
    v_mfma_f32_16x16x32_bf16 v[48:51], v[160:163], v[184:187], 0
    ds_read_b128 v[236:239], v1 offset:15360
    v_mfma_f32_16x16x32_bf16 v[52:55], v[164:167], v[184:187], 0
    ds_read_b128 v[240:243], v1 offset:16384
    v_mfma_f32_16x16x32_bf16 v[56:59], v[160:163], v[188:191], 0
    ds_read_b128 v[244:247], v1 offset:17408
    v_mfma_f32_16x16x32_bf16 v[60:63], v[164:167], v[188:191], 0
    v_mfma_f32_16x16x32_bf16 v[64:67], v[160:163], v[192:195], 0
    v_mfma_f32_16x16x32_bf16 v[68:71], v[164:167], v[192:195], 0
    v_mfma_f32_16x16x32_bf16 v[72:75], v[160:163], v[196:199], 0
    v_mfma_f32_16x16x32_bf16 v[76:79], v[164:167], v[196:199], 0
    v_mfma_f32_16x16x32_bf16 v[80:83], v[160:163], v[200:203], 0
    v_mfma_f32_16x16x32_bf16 v[84:87], v[164:167], v[200:203], 0
    s_waitcnt lgkmcnt(0)
    s_barrier
    v_mfma_f32_16x16x32_bf16 v[16:19], v[204:207], v[212:215], v[16:19]
    ds_read_b128 v[160:163], v3 offset:36864
    v_mfma_f32_16x16x32_bf16 v[20:23], v[208:211], v[212:215], v[20:23]
    ds_read_b128 v[164:167], v3 offset:38912
    v_mfma_f32_16x16x32_bf16 v[24:27], v[204:207], v[216:219], v[24:27]
    ds_read_b128 v[168:171], v1 offset:36864
    v_mfma_f32_16x16x32_bf16 v[28:31], v[208:211], v[216:219], v[28:31]
    ds_read_b128 v[172:175], v1 offset:37888
    v_mfma_f32_16x16x32_bf16 v[32:35], v[204:207], v[220:223], v[32:35]
    ds_read_b128 v[176:179], v1 offset:38912
    v_mfma_f32_16x16x32_bf16 v[36:39], v[208:211], v[220:223], v[36:39]
    ds_read_b128 v[180:183], v1 offset:39936
    v_mfma_f32_16x16x32_bf16 v[40:43], v[204:207], v[224:227], v[40:43]
    ds_read_b128 v[184:187], v1 offset:40960
    v_mfma_f32_16x16x32_bf16 v[44:47], v[208:211], v[224:227], v[44:47]
    ds_read_b128 v[188:191], v1 offset:41984
    v_mfma_f32_16x16x32_bf16 v[48:51], v[204:207], v[228:231], v[48:51]
    ds_read_b128 v[192:195], v1 offset:43008
    v_mfma_f32_16x16x32_bf16 v[52:55], v[208:211], v[228:231], v[52:55]
    ds_read_b128 v[196:199], v1 offset:44032
    v_lshrrev_b32 v5, 8, v1
    v_mfma_f32_16x16x32_bf16 v[56:59], v[204:207], v[232:235], v[56:59]
    ds_read_b128 v[200:203], v1 offset:45056
    v_bfe_u32 v6, v1, 4, 4
    v_mfma_f32_16x16x32_bf16 v[60:63], v[208:211], v[232:235], v[60:63]
    v_lshlrev_b32 v7, 2, v6
    v_mfma_f32_16x16x32_bf16 v[64:67], v[204:207], v[236:239], v[64:67]
    s_lshl_b32 s33, s20, 8
    v_mfma_f32_16x16x32_bf16 v[68:71], v[208:211], v[236:239], v[68:71]
    s_add_u32 s33, s33, 147456
    v_mfma_f32_16x16x32_bf16 v[72:75], v[204:207], v[240:243], v[72:75]
    v_add_u32 v4, s33, v7
    v_mfma_f32_16x16x32_bf16 v[76:79], v[208:211], v[240:243], v[76:79]
    v_lshl_add_u32 v252, v5, 4, s33
    v_mfma_f32_16x16x32_bf16 v[80:83], v[204:207], v[244:247], v[80:83]
    v_add_u32 v7, 159744, v7
    v_mfma_f32_16x16x32_bf16 v[84:87], v[208:211], v[244:247], v[84:87]
    s_waitcnt vmcnt(0)
    v_add_f32 v248, v8, v10
    s_waitcnt lgkmcnt(5)
    v_mfma_f32_16x16x32_bf16 v[16:19], v[160:163], v[168:171], v[16:19]
    ds_read_b128 v[204:207], v3 offset:37888
    v_mfma_f32_16x16x32_bf16 v[20:23], v[164:167], v[168:171], v[20:23]
    ds_read_b128 v[208:211], v3 offset:39936
    v_mfma_f32_16x16x32_bf16 v[24:27], v[160:163], v[172:175], v[24:27]
    ds_read_b128 v[212:215], v1 offset:46080
    v_mfma_f32_16x16x32_bf16 v[28:31], v[164:167], v[172:175], v[28:31]
    ds_read_b128 v[216:219], v1 offset:47104
    v_mfma_f32_16x16x32_bf16 v[32:35], v[160:163], v[176:179], v[32:35]
    ds_read_b128 v[220:223], v1 offset:48128
    v_mfma_f32_16x16x32_bf16 v[36:39], v[164:167], v[176:179], v[36:39]
    ds_read_b128 v[224:227], v1 offset:49152
    v_mfma_f32_16x16x32_bf16 v[40:43], v[160:163], v[180:183], v[40:43]
    ds_read_b128 v[228:231], v1 offset:50176
    v_mfma_f32_16x16x32_bf16 v[44:47], v[164:167], v[180:183], v[44:47]
    ds_read_b128 v[232:235], v1 offset:51200
    s_waitcnt lgkmcnt(8)
    v_mfma_f32_16x16x32_bf16 v[48:51], v[160:163], v[184:187], v[48:51]
    ds_read_b128 v[236:239], v1 offset:52224
    v_mfma_f32_16x16x32_bf16 v[52:55], v[164:167], v[184:187], v[52:55]
    ds_read_b128 v[240:243], v1 offset:53248
    v_add_f32 v249, v9, v11
    v_mfma_f32_16x16x32_bf16 v[56:59], v[160:163], v[188:191], v[56:59]
    ds_read_b128 v[244:247], v1 offset:54272
    v_add_f32 v250, v12, v14
    v_mfma_f32_16x16x32_bf16 v[60:63], v[164:167], v[188:191], v[60:63]
    v_add_f32 v251, v13, v15
    v_mfma_f32_16x16x32_bf16 v[64:67], v[160:163], v[192:195], v[64:67]
    v_mov_b32 v8, v248
    v_mfma_f32_16x16x32_bf16 v[68:71], v[164:167], v[192:195], v[68:71]
    v_mov_b32 v9, v249
    v_mfma_f32_16x16x32_bf16 v[72:75], v[160:163], v[196:199], v[72:75]
    v_mov_b32 v12, v250
    v_mfma_f32_16x16x32_bf16 v[76:79], v[164:167], v[196:199], v[76:79]
    v_mov_b32 v13, v251
    v_mfma_f32_16x16x32_bf16 v[80:83], v[160:163], v[200:203], v[80:83]
    v_permlane32_swap_b32 v248, v8
    v_mfma_f32_16x16x32_bf16 v[84:87], v[164:167], v[200:203], v[84:87]
    v_permlane32_swap_b32 v249, v9
    v_permlane32_swap_b32 v250, v12
    s_waitcnt lgkmcnt(0)
    s_barrier
    v_mfma_f32_16x16x32_bf16 v[16:19], v[204:207], v[212:215], v[16:19]
    ds_read_b128 v[160:163], v0 offset:0
    v_mfma_f32_16x16x32_bf16 v[20:23], v[208:211], v[212:215], v[20:23]
    ds_read_b128 v[164:167], v0 offset:2048
    v_mfma_f32_16x16x32_bf16 v[24:27], v[204:207], v[216:219], v[24:27]
    ds_read_b128 v[168:171], v2 offset:0
    v_mfma_f32_16x16x32_bf16 v[28:31], v[208:211], v[216:219], v[28:31]
    ds_read_b128 v[172:175], v2 offset:1024
    v_mfma_f32_16x16x32_bf16 v[32:35], v[204:207], v[220:223], v[32:35]
    ds_read_b128 v[176:179], v2 offset:2048
    v_mfma_f32_16x16x32_bf16 v[36:39], v[208:211], v[220:223], v[36:39]
    ds_read_b128 v[180:183], v2 offset:3072
    v_mfma_f32_16x16x32_bf16 v[40:43], v[204:207], v[224:227], v[40:43]
    ds_read_b128 v[184:187], v2 offset:4096
    v_mfma_f32_16x16x32_bf16 v[44:47], v[208:211], v[224:227], v[44:47]
    ds_read_b128 v[188:191], v2 offset:5120
    v_mfma_f32_16x16x32_bf16 v[48:51], v[204:207], v[228:231], v[48:51]
    ds_read_b128 v[192:195], v2 offset:6144
    v_mfma_f32_16x16x32_bf16 v[52:55], v[208:211], v[228:231], v[52:55]
    ds_read_b128 v[196:199], v2 offset:7168
    v_permlane32_swap_b32 v251, v13
    v_mfma_f32_16x16x32_bf16 v[56:59], v[204:207], v[232:235], v[56:59]
    ds_read_b128 v[200:203], v2 offset:8192
    v_add_f32 v248, v248, v8
    v_mfma_f32_16x16x32_bf16 v[60:63], v[208:211], v[232:235], v[60:63]
    ds_read2_b32 v[128:129], v7 offset0:0 offset1:16
    v_add_f32 v249, v249, v9
    v_mfma_f32_16x16x32_bf16 v[64:67], v[204:207], v[236:239], v[64:67]
    ds_read2_b32 v[130:131], v7 offset0:32 offset1:48
    v_add_f32 v250, v250, v12
    v_mfma_f32_16x16x32_bf16 v[68:71], v[208:211], v[236:239], v[68:71]
    ds_read2_b32 v[132:133], v7 offset0:64 offset1:80
    v_add_f32 v251, v251, v13
    v_mfma_f32_16x16x32_bf16 v[72:75], v[204:207], v[240:243], v[72:75]
    ds_read2_b32 v[134:135], v7 offset0:96 offset1:112
    v_mov_b32 v8, v248
    v_mfma_f32_16x16x32_bf16 v[76:79], v[208:211], v[240:243], v[76:79]
    ds_read2_b32 v[136:137], v7 offset0:128 offset1:144
    v_mov_b32 v9, v249
    v_mfma_f32_16x16x32_bf16 v[80:83], v[204:207], v[244:247], v[80:83]
    v_mov_b32 v12, v250
    v_mfma_f32_16x16x32_bf16 v[84:87], v[208:211], v[244:247], v[84:87]
    v_mov_b32 v13, v251
    v_permlane16_swap_b32 v248, v8
    s_waitcnt lgkmcnt(10)
    v_mfma_f32_16x16x32_bf16 v[16:19], v[160:163], v[168:171], v[16:19]
    ds_read_b128 v[204:207], v0 offset:1024
    v_mfma_f32_16x16x32_bf16 v[20:23], v[164:167], v[168:171], v[20:23]
    ds_read_b128 v[208:211], v0 offset:3072
    v_mfma_f32_16x16x32_bf16 v[24:27], v[160:163], v[172:175], v[24:27]
    ds_read_b128 v[212:215], v2 offset:9216
    v_mfma_f32_16x16x32_bf16 v[28:31], v[164:167], v[172:175], v[28:31]
    ds_read_b128 v[216:219], v2 offset:10240
    v_mfma_f32_16x16x32_bf16 v[32:35], v[160:163], v[176:179], v[32:35]
    ds_read_b128 v[220:223], v2 offset:11264
    v_mfma_f32_16x16x32_bf16 v[36:39], v[164:167], v[176:179], v[36:39]
    ds_read_b128 v[224:227], v2 offset:12288
    v_mfma_f32_16x16x32_bf16 v[40:43], v[160:163], v[180:183], v[40:43]
    ds_read_b128 v[228:231], v2 offset:13312
    v_mfma_f32_16x16x32_bf16 v[44:47], v[164:167], v[180:183], v[44:47]
    ds_read_b128 v[232:235], v2 offset:14336
    s_waitcnt lgkmcnt(8)
    v_mfma_f32_16x16x32_bf16 v[48:51], v[160:163], v[184:187], v[48:51]
    ds_read_b128 v[236:239], v2 offset:15360
    v_mfma_f32_16x16x32_bf16 v[52:55], v[164:167], v[184:187], v[52:55]
    ds_read_b128 v[240:243], v2 offset:16384
    v_permlane16_swap_b32 v249, v9
    v_mfma_f32_16x16x32_bf16 v[56:59], v[160:163], v[188:191], v[56:59]
    ds_read_b128 v[244:247], v2 offset:17408
    v_permlane16_swap_b32 v250, v12
    v_mfma_f32_16x16x32_bf16 v[60:63], v[164:167], v[188:191], v[60:63]
    v_permlane16_swap_b32 v251, v13
    v_mfma_f32_16x16x32_bf16 v[64:67], v[160:163], v[192:195], v[64:67]
    v_add_f32 v248, v248, v8
    v_mfma_f32_16x16x32_bf16 v[68:71], v[164:167], v[192:195], v[68:71]
    v_add_f32 v249, v249, v9
    v_mfma_f32_16x16x32_bf16 v[72:75], v[160:163], v[196:199], v[72:75]
    v_add_f32 v250, v250, v12
    v_mfma_f32_16x16x32_bf16 v[76:79], v[164:167], v[196:199], v[76:79]
    v_add_f32 v251, v251, v13
    v_mfma_f32_16x16x32_bf16 v[80:83], v[160:163], v[200:203], v[80:83]
    v_mul_f32 v248, 0x3ae38e39, v248
    v_mfma_f32_16x16x32_bf16 v[84:87], v[164:167], v[200:203], v[84:87]
    v_mul_f32 v249, 0x3ae38e39, v249
    v_mul_f32 v250, 0x3ae38e39, v250
    s_waitcnt lgkmcnt(0)
    s_barrier
    v_mfma_f32_16x16x32_bf16 v[16:19], v[204:207], v[212:215], v[16:19]
    ds_read_b128 v[160:163], v0 offset:36864
    v_mfma_f32_16x16x32_bf16 v[20:23], v[208:211], v[212:215], v[20:23]
    ds_read_b128 v[164:167], v0 offset:38912
    v_mfma_f32_16x16x32_bf16 v[24:27], v[204:207], v[216:219], v[24:27]
    ds_read_b128 v[168:171], v2 offset:36864
    v_mfma_f32_16x16x32_bf16 v[28:31], v[208:211], v[216:219], v[28:31]
    ds_read_b128 v[172:175], v2 offset:37888
    v_mfma_f32_16x16x32_bf16 v[32:35], v[204:207], v[220:223], v[32:35]
    ds_read_b128 v[176:179], v2 offset:38912
    v_mfma_f32_16x16x32_bf16 v[36:39], v[208:211], v[220:223], v[36:39]
    ds_read_b128 v[180:183], v2 offset:39936
    v_mfma_f32_16x16x32_bf16 v[40:43], v[204:207], v[224:227], v[40:43]
    ds_read_b128 v[184:187], v2 offset:40960
    v_mfma_f32_16x16x32_bf16 v[44:47], v[208:211], v[224:227], v[44:47]
    ds_read_b128 v[188:191], v2 offset:41984
    v_mfma_f32_16x16x32_bf16 v[48:51], v[204:207], v[228:231], v[48:51]
    ds_read_b128 v[192:195], v2 offset:43008
    v_mfma_f32_16x16x32_bf16 v[52:55], v[208:211], v[228:231], v[52:55]
    ds_read_b128 v[196:199], v2 offset:44032
    v_mul_f32 v251, 0x3ae38e39, v251
    v_mfma_f32_16x16x32_bf16 v[56:59], v[204:207], v[232:235], v[56:59]
    ds_read_b128 v[200:203], v2 offset:45056
    v_fma_f32 v249, -v248, v248, v249
    v_mfma_f32_16x16x32_bf16 v[60:63], v[208:211], v[232:235], v[60:63]
    v_fma_f32 v251, -v250, v250, v251
    v_mfma_f32_16x16x32_bf16 v[64:67], v[204:207], v[236:239], v[64:67]
    v_max_f32 v249, 0, v249
    v_mfma_f32_16x16x32_bf16 v[68:71], v[208:211], v[236:239], v[68:71]
    v_max_f32 v251, 0, v251
    v_mfma_f32_16x16x32_bf16 v[72:75], v[204:207], v[240:243], v[72:75]
    v_add_f32 v249, 0x3727c5ac, v249
    v_mfma_f32_16x16x32_bf16 v[76:79], v[208:211], v[240:243], v[76:79]
    v_add_f32 v251, 0x3727c5ac, v251
    v_mfma_f32_16x16x32_bf16 v[80:83], v[204:207], v[244:247], v[80:83]
    v_rsq_f32 v249, v249
    v_mfma_f32_16x16x32_bf16 v[84:87], v[208:211], v[244:247], v[84:87]
    v_rsq_f32 v251, v251
    s_nop 0
    s_waitcnt lgkmcnt(5)
    v_mfma_f32_16x16x32_bf16 v[16:19], v[160:163], v[168:171], v[16:19]
    ds_read_b128 v[204:207], v0 offset:37888
    v_mfma_f32_16x16x32_bf16 v[20:23], v[164:167], v[168:171], v[20:23]
    ds_read_b128 v[208:211], v0 offset:39936
    v_mfma_f32_16x16x32_bf16 v[24:27], v[160:163], v[172:175], v[24:27]
    ds_read_b128 v[212:215], v2 offset:46080
    v_mfma_f32_16x16x32_bf16 v[28:31], v[164:167], v[172:175], v[28:31]
    ds_read_b128 v[216:219], v2 offset:47104
    v_mfma_f32_16x16x32_bf16 v[32:35], v[160:163], v[176:179], v[32:35]
    ds_read_b128 v[220:223], v2 offset:48128
    v_mfma_f32_16x16x32_bf16 v[36:39], v[164:167], v[176:179], v[36:39]
    ds_read_b128 v[224:227], v2 offset:49152
    v_mfma_f32_16x16x32_bf16 v[40:43], v[160:163], v[180:183], v[40:43]
    ds_read_b128 v[228:231], v2 offset:50176
    v_mfma_f32_16x16x32_bf16 v[44:47], v[164:167], v[180:183], v[44:47]
    ds_read_b128 v[232:235], v2 offset:51200
    s_waitcnt lgkmcnt(8)
    v_mfma_f32_16x16x32_bf16 v[48:51], v[160:163], v[184:187], v[48:51]
    ds_read_b128 v[236:239], v2 offset:52224
    v_mfma_f32_16x16x32_bf16 v[52:55], v[164:167], v[184:187], v[52:55]
    ds_read_b128 v[240:243], v2 offset:53248
    v_mfma_f32_16x16x32_bf16 v[56:59], v[160:163], v[188:191], v[56:59]
    ds_read_b128 v[244:247], v2 offset:54272
    v_mfma_f32_16x16x32_bf16 v[60:63], v[164:167], v[188:191], v[60:63]
    v_mfma_f32_16x16x32_bf16 v[64:67], v[160:163], v[192:195], v[64:67]
    v_mfma_f32_16x16x32_bf16 v[68:71], v[164:167], v[192:195], v[68:71]
    v_mfma_f32_16x16x32_bf16 v[72:75], v[160:163], v[196:199], v[72:75]
    v_mfma_f32_16x16x32_bf16 v[76:79], v[164:167], v[196:199], v[76:79]
    v_mfma_f32_16x16x32_bf16 v[80:83], v[160:163], v[200:203], v[80:83]
    v_mfma_f32_16x16x32_bf16 v[84:87], v[164:167], v[200:203], v[84:87]
    s_waitcnt lgkmcnt(0)
    s_barrier
    v_mfma_f32_16x16x32_bf16 v[16:19], v[204:207], v[212:215], v[16:19]
    ds_read_b128 v[160:163], v3 offset:0
    v_mfma_f32_16x16x32_bf16 v[20:23], v[208:211], v[212:215], v[20:23]
    ds_read_b128 v[164:167], v3 offset:2048
    v_mfma_f32_16x16x32_bf16 v[24:27], v[204:207], v[216:219], v[24:27]
    ds_read_b128 v[168:171], v1 offset:0
    v_mfma_f32_16x16x32_bf16 v[28:31], v[208:211], v[216:219], v[28:31]
    ds_read_b128 v[172:175], v1 offset:1024
    v_mfma_f32_16x16x32_bf16 v[32:35], v[204:207], v[220:223], v[32:35]
    ds_read_b128 v[176:179], v1 offset:2048
    v_mfma_f32_16x16x32_bf16 v[36:39], v[208:211], v[220:223], v[36:39]
    ds_read_b128 v[180:183], v1 offset:3072
    v_mfma_f32_16x16x32_bf16 v[40:43], v[204:207], v[224:227], v[40:43]
    ds_read_b128 v[184:187], v1 offset:4096
    v_mfma_f32_16x16x32_bf16 v[44:47], v[208:211], v[224:227], v[44:47]
    ds_read_b128 v[188:191], v1 offset:5120
    v_mfma_f32_16x16x32_bf16 v[48:51], v[204:207], v[228:231], v[48:51]
    ds_read_b128 v[192:195], v1 offset:6144
    v_mfma_f32_16x16x32_bf16 v[52:55], v[208:211], v[228:231], v[52:55]
    ds_read_b128 v[196:199], v1 offset:7168
    v_mfma_f32_16x16x32_bf16 v[56:59], v[204:207], v[232:235], v[56:59]
    ds_read_b128 v[200:203], v1 offset:8192
    v_mfma_f32_16x16x32_bf16 v[60:63], v[208:211], v[232:235], v[60:63]
    ds_write2_b32 v4, v248, v249 offset0:0 offset1:32
    v_mfma_f32_16x16x32_bf16 v[64:67], v[204:207], v[236:239], v[64:67]
    ds_write2_b32 v4, v250, v251 offset0:16 offset1:48
    v_mfma_f32_16x16x32_bf16 v[68:71], v[208:211], v[236:239], v[68:71]
    ds_read_b128 v[88:91], v252 offset:0
    v_mfma_f32_16x16x32_bf16 v[72:75], v[204:207], v[240:243], v[72:75]
    ds_read_b128 v[92:95], v252 offset:64
    v_mfma_f32_16x16x32_bf16 v[76:79], v[208:211], v[240:243], v[76:79]
    ds_read_b128 v[96:99], v252 offset:128
    v_mfma_f32_16x16x32_bf16 v[80:83], v[204:207], v[244:247], v[80:83]
    ds_read_b128 v[100:103], v252 offset:192
    v_mfma_f32_16x16x32_bf16 v[84:87], v[208:211], v[244:247], v[84:87]
    s_waitcnt lgkmcnt(11)
    v_mfma_f32_16x16x32_bf16 v[16:19], v[160:163], v[168:171], v[16:19]
    ds_read_b128 v[204:207], v3 offset:1024
    v_mfma_f32_16x16x32_bf16 v[20:23], v[164:167], v[168:171], v[20:23]
    ds_read_b128 v[208:211], v3 offset:3072
    v_mfma_f32_16x16x32_bf16 v[24:27], v[160:163], v[172:175], v[24:27]
    ds_read_b128 v[212:215], v1 offset:9216
    v_mfma_f32_16x16x32_bf16 v[28:31], v[164:167], v[172:175], v[28:31]
    ds_read_b128 v[216:219], v1 offset:10240
    v_mfma_f32_16x16x32_bf16 v[32:35], v[160:163], v[176:179], v[32:35]
    ds_read_b128 v[220:223], v1 offset:11264
    v_mfma_f32_16x16x32_bf16 v[36:39], v[164:167], v[176:179], v[36:39]
    ds_read_b128 v[224:227], v1 offset:12288
    v_mfma_f32_16x16x32_bf16 v[40:43], v[160:163], v[180:183], v[40:43]
    ds_read_b128 v[228:231], v1 offset:13312
    v_mfma_f32_16x16x32_bf16 v[44:47], v[164:167], v[180:183], v[44:47]
    ds_read_b128 v[232:235], v1 offset:14336
    s_waitcnt lgkmcnt(8)
    v_mfma_f32_16x16x32_bf16 v[48:51], v[160:163], v[184:187], v[48:51]
    ds_read_b128 v[236:239], v1 offset:15360
    v_mfma_f32_16x16x32_bf16 v[52:55], v[164:167], v[184:187], v[52:55]
    ds_read_b128 v[240:243], v1 offset:16384
    v_rcp_f32 v120, v96
    v_mfma_f32_16x16x32_bf16 v[56:59], v[160:163], v[188:191], v[56:59]
    ds_read_b128 v[244:247], v1 offset:17408
    v_mul_f32 v104, s40, v96
    v_mfma_f32_16x16x32_bf16 v[60:63], v[164:167], v[188:191], v[60:63]
    v_mul_f32 v112, v96, v96
    v_mfma_f32_16x16x32_bf16 v[64:67], v[160:163], v[192:195], v[64:67]
    v_rcp_f32 v121, v97
    v_mfma_f32_16x16x32_bf16 v[68:71], v[164:167], v[192:195], v[68:71]
    v_mul_f32 v105, s40, v97
    v_mfma_f32_16x16x32_bf16 v[72:75], v[160:163], v[196:199], v[72:75]
    v_mul_f32 v113, v97, v97
    v_mfma_f32_16x16x32_bf16 v[76:79], v[164:167], v[196:199], v[76:79]
    v_rcp_f32 v122, v98
    v_mfma_f32_16x16x32_bf16 v[80:83], v[160:163], v[200:203], v[80:83]
    v_mul_f32 v106, s40, v98
    v_mfma_f32_16x16x32_bf16 v[84:87], v[164:167], v[200:203], v[84:87]
    v_mul_f32 v114, v98, v98
    v_rcp_f32 v123, v99
    s_waitcnt lgkmcnt(0)
    s_barrier
    v_mfma_f32_16x16x32_bf16 v[16:19], v[204:207], v[212:215], v[16:19]
    ds_read_b128 v[160:163], v3 offset:36864
    v_mfma_f32_16x16x32_bf16 v[20:23], v[208:211], v[212:215], v[20:23]
    ds_read_b128 v[164:167], v3 offset:38912
    v_mfma_f32_16x16x32_bf16 v[24:27], v[204:207], v[216:219], v[24:27]
    ds_read_b128 v[168:171], v1 offset:36864
    v_mfma_f32_16x16x32_bf16 v[28:31], v[208:211], v[216:219], v[28:31]
    ds_read_b128 v[172:175], v1 offset:37888
    v_mfma_f32_16x16x32_bf16 v[32:35], v[204:207], v[220:223], v[32:35]
    ds_read_b128 v[176:179], v1 offset:38912
    v_mfma_f32_16x16x32_bf16 v[36:39], v[208:211], v[220:223], v[36:39]
    ds_read_b128 v[180:183], v1 offset:39936
    v_mfma_f32_16x16x32_bf16 v[40:43], v[204:207], v[224:227], v[40:43]
    ds_read_b128 v[184:187], v1 offset:40960
    v_mfma_f32_16x16x32_bf16 v[44:47], v[208:211], v[224:227], v[44:47]
    ds_read_b128 v[188:191], v1 offset:41984
    v_mfma_f32_16x16x32_bf16 v[48:51], v[204:207], v[228:231], v[48:51]
    ds_read_b128 v[192:195], v1 offset:43008
    v_mfma_f32_16x16x32_bf16 v[52:55], v[208:211], v[228:231], v[52:55]
    ds_read_b128 v[196:199], v1 offset:44032
    v_mul_f32 v107, s40, v99
    v_mfma_f32_16x16x32_bf16 v[56:59], v[204:207], v[232:235], v[56:59]
    ds_read_b128 v[200:203], v1 offset:45056
    v_mul_f32 v115, v99, v99
    v_mfma_f32_16x16x32_bf16 v[60:63], v[208:211], v[232:235], v[60:63]
    v_rcp_f32 v124, v100
    v_mfma_f32_16x16x32_bf16 v[64:67], v[204:207], v[236:239], v[64:67]
    v_mul_f32 v108, s40, v100
    v_mfma_f32_16x16x32_bf16 v[68:71], v[208:211], v[236:239], v[68:71]
    v_mul_f32 v116, v100, v100
    v_mfma_f32_16x16x32_bf16 v[72:75], v[204:207], v[240:243], v[72:75]
    v_rcp_f32 v125, v101
    v_mfma_f32_16x16x32_bf16 v[76:79], v[208:211], v[240:243], v[76:79]
    v_mul_f32 v109, s40, v101
    v_mfma_f32_16x16x32_bf16 v[80:83], v[204:207], v[244:247], v[80:83]
    v_mul_f32 v117, v101, v101
    v_mfma_f32_16x16x32_bf16 v[84:87], v[208:211], v[244:247], v[84:87]
    v_rcp_f32 v126, v102
    v_mul_f32 v110, s40, v102
    s_waitcnt lgkmcnt(5)
    v_mfma_f32_16x16x32_bf16 v[16:19], v[160:163], v[168:171], v[16:19]
    ds_read_b128 v[204:207], v3 offset:37888
    v_mfma_f32_16x16x32_bf16 v[20:23], v[164:167], v[168:171], v[20:23]
    ds_read_b128 v[208:211], v3 offset:39936
    v_mfma_f32_16x16x32_bf16 v[24:27], v[160:163], v[172:175], v[24:27]
    ds_read_b128 v[212:215], v1 offset:46080
    v_mfma_f32_16x16x32_bf16 v[28:31], v[164:167], v[172:175], v[28:31]
    ds_read_b128 v[216:219], v1 offset:47104
    v_mfma_f32_16x16x32_bf16 v[32:35], v[160:163], v[176:179], v[32:35]
    ds_read_b128 v[220:223], v1 offset:48128
    v_mfma_f32_16x16x32_bf16 v[36:39], v[164:167], v[176:179], v[36:39]
    ds_read_b128 v[224:227], v1 offset:49152
    v_mfma_f32_16x16x32_bf16 v[40:43], v[160:163], v[180:183], v[40:43]
    ds_read_b128 v[228:231], v1 offset:50176
    v_mfma_f32_16x16x32_bf16 v[44:47], v[164:167], v[180:183], v[44:47]
    ds_read_b128 v[232:235], v1 offset:51200
    s_waitcnt lgkmcnt(8)
    v_mfma_f32_16x16x32_bf16 v[48:51], v[160:163], v[184:187], v[48:51]
    ds_read_b128 v[236:239], v1 offset:52224
    v_mfma_f32_16x16x32_bf16 v[52:55], v[164:167], v[184:187], v[52:55]
    ds_read_b128 v[240:243], v1 offset:53248
    v_mul_f32 v118, v102, v102
    v_mfma_f32_16x16x32_bf16 v[56:59], v[160:163], v[188:191], v[56:59]
    ds_read_b128 v[244:247], v1 offset:54272
    v_rcp_f32 v127, v103
    v_mfma_f32_16x16x32_bf16 v[60:63], v[164:167], v[188:191], v[60:63]
    v_mul_f32 v111, s40, v103
    v_mfma_f32_16x16x32_bf16 v[64:67], v[160:163], v[192:195], v[64:67]
    v_mul_f32 v119, v103, v103
    v_mfma_f32_16x16x32_bf16 v[68:71], v[164:167], v[192:195], v[68:71]
    v_mul_f32 v112, s42, v112
    v_mfma_f32_16x16x32_bf16 v[72:75], v[160:163], v[196:199], v[72:75]
    v_mul_f32 v113, s42, v113
    v_mfma_f32_16x16x32_bf16 v[76:79], v[164:167], v[196:199], v[76:79]
    v_mul_f32 v114, s42, v114
    v_mfma_f32_16x16x32_bf16 v[80:83], v[160:163], v[200:203], v[80:83]
    v_mul_f32 v115, s42, v115
    v_mfma_f32_16x16x32_bf16 v[84:87], v[164:167], v[200:203], v[84:87]
    v_mul_f32 v116, s42, v116
    v_mul_f32 v117, s42, v117
    s_waitcnt lgkmcnt(0)
    s_barrier
    v_mfma_f32_16x16x32_bf16 v[16:19], v[204:207], v[212:215], v[16:19]
    ds_read_b128 v[160:163], v0 offset:0
    v_mfma_f32_16x16x32_bf16 v[20:23], v[208:211], v[212:215], v[20:23]
    ds_read_b128 v[164:167], v0 offset:2048
    v_mfma_f32_16x16x32_bf16 v[24:27], v[204:207], v[216:219], v[24:27]
    ds_read_b128 v[168:171], v2 offset:0
    v_mfma_f32_16x16x32_bf16 v[28:31], v[208:211], v[216:219], v[28:31]
    ds_read_b128 v[172:175], v2 offset:1024
    v_mfma_f32_16x16x32_bf16 v[32:35], v[204:207], v[220:223], v[32:35]
    ds_read_b128 v[176:179], v2 offset:2048
    v_mfma_f32_16x16x32_bf16 v[36:39], v[208:211], v[220:223], v[36:39]
    ds_read_b128 v[180:183], v2 offset:3072
    v_mfma_f32_16x16x32_bf16 v[40:43], v[204:207], v[224:227], v[40:43]
    ds_read_b128 v[184:187], v2 offset:4096
    v_mfma_f32_16x16x32_bf16 v[44:47], v[208:211], v[224:227], v[44:47]
    ds_read_b128 v[188:191], v2 offset:5120
    v_mfma_f32_16x16x32_bf16 v[48:51], v[204:207], v[228:231], v[48:51]
    ds_read_b128 v[192:195], v2 offset:6144
    v_mfma_f32_16x16x32_bf16 v[52:55], v[208:211], v[228:231], v[52:55]
    ds_read_b128 v[196:199], v2 offset:7168
    v_mul_f32 v118, s42, v118
    v_mfma_f32_16x16x32_bf16 v[56:59], v[204:207], v[232:235], v[56:59]
    ds_read_b128 v[200:203], v2 offset:8192
    v_mul_f32 v119, s42, v119
    v_mfma_f32_16x16x32_bf16 v[60:63], v[208:211], v[232:235], v[60:63]
    v_mul_f32 v112, v112, v104
    v_mfma_f32_16x16x32_bf16 v[64:67], v[204:207], v[236:239], v[64:67]
    v_mul_f32 v113, v113, v105
    v_mfma_f32_16x16x32_bf16 v[68:71], v[208:211], v[236:239], v[68:71]
    v_mul_f32 v114, v114, v106
    v_mfma_f32_16x16x32_bf16 v[72:75], v[204:207], v[240:243], v[72:75]
    v_mul_f32 v115, v115, v107
    v_mfma_f32_16x16x32_bf16 v[76:79], v[208:211], v[240:243], v[76:79]
    v_mul_f32 v116, v116, v108
    v_mfma_f32_16x16x32_bf16 v[80:83], v[204:207], v[244:247], v[80:83]
    v_mul_f32 v117, v117, v109
    v_mfma_f32_16x16x32_bf16 v[84:87], v[208:211], v[244:247], v[84:87]
    v_mul_f32 v118, v118, v110
    v_mul_f32 v119, v119, v111
    s_waitcnt lgkmcnt(5)
    v_mfma_f32_16x16x32_bf16 v[16:19], v[160:163], v[168:171], v[16:19]
    ds_read_b128 v[204:207], v0 offset:1024
    v_mfma_f32_16x16x32_bf16 v[20:23], v[164:167], v[168:171], v[20:23]
    ds_read_b128 v[208:211], v0 offset:3072
    v_mfma_f32_16x16x32_bf16 v[24:27], v[160:163], v[172:175], v[24:27]
    ds_read_b128 v[212:215], v2 offset:9216
    v_mfma_f32_16x16x32_bf16 v[28:31], v[164:167], v[172:175], v[28:31]
    ds_read_b128 v[216:219], v2 offset:10240
    v_mfma_f32_16x16x32_bf16 v[32:35], v[160:163], v[176:179], v[32:35]
    ds_read_b128 v[220:223], v2 offset:11264
    v_mfma_f32_16x16x32_bf16 v[36:39], v[164:167], v[176:179], v[36:39]
    ds_read_b128 v[224:227], v2 offset:12288
    v_mfma_f32_16x16x32_bf16 v[40:43], v[160:163], v[180:183], v[40:43]
    ds_read_b128 v[228:231], v2 offset:13312
    v_mfma_f32_16x16x32_bf16 v[44:47], v[164:167], v[180:183], v[44:47]
    ds_read_b128 v[232:235], v2 offset:14336
    s_waitcnt lgkmcnt(8)
    v_mfma_f32_16x16x32_bf16 v[48:51], v[160:163], v[184:187], v[48:51]
    ds_read_b128 v[236:239], v2 offset:15360
    v_mfma_f32_16x16x32_bf16 v[52:55], v[164:167], v[184:187], v[52:55]
    ds_read_b128 v[240:243], v2 offset:16384
    v_lshrrev_b32 v8, 2, v6
    v_mfma_f32_16x16x32_bf16 v[56:59], v[160:163], v[188:191], v[56:59]
    ds_read_b128 v[244:247], v2 offset:17408
    v_lshlrev_b32 v8, 4, v8
    v_mfma_f32_16x16x32_bf16 v[60:63], v[164:167], v[188:191], v[60:63]
    v_lshl_add_u32 v8, v5, 6, v8
    v_mfma_f32_16x16x32_bf16 v[64:67], v[160:163], v[192:195], v[64:67]
    v_and_b32 v9, 3, v6
    v_mfma_f32_16x16x32_bf16 v[68:71], v[164:167], v[192:195], v[68:71]
    v_cmp_eq_u32 vcc, 0, v9
    v_mfma_f32_16x16x32_bf16 v[72:75], v[160:163], v[196:199], v[72:75]
    v_bfrev_b32 v10, 1
    v_mfma_f32_16x16x32_bf16 v[76:79], v[164:167], v[196:199], v[76:79]
    v_lshlrev_b32 v9, 4, v9
    v_mfma_f32_16x16x32_bf16 v[80:83], v[160:163], v[200:203], v[80:83]
    v_cndmask_b32 v8, v10, v8, vcc
    v_mfma_f32_16x16x32_bf16 v[84:87], v[164:167], v[200:203], v[84:87]
    v_lshl_add_u32 v9, v5, 6, v9
    v_lshrrev_b32 v255, 2, v6
    s_waitcnt lgkmcnt(0)
    s_barrier
    v_mfma_f32_16x16x32_bf16 v[16:19], v[204:207], v[212:215], v[16:19]
    ds_read_b128 v[160:163], v0 offset:36864
    v_fma_f32 v52, -v92, v132, v52
    v_mfma_f32_16x16x32_bf16 v[20:23], v[208:211], v[212:215], v[20:23]
    ds_read_b128 v[164:167], v0 offset:38912
    v_fma_f32 v56, -v88, v133, v56
    v_mfma_f32_16x16x32_bf16 v[24:27], v[204:207], v[216:219], v[24:27]
    ds_read_b128 v[168:171], v2 offset:36864
    v_fma_f32 v60, -v92, v133, v60
    v_mfma_f32_16x16x32_bf16 v[28:31], v[208:211], v[216:219], v[28:31]
    ds_read_b128 v[172:175], v2 offset:37888
    v_fma_f32 v64, -v88, v134, v64
    v_mfma_f32_16x16x32_bf16 v[32:35], v[204:207], v[220:223], v[32:35]
    ds_read_b128 v[176:179], v2 offset:38912
    v_fma_f32 v68, -v92, v134, v68
    v_mfma_f32_16x16x32_bf16 v[36:39], v[208:211], v[220:223], v[36:39]
    ds_read_b128 v[180:183], v2 offset:39936
    v_fma_f32 v72, -v88, v135, v72
    v_mfma_f32_16x16x32_bf16 v[40:43], v[204:207], v[224:227], v[40:43]
    ds_read_b128 v[184:187], v2 offset:40960
    v_fma_f32 v76, -v92, v135, v76
    v_mfma_f32_16x16x32_bf16 v[44:47], v[208:211], v[224:227], v[44:47]
    ds_read_b128 v[188:191], v2 offset:41984
    v_fma_f32 v80, -v88, v136, v80
    v_mfma_f32_16x16x32_bf16 v[48:51], v[204:207], v[228:231], v[48:51]
    ds_read_b128 v[192:195], v2 offset:43008
    v_fma_f32 v84, -v92, v136, v84
    v_mfma_f32_16x16x32_bf16 v[52:55], v[208:211], v[228:231], v[52:55]
    ds_read_b128 v[196:199], v2 offset:44032
    v_lshl_add_u32 v255, v255, 8, v9
    v_fma_f32 v16, -v88, v128, v16
    v_mfma_f32_16x16x32_bf16 v[56:59], v[204:207], v[232:235], v[56:59]
    ds_read_b128 v[200:203], v2 offset:45056
    v_fma_f32 v20, -v92, v128, v20
    v_mfma_f32_16x16x32_bf16 v[60:63], v[208:211], v[232:235], v[60:63]
    v_fma_f32 v24, -v88, v129, v24
    v_mfma_f32_16x16x32_bf16 v[64:67], v[204:207], v[236:239], v[64:67]
    v_fma_f32 v28, -v92, v129, v28
    v_mfma_f32_16x16x32_bf16 v[68:71], v[208:211], v[236:239], v[68:71]
    v_fma_f32 v32, -v88, v130, v32
    v_mfma_f32_16x16x32_bf16 v[72:75], v[204:207], v[240:243], v[72:75]
    v_fma_f32 v36, -v92, v130, v36
    v_mfma_f32_16x16x32_bf16 v[76:79], v[208:211], v[240:243], v[76:79]
    v_fma_f32 v40, -v88, v131, v40
    v_mfma_f32_16x16x32_bf16 v[80:83], v[204:207], v[244:247], v[80:83]
    v_fma_f32 v44, -v92, v131, v44
    v_mfma_f32_16x16x32_bf16 v[84:87], v[208:211], v[244:247], v[84:87]
    v_fma_f32 v48, -v88, v132, v48
    s_waitcnt lgkmcnt(5)
    v_mfma_f32_16x16x32_bf16 v[16:19], v[160:163], v[168:171], v[16:19]
    ds_read_b128 v[204:207], v0 offset:37888
    v_fma_f32 v53, -v93, v132, v53
    v_mfma_f32_16x16x32_bf16 v[20:23], v[164:167], v[168:171], v[20:23]
    ds_read_b128 v[208:211], v0 offset:39936
    v_fma_f32 v57, -v89, v133, v57
    v_mfma_f32_16x16x32_bf16 v[24:27], v[160:163], v[172:175], v[24:27]
    ds_read_b128 v[212:215], v2 offset:46080
    v_fma_f32 v61, -v93, v133, v61
    v_mfma_f32_16x16x32_bf16 v[28:31], v[164:167], v[172:175], v[28:31]
    ds_read_b128 v[216:219], v2 offset:47104
    v_fma_f32 v65, -v89, v134, v65
    v_mfma_f32_16x16x32_bf16 v[32:35], v[160:163], v[176:179], v[32:35]
    ds_read_b128 v[220:223], v2 offset:48128
    v_fma_f32 v69, -v93, v134, v69
    v_mfma_f32_16x16x32_bf16 v[36:39], v[164:167], v[176:179], v[36:39]
    ds_read_b128 v[224:227], v2 offset:49152
    v_fma_f32 v73, -v89, v135, v73
    v_mfma_f32_16x16x32_bf16 v[40:43], v[160:163], v[180:183], v[40:43]
    ds_read_b128 v[228:231], v2 offset:50176
    v_fma_f32 v77, -v93, v135, v77
    v_mfma_f32_16x16x32_bf16 v[44:47], v[164:167], v[180:183], v[44:47]
    ds_read_b128 v[232:235], v2 offset:51200
    s_waitcnt lgkmcnt(8)
    v_fma_f32 v81, -v89, v136, v81
    v_mfma_f32_16x16x32_bf16 v[48:51], v[160:163], v[184:187], v[48:51]
    ds_read_b128 v[236:239], v2 offset:52224
    v_fma_f32 v85, -v93, v136, v85
    v_mfma_f32_16x16x32_bf16 v[52:55], v[164:167], v[184:187], v[52:55]
    ds_read_b128 v[240:243], v2 offset:53248
    v_fma_f32 v17, -v89, v128, v17
    v_mfma_f32_16x16x32_bf16 v[56:59], v[160:163], v[188:191], v[56:59]
    ds_read_b128 v[244:247], v2 offset:54272
    v_fma_f32 v21, -v93, v128, v21
    v_mfma_f32_16x16x32_bf16 v[60:63], v[164:167], v[188:191], v[60:63]
    v_fma_f32 v25, -v89, v129, v25
    v_mfma_f32_16x16x32_bf16 v[64:67], v[160:163], v[192:195], v[64:67]
    v_fma_f32 v29, -v93, v129, v29
    v_mfma_f32_16x16x32_bf16 v[68:71], v[164:167], v[192:195], v[68:71]
    v_fma_f32 v33, -v89, v130, v33
    v_mfma_f32_16x16x32_bf16 v[72:75], v[160:163], v[196:199], v[72:75]
    v_fma_f32 v37, -v93, v130, v37
    v_mfma_f32_16x16x32_bf16 v[76:79], v[164:167], v[196:199], v[76:79]
    v_fma_f32 v41, -v89, v131, v41
    v_mfma_f32_16x16x32_bf16 v[80:83], v[160:163], v[200:203], v[80:83]
    v_fma_f32 v45, -v93, v131, v45
    v_mfma_f32_16x16x32_bf16 v[84:87], v[164:167], v[200:203], v[84:87]
    v_fma_f32 v49, -v89, v132, v49
    s_waitcnt lgkmcnt(0)
    s_barrier
    v_mfma_f32_16x16x32_bf16 v[16:19], v[204:207], v[212:215], v[16:19]
    ds_read_b128 v[160:163], v3 offset:0
    v_fma_f32 v54, -v94, v132, v54
    v_mfma_f32_16x16x32_bf16 v[20:23], v[208:211], v[212:215], v[20:23]
    ds_read_b128 v[164:167], v3 offset:2048
    v_fma_f32 v58, -v90, v133, v58
    v_mfma_f32_16x16x32_bf16 v[24:27], v[204:207], v[216:219], v[24:27]
    ds_read_b128 v[168:171], v1 offset:0
    v_fma_f32 v62, -v94, v133, v62
    v_mfma_f32_16x16x32_bf16 v[28:31], v[208:211], v[216:219], v[28:31]
    ds_read_b128 v[172:175], v1 offset:1024
    v_fma_f32 v66, -v90, v134, v66
    v_mfma_f32_16x16x32_bf16 v[32:35], v[204:207], v[220:223], v[32:35]
    ds_read_b128 v[176:179], v1 offset:2048
    v_fma_f32 v70, -v94, v134, v70
    v_mfma_f32_16x16x32_bf16 v[36:39], v[208:211], v[220:223], v[36:39]
    ds_read_b128 v[180:183], v1 offset:3072
    v_fma_f32 v74, -v90, v135, v74
    v_mfma_f32_16x16x32_bf16 v[40:43], v[204:207], v[224:227], v[40:43]
    ds_read_b128 v[184:187], v1 offset:4096
    v_fma_f32 v78, -v94, v135, v78
    v_mfma_f32_16x16x32_bf16 v[44:47], v[208:211], v[224:227], v[44:47]
    ds_read_b128 v[188:191], v1 offset:5120
    v_fma_f32 v82, -v90, v136, v82
    v_mfma_f32_16x16x32_bf16 v[48:51], v[204:207], v[228:231], v[48:51]
    ds_read_b128 v[192:195], v1 offset:6144
    v_fma_f32 v86, -v94, v136, v86
    v_mfma_f32_16x16x32_bf16 v[52:55], v[208:211], v[228:231], v[52:55]
    ds_read_b128 v[196:199], v1 offset:7168
    v_fma_f32 v18, -v90, v128, v18
    v_mfma_f32_16x16x32_bf16 v[56:59], v[204:207], v[232:235], v[56:59]
    ds_read_b128 v[200:203], v1 offset:8192
    v_fma_f32 v22, -v94, v128, v22
    v_mfma_f32_16x16x32_bf16 v[60:63], v[208:211], v[232:235], v[60:63]
    v_fma_f32 v26, -v90, v129, v26
    v_mfma_f32_16x16x32_bf16 v[64:67], v[204:207], v[236:239], v[64:67]
    v_fma_f32 v30, -v94, v129, v30
    v_mfma_f32_16x16x32_bf16 v[68:71], v[208:211], v[236:239], v[68:71]
    v_fma_f32 v34, -v90, v130, v34
    v_mfma_f32_16x16x32_bf16 v[72:75], v[204:207], v[240:243], v[72:75]
    v_fma_f32 v38, -v94, v130, v38
    v_mfma_f32_16x16x32_bf16 v[76:79], v[208:211], v[240:243], v[76:79]
    v_fma_f32 v42, -v90, v131, v42
    v_mfma_f32_16x16x32_bf16 v[80:83], v[204:207], v[244:247], v[80:83]
    v_fma_f32 v46, -v94, v131, v46
    v_mfma_f32_16x16x32_bf16 v[84:87], v[208:211], v[244:247], v[84:87]
    v_fma_f32 v50, -v90, v132, v50
    s_waitcnt lgkmcnt(5)
    v_mfma_f32_16x16x32_bf16 v[16:19], v[160:163], v[168:171], v[16:19]
    ds_read_b128 v[204:207], v3 offset:1024
    v_fma_f32 v55, -v95, v132, v55
    v_mfma_f32_16x16x32_bf16 v[20:23], v[164:167], v[168:171], v[20:23]
    ds_read_b128 v[208:211], v3 offset:3072
    v_fma_f32 v59, -v91, v133, v59
    v_mfma_f32_16x16x32_bf16 v[24:27], v[160:163], v[172:175], v[24:27]
    ds_read_b128 v[212:215], v1 offset:9216
    v_fma_f32 v63, -v95, v133, v63
    v_mfma_f32_16x16x32_bf16 v[28:31], v[164:167], v[172:175], v[28:31]
    ds_read_b128 v[216:219], v1 offset:10240
    v_fma_f32 v67, -v91, v134, v67
    v_mfma_f32_16x16x32_bf16 v[32:35], v[160:163], v[176:179], v[32:35]
    ds_read_b128 v[220:223], v1 offset:11264
    v_fma_f32 v71, -v95, v134, v71
    v_mfma_f32_16x16x32_bf16 v[36:39], v[164:167], v[176:179], v[36:39]
    ds_read_b128 v[224:227], v1 offset:12288
    v_fma_f32 v75, -v91, v135, v75
    v_mfma_f32_16x16x32_bf16 v[40:43], v[160:163], v[180:183], v[40:43]
    ds_read_b128 v[228:231], v1 offset:13312
    v_fma_f32 v79, -v95, v135, v79
    v_mfma_f32_16x16x32_bf16 v[44:47], v[164:167], v[180:183], v[44:47]
    ds_read_b128 v[232:235], v1 offset:14336
    s_waitcnt lgkmcnt(8)
    v_fma_f32 v83, -v91, v136, v83
    v_mfma_f32_16x16x32_bf16 v[48:51], v[160:163], v[184:187], v[48:51]
    ds_read_b128 v[236:239], v1 offset:15360
    v_fma_f32 v87, -v95, v136, v87
    v_mfma_f32_16x16x32_bf16 v[52:55], v[164:167], v[184:187], v[52:55]
    ds_read_b128 v[240:243], v1 offset:16384
    v_fma_f32 v19, -v91, v128, v19
    v_mfma_f32_16x16x32_bf16 v[56:59], v[160:163], v[188:191], v[56:59]
    ds_read_b128 v[244:247], v1 offset:17408
    v_fma_f32 v23, -v95, v128, v23
    v_mfma_f32_16x16x32_bf16 v[60:63], v[164:167], v[188:191], v[60:63]
    v_fma_f32 v27, -v91, v129, v27
    v_mfma_f32_16x16x32_bf16 v[64:67], v[160:163], v[192:195], v[64:67]
    v_fma_f32 v31, -v95, v129, v31
    v_mfma_f32_16x16x32_bf16 v[68:71], v[164:167], v[192:195], v[68:71]
    v_fma_f32 v35, -v91, v130, v35
    v_mfma_f32_16x16x32_bf16 v[72:75], v[160:163], v[196:199], v[72:75]
    v_fma_f32 v39, -v95, v130, v39
    v_mfma_f32_16x16x32_bf16 v[76:79], v[164:167], v[196:199], v[76:79]
    v_fma_f32 v43, -v91, v131, v43
    v_mfma_f32_16x16x32_bf16 v[80:83], v[160:163], v[200:203], v[80:83]
    v_fma_f32 v47, -v95, v131, v47
    v_mfma_f32_16x16x32_bf16 v[84:87], v[164:167], v[200:203], v[84:87]
    v_fma_f32 v51, -v91, v132, v51
    s_waitcnt lgkmcnt(0)
    s_barrier
    v_mfma_f32_16x16x32_bf16 v[16:19], v[204:207], v[212:215], v[16:19]
    ds_read_b128 v[160:163], v3 offset:36864
    v_mfma_f32_16x16x32_bf16 v[20:23], v[208:211], v[212:215], v[20:23]
    ds_read_b128 v[164:167], v3 offset:38912
    v_mfma_f32_16x16x32_bf16 v[24:27], v[204:207], v[216:219], v[24:27]
    ds_read_b128 v[168:171], v1 offset:36864
    v_mfma_f32_16x16x32_bf16 v[28:31], v[208:211], v[216:219], v[28:31]
    ds_read_b128 v[172:175], v1 offset:37888
    v_mfma_f32_16x16x32_bf16 v[32:35], v[204:207], v[220:223], v[32:35]
    ds_read_b128 v[176:179], v1 offset:38912
    v_mfma_f32_16x16x32_bf16 v[36:39], v[208:211], v[220:223], v[36:39]
    ds_read_b128 v[180:183], v1 offset:39936
    v_mfma_f32_16x16x32_bf16 v[40:43], v[204:207], v[224:227], v[40:43]
    ds_read_b128 v[184:187], v1 offset:40960
    v_mfma_f32_16x16x32_bf16 v[44:47], v[208:211], v[224:227], v[44:47]
    ds_read_b128 v[188:191], v1 offset:41984
    v_mfma_f32_16x16x32_bf16 v[48:51], v[204:207], v[228:231], v[48:51]
    ds_read_b128 v[192:195], v1 offset:43008
    v_mfma_f32_16x16x32_bf16 v[52:55], v[208:211], v[228:231], v[52:55]
    ds_read_b128 v[196:199], v1 offset:44032
    v_mfma_f32_16x16x32_bf16 v[56:59], v[204:207], v[232:235], v[56:59]
    ds_read_b128 v[200:203], v1 offset:45056
    v_mfma_f32_16x16x32_bf16 v[60:63], v[208:211], v[232:235], v[60:63]
    v_mfma_f32_16x16x32_bf16 v[64:67], v[204:207], v[236:239], v[64:67]
    v_mfma_f32_16x16x32_bf16 v[68:71], v[208:211], v[236:239], v[68:71]
    v_mfma_f32_16x16x32_bf16 v[72:75], v[204:207], v[240:243], v[72:75]
    v_mfma_f32_16x16x32_bf16 v[76:79], v[208:211], v[240:243], v[76:79]
    v_mfma_f32_16x16x32_bf16 v[80:83], v[204:207], v[244:247], v[80:83]
    v_mfma_f32_16x16x32_bf16 v[84:87], v[208:211], v[244:247], v[84:87]
    v_pk_mul_f32 v[220:221], v[16:17], v[16:17]
    v_pk_mul_f32 v[222:223], v[18:19], v[18:19]
    v_pk_mul_f32 v[224:225], v[20:21], v[20:21]
    v_pk_mul_f32 v[226:227], v[22:23], v[22:23]
    v_pk_fma_f32 v[220:221], v[220:221], v[112:113], v[104:105]
    v_pk_fma_f32 v[222:223], v[222:223], v[114:115], v[106:107]
    v_pk_fma_f32 v[224:225], v[224:225], v[116:117], v[108:109]
    v_pk_fma_f32 v[226:227], v[226:227], v[118:119], v[110:111]
    v_pk_mul_f32 v[220:221], v[220:221], v[16:17]
    v_pk_mul_f32 v[222:223], v[222:223], v[18:19]
    v_pk_mul_f32 v[224:225], v[224:225], v[20:21]
    v_pk_mul_f32 v[226:227], v[226:227], v[22:23]
    v_exp_f32 v220, v220
    v_exp_f32 v221, v221
    v_exp_f32 v222, v222
    v_exp_f32 v223, v223
    v_exp_f32 v224, v224
    v_exp_f32 v225, v225
    v_exp_f32 v226, v226
    v_exp_f32 v227, v227
    v_pk_fma_f32 v[220:221], v[220:221], v[120:121], v[120:121]
    v_pk_fma_f32 v[222:223], v[222:223], v[122:123], v[122:123]
    v_pk_fma_f32 v[224:225], v[224:225], v[124:125], v[124:125]
    v_pk_fma_f32 v[226:227], v[226:227], v[126:127], v[126:127]
    v_rcp_f32 v220, v220
    v_rcp_f32 v221, v221
    v_rcp_f32 v222, v222
    v_rcp_f32 v223, v223
    v_rcp_f32 v224, v224
    v_rcp_f32 v225, v225
    v_rcp_f32 v226, v226
    v_rcp_f32 v227, v227
    v_pk_mul_f32 v[16:17], v[16:17], v[220:221]
    v_pk_mul_f32 v[18:19], v[18:19], v[222:223]
    v_pk_mul_f32 v[20:21], v[20:21], v[224:225]
    v_pk_mul_f32 v[22:23], v[22:23], v[226:227]
    v_pk_mul_f32 v[206:207], v[16:17], v[16:17]
    v_pk_mul_f32 v[210:211], v[18:19], v[18:19]
    v_pk_mul_f32 v[214:215], v[20:21], v[20:21]
    v_pk_mul_f32 v[218:219], v[22:23], v[22:23]
    v_pk_mul_f32 v[228:229], v[24:25], v[24:25]
    v_pk_mul_f32 v[230:231], v[26:27], v[26:27]
    v_pk_mul_f32 v[232:233], v[28:29], v[28:29]
    v_pk_mul_f32 v[234:235], v[30:31], v[30:31]
    v_pk_fma_f32 v[228:229], v[228:229], v[112:113], v[104:105]
    v_pk_fma_f32 v[230:231], v[230:231], v[114:115], v[106:107]
    v_pk_fma_f32 v[232:233], v[232:233], v[116:117], v[108:109]
    v_pk_fma_f32 v[234:235], v[234:235], v[118:119], v[110:111]
    v_pk_mul_f32 v[228:229], v[228:229], v[24:25]
    v_pk_mul_f32 v[230:231], v[230:231], v[26:27]
    v_pk_mul_f32 v[232:233], v[232:233], v[28:29]
    v_pk_mul_f32 v[234:235], v[234:235], v[30:31]
    v_exp_f32 v228, v228
    v_exp_f32 v229, v229
    v_exp_f32 v230, v230
    v_exp_f32 v231, v231
    v_exp_f32 v232, v232
    v_exp_f32 v233, v233
    v_exp_f32 v234, v234
    v_exp_f32 v235, v235
    v_pk_fma_f32 v[228:229], v[228:229], v[120:121], v[120:121]
    v_pk_fma_f32 v[230:231], v[230:231], v[122:123], v[122:123]
    v_pk_fma_f32 v[232:233], v[232:233], v[124:125], v[124:125]
    v_pk_fma_f32 v[234:235], v[234:235], v[126:127], v[126:127]
    v_rcp_f32 v228, v228
    v_rcp_f32 v229, v229
    v_rcp_f32 v230, v230
    v_rcp_f32 v231, v231
    v_rcp_f32 v232, v232
    v_rcp_f32 v233, v233
    v_rcp_f32 v234, v234
    v_rcp_f32 v235, v235
    v_pk_mul_f32 v[24:25], v[24:25], v[228:229]
    v_pk_mul_f32 v[26:27], v[26:27], v[230:231]
    v_pk_mul_f32 v[28:29], v[28:29], v[232:233]
    v_pk_mul_f32 v[30:31], v[30:31], v[234:235]
    v_pk_add_f32 v[204:205], v[16:17], v[24:25]
    v_pk_fma_f32 v[206:207], v[24:25], v[24:25], v[206:207]
    v_pk_add_f32 v[208:209], v[18:19], v[26:27]
    v_pk_fma_f32 v[210:211], v[26:27], v[26:27], v[210:211]
    v_pk_add_f32 v[212:213], v[20:21], v[28:29]
    v_pk_fma_f32 v[214:215], v[28:29], v[28:29], v[214:215]
    v_pk_add_f32 v[216:217], v[22:23], v[30:31]
    v_pk_fma_f32 v[218:219], v[30:31], v[30:31], v[218:219]
    v_pk_mul_f32 v[220:221], v[32:33], v[32:33]
    v_pk_mul_f32 v[222:223], v[34:35], v[34:35]
    v_pk_mul_f32 v[224:225], v[36:37], v[36:37]
    v_pk_mul_f32 v[226:227], v[38:39], v[38:39]
    v_pk_fma_f32 v[220:221], v[220:221], v[112:113], v[104:105]
    v_pk_fma_f32 v[222:223], v[222:223], v[114:115], v[106:107]
    v_pk_fma_f32 v[224:225], v[224:225], v[116:117], v[108:109]
    v_pk_fma_f32 v[226:227], v[226:227], v[118:119], v[110:111]
    v_pk_mul_f32 v[220:221], v[220:221], v[32:33]
    v_pk_mul_f32 v[222:223], v[222:223], v[34:35]
    v_pk_mul_f32 v[224:225], v[224:225], v[36:37]
    v_pk_mul_f32 v[226:227], v[226:227], v[38:39]
    v_exp_f32 v220, v220
    v_exp_f32 v221, v221
    v_exp_f32 v222, v222
    v_exp_f32 v223, v223
    v_exp_f32 v224, v224
    v_exp_f32 v225, v225
    v_exp_f32 v226, v226
    v_exp_f32 v227, v227
    v_pk_fma_f32 v[220:221], v[220:221], v[120:121], v[120:121]
    v_pk_fma_f32 v[222:223], v[222:223], v[122:123], v[122:123]
    v_pk_fma_f32 v[224:225], v[224:225], v[124:125], v[124:125]
    v_pk_fma_f32 v[226:227], v[226:227], v[126:127], v[126:127]
    v_rcp_f32 v220, v220
    v_rcp_f32 v221, v221
    v_rcp_f32 v222, v222
    v_rcp_f32 v223, v223
    v_rcp_f32 v224, v224
    v_rcp_f32 v225, v225
    v_rcp_f32 v226, v226
    v_rcp_f32 v227, v227
    v_pk_mul_f32 v[32:33], v[32:33], v[220:221]
    v_pk_mul_f32 v[34:35], v[34:35], v[222:223]
    v_pk_mul_f32 v[36:37], v[36:37], v[224:225]
    v_pk_mul_f32 v[38:39], v[38:39], v[226:227]
    v_pk_add_f32 v[204:205], v[204:205], v[32:33]
    v_pk_fma_f32 v[206:207], v[32:33], v[32:33], v[206:207]
    v_pk_add_f32 v[208:209], v[208:209], v[34:35]
    v_pk_fma_f32 v[210:211], v[34:35], v[34:35], v[210:211]
    v_pk_add_f32 v[212:213], v[212:213], v[36:37]
    v_pk_fma_f32 v[214:215], v[36:37], v[36:37], v[214:215]
    v_pk_add_f32 v[216:217], v[216:217], v[38:39]
    v_pk_fma_f32 v[218:219], v[38:39], v[38:39], v[218:219]
    v_pk_mul_f32 v[228:229], v[40:41], v[40:41]
    v_pk_mul_f32 v[230:231], v[42:43], v[42:43]
    v_pk_mul_f32 v[232:233], v[44:45], v[44:45]
    v_pk_mul_f32 v[234:235], v[46:47], v[46:47]
    v_pk_fma_f32 v[228:229], v[228:229], v[112:113], v[104:105]
    v_pk_fma_f32 v[230:231], v[230:231], v[114:115], v[106:107]
    v_pk_fma_f32 v[232:233], v[232:233], v[116:117], v[108:109]
    v_pk_fma_f32 v[234:235], v[234:235], v[118:119], v[110:111]
    v_pk_mul_f32 v[228:229], v[228:229], v[40:41]
    v_pk_mul_f32 v[230:231], v[230:231], v[42:43]
    v_pk_mul_f32 v[232:233], v[232:233], v[44:45]
    v_pk_mul_f32 v[234:235], v[234:235], v[46:47]
    v_exp_f32 v228, v228
    v_exp_f32 v229, v229
    v_exp_f32 v230, v230
    v_exp_f32 v231, v231
    v_exp_f32 v232, v232
    v_exp_f32 v233, v233
    v_exp_f32 v234, v234
    v_exp_f32 v235, v235
    v_pk_fma_f32 v[228:229], v[228:229], v[120:121], v[120:121]
    v_pk_fma_f32 v[230:231], v[230:231], v[122:123], v[122:123]
    v_pk_fma_f32 v[232:233], v[232:233], v[124:125], v[124:125]
    v_pk_fma_f32 v[234:235], v[234:235], v[126:127], v[126:127]
    v_rcp_f32 v228, v228
    v_rcp_f32 v229, v229
    v_rcp_f32 v230, v230
    v_rcp_f32 v231, v231
    v_rcp_f32 v232, v232
    v_rcp_f32 v233, v233
    v_rcp_f32 v234, v234
    v_rcp_f32 v235, v235
    v_pk_mul_f32 v[40:41], v[40:41], v[228:229]
    v_pk_mul_f32 v[42:43], v[42:43], v[230:231]
    v_pk_mul_f32 v[44:45], v[44:45], v[232:233]
    v_pk_mul_f32 v[46:47], v[46:47], v[234:235]
    v_pk_add_f32 v[204:205], v[204:205], v[40:41]
    v_pk_fma_f32 v[206:207], v[40:41], v[40:41], v[206:207]
    v_pk_add_f32 v[208:209], v[208:209], v[42:43]
    v_pk_fma_f32 v[210:211], v[42:43], v[42:43], v[210:211]
    v_pk_add_f32 v[212:213], v[212:213], v[44:45]
    v_pk_fma_f32 v[214:215], v[44:45], v[44:45], v[214:215]
    v_pk_add_f32 v[216:217], v[216:217], v[46:47]
    v_pk_fma_f32 v[218:219], v[46:47], v[46:47], v[218:219]
    v_pk_mul_f32 v[220:221], v[48:49], v[48:49]
    v_pk_mul_f32 v[222:223], v[50:51], v[50:51]
    v_pk_mul_f32 v[224:225], v[52:53], v[52:53]
    v_pk_mul_f32 v[226:227], v[54:55], v[54:55]
    v_pk_fma_f32 v[220:221], v[220:221], v[112:113], v[104:105]
    v_pk_fma_f32 v[222:223], v[222:223], v[114:115], v[106:107]
    v_pk_fma_f32 v[224:225], v[224:225], v[116:117], v[108:109]
    v_pk_fma_f32 v[226:227], v[226:227], v[118:119], v[110:111]
    v_pk_mul_f32 v[220:221], v[220:221], v[48:49]
    v_pk_mul_f32 v[222:223], v[222:223], v[50:51]
    v_pk_mul_f32 v[224:225], v[224:225], v[52:53]
    v_pk_mul_f32 v[226:227], v[226:227], v[54:55]
    v_exp_f32 v220, v220
    v_exp_f32 v221, v221
    v_exp_f32 v222, v222
    v_exp_f32 v223, v223
    v_exp_f32 v224, v224
    v_exp_f32 v225, v225
    v_exp_f32 v226, v226
    v_exp_f32 v227, v227
    v_pk_fma_f32 v[220:221], v[220:221], v[120:121], v[120:121]
    v_pk_fma_f32 v[222:223], v[222:223], v[122:123], v[122:123]
    v_pk_fma_f32 v[224:225], v[224:225], v[124:125], v[124:125]
    v_pk_fma_f32 v[226:227], v[226:227], v[126:127], v[126:127]
    v_rcp_f32 v220, v220
    v_rcp_f32 v221, v221
    v_rcp_f32 v222, v222
    v_rcp_f32 v223, v223
    v_rcp_f32 v224, v224
    v_rcp_f32 v225, v225
    v_rcp_f32 v226, v226
    v_rcp_f32 v227, v227
    v_pk_mul_f32 v[48:49], v[48:49], v[220:221]
    v_pk_mul_f32 v[50:51], v[50:51], v[222:223]
    v_pk_mul_f32 v[52:53], v[52:53], v[224:225]
    v_pk_mul_f32 v[54:55], v[54:55], v[226:227]
    v_pk_add_f32 v[204:205], v[204:205], v[48:49]
    v_pk_fma_f32 v[206:207], v[48:49], v[48:49], v[206:207]
    v_pk_add_f32 v[208:209], v[208:209], v[50:51]
    v_pk_fma_f32 v[210:211], v[50:51], v[50:51], v[210:211]
    v_pk_add_f32 v[212:213], v[212:213], v[52:53]
    v_pk_fma_f32 v[214:215], v[52:53], v[52:53], v[214:215]
    v_pk_add_f32 v[216:217], v[216:217], v[54:55]
    v_pk_fma_f32 v[218:219], v[54:55], v[54:55], v[218:219]
    v_pk_mul_f32 v[228:229], v[56:57], v[56:57]
    v_pk_mul_f32 v[230:231], v[58:59], v[58:59]
    v_pk_mul_f32 v[232:233], v[60:61], v[60:61]
    v_pk_mul_f32 v[234:235], v[62:63], v[62:63]
    v_pk_fma_f32 v[228:229], v[228:229], v[112:113], v[104:105]
    v_pk_fma_f32 v[230:231], v[230:231], v[114:115], v[106:107]
    v_pk_fma_f32 v[232:233], v[232:233], v[116:117], v[108:109]
    v_pk_fma_f32 v[234:235], v[234:235], v[118:119], v[110:111]
    v_pk_mul_f32 v[228:229], v[228:229], v[56:57]
    v_pk_mul_f32 v[230:231], v[230:231], v[58:59]
    v_pk_mul_f32 v[232:233], v[232:233], v[60:61]
    v_pk_mul_f32 v[234:235], v[234:235], v[62:63]
    v_exp_f32 v228, v228
    v_exp_f32 v229, v229
    v_exp_f32 v230, v230
    v_exp_f32 v231, v231
    v_exp_f32 v232, v232
    v_exp_f32 v233, v233
    v_exp_f32 v234, v234
    v_exp_f32 v235, v235
    v_pk_fma_f32 v[228:229], v[228:229], v[120:121], v[120:121]
    v_pk_fma_f32 v[230:231], v[230:231], v[122:123], v[122:123]
    v_pk_fma_f32 v[232:233], v[232:233], v[124:125], v[124:125]
    v_pk_fma_f32 v[234:235], v[234:235], v[126:127], v[126:127]
    v_rcp_f32 v228, v228
    v_rcp_f32 v229, v229
    v_rcp_f32 v230, v230
    v_rcp_f32 v231, v231
    v_rcp_f32 v232, v232
    v_rcp_f32 v233, v233
    v_rcp_f32 v234, v234
    v_rcp_f32 v235, v235
    v_pk_mul_f32 v[56:57], v[56:57], v[228:229]
    v_pk_mul_f32 v[58:59], v[58:59], v[230:231]
    v_pk_mul_f32 v[60:61], v[60:61], v[232:233]
    v_pk_mul_f32 v[62:63], v[62:63], v[234:235]
    v_pk_add_f32 v[204:205], v[204:205], v[56:57]
    v_pk_fma_f32 v[206:207], v[56:57], v[56:57], v[206:207]
    v_pk_add_f32 v[208:209], v[208:209], v[58:59]
    v_pk_fma_f32 v[210:211], v[58:59], v[58:59], v[210:211]
    v_pk_add_f32 v[212:213], v[212:213], v[60:61]
    v_pk_fma_f32 v[214:215], v[60:61], v[60:61], v[214:215]
    v_pk_add_f32 v[216:217], v[216:217], v[62:63]
    v_pk_fma_f32 v[218:219], v[62:63], v[62:63], v[218:219]
    v_pk_mul_f32 v[220:221], v[64:65], v[64:65]
    v_pk_mul_f32 v[222:223], v[66:67], v[66:67]
    v_pk_mul_f32 v[224:225], v[68:69], v[68:69]
    v_pk_mul_f32 v[226:227], v[70:71], v[70:71]
    v_pk_fma_f32 v[220:221], v[220:221], v[112:113], v[104:105]
    v_pk_fma_f32 v[222:223], v[222:223], v[114:115], v[106:107]
    v_pk_fma_f32 v[224:225], v[224:225], v[116:117], v[108:109]
    v_pk_fma_f32 v[226:227], v[226:227], v[118:119], v[110:111]
    v_pk_mul_f32 v[220:221], v[220:221], v[64:65]
    v_pk_mul_f32 v[222:223], v[222:223], v[66:67]
    v_pk_mul_f32 v[224:225], v[224:225], v[68:69]
    v_pk_mul_f32 v[226:227], v[226:227], v[70:71]
    v_exp_f32 v220, v220
    v_exp_f32 v221, v221
    v_exp_f32 v222, v222
    v_exp_f32 v223, v223
    v_exp_f32 v224, v224
    v_exp_f32 v225, v225
    v_exp_f32 v226, v226
    v_exp_f32 v227, v227
    v_pk_fma_f32 v[220:221], v[220:221], v[120:121], v[120:121]
    v_pk_fma_f32 v[222:223], v[222:223], v[122:123], v[122:123]
    v_pk_fma_f32 v[224:225], v[224:225], v[124:125], v[124:125]
    v_pk_fma_f32 v[226:227], v[226:227], v[126:127], v[126:127]
    v_rcp_f32 v220, v220
    v_rcp_f32 v221, v221
    v_rcp_f32 v222, v222
    v_rcp_f32 v223, v223
    v_rcp_f32 v224, v224
    v_rcp_f32 v225, v225
    v_rcp_f32 v226, v226
    v_rcp_f32 v227, v227
    v_pk_mul_f32 v[64:65], v[64:65], v[220:221]
    v_pk_mul_f32 v[66:67], v[66:67], v[222:223]
    v_pk_mul_f32 v[68:69], v[68:69], v[224:225]
    v_pk_mul_f32 v[70:71], v[70:71], v[226:227]
    v_pk_add_f32 v[204:205], v[204:205], v[64:65]
    v_pk_fma_f32 v[206:207], v[64:65], v[64:65], v[206:207]
    v_pk_add_f32 v[208:209], v[208:209], v[66:67]
    v_pk_fma_f32 v[210:211], v[66:67], v[66:67], v[210:211]
    v_pk_add_f32 v[212:213], v[212:213], v[68:69]
    v_pk_fma_f32 v[214:215], v[68:69], v[68:69], v[214:215]
    v_pk_add_f32 v[216:217], v[216:217], v[70:71]
    v_pk_fma_f32 v[218:219], v[70:71], v[70:71], v[218:219]
    v_pk_mul_f32 v[228:229], v[72:73], v[72:73]
    v_pk_mul_f32 v[230:231], v[74:75], v[74:75]
    v_pk_mul_f32 v[232:233], v[76:77], v[76:77]
    v_pk_mul_f32 v[234:235], v[78:79], v[78:79]
    v_pk_fma_f32 v[228:229], v[228:229], v[112:113], v[104:105]
    v_pk_fma_f32 v[230:231], v[230:231], v[114:115], v[106:107]
    v_pk_fma_f32 v[232:233], v[232:233], v[116:117], v[108:109]
    v_pk_fma_f32 v[234:235], v[234:235], v[118:119], v[110:111]
    v_pk_mul_f32 v[228:229], v[228:229], v[72:73]
    v_pk_mul_f32 v[230:231], v[230:231], v[74:75]
    v_pk_mul_f32 v[232:233], v[232:233], v[76:77]
    v_pk_mul_f32 v[234:235], v[234:235], v[78:79]
    v_exp_f32 v228, v228
    v_exp_f32 v229, v229
    v_exp_f32 v230, v230
    v_exp_f32 v231, v231
    v_exp_f32 v232, v232
    v_exp_f32 v233, v233
    v_exp_f32 v234, v234
    v_exp_f32 v235, v235
    v_pk_fma_f32 v[228:229], v[228:229], v[120:121], v[120:121]
    v_pk_fma_f32 v[230:231], v[230:231], v[122:123], v[122:123]
    v_pk_fma_f32 v[232:233], v[232:233], v[124:125], v[124:125]
    v_pk_fma_f32 v[234:235], v[234:235], v[126:127], v[126:127]
    v_rcp_f32 v228, v228
    v_rcp_f32 v229, v229
    v_rcp_f32 v230, v230
    v_rcp_f32 v231, v231
    v_rcp_f32 v232, v232
    v_rcp_f32 v233, v233
    v_rcp_f32 v234, v234
    v_rcp_f32 v235, v235
    v_pk_mul_f32 v[72:73], v[72:73], v[228:229]
    v_pk_mul_f32 v[74:75], v[74:75], v[230:231]
    v_pk_mul_f32 v[76:77], v[76:77], v[232:233]
    v_pk_mul_f32 v[78:79], v[78:79], v[234:235]
    v_pk_add_f32 v[204:205], v[204:205], v[72:73]
    v_pk_fma_f32 v[206:207], v[72:73], v[72:73], v[206:207]
    v_pk_add_f32 v[208:209], v[208:209], v[74:75]
    v_pk_fma_f32 v[210:211], v[74:75], v[74:75], v[210:211]
    v_pk_add_f32 v[212:213], v[212:213], v[76:77]
    v_pk_fma_f32 v[214:215], v[76:77], v[76:77], v[214:215]
    v_pk_add_f32 v[216:217], v[216:217], v[78:79]
    v_pk_fma_f32 v[218:219], v[78:79], v[78:79], v[218:219]
    v_pk_mul_f32 v[220:221], v[80:81], v[80:81]
    v_pk_mul_f32 v[222:223], v[82:83], v[82:83]
    v_pk_mul_f32 v[224:225], v[84:85], v[84:85]
    v_pk_mul_f32 v[226:227], v[86:87], v[86:87]
    v_pk_fma_f32 v[220:221], v[220:221], v[112:113], v[104:105]
    v_pk_fma_f32 v[222:223], v[222:223], v[114:115], v[106:107]
    v_pk_fma_f32 v[224:225], v[224:225], v[116:117], v[108:109]
    v_pk_fma_f32 v[226:227], v[226:227], v[118:119], v[110:111]
    v_pk_mul_f32 v[220:221], v[220:221], v[80:81]
    v_pk_mul_f32 v[222:223], v[222:223], v[82:83]
    v_pk_mul_f32 v[224:225], v[224:225], v[84:85]
    v_pk_mul_f32 v[226:227], v[226:227], v[86:87]
    v_exp_f32 v220, v220
    v_exp_f32 v221, v221
    v_exp_f32 v222, v222
    v_exp_f32 v223, v223
    v_exp_f32 v224, v224
    v_exp_f32 v225, v225
    v_exp_f32 v226, v226
    v_exp_f32 v227, v227
    v_pk_fma_f32 v[220:221], v[220:221], v[120:121], v[120:121]
    v_pk_fma_f32 v[222:223], v[222:223], v[122:123], v[122:123]
    v_pk_fma_f32 v[224:225], v[224:225], v[124:125], v[124:125]
    v_pk_fma_f32 v[226:227], v[226:227], v[126:127], v[126:127]
    v_rcp_f32 v220, v220
    v_rcp_f32 v221, v221
    v_rcp_f32 v222, v222
    v_rcp_f32 v223, v223
    v_rcp_f32 v224, v224
    v_rcp_f32 v225, v225
    v_rcp_f32 v226, v226
    v_rcp_f32 v227, v227
    v_pk_mul_f32 v[80:81], v[80:81], v[220:221]
    v_pk_mul_f32 v[82:83], v[82:83], v[222:223]
    v_pk_mul_f32 v[84:85], v[84:85], v[224:225]
    v_pk_mul_f32 v[86:87], v[86:87], v[226:227]
    v_pk_add_f32 v[204:205], v[204:205], v[80:81]
    v_pk_fma_f32 v[206:207], v[80:81], v[80:81], v[206:207]
    v_pk_add_f32 v[208:209], v[208:209], v[82:83]
    v_pk_fma_f32 v[210:211], v[82:83], v[82:83], v[210:211]
    v_pk_add_f32 v[212:213], v[212:213], v[84:85]
    v_pk_fma_f32 v[214:215], v[84:85], v[84:85], v[214:215]
    v_pk_add_f32 v[216:217], v[216:217], v[86:87]
    v_pk_fma_f32 v[218:219], v[86:87], v[86:87], v[218:219]
    v_add_f32_dpp v204, v204, v204 row_mirror row_mask:0xf bank_mask:0x3
    v_add_f32_dpp v205, v205, v205 row_mirror row_mask:0xf bank_mask:0x3
    v_add_f32_dpp v206, v206, v206 row_mirror row_mask:0xf bank_mask:0x3
    v_add_f32_dpp v207, v207, v207 row_mirror row_mask:0xf bank_mask:0x3
    v_add_f32_dpp v208, v208, v208 row_mirror row_mask:0xf bank_mask:0x3
    v_add_f32_dpp v209, v209, v209 row_mirror row_mask:0xf bank_mask:0x3
    v_add_f32_dpp v210, v210, v210 row_mirror row_mask:0xf bank_mask:0x3
    v_add_f32_dpp v211, v211, v211 row_mirror row_mask:0xf bank_mask:0x3
    v_add_f32_dpp v204, v212, v212 row_mirror row_mask:0xf bank_mask:0xc
    v_add_f32_dpp v205, v213, v213 row_mirror row_mask:0xf bank_mask:0xc
    v_add_f32_dpp v206, v214, v214 row_mirror row_mask:0xf bank_mask:0xc
    v_add_f32_dpp v207, v215, v215 row_mirror row_mask:0xf bank_mask:0xc
    v_add_f32_dpp v208, v216, v216 row_mirror row_mask:0xf bank_mask:0xc
    v_add_f32_dpp v209, v217, v217 row_mirror row_mask:0xf bank_mask:0xc
    v_add_f32_dpp v210, v218, v218 row_mirror row_mask:0xf bank_mask:0xc
    v_add_f32_dpp v211, v219, v219 row_mirror row_mask:0xf bank_mask:0xc
    v_add_f32_dpp v204, v204, v204 row_half_mirror row_mask:0xf bank_mask:0x5
    v_add_f32_dpp v205, v205, v205 row_half_mirror row_mask:0xf bank_mask:0x5
    v_add_f32_dpp v206, v206, v206 row_half_mirror row_mask:0xf bank_mask:0x5
    v_add_f32_dpp v207, v207, v207 row_half_mirror row_mask:0xf bank_mask:0x5
    v_add_f32_dpp v204, v208, v208 row_half_mirror row_mask:0xf bank_mask:0xa
    v_add_f32_dpp v205, v209, v209 row_half_mirror row_mask:0xf bank_mask:0xa
    v_add_f32_dpp v206, v210, v210 row_half_mirror row_mask:0xf bank_mask:0xa
    v_add_f32_dpp v207, v211, v211 row_half_mirror row_mask:0xf bank_mask:0xa
    v_add_f32_dpp v204, v204, v204 quad_perm:[1,0,3,2] row_mask:0xf bank_mask:0xf
    v_add_f32_dpp v205, v205, v205 quad_perm:[1,0,3,2] row_mask:0xf bank_mask:0xf
    v_add_f32_dpp v206, v206, v206 quad_perm:[1,0,3,2] row_mask:0xf bank_mask:0xf
    v_add_f32_dpp v207, v207, v207 quad_perm:[1,0,3,2] row_mask:0xf bank_mask:0xf
    v_add_f32_dpp v12, v204, v204 quad_perm:[2,3,0,1] row_mask:0xf bank_mask:0xf
    v_add_f32_dpp v14, v205, v205 quad_perm:[2,3,0,1] row_mask:0xf bank_mask:0xf
    v_add_f32_dpp v13, v206, v206 quad_perm:[2,3,0,1] row_mask:0xf bank_mask:0xf
    v_add_f32_dpp v15, v207, v207 quad_perm:[2,3,0,1] row_mask:0xf bank_mask:0xf
    buffer_store_dwordx4 v[12:15], v8, s[4:7], s36 offen sc1
    s_waitcnt lgkmcnt(5)
    v_mfma_f32_16x16x32_bf16 v[88:91], v[168:171], v[160:163], 0
    ds_read_b128 v[204:207], v3 offset:37888
    v_mfma_f32_16x16x32_bf16 v[92:95], v[168:171], v[164:167], 0
    ds_read_b128 v[208:211], v3 offset:39936
    v_mfma_f32_16x16x32_bf16 v[96:99], v[172:175], v[160:163], 0
    ds_read_b128 v[212:215], v1 offset:46080
    v_mfma_f32_16x16x32_bf16 v[100:103], v[172:175], v[164:167], 0
    ds_read_b128 v[216:219], v1 offset:47104
    v_mfma_f32_16x16x32_bf16 v[104:107], v[176:179], v[160:163], 0
    ds_read_b128 v[220:223], v1 offset:48128
    v_mfma_f32_16x16x32_bf16 v[108:111], v[176:179], v[164:167], 0
    ds_read_b128 v[224:227], v1 offset:49152
    v_mfma_f32_16x16x32_bf16 v[112:115], v[180:183], v[160:163], 0
    ds_read_b128 v[228:231], v1 offset:50176
    v_mfma_f32_16x16x32_bf16 v[116:119], v[180:183], v[164:167], 0
    ds_read_b128 v[232:235], v1 offset:51200
    s_waitcnt lgkmcnt(8)
    v_mfma_f32_16x16x32_bf16 v[120:123], v[184:187], v[160:163], 0
    ds_read_b128 v[236:239], v1 offset:52224
    v_mfma_f32_16x16x32_bf16 v[124:127], v[184:187], v[164:167], 0
    ds_read_b128 v[240:243], v1 offset:53248
    v_mfma_f32_16x16x32_bf16 v[128:131], v[188:191], v[160:163], 0
    ds_read_b128 v[244:247], v1 offset:54272
    v_mfma_f32_16x16x32_bf16 v[132:135], v[188:191], v[164:167], 0
    v_mfma_f32_16x16x32_bf16 v[136:139], v[192:195], v[160:163], 0
    v_lshrrev_b32 v255, 8, v1
    v_mfma_f32_16x16x32_bf16 v[140:143], v[192:195], v[164:167], 0
    v_lshl_add_u32 v255, v255, 6, s33
    v_mfma_f32_16x16x32_bf16 v[144:147], v[196:199], v[160:163], 0
    v_mfma_f32_16x16x32_bf16 v[148:151], v[196:199], v[164:167], 0
    v_mfma_f32_16x16x32_bf16 v[152:155], v[200:203], v[160:163], 0
    v_mfma_f32_16x16x32_bf16 v[156:159], v[200:203], v[164:167], 0
    s_waitcnt lgkmcnt(0)
    s_barrier
    v_mfma_f32_16x16x32_bf16 v[88:91], v[212:215], v[204:207], v[88:91]
    ds_read_b128 v[160:163], v0 offset:0
    v_mfma_f32_16x16x32_bf16 v[92:95], v[212:215], v[208:211], v[92:95]
    ds_read_b128 v[164:167], v0 offset:2048
    v_mfma_f32_16x16x32_bf16 v[96:99], v[216:219], v[204:207], v[96:99]
    ds_read_b128 v[168:171], v2 offset:0
    v_mfma_f32_16x16x32_bf16 v[100:103], v[216:219], v[208:211], v[100:103]
    ds_read_b128 v[172:175], v2 offset:1024
    v_mfma_f32_16x16x32_bf16 v[104:107], v[220:223], v[204:207], v[104:107]
    ds_read_b128 v[176:179], v2 offset:2048
    v_mfma_f32_16x16x32_bf16 v[108:111], v[220:223], v[208:211], v[108:111]
    ds_read_b128 v[180:183], v2 offset:3072
    v_mfma_f32_16x16x32_bf16 v[112:115], v[224:227], v[204:207], v[112:115]
    ds_read_b128 v[184:187], v2 offset:4096
    v_mfma_f32_16x16x32_bf16 v[116:119], v[224:227], v[208:211], v[116:119]
    ds_read_b128 v[188:191], v2 offset:5120
    v_mfma_f32_16x16x32_bf16 v[120:123], v[228:231], v[204:207], v[120:123]
    ds_read_b128 v[192:195], v2 offset:6144
    v_mfma_f32_16x16x32_bf16 v[124:127], v[228:231], v[208:211], v[124:127]
    ds_read_b128 v[196:199], v2 offset:7168
    v_mfma_f32_16x16x32_bf16 v[128:131], v[232:235], v[204:207], v[128:131]
    ds_read_b128 v[200:203], v2 offset:8192
    v_mfma_f32_16x16x32_bf16 v[132:135], v[232:235], v[208:211], v[132:135]
    v_mfma_f32_16x16x32_bf16 v[136:139], v[236:239], v[204:207], v[136:139]
    v_mfma_f32_16x16x32_bf16 v[140:143], v[236:239], v[208:211], v[140:143]
    v_mfma_f32_16x16x32_bf16 v[144:147], v[240:243], v[204:207], v[144:147]
    v_mfma_f32_16x16x32_bf16 v[148:151], v[240:243], v[208:211], v[148:151]
    v_mfma_f32_16x16x32_bf16 v[152:155], v[244:247], v[204:207], v[152:155]
    v_mfma_f32_16x16x32_bf16 v[156:159], v[244:247], v[208:211], v[156:159]
    s_waitcnt lgkmcnt(5)
    v_mfma_f32_16x16x32_bf16 v[88:91], v[168:171], v[160:163], v[88:91]
    ds_read_b128 v[204:207], v0 offset:1024
    v_mfma_f32_16x16x32_bf16 v[92:95], v[168:171], v[164:167], v[92:95]
    ds_read_b128 v[208:211], v0 offset:3072
    v_mfma_f32_16x16x32_bf16 v[96:99], v[172:175], v[160:163], v[96:99]
    ds_read_b128 v[212:215], v2 offset:9216
    v_mfma_f32_16x16x32_bf16 v[100:103], v[172:175], v[164:167], v[100:103]
    ds_read_b128 v[216:219], v2 offset:10240
    v_mfma_f32_16x16x32_bf16 v[104:107], v[176:179], v[160:163], v[104:107]
    ds_read_b128 v[220:223], v2 offset:11264
    v_mfma_f32_16x16x32_bf16 v[108:111], v[176:179], v[164:167], v[108:111]
    ds_read_b128 v[224:227], v2 offset:12288
    v_mfma_f32_16x16x32_bf16 v[112:115], v[180:183], v[160:163], v[112:115]
    ds_read_b128 v[228:231], v2 offset:13312
    v_mfma_f32_16x16x32_bf16 v[116:119], v[180:183], v[164:167], v[116:119]
    ds_read_b128 v[232:235], v2 offset:14336
    s_waitcnt lgkmcnt(8)
    v_mfma_f32_16x16x32_bf16 v[120:123], v[184:187], v[160:163], v[120:123]
    ds_read_b128 v[236:239], v2 offset:15360
    v_mfma_f32_16x16x32_bf16 v[124:127], v[184:187], v[164:167], v[124:127]
    ds_read_b128 v[240:243], v2 offset:16384
    v_mfma_f32_16x16x32_bf16 v[128:131], v[188:191], v[160:163], v[128:131]
    ds_read_b128 v[244:247], v2 offset:17408
    v_mfma_f32_16x16x32_bf16 v[132:135], v[188:191], v[164:167], v[132:135]
    v_mfma_f32_16x16x32_bf16 v[136:139], v[192:195], v[160:163], v[136:139]
    v_mfma_f32_16x16x32_bf16 v[140:143], v[192:195], v[164:167], v[140:143]
    v_mfma_f32_16x16x32_bf16 v[144:147], v[196:199], v[160:163], v[144:147]
    v_mfma_f32_16x16x32_bf16 v[148:151], v[196:199], v[164:167], v[148:151]
    v_mfma_f32_16x16x32_bf16 v[152:155], v[200:203], v[160:163], v[152:155]
    v_mfma_f32_16x16x32_bf16 v[156:159], v[200:203], v[164:167], v[156:159]
    s_waitcnt lgkmcnt(0)
    s_barrier
    v_mfma_f32_16x16x32_bf16 v[88:91], v[212:215], v[204:207], v[88:91]
    ds_read_b128 v[160:163], v0 offset:36864
    v_mfma_f32_16x16x32_bf16 v[92:95], v[212:215], v[208:211], v[92:95]
    ds_read_b128 v[164:167], v0 offset:38912
    v_mfma_f32_16x16x32_bf16 v[96:99], v[216:219], v[204:207], v[96:99]
    ds_read_b128 v[168:171], v2 offset:36864
    v_mfma_f32_16x16x32_bf16 v[100:103], v[216:219], v[208:211], v[100:103]
    ds_read_b128 v[172:175], v2 offset:37888
    v_mfma_f32_16x16x32_bf16 v[104:107], v[220:223], v[204:207], v[104:107]
    ds_read_b128 v[176:179], v2 offset:38912
    v_mfma_f32_16x16x32_bf16 v[108:111], v[220:223], v[208:211], v[108:111]
    ds_read_b128 v[180:183], v2 offset:39936
    v_mfma_f32_16x16x32_bf16 v[112:115], v[224:227], v[204:207], v[112:115]
    ds_read_b128 v[184:187], v2 offset:40960
    v_mfma_f32_16x16x32_bf16 v[116:119], v[224:227], v[208:211], v[116:119]
    ds_read_b128 v[188:191], v2 offset:41984
    v_mfma_f32_16x16x32_bf16 v[120:123], v[228:231], v[204:207], v[120:123]
    ds_read_b128 v[192:195], v2 offset:43008
    v_mfma_f32_16x16x32_bf16 v[124:127], v[228:231], v[208:211], v[124:127]
    ds_read_b128 v[196:199], v2 offset:44032
    v_mfma_f32_16x16x32_bf16 v[128:131], v[232:235], v[204:207], v[128:131]
    ds_read_b128 v[200:203], v2 offset:45056
    v_mfma_f32_16x16x32_bf16 v[132:135], v[232:235], v[208:211], v[132:135]
    v_mfma_f32_16x16x32_bf16 v[136:139], v[236:239], v[204:207], v[136:139]
    v_mfma_f32_16x16x32_bf16 v[140:143], v[236:239], v[208:211], v[140:143]
    v_mfma_f32_16x16x32_bf16 v[144:147], v[240:243], v[204:207], v[144:147]
    v_mfma_f32_16x16x32_bf16 v[148:151], v[240:243], v[208:211], v[148:151]
    v_mfma_f32_16x16x32_bf16 v[152:155], v[244:247], v[204:207], v[152:155]
    v_mfma_f32_16x16x32_bf16 v[156:159], v[244:247], v[208:211], v[156:159]
    s_waitcnt lgkmcnt(5)
    v_mfma_f32_16x16x32_bf16 v[88:91], v[168:171], v[160:163], v[88:91]
    ds_read_b128 v[204:207], v0 offset:37888
    v_mfma_f32_16x16x32_bf16 v[92:95], v[168:171], v[164:167], v[92:95]
    ds_read_b128 v[208:211], v0 offset:39936
    v_mfma_f32_16x16x32_bf16 v[96:99], v[172:175], v[160:163], v[96:99]
    ds_read_b128 v[212:215], v2 offset:46080
    v_mfma_f32_16x16x32_bf16 v[100:103], v[172:175], v[164:167], v[100:103]
    ds_read_b128 v[216:219], v2 offset:47104
    v_mfma_f32_16x16x32_bf16 v[104:107], v[176:179], v[160:163], v[104:107]
    ds_read_b128 v[220:223], v2 offset:48128
    v_mfma_f32_16x16x32_bf16 v[108:111], v[176:179], v[164:167], v[108:111]
    ds_read_b128 v[224:227], v2 offset:49152
    v_mfma_f32_16x16x32_bf16 v[112:115], v[180:183], v[160:163], v[112:115]
    ds_read_b128 v[228:231], v2 offset:50176
    v_mfma_f32_16x16x32_bf16 v[116:119], v[180:183], v[164:167], v[116:119]
    ds_read_b128 v[232:235], v2 offset:51200
    s_waitcnt lgkmcnt(8)
    v_mfma_f32_16x16x32_bf16 v[120:123], v[184:187], v[160:163], v[120:123]
    ds_read_b128 v[236:239], v2 offset:52224
    v_mfma_f32_16x16x32_bf16 v[124:127], v[184:187], v[164:167], v[124:127]
    ds_read_b128 v[240:243], v2 offset:53248
    v_mfma_f32_16x16x32_bf16 v[128:131], v[188:191], v[160:163], v[128:131]
    ds_read_b128 v[244:247], v2 offset:54272
    v_mfma_f32_16x16x32_bf16 v[132:135], v[188:191], v[164:167], v[132:135]
    v_mfma_f32_16x16x32_bf16 v[136:139], v[192:195], v[160:163], v[136:139]
    v_mfma_f32_16x16x32_bf16 v[140:143], v[192:195], v[164:167], v[140:143]
    v_mfma_f32_16x16x32_bf16 v[144:147], v[196:199], v[160:163], v[144:147]
    v_mfma_f32_16x16x32_bf16 v[148:151], v[196:199], v[164:167], v[148:151]
    v_mfma_f32_16x16x32_bf16 v[152:155], v[200:203], v[160:163], v[152:155]
    v_mfma_f32_16x16x32_bf16 v[156:159], v[200:203], v[164:167], v[156:159]
    s_waitcnt lgkmcnt(0)
    s_barrier
    v_mfma_f32_16x16x32_bf16 v[88:91], v[212:215], v[204:207], v[88:91]
    ds_read_b128 v[160:163], v3 offset:0
    v_mfma_f32_16x16x32_bf16 v[92:95], v[212:215], v[208:211], v[92:95]
    ds_read_b128 v[164:167], v3 offset:2048
    v_mfma_f32_16x16x32_bf16 v[96:99], v[216:219], v[204:207], v[96:99]
    ds_read_b128 v[168:171], v1 offset:0
    v_mfma_f32_16x16x32_bf16 v[100:103], v[216:219], v[208:211], v[100:103]
    ds_read_b128 v[172:175], v1 offset:1024
    v_mfma_f32_16x16x32_bf16 v[104:107], v[220:223], v[204:207], v[104:107]
    ds_read_b128 v[176:179], v1 offset:2048
    v_mfma_f32_16x16x32_bf16 v[108:111], v[220:223], v[208:211], v[108:111]
    ds_read_b128 v[180:183], v1 offset:3072
    v_mfma_f32_16x16x32_bf16 v[112:115], v[224:227], v[204:207], v[112:115]
    ds_read_b128 v[184:187], v1 offset:4096
    v_mfma_f32_16x16x32_bf16 v[116:119], v[224:227], v[208:211], v[116:119]
    ds_read_b128 v[188:191], v1 offset:5120
    v_mfma_f32_16x16x32_bf16 v[120:123], v[228:231], v[204:207], v[120:123]
    ds_read_b128 v[192:195], v1 offset:6144
    v_mfma_f32_16x16x32_bf16 v[124:127], v[228:231], v[208:211], v[124:127]
    ds_read_b128 v[196:199], v1 offset:7168
    v_mfma_f32_16x16x32_bf16 v[128:131], v[232:235], v[204:207], v[128:131]
    ds_read_b128 v[200:203], v1 offset:8192
    v_mfma_f32_16x16x32_bf16 v[132:135], v[232:235], v[208:211], v[132:135]
    v_mfma_f32_16x16x32_bf16 v[136:139], v[236:239], v[204:207], v[136:139]
    v_mfma_f32_16x16x32_bf16 v[140:143], v[236:239], v[208:211], v[140:143]
    v_mfma_f32_16x16x32_bf16 v[144:147], v[240:243], v[204:207], v[144:147]
    v_mfma_f32_16x16x32_bf16 v[148:151], v[240:243], v[208:211], v[148:151]
    v_mfma_f32_16x16x32_bf16 v[152:155], v[244:247], v[204:207], v[152:155]
    v_mfma_f32_16x16x32_bf16 v[156:159], v[244:247], v[208:211], v[156:159]
    s_waitcnt lgkmcnt(5)
    v_mfma_f32_16x16x32_bf16 v[88:91], v[168:171], v[160:163], v[88:91]
    ds_read_b128 v[204:207], v3 offset:1024
    v_mfma_f32_16x16x32_bf16 v[92:95], v[168:171], v[164:167], v[92:95]
    ds_read_b128 v[208:211], v3 offset:3072
    v_mfma_f32_16x16x32_bf16 v[96:99], v[172:175], v[160:163], v[96:99]
    ds_read_b128 v[212:215], v1 offset:9216
    v_mfma_f32_16x16x32_bf16 v[100:103], v[172:175], v[164:167], v[100:103]
    ds_read_b128 v[216:219], v1 offset:10240
    v_mfma_f32_16x16x32_bf16 v[104:107], v[176:179], v[160:163], v[104:107]
    ds_read_b128 v[220:223], v1 offset:11264
    v_mfma_f32_16x16x32_bf16 v[108:111], v[176:179], v[164:167], v[108:111]
    ds_read_b128 v[224:227], v1 offset:12288
    v_mfma_f32_16x16x32_bf16 v[112:115], v[180:183], v[160:163], v[112:115]
    ds_read_b128 v[228:231], v1 offset:13312
    v_mfma_f32_16x16x32_bf16 v[116:119], v[180:183], v[164:167], v[116:119]
    ds_read_b128 v[232:235], v1 offset:14336
    s_waitcnt lgkmcnt(8)
    v_mfma_f32_16x16x32_bf16 v[120:123], v[184:187], v[160:163], v[120:123]
    ds_read_b128 v[236:239], v1 offset:15360
    v_mfma_f32_16x16x32_bf16 v[124:127], v[184:187], v[164:167], v[124:127]
    ds_read_b128 v[240:243], v1 offset:16384
    v_mfma_f32_16x16x32_bf16 v[128:131], v[188:191], v[160:163], v[128:131]
    ds_read_b128 v[244:247], v1 offset:17408
    v_mfma_f32_16x16x32_bf16 v[132:135], v[188:191], v[164:167], v[132:135]
    v_mfma_f32_16x16x32_bf16 v[136:139], v[192:195], v[160:163], v[136:139]
    v_mfma_f32_16x16x32_bf16 v[140:143], v[192:195], v[164:167], v[140:143]
    v_mfma_f32_16x16x32_bf16 v[144:147], v[196:199], v[160:163], v[144:147]
    v_mfma_f32_16x16x32_bf16 v[148:151], v[196:199], v[164:167], v[148:151]
    v_mfma_f32_16x16x32_bf16 v[152:155], v[200:203], v[160:163], v[152:155]
    v_mfma_f32_16x16x32_bf16 v[156:159], v[200:203], v[164:167], v[156:159]
    s_waitcnt lgkmcnt(0)
    s_barrier
    v_mfma_f32_16x16x32_bf16 v[88:91], v[212:215], v[204:207], v[88:91]
    ds_read_b128 v[160:163], v3 offset:36864
    v_mfma_f32_16x16x32_bf16 v[92:95], v[212:215], v[208:211], v[92:95]
    ds_read_b128 v[164:167], v3 offset:38912
    v_mfma_f32_16x16x32_bf16 v[96:99], v[216:219], v[204:207], v[96:99]
    ds_read_b128 v[168:171], v1 offset:36864
    v_mfma_f32_16x16x32_bf16 v[100:103], v[216:219], v[208:211], v[100:103]
    ds_read_b128 v[172:175], v1 offset:37888
    v_mfma_f32_16x16x32_bf16 v[104:107], v[220:223], v[204:207], v[104:107]
    ds_read_b128 v[176:179], v1 offset:38912
    v_mfma_f32_16x16x32_bf16 v[108:111], v[220:223], v[208:211], v[108:111]
    ds_read_b128 v[180:183], v1 offset:39936
    v_mfma_f32_16x16x32_bf16 v[112:115], v[224:227], v[204:207], v[112:115]
    ds_read_b128 v[184:187], v1 offset:40960
    v_mfma_f32_16x16x32_bf16 v[116:119], v[224:227], v[208:211], v[116:119]
    ds_read_b128 v[188:191], v1 offset:41984
    v_mfma_f32_16x16x32_bf16 v[120:123], v[228:231], v[204:207], v[120:123]
    ds_read_b128 v[192:195], v1 offset:43008
    v_mfma_f32_16x16x32_bf16 v[124:127], v[228:231], v[208:211], v[124:127]
    ds_read_b128 v[196:199], v1 offset:44032
    v_mfma_f32_16x16x32_bf16 v[128:131], v[232:235], v[204:207], v[128:131]
    ds_read_b128 v[200:203], v1 offset:45056
    v_mfma_f32_16x16x32_bf16 v[132:135], v[232:235], v[208:211], v[132:135]
    ds_read_b128 v[4:7], v255 offset:1024
    v_mfma_f32_16x16x32_bf16 v[136:139], v[236:239], v[204:207], v[136:139]
    ds_read_b128 v[8:11], v255 offset:1040
    v_mfma_f32_16x16x32_bf16 v[140:143], v[236:239], v[208:211], v[140:143]
    ds_read_b128 v[12:15], v255 offset:1056
    v_mfma_f32_16x16x32_bf16 v[144:147], v[240:243], v[204:207], v[144:147]
    ds_read_b128 v[252:255], v255 offset:1072
    v_mfma_f32_16x16x32_bf16 v[148:151], v[240:243], v[208:211], v[148:151]
    v_mfma_f32_16x16x32_bf16 v[152:155], v[244:247], v[204:207], v[152:155]
    v_mfma_f32_16x16x32_bf16 v[156:159], v[244:247], v[208:211], v[156:159]
    s_waitcnt lgkmcnt(9)
    v_mfma_f32_16x16x32_bf16 v[88:91], v[168:171], v[160:163], v[88:91]
    ds_read_b128 v[204:207], v3 offset:37888
    v_mfma_f32_16x16x32_bf16 v[92:95], v[168:171], v[164:167], v[92:95]
    ds_read_b128 v[208:211], v3 offset:39936
    v_mfma_f32_16x16x32_bf16 v[96:99], v[172:175], v[160:163], v[96:99]
    ds_read_b128 v[212:215], v1 offset:46080
    v_mfma_f32_16x16x32_bf16 v[100:103], v[172:175], v[164:167], v[100:103]
    ds_read_b128 v[216:219], v1 offset:47104
    v_mfma_f32_16x16x32_bf16 v[104:107], v[176:179], v[160:163], v[104:107]
    ds_read_b128 v[220:223], v1 offset:48128
    v_mfma_f32_16x16x32_bf16 v[108:111], v[176:179], v[164:167], v[108:111]
    ds_read_b128 v[224:227], v1 offset:49152
    v_mfma_f32_16x16x32_bf16 v[112:115], v[180:183], v[160:163], v[112:115]
    ds_read_b128 v[228:231], v1 offset:50176
    v_mfma_f32_16x16x32_bf16 v[116:119], v[180:183], v[164:167], v[116:119]
    ds_read_b128 v[232:235], v1 offset:51200
    s_waitcnt lgkmcnt(8)
    v_mfma_f32_16x16x32_bf16 v[120:123], v[184:187], v[160:163], v[120:123]
    ds_read_b128 v[236:239], v1 offset:52224
    v_fma_f32 v16, v16, v4, -v6
    v_mfma_f32_16x16x32_bf16 v[124:127], v[184:187], v[164:167], v[124:127]
    ds_read_b128 v[240:243], v1 offset:53248
    v_fma_f32 v17, v17, v5, -v7
    v_mfma_f32_16x16x32_bf16 v[128:131], v[188:191], v[160:163], v[128:131]
    ds_read_b128 v[244:247], v1 offset:54272
    v_fma_f32 v18, v18, v8, -v10
    v_mfma_f32_16x16x32_bf16 v[132:135], v[188:191], v[164:167], v[132:135]
    v_fma_f32 v19, v19, v9, -v11
    v_fma_f32 v20, v20, v12, -v14
    v_mfma_f32_16x16x32_bf16 v[136:139], v[192:195], v[160:163], v[136:139]
    v_fma_f32 v21, v21, v13, -v15
    v_fma_f32 v22, v22, v252, -v254
    v_mfma_f32_16x16x32_bf16 v[140:143], v[192:195], v[164:167], v[140:143]
    v_fma_f32 v23, v23, v253, -v255
    v_cvt_pk_bf16_f32 v16, v16, v17
    v_mfma_f32_16x16x32_bf16 v[144:147], v[196:199], v[160:163], v[144:147]
    v_cvt_pk_bf16_f32 v17, v18, v19
    v_cvt_pk_bf16_f32 v18, v20, v21
    v_mfma_f32_16x16x32_bf16 v[148:151], v[196:199], v[164:167], v[148:151]
    v_cvt_pk_bf16_f32 v19, v22, v23
    v_fma_f32 v24, v24, v4, -v6
    v_mfma_f32_16x16x32_bf16 v[152:155], v[200:203], v[160:163], v[152:155]
    v_fma_f32 v25, v25, v5, -v7
    v_fma_f32 v26, v26, v8, -v10
    v_mfma_f32_16x16x32_bf16 v[156:159], v[200:203], v[164:167], v[156:159]
    v_fma_f32 v27, v27, v9, -v11
    s_waitcnt lgkmcnt(0)
    s_barrier
    v_mfma_f32_16x16x32_bf16 v[88:91], v[212:215], v[204:207], v[88:91]
    ds_read_b128 v[160:163], v0 offset:0
    v_mfma_f32_16x16x32_bf16 v[92:95], v[212:215], v[208:211], v[92:95]
    ds_read_b128 v[164:167], v0 offset:2048
    v_fma_f32 v28, v28, v12, -v14
    v_mfma_f32_16x16x32_bf16 v[96:99], v[216:219], v[204:207], v[96:99]
    ds_read_b128 v[168:171], v2 offset:0
    v_fma_f32 v29, v29, v13, -v15
    v_mfma_f32_16x16x32_bf16 v[100:103], v[216:219], v[208:211], v[100:103]
    ds_read_b128 v[172:175], v2 offset:1024
    v_fma_f32 v30, v30, v252, -v254
    v_mfma_f32_16x16x32_bf16 v[104:107], v[220:223], v[204:207], v[104:107]
    ds_read_b128 v[176:179], v2 offset:2048
    v_fma_f32 v31, v31, v253, -v255
    v_mfma_f32_16x16x32_bf16 v[108:111], v[220:223], v[208:211], v[108:111]
    ds_read_b128 v[180:183], v2 offset:3072
    v_permlane32_swap_b32 v16, v18
    v_mfma_f32_16x16x32_bf16 v[112:115], v[224:227], v[204:207], v[112:115]
    ds_read_b128 v[184:187], v2 offset:4096
    v_permlane32_swap_b32 v17, v19
    v_mfma_f32_16x16x32_bf16 v[116:119], v[224:227], v[208:211], v[116:119]
    ds_read_b128 v[188:191], v2 offset:5120
    v_mfma_f32_16x16x32_bf16 v[120:123], v[228:231], v[204:207], v[120:123]
    ds_read_b128 v[192:195], v2 offset:6144
    v_cvt_pk_bf16_f32 v24, v24, v25
    v_mfma_f32_16x16x32_bf16 v[124:127], v[228:231], v[208:211], v[124:127]
    ds_read_b128 v[196:199], v2 offset:7168
    v_cvt_pk_bf16_f32 v25, v26, v27
    v_mfma_f32_16x16x32_bf16 v[128:131], v[232:235], v[204:207], v[128:131]
    ds_read_b128 v[200:203], v2 offset:8192
    v_cvt_pk_bf16_f32 v26, v28, v29
    v_mfma_f32_16x16x32_bf16 v[132:135], v[232:235], v[208:211], v[132:135]
    v_cvt_pk_bf16_f32 v27, v30, v31
    v_permlane16_swap_b32 v16, v18
    v_mfma_f32_16x16x32_bf16 v[136:139], v[236:239], v[204:207], v[136:139]
    v_permlane16_swap_b32 v17, v19
    v_fma_f32 v32, v32, v4, -v6
    v_mfma_f32_16x16x32_bf16 v[140:143], v[236:239], v[208:211], v[140:143]
    v_fma_f32 v33, v33, v5, -v7
    v_fma_f32 v34, v34, v8, -v10
    v_mfma_f32_16x16x32_bf16 v[144:147], v[240:243], v[204:207], v[144:147]
    v_fma_f32 v35, v35, v9, -v11
    v_fma_f32 v36, v36, v12, -v14
    v_mfma_f32_16x16x32_bf16 v[148:151], v[240:243], v[208:211], v[148:151]
    v_fma_f32 v37, v37, v13, -v15
    v_fma_f32 v38, v38, v252, -v254
    v_mfma_f32_16x16x32_bf16 v[152:155], v[244:247], v[204:207], v[152:155]
    v_fma_f32 v39, v39, v253, -v255
    v_permlane32_swap_b32 v24, v26
    v_mfma_f32_16x16x32_bf16 v[156:159], v[244:247], v[208:211], v[156:159]
    v_permlane32_swap_b32 v25, v27
    s_waitcnt lgkmcnt(5)
    v_mfma_f32_16x16x32_bf16 v[88:91], v[168:171], v[160:163], v[88:91]
    ds_read_b128 v[204:207], v0 offset:1024
    v_mfma_f32_16x16x32_bf16 v[92:95], v[168:171], v[164:167], v[92:95]
    ds_read_b128 v[208:211], v0 offset:3072
    v_cvt_pk_bf16_f32 v32, v32, v33
    v_mfma_f32_16x16x32_bf16 v[96:99], v[172:175], v[160:163], v[96:99]
    ds_read_b128 v[212:215], v2 offset:9216
    v_cvt_pk_bf16_f32 v33, v34, v35
    v_mfma_f32_16x16x32_bf16 v[100:103], v[172:175], v[164:167], v[100:103]
    ds_read_b128 v[216:219], v2 offset:10240
    v_cvt_pk_bf16_f32 v34, v36, v37
    v_mfma_f32_16x16x32_bf16 v[104:107], v[176:179], v[160:163], v[104:107]
    ds_read_b128 v[220:223], v2 offset:11264
    v_cvt_pk_bf16_f32 v35, v38, v39
    v_mfma_f32_16x16x32_bf16 v[108:111], v[176:179], v[164:167], v[108:111]
    ds_read_b128 v[224:227], v2 offset:12288
    v_permlane16_swap_b32 v24, v26
    v_mfma_f32_16x16x32_bf16 v[112:115], v[180:183], v[160:163], v[112:115]
    ds_read_b128 v[228:231], v2 offset:13312
    v_permlane16_swap_b32 v25, v27
    v_mfma_f32_16x16x32_bf16 v[116:119], v[180:183], v[164:167], v[116:119]
    ds_read_b128 v[232:235], v2 offset:14336
    s_waitcnt lgkmcnt(8)
    v_mfma_f32_16x16x32_bf16 v[120:123], v[184:187], v[160:163], v[120:123]
    ds_read_b128 v[236:239], v2 offset:15360
    v_fma_f32 v40, v40, v4, -v6
    v_mfma_f32_16x16x32_bf16 v[124:127], v[184:187], v[164:167], v[124:127]
    ds_read_b128 v[240:243], v2 offset:16384
    v_fma_f32 v41, v41, v5, -v7
    v_mfma_f32_16x16x32_bf16 v[128:131], v[188:191], v[160:163], v[128:131]
    ds_read_b128 v[244:247], v2 offset:17408
    v_fma_f32 v42, v42, v8, -v10
    v_mfma_f32_16x16x32_bf16 v[132:135], v[188:191], v[164:167], v[132:135]
    v_fma_f32 v43, v43, v9, -v11
    v_fma_f32 v44, v44, v12, -v14
    v_mfma_f32_16x16x32_bf16 v[136:139], v[192:195], v[160:163], v[136:139]
    v_fma_f32 v45, v45, v13, -v15
    v_fma_f32 v46, v46, v252, -v254
    v_mfma_f32_16x16x32_bf16 v[140:143], v[192:195], v[164:167], v[140:143]
    v_fma_f32 v47, v47, v253, -v255
    v_permlane32_swap_b32 v32, v34
    v_mfma_f32_16x16x32_bf16 v[144:147], v[196:199], v[160:163], v[144:147]
    v_permlane32_swap_b32 v33, v35
    v_cvt_pk_bf16_f32 v40, v40, v41
    v_mfma_f32_16x16x32_bf16 v[148:151], v[196:199], v[164:167], v[148:151]
    v_cvt_pk_bf16_f32 v41, v42, v43
    v_cvt_pk_bf16_f32 v42, v44, v45
    v_mfma_f32_16x16x32_bf16 v[152:155], v[200:203], v[160:163], v[152:155]
    v_cvt_pk_bf16_f32 v43, v46, v47
    v_permlane16_swap_b32 v32, v34
    v_mfma_f32_16x16x32_bf16 v[156:159], v[200:203], v[164:167], v[156:159]
    v_permlane16_swap_b32 v33, v35
    s_waitcnt lgkmcnt(0)
    s_barrier
    v_mfma_f32_16x16x32_bf16 v[88:91], v[212:215], v[204:207], v[88:91]
    ds_read_b128 v[160:163], v0 offset:36864
    v_mfma_f32_16x16x32_bf16 v[92:95], v[212:215], v[208:211], v[92:95]
    ds_read_b128 v[164:167], v0 offset:38912
    v_fma_f32 v48, v48, v4, -v6
    v_mfma_f32_16x16x32_bf16 v[96:99], v[216:219], v[204:207], v[96:99]
    ds_read_b128 v[168:171], v2 offset:36864
    buffer_store_dwordx4 v[16:19], v1, s[4:7], s38 offen offset:0 sc1
    v_fma_f32 v49, v49, v5, -v7
    v_mfma_f32_16x16x32_bf16 v[100:103], v[216:219], v[208:211], v[100:103]
    ds_read_b128 v[172:175], v2 offset:37888
    v_fma_f32 v50, v50, v8, -v10
    v_mfma_f32_16x16x32_bf16 v[104:107], v[220:223], v[204:207], v[104:107]
    ds_read_b128 v[176:179], v2 offset:38912
    v_fma_f32 v51, v51, v9, -v11
    v_mfma_f32_16x16x32_bf16 v[108:111], v[220:223], v[208:211], v[108:111]
    ds_read_b128 v[180:183], v2 offset:39936
    v_fma_f32 v52, v52, v12, -v14
    v_mfma_f32_16x16x32_bf16 v[112:115], v[224:227], v[204:207], v[112:115]
    ds_read_b128 v[184:187], v2 offset:40960
    v_fma_f32 v53, v53, v13, -v15
    v_mfma_f32_16x16x32_bf16 v[116:119], v[224:227], v[208:211], v[116:119]
    ds_read_b128 v[188:191], v2 offset:41984
    v_mfma_f32_16x16x32_bf16 v[120:123], v[228:231], v[204:207], v[120:123]
    ds_read_b128 v[192:195], v2 offset:43008
    v_fma_f32 v54, v54, v252, -v254
    v_mfma_f32_16x16x32_bf16 v[124:127], v[228:231], v[208:211], v[124:127]
    ds_read_b128 v[196:199], v2 offset:44032
    v_fma_f32 v55, v55, v253, -v255
    v_mfma_f32_16x16x32_bf16 v[128:131], v[232:235], v[204:207], v[128:131]
    ds_read_b128 v[200:203], v2 offset:45056
    buffer_store_dwordx4 v[24:27], v1, s[4:7], s38 offen offset:1024 sc1
    v_permlane32_swap_b32 v40, v42
    v_mfma_f32_16x16x32_bf16 v[132:135], v[232:235], v[208:211], v[132:135]
    v_permlane32_swap_b32 v41, v43
    v_cvt_pk_bf16_f32 v48, v48, v49
    v_mfma_f32_16x16x32_bf16 v[136:139], v[236:239], v[204:207], v[136:139]
    v_cvt_pk_bf16_f32 v49, v50, v51
    v_cvt_pk_bf16_f32 v50, v52, v53
    v_mfma_f32_16x16x32_bf16 v[140:143], v[236:239], v[208:211], v[140:143]
    v_cvt_pk_bf16_f32 v51, v54, v55
    v_permlane16_swap_b32 v40, v42
    v_mfma_f32_16x16x32_bf16 v[144:147], v[240:243], v[204:207], v[144:147]
    v_permlane16_swap_b32 v41, v43
    v_fma_f32 v56, v56, v4, -v6
    v_mfma_f32_16x16x32_bf16 v[148:151], v[240:243], v[208:211], v[148:151]
    v_fma_f32 v57, v57, v5, -v7
    v_fma_f32 v58, v58, v8, -v10
    v_mfma_f32_16x16x32_bf16 v[152:155], v[244:247], v[204:207], v[152:155]
    v_fma_f32 v59, v59, v9, -v11
    v_fma_f32 v60, v60, v12, -v14
    v_mfma_f32_16x16x32_bf16 v[156:159], v[244:247], v[208:211], v[156:159]
    v_fma_f32 v61, v61, v13, -v15
    s_waitcnt lgkmcnt(5)
    v_mfma_f32_16x16x32_bf16 v[88:91], v[168:171], v[160:163], v[88:91]
    ds_read_b128 v[204:207], v0 offset:37888
    v_mfma_f32_16x16x32_bf16 v[92:95], v[168:171], v[164:167], v[92:95]
    ds_read_b128 v[208:211], v0 offset:39936
    v_fma_f32 v62, v62, v252, -v254
    v_mfma_f32_16x16x32_bf16 v[96:99], v[172:175], v[160:163], v[96:99]
    ds_read_b128 v[212:215], v2 offset:46080
    buffer_store_dwordx4 v[32:35], v1, s[4:7], s38 offen offset:2048 sc1
    v_fma_f32 v63, v63, v253, -v255
    v_mfma_f32_16x16x32_bf16 v[100:103], v[172:175], v[164:167], v[100:103]
    ds_read_b128 v[216:219], v2 offset:47104
    v_permlane32_swap_b32 v48, v50
    v_mfma_f32_16x16x32_bf16 v[104:107], v[176:179], v[160:163], v[104:107]
    ds_read_b128 v[220:223], v2 offset:48128
    v_permlane32_swap_b32 v49, v51
    v_mfma_f32_16x16x32_bf16 v[108:111], v[176:179], v[164:167], v[108:111]
    ds_read_b128 v[224:227], v2 offset:49152
    v_cvt_pk_bf16_f32 v56, v56, v57
    v_mfma_f32_16x16x32_bf16 v[112:115], v[180:183], v[160:163], v[112:115]
    ds_read_b128 v[228:231], v2 offset:50176
    v_cvt_pk_bf16_f32 v57, v58, v59
    v_mfma_f32_16x16x32_bf16 v[116:119], v[180:183], v[164:167], v[116:119]
    ds_read_b128 v[232:235], v2 offset:51200
    s_waitcnt lgkmcnt(8)
    v_mfma_f32_16x16x32_bf16 v[120:123], v[184:187], v[160:163], v[120:123]
    ds_read_b128 v[236:239], v2 offset:52224
    v_cvt_pk_bf16_f32 v58, v60, v61
    v_mfma_f32_16x16x32_bf16 v[124:127], v[184:187], v[164:167], v[124:127]
    ds_read_b128 v[240:243], v2 offset:53248
    v_cvt_pk_bf16_f32 v59, v62, v63
    v_mfma_f32_16x16x32_bf16 v[128:131], v[188:191], v[160:163], v[128:131]
    ds_read_b128 v[244:247], v2 offset:54272
    buffer_store_dwordx4 v[40:43], v1, s[4:7], s38 offen offset:3072 sc1
    v_permlane16_swap_b32 v48, v50
    v_mfma_f32_16x16x32_bf16 v[132:135], v[188:191], v[164:167], v[132:135]
    v_permlane16_swap_b32 v49, v51
    v_fma_f32 v64, v64, v4, -v6
    v_mfma_f32_16x16x32_bf16 v[136:139], v[192:195], v[160:163], v[136:139]
    v_fma_f32 v65, v65, v5, -v7
    v_fma_f32 v66, v66, v8, -v10
    v_mfma_f32_16x16x32_bf16 v[140:143], v[192:195], v[164:167], v[140:143]
    v_fma_f32 v67, v67, v9, -v11
    v_fma_f32 v68, v68, v12, -v14
    v_mfma_f32_16x16x32_bf16 v[144:147], v[196:199], v[160:163], v[144:147]
    v_fma_f32 v69, v69, v13, -v15
    v_fma_f32 v70, v70, v252, -v254
    v_mfma_f32_16x16x32_bf16 v[148:151], v[196:199], v[164:167], v[148:151]
    v_fma_f32 v71, v71, v253, -v255
    v_permlane32_swap_b32 v56, v58
    v_mfma_f32_16x16x32_bf16 v[152:155], v[200:203], v[160:163], v[152:155]
    v_permlane32_swap_b32 v57, v59
    v_cvt_pk_bf16_f32 v64, v64, v65
    v_mfma_f32_16x16x32_bf16 v[156:159], v[200:203], v[164:167], v[156:159]
    v_cvt_pk_bf16_f32 v65, v66, v67
    s_waitcnt lgkmcnt(0)
    s_barrier
    v_mfma_f32_16x16x32_bf16 v[88:91], v[212:215], v[204:207], v[88:91]
    ds_read_b128 v[160:163], v3 offset:0
    v_mfma_f32_16x16x32_bf16 v[92:95], v[212:215], v[208:211], v[92:95]
    ds_read_b128 v[164:167], v3 offset:2048
    v_cvt_pk_bf16_f32 v66, v68, v69
    v_mfma_f32_16x16x32_bf16 v[96:99], v[216:219], v[204:207], v[96:99]
    ds_read_b128 v[168:171], v1 offset:0
    buffer_store_dwordx4 v[48:51], v1, s[4:7], s39 offen offset:0 sc1
    v_cvt_pk_bf16_f32 v67, v70, v71
    v_mfma_f32_16x16x32_bf16 v[100:103], v[216:219], v[208:211], v[100:103]
    ds_read_b128 v[172:175], v1 offset:1024
    v_permlane16_swap_b32 v56, v58
    v_mfma_f32_16x16x32_bf16 v[104:107], v[220:223], v[204:207], v[104:107]
    ds_read_b128 v[176:179], v1 offset:2048
    v_permlane16_swap_b32 v57, v59
    v_mfma_f32_16x16x32_bf16 v[108:111], v[220:223], v[208:211], v[108:111]
    ds_read_b128 v[180:183], v1 offset:3072
    v_fma_f32 v72, v72, v4, -v6
    v_mfma_f32_16x16x32_bf16 v[112:115], v[224:227], v[204:207], v[112:115]
    ds_read_b128 v[184:187], v1 offset:4096
    v_fma_f32 v73, v73, v5, -v7
    v_mfma_f32_16x16x32_bf16 v[116:119], v[224:227], v[208:211], v[116:119]
    ds_read_b128 v[188:191], v1 offset:5120
    v_mfma_f32_16x16x32_bf16 v[120:123], v[228:231], v[204:207], v[120:123]
    ds_read_b128 v[192:195], v1 offset:6144
    v_fma_f32 v74, v74, v8, -v10
    v_mfma_f32_16x16x32_bf16 v[124:127], v[228:231], v[208:211], v[124:127]
    ds_read_b128 v[196:199], v1 offset:7168
    v_fma_f32 v75, v75, v9, -v11
    v_mfma_f32_16x16x32_bf16 v[128:131], v[232:235], v[204:207], v[128:131]
    ds_read_b128 v[200:203], v1 offset:8192
    v_fma_f32 v76, v76, v12, -v14
    v_mfma_f32_16x16x32_bf16 v[132:135], v[232:235], v[208:211], v[132:135]
    v_fma_f32 v77, v77, v13, -v15
    v_fma_f32 v78, v78, v252, -v254
    v_mfma_f32_16x16x32_bf16 v[136:139], v[236:239], v[204:207], v[136:139]
    v_fma_f32 v79, v79, v253, -v255
    v_permlane32_swap_b32 v64, v66
    v_mfma_f32_16x16x32_bf16 v[140:143], v[236:239], v[208:211], v[140:143]
    v_permlane32_swap_b32 v65, v67
    v_cvt_pk_bf16_f32 v72, v72, v73
    v_mfma_f32_16x16x32_bf16 v[144:147], v[240:243], v[204:207], v[144:147]
    v_cvt_pk_bf16_f32 v73, v74, v75
    v_cvt_pk_bf16_f32 v74, v76, v77
    v_mfma_f32_16x16x32_bf16 v[148:151], v[240:243], v[208:211], v[148:151]
    v_cvt_pk_bf16_f32 v75, v78, v79
    v_permlane16_swap_b32 v64, v66
    v_mfma_f32_16x16x32_bf16 v[152:155], v[244:247], v[204:207], v[152:155]
    v_permlane16_swap_b32 v65, v67
    v_fma_f32 v80, v80, v4, -v6
    v_mfma_f32_16x16x32_bf16 v[156:159], v[244:247], v[208:211], v[156:159]
    v_fma_f32 v81, v81, v5, -v7
    s_waitcnt lgkmcnt(5)
    v_mfma_f32_16x16x32_bf16 v[88:91], v[168:171], v[160:163], v[88:91]
    ds_read_b128 v[204:207], v3 offset:1024
    v_mfma_f32_16x16x32_bf16 v[92:95], v[168:171], v[164:167], v[92:95]
    ds_read_b128 v[208:211], v3 offset:3072
    v_fma_f32 v82, v82, v8, -v10
    v_mfma_f32_16x16x32_bf16 v[96:99], v[172:175], v[160:163], v[96:99]
    ds_read_b128 v[212:215], v1 offset:9216
    buffer_store_dwordx4 v[56:59], v1, s[4:7], s39 offen offset:1024 sc1
    v_fma_f32 v83, v83, v9, -v11
    v_mfma_f32_16x16x32_bf16 v[100:103], v[172:175], v[164:167], v[100:103]
    ds_read_b128 v[216:219], v1 offset:10240
    v_fma_f32 v84, v84, v12, -v14
    v_mfma_f32_16x16x32_bf16 v[104:107], v[176:179], v[160:163], v[104:107]
    ds_read_b128 v[220:223], v1 offset:11264
    v_fma_f32 v85, v85, v13, -v15
    v_mfma_f32_16x16x32_bf16 v[108:111], v[176:179], v[164:167], v[108:111]
    ds_read_b128 v[224:227], v1 offset:12288
    v_fma_f32 v86, v86, v252, -v254
    v_mfma_f32_16x16x32_bf16 v[112:115], v[180:183], v[160:163], v[112:115]
    ds_read_b128 v[228:231], v1 offset:13312
    v_fma_f32 v87, v87, v253, -v255
    v_mfma_f32_16x16x32_bf16 v[116:119], v[180:183], v[164:167], v[116:119]
    ds_read_b128 v[232:235], v1 offset:14336
    s_waitcnt lgkmcnt(8)
    v_mfma_f32_16x16x32_bf16 v[120:123], v[184:187], v[160:163], v[120:123]
    ds_read_b128 v[236:239], v1 offset:15360
    v_permlane32_swap_b32 v72, v74
    v_mfma_f32_16x16x32_bf16 v[124:127], v[184:187], v[164:167], v[124:127]
    ds_read_b128 v[240:243], v1 offset:16384
    v_permlane32_swap_b32 v73, v75
    v_mfma_f32_16x16x32_bf16 v[128:131], v[188:191], v[160:163], v[128:131]
    ds_read_b128 v[244:247], v1 offset:17408
    buffer_store_dwordx4 v[64:67], v1, s[4:7], s39 offen offset:2048 sc1
    v_cvt_pk_bf16_f32 v80, v80, v81
    v_mfma_f32_16x16x32_bf16 v[132:135], v[188:191], v[164:167], v[132:135]
    v_cvt_pk_bf16_f32 v81, v82, v83
    v_cvt_pk_bf16_f32 v82, v84, v85
    v_mfma_f32_16x16x32_bf16 v[136:139], v[192:195], v[160:163], v[136:139]
    v_cvt_pk_bf16_f32 v83, v86, v87
    v_permlane16_swap_b32 v72, v74
    v_mfma_f32_16x16x32_bf16 v[140:143], v[192:195], v[164:167], v[140:143]
    v_permlane16_swap_b32 v73, v75
    s_nop 0
    v_mfma_f32_16x16x32_bf16 v[144:147], v[196:199], v[160:163], v[144:147]
    v_permlane32_swap_b32 v80, v82
    v_permlane32_swap_b32 v81, v83
    v_mfma_f32_16x16x32_bf16 v[148:151], v[196:199], v[164:167], v[148:151]
    s_nop 0
    v_permlane16_swap_b32 v80, v82
    v_mfma_f32_16x16x32_bf16 v[152:155], v[200:203], v[160:163], v[152:155]
    v_permlane16_swap_b32 v81, v83
    v_mul_f32 v4, s40, v249
    v_mfma_f32_16x16x32_bf16 v[156:159], v[200:203], v[164:167], v[156:159]
    v_mul_f32 v6, s40, v251
    s_waitcnt lgkmcnt(0)
    s_barrier
    v_mfma_f32_16x16x32_bf16 v[88:91], v[212:215], v[204:207], v[88:91]
    ds_read_b128 v[160:163], v3 offset:36864
    v_mfma_f32_16x16x32_bf16 v[92:95], v[212:215], v[208:211], v[92:95]
    ds_read_b128 v[164:167], v3 offset:38912
    v_mul_f32 v5, v249, v249
    v_mfma_f32_16x16x32_bf16 v[96:99], v[216:219], v[204:207], v[96:99]
    ds_read_b128 v[168:171], v1 offset:36864
    buffer_store_dwordx4 v[72:75], v1, s[4:7], s39 offen offset:3072 sc1
    v_mul_f32 v7, v251, v251
    v_mfma_f32_16x16x32_bf16 v[100:103], v[216:219], v[208:211], v[100:103]
    ds_read_b128 v[172:175], v1 offset:37888
    v_rcp_f32 v249, v249
    v_mfma_f32_16x16x32_bf16 v[104:107], v[220:223], v[204:207], v[104:107]
    ds_read_b128 v[176:179], v1 offset:38912
    v_rcp_f32 v251, v251
    v_mfma_f32_16x16x32_bf16 v[108:111], v[220:223], v[208:211], v[108:111]
    ds_read_b128 v[180:183], v1 offset:39936
    v_mul_f32 v5, s42, v5
    v_mfma_f32_16x16x32_bf16 v[112:115], v[224:227], v[204:207], v[112:115]
    ds_read_b128 v[184:187], v1 offset:40960
    v_mul_f32 v7, s42, v7
    v_mfma_f32_16x16x32_bf16 v[116:119], v[224:227], v[208:211], v[116:119]
    ds_read_b128 v[188:191], v1 offset:41984
    v_mfma_f32_16x16x32_bf16 v[120:123], v[228:231], v[204:207], v[120:123]
    ds_read_b128 v[192:195], v1 offset:43008
    v_mul_f32 v5, v5, v4
    v_mfma_f32_16x16x32_bf16 v[124:127], v[228:231], v[208:211], v[124:127]
    ds_read_b128 v[196:199], v1 offset:44032
    v_mul_f32 v7, v7, v6
    v_mfma_f32_16x16x32_bf16 v[128:131], v[232:235], v[204:207], v[128:131]
    ds_read_b128 v[200:203], v1 offset:45056
    buffer_store_dwordx4 v[80:83], v1, s[4:7], s46 offen offset:0 sc1
    v_bfe_u32 v13, v1, 4, 4
    v_mfma_f32_16x16x32_bf16 v[132:135], v[232:235], v[208:211], v[132:135]
    v_lshrrev_b32 v8, 1, v13
    v_lshrrev_b32 v9, 8, v1
    v_mfma_f32_16x16x32_bf16 v[136:139], v[236:239], v[204:207], v[136:139]
    v_xor_b32 v8, v8, v9
    v_lshlrev_b32 v8, 4, v8
    v_mfma_f32_16x16x32_bf16 v[140:143], v[236:239], v[208:211], v[140:143]
    v_lshl_add_u32 v8, v13, 7, v8
    s_add_u32 s33, s30, 18432
    v_mfma_f32_16x16x32_bf16 v[144:147], v[240:243], v[204:207], v[144:147]
    v_add_u32 v8, s33, v8
    v_xor_b32 v9, 64, v8
    v_mfma_f32_16x16x32_bf16 v[148:151], v[240:243], v[208:211], v[148:151]
    v_add_u32 v10, 73728, v8
    v_add_u32 v11, 73728, v9
    v_mfma_f32_16x16x32_bf16 v[152:155], v[244:247], v[204:207], v[152:155]
    s_lshl_b32 s33, s20, 6
    s_add_u32 s33, s33, 161280
    v_mfma_f32_16x16x32_bf16 v[156:159], v[244:247], v[208:211], v[156:159]
    v_lshl_add_u32 v13, v13, 1, s33
    s_waitcnt lgkmcnt(5)
    v_mfma_f32_16x16x32_bf16 v[88:91], v[168:171], v[160:163], v[88:91]
    ds_read_b128 v[204:207], v3 offset:37888
    v_mfma_f32_16x16x32_bf16 v[92:95], v[168:171], v[164:167], v[92:95]
    ds_read_b128 v[208:211], v3 offset:39936
    v_mfma_f32_16x16x32_bf16 v[96:99], v[172:175], v[160:163], v[96:99]
    ds_read_b128 v[212:215], v1 offset:46080
    v_mfma_f32_16x16x32_bf16 v[100:103], v[172:175], v[164:167], v[100:103]
    ds_read_b128 v[216:219], v1 offset:47104
    v_mfma_f32_16x16x32_bf16 v[104:107], v[176:179], v[160:163], v[104:107]
    ds_read_b128 v[220:223], v1 offset:48128
    v_mfma_f32_16x16x32_bf16 v[108:111], v[176:179], v[164:167], v[108:111]
    ds_read_b128 v[224:227], v1 offset:49152
    v_mfma_f32_16x16x32_bf16 v[112:115], v[180:183], v[160:163], v[112:115]
    ds_read_b128 v[228:231], v1 offset:50176
    v_mfma_f32_16x16x32_bf16 v[116:119], v[180:183], v[164:167], v[116:119]
    ds_read_b128 v[232:235], v1 offset:51200
    s_waitcnt lgkmcnt(8)
    v_mfma_f32_16x16x32_bf16 v[120:123], v[184:187], v[160:163], v[120:123]
    ds_read_b128 v[236:239], v1 offset:52224
    v_mfma_f32_16x16x32_bf16 v[124:127], v[184:187], v[164:167], v[124:127]
    ds_read_b128 v[240:243], v1 offset:53248
    v_mfma_f32_16x16x32_bf16 v[128:131], v[188:191], v[160:163], v[128:131]
    ds_read_b128 v[244:247], v1 offset:54272
    v_mfma_f32_16x16x32_bf16 v[132:135], v[188:191], v[164:167], v[132:135]
    v_mfma_f32_16x16x32_bf16 v[136:139], v[192:195], v[160:163], v[136:139]
    v_lshrrev_b32 v0, 4, v1
    v_mfma_f32_16x16x32_bf16 v[140:143], v[192:195], v[164:167], v[140:143]
    v_and_b32 v0, 48, v0
    v_mfma_f32_16x16x32_bf16 v[144:147], v[196:199], v[160:163], v[144:147]
    v_add_u32 v0, 160320, v0
    v_mfma_f32_16x16x32_bf16 v[148:151], v[196:199], v[164:167], v[148:151]
    v_mfma_f32_16x16x32_bf16 v[152:155], v[200:203], v[160:163], v[152:155]
    v_mfma_f32_16x16x32_bf16 v[156:159], v[200:203], v[164:167], v[156:159]
    s_waitcnt lgkmcnt(0)
    v_mfma_f32_16x16x32_bf16 v[88:91], v[212:215], v[204:207], v[88:91]
    ds_read_b128 v[168:171], v0 offset:0
    v_mfma_f32_16x16x32_bf16 v[92:95], v[212:215], v[208:211], v[92:95]
    ds_read_b128 v[172:175], v0 offset:64
    v_mfma_f32_16x16x32_bf16 v[96:99], v[216:219], v[204:207], v[96:99]
    ds_read_b128 v[176:179], v0 offset:128
    v_mfma_f32_16x16x32_bf16 v[100:103], v[216:219], v[208:211], v[100:103]
    ds_read_b128 v[180:183], v0 offset:192
    v_mfma_f32_16x16x32_bf16 v[104:107], v[220:223], v[204:207], v[104:107]
    ds_read_b128 v[184:187], v0 offset:256
    v_mfma_f32_16x16x32_bf16 v[108:111], v[220:223], v[208:211], v[108:111]
    ds_read_b128 v[188:191], v0 offset:320
    v_mfma_f32_16x16x32_bf16 v[112:115], v[224:227], v[204:207], v[112:115]
    ds_read_b128 v[192:195], v0 offset:384
    v_mfma_f32_16x16x32_bf16 v[116:119], v[224:227], v[208:211], v[116:119]
    ds_read_b128 v[196:199], v0 offset:448
    v_mfma_f32_16x16x32_bf16 v[120:123], v[228:231], v[204:207], v[120:123]
    ds_read_b128 v[200:203], v0 offset:512
    v_mfma_f32_16x16x32_bf16 v[124:127], v[228:231], v[208:211], v[124:127]
    ds_read_u16 v12, v13
    v_mfma_f32_16x16x32_bf16 v[128:131], v[232:235], v[204:207], v[128:131]
    ds_read_u16 v252, v13 offset:32
    v_mfma_f32_16x16x32_bf16 v[132:135], v[232:235], v[208:211], v[132:135]
    v_mfma_f32_16x16x32_bf16 v[136:139], v[236:239], v[204:207], v[136:139]
    s_lshr_b32 s35, s20, 1
    s_mul_i32 s35, s35, 36864
    v_mfma_f32_16x16x32_bf16 v[140:143], v[236:239], v[208:211], v[140:143]
    s_and_b32 s34, s20, 1
    s_mul_i32 s34, s34, 9216
    v_mfma_f32_16x16x32_bf16 v[144:147], v[240:243], v[204:207], v[144:147]
    s_add_u32 s35, s35, s34
    v_mfma_f32_16x16x32_bf16 v[148:151], v[240:243], v[208:211], v[148:151]
    v_add_u32 v3, s35, v2
    v_mfma_f32_16x16x32_bf16 v[152:155], v[244:247], v[204:207], v[152:155]
    v_mfma_f32_16x16x32_bf16 v[156:159], v[244:247], v[208:211], v[156:159]
    s_waitcnt vmcnt(0)
    s_barrier
    s_waitcnt lgkmcnt(0)
    v_lshlrev_b32 v15, 16, v12
    v_lshlrev_b32 v255, 16, v252
    v_lshlrev_b32 v14, 16, v12
    v_lshlrev_b32 v254, 16, v252
    v_lshlrev_b32 v13, 16, v12
    v_lshlrev_b32 v253, 16, v252
    v_lshlrev_b32 v12, 16, v12
    v_lshlrev_b32 v252, 16, v252
    ds_write_b128 v3, v[16:19] offset:0
    v_pk_fma_f32 v[88:89], v[248:249], v[168:169], v[88:89] op_sel_hi:[0,1,1] neg_lo:[1,0,0] neg_hi:[1,0,0]
    v_pk_fma_f32 v[90:91], v[248:249], v[170:171], v[90:91] op_sel_hi:[0,1,1] neg_lo:[1,0,0] neg_hi:[1,0,0]
    v_pk_fma_f32 v[92:93], v[250:251], v[168:169], v[92:93] op_sel_hi:[0,1,1] neg_lo:[1,0,0] neg_hi:[1,0,0]
    v_pk_fma_f32 v[94:95], v[250:251], v[170:171], v[94:95] op_sel_hi:[0,1,1] neg_lo:[1,0,0] neg_hi:[1,0,0]
    ds_write_b128 v3, v[24:27] offset:1024
    v_pk_fma_f32 v[96:97], v[248:249], v[172:173], v[96:97] op_sel_hi:[0,1,1] neg_lo:[1,0,0] neg_hi:[1,0,0]
    v_pk_fma_f32 v[98:99], v[248:249], v[174:175], v[98:99] op_sel_hi:[0,1,1] neg_lo:[1,0,0] neg_hi:[1,0,0]
    v_pk_fma_f32 v[100:101], v[250:251], v[172:173], v[100:101] op_sel_hi:[0,1,1] neg_lo:[1,0,0] neg_hi:[1,0,0]
    v_pk_fma_f32 v[102:103], v[250:251], v[174:175], v[102:103] op_sel_hi:[0,1,1] neg_lo:[1,0,0] neg_hi:[1,0,0]
    ds_write_b128 v3, v[32:35] offset:2048
    v_pk_fma_f32 v[104:105], v[248:249], v[176:177], v[104:105] op_sel_hi:[0,1,1] neg_lo:[1,0,0] neg_hi:[1,0,0]
    v_pk_fma_f32 v[106:107], v[248:249], v[178:179], v[106:107] op_sel_hi:[0,1,1] neg_lo:[1,0,0] neg_hi:[1,0,0]
    v_pk_fma_f32 v[108:109], v[250:251], v[176:177], v[108:109] op_sel_hi:[0,1,1] neg_lo:[1,0,0] neg_hi:[1,0,0]
    v_pk_fma_f32 v[110:111], v[250:251], v[178:179], v[110:111] op_sel_hi:[0,1,1] neg_lo:[1,0,0] neg_hi:[1,0,0]
    ds_write_b128 v3, v[40:43] offset:3072
    v_pk_fma_f32 v[112:113], v[248:249], v[180:181], v[112:113] op_sel_hi:[0,1,1] neg_lo:[1,0,0] neg_hi:[1,0,0]
    v_pk_fma_f32 v[114:115], v[248:249], v[182:183], v[114:115] op_sel_hi:[0,1,1] neg_lo:[1,0,0] neg_hi:[1,0,0]
    v_pk_fma_f32 v[116:117], v[250:251], v[180:181], v[116:117] op_sel_hi:[0,1,1] neg_lo:[1,0,0] neg_hi:[1,0,0]
    v_pk_fma_f32 v[118:119], v[250:251], v[182:183], v[118:119] op_sel_hi:[0,1,1] neg_lo:[1,0,0] neg_hi:[1,0,0]
    ds_write_b128 v3, v[48:51] offset:4096
    v_pk_fma_f32 v[120:121], v[248:249], v[184:185], v[120:121] op_sel_hi:[0,1,1] neg_lo:[1,0,0] neg_hi:[1,0,0]
    v_pk_fma_f32 v[122:123], v[248:249], v[186:187], v[122:123] op_sel_hi:[0,1,1] neg_lo:[1,0,0] neg_hi:[1,0,0]
    v_pk_fma_f32 v[124:125], v[250:251], v[184:185], v[124:125] op_sel_hi:[0,1,1] neg_lo:[1,0,0] neg_hi:[1,0,0]
    v_pk_fma_f32 v[126:127], v[250:251], v[186:187], v[126:127] op_sel_hi:[0,1,1] neg_lo:[1,0,0] neg_hi:[1,0,0]
    ds_write_b128 v3, v[56:59] offset:5120
    v_pk_fma_f32 v[128:129], v[248:249], v[188:189], v[128:129] op_sel_hi:[0,1,1] neg_lo:[1,0,0] neg_hi:[1,0,0]
    v_pk_fma_f32 v[130:131], v[248:249], v[190:191], v[130:131] op_sel_hi:[0,1,1] neg_lo:[1,0,0] neg_hi:[1,0,0]
    v_pk_fma_f32 v[132:133], v[250:251], v[188:189], v[132:133] op_sel_hi:[0,1,1] neg_lo:[1,0,0] neg_hi:[1,0,0]
    v_pk_fma_f32 v[134:135], v[250:251], v[190:191], v[134:135] op_sel_hi:[0,1,1] neg_lo:[1,0,0] neg_hi:[1,0,0]
    ds_write_b128 v3, v[64:67] offset:6144
    v_pk_fma_f32 v[136:137], v[248:249], v[192:193], v[136:137] op_sel_hi:[0,1,1] neg_lo:[1,0,0] neg_hi:[1,0,0]
    v_pk_fma_f32 v[138:139], v[248:249], v[194:195], v[138:139] op_sel_hi:[0,1,1] neg_lo:[1,0,0] neg_hi:[1,0,0]
    v_pk_fma_f32 v[140:141], v[250:251], v[192:193], v[140:141] op_sel_hi:[0,1,1] neg_lo:[1,0,0] neg_hi:[1,0,0]
    v_pk_fma_f32 v[142:143], v[250:251], v[194:195], v[142:143] op_sel_hi:[0,1,1] neg_lo:[1,0,0] neg_hi:[1,0,0]
    ds_write_b128 v3, v[72:75] offset:7168
    v_pk_fma_f32 v[144:145], v[248:249], v[196:197], v[144:145] op_sel_hi:[0,1,1] neg_lo:[1,0,0] neg_hi:[1,0,0]
    v_pk_fma_f32 v[146:147], v[248:249], v[198:199], v[146:147] op_sel_hi:[0,1,1] neg_lo:[1,0,0] neg_hi:[1,0,0]
    v_pk_fma_f32 v[148:149], v[250:251], v[196:197], v[148:149] op_sel_hi:[0,1,1] neg_lo:[1,0,0] neg_hi:[1,0,0]
    v_pk_fma_f32 v[150:151], v[250:251], v[198:199], v[150:151] op_sel_hi:[0,1,1] neg_lo:[1,0,0] neg_hi:[1,0,0]
    ds_write_b128 v3, v[80:83] offset:8192
    v_pk_fma_f32 v[152:153], v[248:249], v[200:201], v[152:153] op_sel_hi:[0,1,1] neg_lo:[1,0,0] neg_hi:[1,0,0]
    v_pk_fma_f32 v[154:155], v[248:249], v[202:203], v[154:155] op_sel_hi:[0,1,1] neg_lo:[1,0,0] neg_hi:[1,0,0]
    v_pk_fma_f32 v[156:157], v[250:251], v[200:201], v[156:157] op_sel_hi:[0,1,1] neg_lo:[1,0,0] neg_hi:[1,0,0]
    v_pk_fma_f32 v[158:159], v[250:251], v[202:203], v[158:159] op_sel_hi:[0,1,1] neg_lo:[1,0,0] neg_hi:[1,0,0]
    v_pk_mul_f32 v[204:205], v[88:89], v[88:89]
    v_pk_mul_f32 v[206:207], v[90:91], v[90:91]
    v_pk_mul_f32 v[208:209], v[92:93], v[92:93]
    v_pk_mul_f32 v[210:211], v[94:95], v[94:95]
    v_pk_fma_f32 v[204:205], v[204:205], v[4:5], v[4:5] op_sel:[0,1,0] op_sel_hi:[1,1,0]
    v_pk_fma_f32 v[206:207], v[206:207], v[4:5], v[4:5] op_sel:[0,1,0] op_sel_hi:[1,1,0]
    v_pk_fma_f32 v[208:209], v[208:209], v[6:7], v[6:7] op_sel:[0,1,0] op_sel_hi:[1,1,0]
    v_pk_fma_f32 v[210:211], v[210:211], v[6:7], v[6:7] op_sel:[0,1,0] op_sel_hi:[1,1,0]
    v_pk_mul_f32 v[204:205], v[204:205], v[88:89]
    v_pk_mul_f32 v[206:207], v[206:207], v[90:91]
    v_pk_mul_f32 v[208:209], v[208:209], v[92:93]
    v_pk_mul_f32 v[210:211], v[210:211], v[94:95]
    v_exp_f32 v204, v204
    v_exp_f32 v205, v205
    v_exp_f32 v206, v206
    v_exp_f32 v207, v207
    v_exp_f32 v208, v208
    v_exp_f32 v209, v209
    v_exp_f32 v210, v210
    v_exp_f32 v211, v211
    v_pk_fma_f32 v[204:205], v[204:205], v[248:249], v[248:249] op_sel:[0,1,1] op_sel_hi:[1,1,1]
    v_pk_fma_f32 v[206:207], v[206:207], v[248:249], v[248:249] op_sel:[0,1,1] op_sel_hi:[1,1,1]
    v_pk_fma_f32 v[208:209], v[208:209], v[250:251], v[250:251] op_sel:[0,1,1] op_sel_hi:[1,1,1]
    v_pk_fma_f32 v[210:211], v[210:211], v[250:251], v[250:251] op_sel:[0,1,1] op_sel_hi:[1,1,1]
    v_rcp_f32 v204, v204
    v_rcp_f32 v205, v205
    v_rcp_f32 v206, v206
    v_rcp_f32 v207, v207
    v_rcp_f32 v208, v208
    v_rcp_f32 v209, v209
    v_rcp_f32 v210, v210
    v_rcp_f32 v211, v211
    v_pk_mul_f32 v[88:89], v[88:89], v[204:205]
    v_pk_mul_f32 v[90:91], v[90:91], v[206:207]
    v_pk_mul_f32 v[92:93], v[92:93], v[208:209]
    v_pk_mul_f32 v[94:95], v[94:95], v[210:211]
    v_pk_mul_f32 v[212:213], v[96:97], v[96:97]
    v_pk_mul_f32 v[214:215], v[98:99], v[98:99]
    v_pk_mul_f32 v[216:217], v[100:101], v[100:101]
    v_pk_mul_f32 v[218:219], v[102:103], v[102:103]
    v_pk_fma_f32 v[212:213], v[212:213], v[4:5], v[4:5] op_sel:[0,1,0] op_sel_hi:[1,1,0]
    v_pk_fma_f32 v[214:215], v[214:215], v[4:5], v[4:5] op_sel:[0,1,0] op_sel_hi:[1,1,0]
    v_pk_fma_f32 v[216:217], v[216:217], v[6:7], v[6:7] op_sel:[0,1,0] op_sel_hi:[1,1,0]
    v_pk_fma_f32 v[218:219], v[218:219], v[6:7], v[6:7] op_sel:[0,1,0] op_sel_hi:[1,1,0]
    v_pk_mul_f32 v[212:213], v[212:213], v[96:97]
    v_pk_mul_f32 v[214:215], v[214:215], v[98:99]
    v_pk_mul_f32 v[216:217], v[216:217], v[100:101]
    v_pk_mul_f32 v[218:219], v[218:219], v[102:103]
    v_exp_f32 v212, v212
    v_exp_f32 v213, v213
    v_exp_f32 v214, v214
    v_exp_f32 v215, v215
    v_exp_f32 v216, v216
    v_exp_f32 v217, v217
    v_exp_f32 v218, v218
    v_exp_f32 v219, v219
    v_pk_fma_f32 v[212:213], v[212:213], v[248:249], v[248:249] op_sel:[0,1,1] op_sel_hi:[1,1,1]
    v_pk_fma_f32 v[214:215], v[214:215], v[248:249], v[248:249] op_sel:[0,1,1] op_sel_hi:[1,1,1]
    v_pk_fma_f32 v[216:217], v[216:217], v[250:251], v[250:251] op_sel:[0,1,1] op_sel_hi:[1,1,1]
    v_pk_fma_f32 v[218:219], v[218:219], v[250:251], v[250:251] op_sel:[0,1,1] op_sel_hi:[1,1,1]
    v_rcp_f32 v212, v212
    v_rcp_f32 v213, v213
    v_rcp_f32 v214, v214
    v_rcp_f32 v215, v215
    v_rcp_f32 v216, v216
    v_rcp_f32 v217, v217
    v_rcp_f32 v218, v218
    v_rcp_f32 v219, v219
    v_pk_mul_f32 v[96:97], v[96:97], v[212:213]
    v_pk_mul_f32 v[98:99], v[98:99], v[214:215]
    v_pk_mul_f32 v[100:101], v[100:101], v[216:217]
    v_pk_mul_f32 v[102:103], v[102:103], v[218:219]
    v_pk_mul_f32 v[204:205], v[104:105], v[104:105]
    v_pk_mul_f32 v[206:207], v[106:107], v[106:107]
    v_pk_mul_f32 v[208:209], v[108:109], v[108:109]
    v_pk_mul_f32 v[210:211], v[110:111], v[110:111]
    v_pk_fma_f32 v[204:205], v[204:205], v[4:5], v[4:5] op_sel:[0,1,0] op_sel_hi:[1,1,0]
    v_pk_fma_f32 v[206:207], v[206:207], v[4:5], v[4:5] op_sel:[0,1,0] op_sel_hi:[1,1,0]
    v_pk_fma_f32 v[208:209], v[208:209], v[6:7], v[6:7] op_sel:[0,1,0] op_sel_hi:[1,1,0]
    v_pk_fma_f32 v[210:211], v[210:211], v[6:7], v[6:7] op_sel:[0,1,0] op_sel_hi:[1,1,0]
    v_pk_mul_f32 v[204:205], v[204:205], v[104:105]
    v_pk_mul_f32 v[206:207], v[206:207], v[106:107]
    v_pk_mul_f32 v[208:209], v[208:209], v[108:109]
    v_pk_mul_f32 v[210:211], v[210:211], v[110:111]
    v_exp_f32 v204, v204
    v_exp_f32 v205, v205
    v_exp_f32 v206, v206
    v_exp_f32 v207, v207
    v_exp_f32 v208, v208
    v_exp_f32 v209, v209
    v_exp_f32 v210, v210
    v_exp_f32 v211, v211
    v_pk_fma_f32 v[204:205], v[204:205], v[248:249], v[248:249] op_sel:[0,1,1] op_sel_hi:[1,1,1]
    v_pk_fma_f32 v[206:207], v[206:207], v[248:249], v[248:249] op_sel:[0,1,1] op_sel_hi:[1,1,1]
    v_pk_fma_f32 v[208:209], v[208:209], v[250:251], v[250:251] op_sel:[0,1,1] op_sel_hi:[1,1,1]
    v_pk_fma_f32 v[210:211], v[210:211], v[250:251], v[250:251] op_sel:[0,1,1] op_sel_hi:[1,1,1]
    v_rcp_f32 v204, v204
    v_rcp_f32 v205, v205
    v_rcp_f32 v206, v206
    v_rcp_f32 v207, v207
    v_rcp_f32 v208, v208
    v_rcp_f32 v209, v209
    v_rcp_f32 v210, v210
    v_rcp_f32 v211, v211
    v_pk_mul_f32 v[104:105], v[104:105], v[204:205]
    v_pk_mul_f32 v[106:107], v[106:107], v[206:207]
    v_pk_mul_f32 v[108:109], v[108:109], v[208:209]
    v_pk_mul_f32 v[110:111], v[110:111], v[210:211]
    s_waitcnt lgkmcnt(0)
    s_barrier
    ds_read_b128 v[160:163], v10 offset:0
    ds_read_b128 v[164:167], v10 offset:2048
    ds_read_b128 v[168:171], v2 offset:0
    ds_read_b128 v[172:175], v2 offset:1024
    ds_read_b128 v[176:179], v2 offset:2048
    ds_read_b128 v[180:183], v2 offset:3072
    ds_read_b128 v[184:187], v2 offset:4096
    ds_read_b128 v[188:191], v2 offset:5120
    ds_read_b128 v[192:195], v2 offset:6144
    ds_read_b128 v[196:199], v2 offset:7168
    ds_read_b128 v[200:203], v2 offset:8192
    v_pk_mul_f32 v[212:213], v[112:113], v[112:113]
    v_pk_mul_f32 v[214:215], v[114:115], v[114:115]
    v_pk_mul_f32 v[216:217], v[116:117], v[116:117]
    v_pk_mul_f32 v[218:219], v[118:119], v[118:119]
    v_pk_fma_f32 v[212:213], v[212:213], v[4:5], v[4:5] op_sel:[0,1,0] op_sel_hi:[1,1,0]
    v_pk_fma_f32 v[214:215], v[214:215], v[4:5], v[4:5] op_sel:[0,1,0] op_sel_hi:[1,1,0]
    v_pk_fma_f32 v[216:217], v[216:217], v[6:7], v[6:7] op_sel:[0,1,0] op_sel_hi:[1,1,0]
    v_pk_fma_f32 v[218:219], v[218:219], v[6:7], v[6:7] op_sel:[0,1,0] op_sel_hi:[1,1,0]
    v_pk_mul_f32 v[212:213], v[212:213], v[112:113]
    v_pk_mul_f32 v[214:215], v[214:215], v[114:115]
    v_pk_mul_f32 v[216:217], v[216:217], v[116:117]
    v_pk_mul_f32 v[218:219], v[218:219], v[118:119]
    v_exp_f32 v212, v212
    v_exp_f32 v213, v213
    v_exp_f32 v214, v214
    v_exp_f32 v215, v215
    v_exp_f32 v216, v216
    v_exp_f32 v217, v217
    v_exp_f32 v218, v218
    v_exp_f32 v219, v219
    v_pk_fma_f32 v[212:213], v[212:213], v[248:249], v[248:249] op_sel:[0,1,1] op_sel_hi:[1,1,1]
    v_pk_fma_f32 v[214:215], v[214:215], v[248:249], v[248:249] op_sel:[0,1,1] op_sel_hi:[1,1,1]
    v_pk_fma_f32 v[216:217], v[216:217], v[250:251], v[250:251] op_sel:[0,1,1] op_sel_hi:[1,1,1]
    v_pk_fma_f32 v[218:219], v[218:219], v[250:251], v[250:251] op_sel:[0,1,1] op_sel_hi:[1,1,1]
    v_rcp_f32 v212, v212
    v_rcp_f32 v213, v213
    v_rcp_f32 v214, v214
    v_rcp_f32 v215, v215
    v_rcp_f32 v216, v216
    v_rcp_f32 v217, v217
    v_rcp_f32 v218, v218
    v_rcp_f32 v219, v219
    v_pk_mul_f32 v[112:113], v[112:113], v[212:213]
    v_pk_mul_f32 v[114:115], v[114:115], v[214:215]
    v_pk_mul_f32 v[116:117], v[116:117], v[216:217]
    v_pk_mul_f32 v[118:119], v[118:119], v[218:219]
    s_waitcnt lgkmcnt(5)
    v_mfma_f32_16x16x32_bf16 v[16:19], v[168:171], v[160:163], v[12:15]
    ds_read_b128 v[204:207], v11 offset:0
    v_mfma_f32_16x16x32_bf16 v[20:23], v[168:171], v[164:167], v[252:255]
    ds_read_b128 v[208:211], v11 offset:2048
    v_mfma_f32_16x16x32_bf16 v[24:27], v[172:175], v[160:163], v[12:15]
    ds_read_b128 v[212:215], v2 offset:9216
    v_mfma_f32_16x16x32_bf16 v[28:31], v[172:175], v[164:167], v[252:255]
    ds_read_b128 v[216:219], v2 offset:10240
    v_mfma_f32_16x16x32_bf16 v[32:35], v[176:179], v[160:163], v[12:15]
    ds_read_b128 v[220:223], v2 offset:11264
    v_mfma_f32_16x16x32_bf16 v[36:39], v[176:179], v[164:167], v[252:255]
    ds_read_b128 v[224:227], v2 offset:12288
    v_mfma_f32_16x16x32_bf16 v[40:43], v[180:183], v[160:163], v[12:15]
    ds_read_b128 v[228:231], v2 offset:13312
    v_mfma_f32_16x16x32_bf16 v[44:47], v[180:183], v[164:167], v[252:255]
    ds_read_b128 v[232:235], v2 offset:14336
    s_waitcnt lgkmcnt(8)
    v_mfma_f32_16x16x32_bf16 v[48:51], v[184:187], v[160:163], v[12:15]
    ds_read_b128 v[236:239], v2 offset:15360
    v_mfma_f32_16x16x32_bf16 v[52:55], v[184:187], v[164:167], v[252:255]
    ds_read_b128 v[240:243], v2 offset:16384
    v_mfma_f32_16x16x32_bf16 v[56:59], v[188:191], v[160:163], v[12:15]
    ds_read_b128 v[244:247], v2 offset:17408
    v_mfma_f32_16x16x32_bf16 v[60:63], v[188:191], v[164:167], v[252:255]
    v_mfma_f32_16x16x32_bf16 v[64:67], v[192:195], v[160:163], v[12:15]
    v_mfma_f32_16x16x32_bf16 v[68:71], v[192:195], v[164:167], v[252:255]
    v_mfma_f32_16x16x32_bf16 v[72:75], v[196:199], v[160:163], v[12:15]
    v_mfma_f32_16x16x32_bf16 v[76:79], v[196:199], v[164:167], v[252:255]
    v_mfma_f32_16x16x32_bf16 v[80:83], v[200:203], v[160:163], v[12:15]
    v_mfma_f32_16x16x32_bf16 v[84:87], v[200:203], v[164:167], v[252:255]
    s_waitcnt lgkmcnt(0)
    s_barrier
    v_mfma_f32_16x16x32_bf16 v[16:19], v[212:215], v[204:207], v[16:19]
    ds_read_b128 v[160:163], v10 offset:36864
    v_mfma_f32_16x16x32_bf16 v[20:23], v[212:215], v[208:211], v[20:23]
    ds_read_b128 v[164:167], v10 offset:38912
    v_mfma_f32_16x16x32_bf16 v[24:27], v[216:219], v[204:207], v[24:27]
    ds_read_b128 v[168:171], v2 offset:36864
    v_mfma_f32_16x16x32_bf16 v[28:31], v[216:219], v[208:211], v[28:31]
    ds_read_b128 v[172:175], v2 offset:37888
    v_mul_f32 v12, v120, v120
    v_mfma_f32_16x16x32_bf16 v[32:35], v[220:223], v[204:207], v[32:35]
    ds_read_b128 v[176:179], v2 offset:38912
    v_mul_f32 v13, v121, v121
    v_mfma_f32_16x16x32_bf16 v[36:39], v[220:223], v[208:211], v[36:39]
    ds_read_b128 v[180:183], v2 offset:39936
    v_mul_f32 v14, v122, v122
    v_mfma_f32_16x16x32_bf16 v[40:43], v[224:227], v[204:207], v[40:43]
    ds_read_b128 v[184:187], v2 offset:40960
    v_mul_f32 v15, v123, v123
    v_mfma_f32_16x16x32_bf16 v[44:47], v[224:227], v[208:211], v[44:47]
    ds_read_b128 v[188:191], v2 offset:41984
    v_mfma_f32_16x16x32_bf16 v[48:51], v[228:231], v[204:207], v[48:51]
    ds_read_b128 v[192:195], v2 offset:43008
    v_mul_f32 v252, v124, v124
    v_mfma_f32_16x16x32_bf16 v[52:55], v[228:231], v[208:211], v[52:55]
    ds_read_b128 v[196:199], v2 offset:44032
    v_mul_f32 v253, v125, v125
    v_mfma_f32_16x16x32_bf16 v[56:59], v[232:235], v[204:207], v[56:59]
    ds_read_b128 v[200:203], v2 offset:45056
    v_mul_f32 v254, v126, v126
    v_mfma_f32_16x16x32_bf16 v[60:63], v[232:235], v[208:211], v[60:63]
    v_mul_f32 v255, v127, v127
    v_fma_f32 v12, v12, v5, v4
    v_mfma_f32_16x16x32_bf16 v[64:67], v[236:239], v[204:207], v[64:67]
    v_fma_f32 v13, v13, v5, v4
    v_fma_f32 v14, v14, v5, v4
    v_mfma_f32_16x16x32_bf16 v[68:71], v[236:239], v[208:211], v[68:71]
    v_fma_f32 v15, v15, v5, v4
    v_fma_f32 v252, v252, v7, v6
    v_mfma_f32_16x16x32_bf16 v[72:75], v[240:243], v[204:207], v[72:75]
    v_fma_f32 v253, v253, v7, v6
    v_fma_f32 v254, v254, v7, v6
    v_mfma_f32_16x16x32_bf16 v[76:79], v[240:243], v[208:211], v[76:79]
    v_fma_f32 v255, v255, v7, v6
    v_mul_f32 v12, v12, v120
    v_mfma_f32_16x16x32_bf16 v[80:83], v[244:247], v[204:207], v[80:83]
    v_mul_f32 v13, v13, v121
    v_mul_f32 v14, v14, v122
    v_mfma_f32_16x16x32_bf16 v[84:87], v[244:247], v[208:211], v[84:87]
    v_mul_f32 v15, v15, v123
    s_waitcnt lgkmcnt(5)
    v_mfma_f32_16x16x32_bf16 v[16:19], v[168:171], v[160:163], v[16:19]
    ds_read_b128 v[204:207], v11 offset:36864
    v_mfma_f32_16x16x32_bf16 v[20:23], v[168:171], v[164:167], v[20:23]
    ds_read_b128 v[208:211], v11 offset:38912
    v_mul_f32 v252, v252, v124
    v_mfma_f32_16x16x32_bf16 v[24:27], v[172:175], v[160:163], v[24:27]
    ds_read_b128 v[212:215], v2 offset:46080
    v_mul_f32 v253, v253, v125
    v_mfma_f32_16x16x32_bf16 v[28:31], v[172:175], v[164:167], v[28:31]
    ds_read_b128 v[216:219], v2 offset:47104
    v_mul_f32 v254, v254, v126
    v_mfma_f32_16x16x32_bf16 v[32:35], v[176:179], v[160:163], v[32:35]
    ds_read_b128 v[220:223], v2 offset:48128
    v_mul_f32 v255, v255, v127
    v_mfma_f32_16x16x32_bf16 v[36:39], v[176:179], v[164:167], v[36:39]
    ds_read_b128 v[224:227], v2 offset:49152
    v_exp_f32 v12, v12
    v_mfma_f32_16x16x32_bf16 v[40:43], v[180:183], v[160:163], v[40:43]
    ds_read_b128 v[228:231], v2 offset:50176
    v_exp_f32 v13, v13
    v_mfma_f32_16x16x32_bf16 v[44:47], v[180:183], v[164:167], v[44:47]
    ds_read_b128 v[232:235], v2 offset:51200
    s_waitcnt lgkmcnt(8)
    v_mfma_f32_16x16x32_bf16 v[48:51], v[184:187], v[160:163], v[48:51]
    ds_read_b128 v[236:239], v2 offset:52224
    v_exp_f32 v14, v14
    v_mfma_f32_16x16x32_bf16 v[52:55], v[184:187], v[164:167], v[52:55]
    ds_read_b128 v[240:243], v2 offset:53248
    v_exp_f32 v15, v15
    v_mfma_f32_16x16x32_bf16 v[56:59], v[188:191], v[160:163], v[56:59]
    ds_read_b128 v[244:247], v2 offset:54272
    v_exp_f32 v252, v252
    v_mfma_f32_16x16x32_bf16 v[60:63], v[188:191], v[164:167], v[60:63]
    v_exp_f32 v253, v253
    v_mfma_f32_16x16x32_bf16 v[64:67], v[192:195], v[160:163], v[64:67]
    v_exp_f32 v254, v254
    v_mfma_f32_16x16x32_bf16 v[68:71], v[192:195], v[164:167], v[68:71]
    v_exp_f32 v255, v255
    v_mfma_f32_16x16x32_bf16 v[72:75], v[196:199], v[160:163], v[72:75]
    v_fma_f32 v12, v12, v249, v249
    v_fma_f32 v13, v13, v249, v249
    v_mfma_f32_16x16x32_bf16 v[76:79], v[196:199], v[164:167], v[76:79]
    v_fma_f32 v14, v14, v249, v249
    v_fma_f32 v15, v15, v249, v249
    v_mfma_f32_16x16x32_bf16 v[80:83], v[200:203], v[160:163], v[80:83]
    v_fma_f32 v252, v252, v251, v251
    v_fma_f32 v253, v253, v251, v251
    v_mfma_f32_16x16x32_bf16 v[84:87], v[200:203], v[164:167], v[84:87]
    v_fma_f32 v254, v254, v251, v251
    s_waitcnt lgkmcnt(0)
    s_barrier
    v_mfma_f32_16x16x32_bf16 v[16:19], v[212:215], v[204:207], v[16:19]
    ds_read_b128 v[160:163], v8 offset:0
    v_mfma_f32_16x16x32_bf16 v[20:23], v[212:215], v[208:211], v[20:23]
    ds_read_b128 v[164:167], v8 offset:2048
    v_fma_f32 v255, v255, v251, v251
    v_mfma_f32_16x16x32_bf16 v[24:27], v[216:219], v[204:207], v[24:27]
    ds_read_b128 v[168:171], v1 offset:0
    v_rcp_f32 v12, v12
    v_mfma_f32_16x16x32_bf16 v[28:31], v[216:219], v[208:211], v[28:31]
    ds_read_b128 v[172:175], v1 offset:1024
    v_rcp_f32 v13, v13
    v_mfma_f32_16x16x32_bf16 v[32:35], v[220:223], v[204:207], v[32:35]
    ds_read_b128 v[176:179], v1 offset:2048
    v_rcp_f32 v14, v14
    v_mfma_f32_16x16x32_bf16 v[36:39], v[220:223], v[208:211], v[36:39]
    ds_read_b128 v[180:183], v1 offset:3072
    v_rcp_f32 v15, v15
    v_mfma_f32_16x16x32_bf16 v[40:43], v[224:227], v[204:207], v[40:43]
    ds_read_b128 v[184:187], v1 offset:4096
    v_rcp_f32 v252, v252
    v_mfma_f32_16x16x32_bf16 v[44:47], v[224:227], v[208:211], v[44:47]
    ds_read_b128 v[188:191], v1 offset:5120
    v_mfma_f32_16x16x32_bf16 v[48:51], v[228:231], v[204:207], v[48:51]
    ds_read_b128 v[192:195], v1 offset:6144
    v_rcp_f32 v253, v253
    v_mfma_f32_16x16x32_bf16 v[52:55], v[228:231], v[208:211], v[52:55]
    ds_read_b128 v[196:199], v1 offset:7168
    v_rcp_f32 v254, v254
    v_mfma_f32_16x16x32_bf16 v[56:59], v[232:235], v[204:207], v[56:59]
    ds_read_b128 v[200:203], v1 offset:8192
    v_rcp_f32 v255, v255
    v_mfma_f32_16x16x32_bf16 v[60:63], v[232:235], v[208:211], v[60:63]
    v_mul_f32 v120, v120, v12
    v_mul_f32 v121, v121, v13
    v_mfma_f32_16x16x32_bf16 v[64:67], v[236:239], v[204:207], v[64:67]
    v_mul_f32 v122, v122, v14
    v_mul_f32 v123, v123, v15
    v_mfma_f32_16x16x32_bf16 v[68:71], v[236:239], v[208:211], v[68:71]
    v_mul_f32 v124, v124, v252
    v_mul_f32 v125, v125, v253
    v_mfma_f32_16x16x32_bf16 v[72:75], v[240:243], v[204:207], v[72:75]
    v_mul_f32 v126, v126, v254
    v_mul_f32 v127, v127, v255
    v_mfma_f32_16x16x32_bf16 v[76:79], v[240:243], v[208:211], v[76:79]
    v_mul_f32 v12, v128, v128
    v_mul_f32 v13, v129, v129
    v_mfma_f32_16x16x32_bf16 v[80:83], v[244:247], v[204:207], v[80:83]
    v_mul_f32 v14, v130, v130
    v_mul_f32 v15, v131, v131
    v_mfma_f32_16x16x32_bf16 v[84:87], v[244:247], v[208:211], v[84:87]
    v_mul_f32 v252, v132, v132
    s_waitcnt lgkmcnt(5)
    v_mfma_f32_16x16x32_bf16 v[16:19], v[168:171], v[160:163], v[16:19]
    ds_read_b128 v[204:207], v9 offset:0
    v_mfma_f32_16x16x32_bf16 v[20:23], v[168:171], v[164:167], v[20:23]
    ds_read_b128 v[208:211], v9 offset:2048
    v_mul_f32 v253, v133, v133
    v_mfma_f32_16x16x32_bf16 v[24:27], v[172:175], v[160:163], v[24:27]
    ds_read_b128 v[212:215], v1 offset:9216
    v_mul_f32 v254, v134, v134
    v_mfma_f32_16x16x32_bf16 v[28:31], v[172:175], v[164:167], v[28:31]
    ds_read_b128 v[216:219], v1 offset:10240
    v_mul_f32 v255, v135, v135
    v_mfma_f32_16x16x32_bf16 v[32:35], v[176:179], v[160:163], v[32:35]
    ds_read_b128 v[220:223], v1 offset:11264
    v_fma_f32 v12, v12, v5, v4
    v_mfma_f32_16x16x32_bf16 v[36:39], v[176:179], v[164:167], v[36:39]
    ds_read_b128 v[224:227], v1 offset:12288
    v_fma_f32 v13, v13, v5, v4
    v_mfma_f32_16x16x32_bf16 v[40:43], v[180:183], v[160:163], v[40:43]
    ds_read_b128 v[228:231], v1 offset:13312
    v_fma_f32 v14, v14, v5, v4
    v_mfma_f32_16x16x32_bf16 v[44:47], v[180:183], v[164:167], v[44:47]
    ds_read_b128 v[232:235], v1 offset:14336
    s_waitcnt lgkmcnt(8)
    v_mfma_f32_16x16x32_bf16 v[48:51], v[184:187], v[160:163], v[48:51]
    ds_read_b128 v[236:239], v1 offset:15360
    v_fma_f32 v15, v15, v5, v4
    v_mfma_f32_16x16x32_bf16 v[52:55], v[184:187], v[164:167], v[52:55]
    ds_read_b128 v[240:243], v1 offset:16384
    v_fma_f32 v252, v252, v7, v6
    v_mfma_f32_16x16x32_bf16 v[56:59], v[188:191], v[160:163], v[56:59]
    ds_read_b128 v[244:247], v1 offset:17408
    v_fma_f32 v253, v253, v7, v6
    v_mfma_f32_16x16x32_bf16 v[60:63], v[188:191], v[164:167], v[60:63]
    v_fma_f32 v254, v254, v7, v6
    v_fma_f32 v255, v255, v7, v6
    v_mfma_f32_16x16x32_bf16 v[64:67], v[192:195], v[160:163], v[64:67]
    v_mul_f32 v12, v12, v128
    v_mul_f32 v13, v13, v129
    v_mfma_f32_16x16x32_bf16 v[68:71], v[192:195], v[164:167], v[68:71]
    v_mul_f32 v14, v14, v130
    v_mul_f32 v15, v15, v131
    v_mfma_f32_16x16x32_bf16 v[72:75], v[196:199], v[160:163], v[72:75]
    v_mul_f32 v252, v252, v132
    v_mul_f32 v253, v253, v133
    v_mfma_f32_16x16x32_bf16 v[76:79], v[196:199], v[164:167], v[76:79]
    v_mul_f32 v254, v254, v134
    v_mul_f32 v255, v255, v135
    v_mfma_f32_16x16x32_bf16 v[80:83], v[200:203], v[160:163], v[80:83]
    v_exp_f32 v12, v12
    v_mfma_f32_16x16x32_bf16 v[84:87], v[200:203], v[164:167], v[84:87]
    v_exp_f32 v13, v13
    s_waitcnt lgkmcnt(0)
    s_barrier
    v_mfma_f32_16x16x32_bf16 v[16:19], v[212:215], v[204:207], v[16:19]
    ds_read_b128 v[160:163], v8 offset:36864
    v_mfma_f32_16x16x32_bf16 v[20:23], v[212:215], v[208:211], v[20:23]
    ds_read_b128 v[164:167], v8 offset:38912
    v_exp_f32 v14, v14
    v_mfma_f32_16x16x32_bf16 v[24:27], v[216:219], v[204:207], v[24:27]
    ds_read_b128 v[168:171], v1 offset:36864
    v_exp_f32 v15, v15
    v_mfma_f32_16x16x32_bf16 v[28:31], v[216:219], v[208:211], v[28:31]
    ds_read_b128 v[172:175], v1 offset:37888
    v_exp_f32 v252, v252
    v_mfma_f32_16x16x32_bf16 v[32:35], v[220:223], v[204:207], v[32:35]
    ds_read_b128 v[176:179], v1 offset:38912
    v_exp_f32 v253, v253
    v_mfma_f32_16x16x32_bf16 v[36:39], v[220:223], v[208:211], v[36:39]
    ds_read_b128 v[180:183], v1 offset:39936
    v_exp_f32 v254, v254
    v_mfma_f32_16x16x32_bf16 v[40:43], v[224:227], v[204:207], v[40:43]
    ds_read_b128 v[184:187], v1 offset:40960
    v_exp_f32 v255, v255
    v_mfma_f32_16x16x32_bf16 v[44:47], v[224:227], v[208:211], v[44:47]
    ds_read_b128 v[188:191], v1 offset:41984
    v_mfma_f32_16x16x32_bf16 v[48:51], v[228:231], v[204:207], v[48:51]
    ds_read_b128 v[192:195], v1 offset:43008
    v_fma_f32 v12, v12, v249, v249
    v_mfma_f32_16x16x32_bf16 v[52:55], v[228:231], v[208:211], v[52:55]
    ds_read_b128 v[196:199], v1 offset:44032
    v_fma_f32 v13, v13, v249, v249
    v_mfma_f32_16x16x32_bf16 v[56:59], v[232:235], v[204:207], v[56:59]
    ds_read_b128 v[200:203], v1 offset:45056
    v_fma_f32 v14, v14, v249, v249
    v_mfma_f32_16x16x32_bf16 v[60:63], v[232:235], v[208:211], v[60:63]
    v_fma_f32 v15, v15, v249, v249
    v_fma_f32 v252, v252, v251, v251
    v_mfma_f32_16x16x32_bf16 v[64:67], v[236:239], v[204:207], v[64:67]
    v_fma_f32 v253, v253, v251, v251
    v_fma_f32 v254, v254, v251, v251
    v_mfma_f32_16x16x32_bf16 v[68:71], v[236:239], v[208:211], v[68:71]
    v_fma_f32 v255, v255, v251, v251
    v_rcp_f32 v12, v12
    v_mfma_f32_16x16x32_bf16 v[72:75], v[240:243], v[204:207], v[72:75]
    v_rcp_f32 v13, v13
    v_mfma_f32_16x16x32_bf16 v[76:79], v[240:243], v[208:211], v[76:79]
    v_rcp_f32 v14, v14
    v_mfma_f32_16x16x32_bf16 v[80:83], v[244:247], v[204:207], v[80:83]
    v_rcp_f32 v15, v15
    v_mfma_f32_16x16x32_bf16 v[84:87], v[244:247], v[208:211], v[84:87]
    v_rcp_f32 v252, v252
    s_waitcnt lgkmcnt(5)
    v_mfma_f32_16x16x32_bf16 v[16:19], v[168:171], v[160:163], v[16:19]
    ds_read_b128 v[204:207], v9 offset:36864
    v_mfma_f32_16x16x32_bf16 v[20:23], v[168:171], v[164:167], v[20:23]
    ds_read_b128 v[208:211], v9 offset:38912
    v_rcp_f32 v253, v253
    v_mfma_f32_16x16x32_bf16 v[24:27], v[172:175], v[160:163], v[24:27]
    ds_read_b128 v[212:215], v1 offset:46080
    v_rcp_f32 v254, v254
    v_mfma_f32_16x16x32_bf16 v[28:31], v[172:175], v[164:167], v[28:31]
    ds_read_b128 v[216:219], v1 offset:47104
    v_rcp_f32 v255, v255
    v_mfma_f32_16x16x32_bf16 v[32:35], v[176:179], v[160:163], v[32:35]
    ds_read_b128 v[220:223], v1 offset:48128
    v_mul_f32 v128, v128, v12
    v_mfma_f32_16x16x32_bf16 v[36:39], v[176:179], v[164:167], v[36:39]
    ds_read_b128 v[224:227], v1 offset:49152
    v_mul_f32 v129, v129, v13
    v_mfma_f32_16x16x32_bf16 v[40:43], v[180:183], v[160:163], v[40:43]
    ds_read_b128 v[228:231], v1 offset:50176
    v_mul_f32 v130, v130, v14
    v_mfma_f32_16x16x32_bf16 v[44:47], v[180:183], v[164:167], v[44:47]
    ds_read_b128 v[232:235], v1 offset:51200
    s_waitcnt lgkmcnt(8)
    v_mfma_f32_16x16x32_bf16 v[48:51], v[184:187], v[160:163], v[48:51]
    ds_read_b128 v[236:239], v1 offset:52224
    v_mul_f32 v131, v131, v15
    v_mfma_f32_16x16x32_bf16 v[52:55], v[184:187], v[164:167], v[52:55]
    ds_read_b128 v[240:243], v1 offset:53248
    v_mul_f32 v132, v132, v252
    v_mfma_f32_16x16x32_bf16 v[56:59], v[188:191], v[160:163], v[56:59]
    ds_read_b128 v[244:247], v1 offset:54272
    v_mul_f32 v133, v133, v253
    v_mfma_f32_16x16x32_bf16 v[60:63], v[188:191], v[164:167], v[60:63]
    v_mul_f32 v134, v134, v254
    v_mul_f32 v135, v135, v255
    v_mfma_f32_16x16x32_bf16 v[64:67], v[192:195], v[160:163], v[64:67]
    v_mul_f32 v12, v136, v136
    v_mul_f32 v13, v137, v137
    v_mfma_f32_16x16x32_bf16 v[68:71], v[192:195], v[164:167], v[68:71]
    v_mul_f32 v14, v138, v138
    v_mul_f32 v15, v139, v139
    v_mfma_f32_16x16x32_bf16 v[72:75], v[196:199], v[160:163], v[72:75]
    v_mul_f32 v252, v140, v140
    v_mul_f32 v253, v141, v141
    v_mfma_f32_16x16x32_bf16 v[76:79], v[196:199], v[164:167], v[76:79]
    v_mul_f32 v254, v142, v142
    v_mul_f32 v255, v143, v143
    v_mfma_f32_16x16x32_bf16 v[80:83], v[200:203], v[160:163], v[80:83]
    v_fma_f32 v12, v12, v5, v4
    v_fma_f32 v13, v13, v5, v4
    v_mfma_f32_16x16x32_bf16 v[84:87], v[200:203], v[164:167], v[84:87]
    v_fma_f32 v14, v14, v5, v4
    s_waitcnt lgkmcnt(0)
    s_barrier
    v_mfma_f32_16x16x32_bf16 v[16:19], v[212:215], v[204:207], v[16:19]
    ds_read_b128 v[160:163], v10 offset:0
    v_mfma_f32_16x16x32_bf16 v[20:23], v[212:215], v[208:211], v[20:23]
    ds_read_b128 v[164:167], v10 offset:2048
    v_fma_f32 v15, v15, v5, v4
    v_mfma_f32_16x16x32_bf16 v[24:27], v[216:219], v[204:207], v[24:27]
    ds_read_b128 v[168:171], v2 offset:0
    v_fma_f32 v252, v252, v7, v6
    v_mfma_f32_16x16x32_bf16 v[28:31], v[216:219], v[208:211], v[28:31]
    ds_read_b128 v[172:175], v2 offset:1024
    v_fma_f32 v253, v253, v7, v6
    v_mfma_f32_16x16x32_bf16 v[32:35], v[220:223], v[204:207], v[32:35]
    ds_read_b128 v[176:179], v2 offset:2048
    v_fma_f32 v254, v254, v7, v6
    v_mfma_f32_16x16x32_bf16 v[36:39], v[220:223], v[208:211], v[36:39]
    ds_read_b128 v[180:183], v2 offset:3072
    v_fma_f32 v255, v255, v7, v6
    v_mfma_f32_16x16x32_bf16 v[40:43], v[224:227], v[204:207], v[40:43]
    ds_read_b128 v[184:187], v2 offset:4096
    v_mul_f32 v12, v12, v136
    v_mfma_f32_16x16x32_bf16 v[44:47], v[224:227], v[208:211], v[44:47]
    ds_read_b128 v[188:191], v2 offset:5120
    v_mfma_f32_16x16x32_bf16 v[48:51], v[228:231], v[204:207], v[48:51]
    ds_read_b128 v[192:195], v2 offset:6144
    v_mul_f32 v13, v13, v137
    v_mfma_f32_16x16x32_bf16 v[52:55], v[228:231], v[208:211], v[52:55]
    ds_read_b128 v[196:199], v2 offset:7168
    v_mul_f32 v14, v14, v138
    v_mfma_f32_16x16x32_bf16 v[56:59], v[232:235], v[204:207], v[56:59]
    ds_read_b128 v[200:203], v2 offset:8192
    v_mul_f32 v15, v15, v139
    v_mfma_f32_16x16x32_bf16 v[60:63], v[232:235], v[208:211], v[60:63]
    v_mul_f32 v252, v252, v140
    v_mul_f32 v253, v253, v141
    v_mfma_f32_16x16x32_bf16 v[64:67], v[236:239], v[204:207], v[64:67]
    v_mul_f32 v254, v254, v142
    v_mul_f32 v255, v255, v143
    v_mfma_f32_16x16x32_bf16 v[68:71], v[236:239], v[208:211], v[68:71]
    v_exp_f32 v12, v12
    v_mfma_f32_16x16x32_bf16 v[72:75], v[240:243], v[204:207], v[72:75]
    v_exp_f32 v13, v13
    v_mfma_f32_16x16x32_bf16 v[76:79], v[240:243], v[208:211], v[76:79]
    v_exp_f32 v14, v14
    v_mfma_f32_16x16x32_bf16 v[80:83], v[244:247], v[204:207], v[80:83]
    v_exp_f32 v15, v15
    v_mfma_f32_16x16x32_bf16 v[84:87], v[244:247], v[208:211], v[84:87]
    v_exp_f32 v252, v252
    s_waitcnt lgkmcnt(5)
    v_mfma_f32_16x16x32_bf16 v[16:19], v[168:171], v[160:163], v[16:19]
    ds_read_b128 v[204:207], v11 offset:0
    v_mfma_f32_16x16x32_bf16 v[20:23], v[168:171], v[164:167], v[20:23]
    ds_read_b128 v[208:211], v11 offset:2048
    v_exp_f32 v253, v253
    v_mfma_f32_16x16x32_bf16 v[24:27], v[172:175], v[160:163], v[24:27]
    ds_read_b128 v[212:215], v2 offset:9216
    v_exp_f32 v254, v254
    v_mfma_f32_16x16x32_bf16 v[28:31], v[172:175], v[164:167], v[28:31]
    ds_read_b128 v[216:219], v2 offset:10240
    v_exp_f32 v255, v255
    v_mfma_f32_16x16x32_bf16 v[32:35], v[176:179], v[160:163], v[32:35]
    ds_read_b128 v[220:223], v2 offset:11264
    v_fma_f32 v12, v12, v249, v249
    v_mfma_f32_16x16x32_bf16 v[36:39], v[176:179], v[164:167], v[36:39]
    ds_read_b128 v[224:227], v2 offset:12288
    v_fma_f32 v13, v13, v249, v249
    v_mfma_f32_16x16x32_bf16 v[40:43], v[180:183], v[160:163], v[40:43]
    ds_read_b128 v[228:231], v2 offset:13312
    v_fma_f32 v14, v14, v249, v249
    v_mfma_f32_16x16x32_bf16 v[44:47], v[180:183], v[164:167], v[44:47]
    ds_read_b128 v[232:235], v2 offset:14336
    s_waitcnt lgkmcnt(8)
    v_mfma_f32_16x16x32_bf16 v[48:51], v[184:187], v[160:163], v[48:51]
    ds_read_b128 v[236:239], v2 offset:15360
    v_fma_f32 v15, v15, v249, v249
    v_mfma_f32_16x16x32_bf16 v[52:55], v[184:187], v[164:167], v[52:55]
    ds_read_b128 v[240:243], v2 offset:16384
    v_fma_f32 v252, v252, v251, v251
    v_mfma_f32_16x16x32_bf16 v[56:59], v[188:191], v[160:163], v[56:59]
    ds_read_b128 v[244:247], v2 offset:17408
    v_fma_f32 v253, v253, v251, v251
    v_mfma_f32_16x16x32_bf16 v[60:63], v[188:191], v[164:167], v[60:63]
    v_fma_f32 v254, v254, v251, v251
    v_fma_f32 v255, v255, v251, v251
    v_mfma_f32_16x16x32_bf16 v[64:67], v[192:195], v[160:163], v[64:67]
    v_rcp_f32 v12, v12
    v_mfma_f32_16x16x32_bf16 v[68:71], v[192:195], v[164:167], v[68:71]
    v_rcp_f32 v13, v13
    v_mfma_f32_16x16x32_bf16 v[72:75], v[196:199], v[160:163], v[72:75]
    v_rcp_f32 v14, v14
    v_mfma_f32_16x16x32_bf16 v[76:79], v[196:199], v[164:167], v[76:79]
    v_rcp_f32 v15, v15
    v_mfma_f32_16x16x32_bf16 v[80:83], v[200:203], v[160:163], v[80:83]
    v_rcp_f32 v252, v252
    v_mfma_f32_16x16x32_bf16 v[84:87], v[200:203], v[164:167], v[84:87]
    v_rcp_f32 v253, v253
    s_waitcnt lgkmcnt(0)
    s_barrier
    v_mfma_f32_16x16x32_bf16 v[16:19], v[212:215], v[204:207], v[16:19]
    ds_read_b128 v[160:163], v10 offset:36864
    v_mfma_f32_16x16x32_bf16 v[20:23], v[212:215], v[208:211], v[20:23]
    ds_read_b128 v[164:167], v10 offset:38912
    v_rcp_f32 v254, v254
    v_mfma_f32_16x16x32_bf16 v[24:27], v[216:219], v[204:207], v[24:27]
    ds_read_b128 v[168:171], v2 offset:36864
    v_rcp_f32 v255, v255
    v_mfma_f32_16x16x32_bf16 v[28:31], v[216:219], v[208:211], v[28:31]
    ds_read_b128 v[172:175], v2 offset:37888
    v_mul_f32 v136, v136, v12
    v_mfma_f32_16x16x32_bf16 v[32:35], v[220:223], v[204:207], v[32:35]
    ds_read_b128 v[176:179], v2 offset:38912
    v_mul_f32 v137, v137, v13
    v_mfma_f32_16x16x32_bf16 v[36:39], v[220:223], v[208:211], v[36:39]
    ds_read_b128 v[180:183], v2 offset:39936
    v_mul_f32 v138, v138, v14
    v_mfma_f32_16x16x32_bf16 v[40:43], v[224:227], v[204:207], v[40:43]
    ds_read_b128 v[184:187], v2 offset:40960
    v_mul_f32 v139, v139, v15
    v_mfma_f32_16x16x32_bf16 v[44:47], v[224:227], v[208:211], v[44:47]
    ds_read_b128 v[188:191], v2 offset:41984
    v_mfma_f32_16x16x32_bf16 v[48:51], v[228:231], v[204:207], v[48:51]
    ds_read_b128 v[192:195], v2 offset:43008
    v_mul_f32 v140, v140, v252
    v_mfma_f32_16x16x32_bf16 v[52:55], v[228:231], v[208:211], v[52:55]
    ds_read_b128 v[196:199], v2 offset:44032
    v_mul_f32 v141, v141, v253
    v_mfma_f32_16x16x32_bf16 v[56:59], v[232:235], v[204:207], v[56:59]
    ds_read_b128 v[200:203], v2 offset:45056
    v_mul_f32 v142, v142, v254
    v_mfma_f32_16x16x32_bf16 v[60:63], v[232:235], v[208:211], v[60:63]
    v_mul_f32 v143, v143, v255
    v_mul_f32 v12, v144, v144
    v_mfma_f32_16x16x32_bf16 v[64:67], v[236:239], v[204:207], v[64:67]
    v_mul_f32 v13, v145, v145
    v_mul_f32 v14, v146, v146
    v_mfma_f32_16x16x32_bf16 v[68:71], v[236:239], v[208:211], v[68:71]
    v_mul_f32 v15, v147, v147
    v_mul_f32 v252, v148, v148
    v_mfma_f32_16x16x32_bf16 v[72:75], v[240:243], v[204:207], v[72:75]
    v_mul_f32 v253, v149, v149
    v_mul_f32 v254, v150, v150
    v_mfma_f32_16x16x32_bf16 v[76:79], v[240:243], v[208:211], v[76:79]
    v_mul_f32 v255, v151, v151
    v_fma_f32 v12, v12, v5, v4
    v_mfma_f32_16x16x32_bf16 v[80:83], v[244:247], v[204:207], v[80:83]
    v_fma_f32 v13, v13, v5, v4
    v_fma_f32 v14, v14, v5, v4
    v_mfma_f32_16x16x32_bf16 v[84:87], v[244:247], v[208:211], v[84:87]
    v_fma_f32 v15, v15, v5, v4
    s_waitcnt lgkmcnt(5)
    v_mfma_f32_16x16x32_bf16 v[16:19], v[168:171], v[160:163], v[16:19]
    ds_read_b128 v[204:207], v11 offset:36864
    v_mfma_f32_16x16x32_bf16 v[20:23], v[168:171], v[164:167], v[20:23]
    ds_read_b128 v[208:211], v11 offset:38912
    v_fma_f32 v252, v252, v7, v6
    v_mfma_f32_16x16x32_bf16 v[24:27], v[172:175], v[160:163], v[24:27]
    ds_read_b128 v[212:215], v2 offset:46080
    v_fma_f32 v253, v253, v7, v6
    v_mfma_f32_16x16x32_bf16 v[28:31], v[172:175], v[164:167], v[28:31]
    ds_read_b128 v[216:219], v2 offset:47104
    v_fma_f32 v254, v254, v7, v6
    v_mfma_f32_16x16x32_bf16 v[32:35], v[176:179], v[160:163], v[32:35]
    ds_read_b128 v[220:223], v2 offset:48128
    v_fma_f32 v255, v255, v7, v6
    v_mfma_f32_16x16x32_bf16 v[36:39], v[176:179], v[164:167], v[36:39]
    ds_read_b128 v[224:227], v2 offset:49152
    v_mul_f32 v12, v12, v144
    v_mfma_f32_16x16x32_bf16 v[40:43], v[180:183], v[160:163], v[40:43]
    ds_read_b128 v[228:231], v2 offset:50176
    v_mul_f32 v13, v13, v145
    v_mfma_f32_16x16x32_bf16 v[44:47], v[180:183], v[164:167], v[44:47]
    ds_read_b128 v[232:235], v2 offset:51200
    s_waitcnt lgkmcnt(8)
    v_mfma_f32_16x16x32_bf16 v[48:51], v[184:187], v[160:163], v[48:51]
    ds_read_b128 v[236:239], v2 offset:52224
    v_mul_f32 v14, v14, v146
    v_mfma_f32_16x16x32_bf16 v[52:55], v[184:187], v[164:167], v[52:55]
    ds_read_b128 v[240:243], v2 offset:53248
    v_mul_f32 v15, v15, v147
    v_mfma_f32_16x16x32_bf16 v[56:59], v[188:191], v[160:163], v[56:59]
    ds_read_b128 v[244:247], v2 offset:54272
    v_mul_f32 v252, v252, v148
    v_mfma_f32_16x16x32_bf16 v[60:63], v[188:191], v[164:167], v[60:63]
    v_mul_f32 v253, v253, v149
    v_mul_f32 v254, v254, v150
    v_mfma_f32_16x16x32_bf16 v[64:67], v[192:195], v[160:163], v[64:67]
    v_mul_f32 v255, v255, v151
    v_exp_f32 v12, v12
    v_mfma_f32_16x16x32_bf16 v[68:71], v[192:195], v[164:167], v[68:71]
    v_exp_f32 v13, v13
    v_mfma_f32_16x16x32_bf16 v[72:75], v[196:199], v[160:163], v[72:75]
    v_exp_f32 v14, v14
    v_mfma_f32_16x16x32_bf16 v[76:79], v[196:199], v[164:167], v[76:79]
    v_exp_f32 v15, v15
    v_mfma_f32_16x16x32_bf16 v[80:83], v[200:203], v[160:163], v[80:83]
    v_exp_f32 v252, v252
    v_mfma_f32_16x16x32_bf16 v[84:87], v[200:203], v[164:167], v[84:87]
    v_exp_f32 v253, v253
    s_waitcnt lgkmcnt(0)
    s_barrier
    v_mfma_f32_16x16x32_bf16 v[16:19], v[212:215], v[204:207], v[16:19]
    ds_read_b128 v[160:163], v8 offset:0
    v_mfma_f32_16x16x32_bf16 v[20:23], v[212:215], v[208:211], v[20:23]
    ds_read_b128 v[164:167], v8 offset:2048
    v_exp_f32 v254, v254
    v_mfma_f32_16x16x32_bf16 v[24:27], v[216:219], v[204:207], v[24:27]
    ds_read_b128 v[168:171], v1 offset:0
    v_exp_f32 v255, v255
    v_mfma_f32_16x16x32_bf16 v[28:31], v[216:219], v[208:211], v[28:31]
    ds_read_b128 v[172:175], v1 offset:1024
    v_fma_f32 v12, v12, v249, v249
    v_mfma_f32_16x16x32_bf16 v[32:35], v[220:223], v[204:207], v[32:35]
    ds_read_b128 v[176:179], v1 offset:2048
    v_fma_f32 v13, v13, v249, v249
    v_mfma_f32_16x16x32_bf16 v[36:39], v[220:223], v[208:211], v[36:39]
    ds_read_b128 v[180:183], v1 offset:3072
    v_fma_f32 v14, v14, v249, v249
    v_mfma_f32_16x16x32_bf16 v[40:43], v[224:227], v[204:207], v[40:43]
    ds_read_b128 v[184:187], v1 offset:4096
    v_fma_f32 v15, v15, v249, v249
    v_mfma_f32_16x16x32_bf16 v[44:47], v[224:227], v[208:211], v[44:47]
    ds_read_b128 v[188:191], v1 offset:5120
    v_mfma_f32_16x16x32_bf16 v[48:51], v[228:231], v[204:207], v[48:51]
    ds_read_b128 v[192:195], v1 offset:6144
    v_fma_f32 v252, v252, v251, v251
    v_mfma_f32_16x16x32_bf16 v[52:55], v[228:231], v[208:211], v[52:55]
    ds_read_b128 v[196:199], v1 offset:7168
    v_fma_f32 v253, v253, v251, v251
    v_mfma_f32_16x16x32_bf16 v[56:59], v[232:235], v[204:207], v[56:59]
    ds_read_b128 v[200:203], v1 offset:8192
    v_fma_f32 v254, v254, v251, v251
    v_mfma_f32_16x16x32_bf16 v[60:63], v[232:235], v[208:211], v[60:63]
    v_fma_f32 v255, v255, v251, v251
    v_rcp_f32 v12, v12
    v_mfma_f32_16x16x32_bf16 v[64:67], v[236:239], v[204:207], v[64:67]
    v_rcp_f32 v13, v13
    v_mfma_f32_16x16x32_bf16 v[68:71], v[236:239], v[208:211], v[68:71]
    v_rcp_f32 v14, v14
    v_mfma_f32_16x16x32_bf16 v[72:75], v[240:243], v[204:207], v[72:75]
    v_rcp_f32 v15, v15
    v_mfma_f32_16x16x32_bf16 v[76:79], v[240:243], v[208:211], v[76:79]
    v_rcp_f32 v252, v252
    v_mfma_f32_16x16x32_bf16 v[80:83], v[244:247], v[204:207], v[80:83]
    v_rcp_f32 v253, v253
    v_mfma_f32_16x16x32_bf16 v[84:87], v[244:247], v[208:211], v[84:87]
    v_rcp_f32 v254, v254
    s_waitcnt lgkmcnt(5)
    v_mfma_f32_16x16x32_bf16 v[16:19], v[168:171], v[160:163], v[16:19]
    ds_read_b128 v[204:207], v9 offset:0
    v_mfma_f32_16x16x32_bf16 v[20:23], v[168:171], v[164:167], v[20:23]
    ds_read_b128 v[208:211], v9 offset:2048
    v_rcp_f32 v255, v255
    v_mfma_f32_16x16x32_bf16 v[24:27], v[172:175], v[160:163], v[24:27]
    ds_read_b128 v[212:215], v1 offset:9216
    v_mul_f32 v144, v144, v12
    v_mfma_f32_16x16x32_bf16 v[28:31], v[172:175], v[164:167], v[28:31]
    ds_read_b128 v[216:219], v1 offset:10240
    v_mul_f32 v145, v145, v13
    v_mfma_f32_16x16x32_bf16 v[32:35], v[176:179], v[160:163], v[32:35]
    ds_read_b128 v[220:223], v1 offset:11264
    v_mul_f32 v146, v146, v14
    v_mfma_f32_16x16x32_bf16 v[36:39], v[176:179], v[164:167], v[36:39]
    ds_read_b128 v[224:227], v1 offset:12288
    v_mul_f32 v147, v147, v15
    v_mfma_f32_16x16x32_bf16 v[40:43], v[180:183], v[160:163], v[40:43]
    ds_read_b128 v[228:231], v1 offset:13312
    v_mul_f32 v148, v148, v252
    v_mfma_f32_16x16x32_bf16 v[44:47], v[180:183], v[164:167], v[44:47]
    ds_read_b128 v[232:235], v1 offset:14336
    s_waitcnt lgkmcnt(8)
    v_mfma_f32_16x16x32_bf16 v[48:51], v[184:187], v[160:163], v[48:51]
    ds_read_b128 v[236:239], v1 offset:15360
    v_mul_f32 v149, v149, v253
    v_mfma_f32_16x16x32_bf16 v[52:55], v[184:187], v[164:167], v[52:55]
    ds_read_b128 v[240:243], v1 offset:16384
    v_mul_f32 v150, v150, v254
    v_mfma_f32_16x16x32_bf16 v[56:59], v[188:191], v[160:163], v[56:59]
    ds_read_b128 v[244:247], v1 offset:17408
    v_mul_f32 v151, v151, v255
    v_mfma_f32_16x16x32_bf16 v[60:63], v[188:191], v[164:167], v[60:63]
    v_mul_f32 v12, v152, v152
    v_mul_f32 v13, v153, v153
    v_mfma_f32_16x16x32_bf16 v[64:67], v[192:195], v[160:163], v[64:67]
    v_mul_f32 v14, v154, v154
    v_mul_f32 v15, v155, v155
    v_mfma_f32_16x16x32_bf16 v[68:71], v[192:195], v[164:167], v[68:71]
    v_mul_f32 v252, v156, v156
    v_mul_f32 v253, v157, v157
    v_mfma_f32_16x16x32_bf16 v[72:75], v[196:199], v[160:163], v[72:75]
    v_mul_f32 v254, v158, v158
    v_mul_f32 v255, v159, v159
    v_mfma_f32_16x16x32_bf16 v[76:79], v[196:199], v[164:167], v[76:79]
    v_fma_f32 v12, v12, v5, v4
    v_fma_f32 v13, v13, v5, v4
    v_mfma_f32_16x16x32_bf16 v[80:83], v[200:203], v[160:163], v[80:83]
    v_fma_f32 v14, v14, v5, v4
    v_fma_f32 v15, v15, v5, v4
    v_mfma_f32_16x16x32_bf16 v[84:87], v[200:203], v[164:167], v[84:87]
    v_fma_f32 v252, v252, v7, v6
    s_waitcnt lgkmcnt(0)
    s_barrier
    v_mfma_f32_16x16x32_bf16 v[16:19], v[212:215], v[204:207], v[16:19]
    ds_read_b128 v[160:163], v8 offset:36864
    v_mfma_f32_16x16x32_bf16 v[20:23], v[212:215], v[208:211], v[20:23]
    ds_read_b128 v[164:167], v8 offset:38912
    v_fma_f32 v253, v253, v7, v6
    v_mfma_f32_16x16x32_bf16 v[24:27], v[216:219], v[204:207], v[24:27]
    ds_read_b128 v[168:171], v1 offset:36864
    v_fma_f32 v254, v254, v7, v6
    v_mfma_f32_16x16x32_bf16 v[28:31], v[216:219], v[208:211], v[28:31]
    ds_read_b128 v[172:175], v1 offset:37888
    v_fma_f32 v255, v255, v7, v6
    v_mfma_f32_16x16x32_bf16 v[32:35], v[220:223], v[204:207], v[32:35]
    ds_read_b128 v[176:179], v1 offset:38912
    v_mul_f32 v12, v12, v152
    v_mfma_f32_16x16x32_bf16 v[36:39], v[220:223], v[208:211], v[36:39]
    ds_read_b128 v[180:183], v1 offset:39936
    v_mul_f32 v13, v13, v153
    v_mfma_f32_16x16x32_bf16 v[40:43], v[224:227], v[204:207], v[40:43]
    ds_read_b128 v[184:187], v1 offset:40960
    v_mul_f32 v14, v14, v154
    v_mfma_f32_16x16x32_bf16 v[44:47], v[224:227], v[208:211], v[44:47]
    ds_read_b128 v[188:191], v1 offset:41984
    v_mfma_f32_16x16x32_bf16 v[48:51], v[228:231], v[204:207], v[48:51]
    ds_read_b128 v[192:195], v1 offset:43008
    v_mul_f32 v15, v15, v155
    v_mfma_f32_16x16x32_bf16 v[52:55], v[228:231], v[208:211], v[52:55]
    ds_read_b128 v[196:199], v1 offset:44032
    v_mul_f32 v252, v252, v156
    v_mfma_f32_16x16x32_bf16 v[56:59], v[232:235], v[204:207], v[56:59]
    ds_read_b128 v[200:203], v1 offset:45056
    v_mul_f32 v253, v253, v157
    v_mfma_f32_16x16x32_bf16 v[60:63], v[232:235], v[208:211], v[60:63]
    v_mul_f32 v254, v254, v158
    v_mul_f32 v255, v255, v159
    v_mfma_f32_16x16x32_bf16 v[64:67], v[236:239], v[204:207], v[64:67]
    v_exp_f32 v12, v12
    v_mfma_f32_16x16x32_bf16 v[68:71], v[236:239], v[208:211], v[68:71]
    v_exp_f32 v13, v13
    v_mfma_f32_16x16x32_bf16 v[72:75], v[240:243], v[204:207], v[72:75]
    v_exp_f32 v14, v14
    v_mfma_f32_16x16x32_bf16 v[76:79], v[240:243], v[208:211], v[76:79]
    v_exp_f32 v15, v15
    v_mfma_f32_16x16x32_bf16 v[80:83], v[244:247], v[204:207], v[80:83]
    v_exp_f32 v252, v252
    v_mfma_f32_16x16x32_bf16 v[84:87], v[244:247], v[208:211], v[84:87]
    v_exp_f32 v253, v253
    s_waitcnt lgkmcnt(5)
    v_mfma_f32_16x16x32_bf16 v[16:19], v[168:171], v[160:163], v[16:19]
    ds_read_b128 v[204:207], v9 offset:36864
    v_mfma_f32_16x16x32_bf16 v[20:23], v[168:171], v[164:167], v[20:23]
    ds_read_b128 v[208:211], v9 offset:38912
    v_exp_f32 v254, v254
    v_mfma_f32_16x16x32_bf16 v[24:27], v[172:175], v[160:163], v[24:27]
    ds_read_b128 v[212:215], v1 offset:46080
    v_exp_f32 v255, v255
    v_mfma_f32_16x16x32_bf16 v[28:31], v[172:175], v[164:167], v[28:31]
    ds_read_b128 v[216:219], v1 offset:47104
    v_fma_f32 v12, v12, v249, v249
    v_mfma_f32_16x16x32_bf16 v[32:35], v[176:179], v[160:163], v[32:35]
    ds_read_b128 v[220:223], v1 offset:48128
    v_fma_f32 v13, v13, v249, v249
    v_mfma_f32_16x16x32_bf16 v[36:39], v[176:179], v[164:167], v[36:39]
    ds_read_b128 v[224:227], v1 offset:49152
    v_fma_f32 v14, v14, v249, v249
    v_mfma_f32_16x16x32_bf16 v[40:43], v[180:183], v[160:163], v[40:43]
    ds_read_b128 v[228:231], v1 offset:50176
    v_fma_f32 v15, v15, v249, v249
    v_mfma_f32_16x16x32_bf16 v[44:47], v[180:183], v[164:167], v[44:47]
    ds_read_b128 v[232:235], v1 offset:51200
    s_waitcnt lgkmcnt(8)
    v_mfma_f32_16x16x32_bf16 v[48:51], v[184:187], v[160:163], v[48:51]
    ds_read_b128 v[236:239], v1 offset:52224
    v_fma_f32 v252, v252, v251, v251
    v_mfma_f32_16x16x32_bf16 v[52:55], v[184:187], v[164:167], v[52:55]
    ds_read_b128 v[240:243], v1 offset:53248
    v_fma_f32 v253, v253, v251, v251
    v_mfma_f32_16x16x32_bf16 v[56:59], v[188:191], v[160:163], v[56:59]
    ds_read_b128 v[244:247], v1 offset:54272
    v_fma_f32 v254, v254, v251, v251
    v_mfma_f32_16x16x32_bf16 v[60:63], v[188:191], v[164:167], v[60:63]
    v_fma_f32 v255, v255, v251, v251
    v_rcp_f32 v12, v12
    v_mfma_f32_16x16x32_bf16 v[64:67], v[192:195], v[160:163], v[64:67]
    v_rcp_f32 v13, v13
    v_mfma_f32_16x16x32_bf16 v[68:71], v[192:195], v[164:167], v[68:71]
    v_rcp_f32 v14, v14
    v_mfma_f32_16x16x32_bf16 v[72:75], v[196:199], v[160:163], v[72:75]
    v_rcp_f32 v15, v15
    v_mfma_f32_16x16x32_bf16 v[76:79], v[196:199], v[164:167], v[76:79]
    v_rcp_f32 v252, v252
    v_mfma_f32_16x16x32_bf16 v[80:83], v[200:203], v[160:163], v[80:83]
    v_rcp_f32 v253, v253
    v_mfma_f32_16x16x32_bf16 v[84:87], v[200:203], v[164:167], v[84:87]
    v_rcp_f32 v254, v254
    s_waitcnt lgkmcnt(0)
    s_barrier
    v_mfma_f32_16x16x32_bf16 v[16:19], v[212:215], v[204:207], v[16:19]
    ds_read_b128 v[160:163], v10 offset:0
    v_mfma_f32_16x16x32_bf16 v[20:23], v[212:215], v[208:211], v[20:23]
    ds_read_b128 v[164:167], v10 offset:2048
    v_rcp_f32 v255, v255
    v_mfma_f32_16x16x32_bf16 v[24:27], v[216:219], v[204:207], v[24:27]
    ds_read_b128 v[168:171], v2 offset:0
    v_mul_f32 v152, v152, v12
    v_mfma_f32_16x16x32_bf16 v[28:31], v[216:219], v[208:211], v[28:31]
    ds_read_b128 v[172:175], v2 offset:1024
    v_mul_f32 v153, v153, v13
    v_mfma_f32_16x16x32_bf16 v[32:35], v[220:223], v[204:207], v[32:35]
    ds_read_b128 v[176:179], v2 offset:2048
    v_mul_f32 v154, v154, v14
    v_mfma_f32_16x16x32_bf16 v[36:39], v[220:223], v[208:211], v[36:39]
    ds_read_b128 v[180:183], v2 offset:3072
    v_mul_f32 v155, v155, v15
    v_mfma_f32_16x16x32_bf16 v[40:43], v[224:227], v[204:207], v[40:43]
    ds_read_b128 v[184:187], v2 offset:4096
    v_mul_f32 v156, v156, v252
    v_mfma_f32_16x16x32_bf16 v[44:47], v[224:227], v[208:211], v[44:47]
    ds_read_b128 v[188:191], v2 offset:5120
    v_mfma_f32_16x16x32_bf16 v[48:51], v[228:231], v[204:207], v[48:51]
    ds_read_b128 v[192:195], v2 offset:6144
    v_mul_f32 v157, v157, v253
    v_mfma_f32_16x16x32_bf16 v[52:55], v[228:231], v[208:211], v[52:55]
    ds_read_b128 v[196:199], v2 offset:7168
    v_mul_f32 v158, v158, v254
    v_mfma_f32_16x16x32_bf16 v[56:59], v[232:235], v[204:207], v[56:59]
    ds_read_b128 v[200:203], v2 offset:8192
    v_mul_f32 v159, v159, v255
    v_mfma_f32_16x16x32_bf16 v[60:63], v[232:235], v[208:211], v[60:63]
    s_mul_i32 s36, s31, 73728
    s_add_u32 s36, s36, s21
    v_mfma_f32_16x16x32_bf16 v[64:67], v[236:239], v[204:207], v[64:67]
    s_lshl_b32 s34, s24, 10
    s_lshl_b32 s35, s24, 9
    v_mfma_f32_16x16x32_bf16 v[68:71], v[236:239], v[208:211], v[68:71]
    s_add_u32 s35, s35, 65536
    v_add_u32 v14, s34, v1
    v_mfma_f32_16x16x32_bf16 v[72:75], v[240:243], v[204:207], v[72:75]
    v_lshrrev_b32 v15, 1, v1
    v_add_u32 v15, s35, v15
    v_mfma_f32_16x16x32_bf16 v[76:79], v[240:243], v[208:211], v[76:79]
    s_add_u32 s39, s36, 0x1200000
    s_add_u32 s40, s36, 0x1212000
    v_mfma_f32_16x16x32_bf16 v[80:83], v[244:247], v[204:207], v[80:83]
    v_mfma_f32_16x16x32_bf16 v[84:87], v[244:247], v[208:211], v[84:87]
    s_mov_b32 s41, 5
    .p2align 6
L_g_loop:
    s_waitcnt lgkmcnt(5)
    v_mfma_f32_16x16x32_bf16 v[16:19], v[168:171], v[160:163], v[16:19]
    ds_read_b128 v[204:207], v11 offset:0
    v_mfma_f32_16x16x32_bf16 v[20:23], v[168:171], v[164:167], v[20:23]
    ds_read_b128 v[208:211], v11 offset:2048
    v_mfma_f32_16x16x32_bf16 v[24:27], v[172:175], v[160:163], v[24:27]
    ds_read_b128 v[212:215], v2 offset:9216
    v_mfma_f32_16x16x32_bf16 v[28:31], v[172:175], v[164:167], v[28:31]
    ds_read_b128 v[216:219], v2 offset:10240
    v_mfma_f32_16x16x32_bf16 v[32:35], v[176:179], v[160:163], v[32:35]
    ds_read_b128 v[220:223], v2 offset:11264
    v_mfma_f32_16x16x32_bf16 v[36:39], v[176:179], v[164:167], v[36:39]
    ds_read_b128 v[224:227], v2 offset:12288
    v_mfma_f32_16x16x32_bf16 v[40:43], v[180:183], v[160:163], v[40:43]
    ds_read_b128 v[228:231], v2 offset:13312
    v_mfma_f32_16x16x32_bf16 v[44:47], v[180:183], v[164:167], v[44:47]
    ds_read_b128 v[232:235], v2 offset:14336
    s_waitcnt lgkmcnt(8)
    v_mfma_f32_16x16x32_bf16 v[48:51], v[184:187], v[160:163], v[48:51]
    ds_read_b128 v[236:239], v2 offset:15360
    v_mfma_f32_16x16x32_bf16 v[52:55], v[184:187], v[164:167], v[52:55]
    ds_read_b128 v[240:243], v2 offset:16384
    v_mfma_f32_16x16x32_bf16 v[56:59], v[188:191], v[160:163], v[56:59]
    ds_read_b128 v[244:247], v2 offset:17408
    v_mfma_f32_16x16x32_bf16 v[60:63], v[188:191], v[164:167], v[60:63]
    v_mfma_f32_16x16x32_bf16 v[64:67], v[192:195], v[160:163], v[64:67]
    v_mfma_f32_16x16x32_bf16 v[68:71], v[192:195], v[164:167], v[68:71]
    v_mfma_f32_16x16x32_bf16 v[72:75], v[196:199], v[160:163], v[72:75]
    v_mfma_f32_16x16x32_bf16 v[76:79], v[196:199], v[164:167], v[76:79]
    v_mfma_f32_16x16x32_bf16 v[80:83], v[200:203], v[160:163], v[80:83]
    v_mfma_f32_16x16x32_bf16 v[84:87], v[200:203], v[164:167], v[84:87]
    s_waitcnt lgkmcnt(0)
    s_barrier
    v_mfma_f32_16x16x32_bf16 v[16:19], v[212:215], v[204:207], v[16:19]
    ds_read_b128 v[160:163], v10 offset:36864
    v_mfma_f32_16x16x32_bf16 v[20:23], v[212:215], v[208:211], v[20:23]
    ds_read_b128 v[164:167], v10 offset:38912
    v_mfma_f32_16x16x32_bf16 v[24:27], v[216:219], v[204:207], v[24:27]
    ds_read_b128 v[168:171], v2 offset:36864
    v_mfma_f32_16x16x32_bf16 v[28:31], v[216:219], v[208:211], v[28:31]
    ds_read_b128 v[172:175], v2 offset:37888
    v_mfma_f32_16x16x32_bf16 v[32:35], v[220:223], v[204:207], v[32:35]
    ds_read_b128 v[176:179], v2 offset:38912
    v_mfma_f32_16x16x32_bf16 v[36:39], v[220:223], v[208:211], v[36:39]
    ds_read_b128 v[180:183], v2 offset:39936
    v_mfma_f32_16x16x32_bf16 v[40:43], v[224:227], v[204:207], v[40:43]
    ds_read_b128 v[184:187], v2 offset:40960
    v_mfma_f32_16x16x32_bf16 v[44:47], v[224:227], v[208:211], v[44:47]
    ds_read_b128 v[188:191], v2 offset:41984
    v_mfma_f32_16x16x32_bf16 v[48:51], v[228:231], v[204:207], v[48:51]
    ds_read_b128 v[192:195], v2 offset:43008
    v_mfma_f32_16x16x32_bf16 v[52:55], v[228:231], v[208:211], v[52:55]
    ds_read_b128 v[196:199], v2 offset:44032
    v_mfma_f32_16x16x32_bf16 v[56:59], v[232:235], v[204:207], v[56:59]
    ds_read_b128 v[200:203], v2 offset:45056
    v_mfma_f32_16x16x32_bf16 v[60:63], v[232:235], v[208:211], v[60:63]
    v_mfma_f32_16x16x32_bf16 v[64:67], v[236:239], v[204:207], v[64:67]
    v_mfma_f32_16x16x32_bf16 v[68:71], v[236:239], v[208:211], v[68:71]
    v_mfma_f32_16x16x32_bf16 v[72:75], v[240:243], v[204:207], v[72:75]
    v_mfma_f32_16x16x32_bf16 v[76:79], v[240:243], v[208:211], v[76:79]
    v_mfma_f32_16x16x32_bf16 v[80:83], v[244:247], v[204:207], v[80:83]
    v_mfma_f32_16x16x32_bf16 v[84:87], v[244:247], v[208:211], v[84:87]
    s_waitcnt lgkmcnt(5)
    v_mfma_f32_16x16x32_bf16 v[16:19], v[168:171], v[160:163], v[16:19]
    ds_read_b128 v[204:207], v11 offset:36864
    v_mfma_f32_16x16x32_bf16 v[20:23], v[168:171], v[164:167], v[20:23]
    ds_read_b128 v[208:211], v11 offset:38912
    v_mfma_f32_16x16x32_bf16 v[24:27], v[172:175], v[160:163], v[24:27]
    ds_read_b128 v[212:215], v2 offset:46080
    v_mfma_f32_16x16x32_bf16 v[28:31], v[172:175], v[164:167], v[28:31]
    ds_read_b128 v[216:219], v2 offset:47104
    v_mfma_f32_16x16x32_bf16 v[32:35], v[176:179], v[160:163], v[32:35]
    ds_read_b128 v[220:223], v2 offset:48128
    v_mfma_f32_16x16x32_bf16 v[36:39], v[176:179], v[164:167], v[36:39]
    ds_read_b128 v[224:227], v2 offset:49152
    v_mfma_f32_16x16x32_bf16 v[40:43], v[180:183], v[160:163], v[40:43]
    ds_read_b128 v[228:231], v2 offset:50176
    v_mfma_f32_16x16x32_bf16 v[44:47], v[180:183], v[164:167], v[44:47]
    ds_read_b128 v[232:235], v2 offset:51200
    s_waitcnt lgkmcnt(8)
    v_mfma_f32_16x16x32_bf16 v[48:51], v[184:187], v[160:163], v[48:51]
    ds_read_b128 v[236:239], v2 offset:52224
    v_mfma_f32_16x16x32_bf16 v[52:55], v[184:187], v[164:167], v[52:55]
    ds_read_b128 v[240:243], v2 offset:53248
    v_mfma_f32_16x16x32_bf16 v[56:59], v[188:191], v[160:163], v[56:59]
    ds_read_b128 v[244:247], v2 offset:54272
    v_mfma_f32_16x16x32_bf16 v[60:63], v[188:191], v[164:167], v[60:63]
    v_mfma_f32_16x16x32_bf16 v[64:67], v[192:195], v[160:163], v[64:67]
    v_mfma_f32_16x16x32_bf16 v[68:71], v[192:195], v[164:167], v[68:71]
    v_mfma_f32_16x16x32_bf16 v[72:75], v[196:199], v[160:163], v[72:75]
    v_mfma_f32_16x16x32_bf16 v[76:79], v[196:199], v[164:167], v[76:79]
    v_mfma_f32_16x16x32_bf16 v[80:83], v[200:203], v[160:163], v[80:83]
    v_mfma_f32_16x16x32_bf16 v[84:87], v[200:203], v[164:167], v[84:87]
    s_waitcnt lgkmcnt(0)
    s_barrier
    v_mfma_f32_16x16x32_bf16 v[16:19], v[212:215], v[204:207], v[16:19]
    ds_read_b128 v[160:163], v8 offset:0
    v_mfma_f32_16x16x32_bf16 v[20:23], v[212:215], v[208:211], v[20:23]
    ds_read_b128 v[164:167], v8 offset:2048
    v_mfma_f32_16x16x32_bf16 v[24:27], v[216:219], v[204:207], v[24:27]
    ds_read_b128 v[168:171], v1 offset:0
    v_mfma_f32_16x16x32_bf16 v[28:31], v[216:219], v[208:211], v[28:31]
    ds_read_b128 v[172:175], v1 offset:1024
    v_mfma_f32_16x16x32_bf16 v[32:35], v[220:223], v[204:207], v[32:35]
    ds_read_b128 v[176:179], v1 offset:2048
    v_mfma_f32_16x16x32_bf16 v[36:39], v[220:223], v[208:211], v[36:39]
    ds_read_b128 v[180:183], v1 offset:3072
    v_mfma_f32_16x16x32_bf16 v[40:43], v[224:227], v[204:207], v[40:43]
    ds_read_b128 v[184:187], v1 offset:4096
    v_mfma_f32_16x16x32_bf16 v[44:47], v[224:227], v[208:211], v[44:47]
    ds_read_b128 v[188:191], v1 offset:5120
    v_mfma_f32_16x16x32_bf16 v[48:51], v[228:231], v[204:207], v[48:51]
    ds_read_b128 v[192:195], v1 offset:6144
    v_mfma_f32_16x16x32_bf16 v[52:55], v[228:231], v[208:211], v[52:55]
    ds_read_b128 v[196:199], v1 offset:7168
    v_mfma_f32_16x16x32_bf16 v[56:59], v[232:235], v[204:207], v[56:59]
    ds_read_b128 v[200:203], v1 offset:8192
    v_mfma_f32_16x16x32_bf16 v[60:63], v[232:235], v[208:211], v[60:63]
    v_mfma_f32_16x16x32_bf16 v[64:67], v[236:239], v[204:207], v[64:67]
    v_mfma_f32_16x16x32_bf16 v[68:71], v[236:239], v[208:211], v[68:71]
    v_mfma_f32_16x16x32_bf16 v[72:75], v[240:243], v[204:207], v[72:75]
    v_mfma_f32_16x16x32_bf16 v[76:79], v[240:243], v[208:211], v[76:79]
    v_mfma_f32_16x16x32_bf16 v[80:83], v[244:247], v[204:207], v[80:83]
    v_mfma_f32_16x16x32_bf16 v[84:87], v[244:247], v[208:211], v[84:87]
    s_waitcnt lgkmcnt(5)
    v_mfma_f32_16x16x32_bf16 v[16:19], v[168:171], v[160:163], v[16:19]
    ds_read_b128 v[204:207], v9 offset:0
    v_mfma_f32_16x16x32_bf16 v[20:23], v[168:171], v[164:167], v[20:23]
    ds_read_b128 v[208:211], v9 offset:2048
    v_mfma_f32_16x16x32_bf16 v[24:27], v[172:175], v[160:163], v[24:27]
    ds_read_b128 v[212:215], v1 offset:9216
    v_mfma_f32_16x16x32_bf16 v[28:31], v[172:175], v[164:167], v[28:31]
    ds_read_b128 v[216:219], v1 offset:10240
    v_mfma_f32_16x16x32_bf16 v[32:35], v[176:179], v[160:163], v[32:35]
    ds_read_b128 v[220:223], v1 offset:11264
    v_mfma_f32_16x16x32_bf16 v[36:39], v[176:179], v[164:167], v[36:39]
    ds_read_b128 v[224:227], v1 offset:12288
    v_mfma_f32_16x16x32_bf16 v[40:43], v[180:183], v[160:163], v[40:43]
    ds_read_b128 v[228:231], v1 offset:13312
    v_mfma_f32_16x16x32_bf16 v[44:47], v[180:183], v[164:167], v[44:47]
    ds_read_b128 v[232:235], v1 offset:14336
    s_waitcnt lgkmcnt(8)
    v_mfma_f32_16x16x32_bf16 v[48:51], v[184:187], v[160:163], v[48:51]
    ds_read_b128 v[236:239], v1 offset:15360
    v_mfma_f32_16x16x32_bf16 v[52:55], v[184:187], v[164:167], v[52:55]
    ds_read_b128 v[240:243], v1 offset:16384
    v_mfma_f32_16x16x32_bf16 v[56:59], v[188:191], v[160:163], v[56:59]
    ds_read_b128 v[244:247], v1 offset:17408
    v_mfma_f32_16x16x32_bf16 v[60:63], v[188:191], v[164:167], v[60:63]
    v_mfma_f32_16x16x32_bf16 v[64:67], v[192:195], v[160:163], v[64:67]
    v_mfma_f32_16x16x32_bf16 v[68:71], v[192:195], v[164:167], v[68:71]
    v_mfma_f32_16x16x32_bf16 v[72:75], v[196:199], v[160:163], v[72:75]
    v_mfma_f32_16x16x32_bf16 v[76:79], v[196:199], v[164:167], v[76:79]
    v_mfma_f32_16x16x32_bf16 v[80:83], v[200:203], v[160:163], v[80:83]
    v_mfma_f32_16x16x32_bf16 v[84:87], v[200:203], v[164:167], v[84:87]
    s_waitcnt lgkmcnt(0)
    s_barrier
    v_mfma_f32_16x16x32_bf16 v[16:19], v[212:215], v[204:207], v[16:19]
    ds_read_b128 v[160:163], v8 offset:36864
    v_mfma_f32_16x16x32_bf16 v[20:23], v[212:215], v[208:211], v[20:23]
    ds_read_b128 v[164:167], v8 offset:38912
    v_mfma_f32_16x16x32_bf16 v[24:27], v[216:219], v[204:207], v[24:27]
    ds_read_b128 v[168:171], v1 offset:36864
    v_mfma_f32_16x16x32_bf16 v[28:31], v[216:219], v[208:211], v[28:31]
    ds_read_b128 v[172:175], v1 offset:37888
    v_mfma_f32_16x16x32_bf16 v[32:35], v[220:223], v[204:207], v[32:35]
    ds_read_b128 v[176:179], v1 offset:38912
    v_mfma_f32_16x16x32_bf16 v[36:39], v[220:223], v[208:211], v[36:39]
    ds_read_b128 v[180:183], v1 offset:39936
    v_mfma_f32_16x16x32_bf16 v[40:43], v[224:227], v[204:207], v[40:43]
    ds_read_b128 v[184:187], v1 offset:40960
    v_mfma_f32_16x16x32_bf16 v[44:47], v[224:227], v[208:211], v[44:47]
    ds_read_b128 v[188:191], v1 offset:41984
    v_mfma_f32_16x16x32_bf16 v[48:51], v[228:231], v[204:207], v[48:51]
    ds_read_b128 v[192:195], v1 offset:43008
    v_mfma_f32_16x16x32_bf16 v[52:55], v[228:231], v[208:211], v[52:55]
    ds_read_b128 v[196:199], v1 offset:44032
    v_mfma_f32_16x16x32_bf16 v[56:59], v[232:235], v[204:207], v[56:59]
    ds_read_b128 v[200:203], v1 offset:45056
    v_mfma_f32_16x16x32_bf16 v[60:63], v[232:235], v[208:211], v[60:63]
    v_mfma_f32_16x16x32_bf16 v[64:67], v[236:239], v[204:207], v[64:67]
    v_mfma_f32_16x16x32_bf16 v[68:71], v[236:239], v[208:211], v[68:71]
    v_mfma_f32_16x16x32_bf16 v[72:75], v[240:243], v[204:207], v[72:75]
    v_mfma_f32_16x16x32_bf16 v[76:79], v[240:243], v[208:211], v[76:79]
    v_mfma_f32_16x16x32_bf16 v[80:83], v[244:247], v[204:207], v[80:83]
    v_mfma_f32_16x16x32_bf16 v[84:87], v[244:247], v[208:211], v[84:87]
    s_waitcnt lgkmcnt(5)
    v_mfma_f32_16x16x32_bf16 v[16:19], v[168:171], v[160:163], v[16:19]
    ds_read_b128 v[204:207], v9 offset:36864
    v_mfma_f32_16x16x32_bf16 v[20:23], v[168:171], v[164:167], v[20:23]
    ds_read_b128 v[208:211], v9 offset:38912
    v_mfma_f32_16x16x32_bf16 v[24:27], v[172:175], v[160:163], v[24:27]
    ds_read_b128 v[212:215], v1 offset:46080
    v_mfma_f32_16x16x32_bf16 v[28:31], v[172:175], v[164:167], v[28:31]
    ds_read_b128 v[216:219], v1 offset:47104
    v_mfma_f32_16x16x32_bf16 v[32:35], v[176:179], v[160:163], v[32:35]
    ds_read_b128 v[220:223], v1 offset:48128
    v_mfma_f32_16x16x32_bf16 v[36:39], v[176:179], v[164:167], v[36:39]
    ds_read_b128 v[224:227], v1 offset:49152
    v_mfma_f32_16x16x32_bf16 v[40:43], v[180:183], v[160:163], v[40:43]
    ds_read_b128 v[228:231], v1 offset:50176
    v_mfma_f32_16x16x32_bf16 v[44:47], v[180:183], v[164:167], v[44:47]
    ds_read_b128 v[232:235], v1 offset:51200
    s_waitcnt lgkmcnt(8)
    v_mfma_f32_16x16x32_bf16 v[48:51], v[184:187], v[160:163], v[48:51]
    ds_read_b128 v[236:239], v1 offset:52224
    v_mfma_f32_16x16x32_bf16 v[52:55], v[184:187], v[164:167], v[52:55]
    ds_read_b128 v[240:243], v1 offset:53248
    v_mfma_f32_16x16x32_bf16 v[56:59], v[188:191], v[160:163], v[56:59]
    ds_read_b128 v[244:247], v1 offset:54272
    v_mfma_f32_16x16x32_bf16 v[60:63], v[188:191], v[164:167], v[60:63]
    v_mfma_f32_16x16x32_bf16 v[64:67], v[192:195], v[160:163], v[64:67]
    v_mfma_f32_16x16x32_bf16 v[68:71], v[192:195], v[164:167], v[68:71]
    v_mfma_f32_16x16x32_bf16 v[72:75], v[196:199], v[160:163], v[72:75]
    v_mfma_f32_16x16x32_bf16 v[76:79], v[196:199], v[164:167], v[76:79]
    v_mfma_f32_16x16x32_bf16 v[80:83], v[200:203], v[160:163], v[80:83]
    v_mfma_f32_16x16x32_bf16 v[84:87], v[200:203], v[164:167], v[84:87]
    s_waitcnt lgkmcnt(0)
    s_barrier
    v_mfma_f32_16x16x32_bf16 v[16:19], v[212:215], v[204:207], v[16:19]
    ds_read_b128 v[160:163], v10 offset:0
    v_mfma_f32_16x16x32_bf16 v[20:23], v[212:215], v[208:211], v[20:23]
    ds_read_b128 v[164:167], v10 offset:2048
    v_mfma_f32_16x16x32_bf16 v[24:27], v[216:219], v[204:207], v[24:27]
    ds_read_b128 v[168:171], v2 offset:0
    v_mfma_f32_16x16x32_bf16 v[28:31], v[216:219], v[208:211], v[28:31]
    ds_read_b128 v[172:175], v2 offset:1024
    v_mfma_f32_16x16x32_bf16 v[32:35], v[220:223], v[204:207], v[32:35]
    ds_read_b128 v[176:179], v2 offset:2048
    v_mfma_f32_16x16x32_bf16 v[36:39], v[220:223], v[208:211], v[36:39]
    ds_read_b128 v[180:183], v2 offset:3072
    v_mfma_f32_16x16x32_bf16 v[40:43], v[224:227], v[204:207], v[40:43]
    ds_read_b128 v[184:187], v2 offset:4096
    v_mfma_f32_16x16x32_bf16 v[44:47], v[224:227], v[208:211], v[44:47]
    ds_read_b128 v[188:191], v2 offset:5120
    v_mfma_f32_16x16x32_bf16 v[48:51], v[228:231], v[204:207], v[48:51]
    ds_read_b128 v[192:195], v2 offset:6144
    v_mfma_f32_16x16x32_bf16 v[52:55], v[228:231], v[208:211], v[52:55]
    ds_read_b128 v[196:199], v2 offset:7168
    v_mfma_f32_16x16x32_bf16 v[56:59], v[232:235], v[204:207], v[56:59]
    ds_read_b128 v[200:203], v2 offset:8192
    v_mfma_f32_16x16x32_bf16 v[60:63], v[232:235], v[208:211], v[60:63]
    v_mfma_f32_16x16x32_bf16 v[64:67], v[236:239], v[204:207], v[64:67]
    v_mfma_f32_16x16x32_bf16 v[68:71], v[236:239], v[208:211], v[68:71]
    v_mfma_f32_16x16x32_bf16 v[72:75], v[240:243], v[204:207], v[72:75]
    v_mfma_f32_16x16x32_bf16 v[76:79], v[240:243], v[208:211], v[76:79]
    v_mfma_f32_16x16x32_bf16 v[80:83], v[244:247], v[204:207], v[80:83]
    s_sub_u32 s41, s41, 1
    v_mfma_f32_16x16x32_bf16 v[84:87], v[244:247], v[208:211], v[84:87]
    s_cmp_lg_u32 s41, 0
    s_cbranch_scc1 L_g_loop
    s_waitcnt lgkmcnt(5)
    v_mfma_f32_16x16x32_bf16 v[16:19], v[168:171], v[160:163], v[16:19]
    ds_read_b128 v[204:207], v11 offset:0
    v_mfma_f32_16x16x32_bf16 v[20:23], v[168:171], v[164:167], v[20:23]
    ds_read_b128 v[208:211], v11 offset:2048
    v_mfma_f32_16x16x32_bf16 v[24:27], v[172:175], v[160:163], v[24:27]
    ds_read_b128 v[212:215], v2 offset:9216
    v_mfma_f32_16x16x32_bf16 v[28:31], v[172:175], v[164:167], v[28:31]
    ds_read_b128 v[216:219], v2 offset:10240
    v_mfma_f32_16x16x32_bf16 v[32:35], v[176:179], v[160:163], v[32:35]
    ds_read_b128 v[220:223], v2 offset:11264
    v_mfma_f32_16x16x32_bf16 v[36:39], v[176:179], v[164:167], v[36:39]
    ds_read_b128 v[224:227], v2 offset:12288
    v_mfma_f32_16x16x32_bf16 v[40:43], v[180:183], v[160:163], v[40:43]
    ds_read_b128 v[228:231], v2 offset:13312
    v_mfma_f32_16x16x32_bf16 v[44:47], v[180:183], v[164:167], v[44:47]
    ds_read_b128 v[232:235], v2 offset:14336
    s_waitcnt lgkmcnt(8)
    v_mfma_f32_16x16x32_bf16 v[48:51], v[184:187], v[160:163], v[48:51]
    ds_read_b128 v[236:239], v2 offset:15360
    v_mfma_f32_16x16x32_bf16 v[52:55], v[184:187], v[164:167], v[52:55]
    ds_read_b128 v[240:243], v2 offset:16384
    v_mfma_f32_16x16x32_bf16 v[56:59], v[188:191], v[160:163], v[56:59]
    ds_read_b128 v[244:247], v2 offset:17408
    v_mfma_f32_16x16x32_bf16 v[60:63], v[188:191], v[164:167], v[60:63]
    v_mfma_f32_16x16x32_bf16 v[64:67], v[192:195], v[160:163], v[64:67]
    v_mfma_f32_16x16x32_bf16 v[68:71], v[192:195], v[164:167], v[68:71]
    v_mfma_f32_16x16x32_bf16 v[72:75], v[196:199], v[160:163], v[72:75]
    v_mfma_f32_16x16x32_bf16 v[76:79], v[196:199], v[164:167], v[76:79]
    v_mfma_f32_16x16x32_bf16 v[80:83], v[200:203], v[160:163], v[80:83]
    v_mfma_f32_16x16x32_bf16 v[84:87], v[200:203], v[164:167], v[84:87]
    s_waitcnt lgkmcnt(0)
    s_barrier
    v_mfma_f32_16x16x32_bf16 v[16:19], v[212:215], v[204:207], v[16:19]
    ds_read_b128 v[160:163], v10 offset:36864
    v_mfma_f32_16x16x32_bf16 v[20:23], v[212:215], v[208:211], v[20:23]
    ds_read_b128 v[164:167], v10 offset:38912
    v_mfma_f32_16x16x32_bf16 v[24:27], v[216:219], v[204:207], v[24:27]
    ds_read_b128 v[168:171], v2 offset:36864
    v_mfma_f32_16x16x32_bf16 v[28:31], v[216:219], v[208:211], v[28:31]
    ds_read_b128 v[172:175], v2 offset:37888
    v_mfma_f32_16x16x32_bf16 v[32:35], v[220:223], v[204:207], v[32:35]
    ds_read_b128 v[176:179], v2 offset:38912
    v_mfma_f32_16x16x32_bf16 v[36:39], v[220:223], v[208:211], v[36:39]
    ds_read_b128 v[180:183], v2 offset:39936
    v_mfma_f32_16x16x32_bf16 v[40:43], v[224:227], v[204:207], v[40:43]
    ds_read_b128 v[184:187], v2 offset:40960
    v_mfma_f32_16x16x32_bf16 v[44:47], v[224:227], v[208:211], v[44:47]
    ds_read_b128 v[188:191], v2 offset:41984
    v_mfma_f32_16x16x32_bf16 v[48:51], v[228:231], v[204:207], v[48:51]
    ds_read_b128 v[192:195], v2 offset:43008
    v_mfma_f32_16x16x32_bf16 v[52:55], v[228:231], v[208:211], v[52:55]
    ds_read_b128 v[196:199], v2 offset:44032
    v_mfma_f32_16x16x32_bf16 v[56:59], v[232:235], v[204:207], v[56:59]
    ds_read_b128 v[200:203], v2 offset:45056
    v_mfma_f32_16x16x32_bf16 v[60:63], v[232:235], v[208:211], v[60:63]
    v_mfma_f32_16x16x32_bf16 v[64:67], v[236:239], v[204:207], v[64:67]
    v_mfma_f32_16x16x32_bf16 v[68:71], v[236:239], v[208:211], v[68:71]
    v_mfma_f32_16x16x32_bf16 v[72:75], v[240:243], v[204:207], v[72:75]
    v_mfma_f32_16x16x32_bf16 v[76:79], v[240:243], v[208:211], v[76:79]
    v_mfma_f32_16x16x32_bf16 v[80:83], v[244:247], v[204:207], v[80:83]
    v_mfma_f32_16x16x32_bf16 v[84:87], v[244:247], v[208:211], v[84:87]
    s_waitcnt lgkmcnt(5)
    v_mfma_f32_16x16x32_bf16 v[16:19], v[168:171], v[160:163], v[16:19]
    ds_read_b128 v[204:207], v11 offset:36864
    v_mfma_f32_16x16x32_bf16 v[20:23], v[168:171], v[164:167], v[20:23]
    ds_read_b128 v[208:211], v11 offset:38912
    v_mfma_f32_16x16x32_bf16 v[24:27], v[172:175], v[160:163], v[24:27]
    ds_read_b128 v[212:215], v2 offset:46080
    v_mfma_f32_16x16x32_bf16 v[28:31], v[172:175], v[164:167], v[28:31]
    ds_read_b128 v[216:219], v2 offset:47104
    v_mfma_f32_16x16x32_bf16 v[32:35], v[176:179], v[160:163], v[32:35]
    ds_read_b128 v[220:223], v2 offset:48128
    v_mfma_f32_16x16x32_bf16 v[36:39], v[176:179], v[164:167], v[36:39]
    ds_read_b128 v[224:227], v2 offset:49152
    v_mfma_f32_16x16x32_bf16 v[40:43], v[180:183], v[160:163], v[40:43]
    ds_read_b128 v[228:231], v2 offset:50176
    v_mfma_f32_16x16x32_bf16 v[44:47], v[180:183], v[164:167], v[44:47]
    ds_read_b128 v[232:235], v2 offset:51200
    s_waitcnt lgkmcnt(8)
    v_mfma_f32_16x16x32_bf16 v[48:51], v[184:187], v[160:163], v[48:51]
    ds_read_b128 v[236:239], v2 offset:52224
    v_mfma_f32_16x16x32_bf16 v[52:55], v[184:187], v[164:167], v[52:55]
    ds_read_b128 v[240:243], v2 offset:53248
    v_mfma_f32_16x16x32_bf16 v[56:59], v[188:191], v[160:163], v[56:59]
    ds_read_b128 v[244:247], v2 offset:54272
    v_mfma_f32_16x16x32_bf16 v[60:63], v[188:191], v[164:167], v[60:63]
    v_mfma_f32_16x16x32_bf16 v[64:67], v[192:195], v[160:163], v[64:67]
    v_mfma_f32_16x16x32_bf16 v[68:71], v[192:195], v[164:167], v[68:71]
    v_mfma_f32_16x16x32_bf16 v[72:75], v[196:199], v[160:163], v[72:75]
    v_mfma_f32_16x16x32_bf16 v[76:79], v[196:199], v[164:167], v[76:79]
    v_mfma_f32_16x16x32_bf16 v[80:83], v[200:203], v[160:163], v[80:83]
    v_mfma_f32_16x16x32_bf16 v[84:87], v[200:203], v[164:167], v[84:87]
    s_waitcnt lgkmcnt(0)
    s_barrier
    v_mfma_f32_16x16x32_bf16 v[16:19], v[212:215], v[204:207], v[16:19]
    ds_read_b128 v[160:163], v8 offset:0
    v_mfma_f32_16x16x32_bf16 v[20:23], v[212:215], v[208:211], v[20:23]
    ds_read_b128 v[164:167], v8 offset:2048
    v_mfma_f32_16x16x32_bf16 v[24:27], v[216:219], v[204:207], v[24:27]
    ds_read_b128 v[192:195], v1 offset:0
    v_mfma_f32_16x16x32_bf16 v[28:31], v[216:219], v[208:211], v[28:31]
    ds_read_b128 v[168:171], v9 offset:0
    v_mfma_f32_16x16x32_bf16 v[32:35], v[220:223], v[204:207], v[32:35]
    ds_read_b128 v[172:175], v9 offset:2048
    v_mfma_f32_16x16x32_bf16 v[36:39], v[220:223], v[208:211], v[36:39]
    ds_read_b128 v[176:179], v8 offset:36864
    v_mfma_f32_16x16x32_bf16 v[40:43], v[224:227], v[204:207], v[40:43]
    ds_read_b128 v[180:183], v8 offset:38912
    v_mfma_f32_16x16x32_bf16 v[44:47], v[224:227], v[208:211], v[44:47]
    ds_read_b128 v[184:187], v9 offset:36864
    v_mfma_f32_16x16x32_bf16 v[48:51], v[228:231], v[204:207], v[48:51]
    ds_read_b128 v[188:191], v9 offset:38912
    v_mfma_f32_16x16x32_bf16 v[52:55], v[228:231], v[208:211], v[52:55]
    ds_read_b128 v[196:199], v1 offset:9216
    v_mfma_f32_16x16x32_bf16 v[56:59], v[232:235], v[204:207], v[56:59]
    ds_read_b128 v[200:203], v1 offset:36864
    v_mfma_f32_16x16x32_bf16 v[60:63], v[232:235], v[208:211], v[60:63]
    v_mfma_f32_16x16x32_bf16 v[64:67], v[236:239], v[204:207], v[64:67]
    v_mfma_f32_16x16x32_bf16 v[68:71], v[236:239], v[208:211], v[68:71]
    v_mfma_f32_16x16x32_bf16 v[72:75], v[240:243], v[204:207], v[72:75]
    v_mfma_f32_16x16x32_bf16 v[76:79], v[240:243], v[208:211], v[76:79]
    v_mfma_f32_16x16x32_bf16 v[80:83], v[244:247], v[204:207], v[80:83]
    v_mfma_f32_16x16x32_bf16 v[84:87], v[244:247], v[208:211], v[84:87]
    s_waitcnt lgkmcnt(0)
    v_mfma_f32_16x16x32_bf16 v[16:19], v[192:195], v[160:163], v[16:19]
    ds_read_b128 v[204:207], v1 offset:46080
    v_mfma_f32_16x16x32_bf16 v[20:23], v[192:195], v[164:167], v[20:23]
    ds_read_b128 v[208:211], v1 offset:1024
    s_waitcnt lgkmcnt(3)
    v_mfma_f32_16x16x32_bf16 v[16:19], v[196:199], v[168:171], v[16:19]
    ds_read_b128 v[212:215], v1 offset:10240
    v_mfma_f32_16x16x32_bf16 v[20:23], v[196:199], v[172:175], v[20:23]
    ds_read_b128 v[216:219], v1 offset:37888
    s_waitcnt lgkmcnt(4)
    v_mfma_f32_16x16x32_bf16 v[16:19], v[200:203], v[176:179], v[16:19]
    ds_read_b128 v[220:223], v1 offset:47104
    v_mfma_f32_16x16x32_bf16 v[20:23], v[200:203], v[180:183], v[20:23]
    ds_read_b128 v[224:227], v1 offset:2048
    s_waitcnt lgkmcnt(5)
    v_mfma_f32_16x16x32_bf16 v[16:19], v[204:207], v[184:187], v[16:19]
    ds_read_b128 v[228:231], v1 offset:11264
    v_mfma_f32_16x16x32_bf16 v[20:23], v[204:207], v[188:191], v[20:23]
    ds_read_b128 v[232:235], v1 offset:38912
    s_waitcnt lgkmcnt(6)
    v_mfma_f32_16x16x32_bf16 v[24:27], v[208:211], v[160:163], v[24:27]
    ds_read_b128 v[236:239], v1 offset:48128
    v_mfma_f32_16x16x32_bf16 v[28:31], v[208:211], v[164:167], v[28:31]
    ds_read_b128 v[240:243], v1 offset:3072
    s_waitcnt lgkmcnt(7)
    v_mfma_f32_16x16x32_bf16 v[24:27], v[212:215], v[168:171], v[24:27]
    ds_read_b128 v[244:247], v1 offset:12288
    v_mfma_f32_16x16x32_bf16 v[28:31], v[212:215], v[172:175], v[28:31]
    s_waitcnt lgkmcnt(7)
    v_mfma_f32_16x16x32_bf16 v[24:27], v[216:219], v[176:179], v[24:27]
    ds_read_b128 v[192:195], v1 offset:39936
    v_mul_f32 v16, v16, v88
    v_mfma_f32_16x16x32_bf16 v[28:31], v[216:219], v[180:183], v[28:31]
    v_mul_f32 v17, v17, v89
    v_mul_f32 v18, v18, v90
    s_waitcnt lgkmcnt(7)
    v_mfma_f32_16x16x32_bf16 v[24:27], v[220:223], v[184:187], v[24:27]
    ds_read_b128 v[196:199], v1 offset:49152
    v_mul_f32 v19, v19, v91
    v_mfma_f32_16x16x32_bf16 v[28:31], v[220:223], v[188:191], v[28:31]
    v_cvt_pk_bf16_f32 v88, v16, v17
    v_cvt_pk_bf16_f32 v89, v18, v19
    s_waitcnt lgkmcnt(7)
    v_mfma_f32_16x16x32_bf16 v[32:35], v[224:227], v[160:163], v[32:35]
    ds_read_b128 v[200:203], v1 offset:4096
    v_mul_f32 v20, v20, v92
    v_mfma_f32_16x16x32_bf16 v[36:39], v[224:227], v[164:167], v[36:39]
    v_mul_f32 v21, v21, v93
    v_mul_f32 v22, v22, v94
    s_waitcnt lgkmcnt(7)
    v_mfma_f32_16x16x32_bf16 v[32:35], v[228:231], v[168:171], v[32:35]
    ds_read_b128 v[204:207], v1 offset:13312
    v_mul_f32 v23, v23, v95
    v_mfma_f32_16x16x32_bf16 v[36:39], v[228:231], v[172:175], v[36:39]
    v_cvt_pk_bf16_f32 v92, v20, v21
    v_cvt_pk_bf16_f32 v93, v22, v23
    s_waitcnt lgkmcnt(7)
    v_mfma_f32_16x16x32_bf16 v[32:35], v[232:235], v[176:179], v[32:35]
    ds_read_b128 v[208:211], v1 offset:40960
    v_mul_f32 v24, v24, v96
    v_mfma_f32_16x16x32_bf16 v[36:39], v[232:235], v[180:183], v[36:39]
    v_mul_f32 v25, v25, v97
    v_mul_f32 v26, v26, v98
    v_mul_f32 v27, v27, v99
    s_waitcnt lgkmcnt(7)
    v_mfma_f32_16x16x32_bf16 v[32:35], v[236:239], v[184:187], v[32:35]
    ds_read_b128 v[212:215], v1 offset:50176
    v_cvt_pk_bf16_f32 v90, v24, v25
    v_mfma_f32_16x16x32_bf16 v[36:39], v[236:239], v[188:191], v[36:39]
    v_cvt_pk_bf16_f32 v91, v26, v27
    buffer_store_dwordx4 v[88:91], v14, s[4:7], s39 offen sc1
    s_waitcnt lgkmcnt(7)
    v_mfma_f32_16x16x32_bf16 v[40:43], v[240:243], v[160:163], v[40:43]
    ds_read_b128 v[216:219], v1 offset:5120
    v_mul_f32 v28, v28, v100
    v_mfma_f32_16x16x32_bf16 v[44:47], v[240:243], v[164:167], v[44:47]
    v_mul_f32 v29, v29, v101
    v_mul_f32 v30, v30, v102
    s_waitcnt lgkmcnt(7)
    v_mfma_f32_16x16x32_bf16 v[40:43], v[244:247], v[168:171], v[40:43]
    ds_read_b128 v[220:223], v1 offset:14336
    v_mul_f32 v31, v31, v103
    v_mfma_f32_16x16x32_bf16 v[44:47], v[244:247], v[172:175], v[44:47]
    v_cvt_pk_bf16_f32 v94, v28, v29
    v_cvt_pk_bf16_f32 v95, v30, v31
    s_waitcnt lgkmcnt(7)
    v_mfma_f32_16x16x32_bf16 v[40:43], v[192:195], v[176:179], v[40:43]
    ds_read_b128 v[224:227], v1 offset:41984
    buffer_store_dwordx4 v[92:95], v14, s[4:7], s40 offen sc1
    v_mfma_f32_16x16x32_bf16 v[44:47], v[192:195], v[180:183], v[44:47]
    v_add_u32 v14, 16384, v14
    v_mul_f32 v32, v32, v104
    v_mul_f32 v33, v33, v105
    s_waitcnt lgkmcnt(7)
    v_mfma_f32_16x16x32_bf16 v[40:43], v[196:199], v[184:187], v[40:43]
    ds_read_b128 v[228:231], v1 offset:51200
    v_mul_f32 v34, v34, v106
    v_mfma_f32_16x16x32_bf16 v[44:47], v[196:199], v[188:191], v[44:47]
    v_mul_f32 v35, v35, v107
    v_cvt_pk_bf16_f32 v104, v32, v33
    s_waitcnt lgkmcnt(7)
    v_mfma_f32_16x16x32_bf16 v[48:51], v[200:203], v[160:163], v[48:51]
    ds_read_b128 v[232:235], v1 offset:6144
    v_cvt_pk_bf16_f32 v105, v34, v35
    v_mfma_f32_16x16x32_bf16 v[52:55], v[200:203], v[164:167], v[52:55]
    v_mul_f32 v36, v36, v108
    v_mul_f32 v37, v37, v109
    s_waitcnt lgkmcnt(7)
    v_mfma_f32_16x16x32_bf16 v[48:51], v[204:207], v[168:171], v[48:51]
    ds_read_b128 v[236:239], v1 offset:15360
    v_mul_f32 v38, v38, v110
    v_mfma_f32_16x16x32_bf16 v[52:55], v[204:207], v[172:175], v[52:55]
    v_mul_f32 v39, v39, v111
    v_cvt_pk_bf16_f32 v108, v36, v37
    s_waitcnt lgkmcnt(7)
    v_mfma_f32_16x16x32_bf16 v[48:51], v[208:211], v[176:179], v[48:51]
    ds_read_b128 v[240:243], v1 offset:43008
    v_cvt_pk_bf16_f32 v109, v38, v39
    v_mfma_f32_16x16x32_bf16 v[52:55], v[208:211], v[180:183], v[52:55]
    v_mul_f32 v40, v40, v112
    v_mul_f32 v41, v41, v113
    v_mul_f32 v42, v42, v114
    s_waitcnt lgkmcnt(7)
    v_mfma_f32_16x16x32_bf16 v[48:51], v[212:215], v[184:187], v[48:51]
    ds_read_b128 v[244:247], v1 offset:52224
    v_mul_f32 v43, v43, v115
    v_mfma_f32_16x16x32_bf16 v[52:55], v[212:215], v[188:191], v[52:55]
    v_cvt_pk_bf16_f32 v106, v40, v41
    v_cvt_pk_bf16_f32 v107, v42, v43
    s_waitcnt lgkmcnt(7)
    v_mfma_f32_16x16x32_bf16 v[56:59], v[216:219], v[160:163], v[56:59]
    ds_read_b128 v[192:195], v1 offset:7168
    buffer_store_dwordx4 v[104:107], v14, s[4:7], s39 offen sc1
    v_mfma_f32_16x16x32_bf16 v[60:63], v[216:219], v[164:167], v[60:63]
    v_mul_f32 v44, v44, v116
    v_mul_f32 v45, v45, v117
    s_waitcnt lgkmcnt(7)
    v_mfma_f32_16x16x32_bf16 v[56:59], v[220:223], v[168:171], v[56:59]
    ds_read_b128 v[196:199], v1 offset:16384
    v_mul_f32 v46, v46, v118
    v_mfma_f32_16x16x32_bf16 v[60:63], v[220:223], v[172:175], v[60:63]
    v_mul_f32 v47, v47, v119
    v_cvt_pk_bf16_f32 v110, v44, v45
    s_waitcnt lgkmcnt(7)
    v_mfma_f32_16x16x32_bf16 v[56:59], v[224:227], v[176:179], v[56:59]
    ds_read_b128 v[200:203], v1 offset:44032
    v_cvt_pk_bf16_f32 v111, v46, v47
    v_mfma_f32_16x16x32_bf16 v[60:63], v[224:227], v[180:183], v[60:63]
    buffer_store_dwordx4 v[108:111], v14, s[4:7], s40 offen sc1
    v_add_u32 v14, 16384, v14
    v_mul_f32 v48, v48, v120
    s_waitcnt lgkmcnt(7)
    v_mfma_f32_16x16x32_bf16 v[56:59], v[228:231], v[184:187], v[56:59]
    ds_read_b128 v[204:207], v1 offset:53248
    v_mul_f32 v49, v49, v121
    v_mfma_f32_16x16x32_bf16 v[60:63], v[228:231], v[188:191], v[60:63]
    v_mul_f32 v50, v50, v122
    v_mul_f32 v51, v51, v123
    s_waitcnt lgkmcnt(7)
    v_mfma_f32_16x16x32_bf16 v[64:67], v[232:235], v[160:163], v[64:67]
    ds_read_b128 v[208:211], v1 offset:8192
    v_cvt_pk_bf16_f32 v120, v48, v49
    v_mfma_f32_16x16x32_bf16 v[68:71], v[232:235], v[164:167], v[68:71]
    v_cvt_pk_bf16_f32 v121, v50, v51
    v_mul_f32 v52, v52, v124
    s_waitcnt lgkmcnt(7)
    v_mfma_f32_16x16x32_bf16 v[64:67], v[236:239], v[168:171], v[64:67]
    ds_read_b128 v[212:215], v1 offset:17408
    v_mul_f32 v53, v53, v125
    v_mfma_f32_16x16x32_bf16 v[68:71], v[236:239], v[172:175], v[68:71]
    v_mul_f32 v54, v54, v126
    v_mul_f32 v55, v55, v127
    s_waitcnt lgkmcnt(7)
    v_mfma_f32_16x16x32_bf16 v[64:67], v[240:243], v[176:179], v[64:67]
    ds_read_b128 v[216:219], v1 offset:45056
    v_cvt_pk_bf16_f32 v124, v52, v53
    v_mfma_f32_16x16x32_bf16 v[68:71], v[240:243], v[180:183], v[68:71]
    v_cvt_pk_bf16_f32 v125, v54, v55
    v_mul_f32 v56, v56, v128
    v_mul_f32 v57, v57, v129
    s_waitcnt lgkmcnt(7)
    v_mfma_f32_16x16x32_bf16 v[64:67], v[244:247], v[184:187], v[64:67]
    ds_read_b128 v[220:223], v1 offset:54272
    v_mul_f32 v58, v58, v130
    v_mfma_f32_16x16x32_bf16 v[68:71], v[244:247], v[188:191], v[68:71]
    v_mul_f32 v59, v59, v131
    v_cvt_pk_bf16_f32 v122, v56, v57
    v_cvt_pk_bf16_f32 v123, v58, v59
    s_waitcnt lgkmcnt(7)
    v_mfma_f32_16x16x32_bf16 v[72:75], v[192:195], v[160:163], v[72:75]
    buffer_store_dwordx4 v[120:123], v14, s[4:7], s39 offen sc1
    v_mul_f32 v60, v60, v132
    v_mfma_f32_16x16x32_bf16 v[76:79], v[192:195], v[164:167], v[76:79]
    v_mul_f32 v61, v61, v133
    v_mul_f32 v62, v62, v134
    s_waitcnt lgkmcnt(6)
    v_mfma_f32_16x16x32_bf16 v[72:75], v[196:199], v[168:171], v[72:75]
    v_mul_f32 v63, v63, v135
    v_cvt_pk_bf16_f32 v126, v60, v61
    v_mfma_f32_16x16x32_bf16 v[76:79], v[196:199], v[172:175], v[76:79]
    v_cvt_pk_bf16_f32 v127, v62, v63
    buffer_store_dwordx4 v[124:127], v14, s[4:7], s40 offen sc1
    s_waitcnt lgkmcnt(5)
    v_mfma_f32_16x16x32_bf16 v[72:75], v[200:203], v[176:179], v[72:75]
    v_add_u32 v14, 16384, v14
    v_mul_f32 v64, v64, v136
    v_mfma_f32_16x16x32_bf16 v[76:79], v[200:203], v[180:183], v[76:79]
    v_mul_f32 v65, v65, v137
    v_mul_f32 v66, v66, v138
    v_mul_f32 v67, v67, v139
    s_waitcnt lgkmcnt(4)
    v_mfma_f32_16x16x32_bf16 v[72:75], v[204:207], v[184:187], v[72:75]
    v_cvt_pk_bf16_f32 v136, v64, v65
    v_cvt_pk_bf16_f32 v137, v66, v67
    v_mfma_f32_16x16x32_bf16 v[76:79], v[204:207], v[188:191], v[76:79]
    v_mul_f32 v68, v68, v140
    v_mul_f32 v69, v69, v141
    s_waitcnt lgkmcnt(3)
    v_mfma_f32_16x16x32_bf16 v[80:83], v[208:211], v[160:163], v[80:83]
    v_mul_f32 v70, v70, v142
    v_mul_f32 v71, v71, v143
    v_mfma_f32_16x16x32_bf16 v[84:87], v[208:211], v[164:167], v[84:87]
    v_cvt_pk_bf16_f32 v140, v68, v69
    v_cvt_pk_bf16_f32 v141, v70, v71
    s_waitcnt lgkmcnt(2)
    v_mfma_f32_16x16x32_bf16 v[80:83], v[212:215], v[168:171], v[80:83]
    v_mfma_f32_16x16x32_bf16 v[84:87], v[212:215], v[172:175], v[84:87]
    s_waitcnt lgkmcnt(1)
    v_mfma_f32_16x16x32_bf16 v[80:83], v[216:219], v[176:179], v[80:83]
    v_mul_f32 v72, v72, v144
    v_mul_f32 v73, v73, v145
    v_mfma_f32_16x16x32_bf16 v[84:87], v[216:219], v[180:183], v[84:87]
    v_mul_f32 v74, v74, v146
    v_mul_f32 v75, v75, v147
    v_cvt_pk_bf16_f32 v138, v72, v73
    s_waitcnt lgkmcnt(0)
    v_mfma_f32_16x16x32_bf16 v[80:83], v[220:223], v[184:187], v[80:83]
    v_cvt_pk_bf16_f32 v139, v74, v75
    buffer_store_dwordx4 v[136:139], v14, s[4:7], s39 offen sc1
    v_mfma_f32_16x16x32_bf16 v[84:87], v[220:223], v[188:191], v[84:87]
    v_mul_f32 v76, v76, v148
    v_mul_f32 v77, v77, v149
    v_mul_f32 v78, v78, v150
    v_mul_f32 v79, v79, v151
    v_cvt_pk_bf16_f32 v142, v76, v77
    v_cvt_pk_bf16_f32 v143, v78, v79
    buffer_store_dwordx4 v[140:143], v14, s[4:7], s40 offen sc1
    s_nop 1
    v_mul_f32 v80, v80, v152
    v_mul_f32 v81, v81, v153
    v_mul_f32 v82, v82, v154
    v_mul_f32 v83, v83, v155
    v_cvt_pk_bf16_f32 v152, v80, v81
    v_cvt_pk_bf16_f32 v153, v82, v83
    buffer_store_dwordx2 v[152:153], v15, s[4:7], s39 offen sc1
    v_mul_f32 v84, v84, v156
    v_mul_f32 v85, v85, v157
    v_mul_f32 v86, v86, v158
    v_mul_f32 v87, v87, v159
    v_cvt_pk_bf16_f32 v156, v84, v85
    v_cvt_pk_bf16_f32 v157, v86, v87
    buffer_store_dwordx2 v[156:157], v15, s[4:7], s40 offen sc1
    s_barrier
    s_and_b32 s25, s2, 7
    s_lshr_b32 s26, s2, 3
    s_lshr_b32 s23, s25, 1
    s_lshl_b32 s23, s23, 3
    s_lshr_b32 s27, s26, 2
    s_add_u32 s23, s23, s27
    s_and_b32 s24, s25, 1
    s_lshl_b32 s24, s24, 2
    s_and_b32 s27, s26, 3
    s_add_u32 s24, s24, s27
    s_add_u32 s25, s23, s24
    s_and_b32 s25, s25, 3
    s_lshl_b32 s30, s23, 2
    s_add_u32 s30, s30, s20
    s_and_b32 s31, s20, 1
    s_mul_i32 s34, s30, 18432
    s_add_u32 s34, s34, s21
    s_add_u32 s34, s34, 0x300000
    s_lshl_b32 s35, s24, 11
    s_lshr_b32 s36, s24, 2
    s_lshl_b32 s36, s36, 10
    s_and_b32 s37, s24, 3
    s_lshl_b32 s37, s37, 8
    s_add_u32 s36, s36, s37
    s_add_u32 s36, s36, 16384
    v_bfe_u32 v2, v1, 4, 4
    v_lshrrev_b32 v3, 8, v1
    v_add_u32 v4, s35, v1
    v_lshrrev_b32 v0, 1, v3
    v_and_b32 v9, 1, v3
    v_cmp_eq_u32 s[40:41], s31, v0
    v_bfrev_b32 v6, 1
    v_lshlrev_b32 v5, 4, v2
    v_lshl_add_u32 v5, v9, 3, v5
    v_add_u32 v5, s36, v5
    v_cndmask_b32 v5, v6, v5, s[40:41]
    buffer_load_dwordx4 v[220:223], v4, s[4:7], s34 offen offset:0 sc1
    buffer_load_dwordx4 v[224:227], v4, s[4:7], s34 offen offset:1024 sc1
    buffer_load_dwordx2 v[228:229], v5, s[4:7], s34 offen sc1
    s_and_b32 s29, s30, 0xfffe
    s_mul_i32 s29, s29, 73728
    s_add_u32 s29, s29, s21
    s_lshl_b32 s37, s31, 10
    s_add_u32 s29, s29, s37
    s_add_u32 s29, s29, 0x1200000
    s_mul_i32 s37, s31, 73728
    s_sub_u32 s38, 73728, s37
    v_lshlrev_b32 v10, 3, v2
    v_lshrrev_b32 v7, 1, v1
    v_add_u32 v16, s37, v1
    v_add_u32 v17, s38, v1
    v_add_u32 v18, s37, v7
    v_add_u32 v19, s38, v7
    s_lshl_b32 s37, s31, 12
    v_add_u32 v20, 0, v1
    v_add_u32 v12, s37, v20
    v_add_u32 v21, 36864, v1
    v_add_u32 v13, s37, v21
    v_add_u32 v22, 73728, v1
    v_add_u32 v14, s37, v22
    v_add_u32 v23, 110592, v1
    v_add_u32 v15, s37, v23
    s_add_u32 s34, s34, 0x1900000
    s_lshl_b32 s39, s30, 10
    s_add_u32 s39, s39, s21
    s_lshl_b32 s42, s24, 7
    s_add_u32 s39, s39, s42
    s_add_u32 s39, s39, 0x3700000
    v_cmp_eq_u32 vcc, 0, v3
    v_mov_b32 v11, 0x3f803f80
    s_lshr_b32 s44, s23, 1
    v_cndmask_b32 v10, v6, v10, vcc
    s_cmp_eq_u32 s22, 0
    s_cbranch_scc1 L_p5_nf
    v_mul_u32_u24 v8, 1152, v2
    s_mul_i32 s34, s30, 18432
    s_mul_i32 s42, s24, 144
    s_add_u32 s34, s34, s42
    v_lshl_add_u32 v4, v3, 4, v8
    v_lshl_add_u32 v5, v9, 3, v8
    v_cndmask_b32 v5, v6, v5, s[40:41]
L_p5_nf:
    s_lshl_b32 s52, s22, 7
    s_add_u32 s52, s52, s44
    s_lshl_b32 s52, s52, 8
    s_add_u32 s52, s52, 0x450a000
    s_add_u32 s52, s52, s4
    s_addc_u32 s53, s5, 0
    s_waitcnt vmcnt(3)
    s_barrier
    s_cmp_lg_u32 s20, 0
    s_cbranch_scc1 L_ns_d5
    s_mov_b32 s56, 1
    s_atomic_add s56, s[50:51], 0
L_ns_d5:
    s_mul_i32 s37, s20, 4608
    s_add_u32 s37, s37, 131072
    s_xor_b32 s38, s20, 1
    s_mul_i32 s42, s38, 4608
    s_add_u32 s42, s42, 131072
    v_and_b32 v0, 0x1ff, v1
    v_add_u32 v2, s37, v1
    v_add_u32 v3, s37, v0
    v_add_u32 v7, s42, v1
    v_add_u32 v8, s42, v0
    s_lshl_b32 s37, s20, 2
    s_add_u32 s37, s37, 163808
    s_xor_b32 s38, s37, 4
    v_mov_b32 v0, s37
    v_mov_b32 v6, s38
    s_lshl_b32 s43, s22, 1
    s_add_u32 s43, s43, 2
    v_mov_b32 v9, s43
    s_cmp_lg_u32 s20, 0
    s_cbranch_scc1 L_pd_d5
    s_mov_b32 s60, 65536
L_poll_d5:
    s_mov_b32 s57, 0
    s_atomic_add s57, s[52:53], 0 glc
    s_waitcnt lgkmcnt(0)
    s_cmp_ge_u32 s57, 16
    s_cbranch_scc1 L_pd_d5
    s_sub_u32 s60, s60, 1
    s_cbranch_scc1 L_pd_d5
    s_sleep 2
    s_branch L_poll_d5
L_pd_d5:
    s_barrier
    s_mov_b32 s32, 0
    s_lshl_b32 s32, s32, 13
    s_add_u32 s32, s32, s29
    s_add_u32 s33, s32, 4096
    buffer_load_dwordx4 v[124:127], v16, s[4:7], s32 offen offset:0 sc1
    buffer_load_dwordx4 v[128:131], v17, s[4:7], s32 offen offset:0 sc1
    buffer_load_dwordx4 v[132:135], v16, s[4:7], s32 offen offset:2048 sc1
    buffer_load_dwordx4 v[136:139], v17, s[4:7], s32 offen offset:2048 sc1
    buffer_load_dwordx4 v[140:143], v16, s[4:7], s33 offen offset:0 sc1
    buffer_load_dwordx4 v[144:147], v17, s[4:7], s33 offen offset:0 sc1
    buffer_load_dwordx4 v[148:151], v16, s[4:7], s33 offen offset:2048 sc1
    buffer_load_dwordx4 v[152:155], v17, s[4:7], s33 offen offset:2048 sc1
    ds_read_b128 v[64:67], v14 offset:0
    ds_read_b128 v[68:71], v14 offset:1024
    ds_read_b128 v[72:75], v14 offset:2048
    ds_read_b128 v[76:79], v14 offset:3072
    ds_read_b128 v[80:83], v22 offset:8192
    ds_read_b128 v[84:87], v14 offset:9216
    ds_read_b128 v[88:91], v14 offset:10240
    ds_read_b128 v[92:95], v14 offset:11264
    ds_read_b128 v[96:99], v14 offset:12288
    ds_read_b128 v[100:103], v22 offset:17408
    s_add_u32 s45, s29, 8192
    s_add_u32 s46, s29, 12288
    buffer_load_dwordx4 v[156:159], v16, s[4:7], s45 offen offset:0 sc1
    buffer_load_dwordx4 v[160:163], v17, s[4:7], s45 offen offset:0 sc1
    s_lshl_b32 s50, s22, 7
    s_add_u32 s50, s50, s44
    s_lshl_b32 s50, s50, 8
    s_add_u32 s50, s50, 0x450b000
    s_add_u32 s50, s50, s4
    s_addc_u32 s51, s5, 0
    s_waitcnt vmcnt(10)
    v_lshlrev_b32 v24, 16, v220
    v_and_b32 v25, 0xffff0000, v220
    v_lshlrev_b32 v26, 16, v221
    v_and_b32 v27, 0xffff0000, v221
    v_lshlrev_b32 v28, 16, v222
    v_and_b32 v29, 0xffff0000, v222
    v_lshlrev_b32 v30, 16, v223
    v_and_b32 v31, 0xffff0000, v223
    v_lshlrev_b32 v32, 16, v224
    v_and_b32 v33, 0xffff0000, v224
    v_lshlrev_b32 v34, 16, v225
    v_and_b32 v35, 0xffff0000, v225
    v_lshlrev_b32 v36, 16, v226
    v_and_b32 v37, 0xffff0000, v226
    v_lshlrev_b32 v38, 16, v227
    v_and_b32 v39, 0xffff0000, v227
    v_lshlrev_b32 v40, 16, v228
    v_and_b32 v41, 0xffff0000, v228
    v_lshlrev_b32 v42, 16, v229
    v_and_b32 v43, 0xffff0000, v229
    s_waitcnt vmcnt(8) lgkmcnt(5)
    v_mfma_f32_16x16x32_bf16 v[44:47], v[64:67], v[128:131], 0
    ds_read_b128 v[104:107], v14 offset:18432
    s_mov_b32 s32, 2
    s_lshl_b32 s32, s32, 13
    s_add_u32 s32, s32, s29
    s_add_u32 s33, s32, 4096
    v_mfma_f32_16x16x32_bf16 v[24:27], v[64:67], v[124:127], v[24:27]
    ds_read_b128 v[108:111], v14 offset:19456
    buffer_load_dwordx4 v[164:167], v16, s[4:7], s45 offen offset:2048 sc1
    v_mfma_f32_16x16x32_bf16 v[48:51], v[68:71], v[128:131], 0
    ds_read_b128 v[112:115], v14 offset:20480
    v_mfma_f32_16x16x32_bf16 v[28:31], v[68:71], v[124:127], v[28:31]
    ds_read_b128 v[116:119], v14 offset:21504
    buffer_load_dwordx4 v[168:171], v17, s[4:7], s45 offen offset:2048 sc1
    v_mfma_f32_16x16x32_bf16 v[52:55], v[72:75], v[128:131], 0
    ds_read_b128 v[120:123], v22 offset:26624
    v_mfma_f32_16x16x32_bf16 v[32:35], v[72:75], v[124:127], v[32:35]
    buffer_load_dwordx4 v[188:191], v16, s[4:7], s32 offen offset:0 sc1
    v_mfma_f32_16x16x32_bf16 v[56:59], v[76:79], v[128:131], 0
    v_mfma_f32_16x16x32_bf16 v[36:39], v[76:79], v[124:127], v[36:39]
    buffer_load_dwordx4 v[192:195], v17, s[4:7], s32 offen offset:0 sc1
    v_mfma_f32_16x16x32_bf16 v[60:63], v[80:83], v[128:131], 0
    v_mfma_f32_16x16x32_bf16 v[40:43], v[80:83], v[124:127], v[40:43]
    s_waitcnt vmcnt(10) lgkmcnt(5)
    v_mfma_f32_16x16x32_bf16 v[44:47], v[84:87], v[136:139], v[44:47]
    ds_read_b128 v[64:67], v14 offset:27648
    v_mfma_f32_16x16x32_bf16 v[24:27], v[84:87], v[132:135], v[24:27]
    ds_read_b128 v[68:71], v14 offset:28672
    buffer_load_dwordx4 v[172:175], v16, s[4:7], s46 offen offset:0 sc1
    v_mfma_f32_16x16x32_bf16 v[48:51], v[88:91], v[136:139], v[48:51]
    ds_read_b128 v[72:75], v14 offset:29696
    v_mfma_f32_16x16x32_bf16 v[28:31], v[88:91], v[132:135], v[28:31]
    ds_read_b128 v[76:79], v14 offset:30720
    buffer_load_dwordx4 v[176:179], v17, s[4:7], s46 offen offset:0 sc1
    v_mfma_f32_16x16x32_bf16 v[52:55], v[92:95], v[136:139], v[52:55]
    ds_read_b128 v[80:83], v22 offset:35840
    v_mfma_f32_16x16x32_bf16 v[32:35], v[92:95], v[132:135], v[32:35]
    buffer_load_dwordx4 v[196:199], v16, s[4:7], s32 offen offset:2048 sc1
    v_mfma_f32_16x16x32_bf16 v[56:59], v[96:99], v[136:139], v[56:59]
    v_mfma_f32_16x16x32_bf16 v[36:39], v[96:99], v[132:135], v[36:39]
    buffer_load_dwordx4 v[200:203], v17, s[4:7], s32 offen offset:2048 sc1
    v_mfma_f32_16x16x32_bf16 v[60:63], v[100:103], v[136:139], v[60:63]
    v_mfma_f32_16x16x32_bf16 v[40:43], v[100:103], v[132:135], v[40:43]
    s_waitcnt vmcnt(12) lgkmcnt(0)
    s_barrier
    v_mfma_f32_16x16x32_bf16 v[44:47], v[104:107], v[144:147], v[44:47]
    ds_read_b128 v[84:87], v15 offset:0
    v_mfma_f32_16x16x32_bf16 v[24:27], v[104:107], v[140:143], v[24:27]
    ds_read_b128 v[88:91], v15 offset:1024
    buffer_load_dwordx4 v[180:183], v16, s[4:7], s46 offen offset:2048 sc1
    v_mfma_f32_16x16x32_bf16 v[48:51], v[108:111], v[144:147], v[48:51]
    ds_read_b128 v[92:95], v15 offset:2048
    v_mfma_f32_16x16x32_bf16 v[28:31], v[108:111], v[140:143], v[28:31]
    ds_read_b128 v[96:99], v15 offset:3072
    buffer_load_dwordx4 v[184:187], v17, s[4:7], s46 offen offset:2048 sc1
    v_mfma_f32_16x16x32_bf16 v[52:55], v[112:115], v[144:147], v[52:55]
    ds_read_b128 v[100:103], v23 offset:8192
    v_mfma_f32_16x16x32_bf16 v[32:35], v[112:115], v[140:143], v[32:35]
    buffer_load_dwordx4 v[204:207], v16, s[4:7], s33 offen offset:0 sc1
    v_mfma_f32_16x16x32_bf16 v[56:59], v[116:119], v[144:147], v[56:59]
    v_mfma_f32_16x16x32_bf16 v[36:39], v[116:119], v[140:143], v[36:39]
    buffer_load_dwordx4 v[208:211], v17, s[4:7], s33 offen offset:0 sc1
    v_mfma_f32_16x16x32_bf16 v[60:63], v[120:123], v[144:147], v[60:63]
    v_mfma_f32_16x16x32_bf16 v[40:43], v[120:123], v[140:143], v[40:43]
    s_waitcnt vmcnt(14) lgkmcnt(5)
    v_mfma_f32_16x16x32_bf16 v[44:47], v[64:67], v[152:155], v[44:47]
    ds_read_b128 v[104:107], v15 offset:9216
    v_mfma_f32_16x16x32_bf16 v[24:27], v[64:67], v[148:151], v[24:27]
    ds_read_b128 v[108:111], v15 offset:10240
    v_mfma_f32_16x16x32_bf16 v[48:51], v[68:71], v[152:155], v[48:51]
    ds_read_b128 v[112:115], v15 offset:11264
    v_mfma_f32_16x16x32_bf16 v[28:31], v[68:71], v[148:151], v[28:31]
    ds_read_b128 v[116:119], v15 offset:12288
    v_mfma_f32_16x16x32_bf16 v[52:55], v[72:75], v[152:155], v[52:55]
    ds_read_b128 v[120:123], v23 offset:17408
    v_mfma_f32_16x16x32_bf16 v[32:35], v[72:75], v[148:151], v[32:35]
    buffer_load_dwordx4 v[212:215], v16, s[4:7], s33 offen offset:2048 sc1
    v_mfma_f32_16x16x32_bf16 v[56:59], v[76:79], v[152:155], v[56:59]
    v_mfma_f32_16x16x32_bf16 v[36:39], v[76:79], v[148:151], v[36:39]
    buffer_load_dwordx4 v[216:219], v17, s[4:7], s33 offen offset:2048 sc1
    v_mfma_f32_16x16x32_bf16 v[60:63], v[80:83], v[152:155], v[60:63]
    v_mfma_f32_16x16x32_bf16 v[40:43], v[80:83], v[148:151], v[40:43]
    s_waitcnt vmcnt(14) lgkmcnt(5)
    v_mfma_f32_16x16x32_bf16 v[44:47], v[84:87], v[160:163], v[44:47]
    ds_read_b128 v[64:67], v15 offset:18432
    s_mov_b32 s32, 3
    s_lshl_b32 s32, s32, 13
    s_add_u32 s32, s32, s29
    s_add_u32 s33, s32, 4096
    v_mfma_f32_16x16x32_bf16 v[24:27], v[84:87], v[156:159], v[24:27]
    ds_read_b128 v[68:71], v15 offset:19456
    v_mfma_f32_16x16x32_bf16 v[48:51], v[88:91], v[160:163], v[48:51]
    ds_read_b128 v[72:75], v15 offset:20480
    v_mfma_f32_16x16x32_bf16 v[28:31], v[88:91], v[156:159], v[28:31]
    ds_read_b128 v[76:79], v15 offset:21504
    v_mfma_f32_16x16x32_bf16 v[52:55], v[92:95], v[160:163], v[52:55]
    ds_read_b128 v[80:83], v23 offset:26624
    v_mfma_f32_16x16x32_bf16 v[32:35], v[92:95], v[156:159], v[32:35]
    buffer_load_dwordx4 v[124:127], v16, s[4:7], s32 offen offset:0 sc1
    v_mfma_f32_16x16x32_bf16 v[56:59], v[96:99], v[160:163], v[56:59]
    v_mfma_f32_16x16x32_bf16 v[36:39], v[96:99], v[156:159], v[36:39]
    buffer_load_dwordx4 v[128:131], v17, s[4:7], s32 offen offset:0 sc1
    v_mfma_f32_16x16x32_bf16 v[60:63], v[100:103], v[160:163], v[60:63]
    v_mfma_f32_16x16x32_bf16 v[40:43], v[100:103], v[156:159], v[40:43]
    s_waitcnt vmcnt(14) lgkmcnt(5)
    v_mfma_f32_16x16x32_bf16 v[44:47], v[104:107], v[168:171], v[44:47]
    ds_read_b128 v[84:87], v15 offset:27648
    v_mfma_f32_16x16x32_bf16 v[24:27], v[104:107], v[164:167], v[24:27]
    ds_read_b128 v[88:91], v15 offset:28672
    v_mfma_f32_16x16x32_bf16 v[48:51], v[108:111], v[168:171], v[48:51]
    ds_read_b128 v[92:95], v15 offset:29696
    v_mfma_f32_16x16x32_bf16 v[28:31], v[108:111], v[164:167], v[28:31]
    ds_read_b128 v[96:99], v15 offset:30720
    v_mfma_f32_16x16x32_bf16 v[52:55], v[112:115], v[168:171], v[52:55]
    ds_read_b128 v[100:103], v23 offset:35840
    v_mfma_f32_16x16x32_bf16 v[32:35], v[112:115], v[164:167], v[32:35]
    buffer_load_dwordx4 v[132:135], v16, s[4:7], s32 offen offset:2048 sc1
    v_mfma_f32_16x16x32_bf16 v[56:59], v[116:119], v[168:171], v[56:59]
    v_mfma_f32_16x16x32_bf16 v[36:39], v[116:119], v[164:167], v[36:39]
    buffer_load_dwordx4 v[136:139], v17, s[4:7], s32 offen offset:2048 sc1
    v_mfma_f32_16x16x32_bf16 v[60:63], v[120:123], v[168:171], v[60:63]
    v_mfma_f32_16x16x32_bf16 v[40:43], v[120:123], v[164:167], v[40:43]
    s_waitcnt vmcnt(12) lgkmcnt(0)
    s_barrier
    v_mfma_f32_16x16x32_bf16 v[44:47], v[64:67], v[176:179], v[44:47]
    ds_read_b128 v[104:107], v12 offset:0
    v_mfma_f32_16x16x32_bf16 v[24:27], v[64:67], v[172:175], v[24:27]
    ds_read_b128 v[108:111], v12 offset:1024
    v_mfma_f32_16x16x32_bf16 v[48:51], v[68:71], v[176:179], v[48:51]
    ds_read_b128 v[112:115], v12 offset:2048
    v_mfma_f32_16x16x32_bf16 v[28:31], v[68:71], v[172:175], v[28:31]
    ds_read_b128 v[116:119], v12 offset:3072
    v_mfma_f32_16x16x32_bf16 v[52:55], v[72:75], v[176:179], v[52:55]
    ds_read_b128 v[120:123], v20 offset:8192
    v_mfma_f32_16x16x32_bf16 v[32:35], v[72:75], v[172:175], v[32:35]
    buffer_load_dwordx4 v[140:143], v16, s[4:7], s33 offen offset:0 sc1
    v_mfma_f32_16x16x32_bf16 v[56:59], v[76:79], v[176:179], v[56:59]
    v_mfma_f32_16x16x32_bf16 v[36:39], v[76:79], v[172:175], v[36:39]
    buffer_load_dwordx4 v[144:147], v17, s[4:7], s33 offen offset:0 sc1
    v_mfma_f32_16x16x32_bf16 v[60:63], v[80:83], v[176:179], v[60:63]
    v_mfma_f32_16x16x32_bf16 v[40:43], v[80:83], v[172:175], v[40:43]
    s_waitcnt vmcnt(10) lgkmcnt(5)
    v_mfma_f32_16x16x32_bf16 v[44:47], v[84:87], v[184:187], v[44:47]
    ds_read_b128 v[64:67], v12 offset:9216
    v_mfma_f32_16x16x32_bf16 v[24:27], v[84:87], v[180:183], v[24:27]
    ds_read_b128 v[68:71], v12 offset:10240
    v_mfma_f32_16x16x32_bf16 v[48:51], v[88:91], v[184:187], v[48:51]
    ds_read_b128 v[72:75], v12 offset:11264
    v_mfma_f32_16x16x32_bf16 v[28:31], v[88:91], v[180:183], v[28:31]
    ds_read_b128 v[76:79], v12 offset:12288
    v_mfma_f32_16x16x32_bf16 v[52:55], v[92:95], v[184:187], v[52:55]
    ds_read_b128 v[80:83], v20 offset:17408
    v_mfma_f32_16x16x32_bf16 v[32:35], v[92:95], v[180:183], v[32:35]
    buffer_load_dwordx4 v[148:151], v16, s[4:7], s33 offen offset:2048 sc1
    v_mfma_f32_16x16x32_bf16 v[56:59], v[96:99], v[184:187], v[56:59]
    v_mfma_f32_16x16x32_bf16 v[36:39], v[96:99], v[180:183], v[36:39]
    buffer_load_dwordx4 v[152:155], v17, s[4:7], s33 offen offset:2048 sc1
    v_mfma_f32_16x16x32_bf16 v[60:63], v[100:103], v[184:187], v[60:63]
    v_mfma_f32_16x16x32_bf16 v[40:43], v[100:103], v[180:183], v[40:43]
    s_waitcnt vmcnt(12) lgkmcnt(5)
    v_mfma_f32_16x16x32_bf16 v[44:47], v[104:107], v[192:195], v[44:47]
    ds_read_b128 v[84:87], v12 offset:18432
    s_mov_b32 s32, 4
    s_lshl_b32 s32, s32, 13
    s_add_u32 s32, s32, s29
    s_add_u32 s33, s32, 4096
    v_mfma_f32_16x16x32_bf16 v[24:27], v[104:107], v[188:191], v[24:27]
    ds_read_b128 v[88:91], v12 offset:19456
    v_mfma_f32_16x16x32_bf16 v[48:51], v[108:111], v[192:195], v[48:51]
    ds_read_b128 v[92:95], v12 offset:20480
    v_mfma_f32_16x16x32_bf16 v[28:31], v[108:111], v[188:191], v[28:31]
    ds_read_b128 v[96:99], v12 offset:21504
    v_mfma_f32_16x16x32_bf16 v[52:55], v[112:115], v[192:195], v[52:55]
    ds_read_b128 v[100:103], v20 offset:26624
    v_mfma_f32_16x16x32_bf16 v[32:35], v[112:115], v[188:191], v[32:35]
    buffer_load_dwordx4 v[156:159], v16, s[4:7], s32 offen offset:0 sc1
    v_mfma_f32_16x16x32_bf16 v[56:59], v[116:119], v[192:195], v[56:59]
    v_mfma_f32_16x16x32_bf16 v[36:39], v[116:119], v[188:191], v[36:39]
    buffer_load_dwordx4 v[160:163], v17, s[4:7], s32 offen offset:0 sc1
    v_mfma_f32_16x16x32_bf16 v[60:63], v[120:123], v[192:195], v[60:63]
    v_mfma_f32_16x16x32_bf16 v[40:43], v[120:123], v[188:191], v[40:43]
    s_waitcnt vmcnt(14) lgkmcnt(5)
    v_mfma_f32_16x16x32_bf16 v[44:47], v[64:67], v[200:203], v[44:47]
    ds_read_b128 v[104:107], v12 offset:27648
    v_mfma_f32_16x16x32_bf16 v[24:27], v[64:67], v[196:199], v[24:27]
    ds_read_b128 v[108:111], v12 offset:28672
    v_mfma_f32_16x16x32_bf16 v[48:51], v[68:71], v[200:203], v[48:51]
    ds_read_b128 v[112:115], v12 offset:29696
    v_mfma_f32_16x16x32_bf16 v[28:31], v[68:71], v[196:199], v[28:31]
    ds_read_b128 v[116:119], v12 offset:30720
    v_mfma_f32_16x16x32_bf16 v[52:55], v[72:75], v[200:203], v[52:55]
    ds_read_b128 v[120:123], v20 offset:35840
    v_mfma_f32_16x16x32_bf16 v[32:35], v[72:75], v[196:199], v[32:35]
    buffer_load_dwordx4 v[164:167], v16, s[4:7], s32 offen offset:2048 sc1
    v_mfma_f32_16x16x32_bf16 v[56:59], v[76:79], v[200:203], v[56:59]
    v_mfma_f32_16x16x32_bf16 v[36:39], v[76:79], v[196:199], v[36:39]
    buffer_load_dwordx4 v[168:171], v17, s[4:7], s32 offen offset:2048 sc1
    v_mfma_f32_16x16x32_bf16 v[60:63], v[80:83], v[200:203], v[60:63]
    v_mfma_f32_16x16x32_bf16 v[40:43], v[80:83], v[196:199], v[40:43]
    s_waitcnt vmcnt(14) lgkmcnt(0)
    s_barrier
    v_mfma_f32_16x16x32_bf16 v[44:47], v[84:87], v[208:211], v[44:47]
    ds_read_b128 v[64:67], v13 offset:0
    v_mfma_f32_16x16x32_bf16 v[24:27], v[84:87], v[204:207], v[24:27]
    ds_read_b128 v[68:71], v13 offset:1024
    v_mfma_f32_16x16x32_bf16 v[48:51], v[88:91], v[208:211], v[48:51]
    ds_read_b128 v[72:75], v13 offset:2048
    v_mfma_f32_16x16x32_bf16 v[28:31], v[88:91], v[204:207], v[28:31]
    ds_read_b128 v[76:79], v13 offset:3072
    v_mfma_f32_16x16x32_bf16 v[52:55], v[92:95], v[208:211], v[52:55]
    ds_read_b128 v[80:83], v21 offset:8192
    v_mfma_f32_16x16x32_bf16 v[32:35], v[92:95], v[204:207], v[32:35]
    buffer_load_dwordx4 v[172:175], v16, s[4:7], s33 offen offset:0 sc1
    v_mfma_f32_16x16x32_bf16 v[56:59], v[96:99], v[208:211], v[56:59]
    v_mfma_f32_16x16x32_bf16 v[36:39], v[96:99], v[204:207], v[36:39]
    buffer_load_dwordx4 v[176:179], v17, s[4:7], s33 offen offset:0 sc1
    v_mfma_f32_16x16x32_bf16 v[60:63], v[100:103], v[208:211], v[60:63]
    v_mfma_f32_16x16x32_bf16 v[40:43], v[100:103], v[204:207], v[40:43]
    s_waitcnt vmcnt(14) lgkmcnt(5)
    v_mfma_f32_16x16x32_bf16 v[44:47], v[104:107], v[216:219], v[44:47]
    ds_read_b128 v[84:87], v13 offset:9216
    v_mfma_f32_16x16x32_bf16 v[24:27], v[104:107], v[212:215], v[24:27]
    ds_read_b128 v[88:91], v13 offset:10240
    v_mfma_f32_16x16x32_bf16 v[48:51], v[108:111], v[216:219], v[48:51]
    ds_read_b128 v[92:95], v13 offset:11264
    v_mfma_f32_16x16x32_bf16 v[28:31], v[108:111], v[212:215], v[28:31]
    ds_read_b128 v[96:99], v13 offset:12288
    v_mfma_f32_16x16x32_bf16 v[52:55], v[112:115], v[216:219], v[52:55]
    ds_read_b128 v[100:103], v21 offset:17408
    v_mfma_f32_16x16x32_bf16 v[32:35], v[112:115], v[212:215], v[32:35]
    buffer_load_dwordx4 v[180:183], v16, s[4:7], s33 offen offset:2048 sc1
    v_mfma_f32_16x16x32_bf16 v[56:59], v[116:119], v[216:219], v[56:59]
    v_mfma_f32_16x16x32_bf16 v[36:39], v[116:119], v[212:215], v[36:39]
    buffer_load_dwordx4 v[184:187], v17, s[4:7], s33 offen offset:2048 sc1
    v_mfma_f32_16x16x32_bf16 v[60:63], v[120:123], v[216:219], v[60:63]
    v_mfma_f32_16x16x32_bf16 v[40:43], v[120:123], v[212:215], v[40:43]
    s_waitcnt vmcnt(14) lgkmcnt(5)
    v_mfma_f32_16x16x32_bf16 v[44:47], v[64:67], v[128:131], v[44:47]
    ds_read_b128 v[104:107], v13 offset:18432
    s_mov_b32 s32, 5
    s_lshl_b32 s32, s32, 13
    s_add_u32 s32, s32, s29
    s_add_u32 s33, s32, 4096
    v_mfma_f32_16x16x32_bf16 v[24:27], v[64:67], v[124:127], v[24:27]
    ds_read_b128 v[108:111], v13 offset:19456
    v_mfma_f32_16x16x32_bf16 v[48:51], v[68:71], v[128:131], v[48:51]
    ds_read_b128 v[112:115], v13 offset:20480
    v_mfma_f32_16x16x32_bf16 v[28:31], v[68:71], v[124:127], v[28:31]
    ds_read_b128 v[116:119], v13 offset:21504
    v_mfma_f32_16x16x32_bf16 v[52:55], v[72:75], v[128:131], v[52:55]
    ds_read_b128 v[120:123], v21 offset:26624
    v_mfma_f32_16x16x32_bf16 v[32:35], v[72:75], v[124:127], v[32:35]
    buffer_load_dwordx4 v[188:191], v16, s[4:7], s32 offen offset:0 sc1
    v_mfma_f32_16x16x32_bf16 v[56:59], v[76:79], v[128:131], v[56:59]
    v_mfma_f32_16x16x32_bf16 v[36:39], v[76:79], v[124:127], v[36:39]
    buffer_load_dwordx4 v[192:195], v17, s[4:7], s32 offen offset:0 sc1
    v_mfma_f32_16x16x32_bf16 v[60:63], v[80:83], v[128:131], v[60:63]
    v_mfma_f32_16x16x32_bf16 v[40:43], v[80:83], v[124:127], v[40:43]
    s_waitcnt vmcnt(14) lgkmcnt(5)
    v_mfma_f32_16x16x32_bf16 v[44:47], v[84:87], v[136:139], v[44:47]
    ds_read_b128 v[64:67], v13 offset:27648
    v_mfma_f32_16x16x32_bf16 v[24:27], v[84:87], v[132:135], v[24:27]
    ds_read_b128 v[68:71], v13 offset:28672
    v_mfma_f32_16x16x32_bf16 v[48:51], v[88:91], v[136:139], v[48:51]
    ds_read_b128 v[72:75], v13 offset:29696
    v_mfma_f32_16x16x32_bf16 v[28:31], v[88:91], v[132:135], v[28:31]
    ds_read_b128 v[76:79], v13 offset:30720
    v_mfma_f32_16x16x32_bf16 v[52:55], v[92:95], v[136:139], v[52:55]
    ds_read_b128 v[80:83], v21 offset:35840
    v_mfma_f32_16x16x32_bf16 v[32:35], v[92:95], v[132:135], v[32:35]
    buffer_load_dwordx4 v[196:199], v16, s[4:7], s32 offen offset:2048 sc1
    v_mfma_f32_16x16x32_bf16 v[56:59], v[96:99], v[136:139], v[56:59]
    v_mfma_f32_16x16x32_bf16 v[36:39], v[96:99], v[132:135], v[36:39]
    buffer_load_dwordx4 v[200:203], v17, s[4:7], s32 offen offset:2048 sc1
    v_mfma_f32_16x16x32_bf16 v[60:63], v[100:103], v[136:139], v[60:63]
    v_mfma_f32_16x16x32_bf16 v[40:43], v[100:103], v[132:135], v[40:43]
    s_waitcnt vmcnt(14) lgkmcnt(0)
    s_barrier
    v_mfma_f32_16x16x32_bf16 v[44:47], v[104:107], v[144:147], v[44:47]
    ds_read_b128 v[84:87], v14 offset:0
    v_mfma_f32_16x16x32_bf16 v[24:27], v[104:107], v[140:143], v[24:27]
    ds_read_b128 v[88:91], v14 offset:1024
    v_mfma_f32_16x16x32_bf16 v[48:51], v[108:111], v[144:147], v[48:51]
    ds_read_b128 v[92:95], v14 offset:2048
    v_mfma_f32_16x16x32_bf16 v[28:31], v[108:111], v[140:143], v[28:31]
    ds_read_b128 v[96:99], v14 offset:3072
    v_mfma_f32_16x16x32_bf16 v[52:55], v[112:115], v[144:147], v[52:55]
    ds_read_b128 v[100:103], v22 offset:8192
    v_mfma_f32_16x16x32_bf16 v[32:35], v[112:115], v[140:143], v[32:35]
    buffer_load_dwordx4 v[204:207], v16, s[4:7], s33 offen offset:0 sc1
    v_mfma_f32_16x16x32_bf16 v[56:59], v[116:119], v[144:147], v[56:59]
    v_mfma_f32_16x16x32_bf16 v[36:39], v[116:119], v[140:143], v[36:39]
    buffer_load_dwordx4 v[208:211], v17, s[4:7], s33 offen offset:0 sc1
    v_mfma_f32_16x16x32_bf16 v[60:63], v[120:123], v[144:147], v[60:63]
    v_mfma_f32_16x16x32_bf16 v[40:43], v[120:123], v[140:143], v[40:43]
    s_waitcnt vmcnt(14) lgkmcnt(5)
    v_mfma_f32_16x16x32_bf16 v[44:47], v[64:67], v[152:155], v[44:47]
    ds_read_b128 v[104:107], v14 offset:9216
    v_mfma_f32_16x16x32_bf16 v[24:27], v[64:67], v[148:151], v[24:27]
    ds_read_b128 v[108:111], v14 offset:10240
    v_mfma_f32_16x16x32_bf16 v[48:51], v[68:71], v[152:155], v[48:51]
    ds_read_b128 v[112:115], v14 offset:11264
    v_mfma_f32_16x16x32_bf16 v[28:31], v[68:71], v[148:151], v[28:31]
    ds_read_b128 v[116:119], v14 offset:12288
    v_mfma_f32_16x16x32_bf16 v[52:55], v[72:75], v[152:155], v[52:55]
    ds_read_b128 v[120:123], v22 offset:17408
    v_mfma_f32_16x16x32_bf16 v[32:35], v[72:75], v[148:151], v[32:35]
    buffer_load_dwordx4 v[212:215], v16, s[4:7], s33 offen offset:2048 sc1
    v_mfma_f32_16x16x32_bf16 v[56:59], v[76:79], v[152:155], v[56:59]
    v_mfma_f32_16x16x32_bf16 v[36:39], v[76:79], v[148:151], v[36:39]
    buffer_load_dwordx4 v[216:219], v17, s[4:7], s33 offen offset:2048 sc1
    v_mfma_f32_16x16x32_bf16 v[60:63], v[80:83], v[152:155], v[60:63]
    v_mfma_f32_16x16x32_bf16 v[40:43], v[80:83], v[148:151], v[40:43]
    s_waitcnt vmcnt(14) lgkmcnt(5)
    v_mfma_f32_16x16x32_bf16 v[44:47], v[84:87], v[160:163], v[44:47]
    ds_read_b128 v[64:67], v14 offset:18432
    s_mov_b32 s32, 6
    s_lshl_b32 s32, s32, 13
    s_add_u32 s32, s32, s29
    s_add_u32 s33, s32, 4096
    v_mfma_f32_16x16x32_bf16 v[24:27], v[84:87], v[156:159], v[24:27]
    ds_read_b128 v[68:71], v14 offset:19456
    v_mfma_f32_16x16x32_bf16 v[48:51], v[88:91], v[160:163], v[48:51]
    ds_read_b128 v[72:75], v14 offset:20480
    v_mfma_f32_16x16x32_bf16 v[28:31], v[88:91], v[156:159], v[28:31]
    ds_read_b128 v[76:79], v14 offset:21504
    v_mfma_f32_16x16x32_bf16 v[52:55], v[92:95], v[160:163], v[52:55]
    ds_read_b128 v[80:83], v22 offset:26624
    v_mfma_f32_16x16x32_bf16 v[32:35], v[92:95], v[156:159], v[32:35]
    buffer_load_dwordx4 v[124:127], v16, s[4:7], s32 offen offset:0 sc1
    v_mfma_f32_16x16x32_bf16 v[56:59], v[96:99], v[160:163], v[56:59]
    v_mfma_f32_16x16x32_bf16 v[36:39], v[96:99], v[156:159], v[36:39]
    buffer_load_dwordx4 v[128:131], v17, s[4:7], s32 offen offset:0 sc1
    v_mfma_f32_16x16x32_bf16 v[60:63], v[100:103], v[160:163], v[60:63]
    v_mfma_f32_16x16x32_bf16 v[40:43], v[100:103], v[156:159], v[40:43]
    s_waitcnt vmcnt(14) lgkmcnt(5)
    v_mfma_f32_16x16x32_bf16 v[44:47], v[104:107], v[168:171], v[44:47]
    ds_read_b128 v[84:87], v14 offset:27648
    v_mfma_f32_16x16x32_bf16 v[24:27], v[104:107], v[164:167], v[24:27]
    ds_read_b128 v[88:91], v14 offset:28672
    v_mfma_f32_16x16x32_bf16 v[48:51], v[108:111], v[168:171], v[48:51]
    ds_read_b128 v[92:95], v14 offset:29696
    v_mfma_f32_16x16x32_bf16 v[28:31], v[108:111], v[164:167], v[28:31]
    ds_read_b128 v[96:99], v14 offset:30720
    v_mfma_f32_16x16x32_bf16 v[52:55], v[112:115], v[168:171], v[52:55]
    ds_read_b128 v[100:103], v22 offset:35840
    v_mfma_f32_16x16x32_bf16 v[32:35], v[112:115], v[164:167], v[32:35]
    buffer_load_dwordx4 v[132:135], v16, s[4:7], s32 offen offset:2048 sc1
    v_mfma_f32_16x16x32_bf16 v[56:59], v[116:119], v[168:171], v[56:59]
    v_mfma_f32_16x16x32_bf16 v[36:39], v[116:119], v[164:167], v[36:39]
    buffer_load_dwordx4 v[136:139], v17, s[4:7], s32 offen offset:2048 sc1
    v_mfma_f32_16x16x32_bf16 v[60:63], v[120:123], v[168:171], v[60:63]
    v_mfma_f32_16x16x32_bf16 v[40:43], v[120:123], v[164:167], v[40:43]
    s_waitcnt vmcnt(14) lgkmcnt(0)
    s_barrier
    v_mfma_f32_16x16x32_bf16 v[44:47], v[64:67], v[176:179], v[44:47]
    ds_read_b128 v[104:107], v15 offset:0
    v_mfma_f32_16x16x32_bf16 v[24:27], v[64:67], v[172:175], v[24:27]
    ds_read_b128 v[108:111], v15 offset:1024
    v_mfma_f32_16x16x32_bf16 v[48:51], v[68:71], v[176:179], v[48:51]
    ds_read_b128 v[112:115], v15 offset:2048
    v_mfma_f32_16x16x32_bf16 v[28:31], v[68:71], v[172:175], v[28:31]
    ds_read_b128 v[116:119], v15 offset:3072
    v_mfma_f32_16x16x32_bf16 v[52:55], v[72:75], v[176:179], v[52:55]
    ds_read_b128 v[120:123], v23 offset:8192
    v_mfma_f32_16x16x32_bf16 v[32:35], v[72:75], v[172:175], v[32:35]
    buffer_load_dwordx4 v[140:143], v16, s[4:7], s33 offen offset:0 sc1
    v_mfma_f32_16x16x32_bf16 v[56:59], v[76:79], v[176:179], v[56:59]
    v_mfma_f32_16x16x32_bf16 v[36:39], v[76:79], v[172:175], v[36:39]
    buffer_load_dwordx4 v[144:147], v17, s[4:7], s33 offen offset:0 sc1
    v_mfma_f32_16x16x32_bf16 v[60:63], v[80:83], v[176:179], v[60:63]
    v_mfma_f32_16x16x32_bf16 v[40:43], v[80:83], v[172:175], v[40:43]
    s_waitcnt vmcnt(14) lgkmcnt(5)
    v_mfma_f32_16x16x32_bf16 v[44:47], v[84:87], v[184:187], v[44:47]
    ds_read_b128 v[64:67], v15 offset:9216
    v_mfma_f32_16x16x32_bf16 v[24:27], v[84:87], v[180:183], v[24:27]
    ds_read_b128 v[68:71], v15 offset:10240
    v_mfma_f32_16x16x32_bf16 v[48:51], v[88:91], v[184:187], v[48:51]
    ds_read_b128 v[72:75], v15 offset:11264
    v_mfma_f32_16x16x32_bf16 v[28:31], v[88:91], v[180:183], v[28:31]
    ds_read_b128 v[76:79], v15 offset:12288
    v_mfma_f32_16x16x32_bf16 v[52:55], v[92:95], v[184:187], v[52:55]
    ds_read_b128 v[80:83], v23 offset:17408
    v_mfma_f32_16x16x32_bf16 v[32:35], v[92:95], v[180:183], v[32:35]
    buffer_load_dwordx4 v[148:151], v16, s[4:7], s33 offen offset:2048 sc1
    v_mfma_f32_16x16x32_bf16 v[56:59], v[96:99], v[184:187], v[56:59]
    v_mfma_f32_16x16x32_bf16 v[36:39], v[96:99], v[180:183], v[36:39]
    buffer_load_dwordx4 v[152:155], v17, s[4:7], s33 offen offset:2048 sc1
    v_mfma_f32_16x16x32_bf16 v[60:63], v[100:103], v[184:187], v[60:63]
    v_mfma_f32_16x16x32_bf16 v[40:43], v[100:103], v[180:183], v[40:43]
    s_waitcnt vmcnt(14) lgkmcnt(5)
    v_mfma_f32_16x16x32_bf16 v[44:47], v[104:107], v[192:195], v[44:47]
    ds_read_b128 v[84:87], v15 offset:18432
    s_mov_b32 s32, 7
    s_lshl_b32 s32, s32, 13
    s_add_u32 s32, s32, s29
    s_add_u32 s33, s32, 4096
    v_mfma_f32_16x16x32_bf16 v[24:27], v[104:107], v[188:191], v[24:27]
    ds_read_b128 v[88:91], v15 offset:19456
    v_mfma_f32_16x16x32_bf16 v[48:51], v[108:111], v[192:195], v[48:51]
    ds_read_b128 v[92:95], v15 offset:20480
    v_mfma_f32_16x16x32_bf16 v[28:31], v[108:111], v[188:191], v[28:31]
    ds_read_b128 v[96:99], v15 offset:21504
    v_mfma_f32_16x16x32_bf16 v[52:55], v[112:115], v[192:195], v[52:55]
    ds_read_b128 v[100:103], v23 offset:26624
    v_mfma_f32_16x16x32_bf16 v[32:35], v[112:115], v[188:191], v[32:35]
    buffer_load_dwordx4 v[156:159], v16, s[4:7], s32 offen offset:0 sc1
    v_mfma_f32_16x16x32_bf16 v[56:59], v[116:119], v[192:195], v[56:59]
    v_mfma_f32_16x16x32_bf16 v[36:39], v[116:119], v[188:191], v[36:39]
    buffer_load_dwordx4 v[160:163], v17, s[4:7], s32 offen offset:0 sc1
    v_mfma_f32_16x16x32_bf16 v[60:63], v[120:123], v[192:195], v[60:63]
    v_mfma_f32_16x16x32_bf16 v[40:43], v[120:123], v[188:191], v[40:43]
    s_waitcnt vmcnt(14) lgkmcnt(5)
    v_mfma_f32_16x16x32_bf16 v[44:47], v[64:67], v[200:203], v[44:47]
    ds_read_b128 v[104:107], v15 offset:27648
    v_mfma_f32_16x16x32_bf16 v[24:27], v[64:67], v[196:199], v[24:27]
    ds_read_b128 v[108:111], v15 offset:28672
    v_mfma_f32_16x16x32_bf16 v[48:51], v[68:71], v[200:203], v[48:51]
    ds_read_b128 v[112:115], v15 offset:29696
    v_mfma_f32_16x16x32_bf16 v[28:31], v[68:71], v[196:199], v[28:31]
    ds_read_b128 v[116:119], v15 offset:30720
    v_mfma_f32_16x16x32_bf16 v[52:55], v[72:75], v[200:203], v[52:55]
    ds_read_b128 v[120:123], v23 offset:35840
    v_mfma_f32_16x16x32_bf16 v[32:35], v[72:75], v[196:199], v[32:35]
    buffer_load_dwordx4 v[164:167], v16, s[4:7], s32 offen offset:2048 sc1
    v_mfma_f32_16x16x32_bf16 v[56:59], v[76:79], v[200:203], v[56:59]
    v_mfma_f32_16x16x32_bf16 v[36:39], v[76:79], v[196:199], v[36:39]
    buffer_load_dwordx4 v[168:171], v17, s[4:7], s32 offen offset:2048 sc1
    v_mfma_f32_16x16x32_bf16 v[60:63], v[80:83], v[200:203], v[60:63]
    v_mfma_f32_16x16x32_bf16 v[40:43], v[80:83], v[196:199], v[40:43]
    s_waitcnt vmcnt(14) lgkmcnt(0)
    s_barrier
    v_mfma_f32_16x16x32_bf16 v[44:47], v[84:87], v[208:211], v[44:47]
    ds_read_b128 v[64:67], v12 offset:0
    v_mfma_f32_16x16x32_bf16 v[24:27], v[84:87], v[204:207], v[24:27]
    ds_read_b128 v[68:71], v12 offset:1024
    v_mfma_f32_16x16x32_bf16 v[48:51], v[88:91], v[208:211], v[48:51]
    ds_read_b128 v[72:75], v12 offset:2048
    v_mfma_f32_16x16x32_bf16 v[28:31], v[88:91], v[204:207], v[28:31]
    ds_read_b128 v[76:79], v12 offset:3072
    v_mfma_f32_16x16x32_bf16 v[52:55], v[92:95], v[208:211], v[52:55]
    ds_read_b128 v[80:83], v20 offset:8192
    v_mfma_f32_16x16x32_bf16 v[32:35], v[92:95], v[204:207], v[32:35]
    buffer_load_dwordx4 v[172:175], v16, s[4:7], s33 offen offset:0 sc1
    v_mfma_f32_16x16x32_bf16 v[56:59], v[96:99], v[208:211], v[56:59]
    v_mfma_f32_16x16x32_bf16 v[36:39], v[96:99], v[204:207], v[36:39]
    buffer_load_dwordx4 v[176:179], v17, s[4:7], s33 offen offset:0 sc1
    v_mfma_f32_16x16x32_bf16 v[60:63], v[100:103], v[208:211], v[60:63]
    v_mfma_f32_16x16x32_bf16 v[40:43], v[100:103], v[204:207], v[40:43]
    s_waitcnt vmcnt(14) lgkmcnt(5)
    v_mfma_f32_16x16x32_bf16 v[44:47], v[104:107], v[216:219], v[44:47]
    ds_read_b128 v[84:87], v12 offset:9216
    v_mfma_f32_16x16x32_bf16 v[24:27], v[104:107], v[212:215], v[24:27]
    ds_read_b128 v[88:91], v12 offset:10240
    v_mfma_f32_16x16x32_bf16 v[48:51], v[108:111], v[216:219], v[48:51]
    ds_read_b128 v[92:95], v12 offset:11264
    v_mfma_f32_16x16x32_bf16 v[28:31], v[108:111], v[212:215], v[28:31]
    ds_read_b128 v[96:99], v12 offset:12288
    v_mfma_f32_16x16x32_bf16 v[52:55], v[112:115], v[216:219], v[52:55]
    ds_read_b128 v[100:103], v20 offset:17408
    v_mfma_f32_16x16x32_bf16 v[32:35], v[112:115], v[212:215], v[32:35]
    buffer_load_dwordx4 v[180:183], v16, s[4:7], s33 offen offset:2048 sc1
    v_mfma_f32_16x16x32_bf16 v[56:59], v[116:119], v[216:219], v[56:59]
    v_mfma_f32_16x16x32_bf16 v[36:39], v[116:119], v[212:215], v[36:39]
    buffer_load_dwordx4 v[184:187], v17, s[4:7], s33 offen offset:2048 sc1
    v_mfma_f32_16x16x32_bf16 v[60:63], v[120:123], v[216:219], v[60:63]
    v_mfma_f32_16x16x32_bf16 v[40:43], v[120:123], v[212:215], v[40:43]
    s_waitcnt vmcnt(14) lgkmcnt(5)
    v_mfma_f32_16x16x32_bf16 v[44:47], v[64:67], v[128:131], v[44:47]
    ds_read_b128 v[104:107], v12 offset:18432
    s_mov_b32 s32, 8
    s_lshl_b32 s32, s32, 13
    s_add_u32 s32, s32, s29
    s_add_u32 s33, s32, 4096
    v_mfma_f32_16x16x32_bf16 v[24:27], v[64:67], v[124:127], v[24:27]
    ds_read_b128 v[108:111], v12 offset:19456
    v_mfma_f32_16x16x32_bf16 v[48:51], v[68:71], v[128:131], v[48:51]
    ds_read_b128 v[112:115], v12 offset:20480
    v_mfma_f32_16x16x32_bf16 v[28:31], v[68:71], v[124:127], v[28:31]
    ds_read_b128 v[116:119], v12 offset:21504
    v_mfma_f32_16x16x32_bf16 v[52:55], v[72:75], v[128:131], v[52:55]
    ds_read_b128 v[120:123], v20 offset:26624
    v_mfma_f32_16x16x32_bf16 v[32:35], v[72:75], v[124:127], v[32:35]
    buffer_load_dwordx2 v[188:189], v18, s[4:7], s32 offen offset:0 sc1
    v_mfma_f32_16x16x32_bf16 v[56:59], v[76:79], v[128:131], v[56:59]
    buffer_load_dwordx2 v[190:191], v18, s[4:7], s32 offen offset:512 sc1
    v_mfma_f32_16x16x32_bf16 v[36:39], v[76:79], v[124:127], v[36:39]
    buffer_load_dwordx2 v[192:193], v19, s[4:7], s32 offen offset:0 sc1
    v_mfma_f32_16x16x32_bf16 v[60:63], v[80:83], v[128:131], v[60:63]
    buffer_load_dwordx2 v[194:195], v19, s[4:7], s32 offen offset:512 sc1
    v_mfma_f32_16x16x32_bf16 v[40:43], v[80:83], v[124:127], v[40:43]
    s_waitcnt vmcnt(16) lgkmcnt(5)
    v_mfma_f32_16x16x32_bf16 v[44:47], v[84:87], v[136:139], v[44:47]
    ds_read_b128 v[64:67], v12 offset:27648
    v_mfma_f32_16x16x32_bf16 v[24:27], v[84:87], v[132:135], v[24:27]
    ds_read_b128 v[68:71], v12 offset:28672
    v_mfma_f32_16x16x32_bf16 v[48:51], v[88:91], v[136:139], v[48:51]
    ds_read_b128 v[72:75], v12 offset:29696
    v_mfma_f32_16x16x32_bf16 v[28:31], v[88:91], v[132:135], v[28:31]
    ds_read_b128 v[76:79], v12 offset:30720
    v_mfma_f32_16x16x32_bf16 v[52:55], v[92:95], v[136:139], v[52:55]
    ds_read_b128 v[80:83], v20 offset:35840
    v_mfma_f32_16x16x32_bf16 v[32:35], v[92:95], v[132:135], v[32:35]
    buffer_load_dwordx2 v[196:197], v18, s[4:7], s32 offen offset:2048 sc1
    v_mfma_f32_16x16x32_bf16 v[56:59], v[96:99], v[136:139], v[56:59]
    buffer_load_dwordx2 v[198:199], v18, s[4:7], s32 offen offset:2560 sc1
    v_mfma_f32_16x16x32_bf16 v[36:39], v[96:99], v[132:135], v[36:39]
    buffer_load_dwordx2 v[200:201], v19, s[4:7], s32 offen offset:2048 sc1
    v_mfma_f32_16x16x32_bf16 v[60:63], v[100:103], v[136:139], v[60:63]
    buffer_load_dwordx2 v[202:203], v19, s[4:7], s32 offen offset:2560 sc1
    v_mfma_f32_16x16x32_bf16 v[40:43], v[100:103], v[132:135], v[40:43]
    s_waitcnt vmcnt(18) lgkmcnt(0)
    s_barrier
    v_mfma_f32_16x16x32_bf16 v[44:47], v[104:107], v[144:147], v[44:47]
    ds_read_b128 v[84:87], v13 offset:0
    v_mfma_f32_16x16x32_bf16 v[24:27], v[104:107], v[140:143], v[24:27]
    ds_read_b128 v[88:91], v13 offset:1024
    v_mfma_f32_16x16x32_bf16 v[48:51], v[108:111], v[144:147], v[48:51]
    ds_read_b128 v[92:95], v13 offset:2048
    v_mfma_f32_16x16x32_bf16 v[28:31], v[108:111], v[140:143], v[28:31]
    ds_read_b128 v[96:99], v13 offset:3072
    v_mfma_f32_16x16x32_bf16 v[52:55], v[112:115], v[144:147], v[52:55]
    ds_read_b128 v[100:103], v21 offset:8192
    v_mfma_f32_16x16x32_bf16 v[32:35], v[112:115], v[140:143], v[32:35]
    buffer_load_dwordx2 v[204:205], v18, s[4:7], s33 offen offset:0 sc1
    v_mfma_f32_16x16x32_bf16 v[56:59], v[116:119], v[144:147], v[56:59]
    buffer_load_dwordx2 v[206:207], v18, s[4:7], s33 offen offset:512 sc1
    v_mfma_f32_16x16x32_bf16 v[36:39], v[116:119], v[140:143], v[36:39]
    buffer_load_dwordx2 v[208:209], v19, s[4:7], s33 offen offset:0 sc1
    v_mfma_f32_16x16x32_bf16 v[60:63], v[120:123], v[144:147], v[60:63]
    buffer_load_dwordx2 v[210:211], v19, s[4:7], s33 offen offset:512 sc1
    v_mfma_f32_16x16x32_bf16 v[40:43], v[120:123], v[140:143], v[40:43]
    s_waitcnt vmcnt(20) lgkmcnt(5)
    v_mfma_f32_16x16x32_bf16 v[44:47], v[64:67], v[152:155], v[44:47]
    ds_read_b128 v[104:107], v13 offset:9216
    v_mfma_f32_16x16x32_bf16 v[24:27], v[64:67], v[148:151], v[24:27]
    ds_read_b128 v[108:111], v13 offset:10240
    v_mfma_f32_16x16x32_bf16 v[48:51], v[68:71], v[152:155], v[48:51]
    ds_read_b128 v[112:115], v13 offset:11264
    v_mfma_f32_16x16x32_bf16 v[28:31], v[68:71], v[148:151], v[28:31]
    ds_read_b128 v[116:119], v13 offset:12288
    v_mfma_f32_16x16x32_bf16 v[52:55], v[72:75], v[152:155], v[52:55]
    ds_read_b128 v[120:123], v21 offset:17408
    v_mfma_f32_16x16x32_bf16 v[32:35], v[72:75], v[148:151], v[32:35]
    buffer_load_dwordx2 v[212:213], v18, s[4:7], s33 offen offset:2048 sc1
    v_mfma_f32_16x16x32_bf16 v[56:59], v[76:79], v[152:155], v[56:59]
    buffer_load_dwordx2 v[214:215], v18, s[4:7], s33 offen offset:2560 sc1
    v_mfma_f32_16x16x32_bf16 v[36:39], v[76:79], v[148:151], v[36:39]
    buffer_load_dwordx2 v[216:217], v19, s[4:7], s33 offen offset:2048 sc1
    v_mfma_f32_16x16x32_bf16 v[60:63], v[80:83], v[152:155], v[60:63]
    buffer_load_dwordx2 v[218:219], v19, s[4:7], s33 offen offset:2560 sc1
    v_mfma_f32_16x16x32_bf16 v[40:43], v[80:83], v[148:151], v[40:43]
    s_waitcnt vmcnt(22) lgkmcnt(5)
    v_mfma_f32_16x16x32_bf16 v[44:47], v[84:87], v[160:163], v[44:47]
    ds_read_b128 v[64:67], v13 offset:18432
    v_mfma_f32_16x16x32_bf16 v[24:27], v[84:87], v[156:159], v[24:27]
    ds_read_b128 v[68:71], v13 offset:19456
    v_mfma_f32_16x16x32_bf16 v[48:51], v[88:91], v[160:163], v[48:51]
    ds_read_b128 v[72:75], v13 offset:20480
    v_mfma_f32_16x16x32_bf16 v[28:31], v[88:91], v[156:159], v[28:31]
    ds_read_b128 v[76:79], v13 offset:21504
    v_mfma_f32_16x16x32_bf16 v[52:55], v[92:95], v[160:163], v[52:55]
    ds_read_b128 v[80:83], v21 offset:26624
    v_mfma_f32_16x16x32_bf16 v[32:35], v[92:95], v[156:159], v[32:35]
    v_mfma_f32_16x16x32_bf16 v[56:59], v[96:99], v[160:163], v[56:59]
    v_mfma_f32_16x16x32_bf16 v[36:39], v[96:99], v[156:159], v[36:39]
    v_mfma_f32_16x16x32_bf16 v[60:63], v[100:103], v[160:163], v[60:63]
    v_mfma_f32_16x16x32_bf16 v[40:43], v[100:103], v[156:159], v[40:43]
    s_waitcnt vmcnt(20) lgkmcnt(5)
    v_mfma_f32_16x16x32_bf16 v[44:47], v[104:107], v[168:171], v[44:47]
    ds_read_b128 v[84:87], v13 offset:27648
    v_mfma_f32_16x16x32_bf16 v[24:27], v[104:107], v[164:167], v[24:27]
    ds_read_b128 v[88:91], v13 offset:28672
    v_mfma_f32_16x16x32_bf16 v[48:51], v[108:111], v[168:171], v[48:51]
    ds_read_b128 v[92:95], v13 offset:29696
    v_mfma_f32_16x16x32_bf16 v[28:31], v[108:111], v[164:167], v[28:31]
    ds_read_b128 v[96:99], v13 offset:30720
    v_mfma_f32_16x16x32_bf16 v[52:55], v[112:115], v[168:171], v[52:55]
    ds_read_b128 v[100:103], v21 offset:35840
    v_mfma_f32_16x16x32_bf16 v[32:35], v[112:115], v[164:167], v[32:35]
    v_mfma_f32_16x16x32_bf16 v[56:59], v[116:119], v[168:171], v[56:59]
    v_mfma_f32_16x16x32_bf16 v[36:39], v[116:119], v[164:167], v[36:39]
    v_mfma_f32_16x16x32_bf16 v[60:63], v[120:123], v[168:171], v[60:63]
    v_mfma_f32_16x16x32_bf16 v[40:43], v[120:123], v[164:167], v[40:43]
    s_waitcnt vmcnt(18) lgkmcnt(0)
    s_barrier
    v_mfma_f32_16x16x32_bf16 v[44:47], v[64:67], v[176:179], v[44:47]
    ds_read_b128 v[104:107], v14 offset:0
    v_mfma_f32_16x16x32_bf16 v[24:27], v[64:67], v[172:175], v[24:27]
    ds_read_b128 v[108:111], v14 offset:1024
    v_mfma_f32_16x16x32_bf16 v[48:51], v[68:71], v[176:179], v[48:51]
    ds_read_b128 v[112:115], v14 offset:2048
    v_mfma_f32_16x16x32_bf16 v[28:31], v[68:71], v[172:175], v[28:31]
    ds_read_b128 v[116:119], v14 offset:3072
    v_mfma_f32_16x16x32_bf16 v[52:55], v[72:75], v[176:179], v[52:55]
    ds_read_b128 v[120:123], v22 offset:8192
    v_mfma_f32_16x16x32_bf16 v[32:35], v[72:75], v[172:175], v[32:35]
    v_mfma_f32_16x16x32_bf16 v[56:59], v[76:79], v[176:179], v[56:59]
    v_mfma_f32_16x16x32_bf16 v[36:39], v[76:79], v[172:175], v[36:39]
    v_mfma_f32_16x16x32_bf16 v[60:63], v[80:83], v[176:179], v[60:63]
    v_mfma_f32_16x16x32_bf16 v[40:43], v[80:83], v[172:175], v[40:43]
    s_waitcnt vmcnt(16) lgkmcnt(5)
    v_mfma_f32_16x16x32_bf16 v[44:47], v[84:87], v[184:187], v[44:47]
    ds_read_b128 v[64:67], v14 offset:9216
    v_mfma_f32_16x16x32_bf16 v[24:27], v[84:87], v[180:183], v[24:27]
    ds_read_b128 v[68:71], v14 offset:10240
    v_mfma_f32_16x16x32_bf16 v[48:51], v[88:91], v[184:187], v[48:51]
    ds_read_b128 v[72:75], v14 offset:11264
    v_mfma_f32_16x16x32_bf16 v[28:31], v[88:91], v[180:183], v[28:31]
    ds_read_b128 v[76:79], v14 offset:12288
    v_mfma_f32_16x16x32_bf16 v[52:55], v[92:95], v[184:187], v[52:55]
    ds_read_b128 v[80:83], v22 offset:17408
    v_mfma_f32_16x16x32_bf16 v[32:35], v[92:95], v[180:183], v[32:35]
    v_mfma_f32_16x16x32_bf16 v[56:59], v[96:99], v[184:187], v[56:59]
    v_mfma_f32_16x16x32_bf16 v[36:39], v[96:99], v[180:183], v[36:39]
    v_mfma_f32_16x16x32_bf16 v[60:63], v[100:103], v[184:187], v[60:63]
    v_mfma_f32_16x16x32_bf16 v[40:43], v[100:103], v[180:183], v[40:43]
    s_waitcnt vmcnt(12) lgkmcnt(5)
    v_mfma_f32_16x16x32_bf16 v[44:47], v[104:107], v[192:195], v[44:47]
    ds_read_b128 v[84:87], v14 offset:18432
    v_mfma_f32_16x16x32_bf16 v[24:27], v[104:107], v[188:191], v[24:27]
    ds_read_b128 v[88:91], v14 offset:19456
    v_mfma_f32_16x16x32_bf16 v[48:51], v[108:111], v[192:195], v[48:51]
    ds_read_b128 v[92:95], v14 offset:20480
    v_mfma_f32_16x16x32_bf16 v[28:31], v[108:111], v[188:191], v[28:31]
    ds_read_b128 v[96:99], v14 offset:21504
    v_mfma_f32_16x16x32_bf16 v[52:55], v[112:115], v[192:195], v[52:55]
    ds_read_b128 v[100:103], v22 offset:26624
    v_mfma_f32_16x16x32_bf16 v[32:35], v[112:115], v[188:191], v[32:35]
    v_mfma_f32_16x16x32_bf16 v[56:59], v[116:119], v[192:195], v[56:59]
    v_mfma_f32_16x16x32_bf16 v[36:39], v[116:119], v[188:191], v[36:39]
    v_mfma_f32_16x16x32_bf16 v[60:63], v[120:123], v[192:195], v[60:63]
    v_mfma_f32_16x16x32_bf16 v[40:43], v[120:123], v[188:191], v[40:43]
    s_waitcnt vmcnt(8) lgkmcnt(5)
    v_mfma_f32_16x16x32_bf16 v[44:47], v[64:67], v[200:203], v[44:47]
    ds_read_b128 v[104:107], v14 offset:27648
    v_mfma_f32_16x16x32_bf16 v[24:27], v[64:67], v[196:199], v[24:27]
    ds_read_b128 v[108:111], v14 offset:28672
    v_mfma_f32_16x16x32_bf16 v[48:51], v[68:71], v[200:203], v[48:51]
    ds_read_b128 v[112:115], v14 offset:29696
    v_mfma_f32_16x16x32_bf16 v[28:31], v[68:71], v[196:199], v[28:31]
    ds_read_b128 v[116:119], v14 offset:30720
    v_mfma_f32_16x16x32_bf16 v[52:55], v[72:75], v[200:203], v[52:55]
    ds_read_b128 v[120:123], v22 offset:35840
    v_mfma_f32_16x16x32_bf16 v[32:35], v[72:75], v[196:199], v[32:35]
    v_mfma_f32_16x16x32_bf16 v[56:59], v[76:79], v[200:203], v[56:59]
    v_mfma_f32_16x16x32_bf16 v[36:39], v[76:79], v[196:199], v[36:39]
    v_mfma_f32_16x16x32_bf16 v[60:63], v[80:83], v[200:203], v[60:63]
    v_mfma_f32_16x16x32_bf16 v[40:43], v[80:83], v[196:199], v[40:43]
    s_waitcnt vmcnt(4) lgkmcnt(5)
    v_mfma_f32_16x16x32_bf16 v[44:47], v[84:87], v[208:211], v[44:47]
    v_mfma_f32_16x16x32_bf16 v[48:51], v[88:91], v[208:211], v[48:51]
    v_mfma_f32_16x16x32_bf16 v[52:55], v[92:95], v[208:211], v[52:55]
    v_mfma_f32_16x16x32_bf16 v[56:59], v[96:99], v[208:211], v[56:59]
    v_mfma_f32_16x16x32_bf16 v[60:63], v[100:103], v[208:211], v[60:63]
    s_waitcnt vmcnt(0) lgkmcnt(0)
    v_mfma_f32_16x16x32_bf16 v[44:47], v[104:107], v[216:219], v[44:47]
    v_mfma_f32_16x16x32_bf16 v[48:51], v[108:111], v[216:219], v[48:51]
    v_mfma_f32_16x16x32_bf16 v[52:55], v[112:115], v[216:219], v[52:55]
    v_mfma_f32_16x16x32_bf16 v[56:59], v[116:119], v[216:219], v[56:59]
    v_mfma_f32_16x16x32_bf16 v[60:63], v[120:123], v[216:219], v[60:63]
    v_mfma_f32_16x16x32_bf16 v[24:27], v[84:87], v[204:207], v[24:27]
    v_mfma_f32_16x16x32_bf16 v[28:31], v[88:91], v[204:207], v[28:31]
    v_mfma_f32_16x16x32_bf16 v[32:35], v[92:95], v[204:207], v[32:35]
    v_mfma_f32_16x16x32_bf16 v[36:39], v[96:99], v[204:207], v[36:39]
    ds_write_b128 v2, v[44:47] offset:0
    v_mfma_f32_16x16x32_bf16 v[40:43], v[100:103], v[204:207], v[40:43]
    ds_write_b128 v2, v[48:51] offset:1024
    v_mfma_f32_16x16x32_bf16 v[24:27], v[104:107], v[212:215], v[24:27]
    v_mfma_f32_16x16x32_bf16 v[28:31], v[108:111], v[212:215], v[28:31]
    ds_write_b128 v2, v[52:55] offset:2048
    v_mfma_f32_16x16x32_bf16 v[32:35], v[112:115], v[212:215], v[32:35]
    ds_write_b128 v2, v[56:59] offset:3072
    v_mfma_f32_16x16x32_bf16 v[36:39], v[116:119], v[212:215], v[36:39]
    v_mfma_f32_16x16x32_bf16 v[40:43], v[120:123], v[212:215], v[40:43]
    s_mov_b64 exec, s[40:41]
    ds_write_b128 v3, v[60:63] offset:4096
    s_mov_b64 exec, -1
    ds_write_b32 v0, v9
    s_mov_b32 s60, 1048576
L_px_p5:
    ds_read_b32 v232, v6
    ds_read_b128 v[64:67], v7 offset:0
    ds_read_b128 v[68:71], v7 offset:1024
    ds_read_b128 v[72:75], v7 offset:2048
    ds_read_b128 v[76:79], v7 offset:3072
    ds_read_b128 v[80:83], v8 offset:4096
    s_waitcnt lgkmcnt(5)
    v_cmp_ne_u32 vcc, s43, v232
    s_sub_u32 s60, s60, 1
    s_cbranch_scc1 L_py_p5
    s_cbranch_vccnz L_px_p5
L_py_p5:
    s_waitcnt lgkmcnt(4)
    v_pk_add_f32 v[24:25], v[24:25], v[64:65]
    v_pk_add_f32 v[26:27], v[26:27], v[66:67]
    v_cvt_pk_bf16_f32 v220, v24, v25
    v_cvt_pk_bf16_f32 v221, v26, v27
    s_waitcnt lgkmcnt(3)
    v_pk_add_f32 v[28:29], v[28:29], v[68:69]
    v_pk_add_f32 v[30:31], v[30:31], v[70:71]
    v_cvt_pk_bf16_f32 v222, v28, v29
    v_cvt_pk_bf16_f32 v223, v30, v31
    s_waitcnt lgkmcnt(2)
    v_pk_add_f32 v[32:33], v[32:33], v[72:73]
    v_pk_add_f32 v[34:35], v[34:35], v[74:75]
    v_cvt_pk_bf16_f32 v224, v32, v33
    v_cvt_pk_bf16_f32 v225, v34, v35
    s_waitcnt lgkmcnt(1)
    v_pk_add_f32 v[36:37], v[36:37], v[76:77]
    v_pk_add_f32 v[38:39], v[38:39], v[78:79]
    v_cvt_pk_bf16_f32 v226, v36, v37
    v_cvt_pk_bf16_f32 v227, v38, v39
    s_waitcnt lgkmcnt(0)
    v_pk_add_f32 v[40:41], v[40:41], v[80:81]
    v_pk_add_f32 v[42:43], v[42:43], v[82:83]
    v_cvt_pk_bf16_f32 v228, v40, v41
    v_cvt_pk_bf16_f32 v229, v42, v43
    s_cmp_eq_u32 s22, 1
    s_cbranch_scc1 L_fin_p5
    buffer_store_dwordx4 v[220:223], v4, s[4:7], s34 offen offset:0 sc1
    buffer_store_dwordx4 v[224:227], v4, s[4:7], s34 offen offset:1024 sc1
    buffer_store_dwordx2 v[228:229], v5, s[4:7], s34 offen sc1
    v_cndmask_b32 v234, 0, v228, s[40:41]
    v_cndmask_b32 v235, 0, v229, s[40:41]
    v_dot2_f32_bf16 v232, v220, v11, 0
    v_dot2_f32_bf16 v233, v220, v220, 0
    v_dot2_f32_bf16 v232, v221, v11, v232
    v_dot2_f32_bf16 v233, v221, v221, v233
    v_dot2_f32_bf16 v232, v222, v11, v232
    v_dot2_f32_bf16 v233, v222, v222, v233
    v_dot2_f32_bf16 v232, v223, v11, v232
    v_dot2_f32_bf16 v233, v223, v223, v233
    v_dot2_f32_bf16 v232, v224, v11, v232
    v_dot2_f32_bf16 v233, v224, v224, v233
    v_dot2_f32_bf16 v232, v225, v11, v232
    v_dot2_f32_bf16 v233, v225, v225, v233
    v_dot2_f32_bf16 v232, v226, v11, v232
    v_dot2_f32_bf16 v233, v226, v226, v233
    v_dot2_f32_bf16 v232, v227, v11, v232
    v_dot2_f32_bf16 v233, v227, v227, v233
    v_dot2_f32_bf16 v232, v234, v11, v232
    v_dot2_f32_bf16 v233, v234, v234, v233
    v_dot2_f32_bf16 v232, v235, v11, v232
    v_dot2_f32_bf16 v233, v235, v235, v233
    s_nop 2
    v_mov_b32 v234, v232
    v_mov_b32 v235, v233
    s_nop 1
    v_permlane32_swap_b32 v232, v234
    v_permlane32_swap_b32 v233, v235
    v_add_f32 v232, v232, v234
    v_add_f32 v233, v233, v235
    v_mov_b32 v234, v232
    v_mov_b32 v235, v233
    s_nop 1
    v_permlane16_swap_b32 v232, v234
    v_permlane16_swap_b32 v233, v235
    v_add_f32 v232, v232, v234
    v_add_f32 v233, v233, v235
    buffer_store_dwordx2 v[232:233], v10, s[4:7], s39 offen sc1
    s_barrier
    s_mov_b32 s22, 1
    s_mov_b32 s21, 0x1c00000
    s_branch L_m_cl
L_fin_p5:
    buffer_store_dwordx4 v[220:223], v4, s[16:19], s34 offen offset:0
    buffer_store_dwordx4 v[224:227], v4, s[16:19], s34 offen offset:64
    buffer_store_dwordx2 v[228:229], v5, s[16:19], s34 offen offset:128
    s_endpgm
L_m_l1:
    s_and_b32 s25, s2, 7
    s_lshr_b32 s26, s2, 3
    s_lshr_b32 s23, s25, 1
    s_lshl_b32 s23, s23, 2
    s_lshr_b32 s27, s26, 3
    s_add_u32 s23, s23, s27
    s_and_b32 s24, s25, 1
    s_lshl_b32 s24, s24, 3
    s_and_b32 s27, s26, 7
    s_add_u32 s24, s24, s27
    s_mul_i32 s29, s24, 129024
    s_lshl_b32 s30, s20, 12
    s_add_u32 s29, s29, s30
    s_add_u32 s29, s29, 0x3800000
    s_lshl_b32 s31, s23, 3
    s_max_u32 s31, s31, 1
    s_sub_u32 s31, s31, 1
    s_mul_i32 s31, s31, 18432
    s_add_u32 s31, s31, 0x0
    s_lshl_b32 s35, s20, 10
    s_and_b32 s36, s35, 1024
    s_barrier
    s_add_u32 m0, s35, 131072
    s_add_u32 s34, s31, s35
    s_add_u32 s34, s34, 0
    buffer_load_dwordx4 v1, s[4:7], s34 offen sc1 lds
    s_add_u32 m0, s30, 0
    s_add_u32 s34, s29, 0
    buffer_load_dwordx4 v1, s[4:7], s34 offen offset:0 sc1 lds
    buffer_load_dwordx4 v1, s[4:7], s34 offen offset:1024 sc1 lds
    buffer_load_dwordx4 v1, s[4:7], s34 offen offset:2048 sc1 lds
    buffer_load_dwordx4 v1, s[4:7], s34 offen offset:3072 sc1 lds
    s_add_u32 m0, s30, 16384
    s_add_u32 s34, s29, 16384
    buffer_load_dwordx4 v1, s[4:7], s34 offen offset:0 sc1 lds
    buffer_load_dwordx4 v1, s[4:7], s34 offen offset:1024 sc1 lds
    buffer_load_dwordx4 v1, s[4:7], s34 offen offset:2048 sc1 lds
    buffer_load_dwordx4 v1, s[4:7], s34 offen offset:3072 sc1 lds
    s_waitcnt vmcnt(4) lgkmcnt(0)
    s_barrier
    s_add_u32 m0, s35, 135168
    s_add_u32 s34, s31, s35
    s_add_u32 s34, s34, 4096
    buffer_load_dwordx4 v1, s[4:7], s34 offen sc1 lds
    s_add_u32 m0, s30, 32768
    s_add_u32 s34, s29, 32768
    buffer_load_dwordx4 v1, s[4:7], s34 offen offset:0 sc1 lds
    buffer_load_dwordx4 v1, s[4:7], s34 offen offset:1024 sc1 lds
    buffer_load_dwordx4 v1, s[4:7], s34 offen offset:2048 sc1 lds
    buffer_load_dwordx4 v1, s[4:7], s34 offen offset:3072 sc1 lds
    s_add_u32 m0, s30, 49152
    s_add_u32 s34, s29, 49152
    buffer_load_dwordx4 v1, s[4:7], s34 offen offset:0 sc1 lds
    buffer_load_dwordx4 v1, s[4:7], s34 offen offset:1024 sc1 lds
    buffer_load_dwordx4 v1, s[4:7], s34 offen offset:2048 sc1 lds
    buffer_load_dwordx4 v1, s[4:7], s34 offen offset:3072 sc1 lds
    s_cmp_lt_u32 s2, 144
    s_cbranch_scc1 L_p0_t1
    s_cmp_ge_u32 s2, 216
    s_cbranch_scc1 L_p0_t2
    ds_read_b64_tr_b16 v[16:17], v4 offset:0
    ds_read_b64_tr_b16 v[18:19], v4 offset:2048
    ds_read_b64_tr_b16 v[20:21], v4 offset:18432
    ds_read_b64_tr_b16 v[22:23], v4 offset:20480
    ds_read_b64_tr_b16 v[24:25], v4 offset:4096
    ds_read_b64_tr_b16 v[26:27], v4 offset:6144
    ds_read_b64_tr_b16 v[28:29], v4 offset:22528
    ds_read_b64_tr_b16 v[30:31], v4 offset:24576
    ds_read_b64_tr_b16 v[32:33], v4 offset:8192
    ds_read_b64_tr_b16 v[34:35], v4 offset:10240
    ds_read_b64_tr_b16 v[36:37], v4 offset:26624
    ds_read_b64_tr_b16 v[38:39], v4 offset:28672
    ds_read_b64_tr_b16 v[40:41], v4 offset:12288
    ds_read_b64_tr_b16 v[42:43], v4 offset:14336
    ds_read_b64_tr_b16 v[44:45], v4 offset:30720
    ds_read_b64_tr_b16 v[46:47], v4 offset:32768
    ds_read_b64_tr_b16 v[48:49], v5 offset:16384
    ds_read_b64_tr_b16 v[50:51], v5 offset:34816
    s_branch L_p0_t2
L_p0_t1:
    ds_read_b64_tr_b16 v[16:17], v4 offset:0
    ds_read_b64_tr_b16 v[18:19], v4 offset:512
    ds_read_b64_tr_b16 v[20:21], v4 offset:4352
    ds_read_b64_tr_b16 v[22:23], v4 offset:4864
    ds_read_b64_tr_b16 v[24:25], v4 offset:9792
    ds_read_b64_tr_b16 v[26:27], v4 offset:10304
    ds_read_b64_tr_b16 v[28:29], v4 offset:14144
    ds_read_b64_tr_b16 v[30:31], v4 offset:14656
    ds_read_b64_tr_b16 v[32:33], v4 offset:19584
    ds_read_b64_tr_b16 v[34:35], v4 offset:20096
    ds_read_b64_tr_b16 v[36:37], v4 offset:23936
    ds_read_b64_tr_b16 v[38:39], v4 offset:24448
    ds_read_b64_tr_b16 v[40:41], v4 offset:29376
    ds_read_b64_tr_b16 v[42:43], v4 offset:29888
    ds_read_b64_tr_b16 v[44:45], v4 offset:33728
    ds_read_b64_tr_b16 v[46:47], v4 offset:34240
    ds_read_b64_tr_b16 v[48:49], v5 offset:8704
    ds_read_b64_tr_b16 v[50:51], v5 offset:9216
L_p0_t2:
    s_waitcnt lgkmcnt(0)
    s_waitcnt vmcnt(9) lgkmcnt(0)
    s_barrier
    s_add_u32 m0, s35, 139264
    s_add_u32 s34, s31, s35
    s_add_u32 s34, s34, 8192
    buffer_load_dwordx4 v1, s[4:7], s34 offen sc1 lds
    v_lshrrev_b32 v2, 8, v1
    v_bfe_u32 v3, v1, 7, 1
    v_bfe_u32 v4, v1, 4, 3
    v_cmp_gt_u32 vcc, 3, v2
    v_mul_u32_u24 v3, 80, v3
    v_lshl_add_u32 v3, v4, 3, v3
    v_lshrrev_b32 v5, 1, v4
    v_and_b32 v4, 1, v4
    v_lshl_add_u32 v4, v4, 3, 64
    v_cndmask_b32 v2, v5, v2, vcc
    v_cndmask_b32 v3, v4, v3, vcc
    v_mul_u32_u24 v2, 2304, v2
    v_add_u32 v0, v2, v3
    v_lshrrev_b32 v8, 1, v1
    s_mul_i32 s34, s24, 144
    s_add_u32 s34, s34, 0x4400000
    buffer_load_dwordx2 v[2:3], v0, s[4:7], s34 offen sc1
    s_mul_i32 s34, s24, 144
    s_add_u32 s34, s34, 0x4402000
    buffer_load_dwordx2 v[4:5], v0, s[4:7], s34 offen sc1
    s_mul_i32 s34, s24, 144
    s_add_u32 s34, s34, 0x4404000
    buffer_load_dwordx2 v[6:7], v0, s[4:7], s34 offen sc1
    s_mul_i32 s34, s24, 144
    s_add_u32 s34, s34, 0x4406000
    buffer_load_dwordx2 v[12:13], v0, s[4:7], s34 offen sc1
    s_add_u32 m0, s30, 65536
    s_add_u32 s34, s29, 65536
    buffer_load_dwordx4 v1, s[4:7], s34 offen offset:0 sc1 lds
    buffer_load_dwordx4 v1, s[4:7], s34 offen offset:1024 sc1 lds
    buffer_load_dwordx4 v1, s[4:7], s34 offen offset:2048 sc1 lds
    buffer_load_dwordx4 v1, s[4:7], s34 offen offset:3072 sc1 lds
    s_waitcnt vmcnt(13) lgkmcnt(0)
    s_barrier
    s_add_u32 m0, s30, 81920
    s_add_u32 s34, s29, 81920
    buffer_load_dwordx4 v1, s[4:7], s34 offen offset:0 sc1 lds
    buffer_load_dwordx4 v1, s[4:7], s34 offen offset:1024 sc1 lds
    buffer_load_dwordx4 v1, s[4:7], s34 offen offset:2048 sc1 lds
    buffer_load_dwordx4 v1, s[4:7], s34 offen offset:3072 sc1 lds
    s_waitcnt vmcnt(13) lgkmcnt(0)
    s_barrier
    s_add_u32 m0, s35, 143360
    s_add_u32 s34, s31, s35
    s_add_u32 s34, s34, 12288
    buffer_load_dwordx4 v1, s[4:7], s34 offen sc1 lds
    s_add_u32 m0, s30, 98304
    s_add_u32 s34, s29, 98304
    buffer_load_dwordx4 v1, s[4:7], s34 offen offset:0 sc1 lds
    buffer_load_dwordx4 v1, s[4:7], s34 offen offset:1024 sc1 lds
    buffer_load_dwordx4 v1, s[4:7], s34 offen offset:2048 sc1 lds
    buffer_load_dwordx4 v1, s[4:7], s34 offen offset:3072 sc1 lds
    s_waitcnt vmcnt(13)
    v_add_f32 v2, v2, v4
    v_add_f32 v3, v3, v5
    v_add_f32 v6, v6, v12
    v_add_f32 v7, v7, v13
    v_add_f32 v2, v2, v6
    v_add_f32 v3, v3, v7
    v_cmp_gt_u32 vcc, 864, v1
    v_add_u32 v8, 161792, v8
    s_nop 0
    v_cndmask_b32 v2, 0, v2, vcc
    v_cndmask_b32 v3, 0, v3, vcc
    ds_write_b64 v8, v[2:3]
    s_waitcnt vmcnt(9) lgkmcnt(0)
    s_barrier
    s_add_u32 m0, s36, 147456
    s_add_u32 s34, s31, s36
    s_add_u32 s34, s34, 16384
    buffer_load_dwordx4 v1, s[4:7], s34 offen sc1 lds
    s_add_u32 m0, s30, 114688
    s_add_u32 s34, s29, 114688
    buffer_load_dwordx4 v1, s[4:7], s34 offen offset:0 sc1 lds
    buffer_load_dwordx4 v1, s[4:7], s34 offen offset:1024 sc1 lds
    buffer_load_dwordx4 v1, s[4:7], s34 offen offset:2048 sc1 lds
    buffer_load_dwordx4 v1, s[4:7], s34 offen offset:3072 sc1 lds
    s_waitcnt vmcnt(10) lgkmcnt(0)
    s_barrier
    buffer_store_dwordx4 v[16:19], v9, s[4:7], s37 offen sc1
    buffer_store_dwordx4 v[20:23], v10, s[4:7], s38 offen sc1
    buffer_store_dwordx4 v[24:27], v9, s[4:7], s39 offen sc1
    buffer_store_dwordx4 v[28:31], v10, s[4:7], s40 offen sc1
    s_waitcnt vmcnt(9) lgkmcnt(0)
    s_barrier
    buffer_store_dwordx4 v[32:35], v9, s[4:7], s41 offen sc1
    buffer_store_dwordx4 v[36:39], v10, s[4:7], s42 offen sc1
    buffer_store_dwordx4 v[40:43], v9, s[4:7], s43 offen sc1
    s_waitcnt vmcnt(7) lgkmcnt(0)
    s_barrier
    s_mov_b32 s46, 0x4502000
    v_mov_b32 v4, 0
    s_mov_b32 s60, 65536
L_poll_wo:
    buffer_load_dword v5, v4, s[4:7], s46 offen sc1
    s_waitcnt vmcnt(0)
    v_cmp_gt_u32 vcc, 18, v5
    s_sub_u32 s60, s60, 1
    s_cbranch_scc1 L_pd_wo
    s_cbranch_vccz L_pd_wo
    s_sleep 4
    s_branch L_poll_wo
L_pd_wo:
    buffer_store_dwordx4 v[44:47], v10, s[4:7], s47 offen sc1
    buffer_store_dwordx4 v[48:51], v14, s[4:7], s48 offen sc1
    v_dot2_f32_bf16 v12, v16, v11, 0
    v_dot2_f32_bf16 v13, v17, v11, 0
    v_dot2_f32_bf16 v12, v18, v11, v12
    v_dot2_f32_bf16 v13, v19, v11, v13
    v_dot2_f32_bf16 v12, v20, v11, v12
    v_dot2_f32_bf16 v13, v21, v11, v13
    v_dot2_f32_bf16 v12, v22, v11, v12
    v_dot2_f32_bf16 v13, v23, v11, v13
    v_dot2_f32_bf16 v12, v24, v11, v12
    v_dot2_f32_bf16 v13, v25, v11, v13
    v_dot2_f32_bf16 v12, v26, v11, v12
    v_dot2_f32_bf16 v13, v27, v11, v13
    v_dot2_f32_bf16 v12, v28, v11, v12
    v_dot2_f32_bf16 v13, v29, v11, v13
    v_dot2_f32_bf16 v12, v30, v11, v12
    v_dot2_f32_bf16 v13, v31, v11, v13
    v_dot2_f32_bf16 v12, v32, v11, v12
    v_dot2_f32_bf16 v13, v33, v11, v13
    v_dot2_f32_bf16 v12, v34, v11, v12
    v_dot2_f32_bf16 v13, v35, v11, v13
    v_dot2_f32_bf16 v12, v36, v11, v12
    v_dot2_f32_bf16 v13, v37, v11, v13
    v_dot2_f32_bf16 v12, v38, v11, v12
    v_dot2_f32_bf16 v13, v39, v11, v13
    v_dot2_f32_bf16 v12, v40, v11, v12
    v_dot2_f32_bf16 v13, v41, v11, v13
    v_dot2_f32_bf16 v12, v42, v11, v12
    v_dot2_f32_bf16 v13, v43, v11, v13
    v_dot2_f32_bf16 v12, v44, v11, v12
    v_dot2_f32_bf16 v13, v45, v11, v13
    v_dot2_f32_bf16 v12, v46, v11, v12
    v_dot2_f32_bf16 v13, v47, v11, v13
    v_dot2_f32_bf16 v12, v48, v11, v12
    v_dot2_f32_bf16 v13, v49, v11, v13
    v_dot2_f32_bf16 v12, v50, v11, v12
    v_dot2_f32_bf16 v13, v51, v11, v13
    s_nop 2
    v_add_f32 v12, v12, v13
    v_mov_b32 v13, v12
    s_nop 1
    v_permlane32_swap_b32 v12, v13
    v_add_f32 v12, v12, v13
    v_mov_b32 v13, v12
    s_nop 1
    v_permlane16_swap_b32 v12, v13
    v_add_f32 v12, v12, v13
    buffer_store_dword v12, v15, s[4:7], s49 offen sc1
    s_barrier
L_m_ll:
    s_and_b32 s25, s2, 7
    s_lshr_b32 s26, s2, 3
    s_lshr_b32 s23, s25, 1
    s_lshl_b32 s23, s23, 3
    s_lshr_b32 s27, s26, 2
    s_add_u32 s23, s23, s27
    s_and_b32 s24, s25, 1
    s_lshl_b32 s24, s24, 2
    s_and_b32 s27, s26, 3
    s_add_u32 s24, s24, s27
    s_add_u32 s25, s23, s24
    s_and_b32 s25, s25, 3
    s_mul_i32 s29, s24, 82944
    s_add_u32 s29, s29, 0x3a00000
    s_mul_i32 s30, s20, 36864
    s_mul_i32 s31, s20, 18432
    s_add_u32 s31, s31, s29
    s_add_u32 m0, s30, 18432
    s_add_u32 s33, s31, 0
    buffer_load_dwordx4 v1, s[4:7], s33 offen offset:0  sc1 lds
    buffer_load_dwordx4 v1, s[4:7], s33 offen offset:1024  sc1 lds
    buffer_load_dwordx4 v1, s[4:7], s33 offen offset:2048  sc1 lds
    buffer_load_dwordx4 v1, s[4:7], s33 offen offset:3072  sc1 lds
    s_add_u32 m0, s30, 22528
    s_add_u32 s33, s31, 4096
    buffer_load_dwordx4 v1, s[4:7], s33 offen offset:0  sc1 lds
    buffer_load_dwordx4 v1, s[4:7], s33 offen offset:1024  sc1 lds
    buffer_load_dwordx4 v1, s[4:7], s33 offen offset:2048  sc1 lds
    buffer_load_dwordx4 v1, s[4:7], s33 offen offset:3072  sc1 lds
    s_add_u32 m0, s30, 26624
    s_add_u32 s33, s31, 8192
    buffer_load_dwordx4 v1, s[4:7], s33 offen offset:0  sc1 lds
    buffer_load_dwordx4 v1, s[4:7], s33 offen offset:1024  sc1 lds
    buffer_load_dwordx4 v1, s[4:7], s33 offen offset:2048  sc1 lds
    buffer_load_dwordx4 v1, s[4:7], s33 offen offset:3072  sc1 lds
    s_add_u32 m0, s30, 30720
    s_add_u32 s33, s31, 12288
    buffer_load_dwordx4 v1, s[4:7], s33 offen offset:0  sc1 lds
    buffer_load_dwordx4 v1, s[4:7], s33 offen offset:1024  sc1 lds
    buffer_load_dwordx4 v1, s[4:7], s33 offen offset:2048  sc1 lds
    buffer_load_dwordx4 v1, s[4:7], s33 offen offset:3072  sc1 lds
    s_add_u32 m0, s30, 34816
    s_add_u32 s33, s31, 16384
    buffer_load_dwordx4 v1, s[4:7], s33 offen offset:0  sc1 lds
    buffer_load_dwordx4 v1, s[4:7], s33 offen offset:1024  sc1 lds
    s_mul_i32 s30, s20, 3072
    s_add_u32 s31, s30, s29
    s_waitcnt vmcnt(18)
    s_barrier
    s_add_u32 m0, s30, 147456
    s_add_u32 s33, s31, 73728
    buffer_load_dwordx4 v1, s[4:7], s33 offen offset:0  sc1 lds
    buffer_load_dwordx4 v1, s[4:7], s33 offen offset:1024  sc1 lds
    buffer_load_dwordx4 v1, s[4:7], s33 offen offset:2048  sc1 lds
    s_or_b32 s44, s20, s22
    s_cbranch_scc1 L_p2_ns
    s_and_b32 s44, s2, 15
    s_lshl_b32 s44, s44, 8
    s_add_u32 s44, s44, 0x4501000
    s_add_u32 s44, s44, s4
    s_addc_u32 s45, s5, 0
    s_mov_b32 s56, 1
    s_atomic_add s56, s[44:45], 0
L_p2_ns:
    s_waitcnt vmcnt(0)
    s_barrier
    s_and_b32 s25, s2, 7
    s_lshr_b32 s26, s2, 3
    s_and_b32 s23, s25, 1
    s_lshl_b32 s23, s23, 3
    s_and_b32 s27, s26, 7
    s_add_u32 s23, s23, s27
    s_lshr_b32 s24, s25, 1
    s_lshl_b32 s24, s24, 2
    s_lshr_b32 s27, s26, 3
    s_add_u32 s24, s24, s27
    s_add_u32 s28, s23, s24
    s_and_b32 s28, s28, 3
    s_lshl_b32 s30, s20, 12
    s_lshr_b32 s33, s20, 1
    s_mul_i32 s31, s33, 36864
    s_and_b32 s33, s20, 1
    s_lshl_b32 s33, s33, 10
    s_add_u32 s33, s33, 16384
    s_add_u32 s31, s31, s33
    s_sub_u32 s49, s33, s30
    s_mul_i32 s34, s24, 331776
    s_add_u32 s34, s34, s30
    s_add_u32 s34, s34, 0x3b00000
    s_lshl_b32 s35, s23, 3
    s_lshl_b32 s33, s20, 1
    s_add_u32 s35, s35, s33
    s_mul_i32 s35, s35, 18432
    s_add_u32 s35, s35, s21
    s_add_u32 s35, s35, 0x300000
    s_mul_i32 s36, s24, 589824
    s_add_u32 s36, s36, s30
    s_add_u32 s36, s36, s21
    s_add_u32 s36, s36, 0x900000
    v_add_u32 v2, 16384, v1
    s_add_u32 s33, s30, 18432
    v_add_u32 v6, s33, v1
    v_add_u32 v7, 73728, v6
    s_lshl_b32 s29, s23, 2
    s_add_u32 s29, s29, s20
    s_lshl_b32 s29, s29, 12
    s_add_u32 s29, s29, s21
    s_add_u32 s29, s29, 0x1b40000
    v_and_b32 v3, 48, v1
    v_lshrrev_b32 v8, 8, v1
    v_lshl_add_u32 v3, v8, 6, v3
    v_bfe_u32 v8, v1, 6, 2
    v_lshl_add_u32 v3, v8, 8, v3
    s_lshl_b32 s33, s23, 7
    s_lshl_b32 s37, s20, 5
    s_add_u32 s33, s33, s37
    v_lshrrev_b32 v8, 7, v1
    v_add_u32 v8, s33, v8
    v_lshlrev_b32 v8, 12, v8
    v_lshrrev_b32 v9, 8, v1
    v_bfe_u32 v10, v1, 4, 3
    v_xor_b32 v9, v9, v10
    v_lshl_add_u32 v8, v9, 4, v8
    v_xor_b32 v9, 64, v8
    v_add_u32 v9, 31744, v9
    v_add_u32 v10, 63488, v8
    v_add_u32 v11, 63488, v9
    s_cmp_eq_u32 s28, 0
    s_cselect_b32 s44, 4, 0
    s_cmp_eq_u32 s28, 1
    s_cselect_b32 s45, 5, 1
    s_cmp_eq_u32 s28, 2
    s_cselect_b32 s46, 6, 2
    s_cmp_eq_u32 s28, 3
    s_cselect_b32 s47, 7, 3
    s_lshl_b32 s33, s20, 4
    s_add_u32 s33, s33, s24
    s_lshl_b32 s54, s22, 7
    s_add_u32 s54, s54, s33
    s_lshl_b32 s54, s54, 8
    s_add_u32 s54, s54, 0x450c000
    s_add_u32 s54, s54, s4
    s_addc_u32 s55, s5, 0
    s_mov_b32 s33, 0x4501000
    v_and_b32 v4, 0xf0, v1
    v_lshlrev_b32 v4, 4, v4
    s_mov_b32 s60, 65536
L_poll_wr:
    buffer_load_dword v5, v4, s[4:7], s33 offen sc1
    s_waitcnt vmcnt(0)
    v_cmp_gt_u32 vcc, 16, v5
    s_sub_u32 s60, s60, 1
    s_cbranch_scc1 L_pd_wr
    s_cbranch_vccz L_pd_wr
    s_sleep 4
    s_branch L_poll_wr
L_pd_wr:
    s_min_u32 s33, s20, 2
    s_lshl_b32 s33, s33, 9
    v_lshrrev_b32 v4, 1, v1
    v_add_u32 v4, s33, v4
    s_lshl_b32 s51, s24, 12
    s_add_u32 s51, s51, 0x4410000
    buffer_load_dwordx2 v[16:17], v4, s[4:7], s51 offen offset:0 sc1
    buffer_load_dwordx2 v[18:19], v4, s[4:7], s51 offen offset:1152 sc1
    s_mov_b32 s48, 0
    s_mul_i32 s50, s48, 18432
    s_add_u32 s50, s50, s34
    s_add_u32 m0, s30, 0
    s_mov_b32 s53, s50
    buffer_load_dwordx4 v1, s[4:7], s50 offen offset:0  sc1 lds
    buffer_load_dwordx4 v1, s[4:7], s50 offen offset:1024  sc1 lds
    buffer_load_dwordx4 v1, s[4:7], s50 offen offset:2048  sc1 lds
    buffer_load_dwordx4 v1, s[4:7], s50 offen offset:3072  sc1 lds
    s_mov_b32 s48, 1
    s_mul_i32 s50, s48, 18432
    s_add_u32 s50, s50, s34
    s_cmp_ge_u32 s20, 2
    s_cselect_b32 s52, s50, s53
    s_add_u32 m0, s31, 0
    s_add_u32 s52, s52, s49
    buffer_load_dwordx4 v1, s[4:7], s52 offen  sc1 lds
    s_add_u32 m0, s30, 36864
    s_mov_b32 s53, s50
    buffer_load_dwordx4 v1, s[4:7], s50 offen offset:0  sc1 lds
    buffer_load_dwordx4 v1, s[4:7], s50 offen offset:1024  sc1 lds
    buffer_load_dwordx4 v1, s[4:7], s50 offen offset:2048  sc1 lds
    buffer_load_dwordx4 v1, s[4:7], s50 offen offset:3072  sc1 lds
    s_mov_b32 m0, 161280
    v_lshrrev_b32 v5, 2, v1
    s_lshl_b32 s33, s23, 8
    buffer_load_dword v5, s[12:15], s33 offen lds
    s_waitcnt vmcnt(10)
    v_add_u32 v4, 159744, v4
    v_add_f32 v16, v16, v18
    v_add_f32 v17, v17, v19
    ds_write_b64 v4, v[16:17]
    s_waitcnt lgkmcnt(0)
    s_barrier
    s_mov_b32 s48, 2
    s_mul_i32 s50, s48, 18432
    s_add_u32 s50, s50, s34
    s_add_u32 m0, s30, 73728
    s_mov_b32 s53, s50
    buffer_load_dwordx4 v1, s[4:7], s50 offen offset:0  sc1 lds
    buffer_load_dwordx4 v1, s[4:7], s50 offen offset:1024  sc1 lds
    buffer_load_dwordx4 v1, s[4:7], s50 offen offset:2048  sc1 lds
    buffer_load_dwordx4 v1, s[4:7], s50 offen offset:3072  sc1 lds
    s_mov_b32 s48, 3
    s_mul_i32 s50, s48, 18432
    s_add_u32 s50, s50, s34
    s_cmp_ge_u32 s20, 2
    s_cselect_b32 s52, s50, s53
    s_add_u32 m0, s31, 73728
    s_add_u32 s52, s52, s49
    buffer_load_dwordx4 v1, s[4:7], s52 offen  sc1 lds
    s_add_u32 m0, s30, 110592
    s_mov_b32 s53, s50
    buffer_load_dwordx4 v1, s[4:7], s50 offen offset:0  sc1 lds
    buffer_load_dwordx4 v1, s[4:7], s50 offen offset:1024  sc1 lds
    buffer_load_dwordx4 v1, s[4:7], s50 offen offset:2048  sc1 lds
    buffer_load_dwordx4 v1, s[4:7], s50 offen offset:3072  sc1 lds
    s_barrier
    s_add_u32 m0, s30, 18432
    s_add_u32 s51, s35, 0
    buffer_load_dwordx4 v1, s[4:7], s51 offen offset:0 sc1 lds
    buffer_load_dwordx4 v1, s[4:7], s51 offen offset:1024 sc1 lds
    buffer_load_dwordx4 v2, s[4:7], s51 offen offset:2048 sc1 lds
    buffer_load_dwordx4 v2, s[4:7], s51 offen offset:3072 sc1 lds
    s_add_u32 m0, s30, 55296
    s_add_u32 s51, s35, 2048
    buffer_load_dwordx4 v1, s[4:7], s51 offen offset:0 sc1 lds
    buffer_load_dwordx4 v1, s[4:7], s51 offen offset:1024 sc1 lds
    buffer_load_dwordx4 v2, s[4:7], s51 offen offset:2048 sc1 lds
    buffer_load_dwordx4 v2, s[4:7], s51 offen offset:3072 sc1 lds
    s_add_u32 m0, s30, 92160
    s_add_u32 s51, s35, 4096
    buffer_load_dwordx4 v1, s[4:7], s51 offen offset:0 sc1 lds
    buffer_load_dwordx4 v1, s[4:7], s51 offen offset:1024 sc1 lds
    buffer_load_dwordx4 v2, s[4:7], s51 offen offset:2048 sc1 lds
    buffer_load_dwordx4 v2, s[4:7], s51 offen offset:3072 sc1 lds
    s_waitcnt vmcnt(8)
    s_barrier
    s_add_u32 m0, s30, 129024
    s_add_u32 s51, s35, 6144
    buffer_load_dwordx4 v1, s[4:7], s51 offen offset:0 sc1 lds
    buffer_load_dwordx4 v1, s[4:7], s51 offen offset:1024 sc1 lds
    buffer_load_dwordx4 v2, s[4:7], s51 offen offset:2048 sc1 lds
    buffer_load_dwordx4 v2, s[4:7], s51 offen offset:3072 sc1 lds
    s_and_b32 s40, s2, 7
    s_lshr_b32 s26, s2, 3
    s_lshr_b32 s38, s40, 1
    s_lshl_b32 s38, s38, 3
    s_lshr_b32 s27, s26, 2
    s_add_u32 s38, s38, s27
    s_and_b32 s39, s40, 1
    s_lshl_b32 s39, s39, 2
    s_and_b32 s27, s26, 3
    s_add_u32 s39, s39, s27
    s_add_u32 s40, s38, s39
    s_and_b32 s40, s40, 3
    s_mul_i32 s42, s20, 9216
    s_mul_i32 s43, s39, 331776
    s_add_u32 s43, s43, s42
    s_add_u32 s43, s43, 0x4100000
    s_waitcnt vmcnt(8) lgkmcnt(0)
    s_barrier
    s_mov_b32 s48, 4
    s_mul_i32 s50, s48, 18432
    s_add_u32 s50, s50, s34
    s_add_u32 m0, s30, 0
    s_mov_b32 s53, s50
    buffer_load_dwordx4 v1, s[4:7], s50 offen offset:0  sc1 lds
    buffer_load_dwordx4 v1, s[4:7], s50 offen offset:1024  sc1 lds
    buffer_load_dwordx4 v1, s[4:7], s50 offen offset:2048  sc1 lds
    buffer_load_dwordx4 v1, s[4:7], s50 offen offset:3072  sc1 lds
    s_add_u32 m0, s30, 18432
    s_add_u32 s51, s35, 8192
    buffer_load_dwordx4 v1, s[4:7], s51 offen offset:0 sc1 lds
    buffer_load_dwordx4 v1, s[4:7], s51 offen offset:1024 sc1 lds
    buffer_load_dwordx4 v2, s[4:7], s51 offen offset:2048 sc1 lds
    buffer_load_dwordx4 v2, s[4:7], s51 offen offset:3072 sc1 lds
    s_waitcnt vmcnt(12) lgkmcnt(0)
    s_barrier
    s_mov_b32 s48, 5
    s_mul_i32 s50, s48, 18432
    s_add_u32 s50, s50, s34
    s_cmp_ge_u32 s20, 2
    s_cselect_b32 s52, s50, s53
    s_add_u32 m0, s31, 0
    s_add_u32 s52, s52, s49
    buffer_load_dwordx4 v1, s[4:7], s52 offen  sc1 lds
    s_add_u32 m0, s30, 36864
    s_mov_b32 s53, s50
    buffer_load_dwordx4 v1, s[4:7], s50 offen offset:0  sc1 lds
    buffer_load_dwordx4 v1, s[4:7], s50 offen offset:1024  sc1 lds
    buffer_load_dwordx4 v1, s[4:7], s50 offen offset:2048  sc1 lds
    buffer_load_dwordx4 v1, s[4:7], s50 offen offset:3072  sc1 lds
    s_add_u32 m0, s30, 55296
    s_add_u32 s51, s35, 10240
    buffer_load_dwordx4 v1, s[4:7], s51 offen offset:0 sc1 lds
    buffer_load_dwordx4 v1, s[4:7], s51 offen offset:1024 sc1 lds
    buffer_load_dwordx4 v2, s[4:7], s51 offen offset:2048 sc1 lds
    buffer_load_dwordx4 v2, s[4:7], s51 offen offset:3072 sc1 lds
    s_waitcnt vmcnt(17) lgkmcnt(0)
    s_barrier
    s_mov_b32 s48, 6
    s_mul_i32 s50, s48, 18432
    s_add_u32 s50, s50, s34
    s_add_u32 m0, s30, 73728
    s_mov_b32 s53, s50
    buffer_load_dwordx4 v1, s[4:7], s50 offen offset:0  sc1 lds
    buffer_load_dwordx4 v1, s[4:7], s50 offen offset:1024  sc1 lds
    buffer_load_dwordx4 v1, s[4:7], s50 offen offset:2048  sc1 lds
    buffer_load_dwordx4 v1, s[4:7], s50 offen offset:3072  sc1 lds
    s_add_u32 m0, s30, 92160
    s_add_u32 s51, s35, 12288
    buffer_load_dwordx4 v1, s[4:7], s51 offen offset:0 sc1 lds
    buffer_load_dwordx4 v1, s[4:7], s51 offen offset:1024 sc1 lds
    buffer_load_dwordx4 v2, s[4:7], s51 offen offset:2048 sc1 lds
    buffer_load_dwordx4 v2, s[4:7], s51 offen offset:3072 sc1 lds
    s_waitcnt vmcnt(16) lgkmcnt(0)
    s_barrier
    s_mov_b32 s48, 7
    s_mul_i32 s50, s48, 18432
    s_add_u32 s50, s50, s34
    s_cmp_ge_u32 s20, 2
    s_cselect_b32 s52, s50, s53
    s_add_u32 m0, s31, 73728
    s_add_u32 s52, s52, s49
    buffer_load_dwordx4 v1, s[4:7], s52 offen  sc1 lds
    s_add_u32 m0, s30, 110592
    s_mov_b32 s53, s50
    buffer_load_dwordx4 v1, s[4:7], s50 offen offset:0  sc1 lds
    buffer_load_dwordx4 v1, s[4:7], s50 offen offset:1024  sc1 lds
    buffer_load_dwordx4 v1, s[4:7], s50 offen offset:2048  sc1 lds
    buffer_load_dwordx4 v1, s[4:7], s50 offen offset:3072  sc1 lds
    s_add_u32 m0, s30, 129024
    s_add_u32 s51, s35, 14336
    buffer_load_dwordx4 v1, s[4:7], s51 offen offset:0 sc1 lds
    buffer_load_dwordx4 v1, s[4:7], s51 offen offset:1024 sc1 lds
    buffer_load_dwordx4 v2, s[4:7], s51 offen offset:2048 sc1 lds
    buffer_load_dwordx4 v2, s[4:7], s51 offen offset:3072 sc1 lds
    s_waitcnt vmcnt(17) lgkmcnt(0)
    s_barrier
    s_mov_b32 s48, 8
    s_mul_i32 s50, s48, 18432
    s_add_u32 s50, s50, s34
    s_add_u32 m0, s30, 0
    s_mov_b32 s53, s50
    buffer_load_dwordx4 v1, s[4:7], s50 offen offset:0  sc1 lds
    buffer_load_dwordx4 v1, s[4:7], s50 offen offset:1024  sc1 lds
    buffer_load_dwordx4 v1, s[4:7], s50 offen offset:2048  sc1 lds
    buffer_load_dwordx4 v1, s[4:7], s50 offen offset:3072  sc1 lds
    s_add_u32 m0, s30, 18432
    s_add_u32 s51, s35, 16384
    buffer_load_dwordx4 v1, s[4:7], s51 offen offset:0 sc1 lds
    buffer_load_dwordx4 v1, s[4:7], s51 offen offset:1024 sc1 lds
    buffer_load_dwordx4 v2, s[4:7], s51 offen offset:2048 sc1 lds
    buffer_load_dwordx4 v2, s[4:7], s51 offen offset:3072 sc1 lds
    s_cmp_lg_u32 s22, 0
    s_cbranch_scc1 L_p5_k5
    s_add_u32 s32, s43, 294912
    buffer_load_dwordx4 v[220:223], v1, s[4:7], s32 offen offset:0 sc1
    buffer_load_dwordx4 v[224:227], v1, s[4:7], s32 offen offset:1024 sc1
    buffer_load_dwordx4 v[228:231], v1, s[4:7], s32 offen offset:2048 sc1
    buffer_load_dwordx4 v[232:235], v1, s[4:7], s32 offen offset:3072 sc1
    s_add_u32 s32, s43, 299008
    buffer_load_dwordx4 v[236:239], v1, s[4:7], s32 offen offset:0 sc1
L_p5_k5:
    s_waitcnt vmcnt(21) lgkmcnt(0)
    s_cmp_eq_u32 s22, 0
    s_cbranch_scc1 L_wv_902
    s_waitcnt vmcnt(16)
L_wv_902:
    s_barrier
    s_mov_b32 s48, 5
    s_mul_i32 s50, s48, 18432
    s_add_u32 s50, s50, s34
    s_add_u32 s50, s50, 165888
    s_cmp_ge_u32 s20, 2
    s_cselect_b32 s52, s50, s53
    s_add_u32 m0, s31, 0
    s_add_u32 s52, s52, s49
    buffer_load_dwordx4 v1, s[4:7], s52 offen  sc1 lds
    s_add_u32 m0, s30, 36864
    s_mov_b32 s53, s50
    buffer_load_dwordx4 v1, s[4:7], s50 offen offset:0  sc1 lds
    buffer_load_dwordx4 v1, s[4:7], s50 offen offset:1024  sc1 lds
    buffer_load_dwordx4 v1, s[4:7], s50 offen offset:2048  sc1 lds
    buffer_load_dwordx4 v1, s[4:7], s50 offen offset:3072  sc1 lds
    s_cmp_lg_u32 s22, 0
    s_cbranch_scc1 L_p5_k6
    s_add_u32 s32, s43, 299008
    buffer_load_dwordx4 v[240:243], v1, s[4:7], s32 offen offset:1024 sc1
    buffer_load_dwordx4 v[244:247], v1, s[4:7], s32 offen offset:2048 sc1
    buffer_load_dwordx4 v[248:251], v1, s[4:7], s32 offen offset:3072 sc1
    s_add_u32 s32, s43, 303104
    buffer_load_dwordx4 v[252:255], v1, s[4:7], s32 offen offset:0 sc1
    s_add_u32 s32, s43, 258048
    buffer_load_dwordx4 v[184:187], v1, s[4:7], s32 offen offset:0 sc1
    buffer_load_dwordx4 v[188:191], v1, s[4:7], s32 offen offset:1024 sc1
L_p5_k6:
    s_waitcnt vmcnt(24) lgkmcnt(0)
    s_cmp_eq_u32 s22, 0
    s_cbranch_scc1 L_wv_935
    s_waitcnt vmcnt(13)
L_wv_935:
    s_barrier
    s_mov_b32 s48, 6
    s_mul_i32 s50, s48, 18432
    s_add_u32 s50, s50, s34
    s_add_u32 s50, s50, 165888
    s_add_u32 m0, s30, 73728
    s_mov_b32 s53, s50
    buffer_load_dwordx4 v1, s[4:7], s50 offen offset:0  sc1 lds
    buffer_load_dwordx4 v1, s[4:7], s50 offen offset:1024  sc1 lds
    buffer_load_dwordx4 v1, s[4:7], s50 offen offset:2048  sc1 lds
    buffer_load_dwordx4 v1, s[4:7], s50 offen offset:3072  sc1 lds
    s_cmp_lg_u32 s22, 0
    s_cbranch_scc1 L_p5_k7
    s_add_u32 s32, s43, 258048
    buffer_load_dwordx4 v[192:195], v1, s[4:7], s32 offen offset:2048 sc1
    buffer_load_dwordx4 v[196:199], v1, s[4:7], s32 offen offset:3072 sc1
    s_add_u32 s32, s43, 262144
    buffer_load_dwordx4 v[200:203], v1, s[4:7], s32 offen offset:0 sc1
    buffer_load_dwordx4 v[204:207], v1, s[4:7], s32 offen offset:1024 sc1
    buffer_load_dwordx4 v[208:211], v1, s[4:7], s32 offen offset:2048 sc1
    buffer_load_dwordx4 v[212:215], v1, s[4:7], s32 offen offset:3072 sc1
L_p5_k7:
    s_waitcnt vmcnt(20) lgkmcnt(0)
    s_cmp_eq_u32 s22, 0
    s_cbranch_scc1 L_wv_962
    s_waitcnt vmcnt(8)
L_wv_962:
    s_barrier
    s_mov_b32 s48, 7
    s_mul_i32 s50, s48, 18432
    s_add_u32 s50, s50, s34
    s_add_u32 s50, s50, 165888
    s_cmp_ge_u32 s20, 2
    s_cselect_b32 s52, s50, s53
    s_add_u32 m0, s31, 73728
    s_add_u32 s52, s52, s49
    buffer_load_dwordx4 v1, s[4:7], s52 offen  sc1 lds
    s_add_u32 m0, s30, 110592
    s_mov_b32 s53, s50
    buffer_load_dwordx4 v1, s[4:7], s50 offen offset:0  sc1 lds
    buffer_load_dwordx4 v1, s[4:7], s50 offen offset:1024  sc1 lds
    buffer_load_dwordx4 v1, s[4:7], s50 offen offset:2048  sc1 lds
    buffer_load_dwordx4 v1, s[4:7], s50 offen offset:3072  sc1 lds
    s_cmp_lg_u32 s22, 0
    s_cbranch_scc1 L_p5_k8
    s_add_u32 s32, s43, 266240
    buffer_load_dwordx4 v[216:219], v1, s[4:7], s32 offen offset:0 sc1
    s_add_u32 s32, s43, 221184
    buffer_load_dwordx4 v[148:151], v1, s[4:7], s32 offen offset:0 sc1
    buffer_load_dwordx4 v[152:155], v1, s[4:7], s32 offen offset:1024 sc1
    buffer_load_dwordx4 v[156:159], v1, s[4:7], s32 offen offset:2048 sc1
    buffer_load_dwordx4 v[160:163], v1, s[4:7], s32 offen offset:3072 sc1
    s_add_u32 s32, s43, 225280
    buffer_load_dwordx4 v[164:167], v1, s[4:7], s32 offen offset:0 sc1
L_p5_k8:
    s_waitcnt vmcnt(27) lgkmcnt(0)
    s_cmp_eq_u32 s22, 0
    s_cbranch_scc1 L_wv_995
    s_waitcnt vmcnt(9)
L_wv_995:
    s_barrier
    s_mov_b32 s48, 8
    s_mul_i32 s50, s48, 18432
    s_add_u32 s50, s50, s34
    s_add_u32 s50, s50, 165888
    s_add_u32 m0, s30, 0
    s_mov_b32 s53, s50
    buffer_load_dwordx4 v1, s[4:7], s50 offen offset:0  sc1 lds
    buffer_load_dwordx4 v1, s[4:7], s50 offen offset:1024  sc1 lds
    buffer_load_dwordx4 v1, s[4:7], s50 offen offset:2048  sc1 lds
    buffer_load_dwordx4 v1, s[4:7], s50 offen offset:3072  sc1 lds
    s_cmp_lg_u32 s22, 0
    s_cbranch_scc1 L_p5_k9
    s_add_u32 s32, s43, 225280
    buffer_load_dwordx4 v[168:171], v1, s[4:7], s32 offen offset:1024 sc1
    buffer_load_dwordx4 v[172:175], v1, s[4:7], s32 offen offset:2048 sc1
    buffer_load_dwordx4 v[176:179], v1, s[4:7], s32 offen offset:3072 sc1
    s_add_u32 s32, s43, 229376
    buffer_load_dwordx4 v[180:183], v1, s[4:7], s32 offen offset:0 sc1
    s_add_u32 s32, s43, 184320
    buffer_load_dwordx4 v[112:115], v1, s[4:7], s32 offen offset:0 sc1
    buffer_load_dwordx4 v[116:119], v1, s[4:7], s32 offen offset:1024 sc1
    buffer_load_dwordx4 v[120:123], v1, s[4:7], s32 offen offset:2048 sc1
    buffer_load_dwordx4 v[124:127], v1, s[4:7], s32 offen offset:3072 sc1
    s_add_u32 s32, s43, 188416
    buffer_load_dwordx4 v[128:131], v1, s[4:7], s32 offen offset:0 sc1
    buffer_load_dwordx4 v[132:135], v1, s[4:7], s32 offen offset:1024 sc1
    buffer_load_dwordx4 v[136:139], v1, s[4:7], s32 offen offset:2048 sc1
    buffer_load_dwordx4 v[140:143], v1, s[4:7], s32 offen offset:3072 sc1
    s_add_u32 s32, s43, 192512
    buffer_load_dwordx4 v[144:147], v1, s[4:7], s32 offen offset:0 sc1
    s_add_u32 s32, s43, 147456
    buffer_load_dwordx4 v[76:79], v1, s[4:7], s32 offen offset:0 sc1
    buffer_load_dwordx4 v[80:83], v1, s[4:7], s32 offen offset:1024 sc1
    buffer_load_dwordx4 v[84:87], v1, s[4:7], s32 offen offset:2048 sc1
    buffer_load_dwordx4 v[88:91], v1, s[4:7], s32 offen offset:3072 sc1
    s_add_u32 s32, s43, 151552
    buffer_load_dwordx4 v[92:95], v1, s[4:7], s32 offen offset:0 sc1
    buffer_load_dwordx4 v[96:99], v1, s[4:7], s32 offen offset:1024 sc1
    buffer_load_dwordx4 v[100:103], v1, s[4:7], s32 offen offset:2048 sc1
    buffer_load_dwordx4 v[104:107], v1, s[4:7], s32 offen offset:3072 sc1
    s_add_u32 s32, s43, 155648
    buffer_load_dwordx4 v[108:111], v1, s[4:7], s32 offen offset:0 sc1
    s_add_u32 s32, s43, 110592
    buffer_load_dwordx4 v[40:43], v1, s[4:7], s32 offen offset:0 sc1
    buffer_load_dwordx4 v[44:47], v1, s[4:7], s32 offen offset:1024 sc1
    buffer_load_dwordx4 v[48:51], v1, s[4:7], s32 offen offset:2048 sc1
    buffer_load_dwordx4 v[52:55], v1, s[4:7], s32 offen offset:3072 sc1
    s_add_u32 s32, s43, 114688
    buffer_load_dwordx4 v[56:59], v1, s[4:7], s32 offen offset:0 sc1
    buffer_load_dwordx4 v[60:63], v1, s[4:7], s32 offen offset:1024 sc1
    buffer_load_dwordx4 v[64:67], v1, s[4:7], s32 offen offset:2048 sc1
    buffer_load_dwordx4 v[68:71], v1, s[4:7], s32 offen offset:3072 sc1
    s_add_u32 s32, s43, 118784
    buffer_load_dwordx4 v[72:75], v1, s[4:7], s32 offen offset:0 sc1
L_p5_k9:
    s_waitcnt vmcnt(45) lgkmcnt(0)
    s_cmp_eq_u32 s22, 0
    s_cbranch_scc1 L_wv_1056
    s_waitcnt vmcnt(8)
L_wv_1056:
    s_barrier
    s_mov_b32 s48, 0
    s_mul_i32 s50, s48, 18432
    s_add_u32 s50, s50, s34
    s_add_u32 s50, s50, 165888
    s_cmp_ge_u32 s20, 2
    s_cselect_b32 s52, s50, s53
    s_add_u32 m0, s31, 0
    s_add_u32 s52, s52, s49
    buffer_load_dwordx4 v1, s[4:7], s52 offen  sc1 lds
    s_add_u32 m0, s30, 36864
    s_mov_b32 s53, s50
    buffer_load_dwordx4 v1, s[4:7], s50 offen offset:0  sc1 lds
    buffer_load_dwordx4 v1, s[4:7], s50 offen offset:1024  sc1 lds
    buffer_load_dwordx4 v1, s[4:7], s50 offen offset:2048  sc1 lds
    buffer_load_dwordx4 v1, s[4:7], s50 offen offset:3072  sc1 lds
    s_add_u32 m0, s30, 55296
    s_add_u32 s51, s35, 0
    buffer_load_dwordx4 v1, s[4:7], s51 offen offset:0 sc1 lds
    buffer_load_dwordx4 v1, s[4:7], s51 offen offset:1024 sc1 lds
    buffer_load_dwordx4 v2, s[4:7], s51 offen offset:2048 sc1 lds
    buffer_load_dwordx4 v2, s[4:7], s51 offen offset:3072 sc1 lds
    s_waitcnt vmcnt(50) lgkmcnt(0)
    s_cmp_eq_u32 s22, 0
    s_cbranch_scc1 L_wv_1083
    s_waitcnt vmcnt(13)
L_wv_1083:
    s_barrier
    buffer_load_dwordx4 v[16:19], v3, s[4:7], s29 offen offset:0 sc1
    buffer_load_dwordx4 v[20:23], v3, s[4:7], s29 offen offset:1024 sc1
    buffer_load_dwordx4 v[24:27], v3, s[4:7], s29 offen offset:2048 sc1
    buffer_load_dwordx4 v[28:31], v3, s[4:7], s29 offen offset:3072 sc1
    s_mov_b32 s48, 1
    s_mul_i32 s50, s48, 18432
    s_add_u32 s50, s50, s34
    s_add_u32 s50, s50, 165888
    s_add_u32 m0, s30, 73728
    s_mov_b32 s53, s50
    buffer_load_dwordx4 v1, s[4:7], s50 offen offset:0  sc1 lds
    buffer_load_dwordx4 v1, s[4:7], s50 offen offset:1024  sc1 lds
    buffer_load_dwordx4 v1, s[4:7], s50 offen offset:2048  sc1 lds
    buffer_load_dwordx4 v1, s[4:7], s50 offen offset:3072  sc1 lds
    s_add_u32 m0, s30, 92160
    s_add_u32 s51, s35, 2048
    buffer_load_dwordx4 v1, s[4:7], s51 offen offset:0 sc1 lds
    buffer_load_dwordx4 v1, s[4:7], s51 offen offset:1024 sc1 lds
    buffer_load_dwordx4 v2, s[4:7], s51 offen offset:2048 sc1 lds
    buffer_load_dwordx4 v2, s[4:7], s51 offen offset:3072 sc1 lds
    s_waitcnt vmcnt(20) lgkmcnt(0)
    s_barrier
    s_mov_b32 s48, 2
    s_mul_i32 s50, s48, 18432
    s_add_u32 s50, s50, s34
    s_add_u32 s50, s50, 165888
    s_cmp_ge_u32 s20, 2
    s_cselect_b32 s52, s50, s53
    s_add_u32 m0, s31, 73728
    s_add_u32 s52, s52, s49
    buffer_load_dwordx4 v1, s[4:7], s52 offen  sc1 lds
    s_add_u32 m0, s30, 110592
    s_mov_b32 s53, s50
    buffer_load_dwordx4 v1, s[4:7], s50 offen offset:0  sc1 lds
    buffer_load_dwordx4 v1, s[4:7], s50 offen offset:1024  sc1 lds
    buffer_load_dwordx4 v1, s[4:7], s50 offen offset:2048  sc1 lds
    buffer_load_dwordx4 v1, s[4:7], s50 offen offset:3072  sc1 lds
    s_add_u32 m0, s30, 129024
    s_add_u32 s51, s35, 4096
    buffer_load_dwordx4 v1, s[4:7], s51 offen offset:0 sc1 lds
    buffer_load_dwordx4 v1, s[4:7], s51 offen offset:1024 sc1 lds
    buffer_load_dwordx4 v2, s[4:7], s51 offen offset:2048 sc1 lds
    buffer_load_dwordx4 v2, s[4:7], s51 offen offset:3072 sc1 lds
    s_mov_b32 s60, 65536
    s_waitcnt vmcnt(17)
L_g_chk:
    v_or3_b32 v32, v17, v19, v21
    v_or3_b32 v33, v23, v25, v27
    v_or3_b32 v32, v29, v31, v32
    v_or_b32 v32, v32, v33
    v_cmp_gt_i32 vcc, 0, v32
    s_sub_u32 s60, s60, 1
    s_cbranch_scc1 L_g_ok
    s_cbranch_vccz L_g_ok
    buffer_load_dwordx4 v[16:19], v3, s[4:7], s29 offen offset:0 sc1
    buffer_load_dwordx4 v[20:23], v3, s[4:7], s29 offen offset:1024 sc1
    buffer_load_dwordx4 v[24:27], v3, s[4:7], s29 offen offset:2048 sc1
    buffer_load_dwordx4 v[28:31], v3, s[4:7], s29 offen offset:3072 sc1
    s_waitcnt vmcnt(0)
    s_branch L_g_chk
L_g_ok:
    v_add_f32 v16, v16, v20
    v_add_f32 v24, v24, v28
    v_add_f32 v17, v17, v21
    v_add_f32 v25, v25, v29
    v_add_f32 v18, v18, v22
    v_add_f32 v26, v26, v30
    v_add_f32 v19, v19, v23
    v_add_f32 v27, v27, v31
    v_add_f32 v16, v16, v24
    v_add_f32 v17, v17, v25
    v_add_f32 v18, v18, v26
    v_add_f32 v19, v19, v27
    v_add_f32_dpp v16, v16, v16 row_ror:4 row_mask:0xf bank_mask:0xf
    v_add_f32_dpp v17, v17, v17 row_ror:4 row_mask:0xf bank_mask:0xf
    v_add_f32_dpp v18, v18, v18 row_ror:4 row_mask:0xf bank_mask:0xf
    v_add_f32_dpp v19, v19, v19 row_ror:4 row_mask:0xf bank_mask:0xf
    v_add_f32_dpp v16, v16, v16 row_ror:8 row_mask:0xf bank_mask:0xf
    v_add_f32_dpp v17, v17, v17 row_ror:8 row_mask:0xf bank_mask:0xf
    v_add_f32_dpp v18, v18, v18 row_ror:8 row_mask:0xf bank_mask:0xf
    v_add_f32_dpp v19, v19, v19 row_ror:8 row_mask:0xf bank_mask:0xf
    v_mul_f32 v16, 0x39e38e39, v16
    v_mul_f32 v17, 0x39e38e39, v17
    v_mul_f32 v18, 0x39e38e39, v18
    v_mul_f32 v19, 0x39e38e39, v19
    v_fma_f32 v17, -v16, v16, v17
    v_fma_f32 v19, -v18, v18, v19
    v_max_f32 v17, 0, v17
    v_max_f32 v19, 0, v19
    v_add_f32 v17, 0x3727c5ac, v17
    v_add_f32 v19, 0x3727c5ac, v19
    v_rsq_f32 v20, v17
    v_rsq_f32 v21, v19
    v_and_b32 v32, 0xff, v3
    s_lshl_b32 s33, s20, 8
    s_add_u32 s33, s33, 148480
    v_add_u32 v32, s33, v32
    v_mul_f32 v22, v16, v20
    v_mul_f32 v23, v18, v21
    ds_write_b128 v32, v[20:23]
    s_waitcnt vmcnt(17) lgkmcnt(0)
    s_barrier
    s_mov_b32 s48, 3
    s_mul_i32 s50, s48, 18432
    s_add_u32 s50, s50, s34
    s_add_u32 s50, s50, 165888
    s_add_u32 m0, s30, 0
    s_mov_b32 s53, s50
    buffer_load_dwordx4 v1, s[4:7], s50 offen offset:0  sc1 lds
    buffer_load_dwordx4 v1, s[4:7], s50 offen offset:1024  sc1 lds
    buffer_load_dwordx4 v1, s[4:7], s50 offen offset:2048  sc1 lds
    buffer_load_dwordx4 v1, s[4:7], s50 offen offset:3072  sc1 lds
    s_add_u32 m0, s30, 18432
    s_add_u32 s51, s35, 6144
    buffer_load_dwordx4 v1, s[4:7], s51 offen offset:0 sc1 lds
    buffer_load_dwordx4 v1, s[4:7], s51 offen offset:1024 sc1 lds
    buffer_load_dwordx4 v2, s[4:7], s51 offen offset:2048 sc1 lds
    buffer_load_dwordx4 v2, s[4:7], s51 offen offset:3072 sc1 lds
    s_waitcnt vmcnt(16) lgkmcnt(0)
    s_barrier
    s_mov_b32 s48, 4
    s_mul_i32 s50, s48, 18432
    s_add_u32 s50, s50, s34
    s_add_u32 s50, s50, 165888
    s_cmp_ge_u32 s20, 2
    s_cselect_b32 s52, s50, s53
    s_add_u32 m0, s31, 0
    s_add_u32 s52, s52, s49
    buffer_load_dwordx4 v1, s[4:7], s52 offen  sc1 lds
    s_add_u32 m0, s30, 36864
    s_mov_b32 s53, s50
    buffer_load_dwordx4 v1, s[4:7], s50 offen offset:0  sc1 lds
    buffer_load_dwordx4 v1, s[4:7], s50 offen offset:1024  sc1 lds
    buffer_load_dwordx4 v1, s[4:7], s50 offen offset:2048  sc1 lds
    buffer_load_dwordx4 v1, s[4:7], s50 offen offset:3072  sc1 lds
    s_add_u32 m0, s30, 55296
    s_add_u32 s51, s35, 8192
    buffer_load_dwordx4 v1, s[4:7], s51 offen offset:0 sc1 lds
    buffer_load_dwordx4 v1, s[4:7], s51 offen offset:1024 sc1 lds
    buffer_load_dwordx4 v2, s[4:7], s51 offen offset:2048 sc1 lds
    buffer_load_dwordx4 v2, s[4:7], s51 offen offset:3072 sc1 lds
    s_waitcnt vmcnt(17) lgkmcnt(0)
    s_barrier
    s_waitcnt vmcnt(8) lgkmcnt(0)
    s_barrier
    s_waitcnt vmcnt(0) lgkmcnt(0)
    s_barrier
    s_barrier
    s_mov_b32 s56, 1
    s_atomic_add s56, s[54:55], 0
    s_mov_b32 s57, 0
    s_atomic_add s57, s[54:55], 0 glc
    s_lshl_b32 s48, s23, 1
    s_add_u32 s48, s48, 0
    s_add_u32 m0, s30, 92160
    s_lshl_b32 s51, s48, 7
    buffer_load_dwordx4 v8, s[8:11], s51 offen offset:0  lds
    buffer_load_dwordx4 v9, s[8:11], s51 offen offset:1024  lds
    buffer_load_dwordx4 v10, s[8:11], s51 offen offset:2048  lds
    buffer_load_dwordx4 v11, s[8:11], s51 offen offset:3072  lds
    s_lshl_b32 s48, s23, 1
    s_add_u32 s48, s48, 1
    s_add_u32 m0, s30, 129024
    s_lshl_b32 s51, s48, 7
    buffer_load_dwordx4 v8, s[8:11], s51 offen offset:0  lds
    buffer_load_dwordx4 v9, s[8:11], s51 offen offset:1024  lds
    buffer_load_dwordx4 v10, s[8:11], s51 offen offset:2048  lds
    buffer_load_dwordx4 v11, s[8:11], s51 offen offset:3072  lds
    s_lshr_b32 s48, s46, 1
    s_cmp_eq_u32 s48, s23
    s_cselect_b32 s48, 1, 31
    s_and_b32 s48, s48, s46
    s_add_u32 m0, s30, 18432
    s_lshl_b32 s51, s48, 7
    buffer_load_dwordx4 v8, s[8:11], s51 offen offset:0  lds
    buffer_load_dwordx4 v9, s[8:11], s51 offen offset:1024  lds
    buffer_load_dwordx4 v10, s[8:11], s51 offen offset:2048  lds
    buffer_load_dwordx4 v11, s[8:11], s51 offen offset:3072  lds
    s_waitcnt lgkmcnt(0)
    s_cmp_ge_u32 s57, 16
    s_cbranch_scc1 L_g_r0
    s_mov_b32 s57, 0
    s_atomic_add s57, s[54:55], 0 glc
    s_waitcnt vmcnt(8)
    s_barrier
    s_waitcnt lgkmcnt(0)
    s_cmp_ge_u32 s57, 16
    s_cbranch_scc1 L_g_r1
    s_waitcnt vmcnt(4)
    s_barrier
    s_mov_b32 s60, 65536
L_poll_z2:
    s_mov_b32 s57, 0
    s_atomic_add s57, s[54:55], 0 glc
    s_waitcnt lgkmcnt(0)
    s_cmp_ge_u32 s57, 16
    s_cbranch_scc1 L_pd_z2
    s_sub_u32 s60, s60, 1
    s_cbranch_scc1 L_pd_z2
    s_sleep 2
    s_branch L_poll_z2
L_pd_z2:
    s_lshr_b32 s48, s46, 1
    s_cmp_eq_u32 s48, s23
    s_cselect_b32 s48, 1, 31
    s_and_b32 s48, s48, s46
    s_mul_i32 s50, s48, 18432
    s_add_u32 s50, s50, s36
    s_add_u32 m0, s30, 0
    s_mov_b32 s53, s50
    buffer_load_dwordx4 v1, s[4:7], s50 offen offset:0 sc1 lds
    buffer_load_dwordx4 v1, s[4:7], s50 offen offset:1024 sc1 lds
    buffer_load_dwordx4 v1, s[4:7], s50 offen offset:2048 sc1 lds
    buffer_load_dwordx4 v1, s[4:7], s50 offen offset:3072 sc1 lds
    s_lshr_b32 s48, s47, 1
    s_cmp_eq_u32 s48, s23
    s_cselect_b32 s48, 1, 31
    s_and_b32 s48, s48, s47
    s_mul_i32 s50, s48, 18432
    s_add_u32 s50, s50, s36
    s_cmp_ge_u32 s20, 2
    s_cselect_b32 s52, s50, s53
    s_add_u32 m0, s31, 0
    s_add_u32 s52, s52, s49
    buffer_load_dwordx4 v1, s[4:7], s52 offen sc1 lds
    s_add_u32 m0, s30, 36864
    s_mov_b32 s53, s50
    buffer_load_dwordx4 v1, s[4:7], s50 offen offset:0 sc1 lds
    buffer_load_dwordx4 v1, s[4:7], s50 offen offset:1024 sc1 lds
    buffer_load_dwordx4 v1, s[4:7], s50 offen offset:2048 sc1 lds
    buffer_load_dwordx4 v1, s[4:7], s50 offen offset:3072 sc1 lds
    s_lshr_b32 s48, s47, 1
    s_cmp_eq_u32 s48, s23
    s_cselect_b32 s48, 1, 31
    s_and_b32 s48, s48, s47
    s_add_u32 m0, s30, 55296
    s_lshl_b32 s51, s48, 7
    buffer_load_dwordx4 v8, s[8:11], s51 offen offset:0  lds
    buffer_load_dwordx4 v9, s[8:11], s51 offen offset:1024  lds
    buffer_load_dwordx4 v10, s[8:11], s51 offen offset:2048  lds
    buffer_load_dwordx4 v11, s[8:11], s51 offen offset:3072  lds
    s_branch L_g_jn
L_g_r0:
    s_lshr_b32 s48, s46, 1
    s_cmp_eq_u32 s48, s23
    s_cselect_b32 s48, 1, 31
    s_and_b32 s48, s48, s46
    s_mul_i32 s50, s48, 18432
    s_add_u32 s50, s50, s36
    s_add_u32 m0, s30, 0
    s_mov_b32 s53, s50
    buffer_load_dwordx4 v1, s[4:7], s50 offen offset:0 sc1 lds
    buffer_load_dwordx4 v1, s[4:7], s50 offen offset:1024 sc1 lds
    buffer_load_dwordx4 v1, s[4:7], s50 offen offset:2048 sc1 lds
    buffer_load_dwordx4 v1, s[4:7], s50 offen offset:3072 sc1 lds
    s_lshr_b32 s48, s47, 1
    s_cmp_eq_u32 s48, s23
    s_cselect_b32 s48, 1, 31
    s_and_b32 s48, s48, s47
    s_mul_i32 s50, s48, 18432
    s_add_u32 s50, s50, s36
    s_cmp_ge_u32 s20, 2
    s_cselect_b32 s52, s50, s53
    s_add_u32 m0, s31, 0
    s_add_u32 s52, s52, s49
    buffer_load_dwordx4 v1, s[4:7], s52 offen sc1 lds
    s_add_u32 m0, s30, 36864
    s_mov_b32 s53, s50
    buffer_load_dwordx4 v1, s[4:7], s50 offen offset:0 sc1 lds
    buffer_load_dwordx4 v1, s[4:7], s50 offen offset:1024 sc1 lds
    buffer_load_dwordx4 v1, s[4:7], s50 offen offset:2048 sc1 lds
    buffer_load_dwordx4 v1, s[4:7], s50 offen offset:3072 sc1 lds
    s_lshr_b32 s48, s47, 1
    s_cmp_eq_u32 s48, s23
    s_cselect_b32 s48, 1, 31
    s_and_b32 s48, s48, s47
    s_add_u32 m0, s30, 55296
    s_lshl_b32 s51, s48, 7
    buffer_load_dwordx4 v8, s[8:11], s51 offen offset:0  lds
    buffer_load_dwordx4 v9, s[8:11], s51 offen offset:1024  lds
    buffer_load_dwordx4 v10, s[8:11], s51 offen offset:2048  lds
    buffer_load_dwordx4 v11, s[8:11], s51 offen offset:3072  lds
    s_waitcnt vmcnt(21)
    s_barrier
    s_waitcnt vmcnt(17)
    s_barrier
    s_branch L_g_jn
L_g_r1:
    s_lshr_b32 s48, s46, 1
    s_cmp_eq_u32 s48, s23
    s_cselect_b32 s48, 1, 31
    s_and_b32 s48, s48, s46
    s_mul_i32 s50, s48, 18432
    s_add_u32 s50, s50, s36
    s_add_u32 m0, s30, 0
    s_mov_b32 s53, s50
    buffer_load_dwordx4 v1, s[4:7], s50 offen offset:0 sc1 lds
    buffer_load_dwordx4 v1, s[4:7], s50 offen offset:1024 sc1 lds
    buffer_load_dwordx4 v1, s[4:7], s50 offen offset:2048 sc1 lds
    buffer_load_dwordx4 v1, s[4:7], s50 offen offset:3072 sc1 lds
    s_lshr_b32 s48, s47, 1
    s_cmp_eq_u32 s48, s23
    s_cselect_b32 s48, 1, 31
    s_and_b32 s48, s48, s47
    s_mul_i32 s50, s48, 18432
    s_add_u32 s50, s50, s36
    s_cmp_ge_u32 s20, 2
    s_cselect_b32 s52, s50, s53
    s_add_u32 m0, s31, 0
    s_add_u32 s52, s52, s49
    buffer_load_dwordx4 v1, s[4:7], s52 offen sc1 lds
    s_add_u32 m0, s30, 36864
    s_mov_b32 s53, s50
    buffer_load_dwordx4 v1, s[4:7], s50 offen offset:0 sc1 lds
    buffer_load_dwordx4 v1, s[4:7], s50 offen offset:1024 sc1 lds
    buffer_load_dwordx4 v1, s[4:7], s50 offen offset:2048 sc1 lds
    buffer_load_dwordx4 v1, s[4:7], s50 offen offset:3072 sc1 lds
    s_lshr_b32 s48, s47, 1
    s_cmp_eq_u32 s48, s23
    s_cselect_b32 s48, 1, 31
    s_and_b32 s48, s48, s47
    s_add_u32 m0, s30, 55296
    s_lshl_b32 s51, s48, 7
    buffer_load_dwordx4 v8, s[8:11], s51 offen offset:0  lds
    buffer_load_dwordx4 v9, s[8:11], s51 offen offset:1024  lds
    buffer_load_dwordx4 v10, s[8:11], s51 offen offset:2048  lds
    buffer_load_dwordx4 v11, s[8:11], s51 offen offset:3072  lds
    s_waitcnt vmcnt(17)
    s_barrier
L_g_jn:
    s_add_u32 s44, s44, 4
    s_cmp_ge_u32 s44, 32
    s_cselect_b32 s44, 4, s44
    s_add_u32 s45, s45, 4
    s_cmp_ge_u32 s45, 32
    s_cselect_b32 s45, 5, s45
    s_add_u32 s46, s46, 4
    s_and_b32 s46, s46, 31
    s_add_u32 s47, s47, 4
    s_and_b32 s47, s47, 31
    s_lshr_b32 s48, s44, 1
    s_cmp_eq_u32 s48, s23
    s_cselect_b32 s48, 1, 31
    s_and_b32 s48, s48, s44
    s_mul_i32 s50, s48, 18432
    s_add_u32 s50, s50, s36
    s_add_u32 m0, s30, 73728
    s_mov_b32 s53, s50
    buffer_load_dwordx4 v1, s[4:7], s50 offen offset:0 sc1 lds
    buffer_load_dwordx4 v1, s[4:7], s50 offen offset:1024 sc1 lds
    buffer_load_dwordx4 v1, s[4:7], s50 offen offset:2048 sc1 lds
    buffer_load_dwordx4 v1, s[4:7], s50 offen offset:3072 sc1 lds
    s_lshr_b32 s48, s44, 1
    s_cmp_eq_u32 s48, s23
    s_cselect_b32 s48, 1, 31
    s_and_b32 s48, s48, s44
    s_add_u32 m0, s30, 92160
    s_lshl_b32 s51, s48, 7
    buffer_load_dwordx4 v8, s[8:11], s51 offen offset:0  lds
    buffer_load_dwordx4 v9, s[8:11], s51 offen offset:1024  lds
    buffer_load_dwordx4 v10, s[8:11], s51 offen offset:2048  lds
    buffer_load_dwordx4 v11, s[8:11], s51 offen offset:3072  lds
    s_add_u32 s44, s44, 4
    s_cmp_ge_u32 s44, 32
    s_cselect_b32 s44, 4, s44
    s_waitcnt vmcnt(16)
    s_barrier
    s_lshr_b32 s48, s45, 1
    s_cmp_eq_u32 s48, s23
    s_cselect_b32 s48, 1, 31
    s_and_b32 s48, s48, s45
    s_mul_i32 s50, s48, 18432
    s_add_u32 s50, s50, s36
    s_cmp_ge_u32 s20, 2
    s_cselect_b32 s52, s50, s53
    s_add_u32 m0, s31, 73728
    s_add_u32 s52, s52, s49
    buffer_load_dwordx4 v1, s[4:7], s52 offen sc1 lds
    s_add_u32 m0, s30, 110592
    s_mov_b32 s53, s50
    buffer_load_dwordx4 v1, s[4:7], s50 offen offset:0 sc1 lds
    buffer_load_dwordx4 v1, s[4:7], s50 offen offset:1024 sc1 lds
    buffer_load_dwordx4 v1, s[4:7], s50 offen offset:2048 sc1 lds
    buffer_load_dwordx4 v1, s[4:7], s50 offen offset:3072 sc1 lds
    s_lshr_b32 s48, s45, 1
    s_cmp_eq_u32 s48, s23
    s_cselect_b32 s48, 1, 31
    s_and_b32 s48, s48, s45
    s_add_u32 m0, s30, 129024
    s_lshl_b32 s51, s48, 7
    buffer_load_dwordx4 v8, s[8:11], s51 offen offset:0  lds
    buffer_load_dwordx4 v9, s[8:11], s51 offen offset:1024  lds
    buffer_load_dwordx4 v10, s[8:11], s51 offen offset:2048  lds
    buffer_load_dwordx4 v11, s[8:11], s51 offen offset:3072  lds
    s_add_u32 s45, s45, 4
    s_cmp_ge_u32 s45, 32
    s_cselect_b32 s45, 5, s45
    s_waitcnt vmcnt(17)
    s_barrier
    s_lshr_b32 s48, s46, 1
    s_cmp_eq_u32 s48, s23
    s_cselect_b32 s48, 1, 31
    s_and_b32 s48, s48, s46
    s_mul_i32 s50, s48, 18432
    s_add_u32 s50, s50, s36
    s_add_u32 m0, s30, 0
    s_mov_b32 s53, s50
    buffer_load_dwordx4 v1, s[4:7], s50 offen offset:0 sc1 lds
    buffer_load_dwordx4 v1, s[4:7], s50 offen offset:1024 sc1 lds
    buffer_load_dwordx4 v1, s[4:7], s50 offen offset:2048 sc1 lds
    buffer_load_dwordx4 v1, s[4:7], s50 offen offset:3072 sc1 lds
    s_lshr_b32 s48, s46, 1
    s_cmp_eq_u32 s48, s23
    s_cselect_b32 s48, 1, 31
    s_and_b32 s48, s48, s46
    s_add_u32 m0, s30, 18432
    s_lshl_b32 s51, s48, 7
    buffer_load_dwordx4 v8, s[8:11], s51 offen offset:0  lds
    buffer_load_dwordx4 v9, s[8:11], s51 offen offset:1024  lds
    buffer_load_dwordx4 v10, s[8:11], s51 offen offset:2048  lds
    buffer_load_dwordx4 v11, s[8:11], s51 offen offset:3072  lds
    s_add_u32 s46, s46, 4
    s_and_b32 s46, s46, 31
    s_waitcnt vmcnt(16)
    s_barrier
    s_lshr_b32 s48, s47, 1
    s_cmp_eq_u32 s48, s23
    s_cselect_b32 s48, 1, 31
    s_and_b32 s48, s48, s47
    s_mul_i32 s50, s48, 18432
    s_add_u32 s50, s50, s36
    s_cmp_ge_u32 s20, 2
    s_cselect_b32 s52, s50, s53
    s_add_u32 m0, s31, 0
    s_add_u32 s52, s52, s49
    buffer_load_dwordx4 v1, s[4:7], s52 offen sc1 lds
    s_add_u32 m0, s30, 36864
    s_mov_b32 s53, s50
    buffer_load_dwordx4 v1, s[4:7], s50 offen offset:0 sc1 lds
    buffer_load_dwordx4 v1, s[4:7], s50 offen offset:1024 sc1 lds
    buffer_load_dwordx4 v1, s[4:7], s50 offen offset:2048 sc1 lds
    buffer_load_dwordx4 v1, s[4:7], s50 offen offset:3072 sc1 lds
    s_lshr_b32 s48, s47, 1
    s_cmp_eq_u32 s48, s23
    s_cselect_b32 s48, 1, 31
    s_and_b32 s48, s48, s47
    s_add_u32 m0, s30, 55296
    s_lshl_b32 s51, s48, 7
    buffer_load_dwordx4 v8, s[8:11], s51 offen offset:0  lds
    buffer_load_dwordx4 v9, s[8:11], s51 offen offset:1024  lds
    buffer_load_dwordx4 v10, s[8:11], s51 offen offset:2048  lds
    buffer_load_dwordx4 v11, s[8:11], s51 offen offset:3072  lds
    s_add_u32 s47, s47, 4
    s_and_b32 s47, s47, 31
    s_mov_b32 s41, 6
L_g_ll:
    s_waitcnt vmcnt(17)
    s_barrier
    s_lshr_b32 s48, s44, 1
    s_cmp_eq_u32 s48, s23
    s_cselect_b32 s48, 1, 31
    s_and_b32 s48, s48, s44
    s_mul_i32 s50, s48, 18432
    s_add_u32 s50, s50, s36
    s_add_u32 m0, s30, 73728
    s_mov_b32 s53, s50
    buffer_load_dwordx4 v1, s[4:7], s50 offen offset:0 sc1 lds
    buffer_load_dwordx4 v1, s[4:7], s50 offen offset:1024 sc1 lds
    buffer_load_dwordx4 v1, s[4:7], s50 offen offset:2048 sc1 lds
    buffer_load_dwordx4 v1, s[4:7], s50 offen offset:3072 sc1 lds
    s_lshr_b32 s48, s44, 1
    s_cmp_eq_u32 s48, s23
    s_cselect_b32 s48, 1, 31
    s_and_b32 s48, s48, s44
    s_add_u32 m0, s30, 92160
    s_lshl_b32 s51, s48, 7
    buffer_load_dwordx4 v8, s[8:11], s51 offen offset:0  lds
    buffer_load_dwordx4 v9, s[8:11], s51 offen offset:1024  lds
    buffer_load_dwordx4 v10, s[8:11], s51 offen offset:2048  lds
    buffer_load_dwordx4 v11, s[8:11], s51 offen offset:3072  lds
    s_add_u32 s44, s44, 4
    s_cmp_ge_u32 s44, 32
    s_cselect_b32 s44, 4, s44
    s_waitcnt vmcnt(16)
    s_barrier
    s_lshr_b32 s48, s45, 1
    s_cmp_eq_u32 s48, s23
    s_cselect_b32 s48, 1, 31
    s_and_b32 s48, s48, s45
    s_mul_i32 s50, s48, 18432
    s_add_u32 s50, s50, s36
    s_cmp_ge_u32 s20, 2
    s_cselect_b32 s52, s50, s53
    s_add_u32 m0, s31, 73728
    s_add_u32 s52, s52, s49
    buffer_load_dwordx4 v1, s[4:7], s52 offen sc1 lds
    s_add_u32 m0, s30, 110592
    s_mov_b32 s53, s50
    buffer_load_dwordx4 v1, s[4:7], s50 offen offset:0 sc1 lds
    buffer_load_dwordx4 v1, s[4:7], s50 offen offset:1024 sc1 lds
    buffer_load_dwordx4 v1, s[4:7], s50 offen offset:2048 sc1 lds
    buffer_load_dwordx4 v1, s[4:7], s50 offen offset:3072 sc1 lds
    s_lshr_b32 s48, s45, 1
    s_cmp_eq_u32 s48, s23
    s_cselect_b32 s48, 1, 31
    s_and_b32 s48, s48, s45
    s_add_u32 m0, s30, 129024
    s_lshl_b32 s51, s48, 7
    buffer_load_dwordx4 v8, s[8:11], s51 offen offset:0  lds
    buffer_load_dwordx4 v9, s[8:11], s51 offen offset:1024  lds
    buffer_load_dwordx4 v10, s[8:11], s51 offen offset:2048  lds
    buffer_load_dwordx4 v11, s[8:11], s51 offen offset:3072  lds
    s_add_u32 s45, s45, 4
    s_cmp_ge_u32 s45, 32
    s_cselect_b32 s45, 5, s45
    s_waitcnt vmcnt(17)
    s_barrier
    s_lshr_b32 s48, s46, 1
    s_cmp_eq_u32 s48, s23
    s_cselect_b32 s48, 1, 31
    s_and_b32 s48, s48, s46
    s_mul_i32 s50, s48, 18432
    s_add_u32 s50, s50, s36
    s_add_u32 m0, s30, 0
    s_mov_b32 s53, s50
    buffer_load_dwordx4 v1, s[4:7], s50 offen offset:0 sc1 lds
    buffer_load_dwordx4 v1, s[4:7], s50 offen offset:1024 sc1 lds
    buffer_load_dwordx4 v1, s[4:7], s50 offen offset:2048 sc1 lds
    buffer_load_dwordx4 v1, s[4:7], s50 offen offset:3072 sc1 lds
    s_lshr_b32 s48, s46, 1
    s_cmp_eq_u32 s48, s23
    s_cselect_b32 s48, 1, 31
    s_and_b32 s48, s48, s46
    s_add_u32 m0, s30, 18432
    s_lshl_b32 s51, s48, 7
    buffer_load_dwordx4 v8, s[8:11], s51 offen offset:0  lds
    buffer_load_dwordx4 v9, s[8:11], s51 offen offset:1024  lds
    buffer_load_dwordx4 v10, s[8:11], s51 offen offset:2048  lds
    buffer_load_dwordx4 v11, s[8:11], s51 offen offset:3072  lds
    s_add_u32 s46, s46, 4
    s_and_b32 s46, s46, 31
    s_waitcnt vmcnt(16)
    s_barrier
    s_lshr_b32 s48, s47, 1
    s_cmp_eq_u32 s48, s23
    s_cselect_b32 s48, 1, 31
    s_and_b32 s48, s48, s47
    s_mul_i32 s50, s48, 18432
    s_add_u32 s50, s50, s36
    s_cmp_ge_u32 s20, 2
    s_cselect_b32 s52, s50, s53
    s_add_u32 m0, s31, 0
    s_add_u32 s52, s52, s49
    buffer_load_dwordx4 v1, s[4:7], s52 offen sc1 lds
    s_add_u32 m0, s30, 36864
    s_mov_b32 s53, s50
    buffer_load_dwordx4 v1, s[4:7], s50 offen offset:0 sc1 lds
    buffer_load_dwordx4 v1, s[4:7], s50 offen offset:1024 sc1 lds
    buffer_load_dwordx4 v1, s[4:7], s50 offen offset:2048 sc1 lds
    buffer_load_dwordx4 v1, s[4:7], s50 offen offset:3072 sc1 lds
    s_lshr_b32 s48, s47, 1
    s_cmp_eq_u32 s48, s23
    s_cselect_b32 s48, 1, 31
    s_and_b32 s48, s48, s47
    s_add_u32 m0, s30, 55296
    s_lshl_b32 s51, s48, 7
    buffer_load_dwordx4 v8, s[8:11], s51 offen offset:0  lds
    buffer_load_dwordx4 v9, s[8:11], s51 offen offset:1024  lds
    buffer_load_dwordx4 v10, s[8:11], s51 offen offset:2048  lds
    buffer_load_dwordx4 v11, s[8:11], s51 offen offset:3072  lds
    s_add_u32 s47, s47, 4
    s_and_b32 s47, s47, 31
    s_sub_u32 s41, s41, 1
    s_cmp_lg_u32 s41, 0
    s_cbranch_scc1 L_g_ll
    s_waitcnt vmcnt(17)
    s_barrier
    s_mov_b32 s32, 0
    s_mul_i32 s32, s32, 36864
    s_add_u32 s32, s32, s43
    s_add_u32 m0, s42, 73728
    s_add_u32 s33, s32, 0
    buffer_load_dwordx4 v1, s[4:7], s33 offen offset:0  sc1 lds
    buffer_load_dwordx4 v1, s[4:7], s33 offen offset:1024  sc1 lds
    buffer_load_dwordx4 v1, s[4:7], s33 offen offset:2048  sc1 lds
    buffer_load_dwordx4 v1, s[4:7], s33 offen offset:3072  sc1 lds
    s_add_u32 m0, s42, 77824
    s_add_u32 s33, s32, 4096
    buffer_load_dwordx4 v1, s[4:7], s33 offen offset:0  sc1 lds
    buffer_load_dwordx4 v1, s[4:7], s33 offen offset:1024  sc1 lds
    buffer_load_dwordx4 v1, s[4:7], s33 offen offset:2048  sc1 lds
    buffer_load_dwordx4 v1, s[4:7], s33 offen offset:3072  sc1 lds
    s_add_u32 m0, s42, 81920
    s_add_u32 s33, s32, 8192
    buffer_load_dwordx4 v1, s[4:7], s33 offen offset:0  sc1 lds
    s_waitcnt vmcnt(9)
    s_barrier
    s_mov_b32 s32, 1
    s_mul_i32 s32, s32, 36864
    s_add_u32 s32, s32, s43
    s_add_u32 m0, s42, 110592
    s_add_u32 s33, s32, 0
    buffer_load_dwordx4 v1, s[4:7], s33 offen offset:0  sc1 lds
    buffer_load_dwordx4 v1, s[4:7], s33 offen offset:1024  sc1 lds
    buffer_load_dwordx4 v1, s[4:7], s33 offen offset:2048  sc1 lds
    buffer_load_dwordx4 v1, s[4:7], s33 offen offset:3072  sc1 lds
    s_add_u32 m0, s42, 114688
    s_add_u32 s33, s32, 4096
    buffer_load_dwordx4 v1, s[4:7], s33 offen offset:0  sc1 lds
    buffer_load_dwordx4 v1, s[4:7], s33 offen offset:1024  sc1 lds
    buffer_load_dwordx4 v1, s[4:7], s33 offen offset:2048  sc1 lds
    buffer_load_dwordx4 v1, s[4:7], s33 offen offset:3072  sc1 lds
    s_add_u32 m0, s42, 118784
    s_add_u32 s33, s32, 8192
    buffer_load_dwordx4 v1, s[4:7], s33 offen offset:0  sc1 lds
    s_barrier
    v_add_u32 v12, s42, v1
    v_add_u32 v13, 36864, v12
    v_add_u32 v14, 73728, v12
    v_add_u32 v15, 110592, v12
    ds_write_b128 v13, v[40:43] offset:0
    ds_write_b128 v13, v[44:47] offset:1024
    ds_write_b128 v13, v[48:51] offset:2048
    ds_write_b128 v13, v[52:55] offset:3072
    ds_write_b128 v13, v[56:59] offset:4096
    ds_write_b128 v13, v[60:63] offset:5120
    ds_write_b128 v13, v[64:67] offset:6144
    ds_write_b128 v13, v[68:71] offset:7168
    ds_write_b128 v13, v[72:75] offset:8192
    s_barrier
    s_mov_b32 s32, 2
    s_mul_i32 s32, s32, 36864
    s_add_u32 s32, s32, s43
    s_add_u32 m0, s42, 0
    s_add_u32 s33, s32, 0
    buffer_load_dwordx4 v1, s[4:7], s33 offen offset:0  sc1 lds
    buffer_load_dwordx4 v1, s[4:7], s33 offen offset:1024  sc1 lds
    buffer_load_dwordx4 v1, s[4:7], s33 offen offset:2048  sc1 lds
    buffer_load_dwordx4 v1, s[4:7], s33 offen offset:3072  sc1 lds
    s_add_u32 m0, s42, 4096
    s_add_u32 s33, s32, 4096
    buffer_load_dwordx4 v1, s[4:7], s33 offen offset:0  sc1 lds
    buffer_load_dwordx4 v1, s[4:7], s33 offen offset:1024  sc1 lds
    buffer_load_dwordx4 v1, s[4:7], s33 offen offset:2048  sc1 lds
    buffer_load_dwordx4 v1, s[4:7], s33 offen offset:3072  sc1 lds
    s_add_u32 m0, s42, 8192
    s_add_u32 s33, s32, 8192
    buffer_load_dwordx4 v1, s[4:7], s33 offen offset:0  sc1 lds
    s_waitcnt vmcnt(18) lgkmcnt(0)
    s_barrier
    s_waitcnt vmcnt(9) lgkmcnt(15)
    s_barrier
    ds_write_b128 v14, v[76:79] offset:0
    ds_write_b128 v14, v[80:83] offset:1024
    ds_write_b128 v14, v[84:87] offset:2048
    ds_write_b128 v14, v[88:91] offset:3072
    ds_write_b128 v14, v[92:95] offset:4096
    ds_write_b128 v14, v[96:99] offset:5120
    ds_write_b128 v14, v[100:103] offset:6144
    s_waitcnt vmcnt(0) lgkmcnt(15)
    s_barrier
    ds_write_b128 v14, v[104:107] offset:7168
    ds_write_b128 v14, v[108:111] offset:8192
    ds_write_b128 v15, v[112:115] offset:0
    ds_write_b128 v15, v[116:119] offset:1024
    ds_write_b128 v15, v[120:123] offset:2048
    ds_write_b128 v15, v[124:127] offset:3072
    ds_write_b128 v15, v[128:131] offset:4096
    s_waitcnt vmcnt(63) lgkmcnt(15)
    s_barrier
    ds_write_b128 v15, v[132:135] offset:5120
    ds_write_b128 v15, v[136:139] offset:6144
    ds_write_b128 v15, v[140:143] offset:7168
    ds_write_b128 v15, v[144:147] offset:8192
    ds_write_b128 v12, v[148:151] offset:0
    ds_write_b128 v12, v[152:155] offset:1024
    ds_write_b128 v12, v[156:159] offset:2048
    s_waitcnt vmcnt(63) lgkmcnt(12)
    s_barrier
    ds_write_b128 v12, v[160:163] offset:3072
    ds_write_b128 v12, v[164:167] offset:4096
    ds_write_b128 v12, v[168:171] offset:5120
    ds_write_b128 v12, v[172:175] offset:6144
    ds_write_b128 v12, v[176:179] offset:7168
    ds_write_b128 v12, v[180:183] offset:8192
    s_waitcnt vmcnt(63) lgkmcnt(9)
    s_barrier
    ds_write_b128 v13, v[184:187] offset:0
    ds_write_b128 v13, v[188:191] offset:1024
    ds_write_b128 v13, v[192:195] offset:2048
    ds_write_b128 v13, v[196:199] offset:3072
    ds_write_b128 v13, v[200:203] offset:4096
    ds_write_b128 v13, v[204:207] offset:5120
    s_waitcnt vmcnt(63) lgkmcnt(6)
    s_barrier
    s_and_b32 s25, s2, 7
    s_lshr_b32 s26, s2, 3
    s_lshr_b32 s23, s25, 1
    s_lshl_b32 s23, s23, 2
    s_lshr_b32 s27, s26, 3
    s_add_u32 s23, s23, s27
    s_and_b32 s24, s25, 1
    s_lshl_b32 s24, s24, 3
    s_and_b32 s27, s26, 7
    s_add_u32 s24, s24, s27
    s_mul_i32 s29, s24, 129024
    s_lshl_b32 s30, s20, 12
    s_add_u32 s29, s29, s30
    s_add_u32 s29, s29, 0x3800000
    s_lshl_b32 s31, s23, 3
    s_max_u32 s31, s31, 1
    s_sub_u32 s31, s31, 1
    s_mul_i32 s31, s31, 18432
    s_add_u32 s31, s31, 0x1c00000
    s_lshl_b32 s35, s20, 10
    s_and_b32 s36, s35, 1024
    ds_write_b128 v13, v[208:211] offset:6144
    ds_write_b128 v13, v[212:215] offset:7168
    ds_write_b128 v13, v[216:219] offset:8192
    ds_write_b128 v14, v[220:223] offset:0
    ds_write_b128 v14, v[224:227] offset:1024
    ds_write_b128 v14, v[228:231] offset:2048
    s_waitcnt vmcnt(63) lgkmcnt(3)
    s_barrier
    ds_write_b128 v14, v[232:235] offset:3072
    ds_write_b128 v14, v[236:239] offset:4096
    ds_write_b128 v14, v[240:243] offset:5120
    ds_write_b128 v14, v[244:247] offset:6144
    ds_write_b128 v14, v[248:251] offset:7168
    ds_write_b128 v14, v[252:255] offset:8192
    s_waitcnt vmcnt(63) lgkmcnt(0)
    s_barrier
    s_cmp_eq_u32 s22, 1
    s_cbranch_scc1 L_m_t8
    s_add_u32 m0, s30, 0
    s_add_u32 s34, s29, 0
    buffer_load_dwordx4 v1, s[4:7], s34 offen offset:0 sc1 lds
    buffer_load_dwordx4 v1, s[4:7], s34 offen offset:1024 sc1 lds
    buffer_load_dwordx4 v1, s[4:7], s34 offen offset:2048 sc1 lds
    buffer_load_dwordx4 v1, s[4:7], s34 offen offset:3072 sc1 lds
    s_add_u32 m0, s30, 16384
    s_add_u32 s34, s29, 16384
    buffer_load_dwordx4 v1, s[4:7], s34 offen offset:0 sc1 lds
    buffer_load_dwordx4 v1, s[4:7], s34 offen offset:1024 sc1 lds
    buffer_load_dwordx4 v1, s[4:7], s34 offen offset:2048 sc1 lds
    buffer_load_dwordx4 v1, s[4:7], s34 offen offset:3072 sc1 lds
L_m_t8:
    s_cmp_eq_u32 s22, 1
    s_cbranch_scc1 L_m_lfin
    s_barrier
    s_add_u32 m0, s30, 32768
    s_add_u32 s34, s29, 32768
    buffer_load_dwordx4 v1, s[4:7], s34 offen offset:0 sc1 lds
    buffer_load_dwordx4 v1, s[4:7], s34 offen offset:1024 sc1 lds
    buffer_load_dwordx4 v1, s[4:7], s34 offen offset:2048 sc1 lds
    buffer_load_dwordx4 v1, s[4:7], s34 offen offset:3072 sc1 lds
    s_add_u32 m0, s30, 114688
    s_add_u32 s34, s29, 114688
    buffer_load_dwordx4 v1, s[4:7], s34 offen offset:0 sc1 lds
    buffer_load_dwordx4 v1, s[4:7], s34 offen offset:1024 sc1 lds
    buffer_load_dwordx4 v1, s[4:7], s34 offen offset:2048 sc1 lds
    buffer_load_dwordx4 v1, s[4:7], s34 offen offset:3072 sc1 lds
    s_mov_b32 s22, 1
    s_mov_b32 s21, 0x1c00000
    s_barrier
    s_barrier
    s_add_u32 m0, s30, 49152
    s_add_u32 s34, s29, 49152
    buffer_load_dwordx4 v1, s[4:7], s34 offen offset:0 sc1 lds
    buffer_load_dwordx4 v1, s[4:7], s34 offen offset:1024 sc1 lds
    buffer_load_dwordx4 v1, s[4:7], s34 offen offset:2048 sc1 lds
    buffer_load_dwordx4 v1, s[4:7], s34 offen offset:3072 sc1 lds
    v_lshrrev_b32 v2, 8, v1
    v_bfe_u32 v3, v1, 7, 1
    v_bfe_u32 v4, v1, 4, 3
    v_cmp_gt_u32 vcc, 3, v2
    v_mul_u32_u24 v3, 80, v3
    v_lshl_add_u32 v3, v4, 3, v3
    v_lshrrev_b32 v5, 1, v4
    v_and_b32 v4, 1, v4
    v_lshl_add_u32 v4, v4, 3, 64
    v_cndmask_b32 v2, v5, v2, vcc
    v_cndmask_b32 v3, v4, v3, vcc
    v_mul_u32_u24 v2, 2304, v2
    v_add_u32 v0, v2, v3
    v_lshrrev_b32 v8, 1, v1
    s_mul_i32 s34, s24, 144
    s_add_u32 s34, s34, 0x4400000
    buffer_load_dwordx2 v[2:3], v0, s[4:7], s34 offen sc1
    s_mul_i32 s34, s24, 144
    s_add_u32 s34, s34, 0x4402000
    buffer_load_dwordx2 v[4:5], v0, s[4:7], s34 offen sc1
    s_mul_i32 s34, s24, 144
    s_add_u32 s34, s34, 0x4404000
    buffer_load_dwordx2 v[6:7], v0, s[4:7], s34 offen sc1
    s_mul_i32 s34, s24, 144
    s_add_u32 s34, s34, 0x4406000
    buffer_load_dwordx2 v[12:13], v0, s[4:7], s34 offen sc1
    s_add_u32 m0, s30, 65536
    s_add_u32 s34, s29, 65536
    buffer_load_dwordx4 v1, s[4:7], s34 offen offset:0 sc1 lds
    buffer_load_dwordx4 v1, s[4:7], s34 offen offset:1024 sc1 lds
    buffer_load_dwordx4 v1, s[4:7], s34 offen offset:2048 sc1 lds
    buffer_load_dwordx4 v1, s[4:7], s34 offen offset:3072 sc1 lds
    s_add_u32 m0, s30, 81920
    s_add_u32 s34, s29, 81920
    buffer_load_dwordx4 v1, s[4:7], s34 offen offset:0 sc1 lds
    buffer_load_dwordx4 v1, s[4:7], s34 offen offset:1024 sc1 lds
    buffer_load_dwordx4 v1, s[4:7], s34 offen offset:2048 sc1 lds
    buffer_load_dwordx4 v1, s[4:7], s34 offen offset:3072 sc1 lds
    s_barrier
    s_add_u32 m0, s35, 131072
    s_add_u32 s34, s31, s35
    s_add_u32 s34, s34, 0
    buffer_load_dwordx4 v1, s[4:7], s34 offen sc1 lds
    s_waitcnt vmcnt(29) lgkmcnt(0)
    s_barrier
    s_add_u32 m0, s35, 135168
    s_add_u32 s34, s31, s35
    s_add_u32 s34, s34, 4096
    buffer_load_dwordx4 v1, s[4:7], s34 offen sc1 lds
    s_add_u32 m0, s35, 139264
    s_add_u32 s34, s31, s35
    s_add_u32 s34, s34, 8192
    buffer_load_dwordx4 v1, s[4:7], s34 offen sc1 lds
    s_add_u32 m0, s35, 143360
    s_add_u32 s34, s31, s35
    s_add_u32 s34, s34, 12288
    buffer_load_dwordx4 v1, s[4:7], s34 offen sc1 lds
    s_add_u32 m0, s30, 98304
    s_add_u32 s34, s29, 98304
    buffer_load_dwordx4 v1, s[4:7], s34 offen offset:0 sc1 lds
    buffer_load_dwordx4 v1, s[4:7], s34 offen offset:1024 sc1 lds
    buffer_load_dwordx4 v1, s[4:7], s34 offen offset:2048 sc1 lds
    buffer_load_dwordx4 v1, s[4:7], s34 offen offset:3072 sc1 lds
    s_add_u32 m0, s36, 147456
    s_add_u32 s34, s31, s36
    s_add_u32 s34, s34, 16384
    buffer_load_dwordx4 v1, s[4:7], s34 offen sc1 lds
    s_waitcnt vmcnt(8) lgkmcnt(0)
    s_barrier
    s_waitcnt vmcnt(8) lgkmcnt(0)
    s_barrier
    s_waitcnt vmcnt(7) lgkmcnt(0)
    s_barrier
    v_add_f32 v2, v2, v4
    v_add_f32 v3, v3, v5
    v_add_f32 v6, v6, v12
    v_add_f32 v7, v7, v13
    v_add_f32 v2, v2, v6
    v_add_f32 v3, v3, v7
    v_cmp_gt_u32 vcc, 864, v1
    v_add_u32 v8, 161792, v8
    s_nop 0
    v_cndmask_b32 v2, 0, v2, vcc
    v_cndmask_b32 v3, 0, v3, vcc
    ds_write_b64 v8, v[2:3]
    s_waitcnt vmcnt(6) lgkmcnt(0)
    s_barrier
    s_waitcnt vmcnt(6) lgkmcnt(0)
    s_barrier
    s_waitcnt vmcnt(1) lgkmcnt(0)
    s_barrier
    s_waitcnt vmcnt(0) lgkmcnt(0)
    s_barrier
    s_barrier
    s_branch L_m_ll
L_m_lfin:
L_end_m:
    s_endpgm

.section .rodata,"a"
.p2align 6
.amdhsa_kernel interleave_layers__sliding_local_dilated__mixer_gmlp__prompt_kernel
  .amdhsa_next_free_vgpr 256
  .amdhsa_next_free_sgpr 102
  .amdhsa_accum_offset 256
  .amdhsa_group_segment_fixed_size 0
  .amdhsa_kernarg_size 88
  .amdhsa_user_sgpr_count 2
  .amdhsa_user_sgpr_kernarg_segment_ptr 1
  .amdhsa_system_sgpr_workgroup_id_x 1
  .amdhsa_float_denorm_mode_32 3
.end_amdhsa_kernel
```

```asm
; @launch grid=(256,1,1) block=(512,1,1) lds=163840
.amdgcn_target "amdgcn-amd-amdhsa--gfx950"
.text
.globl interleave_layers__sliding_local_dilated__mixer_gmlp__prompt_kernel
.p2align 8
.type interleave_layers__sliding_local_dilated__mixer_gmlp__prompt_kernel,@function
interleave_layers__sliding_local_dilated__mixer_gmlp__prompt_kernel:
    s_cmp_ge_u32 s2, 256
    s_cbranch_scc1 L_end_m
    s_load_dwordx16 s[36:51], s[0:1], 0
    s_load_dwordx4 s[56:59], s[0:1], 64
    s_load_dwordx2 s[24:25], s[0:1], 80
    s_getpc_b64 s[26:27]
L_m_pc:
    s_sub_u32 s26, s26, L_m_pc-interleave_layers__sliding_local_dilated__mixer_gmlp__prompt_kernel
    s_subb_u32 s27, s27, 0
    v_lshlrev_b32 v4, 4, v0
    v_mov_b32 v5, s27
    v_add_co_u32 v6, vcc, s26, v4
    s_lshr_b32 s28, s2, 3
    s_lshl_b32 s28, s28, 11
    v_addc_co_u32 v7, vcc, 0, v5, vcc
    global_load_dwordx4 v[60:63], v[6:7], off
    v_lshl_add_u32 v4, v0, 2, s28
    v_min_u32 v4, L_end_m-interleave_layers__sliding_local_dilated__mixer_gmlp__prompt_kernel-4, v4
    v_add_co_u32 v6, vcc, s26, v4
    s_nop 1
    v_addc_co_u32 v7, vcc, 0, v5, vcc
    global_load_dword v64, v[6:7], off
    v_lshrrev_b32 v2, 6, v0
    v_and_b32 v1, 63, v0
    v_lshlrev_b32 v1, 4, v1
    v_readfirstlane_b32 s23, v2
    s_mov_b32 s22, 0
    s_mov_b32 s21, 0
    s_and_b32 s20, s23, 3
    s_waitcnt lgkmcnt(0)
    s_mov_b32 s4, s24
    s_mov_b32 s5, s25
    s_mov_b32 s6, 0x10000000
    s_mov_b32 s7, 0x20000
    s_mov_b32 s8, s46
    s_mov_b32 s9, s47
    s_mov_b32 s10, 0x800000
    s_mov_b32 s11, 0x20000
    s_mov_b32 s12, s48
    s_mov_b32 s13, s49
    s_mov_b32 s14, 0x1000
    s_mov_b32 s15, 0x20000
    s_mov_b32 s16, s56
    s_mov_b32 s17, s57
    s_mov_b32 s18, 0x240000
    s_mov_b32 s19, 0x20000
    s_cmp_ge_u32 s23, 4
    s_cbranch_scc1 L_ld_m
    v_mov_b32 v2, 163808
    v_mov_b32 v4, 0
    v_mov_b32 v5, 0
    ds_write2_b64 v2, v[4:5], v[4:5] offset0:0 offset1:1
    s_waitcnt lgkmcnt(0)
    v_bfe_u32 v2, v1, 4, 4
    v_lshrrev_b32 v3, 8, v1
    v_bfrev_b32 v6, 1
    v_mov_b32 v11, 0x3f803f80
    s_lshl_b32 s30, s20, 12
    s_and_b32 s29, s20, 1
    s_cmp_lt_u32 s2, 128
    s_cbranch_scc1 L_p0_x
    s_cmp_lt_u32 s2, 236
    s_cbranch_scc1 L_p0_wq
    s_cmp_lt_u32 s2, 254
    s_cbranch_scc1 L_p0_wo
    s_mov_b32 s46, 0
    s_mov_b32 s27, 0x800000
    s_barrier
    s_barrier
    s_branch L_p0_cd
L_p0_wo:
    s_mul_i32 s30, s20, 9216
    s_sub_u32 s26, s2, 236
    s_mul_i32 s28, s26, 57
    s_lshr_b32 s28, s28, 9
    s_mul_i32 s27, s28, 9
    s_sub_u32 s27, s26, s27
    s_mov_b32 s32, s40
    s_mov_b32 s33, s41
    s_mov_b32 s34, 0xa2000
    s_mov_b32 s35, 0x20000
    s_mul_i32 s29, s28, 331776
    s_lshl_b32 s31, s27, 7
    s_add_u32 s29, s29, s31
    s_mul_i32 s31, s20, 82944
    s_add_u32 s29, s29, s31
    s_mul_i32 s30, s20, 9216
    v_lshrrev_b32 v4, 7, v1
    v_mul_u32_u24 v4, 1152, v4
    v_and_b32 v5, 0x70, v1
    v_add_u32 v4, v4, v5
    s_add_u32 m0, s30, 0
    s_add_u32 s31, s29, 0
    buffer_load_dwordx4 v4, s[32:35], s31 offen  lds
    s_add_u32 m0, s30, 1024
    s_add_u32 s31, s29, 9216
    buffer_load_dwordx4 v4, s[32:35], s31 offen  lds
    s_add_u32 m0, s30, 2048
    s_add_u32 s31, s29, 18432
    buffer_load_dwordx4 v4, s[32:35], s31 offen  lds
    s_add_u32 m0, s30, 3072
    s_add_u32 s31, s29, 27648
    buffer_load_dwordx4 v4, s[32:35], s31 offen  lds
    s_add_u32 m0, s30, 4096
    s_add_u32 s31, s29, 36864
    buffer_load_dwordx4 v4, s[32:35], s31 offen  lds
    s_add_u32 m0, s30, 5120
    s_add_u32 s31, s29, 46080
    buffer_load_dwordx4 v4, s[32:35], s31 offen  lds
    s_add_u32 m0, s30, 6144
    s_add_u32 s31, s29, 55296
    buffer_load_dwordx4 v4, s[32:35], s31 offen  lds
    s_add_u32 m0, s30, 7168
    s_add_u32 s31, s29, 64512
    buffer_load_dwordx4 v4, s[32:35], s31 offen  lds
    s_add_u32 m0, s30, 8192
    s_add_u32 s31, s29, 73728
    buffer_load_dwordx4 v4, s[32:35], s31 offen  lds
    s_barrier
    v_lshrrev_b32 v7, 2, v2
    v_and_b32 v8, 3, v2
    v_bfe_u32 v9, v1, 7, 0
    v_xor_b32 v9, s20, v9
    v_lshlrev_b32 v9, 5, v9
    v_lshl_add_u32 v9, v7, 7, v9
    v_lshl_add_u32 v9, v8, 3, v9
    v_add_u32 v9, 0, v9
    v_mul_u32_u24 v4, 512, v3
    v_add_u32 v4, v4, v9
    v_mul_u32_u24 v5, 9216, v3
    v_add_u32 v5, v5, v9
    s_lshl_b32 s31, s27, 2
    s_add_u32 s31, s31, s20
    v_lshl_add_u32 v7, s31, 2, v7
    v_lshlrev_b32 v8, 4, v8
    v_lshl_add_u32 v8, v3, 8, v8
    v_mul_u32_u24 v9, 57, v7
    v_lshrrev_b32 v9, 10, v9
    v_mul_u32_u24 v10, 18, v9
    v_sub_u32 v10, v7, v10
    v_lshrrev_b32 v12, 3, v10
    v_and_b32 v13, 1, v10
    v_lshl_add_u32 v12, v12, 1, v13
    v_bfe_u32 v14, v10, 1, 2
    v_cmp_gt_u32 vcc, 16, v10
    v_mul_u32_u24 v9, 82944, v9
    v_add_u32 v9, v9, v8
    v_cndmask_b32 v12, 8, v12, vcc
    v_cndmask_b32 v14, v13, v14, vcc
    v_mov_b32 v15, 0x1000
    v_mov_b32 v13, 0x80
    v_cndmask_b32 v15, v13, v15, vcc
    v_lshl_add_u32 v9, v12, 10, v9
    v_lshl_add_u32 v9, v14, 6, v9
    v_add_u32 v10, v9, v15
    s_and_b32 s31, s28, 1
    s_cmp_eq_u32 s31, 1
    s_cselect_b64 vcc, -1, 0
    v_cndmask_b32 v14, v9, v10, vcc
    s_mul_i32 s31, s28, 36864
    s_add_u32 s37, s31, 0x3a00000
    s_add_u32 s38, s31, 0x3a00000
    s_add_u32 s39, s31, 0x3a02400
    s_add_u32 s40, s31, 0x3a02400
    s_add_u32 s41, s31, 0x3a04800
    s_add_u32 s42, s31, 0x3a04800
    s_add_u32 s43, s31, 0x3a06c00
    s_add_u32 s47, s31, 0x3a06c00
    s_lshr_b32 s31, s28, 1
    s_mul_i32 s31, s31, 9216
    s_add_u32 s48, s31, 0x3a12000
    s_cmp_ge_u32 s26, 4
    s_cbranch_scc1 L_p0_n2
    s_lshl_b32 s31, s26, 2
    s_add_u32 s31, s31, s20
    s_lshl_b32 s31, s31, 12
    s_add_u32 s31, s31, 0x4508000
    v_and_b32 v56, 0x380, v1
    v_add_u32 v56, v56, v1
    v_mov_b32 v52, 0
    v_mov_b32 v53, 0
    v_mov_b32 v54, 0
    v_mov_b32 v55, 0
    buffer_store_dwordx4 v[52:55], v56, s[4:7], s31 offen offset:0 sc1
    buffer_store_dwordx4 v[52:55], v56, s[4:7], s31 offen offset:2048 sc1
L_p0_n2:
    s_waitcnt vmcnt(0)
    s_barrier
    ds_read_b64_tr_b16 v[16:17], v4 offset:0
    ds_read_b64_tr_b16 v[18:19], v4 offset:2560
    ds_read_b64_tr_b16 v[20:21], v4 offset:4608
    ds_read_b64_tr_b16 v[22:23], v4 offset:7168
    ds_read_b64_tr_b16 v[24:25], v4 offset:9216
    ds_read_b64_tr_b16 v[26:27], v4 offset:11776
    ds_read_b64_tr_b16 v[28:29], v4 offset:13824
    ds_read_b64_tr_b16 v[30:31], v4 offset:16384
    ds_read_b64_tr_b16 v[32:33], v4 offset:18432
    ds_read_b64_tr_b16 v[34:35], v4 offset:20992
    ds_read_b64_tr_b16 v[36:37], v4 offset:23040
    ds_read_b64_tr_b16 v[38:39], v4 offset:25600
    ds_read_b64_tr_b16 v[40:41], v4 offset:27648
    ds_read_b64_tr_b16 v[42:43], v4 offset:30208
    ds_read_b64_tr_b16 v[44:45], v4 offset:32256
    ds_read_b64_tr_b16 v[46:47], v4 offset:34816
    ds_read_b64_tr_b16 v[48:49], v5 offset:2048
    ds_read_b64_tr_b16 v[50:51], v5 offset:6656
    s_waitcnt lgkmcnt(15)
    s_mov_b32 s31, s37
    buffer_store_dwordx4 v[16:19], v9, s[4:7], s31 offen sc1
    s_waitcnt lgkmcnt(14)
    s_mov_b32 s31, s38
    buffer_store_dwordx4 v[20:23], v10, s[4:7], s31 offen sc1
    s_waitcnt lgkmcnt(12)
    s_mov_b32 s31, s39
    buffer_store_dwordx4 v[24:27], v9, s[4:7], s31 offen sc1
    s_waitcnt lgkmcnt(10)
    s_mov_b32 s31, s40
    buffer_store_dwordx4 v[28:31], v10, s[4:7], s31 offen sc1
    s_waitcnt lgkmcnt(8)
    s_mov_b32 s31, s41
    buffer_store_dwordx4 v[32:35], v9, s[4:7], s31 offen sc1
    s_waitcnt lgkmcnt(6)
    s_mov_b32 s31, s42
    buffer_store_dwordx4 v[36:39], v10, s[4:7], s31 offen sc1
    s_waitcnt lgkmcnt(4)
    s_mov_b32 s31, s43
    buffer_store_dwordx4 v[40:43], v9, s[4:7], s31 offen sc1
    s_waitcnt lgkmcnt(2)
    s_mov_b32 s31, s47
    buffer_store_dwordx4 v[44:47], v10, s[4:7], s31 offen sc1
    s_waitcnt lgkmcnt(0)
    s_mov_b32 s31, s48
    buffer_store_dwordx4 v[48:51], v14, s[4:7], s31 offen sc1
    s_mov_b32 s46, 1
    s_mov_b32 s27, 32
    s_branch L_p0_cd
L_p0_wq:
    s_mov_b32 s32, s38
    s_mov_b32 s33, s39
    s_mov_b32 s34, 0x1e6000
    s_mov_b32 s35, 0x20000
    s_sub_u32 s23, s2, 128
    s_mul_i32 s25, s23, 19
    s_lshr_b32 s25, s25, 9
    s_mul_i32 s24, s25, 27
    s_sub_u32 s24, s23, s24
    s_mul_i32 s26, s25, 497664
    s_lshl_b32 s31, s24, 7
    s_add_u32 s26, s26, s31
    v_lshrrev_b32 v4, 7, v1
    v_mul_u32_u24 v4, 3456, v4
    v_lshrrev_b32 v5, 4, v1
    v_and_b32 v5, 16, v5
    v_xor_b32 v5, v5, v1
    v_and_b32 v5, 0x70, v5
    v_add_u32 v4, v4, v5
    s_mul_i32 s31, s20, 110592
    s_add_u32 s27, s26, s31
    s_mul_i32 s30, s20, 4224
    s_add_u32 m0, s30, 0
    s_add_u32 s31, s27, 0
    buffer_load_dwordx4 v4, s[32:35], s31 offen  lds
    s_add_u32 m0, s30, 1056
    s_add_u32 s31, s27, 27648
    buffer_load_dwordx4 v4, s[32:35], s31 offen  lds
    s_add_u32 m0, s30, 2112
    s_add_u32 s31, s27, 55296
    buffer_load_dwordx4 v4, s[32:35], s31 offen  lds
    s_add_u32 m0, s30, 3168
    s_add_u32 s31, s27, 82944
    buffer_load_dwordx4 v4, s[32:35], s31 offen  lds
    s_cmp_ge_u32 s20, 2
    s_cbranch_scc1 L_p0_q5
    s_mul_i32 s31, s29, 1056
    s_add_u32 m0, s31, 16896
    s_mul_i32 s31, s29, 27648
    s_add_u32 s31, s31, s26
    s_add_u32 s31, s31, 442368
    buffer_load_dwordx4 v4, s[32:35], s31 offen  lds
L_p0_q5:
    s_barrier
    v_lshrrev_b32 v7, 2, v2
    v_and_b32 v8, 3, v2
    s_lshl_b32 s31, s20, 5
    v_and_b32 v9, 2, v7
    v_xor_b32 v9, v9, v3
    v_lshlrev_b32 v9, 3, v9
    v_lshl_add_u32 v9, v7, 7, v9
    v_add_u32 v9, s31, v9
    v_mul_u32_u24 v4, 1056, v8
    v_add_u32 v4, v4, v9
    v_and_b32 v5, 1, v2
    v_mul_u32_u24 v5, 9504, v5
    v_add_u32 v5, v5, v9
    s_lshl_b32 s31, s24, 2
    s_add_u32 s31, s31, s20
    v_lshlrev_b32 v8, 4, v8
    v_lshl_add_u32 v8, v7, 8, v8
    v_lshl_add_u32 v7, s31, 2, v3
    v_mul_u32_u24 v9, 57, v7
    v_lshrrev_b32 v9, 13, v9
    v_mul_u32_u24 v10, 144, v9
    v_sub_u32 v10, v7, v10
    v_mul_u32_u24 v12, 57, v10
    v_lshrrev_b32 v12, 9, v12
    v_mul_u32_u24 v13, 9, v12
    v_sub_u32 v13, v10, v13
    v_cmp_lt_u32 s[36:37], 4, v13
    v_cmp_eq_u32 s[38:39], 4, v13
    v_cmp_eq_u32 s[40:41], 2, v9
    v_lshlrev_b32 v14, 1, v9
    v_add_u32 v15, 1, v14
    v_subrev_u32 v10, 5, v13
    v_cndmask_b32 v14, v14, v15, s[36:37]
    v_cndmask_b32 v13, v13, v10, s[36:37]
    v_cndmask_b32 v14, v14, 6, s[38:39]
    v_cndmask_b32 v13, v13, v9, s[38:39]
    s_and_b64 s[40:41], s[40:41], s[38:39]
    s_mov_b32 s31, 129024
    v_mul_lo_u32 v9, v12, s31
    v_add_u32 v9, v9, v8
    v_lshl_add_u32 v9, v14, 10, v9
    v_lshl_add_u32 v9, v13, 6, v9
    s_and_b32 s31, s25, 1
    v_lshrrev_b32 v8, 3, v2
    v_cmp_eq_u32 vcc, s31, v8
    v_add_u32 v15, 64, v9
    v_cndmask_b32 v15, v6, v15, s[40:41]
    v_cndmask_b32 v8, v6, v9, vcc
    v_lshlrev_b32 v10, 2, v2
    v_lshl_add_u32 v10, v7, 4, v10
    v_cmp_gt_u32 vcc, 4, v2
    s_lshl_b32 s45, s25, 13
    s_add_u32 s45, s45, 0x4400000
    v_cndmask_b32 v10, v6, v10, vcc
    s_mul_i32 s42, s25, 28672
    s_add_u32 s42, s42, 0x3800000
    s_lshr_b32 s44, s25, 1
    s_mul_i32 s44, s44, 7168
    s_add_u32 s44, s44, 0x381c000
    s_mul_i32 s26, s24, 29
    s_lshr_b32 s26, s26, 8
    s_mul_i32 s27, s26, 9
    s_sub_u32 s27, s24, s27
    s_lshl_b32 s27, s27, 4
    s_add_u32 s28, s27, 16
    v_lshrrev_b32 v254, 4, v1
    v_mul_u32_u24 v7, 9, v254
    v_add_u32 v255, 9, v7
    v_min_u32 v255, s28, v255
    v_max_u32 v7, s27, v7
    v_sub_u32 v255, v255, v7
    v_cmp_lt_i32 vcc, 0, v255
    v_lshlrev_b32 v254, 8, v254
    v_mov_b32 v14, 0x3f003f00
    v_cndmask_b32 v254, v6, v254, vcc
    s_cmp_eq_u64 s[40:41], 0
    s_cbranch_scc1 L_p0_np
    v_mov_b32 v52, 0
    v_mov_b32 v53, 0
    v_mov_b32 v54, 0
    v_mov_b32 v55, 0
    s_add_u32 s31, s42, 0
    buffer_store_dwordx4 v[52:55], v15, s[4:7], s31 offen sc1
    s_add_u32 s31, s42, 7168
    buffer_store_dwordx4 v[52:55], v15, s[4:7], s31 offen sc1
    s_add_u32 s31, s42, 14336
    buffer_store_dwordx4 v[52:55], v15, s[4:7], s31 offen sc1
    s_add_u32 s31, s42, 21504
    buffer_store_dwordx4 v[52:55], v15, s[4:7], s31 offen sc1
    s_mov_b32 s31, s44
    buffer_store_dwordx4 v[52:55], v15, s[4:7], s31 offen sc1
    s_waitcnt vmcnt(5)
    s_branch L_p0_n3
L_p0_np:
    s_waitcnt vmcnt(0)
L_p0_n3:
    s_barrier
    ds_read_b64_tr_b16 v[16:17], v4 offset:0
    ds_read_b64_tr_b16 v[18:19], v4 offset:512
    ds_read_b64_tr_b16 v[20:21], v4 offset:4224
    ds_read_b64_tr_b16 v[22:23], v4 offset:4736
    ds_read_b64_tr_b16 v[24:25], v4 offset:9504
    ds_read_b64_tr_b16 v[26:27], v4 offset:10016
    ds_read_b64_tr_b16 v[28:29], v4 offset:13728
    ds_read_b64_tr_b16 v[30:31], v4 offset:14240
    ds_read_b64_tr_b16 v[32:33], v5 offset:8448
    ds_read_b64_tr_b16 v[34:35], v5 offset:8960
    s_waitcnt lgkmcnt(8)
    s_add_u32 s31, s42, 0
    buffer_store_dwordx4 v[16:19], v9, s[4:7], s31 offen sc1
    s_waitcnt lgkmcnt(6)
    s_add_u32 s31, s42, 7168
    buffer_store_dwordx4 v[20:23], v9, s[4:7], s31 offen sc1
    s_waitcnt lgkmcnt(4)
    s_add_u32 s31, s42, 14336
    buffer_store_dwordx4 v[24:27], v9, s[4:7], s31 offen sc1
    s_waitcnt lgkmcnt(2)
    s_add_u32 s31, s42, 21504
    buffer_store_dwordx4 v[28:31], v9, s[4:7], s31 offen sc1
    s_waitcnt lgkmcnt(0)
    s_mov_b32 s31, s44
    buffer_store_dwordx4 v[32:35], v8, s[4:7], s31 offen sc1
    v_dot2_f32_bf16 v12, v16, v11, 0
    v_dot2_f32_bf16 v13, v17, v11, 0
    v_dot2_f32_bf16 v12, v18, v11, v12
    v_dot2_f32_bf16 v13, v19, v11, v13
    v_dot2_f32_bf16 v12, v20, v11, v12
    v_dot2_f32_bf16 v13, v21, v11, v13
    v_dot2_f32_bf16 v12, v22, v11, v12
    v_dot2_f32_bf16 v13, v23, v11, v13
    v_dot2_f32_bf16 v12, v24, v11, v12
    v_dot2_f32_bf16 v13, v25, v11, v13
    v_dot2_f32_bf16 v12, v26, v11, v12
    v_dot2_f32_bf16 v13, v27, v11, v13
    v_dot2_f32_bf16 v12, v28, v11, v12
    v_dot2_f32_bf16 v13, v29, v11, v13
    v_dot2_f32_bf16 v12, v30, v11, v12
    v_dot2_f32_bf16 v13, v31, v11, v13
    v_dot2_f32_bf16 v12, v32, v14, v12
    v_dot2_f32_bf16 v13, v33, v14, v13
    v_dot2_f32_bf16 v12, v34, v14, v12
    v_dot2_f32_bf16 v13, v35, v14, v13
    s_nop 2
    v_add_f32 v12, v12, v13
    s_nop 1
    v_add_f32_dpp v12, v12, v12 row_ror:4 row_mask:0xf bank_mask:0xf
    s_nop 1
    v_add_f32_dpp v12, v12, v12 row_ror:8 row_mask:0xf bank_mask:0xf
    buffer_store_dword v12, v10, s[4:7], s45 offen sc1
    s_branch L_p0_ce
L_p0_x:
    s_mov_b32 s32, s36
    s_mov_b32 s33, s37
    s_mov_b32 s34, 0x240000
    s_mov_b32 s35, 0x20000
    s_mul_i32 s26, s2, 18432
    s_mul_i32 s31, s20, 288
    s_add_u32 s28, s26, s31
    v_lshrrev_b32 v4, 6, v1
    v_mul_u32_u24 v4, 1152, v4
    v_and_b32 v5, 48, v1
    v_add_u32 v4, v4, v5
    s_add_u32 m0, s30, 0
    s_add_u32 s31, s28, 0
    buffer_load_dwordx4 v4, s[32:35], s31 offen  lds
    s_add_u32 m0, s30, 1024
    s_add_u32 s31, s28, 64
    buffer_load_dwordx4 v4, s[32:35], s31 offen  lds
    s_add_u32 m0, s30, 2048
    s_add_u32 s31, s28, 144
    buffer_load_dwordx4 v4, s[32:35], s31 offen  lds
    s_add_u32 m0, s30, 3072
    s_add_u32 s31, s28, 208
    buffer_load_dwordx4 v4, s[32:35], s31 offen  lds
    s_mul_i32 s31, s29, 576
    s_add_u32 s31, s31, s26
    v_mul_u32_u24 v7, 1152, v2
    v_mul_u32_u24 v5, 144, v3
    v_add_u32 v5, v5, v7
    buffer_load_dwordx4 v[32:35], v5, s[32:35], s31 offen offset:128
    s_lshl_b32 s27, s29, 10
    s_add_u32 s27, s27, 16384
    s_barrier
    s_barrier
    v_lshlrev_b32 v4, 6, v2
    v_lshl_add_u32 v4, v3, 4, v4
    v_add_u32 v4, s30, v4
    s_add_u32 s26, s26, 0x0
    s_add_u32 s42, s26, s30
    s_add_u32 s44, s26, s27
    s_lshl_b32 s45, s2, 10
    s_lshl_b32 s31, s20, 8
    s_add_u32 s45, s45, s31
    s_add_u32 s45, s45, 0x1b00000
    v_cmp_gt_u32 vcc, 2, v3
    v_lshrrev_b32 v10, 1, v1
    s_mov_b32 s46, 2
    v_cndmask_b32 v10, v6, v10, vcc
    s_lshr_b32 s27, s2, 3
    s_add_u32 s27, s27, 48
    s_waitcnt vmcnt(0)
    ds_read_b128 v[16:19], v4 offset:0
    ds_read_b128 v[20:23], v4 offset:1024
    ds_read_b128 v[24:27], v4 offset:2048
    ds_read_b128 v[28:31], v4 offset:3072
    s_waitcnt lgkmcnt(3)
    buffer_store_dwordx4 v[16:19], v1, s[4:7], s42 offen offset:0 sc1
    s_waitcnt lgkmcnt(2)
    buffer_store_dwordx4 v[20:23], v1, s[4:7], s42 offen offset:1024 sc1
    s_waitcnt lgkmcnt(1)
    buffer_store_dwordx4 v[24:27], v1, s[4:7], s42 offen offset:2048 sc1
    s_waitcnt lgkmcnt(0)
    buffer_store_dwordx4 v[28:31], v1, s[4:7], s42 offen offset:3072 sc1
    v_dot2_f32_bf16 v12, v16, v11, 0
    v_dot2_f32_bf16 v13, v16, v16, 0
    v_dot2_f32_bf16 v12, v17, v11, v12
    v_dot2_f32_bf16 v13, v17, v17, v13
    v_dot2_f32_bf16 v12, v18, v11, v12
    v_dot2_f32_bf16 v13, v18, v18, v13
    v_dot2_f32_bf16 v12, v19, v11, v12
    v_dot2_f32_bf16 v13, v19, v19, v13
    v_dot2_f32_bf16 v12, v20, v11, v12
    v_dot2_f32_bf16 v13, v20, v20, v13
    v_dot2_f32_bf16 v12, v21, v11, v12
    v_dot2_f32_bf16 v13, v21, v21, v13
    v_dot2_f32_bf16 v12, v22, v11, v12
    v_dot2_f32_bf16 v13, v22, v22, v13
    v_dot2_f32_bf16 v12, v23, v11, v12
    v_dot2_f32_bf16 v13, v23, v23, v13
    v_dot2_f32_bf16 v12, v24, v11, v12
    v_dot2_f32_bf16 v13, v24, v24, v13
    v_dot2_f32_bf16 v12, v25, v11, v12
    v_dot2_f32_bf16 v13, v25, v25, v13
    v_dot2_f32_bf16 v12, v26, v11, v12
    v_dot2_f32_bf16 v13, v26, v26, v13
    v_dot2_f32_bf16 v12, v27, v11, v12
    v_dot2_f32_bf16 v13, v27, v27, v13
    v_dot2_f32_bf16 v12, v28, v11, v12
    v_dot2_f32_bf16 v13, v28, v28, v13
    v_dot2_f32_bf16 v12, v29, v11, v12
    v_dot2_f32_bf16 v13, v29, v29, v13
    v_dot2_f32_bf16 v12, v30, v11, v12
    v_dot2_f32_bf16 v13, v30, v30, v13
    v_dot2_f32_bf16 v12, v31, v11, v12
    v_dot2_f32_bf16 v13, v31, v31, v13
    s_waitcnt lgkmcnt(0)
    s_cmp_ge_u32 s20, 2
    s_cbranch_scc1 L_p0_xs
    buffer_store_dwordx4 v[32:35], v1, s[4:7], s44 offen sc1
    v_dot2_f32_bf16 v12, v32, v11, v12
    v_dot2_f32_bf16 v13, v32, v32, v13
    v_dot2_f32_bf16 v12, v33, v11, v12
    v_dot2_f32_bf16 v13, v33, v33, v13
    v_dot2_f32_bf16 v12, v34, v11, v12
    v_dot2_f32_bf16 v13, v34, v34, v13
    v_dot2_f32_bf16 v12, v35, v11, v12
    v_dot2_f32_bf16 v13, v35, v35, v13
L_p0_xs:
    s_nop 2
    v_mov_b32 v14, v12
    v_mov_b32 v15, v13
    s_nop 1
    v_permlane32_swap_b32 v12, v14
    v_permlane32_swap_b32 v13, v15
    v_add_f32 v12, v12, v14
    v_add_f32 v13, v13, v15
    buffer_store_dwordx2 v[12:13], v10, s[4:7], s45 offen sc1
L_p0_cd:
    v_cmp_eq_u32 vcc, 0, v1
    s_lshl_b32 s27, s27, 8
    v_mov_b32 v255, s46
    v_mov_b32 v254, s27
    v_cndmask_b32 v254, v6, v254, vcc
L_p0_ce:
    s_mov_b32 s48, s58
    s_mov_b32 s49, s59
    s_mov_b32 s50, 0x100
    s_mov_b32 s51, 0x20000
    v_mov_b32 v4, 0
    buffer_load_dword v246, v4, s[48:51], 0 offen sc1
    s_barrier
    s_branch L_m_cl
L_d1_first:
    v_cmp_gt_u32 vcc, 4, v246
    v_mov_b32 v4, 0
    s_mov_b32 s46, 0x4500000
    s_cbranch_vccz L_pd_dbg
    s_mov_b32 s60, 65536
L_poll_dbg:
    buffer_load_dword v5, v4, s[48:51], 0 offen sc1
    s_waitcnt vmcnt(0)
    v_cmp_gt_u32 vcc, 4, v5
    s_sub_u32 s60, s60, 1
    s_cbranch_scc1 L_pd_dbg
    s_cbranch_vccz L_pd_dbg
    s_sleep 4
    s_branch L_poll_dbg
L_pd_dbg:
    buffer_atomic_add v255, v254, s[4:7], s46 offen sc1
    s_branch L_ns_d1
L_ld_m:
    s_cmp_lg_u32 s2, 0
    s_cbranch_scc1 L_p0_nz
    s_lshl_b32 s31, s20, 12
    s_add_u32 s31, s31, 0x4500000
    v_and_b32 v56, 0x380, v1
    v_add_u32 v56, v56, v1
    v_mov_b32 v52, 0
    v_mov_b32 v53, 0
    v_mov_b32 v54, 0
    v_mov_b32 v55, 0
    buffer_store_dwordx4 v[52:55], v56, s[4:7], s31 offen offset:0 sc1
    buffer_store_dwordx4 v[52:55], v56, s[4:7], s31 offen offset:2048 sc1
    s_waitcnt vmcnt(0)
    s_mov_b32 s53, 1
    s_atomic_add s53, s[58:59], 0
L_p0_nz:
    v_bfe_u32 v2, v1, 4, 4
    v_lshrrev_b32 v3, 8, v1
    v_bfrev_b32 v6, 1
    v_mov_b32 v11, 0x3f803f80
    s_mul_i32 s30, s20, 9216
    s_cmp_lt_u32 s2, 144
    s_cbranch_scc1 L_p0_wi
    s_cmp_lt_u32 s2, 216
    s_cbranch_scc1 L_p0_wu
    v_mov_b32 v9, v6
    v_mov_b32 v10, v6
    v_mov_b32 v14, v6
    v_mov_b32 v15, v6
    s_mov_b32 s37, 0
    s_mov_b32 s38, 0
    s_mov_b32 s39, 0
    s_mov_b32 s40, 0
    s_mov_b32 s41, 0
    s_mov_b32 s42, 0
    s_mov_b32 s43, 0
    s_mov_b32 s47, 0
    s_mov_b32 s48, 0
    s_mov_b32 s49, 0
    s_barrier
    s_barrier
    s_barrier
    s_barrier
    s_barrier
    s_branch L_p0_ld
L_p0_wu:
    s_sub_u32 s26, s2, 144
    s_mul_i32 s28, s26, 57
    s_lshr_b32 s28, s28, 9
    s_mul_i32 s27, s28, 9
    s_sub_u32 s27, s26, s27
    s_mov_b32 s32, s50
    s_mov_b32 s33, s51
    s_mov_b32 s34, 0x288000
    s_mov_b32 s35, 0x20000
    s_mul_i32 s29, s28, 331776
    s_lshl_b32 s31, s27, 7
    s_add_u32 s29, s29, s31
    s_mul_i32 s31, s20, 82944
    s_add_u32 s29, s29, s31
    s_mul_i32 s30, s20, 9216
    v_lshrrev_b32 v4, 7, v1
    v_mul_u32_u24 v4, 1152, v4
    v_and_b32 v5, 0x70, v1
    v_bfe_u32 v7, v1, 8, 2
    v_lshlrev_b32 v7, 5, v7
    v_xor_b32 v5, v5, v7
    v_add_u32 v4, v4, v5
    s_barrier
    s_barrier
    s_barrier
    s_barrier
    s_barrier
    s_add_u32 m0, s30, 91904
    s_add_u32 s31, s29, 0
    buffer_load_dwordx4 v4, s[32:35], s31 offen  lds
    s_add_u32 m0, s30, 92928
    s_add_u32 s31, s29, 9216
    buffer_load_dwordx4 v4, s[32:35], s31 offen  lds
    s_add_u32 m0, s30, 93952
    s_add_u32 s31, s29, 18432
    buffer_load_dwordx4 v4, s[32:35], s31 offen  lds
    s_add_u32 m0, s30, 94976
    s_add_u32 s31, s29, 27648
    buffer_load_dwordx4 v4, s[32:35], s31 offen  lds
    s_add_u32 m0, s30, 96000
    s_add_u32 s31, s29, 36864
    buffer_load_dwordx4 v4, s[32:35], s31 offen  lds
    s_add_u32 m0, s30, 97024
    s_add_u32 s31, s29, 46080
    buffer_load_dwordx4 v4, s[32:35], s31 offen  lds
    s_add_u32 m0, s30, 98048
    s_add_u32 s31, s29, 55296
    buffer_load_dwordx4 v4, s[32:35], s31 offen  lds
    s_add_u32 m0, s30, 99072
    s_add_u32 s31, s29, 64512
    buffer_load_dwordx4 v4, s[32:35], s31 offen  lds
    s_add_u32 m0, s30, 100096
    s_add_u32 s31, s29, 73728
    buffer_load_dwordx4 v4, s[32:35], s31 offen  lds
    v_lshrrev_b32 v7, 2, v2
    v_and_b32 v8, 3, v2
    v_bfe_u32 v9, v1, 7, 2
    v_xor_b32 v9, s20, v9
    v_lshlrev_b32 v9, 5, v9
    v_lshl_add_u32 v9, v7, 7, v9
    v_lshl_add_u32 v9, v8, 3, v9
    v_add_u32 v9, 91904, v9
    v_mul_u32_u24 v4, 512, v3
    v_add_u32 v4, v4, v9
    v_mul_u32_u24 v5, 512, v3
    v_add_u32 v5, v5, v9
    s_lshl_b32 s31, s27, 2
    s_add_u32 s31, s31, s20
    v_lshl_add_u32 v7, s31, 2, v7
    v_lshlrev_b32 v8, 4, v8
    v_lshl_add_u32 v8, v3, 8, v8
    v_mul_u32_u24 v9, 57, v7
    v_lshrrev_b32 v9, 10, v9
    v_mul_u32_u24 v10, 18, v9
    v_sub_u32 v10, v7, v10
    v_lshrrev_b32 v12, 3, v10
    v_and_b32 v13, 1, v10
    v_lshl_add_u32 v12, v12, 1, v13
    v_bfe_u32 v14, v10, 1, 2
    v_cmp_gt_u32 vcc, 16, v10
    v_mul_u32_u24 v9, 331776, v9
    v_add_u32 v9, v9, v8
    v_cndmask_b32 v12, 8, v12, vcc
    v_cndmask_b32 v14, v13, v14, vcc
    v_mov_b32 v15, 0x1000
    v_mov_b32 v13, 0x80
    v_cndmask_b32 v15, v13, v15, vcc
    v_lshl_add_u32 v9, v12, 10, v9
    v_lshl_add_u32 v9, v14, 6, v9
    v_add_u32 v10, v9, v15
    s_and_b32 s31, s28, 1
    s_cmp_eq_u32 s31, 1
    s_cselect_b64 vcc, -1, 0
    v_cndmask_b32 v14, v9, v10, vcc
    s_mul_i32 s31, s28, 9216
    s_add_u32 s37, s31, 0x4100000
    s_add_u32 s38, s31, 0x4100000
    s_add_u32 s39, s31, 0x4112000
    s_add_u32 s40, s31, 0x4112000
    s_add_u32 s41, s31, 0x4124000
    s_add_u32 s42, s31, 0x4124000
    s_add_u32 s43, s31, 0x4136000
    s_add_u32 s47, s31, 0x4136000
    s_lshr_b32 s31, s28, 1
    s_mul_i32 s31, s31, 9216
    s_add_u32 s48, s31, 0x4148000
    v_mov_b32 v15, v6
    s_mov_b32 s49, 0
    s_branch L_p0_ld
L_p0_wi:
    s_mov_b32 s26, s2
    s_mul_i32 s28, s26, 57
    s_lshr_b32 s28, s28, 12
    s_mul_i32 s27, s28, 72
    s_sub_u32 s27, s26, s27
    s_mov_b32 s32, s44
    s_mov_b32 s33, s45
    s_mov_b32 s34, 0x510000
    s_mov_b32 s35, 0x20000
    s_mul_i32 s29, s28, 2654208
    s_lshl_b32 s31, s27, 7
    s_add_u32 s29, s29, s31
    s_mul_i32 s31, s20, 663552
    s_add_u32 s29, s29, s31
    s_mul_i32 s30, s20, 9792
    v_lshrrev_b32 v4, 7, v1
    v_mul_u32_u24 v4, 9216, v4
    v_and_b32 v5, 0x70, v1
    v_bfe_u32 v7, v1, 8, 1
    v_lshlrev_b32 v7, 5, v7
    v_xor_b32 v5, v5, v7
    v_add_u32 v4, v4, v5
    s_barrier
    s_barrier
    s_barrier
    s_barrier
    s_barrier
    s_add_u32 m0, s30, 91904
    s_add_u32 s31, s29, 0
    buffer_load_dwordx4 v4, s[32:35], s31 offen  lds
    s_add_u32 m0, s30, 92992
    s_add_u32 s31, s29, 73728
    buffer_load_dwordx4 v4, s[32:35], s31 offen  lds
    s_add_u32 m0, s30, 94080
    s_add_u32 s31, s29, 147456
    buffer_load_dwordx4 v4, s[32:35], s31 offen  lds
    s_add_u32 m0, s30, 95168
    s_add_u32 s31, s29, 221184
    buffer_load_dwordx4 v4, s[32:35], s31 offen  lds
    s_add_u32 m0, s30, 96256
    s_add_u32 s31, s29, 294912
    buffer_load_dwordx4 v4, s[32:35], s31 offen  lds
    s_add_u32 m0, s30, 97344
    s_add_u32 s31, s29, 368640
    buffer_load_dwordx4 v4, s[32:35], s31 offen  lds
    s_add_u32 m0, s30, 98432
    s_add_u32 s31, s29, 442368
    buffer_load_dwordx4 v4, s[32:35], s31 offen  lds
    s_add_u32 m0, s30, 99520
    s_add_u32 s31, s29, 516096
    buffer_load_dwordx4 v4, s[32:35], s31 offen  lds
    s_add_u32 m0, s30, 100608
    s_add_u32 s31, s29, 589824
    buffer_load_dwordx4 v4, s[32:35], s31 offen  lds
    v_lshrrev_b32 v7, 2, v2
    v_and_b32 v8, 3, v2
    v_bfe_u32 v9, v1, 7, 1
    v_xor_b32 v9, s20, v9
    v_lshlrev_b32 v9, 5, v9
    v_lshl_add_u32 v9, v7, 7, v9
    v_lshl_add_u32 v9, v8, 3, v9
    v_add_u32 v9, 91904, v9
    v_mul_u32_u24 v4, 1088, v3
    v_add_u32 v4, v4, v9
    v_mul_u32_u24 v5, 9792, v3
    v_add_u32 v5, v5, v9
    s_lshl_b32 s31, s27, 2
    s_add_u32 s31, s31, s20
    v_lshl_add_u32 v7, s31, 2, v7
    v_lshlrev_b32 v8, 4, v8
    v_lshl_add_u32 v8, v3, 8, v8
    s_cmp_lt_u32 s31, 144
    s_cselect_b32 s23, 1, 0
    s_cselect_b32 s24, 0, 144
    s_sub_u32 s26, s31, s24
    s_mul_i32 s25, s26, 57
    s_lshr_b32 s25, s25, 9
    s_mul_i32 s24, s25, 9
    s_sub_u32 s24, s26, s24
    s_lshl_b32 s26, s25, 1
    s_add_u32 s26, s26, s23
    s_mul_i32 s26, s26, 165888
    s_lshl_b32 s31, s24, 10
    s_add_u32 s26, s26, s31
    s_add_u32 s26, s26, 0x3b00000
    s_mul_i32 s31, s28, 9216
    s_add_u32 s48, s26, s31
    s_add_u32 s48, s48, 147456
    s_lshl_b32 s31, s31, 3
    s_add_u32 s26, s26, s31
    s_add_u32 s37, s26, 0
    s_add_u32 s38, s26, 9216
    s_add_u32 s39, s26, 18432
    s_add_u32 s40, s26, 27648
    s_add_u32 s41, s26, 36864
    s_add_u32 s42, s26, 46080
    s_add_u32 s43, s26, 55296
    s_add_u32 s47, s26, 64512
    s_lshl_b32 s49, s25, 12
    s_mul_i32 s31, s28, 1152
    s_add_u32 s49, s49, s31
    s_mul_i32 s31, s23, 576
    s_add_u32 s49, s49, s31
    s_lshl_b32 s31, s24, 6
    s_add_u32 s49, s49, s31
    s_add_u32 s49, s49, 0x4410000
    v_cmp_eq_u32 vcc, 0, v3
    v_lshlrev_b32 v15, 2, v2
    v_mov_b32 v9, v1
    v_mov_b32 v10, v1
    v_mov_b32 v14, v1
    v_cndmask_b32 v15, v6, v15, vcc
L_p0_ld:
    s_waitcnt lgkmcnt(0)
    s_branch L_m_l1
L_m_cl:
    s_and_b32 s25, s2, 7
    s_lshr_b32 s26, s2, 3
    s_lshr_b32 s23, s25, 1
    s_lshl_b32 s23, s23, 2
    s_lshr_b32 s27, s26, 3
    s_add_u32 s23, s23, s27
    s_and_b32 s24, s25, 1
    s_lshl_b32 s24, s24, 3
    s_and_b32 s27, s26, 7
    s_add_u32 s24, s24, s27
    s_lshl_b32 s30, s23, 3
    s_lshl_b32 s31, s20, 1
    s_add_u32 s31, s30, s31
    s_mul_i32 s29, s31, 18432
    s_add_u32 s29, s29, s21
    s_add_u32 s35, s29, 0x600000
    s_add_u32 s29, s29, 0x0
    s_max_u32 s30, s30, 1
    s_sub_u32 s30, s30, 1
    s_lshl_b32 s30, s30, 10
    s_add_u32 s30, s30, s21
    s_add_u32 s30, s30, 0x1b00000
    s_lshl_b32 s32, s31, 10
    s_add_u32 s32, s32, s21
    s_add_u32 s32, s32, 0x1b00000
    v_bfe_u32 v2, v1, 4, 4
    v_lshrrev_b32 v3, 8, v1
    s_lshl_b32 s33, s20, 2
    s_lshr_b32 s33, 0x3362, s33
    s_and_b32 s33, s33, 15
    s_min_u32 s34, s20, 1
    s_add_u32 s34, s34, 4
    s_lshl_b32 s36, s33, 10
    s_lshl_b32 s37, s34, 10
    v_add_u32 v247, 64512, v1
    v_add_u32 v248, 131072, v1
    v_add_u32 v249, s36, v1
    v_add_u32 v250, s36, v247
    v_add_u32 v251, s37, v1
    v_add_u32 v252, s37, v247
    v_add_u32 v253, 18432, v1
    v_lshrrev_b32 v0, 1, v1
    s_add_u32 s38, s29, 0
    s_add_u32 s39, s29, 4096
    s_add_u32 s40, s29, 8192
    s_add_u32 s41, s29, 12288
    s_add_u32 s42, s29, 16384
    s_max_u32 s44, s23, 1
    s_sub_u32 s44, s44, 1
    s_lshl_b32 s52, s22, 7
    s_add_u32 s52, s52, s23
    s_lshl_b32 s52, s52, 8
    s_add_u32 s52, s52, 0x4503000
    s_add_u32 s52, s52, s4
    s_addc_u32 s53, s5, 0
    s_lshl_b32 s54, s22, 7
    s_add_u32 s54, s54, s44
    s_lshl_b32 s54, s54, 8
    s_add_u32 s54, s54, 0x4503000
    s_add_u32 s54, s54, s4
    s_addc_u32 s55, s5, 0
    s_lshl_b32 s44, s24, 8
    s_add_u32 s44, s44, 0x4500000
    s_add_u32 s44, s44, s4
    s_addc_u32 s45, s5, 0
    s_waitcnt vmcnt(0)
    s_barrier
    s_cmp_lg_u32 s20, 0
    s_cbranch_scc1 L_ns_d1
    s_cmp_eq_u32 s22, 0
    s_cbranch_scc1 L_d1_first
    s_mov_b32 s56, 1
    s_atomic_add s56, s[50:51], 0
L_ns_d1:
    s_barrier
    s_cmp_lg_u32 s20, 0
    s_cbranch_scc1 L_pd_d1
    s_mov_b32 s60, 65536
L_poll_d1:
    s_mov_b32 s57, 0
    s_atomic_add s57, s[52:53], 0 glc
    s_mov_b32 s58, 0
    s_atomic_add s58, s[54:55], 0 glc
    s_mov_b32 s59, 0
    s_atomic_add s59, s[44:45], 0 glc
    s_waitcnt lgkmcnt(0)
    s_cmp_ge_u32 s59, 108
    s_cselect_b32 s59, 16, 0
    s_min_u32 s57, s57, s58
    s_min_u32 s57, s57, s59
    s_cmp_ge_u32 s57, 16
    s_cbranch_scc1 L_pd_d1
    s_sub_u32 s60, s60, 1
    s_cbranch_scc1 L_pd_d1
    s_sleep 2
    s_branch L_poll_d1
L_pd_d1:
    s_barrier
    buffer_load_dwordx4 v[160:163], v1, s[4:7], s38 offen offset:0 sc1
    buffer_load_dwordx4 v[164:167], v253, s[4:7], s38 offen offset:0 sc1
    buffer_load_dwordx4 v[168:171], v1, s[4:7], s38 offen offset:1024 sc1
    buffer_load_dwordx4 v[172:175], v253, s[4:7], s38 offen offset:1024 sc1
    buffer_load_dwordx4 v[176:179], v1, s[4:7], s38 offen offset:2048 sc1
    buffer_load_dwordx4 v[180:183], v253, s[4:7], s38 offen offset:2048 sc1
    buffer_load_dwordx4 v[184:187], v1, s[4:7], s38 offen offset:3072 sc1
    buffer_load_dwordx4 v[188:191], v253, s[4:7], s38 offen offset:3072 sc1
    s_barrier
    ds_read_b128 v[80:83], v1 offset:0
    ds_read_b128 v[84:87], v1 offset:1024
    ds_read_b128 v[88:91], v1 offset:2048
    ds_read_b128 v[92:95], v1 offset:3072
    ds_read_b128 v[96:99], v1 offset:4096
    ds_read_b128 v[100:103], v1 offset:5120
    ds_read_b128 v[104:107], v1 offset:6144
    buffer_load_dwordx2 v[4:5], v0, s[4:7], s30 offen offset:0 sc1
    buffer_load_dwordx2 v[6:7], v0, s[4:7], s30 offen offset:512 sc1
    buffer_load_dwordx2 v[8:9], v0, s[4:7], s32 offen offset:0 sc1
    buffer_load_dwordx2 v[10:11], v0, s[4:7], s32 offen offset:512 sc1
    buffer_load_dwordx2 v[12:13], v0, s[4:7], s32 offen offset:1024 sc1
    buffer_load_dwordx2 v[14:15], v0, s[4:7], s32 offen offset:1536 sc1
    s_lshl_b32 s50, s22, 7
    s_add_u32 s50, s50, s23
    s_lshl_b32 s50, s50, 8
    s_add_u32 s50, s50, 0x4508000
    s_add_u32 s50, s50, s4
    s_addc_u32 s51, s5, 0
    s_waitcnt vmcnt(12) lgkmcnt(3)
    v_mfma_f32_16x16x32_bf16 v[16:19], v[80:83], v[160:163], 0
    ds_read_b128 v[120:123], v1 offset:7168
    v_mfma_f32_16x16x32_bf16 v[44:47], v[80:83], v[164:167], 0
    ds_read_b128 v[124:127], v1 offset:8192
    v_mfma_f32_16x16x32_bf16 v[20:23], v[84:87], v[160:163], 0
    ds_read_b128 v[128:131], v1 offset:9216
    v_mfma_f32_16x16x32_bf16 v[48:51], v[84:87], v[164:167], 0
    ds_read_b128 v[132:135], v1 offset:10240
    v_mfma_f32_16x16x32_bf16 v[24:27], v[88:91], v[160:163], 0
    ds_read_b128 v[136:139], v1 offset:11264
    v_mfma_f32_16x16x32_bf16 v[52:55], v[88:91], v[164:167], 0
    ds_read_b128 v[140:143], v1 offset:12288
    v_mfma_f32_16x16x32_bf16 v[28:31], v[92:95], v[160:163], 0
    ds_read_b128 v[144:147], v1 offset:13312
    v_mfma_f32_16x16x32_bf16 v[56:59], v[92:95], v[164:167], 0
    s_waitcnt lgkmcnt(7)
    v_mfma_f32_16x16x32_bf16 v[32:35], v[160:163], v[96:99], 0
    v_mfma_f32_16x16x32_bf16 v[60:63], v[164:167], v[96:99], 0
    v_mfma_f32_16x16x32_bf16 v[36:39], v[160:163], v[100:103], 0
    buffer_load_dwordx4 v[192:195], v1, s[4:7], s39 offen offset:0 sc1
    v_mfma_f32_16x16x32_bf16 v[64:67], v[164:167], v[100:103], 0
    buffer_load_dwordx4 v[196:199], v253, s[4:7], s39 offen offset:0 sc1
    v_mfma_f32_16x16x32_bf16 v[40:43], v[104:107], v[160:163], 0
    buffer_load_dwordx4 v[200:203], v1, s[4:7], s39 offen offset:1024 sc1
    v_mfma_f32_16x16x32_bf16 v[68:71], v[104:107], v[164:167], 0
    buffer_load_dwordx4 v[204:207], v253, s[4:7], s39 offen offset:1024 sc1
    s_waitcnt vmcnt(14) lgkmcnt(3)
    s_barrier
    v_mfma_f32_16x16x32_bf16 v[16:19], v[120:123], v[168:171], v[16:19]
    ds_read_b128 v[80:83], v1 offset:14336
    v_mfma_f32_16x16x32_bf16 v[44:47], v[120:123], v[172:175], v[44:47]
    ds_read_b128 v[84:87], v1 offset:15360
    v_mfma_f32_16x16x32_bf16 v[20:23], v[124:127], v[168:171], v[20:23]
    ds_read_b128 v[88:91], v1 offset:16384
    v_mfma_f32_16x16x32_bf16 v[48:51], v[124:127], v[172:175], v[48:51]
    ds_read_b128 v[92:95], v1 offset:17408
    v_mfma_f32_16x16x32_bf16 v[24:27], v[128:131], v[168:171], v[24:27]
    ds_read_b128 v[96:99], v1 offset:18432
    v_mfma_f32_16x16x32_bf16 v[52:55], v[128:131], v[172:175], v[52:55]
    ds_read_b128 v[100:103], v1 offset:19456
    v_mfma_f32_16x16x32_bf16 v[28:31], v[132:135], v[168:171], v[28:31]
    ds_read_b128 v[104:107], v1 offset:20480
    v_mfma_f32_16x16x32_bf16 v[56:59], v[132:135], v[172:175], v[56:59]
    ds_read_b128 v[108:111], v248 offset:0
    s_waitcnt lgkmcnt(8)
    v_mfma_f32_16x16x32_bf16 v[32:35], v[168:171], v[136:139], v[32:35]
    ds_read_b128 v[112:115], v249 offset:0
    v_mfma_f32_16x16x32_bf16 v[60:63], v[172:175], v[136:139], v[60:63]
    ds_read_b128 v[116:119], v251 offset:0
    v_mfma_f32_16x16x32_bf16 v[36:39], v[168:171], v[140:143], v[36:39]
    buffer_load_dwordx4 v[160:163], v1, s[4:7], s39 offen offset:2048 sc1
    v_mfma_f32_16x16x32_bf16 v[64:67], v[172:175], v[140:143], v[64:67]
    buffer_load_dwordx4 v[164:167], v253, s[4:7], s39 offen offset:2048 sc1
    v_mfma_f32_16x16x32_bf16 v[40:43], v[144:147], v[168:171], v[40:43]
    v_mfma_f32_16x16x32_bf16 v[68:71], v[144:147], v[172:175], v[68:71]
    s_waitcnt vmcnt(6) lgkmcnt(6)
    v_mfma_f32_16x16x32_bf16 v[16:19], v[80:83], v[176:179], v[16:19]
    ds_read_b128 v[120:123], v1 offset:21504
    v_mfma_f32_16x16x32_bf16 v[44:47], v[80:83], v[180:183], v[44:47]
    ds_read_b128 v[124:127], v1 offset:22528
    v_add_f32 v240, v4, v6
    v_mfma_f32_16x16x32_bf16 v[20:23], v[84:87], v[176:179], v[20:23]
    ds_read_b128 v[128:131], v1 offset:23552
    v_add_f32 v241, v5, v7
    v_mfma_f32_16x16x32_bf16 v[48:51], v[84:87], v[180:183], v[48:51]
    ds_read_b128 v[132:135], v1 offset:24576
    v_add_f32 v242, v8, v10
    v_mfma_f32_16x16x32_bf16 v[24:27], v[88:91], v[176:179], v[24:27]
    ds_read_b128 v[136:139], v1 offset:25600
    v_add_f32 v243, v9, v11
    v_mfma_f32_16x16x32_bf16 v[52:55], v[88:91], v[180:183], v[52:55]
    ds_read_b128 v[140:143], v1 offset:26624
    v_add_f32 v244, v12, v14
    v_mfma_f32_16x16x32_bf16 v[28:31], v[92:95], v[176:179], v[28:31]
    ds_read_b128 v[144:147], v1 offset:27648
    v_add_f32 v245, v13, v15
    v_mfma_f32_16x16x32_bf16 v[56:59], v[92:95], v[180:183], v[56:59]
    ds_read_b128 v[148:151], v248 offset:1024
    s_waitcnt lgkmcnt(8)
    v_mfma_f32_16x16x32_bf16 v[32:35], v[176:179], v[96:99], v[32:35]
    ds_read_b128 v[152:155], v249 offset:7168
    v_mov_b32 v4, v240
    v_mfma_f32_16x16x32_bf16 v[60:63], v[180:183], v[96:99], v[60:63]
    ds_read_b128 v[156:159], v251 offset:7168
    v_mov_b32 v5, v241
    v_mfma_f32_16x16x32_bf16 v[36:39], v[176:179], v[100:103], v[36:39]
    buffer_load_dwordx4 v[168:171], v1, s[4:7], s39 offen offset:3072 sc1
    v_mfma_f32_16x16x32_bf16 v[64:67], v[180:183], v[100:103], v[64:67]
    buffer_load_dwordx4 v[172:175], v253, s[4:7], s39 offen offset:3072 sc1
    v_mfma_f32_16x16x32_bf16 v[40:43], v[104:107], v[176:179], v[40:43]
    v_mov_b32 v8, v242
    v_mfma_f32_16x16x32_bf16 v[68:71], v[104:107], v[180:183], v[68:71]
    v_mov_b32 v9, v243
    v_mfma_f32_16x16x32_bf16 v[72:75], v[112:115], v[108:111], 0
    v_mov_b32 v12, v244
    v_mov_b32 v13, v245
    v_mfma_f32_16x16x32_bf16 v[76:79], v[108:111], v[116:119], 0
    v_permlane32_swap_b32 v240, v4
    s_waitcnt vmcnt(8) lgkmcnt(6)
    s_barrier
    v_mfma_f32_16x16x32_bf16 v[16:19], v[120:123], v[184:187], v[16:19]
    ds_read_b128 v[80:83], v1 offset:28672
    v_mfma_f32_16x16x32_bf16 v[44:47], v[120:123], v[188:191], v[44:47]
    ds_read_b128 v[84:87], v1 offset:29696
    v_permlane32_swap_b32 v241, v5
    v_mfma_f32_16x16x32_bf16 v[20:23], v[124:127], v[184:187], v[20:23]
    ds_read_b128 v[88:91], v1 offset:30720
    v_permlane32_swap_b32 v242, v8
    v_mfma_f32_16x16x32_bf16 v[48:51], v[124:127], v[188:191], v[48:51]
    ds_read_b128 v[92:95], v1 offset:31744
    v_permlane32_swap_b32 v243, v9
    v_mfma_f32_16x16x32_bf16 v[24:27], v[128:131], v[184:187], v[24:27]
    ds_read_b128 v[96:99], v1 offset:32768
    v_permlane32_swap_b32 v244, v12
    v_mfma_f32_16x16x32_bf16 v[52:55], v[128:131], v[188:191], v[52:55]
    ds_read_b128 v[100:103], v1 offset:33792
    v_permlane32_swap_b32 v245, v13
    v_mfma_f32_16x16x32_bf16 v[28:31], v[132:135], v[184:187], v[28:31]
    ds_read_b128 v[104:107], v1 offset:34816
    v_add_f32 v240, v240, v4
    v_mfma_f32_16x16x32_bf16 v[56:59], v[132:135], v[188:191], v[56:59]
    ds_read_b128 v[108:111], v248 offset:2048
    s_waitcnt lgkmcnt(8)
    v_mfma_f32_16x16x32_bf16 v[32:35], v[184:187], v[136:139], v[32:35]
    ds_read_b128 v[112:115], v249 offset:14336
    v_add_f32 v241, v241, v5
    v_mfma_f32_16x16x32_bf16 v[60:63], v[188:191], v[136:139], v[60:63]
    ds_read_b128 v[116:119], v251 offset:14336
    v_add_f32 v242, v242, v8
    v_mfma_f32_16x16x32_bf16 v[36:39], v[184:187], v[140:143], v[36:39]
    buffer_load_dwordx4 v[176:179], v1, s[4:7], s40 offen offset:0 sc1
    v_mfma_f32_16x16x32_bf16 v[64:67], v[188:191], v[140:143], v[64:67]
    buffer_load_dwordx4 v[180:183], v253, s[4:7], s40 offen offset:0 sc1
    v_mfma_f32_16x16x32_bf16 v[40:43], v[144:147], v[184:187], v[40:43]
    v_add_f32 v243, v243, v9
    v_mfma_f32_16x16x32_bf16 v[68:71], v[144:147], v[188:191], v[68:71]
    v_add_f32 v244, v244, v12
    v_mfma_f32_16x16x32_bf16 v[72:75], v[152:155], v[148:151], v[72:75]
    v_add_f32 v245, v245, v13
    v_mov_b32 v4, v240
    v_mfma_f32_16x16x32_bf16 v[76:79], v[148:151], v[156:159], v[76:79]
    v_mov_b32 v5, v241
    s_waitcnt vmcnt(8) lgkmcnt(6)
    v_mfma_f32_16x16x32_bf16 v[16:19], v[80:83], v[192:195], v[16:19]
    ds_read_b128 v[120:123], v1 offset:35840
    v_mfma_f32_16x16x32_bf16 v[44:47], v[80:83], v[196:199], v[44:47]
    ds_read_b128 v[124:127], v1 offset:36864
    v_mov_b32 v8, v242
    v_mfma_f32_16x16x32_bf16 v[20:23], v[84:87], v[192:195], v[20:23]
    ds_read_b128 v[128:131], v1 offset:37888
    v_mov_b32 v9, v243
    v_mfma_f32_16x16x32_bf16 v[48:51], v[84:87], v[196:199], v[48:51]
    ds_read_b128 v[132:135], v1 offset:38912
    v_mov_b32 v12, v244
    v_mfma_f32_16x16x32_bf16 v[24:27], v[88:91], v[192:195], v[24:27]
    ds_read_b128 v[136:139], v1 offset:39936
    v_mov_b32 v13, v245
    v_mfma_f32_16x16x32_bf16 v[52:55], v[88:91], v[196:199], v[52:55]
    ds_read_b128 v[140:143], v1 offset:40960
    v_permlane16_swap_b32 v240, v4
    v_mfma_f32_16x16x32_bf16 v[28:31], v[92:95], v[192:195], v[28:31]
    ds_read_b128 v[144:147], v1 offset:41984
    v_permlane16_swap_b32 v241, v5
    v_mfma_f32_16x16x32_bf16 v[56:59], v[92:95], v[196:199], v[56:59]
    ds_read_b128 v[148:151], v248 offset:3072
    s_waitcnt lgkmcnt(8)
    v_mfma_f32_16x16x32_bf16 v[32:35], v[192:195], v[96:99], v[32:35]
    ds_read_b128 v[152:155], v249 offset:21504
    v_permlane16_swap_b32 v242, v8
    v_mfma_f32_16x16x32_bf16 v[60:63], v[196:199], v[96:99], v[60:63]
    ds_read_b128 v[156:159], v251 offset:21504
    v_permlane16_swap_b32 v243, v9
    v_mfma_f32_16x16x32_bf16 v[36:39], v[192:195], v[100:103], v[36:39]
    buffer_load_dwordx4 v[184:187], v1, s[4:7], s40 offen offset:1024 sc1
    v_mfma_f32_16x16x32_bf16 v[64:67], v[196:199], v[100:103], v[64:67]
    buffer_load_dwordx4 v[188:191], v253, s[4:7], s40 offen offset:1024 sc1
    v_mfma_f32_16x16x32_bf16 v[40:43], v[104:107], v[192:195], v[40:43]
    v_permlane16_swap_b32 v244, v12
    v_mfma_f32_16x16x32_bf16 v[68:71], v[104:107], v[196:199], v[68:71]
    v_permlane16_swap_b32 v245, v13
    v_mfma_f32_16x16x32_bf16 v[72:75], v[112:115], v[108:111], v[72:75]
    v_add_f32 v240, v240, v4
    v_add_f32 v241, v241, v5
    v_mfma_f32_16x16x32_bf16 v[76:79], v[108:111], v[116:119], v[76:79]
    v_add_f32 v242, v242, v8
    s_waitcnt vmcnt(8) lgkmcnt(6)
    s_barrier
    v_mfma_f32_16x16x32_bf16 v[16:19], v[120:123], v[200:203], v[16:19]
    ds_read_b128 v[80:83], v1 offset:43008
    v_mfma_f32_16x16x32_bf16 v[44:47], v[120:123], v[204:207], v[44:47]
    ds_read_b128 v[84:87], v1 offset:44032
    v_add_f32 v243, v243, v9
    v_mfma_f32_16x16x32_bf16 v[20:23], v[124:127], v[200:203], v[20:23]
    ds_read_b128 v[88:91], v1 offset:45056
    v_add_f32 v244, v244, v12
    v_mfma_f32_16x16x32_bf16 v[48:51], v[124:127], v[204:207], v[48:51]
    ds_read_b128 v[92:95], v1 offset:46080
    v_add_f32 v245, v245, v13
    v_mfma_f32_16x16x32_bf16 v[24:27], v[128:131], v[200:203], v[24:27]
    ds_read_b128 v[96:99], v1 offset:47104
    v_mul_f32 v240, 0x3ae38e39, v240
    v_mfma_f32_16x16x32_bf16 v[52:55], v[128:131], v[204:207], v[52:55]
    ds_read_b128 v[100:103], v1 offset:48128
    v_mul_f32 v241, 0x3ae38e39, v241
    v_mfma_f32_16x16x32_bf16 v[28:31], v[132:135], v[200:203], v[28:31]
    ds_read_b128 v[104:107], v1 offset:49152
    v_mul_f32 v242, 0x3ae38e39, v242
    v_mfma_f32_16x16x32_bf16 v[56:59], v[132:135], v[204:207], v[56:59]
    ds_read_b128 v[108:111], v248 offset:4096
    s_waitcnt lgkmcnt(8)
    v_mfma_f32_16x16x32_bf16 v[32:35], v[200:203], v[136:139], v[32:35]
    ds_read_b128 v[112:115], v249 offset:28672
    v_mul_f32 v243, 0x3ae38e39, v243
    v_mfma_f32_16x16x32_bf16 v[60:63], v[204:207], v[136:139], v[60:63]
    ds_read_b128 v[116:119], v251 offset:28672
    v_mul_f32 v244, 0x3ae38e39, v244
    v_mfma_f32_16x16x32_bf16 v[36:39], v[200:203], v[140:143], v[36:39]
    buffer_load_dwordx4 v[192:195], v1, s[4:7], s40 offen offset:2048 sc1
    v_mfma_f32_16x16x32_bf16 v[64:67], v[204:207], v[140:143], v[64:67]
    buffer_load_dwordx4 v[196:199], v253, s[4:7], s40 offen offset:2048 sc1
    v_mfma_f32_16x16x32_bf16 v[40:43], v[144:147], v[200:203], v[40:43]
    v_mul_f32 v245, 0x3ae38e39, v245
    v_mfma_f32_16x16x32_bf16 v[68:71], v[144:147], v[204:207], v[68:71]
    v_fma_f32 v241, -v240, v240, v241
    v_mfma_f32_16x16x32_bf16 v[72:75], v[152:155], v[148:151], v[72:75]
    v_fma_f32 v243, -v242, v242, v243
    v_fma_f32 v245, -v244, v244, v245
    v_mfma_f32_16x16x32_bf16 v[76:79], v[148:151], v[156:159], v[76:79]
    v_max_f32 v241, 0, v241
    s_waitcnt vmcnt(8) lgkmcnt(6)
    v_mfma_f32_16x16x32_bf16 v[16:19], v[80:83], v[160:163], v[16:19]
    ds_read_b128 v[120:123], v1 offset:50176
    v_mfma_f32_16x16x32_bf16 v[44:47], v[80:83], v[164:167], v[44:47]
    ds_read_b128 v[124:127], v1 offset:51200
    v_max_f32 v243, 0, v243
    v_mfma_f32_16x16x32_bf16 v[20:23], v[84:87], v[160:163], v[20:23]
    ds_read_b128 v[128:131], v1 offset:52224
    v_max_f32 v245, 0, v245
    v_mfma_f32_16x16x32_bf16 v[48:51], v[84:87], v[164:167], v[48:51]
    ds_read_b128 v[132:135], v1 offset:53248
    v_add_f32 v241, 0x3727c5ac, v241
    v_mfma_f32_16x16x32_bf16 v[24:27], v[88:91], v[160:163], v[24:27]
    ds_read_b128 v[136:139], v1 offset:54272
    v_add_f32 v243, 0x3727c5ac, v243
    v_mfma_f32_16x16x32_bf16 v[52:55], v[88:91], v[164:167], v[52:55]
    ds_read_b128 v[140:143], v1 offset:55296
    v_add_f32 v245, 0x3727c5ac, v245
    v_mfma_f32_16x16x32_bf16 v[28:31], v[92:95], v[160:163], v[28:31]
    ds_read_b128 v[144:147], v1 offset:56320
    v_rsq_f32 v241, v241
    v_mfma_f32_16x16x32_bf16 v[56:59], v[92:95], v[164:167], v[56:59]
    ds_read_b128 v[148:151], v248 offset:5120
    s_waitcnt lgkmcnt(8)
    v_mfma_f32_16x16x32_bf16 v[32:35], v[160:163], v[96:99], v[32:35]
    ds_read_b128 v[152:155], v249 offset:35840
    v_rsq_f32 v243, v243
    v_mfma_f32_16x16x32_bf16 v[60:63], v[164:167], v[96:99], v[60:63]
    ds_read_b128 v[156:159], v251 offset:35840
    v_rsq_f32 v245, v245
    v_mfma_f32_16x16x32_bf16 v[36:39], v[160:163], v[100:103], v[36:39]
    buffer_load_dwordx4 v[200:203], v1, s[4:7], s40 offen offset:3072 sc1
    v_mfma_f32_16x16x32_bf16 v[64:67], v[164:167], v[100:103], v[64:67]
    buffer_load_dwordx4 v[204:207], v253, s[4:7], s40 offen offset:3072 sc1
    v_mfma_f32_16x16x32_bf16 v[40:43], v[104:107], v[160:163], v[40:43]
    s_nop 0
    v_mfma_f32_16x16x32_bf16 v[68:71], v[104:107], v[164:167], v[68:71]
    v_lshlrev_b32 v255, 4, v3
    v_mfma_f32_16x16x32_bf16 v[72:75], v[112:115], v[108:111], v[72:75]
    v_add_u32 v236, 161792, v255
    s_lshl_b32 s36, s33, 6
    v_mfma_f32_16x16x32_bf16 v[76:79], v[108:111], v[116:119], v[76:79]
    v_add_u32 v237, s36, v236
    s_waitcnt vmcnt(8) lgkmcnt(6)
    v_mfma_f32_16x16x32_bf16 v[16:19], v[120:123], v[168:171], v[16:19]
    ds_read_b128 v[80:83], v1 offset:57344
    v_mfma_f32_16x16x32_bf16 v[44:47], v[120:123], v[172:175], v[44:47]
    ds_read_b128 v[84:87], v1 offset:58368
    v_lshlrev_b32 v254, 2, v2
    v_mfma_f32_16x16x32_bf16 v[20:23], v[124:127], v[168:171], v[20:23]
    ds_read_b128 v[88:91], v1 offset:59392
    v_add_u32 v238, 161792, v254
    v_mfma_f32_16x16x32_bf16 v[48:51], v[124:127], v[172:175], v[48:51]
    ds_read_b128 v[92:95], v1 offset:60416
    s_lshl_b32 s37, s34, 6
    v_mfma_f32_16x16x32_bf16 v[24:27], v[128:131], v[168:171], v[24:27]
    ds_read_b128 v[96:99], v1 offset:61440
    v_add_u32 v239, s37, v238
    v_mfma_f32_16x16x32_bf16 v[52:55], v[128:131], v[172:175], v[52:55]
    ds_read_b128 v[100:103], v1 offset:62464
    s_mul_i32 s36, s20, 3072
    v_mfma_f32_16x16x32_bf16 v[28:31], v[132:135], v[168:171], v[28:31]
    ds_read_b128 v[104:107], v1 offset:63488
    s_add_u32 s36, s36, 153600
    v_mfma_f32_16x16x32_bf16 v[56:59], v[132:135], v[172:175], v[56:59]
    ds_read_b128 v[108:111], v248 offset:6144
    s_waitcnt lgkmcnt(8)
    v_mfma_f32_16x16x32_bf16 v[32:35], v[168:171], v[136:139], v[32:35]
    ds_read_b128 v[112:115], v249 offset:43008
    v_add_u32 v254, s36, v254
    v_mfma_f32_16x16x32_bf16 v[60:63], v[172:175], v[136:139], v[60:63]
    ds_read_b128 v[116:119], v251 offset:43008
    v_add_u32 v255, s36, v255
    v_mfma_f32_16x16x32_bf16 v[36:39], v[168:171], v[140:143], v[36:39]
    buffer_load_dwordx4 v[160:163], v1, s[4:7], s41 offen offset:0 sc1
    v_mfma_f32_16x16x32_bf16 v[64:67], v[172:175], v[140:143], v[64:67]
    buffer_load_dwordx4 v[164:167], v253, s[4:7], s41 offen offset:0 sc1
    v_mfma_f32_16x16x32_bf16 v[40:43], v[144:147], v[168:171], v[40:43]
    v_mfma_f32_16x16x32_bf16 v[68:71], v[144:147], v[172:175], v[68:71]
    ds_write2_b32 v254, v240, v241 offset0:0 offset1:16
    v_mfma_f32_16x16x32_bf16 v[72:75], v[152:155], v[148:151], v[72:75]
    ds_write2_b32 v254, v242, v243 offset0:32 offset1:48
    v_mfma_f32_16x16x32_bf16 v[76:79], v[148:151], v[156:159], v[76:79]
    ds_write2_b32 v254, v244, v245 offset0:64 offset1:80
    s_waitcnt vmcnt(8) lgkmcnt(9)
    s_barrier
    v_mfma_f32_16x16x32_bf16 v[16:19], v[80:83], v[176:179], v[16:19]
    ds_read_b128 v[120:123], v247 offset:0
    v_mfma_f32_16x16x32_bf16 v[44:47], v[80:83], v[180:183], v[44:47]
    ds_read_b128 v[124:127], v247 offset:1024
    v_mfma_f32_16x16x32_bf16 v[20:23], v[84:87], v[176:179], v[20:23]
    ds_read_b128 v[128:131], v247 offset:2048
    v_mfma_f32_16x16x32_bf16 v[48:51], v[84:87], v[180:183], v[48:51]
    ds_read_b128 v[132:135], v247 offset:3072
    v_mfma_f32_16x16x32_bf16 v[24:27], v[88:91], v[176:179], v[24:27]
    ds_read_b128 v[136:139], v247 offset:4096
    v_mfma_f32_16x16x32_bf16 v[52:55], v[88:91], v[180:183], v[52:55]
    ds_read_b128 v[140:143], v247 offset:5120
    v_mfma_f32_16x16x32_bf16 v[28:31], v[92:95], v[176:179], v[28:31]
    ds_read_b128 v[144:147], v247 offset:6144
    v_mfma_f32_16x16x32_bf16 v[56:59], v[92:95], v[180:183], v[56:59]
    ds_read_b128 v[148:151], v248 offset:7168
    s_waitcnt lgkmcnt(8)
    v_mfma_f32_16x16x32_bf16 v[32:35], v[176:179], v[96:99], v[32:35]
    ds_read_b128 v[152:155], v249 offset:50176
    v_mfma_f32_16x16x32_bf16 v[60:63], v[180:183], v[96:99], v[60:63]
    ds_read_b128 v[156:159], v251 offset:50176
    v_mfma_f32_16x16x32_bf16 v[36:39], v[176:179], v[100:103], v[36:39]
    buffer_load_dwordx4 v[168:171], v1, s[4:7], s41 offen offset:1024 sc1
    ds_read_b128 v[208:211], v236 offset:0
    v_mfma_f32_16x16x32_bf16 v[64:67], v[180:183], v[100:103], v[64:67]
    buffer_load_dwordx4 v[172:175], v253, s[4:7], s41 offen offset:1024 sc1
    ds_read_b128 v[212:215], v236 offset:64
    v_mfma_f32_16x16x32_bf16 v[40:43], v[104:107], v[176:179], v[40:43]
    ds_read_b128 v[216:219], v236 offset:128
    v_mfma_f32_16x16x32_bf16 v[68:71], v[104:107], v[180:183], v[68:71]
    ds_read_b128 v[220:223], v236 offset:192
    v_mfma_f32_16x16x32_bf16 v[72:75], v[112:115], v[108:111], v[72:75]
    ds_read_b128 v[224:227], v236 offset:384
    v_mfma_f32_16x16x32_bf16 v[76:79], v[108:111], v[116:119], v[76:79]
    ds_read_b128 v[228:231], v237
    s_waitcnt vmcnt(8) lgkmcnt(12)
    v_mfma_f32_16x16x32_bf16 v[16:19], v[120:123], v[184:187], v[16:19]
    ds_read_b128 v[80:83], v247 offset:7168
    v_mfma_f32_16x16x32_bf16 v[44:47], v[120:123], v[188:191], v[44:47]
    ds_read_b128 v[84:87], v247 offset:8192
    v_mfma_f32_16x16x32_bf16 v[20:23], v[124:127], v[184:187], v[20:23]
    ds_read_b128 v[88:91], v247 offset:9216
    v_mfma_f32_16x16x32_bf16 v[48:51], v[124:127], v[188:191], v[48:51]
    ds_read_b128 v[92:95], v247 offset:10240
    v_mfma_f32_16x16x32_bf16 v[24:27], v[128:131], v[184:187], v[24:27]
    ds_read_b128 v[96:99], v247 offset:11264
    v_mfma_f32_16x16x32_bf16 v[52:55], v[128:131], v[188:191], v[52:55]
    ds_read_b128 v[100:103], v247 offset:12288
    v_mfma_f32_16x16x32_bf16 v[28:31], v[132:135], v[184:187], v[28:31]
    ds_read_b128 v[104:107], v247 offset:13312
    v_mfma_f32_16x16x32_bf16 v[56:59], v[132:135], v[188:191], v[56:59]
    ds_read_b128 v[108:111], v248 offset:8192
    s_waitcnt lgkmcnt(8)
    v_mfma_f32_16x16x32_bf16 v[32:35], v[184:187], v[136:139], v[32:35]
    ds_read_b128 v[112:115], v249 offset:57344
    v_mfma_f32_16x16x32_bf16 v[60:63], v[188:191], v[136:139], v[60:63]
    ds_read_b128 v[116:119], v251 offset:57344
    v_mfma_f32_16x16x32_bf16 v[36:39], v[184:187], v[140:143], v[36:39]
    buffer_load_dwordx4 v[176:179], v1, s[4:7], s41 offen offset:2048 sc1
    v_mfma_f32_16x16x32_bf16 v[64:67], v[188:191], v[140:143], v[64:67]
    buffer_load_dwordx4 v[180:183], v253, s[4:7], s41 offen offset:2048 sc1
    ds_read2_b32 v[232:233], v238 offset0:64 offset1:80
    v_mfma_f32_16x16x32_bf16 v[40:43], v[144:147], v[184:187], v[40:43]
    ds_read_b32 v234, v239
    v_mfma_f32_16x16x32_bf16 v[68:71], v[144:147], v[188:191], v[68:71]
    ds_read_b128 v[4:7], v255 offset:0
    v_mfma_f32_16x16x32_bf16 v[72:75], v[152:155], v[148:151], v[72:75]
    ds_read_b128 v[8:11], v255 offset:128
    v_mfma_f32_16x16x32_bf16 v[76:79], v[148:151], v[156:159], v[76:79]
    ds_read_b128 v[12:15], v255 offset:256
    s_waitcnt vmcnt(8) lgkmcnt(11)
    s_barrier
    v_mfma_f32_16x16x32_bf16 v[16:19], v[80:83], v[192:195], v[16:19]
    ds_read_b128 v[120:123], v247 offset:14336
    v_mfma_f32_16x16x32_bf16 v[44:47], v[80:83], v[196:199], v[44:47]
    ds_read_b128 v[124:127], v247 offset:15360
    v_mfma_f32_16x16x32_bf16 v[20:23], v[84:87], v[192:195], v[20:23]
    ds_read_b128 v[128:131], v247 offset:16384
    v_mfma_f32_16x16x32_bf16 v[48:51], v[84:87], v[196:199], v[48:51]
    ds_read_b128 v[132:135], v247 offset:17408
    v_mfma_f32_16x16x32_bf16 v[24:27], v[88:91], v[192:195], v[24:27]
    ds_read_b128 v[136:139], v247 offset:18432
    v_mfma_f32_16x16x32_bf16 v[52:55], v[88:91], v[196:199], v[52:55]
    ds_read_b128 v[140:143], v247 offset:19456
    v_mfma_f32_16x16x32_bf16 v[28:31], v[92:95], v[192:195], v[28:31]
    ds_read_b128 v[144:147], v247 offset:20480
    v_mfma_f32_16x16x32_bf16 v[56:59], v[92:95], v[196:199], v[56:59]
    ds_read_b128 v[148:151], v248 offset:9216
    s_waitcnt lgkmcnt(8)
    v_mfma_f32_16x16x32_bf16 v[32:35], v[192:195], v[96:99], v[32:35]
    ds_read_b128 v[152:155], v250 offset:0
    v_mfma_f32_16x16x32_bf16 v[60:63], v[196:199], v[96:99], v[60:63]
    ds_read_b128 v[156:159], v252 offset:0
    v_mfma_f32_16x16x32_bf16 v[36:39], v[192:195], v[100:103], v[36:39]
    buffer_load_dwordx4 v[184:187], v1, s[4:7], s41 offen offset:3072 sc1
    v_mfma_f32_16x16x32_bf16 v[64:67], v[196:199], v[100:103], v[64:67]
    buffer_load_dwordx4 v[188:191], v253, s[4:7], s41 offen offset:3072 sc1
    v_mfma_f32_16x16x32_bf16 v[40:43], v[104:107], v[192:195], v[40:43]
    v_mfma_f32_16x16x32_bf16 v[68:71], v[104:107], v[196:199], v[68:71]
    v_mfma_f32_16x16x32_bf16 v[72:75], v[112:115], v[108:111], v[72:75]
    v_mfma_f32_16x16x32_bf16 v[76:79], v[108:111], v[116:119], v[76:79]
    s_waitcnt vmcnt(8) lgkmcnt(6)
    v_mfma_f32_16x16x32_bf16 v[16:19], v[120:123], v[200:203], v[16:19]
    ds_read_b128 v[80:83], v247 offset:21504
    v_fma_f32 v32, -v8, v232, v32
    v_mfma_f32_16x16x32_bf16 v[44:47], v[120:123], v[204:207], v[44:47]
    ds_read_b128 v[84:87], v247 offset:22528
    v_fma_f32 v60, -v12, v232, v60
    v_mfma_f32_16x16x32_bf16 v[20:23], v[124:127], v[200:203], v[20:23]
    ds_read_b128 v[88:91], v247 offset:23552
    v_fma_f32 v36, -v8, v233, v36
    v_mfma_f32_16x16x32_bf16 v[48:51], v[124:127], v[204:207], v[48:51]
    ds_read_b128 v[92:95], v247 offset:24576
    v_fma_f32 v64, -v12, v233, v64
    v_mfma_f32_16x16x32_bf16 v[24:27], v[128:131], v[200:203], v[24:27]
    ds_read_b128 v[96:99], v247 offset:25600
    v_fma_f32 v40, -v242, v224, v40
    v_mfma_f32_16x16x32_bf16 v[52:55], v[128:131], v[204:207], v[52:55]
    ds_read_b128 v[100:103], v247 offset:26624
    v_fma_f32 v68, -v244, v224, v68
    v_mfma_f32_16x16x32_bf16 v[28:31], v[132:135], v[200:203], v[28:31]
    ds_read_b128 v[104:107], v247 offset:27648
    v_fma_f32 v72, -v240, v228, v72
    v_mfma_f32_16x16x32_bf16 v[56:59], v[132:135], v[204:207], v[56:59]
    ds_read_b128 v[108:111], v248 offset:10240
    s_waitcnt lgkmcnt(8)
    v_fma_f32 v76, -v4, v234, v76
    v_mfma_f32_16x16x32_bf16 v[32:35], v[200:203], v[136:139], v[32:35]
    ds_read_b128 v[112:115], v250 offset:7168
    v_fma_f32 v16, -v242, v208, v16
    v_mfma_f32_16x16x32_bf16 v[60:63], v[204:207], v[136:139], v[60:63]
    ds_read_b128 v[116:119], v252 offset:7168
    v_fma_f32 v44, -v244, v208, v44
    v_mfma_f32_16x16x32_bf16 v[36:39], v[200:203], v[140:143], v[36:39]
    buffer_load_dwordx4 v[192:195], v1, s[4:7], s42 offen offset:0 sc1
    v_fma_f32 v20, -v242, v212, v20
    v_mfma_f32_16x16x32_bf16 v[64:67], v[204:207], v[140:143], v[64:67]
    buffer_load_dwordx4 v[196:199], v253, s[4:7], s42 offen offset:0 sc1
    v_fma_f32 v48, -v244, v212, v48
    v_mfma_f32_16x16x32_bf16 v[40:43], v[144:147], v[200:203], v[40:43]
    v_fma_f32 v24, -v242, v216, v24
    v_mfma_f32_16x16x32_bf16 v[68:71], v[144:147], v[204:207], v[68:71]
    v_fma_f32 v52, -v244, v216, v52
    v_mfma_f32_16x16x32_bf16 v[72:75], v[152:155], v[148:151], v[72:75]
    v_fma_f32 v28, -v242, v220, v28
    v_mfma_f32_16x16x32_bf16 v[76:79], v[148:151], v[156:159], v[76:79]
    v_fma_f32 v56, -v244, v220, v56
    s_waitcnt vmcnt(8) lgkmcnt(6)
    s_barrier
    v_mfma_f32_16x16x32_bf16 v[16:19], v[80:83], v[160:163], v[16:19]
    ds_read_b128 v[120:123], v247 offset:28672
    v_fma_f32 v33, -v9, v232, v33
    v_mfma_f32_16x16x32_bf16 v[44:47], v[80:83], v[164:167], v[44:47]
    ds_read_b128 v[124:127], v247 offset:29696
    v_fma_f32 v61, -v13, v232, v61
    v_mfma_f32_16x16x32_bf16 v[20:23], v[84:87], v[160:163], v[20:23]
    ds_read_b128 v[128:131], v247 offset:30720
    v_fma_f32 v37, -v9, v233, v37
    v_mfma_f32_16x16x32_bf16 v[48:51], v[84:87], v[164:167], v[48:51]
    ds_read_b128 v[132:135], v247 offset:31744
    v_fma_f32 v65, -v13, v233, v65
    v_mfma_f32_16x16x32_bf16 v[24:27], v[88:91], v[160:163], v[24:27]
    ds_read_b128 v[136:139], v247 offset:32768
    v_fma_f32 v41, -v242, v225, v41
    v_mfma_f32_16x16x32_bf16 v[52:55], v[88:91], v[164:167], v[52:55]
    ds_read_b128 v[140:143], v247 offset:33792
    v_fma_f32 v69, -v244, v225, v69
    v_mfma_f32_16x16x32_bf16 v[28:31], v[92:95], v[160:163], v[28:31]
    ds_read_b128 v[144:147], v247 offset:34816
    v_fma_f32 v73, -v240, v229, v73
    v_mfma_f32_16x16x32_bf16 v[56:59], v[92:95], v[164:167], v[56:59]
    ds_read_b128 v[148:151], v248 offset:11264
    s_waitcnt lgkmcnt(8)
    v_fma_f32 v77, -v5, v234, v77
    v_mfma_f32_16x16x32_bf16 v[32:35], v[160:163], v[96:99], v[32:35]
    ds_read_b128 v[152:155], v250 offset:14336
    v_fma_f32 v17, -v242, v209, v17
    v_mfma_f32_16x16x32_bf16 v[60:63], v[164:167], v[96:99], v[60:63]
    ds_read_b128 v[156:159], v252 offset:14336
    v_fma_f32 v45, -v244, v209, v45
    v_mfma_f32_16x16x32_bf16 v[36:39], v[160:163], v[100:103], v[36:39]
    buffer_load_dwordx4 v[200:203], v1, s[4:7], s42 offen offset:1024 sc1
    v_fma_f32 v21, -v242, v213, v21
    v_mfma_f32_16x16x32_bf16 v[64:67], v[164:167], v[100:103], v[64:67]
    buffer_load_dwordx4 v[204:207], v253, s[4:7], s42 offen offset:1024 sc1
    v_fma_f32 v49, -v244, v213, v49
    v_mfma_f32_16x16x32_bf16 v[40:43], v[104:107], v[160:163], v[40:43]
    v_fma_f32 v25, -v242, v217, v25
    v_mfma_f32_16x16x32_bf16 v[68:71], v[104:107], v[164:167], v[68:71]
    v_fma_f32 v53, -v244, v217, v53
    v_mfma_f32_16x16x32_bf16 v[72:75], v[112:115], v[108:111], v[72:75]
    v_fma_f32 v29, -v242, v221, v29
    v_mfma_f32_16x16x32_bf16 v[76:79], v[108:111], v[116:119], v[76:79]
    v_fma_f32 v57, -v244, v221, v57
    s_waitcnt vmcnt(8) lgkmcnt(6)
    v_mfma_f32_16x16x32_bf16 v[16:19], v[120:123], v[168:171], v[16:19]
    ds_read_b128 v[80:83], v247 offset:35840
    v_fma_f32 v34, -v10, v232, v34
    v_mfma_f32_16x16x32_bf16 v[44:47], v[120:123], v[172:175], v[44:47]
    ds_read_b128 v[84:87], v247 offset:36864
    v_fma_f32 v62, -v14, v232, v62
    v_mfma_f32_16x16x32_bf16 v[20:23], v[124:127], v[168:171], v[20:23]
    ds_read_b128 v[88:91], v247 offset:37888
    v_fma_f32 v38, -v10, v233, v38
    v_mfma_f32_16x16x32_bf16 v[48:51], v[124:127], v[172:175], v[48:51]
    ds_read_b128 v[92:95], v247 offset:38912
    v_fma_f32 v66, -v14, v233, v66
    v_mfma_f32_16x16x32_bf16 v[24:27], v[128:131], v[168:171], v[24:27]
    ds_read_b128 v[96:99], v247 offset:39936
    v_fma_f32 v42, -v242, v226, v42
    v_mfma_f32_16x16x32_bf16 v[52:55], v[128:131], v[172:175], v[52:55]
    ds_read_b128 v[100:103], v247 offset:40960
    v_fma_f32 v70, -v244, v226, v70
    v_mfma_f32_16x16x32_bf16 v[28:31], v[132:135], v[168:171], v[28:31]
    ds_read_b128 v[104:107], v247 offset:41984
    v_fma_f32 v74, -v240, v230, v74
    v_mfma_f32_16x16x32_bf16 v[56:59], v[132:135], v[172:175], v[56:59]
    ds_read_b128 v[108:111], v248 offset:12288
    s_waitcnt lgkmcnt(8)
    v_fma_f32 v78, -v6, v234, v78
    v_mfma_f32_16x16x32_bf16 v[32:35], v[168:171], v[136:139], v[32:35]
    ds_read_b128 v[112:115], v250 offset:21504
    v_fma_f32 v18, -v242, v210, v18
    v_mfma_f32_16x16x32_bf16 v[60:63], v[172:175], v[136:139], v[60:63]
    ds_read_b128 v[116:119], v252 offset:21504
    v_fma_f32 v46, -v244, v210, v46
    v_mfma_f32_16x16x32_bf16 v[36:39], v[168:171], v[140:143], v[36:39]
    v_fma_f32 v22, -v242, v214, v22
    v_mfma_f32_16x16x32_bf16 v[64:67], v[172:175], v[140:143], v[64:67]
    v_fma_f32 v50, -v244, v214, v50
    v_mfma_f32_16x16x32_bf16 v[40:43], v[144:147], v[168:171], v[40:43]
    v_fma_f32 v26, -v242, v218, v26
    v_mfma_f32_16x16x32_bf16 v[68:71], v[144:147], v[172:175], v[68:71]
    v_fma_f32 v54, -v244, v218, v54
    v_mfma_f32_16x16x32_bf16 v[72:75], v[152:155], v[148:151], v[72:75]
    v_fma_f32 v30, -v242, v222, v30
    v_mfma_f32_16x16x32_bf16 v[76:79], v[148:151], v[156:159], v[76:79]
    v_fma_f32 v58, -v244, v222, v58
    s_waitcnt vmcnt(6) lgkmcnt(6)
    v_mfma_f32_16x16x32_bf16 v[16:19], v[80:83], v[176:179], v[16:19]
    ds_read_b128 v[120:123], v247 offset:43008
    v_fma_f32 v35, -v11, v232, v35
    v_mfma_f32_16x16x32_bf16 v[44:47], v[80:83], v[180:183], v[44:47]
    ds_read_b128 v[124:127], v247 offset:44032
    v_fma_f32 v63, -v15, v232, v63
    v_mfma_f32_16x16x32_bf16 v[20:23], v[84:87], v[176:179], v[20:23]
    ds_read_b128 v[128:131], v247 offset:45056
    v_fma_f32 v39, -v11, v233, v39
    v_mfma_f32_16x16x32_bf16 v[48:51], v[84:87], v[180:183], v[48:51]
    ds_read_b128 v[132:135], v247 offset:46080
    v_fma_f32 v67, -v15, v233, v67
    v_mfma_f32_16x16x32_bf16 v[24:27], v[88:91], v[176:179], v[24:27]
    ds_read_b128 v[136:139], v247 offset:47104
    v_fma_f32 v43, -v242, v227, v43
    v_mfma_f32_16x16x32_bf16 v[52:55], v[88:91], v[180:183], v[52:55]
    ds_read_b128 v[140:143], v247 offset:48128
    v_fma_f32 v71, -v244, v227, v71
    v_mfma_f32_16x16x32_bf16 v[28:31], v[92:95], v[176:179], v[28:31]
    ds_read_b128 v[144:147], v247 offset:49152
    v_fma_f32 v75, -v240, v231, v75
    v_mfma_f32_16x16x32_bf16 v[56:59], v[92:95], v[180:183], v[56:59]
    ds_read_b128 v[148:151], v248 offset:13312
    s_waitcnt lgkmcnt(8)
    v_fma_f32 v79, -v7, v234, v79
    v_mfma_f32_16x16x32_bf16 v[32:35], v[176:179], v[96:99], v[32:35]
    ds_read_b128 v[152:155], v250 offset:28672
    v_fma_f32 v19, -v242, v211, v19
    v_mfma_f32_16x16x32_bf16 v[60:63], v[180:183], v[96:99], v[60:63]
    ds_read_b128 v[156:159], v252 offset:28672
    v_fma_f32 v47, -v244, v211, v47
    v_mfma_f32_16x16x32_bf16 v[36:39], v[176:179], v[100:103], v[36:39]
    v_fma_f32 v23, -v242, v215, v23
    v_mfma_f32_16x16x32_bf16 v[64:67], v[180:183], v[100:103], v[64:67]
    v_fma_f32 v51, -v244, v215, v51
    v_mfma_f32_16x16x32_bf16 v[40:43], v[104:107], v[176:179], v[40:43]
    v_fma_f32 v27, -v242, v219, v27
    v_mfma_f32_16x16x32_bf16 v[68:71], v[104:107], v[180:183], v[68:71]
    v_fma_f32 v55, -v244, v219, v55
    v_mfma_f32_16x16x32_bf16 v[72:75], v[112:115], v[108:111], v[72:75]
    v_fma_f32 v31, -v242, v223, v31
    v_mfma_f32_16x16x32_bf16 v[76:79], v[108:111], v[116:119], v[76:79]
    v_fma_f32 v59, -v244, v223, v59
    s_waitcnt vmcnt(4) lgkmcnt(6)
    s_barrier
    v_mfma_f32_16x16x32_bf16 v[16:19], v[120:123], v[184:187], v[16:19]
    ds_read_b128 v[80:83], v247 offset:50176
    v_mfma_f32_16x16x32_bf16 v[44:47], v[120:123], v[188:191], v[44:47]
    ds_read_b128 v[84:87], v247 offset:51200
    v_and_b32 v4, 1, v2
    v_mfma_f32_16x16x32_bf16 v[20:23], v[124:127], v[184:187], v[20:23]
    ds_read_b128 v[88:91], v247 offset:52224
    v_lshl_add_u32 v5, v3, 2, v4
    v_mfma_f32_16x16x32_bf16 v[48:51], v[124:127], v[188:191], v[48:51]
    ds_read_b128 v[92:95], v247 offset:53248
    v_add_u32 v6, 2, v5
    v_mfma_f32_16x16x32_bf16 v[24:27], v[128:131], v[184:187], v[24:27]
    ds_read_b128 v[96:99], v247 offset:54272
    v_cmp_eq_u32 s[40:41], 1, v4
    v_mfma_f32_16x16x32_bf16 v[52:55], v[128:131], v[188:191], v[52:55]
    ds_read_b128 v[100:103], v247 offset:55296
    v_cmp_le_u32 s[42:43], v5, v2
    v_mfma_f32_16x16x32_bf16 v[28:31], v[132:135], v[184:187], v[28:31]
    ds_read_b128 v[104:107], v247 offset:56320
    v_cmp_le_u32 s[44:45], v6, v2
    v_mfma_f32_16x16x32_bf16 v[56:59], v[132:135], v[188:191], v[56:59]
    ds_read_b128 v[108:111], v248 offset:14336
    s_waitcnt lgkmcnt(8)
    v_mfma_f32_16x16x32_bf16 v[32:35], v[184:187], v[136:139], v[32:35]
    ds_read_b128 v[112:115], v250 offset:35840
    v_mov_b32 v4, 0x0c0c0100
    v_mfma_f32_16x16x32_bf16 v[60:63], v[188:191], v[136:139], v[60:63]
    ds_read_b128 v[116:119], v252 offset:35840
    v_mov_b32 v5, 0x01000c0c
    v_mfma_f32_16x16x32_bf16 v[36:39], v[184:187], v[140:143], v[36:39]
    v_mov_b32 v6, 0x0c0c0302
    v_mov_b32 v7, 0x03020c0c
    v_mfma_f32_16x16x32_bf16 v[64:67], v[188:191], v[140:143], v[64:67]
    v_mov_b32 v8, 0x0c0c0c0c
    v_cndmask_b32 v4, v4, v5, s[40:41]
    v_mfma_f32_16x16x32_bf16 v[40:43], v[144:147], v[184:187], v[40:43]
    v_cndmask_b32 v6, v6, v7, s[40:41]
    v_cndmask_b32 v12, v4, v8, s[42:43]
    v_mfma_f32_16x16x32_bf16 v[68:71], v[144:147], v[188:191], v[68:71]
    v_cndmask_b32 v13, v6, v8, s[44:45]
    v_cndmask_b32 v14, v8, v4, s[42:43]
    v_mfma_f32_16x16x32_bf16 v[72:75], v[152:155], v[148:151], v[72:75]
    v_cndmask_b32 v15, v8, v6, s[44:45]
    s_cmp_eq_u32 s31, 0
    v_mfma_f32_16x16x32_bf16 v[76:79], v[148:151], v[156:159], v[76:79]
    s_cselect_b64 s[48:49], s[42:43], -1
    s_cselect_b64 s[38:39], s[44:45], -1
    s_waitcnt vmcnt(2) lgkmcnt(6)
    v_mfma_f32_16x16x32_bf16 v[16:19], v[80:83], v[192:195], v[16:19]
    ds_read_b128 v[120:123], v247 offset:57344
    v_mfma_f32_16x16x32_bf16 v[44:47], v[80:83], v[196:199], v[44:47]
    ds_read_b128 v[124:127], v247 offset:58368
    s_mul_i32 s36, s20, 3072
    v_mfma_f32_16x16x32_bf16 v[20:23], v[84:87], v[192:195], v[20:23]
    ds_read_b128 v[128:131], v247 offset:59392
    s_add_u32 s36, s36, 149504
    v_mfma_f32_16x16x32_bf16 v[48:51], v[84:87], v[196:199], v[48:51]
    ds_read_b128 v[132:135], v247 offset:60416
    v_add_u32 v9, s36, v0
    v_mfma_f32_16x16x32_bf16 v[24:27], v[88:91], v[192:195], v[24:27]
    ds_read_b128 v[136:139], v247 offset:61440
    s_lshl_b32 s37, s20, 9
    v_mfma_f32_16x16x32_bf16 v[52:55], v[88:91], v[196:199], v[52:55]
    ds_read_b128 v[140:143], v247 offset:62464
    s_add_u32 s37, s37, 149504
    v_mfma_f32_16x16x32_bf16 v[28:31], v[92:95], v[192:195], v[28:31]
    ds_read_b128 v[144:147], v247 offset:63488
    v_add_u32 v10, s37, v0
    v_mfma_f32_16x16x32_bf16 v[56:59], v[92:95], v[196:199], v[56:59]
    ds_read_b128 v[148:151], v248 offset:15360
    s_waitcnt lgkmcnt(8)
    v_mfma_f32_16x16x32_bf16 v[32:35], v[192:195], v[96:99], v[32:35]
    ds_read_b128 v[152:155], v250 offset:43008
    v_lshlrev_b32 v4, 2, v3
    v_mfma_f32_16x16x32_bf16 v[60:63], v[196:199], v[96:99], v[60:63]
    ds_read_b128 v[156:159], v252 offset:43008
    v_sub_u32 v4, v2, v4
    v_mfma_f32_16x16x32_bf16 v[36:39], v[192:195], v[100:103], v[36:39]
    v_lshlrev_b32 v5, 4, v4
    v_lshrrev_b32 v4, 1, v4
    v_mfma_f32_16x16x32_bf16 v[64:67], v[196:199], v[100:103], v[64:67]
    v_mov_b32 v6, 0x3f80
    v_lshlrev_b32 v5, v5, v6
    v_mfma_f32_16x16x32_bf16 v[40:43], v[104:107], v[192:195], v[40:43]
    v_cmp_eq_u32 vcc, 0, v4
    v_cmp_eq_u32 s[46:47], 1, v4
    v_mfma_f32_16x16x32_bf16 v[68:71], v[104:107], v[196:199], v[68:71]
    ds_read_b128 v[208:211], v255 offset:64
    s_lshl_b32 s36, s24, 10
    v_add_u32 v4, s36, v1
    v_mfma_f32_16x16x32_bf16 v[72:75], v[112:115], v[108:111], v[72:75]
    ds_read_b128 v[212:215], v255 offset:192
    v_cndmask_b32 v234, 0, v5, vcc
    v_cndmask_b32 v235, 0, v5, s[46:47]
    v_mfma_f32_16x16x32_bf16 v[76:79], v[108:111], v[116:119], v[76:79]
    ds_read_b128 v[216:219], v255 offset:320
    v_add_u32 v5, 18432, v4
    s_lshl_b32 s36, s24, 7
    s_waitcnt vmcnt(0) lgkmcnt(9)
    v_mfma_f32_16x16x32_bf16 v[16:19], v[120:123], v[200:203], v[16:19]
    ds_read_b128 v[80:83], v248 offset:16384
    v_mfma_f32_16x16x32_bf16 v[44:47], v[120:123], v[204:207], v[44:47]
    ds_read_b128 v[84:87], v250 offset:50176
    s_add_u32 s36, s36, 16384
    v_mfma_f32_16x16x32_bf16 v[20:23], v[124:127], v[200:203], v[20:23]
    ds_read_b128 v[88:91], v252 offset:50176
    v_cmp_eq_u32 vcc, 2, v3
    v_mfma_f32_16x16x32_bf16 v[48:51], v[124:127], v[204:207], v[48:51]
    ds_read_b128 v[92:95], v248 offset:17408
    v_lshl_add_u32 v6, v2, 3, s36
    v_mfma_f32_16x16x32_bf16 v[24:27], v[128:131], v[200:203], v[24:27]
    ds_read_b128 v[96:99], v250 offset:57344
    v_bfrev_b32 v7, 1
    v_mfma_f32_16x16x32_bf16 v[52:55], v[128:131], v[204:207], v[52:55]
    ds_read_b128 v[100:103], v252 offset:57344
    v_cndmask_b32 v6, v7, v6, vcc
    v_mfma_f32_16x16x32_bf16 v[28:31], v[132:135], v[200:203], v[28:31]
    v_add_u32 v7, 18432, v6
    v_mov_b32 v106, 0
    v_mfma_f32_16x16x32_bf16 v[56:59], v[132:135], v[204:207], v[56:59]
    s_waitcnt lgkmcnt(6)
    v_mov_b32 v107, 0
    v_mfma_f32_16x16x32_bf16 v[32:35], v[200:203], v[136:139], v[32:35]
    v_mov_b32 v8, 0xf149f2ca
    v_mov_b32 v108, 0
    v_mfma_f32_16x16x32_bf16 v[60:63], v[204:207], v[136:139], v[60:63]
    s_mov_b32 s33, 0x3eae1a93
    v_mov_b32 v109, 0
    v_mfma_f32_16x16x32_bf16 v[36:39], v[200:203], v[140:143], v[36:39]
    v_mov_b32 v236, 0x3f803f80
    v_mov_b32 v237, 0x3f803f80
    v_mfma_f32_16x16x32_bf16 v[64:67], v[204:207], v[140:143], v[64:67]
    v_mov_b32 v238, 0x3f803f80
    v_mov_b32 v239, 0x3f803f80
    v_mfma_f32_16x16x32_bf16 v[40:43], v[144:147], v[200:203], v[40:43]
    v_mov_b32 v114, 0
    v_mfma_f32_16x16x32_bf16 v[68:71], v[144:147], v[204:207], v[68:71]
    v_mov_b32 v115, 0
    v_mfma_f32_16x16x32_bf16 v[72:75], v[152:155], v[148:151], v[72:75]
    v_mov_b32 v116, 0
    v_mfma_f32_16x16x32_bf16 v[76:79], v[148:151], v[156:159], v[76:79]
    v_mov_b32 v117, 0
    s_waitcnt lgkmcnt(0)
    v_mfma_f32_16x16x32_bf16 v[72:75], v[84:87], v[80:83], v[72:75]
    v_mfma_f32_16x16x32_bf16 v[76:79], v[80:83], v[88:91], v[76:79]
    v_mfma_f32_16x16x32_bf16 v[72:75], v[96:99], v[92:95], v[72:75]
    v_mfma_f32_16x16x32_bf16 v[76:79], v[92:95], v[100:103], v[76:79]
    v_pk_mul_f32 v[52:53], v[52:53], v[244:245] op_sel:[0,1] op_sel_hi:[1,1]
    v_pk_mul_f32 v[54:55], v[54:55], v[244:245] op_sel:[0,1] op_sel_hi:[1,1]
    v_pk_mul_f32 v[56:57], v[56:57], v[244:245] op_sel:[0,1] op_sel_hi:[1,1]
    v_pk_mul_f32 v[58:59], v[58:59], v[244:245] op_sel:[0,1] op_sel_hi:[1,1]
    v_pk_mul_f32 v[60:61], v[60:61], v[216:217]
    v_pk_mul_f32 v[62:63], v[62:63], v[218:219]
    v_pk_mul_f32 v[64:65], v[64:65], v[216:217]
    v_pk_mul_f32 v[66:67], v[66:67], v[218:219]
    v_pk_mul_f32 v[68:69], v[68:69], v[244:245] op_sel:[0,1] op_sel_hi:[1,1]
    v_pk_mul_f32 v[70:71], v[70:71], v[244:245] op_sel:[0,1] op_sel_hi:[1,1]
    v_pk_mul_f32 v[72:73], v[72:73], v[240:241] op_sel:[0,1] op_sel_hi:[1,1]
    v_pk_mul_f32 v[74:75], v[74:75], v[240:241] op_sel:[0,1] op_sel_hi:[1,1]
    v_pk_mul_f32 v[76:77], v[76:77], v[208:209]
    v_pk_mul_f32 v[78:79], v[78:79], v[210:211]
    v_cvt_pk_bf16_f32 v172, v52, v53
    v_cvt_pk_bf16_f32 v173, v54, v55
    v_cvt_pk_bf16_f32 v176, v56, v57
    v_cvt_pk_bf16_f32 v177, v58, v59
    v_cvt_pk_bf16_f32 v182, v60, v61
    v_cvt_pk_bf16_f32 v183, v62, v63
    v_cvt_pk_bf16_f32 v188, v64, v65
    v_cvt_pk_bf16_f32 v189, v66, v67
    v_cvt_pk_bf16_f32 v174, v68, v69
    v_cvt_pk_bf16_f32 v175, v70, v71
    v_cvt_pk_bf16_f32 v220, v72, v73
    v_cvt_pk_bf16_f32 v221, v74, v75
    v_cvt_pk_bf16_f32 v222, v76, v77
    v_cvt_pk_bf16_f32 v223, v78, v79
    s_cmp_eq_u32 s20, 3
    s_cbranch_scc1 L_a_nw
    ds_write2st64_b64 v9, v[172:173], v[174:175] offset0:6 offset1:7
    ds_write2st64_b64 v9, v[176:177], v[182:183] offset0:8 offset1:9
    ds_write_b64 v9, v[188:189] offset:5120
    ds_write2st64_b64 v10, v[220:221], v[222:223] offset0:0 offset1:3
L_a_nw:
    v_pk_mul_f32 v[24:25], v[24:25], v[242:243] op_sel:[0,1] op_sel_hi:[1,1]
    v_pk_mul_f32 v[26:27], v[26:27], v[242:243] op_sel:[0,1] op_sel_hi:[1,1]
    v_pk_mul_f32 v[28:29], v[28:29], v[242:243] op_sel:[0,1] op_sel_hi:[1,1]
    v_pk_mul_f32 v[30:31], v[30:31], v[242:243] op_sel:[0,1] op_sel_hi:[1,1]
    v_pk_mul_f32 v[32:33], v[32:33], v[212:213]
    v_pk_mul_f32 v[34:35], v[34:35], v[214:215]
    v_pk_mul_f32 v[36:37], v[36:37], v[212:213]
    v_pk_mul_f32 v[38:39], v[38:39], v[214:215]
    v_pk_mul_f32 v[40:41], v[40:41], v[242:243] op_sel:[0,1] op_sel_hi:[1,1]
    v_pk_mul_f32 v[42:43], v[42:43], v[242:243] op_sel:[0,1] op_sel_hi:[1,1]
    v_cvt_pk_bf16_f32 v166, v24, v25
    v_cvt_pk_bf16_f32 v167, v26, v27
    v_cvt_pk_bf16_f32 v170, v28, v29
    v_cvt_pk_bf16_f32 v171, v30, v31
    v_cvt_pk_bf16_f32 v180, v32, v33
    v_cvt_pk_bf16_f32 v181, v34, v35
    v_cvt_pk_bf16_f32 v186, v36, v37
    v_cvt_pk_bf16_f32 v187, v38, v39
    v_cvt_pk_bf16_f32 v168, v40, v41
    v_cvt_pk_bf16_f32 v169, v42, v43
    s_waitcnt lgkmcnt(0)
    s_barrier
    ds_read2st64_b64 v[160:163], v9 offset0:0 offset1:1
    ds_read_b64 v[164:165], v9 offset:1024
    ds_read_b64 v[178:179], v9 offset:1536
    ds_read_b64 v[184:185], v9 offset:2048
    v_mfma_f32_16x16x16_bf16 v[128:131], v[174:175], v[234:235], 0
    v_mfma_f32_16x16x16_bf16 v[124:127], v[168:169], v[234:235], 0
    v_pk_mul_f32 v[44:45], v[44:45], v[244:245] op_sel:[0,1] op_sel_hi:[1,1]
    v_pk_mul_f32 v[46:47], v[46:47], v[244:245] op_sel:[0,1] op_sel_hi:[1,1]
    v_pk_mul_f32 v[48:49], v[48:49], v[244:245] op_sel:[0,1] op_sel_hi:[1,1]
    v_pk_mul_f32 v[50:51], v[50:51], v[244:245] op_sel:[0,1] op_sel_hi:[1,1]
    v_pk_mul_f32 v[16:17], v[16:17], v[242:243] op_sel:[0,1] op_sel_hi:[1,1]
    v_pk_mul_f32 v[18:19], v[18:19], v[242:243] op_sel:[0,1] op_sel_hi:[1,1]
    v_pk_mul_f32 v[20:21], v[20:21], v[242:243] op_sel:[0,1] op_sel_hi:[1,1]
    v_pk_mul_f32 v[22:23], v[22:23], v[242:243] op_sel:[0,1] op_sel_hi:[1,1]
    v_cvt_pk_bf16_f32 v112, v44, v45
    v_cvt_pk_bf16_f32 v113, v46, v47
    v_cvt_pk_bf16_f32 v118, v48, v49
    v_cvt_pk_bf16_f32 v119, v50, v51
    v_cvt_pk_bf16_f32 v104, v16, v17
    v_cvt_pk_bf16_f32 v105, v18, v19
    v_cvt_pk_bf16_f32 v110, v20, v21
    v_cvt_pk_bf16_f32 v111, v22, v23
    v_permlane16_swap_b32 v114, v174
    v_permlane16_swap_b32 v117, v175
    v_permlane16_swap_b32 v106, v168
    v_permlane16_swap_b32 v109, v169
    s_waitcnt lgkmcnt(0)
    v_mfma_f32_16x16x16_bf16 v[120:123], v[162:163], v[234:235], 0
    v_mfma_f32_16x16x32_bf16 v[20:23], v[172:175], v[112:115], 0
    v_mfma_f32_16x16x32_bf16 v[16:19], v[166:169], v[112:115], 0
    v_mfma_f32_16x16x32_bf16 v[28:31], v[174:177], v[116:119], 0
    v_mfma_f32_16x16x32_bf16 v[24:27], v[168:171], v[116:119], 0
    v_mfma_f32_16x16x32_bf16 v[36:39], v[166:169], v[104:107], 0
    v_mfma_f32_16x16x32_bf16 v[32:35], v[160:163], v[104:107], 0
    v_mfma_f32_16x16x32_bf16 v[44:47], v[168:171], v[108:111], 0
    v_mfma_f32_16x16x32_bf16 v[40:43], v[162:165], v[108:111], 0
    v_cvt_pk_bf16_f32 v194, v128, v129
    v_cvt_pk_bf16_f32 v195, v130, v131
    v_cvt_pk_bf16_f32 v192, v124, v125
    v_cvt_pk_bf16_f32 v193, v126, v127
    v_cvt_pk_bf16_f32 v190, v120, v121
    v_cvt_pk_bf16_f32 v191, v122, v123
    v_cndmask_b32 v20, v20, v21, s[40:41]
    v_cndmask_b32 v16, v16, v17, s[40:41]
    v_cndmask_b32 v48, v16, v20, s[42:43]
    v_cndmask_b32 v22, v22, v23, s[40:41]
    v_cndmask_b32 v18, v18, v19, s[40:41]
    v_cndmask_b32 v49, v18, v22, s[44:45]
    v_max_f32 v56, v48, v49
    v_cndmask_b32 v28, v28, v29, s[40:41]
    v_cndmask_b32 v24, v24, v25, s[40:41]
    v_cndmask_b32 v50, v24, v28, s[42:43]
    v_cndmask_b32 v30, v30, v31, s[40:41]
    v_cndmask_b32 v26, v26, v27, s[40:41]
    v_cndmask_b32 v51, v26, v30, s[44:45]
    v_max_f32 v57, v50, v51
    v_cndmask_b32 v36, v36, v37, s[40:41]
    v_cndmask_b32 v32, v32, v33, s[40:41]
    v_cndmask_b32 v52, v32, v36, s[42:43]
    v_cndmask_b32 v52, v8, v52, s[48:49]
    v_cndmask_b32 v38, v38, v39, s[40:41]
    v_cndmask_b32 v34, v34, v35, s[40:41]
    v_cndmask_b32 v53, v34, v38, s[44:45]
    v_cndmask_b32 v53, v8, v53, s[38:39]
    v_max_f32 v58, v52, v53
    v_permlane32_swap_b32 v56, v57
    v_max_f32 v56, v56, v57
    v_cndmask_b32 v44, v44, v45, s[40:41]
    v_cndmask_b32 v40, v40, v41, s[40:41]
    v_cndmask_b32 v54, v40, v44, s[42:43]
    v_cndmask_b32 v54, v8, v54, s[48:49]
    v_cndmask_b32 v46, v46, v47, s[40:41]
    v_cndmask_b32 v42, v42, v43, s[40:41]
    v_cndmask_b32 v55, v42, v46, s[44:45]
    v_cndmask_b32 v55, v8, v55, s[38:39]
    v_max_f32 v59, v54, v55
    s_nop 1
    v_permlane32_swap_b32 v58, v59
    v_max_f32 v58, v58, v59
    s_nop 1
    v_permlane16_swap_b32 v56, v58
    v_max_f32 v57, v56, v58
    v_mul_f32 v56, s33, v57
    v_mul_f32 v58, s33, v57
    s_nop 1
    v_permlane16_swap_b32 v56, v58
    v_mov_b32 v57, v56
    v_mov_b32 v59, v58
    s_nop 0
    v_permlane32_swap_b32 v56, v57
    v_permlane32_swap_b32 v58, v59
    v_fma_f32 v48, v48, s33, -v56
    v_fma_f32 v49, v49, s33, -v56
    v_fma_f32 v50, v50, s33, -v57
    v_fma_f32 v51, v51, s33, -v57
    v_fma_f32 v52, v52, s33, -v58
    v_fma_f32 v53, v53, s33, -v58
    v_fma_f32 v54, v54, s33, -v59
    v_fma_f32 v55, v55, s33, -v59
    v_exp_f32 v48, v48
    v_exp_f32 v49, v49
    v_exp_f32 v50, v50
    v_exp_f32 v51, v51
    v_exp_f32 v52, v52
    v_exp_f32 v53, v53
    v_exp_f32 v54, v54
    v_exp_f32 v55, v55
    v_cvt_pk_bf16_f32 v56, v48, v49
    v_cvt_pk_bf16_f32 v57, v50, v51
    v_cvt_pk_bf16_f32 v58, v52, v53
    v_cvt_pk_bf16_f32 v59, v54, v55
    v_perm_b32 v64, v56, v56, v12
    v_perm_b32 v65, v56, v56, v13
    v_perm_b32 v66, v56, v56, v14
    v_perm_b32 v67, v56, v56, v15
    v_perm_b32 v68, v57, v57, v12
    v_perm_b32 v69, v57, v57, v13
    v_perm_b32 v70, v57, v57, v14
    v_perm_b32 v71, v57, v57, v15
    v_perm_b32 v72, v58, v58, v12
    v_perm_b32 v73, v58, v58, v13
    v_perm_b32 v74, v58, v58, v14
    v_perm_b32 v75, v58, v58, v15
    v_perm_b32 v76, v59, v59, v12
    v_perm_b32 v77, v59, v59, v13
    v_perm_b32 v78, v59, v59, v14
    v_perm_b32 v79, v59, v59, v15
    v_mfma_f32_16x16x32_bf16 v[80:83], v[236:239], v[64:67], 0
    v_mfma_f32_16x16x32_bf16 v[84:87], v[236:239], v[68:71], 0
    v_mfma_f32_16x16x32_bf16 v[88:91], v[236:239], v[72:75], 0
    v_mfma_f32_16x16x32_bf16 v[92:95], v[236:239], v[76:79], 0
    v_mfma_f32_16x16x32_bf16 v[16:19], v[180:183], v[64:67], 0
    v_mfma_f32_16x16x32_bf16 v[20:23], v[192:195], v[64:67], 0
    v_mfma_f32_16x16x32_bf16 v[24:27], v[186:189], v[68:71], 0
    v_mfma_f32_16x16x32_bf16 v[28:31], v[192:195], v[68:71], 0
    v_mfma_f32_16x16x32_bf16 v[32:35], v[178:181], v[72:75], 0
    v_mfma_f32_16x16x32_bf16 v[36:39], v[190:193], v[72:75], 0
    v_mfma_f32_16x16x32_bf16 v[40:43], v[184:187], v[76:79], 0
    v_mfma_f32_16x16x32_bf16 v[44:47], v[190:193], v[76:79], 0
    v_rcp_f32 v80, v80
    v_rcp_f32 v84, v84
    v_rcp_f32 v88, v88
    v_rcp_f32 v92, v92
    v_pk_mul_f32 v[16:17], v[16:17], v[80:81] op_sel_hi:[1,0]
    v_pk_mul_f32 v[18:19], v[18:19], v[80:81] op_sel_hi:[1,0]
    v_pk_mul_f32 v[20:21], v[20:21], v[80:81] op_sel_hi:[1,0]
    v_pk_mul_f32 v[24:25], v[24:25], v[84:85] op_sel_hi:[1,0]
    v_pk_mul_f32 v[26:27], v[26:27], v[84:85] op_sel_hi:[1,0]
    v_pk_mul_f32 v[30:31], v[30:31], v[84:85] op_sel_hi:[1,0]
    v_cvt_pk_bf16_f32 v220, v16, v17
    v_cvt_pk_bf16_f32 v221, v18, v19
    v_cvt_pk_bf16_f32 v224, v20, v21
    v_cvt_pk_bf16_f32 v222, v24, v25
    v_cvt_pk_bf16_f32 v223, v26, v27
    v_cvt_pk_bf16_f32 v225, v30, v31
    buffer_store_dwordx4 v[220:223], v5, s[4:7], s35 offen sc1
    buffer_store_dwordx2 v[224:225], v7, s[4:7], s35 offen sc1
    v_pk_mul_f32 v[32:33], v[32:33], v[88:89] op_sel_hi:[1,0]
    v_pk_mul_f32 v[34:35], v[34:35], v[88:89] op_sel_hi:[1,0]
    v_pk_mul_f32 v[36:37], v[36:37], v[88:89] op_sel_hi:[1,0]
    v_pk_mul_f32 v[40:41], v[40:41], v[92:93] op_sel_hi:[1,0]
    v_pk_mul_f32 v[42:43], v[42:43], v[92:93] op_sel_hi:[1,0]
    v_pk_mul_f32 v[46:47], v[46:47], v[92:93] op_sel_hi:[1,0]
    v_cvt_pk_bf16_f32 v228, v32, v33
    v_cvt_pk_bf16_f32 v229, v34, v35
    v_cvt_pk_bf16_f32 v232, v36, v37
    v_cvt_pk_bf16_f32 v230, v40, v41
    v_cvt_pk_bf16_f32 v231, v42, v43
    v_cvt_pk_bf16_f32 v233, v46, v47
    buffer_store_dwordx4 v[228:231], v4, s[4:7], s35 offen sc1
    buffer_store_dwordx2 v[232:233], v6, s[4:7], s35 offen sc1
    s_and_b32 s25, s2, 7
    s_lshr_b32 s26, s2, 3
    s_lshr_b32 s23, s25, 1
    s_lshl_b32 s23, s23, 3
    s_lshr_b32 s27, s26, 2
    s_add_u32 s23, s23, s27
    s_and_b32 s24, s25, 1
    s_lshl_b32 s24, s24, 2
    s_and_b32 s27, s26, 3
    s_add_u32 s24, s24, s27
    s_add_u32 s25, s23, s24
    s_and_b32 s25, s25, 3
    s_lshl_b32 s30, s23, 2
    s_add_u32 s30, s30, s20
    s_mul_i32 s29, s30, 18432
    s_add_u32 s29, s29, s21
    s_add_u32 s29, s29, 0x600000
    s_mul_i32 s34, s30, 18432
    s_add_u32 s34, s34, s21
    s_add_u32 s34, s34, 0x0
    s_lshl_b32 s35, s24, 11
    s_lshr_b32 s36, s24, 2
    s_lshl_b32 s36, s36, 10
    s_and_b32 s37, s24, 3
    s_lshl_b32 s37, s37, 8
    s_add_u32 s36, s36, s37
    s_add_u32 s36, s36, 16384
    v_bfe_u32 v2, v1, 4, 4
    v_lshrrev_b32 v3, 8, v1
    v_add_u32 v4, s35, v1
    v_lshlrev_b32 v5, 4, v2
    v_lshl_add_u32 v5, v3, 3, v5
    v_add_u32 v5, s36, v5
    v_cmp_gt_u32 s[40:41], 2, v3
    v_bfrev_b32 v6, 1
    v_add_u32 v12, 0, v1
    v_add_u32 v13, 36864, v1
    v_add_u32 v14, 73728, v1
    v_add_u32 v15, 110592, v1
    v_cndmask_b32 v5, v6, v5, s[40:41]
    buffer_load_dwordx4 v[208:211], v4, s[4:7], s34 offen offset:0 sc1
    buffer_load_dwordx4 v[212:215], v4, s[4:7], s34 offen offset:1024 sc1
    buffer_load_dwordx2 v[216:217], v5, s[4:7], s34 offen sc1
    s_add_u32 s34, s34, 0x300000
    s_lshl_b32 s39, s30, 10
    s_add_u32 s39, s39, s21
    s_lshl_b32 s42, s24, 7
    s_add_u32 s39, s39, s42
    s_add_u32 s39, s39, 0x1b20000
    v_cmp_eq_u32 vcc, 0, v3
    v_lshlrev_b32 v10, 3, v2
    v_mov_b32 v11, 0x3f803f80
    v_lshl_add_u32 v7, v3, 8, v10
    v_cndmask_b32 v10, v6, v10, vcc
    s_lshr_b32 s44, s23, 1
    s_lshl_b32 s52, s22, 7
    s_add_u32 s52, s52, s44
    s_lshl_b32 s52, s52, 8
    s_add_u32 s52, s52, 0x4508000
    s_add_u32 s52, s52, s4
    s_addc_u32 s53, s5, 0
    s_waitcnt vmcnt(3)
    s_barrier
    s_cmp_lg_u32 s20, 0
    s_cbranch_scc1 L_ns_d2
    s_mov_b32 s56, 1
    s_atomic_add s56, s[50:51], 0
L_ns_d2:
    s_cmp_lg_u32 s20, 0
    s_cbranch_scc1 L_pd_d2
    s_mov_b32 s60, 65536
L_poll_d2:
    s_mov_b32 s57, 0
    s_atomic_add s57, s[52:53], 0 glc
    s_waitcnt lgkmcnt(0)
    s_cmp_ge_u32 s57, 16
    s_cbranch_scc1 L_pd_d2
    s_sub_u32 s60, s60, 1
    s_cbranch_scc1 L_pd_d2
    s_sleep 2
    s_branch L_poll_d2
L_pd_d2:
    s_barrier
    s_mov_b32 s32, 0
    s_lshl_b32 s32, s32, 13
    s_add_u32 s32, s32, s29
    s_add_u32 s33, s32, 4096
    buffer_load_dwordx4 v[112:115], v1, s[4:7], s32 offen offset:0 sc1
    buffer_load_dwordx4 v[116:119], v1, s[4:7], s32 offen offset:1024 sc1
    buffer_load_dwordx4 v[120:123], v1, s[4:7], s32 offen offset:2048 sc1
    buffer_load_dwordx4 v[124:127], v1, s[4:7], s32 offen offset:3072 sc1
    buffer_load_dwordx4 v[128:131], v1, s[4:7], s33 offen offset:0 sc1
    buffer_load_dwordx4 v[132:135], v1, s[4:7], s33 offen offset:1024 sc1
    buffer_load_dwordx4 v[136:139], v1, s[4:7], s33 offen offset:2048 sc1
    buffer_load_dwordx4 v[140:143], v1, s[4:7], s33 offen offset:3072 sc1
    ds_read_b128 v[40:43], v12 offset:18432
    ds_read_b128 v[44:47], v12 offset:19456
    ds_read_b128 v[48:51], v12 offset:20480
    ds_read_b128 v[52:55], v12 offset:21504
    ds_read_b128 v[72:75], v12 offset:26624
    ds_read_b128 v[56:59], v12 offset:22528
    ds_read_b128 v[60:63], v12 offset:23552
    ds_read_b128 v[64:67], v12 offset:24576
    ds_read_b128 v[68:71], v12 offset:25600
    s_add_u32 s45, s29, 8192
    s_add_u32 s46, s29, 12288
    s_add_u32 s47, s29, 16384
    buffer_load_dwordx4 v[144:147], v1, s[4:7], s45 offen offset:0 sc1
    buffer_load_dwordx4 v[148:151], v1, s[4:7], s45 offen offset:1024 sc1
    s_lshl_b32 s42, s23, 3
    s_add_u32 s42, s42, s24
    s_lshl_b32 s42, s42, 2
    s_add_u32 s42, s42, s20
    s_lshl_b32 s42, s42, 8
    s_add_u32 s42, s42, s21
    s_add_u32 s42, s42, 0x1b40000
    v_mov_b32 v220, -1.0
    v_lshrrev_b32 v221, 2, v1
    buffer_store_dword v220, v221, s[4:7], s42 offen sc1
    s_lshl_b32 s50, s22, 7
    s_add_u32 s50, s50, s44
    s_lshl_b32 s50, s50, 8
    s_add_u32 s50, s50, 0x4509000
    s_add_u32 s50, s50, s4
    s_addc_u32 s51, s5, 0
    s_waitcnt vmcnt(11)
    v_lshlrev_b32 v16, 16, v208
    v_and_b32 v17, 0xffff0000, v208
    v_lshlrev_b32 v18, 16, v209
    v_and_b32 v19, 0xffff0000, v209
    v_lshlrev_b32 v20, 16, v210
    v_and_b32 v21, 0xffff0000, v210
    v_lshlrev_b32 v22, 16, v211
    v_and_b32 v23, 0xffff0000, v211
    v_lshlrev_b32 v24, 16, v212
    v_and_b32 v25, 0xffff0000, v212
    v_lshlrev_b32 v26, 16, v213
    v_and_b32 v27, 0xffff0000, v213
    v_lshlrev_b32 v28, 16, v214
    v_and_b32 v29, 0xffff0000, v214
    v_lshlrev_b32 v30, 16, v215
    v_and_b32 v31, 0xffff0000, v215
    v_lshlrev_b32 v32, 16, v216
    v_and_b32 v33, 0xffff0000, v216
    v_lshlrev_b32 v34, 16, v217
    v_and_b32 v35, 0xffff0000, v217
    s_waitcnt vmcnt(9) lgkmcnt(4)
    v_mfma_f32_16x16x32_bf16 v[16:19], v[40:43], v[112:115], v[16:19]
    ds_read_b128 v[76:79], v12 offset:27648
    v_mfma_f32_16x16x32_bf16 v[20:23], v[44:47], v[112:115], v[20:23]
    ds_read_b128 v[80:83], v12 offset:28672
    buffer_load_dwordx4 v[152:155], v1, s[4:7], s45 offen offset:2048 sc1
    v_mfma_f32_16x16x32_bf16 v[24:27], v[48:51], v[112:115], v[24:27]
    ds_read_b128 v[84:87], v12 offset:29696
    v_mfma_f32_16x16x32_bf16 v[28:31], v[52:55], v[112:115], v[28:31]
    ds_read_b128 v[88:91], v12 offset:30720
    v_mfma_f32_16x16x32_bf16 v[32:35], v[72:75], v[112:115], v[32:35]
    ds_read_b128 v[108:111], v12 offset:35840
    s_waitcnt lgkmcnt(5)
    buffer_load_dwordx4 v[156:159], v1, s[4:7], s45 offen offset:3072 sc1
    v_mfma_f32_16x16x32_bf16 v[16:19], v[56:59], v[116:119], v[16:19]
    ds_read_b128 v[92:95], v12 offset:31744
    v_mfma_f32_16x16x32_bf16 v[20:23], v[60:63], v[116:119], v[20:23]
    ds_read_b128 v[96:99], v12 offset:32768
    v_mfma_f32_16x16x32_bf16 v[24:27], v[64:67], v[116:119], v[24:27]
    ds_read_b128 v[100:103], v12 offset:33792
    buffer_load_dwordx4 v[160:163], v1, s[4:7], s46 offen offset:0 sc1
    v_mfma_f32_16x16x32_bf16 v[28:31], v[68:71], v[116:119], v[28:31]
    ds_read_b128 v[104:107], v12 offset:34816
    v_mfma_f32_16x16x32_bf16 v[36:39], v[72:75], v[116:119], 0
    s_waitcnt vmcnt(10) lgkmcnt(4)
    v_mfma_f32_16x16x32_bf16 v[16:19], v[76:79], v[120:123], v[16:19]
    ds_read_b128 v[40:43], v13 offset:18432
    v_mfma_f32_16x16x32_bf16 v[20:23], v[80:83], v[120:123], v[20:23]
    ds_read_b128 v[44:47], v13 offset:19456
    buffer_load_dwordx4 v[164:167], v1, s[4:7], s46 offen offset:1024 sc1
    v_mfma_f32_16x16x32_bf16 v[24:27], v[84:87], v[120:123], v[24:27]
    ds_read_b128 v[48:51], v13 offset:20480
    v_mfma_f32_16x16x32_bf16 v[28:31], v[88:91], v[120:123], v[28:31]
    ds_read_b128 v[52:55], v13 offset:21504
    v_mfma_f32_16x16x32_bf16 v[32:35], v[108:111], v[120:123], v[32:35]
    ds_read_b128 v[72:75], v13 offset:26624
    s_waitcnt lgkmcnt(5)
    buffer_load_dwordx4 v[168:171], v1, s[4:7], s46 offen offset:2048 sc1
    v_mfma_f32_16x16x32_bf16 v[16:19], v[92:95], v[124:127], v[16:19]
    ds_read_b128 v[56:59], v13 offset:22528
    v_mfma_f32_16x16x32_bf16 v[20:23], v[96:99], v[124:127], v[20:23]
    ds_read_b128 v[60:63], v13 offset:23552
    v_mfma_f32_16x16x32_bf16 v[24:27], v[100:103], v[124:127], v[24:27]
    ds_read_b128 v[64:67], v13 offset:24576
    buffer_load_dwordx4 v[172:175], v1, s[4:7], s46 offen offset:3072 sc1
    v_mfma_f32_16x16x32_bf16 v[28:31], v[104:107], v[124:127], v[28:31]
    ds_read_b128 v[68:71], v13 offset:25600
    v_mfma_f32_16x16x32_bf16 v[36:39], v[108:111], v[124:127], v[36:39]
    s_waitcnt vmcnt(11) lgkmcnt(4)
    v_mfma_f32_16x16x32_bf16 v[16:19], v[40:43], v[128:131], v[16:19]
    ds_read_b128 v[76:79], v13 offset:27648
    v_mfma_f32_16x16x32_bf16 v[20:23], v[44:47], v[128:131], v[20:23]
    ds_read_b128 v[80:83], v13 offset:28672
    buffer_load_dwordx2 v[176:177], v7, s[4:7], s47 offen offset:0 sc1
    v_mfma_f32_16x16x32_bf16 v[24:27], v[48:51], v[128:131], v[24:27]
    ds_read_b128 v[84:87], v13 offset:29696
    v_mfma_f32_16x16x32_bf16 v[28:31], v[52:55], v[128:131], v[28:31]
    ds_read_b128 v[88:91], v13 offset:30720
    v_mfma_f32_16x16x32_bf16 v[32:35], v[72:75], v[128:131], v[32:35]
    ds_read_b128 v[108:111], v13 offset:35840
    s_waitcnt lgkmcnt(5)
    buffer_load_dwordx2 v[178:179], v7, s[4:7], s47 offen offset:128 sc1
    v_mfma_f32_16x16x32_bf16 v[16:19], v[56:59], v[132:135], v[16:19]
    ds_read_b128 v[92:95], v13 offset:31744
    v_mfma_f32_16x16x32_bf16 v[20:23], v[60:63], v[132:135], v[20:23]
    ds_read_b128 v[96:99], v13 offset:32768
    v_mfma_f32_16x16x32_bf16 v[24:27], v[64:67], v[132:135], v[24:27]
    ds_read_b128 v[100:103], v13 offset:33792
    buffer_load_dwordx2 v[180:181], v7, s[4:7], s47 offen offset:1024 sc1
    v_mfma_f32_16x16x32_bf16 v[28:31], v[68:71], v[132:135], v[28:31]
    ds_read_b128 v[104:107], v13 offset:34816
    v_mfma_f32_16x16x32_bf16 v[36:39], v[72:75], v[132:135], v[36:39]
    s_waitcnt vmcnt(12) lgkmcnt(4)
    v_mfma_f32_16x16x32_bf16 v[16:19], v[76:79], v[136:139], v[16:19]
    ds_read_b128 v[40:43], v14 offset:18432
    v_mfma_f32_16x16x32_bf16 v[20:23], v[80:83], v[136:139], v[20:23]
    ds_read_b128 v[44:47], v14 offset:19456
    buffer_load_dwordx2 v[182:183], v7, s[4:7], s47 offen offset:1152 sc1
    v_mfma_f32_16x16x32_bf16 v[24:27], v[84:87], v[136:139], v[24:27]
    ds_read_b128 v[48:51], v14 offset:20480
    v_mfma_f32_16x16x32_bf16 v[28:31], v[88:91], v[136:139], v[28:31]
    ds_read_b128 v[52:55], v14 offset:21504
    v_mfma_f32_16x16x32_bf16 v[32:35], v[108:111], v[136:139], v[32:35]
    ds_read_b128 v[72:75], v14 offset:26624
    s_waitcnt lgkmcnt(5)
    v_mfma_f32_16x16x32_bf16 v[16:19], v[92:95], v[140:143], v[16:19]
    ds_read_b128 v[56:59], v14 offset:22528
    v_mfma_f32_16x16x32_bf16 v[20:23], v[96:99], v[140:143], v[20:23]
    ds_read_b128 v[60:63], v14 offset:23552
    v_mfma_f32_16x16x32_bf16 v[24:27], v[100:103], v[140:143], v[24:27]
    ds_read_b128 v[64:67], v14 offset:24576
    v_mfma_f32_16x16x32_bf16 v[28:31], v[104:107], v[140:143], v[28:31]
    ds_read_b128 v[68:71], v14 offset:25600
    v_mfma_f32_16x16x32_bf16 v[36:39], v[108:111], v[140:143], v[36:39]
    s_waitcnt vmcnt(11) lgkmcnt(4)
    v_mfma_f32_16x16x32_bf16 v[16:19], v[40:43], v[144:147], v[16:19]
    ds_read_b128 v[76:79], v14 offset:27648
    v_mfma_f32_16x16x32_bf16 v[20:23], v[44:47], v[144:147], v[20:23]
    ds_read_b128 v[80:83], v14 offset:28672
    v_mfma_f32_16x16x32_bf16 v[24:27], v[48:51], v[144:147], v[24:27]
    ds_read_b128 v[84:87], v14 offset:29696
    v_mfma_f32_16x16x32_bf16 v[28:31], v[52:55], v[144:147], v[28:31]
    ds_read_b128 v[88:91], v14 offset:30720
    v_mfma_f32_16x16x32_bf16 v[32:35], v[72:75], v[144:147], v[32:35]
    ds_read_b128 v[108:111], v14 offset:35840
    s_waitcnt lgkmcnt(5)
    v_mfma_f32_16x16x32_bf16 v[16:19], v[56:59], v[148:151], v[16:19]
    ds_read_b128 v[92:95], v14 offset:31744
    v_mfma_f32_16x16x32_bf16 v[20:23], v[60:63], v[148:151], v[20:23]
    ds_read_b128 v[96:99], v14 offset:32768
    v_mfma_f32_16x16x32_bf16 v[24:27], v[64:67], v[148:151], v[24:27]
    ds_read_b128 v[100:103], v14 offset:33792
    v_mfma_f32_16x16x32_bf16 v[28:31], v[68:71], v[148:151], v[28:31]
    ds_read_b128 v[104:107], v14 offset:34816
    v_mfma_f32_16x16x32_bf16 v[36:39], v[72:75], v[148:151], v[36:39]
    s_waitcnt vmcnt(8) lgkmcnt(4)
    v_mfma_f32_16x16x32_bf16 v[16:19], v[76:79], v[152:155], v[16:19]
    ds_read_b128 v[40:43], v15 offset:18432
    v_mfma_f32_16x16x32_bf16 v[20:23], v[80:83], v[152:155], v[20:23]
    ds_read_b128 v[44:47], v15 offset:19456
    v_mfma_f32_16x16x32_bf16 v[24:27], v[84:87], v[152:155], v[24:27]
    ds_read_b128 v[48:51], v15 offset:20480
    v_mfma_f32_16x16x32_bf16 v[28:31], v[88:91], v[152:155], v[28:31]
    ds_read_b128 v[52:55], v15 offset:21504
    v_mfma_f32_16x16x32_bf16 v[32:35], v[108:111], v[152:155], v[32:35]
    ds_read_b128 v[72:75], v15 offset:26624
    s_waitcnt lgkmcnt(5)
    v_mfma_f32_16x16x32_bf16 v[16:19], v[92:95], v[156:159], v[16:19]
    ds_read_b128 v[56:59], v15 offset:22528
    v_mfma_f32_16x16x32_bf16 v[20:23], v[96:99], v[156:159], v[20:23]
    ds_read_b128 v[60:63], v15 offset:23552
    v_mfma_f32_16x16x32_bf16 v[24:27], v[100:103], v[156:159], v[24:27]
    ds_read_b128 v[64:67], v15 offset:24576
    v_mfma_f32_16x16x32_bf16 v[28:31], v[104:107], v[156:159], v[28:31]
    ds_read_b128 v[68:71], v15 offset:25600
    v_mfma_f32_16x16x32_bf16 v[36:39], v[108:111], v[156:159], v[36:39]
    s_waitcnt vmcnt(6) lgkmcnt(4)
    v_mfma_f32_16x16x32_bf16 v[16:19], v[40:43], v[160:163], v[16:19]
    ds_read_b128 v[76:79], v15 offset:27648
    v_mfma_f32_16x16x32_bf16 v[20:23], v[44:47], v[160:163], v[20:23]
    ds_read_b128 v[80:83], v15 offset:28672
    v_mfma_f32_16x16x32_bf16 v[24:27], v[48:51], v[160:163], v[24:27]
    ds_read_b128 v[84:87], v15 offset:29696
    v_mfma_f32_16x16x32_bf16 v[28:31], v[52:55], v[160:163], v[28:31]
    ds_read_b128 v[88:91], v15 offset:30720
    v_mfma_f32_16x16x32_bf16 v[32:35], v[72:75], v[160:163], v[32:35]
    ds_read_b128 v[108:111], v15 offset:35840
    s_waitcnt lgkmcnt(5)
    v_mfma_f32_16x16x32_bf16 v[16:19], v[56:59], v[164:167], v[16:19]
    ds_read_b128 v[92:95], v15 offset:31744
    v_mfma_f32_16x16x32_bf16 v[20:23], v[60:63], v[164:167], v[20:23]
    ds_read_b128 v[96:99], v15 offset:32768
    v_mfma_f32_16x16x32_bf16 v[24:27], v[64:67], v[164:167], v[24:27]
    ds_read_b128 v[100:103], v15 offset:33792
    v_mfma_f32_16x16x32_bf16 v[28:31], v[68:71], v[164:167], v[28:31]
    ds_read_b128 v[104:107], v15 offset:34816
    v_mfma_f32_16x16x32_bf16 v[36:39], v[72:75], v[164:167], v[36:39]
    s_waitcnt vmcnt(4) lgkmcnt(4)
    v_mfma_f32_16x16x32_bf16 v[16:19], v[76:79], v[168:171], v[16:19]
    ds_read_b128 v[40:43], v15 offset:36864
    v_mfma_f32_16x16x32_bf16 v[20:23], v[80:83], v[168:171], v[20:23]
    ds_read_b128 v[44:47], v15 offset:37888
    v_mfma_f32_16x16x32_bf16 v[24:27], v[84:87], v[168:171], v[24:27]
    ds_read_b128 v[48:51], v15 offset:38912
    v_mfma_f32_16x16x32_bf16 v[28:31], v[88:91], v[168:171], v[28:31]
    ds_read_b128 v[52:55], v15 offset:39936
    v_mfma_f32_16x16x32_bf16 v[32:35], v[108:111], v[168:171], v[32:35]
    ds_read_b128 v[72:75], v15 offset:45056
    s_waitcnt lgkmcnt(5)
    v_mfma_f32_16x16x32_bf16 v[16:19], v[92:95], v[172:175], v[16:19]
    ds_read_b128 v[56:59], v15 offset:40960
    v_mfma_f32_16x16x32_bf16 v[20:23], v[96:99], v[172:175], v[20:23]
    ds_read_b128 v[60:63], v15 offset:41984
    v_mfma_f32_16x16x32_bf16 v[24:27], v[100:103], v[172:175], v[24:27]
    ds_read_b128 v[64:67], v15 offset:43008
    v_mfma_f32_16x16x32_bf16 v[28:31], v[104:107], v[172:175], v[28:31]
    ds_read_b128 v[68:71], v15 offset:44032
    v_mfma_f32_16x16x32_bf16 v[36:39], v[108:111], v[172:175], v[36:39]
    s_waitcnt vmcnt(0) lgkmcnt(4)
    v_mfma_f32_16x16x32_bf16 v[16:19], v[40:43], v[176:179], v[16:19]
    v_mfma_f32_16x16x32_bf16 v[20:23], v[44:47], v[176:179], v[20:23]
    v_mfma_f32_16x16x32_bf16 v[24:27], v[48:51], v[176:179], v[24:27]
    v_mfma_f32_16x16x32_bf16 v[28:31], v[52:55], v[176:179], v[28:31]
    v_mfma_f32_16x16x32_bf16 v[32:35], v[72:75], v[176:179], v[32:35]
    s_waitcnt lgkmcnt(0)
    v_mfma_f32_16x16x32_bf16 v[16:19], v[56:59], v[180:183], v[16:19]
    v_mfma_f32_16x16x32_bf16 v[20:23], v[60:63], v[180:183], v[20:23]
    v_mfma_f32_16x16x32_bf16 v[24:27], v[64:67], v[180:183], v[24:27]
    v_mfma_f32_16x16x32_bf16 v[28:31], v[68:71], v[180:183], v[28:31]
    v_mfma_f32_16x16x32_bf16 v[36:39], v[72:75], v[180:183], v[36:39]
    s_nop 3
    v_cvt_pk_bf16_f32 v208, v16, v17
    v_cvt_pk_bf16_f32 v209, v18, v19
    v_cvt_pk_bf16_f32 v210, v20, v21
    v_cvt_pk_bf16_f32 v211, v22, v23
    v_cvt_pk_bf16_f32 v212, v24, v25
    v_cvt_pk_bf16_f32 v213, v26, v27
    v_cvt_pk_bf16_f32 v214, v28, v29
    v_cvt_pk_bf16_f32 v215, v30, v31
    buffer_store_dwordx4 v[208:211], v4, s[4:7], s34 offen offset:0 sc1
    buffer_store_dwordx4 v[212:215], v4, s[4:7], s34 offen offset:1024 sc1
    v_permlane32_swap_b32 v36, v220
    v_permlane32_swap_b32 v37, v221
    v_permlane32_swap_b32 v38, v222
    v_permlane32_swap_b32 v39, v223
    v_pk_add_f32 v[32:33], v[32:33], v[220:221]
    v_pk_add_f32 v[34:35], v[34:35], v[222:223]
    v_cvt_pk_bf16_f32 v216, v32, v33
    v_cvt_pk_bf16_f32 v217, v34, v35
    buffer_store_dwordx2 v[216:217], v5, s[4:7], s34 offen sc1
    v_cndmask_b32 v222, 0, v216, s[40:41]
    v_cndmask_b32 v223, 0, v217, s[40:41]
    v_dot2_f32_bf16 v220, v208, v11, 0
    v_dot2_f32_bf16 v221, v208, v208, 0
    v_dot2_f32_bf16 v224, v209, v11, 0
    v_dot2_f32_bf16 v225, v209, v209, 0
    v_dot2_f32_bf16 v220, v210, v11, v220
    v_dot2_f32_bf16 v221, v210, v210, v221
    v_dot2_f32_bf16 v224, v211, v11, v224
    v_dot2_f32_bf16 v225, v211, v211, v225
    v_dot2_f32_bf16 v220, v212, v11, v220
    v_dot2_f32_bf16 v221, v212, v212, v221
    v_dot2_f32_bf16 v224, v213, v11, v224
    v_dot2_f32_bf16 v225, v213, v213, v225
    v_dot2_f32_bf16 v220, v214, v11, v220
    v_dot2_f32_bf16 v221, v214, v214, v221
    v_dot2_f32_bf16 v224, v215, v11, v224
    v_dot2_f32_bf16 v225, v215, v215, v225
    v_dot2_f32_bf16 v220, v222, v11, v220
    v_dot2_f32_bf16 v221, v222, v222, v221
    v_dot2_f32_bf16 v224, v223, v11, v224
    v_dot2_f32_bf16 v225, v223, v223, v225
    s_nop 2
    v_pk_add_f32 v[220:221], v[220:221], v[224:225]
    v_mov_b32 v222, v220
    v_mov_b32 v223, v221
    s_nop 1
    v_permlane32_swap_b32 v220, v222
    v_permlane32_swap_b32 v221, v223
    v_add_f32 v220, v220, v222
    v_add_f32 v221, v221, v223
    v_mov_b32 v222, v220
    v_mov_b32 v223, v221
    s_nop 1
    v_permlane16_swap_b32 v220, v222
    v_permlane16_swap_b32 v221, v223
    v_add_f32 v220, v220, v222
    v_add_f32 v221, v221, v223
    buffer_store_dwordx2 v[220:221], v10, s[4:7], s39 offen sc1
    s_and_b32 s25, s2, 7
    s_lshr_b32 s26, s2, 3
    s_and_b32 s23, s25, 1
    s_lshl_b32 s23, s23, 3
    s_and_b32 s27, s26, 7
    s_add_u32 s23, s23, s27
    s_lshr_b32 s24, s25, 1
    s_lshl_b32 s24, s24, 2
    s_lshr_b32 s27, s26, 3
    s_add_u32 s24, s24, s27
    s_add_u32 s28, s23, s24
    s_and_b32 s28, s28, 3
    s_lshl_b32 s30, s20, 12
    s_lshl_b32 s31, s23, 3
    s_lshl_b32 s33, s20, 1
    s_add_u32 s31, s31, s33
    s_lshl_b32 s32, s31, 10
    s_add_u32 s32, s32, s21
    s_add_u32 s32, s32, 0x1b20000
    v_add_u32 v2, 73728, v1
    s_add_u32 s33, s30, 18432
    v_add_u32 v3, s33, v1
    v_add_u32 v0, s33, v2
    s_lshr_b32 s34, s31, 1
    s_lshl_b32 s35, s34, 12
    s_add_u32 s35, s35, s21
    s_add_u32 s35, s35, 0x1b40000
    s_lshl_b32 s36, s24, 8
    s_add_u32 s36, s36, s35
    s_lshl_b32 s38, s24, 6
    s_add_u32 s38, s38, s34
    s_mul_i32 s38, s38, 9216
    s_add_u32 s38, s38, s21
    s_add_u32 s38, s38, 0x900000
    s_add_u32 s39, s38, 4096
    s_add_u32 s46, s38, 8192
    s_mov_b32 s40, 0xc0135761
    s_mov_b32 s42, 0x3d372713
    s_mov_b32 s44, 0x39e38e39
    s_mov_b32 s45, 0x3727c5ac
    v_lshrrev_b32 v4, 1, v1
    s_lshl_b32 s52, s22, 7
    s_add_u32 s52, s52, s23
    s_lshl_b32 s52, s52, 8
    s_add_u32 s52, s52, 0x4509000
    s_add_u32 s52, s52, s4
    s_addc_u32 s53, s5, 0
    s_waitcnt vmcnt(0)
    s_barrier
    s_cmp_lg_u32 s20, 0
    s_cbranch_scc1 L_ns_d3
    s_mov_b32 s56, 1
    s_atomic_add s56, s[50:51], 0
L_ns_d3:
    s_cmp_lg_u32 s20, 0
    s_cbranch_scc1 L_pd_d3
    s_mov_b32 s60, 65536
L_poll_d3:
    s_mov_b32 s57, 0
    s_atomic_add s57, s[52:53], 0 glc
    s_waitcnt lgkmcnt(0)
    s_cmp_ge_u32 s57, 16
    s_cbranch_scc1 L_pd_d3
    s_sub_u32 s60, s60, 1
    s_cbranch_scc1 L_pd_d3
    s_sleep 2
    s_branch L_poll_d3
L_pd_d3:
    s_barrier
    buffer_load_dwordx2 v[8:9], v4, s[4:7], s32 offen offset:0 sc1
    buffer_load_dwordx2 v[10:11], v4, s[4:7], s32 offen offset:512 sc1
    buffer_load_dwordx2 v[12:13], v4, s[4:7], s32 offen offset:1024 sc1
    buffer_load_dwordx2 v[14:15], v4, s[4:7], s32 offen offset:1536 sc1
    s_lshl_b32 s50, s22, 7
    s_add_u32 s50, s50, s23
    s_lshl_b32 s50, s50, 8
    s_add_u32 s50, s50, 0x450a000
    s_add_u32 s50, s50, s4
    s_addc_u32 s51, s5, 0
    s_barrier
    ds_read_b128 v[160:163], v3 offset:0
    ds_read_b128 v[164:167], v3 offset:2048
    ds_read_b128 v[168:171], v1 offset:0
    ds_read_b128 v[172:175], v1 offset:1024
    ds_read_b128 v[176:179], v1 offset:2048
    ds_read_b128 v[180:183], v1 offset:3072
    ds_read_b128 v[184:187], v1 offset:4096
    ds_read_b128 v[188:191], v1 offset:5120
    ds_read_b128 v[192:195], v1 offset:6144
    ds_read_b128 v[196:199], v1 offset:7168
    ds_read_b128 v[200:203], v1 offset:8192
    s_waitcnt lgkmcnt(5)
    v_mfma_f32_16x16x32_bf16 v[16:19], v[160:163], v[168:171], 0
    ds_read_b128 v[204:207], v3 offset:1024
    v_mfma_f32_16x16x32_bf16 v[20:23], v[164:167], v[168:171], 0
    ds_read_b128 v[208:211], v3 offset:3072
    v_mfma_f32_16x16x32_bf16 v[24:27], v[160:163], v[172:175], 0
    ds_read_b128 v[212:215], v1 offset:9216
    v_mfma_f32_16x16x32_bf16 v[28:31], v[164:167], v[172:175], 0
    ds_read_b128 v[216:219], v1 offset:10240
    v_mfma_f32_16x16x32_bf16 v[32:35], v[160:163], v[176:179], 0
    ds_read_b128 v[220:223], v1 offset:11264
    v_mfma_f32_16x16x32_bf16 v[36:39], v[164:167], v[176:179], 0
    ds_read_b128 v[224:227], v1 offset:12288
    v_mfma_f32_16x16x32_bf16 v[40:43], v[160:163], v[180:183], 0
    ds_read_b128 v[228:231], v1 offset:13312
    v_mfma_f32_16x16x32_bf16 v[44:47], v[164:167], v[180:183], 0
    ds_read_b128 v[232:235], v1 offset:14336
    s_waitcnt lgkmcnt(8)
    v_mfma_f32_16x16x32_bf16 v[48:51], v[160:163], v[184:187], 0
    ds_read_b128 v[236:239], v1 offset:15360
    v_mfma_f32_16x16x32_bf16 v[52:55], v[164:167], v[184:187], 0
    ds_read_b128 v[240:243], v1 offset:16384
    v_mfma_f32_16x16x32_bf16 v[56:59], v[160:163], v[188:191], 0
    ds_read_b128 v[244:247], v1 offset:17408
    v_mfma_f32_16x16x32_bf16 v[60:63], v[164:167], v[188:191], 0
    v_mfma_f32_16x16x32_bf16 v[64:67], v[160:163], v[192:195], 0
    v_mfma_f32_16x16x32_bf16 v[68:71], v[164:167], v[192:195], 0
    v_mfma_f32_16x16x32_bf16 v[72:75], v[160:163], v[196:199], 0
    v_mfma_f32_16x16x32_bf16 v[76:79], v[164:167], v[196:199], 0
    v_mfma_f32_16x16x32_bf16 v[80:83], v[160:163], v[200:203], 0
    v_mfma_f32_16x16x32_bf16 v[84:87], v[164:167], v[200:203], 0
    s_waitcnt lgkmcnt(0)
    s_barrier
    v_mfma_f32_16x16x32_bf16 v[16:19], v[204:207], v[212:215], v[16:19]
    ds_read_b128 v[160:163], v3 offset:36864
    v_mfma_f32_16x16x32_bf16 v[20:23], v[208:211], v[212:215], v[20:23]
    ds_read_b128 v[164:167], v3 offset:38912
    v_mfma_f32_16x16x32_bf16 v[24:27], v[204:207], v[216:219], v[24:27]
    ds_read_b128 v[168:171], v1 offset:36864
    v_mfma_f32_16x16x32_bf16 v[28:31], v[208:211], v[216:219], v[28:31]
    ds_read_b128 v[172:175], v1 offset:37888
    v_mfma_f32_16x16x32_bf16 v[32:35], v[204:207], v[220:223], v[32:35]
    ds_read_b128 v[176:179], v1 offset:38912
    v_mfma_f32_16x16x32_bf16 v[36:39], v[208:211], v[220:223], v[36:39]
    ds_read_b128 v[180:183], v1 offset:39936
    v_mfma_f32_16x16x32_bf16 v[40:43], v[204:207], v[224:227], v[40:43]
    ds_read_b128 v[184:187], v1 offset:40960
    v_mfma_f32_16x16x32_bf16 v[44:47], v[208:211], v[224:227], v[44:47]
    ds_read_b128 v[188:191], v1 offset:41984
    v_mfma_f32_16x16x32_bf16 v[48:51], v[204:207], v[228:231], v[48:51]
    ds_read_b128 v[192:195], v1 offset:43008
    v_mfma_f32_16x16x32_bf16 v[52:55], v[208:211], v[228:231], v[52:55]
    ds_read_b128 v[196:199], v1 offset:44032
    v_lshrrev_b32 v5, 8, v1
    v_mfma_f32_16x16x32_bf16 v[56:59], v[204:207], v[232:235], v[56:59]
    ds_read_b128 v[200:203], v1 offset:45056
    v_bfe_u32 v6, v1, 4, 4
    v_mfma_f32_16x16x32_bf16 v[60:63], v[208:211], v[232:235], v[60:63]
    v_lshlrev_b32 v7, 2, v6
    v_mfma_f32_16x16x32_bf16 v[64:67], v[204:207], v[236:239], v[64:67]
    s_lshl_b32 s33, s20, 8
    v_mfma_f32_16x16x32_bf16 v[68:71], v[208:211], v[236:239], v[68:71]
    s_add_u32 s33, s33, 147456
    v_mfma_f32_16x16x32_bf16 v[72:75], v[204:207], v[240:243], v[72:75]
    v_add_u32 v4, s33, v7
    v_mfma_f32_16x16x32_bf16 v[76:79], v[208:211], v[240:243], v[76:79]
    v_lshl_add_u32 v252, v5, 4, s33
    v_mfma_f32_16x16x32_bf16 v[80:83], v[204:207], v[244:247], v[80:83]
    v_add_u32 v7, 159744, v7
    v_mfma_f32_16x16x32_bf16 v[84:87], v[208:211], v[244:247], v[84:87]
    s_waitcnt vmcnt(0)
    v_add_f32 v248, v8, v10
    s_waitcnt lgkmcnt(5)
    v_mfma_f32_16x16x32_bf16 v[16:19], v[160:163], v[168:171], v[16:19]
    ds_read_b128 v[204:207], v3 offset:37888
    v_mfma_f32_16x16x32_bf16 v[20:23], v[164:167], v[168:171], v[20:23]
    ds_read_b128 v[208:211], v3 offset:39936
    v_mfma_f32_16x16x32_bf16 v[24:27], v[160:163], v[172:175], v[24:27]
    ds_read_b128 v[212:215], v1 offset:46080
    v_mfma_f32_16x16x32_bf16 v[28:31], v[164:167], v[172:175], v[28:31]
    ds_read_b128 v[216:219], v1 offset:47104
    v_mfma_f32_16x16x32_bf16 v[32:35], v[160:163], v[176:179], v[32:35]
    ds_read_b128 v[220:223], v1 offset:48128
    v_mfma_f32_16x16x32_bf16 v[36:39], v[164:167], v[176:179], v[36:39]
    ds_read_b128 v[224:227], v1 offset:49152
    v_mfma_f32_16x16x32_bf16 v[40:43], v[160:163], v[180:183], v[40:43]
    ds_read_b128 v[228:231], v1 offset:50176
    v_mfma_f32_16x16x32_bf16 v[44:47], v[164:167], v[180:183], v[44:47]
    ds_read_b128 v[232:235], v1 offset:51200
    s_waitcnt lgkmcnt(8)
    v_mfma_f32_16x16x32_bf16 v[48:51], v[160:163], v[184:187], v[48:51]
    ds_read_b128 v[236:239], v1 offset:52224
    v_mfma_f32_16x16x32_bf16 v[52:55], v[164:167], v[184:187], v[52:55]
    ds_read_b128 v[240:243], v1 offset:53248
    v_add_f32 v249, v9, v11
    v_mfma_f32_16x16x32_bf16 v[56:59], v[160:163], v[188:191], v[56:59]
    ds_read_b128 v[244:247], v1 offset:54272
    v_add_f32 v250, v12, v14
    v_mfma_f32_16x16x32_bf16 v[60:63], v[164:167], v[188:191], v[60:63]
    v_add_f32 v251, v13, v15
    v_mfma_f32_16x16x32_bf16 v[64:67], v[160:163], v[192:195], v[64:67]
    v_mov_b32 v8, v248
    v_mfma_f32_16x16x32_bf16 v[68:71], v[164:167], v[192:195], v[68:71]
    v_mov_b32 v9, v249
    v_mfma_f32_16x16x32_bf16 v[72:75], v[160:163], v[196:199], v[72:75]
    v_mov_b32 v12, v250
    v_mfma_f32_16x16x32_bf16 v[76:79], v[164:167], v[196:199], v[76:79]
    v_mov_b32 v13, v251
    v_mfma_f32_16x16x32_bf16 v[80:83], v[160:163], v[200:203], v[80:83]
    v_permlane32_swap_b32 v248, v8
    v_mfma_f32_16x16x32_bf16 v[84:87], v[164:167], v[200:203], v[84:87]
    v_permlane32_swap_b32 v249, v9
    v_permlane32_swap_b32 v250, v12
    s_waitcnt lgkmcnt(0)
    s_barrier
    v_mfma_f32_16x16x32_bf16 v[16:19], v[204:207], v[212:215], v[16:19]
    ds_read_b128 v[160:163], v0 offset:0
    v_mfma_f32_16x16x32_bf16 v[20:23], v[208:211], v[212:215], v[20:23]
    ds_read_b128 v[164:167], v0 offset:2048
    v_mfma_f32_16x16x32_bf16 v[24:27], v[204:207], v[216:219], v[24:27]
    ds_read_b128 v[168:171], v2 offset:0
    v_mfma_f32_16x16x32_bf16 v[28:31], v[208:211], v[216:219], v[28:31]
    ds_read_b128 v[172:175], v2 offset:1024
    v_mfma_f32_16x16x32_bf16 v[32:35], v[204:207], v[220:223], v[32:35]
    ds_read_b128 v[176:179], v2 offset:2048
    v_mfma_f32_16x16x32_bf16 v[36:39], v[208:211], v[220:223], v[36:39]
    ds_read_b128 v[180:183], v2 offset:3072
    v_mfma_f32_16x16x32_bf16 v[40:43], v[204:207], v[224:227], v[40:43]
    ds_read_b128 v[184:187], v2 offset:4096
    v_mfma_f32_16x16x32_bf16 v[44:47], v[208:211], v[224:227], v[44:47]
    ds_read_b128 v[188:191], v2 offset:5120
    v_mfma_f32_16x16x32_bf16 v[48:51], v[204:207], v[228:231], v[48:51]
    ds_read_b128 v[192:195], v2 offset:6144
    v_mfma_f32_16x16x32_bf16 v[52:55], v[208:211], v[228:231], v[52:55]
    ds_read_b128 v[196:199], v2 offset:7168
    v_permlane32_swap_b32 v251, v13
    v_mfma_f32_16x16x32_bf16 v[56:59], v[204:207], v[232:235], v[56:59]
    ds_read_b128 v[200:203], v2 offset:8192
    v_add_f32 v248, v248, v8
    v_mfma_f32_16x16x32_bf16 v[60:63], v[208:211], v[232:235], v[60:63]
    ds_read2_b32 v[128:129], v7 offset0:0 offset1:16
    v_add_f32 v249, v249, v9
    v_mfma_f32_16x16x32_bf16 v[64:67], v[204:207], v[236:239], v[64:67]
    ds_read2_b32 v[130:131], v7 offset0:32 offset1:48
    v_add_f32 v250, v250, v12
    v_mfma_f32_16x16x32_bf16 v[68:71], v[208:211], v[236:239], v[68:71]
    ds_read2_b32 v[132:133], v7 offset0:64 offset1:80
    v_add_f32 v251, v251, v13
    v_mfma_f32_16x16x32_bf16 v[72:75], v[204:207], v[240:243], v[72:75]
    ds_read2_b32 v[134:135], v7 offset0:96 offset1:112
    v_mov_b32 v8, v248
    v_mfma_f32_16x16x32_bf16 v[76:79], v[208:211], v[240:243], v[76:79]
    ds_read2_b32 v[136:137], v7 offset0:128 offset1:144
    v_mov_b32 v9, v249
    v_mfma_f32_16x16x32_bf16 v[80:83], v[204:207], v[244:247], v[80:83]
    v_mov_b32 v12, v250
    v_mfma_f32_16x16x32_bf16 v[84:87], v[208:211], v[244:247], v[84:87]
    v_mov_b32 v13, v251
    v_permlane16_swap_b32 v248, v8
    s_waitcnt lgkmcnt(10)
    v_mfma_f32_16x16x32_bf16 v[16:19], v[160:163], v[168:171], v[16:19]
    ds_read_b128 v[204:207], v0 offset:1024
    v_mfma_f32_16x16x32_bf16 v[20:23], v[164:167], v[168:171], v[20:23]
    ds_read_b128 v[208:211], v0 offset:3072
    v_mfma_f32_16x16x32_bf16 v[24:27], v[160:163], v[172:175], v[24:27]
    ds_read_b128 v[212:215], v2 offset:9216
    v_mfma_f32_16x16x32_bf16 v[28:31], v[164:167], v[172:175], v[28:31]
    ds_read_b128 v[216:219], v2 offset:10240
    v_mfma_f32_16x16x32_bf16 v[32:35], v[160:163], v[176:179], v[32:35]
    ds_read_b128 v[220:223], v2 offset:11264
    v_mfma_f32_16x16x32_bf16 v[36:39], v[164:167], v[176:179], v[36:39]
    ds_read_b128 v[224:227], v2 offset:12288
    v_mfma_f32_16x16x32_bf16 v[40:43], v[160:163], v[180:183], v[40:43]
    ds_read_b128 v[228:231], v2 offset:13312
    v_mfma_f32_16x16x32_bf16 v[44:47], v[164:167], v[180:183], v[44:47]
    ds_read_b128 v[232:235], v2 offset:14336
    s_waitcnt lgkmcnt(8)
    v_mfma_f32_16x16x32_bf16 v[48:51], v[160:163], v[184:187], v[48:51]
    ds_read_b128 v[236:239], v2 offset:15360
    v_mfma_f32_16x16x32_bf16 v[52:55], v[164:167], v[184:187], v[52:55]
    ds_read_b128 v[240:243], v2 offset:16384
    v_permlane16_swap_b32 v249, v9
    v_mfma_f32_16x16x32_bf16 v[56:59], v[160:163], v[188:191], v[56:59]
    ds_read_b128 v[244:247], v2 offset:17408
    v_permlane16_swap_b32 v250, v12
    v_mfma_f32_16x16x32_bf16 v[60:63], v[164:167], v[188:191], v[60:63]
    v_permlane16_swap_b32 v251, v13
    v_mfma_f32_16x16x32_bf16 v[64:67], v[160:163], v[192:195], v[64:67]
    v_add_f32 v248, v248, v8
    v_mfma_f32_16x16x32_bf16 v[68:71], v[164:167], v[192:195], v[68:71]
    v_add_f32 v249, v249, v9
    v_mfma_f32_16x16x32_bf16 v[72:75], v[160:163], v[196:199], v[72:75]
    v_add_f32 v250, v250, v12
    v_mfma_f32_16x16x32_bf16 v[76:79], v[164:167], v[196:199], v[76:79]
    v_add_f32 v251, v251, v13
    v_mfma_f32_16x16x32_bf16 v[80:83], v[160:163], v[200:203], v[80:83]
    v_mul_f32 v248, 0x3ae38e39, v248
    v_mfma_f32_16x16x32_bf16 v[84:87], v[164:167], v[200:203], v[84:87]
    v_mul_f32 v249, 0x3ae38e39, v249
    v_mul_f32 v250, 0x3ae38e39, v250
    s_waitcnt lgkmcnt(0)
    s_barrier
    v_mfma_f32_16x16x32_bf16 v[16:19], v[204:207], v[212:215], v[16:19]
    ds_read_b128 v[160:163], v0 offset:36864
    v_mfma_f32_16x16x32_bf16 v[20:23], v[208:211], v[212:215], v[20:23]
    ds_read_b128 v[164:167], v0 offset:38912
    v_mfma_f32_16x16x32_bf16 v[24:27], v[204:207], v[216:219], v[24:27]
    ds_read_b128 v[168:171], v2 offset:36864
    v_mfma_f32_16x16x32_bf16 v[28:31], v[208:211], v[216:219], v[28:31]
    ds_read_b128 v[172:175], v2 offset:37888
    v_mfma_f32_16x16x32_bf16 v[32:35], v[204:207], v[220:223], v[32:35]
    ds_read_b128 v[176:179], v2 offset:38912
    v_mfma_f32_16x16x32_bf16 v[36:39], v[208:211], v[220:223], v[36:39]
    ds_read_b128 v[180:183], v2 offset:39936
    v_mfma_f32_16x16x32_bf16 v[40:43], v[204:207], v[224:227], v[40:43]
    ds_read_b128 v[184:187], v2 offset:40960
    v_mfma_f32_16x16x32_bf16 v[44:47], v[208:211], v[224:227], v[44:47]
    ds_read_b128 v[188:191], v2 offset:41984
    v_mfma_f32_16x16x32_bf16 v[48:51], v[204:207], v[228:231], v[48:51]
    ds_read_b128 v[192:195], v2 offset:43008
    v_mfma_f32_16x16x32_bf16 v[52:55], v[208:211], v[228:231], v[52:55]
    ds_read_b128 v[196:199], v2 offset:44032
    v_mul_f32 v251, 0x3ae38e39, v251
    v_mfma_f32_16x16x32_bf16 v[56:59], v[204:207], v[232:235], v[56:59]
    ds_read_b128 v[200:203], v2 offset:45056
    v_fma_f32 v249, -v248, v248, v249
    v_mfma_f32_16x16x32_bf16 v[60:63], v[208:211], v[232:235], v[60:63]
    v_fma_f32 v251, -v250, v250, v251
    v_mfma_f32_16x16x32_bf16 v[64:67], v[204:207], v[236:239], v[64:67]
    v_max_f32 v249, 0, v249
    v_mfma_f32_16x16x32_bf16 v[68:71], v[208:211], v[236:239], v[68:71]
    v_max_f32 v251, 0, v251
    v_mfma_f32_16x16x32_bf16 v[72:75], v[204:207], v[240:243], v[72:75]
    v_add_f32 v249, 0x3727c5ac, v249
    v_mfma_f32_16x16x32_bf16 v[76:79], v[208:211], v[240:243], v[76:79]
    v_add_f32 v251, 0x3727c5ac, v251
    v_mfma_f32_16x16x32_bf16 v[80:83], v[204:207], v[244:247], v[80:83]
    v_rsq_f32 v249, v249
    v_mfma_f32_16x16x32_bf16 v[84:87], v[208:211], v[244:247], v[84:87]
    v_rsq_f32 v251, v251
    s_nop 0
    s_waitcnt lgkmcnt(5)
    v_mfma_f32_16x16x32_bf16 v[16:19], v[160:163], v[168:171], v[16:19]
    ds_read_b128 v[204:207], v0 offset:37888
    v_mfma_f32_16x16x32_bf16 v[20:23], v[164:167], v[168:171], v[20:23]
    ds_read_b128 v[208:211], v0 offset:39936
    v_mfma_f32_16x16x32_bf16 v[24:27], v[160:163], v[172:175], v[24:27]
    ds_read_b128 v[212:215], v2 offset:46080
    v_mfma_f32_16x16x32_bf16 v[28:31], v[164:167], v[172:175], v[28:31]
    ds_read_b128 v[216:219], v2 offset:47104
    v_mfma_f32_16x16x32_bf16 v[32:35], v[160:163], v[176:179], v[32:35]
    ds_read_b128 v[220:223], v2 offset:48128
    v_mfma_f32_16x16x32_bf16 v[36:39], v[164:167], v[176:179], v[36:39]
    ds_read_b128 v[224:227], v2 offset:49152
    v_mfma_f32_16x16x32_bf16 v[40:43], v[160:163], v[180:183], v[40:43]
    ds_read_b128 v[228:231], v2 offset:50176
    v_mfma_f32_16x16x32_bf16 v[44:47], v[164:167], v[180:183], v[44:47]
    ds_read_b128 v[232:235], v2 offset:51200
    s_waitcnt lgkmcnt(8)
    v_mfma_f32_16x16x32_bf16 v[48:51], v[160:163], v[184:187], v[48:51]
    ds_read_b128 v[236:239], v2 offset:52224
    v_mfma_f32_16x16x32_bf16 v[52:55], v[164:167], v[184:187], v[52:55]
    ds_read_b128 v[240:243], v2 offset:53248
    v_mfma_f32_16x16x32_bf16 v[56:59], v[160:163], v[188:191], v[56:59]
    ds_read_b128 v[244:247], v2 offset:54272
    v_mfma_f32_16x16x32_bf16 v[60:63], v[164:167], v[188:191], v[60:63]
    v_mfma_f32_16x16x32_bf16 v[64:67], v[160:163], v[192:195], v[64:67]
    v_mfma_f32_16x16x32_bf16 v[68:71], v[164:167], v[192:195], v[68:71]
    v_mfma_f32_16x16x32_bf16 v[72:75], v[160:163], v[196:199], v[72:75]
    v_mfma_f32_16x16x32_bf16 v[76:79], v[164:167], v[196:199], v[76:79]
    v_mfma_f32_16x16x32_bf16 v[80:83], v[160:163], v[200:203], v[80:83]
    v_mfma_f32_16x16x32_bf16 v[84:87], v[164:167], v[200:203], v[84:87]
    s_waitcnt lgkmcnt(0)
    s_barrier
    v_mfma_f32_16x16x32_bf16 v[16:19], v[204:207], v[212:215], v[16:19]
    ds_read_b128 v[160:163], v3 offset:0
    v_mfma_f32_16x16x32_bf16 v[20:23], v[208:211], v[212:215], v[20:23]
    ds_read_b128 v[164:167], v3 offset:2048
    v_mfma_f32_16x16x32_bf16 v[24:27], v[204:207], v[216:219], v[24:27]
    ds_read_b128 v[168:171], v1 offset:0
    v_mfma_f32_16x16x32_bf16 v[28:31], v[208:211], v[216:219], v[28:31]
    ds_read_b128 v[172:175], v1 offset:1024
    v_mfma_f32_16x16x32_bf16 v[32:35], v[204:207], v[220:223], v[32:35]
    ds_read_b128 v[176:179], v1 offset:2048
    v_mfma_f32_16x16x32_bf16 v[36:39], v[208:211], v[220:223], v[36:39]
    ds_read_b128 v[180:183], v1 offset:3072
    v_mfma_f32_16x16x32_bf16 v[40:43], v[204:207], v[224:227], v[40:43]
    ds_read_b128 v[184:187], v1 offset:4096
    v_mfma_f32_16x16x32_bf16 v[44:47], v[208:211], v[224:227], v[44:47]
    ds_read_b128 v[188:191], v1 offset:5120
    v_mfma_f32_16x16x32_bf16 v[48:51], v[204:207], v[228:231], v[48:51]
    ds_read_b128 v[192:195], v1 offset:6144
    v_mfma_f32_16x16x32_bf16 v[52:55], v[208:211], v[228:231], v[52:55]
    ds_read_b128 v[196:199], v1 offset:7168
    v_mfma_f32_16x16x32_bf16 v[56:59], v[204:207], v[232:235], v[56:59]
    ds_read_b128 v[200:203], v1 offset:8192
    v_mfma_f32_16x16x32_bf16 v[60:63], v[208:211], v[232:235], v[60:63]
    ds_write2_b32 v4, v248, v249 offset0:0 offset1:32
    v_mfma_f32_16x16x32_bf16 v[64:67], v[204:207], v[236:239], v[64:67]
    ds_write2_b32 v4, v250, v251 offset0:16 offset1:48
    v_mfma_f32_16x16x32_bf16 v[68:71], v[208:211], v[236:239], v[68:71]
    ds_read_b128 v[88:91], v252 offset:0
    v_mfma_f32_16x16x32_bf16 v[72:75], v[204:207], v[240:243], v[72:75]
    ds_read_b128 v[92:95], v252 offset:64
    v_mfma_f32_16x16x32_bf16 v[76:79], v[208:211], v[240:243], v[76:79]
    ds_read_b128 v[96:99], v252 offset:128
    v_mfma_f32_16x16x32_bf16 v[80:83], v[204:207], v[244:247], v[80:83]
    ds_read_b128 v[100:103], v252 offset:192
    v_mfma_f32_16x16x32_bf16 v[84:87], v[208:211], v[244:247], v[84:87]
    s_waitcnt lgkmcnt(11)
    v_mfma_f32_16x16x32_bf16 v[16:19], v[160:163], v[168:171], v[16:19]
    ds_read_b128 v[204:207], v3 offset:1024
    v_mfma_f32_16x16x32_bf16 v[20:23], v[164:167], v[168:171], v[20:23]
    ds_read_b128 v[208:211], v3 offset:3072
    v_mfma_f32_16x16x32_bf16 v[24:27], v[160:163], v[172:175], v[24:27]
    ds_read_b128 v[212:215], v1 offset:9216
    v_mfma_f32_16x16x32_bf16 v[28:31], v[164:167], v[172:175], v[28:31]
    ds_read_b128 v[216:219], v1 offset:10240
    v_mfma_f32_16x16x32_bf16 v[32:35], v[160:163], v[176:179], v[32:35]
    ds_read_b128 v[220:223], v1 offset:11264
    v_mfma_f32_16x16x32_bf16 v[36:39], v[164:167], v[176:179], v[36:39]
    ds_read_b128 v[224:227], v1 offset:12288
    v_mfma_f32_16x16x32_bf16 v[40:43], v[160:163], v[180:183], v[40:43]
    ds_read_b128 v[228:231], v1 offset:13312
    v_mfma_f32_16x16x32_bf16 v[44:47], v[164:167], v[180:183], v[44:47]
    ds_read_b128 v[232:235], v1 offset:14336
    s_waitcnt lgkmcnt(8)
    v_mfma_f32_16x16x32_bf16 v[48:51], v[160:163], v[184:187], v[48:51]
    ds_read_b128 v[236:239], v1 offset:15360
    v_mfma_f32_16x16x32_bf16 v[52:55], v[164:167], v[184:187], v[52:55]
    ds_read_b128 v[240:243], v1 offset:16384
    v_rcp_f32 v120, v96
    v_mfma_f32_16x16x32_bf16 v[56:59], v[160:163], v[188:191], v[56:59]
    ds_read_b128 v[244:247], v1 offset:17408
    v_mul_f32 v104, s40, v96
    v_mfma_f32_16x16x32_bf16 v[60:63], v[164:167], v[188:191], v[60:63]
    v_mul_f32 v112, v96, v96
    v_mfma_f32_16x16x32_bf16 v[64:67], v[160:163], v[192:195], v[64:67]
    v_rcp_f32 v121, v97
    v_mfma_f32_16x16x32_bf16 v[68:71], v[164:167], v[192:195], v[68:71]
    v_mul_f32 v105, s40, v97
    v_mfma_f32_16x16x32_bf16 v[72:75], v[160:163], v[196:199], v[72:75]
    v_mul_f32 v113, v97, v97
    v_mfma_f32_16x16x32_bf16 v[76:79], v[164:167], v[196:199], v[76:79]
    v_rcp_f32 v122, v98
    v_mfma_f32_16x16x32_bf16 v[80:83], v[160:163], v[200:203], v[80:83]
    v_mul_f32 v106, s40, v98
    v_mfma_f32_16x16x32_bf16 v[84:87], v[164:167], v[200:203], v[84:87]
    v_mul_f32 v114, v98, v98
    v_rcp_f32 v123, v99
    s_waitcnt lgkmcnt(0)
    s_barrier
    v_mfma_f32_16x16x32_bf16 v[16:19], v[204:207], v[212:215], v[16:19]
    ds_read_b128 v[160:163], v3 offset:36864
    v_mfma_f32_16x16x32_bf16 v[20:23], v[208:211], v[212:215], v[20:23]
    ds_read_b128 v[164:167], v3 offset:38912
    v_mfma_f32_16x16x32_bf16 v[24:27], v[204:207], v[216:219], v[24:27]
    ds_read_b128 v[168:171], v1 offset:36864
    v_mfma_f32_16x16x32_bf16 v[28:31], v[208:211], v[216:219], v[28:31]
    ds_read_b128 v[172:175], v1 offset:37888
    v_mfma_f32_16x16x32_bf16 v[32:35], v[204:207], v[220:223], v[32:35]
    ds_read_b128 v[176:179], v1 offset:38912
    v_mfma_f32_16x16x32_bf16 v[36:39], v[208:211], v[220:223], v[36:39]
    ds_read_b128 v[180:183], v1 offset:39936
    v_mfma_f32_16x16x32_bf16 v[40:43], v[204:207], v[224:227], v[40:43]
    ds_read_b128 v[184:187], v1 offset:40960
    v_mfma_f32_16x16x32_bf16 v[44:47], v[208:211], v[224:227], v[44:47]
    ds_read_b128 v[188:191], v1 offset:41984
    v_mfma_f32_16x16x32_bf16 v[48:51], v[204:207], v[228:231], v[48:51]
    ds_read_b128 v[192:195], v1 offset:43008
    v_mfma_f32_16x16x32_bf16 v[52:55], v[208:211], v[228:231], v[52:55]
    ds_read_b128 v[196:199], v1 offset:44032
    v_mul_f32 v107, s40, v99
    v_mfma_f32_16x16x32_bf16 v[56:59], v[204:207], v[232:235], v[56:59]
    ds_read_b128 v[200:203], v1 offset:45056
    v_mul_f32 v115, v99, v99
    v_mfma_f32_16x16x32_bf16 v[60:63], v[208:211], v[232:235], v[60:63]
    v_rcp_f32 v124, v100
    v_mfma_f32_16x16x32_bf16 v[64:67], v[204:207], v[236:239], v[64:67]
    v_mul_f32 v108, s40, v100
    v_mfma_f32_16x16x32_bf16 v[68:71], v[208:211], v[236:239], v[68:71]
    v_mul_f32 v116, v100, v100
    v_mfma_f32_16x16x32_bf16 v[72:75], v[204:207], v[240:243], v[72:75]
    v_rcp_f32 v125, v101
    v_mfma_f32_16x16x32_bf16 v[76:79], v[208:211], v[240:243], v[76:79]
    v_mul_f32 v109, s40, v101
    v_mfma_f32_16x16x32_bf16 v[80:83], v[204:207], v[244:247], v[80:83]
    v_mul_f32 v117, v101, v101
    v_mfma_f32_16x16x32_bf16 v[84:87], v[208:211], v[244:247], v[84:87]
    v_rcp_f32 v126, v102
    v_mul_f32 v110, s40, v102
    s_waitcnt lgkmcnt(5)
    v_mfma_f32_16x16x32_bf16 v[16:19], v[160:163], v[168:171], v[16:19]
    ds_read_b128 v[204:207], v3 offset:37888
    v_mfma_f32_16x16x32_bf16 v[20:23], v[164:167], v[168:171], v[20:23]
    ds_read_b128 v[208:211], v3 offset:39936
    v_mfma_f32_16x16x32_bf16 v[24:27], v[160:163], v[172:175], v[24:27]
    ds_read_b128 v[212:215], v1 offset:46080
    v_mfma_f32_16x16x32_bf16 v[28:31], v[164:167], v[172:175], v[28:31]
    ds_read_b128 v[216:219], v1 offset:47104
    v_mfma_f32_16x16x32_bf16 v[32:35], v[160:163], v[176:179], v[32:35]
    ds_read_b128 v[220:223], v1 offset:48128
    v_mfma_f32_16x16x32_bf16 v[36:39], v[164:167], v[176:179], v[36:39]
    ds_read_b128 v[224:227], v1 offset:49152
    v_mfma_f32_16x16x32_bf16 v[40:43], v[160:163], v[180:183], v[40:43]
    ds_read_b128 v[228:231], v1 offset:50176
    v_mfma_f32_16x16x32_bf16 v[44:47], v[164:167], v[180:183], v[44:47]
    ds_read_b128 v[232:235], v1 offset:51200
    s_waitcnt lgkmcnt(8)
    v_mfma_f32_16x16x32_bf16 v[48:51], v[160:163], v[184:187], v[48:51]
    ds_read_b128 v[236:239], v1 offset:52224
    v_mfma_f32_16x16x32_bf16 v[52:55], v[164:167], v[184:187], v[52:55]
    ds_read_b128 v[240:243], v1 offset:53248
    v_mul_f32 v118, v102, v102
    v_mfma_f32_16x16x32_bf16 v[56:59], v[160:163], v[188:191], v[56:59]
    ds_read_b128 v[244:247], v1 offset:54272
    v_rcp_f32 v127, v103
    v_mfma_f32_16x16x32_bf16 v[60:63], v[164:167], v[188:191], v[60:63]
    v_mul_f32 v111, s40, v103
    v_mfma_f32_16x16x32_bf16 v[64:67], v[160:163], v[192:195], v[64:67]
    v_mul_f32 v119, v103, v103
    v_mfma_f32_16x16x32_bf16 v[68:71], v[164:167], v[192:195], v[68:71]
    v_mul_f32 v112, s42, v112
    v_mfma_f32_16x16x32_bf16 v[72:75], v[160:163], v[196:199], v[72:75]
    v_mul_f32 v113, s42, v113
    v_mfma_f32_16x16x32_bf16 v[76:79], v[164:167], v[196:199], v[76:79]
    v_mul_f32 v114, s42, v114
    v_mfma_f32_16x16x32_bf16 v[80:83], v[160:163], v[200:203], v[80:83]
    v_mul_f32 v115, s42, v115
    v_mfma_f32_16x16x32_bf16 v[84:87], v[164:167], v[200:203], v[84:87]
    v_mul_f32 v116, s42, v116
    v_mul_f32 v117, s42, v117
    s_waitcnt lgkmcnt(0)
    s_barrier
    v_mfma_f32_16x16x32_bf16 v[16:19], v[204:207], v[212:215], v[16:19]
    ds_read_b128 v[160:163], v0 offset:0
    v_mfma_f32_16x16x32_bf16 v[20:23], v[208:211], v[212:215], v[20:23]
    ds_read_b128 v[164:167], v0 offset:2048
    v_mfma_f32_16x16x32_bf16 v[24:27], v[204:207], v[216:219], v[24:27]
    ds_read_b128 v[168:171], v2 offset:0
    v_mfma_f32_16x16x32_bf16 v[28:31], v[208:211], v[216:219], v[28:31]
    ds_read_b128 v[172:175], v2 offset:1024
    v_mfma_f32_16x16x32_bf16 v[32:35], v[204:207], v[220:223], v[32:35]
    ds_read_b128 v[176:179], v2 offset:2048
    v_mfma_f32_16x16x32_bf16 v[36:39], v[208:211], v[220:223], v[36:39]
    ds_read_b128 v[180:183], v2 offset:3072
    v_mfma_f32_16x16x32_bf16 v[40:43], v[204:207], v[224:227], v[40:43]
    ds_read_b128 v[184:187], v2 offset:4096
    v_mfma_f32_16x16x32_bf16 v[44:47], v[208:211], v[224:227], v[44:47]
    ds_read_b128 v[188:191], v2 offset:5120
    v_mfma_f32_16x16x32_bf16 v[48:51], v[204:207], v[228:231], v[48:51]
    ds_read_b128 v[192:195], v2 offset:6144
    v_mfma_f32_16x16x32_bf16 v[52:55], v[208:211], v[228:231], v[52:55]
    ds_read_b128 v[196:199], v2 offset:7168
    v_mul_f32 v118, s42, v118
    v_mfma_f32_16x16x32_bf16 v[56:59], v[204:207], v[232:235], v[56:59]
    ds_read_b128 v[200:203], v2 offset:8192
    v_mul_f32 v119, s42, v119
    v_mfma_f32_16x16x32_bf16 v[60:63], v[208:211], v[232:235], v[60:63]
    v_mul_f32 v112, v112, v104
    v_mfma_f32_16x16x32_bf16 v[64:67], v[204:207], v[236:239], v[64:67]
    v_mul_f32 v113, v113, v105
    v_mfma_f32_16x16x32_bf16 v[68:71], v[208:211], v[236:239], v[68:71]
    v_mul_f32 v114, v114, v106
    v_mfma_f32_16x16x32_bf16 v[72:75], v[204:207], v[240:243], v[72:75]
    v_mul_f32 v115, v115, v107
    v_mfma_f32_16x16x32_bf16 v[76:79], v[208:211], v[240:243], v[76:79]
    v_mul_f32 v116, v116, v108
    v_mfma_f32_16x16x32_bf16 v[80:83], v[204:207], v[244:247], v[80:83]
    v_mul_f32 v117, v117, v109
    v_mfma_f32_16x16x32_bf16 v[84:87], v[208:211], v[244:247], v[84:87]
    v_mul_f32 v118, v118, v110
    v_mul_f32 v119, v119, v111
    s_waitcnt lgkmcnt(5)
    v_mfma_f32_16x16x32_bf16 v[16:19], v[160:163], v[168:171], v[16:19]
    ds_read_b128 v[204:207], v0 offset:1024
    v_mfma_f32_16x16x32_bf16 v[20:23], v[164:167], v[168:171], v[20:23]
    ds_read_b128 v[208:211], v0 offset:3072
    v_mfma_f32_16x16x32_bf16 v[24:27], v[160:163], v[172:175], v[24:27]
    ds_read_b128 v[212:215], v2 offset:9216
    v_mfma_f32_16x16x32_bf16 v[28:31], v[164:167], v[172:175], v[28:31]
    ds_read_b128 v[216:219], v2 offset:10240
    v_mfma_f32_16x16x32_bf16 v[32:35], v[160:163], v[176:179], v[32:35]
    ds_read_b128 v[220:223], v2 offset:11264
    v_mfma_f32_16x16x32_bf16 v[36:39], v[164:167], v[176:179], v[36:39]
    ds_read_b128 v[224:227], v2 offset:12288
    v_mfma_f32_16x16x32_bf16 v[40:43], v[160:163], v[180:183], v[40:43]
    ds_read_b128 v[228:231], v2 offset:13312
    v_mfma_f32_16x16x32_bf16 v[44:47], v[164:167], v[180:183], v[44:47]
    ds_read_b128 v[232:235], v2 offset:14336
    s_waitcnt lgkmcnt(8)
    v_mfma_f32_16x16x32_bf16 v[48:51], v[160:163], v[184:187], v[48:51]
    ds_read_b128 v[236:239], v2 offset:15360
    v_mfma_f32_16x16x32_bf16 v[52:55], v[164:167], v[184:187], v[52:55]
    ds_read_b128 v[240:243], v2 offset:16384
    v_lshrrev_b32 v8, 2, v6
    v_mfma_f32_16x16x32_bf16 v[56:59], v[160:163], v[188:191], v[56:59]
    ds_read_b128 v[244:247], v2 offset:17408
    v_lshlrev_b32 v8, 4, v8
    v_mfma_f32_16x16x32_bf16 v[60:63], v[164:167], v[188:191], v[60:63]
    v_lshl_add_u32 v8, v5, 6, v8
    v_mfma_f32_16x16x32_bf16 v[64:67], v[160:163], v[192:195], v[64:67]
    v_and_b32 v9, 3, v6
    v_mfma_f32_16x16x32_bf16 v[68:71], v[164:167], v[192:195], v[68:71]
    v_cmp_eq_u32 vcc, 0, v9
    v_mfma_f32_16x16x32_bf16 v[72:75], v[160:163], v[196:199], v[72:75]
    v_bfrev_b32 v10, 1
    v_mfma_f32_16x16x32_bf16 v[76:79], v[164:167], v[196:199], v[76:79]
    v_lshlrev_b32 v9, 4, v9
    v_mfma_f32_16x16x32_bf16 v[80:83], v[160:163], v[200:203], v[80:83]
    v_cndmask_b32 v8, v10, v8, vcc
    v_mfma_f32_16x16x32_bf16 v[84:87], v[164:167], v[200:203], v[84:87]
    v_lshl_add_u32 v9, v5, 6, v9
    v_lshrrev_b32 v255, 2, v6
    s_waitcnt lgkmcnt(0)
    s_barrier
    v_mfma_f32_16x16x32_bf16 v[16:19], v[204:207], v[212:215], v[16:19]
    ds_read_b128 v[160:163], v0 offset:36864
    v_fma_f32 v52, -v92, v132, v52
    v_mfma_f32_16x16x32_bf16 v[20:23], v[208:211], v[212:215], v[20:23]
    ds_read_b128 v[164:167], v0 offset:38912
    v_fma_f32 v56, -v88, v133, v56
    v_mfma_f32_16x16x32_bf16 v[24:27], v[204:207], v[216:219], v[24:27]
    ds_read_b128 v[168:171], v2 offset:36864
    v_fma_f32 v60, -v92, v133, v60
    v_mfma_f32_16x16x32_bf16 v[28:31], v[208:211], v[216:219], v[28:31]
    ds_read_b128 v[172:175], v2 offset:37888
    v_fma_f32 v64, -v88, v134, v64
    v_mfma_f32_16x16x32_bf16 v[32:35], v[204:207], v[220:223], v[32:35]
    ds_read_b128 v[176:179], v2 offset:38912
    v_fma_f32 v68, -v92, v134, v68
    v_mfma_f32_16x16x32_bf16 v[36:39], v[208:211], v[220:223], v[36:39]
    ds_read_b128 v[180:183], v2 offset:39936
    v_fma_f32 v72, -v88, v135, v72
    v_mfma_f32_16x16x32_bf16 v[40:43], v[204:207], v[224:227], v[40:43]
    ds_read_b128 v[184:187], v2 offset:40960
    v_fma_f32 v76, -v92, v135, v76
    v_mfma_f32_16x16x32_bf16 v[44:47], v[208:211], v[224:227], v[44:47]
    ds_read_b128 v[188:191], v2 offset:41984
    v_fma_f32 v80, -v88, v136, v80
    v_mfma_f32_16x16x32_bf16 v[48:51], v[204:207], v[228:231], v[48:51]
    ds_read_b128 v[192:195], v2 offset:43008
    v_fma_f32 v84, -v92, v136, v84
    v_mfma_f32_16x16x32_bf16 v[52:55], v[208:211], v[228:231], v[52:55]
    ds_read_b128 v[196:199], v2 offset:44032
    v_lshl_add_u32 v255, v255, 8, v9
    v_fma_f32 v16, -v88, v128, v16
    v_mfma_f32_16x16x32_bf16 v[56:59], v[204:207], v[232:235], v[56:59]
    ds_read_b128 v[200:203], v2 offset:45056
    v_fma_f32 v20, -v92, v128, v20
    v_mfma_f32_16x16x32_bf16 v[60:63], v[208:211], v[232:235], v[60:63]
    v_fma_f32 v24, -v88, v129, v24
    v_mfma_f32_16x16x32_bf16 v[64:67], v[204:207], v[236:239], v[64:67]
    v_fma_f32 v28, -v92, v129, v28
    v_mfma_f32_16x16x32_bf16 v[68:71], v[208:211], v[236:239], v[68:71]
    v_fma_f32 v32, -v88, v130, v32
    v_mfma_f32_16x16x32_bf16 v[72:75], v[204:207], v[240:243], v[72:75]
    v_fma_f32 v36, -v92, v130, v36
    v_mfma_f32_16x16x32_bf16 v[76:79], v[208:211], v[240:243], v[76:79]
    v_fma_f32 v40, -v88, v131, v40
    v_mfma_f32_16x16x32_bf16 v[80:83], v[204:207], v[244:247], v[80:83]
    v_fma_f32 v44, -v92, v131, v44
    v_mfma_f32_16x16x32_bf16 v[84:87], v[208:211], v[244:247], v[84:87]
    v_fma_f32 v48, -v88, v132, v48
    s_waitcnt lgkmcnt(5)
    v_mfma_f32_16x16x32_bf16 v[16:19], v[160:163], v[168:171], v[16:19]
    ds_read_b128 v[204:207], v0 offset:37888
    v_fma_f32 v53, -v93, v132, v53
    v_mfma_f32_16x16x32_bf16 v[20:23], v[164:167], v[168:171], v[20:23]
    ds_read_b128 v[208:211], v0 offset:39936
    v_fma_f32 v57, -v89, v133, v57
    v_mfma_f32_16x16x32_bf16 v[24:27], v[160:163], v[172:175], v[24:27]
    ds_read_b128 v[212:215], v2 offset:46080
    v_fma_f32 v61, -v93, v133, v61
    v_mfma_f32_16x16x32_bf16 v[28:31], v[164:167], v[172:175], v[28:31]
    ds_read_b128 v[216:219], v2 offset:47104
    v_fma_f32 v65, -v89, v134, v65
    v_mfma_f32_16x16x32_bf16 v[32:35], v[160:163], v[176:179], v[32:35]
    ds_read_b128 v[220:223], v2 offset:48128
    v_fma_f32 v69, -v93, v134, v69
    v_mfma_f32_16x16x32_bf16 v[36:39], v[164:167], v[176:179], v[36:39]
    ds_read_b128 v[224:227], v2 offset:49152
    v_fma_f32 v73, -v89, v135, v73
    v_mfma_f32_16x16x32_bf16 v[40:43], v[160:163], v[180:183], v[40:43]
    ds_read_b128 v[228:231], v2 offset:50176
    v_fma_f32 v77, -v93, v135, v77
    v_mfma_f32_16x16x32_bf16 v[44:47], v[164:167], v[180:183], v[44:47]
    ds_read_b128 v[232:235], v2 offset:51200
    s_waitcnt lgkmcnt(8)
    v_fma_f32 v81, -v89, v136, v81
    v_mfma_f32_16x16x32_bf16 v[48:51], v[160:163], v[184:187], v[48:51]
    ds_read_b128 v[236:239], v2 offset:52224
    v_fma_f32 v85, -v93, v136, v85
    v_mfma_f32_16x16x32_bf16 v[52:55], v[164:167], v[184:187], v[52:55]
    ds_read_b128 v[240:243], v2 offset:53248
    v_fma_f32 v17, -v89, v128, v17
    v_mfma_f32_16x16x32_bf16 v[56:59], v[160:163], v[188:191], v[56:59]
    ds_read_b128 v[244:247], v2 offset:54272
    v_fma_f32 v21, -v93, v128, v21
    v_mfma_f32_16x16x32_bf16 v[60:63], v[164:167], v[188:191], v[60:63]
    v_fma_f32 v25, -v89, v129, v25
    v_mfma_f32_16x16x32_bf16 v[64:67], v[160:163], v[192:195], v[64:67]
    v_fma_f32 v29, -v93, v129, v29
    v_mfma_f32_16x16x32_bf16 v[68:71], v[164:167], v[192:195], v[68:71]
    v_fma_f32 v33, -v89, v130, v33
    v_mfma_f32_16x16x32_bf16 v[72:75], v[160:163], v[196:199], v[72:75]
    v_fma_f32 v37, -v93, v130, v37
    v_mfma_f32_16x16x32_bf16 v[76:79], v[164:167], v[196:199], v[76:79]
    v_fma_f32 v41, -v89, v131, v41
    v_mfma_f32_16x16x32_bf16 v[80:83], v[160:163], v[200:203], v[80:83]
    v_fma_f32 v45, -v93, v131, v45
    v_mfma_f32_16x16x32_bf16 v[84:87], v[164:167], v[200:203], v[84:87]
    v_fma_f32 v49, -v89, v132, v49
    s_waitcnt lgkmcnt(0)
    s_barrier
    v_mfma_f32_16x16x32_bf16 v[16:19], v[204:207], v[212:215], v[16:19]
    ds_read_b128 v[160:163], v3 offset:0
    v_fma_f32 v54, -v94, v132, v54
    v_mfma_f32_16x16x32_bf16 v[20:23], v[208:211], v[212:215], v[20:23]
    ds_read_b128 v[164:167], v3 offset:2048
    v_fma_f32 v58, -v90, v133, v58
    v_mfma_f32_16x16x32_bf16 v[24:27], v[204:207], v[216:219], v[24:27]
    ds_read_b128 v[168:171], v1 offset:0
    v_fma_f32 v62, -v94, v133, v62
    v_mfma_f32_16x16x32_bf16 v[28:31], v[208:211], v[216:219], v[28:31]
    ds_read_b128 v[172:175], v1 offset:1024
    v_fma_f32 v66, -v90, v134, v66
    v_mfma_f32_16x16x32_bf16 v[32:35], v[204:207], v[220:223], v[32:35]
    ds_read_b128 v[176:179], v1 offset:2048
    v_fma_f32 v70, -v94, v134, v70
    v_mfma_f32_16x16x32_bf16 v[36:39], v[208:211], v[220:223], v[36:39]
    ds_read_b128 v[180:183], v1 offset:3072
    v_fma_f32 v74, -v90, v135, v74
    v_mfma_f32_16x16x32_bf16 v[40:43], v[204:207], v[224:227], v[40:43]
    ds_read_b128 v[184:187], v1 offset:4096
    v_fma_f32 v78, -v94, v135, v78
    v_mfma_f32_16x16x32_bf16 v[44:47], v[208:211], v[224:227], v[44:47]
    ds_read_b128 v[188:191], v1 offset:5120
    v_fma_f32 v82, -v90, v136, v82
    v_mfma_f32_16x16x32_bf16 v[48:51], v[204:207], v[228:231], v[48:51]
    ds_read_b128 v[192:195], v1 offset:6144
    v_fma_f32 v86, -v94, v136, v86
    v_mfma_f32_16x16x32_bf16 v[52:55], v[208:211], v[228:231], v[52:55]
    ds_read_b128 v[196:199], v1 offset:7168
    v_fma_f32 v18, -v90, v128, v18
    v_mfma_f32_16x16x32_bf16 v[56:59], v[204:207], v[232:235], v[56:59]
    ds_read_b128 v[200:203], v1 offset:8192
    v_fma_f32 v22, -v94, v128, v22
    v_mfma_f32_16x16x32_bf16 v[60:63], v[208:211], v[232:235], v[60:63]
    v_fma_f32 v26, -v90, v129, v26
    v_mfma_f32_16x16x32_bf16 v[64:67], v[204:207], v[236:239], v[64:67]
    v_fma_f32 v30, -v94, v129, v30
    v_mfma_f32_16x16x32_bf16 v[68:71], v[208:211], v[236:239], v[68:71]
    v_fma_f32 v34, -v90, v130, v34
    v_mfma_f32_16x16x32_bf16 v[72:75], v[204:207], v[240:243], v[72:75]
    v_fma_f32 v38, -v94, v130, v38
    v_mfma_f32_16x16x32_bf16 v[76:79], v[208:211], v[240:243], v[76:79]
    v_fma_f32 v42, -v90, v131, v42
    v_mfma_f32_16x16x32_bf16 v[80:83], v[204:207], v[244:247], v[80:83]
    v_fma_f32 v46, -v94, v131, v46
    v_mfma_f32_16x16x32_bf16 v[84:87], v[208:211], v[244:247], v[84:87]
    v_fma_f32 v50, -v90, v132, v50
    s_waitcnt lgkmcnt(5)
    v_mfma_f32_16x16x32_bf16 v[16:19], v[160:163], v[168:171], v[16:19]
    ds_read_b128 v[204:207], v3 offset:1024
    v_fma_f32 v55, -v95, v132, v55
    v_mfma_f32_16x16x32_bf16 v[20:23], v[164:167], v[168:171], v[20:23]
    ds_read_b128 v[208:211], v3 offset:3072
    v_fma_f32 v59, -v91, v133, v59
    v_mfma_f32_16x16x32_bf16 v[24:27], v[160:163], v[172:175], v[24:27]
    ds_read_b128 v[212:215], v1 offset:9216
    v_fma_f32 v63, -v95, v133, v63
    v_mfma_f32_16x16x32_bf16 v[28:31], v[164:167], v[172:175], v[28:31]
    ds_read_b128 v[216:219], v1 offset:10240
    v_fma_f32 v67, -v91, v134, v67
    v_mfma_f32_16x16x32_bf16 v[32:35], v[160:163], v[176:179], v[32:35]
    ds_read_b128 v[220:223], v1 offset:11264
    v_fma_f32 v71, -v95, v134, v71
    v_mfma_f32_16x16x32_bf16 v[36:39], v[164:167], v[176:179], v[36:39]
    ds_read_b128 v[224:227], v1 offset:12288
    v_fma_f32 v75, -v91, v135, v75
    v_mfma_f32_16x16x32_bf16 v[40:43], v[160:163], v[180:183], v[40:43]
    ds_read_b128 v[228:231], v1 offset:13312
    v_fma_f32 v79, -v95, v135, v79
    v_mfma_f32_16x16x32_bf16 v[44:47], v[164:167], v[180:183], v[44:47]
    ds_read_b128 v[232:235], v1 offset:14336
    s_waitcnt lgkmcnt(8)
    v_fma_f32 v83, -v91, v136, v83
    v_mfma_f32_16x16x32_bf16 v[48:51], v[160:163], v[184:187], v[48:51]
    ds_read_b128 v[236:239], v1 offset:15360
    v_fma_f32 v87, -v95, v136, v87
    v_mfma_f32_16x16x32_bf16 v[52:55], v[164:167], v[184:187], v[52:55]
    ds_read_b128 v[240:243], v1 offset:16384
    v_fma_f32 v19, -v91, v128, v19
    v_mfma_f32_16x16x32_bf16 v[56:59], v[160:163], v[188:191], v[56:59]
    ds_read_b128 v[244:247], v1 offset:17408
    v_fma_f32 v23, -v95, v128, v23
    v_mfma_f32_16x16x32_bf16 v[60:63], v[164:167], v[188:191], v[60:63]
    v_fma_f32 v27, -v91, v129, v27
    v_mfma_f32_16x16x32_bf16 v[64:67], v[160:163], v[192:195], v[64:67]
    v_fma_f32 v31, -v95, v129, v31
    v_mfma_f32_16x16x32_bf16 v[68:71], v[164:167], v[192:195], v[68:71]
    v_fma_f32 v35, -v91, v130, v35
    v_mfma_f32_16x16x32_bf16 v[72:75], v[160:163], v[196:199], v[72:75]
    v_fma_f32 v39, -v95, v130, v39
    v_mfma_f32_16x16x32_bf16 v[76:79], v[164:167], v[196:199], v[76:79]
    v_fma_f32 v43, -v91, v131, v43
    v_mfma_f32_16x16x32_bf16 v[80:83], v[160:163], v[200:203], v[80:83]
    v_fma_f32 v47, -v95, v131, v47
    v_mfma_f32_16x16x32_bf16 v[84:87], v[164:167], v[200:203], v[84:87]
    v_fma_f32 v51, -v91, v132, v51
    s_waitcnt lgkmcnt(0)
    s_barrier
    v_mfma_f32_16x16x32_bf16 v[16:19], v[204:207], v[212:215], v[16:19]
    ds_read_b128 v[160:163], v3 offset:36864
    v_mfma_f32_16x16x32_bf16 v[20:23], v[208:211], v[212:215], v[20:23]
    ds_read_b128 v[164:167], v3 offset:38912
    v_mfma_f32_16x16x32_bf16 v[24:27], v[204:207], v[216:219], v[24:27]
    ds_read_b128 v[168:171], v1 offset:36864
    v_mfma_f32_16x16x32_bf16 v[28:31], v[208:211], v[216:219], v[28:31]
    ds_read_b128 v[172:175], v1 offset:37888
    v_mfma_f32_16x16x32_bf16 v[32:35], v[204:207], v[220:223], v[32:35]
    ds_read_b128 v[176:179], v1 offset:38912
    v_mfma_f32_16x16x32_bf16 v[36:39], v[208:211], v[220:223], v[36:39]
    ds_read_b128 v[180:183], v1 offset:39936
    v_mfma_f32_16x16x32_bf16 v[40:43], v[204:207], v[224:227], v[40:43]
    ds_read_b128 v[184:187], v1 offset:40960
    v_mfma_f32_16x16x32_bf16 v[44:47], v[208:211], v[224:227], v[44:47]
    ds_read_b128 v[188:191], v1 offset:41984
    v_mfma_f32_16x16x32_bf16 v[48:51], v[204:207], v[228:231], v[48:51]
    ds_read_b128 v[192:195], v1 offset:43008
    v_mfma_f32_16x16x32_bf16 v[52:55], v[208:211], v[228:231], v[52:55]
    ds_read_b128 v[196:199], v1 offset:44032
    v_mfma_f32_16x16x32_bf16 v[56:59], v[204:207], v[232:235], v[56:59]
    ds_read_b128 v[200:203], v1 offset:45056
    v_mfma_f32_16x16x32_bf16 v[60:63], v[208:211], v[232:235], v[60:63]
    v_mfma_f32_16x16x32_bf16 v[64:67], v[204:207], v[236:239], v[64:67]
    v_mfma_f32_16x16x32_bf16 v[68:71], v[208:211], v[236:239], v[68:71]
    v_mfma_f32_16x16x32_bf16 v[72:75], v[204:207], v[240:243], v[72:75]
    v_mfma_f32_16x16x32_bf16 v[76:79], v[208:211], v[240:243], v[76:79]
    v_mfma_f32_16x16x32_bf16 v[80:83], v[204:207], v[244:247], v[80:83]
    v_mfma_f32_16x16x32_bf16 v[84:87], v[208:211], v[244:247], v[84:87]
    v_pk_mul_f32 v[220:221], v[16:17], v[16:17]
    v_pk_mul_f32 v[222:223], v[18:19], v[18:19]
    v_pk_mul_f32 v[224:225], v[20:21], v[20:21]
    v_pk_mul_f32 v[226:227], v[22:23], v[22:23]
    v_pk_fma_f32 v[220:221], v[220:221], v[112:113], v[104:105]
    v_pk_fma_f32 v[222:223], v[222:223], v[114:115], v[106:107]
    v_pk_fma_f32 v[224:225], v[224:225], v[116:117], v[108:109]
    v_pk_fma_f32 v[226:227], v[226:227], v[118:119], v[110:111]
    v_pk_mul_f32 v[220:221], v[220:221], v[16:17]
    v_pk_mul_f32 v[222:223], v[222:223], v[18:19]
    v_pk_mul_f32 v[224:225], v[224:225], v[20:21]
    v_pk_mul_f32 v[226:227], v[226:227], v[22:23]
    v_exp_f32 v220, v220
    v_exp_f32 v221, v221
    v_exp_f32 v222, v222
    v_exp_f32 v223, v223
    v_exp_f32 v224, v224
    v_exp_f32 v225, v225
    v_exp_f32 v226, v226
    v_exp_f32 v227, v227
    v_pk_fma_f32 v[220:221], v[220:221], v[120:121], v[120:121]
    v_pk_fma_f32 v[222:223], v[222:223], v[122:123], v[122:123]
    v_pk_fma_f32 v[224:225], v[224:225], v[124:125], v[124:125]
    v_pk_fma_f32 v[226:227], v[226:227], v[126:127], v[126:127]
    v_rcp_f32 v220, v220
    v_rcp_f32 v221, v221
    v_rcp_f32 v222, v222
    v_rcp_f32 v223, v223
    v_rcp_f32 v224, v224
    v_rcp_f32 v225, v225
    v_rcp_f32 v226, v226
    v_rcp_f32 v227, v227
    v_pk_mul_f32 v[16:17], v[16:17], v[220:221]
    v_pk_mul_f32 v[18:19], v[18:19], v[222:223]
    v_pk_mul_f32 v[20:21], v[20:21], v[224:225]
    v_pk_mul_f32 v[22:23], v[22:23], v[226:227]
    v_pk_mul_f32 v[206:207], v[16:17], v[16:17]
    v_pk_mul_f32 v[210:211], v[18:19], v[18:19]
    v_pk_mul_f32 v[214:215], v[20:21], v[20:21]
    v_pk_mul_f32 v[218:219], v[22:23], v[22:23]
    v_pk_mul_f32 v[228:229], v[24:25], v[24:25]
    v_pk_mul_f32 v[230:231], v[26:27], v[26:27]
    v_pk_mul_f32 v[232:233], v[28:29], v[28:29]
    v_pk_mul_f32 v[234:235], v[30:31], v[30:31]
    v_pk_fma_f32 v[228:229], v[228:229], v[112:113], v[104:105]
    v_pk_fma_f32 v[230:231], v[230:231], v[114:115], v[106:107]
    v_pk_fma_f32 v[232:233], v[232:233], v[116:117], v[108:109]
    v_pk_fma_f32 v[234:235], v[234:235], v[118:119], v[110:111]
    v_pk_mul_f32 v[228:229], v[228:229], v[24:25]
    v_pk_mul_f32 v[230:231], v[230:231], v[26:27]
    v_pk_mul_f32 v[232:233], v[232:233], v[28:29]
    v_pk_mul_f32 v[234:235], v[234:235], v[30:31]
    v_exp_f32 v228, v228
    v_exp_f32 v229, v229
    v_exp_f32 v230, v230
    v_exp_f32 v231, v231
    v_exp_f32 v232, v232
    v_exp_f32 v233, v233
    v_exp_f32 v234, v234
    v_exp_f32 v235, v235
    v_pk_fma_f32 v[228:229], v[228:229], v[120:121], v[120:121]
    v_pk_fma_f32 v[230:231], v[230:231], v[122:123], v[122:123]
    v_pk_fma_f32 v[232:233], v[232:233], v[124:125], v[124:125]
    v_pk_fma_f32 v[234:235], v[234:235], v[126:127], v[126:127]
    v_rcp_f32 v228, v228
    v_rcp_f32 v229, v229
    v_rcp_f32 v230, v230
    v_rcp_f32 v231, v231
    v_rcp_f32 v232, v232
    v_rcp_f32 v233, v233
    v_rcp_f32 v234, v234
    v_rcp_f32 v235, v235
    v_pk_mul_f32 v[24:25], v[24:25], v[228:229]
    v_pk_mul_f32 v[26:27], v[26:27], v[230:231]
    v_pk_mul_f32 v[28:29], v[28:29], v[232:233]
    v_pk_mul_f32 v[30:31], v[30:31], v[234:235]
    v_pk_add_f32 v[204:205], v[16:17], v[24:25]
    v_pk_fma_f32 v[206:207], v[24:25], v[24:25], v[206:207]
    v_pk_add_f32 v[208:209], v[18:19], v[26:27]
    v_pk_fma_f32 v[210:211], v[26:27], v[26:27], v[210:211]
    v_pk_add_f32 v[212:213], v[20:21], v[28:29]
    v_pk_fma_f32 v[214:215], v[28:29], v[28:29], v[214:215]
    v_pk_add_f32 v[216:217], v[22:23], v[30:31]
    v_pk_fma_f32 v[218:219], v[30:31], v[30:31], v[218:219]
    v_pk_mul_f32 v[220:221], v[32:33], v[32:33]
    v_pk_mul_f32 v[222:223], v[34:35], v[34:35]
    v_pk_mul_f32 v[224:225], v[36:37], v[36:37]
    v_pk_mul_f32 v[226:227], v[38:39], v[38:39]
    v_pk_fma_f32 v[220:221], v[220:221], v[112:113], v[104:105]
    v_pk_fma_f32 v[222:223], v[222:223], v[114:115], v[106:107]
    v_pk_fma_f32 v[224:225], v[224:225], v[116:117], v[108:109]
    v_pk_fma_f32 v[226:227], v[226:227], v[118:119], v[110:111]
    v_pk_mul_f32 v[220:221], v[220:221], v[32:33]
    v_pk_mul_f32 v[222:223], v[222:223], v[34:35]
    v_pk_mul_f32 v[224:225], v[224:225], v[36:37]
    v_pk_mul_f32 v[226:227], v[226:227], v[38:39]
    v_exp_f32 v220, v220
    v_exp_f32 v221, v221
    v_exp_f32 v222, v222
    v_exp_f32 v223, v223
    v_exp_f32 v224, v224
    v_exp_f32 v225, v225
    v_exp_f32 v226, v226
    v_exp_f32 v227, v227
    v_pk_fma_f32 v[220:221], v[220:221], v[120:121], v[120:121]
    v_pk_fma_f32 v[222:223], v[222:223], v[122:123], v[122:123]
    v_pk_fma_f32 v[224:225], v[224:225], v[124:125], v[124:125]
    v_pk_fma_f32 v[226:227], v[226:227], v[126:127], v[126:127]
    v_rcp_f32 v220, v220
    v_rcp_f32 v221, v221
    v_rcp_f32 v222, v222
    v_rcp_f32 v223, v223
    v_rcp_f32 v224, v224
    v_rcp_f32 v225, v225
    v_rcp_f32 v226, v226
    v_rcp_f32 v227, v227
    v_pk_mul_f32 v[32:33], v[32:33], v[220:221]
    v_pk_mul_f32 v[34:35], v[34:35], v[222:223]
    v_pk_mul_f32 v[36:37], v[36:37], v[224:225]
    v_pk_mul_f32 v[38:39], v[38:39], v[226:227]
    v_pk_add_f32 v[204:205], v[204:205], v[32:33]
    v_pk_fma_f32 v[206:207], v[32:33], v[32:33], v[206:207]
    v_pk_add_f32 v[208:209], v[208:209], v[34:35]
    v_pk_fma_f32 v[210:211], v[34:35], v[34:35], v[210:211]
    v_pk_add_f32 v[212:213], v[212:213], v[36:37]
    v_pk_fma_f32 v[214:215], v[36:37], v[36:37], v[214:215]
    v_pk_add_f32 v[216:217], v[216:217], v[38:39]
    v_pk_fma_f32 v[218:219], v[38:39], v[38:39], v[218:219]
    v_pk_mul_f32 v[228:229], v[40:41], v[40:41]
    v_pk_mul_f32 v[230:231], v[42:43], v[42:43]
    v_pk_mul_f32 v[232:233], v[44:45], v[44:45]
    v_pk_mul_f32 v[234:235], v[46:47], v[46:47]
    v_pk_fma_f32 v[228:229], v[228:229], v[112:113], v[104:105]
    v_pk_fma_f32 v[230:231], v[230:231], v[114:115], v[106:107]
    v_pk_fma_f32 v[232:233], v[232:233], v[116:117], v[108:109]
    v_pk_fma_f32 v[234:235], v[234:235], v[118:119], v[110:111]
    v_pk_mul_f32 v[228:229], v[228:229], v[40:41]
    v_pk_mul_f32 v[230:231], v[230:231], v[42:43]
    v_pk_mul_f32 v[232:233], v[232:233], v[44:45]
    v_pk_mul_f32 v[234:235], v[234:235], v[46:47]
    v_exp_f32 v228, v228
    v_exp_f32 v229, v229
    v_exp_f32 v230, v230
    v_exp_f32 v231, v231
    v_exp_f32 v232, v232
    v_exp_f32 v233, v233
    v_exp_f32 v234, v234
    v_exp_f32 v235, v235
    v_pk_fma_f32 v[228:229], v[228:229], v[120:121], v[120:121]
    v_pk_fma_f32 v[230:231], v[230:231], v[122:123], v[122:123]
    v_pk_fma_f32 v[232:233], v[232:233], v[124:125], v[124:125]
    v_pk_fma_f32 v[234:235], v[234:235], v[126:127], v[126:127]
    v_rcp_f32 v228, v228
    v_rcp_f32 v229, v229
    v_rcp_f32 v230, v230
    v_rcp_f32 v231, v231
    v_rcp_f32 v232, v232
    v_rcp_f32 v233, v233
    v_rcp_f32 v234, v234
    v_rcp_f32 v235, v235
    v_pk_mul_f32 v[40:41], v[40:41], v[228:229]
    v_pk_mul_f32 v[42:43], v[42:43], v[230:231]
    v_pk_mul_f32 v[44:45], v[44:45], v[232:233]
    v_pk_mul_f32 v[46:47], v[46:47], v[234:235]
    v_pk_add_f32 v[204:205], v[204:205], v[40:41]
    v_pk_fma_f32 v[206:207], v[40:41], v[40:41], v[206:207]
    v_pk_add_f32 v[208:209], v[208:209], v[42:43]
    v_pk_fma_f32 v[210:211], v[42:43], v[42:43], v[210:211]
    v_pk_add_f32 v[212:213], v[212:213], v[44:45]
    v_pk_fma_f32 v[214:215], v[44:45], v[44:45], v[214:215]
    v_pk_add_f32 v[216:217], v[216:217], v[46:47]
    v_pk_fma_f32 v[218:219], v[46:47], v[46:47], v[218:219]
    v_pk_mul_f32 v[220:221], v[48:49], v[48:49]
    v_pk_mul_f32 v[222:223], v[50:51], v[50:51]
    v_pk_mul_f32 v[224:225], v[52:53], v[52:53]
    v_pk_mul_f32 v[226:227], v[54:55], v[54:55]
    v_pk_fma_f32 v[220:221], v[220:221], v[112:113], v[104:105]
    v_pk_fma_f32 v[222:223], v[222:223], v[114:115], v[106:107]
    v_pk_fma_f32 v[224:225], v[224:225], v[116:117], v[108:109]
    v_pk_fma_f32 v[226:227], v[226:227], v[118:119], v[110:111]
    v_pk_mul_f32 v[220:221], v[220:221], v[48:49]
    v_pk_mul_f32 v[222:223], v[222:223], v[50:51]
    v_pk_mul_f32 v[224:225], v[224:225], v[52:53]
    v_pk_mul_f32 v[226:227], v[226:227], v[54:55]
    v_exp_f32 v220, v220
    v_exp_f32 v221, v221
    v_exp_f32 v222, v222
    v_exp_f32 v223, v223
    v_exp_f32 v224, v224
    v_exp_f32 v225, v225
    v_exp_f32 v226, v226
    v_exp_f32 v227, v227
    v_pk_fma_f32 v[220:221], v[220:221], v[120:121], v[120:121]
    v_pk_fma_f32 v[222:223], v[222:223], v[122:123], v[122:123]
    v_pk_fma_f32 v[224:225], v[224:225], v[124:125], v[124:125]
    v_pk_fma_f32 v[226:227], v[226:227], v[126:127], v[126:127]
    v_rcp_f32 v220, v220
    v_rcp_f32 v221, v221
    v_rcp_f32 v222, v222
    v_rcp_f32 v223, v223
    v_rcp_f32 v224, v224
    v_rcp_f32 v225, v225
    v_rcp_f32 v226, v226
    v_rcp_f32 v227, v227
    v_pk_mul_f32 v[48:49], v[48:49], v[220:221]
    v_pk_mul_f32 v[50:51], v[50:51], v[222:223]
    v_pk_mul_f32 v[52:53], v[52:53], v[224:225]
    v_pk_mul_f32 v[54:55], v[54:55], v[226:227]
    v_pk_add_f32 v[204:205], v[204:205], v[48:49]
    v_pk_fma_f32 v[206:207], v[48:49], v[48:49], v[206:207]
    v_pk_add_f32 v[208:209], v[208:209], v[50:51]
    v_pk_fma_f32 v[210:211], v[50:51], v[50:51], v[210:211]
    v_pk_add_f32 v[212:213], v[212:213], v[52:53]
    v_pk_fma_f32 v[214:215], v[52:53], v[52:53], v[214:215]
    v_pk_add_f32 v[216:217], v[216:217], v[54:55]
    v_pk_fma_f32 v[218:219], v[54:55], v[54:55], v[218:219]
    v_pk_mul_f32 v[228:229], v[56:57], v[56:57]
    v_pk_mul_f32 v[230:231], v[58:59], v[58:59]
    v_pk_mul_f32 v[232:233], v[60:61], v[60:61]
    v_pk_mul_f32 v[234:235], v[62:63], v[62:63]
    v_pk_fma_f32 v[228:229], v[228:229], v[112:113], v[104:105]
    v_pk_fma_f32 v[230:231], v[230:231], v[114:115], v[106:107]
    v_pk_fma_f32 v[232:233], v[232:233], v[116:117], v[108:109]
    v_pk_fma_f32 v[234:235], v[234:235], v[118:119], v[110:111]
    v_pk_mul_f32 v[228:229], v[228:229], v[56:57]
    v_pk_mul_f32 v[230:231], v[230:231], v[58:59]
    v_pk_mul_f32 v[232:233], v[232:233], v[60:61]
    v_pk_mul_f32 v[234:235], v[234:235], v[62:63]
    v_exp_f32 v228, v228
    v_exp_f32 v229, v229
    v_exp_f32 v230, v230
    v_exp_f32 v231, v231
    v_exp_f32 v232, v232
    v_exp_f32 v233, v233
    v_exp_f32 v234, v234
    v_exp_f32 v235, v235
    v_pk_fma_f32 v[228:229], v[228:229], v[120:121], v[120:121]
    v_pk_fma_f32 v[230:231], v[230:231], v[122:123], v[122:123]
    v_pk_fma_f32 v[232:233], v[232:233], v[124:125], v[124:125]
    v_pk_fma_f32 v[234:235], v[234:235], v[126:127], v[126:127]
    v_rcp_f32 v228, v228
    v_rcp_f32 v229, v229
    v_rcp_f32 v230, v230
    v_rcp_f32 v231, v231
    v_rcp_f32 v232, v232
    v_rcp_f32 v233, v233
    v_rcp_f32 v234, v234
    v_rcp_f32 v235, v235
    v_pk_mul_f32 v[56:57], v[56:57], v[228:229]
    v_pk_mul_f32 v[58:59], v[58:59], v[230:231]
    v_pk_mul_f32 v[60:61], v[60:61], v[232:233]
    v_pk_mul_f32 v[62:63], v[62:63], v[234:235]
    v_pk_add_f32 v[204:205], v[204:205], v[56:57]
    v_pk_fma_f32 v[206:207], v[56:57], v[56:57], v[206:207]
    v_pk_add_f32 v[208:209], v[208:209], v[58:59]
    v_pk_fma_f32 v[210:211], v[58:59], v[58:59], v[210:211]
    v_pk_add_f32 v[212:213], v[212:213], v[60:61]
    v_pk_fma_f32 v[214:215], v[60:61], v[60:61], v[214:215]
    v_pk_add_f32 v[216:217], v[216:217], v[62:63]
    v_pk_fma_f32 v[218:219], v[62:63], v[62:63], v[218:219]
    v_pk_mul_f32 v[220:221], v[64:65], v[64:65]
    v_pk_mul_f32 v[222:223], v[66:67], v[66:67]
    v_pk_mul_f32 v[224:225], v[68:69], v[68:69]
    v_pk_mul_f32 v[226:227], v[70:71], v[70:71]
    v_pk_fma_f32 v[220:221], v[220:221], v[112:113], v[104:105]
    v_pk_fma_f32 v[222:223], v[222:223], v[114:115], v[106:107]
    v_pk_fma_f32 v[224:225], v[224:225], v[116:117], v[108:109]
    v_pk_fma_f32 v[226:227], v[226:227], v[118:119], v[110:111]
    v_pk_mul_f32 v[220:221], v[220:221], v[64:65]
    v_pk_mul_f32 v[222:223], v[222:223], v[66:67]
    v_pk_mul_f32 v[224:225], v[224:225], v[68:69]
    v_pk_mul_f32 v[226:227], v[226:227], v[70:71]
    v_exp_f32 v220, v220
    v_exp_f32 v221, v221
    v_exp_f32 v222, v222
    v_exp_f32 v223, v223
    v_exp_f32 v224, v224
    v_exp_f32 v225, v225
    v_exp_f32 v226, v226
    v_exp_f32 v227, v227
    v_pk_fma_f32 v[220:221], v[220:221], v[120:121], v[120:121]
    v_pk_fma_f32 v[222:223], v[222:223], v[122:123], v[122:123]
    v_pk_fma_f32 v[224:225], v[224:225], v[124:125], v[124:125]
    v_pk_fma_f32 v[226:227], v[226:227], v[126:127], v[126:127]
    v_rcp_f32 v220, v220
    v_rcp_f32 v221, v221
    v_rcp_f32 v222, v222
    v_rcp_f32 v223, v223
    v_rcp_f32 v224, v224
    v_rcp_f32 v225, v225
    v_rcp_f32 v226, v226
    v_rcp_f32 v227, v227
    v_pk_mul_f32 v[64:65], v[64:65], v[220:221]
    v_pk_mul_f32 v[66:67], v[66:67], v[222:223]
    v_pk_mul_f32 v[68:69], v[68:69], v[224:225]
    v_pk_mul_f32 v[70:71], v[70:71], v[226:227]
    v_pk_add_f32 v[204:205], v[204:205], v[64:65]
    v_pk_fma_f32 v[206:207], v[64:65], v[64:65], v[206:207]
    v_pk_add_f32 v[208:209], v[208:209], v[66:67]
    v_pk_fma_f32 v[210:211], v[66:67], v[66:67], v[210:211]
    v_pk_add_f32 v[212:213], v[212:213], v[68:69]
    v_pk_fma_f32 v[214:215], v[68:69], v[68:69], v[214:215]
    v_pk_add_f32 v[216:217], v[216:217], v[70:71]
    v_pk_fma_f32 v[218:219], v[70:71], v[70:71], v[218:219]
    v_pk_mul_f32 v[228:229], v[72:73], v[72:73]
    v_pk_mul_f32 v[230:231], v[74:75], v[74:75]
    v_pk_mul_f32 v[232:233], v[76:77], v[76:77]
    v_pk_mul_f32 v[234:235], v[78:79], v[78:79]
    v_pk_fma_f32 v[228:229], v[228:229], v[112:113], v[104:105]
    v_pk_fma_f32 v[230:231], v[230:231], v[114:115], v[106:107]
    v_pk_fma_f32 v[232:233], v[232:233], v[116:117], v[108:109]
    v_pk_fma_f32 v[234:235], v[234:235], v[118:119], v[110:111]
    v_pk_mul_f32 v[228:229], v[228:229], v[72:73]
    v_pk_mul_f32 v[230:231], v[230:231], v[74:75]
    v_pk_mul_f32 v[232:233], v[232:233], v[76:77]
    v_pk_mul_f32 v[234:235], v[234:235], v[78:79]
    v_exp_f32 v228, v228
    v_exp_f32 v229, v229
    v_exp_f32 v230, v230
    v_exp_f32 v231, v231
    v_exp_f32 v232, v232
    v_exp_f32 v233, v233
    v_exp_f32 v234, v234
    v_exp_f32 v235, v235
    v_pk_fma_f32 v[228:229], v[228:229], v[120:121], v[120:121]
    v_pk_fma_f32 v[230:231], v[230:231], v[122:123], v[122:123]
    v_pk_fma_f32 v[232:233], v[232:233], v[124:125], v[124:125]
    v_pk_fma_f32 v[234:235], v[234:235], v[126:127], v[126:127]
    v_rcp_f32 v228, v228
    v_rcp_f32 v229, v229
    v_rcp_f32 v230, v230
    v_rcp_f32 v231, v231
    v_rcp_f32 v232, v232
    v_rcp_f32 v233, v233
    v_rcp_f32 v234, v234
    v_rcp_f32 v235, v235
    v_pk_mul_f32 v[72:73], v[72:73], v[228:229]
    v_pk_mul_f32 v[74:75], v[74:75], v[230:231]
    v_pk_mul_f32 v[76:77], v[76:77], v[232:233]
    v_pk_mul_f32 v[78:79], v[78:79], v[234:235]
    v_pk_add_f32 v[204:205], v[204:205], v[72:73]
    v_pk_fma_f32 v[206:207], v[72:73], v[72:73], v[206:207]
    v_pk_add_f32 v[208:209], v[208:209], v[74:75]
    v_pk_fma_f32 v[210:211], v[74:75], v[74:75], v[210:211]
    v_pk_add_f32 v[212:213], v[212:213], v[76:77]
    v_pk_fma_f32 v[214:215], v[76:77], v[76:77], v[214:215]
    v_pk_add_f32 v[216:217], v[216:217], v[78:79]
    v_pk_fma_f32 v[218:219], v[78:79], v[78:79], v[218:219]
    v_pk_mul_f32 v[220:221], v[80:81], v[80:81]
    v_pk_mul_f32 v[222:223], v[82:83], v[82:83]
    v_pk_mul_f32 v[224:225], v[84:85], v[84:85]
    v_pk_mul_f32 v[226:227], v[86:87], v[86:87]
    v_pk_fma_f32 v[220:221], v[220:221], v[112:113], v[104:105]
    v_pk_fma_f32 v[222:223], v[222:223], v[114:115], v[106:107]
    v_pk_fma_f32 v[224:225], v[224:225], v[116:117], v[108:109]
    v_pk_fma_f32 v[226:227], v[226:227], v[118:119], v[110:111]
    v_pk_mul_f32 v[220:221], v[220:221], v[80:81]
    v_pk_mul_f32 v[222:223], v[222:223], v[82:83]
    v_pk_mul_f32 v[224:225], v[224:225], v[84:85]
    v_pk_mul_f32 v[226:227], v[226:227], v[86:87]
    v_exp_f32 v220, v220
    v_exp_f32 v221, v221
    v_exp_f32 v222, v222
    v_exp_f32 v223, v223
    v_exp_f32 v224, v224
    v_exp_f32 v225, v225
    v_exp_f32 v226, v226
    v_exp_f32 v227, v227
    v_pk_fma_f32 v[220:221], v[220:221], v[120:121], v[120:121]
    v_pk_fma_f32 v[222:223], v[222:223], v[122:123], v[122:123]
    v_pk_fma_f32 v[224:225], v[224:225], v[124:125], v[124:125]
    v_pk_fma_f32 v[226:227], v[226:227], v[126:127], v[126:127]
    v_rcp_f32 v220, v220
    v_rcp_f32 v221, v221
    v_rcp_f32 v222, v222
    v_rcp_f32 v223, v223
    v_rcp_f32 v224, v224
    v_rcp_f32 v225, v225
    v_rcp_f32 v226, v226
    v_rcp_f32 v227, v227
    v_pk_mul_f32 v[80:81], v[80:81], v[220:221]
    v_pk_mul_f32 v[82:83], v[82:83], v[222:223]
    v_pk_mul_f32 v[84:85], v[84:85], v[224:225]
    v_pk_mul_f32 v[86:87], v[86:87], v[226:227]
    v_pk_add_f32 v[204:205], v[204:205], v[80:81]
    v_pk_fma_f32 v[206:207], v[80:81], v[80:81], v[206:207]
    v_pk_add_f32 v[208:209], v[208:209], v[82:83]
    v_pk_fma_f32 v[210:211], v[82:83], v[82:83], v[210:211]
    v_pk_add_f32 v[212:213], v[212:213], v[84:85]
    v_pk_fma_f32 v[214:215], v[84:85], v[84:85], v[214:215]
    v_pk_add_f32 v[216:217], v[216:217], v[86:87]
    v_pk_fma_f32 v[218:219], v[86:87], v[86:87], v[218:219]
    v_add_f32_dpp v204, v204, v204 row_mirror row_mask:0xf bank_mask:0x3
    v_add_f32_dpp v205, v205, v205 row_mirror row_mask:0xf bank_mask:0x3
    v_add_f32_dpp v206, v206, v206 row_mirror row_mask:0xf bank_mask:0x3
    v_add_f32_dpp v207, v207, v207 row_mirror row_mask:0xf bank_mask:0x3
    v_add_f32_dpp v208, v208, v208 row_mirror row_mask:0xf bank_mask:0x3
    v_add_f32_dpp v209, v209, v209 row_mirror row_mask:0xf bank_mask:0x3
    v_add_f32_dpp v210, v210, v210 row_mirror row_mask:0xf bank_mask:0x3
    v_add_f32_dpp v211, v211, v211 row_mirror row_mask:0xf bank_mask:0x3
    v_add_f32_dpp v204, v212, v212 row_mirror row_mask:0xf bank_mask:0xc
    v_add_f32_dpp v205, v213, v213 row_mirror row_mask:0xf bank_mask:0xc
    v_add_f32_dpp v206, v214, v214 row_mirror row_mask:0xf bank_mask:0xc
    v_add_f32_dpp v207, v215, v215 row_mirror row_mask:0xf bank_mask:0xc
    v_add_f32_dpp v208, v216, v216 row_mirror row_mask:0xf bank_mask:0xc
    v_add_f32_dpp v209, v217, v217 row_mirror row_mask:0xf bank_mask:0xc
    v_add_f32_dpp v210, v218, v218 row_mirror row_mask:0xf bank_mask:0xc
    v_add_f32_dpp v211, v219, v219 row_mirror row_mask:0xf bank_mask:0xc
    v_add_f32_dpp v204, v204, v204 row_half_mirror row_mask:0xf bank_mask:0x5
    v_add_f32_dpp v205, v205, v205 row_half_mirror row_mask:0xf bank_mask:0x5
    v_add_f32_dpp v206, v206, v206 row_half_mirror row_mask:0xf bank_mask:0x5
    v_add_f32_dpp v207, v207, v207 row_half_mirror row_mask:0xf bank_mask:0x5
    v_add_f32_dpp v204, v208, v208 row_half_mirror row_mask:0xf bank_mask:0xa
    v_add_f32_dpp v205, v209, v209 row_half_mirror row_mask:0xf bank_mask:0xa
    v_add_f32_dpp v206, v210, v210 row_half_mirror row_mask:0xf bank_mask:0xa
    v_add_f32_dpp v207, v211, v211 row_half_mirror row_mask:0xf bank_mask:0xa
    v_add_f32_dpp v204, v204, v204 quad_perm:[1,0,3,2] row_mask:0xf bank_mask:0xf
    v_add_f32_dpp v205, v205, v205 quad_perm:[1,0,3,2] row_mask:0xf bank_mask:0xf
    v_add_f32_dpp v206, v206, v206 quad_perm:[1,0,3,2] row_mask:0xf bank_mask:0xf
    v_add_f32_dpp v207, v207, v207 quad_perm:[1,0,3,2] row_mask:0xf bank_mask:0xf
    v_add_f32_dpp v12, v204, v204 quad_perm:[2,3,0,1] row_mask:0xf bank_mask:0xf
    v_add_f32_dpp v14, v205, v205 quad_perm:[2,3,0,1] row_mask:0xf bank_mask:0xf
    v_add_f32_dpp v13, v206, v206 quad_perm:[2,3,0,1] row_mask:0xf bank_mask:0xf
    v_add_f32_dpp v15, v207, v207 quad_perm:[2,3,0,1] row_mask:0xf bank_mask:0xf
    buffer_store_dwordx4 v[12:15], v8, s[4:7], s36 offen sc1
    s_waitcnt lgkmcnt(5)
    v_mfma_f32_16x16x32_bf16 v[88:91], v[168:171], v[160:163], 0
    ds_read_b128 v[204:207], v3 offset:37888
    v_mfma_f32_16x16x32_bf16 v[92:95], v[168:171], v[164:167], 0
    ds_read_b128 v[208:211], v3 offset:39936
    v_mfma_f32_16x16x32_bf16 v[96:99], v[172:175], v[160:163], 0
    ds_read_b128 v[212:215], v1 offset:46080
    v_mfma_f32_16x16x32_bf16 v[100:103], v[172:175], v[164:167], 0
    ds_read_b128 v[216:219], v1 offset:47104
    v_mfma_f32_16x16x32_bf16 v[104:107], v[176:179], v[160:163], 0
    ds_read_b128 v[220:223], v1 offset:48128
    v_mfma_f32_16x16x32_bf16 v[108:111], v[176:179], v[164:167], 0
    ds_read_b128 v[224:227], v1 offset:49152
    v_mfma_f32_16x16x32_bf16 v[112:115], v[180:183], v[160:163], 0
    ds_read_b128 v[228:231], v1 offset:50176
    v_mfma_f32_16x16x32_bf16 v[116:119], v[180:183], v[164:167], 0
    ds_read_b128 v[232:235], v1 offset:51200
    s_waitcnt lgkmcnt(8)
    v_mfma_f32_16x16x32_bf16 v[120:123], v[184:187], v[160:163], 0
    ds_read_b128 v[236:239], v1 offset:52224
    v_mfma_f32_16x16x32_bf16 v[124:127], v[184:187], v[164:167], 0
    ds_read_b128 v[240:243], v1 offset:53248
    v_mfma_f32_16x16x32_bf16 v[128:131], v[188:191], v[160:163], 0
    ds_read_b128 v[244:247], v1 offset:54272
    v_mfma_f32_16x16x32_bf16 v[132:135], v[188:191], v[164:167], 0
    v_mfma_f32_16x16x32_bf16 v[136:139], v[192:195], v[160:163], 0
    v_lshrrev_b32 v255, 8, v1
    v_mfma_f32_16x16x32_bf16 v[140:143], v[192:195], v[164:167], 0
    v_lshl_add_u32 v255, v255, 6, s33
    v_mfma_f32_16x16x32_bf16 v[144:147], v[196:199], v[160:163], 0
    v_mfma_f32_16x16x32_bf16 v[148:151], v[196:199], v[164:167], 0
    v_mfma_f32_16x16x32_bf16 v[152:155], v[200:203], v[160:163], 0
    v_mfma_f32_16x16x32_bf16 v[156:159], v[200:203], v[164:167], 0
    s_waitcnt lgkmcnt(0)
    s_barrier
    v_mfma_f32_16x16x32_bf16 v[88:91], v[212:215], v[204:207], v[88:91]
    ds_read_b128 v[160:163], v0 offset:0
    v_mfma_f32_16x16x32_bf16 v[92:95], v[212:215], v[208:211], v[92:95]
    ds_read_b128 v[164:167], v0 offset:2048
    v_mfma_f32_16x16x32_bf16 v[96:99], v[216:219], v[204:207], v[96:99]
    ds_read_b128 v[168:171], v2 offset:0
    v_mfma_f32_16x16x32_bf16 v[100:103], v[216:219], v[208:211], v[100:103]
    ds_read_b128 v[172:175], v2 offset:1024
    v_mfma_f32_16x16x32_bf16 v[104:107], v[220:223], v[204:207], v[104:107]
    ds_read_b128 v[176:179], v2 offset:2048
    v_mfma_f32_16x16x32_bf16 v[108:111], v[220:223], v[208:211], v[108:111]
    ds_read_b128 v[180:183], v2 offset:3072
    v_mfma_f32_16x16x32_bf16 v[112:115], v[224:227], v[204:207], v[112:115]
    ds_read_b128 v[184:187], v2 offset:4096
    v_mfma_f32_16x16x32_bf16 v[116:119], v[224:227], v[208:211], v[116:119]
    ds_read_b128 v[188:191], v2 offset:5120
    v_mfma_f32_16x16x32_bf16 v[120:123], v[228:231], v[204:207], v[120:123]
    ds_read_b128 v[192:195], v2 offset:6144
    v_mfma_f32_16x16x32_bf16 v[124:127], v[228:231], v[208:211], v[124:127]
    ds_read_b128 v[196:199], v2 offset:7168
    v_mfma_f32_16x16x32_bf16 v[128:131], v[232:235], v[204:207], v[128:131]
    ds_read_b128 v[200:203], v2 offset:8192
    v_mfma_f32_16x16x32_bf16 v[132:135], v[232:235], v[208:211], v[132:135]
    v_mfma_f32_16x16x32_bf16 v[136:139], v[236:239], v[204:207], v[136:139]
    v_mfma_f32_16x16x32_bf16 v[140:143], v[236:239], v[208:211], v[140:143]
    v_mfma_f32_16x16x32_bf16 v[144:147], v[240:243], v[204:207], v[144:147]
    v_mfma_f32_16x16x32_bf16 v[148:151], v[240:243], v[208:211], v[148:151]
    v_mfma_f32_16x16x32_bf16 v[152:155], v[244:247], v[204:207], v[152:155]
    v_mfma_f32_16x16x32_bf16 v[156:159], v[244:247], v[208:211], v[156:159]
    s_waitcnt lgkmcnt(5)
    v_mfma_f32_16x16x32_bf16 v[88:91], v[168:171], v[160:163], v[88:91]
    ds_read_b128 v[204:207], v0 offset:1024
    v_mfma_f32_16x16x32_bf16 v[92:95], v[168:171], v[164:167], v[92:95]
    ds_read_b128 v[208:211], v0 offset:3072
    v_mfma_f32_16x16x32_bf16 v[96:99], v[172:175], v[160:163], v[96:99]
    ds_read_b128 v[212:215], v2 offset:9216
    v_mfma_f32_16x16x32_bf16 v[100:103], v[172:175], v[164:167], v[100:103]
    ds_read_b128 v[216:219], v2 offset:10240
    v_mfma_f32_16x16x32_bf16 v[104:107], v[176:179], v[160:163], v[104:107]
    ds_read_b128 v[220:223], v2 offset:11264
    v_mfma_f32_16x16x32_bf16 v[108:111], v[176:179], v[164:167], v[108:111]
    ds_read_b128 v[224:227], v2 offset:12288
    v_mfma_f32_16x16x32_bf16 v[112:115], v[180:183], v[160:163], v[112:115]
    ds_read_b128 v[228:231], v2 offset:13312
    v_mfma_f32_16x16x32_bf16 v[116:119], v[180:183], v[164:167], v[116:119]
    ds_read_b128 v[232:235], v2 offset:14336
    s_waitcnt lgkmcnt(8)
    v_mfma_f32_16x16x32_bf16 v[120:123], v[184:187], v[160:163], v[120:123]
    ds_read_b128 v[236:239], v2 offset:15360
    v_mfma_f32_16x16x32_bf16 v[124:127], v[184:187], v[164:167], v[124:127]
    ds_read_b128 v[240:243], v2 offset:16384
    v_mfma_f32_16x16x32_bf16 v[128:131], v[188:191], v[160:163], v[128:131]
    ds_read_b128 v[244:247], v2 offset:17408
    v_mfma_f32_16x16x32_bf16 v[132:135], v[188:191], v[164:167], v[132:135]
    v_mfma_f32_16x16x32_bf16 v[136:139], v[192:195], v[160:163], v[136:139]
    v_mfma_f32_16x16x32_bf16 v[140:143], v[192:195], v[164:167], v[140:143]
    v_mfma_f32_16x16x32_bf16 v[144:147], v[196:199], v[160:163], v[144:147]
    v_mfma_f32_16x16x32_bf16 v[148:151], v[196:199], v[164:167], v[148:151]
    v_mfma_f32_16x16x32_bf16 v[152:155], v[200:203], v[160:163], v[152:155]
    v_mfma_f32_16x16x32_bf16 v[156:159], v[200:203], v[164:167], v[156:159]
    s_waitcnt lgkmcnt(0)
    s_barrier
    v_mfma_f32_16x16x32_bf16 v[88:91], v[212:215], v[204:207], v[88:91]
    ds_read_b128 v[160:163], v0 offset:36864
    v_mfma_f32_16x16x32_bf16 v[92:95], v[212:215], v[208:211], v[92:95]
    ds_read_b128 v[164:167], v0 offset:38912
    v_mfma_f32_16x16x32_bf16 v[96:99], v[216:219], v[204:207], v[96:99]
    ds_read_b128 v[168:171], v2 offset:36864
    v_mfma_f32_16x16x32_bf16 v[100:103], v[216:219], v[208:211], v[100:103]
    ds_read_b128 v[172:175], v2 offset:37888
    v_mfma_f32_16x16x32_bf16 v[104:107], v[220:223], v[204:207], v[104:107]
    ds_read_b128 v[176:179], v2 offset:38912
    v_mfma_f32_16x16x32_bf16 v[108:111], v[220:223], v[208:211], v[108:111]
    ds_read_b128 v[180:183], v2 offset:39936
    v_mfma_f32_16x16x32_bf16 v[112:115], v[224:227], v[204:207], v[112:115]
    ds_read_b128 v[184:187], v2 offset:40960
    v_mfma_f32_16x16x32_bf16 v[116:119], v[224:227], v[208:211], v[116:119]
    ds_read_b128 v[188:191], v2 offset:41984
    v_mfma_f32_16x16x32_bf16 v[120:123], v[228:231], v[204:207], v[120:123]
    ds_read_b128 v[192:195], v2 offset:43008
    v_mfma_f32_16x16x32_bf16 v[124:127], v[228:231], v[208:211], v[124:127]
    ds_read_b128 v[196:199], v2 offset:44032
    v_mfma_f32_16x16x32_bf16 v[128:131], v[232:235], v[204:207], v[128:131]
    ds_read_b128 v[200:203], v2 offset:45056
    v_mfma_f32_16x16x32_bf16 v[132:135], v[232:235], v[208:211], v[132:135]
    v_mfma_f32_16x16x32_bf16 v[136:139], v[236:239], v[204:207], v[136:139]
    v_mfma_f32_16x16x32_bf16 v[140:143], v[236:239], v[208:211], v[140:143]
    v_mfma_f32_16x16x32_bf16 v[144:147], v[240:243], v[204:207], v[144:147]
    v_mfma_f32_16x16x32_bf16 v[148:151], v[240:243], v[208:211], v[148:151]
    v_mfma_f32_16x16x32_bf16 v[152:155], v[244:247], v[204:207], v[152:155]
    v_mfma_f32_16x16x32_bf16 v[156:159], v[244:247], v[208:211], v[156:159]
    s_waitcnt lgkmcnt(5)
    v_mfma_f32_16x16x32_bf16 v[88:91], v[168:171], v[160:163], v[88:91]
    ds_read_b128 v[204:207], v0 offset:37888
    v_mfma_f32_16x16x32_bf16 v[92:95], v[168:171], v[164:167], v[92:95]
    ds_read_b128 v[208:211], v0 offset:39936
    v_mfma_f32_16x16x32_bf16 v[96:99], v[172:175], v[160:163], v[96:99]
    ds_read_b128 v[212:215], v2 offset:46080
    v_mfma_f32_16x16x32_bf16 v[100:103], v[172:175], v[164:167], v[100:103]
    ds_read_b128 v[216:219], v2 offset:47104
    v_mfma_f32_16x16x32_bf16 v[104:107], v[176:179], v[160:163], v[104:107]
    ds_read_b128 v[220:223], v2 offset:48128
    v_mfma_f32_16x16x32_bf16 v[108:111], v[176:179], v[164:167], v[108:111]
    ds_read_b128 v[224:227], v2 offset:49152
    v_mfma_f32_16x16x32_bf16 v[112:115], v[180:183], v[160:163], v[112:115]
    ds_read_b128 v[228:231], v2 offset:50176
    v_mfma_f32_16x16x32_bf16 v[116:119], v[180:183], v[164:167], v[116:119]
    ds_read_b128 v[232:235], v2 offset:51200
    s_waitcnt lgkmcnt(8)
    v_mfma_f32_16x16x32_bf16 v[120:123], v[184:187], v[160:163], v[120:123]
    ds_read_b128 v[236:239], v2 offset:52224
    v_mfma_f32_16x16x32_bf16 v[124:127], v[184:187], v[164:167], v[124:127]
    ds_read_b128 v[240:243], v2 offset:53248
    v_mfma_f32_16x16x32_bf16 v[128:131], v[188:191], v[160:163], v[128:131]
    ds_read_b128 v[244:247], v2 offset:54272
    v_mfma_f32_16x16x32_bf16 v[132:135], v[188:191], v[164:167], v[132:135]
    v_mfma_f32_16x16x32_bf16 v[136:139], v[192:195], v[160:163], v[136:139]
    v_mfma_f32_16x16x32_bf16 v[140:143], v[192:195], v[164:167], v[140:143]
    v_mfma_f32_16x16x32_bf16 v[144:147], v[196:199], v[160:163], v[144:147]
    v_mfma_f32_16x16x32_bf16 v[148:151], v[196:199], v[164:167], v[148:151]
    v_mfma_f32_16x16x32_bf16 v[152:155], v[200:203], v[160:163], v[152:155]
    v_mfma_f32_16x16x32_bf16 v[156:159], v[200:203], v[164:167], v[156:159]
    s_waitcnt lgkmcnt(0)
    s_barrier
    v_mfma_f32_16x16x32_bf16 v[88:91], v[212:215], v[204:207], v[88:91]
    ds_read_b128 v[160:163], v3 offset:0
    v_mfma_f32_16x16x32_bf16 v[92:95], v[212:215], v[208:211], v[92:95]
    ds_read_b128 v[164:167], v3 offset:2048
    v_mfma_f32_16x16x32_bf16 v[96:99], v[216:219], v[204:207], v[96:99]
    ds_read_b128 v[168:171], v1 offset:0
    v_mfma_f32_16x16x32_bf16 v[100:103], v[216:219], v[208:211], v[100:103]
    ds_read_b128 v[172:175], v1 offset:1024
    v_mfma_f32_16x16x32_bf16 v[104:107], v[220:223], v[204:207], v[104:107]
    ds_read_b128 v[176:179], v1 offset:2048
    v_mfma_f32_16x16x32_bf16 v[108:111], v[220:223], v[208:211], v[108:111]
    ds_read_b128 v[180:183], v1 offset:3072
    v_mfma_f32_16x16x32_bf16 v[112:115], v[224:227], v[204:207], v[112:115]
    ds_read_b128 v[184:187], v1 offset:4096
    v_mfma_f32_16x16x32_bf16 v[116:119], v[224:227], v[208:211], v[116:119]
    ds_read_b128 v[188:191], v1 offset:5120
    v_mfma_f32_16x16x32_bf16 v[120:123], v[228:231], v[204:207], v[120:123]
    ds_read_b128 v[192:195], v1 offset:6144
    v_mfma_f32_16x16x32_bf16 v[124:127], v[228:231], v[208:211], v[124:127]
    ds_read_b128 v[196:199], v1 offset:7168
    v_mfma_f32_16x16x32_bf16 v[128:131], v[232:235], v[204:207], v[128:131]
    ds_read_b128 v[200:203], v1 offset:8192
    v_mfma_f32_16x16x32_bf16 v[132:135], v[232:235], v[208:211], v[132:135]
    v_mfma_f32_16x16x32_bf16 v[136:139], v[236:239], v[204:207], v[136:139]
    v_mfma_f32_16x16x32_bf16 v[140:143], v[236:239], v[208:211], v[140:143]
    v_mfma_f32_16x16x32_bf16 v[144:147], v[240:243], v[204:207], v[144:147]
    v_mfma_f32_16x16x32_bf16 v[148:151], v[240:243], v[208:211], v[148:151]
    v_mfma_f32_16x16x32_bf16 v[152:155], v[244:247], v[204:207], v[152:155]
    v_mfma_f32_16x16x32_bf16 v[156:159], v[244:247], v[208:211], v[156:159]
    s_waitcnt lgkmcnt(5)
    v_mfma_f32_16x16x32_bf16 v[88:91], v[168:171], v[160:163], v[88:91]
    ds_read_b128 v[204:207], v3 offset:1024
    v_mfma_f32_16x16x32_bf16 v[92:95], v[168:171], v[164:167], v[92:95]
    ds_read_b128 v[208:211], v3 offset:3072
    v_mfma_f32_16x16x32_bf16 v[96:99], v[172:175], v[160:163], v[96:99]
    ds_read_b128 v[212:215], v1 offset:9216
    v_mfma_f32_16x16x32_bf16 v[100:103], v[172:175], v[164:167], v[100:103]
    ds_read_b128 v[216:219], v1 offset:10240
    v_mfma_f32_16x16x32_bf16 v[104:107], v[176:179], v[160:163], v[104:107]
    ds_read_b128 v[220:223], v1 offset:11264
    v_mfma_f32_16x16x32_bf16 v[108:111], v[176:179], v[164:167], v[108:111]
    ds_read_b128 v[224:227], v1 offset:12288
    v_mfma_f32_16x16x32_bf16 v[112:115], v[180:183], v[160:163], v[112:115]
    ds_read_b128 v[228:231], v1 offset:13312
    v_mfma_f32_16x16x32_bf16 v[116:119], v[180:183], v[164:167], v[116:119]
    ds_read_b128 v[232:235], v1 offset:14336
    s_waitcnt lgkmcnt(8)
    v_mfma_f32_16x16x32_bf16 v[120:123], v[184:187], v[160:163], v[120:123]
    ds_read_b128 v[236:239], v1 offset:15360
    v_mfma_f32_16x16x32_bf16 v[124:127], v[184:187], v[164:167], v[124:127]
    ds_read_b128 v[240:243], v1 offset:16384
    v_mfma_f32_16x16x32_bf16 v[128:131], v[188:191], v[160:163], v[128:131]
    ds_read_b128 v[244:247], v1 offset:17408
    v_mfma_f32_16x16x32_bf16 v[132:135], v[188:191], v[164:167], v[132:135]
    v_mfma_f32_16x16x32_bf16 v[136:139], v[192:195], v[160:163], v[136:139]
    v_mfma_f32_16x16x32_bf16 v[140:143], v[192:195], v[164:167], v[140:143]
    v_mfma_f32_16x16x32_bf16 v[144:147], v[196:199], v[160:163], v[144:147]
    v_mfma_f32_16x16x32_bf16 v[148:151], v[196:199], v[164:167], v[148:151]
    v_mfma_f32_16x16x32_bf16 v[152:155], v[200:203], v[160:163], v[152:155]
    v_mfma_f32_16x16x32_bf16 v[156:159], v[200:203], v[164:167], v[156:159]
    s_waitcnt lgkmcnt(0)
    s_barrier
    v_mfma_f32_16x16x32_bf16 v[88:91], v[212:215], v[204:207], v[88:91]
    ds_read_b128 v[160:163], v3 offset:36864
    v_mfma_f32_16x16x32_bf16 v[92:95], v[212:215], v[208:211], v[92:95]
    ds_read_b128 v[164:167], v3 offset:38912
    v_mfma_f32_16x16x32_bf16 v[96:99], v[216:219], v[204:207], v[96:99]
    ds_read_b128 v[168:171], v1 offset:36864
    v_mfma_f32_16x16x32_bf16 v[100:103], v[216:219], v[208:211], v[100:103]
    ds_read_b128 v[172:175], v1 offset:37888
    v_mfma_f32_16x16x32_bf16 v[104:107], v[220:223], v[204:207], v[104:107]
    ds_read_b128 v[176:179], v1 offset:38912
    v_mfma_f32_16x16x32_bf16 v[108:111], v[220:223], v[208:211], v[108:111]
    ds_read_b128 v[180:183], v1 offset:39936
    v_mfma_f32_16x16x32_bf16 v[112:115], v[224:227], v[204:207], v[112:115]
    ds_read_b128 v[184:187], v1 offset:40960
    v_mfma_f32_16x16x32_bf16 v[116:119], v[224:227], v[208:211], v[116:119]
    ds_read_b128 v[188:191], v1 offset:41984
    v_mfma_f32_16x16x32_bf16 v[120:123], v[228:231], v[204:207], v[120:123]
    ds_read_b128 v[192:195], v1 offset:43008
    v_mfma_f32_16x16x32_bf16 v[124:127], v[228:231], v[208:211], v[124:127]
    ds_read_b128 v[196:199], v1 offset:44032
    v_mfma_f32_16x16x32_bf16 v[128:131], v[232:235], v[204:207], v[128:131]
    ds_read_b128 v[200:203], v1 offset:45056
    v_mfma_f32_16x16x32_bf16 v[132:135], v[232:235], v[208:211], v[132:135]
    ds_read_b128 v[4:7], v255 offset:1024
    v_mfma_f32_16x16x32_bf16 v[136:139], v[236:239], v[204:207], v[136:139]
    ds_read_b128 v[8:11], v255 offset:1040
    v_mfma_f32_16x16x32_bf16 v[140:143], v[236:239], v[208:211], v[140:143]
    ds_read_b128 v[12:15], v255 offset:1056
    v_mfma_f32_16x16x32_bf16 v[144:147], v[240:243], v[204:207], v[144:147]
    ds_read_b128 v[252:255], v255 offset:1072
    v_mfma_f32_16x16x32_bf16 v[148:151], v[240:243], v[208:211], v[148:151]
    v_mfma_f32_16x16x32_bf16 v[152:155], v[244:247], v[204:207], v[152:155]
    v_mfma_f32_16x16x32_bf16 v[156:159], v[244:247], v[208:211], v[156:159]
    s_waitcnt lgkmcnt(9)
    v_mfma_f32_16x16x32_bf16 v[88:91], v[168:171], v[160:163], v[88:91]
    ds_read_b128 v[204:207], v3 offset:37888
    v_mfma_f32_16x16x32_bf16 v[92:95], v[168:171], v[164:167], v[92:95]
    ds_read_b128 v[208:211], v3 offset:39936
    v_mfma_f32_16x16x32_bf16 v[96:99], v[172:175], v[160:163], v[96:99]
    ds_read_b128 v[212:215], v1 offset:46080
    v_mfma_f32_16x16x32_bf16 v[100:103], v[172:175], v[164:167], v[100:103]
    ds_read_b128 v[216:219], v1 offset:47104
    v_mfma_f32_16x16x32_bf16 v[104:107], v[176:179], v[160:163], v[104:107]
    ds_read_b128 v[220:223], v1 offset:48128
    v_mfma_f32_16x16x32_bf16 v[108:111], v[176:179], v[164:167], v[108:111]
    ds_read_b128 v[224:227], v1 offset:49152
    v_mfma_f32_16x16x32_bf16 v[112:115], v[180:183], v[160:163], v[112:115]
    ds_read_b128 v[228:231], v1 offset:50176
    v_mfma_f32_16x16x32_bf16 v[116:119], v[180:183], v[164:167], v[116:119]
    ds_read_b128 v[232:235], v1 offset:51200
    s_waitcnt lgkmcnt(8)
    v_mfma_f32_16x16x32_bf16 v[120:123], v[184:187], v[160:163], v[120:123]
    ds_read_b128 v[236:239], v1 offset:52224
    v_fma_f32 v16, v16, v4, -v6
    v_mfma_f32_16x16x32_bf16 v[124:127], v[184:187], v[164:167], v[124:127]
    ds_read_b128 v[240:243], v1 offset:53248
    v_fma_f32 v17, v17, v5, -v7
    v_mfma_f32_16x16x32_bf16 v[128:131], v[188:191], v[160:163], v[128:131]
    ds_read_b128 v[244:247], v1 offset:54272
    v_fma_f32 v18, v18, v8, -v10
    v_mfma_f32_16x16x32_bf16 v[132:135], v[188:191], v[164:167], v[132:135]
    v_fma_f32 v19, v19, v9, -v11
    v_fma_f32 v20, v20, v12, -v14
    v_mfma_f32_16x16x32_bf16 v[136:139], v[192:195], v[160:163], v[136:139]
    v_fma_f32 v21, v21, v13, -v15
    v_fma_f32 v22, v22, v252, -v254
    v_mfma_f32_16x16x32_bf16 v[140:143], v[192:195], v[164:167], v[140:143]
    v_fma_f32 v23, v23, v253, -v255
    v_cvt_pk_bf16_f32 v16, v16, v17
    v_mfma_f32_16x16x32_bf16 v[144:147], v[196:199], v[160:163], v[144:147]
    v_cvt_pk_bf16_f32 v17, v18, v19
    v_cvt_pk_bf16_f32 v18, v20, v21
    v_mfma_f32_16x16x32_bf16 v[148:151], v[196:199], v[164:167], v[148:151]
    v_cvt_pk_bf16_f32 v19, v22, v23
    v_fma_f32 v24, v24, v4, -v6
    v_mfma_f32_16x16x32_bf16 v[152:155], v[200:203], v[160:163], v[152:155]
    v_fma_f32 v25, v25, v5, -v7
    v_fma_f32 v26, v26, v8, -v10
    v_mfma_f32_16x16x32_bf16 v[156:159], v[200:203], v[164:167], v[156:159]
    v_fma_f32 v27, v27, v9, -v11
    s_waitcnt lgkmcnt(0)
    s_barrier
    v_mfma_f32_16x16x32_bf16 v[88:91], v[212:215], v[204:207], v[88:91]
    ds_read_b128 v[160:163], v0 offset:0
    v_mfma_f32_16x16x32_bf16 v[92:95], v[212:215], v[208:211], v[92:95]
    ds_read_b128 v[164:167], v0 offset:2048
    v_fma_f32 v28, v28, v12, -v14
    v_mfma_f32_16x16x32_bf16 v[96:99], v[216:219], v[204:207], v[96:99]
    ds_read_b128 v[168:171], v2 offset:0
    v_fma_f32 v29, v29, v13, -v15
    v_mfma_f32_16x16x32_bf16 v[100:103], v[216:219], v[208:211], v[100:103]
    ds_read_b128 v[172:175], v2 offset:1024
    v_fma_f32 v30, v30, v252, -v254
    v_mfma_f32_16x16x32_bf16 v[104:107], v[220:223], v[204:207], v[104:107]
    ds_read_b128 v[176:179], v2 offset:2048
    v_fma_f32 v31, v31, v253, -v255
    v_mfma_f32_16x16x32_bf16 v[108:111], v[220:223], v[208:211], v[108:111]
    ds_read_b128 v[180:183], v2 offset:3072
    v_permlane32_swap_b32 v16, v18
    v_mfma_f32_16x16x32_bf16 v[112:115], v[224:227], v[204:207], v[112:115]
    ds_read_b128 v[184:187], v2 offset:4096
    v_permlane32_swap_b32 v17, v19
    v_mfma_f32_16x16x32_bf16 v[116:119], v[224:227], v[208:211], v[116:119]
    ds_read_b128 v[188:191], v2 offset:5120
    v_mfma_f32_16x16x32_bf16 v[120:123], v[228:231], v[204:207], v[120:123]
    ds_read_b128 v[192:195], v2 offset:6144
    v_cvt_pk_bf16_f32 v24, v24, v25
    v_mfma_f32_16x16x32_bf16 v[124:127], v[228:231], v[208:211], v[124:127]
    ds_read_b128 v[196:199], v2 offset:7168
    v_cvt_pk_bf16_f32 v25, v26, v27
    v_mfma_f32_16x16x32_bf16 v[128:131], v[232:235], v[204:207], v[128:131]
    ds_read_b128 v[200:203], v2 offset:8192
    v_cvt_pk_bf16_f32 v26, v28, v29
    v_mfma_f32_16x16x32_bf16 v[132:135], v[232:235], v[208:211], v[132:135]
    v_cvt_pk_bf16_f32 v27, v30, v31
    v_permlane16_swap_b32 v16, v18
    v_mfma_f32_16x16x32_bf16 v[136:139], v[236:239], v[204:207], v[136:139]
    v_permlane16_swap_b32 v17, v19
    v_fma_f32 v32, v32, v4, -v6
    v_mfma_f32_16x16x32_bf16 v[140:143], v[236:239], v[208:211], v[140:143]
    v_fma_f32 v33, v33, v5, -v7
    v_fma_f32 v34, v34, v8, -v10
    v_mfma_f32_16x16x32_bf16 v[144:147], v[240:243], v[204:207], v[144:147]
    v_fma_f32 v35, v35, v9, -v11
    v_fma_f32 v36, v36, v12, -v14
    v_mfma_f32_16x16x32_bf16 v[148:151], v[240:243], v[208:211], v[148:151]
    v_fma_f32 v37, v37, v13, -v15
    v_fma_f32 v38, v38, v252, -v254
    v_mfma_f32_16x16x32_bf16 v[152:155], v[244:247], v[204:207], v[152:155]
    v_fma_f32 v39, v39, v253, -v255
    v_permlane32_swap_b32 v24, v26
    v_mfma_f32_16x16x32_bf16 v[156:159], v[244:247], v[208:211], v[156:159]
    v_permlane32_swap_b32 v25, v27
    s_waitcnt lgkmcnt(5)
    v_mfma_f32_16x16x32_bf16 v[88:91], v[168:171], v[160:163], v[88:91]
    ds_read_b128 v[204:207], v0 offset:1024
    v_mfma_f32_16x16x32_bf16 v[92:95], v[168:171], v[164:167], v[92:95]
    ds_read_b128 v[208:211], v0 offset:3072
    v_cvt_pk_bf16_f32 v32, v32, v33
    v_mfma_f32_16x16x32_bf16 v[96:99], v[172:175], v[160:163], v[96:99]
    ds_read_b128 v[212:215], v2 offset:9216
    v_cvt_pk_bf16_f32 v33, v34, v35
    v_mfma_f32_16x16x32_bf16 v[100:103], v[172:175], v[164:167], v[100:103]
    ds_read_b128 v[216:219], v2 offset:10240
    v_cvt_pk_bf16_f32 v34, v36, v37
    v_mfma_f32_16x16x32_bf16 v[104:107], v[176:179], v[160:163], v[104:107]
    ds_read_b128 v[220:223], v2 offset:11264
    v_cvt_pk_bf16_f32 v35, v38, v39
    v_mfma_f32_16x16x32_bf16 v[108:111], v[176:179], v[164:167], v[108:111]
    ds_read_b128 v[224:227], v2 offset:12288
    v_permlane16_swap_b32 v24, v26
    v_mfma_f32_16x16x32_bf16 v[112:115], v[180:183], v[160:163], v[112:115]
    ds_read_b128 v[228:231], v2 offset:13312
    v_permlane16_swap_b32 v25, v27
    v_mfma_f32_16x16x32_bf16 v[116:119], v[180:183], v[164:167], v[116:119]
    ds_read_b128 v[232:235], v2 offset:14336
    s_waitcnt lgkmcnt(8)
    v_mfma_f32_16x16x32_bf16 v[120:123], v[184:187], v[160:163], v[120:123]
    ds_read_b128 v[236:239], v2 offset:15360
    v_fma_f32 v40, v40, v4, -v6
    v_mfma_f32_16x16x32_bf16 v[124:127], v[184:187], v[164:167], v[124:127]
    ds_read_b128 v[240:243], v2 offset:16384
    v_fma_f32 v41, v41, v5, -v7
    v_mfma_f32_16x16x32_bf16 v[128:131], v[188:191], v[160:163], v[128:131]
    ds_read_b128 v[244:247], v2 offset:17408
    v_fma_f32 v42, v42, v8, -v10
    v_mfma_f32_16x16x32_bf16 v[132:135], v[188:191], v[164:167], v[132:135]
    v_fma_f32 v43, v43, v9, -v11
    v_fma_f32 v44, v44, v12, -v14
    v_mfma_f32_16x16x32_bf16 v[136:139], v[192:195], v[160:163], v[136:139]
    v_fma_f32 v45, v45, v13, -v15
    v_fma_f32 v46, v46, v252, -v254
    v_mfma_f32_16x16x32_bf16 v[140:143], v[192:195], v[164:167], v[140:143]
    v_fma_f32 v47, v47, v253, -v255
    v_permlane32_swap_b32 v32, v34
    v_mfma_f32_16x16x32_bf16 v[144:147], v[196:199], v[160:163], v[144:147]
    v_permlane32_swap_b32 v33, v35
    v_cvt_pk_bf16_f32 v40, v40, v41
    v_mfma_f32_16x16x32_bf16 v[148:151], v[196:199], v[164:167], v[148:151]
    v_cvt_pk_bf16_f32 v41, v42, v43
    v_cvt_pk_bf16_f32 v42, v44, v45
    v_mfma_f32_16x16x32_bf16 v[152:155], v[200:203], v[160:163], v[152:155]
    v_cvt_pk_bf16_f32 v43, v46, v47
    v_permlane16_swap_b32 v32, v34
    v_mfma_f32_16x16x32_bf16 v[156:159], v[200:203], v[164:167], v[156:159]
    v_permlane16_swap_b32 v33, v35
    s_waitcnt lgkmcnt(0)
    s_barrier
    v_mfma_f32_16x16x32_bf16 v[88:91], v[212:215], v[204:207], v[88:91]
    ds_read_b128 v[160:163], v0 offset:36864
    v_mfma_f32_16x16x32_bf16 v[92:95], v[212:215], v[208:211], v[92:95]
    ds_read_b128 v[164:167], v0 offset:38912
    v_fma_f32 v48, v48, v4, -v6
    v_mfma_f32_16x16x32_bf16 v[96:99], v[216:219], v[204:207], v[96:99]
    ds_read_b128 v[168:171], v2 offset:36864
    buffer_store_dwordx4 v[16:19], v1, s[4:7], s38 offen offset:0 sc1
    v_fma_f32 v49, v49, v5, -v7
    v_mfma_f32_16x16x32_bf16 v[100:103], v[216:219], v[208:211], v[100:103]
    ds_read_b128 v[172:175], v2 offset:37888
    v_fma_f32 v50, v50, v8, -v10
    v_mfma_f32_16x16x32_bf16 v[104:107], v[220:223], v[204:207], v[104:107]
    ds_read_b128 v[176:179], v2 offset:38912
    v_fma_f32 v51, v51, v9, -v11
    v_mfma_f32_16x16x32_bf16 v[108:111], v[220:223], v[208:211], v[108:111]
    ds_read_b128 v[180:183], v2 offset:39936
    v_fma_f32 v52, v52, v12, -v14
    v_mfma_f32_16x16x32_bf16 v[112:115], v[224:227], v[204:207], v[112:115]
    ds_read_b128 v[184:187], v2 offset:40960
    v_fma_f32 v53, v53, v13, -v15
    v_mfma_f32_16x16x32_bf16 v[116:119], v[224:227], v[208:211], v[116:119]
    ds_read_b128 v[188:191], v2 offset:41984
    v_mfma_f32_16x16x32_bf16 v[120:123], v[228:231], v[204:207], v[120:123]
    ds_read_b128 v[192:195], v2 offset:43008
    v_fma_f32 v54, v54, v252, -v254
    v_mfma_f32_16x16x32_bf16 v[124:127], v[228:231], v[208:211], v[124:127]
    ds_read_b128 v[196:199], v2 offset:44032
    v_fma_f32 v55, v55, v253, -v255
    v_mfma_f32_16x16x32_bf16 v[128:131], v[232:235], v[204:207], v[128:131]
    ds_read_b128 v[200:203], v2 offset:45056
    buffer_store_dwordx4 v[24:27], v1, s[4:7], s38 offen offset:1024 sc1
    v_permlane32_swap_b32 v40, v42
    v_mfma_f32_16x16x32_bf16 v[132:135], v[232:235], v[208:211], v[132:135]
    v_permlane32_swap_b32 v41, v43
    v_cvt_pk_bf16_f32 v48, v48, v49
    v_mfma_f32_16x16x32_bf16 v[136:139], v[236:239], v[204:207], v[136:139]
    v_cvt_pk_bf16_f32 v49, v50, v51
    v_cvt_pk_bf16_f32 v50, v52, v53
    v_mfma_f32_16x16x32_bf16 v[140:143], v[236:239], v[208:211], v[140:143]
    v_cvt_pk_bf16_f32 v51, v54, v55
    v_permlane16_swap_b32 v40, v42
    v_mfma_f32_16x16x32_bf16 v[144:147], v[240:243], v[204:207], v[144:147]
    v_permlane16_swap_b32 v41, v43
    v_fma_f32 v56, v56, v4, -v6
    v_mfma_f32_16x16x32_bf16 v[148:151], v[240:243], v[208:211], v[148:151]
    v_fma_f32 v57, v57, v5, -v7
    v_fma_f32 v58, v58, v8, -v10
    v_mfma_f32_16x16x32_bf16 v[152:155], v[244:247], v[204:207], v[152:155]
    v_fma_f32 v59, v59, v9, -v11
    v_fma_f32 v60, v60, v12, -v14
    v_mfma_f32_16x16x32_bf16 v[156:159], v[244:247], v[208:211], v[156:159]
    v_fma_f32 v61, v61, v13, -v15
    s_waitcnt lgkmcnt(5)
    v_mfma_f32_16x16x32_bf16 v[88:91], v[168:171], v[160:163], v[88:91]
    ds_read_b128 v[204:207], v0 offset:37888
    v_mfma_f32_16x16x32_bf16 v[92:95], v[168:171], v[164:167], v[92:95]
    ds_read_b128 v[208:211], v0 offset:39936
    v_fma_f32 v62, v62, v252, -v254
    v_mfma_f32_16x16x32_bf16 v[96:99], v[172:175], v[160:163], v[96:99]
    ds_read_b128 v[212:215], v2 offset:46080
    buffer_store_dwordx4 v[32:35], v1, s[4:7], s38 offen offset:2048 sc1
    v_fma_f32 v63, v63, v253, -v255
    v_mfma_f32_16x16x32_bf16 v[100:103], v[172:175], v[164:167], v[100:103]
    ds_read_b128 v[216:219], v2 offset:47104
    v_permlane32_swap_b32 v48, v50
    v_mfma_f32_16x16x32_bf16 v[104:107], v[176:179], v[160:163], v[104:107]
    ds_read_b128 v[220:223], v2 offset:48128
    v_permlane32_swap_b32 v49, v51
    v_mfma_f32_16x16x32_bf16 v[108:111], v[176:179], v[164:167], v[108:111]
    ds_read_b128 v[224:227], v2 offset:49152
    v_cvt_pk_bf16_f32 v56, v56, v57
    v_mfma_f32_16x16x32_bf16 v[112:115], v[180:183], v[160:163], v[112:115]
    ds_read_b128 v[228:231], v2 offset:50176
    v_cvt_pk_bf16_f32 v57, v58, v59
    v_mfma_f32_16x16x32_bf16 v[116:119], v[180:183], v[164:167], v[116:119]
    ds_read_b128 v[232:235], v2 offset:51200
    s_waitcnt lgkmcnt(8)
    v_mfma_f32_16x16x32_bf16 v[120:123], v[184:187], v[160:163], v[120:123]
    ds_read_b128 v[236:239], v2 offset:52224
    v_cvt_pk_bf16_f32 v58, v60, v61
    v_mfma_f32_16x16x32_bf16 v[124:127], v[184:187], v[164:167], v[124:127]
    ds_read_b128 v[240:243], v2 offset:53248
    v_cvt_pk_bf16_f32 v59, v62, v63
    v_mfma_f32_16x16x32_bf16 v[128:131], v[188:191], v[160:163], v[128:131]
    ds_read_b128 v[244:247], v2 offset:54272
    buffer_store_dwordx4 v[40:43], v1, s[4:7], s38 offen offset:3072 sc1
    v_permlane16_swap_b32 v48, v50
    v_mfma_f32_16x16x32_bf16 v[132:135], v[188:191], v[164:167], v[132:135]
    v_permlane16_swap_b32 v49, v51
    v_fma_f32 v64, v64, v4, -v6
    v_mfma_f32_16x16x32_bf16 v[136:139], v[192:195], v[160:163], v[136:139]
    v_fma_f32 v65, v65, v5, -v7
    v_fma_f32 v66, v66, v8, -v10
    v_mfma_f32_16x16x32_bf16 v[140:143], v[192:195], v[164:167], v[140:143]
    v_fma_f32 v67, v67, v9, -v11
    v_fma_f32 v68, v68, v12, -v14
    v_mfma_f32_16x16x32_bf16 v[144:147], v[196:199], v[160:163], v[144:147]
    v_fma_f32 v69, v69, v13, -v15
    v_fma_f32 v70, v70, v252, -v254
    v_mfma_f32_16x16x32_bf16 v[148:151], v[196:199], v[164:167], v[148:151]
    v_fma_f32 v71, v71, v253, -v255
    v_permlane32_swap_b32 v56, v58
    v_mfma_f32_16x16x32_bf16 v[152:155], v[200:203], v[160:163], v[152:155]
    v_permlane32_swap_b32 v57, v59
    v_cvt_pk_bf16_f32 v64, v64, v65
    v_mfma_f32_16x16x32_bf16 v[156:159], v[200:203], v[164:167], v[156:159]
    v_cvt_pk_bf16_f32 v65, v66, v67
    s_waitcnt lgkmcnt(0)
    s_barrier
    v_mfma_f32_16x16x32_bf16 v[88:91], v[212:215], v[204:207], v[88:91]
    ds_read_b128 v[160:163], v3 offset:0
    v_mfma_f32_16x16x32_bf16 v[92:95], v[212:215], v[208:211], v[92:95]
    ds_read_b128 v[164:167], v3 offset:2048
    v_cvt_pk_bf16_f32 v66, v68, v69
    v_mfma_f32_16x16x32_bf16 v[96:99], v[216:219], v[204:207], v[96:99]
    ds_read_b128 v[168:171], v1 offset:0
    buffer_store_dwordx4 v[48:51], v1, s[4:7], s39 offen offset:0 sc1
    v_cvt_pk_bf16_f32 v67, v70, v71
    v_mfma_f32_16x16x32_bf16 v[100:103], v[216:219], v[208:211], v[100:103]
    ds_read_b128 v[172:175], v1 offset:1024
    v_permlane16_swap_b32 v56, v58
    v_mfma_f32_16x16x32_bf16 v[104:107], v[220:223], v[204:207], v[104:107]
    ds_read_b128 v[176:179], v1 offset:2048
    v_permlane16_swap_b32 v57, v59
    v_mfma_f32_16x16x32_bf16 v[108:111], v[220:223], v[208:211], v[108:111]
    ds_read_b128 v[180:183], v1 offset:3072
    v_fma_f32 v72, v72, v4, -v6
    v_mfma_f32_16x16x32_bf16 v[112:115], v[224:227], v[204:207], v[112:115]
    ds_read_b128 v[184:187], v1 offset:4096
    v_fma_f32 v73, v73, v5, -v7
    v_mfma_f32_16x16x32_bf16 v[116:119], v[224:227], v[208:211], v[116:119]
    ds_read_b128 v[188:191], v1 offset:5120
    v_mfma_f32_16x16x32_bf16 v[120:123], v[228:231], v[204:207], v[120:123]
    ds_read_b128 v[192:195], v1 offset:6144
    v_fma_f32 v74, v74, v8, -v10
    v_mfma_f32_16x16x32_bf16 v[124:127], v[228:231], v[208:211], v[124:127]
    ds_read_b128 v[196:199], v1 offset:7168
    v_fma_f32 v75, v75, v9, -v11
    v_mfma_f32_16x16x32_bf16 v[128:131], v[232:235], v[204:207], v[128:131]
    ds_read_b128 v[200:203], v1 offset:8192
    v_fma_f32 v76, v76, v12, -v14
    v_mfma_f32_16x16x32_bf16 v[132:135], v[232:235], v[208:211], v[132:135]
    v_fma_f32 v77, v77, v13, -v15
    v_fma_f32 v78, v78, v252, -v254
    v_mfma_f32_16x16x32_bf16 v[136:139], v[236:239], v[204:207], v[136:139]
    v_fma_f32 v79, v79, v253, -v255
    v_permlane32_swap_b32 v64, v66
    v_mfma_f32_16x16x32_bf16 v[140:143], v[236:239], v[208:211], v[140:143]
    v_permlane32_swap_b32 v65, v67
    v_cvt_pk_bf16_f32 v72, v72, v73
    v_mfma_f32_16x16x32_bf16 v[144:147], v[240:243], v[204:207], v[144:147]
    v_cvt_pk_bf16_f32 v73, v74, v75
    v_cvt_pk_bf16_f32 v74, v76, v77
    v_mfma_f32_16x16x32_bf16 v[148:151], v[240:243], v[208:211], v[148:151]
    v_cvt_pk_bf16_f32 v75, v78, v79
    v_permlane16_swap_b32 v64, v66
    v_mfma_f32_16x16x32_bf16 v[152:155], v[244:247], v[204:207], v[152:155]
    v_permlane16_swap_b32 v65, v67
    v_fma_f32 v80, v80, v4, -v6
    v_mfma_f32_16x16x32_bf16 v[156:159], v[244:247], v[208:211], v[156:159]
    v_fma_f32 v81, v81, v5, -v7
    s_waitcnt lgkmcnt(5)
    v_mfma_f32_16x16x32_bf16 v[88:91], v[168:171], v[160:163], v[88:91]
    ds_read_b128 v[204:207], v3 offset:1024
    v_mfma_f32_16x16x32_bf16 v[92:95], v[168:171], v[164:167], v[92:95]
    ds_read_b128 v[208:211], v3 offset:3072
    v_fma_f32 v82, v82, v8, -v10
    v_mfma_f32_16x16x32_bf16 v[96:99], v[172:175], v[160:163], v[96:99]
    ds_read_b128 v[212:215], v1 offset:9216
    buffer_store_dwordx4 v[56:59], v1, s[4:7], s39 offen offset:1024 sc1
    v_fma_f32 v83, v83, v9, -v11
    v_mfma_f32_16x16x32_bf16 v[100:103], v[172:175], v[164:167], v[100:103]
    ds_read_b128 v[216:219], v1 offset:10240
    v_fma_f32 v84, v84, v12, -v14
    v_mfma_f32_16x16x32_bf16 v[104:107], v[176:179], v[160:163], v[104:107]
    ds_read_b128 v[220:223], v1 offset:11264
    v_fma_f32 v85, v85, v13, -v15
    v_mfma_f32_16x16x32_bf16 v[108:111], v[176:179], v[164:167], v[108:111]
    ds_read_b128 v[224:227], v1 offset:12288
    v_fma_f32 v86, v86, v252, -v254
    v_mfma_f32_16x16x32_bf16 v[112:115], v[180:183], v[160:163], v[112:115]
    ds_read_b128 v[228:231], v1 offset:13312
    v_fma_f32 v87, v87, v253, -v255
    v_mfma_f32_16x16x32_bf16 v[116:119], v[180:183], v[164:167], v[116:119]
    ds_read_b128 v[232:235], v1 offset:14336
    s_waitcnt lgkmcnt(8)
    v_mfma_f32_16x16x32_bf16 v[120:123], v[184:187], v[160:163], v[120:123]
    ds_read_b128 v[236:239], v1 offset:15360
    v_permlane32_swap_b32 v72, v74
    v_mfma_f32_16x16x32_bf16 v[124:127], v[184:187], v[164:167], v[124:127]
    ds_read_b128 v[240:243], v1 offset:16384
    v_permlane32_swap_b32 v73, v75
    v_mfma_f32_16x16x32_bf16 v[128:131], v[188:191], v[160:163], v[128:131]
    ds_read_b128 v[244:247], v1 offset:17408
    buffer_store_dwordx4 v[64:67], v1, s[4:7], s39 offen offset:2048 sc1
    v_cvt_pk_bf16_f32 v80, v80, v81
    v_mfma_f32_16x16x32_bf16 v[132:135], v[188:191], v[164:167], v[132:135]
    v_cvt_pk_bf16_f32 v81, v82, v83
    v_cvt_pk_bf16_f32 v82, v84, v85
    v_mfma_f32_16x16x32_bf16 v[136:139], v[192:195], v[160:163], v[136:139]
    v_cvt_pk_bf16_f32 v83, v86, v87
    v_permlane16_swap_b32 v72, v74
    v_mfma_f32_16x16x32_bf16 v[140:143], v[192:195], v[164:167], v[140:143]
    v_permlane16_swap_b32 v73, v75
    s_nop 0
    v_mfma_f32_16x16x32_bf16 v[144:147], v[196:199], v[160:163], v[144:147]
    v_permlane32_swap_b32 v80, v82
    v_permlane32_swap_b32 v81, v83
    v_mfma_f32_16x16x32_bf16 v[148:151], v[196:199], v[164:167], v[148:151]
    s_nop 0
    v_permlane16_swap_b32 v80, v82
    v_mfma_f32_16x16x32_bf16 v[152:155], v[200:203], v[160:163], v[152:155]
    v_permlane16_swap_b32 v81, v83
    v_mul_f32 v4, s40, v249
    v_mfma_f32_16x16x32_bf16 v[156:159], v[200:203], v[164:167], v[156:159]
    v_mul_f32 v6, s40, v251
    s_waitcnt lgkmcnt(0)
    s_barrier
    v_mfma_f32_16x16x32_bf16 v[88:91], v[212:215], v[204:207], v[88:91]
    ds_read_b128 v[160:163], v3 offset:36864
    v_mfma_f32_16x16x32_bf16 v[92:95], v[212:215], v[208:211], v[92:95]
    ds_read_b128 v[164:167], v3 offset:38912
    v_mul_f32 v5, v249, v249
    v_mfma_f32_16x16x32_bf16 v[96:99], v[216:219], v[204:207], v[96:99]
    ds_read_b128 v[168:171], v1 offset:36864
    buffer_store_dwordx4 v[72:75], v1, s[4:7], s39 offen offset:3072 sc1
    v_mul_f32 v7, v251, v251
    v_mfma_f32_16x16x32_bf16 v[100:103], v[216:219], v[208:211], v[100:103]
    ds_read_b128 v[172:175], v1 offset:37888
    v_rcp_f32 v249, v249
    v_mfma_f32_16x16x32_bf16 v[104:107], v[220:223], v[204:207], v[104:107]
    ds_read_b128 v[176:179], v1 offset:38912
    v_rcp_f32 v251, v251
    v_mfma_f32_16x16x32_bf16 v[108:111], v[220:223], v[208:211], v[108:111]
    ds_read_b128 v[180:183], v1 offset:39936
    v_mul_f32 v5, s42, v5
    v_mfma_f32_16x16x32_bf16 v[112:115], v[224:227], v[204:207], v[112:115]
    ds_read_b128 v[184:187], v1 offset:40960
    v_mul_f32 v7, s42, v7
    v_mfma_f32_16x16x32_bf16 v[116:119], v[224:227], v[208:211], v[116:119]
    ds_read_b128 v[188:191], v1 offset:41984
    v_mfma_f32_16x16x32_bf16 v[120:123], v[228:231], v[204:207], v[120:123]
    ds_read_b128 v[192:195], v1 offset:43008
    v_mul_f32 v5, v5, v4
    v_mfma_f32_16x16x32_bf16 v[124:127], v[228:231], v[208:211], v[124:127]
    ds_read_b128 v[196:199], v1 offset:44032
    v_mul_f32 v7, v7, v6
    v_mfma_f32_16x16x32_bf16 v[128:131], v[232:235], v[204:207], v[128:131]
    ds_read_b128 v[200:203], v1 offset:45056
    buffer_store_dwordx4 v[80:83], v1, s[4:7], s46 offen offset:0 sc1
    v_bfe_u32 v13, v1, 4, 4
    v_mfma_f32_16x16x32_bf16 v[132:135], v[232:235], v[208:211], v[132:135]
    v_lshrrev_b32 v8, 1, v13
    v_lshrrev_b32 v9, 8, v1
    v_mfma_f32_16x16x32_bf16 v[136:139], v[236:239], v[204:207], v[136:139]
    v_xor_b32 v8, v8, v9
    v_lshlrev_b32 v8, 4, v8
    v_mfma_f32_16x16x32_bf16 v[140:143], v[236:239], v[208:211], v[140:143]
    v_lshl_add_u32 v8, v13, 7, v8
    s_add_u32 s33, s30, 18432
    v_mfma_f32_16x16x32_bf16 v[144:147], v[240:243], v[204:207], v[144:147]
    v_add_u32 v8, s33, v8
    v_xor_b32 v9, 64, v8
    v_mfma_f32_16x16x32_bf16 v[148:151], v[240:243], v[208:211], v[148:151]
    v_add_u32 v10, 73728, v8
    v_add_u32 v11, 73728, v9
    v_mfma_f32_16x16x32_bf16 v[152:155], v[244:247], v[204:207], v[152:155]
    s_lshl_b32 s33, s20, 6
    s_add_u32 s33, s33, 161280
    v_mfma_f32_16x16x32_bf16 v[156:159], v[244:247], v[208:211], v[156:159]
    v_lshl_add_u32 v13, v13, 1, s33
    s_waitcnt lgkmcnt(5)
    v_mfma_f32_16x16x32_bf16 v[88:91], v[168:171], v[160:163], v[88:91]
    ds_read_b128 v[204:207], v3 offset:37888
    v_mfma_f32_16x16x32_bf16 v[92:95], v[168:171], v[164:167], v[92:95]
    ds_read_b128 v[208:211], v3 offset:39936
    v_mfma_f32_16x16x32_bf16 v[96:99], v[172:175], v[160:163], v[96:99]
    ds_read_b128 v[212:215], v1 offset:46080
    v_mfma_f32_16x16x32_bf16 v[100:103], v[172:175], v[164:167], v[100:103]
    ds_read_b128 v[216:219], v1 offset:47104
    v_mfma_f32_16x16x32_bf16 v[104:107], v[176:179], v[160:163], v[104:107]
    ds_read_b128 v[220:223], v1 offset:48128
    v_mfma_f32_16x16x32_bf16 v[108:111], v[176:179], v[164:167], v[108:111]
    ds_read_b128 v[224:227], v1 offset:49152
    v_mfma_f32_16x16x32_bf16 v[112:115], v[180:183], v[160:163], v[112:115]
    ds_read_b128 v[228:231], v1 offset:50176
    v_mfma_f32_16x16x32_bf16 v[116:119], v[180:183], v[164:167], v[116:119]
    ds_read_b128 v[232:235], v1 offset:51200
    s_waitcnt lgkmcnt(8)
    v_mfma_f32_16x16x32_bf16 v[120:123], v[184:187], v[160:163], v[120:123]
    ds_read_b128 v[236:239], v1 offset:52224
    v_mfma_f32_16x16x32_bf16 v[124:127], v[184:187], v[164:167], v[124:127]
    ds_read_b128 v[240:243], v1 offset:53248
    v_mfma_f32_16x16x32_bf16 v[128:131], v[188:191], v[160:163], v[128:131]
    ds_read_b128 v[244:247], v1 offset:54272
    v_mfma_f32_16x16x32_bf16 v[132:135], v[188:191], v[164:167], v[132:135]
    v_mfma_f32_16x16x32_bf16 v[136:139], v[192:195], v[160:163], v[136:139]
    v_lshrrev_b32 v0, 4, v1
    v_mfma_f32_16x16x32_bf16 v[140:143], v[192:195], v[164:167], v[140:143]
    v_and_b32 v0, 48, v0
    v_mfma_f32_16x16x32_bf16 v[144:147], v[196:199], v[160:163], v[144:147]
    v_add_u32 v0, 160320, v0
    v_mfma_f32_16x16x32_bf16 v[148:151], v[196:199], v[164:167], v[148:151]
    v_mfma_f32_16x16x32_bf16 v[152:155], v[200:203], v[160:163], v[152:155]
    v_mfma_f32_16x16x32_bf16 v[156:159], v[200:203], v[164:167], v[156:159]
    s_waitcnt lgkmcnt(0)
    v_mfma_f32_16x16x32_bf16 v[88:91], v[212:215], v[204:207], v[88:91]
    ds_read_b128 v[168:171], v0 offset:0
    v_mfma_f32_16x16x32_bf16 v[92:95], v[212:215], v[208:211], v[92:95]
    ds_read_b128 v[172:175], v0 offset:64
    v_mfma_f32_16x16x32_bf16 v[96:99], v[216:219], v[204:207], v[96:99]
    ds_read_b128 v[176:179], v0 offset:128
    v_mfma_f32_16x16x32_bf16 v[100:103], v[216:219], v[208:211], v[100:103]
    ds_read_b128 v[180:183], v0 offset:192
    v_mfma_f32_16x16x32_bf16 v[104:107], v[220:223], v[204:207], v[104:107]
    ds_read_b128 v[184:187], v0 offset:256
    v_mfma_f32_16x16x32_bf16 v[108:111], v[220:223], v[208:211], v[108:111]
    ds_read_b128 v[188:191], v0 offset:320
    v_mfma_f32_16x16x32_bf16 v[112:115], v[224:227], v[204:207], v[112:115]
    ds_read_b128 v[192:195], v0 offset:384
    v_mfma_f32_16x16x32_bf16 v[116:119], v[224:227], v[208:211], v[116:119]
    ds_read_b128 v[196:199], v0 offset:448
    v_mfma_f32_16x16x32_bf16 v[120:123], v[228:231], v[204:207], v[120:123]
    ds_read_b128 v[200:203], v0 offset:512
    v_mfma_f32_16x16x32_bf16 v[124:127], v[228:231], v[208:211], v[124:127]
    ds_read_u16 v12, v13
    v_mfma_f32_16x16x32_bf16 v[128:131], v[232:235], v[204:207], v[128:131]
    ds_read_u16 v252, v13 offset:32
    v_mfma_f32_16x16x32_bf16 v[132:135], v[232:235], v[208:211], v[132:135]
    v_mfma_f32_16x16x32_bf16 v[136:139], v[236:239], v[204:207], v[136:139]
    s_lshr_b32 s35, s20, 1
    s_mul_i32 s35, s35, 36864
    v_mfma_f32_16x16x32_bf16 v[140:143], v[236:239], v[208:211], v[140:143]
    s_and_b32 s34, s20, 1
    s_mul_i32 s34, s34, 9216
    v_mfma_f32_16x16x32_bf16 v[144:147], v[240:243], v[204:207], v[144:147]
    s_add_u32 s35, s35, s34
    v_mfma_f32_16x16x32_bf16 v[148:151], v[240:243], v[208:211], v[148:151]
    v_add_u32 v3, s35, v2
    v_mfma_f32_16x16x32_bf16 v[152:155], v[244:247], v[204:207], v[152:155]
    v_mfma_f32_16x16x32_bf16 v[156:159], v[244:247], v[208:211], v[156:159]
    s_waitcnt vmcnt(0)
    s_barrier
    s_waitcnt lgkmcnt(0)
    v_lshlrev_b32 v15, 16, v12
    v_lshlrev_b32 v255, 16, v252
    v_lshlrev_b32 v14, 16, v12
    v_lshlrev_b32 v254, 16, v252
    v_lshlrev_b32 v13, 16, v12
    v_lshlrev_b32 v253, 16, v252
    v_lshlrev_b32 v12, 16, v12
    v_lshlrev_b32 v252, 16, v252
    ds_write_b128 v3, v[16:19] offset:0
    v_pk_fma_f32 v[88:89], v[248:249], v[168:169], v[88:89] op_sel_hi:[0,1,1] neg_lo:[1,0,0] neg_hi:[1,0,0]
    v_pk_fma_f32 v[90:91], v[248:249], v[170:171], v[90:91] op_sel_hi:[0,1,1] neg_lo:[1,0,0] neg_hi:[1,0,0]
    v_pk_fma_f32 v[92:93], v[250:251], v[168:169], v[92:93] op_sel_hi:[0,1,1] neg_lo:[1,0,0] neg_hi:[1,0,0]
    v_pk_fma_f32 v[94:95], v[250:251], v[170:171], v[94:95] op_sel_hi:[0,1,1] neg_lo:[1,0,0] neg_hi:[1,0,0]
    ds_write_b128 v3, v[24:27] offset:1024
    v_pk_fma_f32 v[96:97], v[248:249], v[172:173], v[96:97] op_sel_hi:[0,1,1] neg_lo:[1,0,0] neg_hi:[1,0,0]
    v_pk_fma_f32 v[98:99], v[248:249], v[174:175], v[98:99] op_sel_hi:[0,1,1] neg_lo:[1,0,0] neg_hi:[1,0,0]
    v_pk_fma_f32 v[100:101], v[250:251], v[172:173], v[100:101] op_sel_hi:[0,1,1] neg_lo:[1,0,0] neg_hi:[1,0,0]
    v_pk_fma_f32 v[102:103], v[250:251], v[174:175], v[102:103] op_sel_hi:[0,1,1] neg_lo:[1,0,0] neg_hi:[1,0,0]
    ds_write_b128 v3, v[32:35] offset:2048
    v_pk_fma_f32 v[104:105], v[248:249], v[176:177], v[104:105] op_sel_hi:[0,1,1] neg_lo:[1,0,0] neg_hi:[1,0,0]
    v_pk_fma_f32 v[106:107], v[248:249], v[178:179], v[106:107] op_sel_hi:[0,1,1] neg_lo:[1,0,0] neg_hi:[1,0,0]
    v_pk_fma_f32 v[108:109], v[250:251], v[176:177], v[108:109] op_sel_hi:[0,1,1] neg_lo:[1,0,0] neg_hi:[1,0,0]
    v_pk_fma_f32 v[110:111], v[250:251], v[178:179], v[110:111] op_sel_hi:[0,1,1] neg_lo:[1,0,0] neg_hi:[1,0,0]
    ds_write_b128 v3, v[40:43] offset:3072
    v_pk_fma_f32 v[112:113], v[248:249], v[180:181], v[112:113] op_sel_hi:[0,1,1] neg_lo:[1,0,0] neg_hi:[1,0,0]
    v_pk_fma_f32 v[114:115], v[248:249], v[182:183], v[114:115] op_sel_hi:[0,1,1] neg_lo:[1,0,0] neg_hi:[1,0,0]
    v_pk_fma_f32 v[116:117], v[250:251], v[180:181], v[116:117] op_sel_hi:[0,1,1] neg_lo:[1,0,0] neg_hi:[1,0,0]
    v_pk_fma_f32 v[118:119], v[250:251], v[182:183], v[118:119] op_sel_hi:[0,1,1] neg_lo:[1,0,0] neg_hi:[1,0,0]
    ds_write_b128 v3, v[48:51] offset:4096
    v_pk_fma_f32 v[120:121], v[248:249], v[184:185], v[120:121] op_sel_hi:[0,1,1] neg_lo:[1,0,0] neg_hi:[1,0,0]
    v_pk_fma_f32 v[122:123], v[248:249], v[186:187], v[122:123] op_sel_hi:[0,1,1] neg_lo:[1,0,0] neg_hi:[1,0,0]
    v_pk_fma_f32 v[124:125], v[250:251], v[184:185], v[124:125] op_sel_hi:[0,1,1] neg_lo:[1,0,0] neg_hi:[1,0,0]
    v_pk_fma_f32 v[126:127], v[250:251], v[186:187], v[126:127] op_sel_hi:[0,1,1] neg_lo:[1,0,0] neg_hi:[1,0,0]
    ds_write_b128 v3, v[56:59] offset:5120
    v_pk_fma_f32 v[128:129], v[248:249], v[188:189], v[128:129] op_sel_hi:[0,1,1] neg_lo:[1,0,0] neg_hi:[1,0,0]
    v_pk_fma_f32 v[130:131], v[248:249], v[190:191], v[130:131] op_sel_hi:[0,1,1] neg_lo:[1,0,0] neg_hi:[1,0,0]
    v_pk_fma_f32 v[132:133], v[250:251], v[188:189], v[132:133] op_sel_hi:[0,1,1] neg_lo:[1,0,0] neg_hi:[1,0,0]
    v_pk_fma_f32 v[134:135], v[250:251], v[190:191], v[134:135] op_sel_hi:[0,1,1] neg_lo:[1,0,0] neg_hi:[1,0,0]
    ds_write_b128 v3, v[64:67] offset:6144
    v_pk_fma_f32 v[136:137], v[248:249], v[192:193], v[136:137] op_sel_hi:[0,1,1] neg_lo:[1,0,0] neg_hi:[1,0,0]
    v_pk_fma_f32 v[138:139], v[248:249], v[194:195], v[138:139] op_sel_hi:[0,1,1] neg_lo:[1,0,0] neg_hi:[1,0,0]
    v_pk_fma_f32 v[140:141], v[250:251], v[192:193], v[140:141] op_sel_hi:[0,1,1] neg_lo:[1,0,0] neg_hi:[1,0,0]
    v_pk_fma_f32 v[142:143], v[250:251], v[194:195], v[142:143] op_sel_hi:[0,1,1] neg_lo:[1,0,0] neg_hi:[1,0,0]
    ds_write_b128 v3, v[72:75] offset:7168
    v_pk_fma_f32 v[144:145], v[248:249], v[196:197], v[144:145] op_sel_hi:[0,1,1] neg_lo:[1,0,0] neg_hi:[1,0,0]
    v_pk_fma_f32 v[146:147], v[248:249], v[198:199], v[146:147] op_sel_hi:[0,1,1] neg_lo:[1,0,0] neg_hi:[1,0,0]
    v_pk_fma_f32 v[148:149], v[250:251], v[196:197], v[148:149] op_sel_hi:[0,1,1] neg_lo:[1,0,0] neg_hi:[1,0,0]
    v_pk_fma_f32 v[150:151], v[250:251], v[198:199], v[150:151] op_sel_hi:[0,1,1] neg_lo:[1,0,0] neg_hi:[1,0,0]
    ds_write_b128 v3, v[80:83] offset:8192
    v_pk_fma_f32 v[152:153], v[248:249], v[200:201], v[152:153] op_sel_hi:[0,1,1] neg_lo:[1,0,0] neg_hi:[1,0,0]
    v_pk_fma_f32 v[154:155], v[248:249], v[202:203], v[154:155] op_sel_hi:[0,1,1] neg_lo:[1,0,0] neg_hi:[1,0,0]
    v_pk_fma_f32 v[156:157], v[250:251], v[200:201], v[156:157] op_sel_hi:[0,1,1] neg_lo:[1,0,0] neg_hi:[1,0,0]
    v_pk_fma_f32 v[158:159], v[250:251], v[202:203], v[158:159] op_sel_hi:[0,1,1] neg_lo:[1,0,0] neg_hi:[1,0,0]
    v_pk_mul_f32 v[204:205], v[88:89], v[88:89]
    v_pk_mul_f32 v[206:207], v[90:91], v[90:91]
    v_pk_mul_f32 v[208:209], v[92:93], v[92:93]
    v_pk_mul_f32 v[210:211], v[94:95], v[94:95]
    v_pk_fma_f32 v[204:205], v[204:205], v[4:5], v[4:5] op_sel:[0,1,0] op_sel_hi:[1,1,0]
    v_pk_fma_f32 v[206:207], v[206:207], v[4:5], v[4:5] op_sel:[0,1,0] op_sel_hi:[1,1,0]
    v_pk_fma_f32 v[208:209], v[208:209], v[6:7], v[6:7] op_sel:[0,1,0] op_sel_hi:[1,1,0]
    v_pk_fma_f32 v[210:211], v[210:211], v[6:7], v[6:7] op_sel:[0,1,0] op_sel_hi:[1,1,0]
    v_pk_mul_f32 v[204:205], v[204:205], v[88:89]
    v_pk_mul_f32 v[206:207], v[206:207], v[90:91]
    v_pk_mul_f32 v[208:209], v[208:209], v[92:93]
    v_pk_mul_f32 v[210:211], v[210:211], v[94:95]
    v_exp_f32 v204, v204
    v_exp_f32 v205, v205
    v_exp_f32 v206, v206
    v_exp_f32 v207, v207
    v_exp_f32 v208, v208
    v_exp_f32 v209, v209
    v_exp_f32 v210, v210
    v_exp_f32 v211, v211
    v_pk_fma_f32 v[204:205], v[204:205], v[248:249], v[248:249] op_sel:[0,1,1] op_sel_hi:[1,1,1]
    v_pk_fma_f32 v[206:207], v[206:207], v[248:249], v[248:249] op_sel:[0,1,1] op_sel_hi:[1,1,1]
    v_pk_fma_f32 v[208:209], v[208:209], v[250:251], v[250:251] op_sel:[0,1,1] op_sel_hi:[1,1,1]
    v_pk_fma_f32 v[210:211], v[210:211], v[250:251], v[250:251] op_sel:[0,1,1] op_sel_hi:[1,1,1]
    v_rcp_f32 v204, v204
    v_rcp_f32 v205, v205
    v_rcp_f32 v206, v206
    v_rcp_f32 v207, v207
    v_rcp_f32 v208, v208
    v_rcp_f32 v209, v209
    v_rcp_f32 v210, v210
    v_rcp_f32 v211, v211
    v_pk_mul_f32 v[88:89], v[88:89], v[204:205]
    v_pk_mul_f32 v[90:91], v[90:91], v[206:207]
    v_pk_mul_f32 v[92:93], v[92:93], v[208:209]
    v_pk_mul_f32 v[94:95], v[94:95], v[210:211]
    v_pk_mul_f32 v[212:213], v[96:97], v[96:97]
    v_pk_mul_f32 v[214:215], v[98:99], v[98:99]
    v_pk_mul_f32 v[216:217], v[100:101], v[100:101]
    v_pk_mul_f32 v[218:219], v[102:103], v[102:103]
    v_pk_fma_f32 v[212:213], v[212:213], v[4:5], v[4:5] op_sel:[0,1,0] op_sel_hi:[1,1,0]
    v_pk_fma_f32 v[214:215], v[214:215], v[4:5], v[4:5] op_sel:[0,1,0] op_sel_hi:[1,1,0]
    v_pk_fma_f32 v[216:217], v[216:217], v[6:7], v[6:7] op_sel:[0,1,0] op_sel_hi:[1,1,0]
    v_pk_fma_f32 v[218:219], v[218:219], v[6:7], v[6:7] op_sel:[0,1,0] op_sel_hi:[1,1,0]
    v_pk_mul_f32 v[212:213], v[212:213], v[96:97]
    v_pk_mul_f32 v[214:215], v[214:215], v[98:99]
    v_pk_mul_f32 v[216:217], v[216:217], v[100:101]
    v_pk_mul_f32 v[218:219], v[218:219], v[102:103]
    v_exp_f32 v212, v212
    v_exp_f32 v213, v213
    v_exp_f32 v214, v214
    v_exp_f32 v215, v215
    v_exp_f32 v216, v216
    v_exp_f32 v217, v217
    v_exp_f32 v218, v218
    v_exp_f32 v219, v219
    v_pk_fma_f32 v[212:213], v[212:213], v[248:249], v[248:249] op_sel:[0,1,1] op_sel_hi:[1,1,1]
    v_pk_fma_f32 v[214:215], v[214:215], v[248:249], v[248:249] op_sel:[0,1,1] op_sel_hi:[1,1,1]
    v_pk_fma_f32 v[216:217], v[216:217], v[250:251], v[250:251] op_sel:[0,1,1] op_sel_hi:[1,1,1]
    v_pk_fma_f32 v[218:219], v[218:219], v[250:251], v[250:251] op_sel:[0,1,1] op_sel_hi:[1,1,1]
    v_rcp_f32 v212, v212
    v_rcp_f32 v213, v213
    v_rcp_f32 v214, v214
    v_rcp_f32 v215, v215
    v_rcp_f32 v216, v216
    v_rcp_f32 v217, v217
    v_rcp_f32 v218, v218
    v_rcp_f32 v219, v219
    v_pk_mul_f32 v[96:97], v[96:97], v[212:213]
    v_pk_mul_f32 v[98:99], v[98:99], v[214:215]
    v_pk_mul_f32 v[100:101], v[100:101], v[216:217]
    v_pk_mul_f32 v[102:103], v[102:103], v[218:219]
    v_pk_mul_f32 v[204:205], v[104:105], v[104:105]
    v_pk_mul_f32 v[206:207], v[106:107], v[106:107]
    v_pk_mul_f32 v[208:209], v[108:109], v[108:109]
    v_pk_mul_f32 v[210:211], v[110:111], v[110:111]
    v_pk_fma_f32 v[204:205], v[204:205], v[4:5], v[4:5] op_sel:[0,1,0] op_sel_hi:[1,1,0]
    v_pk_fma_f32 v[206:207], v[206:207], v[4:5], v[4:5] op_sel:[0,1,0] op_sel_hi:[1,1,0]
    v_pk_fma_f32 v[208:209], v[208:209], v[6:7], v[6:7] op_sel:[0,1,0] op_sel_hi:[1,1,0]
    v_pk_fma_f32 v[210:211], v[210:211], v[6:7], v[6:7] op_sel:[0,1,0] op_sel_hi:[1,1,0]
    v_pk_mul_f32 v[204:205], v[204:205], v[104:105]
    v_pk_mul_f32 v[206:207], v[206:207], v[106:107]
    v_pk_mul_f32 v[208:209], v[208:209], v[108:109]
    v_pk_mul_f32 v[210:211], v[210:211], v[110:111]
    v_exp_f32 v204, v204
    v_exp_f32 v205, v205
    v_exp_f32 v206, v206
    v_exp_f32 v207, v207
    v_exp_f32 v208, v208
    v_exp_f32 v209, v209
    v_exp_f32 v210, v210
    v_exp_f32 v211, v211
    v_pk_fma_f32 v[204:205], v[204:205], v[248:249], v[248:249] op_sel:[0,1,1] op_sel_hi:[1,1,1]
    v_pk_fma_f32 v[206:207], v[206:207], v[248:249], v[248:249] op_sel:[0,1,1] op_sel_hi:[1,1,1]
    v_pk_fma_f32 v[208:209], v[208:209], v[250:251], v[250:251] op_sel:[0,1,1] op_sel_hi:[1,1,1]
    v_pk_fma_f32 v[210:211], v[210:211], v[250:251], v[250:251] op_sel:[0,1,1] op_sel_hi:[1,1,1]
    v_rcp_f32 v204, v204
    v_rcp_f32 v205, v205
    v_rcp_f32 v206, v206
    v_rcp_f32 v207, v207
    v_rcp_f32 v208, v208
    v_rcp_f32 v209, v209
    v_rcp_f32 v210, v210
    v_rcp_f32 v211, v211
    v_pk_mul_f32 v[104:105], v[104:105], v[204:205]
    v_pk_mul_f32 v[106:107], v[106:107], v[206:207]
    v_pk_mul_f32 v[108:109], v[108:109], v[208:209]
    v_pk_mul_f32 v[110:111], v[110:111], v[210:211]
    s_waitcnt lgkmcnt(0)
    s_barrier
    ds_read_b128 v[160:163], v10 offset:0
    ds_read_b128 v[164:167], v10 offset:2048
    ds_read_b128 v[168:171], v2 offset:0
    ds_read_b128 v[172:175], v2 offset:1024
    ds_read_b128 v[176:179], v2 offset:2048
    ds_read_b128 v[180:183], v2 offset:3072
    ds_read_b128 v[184:187], v2 offset:4096
    ds_read_b128 v[188:191], v2 offset:5120
    ds_read_b128 v[192:195], v2 offset:6144
    ds_read_b128 v[196:199], v2 offset:7168
    ds_read_b128 v[200:203], v2 offset:8192
    v_pk_mul_f32 v[212:213], v[112:113], v[112:113]
    v_pk_mul_f32 v[214:215], v[114:115], v[114:115]
    v_pk_mul_f32 v[216:217], v[116:117], v[116:117]
    v_pk_mul_f32 v[218:219], v[118:119], v[118:119]
    v_pk_fma_f32 v[212:213], v[212:213], v[4:5], v[4:5] op_sel:[0,1,0] op_sel_hi:[1,1,0]
    v_pk_fma_f32 v[214:215], v[214:215], v[4:5], v[4:5] op_sel:[0,1,0] op_sel_hi:[1,1,0]
    v_pk_fma_f32 v[216:217], v[216:217], v[6:7], v[6:7] op_sel:[0,1,0] op_sel_hi:[1,1,0]
    v_pk_fma_f32 v[218:219], v[218:219], v[6:7], v[6:7] op_sel:[0,1,0] op_sel_hi:[1,1,0]
    v_pk_mul_f32 v[212:213], v[212:213], v[112:113]
    v_pk_mul_f32 v[214:215], v[214:215], v[114:115]
    v_pk_mul_f32 v[216:217], v[216:217], v[116:117]
    v_pk_mul_f32 v[218:219], v[218:219], v[118:119]
    v_exp_f32 v212, v212
    v_exp_f32 v213, v213
    v_exp_f32 v214, v214
    v_exp_f32 v215, v215
    v_exp_f32 v216, v216
    v_exp_f32 v217, v217
    v_exp_f32 v218, v218
    v_exp_f32 v219, v219
    v_pk_fma_f32 v[212:213], v[212:213], v[248:249], v[248:249] op_sel:[0,1,1] op_sel_hi:[1,1,1]
    v_pk_fma_f32 v[214:215], v[214:215], v[248:249], v[248:249] op_sel:[0,1,1] op_sel_hi:[1,1,1]
    v_pk_fma_f32 v[216:217], v[216:217], v[250:251], v[250:251] op_sel:[0,1,1] op_sel_hi:[1,1,1]
    v_pk_fma_f32 v[218:219], v[218:219], v[250:251], v[250:251] op_sel:[0,1,1] op_sel_hi:[1,1,1]
    v_rcp_f32 v212, v212
    v_rcp_f32 v213, v213
    v_rcp_f32 v214, v214
    v_rcp_f32 v215, v215
    v_rcp_f32 v216, v216
    v_rcp_f32 v217, v217
    v_rcp_f32 v218, v218
    v_rcp_f32 v219, v219
    v_pk_mul_f32 v[112:113], v[112:113], v[212:213]
    v_pk_mul_f32 v[114:115], v[114:115], v[214:215]
    v_pk_mul_f32 v[116:117], v[116:117], v[216:217]
    v_pk_mul_f32 v[118:119], v[118:119], v[218:219]
    s_waitcnt lgkmcnt(5)
    v_mfma_f32_16x16x32_bf16 v[16:19], v[168:171], v[160:163], v[12:15]
    ds_read_b128 v[204:207], v11 offset:0
    v_mfma_f32_16x16x32_bf16 v[20:23], v[168:171], v[164:167], v[252:255]
    ds_read_b128 v[208:211], v11 offset:2048
    v_mfma_f32_16x16x32_bf16 v[24:27], v[172:175], v[160:163], v[12:15]
    ds_read_b128 v[212:215], v2 offset:9216
    v_mfma_f32_16x16x32_bf16 v[28:31], v[172:175], v[164:167], v[252:255]
    ds_read_b128 v[216:219], v2 offset:10240
    v_mfma_f32_16x16x32_bf16 v[32:35], v[176:179], v[160:163], v[12:15]
    ds_read_b128 v[220:223], v2 offset:11264
    v_mfma_f32_16x16x32_bf16 v[36:39], v[176:179], v[164:167], v[252:255]
    ds_read_b128 v[224:227], v2 offset:12288
    v_mfma_f32_16x16x32_bf16 v[40:43], v[180:183], v[160:163], v[12:15]
    ds_read_b128 v[228:231], v2 offset:13312
    v_mfma_f32_16x16x32_bf16 v[44:47], v[180:183], v[164:167], v[252:255]
    ds_read_b128 v[232:235], v2 offset:14336
    s_waitcnt lgkmcnt(8)
    v_mfma_f32_16x16x32_bf16 v[48:51], v[184:187], v[160:163], v[12:15]
    ds_read_b128 v[236:239], v2 offset:15360
    v_mfma_f32_16x16x32_bf16 v[52:55], v[184:187], v[164:167], v[252:255]
    ds_read_b128 v[240:243], v2 offset:16384
    v_mfma_f32_16x16x32_bf16 v[56:59], v[188:191], v[160:163], v[12:15]
    ds_read_b128 v[244:247], v2 offset:17408
    v_mfma_f32_16x16x32_bf16 v[60:63], v[188:191], v[164:167], v[252:255]
    v_mfma_f32_16x16x32_bf16 v[64:67], v[192:195], v[160:163], v[12:15]
    v_mfma_f32_16x16x32_bf16 v[68:71], v[192:195], v[164:167], v[252:255]
    v_mfma_f32_16x16x32_bf16 v[72:75], v[196:199], v[160:163], v[12:15]
    v_mfma_f32_16x16x32_bf16 v[76:79], v[196:199], v[164:167], v[252:255]
    v_mfma_f32_16x16x32_bf16 v[80:83], v[200:203], v[160:163], v[12:15]
    v_mfma_f32_16x16x32_bf16 v[84:87], v[200:203], v[164:167], v[252:255]
    s_waitcnt lgkmcnt(0)
    s_barrier
    v_mfma_f32_16x16x32_bf16 v[16:19], v[212:215], v[204:207], v[16:19]
    ds_read_b128 v[160:163], v10 offset:36864
    v_mfma_f32_16x16x32_bf16 v[20:23], v[212:215], v[208:211], v[20:23]
    ds_read_b128 v[164:167], v10 offset:38912
    v_mfma_f32_16x16x32_bf16 v[24:27], v[216:219], v[204:207], v[24:27]
    ds_read_b128 v[168:171], v2 offset:36864
    v_mfma_f32_16x16x32_bf16 v[28:31], v[216:219], v[208:211], v[28:31]
    ds_read_b128 v[172:175], v2 offset:37888
    v_mul_f32 v12, v120, v120
    v_mfma_f32_16x16x32_bf16 v[32:35], v[220:223], v[204:207], v[32:35]
    ds_read_b128 v[176:179], v2 offset:38912
    v_mul_f32 v13, v121, v121
    v_mfma_f32_16x16x32_bf16 v[36:39], v[220:223], v[208:211], v[36:39]
    ds_read_b128 v[180:183], v2 offset:39936
    v_mul_f32 v14, v122, v122
    v_mfma_f32_16x16x32_bf16 v[40:43], v[224:227], v[204:207], v[40:43]
    ds_read_b128 v[184:187], v2 offset:40960
    v_mul_f32 v15, v123, v123
    v_mfma_f32_16x16x32_bf16 v[44:47], v[224:227], v[208:211], v[44:47]
    ds_read_b128 v[188:191], v2 offset:41984
    v_mfma_f32_16x16x32_bf16 v[48:51], v[228:231], v[204:207], v[48:51]
    ds_read_b128 v[192:195], v2 offset:43008
    v_mul_f32 v252, v124, v124
    v_mfma_f32_16x16x32_bf16 v[52:55], v[228:231], v[208:211], v[52:55]
    ds_read_b128 v[196:199], v2 offset:44032
    v_mul_f32 v253, v125, v125
    v_mfma_f32_16x16x32_bf16 v[56:59], v[232:235], v[204:207], v[56:59]
    ds_read_b128 v[200:203], v2 offset:45056
    v_mul_f32 v254, v126, v126
    v_mfma_f32_16x16x32_bf16 v[60:63], v[232:235], v[208:211], v[60:63]
    v_mul_f32 v255, v127, v127
    v_fma_f32 v12, v12, v5, v4
    v_mfma_f32_16x16x32_bf16 v[64:67], v[236:239], v[204:207], v[64:67]
    v_fma_f32 v13, v13, v5, v4
    v_fma_f32 v14, v14, v5, v4
    v_mfma_f32_16x16x32_bf16 v[68:71], v[236:239], v[208:211], v[68:71]
    v_fma_f32 v15, v15, v5, v4
    v_fma_f32 v252, v252, v7, v6
    v_mfma_f32_16x16x32_bf16 v[72:75], v[240:243], v[204:207], v[72:75]
    v_fma_f32 v253, v253, v7, v6
    v_fma_f32 v254, v254, v7, v6
    v_mfma_f32_16x16x32_bf16 v[76:79], v[240:243], v[208:211], v[76:79]
    v_fma_f32 v255, v255, v7, v6
    v_mul_f32 v12, v12, v120
    v_mfma_f32_16x16x32_bf16 v[80:83], v[244:247], v[204:207], v[80:83]
    v_mul_f32 v13, v13, v121
    v_mul_f32 v14, v14, v122
    v_mfma_f32_16x16x32_bf16 v[84:87], v[244:247], v[208:211], v[84:87]
    v_mul_f32 v15, v15, v123
    s_waitcnt lgkmcnt(5)
    v_mfma_f32_16x16x32_bf16 v[16:19], v[168:171], v[160:163], v[16:19]
    ds_read_b128 v[204:207], v11 offset:36864
    v_mfma_f32_16x16x32_bf16 v[20:23], v[168:171], v[164:167], v[20:23]
    ds_read_b128 v[208:211], v11 offset:38912
    v_mul_f32 v252, v252, v124
    v_mfma_f32_16x16x32_bf16 v[24:27], v[172:175], v[160:163], v[24:27]
    ds_read_b128 v[212:215], v2 offset:46080
    v_mul_f32 v253, v253, v125
    v_mfma_f32_16x16x32_bf16 v[28:31], v[172:175], v[164:167], v[28:31]
    ds_read_b128 v[216:219], v2 offset:47104
    v_mul_f32 v254, v254, v126
    v_mfma_f32_16x16x32_bf16 v[32:35], v[176:179], v[160:163], v[32:35]
    ds_read_b128 v[220:223], v2 offset:48128
    v_mul_f32 v255, v255, v127
    v_mfma_f32_16x16x32_bf16 v[36:39], v[176:179], v[164:167], v[36:39]
    ds_read_b128 v[224:227], v2 offset:49152
    v_exp_f32 v12, v12
    v_mfma_f32_16x16x32_bf16 v[40:43], v[180:183], v[160:163], v[40:43]
    ds_read_b128 v[228:231], v2 offset:50176
    v_exp_f32 v13, v13
    v_mfma_f32_16x16x32_bf16 v[44:47], v[180:183], v[164:167], v[44:47]
    ds_read_b128 v[232:235], v2 offset:51200
    s_waitcnt lgkmcnt(8)
    v_mfma_f32_16x16x32_bf16 v[48:51], v[184:187], v[160:163], v[48:51]
    ds_read_b128 v[236:239], v2 offset:52224
    v_exp_f32 v14, v14
    v_mfma_f32_16x16x32_bf16 v[52:55], v[184:187], v[164:167], v[52:55]
    ds_read_b128 v[240:243], v2 offset:53248
    v_exp_f32 v15, v15
    v_mfma_f32_16x16x32_bf16 v[56:59], v[188:191], v[160:163], v[56:59]
    ds_read_b128 v[244:247], v2 offset:54272
    v_exp_f32 v252, v252
    v_mfma_f32_16x16x32_bf16 v[60:63], v[188:191], v[164:167], v[60:63]
    v_exp_f32 v253, v253
    v_mfma_f32_16x16x32_bf16 v[64:67], v[192:195], v[160:163], v[64:67]
    v_exp_f32 v254, v254
    v_mfma_f32_16x16x32_bf16 v[68:71], v[192:195], v[164:167], v[68:71]
    v_exp_f32 v255, v255
    v_mfma_f32_16x16x32_bf16 v[72:75], v[196:199], v[160:163], v[72:75]
    v_fma_f32 v12, v12, v249, v249
    v_fma_f32 v13, v13, v249, v249
    v_mfma_f32_16x16x32_bf16 v[76:79], v[196:199], v[164:167], v[76:79]
    v_fma_f32 v14, v14, v249, v249
    v_fma_f32 v15, v15, v249, v249
    v_mfma_f32_16x16x32_bf16 v[80:83], v[200:203], v[160:163], v[80:83]
    v_fma_f32 v252, v252, v251, v251
    v_fma_f32 v253, v253, v251, v251
    v_mfma_f32_16x16x32_bf16 v[84:87], v[200:203], v[164:167], v[84:87]
    v_fma_f32 v254, v254, v251, v251
    s_waitcnt lgkmcnt(0)
    s_barrier
    v_mfma_f32_16x16x32_bf16 v[16:19], v[212:215], v[204:207], v[16:19]
    ds_read_b128 v[160:163], v8 offset:0
    v_mfma_f32_16x16x32_bf16 v[20:23], v[212:215], v[208:211], v[20:23]
    ds_read_b128 v[164:167], v8 offset:2048
    v_fma_f32 v255, v255, v251, v251
    v_mfma_f32_16x16x32_bf16 v[24:27], v[216:219], v[204:207], v[24:27]
    ds_read_b128 v[168:171], v1 offset:0
    v_rcp_f32 v12, v12
    v_mfma_f32_16x16x32_bf16 v[28:31], v[216:219], v[208:211], v[28:31]
    ds_read_b128 v[172:175], v1 offset:1024
    v_rcp_f32 v13, v13
    v_mfma_f32_16x16x32_bf16 v[32:35], v[220:223], v[204:207], v[32:35]
    ds_read_b128 v[176:179], v1 offset:2048
    v_rcp_f32 v14, v14
    v_mfma_f32_16x16x32_bf16 v[36:39], v[220:223], v[208:211], v[36:39]
    ds_read_b128 v[180:183], v1 offset:3072
    v_rcp_f32 v15, v15
    v_mfma_f32_16x16x32_bf16 v[40:43], v[224:227], v[204:207], v[40:43]
    ds_read_b128 v[184:187], v1 offset:4096
    v_rcp_f32 v252, v252
    v_mfma_f32_16x16x32_bf16 v[44:47], v[224:227], v[208:211], v[44:47]
    ds_read_b128 v[188:191], v1 offset:5120
    v_mfma_f32_16x16x32_bf16 v[48:51], v[228:231], v[204:207], v[48:51]
    ds_read_b128 v[192:195], v1 offset:6144
    v_rcp_f32 v253, v253
    v_mfma_f32_16x16x32_bf16 v[52:55], v[228:231], v[208:211], v[52:55]
    ds_read_b128 v[196:199], v1 offset:7168
    v_rcp_f32 v254, v254
    v_mfma_f32_16x16x32_bf16 v[56:59], v[232:235], v[204:207], v[56:59]
    ds_read_b128 v[200:203], v1 offset:8192
    v_rcp_f32 v255, v255
    v_mfma_f32_16x16x32_bf16 v[60:63], v[232:235], v[208:211], v[60:63]
    v_mul_f32 v120, v120, v12
    v_mul_f32 v121, v121, v13
    v_mfma_f32_16x16x32_bf16 v[64:67], v[236:239], v[204:207], v[64:67]
    v_mul_f32 v122, v122, v14
    v_mul_f32 v123, v123, v15
    v_mfma_f32_16x16x32_bf16 v[68:71], v[236:239], v[208:211], v[68:71]
    v_mul_f32 v124, v124, v252
    v_mul_f32 v125, v125, v253
    v_mfma_f32_16x16x32_bf16 v[72:75], v[240:243], v[204:207], v[72:75]
    v_mul_f32 v126, v126, v254
    v_mul_f32 v127, v127, v255
    v_mfma_f32_16x16x32_bf16 v[76:79], v[240:243], v[208:211], v[76:79]
    v_mul_f32 v12, v128, v128
    v_mul_f32 v13, v129, v129
    v_mfma_f32_16x16x32_bf16 v[80:83], v[244:247], v[204:207], v[80:83]
    v_mul_f32 v14, v130, v130
    v_mul_f32 v15, v131, v131
    v_mfma_f32_16x16x32_bf16 v[84:87], v[244:247], v[208:211], v[84:87]
    v_mul_f32 v252, v132, v132
    s_waitcnt lgkmcnt(5)
    v_mfma_f32_16x16x32_bf16 v[16:19], v[168:171], v[160:163], v[16:19]
    ds_read_b128 v[204:207], v9 offset:0
    v_mfma_f32_16x16x32_bf16 v[20:23], v[168:171], v[164:167], v[20:23]
    ds_read_b128 v[208:211], v9 offset:2048
    v_mul_f32 v253, v133, v133
    v_mfma_f32_16x16x32_bf16 v[24:27], v[172:175], v[160:163], v[24:27]
    ds_read_b128 v[212:215], v1 offset:9216
    v_mul_f32 v254, v134, v134
    v_mfma_f32_16x16x32_bf16 v[28:31], v[172:175], v[164:167], v[28:31]
    ds_read_b128 v[216:219], v1 offset:10240
    v_mul_f32 v255, v135, v135
    v_mfma_f32_16x16x32_bf16 v[32:35], v[176:179], v[160:163], v[32:35]
    ds_read_b128 v[220:223], v1 offset:11264
    v_fma_f32 v12, v12, v5, v4
    v_mfma_f32_16x16x32_bf16 v[36:39], v[176:179], v[164:167], v[36:39]
    ds_read_b128 v[224:227], v1 offset:12288
    v_fma_f32 v13, v13, v5, v4
    v_mfma_f32_16x16x32_bf16 v[40:43], v[180:183], v[160:163], v[40:43]
    ds_read_b128 v[228:231], v1 offset:13312
    v_fma_f32 v14, v14, v5, v4
    v_mfma_f32_16x16x32_bf16 v[44:47], v[180:183], v[164:167], v[44:47]
    ds_read_b128 v[232:235], v1 offset:14336
    s_waitcnt lgkmcnt(8)
    v_mfma_f32_16x16x32_bf16 v[48:51], v[184:187], v[160:163], v[48:51]
    ds_read_b128 v[236:239], v1 offset:15360
    v_fma_f32 v15, v15, v5, v4
    v_mfma_f32_16x16x32_bf16 v[52:55], v[184:187], v[164:167], v[52:55]
    ds_read_b128 v[240:243], v1 offset:16384
    v_fma_f32 v252, v252, v7, v6
    v_mfma_f32_16x16x32_bf16 v[56:59], v[188:191], v[160:163], v[56:59]
    ds_read_b128 v[244:247], v1 offset:17408
    v_fma_f32 v253, v253, v7, v6
    v_mfma_f32_16x16x32_bf16 v[60:63], v[188:191], v[164:167], v[60:63]
    v_fma_f32 v254, v254, v7, v6
    v_fma_f32 v255, v255, v7, v6
    v_mfma_f32_16x16x32_bf16 v[64:67], v[192:195], v[160:163], v[64:67]
    v_mul_f32 v12, v12, v128
    v_mul_f32 v13, v13, v129
    v_mfma_f32_16x16x32_bf16 v[68:71], v[192:195], v[164:167], v[68:71]
    v_mul_f32 v14, v14, v130
    v_mul_f32 v15, v15, v131
    v_mfma_f32_16x16x32_bf16 v[72:75], v[196:199], v[160:163], v[72:75]
    v_mul_f32 v252, v252, v132
    v_mul_f32 v253, v253, v133
    v_mfma_f32_16x16x32_bf16 v[76:79], v[196:199], v[164:167], v[76:79]
    v_mul_f32 v254, v254, v134
    v_mul_f32 v255, v255, v135
    v_mfma_f32_16x16x32_bf16 v[80:83], v[200:203], v[160:163], v[80:83]
    v_exp_f32 v12, v12
    v_mfma_f32_16x16x32_bf16 v[84:87], v[200:203], v[164:167], v[84:87]
    v_exp_f32 v13, v13
    s_waitcnt lgkmcnt(0)
    s_barrier
    v_mfma_f32_16x16x32_bf16 v[16:19], v[212:215], v[204:207], v[16:19]
    ds_read_b128 v[160:163], v8 offset:36864
    v_mfma_f32_16x16x32_bf16 v[20:23], v[212:215], v[208:211], v[20:23]
    ds_read_b128 v[164:167], v8 offset:38912
    v_exp_f32 v14, v14
    v_mfma_f32_16x16x32_bf16 v[24:27], v[216:219], v[204:207], v[24:27]
    ds_read_b128 v[168:171], v1 offset:36864
    v_exp_f32 v15, v15
    v_mfma_f32_16x16x32_bf16 v[28:31], v[216:219], v[208:211], v[28:31]
    ds_read_b128 v[172:175], v1 offset:37888
    v_exp_f32 v252, v252
    v_mfma_f32_16x16x32_bf16 v[32:35], v[220:223], v[204:207], v[32:35]
    ds_read_b128 v[176:179], v1 offset:38912
    v_exp_f32 v253, v253
    v_mfma_f32_16x16x32_bf16 v[36:39], v[220:223], v[208:211], v[36:39]
    ds_read_b128 v[180:183], v1 offset:39936
    v_exp_f32 v254, v254
    v_mfma_f32_16x16x32_bf16 v[40:43], v[224:227], v[204:207], v[40:43]
    ds_read_b128 v[184:187], v1 offset:40960
    v_exp_f32 v255, v255
    v_mfma_f32_16x16x32_bf16 v[44:47], v[224:227], v[208:211], v[44:47]
    ds_read_b128 v[188:191], v1 offset:41984
    v_mfma_f32_16x16x32_bf16 v[48:51], v[228:231], v[204:207], v[48:51]
    ds_read_b128 v[192:195], v1 offset:43008
    v_fma_f32 v12, v12, v249, v249
    v_mfma_f32_16x16x32_bf16 v[52:55], v[228:231], v[208:211], v[52:55]
    ds_read_b128 v[196:199], v1 offset:44032
    v_fma_f32 v13, v13, v249, v249
    v_mfma_f32_16x16x32_bf16 v[56:59], v[232:235], v[204:207], v[56:59]
    ds_read_b128 v[200:203], v1 offset:45056
    v_fma_f32 v14, v14, v249, v249
    v_mfma_f32_16x16x32_bf16 v[60:63], v[232:235], v[208:211], v[60:63]
    v_fma_f32 v15, v15, v249, v249
    v_fma_f32 v252, v252, v251, v251
    v_mfma_f32_16x16x32_bf16 v[64:67], v[236:239], v[204:207], v[64:67]
    v_fma_f32 v253, v253, v251, v251
    v_fma_f32 v254, v254, v251, v251
    v_mfma_f32_16x16x32_bf16 v[68:71], v[236:239], v[208:211], v[68:71]
    v_fma_f32 v255, v255, v251, v251
    v_rcp_f32 v12, v12
    v_mfma_f32_16x16x32_bf16 v[72:75], v[240:243], v[204:207], v[72:75]
    v_rcp_f32 v13, v13
    v_mfma_f32_16x16x32_bf16 v[76:79], v[240:243], v[208:211], v[76:79]
    v_rcp_f32 v14, v14
    v_mfma_f32_16x16x32_bf16 v[80:83], v[244:247], v[204:207], v[80:83]
    v_rcp_f32 v15, v15
    v_mfma_f32_16x16x32_bf16 v[84:87], v[244:247], v[208:211], v[84:87]
    v_rcp_f32 v252, v252
    s_waitcnt lgkmcnt(5)
    v_mfma_f32_16x16x32_bf16 v[16:19], v[168:171], v[160:163], v[16:19]
    ds_read_b128 v[204:207], v9 offset:36864
    v_mfma_f32_16x16x32_bf16 v[20:23], v[168:171], v[164:167], v[20:23]
    ds_read_b128 v[208:211], v9 offset:38912
    v_rcp_f32 v253, v253
    v_mfma_f32_16x16x32_bf16 v[24:27], v[172:175], v[160:163], v[24:27]
    ds_read_b128 v[212:215], v1 offset:46080
    v_rcp_f32 v254, v254
    v_mfma_f32_16x16x32_bf16 v[28:31], v[172:175], v[164:167], v[28:31]
    ds_read_b128 v[216:219], v1 offset:47104
    v_rcp_f32 v255, v255
    v_mfma_f32_16x16x32_bf16 v[32:35], v[176:179], v[160:163], v[32:35]
    ds_read_b128 v[220:223], v1 offset:48128
    v_mul_f32 v128, v128, v12
    v_mfma_f32_16x16x32_bf16 v[36:39], v[176:179], v[164:167], v[36:39]
    ds_read_b128 v[224:227], v1 offset:49152
    v_mul_f32 v129, v129, v13
    v_mfma_f32_16x16x32_bf16 v[40:43], v[180:183], v[160:163], v[40:43]
    ds_read_b128 v[228:231], v1 offset:50176
    v_mul_f32 v130, v130, v14
    v_mfma_f32_16x16x32_bf16 v[44:47], v[180:183], v[164:167], v[44:47]
    ds_read_b128 v[232:235], v1 offset:51200
    s_waitcnt lgkmcnt(8)
    v_mfma_f32_16x16x32_bf16 v[48:51], v[184:187], v[160:163], v[48:51]
    ds_read_b128 v[236:239], v1 offset:52224
    v_mul_f32 v131, v131, v15
    v_mfma_f32_16x16x32_bf16 v[52:55], v[184:187], v[164:167], v[52:55]
    ds_read_b128 v[240:243], v1 offset:53248
    v_mul_f32 v132, v132, v252
    v_mfma_f32_16x16x32_bf16 v[56:59], v[188:191], v[160:163], v[56:59]
    ds_read_b128 v[244:247], v1 offset:54272
    v_mul_f32 v133, v133, v253
    v_mfma_f32_16x16x32_bf16 v[60:63], v[188:191], v[164:167], v[60:63]
    v_mul_f32 v134, v134, v254
    v_mul_f32 v135, v135, v255
    v_mfma_f32_16x16x32_bf16 v[64:67], v[192:195], v[160:163], v[64:67]
    v_mul_f32 v12, v136, v136
    v_mul_f32 v13, v137, v137
    v_mfma_f32_16x16x32_bf16 v[68:71], v[192:195], v[164:167], v[68:71]
    v_mul_f32 v14, v138, v138
    v_mul_f32 v15, v139, v139
    v_mfma_f32_16x16x32_bf16 v[72:75], v[196:199], v[160:163], v[72:75]
    v_mul_f32 v252, v140, v140
    v_mul_f32 v253, v141, v141
    v_mfma_f32_16x16x32_bf16 v[76:79], v[196:199], v[164:167], v[76:79]
    v_mul_f32 v254, v142, v142
    v_mul_f32 v255, v143, v143
    v_mfma_f32_16x16x32_bf16 v[80:83], v[200:203], v[160:163], v[80:83]
    v_fma_f32 v12, v12, v5, v4
    v_fma_f32 v13, v13, v5, v4
    v_mfma_f32_16x16x32_bf16 v[84:87], v[200:203], v[164:167], v[84:87]
    v_fma_f32 v14, v14, v5, v4
    s_waitcnt lgkmcnt(0)
    s_barrier
    v_mfma_f32_16x16x32_bf16 v[16:19], v[212:215], v[204:207], v[16:19]
    ds_read_b128 v[160:163], v10 offset:0
    v_mfma_f32_16x16x32_bf16 v[20:23], v[212:215], v[208:211], v[20:23]
    ds_read_b128 v[164:167], v10 offset:2048
    v_fma_f32 v15, v15, v5, v4
    v_mfma_f32_16x16x32_bf16 v[24:27], v[216:219], v[204:207], v[24:27]
    ds_read_b128 v[168:171], v2 offset:0
    v_fma_f32 v252, v252, v7, v6
    v_mfma_f32_16x16x32_bf16 v[28:31], v[216:219], v[208:211], v[28:31]
    ds_read_b128 v[172:175], v2 offset:1024
    v_fma_f32 v253, v253, v7, v6
    v_mfma_f32_16x16x32_bf16 v[32:35], v[220:223], v[204:207], v[32:35]
    ds_read_b128 v[176:179], v2 offset:2048
    v_fma_f32 v254, v254, v7, v6
    v_mfma_f32_16x16x32_bf16 v[36:39], v[220:223], v[208:211], v[36:39]
    ds_read_b128 v[180:183], v2 offset:3072
    v_fma_f32 v255, v255, v7, v6
    v_mfma_f32_16x16x32_bf16 v[40:43], v[224:227], v[204:207], v[40:43]
    ds_read_b128 v[184:187], v2 offset:4096
    v_mul_f32 v12, v12, v136
    v_mfma_f32_16x16x32_bf16 v[44:47], v[224:227], v[208:211], v[44:47]
    ds_read_b128 v[188:191], v2 offset:5120
    v_mfma_f32_16x16x32_bf16 v[48:51], v[228:231], v[204:207], v[48:51]
    ds_read_b128 v[192:195], v2 offset:6144
    v_mul_f32 v13, v13, v137
    v_mfma_f32_16x16x32_bf16 v[52:55], v[228:231], v[208:211], v[52:55]
    ds_read_b128 v[196:199], v2 offset:7168
    v_mul_f32 v14, v14, v138
    v_mfma_f32_16x16x32_bf16 v[56:59], v[232:235], v[204:207], v[56:59]
    ds_read_b128 v[200:203], v2 offset:8192
    v_mul_f32 v15, v15, v139
    v_mfma_f32_16x16x32_bf16 v[60:63], v[232:235], v[208:211], v[60:63]
    v_mul_f32 v252, v252, v140
    v_mul_f32 v253, v253, v141
    v_mfma_f32_16x16x32_bf16 v[64:67], v[236:239], v[204:207], v[64:67]
    v_mul_f32 v254, v254, v142
    v_mul_f32 v255, v255, v143
    v_mfma_f32_16x16x32_bf16 v[68:71], v[236:239], v[208:211], v[68:71]
    v_exp_f32 v12, v12
    v_mfma_f32_16x16x32_bf16 v[72:75], v[240:243], v[204:207], v[72:75]
    v_exp_f32 v13, v13
    v_mfma_f32_16x16x32_bf16 v[76:79], v[240:243], v[208:211], v[76:79]
    v_exp_f32 v14, v14
    v_mfma_f32_16x16x32_bf16 v[80:83], v[244:247], v[204:207], v[80:83]
    v_exp_f32 v15, v15
    v_mfma_f32_16x16x32_bf16 v[84:87], v[244:247], v[208:211], v[84:87]
    v_exp_f32 v252, v252
    s_waitcnt lgkmcnt(5)
    v_mfma_f32_16x16x32_bf16 v[16:19], v[168:171], v[160:163], v[16:19]
    ds_read_b128 v[204:207], v11 offset:0
    v_mfma_f32_16x16x32_bf16 v[20:23], v[168:171], v[164:167], v[20:23]
    ds_read_b128 v[208:211], v11 offset:2048
    v_exp_f32 v253, v253
    v_mfma_f32_16x16x32_bf16 v[24:27], v[172:175], v[160:163], v[24:27]
    ds_read_b128 v[212:215], v2 offset:9216
    v_exp_f32 v254, v254
    v_mfma_f32_16x16x32_bf16 v[28:31], v[172:175], v[164:167], v[28:31]
    ds_read_b128 v[216:219], v2 offset:10240
    v_exp_f32 v255, v255
    v_mfma_f32_16x16x32_bf16 v[32:35], v[176:179], v[160:163], v[32:35]
    ds_read_b128 v[220:223], v2 offset:11264
    v_fma_f32 v12, v12, v249, v249
    v_mfma_f32_16x16x32_bf16 v[36:39], v[176:179], v[164:167], v[36:39]
    ds_read_b128 v[224:227], v2 offset:12288
    v_fma_f32 v13, v13, v249, v249
    v_mfma_f32_16x16x32_bf16 v[40:43], v[180:183], v[160:163], v[40:43]
    ds_read_b128 v[228:231], v2 offset:13312
    v_fma_f32 v14, v14, v249, v249
    v_mfma_f32_16x16x32_bf16 v[44:47], v[180:183], v[164:167], v[44:47]
    ds_read_b128 v[232:235], v2 offset:14336
    s_waitcnt lgkmcnt(8)
    v_mfma_f32_16x16x32_bf16 v[48:51], v[184:187], v[160:163], v[48:51]
    ds_read_b128 v[236:239], v2 offset:15360
    v_fma_f32 v15, v15, v249, v249
    v_mfma_f32_16x16x32_bf16 v[52:55], v[184:187], v[164:167], v[52:55]
    ds_read_b128 v[240:243], v2 offset:16384
    v_fma_f32 v252, v252, v251, v251
    v_mfma_f32_16x16x32_bf16 v[56:59], v[188:191], v[160:163], v[56:59]
    ds_read_b128 v[244:247], v2 offset:17408
    v_fma_f32 v253, v253, v251, v251
    v_mfma_f32_16x16x32_bf16 v[60:63], v[188:191], v[164:167], v[60:63]
    v_fma_f32 v254, v254, v251, v251
    v_fma_f32 v255, v255, v251, v251
    v_mfma_f32_16x16x32_bf16 v[64:67], v[192:195], v[160:163], v[64:67]
    v_rcp_f32 v12, v12
    v_mfma_f32_16x16x32_bf16 v[68:71], v[192:195], v[164:167], v[68:71]
    v_rcp_f32 v13, v13
    v_mfma_f32_16x16x32_bf16 v[72:75], v[196:199], v[160:163], v[72:75]
    v_rcp_f32 v14, v14
    v_mfma_f32_16x16x32_bf16 v[76:79], v[196:199], v[164:167], v[76:79]
    v_rcp_f32 v15, v15
    v_mfma_f32_16x16x32_bf16 v[80:83], v[200:203], v[160:163], v[80:83]
    v_rcp_f32 v252, v252
    v_mfma_f32_16x16x32_bf16 v[84:87], v[200:203], v[164:167], v[84:87]
    v_rcp_f32 v253, v253
    s_waitcnt lgkmcnt(0)
    s_barrier
    v_mfma_f32_16x16x32_bf16 v[16:19], v[212:215], v[204:207], v[16:19]
    ds_read_b128 v[160:163], v10 offset:36864
    v_mfma_f32_16x16x32_bf16 v[20:23], v[212:215], v[208:211], v[20:23]
    ds_read_b128 v[164:167], v10 offset:38912
    v_rcp_f32 v254, v254
    v_mfma_f32_16x16x32_bf16 v[24:27], v[216:219], v[204:207], v[24:27]
    ds_read_b128 v[168:171], v2 offset:36864
    v_rcp_f32 v255, v255
    v_mfma_f32_16x16x32_bf16 v[28:31], v[216:219], v[208:211], v[28:31]
    ds_read_b128 v[172:175], v2 offset:37888
    v_mul_f32 v136, v136, v12
    v_mfma_f32_16x16x32_bf16 v[32:35], v[220:223], v[204:207], v[32:35]
    ds_read_b128 v[176:179], v2 offset:38912
    v_mul_f32 v137, v137, v13
    v_mfma_f32_16x16x32_bf16 v[36:39], v[220:223], v[208:211], v[36:39]
    ds_read_b128 v[180:183], v2 offset:39936
    v_mul_f32 v138, v138, v14
    v_mfma_f32_16x16x32_bf16 v[40:43], v[224:227], v[204:207], v[40:43]
    ds_read_b128 v[184:187], v2 offset:40960
    v_mul_f32 v139, v139, v15
    v_mfma_f32_16x16x32_bf16 v[44:47], v[224:227], v[208:211], v[44:47]
    ds_read_b128 v[188:191], v2 offset:41984
    v_mfma_f32_16x16x32_bf16 v[48:51], v[228:231], v[204:207], v[48:51]
    ds_read_b128 v[192:195], v2 offset:43008
    v_mul_f32 v140, v140, v252
    v_mfma_f32_16x16x32_bf16 v[52:55], v[228:231], v[208:211], v[52:55]
    ds_read_b128 v[196:199], v2 offset:44032
    v_mul_f32 v141, v141, v253
    v_mfma_f32_16x16x32_bf16 v[56:59], v[232:235], v[204:207], v[56:59]
    ds_read_b128 v[200:203], v2 offset:45056
    v_mul_f32 v142, v142, v254
    v_mfma_f32_16x16x32_bf16 v[60:63], v[232:235], v[208:211], v[60:63]
    v_mul_f32 v143, v143, v255
    v_mul_f32 v12, v144, v144
    v_mfma_f32_16x16x32_bf16 v[64:67], v[236:239], v[204:207], v[64:67]
    v_mul_f32 v13, v145, v145
    v_mul_f32 v14, v146, v146
    v_mfma_f32_16x16x32_bf16 v[68:71], v[236:239], v[208:211], v[68:71]
    v_mul_f32 v15, v147, v147
    v_mul_f32 v252, v148, v148
    v_mfma_f32_16x16x32_bf16 v[72:75], v[240:243], v[204:207], v[72:75]
    v_mul_f32 v253, v149, v149
    v_mul_f32 v254, v150, v150
    v_mfma_f32_16x16x32_bf16 v[76:79], v[240:243], v[208:211], v[76:79]
    v_mul_f32 v255, v151, v151
    v_fma_f32 v12, v12, v5, v4
    v_mfma_f32_16x16x32_bf16 v[80:83], v[244:247], v[204:207], v[80:83]
    v_fma_f32 v13, v13, v5, v4
    v_fma_f32 v14, v14, v5, v4
    v_mfma_f32_16x16x32_bf16 v[84:87], v[244:247], v[208:211], v[84:87]
    v_fma_f32 v15, v15, v5, v4
    s_waitcnt lgkmcnt(5)
    v_mfma_f32_16x16x32_bf16 v[16:19], v[168:171], v[160:163], v[16:19]
    ds_read_b128 v[204:207], v11 offset:36864
    v_mfma_f32_16x16x32_bf16 v[20:23], v[168:171], v[164:167], v[20:23]
    ds_read_b128 v[208:211], v11 offset:38912
    v_fma_f32 v252, v252, v7, v6
    v_mfma_f32_16x16x32_bf16 v[24:27], v[172:175], v[160:163], v[24:27]
    ds_read_b128 v[212:215], v2 offset:46080
    v_fma_f32 v253, v253, v7, v6
    v_mfma_f32_16x16x32_bf16 v[28:31], v[172:175], v[164:167], v[28:31]
    ds_read_b128 v[216:219], v2 offset:47104
    v_fma_f32 v254, v254, v7, v6
    v_mfma_f32_16x16x32_bf16 v[32:35], v[176:179], v[160:163], v[32:35]
    ds_read_b128 v[220:223], v2 offset:48128
    v_fma_f32 v255, v255, v7, v6
    v_mfma_f32_16x16x32_bf16 v[36:39], v[176:179], v[164:167], v[36:39]
    ds_read_b128 v[224:227], v2 offset:49152
    v_mul_f32 v12, v12, v144
    v_mfma_f32_16x16x32_bf16 v[40:43], v[180:183], v[160:163], v[40:43]
    ds_read_b128 v[228:231], v2 offset:50176
    v_mul_f32 v13, v13, v145
    v_mfma_f32_16x16x32_bf16 v[44:47], v[180:183], v[164:167], v[44:47]
    ds_read_b128 v[232:235], v2 offset:51200
    s_waitcnt lgkmcnt(8)
    v_mfma_f32_16x16x32_bf16 v[48:51], v[184:187], v[160:163], v[48:51]
    ds_read_b128 v[236:239], v2 offset:52224
    v_mul_f32 v14, v14, v146
    v_mfma_f32_16x16x32_bf16 v[52:55], v[184:187], v[164:167], v[52:55]
    ds_read_b128 v[240:243], v2 offset:53248
    v_mul_f32 v15, v15, v147
    v_mfma_f32_16x16x32_bf16 v[56:59], v[188:191], v[160:163], v[56:59]
    ds_read_b128 v[244:247], v2 offset:54272
    v_mul_f32 v252, v252, v148
    v_mfma_f32_16x16x32_bf16 v[60:63], v[188:191], v[164:167], v[60:63]
    v_mul_f32 v253, v253, v149
    v_mul_f32 v254, v254, v150
    v_mfma_f32_16x16x32_bf16 v[64:67], v[192:195], v[160:163], v[64:67]
    v_mul_f32 v255, v255, v151
    v_exp_f32 v12, v12
    v_mfma_f32_16x16x32_bf16 v[68:71], v[192:195], v[164:167], v[68:71]
    v_exp_f32 v13, v13
    v_mfma_f32_16x16x32_bf16 v[72:75], v[196:199], v[160:163], v[72:75]
    v_exp_f32 v14, v14
    v_mfma_f32_16x16x32_bf16 v[76:79], v[196:199], v[164:167], v[76:79]
    v_exp_f32 v15, v15
    v_mfma_f32_16x16x32_bf16 v[80:83], v[200:203], v[160:163], v[80:83]
    v_exp_f32 v252, v252
    v_mfma_f32_16x16x32_bf16 v[84:87], v[200:203], v[164:167], v[84:87]
    v_exp_f32 v253, v253
    s_waitcnt lgkmcnt(0)
    s_barrier
    v_mfma_f32_16x16x32_bf16 v[16:19], v[212:215], v[204:207], v[16:19]
    ds_read_b128 v[160:163], v8 offset:0
    v_mfma_f32_16x16x32_bf16 v[20:23], v[212:215], v[208:211], v[20:23]
    ds_read_b128 v[164:167], v8 offset:2048
    v_exp_f32 v254, v254
    v_mfma_f32_16x16x32_bf16 v[24:27], v[216:219], v[204:207], v[24:27]
    ds_read_b128 v[168:171], v1 offset:0
    v_exp_f32 v255, v255
    v_mfma_f32_16x16x32_bf16 v[28:31], v[216:219], v[208:211], v[28:31]
    ds_read_b128 v[172:175], v1 offset:1024
    v_fma_f32 v12, v12, v249, v249
    v_mfma_f32_16x16x32_bf16 v[32:35], v[220:223], v[204:207], v[32:35]
    ds_read_b128 v[176:179], v1 offset:2048
    v_fma_f32 v13, v13, v249, v249
    v_mfma_f32_16x16x32_bf16 v[36:39], v[220:223], v[208:211], v[36:39]
    ds_read_b128 v[180:183], v1 offset:3072
    v_fma_f32 v14, v14, v249, v249
    v_mfma_f32_16x16x32_bf16 v[40:43], v[224:227], v[204:207], v[40:43]
    ds_read_b128 v[184:187], v1 offset:4096
    v_fma_f32 v15, v15, v249, v249
    v_mfma_f32_16x16x32_bf16 v[44:47], v[224:227], v[208:211], v[44:47]
    ds_read_b128 v[188:191], v1 offset:5120
    v_mfma_f32_16x16x32_bf16 v[48:51], v[228:231], v[204:207], v[48:51]
    ds_read_b128 v[192:195], v1 offset:6144
    v_fma_f32 v252, v252, v251, v251
    v_mfma_f32_16x16x32_bf16 v[52:55], v[228:231], v[208:211], v[52:55]
    ds_read_b128 v[196:199], v1 offset:7168
    v_fma_f32 v253, v253, v251, v251
    v_mfma_f32_16x16x32_bf16 v[56:59], v[232:235], v[204:207], v[56:59]
    ds_read_b128 v[200:203], v1 offset:8192
    v_fma_f32 v254, v254, v251, v251
    v_mfma_f32_16x16x32_bf16 v[60:63], v[232:235], v[208:211], v[60:63]
    v_fma_f32 v255, v255, v251, v251
    v_rcp_f32 v12, v12
    v_mfma_f32_16x16x32_bf16 v[64:67], v[236:239], v[204:207], v[64:67]
    v_rcp_f32 v13, v13
    v_mfma_f32_16x16x32_bf16 v[68:71], v[236:239], v[208:211], v[68:71]
    v_rcp_f32 v14, v14
    v_mfma_f32_16x16x32_bf16 v[72:75], v[240:243], v[204:207], v[72:75]
    v_rcp_f32 v15, v15
    v_mfma_f32_16x16x32_bf16 v[76:79], v[240:243], v[208:211], v[76:79]
    v_rcp_f32 v252, v252
    v_mfma_f32_16x16x32_bf16 v[80:83], v[244:247], v[204:207], v[80:83]
    v_rcp_f32 v253, v253
    v_mfma_f32_16x16x32_bf16 v[84:87], v[244:247], v[208:211], v[84:87]
    v_rcp_f32 v254, v254
    s_waitcnt lgkmcnt(5)
    v_mfma_f32_16x16x32_bf16 v[16:19], v[168:171], v[160:163], v[16:19]
    ds_read_b128 v[204:207], v9 offset:0
    v_mfma_f32_16x16x32_bf16 v[20:23], v[168:171], v[164:167], v[20:23]
    ds_read_b128 v[208:211], v9 offset:2048
    v_rcp_f32 v255, v255
    v_mfma_f32_16x16x32_bf16 v[24:27], v[172:175], v[160:163], v[24:27]
    ds_read_b128 v[212:215], v1 offset:9216
    v_mul_f32 v144, v144, v12
    v_mfma_f32_16x16x32_bf16 v[28:31], v[172:175], v[164:167], v[28:31]
    ds_read_b128 v[216:219], v1 offset:10240
    v_mul_f32 v145, v145, v13
    v_mfma_f32_16x16x32_bf16 v[32:35], v[176:179], v[160:163], v[32:35]
    ds_read_b128 v[220:223], v1 offset:11264
    v_mul_f32 v146, v146, v14
    v_mfma_f32_16x16x32_bf16 v[36:39], v[176:179], v[164:167], v[36:39]
    ds_read_b128 v[224:227], v1 offset:12288
    v_mul_f32 v147, v147, v15
    v_mfma_f32_16x16x32_bf16 v[40:43], v[180:183], v[160:163], v[40:43]
    ds_read_b128 v[228:231], v1 offset:13312
    v_mul_f32 v148, v148, v252
    v_mfma_f32_16x16x32_bf16 v[44:47], v[180:183], v[164:167], v[44:47]
    ds_read_b128 v[232:235], v1 offset:14336
    s_waitcnt lgkmcnt(8)
    v_mfma_f32_16x16x32_bf16 v[48:51], v[184:187], v[160:163], v[48:51]
    ds_read_b128 v[236:239], v1 offset:15360
    v_mul_f32 v149, v149, v253
    v_mfma_f32_16x16x32_bf16 v[52:55], v[184:187], v[164:167], v[52:55]
    ds_read_b128 v[240:243], v1 offset:16384
    v_mul_f32 v150, v150, v254
    v_mfma_f32_16x16x32_bf16 v[56:59], v[188:191], v[160:163], v[56:59]
    ds_read_b128 v[244:247], v1 offset:17408
    v_mul_f32 v151, v151, v255
    v_mfma_f32_16x16x32_bf16 v[60:63], v[188:191], v[164:167], v[60:63]
    v_mul_f32 v12, v152, v152
    v_mul_f32 v13, v153, v153
    v_mfma_f32_16x16x32_bf16 v[64:67], v[192:195], v[160:163], v[64:67]
    v_mul_f32 v14, v154, v154
    v_mul_f32 v15, v155, v155
    v_mfma_f32_16x16x32_bf16 v[68:71], v[192:195], v[164:167], v[68:71]
    v_mul_f32 v252, v156, v156
    v_mul_f32 v253, v157, v157
    v_mfma_f32_16x16x32_bf16 v[72:75], v[196:199], v[160:163], v[72:75]
    v_mul_f32 v254, v158, v158
    v_mul_f32 v255, v159, v159
    v_mfma_f32_16x16x32_bf16 v[76:79], v[196:199], v[164:167], v[76:79]
    v_fma_f32 v12, v12, v5, v4
    v_fma_f32 v13, v13, v5, v4
    v_mfma_f32_16x16x32_bf16 v[80:83], v[200:203], v[160:163], v[80:83]
    v_fma_f32 v14, v14, v5, v4
    v_fma_f32 v15, v15, v5, v4
    v_mfma_f32_16x16x32_bf16 v[84:87], v[200:203], v[164:167], v[84:87]
    v_fma_f32 v252, v252, v7, v6
    s_waitcnt lgkmcnt(0)
    s_barrier
    v_mfma_f32_16x16x32_bf16 v[16:19], v[212:215], v[204:207], v[16:19]
    ds_read_b128 v[160:163], v8 offset:36864
    v_mfma_f32_16x16x32_bf16 v[20:23], v[212:215], v[208:211], v[20:23]
    ds_read_b128 v[164:167], v8 offset:38912
    v_fma_f32 v253, v253, v7, v6
    v_mfma_f32_16x16x32_bf16 v[24:27], v[216:219], v[204:207], v[24:27]
    ds_read_b128 v[168:171], v1 offset:36864
    v_fma_f32 v254, v254, v7, v6
    v_mfma_f32_16x16x32_bf16 v[28:31], v[216:219], v[208:211], v[28:31]
    ds_read_b128 v[172:175], v1 offset:37888
    v_fma_f32 v255, v255, v7, v6
    v_mfma_f32_16x16x32_bf16 v[32:35], v[220:223], v[204:207], v[32:35]
    ds_read_b128 v[176:179], v1 offset:38912
    v_mul_f32 v12, v12, v152
    v_mfma_f32_16x16x32_bf16 v[36:39], v[220:223], v[208:211], v[36:39]
    ds_read_b128 v[180:183], v1 offset:39936
    v_mul_f32 v13, v13, v153
    v_mfma_f32_16x16x32_bf16 v[40:43], v[224:227], v[204:207], v[40:43]
    ds_read_b128 v[184:187], v1 offset:40960
    v_mul_f32 v14, v14, v154
    v_mfma_f32_16x16x32_bf16 v[44:47], v[224:227], v[208:211], v[44:47]
    ds_read_b128 v[188:191], v1 offset:41984
    v_mfma_f32_16x16x32_bf16 v[48:51], v[228:231], v[204:207], v[48:51]
    ds_read_b128 v[192:195], v1 offset:43008
    v_mul_f32 v15, v15, v155
    v_mfma_f32_16x16x32_bf16 v[52:55], v[228:231], v[208:211], v[52:55]
    ds_read_b128 v[196:199], v1 offset:44032
    v_mul_f32 v252, v252, v156
    v_mfma_f32_16x16x32_bf16 v[56:59], v[232:235], v[204:207], v[56:59]
    ds_read_b128 v[200:203], v1 offset:45056
    v_mul_f32 v253, v253, v157
    v_mfma_f32_16x16x32_bf16 v[60:63], v[232:235], v[208:211], v[60:63]
    v_mul_f32 v254, v254, v158
    v_mul_f32 v255, v255, v159
    v_mfma_f32_16x16x32_bf16 v[64:67], v[236:239], v[204:207], v[64:67]
    v_exp_f32 v12, v12
    v_mfma_f32_16x16x32_bf16 v[68:71], v[236:239], v[208:211], v[68:71]
    v_exp_f32 v13, v13
    v_mfma_f32_16x16x32_bf16 v[72:75], v[240:243], v[204:207], v[72:75]
    v_exp_f32 v14, v14
    v_mfma_f32_16x16x32_bf16 v[76:79], v[240:243], v[208:211], v[76:79]
    v_exp_f32 v15, v15
    v_mfma_f32_16x16x32_bf16 v[80:83], v[244:247], v[204:207], v[80:83]
    v_exp_f32 v252, v252
    v_mfma_f32_16x16x32_bf16 v[84:87], v[244:247], v[208:211], v[84:87]
    v_exp_f32 v253, v253
    s_waitcnt lgkmcnt(5)
    v_mfma_f32_16x16x32_bf16 v[16:19], v[168:171], v[160:163], v[16:19]
    ds_read_b128 v[204:207], v9 offset:36864
    v_mfma_f32_16x16x32_bf16 v[20:23], v[168:171], v[164:167], v[20:23]
    ds_read_b128 v[208:211], v9 offset:38912
    v_exp_f32 v254, v254
    v_mfma_f32_16x16x32_bf16 v[24:27], v[172:175], v[160:163], v[24:27]
    ds_read_b128 v[212:215], v1 offset:46080
    v_exp_f32 v255, v255
    v_mfma_f32_16x16x32_bf16 v[28:31], v[172:175], v[164:167], v[28:31]
    ds_read_b128 v[216:219], v1 offset:47104
    v_fma_f32 v12, v12, v249, v249
    v_mfma_f32_16x16x32_bf16 v[32:35], v[176:179], v[160:163], v[32:35]
    ds_read_b128 v[220:223], v1 offset:48128
    v_fma_f32 v13, v13, v249, v249
    v_mfma_f32_16x16x32_bf16 v[36:39], v[176:179], v[164:167], v[36:39]
    ds_read_b128 v[224:227], v1 offset:49152
    v_fma_f32 v14, v14, v249, v249
    v_mfma_f32_16x16x32_bf16 v[40:43], v[180:183], v[160:163], v[40:43]
    ds_read_b128 v[228:231], v1 offset:50176
    v_fma_f32 v15, v15, v249, v249
    v_mfma_f32_16x16x32_bf16 v[44:47], v[180:183], v[164:167], v[44:47]
    ds_read_b128 v[232:235], v1 offset:51200
    s_waitcnt lgkmcnt(8)
    v_mfma_f32_16x16x32_bf16 v[48:51], v[184:187], v[160:163], v[48:51]
    ds_read_b128 v[236:239], v1 offset:52224
    v_fma_f32 v252, v252, v251, v251
    v_mfma_f32_16x16x32_bf16 v[52:55], v[184:187], v[164:167], v[52:55]
    ds_read_b128 v[240:243], v1 offset:53248
    v_fma_f32 v253, v253, v251, v251
    v_mfma_f32_16x16x32_bf16 v[56:59], v[188:191], v[160:163], v[56:59]
    ds_read_b128 v[244:247], v1 offset:54272
    v_fma_f32 v254, v254, v251, v251
    v_mfma_f32_16x16x32_bf16 v[60:63], v[188:191], v[164:167], v[60:63]
    v_fma_f32 v255, v255, v251, v251
    v_rcp_f32 v12, v12
    v_mfma_f32_16x16x32_bf16 v[64:67], v[192:195], v[160:163], v[64:67]
    v_rcp_f32 v13, v13
    v_mfma_f32_16x16x32_bf16 v[68:71], v[192:195], v[164:167], v[68:71]
    v_rcp_f32 v14, v14
    v_mfma_f32_16x16x32_bf16 v[72:75], v[196:199], v[160:163], v[72:75]
    v_rcp_f32 v15, v15
    v_mfma_f32_16x16x32_bf16 v[76:79], v[196:199], v[164:167], v[76:79]
    v_rcp_f32 v252, v252
    v_mfma_f32_16x16x32_bf16 v[80:83], v[200:203], v[160:163], v[80:83]
    v_rcp_f32 v253, v253
    v_mfma_f32_16x16x32_bf16 v[84:87], v[200:203], v[164:167], v[84:87]
    v_rcp_f32 v254, v254
    s_waitcnt lgkmcnt(0)
    s_barrier
    v_mfma_f32_16x16x32_bf16 v[16:19], v[212:215], v[204:207], v[16:19]
    ds_read_b128 v[160:163], v10 offset:0
    v_mfma_f32_16x16x32_bf16 v[20:23], v[212:215], v[208:211], v[20:23]
    ds_read_b128 v[164:167], v10 offset:2048
    v_rcp_f32 v255, v255
    v_mfma_f32_16x16x32_bf16 v[24:27], v[216:219], v[204:207], v[24:27]
    ds_read_b128 v[168:171], v2 offset:0
    v_mul_f32 v152, v152, v12
    v_mfma_f32_16x16x32_bf16 v[28:31], v[216:219], v[208:211], v[28:31]
    ds_read_b128 v[172:175], v2 offset:1024
    v_mul_f32 v153, v153, v13
    v_mfma_f32_16x16x32_bf16 v[32:35], v[220:223], v[204:207], v[32:35]
    ds_read_b128 v[176:179], v2 offset:2048
    v_mul_f32 v154, v154, v14
    v_mfma_f32_16x16x32_bf16 v[36:39], v[220:223], v[208:211], v[36:39]
    ds_read_b128 v[180:183], v2 offset:3072
    v_mul_f32 v155, v155, v15
    v_mfma_f32_16x16x32_bf16 v[40:43], v[224:227], v[204:207], v[40:43]
    ds_read_b128 v[184:187], v2 offset:4096
    v_mul_f32 v156, v156, v252
    v_mfma_f32_16x16x32_bf16 v[44:47], v[224:227], v[208:211], v[44:47]
    ds_read_b128 v[188:191], v2 offset:5120
    v_mfma_f32_16x16x32_bf16 v[48:51], v[228:231], v[204:207], v[48:51]
    ds_read_b128 v[192:195], v2 offset:6144
    v_mul_f32 v157, v157, v253
    v_mfma_f32_16x16x32_bf16 v[52:55], v[228:231], v[208:211], v[52:55]
    ds_read_b128 v[196:199], v2 offset:7168
    v_mul_f32 v158, v158, v254
    v_mfma_f32_16x16x32_bf16 v[56:59], v[232:235], v[204:207], v[56:59]
    ds_read_b128 v[200:203], v2 offset:8192
    v_mul_f32 v159, v159, v255
    v_mfma_f32_16x16x32_bf16 v[60:63], v[232:235], v[208:211], v[60:63]
    s_mul_i32 s36, s31, 73728
    s_add_u32 s36, s36, s21
    v_mfma_f32_16x16x32_bf16 v[64:67], v[236:239], v[204:207], v[64:67]
    s_lshl_b32 s34, s24, 10
    s_lshl_b32 s35, s24, 9
    v_mfma_f32_16x16x32_bf16 v[68:71], v[236:239], v[208:211], v[68:71]
    s_add_u32 s35, s35, 65536
    v_add_u32 v14, s34, v1
    v_mfma_f32_16x16x32_bf16 v[72:75], v[240:243], v[204:207], v[72:75]
    v_lshrrev_b32 v15, 1, v1
    v_add_u32 v15, s35, v15
    v_mfma_f32_16x16x32_bf16 v[76:79], v[240:243], v[208:211], v[76:79]
    s_add_u32 s39, s36, 0x1200000
    s_add_u32 s40, s36, 0x1212000
    v_mfma_f32_16x16x32_bf16 v[80:83], v[244:247], v[204:207], v[80:83]
    v_mfma_f32_16x16x32_bf16 v[84:87], v[244:247], v[208:211], v[84:87]
    s_mov_b32 s41, 5
    .p2align 6
L_g_loop:
    s_waitcnt lgkmcnt(5)
    v_mfma_f32_16x16x32_bf16 v[16:19], v[168:171], v[160:163], v[16:19]
    ds_read_b128 v[204:207], v11 offset:0
    v_mfma_f32_16x16x32_bf16 v[20:23], v[168:171], v[164:167], v[20:23]
    ds_read_b128 v[208:211], v11 offset:2048
    v_mfma_f32_16x16x32_bf16 v[24:27], v[172:175], v[160:163], v[24:27]
    ds_read_b128 v[212:215], v2 offset:9216
    v_mfma_f32_16x16x32_bf16 v[28:31], v[172:175], v[164:167], v[28:31]
    ds_read_b128 v[216:219], v2 offset:10240
    v_mfma_f32_16x16x32_bf16 v[32:35], v[176:179], v[160:163], v[32:35]
    ds_read_b128 v[220:223], v2 offset:11264
    v_mfma_f32_16x16x32_bf16 v[36:39], v[176:179], v[164:167], v[36:39]
    ds_read_b128 v[224:227], v2 offset:12288
    v_mfma_f32_16x16x32_bf16 v[40:43], v[180:183], v[160:163], v[40:43]
    ds_read_b128 v[228:231], v2 offset:13312
    v_mfma_f32_16x16x32_bf16 v[44:47], v[180:183], v[164:167], v[44:47]
    ds_read_b128 v[232:235], v2 offset:14336
    s_waitcnt lgkmcnt(8)
    v_mfma_f32_16x16x32_bf16 v[48:51], v[184:187], v[160:163], v[48:51]
    ds_read_b128 v[236:239], v2 offset:15360
    v_mfma_f32_16x16x32_bf16 v[52:55], v[184:187], v[164:167], v[52:55]
    ds_read_b128 v[240:243], v2 offset:16384
    v_mfma_f32_16x16x32_bf16 v[56:59], v[188:191], v[160:163], v[56:59]
    ds_read_b128 v[244:247], v2 offset:17408
    v_mfma_f32_16x16x32_bf16 v[60:63], v[188:191], v[164:167], v[60:63]
    v_mfma_f32_16x16x32_bf16 v[64:67], v[192:195], v[160:163], v[64:67]
    v_mfma_f32_16x16x32_bf16 v[68:71], v[192:195], v[164:167], v[68:71]
    v_mfma_f32_16x16x32_bf16 v[72:75], v[196:199], v[160:163], v[72:75]
    v_mfma_f32_16x16x32_bf16 v[76:79], v[196:199], v[164:167], v[76:79]
    v_mfma_f32_16x16x32_bf16 v[80:83], v[200:203], v[160:163], v[80:83]
    v_mfma_f32_16x16x32_bf16 v[84:87], v[200:203], v[164:167], v[84:87]
    s_waitcnt lgkmcnt(0)
    s_barrier
    v_mfma_f32_16x16x32_bf16 v[16:19], v[212:215], v[204:207], v[16:19]
    ds_read_b128 v[160:163], v10 offset:36864
    v_mfma_f32_16x16x32_bf16 v[20:23], v[212:215], v[208:211], v[20:23]
    ds_read_b128 v[164:167], v10 offset:38912
    v_mfma_f32_16x16x32_bf16 v[24:27], v[216:219], v[204:207], v[24:27]
    ds_read_b128 v[168:171], v2 offset:36864
    v_mfma_f32_16x16x32_bf16 v[28:31], v[216:219], v[208:211], v[28:31]
    ds_read_b128 v[172:175], v2 offset:37888
    v_mfma_f32_16x16x32_bf16 v[32:35], v[220:223], v[204:207], v[32:35]
    ds_read_b128 v[176:179], v2 offset:38912
    v_mfma_f32_16x16x32_bf16 v[36:39], v[220:223], v[208:211], v[36:39]
    ds_read_b128 v[180:183], v2 offset:39936
    v_mfma_f32_16x16x32_bf16 v[40:43], v[224:227], v[204:207], v[40:43]
    ds_read_b128 v[184:187], v2 offset:40960
    v_mfma_f32_16x16x32_bf16 v[44:47], v[224:227], v[208:211], v[44:47]
    ds_read_b128 v[188:191], v2 offset:41984
    v_mfma_f32_16x16x32_bf16 v[48:51], v[228:231], v[204:207], v[48:51]
    ds_read_b128 v[192:195], v2 offset:43008
    v_mfma_f32_16x16x32_bf16 v[52:55], v[228:231], v[208:211], v[52:55]
    ds_read_b128 v[196:199], v2 offset:44032
    v_mfma_f32_16x16x32_bf16 v[56:59], v[232:235], v[204:207], v[56:59]
    ds_read_b128 v[200:203], v2 offset:45056
    v_mfma_f32_16x16x32_bf16 v[60:63], v[232:235], v[208:211], v[60:63]
    v_mfma_f32_16x16x32_bf16 v[64:67], v[236:239], v[204:207], v[64:67]
    v_mfma_f32_16x16x32_bf16 v[68:71], v[236:239], v[208:211], v[68:71]
    v_mfma_f32_16x16x32_bf16 v[72:75], v[240:243], v[204:207], v[72:75]
    v_mfma_f32_16x16x32_bf16 v[76:79], v[240:243], v[208:211], v[76:79]
    v_mfma_f32_16x16x32_bf16 v[80:83], v[244:247], v[204:207], v[80:83]
    v_mfma_f32_16x16x32_bf16 v[84:87], v[244:247], v[208:211], v[84:87]
    s_waitcnt lgkmcnt(5)
    v_mfma_f32_16x16x32_bf16 v[16:19], v[168:171], v[160:163], v[16:19]
    ds_read_b128 v[204:207], v11 offset:36864
    v_mfma_f32_16x16x32_bf16 v[20:23], v[168:171], v[164:167], v[20:23]
    ds_read_b128 v[208:211], v11 offset:38912
    v_mfma_f32_16x16x32_bf16 v[24:27], v[172:175], v[160:163], v[24:27]
    ds_read_b128 v[212:215], v2 offset:46080
    v_mfma_f32_16x16x32_bf16 v[28:31], v[172:175], v[164:167], v[28:31]
    ds_read_b128 v[216:219], v2 offset:47104
    v_mfma_f32_16x16x32_bf16 v[32:35], v[176:179], v[160:163], v[32:35]
    ds_read_b128 v[220:223], v2 offset:48128
    v_mfma_f32_16x16x32_bf16 v[36:39], v[176:179], v[164:167], v[36:39]
    ds_read_b128 v[224:227], v2 offset:49152
    v_mfma_f32_16x16x32_bf16 v[40:43], v[180:183], v[160:163], v[40:43]
    ds_read_b128 v[228:231], v2 offset:50176
    v_mfma_f32_16x16x32_bf16 v[44:47], v[180:183], v[164:167], v[44:47]
    ds_read_b128 v[232:235], v2 offset:51200
    s_waitcnt lgkmcnt(8)
    v_mfma_f32_16x16x32_bf16 v[48:51], v[184:187], v[160:163], v[48:51]
    ds_read_b128 v[236:239], v2 offset:52224
    v_mfma_f32_16x16x32_bf16 v[52:55], v[184:187], v[164:167], v[52:55]
    ds_read_b128 v[240:243], v2 offset:53248
    v_mfma_f32_16x16x32_bf16 v[56:59], v[188:191], v[160:163], v[56:59]
    ds_read_b128 v[244:247], v2 offset:54272
    v_mfma_f32_16x16x32_bf16 v[60:63], v[188:191], v[164:167], v[60:63]
    v_mfma_f32_16x16x32_bf16 v[64:67], v[192:195], v[160:163], v[64:67]
    v_mfma_f32_16x16x32_bf16 v[68:71], v[192:195], v[164:167], v[68:71]
    v_mfma_f32_16x16x32_bf16 v[72:75], v[196:199], v[160:163], v[72:75]
    v_mfma_f32_16x16x32_bf16 v[76:79], v[196:199], v[164:167], v[76:79]
    v_mfma_f32_16x16x32_bf16 v[80:83], v[200:203], v[160:163], v[80:83]
    v_mfma_f32_16x16x32_bf16 v[84:87], v[200:203], v[164:167], v[84:87]
    s_waitcnt lgkmcnt(0)
    s_barrier
    v_mfma_f32_16x16x32_bf16 v[16:19], v[212:215], v[204:207], v[16:19]
    ds_read_b128 v[160:163], v8 offset:0
    v_mfma_f32_16x16x32_bf16 v[20:23], v[212:215], v[208:211], v[20:23]
    ds_read_b128 v[164:167], v8 offset:2048
    v_mfma_f32_16x16x32_bf16 v[24:27], v[216:219], v[204:207], v[24:27]
    ds_read_b128 v[168:171], v1 offset:0
    v_mfma_f32_16x16x32_bf16 v[28:31], v[216:219], v[208:211], v[28:31]
    ds_read_b128 v[172:175], v1 offset:1024
    v_mfma_f32_16x16x32_bf16 v[32:35], v[220:223], v[204:207], v[32:35]
    ds_read_b128 v[176:179], v1 offset:2048
    v_mfma_f32_16x16x32_bf16 v[36:39], v[220:223], v[208:211], v[36:39]
    ds_read_b128 v[180:183], v1 offset:3072
    v_mfma_f32_16x16x32_bf16 v[40:43], v[224:227], v[204:207], v[40:43]
    ds_read_b128 v[184:187], v1 offset:4096
    v_mfma_f32_16x16x32_bf16 v[44:47], v[224:227], v[208:211], v[44:47]
    ds_read_b128 v[188:191], v1 offset:5120
    v_mfma_f32_16x16x32_bf16 v[48:51], v[228:231], v[204:207], v[48:51]
    ds_read_b128 v[192:195], v1 offset:6144
    v_mfma_f32_16x16x32_bf16 v[52:55], v[228:231], v[208:211], v[52:55]
    ds_read_b128 v[196:199], v1 offset:7168
    v_mfma_f32_16x16x32_bf16 v[56:59], v[232:235], v[204:207], v[56:59]
    ds_read_b128 v[200:203], v1 offset:8192
    v_mfma_f32_16x16x32_bf16 v[60:63], v[232:235], v[208:211], v[60:63]
    v_mfma_f32_16x16x32_bf16 v[64:67], v[236:239], v[204:207], v[64:67]
    v_mfma_f32_16x16x32_bf16 v[68:71], v[236:239], v[208:211], v[68:71]
    v_mfma_f32_16x16x32_bf16 v[72:75], v[240:243], v[204:207], v[72:75]
    v_mfma_f32_16x16x32_bf16 v[76:79], v[240:243], v[208:211], v[76:79]
    v_mfma_f32_16x16x32_bf16 v[80:83], v[244:247], v[204:207], v[80:83]
    v_mfma_f32_16x16x32_bf16 v[84:87], v[244:247], v[208:211], v[84:87]
    s_waitcnt lgkmcnt(5)
    v_mfma_f32_16x16x32_bf16 v[16:19], v[168:171], v[160:163], v[16:19]
    ds_read_b128 v[204:207], v9 offset:0
    v_mfma_f32_16x16x32_bf16 v[20:23], v[168:171], v[164:167], v[20:23]
    ds_read_b128 v[208:211], v9 offset:2048
    v_mfma_f32_16x16x32_bf16 v[24:27], v[172:175], v[160:163], v[24:27]
    ds_read_b128 v[212:215], v1 offset:9216
    v_mfma_f32_16x16x32_bf16 v[28:31], v[172:175], v[164:167], v[28:31]
    ds_read_b128 v[216:219], v1 offset:10240
    v_mfma_f32_16x16x32_bf16 v[32:35], v[176:179], v[160:163], v[32:35]
    ds_read_b128 v[220:223], v1 offset:11264
    v_mfma_f32_16x16x32_bf16 v[36:39], v[176:179], v[164:167], v[36:39]
    ds_read_b128 v[224:227], v1 offset:12288
    v_mfma_f32_16x16x32_bf16 v[40:43], v[180:183], v[160:163], v[40:43]
    ds_read_b128 v[228:231], v1 offset:13312
    v_mfma_f32_16x16x32_bf16 v[44:47], v[180:183], v[164:167], v[44:47]
    ds_read_b128 v[232:235], v1 offset:14336
    s_waitcnt lgkmcnt(8)
    v_mfma_f32_16x16x32_bf16 v[48:51], v[184:187], v[160:163], v[48:51]
    ds_read_b128 v[236:239], v1 offset:15360
    v_mfma_f32_16x16x32_bf16 v[52:55], v[184:187], v[164:167], v[52:55]
    ds_read_b128 v[240:243], v1 offset:16384
    v_mfma_f32_16x16x32_bf16 v[56:59], v[188:191], v[160:163], v[56:59]
    ds_read_b128 v[244:247], v1 offset:17408
    v_mfma_f32_16x16x32_bf16 v[60:63], v[188:191], v[164:167], v[60:63]
    v_mfma_f32_16x16x32_bf16 v[64:67], v[192:195], v[160:163], v[64:67]
    v_mfma_f32_16x16x32_bf16 v[68:71], v[192:195], v[164:167], v[68:71]
    v_mfma_f32_16x16x32_bf16 v[72:75], v[196:199], v[160:163], v[72:75]
    v_mfma_f32_16x16x32_bf16 v[76:79], v[196:199], v[164:167], v[76:79]
    v_mfma_f32_16x16x32_bf16 v[80:83], v[200:203], v[160:163], v[80:83]
    v_mfma_f32_16x16x32_bf16 v[84:87], v[200:203], v[164:167], v[84:87]
    s_waitcnt lgkmcnt(0)
    s_barrier
    v_mfma_f32_16x16x32_bf16 v[16:19], v[212:215], v[204:207], v[16:19]
    ds_read_b128 v[160:163], v8 offset:36864
    v_mfma_f32_16x16x32_bf16 v[20:23], v[212:215], v[208:211], v[20:23]
    ds_read_b128 v[164:167], v8 offset:38912
    v_mfma_f32_16x16x32_bf16 v[24:27], v[216:219], v[204:207], v[24:27]
    ds_read_b128 v[168:171], v1 offset:36864
    v_mfma_f32_16x16x32_bf16 v[28:31], v[216:219], v[208:211], v[28:31]
    ds_read_b128 v[172:175], v1 offset:37888
    v_mfma_f32_16x16x32_bf16 v[32:35], v[220:223], v[204:207], v[32:35]
    ds_read_b128 v[176:179], v1 offset:38912
    v_mfma_f32_16x16x32_bf16 v[36:39], v[220:223], v[208:211], v[36:39]
    ds_read_b128 v[180:183], v1 offset:39936
    v_mfma_f32_16x16x32_bf16 v[40:43], v[224:227], v[204:207], v[40:43]
    ds_read_b128 v[184:187], v1 offset:40960
    v_mfma_f32_16x16x32_bf16 v[44:47], v[224:227], v[208:211], v[44:47]
    ds_read_b128 v[188:191], v1 offset:41984
    v_mfma_f32_16x16x32_bf16 v[48:51], v[228:231], v[204:207], v[48:51]
    ds_read_b128 v[192:195], v1 offset:43008
    v_mfma_f32_16x16x32_bf16 v[52:55], v[228:231], v[208:211], v[52:55]
    ds_read_b128 v[196:199], v1 offset:44032
    v_mfma_f32_16x16x32_bf16 v[56:59], v[232:235], v[204:207], v[56:59]
    ds_read_b128 v[200:203], v1 offset:45056
    v_mfma_f32_16x16x32_bf16 v[60:63], v[232:235], v[208:211], v[60:63]
    v_mfma_f32_16x16x32_bf16 v[64:67], v[236:239], v[204:207], v[64:67]
    v_mfma_f32_16x16x32_bf16 v[68:71], v[236:239], v[208:211], v[68:71]
    v_mfma_f32_16x16x32_bf16 v[72:75], v[240:243], v[204:207], v[72:75]
    v_mfma_f32_16x16x32_bf16 v[76:79], v[240:243], v[208:211], v[76:79]
    v_mfma_f32_16x16x32_bf16 v[80:83], v[244:247], v[204:207], v[80:83]
    v_mfma_f32_16x16x32_bf16 v[84:87], v[244:247], v[208:211], v[84:87]
    s_waitcnt lgkmcnt(5)
    v_mfma_f32_16x16x32_bf16 v[16:19], v[168:171], v[160:163], v[16:19]
    ds_read_b128 v[204:207], v9 offset:36864
    v_mfma_f32_16x16x32_bf16 v[20:23], v[168:171], v[164:167], v[20:23]
    ds_read_b128 v[208:211], v9 offset:38912
    v_mfma_f32_16x16x32_bf16 v[24:27], v[172:175], v[160:163], v[24:27]
    ds_read_b128 v[212:215], v1 offset:46080
    v_mfma_f32_16x16x32_bf16 v[28:31], v[172:175], v[164:167], v[28:31]
    ds_read_b128 v[216:219], v1 offset:47104
    v_mfma_f32_16x16x32_bf16 v[32:35], v[176:179], v[160:163], v[32:35]
    ds_read_b128 v[220:223], v1 offset:48128
    v_mfma_f32_16x16x32_bf16 v[36:39], v[176:179], v[164:167], v[36:39]
    ds_read_b128 v[224:227], v1 offset:49152
    v_mfma_f32_16x16x32_bf16 v[40:43], v[180:183], v[160:163], v[40:43]
    ds_read_b128 v[228:231], v1 offset:50176
    v_mfma_f32_16x16x32_bf16 v[44:47], v[180:183], v[164:167], v[44:47]
    ds_read_b128 v[232:235], v1 offset:51200
    s_waitcnt lgkmcnt(8)
    v_mfma_f32_16x16x32_bf16 v[48:51], v[184:187], v[160:163], v[48:51]
    ds_read_b128 v[236:239], v1 offset:52224
    v_mfma_f32_16x16x32_bf16 v[52:55], v[184:187], v[164:167], v[52:55]
    ds_read_b128 v[240:243], v1 offset:53248
    v_mfma_f32_16x16x32_bf16 v[56:59], v[188:191], v[160:163], v[56:59]
    ds_read_b128 v[244:247], v1 offset:54272
    v_mfma_f32_16x16x32_bf16 v[60:63], v[188:191], v[164:167], v[60:63]
    v_mfma_f32_16x16x32_bf16 v[64:67], v[192:195], v[160:163], v[64:67]
    v_mfma_f32_16x16x32_bf16 v[68:71], v[192:195], v[164:167], v[68:71]
    v_mfma_f32_16x16x32_bf16 v[72:75], v[196:199], v[160:163], v[72:75]
    v_mfma_f32_16x16x32_bf16 v[76:79], v[196:199], v[164:167], v[76:79]
    v_mfma_f32_16x16x32_bf16 v[80:83], v[200:203], v[160:163], v[80:83]
    v_mfma_f32_16x16x32_bf16 v[84:87], v[200:203], v[164:167], v[84:87]
    s_waitcnt lgkmcnt(0)
    s_barrier
    v_mfma_f32_16x16x32_bf16 v[16:19], v[212:215], v[204:207], v[16:19]
    ds_read_b128 v[160:163], v10 offset:0
    v_mfma_f32_16x16x32_bf16 v[20:23], v[212:215], v[208:211], v[20:23]
    ds_read_b128 v[164:167], v10 offset:2048
    v_mfma_f32_16x16x32_bf16 v[24:27], v[216:219], v[204:207], v[24:27]
    ds_read_b128 v[168:171], v2 offset:0
    v_mfma_f32_16x16x32_bf16 v[28:31], v[216:219], v[208:211], v[28:31]
    ds_read_b128 v[172:175], v2 offset:1024
    v_mfma_f32_16x16x32_bf16 v[32:35], v[220:223], v[204:207], v[32:35]
    ds_read_b128 v[176:179], v2 offset:2048
    v_mfma_f32_16x16x32_bf16 v[36:39], v[220:223], v[208:211], v[36:39]
    ds_read_b128 v[180:183], v2 offset:3072
    v_mfma_f32_16x16x32_bf16 v[40:43], v[224:227], v[204:207], v[40:43]
    ds_read_b128 v[184:187], v2 offset:4096
    v_mfma_f32_16x16x32_bf16 v[44:47], v[224:227], v[208:211], v[44:47]
    ds_read_b128 v[188:191], v2 offset:5120
    v_mfma_f32_16x16x32_bf16 v[48:51], v[228:231], v[204:207], v[48:51]
    ds_read_b128 v[192:195], v2 offset:6144
    v_mfma_f32_16x16x32_bf16 v[52:55], v[228:231], v[208:211], v[52:55]
    ds_read_b128 v[196:199], v2 offset:7168
    v_mfma_f32_16x16x32_bf16 v[56:59], v[232:235], v[204:207], v[56:59]
    ds_read_b128 v[200:203], v2 offset:8192
    v_mfma_f32_16x16x32_bf16 v[60:63], v[232:235], v[208:211], v[60:63]
    v_mfma_f32_16x16x32_bf16 v[64:67], v[236:239], v[204:207], v[64:67]
    v_mfma_f32_16x16x32_bf16 v[68:71], v[236:239], v[208:211], v[68:71]
    v_mfma_f32_16x16x32_bf16 v[72:75], v[240:243], v[204:207], v[72:75]
    v_mfma_f32_16x16x32_bf16 v[76:79], v[240:243], v[208:211], v[76:79]
    v_mfma_f32_16x16x32_bf16 v[80:83], v[244:247], v[204:207], v[80:83]
    s_sub_u32 s41, s41, 1
    v_mfma_f32_16x16x32_bf16 v[84:87], v[244:247], v[208:211], v[84:87]
    s_cmp_lg_u32 s41, 0
    s_cbranch_scc1 L_g_loop
    s_waitcnt lgkmcnt(5)
    v_mfma_f32_16x16x32_bf16 v[16:19], v[168:171], v[160:163], v[16:19]
    ds_read_b128 v[204:207], v11 offset:0
    v_mfma_f32_16x16x32_bf16 v[20:23], v[168:171], v[164:167], v[20:23]
    ds_read_b128 v[208:211], v11 offset:2048
    v_mfma_f32_16x16x32_bf16 v[24:27], v[172:175], v[160:163], v[24:27]
    ds_read_b128 v[212:215], v2 offset:9216
    v_mfma_f32_16x16x32_bf16 v[28:31], v[172:175], v[164:167], v[28:31]
    ds_read_b128 v[216:219], v2 offset:10240
    v_mfma_f32_16x16x32_bf16 v[32:35], v[176:179], v[160:163], v[32:35]
    ds_read_b128 v[220:223], v2 offset:11264
    v_mfma_f32_16x16x32_bf16 v[36:39], v[176:179], v[164:167], v[36:39]
    ds_read_b128 v[224:227], v2 offset:12288
    v_mfma_f32_16x16x32_bf16 v[40:43], v[180:183], v[160:163], v[40:43]
    ds_read_b128 v[228:231], v2 offset:13312
    v_mfma_f32_16x16x32_bf16 v[44:47], v[180:183], v[164:167], v[44:47]
    ds_read_b128 v[232:235], v2 offset:14336
    s_waitcnt lgkmcnt(8)
    v_mfma_f32_16x16x32_bf16 v[48:51], v[184:187], v[160:163], v[48:51]
    ds_read_b128 v[236:239], v2 offset:15360
    v_mfma_f32_16x16x32_bf16 v[52:55], v[184:187], v[164:167], v[52:55]
    ds_read_b128 v[240:243], v2 offset:16384
    v_mfma_f32_16x16x32_bf16 v[56:59], v[188:191], v[160:163], v[56:59]
    ds_read_b128 v[244:247], v2 offset:17408
    v_mfma_f32_16x16x32_bf16 v[60:63], v[188:191], v[164:167], v[60:63]
    v_mfma_f32_16x16x32_bf16 v[64:67], v[192:195], v[160:163], v[64:67]
    v_mfma_f32_16x16x32_bf16 v[68:71], v[192:195], v[164:167], v[68:71]
    v_mfma_f32_16x16x32_bf16 v[72:75], v[196:199], v[160:163], v[72:75]
    v_mfma_f32_16x16x32_bf16 v[76:79], v[196:199], v[164:167], v[76:79]
    v_mfma_f32_16x16x32_bf16 v[80:83], v[200:203], v[160:163], v[80:83]
    v_mfma_f32_16x16x32_bf16 v[84:87], v[200:203], v[164:167], v[84:87]
    s_waitcnt lgkmcnt(0)
    s_barrier
    v_mfma_f32_16x16x32_bf16 v[16:19], v[212:215], v[204:207], v[16:19]
    ds_read_b128 v[160:163], v10 offset:36864
    v_mfma_f32_16x16x32_bf16 v[20:23], v[212:215], v[208:211], v[20:23]
    ds_read_b128 v[164:167], v10 offset:38912
    v_mfma_f32_16x16x32_bf16 v[24:27], v[216:219], v[204:207], v[24:27]
    ds_read_b128 v[168:171], v2 offset:36864
    v_mfma_f32_16x16x32_bf16 v[28:31], v[216:219], v[208:211], v[28:31]
    ds_read_b128 v[172:175], v2 offset:37888
    v_mfma_f32_16x16x32_bf16 v[32:35], v[220:223], v[204:207], v[32:35]
    ds_read_b128 v[176:179], v2 offset:38912
    v_mfma_f32_16x16x32_bf16 v[36:39], v[220:223], v[208:211], v[36:39]
    ds_read_b128 v[180:183], v2 offset:39936
    v_mfma_f32_16x16x32_bf16 v[40:43], v[224:227], v[204:207], v[40:43]
    ds_read_b128 v[184:187], v2 offset:40960
    v_mfma_f32_16x16x32_bf16 v[44:47], v[224:227], v[208:211], v[44:47]
    ds_read_b128 v[188:191], v2 offset:41984
    v_mfma_f32_16x16x32_bf16 v[48:51], v[228:231], v[204:207], v[48:51]
    ds_read_b128 v[192:195], v2 offset:43008
    v_mfma_f32_16x16x32_bf16 v[52:55], v[228:231], v[208:211], v[52:55]
    ds_read_b128 v[196:199], v2 offset:44032
    v_mfma_f32_16x16x32_bf16 v[56:59], v[232:235], v[204:207], v[56:59]
    ds_read_b128 v[200:203], v2 offset:45056
    v_mfma_f32_16x16x32_bf16 v[60:63], v[232:235], v[208:211], v[60:63]
    v_mfma_f32_16x16x32_bf16 v[64:67], v[236:239], v[204:207], v[64:67]
    v_mfma_f32_16x16x32_bf16 v[68:71], v[236:239], v[208:211], v[68:71]
    v_mfma_f32_16x16x32_bf16 v[72:75], v[240:243], v[204:207], v[72:75]
    v_mfma_f32_16x16x32_bf16 v[76:79], v[240:243], v[208:211], v[76:79]
    v_mfma_f32_16x16x32_bf16 v[80:83], v[244:247], v[204:207], v[80:83]
    v_mfma_f32_16x16x32_bf16 v[84:87], v[244:247], v[208:211], v[84:87]
    s_waitcnt lgkmcnt(5)
    v_mfma_f32_16x16x32_bf16 v[16:19], v[168:171], v[160:163], v[16:19]
    ds_read_b128 v[204:207], v11 offset:36864
    v_mfma_f32_16x16x32_bf16 v[20:23], v[168:171], v[164:167], v[20:23]
    ds_read_b128 v[208:211], v11 offset:38912
    v_mfma_f32_16x16x32_bf16 v[24:27], v[172:175], v[160:163], v[24:27]
    ds_read_b128 v[212:215], v2 offset:46080
    v_mfma_f32_16x16x32_bf16 v[28:31], v[172:175], v[164:167], v[28:31]
    ds_read_b128 v[216:219], v2 offset:47104
    v_mfma_f32_16x16x32_bf16 v[32:35], v[176:179], v[160:163], v[32:35]
    ds_read_b128 v[220:223], v2 offset:48128
    v_mfma_f32_16x16x32_bf16 v[36:39], v[176:179], v[164:167], v[36:39]
    ds_read_b128 v[224:227], v2 offset:49152
    v_mfma_f32_16x16x32_bf16 v[40:43], v[180:183], v[160:163], v[40:43]
    ds_read_b128 v[228:231], v2 offset:50176
    v_mfma_f32_16x16x32_bf16 v[44:47], v[180:183], v[164:167], v[44:47]
    ds_read_b128 v[232:235], v2 offset:51200
    s_waitcnt lgkmcnt(8)
    v_mfma_f32_16x16x32_bf16 v[48:51], v[184:187], v[160:163], v[48:51]
    ds_read_b128 v[236:239], v2 offset:52224
    v_mfma_f32_16x16x32_bf16 v[52:55], v[184:187], v[164:167], v[52:55]
    ds_read_b128 v[240:243], v2 offset:53248
    v_mfma_f32_16x16x32_bf16 v[56:59], v[188:191], v[160:163], v[56:59]
    ds_read_b128 v[244:247], v2 offset:54272
    v_mfma_f32_16x16x32_bf16 v[60:63], v[188:191], v[164:167], v[60:63]
    v_mfma_f32_16x16x32_bf16 v[64:67], v[192:195], v[160:163], v[64:67]
    v_mfma_f32_16x16x32_bf16 v[68:71], v[192:195], v[164:167], v[68:71]
    v_mfma_f32_16x16x32_bf16 v[72:75], v[196:199], v[160:163], v[72:75]
    v_mfma_f32_16x16x32_bf16 v[76:79], v[196:199], v[164:167], v[76:79]
    v_mfma_f32_16x16x32_bf16 v[80:83], v[200:203], v[160:163], v[80:83]
    v_mfma_f32_16x16x32_bf16 v[84:87], v[200:203], v[164:167], v[84:87]
    s_waitcnt lgkmcnt(0)
    s_barrier
    v_mfma_f32_16x16x32_bf16 v[16:19], v[212:215], v[204:207], v[16:19]
    ds_read_b128 v[160:163], v8 offset:0
    v_mfma_f32_16x16x32_bf16 v[20:23], v[212:215], v[208:211], v[20:23]
    ds_read_b128 v[164:167], v8 offset:2048
    v_mfma_f32_16x16x32_bf16 v[24:27], v[216:219], v[204:207], v[24:27]
    ds_read_b128 v[192:195], v1 offset:0
    v_mfma_f32_16x16x32_bf16 v[28:31], v[216:219], v[208:211], v[28:31]
    ds_read_b128 v[168:171], v9 offset:0
    v_mfma_f32_16x16x32_bf16 v[32:35], v[220:223], v[204:207], v[32:35]
    ds_read_b128 v[172:175], v9 offset:2048
    v_mfma_f32_16x16x32_bf16 v[36:39], v[220:223], v[208:211], v[36:39]
    ds_read_b128 v[176:179], v8 offset:36864
    v_mfma_f32_16x16x32_bf16 v[40:43], v[224:227], v[204:207], v[40:43]
    ds_read_b128 v[180:183], v8 offset:38912
    v_mfma_f32_16x16x32_bf16 v[44:47], v[224:227], v[208:211], v[44:47]
    ds_read_b128 v[184:187], v9 offset:36864
    v_mfma_f32_16x16x32_bf16 v[48:51], v[228:231], v[204:207], v[48:51]
    ds_read_b128 v[188:191], v9 offset:38912
    v_mfma_f32_16x16x32_bf16 v[52:55], v[228:231], v[208:211], v[52:55]
    ds_read_b128 v[196:199], v1 offset:9216
    v_mfma_f32_16x16x32_bf16 v[56:59], v[232:235], v[204:207], v[56:59]
    ds_read_b128 v[200:203], v1 offset:36864
    v_mfma_f32_16x16x32_bf16 v[60:63], v[232:235], v[208:211], v[60:63]
    v_mfma_f32_16x16x32_bf16 v[64:67], v[236:239], v[204:207], v[64:67]
    v_mfma_f32_16x16x32_bf16 v[68:71], v[236:239], v[208:211], v[68:71]
    v_mfma_f32_16x16x32_bf16 v[72:75], v[240:243], v[204:207], v[72:75]
    v_mfma_f32_16x16x32_bf16 v[76:79], v[240:243], v[208:211], v[76:79]
    v_mfma_f32_16x16x32_bf16 v[80:83], v[244:247], v[204:207], v[80:83]
    v_mfma_f32_16x16x32_bf16 v[84:87], v[244:247], v[208:211], v[84:87]
    s_waitcnt lgkmcnt(0)
    v_mfma_f32_16x16x32_bf16 v[16:19], v[192:195], v[160:163], v[16:19]
    ds_read_b128 v[204:207], v1 offset:46080
    v_mfma_f32_16x16x32_bf16 v[20:23], v[192:195], v[164:167], v[20:23]
    ds_read_b128 v[208:211], v1 offset:1024
    s_waitcnt lgkmcnt(3)
    v_mfma_f32_16x16x32_bf16 v[16:19], v[196:199], v[168:171], v[16:19]
    ds_read_b128 v[212:215], v1 offset:10240
    v_mfma_f32_16x16x32_bf16 v[20:23], v[196:199], v[172:175], v[20:23]
    ds_read_b128 v[216:219], v1 offset:37888
    s_waitcnt lgkmcnt(4)
    v_mfma_f32_16x16x32_bf16 v[16:19], v[200:203], v[176:179], v[16:19]
    ds_read_b128 v[220:223], v1 offset:47104
    v_mfma_f32_16x16x32_bf16 v[20:23], v[200:203], v[180:183], v[20:23]
    ds_read_b128 v[224:227], v1 offset:2048
    s_waitcnt lgkmcnt(5)
    v_mfma_f32_16x16x32_bf16 v[16:19], v[204:207], v[184:187], v[16:19]
    ds_read_b128 v[228:231], v1 offset:11264
    v_mfma_f32_16x16x32_bf16 v[20:23], v[204:207], v[188:191], v[20:23]
    ds_read_b128 v[232:235], v1 offset:38912
    s_waitcnt lgkmcnt(6)
    v_mfma_f32_16x16x32_bf16 v[24:27], v[208:211], v[160:163], v[24:27]
    ds_read_b128 v[236:239], v1 offset:48128
    v_mfma_f32_16x16x32_bf16 v[28:31], v[208:211], v[164:167], v[28:31]
    ds_read_b128 v[240:243], v1 offset:3072
    s_waitcnt lgkmcnt(7)
    v_mfma_f32_16x16x32_bf16 v[24:27], v[212:215], v[168:171], v[24:27]
    ds_read_b128 v[244:247], v1 offset:12288
    v_mfma_f32_16x16x32_bf16 v[28:31], v[212:215], v[172:175], v[28:31]
    s_waitcnt lgkmcnt(7)
    v_mfma_f32_16x16x32_bf16 v[24:27], v[216:219], v[176:179], v[24:27]
    ds_read_b128 v[192:195], v1 offset:39936
    v_mul_f32 v16, v16, v88
    v_mfma_f32_16x16x32_bf16 v[28:31], v[216:219], v[180:183], v[28:31]
    v_mul_f32 v17, v17, v89
    v_mul_f32 v18, v18, v90
    s_waitcnt lgkmcnt(7)
    v_mfma_f32_16x16x32_bf16 v[24:27], v[220:223], v[184:187], v[24:27]
    ds_read_b128 v[196:199], v1 offset:49152
    v_mul_f32 v19, v19, v91
    v_mfma_f32_16x16x32_bf16 v[28:31], v[220:223], v[188:191], v[28:31]
    v_cvt_pk_bf16_f32 v88, v16, v17
    v_cvt_pk_bf16_f32 v89, v18, v19
    s_waitcnt lgkmcnt(7)
    v_mfma_f32_16x16x32_bf16 v[32:35], v[224:227], v[160:163], v[32:35]
    ds_read_b128 v[200:203], v1 offset:4096
    v_mul_f32 v20, v20, v92
    v_mfma_f32_16x16x32_bf16 v[36:39], v[224:227], v[164:167], v[36:39]
    v_mul_f32 v21, v21, v93
    v_mul_f32 v22, v22, v94
    s_waitcnt lgkmcnt(7)
    v_mfma_f32_16x16x32_bf16 v[32:35], v[228:231], v[168:171], v[32:35]
    ds_read_b128 v[204:207], v1 offset:13312
    v_mul_f32 v23, v23, v95
    v_mfma_f32_16x16x32_bf16 v[36:39], v[228:231], v[172:175], v[36:39]
    v_cvt_pk_bf16_f32 v92, v20, v21
    v_cvt_pk_bf16_f32 v93, v22, v23
    s_waitcnt lgkmcnt(7)
    v_mfma_f32_16x16x32_bf16 v[32:35], v[232:235], v[176:179], v[32:35]
    ds_read_b128 v[208:211], v1 offset:40960
    v_mul_f32 v24, v24, v96
    v_mfma_f32_16x16x32_bf16 v[36:39], v[232:235], v[180:183], v[36:39]
    v_mul_f32 v25, v25, v97
    v_mul_f32 v26, v26, v98
    v_mul_f32 v27, v27, v99
    s_waitcnt lgkmcnt(7)
    v_mfma_f32_16x16x32_bf16 v[32:35], v[236:239], v[184:187], v[32:35]
    ds_read_b128 v[212:215], v1 offset:50176
    v_cvt_pk_bf16_f32 v90, v24, v25
    v_mfma_f32_16x16x32_bf16 v[36:39], v[236:239], v[188:191], v[36:39]
    v_cvt_pk_bf16_f32 v91, v26, v27
    buffer_store_dwordx4 v[88:91], v14, s[4:7], s39 offen sc1
    s_waitcnt lgkmcnt(7)
    v_mfma_f32_16x16x32_bf16 v[40:43], v[240:243], v[160:163], v[40:43]
    ds_read_b128 v[216:219], v1 offset:5120
    v_mul_f32 v28, v28, v100
    v_mfma_f32_16x16x32_bf16 v[44:47], v[240:243], v[164:167], v[44:47]
    v_mul_f32 v29, v29, v101
    v_mul_f32 v30, v30, v102
    s_waitcnt lgkmcnt(7)
    v_mfma_f32_16x16x32_bf16 v[40:43], v[244:247], v[168:171], v[40:43]
    ds_read_b128 v[220:223], v1 offset:14336
    v_mul_f32 v31, v31, v103
    v_mfma_f32_16x16x32_bf16 v[44:47], v[244:247], v[172:175], v[44:47]
    v_cvt_pk_bf16_f32 v94, v28, v29
    v_cvt_pk_bf16_f32 v95, v30, v31
    s_waitcnt lgkmcnt(7)
    v_mfma_f32_16x16x32_bf16 v[40:43], v[192:195], v[176:179], v[40:43]
    ds_read_b128 v[224:227], v1 offset:41984
    buffer_store_dwordx4 v[92:95], v14, s[4:7], s40 offen sc1
    v_mfma_f32_16x16x32_bf16 v[44:47], v[192:195], v[180:183], v[44:47]
    v_add_u32 v14, 16384, v14
    v_mul_f32 v32, v32, v104
    v_mul_f32 v33, v33, v105
    s_waitcnt lgkmcnt(7)
    v_mfma_f32_16x16x32_bf16 v[40:43], v[196:199], v[184:187], v[40:43]
    ds_read_b128 v[228:231], v1 offset:51200
    v_mul_f32 v34, v34, v106
    v_mfma_f32_16x16x32_bf16 v[44:47], v[196:199], v[188:191], v[44:47]
    v_mul_f32 v35, v35, v107
    v_cvt_pk_bf16_f32 v104, v32, v33
    s_waitcnt lgkmcnt(7)
    v_mfma_f32_16x16x32_bf16 v[48:51], v[200:203], v[160:163], v[48:51]
    ds_read_b128 v[232:235], v1 offset:6144
    v_cvt_pk_bf16_f32 v105, v34, v35
    v_mfma_f32_16x16x32_bf16 v[52:55], v[200:203], v[164:167], v[52:55]
    v_mul_f32 v36, v36, v108
    v_mul_f32 v37, v37, v109
    s_waitcnt lgkmcnt(7)
    v_mfma_f32_16x16x32_bf16 v[48:51], v[204:207], v[168:171], v[48:51]
    ds_read_b128 v[236:239], v1 offset:15360
    v_mul_f32 v38, v38, v110
    v_mfma_f32_16x16x32_bf16 v[52:55], v[204:207], v[172:175], v[52:55]
    v_mul_f32 v39, v39, v111
    v_cvt_pk_bf16_f32 v108, v36, v37
    s_waitcnt lgkmcnt(7)
    v_mfma_f32_16x16x32_bf16 v[48:51], v[208:211], v[176:179], v[48:51]
    ds_read_b128 v[240:243], v1 offset:43008
    v_cvt_pk_bf16_f32 v109, v38, v39
    v_mfma_f32_16x16x32_bf16 v[52:55], v[208:211], v[180:183], v[52:55]
    v_mul_f32 v40, v40, v112
    v_mul_f32 v41, v41, v113
    v_mul_f32 v42, v42, v114
    s_waitcnt lgkmcnt(7)
    v_mfma_f32_16x16x32_bf16 v[48:51], v[212:215], v[184:187], v[48:51]
    ds_read_b128 v[244:247], v1 offset:52224
    v_mul_f32 v43, v43, v115
    v_mfma_f32_16x16x32_bf16 v[52:55], v[212:215], v[188:191], v[52:55]
    v_cvt_pk_bf16_f32 v106, v40, v41
    v_cvt_pk_bf16_f32 v107, v42, v43
    s_waitcnt lgkmcnt(7)
    v_mfma_f32_16x16x32_bf16 v[56:59], v[216:219], v[160:163], v[56:59]
    ds_read_b128 v[192:195], v1 offset:7168
    buffer_store_dwordx4 v[104:107], v14, s[4:7], s39 offen sc1
    v_mfma_f32_16x16x32_bf16 v[60:63], v[216:219], v[164:167], v[60:63]
    v_mul_f32 v44, v44, v116
    v_mul_f32 v45, v45, v117
    s_waitcnt lgkmcnt(7)
    v_mfma_f32_16x16x32_bf16 v[56:59], v[220:223], v[168:171], v[56:59]
    ds_read_b128 v[196:199], v1 offset:16384
    v_mul_f32 v46, v46, v118
    v_mfma_f32_16x16x32_bf16 v[60:63], v[220:223], v[172:175], v[60:63]
    v_mul_f32 v47, v47, v119
    v_cvt_pk_bf16_f32 v110, v44, v45
    s_waitcnt lgkmcnt(7)
    v_mfma_f32_16x16x32_bf16 v[56:59], v[224:227], v[176:179], v[56:59]
    ds_read_b128 v[200:203], v1 offset:44032
    v_cvt_pk_bf16_f32 v111, v46, v47
    v_mfma_f32_16x16x32_bf16 v[60:63], v[224:227], v[180:183], v[60:63]
    buffer_store_dwordx4 v[108:111], v14, s[4:7], s40 offen sc1
    v_add_u32 v14, 16384, v14
    v_mul_f32 v48, v48, v120
    s_waitcnt lgkmcnt(7)
    v_mfma_f32_16x16x32_bf16 v[56:59], v[228:231], v[184:187], v[56:59]
    ds_read_b128 v[204:207], v1 offset:53248
    v_mul_f32 v49, v49, v121
    v_mfma_f32_16x16x32_bf16 v[60:63], v[228:231], v[188:191], v[60:63]
    v_mul_f32 v50, v50, v122
    v_mul_f32 v51, v51, v123
    s_waitcnt lgkmcnt(7)
    v_mfma_f32_16x16x32_bf16 v[64:67], v[232:235], v[160:163], v[64:67]
    ds_read_b128 v[208:211], v1 offset:8192
    v_cvt_pk_bf16_f32 v120, v48, v49
    v_mfma_f32_16x16x32_bf16 v[68:71], v[232:235], v[164:167], v[68:71]
    v_cvt_pk_bf16_f32 v121, v50, v51
    v_mul_f32 v52, v52, v124
    s_waitcnt lgkmcnt(7)
    v_mfma_f32_16x16x32_bf16 v[64:67], v[236:239], v[168:171], v[64:67]
    ds_read_b128 v[212:215], v1 offset:17408
    v_mul_f32 v53, v53, v125
    v_mfma_f32_16x16x32_bf16 v[68:71], v[236:239], v[172:175], v[68:71]
    v_mul_f32 v54, v54, v126
    v_mul_f32 v55, v55, v127
    s_waitcnt lgkmcnt(7)
    v_mfma_f32_16x16x32_bf16 v[64:67], v[240:243], v[176:179], v[64:67]
    ds_read_b128 v[216:219], v1 offset:45056
    v_cvt_pk_bf16_f32 v124, v52, v53
    v_mfma_f32_16x16x32_bf16 v[68:71], v[240:243], v[180:183], v[68:71]
    v_cvt_pk_bf16_f32 v125, v54, v55
    v_mul_f32 v56, v56, v128
    v_mul_f32 v57, v57, v129
    s_waitcnt lgkmcnt(7)
    v_mfma_f32_16x16x32_bf16 v[64:67], v[244:247], v[184:187], v[64:67]
    ds_read_b128 v[220:223], v1 offset:54272
    v_mul_f32 v58, v58, v130
    v_mfma_f32_16x16x32_bf16 v[68:71], v[244:247], v[188:191], v[68:71]
    v_mul_f32 v59, v59, v131
    v_cvt_pk_bf16_f32 v122, v56, v57
    v_cvt_pk_bf16_f32 v123, v58, v59
    s_waitcnt lgkmcnt(7)
    v_mfma_f32_16x16x32_bf16 v[72:75], v[192:195], v[160:163], v[72:75]
    buffer_store_dwordx4 v[120:123], v14, s[4:7], s39 offen sc1
    v_mul_f32 v60, v60, v132
    v_mfma_f32_16x16x32_bf16 v[76:79], v[192:195], v[164:167], v[76:79]
    v_mul_f32 v61, v61, v133
    v_mul_f32 v62, v62, v134
    s_waitcnt lgkmcnt(6)
    v_mfma_f32_16x16x32_bf16 v[72:75], v[196:199], v[168:171], v[72:75]
    v_mul_f32 v63, v63, v135
    v_cvt_pk_bf16_f32 v126, v60, v61
    v_mfma_f32_16x16x32_bf16 v[76:79], v[196:199], v[172:175], v[76:79]
    v_cvt_pk_bf16_f32 v127, v62, v63
    buffer_store_dwordx4 v[124:127], v14, s[4:7], s40 offen sc1
    s_waitcnt lgkmcnt(5)
    v_mfma_f32_16x16x32_bf16 v[72:75], v[200:203], v[176:179], v[72:75]
    v_add_u32 v14, 16384, v14
    v_mul_f32 v64, v64, v136
    v_mfma_f32_16x16x32_bf16 v[76:79], v[200:203], v[180:183], v[76:79]
    v_mul_f32 v65, v65, v137
    v_mul_f32 v66, v66, v138
    v_mul_f32 v67, v67, v139
    s_waitcnt lgkmcnt(4)
    v_mfma_f32_16x16x32_bf16 v[72:75], v[204:207], v[184:187], v[72:75]
    v_cvt_pk_bf16_f32 v136, v64, v65
    v_cvt_pk_bf16_f32 v137, v66, v67
    v_mfma_f32_16x16x32_bf16 v[76:79], v[204:207], v[188:191], v[76:79]
    v_mul_f32 v68, v68, v140
    v_mul_f32 v69, v69, v141
    s_waitcnt lgkmcnt(3)
    v_mfma_f32_16x16x32_bf16 v[80:83], v[208:211], v[160:163], v[80:83]
    v_mul_f32 v70, v70, v142
    v_mul_f32 v71, v71, v143
    v_mfma_f32_16x16x32_bf16 v[84:87], v[208:211], v[164:167], v[84:87]
    v_cvt_pk_bf16_f32 v140, v68, v69
    v_cvt_pk_bf16_f32 v141, v70, v71
    s_waitcnt lgkmcnt(2)
    v_mfma_f32_16x16x32_bf16 v[80:83], v[212:215], v[168:171], v[80:83]
    v_mfma_f32_16x16x32_bf16 v[84:87], v[212:215], v[172:175], v[84:87]
    s_waitcnt lgkmcnt(1)
    v_mfma_f32_16x16x32_bf16 v[80:83], v[216:219], v[176:179], v[80:83]
    v_mul_f32 v72, v72, v144
    v_mul_f32 v73, v73, v145
    v_mfma_f32_16x16x32_bf16 v[84:87], v[216:219], v[180:183], v[84:87]
    v_mul_f32 v74, v74, v146
    v_mul_f32 v75, v75, v147
    v_cvt_pk_bf16_f32 v138, v72, v73
    s_waitcnt lgkmcnt(0)
    v_mfma_f32_16x16x32_bf16 v[80:83], v[220:223], v[184:187], v[80:83]
    v_cvt_pk_bf16_f32 v139, v74, v75
    buffer_store_dwordx4 v[136:139], v14, s[4:7], s39 offen sc1
    v_mfma_f32_16x16x32_bf16 v[84:87], v[220:223], v[188:191], v[84:87]
    v_mul_f32 v76, v76, v148
    v_mul_f32 v77, v77, v149
    v_mul_f32 v78, v78, v150
    v_mul_f32 v79, v79, v151
    v_cvt_pk_bf16_f32 v142, v76, v77
    v_cvt_pk_bf16_f32 v143, v78, v79
    buffer_store_dwordx4 v[140:143], v14, s[4:7], s40 offen sc1
    s_nop 1
    v_mul_f32 v80, v80, v152
    v_mul_f32 v81, v81, v153
    v_mul_f32 v82, v82, v154
    v_mul_f32 v83, v83, v155
    v_cvt_pk_bf16_f32 v152, v80, v81
    v_cvt_pk_bf16_f32 v153, v82, v83
    buffer_store_dwordx2 v[152:153], v15, s[4:7], s39 offen sc1
    v_mul_f32 v84, v84, v156
    v_mul_f32 v85, v85, v157
    v_mul_f32 v86, v86, v158
    v_mul_f32 v87, v87, v159
    v_cvt_pk_bf16_f32 v156, v84, v85
    v_cvt_pk_bf16_f32 v157, v86, v87
    buffer_store_dwordx2 v[156:157], v15, s[4:7], s40 offen sc1
    s_barrier
    s_and_b32 s25, s2, 7
    s_lshr_b32 s26, s2, 3
    s_lshr_b32 s23, s25, 1
    s_lshl_b32 s23, s23, 3
    s_lshr_b32 s27, s26, 2
    s_add_u32 s23, s23, s27
    s_and_b32 s24, s25, 1
    s_lshl_b32 s24, s24, 2
    s_and_b32 s27, s26, 3
    s_add_u32 s24, s24, s27
    s_add_u32 s25, s23, s24
    s_and_b32 s25, s25, 3
    s_lshl_b32 s30, s23, 2
    s_add_u32 s30, s30, s20
    s_and_b32 s31, s20, 1
    s_mul_i32 s34, s30, 18432
    s_add_u32 s34, s34, s21
    s_add_u32 s34, s34, 0x300000
    s_lshl_b32 s35, s24, 11
    s_lshr_b32 s36, s24, 2
    s_lshl_b32 s36, s36, 10
    s_and_b32 s37, s24, 3
    s_lshl_b32 s37, s37, 8
    s_add_u32 s36, s36, s37
    s_add_u32 s36, s36, 16384
    v_bfe_u32 v2, v1, 4, 4
    v_lshrrev_b32 v3, 8, v1
    v_add_u32 v4, s35, v1
    v_lshrrev_b32 v0, 1, v3
    v_and_b32 v9, 1, v3
    v_cmp_eq_u32 s[40:41], s31, v0
    v_bfrev_b32 v6, 1
    v_lshlrev_b32 v5, 4, v2
    v_lshl_add_u32 v5, v9, 3, v5
    v_add_u32 v5, s36, v5
    v_cndmask_b32 v5, v6, v5, s[40:41]
    buffer_load_dwordx4 v[220:223], v4, s[4:7], s34 offen offset:0 sc1
    buffer_load_dwordx4 v[224:227], v4, s[4:7], s34 offen offset:1024 sc1
    buffer_load_dwordx2 v[228:229], v5, s[4:7], s34 offen sc1
    s_and_b32 s29, s30, 0xfffe
    s_mul_i32 s29, s29, 73728
    s_add_u32 s29, s29, s21
    s_lshl_b32 s37, s31, 10
    s_add_u32 s29, s29, s37
    s_add_u32 s29, s29, 0x1200000
    s_mul_i32 s37, s31, 73728
    s_sub_u32 s38, 73728, s37
    v_lshlrev_b32 v10, 3, v2
    v_lshrrev_b32 v7, 1, v1
    v_add_u32 v16, s37, v1
    v_add_u32 v17, s38, v1
    v_add_u32 v18, s37, v7
    v_add_u32 v19, s38, v7
    s_lshl_b32 s37, s31, 12
    v_add_u32 v20, 0, v1
    v_add_u32 v12, s37, v20
    v_add_u32 v21, 36864, v1
    v_add_u32 v13, s37, v21
    v_add_u32 v22, 73728, v1
    v_add_u32 v14, s37, v22
    v_add_u32 v23, 110592, v1
    v_add_u32 v15, s37, v23
    s_add_u32 s34, s34, 0x1900000
    s_lshl_b32 s39, s30, 10
    s_add_u32 s39, s39, s21
    s_lshl_b32 s42, s24, 7
    s_add_u32 s39, s39, s42
    s_add_u32 s39, s39, 0x3700000
    v_cmp_eq_u32 vcc, 0, v3
    v_mov_b32 v11, 0x3f803f80
    s_lshr_b32 s44, s23, 1
    v_cndmask_b32 v10, v6, v10, vcc
    s_cmp_eq_u32 s22, 0
    s_cbranch_scc1 L_p5_nf
    v_mul_u32_u24 v8, 1152, v2
    s_mul_i32 s34, s30, 18432
    s_mul_i32 s42, s24, 144
    s_add_u32 s34, s34, s42
    v_lshl_add_u32 v4, v3, 4, v8
    v_lshl_add_u32 v5, v9, 3, v8
    v_cndmask_b32 v5, v6, v5, s[40:41]
L_p5_nf:
    s_lshl_b32 s52, s22, 7
    s_add_u32 s52, s52, s44
    s_lshl_b32 s52, s52, 8
    s_add_u32 s52, s52, 0x450a000
    s_add_u32 s52, s52, s4
    s_addc_u32 s53, s5, 0
    s_waitcnt vmcnt(3)
    s_barrier
    s_cmp_lg_u32 s20, 0
    s_cbranch_scc1 L_ns_d5
    s_mov_b32 s56, 1
    s_atomic_add s56, s[50:51], 0
L_ns_d5:
    s_mul_i32 s37, s20, 4608
    s_add_u32 s37, s37, 131072
    s_xor_b32 s38, s20, 1
    s_mul_i32 s42, s38, 4608
    s_add_u32 s42, s42, 131072
    v_and_b32 v0, 0x1ff, v1
    v_add_u32 v2, s37, v1
    v_add_u32 v3, s37, v0
    v_add_u32 v7, s42, v1
    v_add_u32 v8, s42, v0
    s_lshl_b32 s37, s20, 2
    s_add_u32 s37, s37, 163808
    s_xor_b32 s38, s37, 4
    v_mov_b32 v0, s37
    v_mov_b32 v6, s38
    s_lshl_b32 s43, s22, 1
    s_add_u32 s43, s43, 2
    v_mov_b32 v9, s43
    s_cmp_lg_u32 s20, 0
    s_cbranch_scc1 L_pd_d5
    s_mov_b32 s60, 65536
L_poll_d5:
    s_mov_b32 s57, 0
    s_atomic_add s57, s[52:53], 0 glc
    s_waitcnt lgkmcnt(0)
    s_cmp_ge_u32 s57, 16
    s_cbranch_scc1 L_pd_d5
    s_sub_u32 s60, s60, 1
    s_cbranch_scc1 L_pd_d5
    s_sleep 2
    s_branch L_poll_d5
L_pd_d5:
    s_barrier
    s_mov_b32 s32, 0
    s_lshl_b32 s32, s32, 13
    s_add_u32 s32, s32, s29
    s_add_u32 s33, s32, 4096
    buffer_load_dwordx4 v[124:127], v16, s[4:7], s32 offen offset:0 sc1
    buffer_load_dwordx4 v[128:131], v17, s[4:7], s32 offen offset:0 sc1
    buffer_load_dwordx4 v[132:135], v16, s[4:7], s32 offen offset:2048 sc1
    buffer_load_dwordx4 v[136:139], v17, s[4:7], s32 offen offset:2048 sc1
    buffer_load_dwordx4 v[140:143], v16, s[4:7], s33 offen offset:0 sc1
    buffer_load_dwordx4 v[144:147], v17, s[4:7], s33 offen offset:0 sc1
    buffer_load_dwordx4 v[148:151], v16, s[4:7], s33 offen offset:2048 sc1
    buffer_load_dwordx4 v[152:155], v17, s[4:7], s33 offen offset:2048 sc1
    ds_read_b128 v[64:67], v14 offset:0
    ds_read_b128 v[68:71], v14 offset:1024
    ds_read_b128 v[72:75], v14 offset:2048
    ds_read_b128 v[76:79], v14 offset:3072
    ds_read_b128 v[80:83], v22 offset:8192
    ds_read_b128 v[84:87], v14 offset:9216
    ds_read_b128 v[88:91], v14 offset:10240
    ds_read_b128 v[92:95], v14 offset:11264
    ds_read_b128 v[96:99], v14 offset:12288
    ds_read_b128 v[100:103], v22 offset:17408
    s_add_u32 s45, s29, 8192
    s_add_u32 s46, s29, 12288
    buffer_load_dwordx4 v[156:159], v16, s[4:7], s45 offen offset:0 sc1
    buffer_load_dwordx4 v[160:163], v17, s[4:7], s45 offen offset:0 sc1
    s_lshl_b32 s50, s22, 7
    s_add_u32 s50, s50, s44
    s_lshl_b32 s50, s50, 8
    s_add_u32 s50, s50, 0x450b000
    s_add_u32 s50, s50, s4
    s_addc_u32 s51, s5, 0
    s_waitcnt vmcnt(10)
    v_lshlrev_b32 v24, 16, v220
    v_and_b32 v25, 0xffff0000, v220
    v_lshlrev_b32 v26, 16, v221
    v_and_b32 v27, 0xffff0000, v221
    v_lshlrev_b32 v28, 16, v222
    v_and_b32 v29, 0xffff0000, v222
    v_lshlrev_b32 v30, 16, v223
    v_and_b32 v31, 0xffff0000, v223
    v_lshlrev_b32 v32, 16, v224
    v_and_b32 v33, 0xffff0000, v224
    v_lshlrev_b32 v34, 16, v225
    v_and_b32 v35, 0xffff0000, v225
    v_lshlrev_b32 v36, 16, v226
    v_and_b32 v37, 0xffff0000, v226
    v_lshlrev_b32 v38, 16, v227
    v_and_b32 v39, 0xffff0000, v227
    v_lshlrev_b32 v40, 16, v228
    v_and_b32 v41, 0xffff0000, v228
    v_lshlrev_b32 v42, 16, v229
    v_and_b32 v43, 0xffff0000, v229
    s_waitcnt vmcnt(8) lgkmcnt(5)
    v_mfma_f32_16x16x32_bf16 v[44:47], v[64:67], v[128:131], 0
    ds_read_b128 v[104:107], v14 offset:18432
    s_mov_b32 s32, 2
    s_lshl_b32 s32, s32, 13
    s_add_u32 s32, s32, s29
    s_add_u32 s33, s32, 4096
    v_mfma_f32_16x16x32_bf16 v[24:27], v[64:67], v[124:127], v[24:27]
    ds_read_b128 v[108:111], v14 offset:19456
    buffer_load_dwordx4 v[164:167], v16, s[4:7], s45 offen offset:2048 sc1
    v_mfma_f32_16x16x32_bf16 v[48:51], v[68:71], v[128:131], 0
    ds_read_b128 v[112:115], v14 offset:20480
    v_mfma_f32_16x16x32_bf16 v[28:31], v[68:71], v[124:127], v[28:31]
    ds_read_b128 v[116:119], v14 offset:21504
    buffer_load_dwordx4 v[168:171], v17, s[4:7], s45 offen offset:2048 sc1
    v_mfma_f32_16x16x32_bf16 v[52:55], v[72:75], v[128:131], 0
    ds_read_b128 v[120:123], v22 offset:26624
    v_mfma_f32_16x16x32_bf16 v[32:35], v[72:75], v[124:127], v[32:35]
    buffer_load_dwordx4 v[188:191], v16, s[4:7], s32 offen offset:0 sc1
    v_mfma_f32_16x16x32_bf16 v[56:59], v[76:79], v[128:131], 0
    v_mfma_f32_16x16x32_bf16 v[36:39], v[76:79], v[124:127], v[36:39]
    buffer_load_dwordx4 v[192:195], v17, s[4:7], s32 offen offset:0 sc1
    v_mfma_f32_16x16x32_bf16 v[60:63], v[80:83], v[128:131], 0
    v_mfma_f32_16x16x32_bf16 v[40:43], v[80:83], v[124:127], v[40:43]
    s_waitcnt vmcnt(10) lgkmcnt(5)
    v_mfma_f32_16x16x32_bf16 v[44:47], v[84:87], v[136:139], v[44:47]
    ds_read_b128 v[64:67], v14 offset:27648
    v_mfma_f32_16x16x32_bf16 v[24:27], v[84:87], v[132:135], v[24:27]
    ds_read_b128 v[68:71], v14 offset:28672
    buffer_load_dwordx4 v[172:175], v16, s[4:7], s46 offen offset:0 sc1
    v_mfma_f32_16x16x32_bf16 v[48:51], v[88:91], v[136:139], v[48:51]
    ds_read_b128 v[72:75], v14 offset:29696
    v_mfma_f32_16x16x32_bf16 v[28:31], v[88:91], v[132:135], v[28:31]
    ds_read_b128 v[76:79], v14 offset:30720
    buffer_load_dwordx4 v[176:179], v17, s[4:7], s46 offen offset:0 sc1
    v_mfma_f32_16x16x32_bf16 v[52:55], v[92:95], v[136:139], v[52:55]
    ds_read_b128 v[80:83], v22 offset:35840
    v_mfma_f32_16x16x32_bf16 v[32:35], v[92:95], v[132:135], v[32:35]
    buffer_load_dwordx4 v[196:199], v16, s[4:7], s32 offen offset:2048 sc1
    v_mfma_f32_16x16x32_bf16 v[56:59], v[96:99], v[136:139], v[56:59]
    v_mfma_f32_16x16x32_bf16 v[36:39], v[96:99], v[132:135], v[36:39]
    buffer_load_dwordx4 v[200:203], v17, s[4:7], s32 offen offset:2048 sc1
    v_mfma_f32_16x16x32_bf16 v[60:63], v[100:103], v[136:139], v[60:63]
    v_mfma_f32_16x16x32_bf16 v[40:43], v[100:103], v[132:135], v[40:43]
    s_waitcnt vmcnt(12) lgkmcnt(0)
    s_barrier
    v_mfma_f32_16x16x32_bf16 v[44:47], v[104:107], v[144:147], v[44:47]
    ds_read_b128 v[84:87], v15 offset:0
    v_mfma_f32_16x16x32_bf16 v[24:27], v[104:107], v[140:143], v[24:27]
    ds_read_b128 v[88:91], v15 offset:1024
    buffer_load_dwordx4 v[180:183], v16, s[4:7], s46 offen offset:2048 sc1
    v_mfma_f32_16x16x32_bf16 v[48:51], v[108:111], v[144:147], v[48:51]
    ds_read_b128 v[92:95], v15 offset:2048
    v_mfma_f32_16x16x32_bf16 v[28:31], v[108:111], v[140:143], v[28:31]
    ds_read_b128 v[96:99], v15 offset:3072
    buffer_load_dwordx4 v[184:187], v17, s[4:7], s46 offen offset:2048 sc1
    v_mfma_f32_16x16x32_bf16 v[52:55], v[112:115], v[144:147], v[52:55]
    ds_read_b128 v[100:103], v23 offset:8192
    v_mfma_f32_16x16x32_bf16 v[32:35], v[112:115], v[140:143], v[32:35]
    buffer_load_dwordx4 v[204:207], v16, s[4:7], s33 offen offset:0 sc1
    v_mfma_f32_16x16x32_bf16 v[56:59], v[116:119], v[144:147], v[56:59]
    v_mfma_f32_16x16x32_bf16 v[36:39], v[116:119], v[140:143], v[36:39]
    buffer_load_dwordx4 v[208:211], v17, s[4:7], s33 offen offset:0 sc1
    v_mfma_f32_16x16x32_bf16 v[60:63], v[120:123], v[144:147], v[60:63]
    v_mfma_f32_16x16x32_bf16 v[40:43], v[120:123], v[140:143], v[40:43]
    s_waitcnt vmcnt(14) lgkmcnt(5)
    v_mfma_f32_16x16x32_bf16 v[44:47], v[64:67], v[152:155], v[44:47]
    ds_read_b128 v[104:107], v15 offset:9216
    v_mfma_f32_16x16x32_bf16 v[24:27], v[64:67], v[148:151], v[24:27]
    ds_read_b128 v[108:111], v15 offset:10240
    v_mfma_f32_16x16x32_bf16 v[48:51], v[68:71], v[152:155], v[48:51]
    ds_read_b128 v[112:115], v15 offset:11264
    v_mfma_f32_16x16x32_bf16 v[28:31], v[68:71], v[148:151], v[28:31]
    ds_read_b128 v[116:119], v15 offset:12288
    v_mfma_f32_16x16x32_bf16 v[52:55], v[72:75], v[152:155], v[52:55]
    ds_read_b128 v[120:123], v23 offset:17408
    v_mfma_f32_16x16x32_bf16 v[32:35], v[72:75], v[148:151], v[32:35]
    buffer_load_dwordx4 v[212:215], v16, s[4:7], s33 offen offset:2048 sc1
    v_mfma_f32_16x16x32_bf16 v[56:59], v[76:79], v[152:155], v[56:59]
    v_mfma_f32_16x16x32_bf16 v[36:39], v[76:79], v[148:151], v[36:39]
    buffer_load_dwordx4 v[216:219], v17, s[4:7], s33 offen offset:2048 sc1
    v_mfma_f32_16x16x32_bf16 v[60:63], v[80:83], v[152:155], v[60:63]
    v_mfma_f32_16x16x32_bf16 v[40:43], v[80:83], v[148:151], v[40:43]
    s_waitcnt vmcnt(14) lgkmcnt(5)
    v_mfma_f32_16x16x32_bf16 v[44:47], v[84:87], v[160:163], v[44:47]
    ds_read_b128 v[64:67], v15 offset:18432
    s_mov_b32 s32, 3
    s_lshl_b32 s32, s32, 13
    s_add_u32 s32, s32, s29
    s_add_u32 s33, s32, 4096
    v_mfma_f32_16x16x32_bf16 v[24:27], v[84:87], v[156:159], v[24:27]
    ds_read_b128 v[68:71], v15 offset:19456
    v_mfma_f32_16x16x32_bf16 v[48:51], v[88:91], v[160:163], v[48:51]
    ds_read_b128 v[72:75], v15 offset:20480
    v_mfma_f32_16x16x32_bf16 v[28:31], v[88:91], v[156:159], v[28:31]
    ds_read_b128 v[76:79], v15 offset:21504
    v_mfma_f32_16x16x32_bf16 v[52:55], v[92:95], v[160:163], v[52:55]
    ds_read_b128 v[80:83], v23 offset:26624
    v_mfma_f32_16x16x32_bf16 v[32:35], v[92:95], v[156:159], v[32:35]
    buffer_load_dwordx4 v[124:127], v16, s[4:7], s32 offen offset:0 sc1
    v_mfma_f32_16x16x32_bf16 v[56:59], v[96:99], v[160:163], v[56:59]
    v_mfma_f32_16x16x32_bf16 v[36:39], v[96:99], v[156:159], v[36:39]
    buffer_load_dwordx4 v[128:131], v17, s[4:7], s32 offen offset:0 sc1
    v_mfma_f32_16x16x32_bf16 v[60:63], v[100:103], v[160:163], v[60:63]
    v_mfma_f32_16x16x32_bf16 v[40:43], v[100:103], v[156:159], v[40:43]
    s_waitcnt vmcnt(14) lgkmcnt(5)
    v_mfma_f32_16x16x32_bf16 v[44:47], v[104:107], v[168:171], v[44:47]
    ds_read_b128 v[84:87], v15 offset:27648
    v_mfma_f32_16x16x32_bf16 v[24:27], v[104:107], v[164:167], v[24:27]
    ds_read_b128 v[88:91], v15 offset:28672
    v_mfma_f32_16x16x32_bf16 v[48:51], v[108:111], v[168:171], v[48:51]
    ds_read_b128 v[92:95], v15 offset:29696
    v_mfma_f32_16x16x32_bf16 v[28:31], v[108:111], v[164:167], v[28:31]
    ds_read_b128 v[96:99], v15 offset:30720
    v_mfma_f32_16x16x32_bf16 v[52:55], v[112:115], v[168:171], v[52:55]
    ds_read_b128 v[100:103], v23 offset:35840
    v_mfma_f32_16x16x32_bf16 v[32:35], v[112:115], v[164:167], v[32:35]
    buffer_load_dwordx4 v[132:135], v16, s[4:7], s32 offen offset:2048 sc1
    v_mfma_f32_16x16x32_bf16 v[56:59], v[116:119], v[168:171], v[56:59]
    v_mfma_f32_16x16x32_bf16 v[36:39], v[116:119], v[164:167], v[36:39]
    buffer_load_dwordx4 v[136:139], v17, s[4:7], s32 offen offset:2048 sc1
    v_mfma_f32_16x16x32_bf16 v[60:63], v[120:123], v[168:171], v[60:63]
    v_mfma_f32_16x16x32_bf16 v[40:43], v[120:123], v[164:167], v[40:43]
    s_waitcnt vmcnt(12) lgkmcnt(0)
    s_barrier
    v_mfma_f32_16x16x32_bf16 v[44:47], v[64:67], v[176:179], v[44:47]
    ds_read_b128 v[104:107], v12 offset:0
    v_mfma_f32_16x16x32_bf16 v[24:27], v[64:67], v[172:175], v[24:27]
    ds_read_b128 v[108:111], v12 offset:1024
    v_mfma_f32_16x16x32_bf16 v[48:51], v[68:71], v[176:179], v[48:51]
    ds_read_b128 v[112:115], v12 offset:2048
    v_mfma_f32_16x16x32_bf16 v[28:31], v[68:71], v[172:175], v[28:31]
    ds_read_b128 v[116:119], v12 offset:3072
    v_mfma_f32_16x16x32_bf16 v[52:55], v[72:75], v[176:179], v[52:55]
    ds_read_b128 v[120:123], v20 offset:8192
    v_mfma_f32_16x16x32_bf16 v[32:35], v[72:75], v[172:175], v[32:35]
    buffer_load_dwordx4 v[140:143], v16, s[4:7], s33 offen offset:0 sc1
    v_mfma_f32_16x16x32_bf16 v[56:59], v[76:79], v[176:179], v[56:59]
    v_mfma_f32_16x16x32_bf16 v[36:39], v[76:79], v[172:175], v[36:39]
    buffer_load_dwordx4 v[144:147], v17, s[4:7], s33 offen offset:0 sc1
    v_mfma_f32_16x16x32_bf16 v[60:63], v[80:83], v[176:179], v[60:63]
    v_mfma_f32_16x16x32_bf16 v[40:43], v[80:83], v[172:175], v[40:43]
    s_waitcnt vmcnt(10) lgkmcnt(5)
    v_mfma_f32_16x16x32_bf16 v[44:47], v[84:87], v[184:187], v[44:47]
    ds_read_b128 v[64:67], v12 offset:9216
    v_mfma_f32_16x16x32_bf16 v[24:27], v[84:87], v[180:183], v[24:27]
    ds_read_b128 v[68:71], v12 offset:10240
    v_mfma_f32_16x16x32_bf16 v[48:51], v[88:91], v[184:187], v[48:51]
    ds_read_b128 v[72:75], v12 offset:11264
    v_mfma_f32_16x16x32_bf16 v[28:31], v[88:91], v[180:183], v[28:31]
    ds_read_b128 v[76:79], v12 offset:12288
    v_mfma_f32_16x16x32_bf16 v[52:55], v[92:95], v[184:187], v[52:55]
    ds_read_b128 v[80:83], v20 offset:17408
    v_mfma_f32_16x16x32_bf16 v[32:35], v[92:95], v[180:183], v[32:35]
    buffer_load_dwordx4 v[148:151], v16, s[4:7], s33 offen offset:2048 sc1
    v_mfma_f32_16x16x32_bf16 v[56:59], v[96:99], v[184:187], v[56:59]
    v_mfma_f32_16x16x32_bf16 v[36:39], v[96:99], v[180:183], v[36:39]
    buffer_load_dwordx4 v[152:155], v17, s[4:7], s33 offen offset:2048 sc1
    v_mfma_f32_16x16x32_bf16 v[60:63], v[100:103], v[184:187], v[60:63]
    v_mfma_f32_16x16x32_bf16 v[40:43], v[100:103], v[180:183], v[40:43]
    s_waitcnt vmcnt(12) lgkmcnt(5)
    v_mfma_f32_16x16x32_bf16 v[44:47], v[104:107], v[192:195], v[44:47]
    ds_read_b128 v[84:87], v12 offset:18432
    s_mov_b32 s32, 4
    s_lshl_b32 s32, s32, 13
    s_add_u32 s32, s32, s29
    s_add_u32 s33, s32, 4096
    v_mfma_f32_16x16x32_bf16 v[24:27], v[104:107], v[188:191], v[24:27]
    ds_read_b128 v[88:91], v12 offset:19456
    v_mfma_f32_16x16x32_bf16 v[48:51], v[108:111], v[192:195], v[48:51]
    ds_read_b128 v[92:95], v12 offset:20480
    v_mfma_f32_16x16x32_bf16 v[28:31], v[108:111], v[188:191], v[28:31]
    ds_read_b128 v[96:99], v12 offset:21504
    v_mfma_f32_16x16x32_bf16 v[52:55], v[112:115], v[192:195], v[52:55]
    ds_read_b128 v[100:103], v20 offset:26624
    v_mfma_f32_16x16x32_bf16 v[32:35], v[112:115], v[188:191], v[32:35]
    buffer_load_dwordx4 v[156:159], v16, s[4:7], s32 offen offset:0 sc1
    v_mfma_f32_16x16x32_bf16 v[56:59], v[116:119], v[192:195], v[56:59]
    v_mfma_f32_16x16x32_bf16 v[36:39], v[116:119], v[188:191], v[36:39]
    buffer_load_dwordx4 v[160:163], v17, s[4:7], s32 offen offset:0 sc1
    v_mfma_f32_16x16x32_bf16 v[60:63], v[120:123], v[192:195], v[60:63]
    v_mfma_f32_16x16x32_bf16 v[40:43], v[120:123], v[188:191], v[40:43]
    s_waitcnt vmcnt(14) lgkmcnt(5)
    v_mfma_f32_16x16x32_bf16 v[44:47], v[64:67], v[200:203], v[44:47]
    ds_read_b128 v[104:107], v12 offset:27648
    v_mfma_f32_16x16x32_bf16 v[24:27], v[64:67], v[196:199], v[24:27]
    ds_read_b128 v[108:111], v12 offset:28672
    v_mfma_f32_16x16x32_bf16 v[48:51], v[68:71], v[200:203], v[48:51]
    ds_read_b128 v[112:115], v12 offset:29696
    v_mfma_f32_16x16x32_bf16 v[28:31], v[68:71], v[196:199], v[28:31]
    ds_read_b128 v[116:119], v12 offset:30720
    v_mfma_f32_16x16x32_bf16 v[52:55], v[72:75], v[200:203], v[52:55]
    ds_read_b128 v[120:123], v20 offset:35840
    v_mfma_f32_16x16x32_bf16 v[32:35], v[72:75], v[196:199], v[32:35]
    buffer_load_dwordx4 v[164:167], v16, s[4:7], s32 offen offset:2048 sc1
    v_mfma_f32_16x16x32_bf16 v[56:59], v[76:79], v[200:203], v[56:59]
    v_mfma_f32_16x16x32_bf16 v[36:39], v[76:79], v[196:199], v[36:39]
    buffer_load_dwordx4 v[168:171], v17, s[4:7], s32 offen offset:2048 sc1
    v_mfma_f32_16x16x32_bf16 v[60:63], v[80:83], v[200:203], v[60:63]
    v_mfma_f32_16x16x32_bf16 v[40:43], v[80:83], v[196:199], v[40:43]
    s_waitcnt vmcnt(14) lgkmcnt(0)
    s_barrier
    v_mfma_f32_16x16x32_bf16 v[44:47], v[84:87], v[208:211], v[44:47]
    ds_read_b128 v[64:67], v13 offset:0
    v_mfma_f32_16x16x32_bf16 v[24:27], v[84:87], v[204:207], v[24:27]
    ds_read_b128 v[68:71], v13 offset:1024
    v_mfma_f32_16x16x32_bf16 v[48:51], v[88:91], v[208:211], v[48:51]
    ds_read_b128 v[72:75], v13 offset:2048
    v_mfma_f32_16x16x32_bf16 v[28:31], v[88:91], v[204:207], v[28:31]
    ds_read_b128 v[76:79], v13 offset:3072
    v_mfma_f32_16x16x32_bf16 v[52:55], v[92:95], v[208:211], v[52:55]
    ds_read_b128 v[80:83], v21 offset:8192
    v_mfma_f32_16x16x32_bf16 v[32:35], v[92:95], v[204:207], v[32:35]
    buffer_load_dwordx4 v[172:175], v16, s[4:7], s33 offen offset:0 sc1
    v_mfma_f32_16x16x32_bf16 v[56:59], v[96:99], v[208:211], v[56:59]
    v_mfma_f32_16x16x32_bf16 v[36:39], v[96:99], v[204:207], v[36:39]
    buffer_load_dwordx4 v[176:179], v17, s[4:7], s33 offen offset:0 sc1
    v_mfma_f32_16x16x32_bf16 v[60:63], v[100:103], v[208:211], v[60:63]
    v_mfma_f32_16x16x32_bf16 v[40:43], v[100:103], v[204:207], v[40:43]
    s_waitcnt vmcnt(14) lgkmcnt(5)
    v_mfma_f32_16x16x32_bf16 v[44:47], v[104:107], v[216:219], v[44:47]
    ds_read_b128 v[84:87], v13 offset:9216
    v_mfma_f32_16x16x32_bf16 v[24:27], v[104:107], v[212:215], v[24:27]
    ds_read_b128 v[88:91], v13 offset:10240
    v_mfma_f32_16x16x32_bf16 v[48:51], v[108:111], v[216:219], v[48:51]
    ds_read_b128 v[92:95], v13 offset:11264
    v_mfma_f32_16x16x32_bf16 v[28:31], v[108:111], v[212:215], v[28:31]
    ds_read_b128 v[96:99], v13 offset:12288
    v_mfma_f32_16x16x32_bf16 v[52:55], v[112:115], v[216:219], v[52:55]
    ds_read_b128 v[100:103], v21 offset:17408
    v_mfma_f32_16x16x32_bf16 v[32:35], v[112:115], v[212:215], v[32:35]
    buffer_load_dwordx4 v[180:183], v16, s[4:7], s33 offen offset:2048 sc1
    v_mfma_f32_16x16x32_bf16 v[56:59], v[116:119], v[216:219], v[56:59]
    v_mfma_f32_16x16x32_bf16 v[36:39], v[116:119], v[212:215], v[36:39]
    buffer_load_dwordx4 v[184:187], v17, s[4:7], s33 offen offset:2048 sc1
    v_mfma_f32_16x16x32_bf16 v[60:63], v[120:123], v[216:219], v[60:63]
    v_mfma_f32_16x16x32_bf16 v[40:43], v[120:123], v[212:215], v[40:43]
    s_waitcnt vmcnt(14) lgkmcnt(5)
    v_mfma_f32_16x16x32_bf16 v[44:47], v[64:67], v[128:131], v[44:47]
    ds_read_b128 v[104:107], v13 offset:18432
    s_mov_b32 s32, 5
    s_lshl_b32 s32, s32, 13
    s_add_u32 s32, s32, s29
    s_add_u32 s33, s32, 4096
    v_mfma_f32_16x16x32_bf16 v[24:27], v[64:67], v[124:127], v[24:27]
    ds_read_b128 v[108:111], v13 offset:19456
    v_mfma_f32_16x16x32_bf16 v[48:51], v[68:71], v[128:131], v[48:51]
    ds_read_b128 v[112:115], v13 offset:20480
    v_mfma_f32_16x16x32_bf16 v[28:31], v[68:71], v[124:127], v[28:31]
    ds_read_b128 v[116:119], v13 offset:21504
    v_mfma_f32_16x16x32_bf16 v[52:55], v[72:75], v[128:131], v[52:55]
    ds_read_b128 v[120:123], v21 offset:26624
    v_mfma_f32_16x16x32_bf16 v[32:35], v[72:75], v[124:127], v[32:35]
    buffer_load_dwordx4 v[188:191], v16, s[4:7], s32 offen offset:0 sc1
    v_mfma_f32_16x16x32_bf16 v[56:59], v[76:79], v[128:131], v[56:59]
    v_mfma_f32_16x16x32_bf16 v[36:39], v[76:79], v[124:127], v[36:39]
    buffer_load_dwordx4 v[192:195], v17, s[4:7], s32 offen offset:0 sc1
    v_mfma_f32_16x16x32_bf16 v[60:63], v[80:83], v[128:131], v[60:63]
    v_mfma_f32_16x16x32_bf16 v[40:43], v[80:83], v[124:127], v[40:43]
    s_waitcnt vmcnt(14) lgkmcnt(5)
    v_mfma_f32_16x16x32_bf16 v[44:47], v[84:87], v[136:139], v[44:47]
    ds_read_b128 v[64:67], v13 offset:27648
    v_mfma_f32_16x16x32_bf16 v[24:27], v[84:87], v[132:135], v[24:27]
    ds_read_b128 v[68:71], v13 offset:28672
    v_mfma_f32_16x16x32_bf16 v[48:51], v[88:91], v[136:139], v[48:51]
    ds_read_b128 v[72:75], v13 offset:29696
    v_mfma_f32_16x16x32_bf16 v[28:31], v[88:91], v[132:135], v[28:31]
    ds_read_b128 v[76:79], v13 offset:30720
    v_mfma_f32_16x16x32_bf16 v[52:55], v[92:95], v[136:139], v[52:55]
    ds_read_b128 v[80:83], v21 offset:35840
    v_mfma_f32_16x16x32_bf16 v[32:35], v[92:95], v[132:135], v[32:35]
    buffer_load_dwordx4 v[196:199], v16, s[4:7], s32 offen offset:2048 sc1
    v_mfma_f32_16x16x32_bf16 v[56:59], v[96:99], v[136:139], v[56:59]
    v_mfma_f32_16x16x32_bf16 v[36:39], v[96:99], v[132:135], v[36:39]
    buffer_load_dwordx4 v[200:203], v17, s[4:7], s32 offen offset:2048 sc1
    v_mfma_f32_16x16x32_bf16 v[60:63], v[100:103], v[136:139], v[60:63]
    v_mfma_f32_16x16x32_bf16 v[40:43], v[100:103], v[132:135], v[40:43]
    s_waitcnt vmcnt(14) lgkmcnt(0)
    s_barrier
    v_mfma_f32_16x16x32_bf16 v[44:47], v[104:107], v[144:147], v[44:47]
    ds_read_b128 v[84:87], v14 offset:0
    v_mfma_f32_16x16x32_bf16 v[24:27], v[104:107], v[140:143], v[24:27]
    ds_read_b128 v[88:91], v14 offset:1024
    v_mfma_f32_16x16x32_bf16 v[48:51], v[108:111], v[144:147], v[48:51]
    ds_read_b128 v[92:95], v14 offset:2048
    v_mfma_f32_16x16x32_bf16 v[28:31], v[108:111], v[140:143], v[28:31]
    ds_read_b128 v[96:99], v14 offset:3072
    v_mfma_f32_16x16x32_bf16 v[52:55], v[112:115], v[144:147], v[52:55]
    ds_read_b128 v[100:103], v22 offset:8192
    v_mfma_f32_16x16x32_bf16 v[32:35], v[112:115], v[140:143], v[32:35]
    buffer_load_dwordx4 v[204:207], v16, s[4:7], s33 offen offset:0 sc1
    v_mfma_f32_16x16x32_bf16 v[56:59], v[116:119], v[144:147], v[56:59]
    v_mfma_f32_16x16x32_bf16 v[36:39], v[116:119], v[140:143], v[36:39]
    buffer_load_dwordx4 v[208:211], v17, s[4:7], s33 offen offset:0 sc1
    v_mfma_f32_16x16x32_bf16 v[60:63], v[120:123], v[144:147], v[60:63]
    v_mfma_f32_16x16x32_bf16 v[40:43], v[120:123], v[140:143], v[40:43]
    s_waitcnt vmcnt(14) lgkmcnt(5)
    v_mfma_f32_16x16x32_bf16 v[44:47], v[64:67], v[152:155], v[44:47]
    ds_read_b128 v[104:107], v14 offset:9216
    v_mfma_f32_16x16x32_bf16 v[24:27], v[64:67], v[148:151], v[24:27]
    ds_read_b128 v[108:111], v14 offset:10240
    v_mfma_f32_16x16x32_bf16 v[48:51], v[68:71], v[152:155], v[48:51]
    ds_read_b128 v[112:115], v14 offset:11264
    v_mfma_f32_16x16x32_bf16 v[28:31], v[68:71], v[148:151], v[28:31]
    ds_read_b128 v[116:119], v14 offset:12288
    v_mfma_f32_16x16x32_bf16 v[52:55], v[72:75], v[152:155], v[52:55]
    ds_read_b128 v[120:123], v22 offset:17408
    v_mfma_f32_16x16x32_bf16 v[32:35], v[72:75], v[148:151], v[32:35]
    buffer_load_dwordx4 v[212:215], v16, s[4:7], s33 offen offset:2048 sc1
    v_mfma_f32_16x16x32_bf16 v[56:59], v[76:79], v[152:155], v[56:59]
    v_mfma_f32_16x16x32_bf16 v[36:39], v[76:79], v[148:151], v[36:39]
    buffer_load_dwordx4 v[216:219], v17, s[4:7], s33 offen offset:2048 sc1
    v_mfma_f32_16x16x32_bf16 v[60:63], v[80:83], v[152:155], v[60:63]
    v_mfma_f32_16x16x32_bf16 v[40:43], v[80:83], v[148:151], v[40:43]
    s_waitcnt vmcnt(14) lgkmcnt(5)
    v_mfma_f32_16x16x32_bf16 v[44:47], v[84:87], v[160:163], v[44:47]
    ds_read_b128 v[64:67], v14 offset:18432
    s_mov_b32 s32, 6
    s_lshl_b32 s32, s32, 13
    s_add_u32 s32, s32, s29
    s_add_u32 s33, s32, 4096
    v_mfma_f32_16x16x32_bf16 v[24:27], v[84:87], v[156:159], v[24:27]
    ds_read_b128 v[68:71], v14 offset:19456
    v_mfma_f32_16x16x32_bf16 v[48:51], v[88:91], v[160:163], v[48:51]
    ds_read_b128 v[72:75], v14 offset:20480
    v_mfma_f32_16x16x32_bf16 v[28:31], v[88:91], v[156:159], v[28:31]
    ds_read_b128 v[76:79], v14 offset:21504
    v_mfma_f32_16x16x32_bf16 v[52:55], v[92:95], v[160:163], v[52:55]
    ds_read_b128 v[80:83], v22 offset:26624
    v_mfma_f32_16x16x32_bf16 v[32:35], v[92:95], v[156:159], v[32:35]
    buffer_load_dwordx4 v[124:127], v16, s[4:7], s32 offen offset:0 sc1
    v_mfma_f32_16x16x32_bf16 v[56:59], v[96:99], v[160:163], v[56:59]
    v_mfma_f32_16x16x32_bf16 v[36:39], v[96:99], v[156:159], v[36:39]
    buffer_load_dwordx4 v[128:131], v17, s[4:7], s32 offen offset:0 sc1
    v_mfma_f32_16x16x32_bf16 v[60:63], v[100:103], v[160:163], v[60:63]
    v_mfma_f32_16x16x32_bf16 v[40:43], v[100:103], v[156:159], v[40:43]
    s_waitcnt vmcnt(14) lgkmcnt(5)
    v_mfma_f32_16x16x32_bf16 v[44:47], v[104:107], v[168:171], v[44:47]
    ds_read_b128 v[84:87], v14 offset:27648
    v_mfma_f32_16x16x32_bf16 v[24:27], v[104:107], v[164:167], v[24:27]
    ds_read_b128 v[88:91], v14 offset:28672
    v_mfma_f32_16x16x32_bf16 v[48:51], v[108:111], v[168:171], v[48:51]
    ds_read_b128 v[92:95], v14 offset:29696
    v_mfma_f32_16x16x32_bf16 v[28:31], v[108:111], v[164:167], v[28:31]
    ds_read_b128 v[96:99], v14 offset:30720
    v_mfma_f32_16x16x32_bf16 v[52:55], v[112:115], v[168:171], v[52:55]
    ds_read_b128 v[100:103], v22 offset:35840
    v_mfma_f32_16x16x32_bf16 v[32:35], v[112:115], v[164:167], v[32:35]
    buffer_load_dwordx4 v[132:135], v16, s[4:7], s32 offen offset:2048 sc1
    v_mfma_f32_16x16x32_bf16 v[56:59], v[116:119], v[168:171], v[56:59]
    v_mfma_f32_16x16x32_bf16 v[36:39], v[116:119], v[164:167], v[36:39]
    buffer_load_dwordx4 v[136:139], v17, s[4:7], s32 offen offset:2048 sc1
    v_mfma_f32_16x16x32_bf16 v[60:63], v[120:123], v[168:171], v[60:63]
    v_mfma_f32_16x16x32_bf16 v[40:43], v[120:123], v[164:167], v[40:43]
    s_waitcnt vmcnt(14) lgkmcnt(0)
    s_barrier
    v_mfma_f32_16x16x32_bf16 v[44:47], v[64:67], v[176:179], v[44:47]
    ds_read_b128 v[104:107], v15 offset:0
    v_mfma_f32_16x16x32_bf16 v[24:27], v[64:67], v[172:175], v[24:27]
    ds_read_b128 v[108:111], v15 offset:1024
    v_mfma_f32_16x16x32_bf16 v[48:51], v[68:71], v[176:179], v[48:51]
    ds_read_b128 v[112:115], v15 offset:2048
    v_mfma_f32_16x16x32_bf16 v[28:31], v[68:71], v[172:175], v[28:31]
    ds_read_b128 v[116:119], v15 offset:3072
    v_mfma_f32_16x16x32_bf16 v[52:55], v[72:75], v[176:179], v[52:55]
    ds_read_b128 v[120:123], v23 offset:8192
    v_mfma_f32_16x16x32_bf16 v[32:35], v[72:75], v[172:175], v[32:35]
    buffer_load_dwordx4 v[140:143], v16, s[4:7], s33 offen offset:0 sc1
    v_mfma_f32_16x16x32_bf16 v[56:59], v[76:79], v[176:179], v[56:59]
    v_mfma_f32_16x16x32_bf16 v[36:39], v[76:79], v[172:175], v[36:39]
    buffer_load_dwordx4 v[144:147], v17, s[4:7], s33 offen offset:0 sc1
    v_mfma_f32_16x16x32_bf16 v[60:63], v[80:83], v[176:179], v[60:63]
    v_mfma_f32_16x16x32_bf16 v[40:43], v[80:83], v[172:175], v[40:43]
    s_waitcnt vmcnt(14) lgkmcnt(5)
    v_mfma_f32_16x16x32_bf16 v[44:47], v[84:87], v[184:187], v[44:47]
    ds_read_b128 v[64:67], v15 offset:9216
    v_mfma_f32_16x16x32_bf16 v[24:27], v[84:87], v[180:183], v[24:27]
    ds_read_b128 v[68:71], v15 offset:10240
    v_mfma_f32_16x16x32_bf16 v[48:51], v[88:91], v[184:187], v[48:51]
    ds_read_b128 v[72:75], v15 offset:11264
    v_mfma_f32_16x16x32_bf16 v[28:31], v[88:91], v[180:183], v[28:31]
    ds_read_b128 v[76:79], v15 offset:12288
    v_mfma_f32_16x16x32_bf16 v[52:55], v[92:95], v[184:187], v[52:55]
    ds_read_b128 v[80:83], v23 offset:17408
    v_mfma_f32_16x16x32_bf16 v[32:35], v[92:95], v[180:183], v[32:35]
    buffer_load_dwordx4 v[148:151], v16, s[4:7], s33 offen offset:2048 sc1
    v_mfma_f32_16x16x32_bf16 v[56:59], v[96:99], v[184:187], v[56:59]
    v_mfma_f32_16x16x32_bf16 v[36:39], v[96:99], v[180:183], v[36:39]
    buffer_load_dwordx4 v[152:155], v17, s[4:7], s33 offen offset:2048 sc1
    v_mfma_f32_16x16x32_bf16 v[60:63], v[100:103], v[184:187], v[60:63]
    v_mfma_f32_16x16x32_bf16 v[40:43], v[100:103], v[180:183], v[40:43]
    s_waitcnt vmcnt(14) lgkmcnt(5)
    v_mfma_f32_16x16x32_bf16 v[44:47], v[104:107], v[192:195], v[44:47]
    ds_read_b128 v[84:87], v15 offset:18432
    s_mov_b32 s32, 7
    s_lshl_b32 s32, s32, 13
    s_add_u32 s32, s32, s29
    s_add_u32 s33, s32, 4096
    v_mfma_f32_16x16x32_bf16 v[24:27], v[104:107], v[188:191], v[24:27]
    ds_read_b128 v[88:91], v15 offset:19456
    v_mfma_f32_16x16x32_bf16 v[48:51], v[108:111], v[192:195], v[48:51]
    ds_read_b128 v[92:95], v15 offset:20480
    v_mfma_f32_16x16x32_bf16 v[28:31], v[108:111], v[188:191], v[28:31]
    ds_read_b128 v[96:99], v15 offset:21504
    v_mfma_f32_16x16x32_bf16 v[52:55], v[112:115], v[192:195], v[52:55]
    ds_read_b128 v[100:103], v23 offset:26624
    v_mfma_f32_16x16x32_bf16 v[32:35], v[112:115], v[188:191], v[32:35]
    buffer_load_dwordx4 v[156:159], v16, s[4:7], s32 offen offset:0 sc1
    v_mfma_f32_16x16x32_bf16 v[56:59], v[116:119], v[192:195], v[56:59]
    v_mfma_f32_16x16x32_bf16 v[36:39], v[116:119], v[188:191], v[36:39]
    buffer_load_dwordx4 v[160:163], v17, s[4:7], s32 offen offset:0 sc1
    v_mfma_f32_16x16x32_bf16 v[60:63], v[120:123], v[192:195], v[60:63]
    v_mfma_f32_16x16x32_bf16 v[40:43], v[120:123], v[188:191], v[40:43]
    s_waitcnt vmcnt(14) lgkmcnt(5)
    v_mfma_f32_16x16x32_bf16 v[44:47], v[64:67], v[200:203], v[44:47]
    ds_read_b128 v[104:107], v15 offset:27648
    v_mfma_f32_16x16x32_bf16 v[24:27], v[64:67], v[196:199], v[24:27]
    ds_read_b128 v[108:111], v15 offset:28672
    v_mfma_f32_16x16x32_bf16 v[48:51], v[68:71], v[200:203], v[48:51]
    ds_read_b128 v[112:115], v15 offset:29696
    v_mfma_f32_16x16x32_bf16 v[28:31], v[68:71], v[196:199], v[28:31]
    ds_read_b128 v[116:119], v15 offset:30720
    v_mfma_f32_16x16x32_bf16 v[52:55], v[72:75], v[200:203], v[52:55]
    ds_read_b128 v[120:123], v23 offset:35840
    v_mfma_f32_16x16x32_bf16 v[32:35], v[72:75], v[196:199], v[32:35]
    buffer_load_dwordx4 v[164:167], v16, s[4:7], s32 offen offset:2048 sc1
    v_mfma_f32_16x16x32_bf16 v[56:59], v[76:79], v[200:203], v[56:59]
    v_mfma_f32_16x16x32_bf16 v[36:39], v[76:79], v[196:199], v[36:39]
    buffer_load_dwordx4 v[168:171], v17, s[4:7], s32 offen offset:2048 sc1
    v_mfma_f32_16x16x32_bf16 v[60:63], v[80:83], v[200:203], v[60:63]
    v_mfma_f32_16x16x32_bf16 v[40:43], v[80:83], v[196:199], v[40:43]
    s_waitcnt vmcnt(14) lgkmcnt(0)
    s_barrier
    v_mfma_f32_16x16x32_bf16 v[44:47], v[84:87], v[208:211], v[44:47]
    ds_read_b128 v[64:67], v12 offset:0
    v_mfma_f32_16x16x32_bf16 v[24:27], v[84:87], v[204:207], v[24:27]
    ds_read_b128 v[68:71], v12 offset:1024
    v_mfma_f32_16x16x32_bf16 v[48:51], v[88:91], v[208:211], v[48:51]
    ds_read_b128 v[72:75], v12 offset:2048
    v_mfma_f32_16x16x32_bf16 v[28:31], v[88:91], v[204:207], v[28:31]
    ds_read_b128 v[76:79], v12 offset:3072
    v_mfma_f32_16x16x32_bf16 v[52:55], v[92:95], v[208:211], v[52:55]
    ds_read_b128 v[80:83], v20 offset:8192
    v_mfma_f32_16x16x32_bf16 v[32:35], v[92:95], v[204:207], v[32:35]
    buffer_load_dwordx4 v[172:175], v16, s[4:7], s33 offen offset:0 sc1
    v_mfma_f32_16x16x32_bf16 v[56:59], v[96:99], v[208:211], v[56:59]
    v_mfma_f32_16x16x32_bf16 v[36:39], v[96:99], v[204:207], v[36:39]
    buffer_load_dwordx4 v[176:179], v17, s[4:7], s33 offen offset:0 sc1
    v_mfma_f32_16x16x32_bf16 v[60:63], v[100:103], v[208:211], v[60:63]
    v_mfma_f32_16x16x32_bf16 v[40:43], v[100:103], v[204:207], v[40:43]
    s_waitcnt vmcnt(14) lgkmcnt(5)
    v_mfma_f32_16x16x32_bf16 v[44:47], v[104:107], v[216:219], v[44:47]
    ds_read_b128 v[84:87], v12 offset:9216
    v_mfma_f32_16x16x32_bf16 v[24:27], v[104:107], v[212:215], v[24:27]
    ds_read_b128 v[88:91], v12 offset:10240
    v_mfma_f32_16x16x32_bf16 v[48:51], v[108:111], v[216:219], v[48:51]
    ds_read_b128 v[92:95], v12 offset:11264
    v_mfma_f32_16x16x32_bf16 v[28:31], v[108:111], v[212:215], v[28:31]
    ds_read_b128 v[96:99], v12 offset:12288
    v_mfma_f32_16x16x32_bf16 v[52:55], v[112:115], v[216:219], v[52:55]
    ds_read_b128 v[100:103], v20 offset:17408
    v_mfma_f32_16x16x32_bf16 v[32:35], v[112:115], v[212:215], v[32:35]
    buffer_load_dwordx4 v[180:183], v16, s[4:7], s33 offen offset:2048 sc1
    v_mfma_f32_16x16x32_bf16 v[56:59], v[116:119], v[216:219], v[56:59]
    v_mfma_f32_16x16x32_bf16 v[36:39], v[116:119], v[212:215], v[36:39]
    buffer_load_dwordx4 v[184:187], v17, s[4:7], s33 offen offset:2048 sc1
    v_mfma_f32_16x16x32_bf16 v[60:63], v[120:123], v[216:219], v[60:63]
    v_mfma_f32_16x16x32_bf16 v[40:43], v[120:123], v[212:215], v[40:43]
    s_waitcnt vmcnt(14) lgkmcnt(5)
    v_mfma_f32_16x16x32_bf16 v[44:47], v[64:67], v[128:131], v[44:47]
    ds_read_b128 v[104:107], v12 offset:18432
    s_mov_b32 s32, 8
    s_lshl_b32 s32, s32, 13
    s_add_u32 s32, s32, s29
    s_add_u32 s33, s32, 4096
    v_mfma_f32_16x16x32_bf16 v[24:27], v[64:67], v[124:127], v[24:27]
    ds_read_b128 v[108:111], v12 offset:19456
    v_mfma_f32_16x16x32_bf16 v[48:51], v[68:71], v[128:131], v[48:51]
    ds_read_b128 v[112:115], v12 offset:20480
    v_mfma_f32_16x16x32_bf16 v[28:31], v[68:71], v[124:127], v[28:31]
    ds_read_b128 v[116:119], v12 offset:21504
    v_mfma_f32_16x16x32_bf16 v[52:55], v[72:75], v[128:131], v[52:55]
    ds_read_b128 v[120:123], v20 offset:26624
    v_mfma_f32_16x16x32_bf16 v[32:35], v[72:75], v[124:127], v[32:35]
    buffer_load_dwordx2 v[188:189], v18, s[4:7], s32 offen offset:0 sc1
    v_mfma_f32_16x16x32_bf16 v[56:59], v[76:79], v[128:131], v[56:59]
    buffer_load_dwordx2 v[190:191], v18, s[4:7], s32 offen offset:512 sc1
    v_mfma_f32_16x16x32_bf16 v[36:39], v[76:79], v[124:127], v[36:39]
    buffer_load_dwordx2 v[192:193], v19, s[4:7], s32 offen offset:0 sc1
    v_mfma_f32_16x16x32_bf16 v[60:63], v[80:83], v[128:131], v[60:63]
    buffer_load_dwordx2 v[194:195], v19, s[4:7], s32 offen offset:512 sc1
    v_mfma_f32_16x16x32_bf16 v[40:43], v[80:83], v[124:127], v[40:43]
    s_waitcnt vmcnt(16) lgkmcnt(5)
    v_mfma_f32_16x16x32_bf16 v[44:47], v[84:87], v[136:139], v[44:47]
    ds_read_b128 v[64:67], v12 offset:27648
    v_mfma_f32_16x16x32_bf16 v[24:27], v[84:87], v[132:135], v[24:27]
    ds_read_b128 v[68:71], v12 offset:28672
    v_mfma_f32_16x16x32_bf16 v[48:51], v[88:91], v[136:139], v[48:51]
    ds_read_b128 v[72:75], v12 offset:29696
    v_mfma_f32_16x16x32_bf16 v[28:31], v[88:91], v[132:135], v[28:31]
    ds_read_b128 v[76:79], v12 offset:30720
    v_mfma_f32_16x16x32_bf16 v[52:55], v[92:95], v[136:139], v[52:55]
    ds_read_b128 v[80:83], v20 offset:35840
    v_mfma_f32_16x16x32_bf16 v[32:35], v[92:95], v[132:135], v[32:35]
    buffer_load_dwordx2 v[196:197], v18, s[4:7], s32 offen offset:2048 sc1
    v_mfma_f32_16x16x32_bf16 v[56:59], v[96:99], v[136:139], v[56:59]
    buffer_load_dwordx2 v[198:199], v18, s[4:7], s32 offen offset:2560 sc1
    v_mfma_f32_16x16x32_bf16 v[36:39], v[96:99], v[132:135], v[36:39]
    buffer_load_dwordx2 v[200:201], v19, s[4:7], s32 offen offset:2048 sc1
    v_mfma_f32_16x16x32_bf16 v[60:63], v[100:103], v[136:139], v[60:63]
    buffer_load_dwordx2 v[202:203], v19, s[4:7], s32 offen offset:2560 sc1
    v_mfma_f32_16x16x32_bf16 v[40:43], v[100:103], v[132:135], v[40:43]
    s_waitcnt vmcnt(18) lgkmcnt(0)
    s_barrier
    v_mfma_f32_16x16x32_bf16 v[44:47], v[104:107], v[144:147], v[44:47]
    ds_read_b128 v[84:87], v13 offset:0
    v_mfma_f32_16x16x32_bf16 v[24:27], v[104:107], v[140:143], v[24:27]
    ds_read_b128 v[88:91], v13 offset:1024
    v_mfma_f32_16x16x32_bf16 v[48:51], v[108:111], v[144:147], v[48:51]
    ds_read_b128 v[92:95], v13 offset:2048
    v_mfma_f32_16x16x32_bf16 v[28:31], v[108:111], v[140:143], v[28:31]
    ds_read_b128 v[96:99], v13 offset:3072
    v_mfma_f32_16x16x32_bf16 v[52:55], v[112:115], v[144:147], v[52:55]
    ds_read_b128 v[100:103], v21 offset:8192
    v_mfma_f32_16x16x32_bf16 v[32:35], v[112:115], v[140:143], v[32:35]
    buffer_load_dwordx2 v[204:205], v18, s[4:7], s33 offen offset:0 sc1
    v_mfma_f32_16x16x32_bf16 v[56:59], v[116:119], v[144:147], v[56:59]
    buffer_load_dwordx2 v[206:207], v18, s[4:7], s33 offen offset:512 sc1
    v_mfma_f32_16x16x32_bf16 v[36:39], v[116:119], v[140:143], v[36:39]
    buffer_load_dwordx2 v[208:209], v19, s[4:7], s33 offen offset:0 sc1
    v_mfma_f32_16x16x32_bf16 v[60:63], v[120:123], v[144:147], v[60:63]
    buffer_load_dwordx2 v[210:211], v19, s[4:7], s33 offen offset:512 sc1
    v_mfma_f32_16x16x32_bf16 v[40:43], v[120:123], v[140:143], v[40:43]
    s_waitcnt vmcnt(20) lgkmcnt(5)
    v_mfma_f32_16x16x32_bf16 v[44:47], v[64:67], v[152:155], v[44:47]
    ds_read_b128 v[104:107], v13 offset:9216
    v_mfma_f32_16x16x32_bf16 v[24:27], v[64:67], v[148:151], v[24:27]
    ds_read_b128 v[108:111], v13 offset:10240
    v_mfma_f32_16x16x32_bf16 v[48:51], v[68:71], v[152:155], v[48:51]
    ds_read_b128 v[112:115], v13 offset:11264
    v_mfma_f32_16x16x32_bf16 v[28:31], v[68:71], v[148:151], v[28:31]
    ds_read_b128 v[116:119], v13 offset:12288
    v_mfma_f32_16x16x32_bf16 v[52:55], v[72:75], v[152:155], v[52:55]
    ds_read_b128 v[120:123], v21 offset:17408
    v_mfma_f32_16x16x32_bf16 v[32:35], v[72:75], v[148:151], v[32:35]
    buffer_load_dwordx2 v[212:213], v18, s[4:7], s33 offen offset:2048 sc1
    v_mfma_f32_16x16x32_bf16 v[56:59], v[76:79], v[152:155], v[56:59]
    buffer_load_dwordx2 v[214:215], v18, s[4:7], s33 offen offset:2560 sc1
    v_mfma_f32_16x16x32_bf16 v[36:39], v[76:79], v[148:151], v[36:39]
    buffer_load_dwordx2 v[216:217], v19, s[4:7], s33 offen offset:2048 sc1
    v_mfma_f32_16x16x32_bf16 v[60:63], v[80:83], v[152:155], v[60:63]
    buffer_load_dwordx2 v[218:219], v19, s[4:7], s33 offen offset:2560 sc1
    v_mfma_f32_16x16x32_bf16 v[40:43], v[80:83], v[148:151], v[40:43]
    s_waitcnt vmcnt(22) lgkmcnt(5)
    v_mfma_f32_16x16x32_bf16 v[44:47], v[84:87], v[160:163], v[44:47]
    ds_read_b128 v[64:67], v13 offset:18432
    v_mfma_f32_16x16x32_bf16 v[24:27], v[84:87], v[156:159], v[24:27]
    ds_read_b128 v[68:71], v13 offset:19456
    v_mfma_f32_16x16x32_bf16 v[48:51], v[88:91], v[160:163], v[48:51]
    ds_read_b128 v[72:75], v13 offset:20480
    v_mfma_f32_16x16x32_bf16 v[28:31], v[88:91], v[156:159], v[28:31]
    ds_read_b128 v[76:79], v13 offset:21504
    v_mfma_f32_16x16x32_bf16 v[52:55], v[92:95], v[160:163], v[52:55]
    ds_read_b128 v[80:83], v21 offset:26624
    v_mfma_f32_16x16x32_bf16 v[32:35], v[92:95], v[156:159], v[32:35]
    v_mfma_f32_16x16x32_bf16 v[56:59], v[96:99], v[160:163], v[56:59]
    v_mfma_f32_16x16x32_bf16 v[36:39], v[96:99], v[156:159], v[36:39]
    v_mfma_f32_16x16x32_bf16 v[60:63], v[100:103], v[160:163], v[60:63]
    v_mfma_f32_16x16x32_bf16 v[40:43], v[100:103], v[156:159], v[40:43]
    s_waitcnt vmcnt(20) lgkmcnt(5)
    v_mfma_f32_16x16x32_bf16 v[44:47], v[104:107], v[168:171], v[44:47]
    ds_read_b128 v[84:87], v13 offset:27648
    v_mfma_f32_16x16x32_bf16 v[24:27], v[104:107], v[164:167], v[24:27]
    ds_read_b128 v[88:91], v13 offset:28672
    v_mfma_f32_16x16x32_bf16 v[48:51], v[108:111], v[168:171], v[48:51]
    ds_read_b128 v[92:95], v13 offset:29696
    v_mfma_f32_16x16x32_bf16 v[28:31], v[108:111], v[164:167], v[28:31]
    ds_read_b128 v[96:99], v13 offset:30720
    v_mfma_f32_16x16x32_bf16 v[52:55], v[112:115], v[168:171], v[52:55]
    ds_read_b128 v[100:103], v21 offset:35840
    v_mfma_f32_16x16x32_bf16 v[32:35], v[112:115], v[164:167], v[32:35]
    v_mfma_f32_16x16x32_bf16 v[56:59], v[116:119], v[168:171], v[56:59]
    v_mfma_f32_16x16x32_bf16 v[36:39], v[116:119], v[164:167], v[36:39]
    v_mfma_f32_16x16x32_bf16 v[60:63], v[120:123], v[168:171], v[60:63]
    v_mfma_f32_16x16x32_bf16 v[40:43], v[120:123], v[164:167], v[40:43]
    s_waitcnt vmcnt(18) lgkmcnt(0)
    s_barrier
    v_mfma_f32_16x16x32_bf16 v[44:47], v[64:67], v[176:179], v[44:47]
    ds_read_b128 v[104:107], v14 offset:0
    v_mfma_f32_16x16x32_bf16 v[24:27], v[64:67], v[172:175], v[24:27]
    ds_read_b128 v[108:111], v14 offset:1024
    v_mfma_f32_16x16x32_bf16 v[48:51], v[68:71], v[176:179], v[48:51]
    ds_read_b128 v[112:115], v14 offset:2048
    v_mfma_f32_16x16x32_bf16 v[28:31], v[68:71], v[172:175], v[28:31]
    ds_read_b128 v[116:119], v14 offset:3072
    v_mfma_f32_16x16x32_bf16 v[52:55], v[72:75], v[176:179], v[52:55]
    ds_read_b128 v[120:123], v22 offset:8192
    v_mfma_f32_16x16x32_bf16 v[32:35], v[72:75], v[172:175], v[32:35]
    v_mfma_f32_16x16x32_bf16 v[56:59], v[76:79], v[176:179], v[56:59]
    v_mfma_f32_16x16x32_bf16 v[36:39], v[76:79], v[172:175], v[36:39]
    v_mfma_f32_16x16x32_bf16 v[60:63], v[80:83], v[176:179], v[60:63]
    v_mfma_f32_16x16x32_bf16 v[40:43], v[80:83], v[172:175], v[40:43]
    s_waitcnt vmcnt(16) lgkmcnt(5)
    v_mfma_f32_16x16x32_bf16 v[44:47], v[84:87], v[184:187], v[44:47]
    ds_read_b128 v[64:67], v14 offset:9216
    v_mfma_f32_16x16x32_bf16 v[24:27], v[84:87], v[180:183], v[24:27]
    ds_read_b128 v[68:71], v14 offset:10240
    v_mfma_f32_16x16x32_bf16 v[48:51], v[88:91], v[184:187], v[48:51]
    ds_read_b128 v[72:75], v14 offset:11264
    v_mfma_f32_16x16x32_bf16 v[28:31], v[88:91], v[180:183], v[28:31]
    ds_read_b128 v[76:79], v14 offset:12288
    v_mfma_f32_16x16x32_bf16 v[52:55], v[92:95], v[184:187], v[52:55]
    ds_read_b128 v[80:83], v22 offset:17408
    v_mfma_f32_16x16x32_bf16 v[32:35], v[92:95], v[180:183], v[32:35]
    v_mfma_f32_16x16x32_bf16 v[56:59], v[96:99], v[184:187], v[56:59]
    v_mfma_f32_16x16x32_bf16 v[36:39], v[96:99], v[180:183], v[36:39]
    v_mfma_f32_16x16x32_bf16 v[60:63], v[100:103], v[184:187], v[60:63]
    v_mfma_f32_16x16x32_bf16 v[40:43], v[100:103], v[180:183], v[40:43]
    s_waitcnt vmcnt(12) lgkmcnt(5)
    v_mfma_f32_16x16x32_bf16 v[44:47], v[104:107], v[192:195], v[44:47]
    ds_read_b128 v[84:87], v14 offset:18432
    v_mfma_f32_16x16x32_bf16 v[24:27], v[104:107], v[188:191], v[24:27]
    ds_read_b128 v[88:91], v14 offset:19456
    v_mfma_f32_16x16x32_bf16 v[48:51], v[108:111], v[192:195], v[48:51]
    ds_read_b128 v[92:95], v14 offset:20480
    v_mfma_f32_16x16x32_bf16 v[28:31], v[108:111], v[188:191], v[28:31]
    ds_read_b128 v[96:99], v14 offset:21504
    v_mfma_f32_16x16x32_bf16 v[52:55], v[112:115], v[192:195], v[52:55]
    ds_read_b128 v[100:103], v22 offset:26624
    v_mfma_f32_16x16x32_bf16 v[32:35], v[112:115], v[188:191], v[32:35]
    v_mfma_f32_16x16x32_bf16 v[56:59], v[116:119], v[192:195], v[56:59]
    v_mfma_f32_16x16x32_bf16 v[36:39], v[116:119], v[188:191], v[36:39]
    v_mfma_f32_16x16x32_bf16 v[60:63], v[120:123], v[192:195], v[60:63]
    v_mfma_f32_16x16x32_bf16 v[40:43], v[120:123], v[188:191], v[40:43]
    s_waitcnt vmcnt(8) lgkmcnt(5)
    v_mfma_f32_16x16x32_bf16 v[44:47], v[64:67], v[200:203], v[44:47]
    ds_read_b128 v[104:107], v14 offset:27648
    v_mfma_f32_16x16x32_bf16 v[24:27], v[64:67], v[196:199], v[24:27]
    ds_read_b128 v[108:111], v14 offset:28672
    v_mfma_f32_16x16x32_bf16 v[48:51], v[68:71], v[200:203], v[48:51]
    ds_read_b128 v[112:115], v14 offset:29696
    v_mfma_f32_16x16x32_bf16 v[28:31], v[68:71], v[196:199], v[28:31]
    ds_read_b128 v[116:119], v14 offset:30720
    v_mfma_f32_16x16x32_bf16 v[52:55], v[72:75], v[200:203], v[52:55]
    ds_read_b128 v[120:123], v22 offset:35840
    v_mfma_f32_16x16x32_bf16 v[32:35], v[72:75], v[196:199], v[32:35]
    v_mfma_f32_16x16x32_bf16 v[56:59], v[76:79], v[200:203], v[56:59]
    v_mfma_f32_16x16x32_bf16 v[36:39], v[76:79], v[196:199], v[36:39]
    v_mfma_f32_16x16x32_bf16 v[60:63], v[80:83], v[200:203], v[60:63]
    v_mfma_f32_16x16x32_bf16 v[40:43], v[80:83], v[196:199], v[40:43]
    s_waitcnt vmcnt(4) lgkmcnt(5)
    v_mfma_f32_16x16x32_bf16 v[44:47], v[84:87], v[208:211], v[44:47]
    v_mfma_f32_16x16x32_bf16 v[24:27], v[84:87], v[204:207], v[24:27]
    v_mfma_f32_16x16x32_bf16 v[48:51], v[88:91], v[208:211], v[48:51]
    v_mfma_f32_16x16x32_bf16 v[28:31], v[88:91], v[204:207], v[28:31]
    v_mfma_f32_16x16x32_bf16 v[52:55], v[92:95], v[208:211], v[52:55]
    v_mfma_f32_16x16x32_bf16 v[32:35], v[92:95], v[204:207], v[32:35]
    v_mfma_f32_16x16x32_bf16 v[56:59], v[96:99], v[208:211], v[56:59]
    v_mfma_f32_16x16x32_bf16 v[36:39], v[96:99], v[204:207], v[36:39]
    v_mfma_f32_16x16x32_bf16 v[60:63], v[100:103], v[208:211], v[60:63]
    v_mfma_f32_16x16x32_bf16 v[40:43], v[100:103], v[204:207], v[40:43]
    s_waitcnt vmcnt(0) lgkmcnt(0)
    v_mfma_f32_16x16x32_bf16 v[44:47], v[104:107], v[216:219], v[44:47]
    v_mfma_f32_16x16x32_bf16 v[48:51], v[108:111], v[216:219], v[48:51]
    v_mfma_f32_16x16x32_bf16 v[52:55], v[112:115], v[216:219], v[52:55]
    v_mfma_f32_16x16x32_bf16 v[56:59], v[116:119], v[216:219], v[56:59]
    v_mfma_f32_16x16x32_bf16 v[60:63], v[120:123], v[216:219], v[60:63]
    v_mfma_f32_16x16x32_bf16 v[24:27], v[104:107], v[212:215], v[24:27]
    v_mfma_f32_16x16x32_bf16 v[28:31], v[108:111], v[212:215], v[28:31]
    v_mfma_f32_16x16x32_bf16 v[32:35], v[112:115], v[212:215], v[32:35]
    v_mfma_f32_16x16x32_bf16 v[36:39], v[116:119], v[212:215], v[36:39]
    v_mfma_f32_16x16x32_bf16 v[40:43], v[120:123], v[212:215], v[40:43]
    ds_write_b128 v2, v[44:47] offset:0
    ds_write_b128 v2, v[48:51] offset:1024
    ds_write_b128 v2, v[52:55] offset:2048
    ds_write_b128 v2, v[56:59] offset:3072
    s_mov_b64 exec, s[40:41]
    ds_write_b128 v3, v[60:63] offset:4096
    s_mov_b64 exec, -1
    ds_write_b32 v0, v9
    s_mov_b32 s60, 1048576
L_px_p5:
    ds_read_b32 v232, v6
    ds_read_b128 v[64:67], v7 offset:0
    ds_read_b128 v[68:71], v7 offset:1024
    ds_read_b128 v[72:75], v7 offset:2048
    ds_read_b128 v[76:79], v7 offset:3072
    ds_read_b128 v[80:83], v8 offset:4096
    s_waitcnt lgkmcnt(5)
    v_cmp_ne_u32 vcc, s43, v232
    s_sub_u32 s60, s60, 1
    s_cbranch_scc1 L_py_p5
    s_cbranch_vccnz L_px_p5
L_py_p5:
    s_waitcnt lgkmcnt(4)
    v_pk_add_f32 v[24:25], v[24:25], v[64:65]
    v_pk_add_f32 v[26:27], v[26:27], v[66:67]
    v_cvt_pk_bf16_f32 v220, v24, v25
    v_cvt_pk_bf16_f32 v221, v26, v27
    s_waitcnt lgkmcnt(3)
    v_pk_add_f32 v[28:29], v[28:29], v[68:69]
    v_pk_add_f32 v[30:31], v[30:31], v[70:71]
    v_cvt_pk_bf16_f32 v222, v28, v29
    v_cvt_pk_bf16_f32 v223, v30, v31
    s_waitcnt lgkmcnt(2)
    v_pk_add_f32 v[32:33], v[32:33], v[72:73]
    v_pk_add_f32 v[34:35], v[34:35], v[74:75]
    v_cvt_pk_bf16_f32 v224, v32, v33
    v_cvt_pk_bf16_f32 v225, v34, v35
    s_waitcnt lgkmcnt(1)
    v_pk_add_f32 v[36:37], v[36:37], v[76:77]
    v_pk_add_f32 v[38:39], v[38:39], v[78:79]
    v_cvt_pk_bf16_f32 v226, v36, v37
    v_cvt_pk_bf16_f32 v227, v38, v39
    s_waitcnt lgkmcnt(0)
    v_pk_add_f32 v[40:41], v[40:41], v[80:81]
    v_pk_add_f32 v[42:43], v[42:43], v[82:83]
    v_cvt_pk_bf16_f32 v228, v40, v41
    v_cvt_pk_bf16_f32 v229, v42, v43
    s_cmp_eq_u32 s22, 1
    s_cbranch_scc1 L_fin_p5
    buffer_store_dwordx4 v[220:223], v4, s[4:7], s34 offen offset:0 sc1
    buffer_store_dwordx4 v[224:227], v4, s[4:7], s34 offen offset:1024 sc1
    buffer_store_dwordx2 v[228:229], v5, s[4:7], s34 offen sc1
    v_cndmask_b32 v234, 0, v228, s[40:41]
    v_cndmask_b32 v235, 0, v229, s[40:41]
    v_dot2_f32_bf16 v232, v220, v11, 0
    v_dot2_f32_bf16 v233, v220, v220, 0
    v_dot2_f32_bf16 v232, v221, v11, v232
    v_dot2_f32_bf16 v233, v221, v221, v233
    v_dot2_f32_bf16 v232, v222, v11, v232
    v_dot2_f32_bf16 v233, v222, v222, v233
    v_dot2_f32_bf16 v232, v223, v11, v232
    v_dot2_f32_bf16 v233, v223, v223, v233
    v_dot2_f32_bf16 v232, v224, v11, v232
    v_dot2_f32_bf16 v233, v224, v224, v233
    v_dot2_f32_bf16 v232, v225, v11, v232
    v_dot2_f32_bf16 v233, v225, v225, v233
    v_dot2_f32_bf16 v232, v226, v11, v232
    v_dot2_f32_bf16 v233, v226, v226, v233
    v_dot2_f32_bf16 v232, v227, v11, v232
    v_dot2_f32_bf16 v233, v227, v227, v233
    v_dot2_f32_bf16 v232, v234, v11, v232
    v_dot2_f32_bf16 v233, v234, v234, v233
    v_dot2_f32_bf16 v232, v235, v11, v232
    v_dot2_f32_bf16 v233, v235, v235, v233
    s_nop 2
    v_mov_b32 v234, v232
    v_mov_b32 v235, v233
    s_nop 1
    v_permlane32_swap_b32 v232, v234
    v_permlane32_swap_b32 v233, v235
    v_add_f32 v232, v232, v234
    v_add_f32 v233, v233, v235
    v_mov_b32 v234, v232
    v_mov_b32 v235, v233
    s_nop 1
    v_permlane16_swap_b32 v232, v234
    v_permlane16_swap_b32 v233, v235
    v_add_f32 v232, v232, v234
    v_add_f32 v233, v233, v235
    buffer_store_dwordx2 v[232:233], v10, s[4:7], s39 offen sc1
    s_barrier
    s_mov_b32 s22, 1
    s_mov_b32 s21, 0x1c00000
    s_branch L_m_cl
L_fin_p5:
    buffer_store_dwordx4 v[220:223], v4, s[16:19], s34 offen offset:0
    buffer_store_dwordx4 v[224:227], v4, s[16:19], s34 offen offset:64
    buffer_store_dwordx2 v[228:229], v5, s[16:19], s34 offen offset:128
    s_endpgm
L_m_l1:
    s_and_b32 s25, s2, 7
    s_lshr_b32 s26, s2, 3
    s_lshr_b32 s23, s25, 1
    s_lshl_b32 s23, s23, 2
    s_lshr_b32 s27, s26, 3
    s_add_u32 s23, s23, s27
    s_and_b32 s24, s25, 1
    s_lshl_b32 s24, s24, 3
    s_and_b32 s27, s26, 7
    s_add_u32 s24, s24, s27
    s_mul_i32 s29, s24, 129024
    s_lshl_b32 s30, s20, 12
    s_add_u32 s29, s29, s30
    s_add_u32 s29, s29, 0x3800000
    s_lshl_b32 s31, s23, 3
    s_max_u32 s31, s31, 1
    s_sub_u32 s31, s31, 1
    s_mul_i32 s31, s31, 18432
    s_add_u32 s31, s31, 0x0
    s_lshl_b32 s35, s20, 10
    s_and_b32 s36, s35, 1024
    s_barrier
    s_add_u32 m0, s35, 131072
    s_add_u32 s34, s31, s35
    s_add_u32 s34, s34, 0
    buffer_load_dwordx4 v1, s[4:7], s34 offen sc1 lds
    s_add_u32 m0, s30, 0
    s_add_u32 s34, s29, 0
    buffer_load_dwordx4 v1, s[4:7], s34 offen offset:0 sc1 lds
    buffer_load_dwordx4 v1, s[4:7], s34 offen offset:1024 sc1 lds
    buffer_load_dwordx4 v1, s[4:7], s34 offen offset:2048 sc1 lds
    buffer_load_dwordx4 v1, s[4:7], s34 offen offset:3072 sc1 lds
    s_add_u32 m0, s30, 16384
    s_add_u32 s34, s29, 16384
    buffer_load_dwordx4 v1, s[4:7], s34 offen offset:0 sc1 lds
    buffer_load_dwordx4 v1, s[4:7], s34 offen offset:1024 sc1 lds
    buffer_load_dwordx4 v1, s[4:7], s34 offen offset:2048 sc1 lds
    buffer_load_dwordx4 v1, s[4:7], s34 offen offset:3072 sc1 lds
    s_waitcnt vmcnt(4) lgkmcnt(0)
    s_barrier
    s_add_u32 m0, s35, 135168
    s_add_u32 s34, s31, s35
    s_add_u32 s34, s34, 4096
    buffer_load_dwordx4 v1, s[4:7], s34 offen sc1 lds
    s_add_u32 m0, s30, 32768
    s_add_u32 s34, s29, 32768
    buffer_load_dwordx4 v1, s[4:7], s34 offen offset:0 sc1 lds
    buffer_load_dwordx4 v1, s[4:7], s34 offen offset:1024 sc1 lds
    buffer_load_dwordx4 v1, s[4:7], s34 offen offset:2048 sc1 lds
    buffer_load_dwordx4 v1, s[4:7], s34 offen offset:3072 sc1 lds
    s_add_u32 m0, s30, 49152
    s_add_u32 s34, s29, 49152
    buffer_load_dwordx4 v1, s[4:7], s34 offen offset:0 sc1 lds
    buffer_load_dwordx4 v1, s[4:7], s34 offen offset:1024 sc1 lds
    buffer_load_dwordx4 v1, s[4:7], s34 offen offset:2048 sc1 lds
    buffer_load_dwordx4 v1, s[4:7], s34 offen offset:3072 sc1 lds
    s_cmp_lt_u32 s2, 144
    s_cbranch_scc1 L_p0_t1
    s_cmp_ge_u32 s2, 216
    s_cbranch_scc1 L_p0_t2
    ds_read_b64_tr_b16 v[16:17], v4 offset:0
    ds_read_b64_tr_b16 v[18:19], v4 offset:2048
    ds_read_b64_tr_b16 v[20:21], v4 offset:18432
    ds_read_b64_tr_b16 v[22:23], v4 offset:20480
    ds_read_b64_tr_b16 v[24:25], v4 offset:4096
    ds_read_b64_tr_b16 v[26:27], v4 offset:6144
    ds_read_b64_tr_b16 v[28:29], v4 offset:22528
    ds_read_b64_tr_b16 v[30:31], v4 offset:24576
    ds_read_b64_tr_b16 v[32:33], v4 offset:8192
    ds_read_b64_tr_b16 v[34:35], v4 offset:10240
    ds_read_b64_tr_b16 v[36:37], v4 offset:26624
    ds_read_b64_tr_b16 v[38:39], v4 offset:28672
    ds_read_b64_tr_b16 v[40:41], v4 offset:12288
    ds_read_b64_tr_b16 v[42:43], v4 offset:14336
    ds_read_b64_tr_b16 v[44:45], v4 offset:30720
    ds_read_b64_tr_b16 v[46:47], v4 offset:32768
    ds_read_b64_tr_b16 v[48:49], v5 offset:16384
    ds_read_b64_tr_b16 v[50:51], v5 offset:34816
    s_branch L_p0_t2
L_p0_t1:
    ds_read_b64_tr_b16 v[16:17], v4 offset:0
    ds_read_b64_tr_b16 v[18:19], v4 offset:512
    ds_read_b64_tr_b16 v[20:21], v4 offset:4352
    ds_read_b64_tr_b16 v[22:23], v4 offset:4864
    ds_read_b64_tr_b16 v[24:25], v4 offset:9792
    ds_read_b64_tr_b16 v[26:27], v4 offset:10304
    ds_read_b64_tr_b16 v[28:29], v4 offset:14144
    ds_read_b64_tr_b16 v[30:31], v4 offset:14656
    ds_read_b64_tr_b16 v[32:33], v4 offset:19584
    ds_read_b64_tr_b16 v[34:35], v4 offset:20096
    ds_read_b64_tr_b16 v[36:37], v4 offset:23936
    ds_read_b64_tr_b16 v[38:39], v4 offset:24448
    ds_read_b64_tr_b16 v[40:41], v4 offset:29376
    ds_read_b64_tr_b16 v[42:43], v4 offset:29888
    ds_read_b64_tr_b16 v[44:45], v4 offset:33728
    ds_read_b64_tr_b16 v[46:47], v4 offset:34240
    ds_read_b64_tr_b16 v[48:49], v5 offset:8704
    ds_read_b64_tr_b16 v[50:51], v5 offset:9216
L_p0_t2:
    s_waitcnt lgkmcnt(0)
    s_waitcnt vmcnt(9) lgkmcnt(0)
    s_barrier
    s_add_u32 m0, s35, 139264
    s_add_u32 s34, s31, s35
    s_add_u32 s34, s34, 8192
    buffer_load_dwordx4 v1, s[4:7], s34 offen sc1 lds
    v_lshrrev_b32 v2, 8, v1
    v_bfe_u32 v3, v1, 7, 1
    v_bfe_u32 v4, v1, 4, 3
    v_cmp_gt_u32 vcc, 3, v2
    v_mul_u32_u24 v3, 80, v3
    v_lshl_add_u32 v3, v4, 3, v3
    v_lshrrev_b32 v5, 1, v4
    v_and_b32 v4, 1, v4
    v_lshl_add_u32 v4, v4, 3, 64
    v_cndmask_b32 v2, v5, v2, vcc
    v_cndmask_b32 v3, v4, v3, vcc
    v_mul_u32_u24 v2, 2304, v2
    v_add_u32 v0, v2, v3
    v_lshrrev_b32 v8, 1, v1
    s_mul_i32 s34, s24, 144
    s_add_u32 s34, s34, 0x4400000
    buffer_load_dwordx2 v[2:3], v0, s[4:7], s34 offen sc1
    s_mul_i32 s34, s24, 144
    s_add_u32 s34, s34, 0x4402000
    buffer_load_dwordx2 v[4:5], v0, s[4:7], s34 offen sc1
    s_mul_i32 s34, s24, 144
    s_add_u32 s34, s34, 0x4404000
    buffer_load_dwordx2 v[6:7], v0, s[4:7], s34 offen sc1
    s_mul_i32 s34, s24, 144
    s_add_u32 s34, s34, 0x4406000
    buffer_load_dwordx2 v[12:13], v0, s[4:7], s34 offen sc1
    s_add_u32 m0, s30, 65536
    s_add_u32 s34, s29, 65536
    buffer_load_dwordx4 v1, s[4:7], s34 offen offset:0 sc1 lds
    buffer_load_dwordx4 v1, s[4:7], s34 offen offset:1024 sc1 lds
    buffer_load_dwordx4 v1, s[4:7], s34 offen offset:2048 sc1 lds
    buffer_load_dwordx4 v1, s[4:7], s34 offen offset:3072 sc1 lds
    s_waitcnt vmcnt(13) lgkmcnt(0)
    s_barrier
    s_add_u32 m0, s30, 81920
    s_add_u32 s34, s29, 81920
    buffer_load_dwordx4 v1, s[4:7], s34 offen offset:0 sc1 lds
    buffer_load_dwordx4 v1, s[4:7], s34 offen offset:1024 sc1 lds
    buffer_load_dwordx4 v1, s[4:7], s34 offen offset:2048 sc1 lds
    buffer_load_dwordx4 v1, s[4:7], s34 offen offset:3072 sc1 lds
    s_waitcnt vmcnt(13) lgkmcnt(0)
    s_barrier
    s_add_u32 m0, s35, 143360
    s_add_u32 s34, s31, s35
    s_add_u32 s34, s34, 12288
    buffer_load_dwordx4 v1, s[4:7], s34 offen sc1 lds
    s_add_u32 m0, s30, 98304
    s_add_u32 s34, s29, 98304
    buffer_load_dwordx4 v1, s[4:7], s34 offen offset:0 sc1 lds
    buffer_load_dwordx4 v1, s[4:7], s34 offen offset:1024 sc1 lds
    buffer_load_dwordx4 v1, s[4:7], s34 offen offset:2048 sc1 lds
    buffer_load_dwordx4 v1, s[4:7], s34 offen offset:3072 sc1 lds
    s_waitcnt vmcnt(13)
    v_add_f32 v2, v2, v4
    v_add_f32 v3, v3, v5
    v_add_f32 v6, v6, v12
    v_add_f32 v7, v7, v13
    v_add_f32 v2, v2, v6
    v_add_f32 v3, v3, v7
    v_cmp_gt_u32 vcc, 864, v1
    v_add_u32 v8, 161792, v8
    s_nop 0
    v_cndmask_b32 v2, 0, v2, vcc
    v_cndmask_b32 v3, 0, v3, vcc
    ds_write_b64 v8, v[2:3]
    s_waitcnt vmcnt(9) lgkmcnt(0)
    s_barrier
    s_add_u32 m0, s36, 147456
    s_add_u32 s34, s31, s36
    s_add_u32 s34, s34, 16384
    buffer_load_dwordx4 v1, s[4:7], s34 offen sc1 lds
    s_add_u32 m0, s30, 114688
    s_add_u32 s34, s29, 114688
    buffer_load_dwordx4 v1, s[4:7], s34 offen offset:0 sc1 lds
    buffer_load_dwordx4 v1, s[4:7], s34 offen offset:1024 sc1 lds
    buffer_load_dwordx4 v1, s[4:7], s34 offen offset:2048 sc1 lds
    buffer_load_dwordx4 v1, s[4:7], s34 offen offset:3072 sc1 lds
    s_waitcnt vmcnt(10) lgkmcnt(0)
    s_barrier
    buffer_store_dwordx4 v[16:19], v9, s[4:7], s37 offen sc1
    buffer_store_dwordx4 v[20:23], v10, s[4:7], s38 offen sc1
    buffer_store_dwordx4 v[24:27], v9, s[4:7], s39 offen sc1
    buffer_store_dwordx4 v[28:31], v10, s[4:7], s40 offen sc1
    s_waitcnt vmcnt(9) lgkmcnt(0)
    s_barrier
    buffer_store_dwordx4 v[32:35], v9, s[4:7], s41 offen sc1
    buffer_store_dwordx4 v[36:39], v10, s[4:7], s42 offen sc1
    buffer_store_dwordx4 v[40:43], v9, s[4:7], s43 offen sc1
    s_waitcnt vmcnt(7) lgkmcnt(0)
    s_barrier
    s_mov_b32 s46, 0x4502000
    v_mov_b32 v4, 0
    s_mov_b32 s60, 65536
L_poll_wo:
    buffer_load_dword v5, v4, s[4:7], s46 offen sc1
    s_waitcnt vmcnt(0)
    v_cmp_gt_u32 vcc, 18, v5
    s_sub_u32 s60, s60, 1
    s_cbranch_scc1 L_pd_wo
    s_cbranch_vccz L_pd_wo
    s_sleep 4
    s_branch L_poll_wo
L_pd_wo:
    buffer_store_dwordx4 v[44:47], v10, s[4:7], s47 offen sc1
    buffer_store_dwordx4 v[48:51], v14, s[4:7], s48 offen sc1
    v_dot2_f32_bf16 v12, v16, v11, 0
    v_dot2_f32_bf16 v13, v17, v11, 0
    v_dot2_f32_bf16 v12, v18, v11, v12
    v_dot2_f32_bf16 v13, v19, v11, v13
    v_dot2_f32_bf16 v12, v20, v11, v12
    v_dot2_f32_bf16 v13, v21, v11, v13
    v_dot2_f32_bf16 v12, v22, v11, v12
    v_dot2_f32_bf16 v13, v23, v11, v13
    v_dot2_f32_bf16 v12, v24, v11, v12
    v_dot2_f32_bf16 v13, v25, v11, v13
    v_dot2_f32_bf16 v12, v26, v11, v12
    v_dot2_f32_bf16 v13, v27, v11, v13
    v_dot2_f32_bf16 v12, v28, v11, v12
    v_dot2_f32_bf16 v13, v29, v11, v13
    v_dot2_f32_bf16 v12, v30, v11, v12
    v_dot2_f32_bf16 v13, v31, v11, v13
    v_dot2_f32_bf16 v12, v32, v11, v12
    v_dot2_f32_bf16 v13, v33, v11, v13
    v_dot2_f32_bf16 v12, v34, v11, v12
    v_dot2_f32_bf16 v13, v35, v11, v13
    v_dot2_f32_bf16 v12, v36, v11, v12
    v_dot2_f32_bf16 v13, v37, v11, v13
    v_dot2_f32_bf16 v12, v38, v11, v12
    v_dot2_f32_bf16 v13, v39, v11, v13
    v_dot2_f32_bf16 v12, v40, v11, v12
    v_dot2_f32_bf16 v13, v41, v11, v13
    v_dot2_f32_bf16 v12, v42, v11, v12
    v_dot2_f32_bf16 v13, v43, v11, v13
    v_dot2_f32_bf16 v12, v44, v11, v12
    v_dot2_f32_bf16 v13, v45, v11, v13
    v_dot2_f32_bf16 v12, v46, v11, v12
    v_dot2_f32_bf16 v13, v47, v11, v13
    v_dot2_f32_bf16 v12, v48, v11, v12
    v_dot2_f32_bf16 v13, v49, v11, v13
    v_dot2_f32_bf16 v12, v50, v11, v12
    v_dot2_f32_bf16 v13, v51, v11, v13
    s_nop 2
    v_add_f32 v12, v12, v13
    v_mov_b32 v13, v12
    s_nop 1
    v_permlane32_swap_b32 v12, v13
    v_add_f32 v12, v12, v13
    v_mov_b32 v13, v12
    s_nop 1
    v_permlane16_swap_b32 v12, v13
    v_add_f32 v12, v12, v13
    buffer_store_dword v12, v15, s[4:7], s49 offen sc1
    s_barrier
L_m_ll:
    s_and_b32 s25, s2, 7
    s_lshr_b32 s26, s2, 3
    s_lshr_b32 s23, s25, 1
    s_lshl_b32 s23, s23, 3
    s_lshr_b32 s27, s26, 2
    s_add_u32 s23, s23, s27
    s_and_b32 s24, s25, 1
    s_lshl_b32 s24, s24, 2
    s_and_b32 s27, s26, 3
    s_add_u32 s24, s24, s27
    s_add_u32 s25, s23, s24
    s_and_b32 s25, s25, 3
    s_mul_i32 s29, s24, 82944
    s_add_u32 s29, s29, 0x3a00000
    s_mul_i32 s30, s20, 36864
    s_mul_i32 s31, s20, 18432
    s_add_u32 s31, s31, s29
    s_add_u32 m0, s30, 18432
    s_add_u32 s33, s31, 0
    buffer_load_dwordx4 v1, s[4:7], s33 offen offset:0  sc1 lds
    buffer_load_dwordx4 v1, s[4:7], s33 offen offset:1024  sc1 lds
    buffer_load_dwordx4 v1, s[4:7], s33 offen offset:2048  sc1 lds
    buffer_load_dwordx4 v1, s[4:7], s33 offen offset:3072  sc1 lds
    s_add_u32 m0, s30, 22528
    s_add_u32 s33, s31, 4096
    buffer_load_dwordx4 v1, s[4:7], s33 offen offset:0  sc1 lds
    buffer_load_dwordx4 v1, s[4:7], s33 offen offset:1024  sc1 lds
    buffer_load_dwordx4 v1, s[4:7], s33 offen offset:2048  sc1 lds
    buffer_load_dwordx4 v1, s[4:7], s33 offen offset:3072  sc1 lds
    s_add_u32 m0, s30, 26624
    s_add_u32 s33, s31, 8192
    buffer_load_dwordx4 v1, s[4:7], s33 offen offset:0  sc1 lds
    buffer_load_dwordx4 v1, s[4:7], s33 offen offset:1024  sc1 lds
    buffer_load_dwordx4 v1, s[4:7], s33 offen offset:2048  sc1 lds
    buffer_load_dwordx4 v1, s[4:7], s33 offen offset:3072  sc1 lds
    s_add_u32 m0, s30, 30720
    s_add_u32 s33, s31, 12288
    buffer_load_dwordx4 v1, s[4:7], s33 offen offset:0  sc1 lds
    buffer_load_dwordx4 v1, s[4:7], s33 offen offset:1024  sc1 lds
    buffer_load_dwordx4 v1, s[4:7], s33 offen offset:2048  sc1 lds
    buffer_load_dwordx4 v1, s[4:7], s33 offen offset:3072  sc1 lds
    s_add_u32 m0, s30, 34816
    s_add_u32 s33, s31, 16384
    buffer_load_dwordx4 v1, s[4:7], s33 offen offset:0  sc1 lds
    buffer_load_dwordx4 v1, s[4:7], s33 offen offset:1024  sc1 lds
    s_mul_i32 s30, s20, 3072
    s_add_u32 s31, s30, s29
    s_waitcnt vmcnt(18)
    s_barrier
    s_add_u32 m0, s30, 147456
    s_add_u32 s33, s31, 73728
    buffer_load_dwordx4 v1, s[4:7], s33 offen offset:0  sc1 lds
    buffer_load_dwordx4 v1, s[4:7], s33 offen offset:1024  sc1 lds
    buffer_load_dwordx4 v1, s[4:7], s33 offen offset:2048  sc1 lds
    s_or_b32 s44, s20, s22
    s_cbranch_scc1 L_p2_ns
    s_and_b32 s44, s2, 15
    s_lshl_b32 s44, s44, 8
    s_add_u32 s44, s44, 0x4501000
    s_add_u32 s44, s44, s4
    s_addc_u32 s45, s5, 0
    s_mov_b32 s56, 1
    s_atomic_add s56, s[44:45], 0
L_p2_ns:
    s_waitcnt vmcnt(0)
    s_barrier
    s_and_b32 s25, s2, 7
    s_lshr_b32 s26, s2, 3
    s_and_b32 s23, s25, 1
    s_lshl_b32 s23, s23, 3
    s_and_b32 s27, s26, 7
    s_add_u32 s23, s23, s27
    s_lshr_b32 s24, s25, 1
    s_lshl_b32 s24, s24, 2
    s_lshr_b32 s27, s26, 3
    s_add_u32 s24, s24, s27
    s_add_u32 s28, s23, s24
    s_and_b32 s28, s28, 3
    s_lshl_b32 s30, s20, 12
    s_lshr_b32 s33, s20, 1
    s_mul_i32 s31, s33, 36864
    s_and_b32 s33, s20, 1
    s_lshl_b32 s33, s33, 10
    s_add_u32 s33, s33, 16384
    s_add_u32 s31, s31, s33
    s_sub_u32 s49, s33, s30
    s_mul_i32 s34, s24, 331776
    s_add_u32 s34, s34, s30
    s_add_u32 s34, s34, 0x3b00000
    s_lshl_b32 s35, s23, 3
    s_lshl_b32 s33, s20, 1
    s_add_u32 s35, s35, s33
    s_mul_i32 s35, s35, 18432
    s_add_u32 s35, s35, s21
    s_add_u32 s35, s35, 0x300000
    s_mul_i32 s36, s24, 589824
    s_add_u32 s36, s36, s30
    s_add_u32 s36, s36, s21
    s_add_u32 s36, s36, 0x900000
    v_add_u32 v2, 16384, v1
    s_add_u32 s33, s30, 18432
    v_add_u32 v6, s33, v1
    v_add_u32 v7, 73728, v6
    s_lshl_b32 s29, s23, 2
    s_add_u32 s29, s29, s20
    s_lshl_b32 s29, s29, 12
    s_add_u32 s29, s29, s21
    s_add_u32 s29, s29, 0x1b40000
    v_and_b32 v3, 48, v1
    v_lshrrev_b32 v8, 8, v1
    v_lshl_add_u32 v3, v8, 6, v3
    v_bfe_u32 v8, v1, 6, 2
    v_lshl_add_u32 v3, v8, 8, v3
    s_lshl_b32 s33, s23, 7
    s_lshl_b32 s37, s20, 5
    s_add_u32 s33, s33, s37
    v_lshrrev_b32 v8, 7, v1
    v_add_u32 v8, s33, v8
    v_lshlrev_b32 v8, 12, v8
    v_lshrrev_b32 v9, 8, v1
    v_bfe_u32 v10, v1, 4, 3
    v_xor_b32 v9, v9, v10
    v_lshl_add_u32 v8, v9, 4, v8
    v_xor_b32 v9, 64, v8
    v_add_u32 v9, 31744, v9
    v_add_u32 v10, 63488, v8
    v_add_u32 v11, 63488, v9
    s_cmp_eq_u32 s28, 0
    s_cselect_b32 s44, 4, 0
    s_cmp_eq_u32 s28, 1
    s_cselect_b32 s45, 5, 1
    s_cmp_eq_u32 s28, 2
    s_cselect_b32 s46, 6, 2
    s_cmp_eq_u32 s28, 3
    s_cselect_b32 s47, 7, 3
    s_lshl_b32 s33, s20, 4
    s_add_u32 s33, s33, s24
    s_lshl_b32 s54, s22, 7
    s_add_u32 s54, s54, s33
    s_lshl_b32 s54, s54, 8
    s_add_u32 s54, s54, 0x450c000
    s_add_u32 s54, s54, s4
    s_addc_u32 s55, s5, 0
    s_mov_b32 s33, 0x4501000
    v_and_b32 v4, 0xf0, v1
    v_lshlrev_b32 v4, 4, v4
    s_mov_b32 s60, 65536
L_poll_wr:
    buffer_load_dword v5, v4, s[4:7], s33 offen sc1
    s_waitcnt vmcnt(0)
    v_cmp_gt_u32 vcc, 16, v5
    s_sub_u32 s60, s60, 1
    s_cbranch_scc1 L_pd_wr
    s_cbranch_vccz L_pd_wr
    s_sleep 4
    s_branch L_poll_wr
L_pd_wr:
    s_min_u32 s33, s20, 2
    s_lshl_b32 s33, s33, 9
    v_lshrrev_b32 v4, 1, v1
    v_add_u32 v4, s33, v4
    s_lshl_b32 s51, s24, 12
    s_add_u32 s51, s51, 0x4410000
    buffer_load_dwordx2 v[16:17], v4, s[4:7], s51 offen offset:0 sc1
    buffer_load_dwordx2 v[18:19], v4, s[4:7], s51 offen offset:1152 sc1
    s_mov_b32 s48, 0
    s_mul_i32 s50, s48, 18432
    s_add_u32 s50, s50, s34
    s_add_u32 m0, s30, 0
    s_mov_b32 s53, s50
    buffer_load_dwordx4 v1, s[4:7], s50 offen offset:0  sc1 lds
    buffer_load_dwordx4 v1, s[4:7], s50 offen offset:1024  sc1 lds
    buffer_load_dwordx4 v1, s[4:7], s50 offen offset:2048  sc1 lds
    buffer_load_dwordx4 v1, s[4:7], s50 offen offset:3072  sc1 lds
    s_mov_b32 s48, 1
    s_mul_i32 s50, s48, 18432
    s_add_u32 s50, s50, s34
    s_cmp_ge_u32 s20, 2
    s_cselect_b32 s52, s50, s53
    s_add_u32 m0, s31, 0
    s_add_u32 s52, s52, s49
    buffer_load_dwordx4 v1, s[4:7], s52 offen  sc1 lds
    s_add_u32 m0, s30, 36864
    s_mov_b32 s53, s50
    buffer_load_dwordx4 v1, s[4:7], s50 offen offset:0  sc1 lds
    buffer_load_dwordx4 v1, s[4:7], s50 offen offset:1024  sc1 lds
    buffer_load_dwordx4 v1, s[4:7], s50 offen offset:2048  sc1 lds
    buffer_load_dwordx4 v1, s[4:7], s50 offen offset:3072  sc1 lds
    s_mov_b32 m0, 161280
    v_lshrrev_b32 v5, 2, v1
    s_lshl_b32 s33, s23, 8
    buffer_load_dword v5, s[12:15], s33 offen lds
    s_waitcnt vmcnt(10)
    v_add_u32 v4, 159744, v4
    v_add_f32 v16, v16, v18
    v_add_f32 v17, v17, v19
    ds_write_b64 v4, v[16:17]
    s_waitcnt lgkmcnt(0)
    s_barrier
    s_mov_b32 s48, 2
    s_mul_i32 s50, s48, 18432
    s_add_u32 s50, s50, s34
    s_add_u32 m0, s30, 73728
    s_mov_b32 s53, s50
    buffer_load_dwordx4 v1, s[4:7], s50 offen offset:0  sc1 lds
    buffer_load_dwordx4 v1, s[4:7], s50 offen offset:1024  sc1 lds
    buffer_load_dwordx4 v1, s[4:7], s50 offen offset:2048  sc1 lds
    buffer_load_dwordx4 v1, s[4:7], s50 offen offset:3072  sc1 lds
    s_mov_b32 s48, 3
    s_mul_i32 s50, s48, 18432
    s_add_u32 s50, s50, s34
    s_cmp_ge_u32 s20, 2
    s_cselect_b32 s52, s50, s53
    s_add_u32 m0, s31, 73728
    s_add_u32 s52, s52, s49
    buffer_load_dwordx4 v1, s[4:7], s52 offen  sc1 lds
    s_add_u32 m0, s30, 110592
    s_mov_b32 s53, s50
    buffer_load_dwordx4 v1, s[4:7], s50 offen offset:0  sc1 lds
    buffer_load_dwordx4 v1, s[4:7], s50 offen offset:1024  sc1 lds
    buffer_load_dwordx4 v1, s[4:7], s50 offen offset:2048  sc1 lds
    buffer_load_dwordx4 v1, s[4:7], s50 offen offset:3072  sc1 lds
    s_barrier
    s_add_u32 m0, s30, 18432
    s_add_u32 s51, s35, 0
    buffer_load_dwordx4 v1, s[4:7], s51 offen offset:0 sc1 lds
    buffer_load_dwordx4 v1, s[4:7], s51 offen offset:1024 sc1 lds
    buffer_load_dwordx4 v2, s[4:7], s51 offen offset:2048 sc1 lds
    buffer_load_dwordx4 v2, s[4:7], s51 offen offset:3072 sc1 lds
    s_add_u32 m0, s30, 55296
    s_add_u32 s51, s35, 2048
    buffer_load_dwordx4 v1, s[4:7], s51 offen offset:0 sc1 lds
    buffer_load_dwordx4 v1, s[4:7], s51 offen offset:1024 sc1 lds
    buffer_load_dwordx4 v2, s[4:7], s51 offen offset:2048 sc1 lds
    buffer_load_dwordx4 v2, s[4:7], s51 offen offset:3072 sc1 lds
    s_add_u32 m0, s30, 92160
    s_add_u32 s51, s35, 4096
    buffer_load_dwordx4 v1, s[4:7], s51 offen offset:0 sc1 lds
    buffer_load_dwordx4 v1, s[4:7], s51 offen offset:1024 sc1 lds
    buffer_load_dwordx4 v2, s[4:7], s51 offen offset:2048 sc1 lds
    buffer_load_dwordx4 v2, s[4:7], s51 offen offset:3072 sc1 lds
    s_waitcnt vmcnt(8)
    s_barrier
    s_add_u32 m0, s30, 129024
    s_add_u32 s51, s35, 6144
    buffer_load_dwordx4 v1, s[4:7], s51 offen offset:0 sc1 lds
    buffer_load_dwordx4 v1, s[4:7], s51 offen offset:1024 sc1 lds
    buffer_load_dwordx4 v2, s[4:7], s51 offen offset:2048 sc1 lds
    buffer_load_dwordx4 v2, s[4:7], s51 offen offset:3072 sc1 lds
    s_and_b32 s40, s2, 7
    s_lshr_b32 s26, s2, 3
    s_lshr_b32 s38, s40, 1
    s_lshl_b32 s38, s38, 3
    s_lshr_b32 s27, s26, 2
    s_add_u32 s38, s38, s27
    s_and_b32 s39, s40, 1
    s_lshl_b32 s39, s39, 2
    s_and_b32 s27, s26, 3
    s_add_u32 s39, s39, s27
    s_add_u32 s40, s38, s39
    s_and_b32 s40, s40, 3
    s_mul_i32 s42, s20, 9216
    s_mul_i32 s43, s39, 331776
    s_add_u32 s43, s43, s42
    s_add_u32 s43, s43, 0x4100000
    s_waitcnt vmcnt(8) lgkmcnt(0)
    s_barrier
    s_mov_b32 s48, 4
    s_mul_i32 s50, s48, 18432
    s_add_u32 s50, s50, s34
    s_add_u32 m0, s30, 0
    s_mov_b32 s53, s50
    buffer_load_dwordx4 v1, s[4:7], s50 offen offset:0  sc1 lds
    buffer_load_dwordx4 v1, s[4:7], s50 offen offset:1024  sc1 lds
    buffer_load_dwordx4 v1, s[4:7], s50 offen offset:2048  sc1 lds
    buffer_load_dwordx4 v1, s[4:7], s50 offen offset:3072  sc1 lds
    s_add_u32 m0, s30, 18432
    s_add_u32 s51, s35, 8192
    buffer_load_dwordx4 v1, s[4:7], s51 offen offset:0 sc1 lds
    buffer_load_dwordx4 v1, s[4:7], s51 offen offset:1024 sc1 lds
    buffer_load_dwordx4 v2, s[4:7], s51 offen offset:2048 sc1 lds
    buffer_load_dwordx4 v2, s[4:7], s51 offen offset:3072 sc1 lds
    s_waitcnt vmcnt(12) lgkmcnt(0)
    s_barrier
    s_mov_b32 s48, 5
    s_mul_i32 s50, s48, 18432
    s_add_u32 s50, s50, s34
    s_cmp_ge_u32 s20, 2
    s_cselect_b32 s52, s50, s53
    s_add_u32 m0, s31, 0
    s_add_u32 s52, s52, s49
    buffer_load_dwordx4 v1, s[4:7], s52 offen  sc1 lds
    s_add_u32 m0, s30, 36864
    s_mov_b32 s53, s50
    buffer_load_dwordx4 v1, s[4:7], s50 offen offset:0  sc1 lds
    buffer_load_dwordx4 v1, s[4:7], s50 offen offset:1024  sc1 lds
    buffer_load_dwordx4 v1, s[4:7], s50 offen offset:2048  sc1 lds
    buffer_load_dwordx4 v1, s[4:7], s50 offen offset:3072  sc1 lds
    s_add_u32 m0, s30, 55296
    s_add_u32 s51, s35, 10240
    buffer_load_dwordx4 v1, s[4:7], s51 offen offset:0 sc1 lds
    buffer_load_dwordx4 v1, s[4:7], s51 offen offset:1024 sc1 lds
    buffer_load_dwordx4 v2, s[4:7], s51 offen offset:2048 sc1 lds
    buffer_load_dwordx4 v2, s[4:7], s51 offen offset:3072 sc1 lds
    s_waitcnt vmcnt(17) lgkmcnt(0)
    s_barrier
    s_mov_b32 s48, 6
    s_mul_i32 s50, s48, 18432
    s_add_u32 s50, s50, s34
    s_add_u32 m0, s30, 73728
    s_mov_b32 s53, s50
    buffer_load_dwordx4 v1, s[4:7], s50 offen offset:0  sc1 lds
    buffer_load_dwordx4 v1, s[4:7], s50 offen offset:1024  sc1 lds
    buffer_load_dwordx4 v1, s[4:7], s50 offen offset:2048  sc1 lds
    buffer_load_dwordx4 v1, s[4:7], s50 offen offset:3072  sc1 lds
    s_add_u32 m0, s30, 92160
    s_add_u32 s51, s35, 12288
    buffer_load_dwordx4 v1, s[4:7], s51 offen offset:0 sc1 lds
    buffer_load_dwordx4 v1, s[4:7], s51 offen offset:1024 sc1 lds
    buffer_load_dwordx4 v2, s[4:7], s51 offen offset:2048 sc1 lds
    buffer_load_dwordx4 v2, s[4:7], s51 offen offset:3072 sc1 lds
    s_waitcnt vmcnt(16) lgkmcnt(0)
    s_barrier
    s_mov_b32 s48, 7
    s_mul_i32 s50, s48, 18432
    s_add_u32 s50, s50, s34
    s_cmp_ge_u32 s20, 2
    s_cselect_b32 s52, s50, s53
    s_add_u32 m0, s31, 73728
    s_add_u32 s52, s52, s49
    buffer_load_dwordx4 v1, s[4:7], s52 offen  sc1 lds
    s_add_u32 m0, s30, 110592
    s_mov_b32 s53, s50
    buffer_load_dwordx4 v1, s[4:7], s50 offen offset:0  sc1 lds
    buffer_load_dwordx4 v1, s[4:7], s50 offen offset:1024  sc1 lds
    buffer_load_dwordx4 v1, s[4:7], s50 offen offset:2048  sc1 lds
    buffer_load_dwordx4 v1, s[4:7], s50 offen offset:3072  sc1 lds
    s_add_u32 m0, s30, 129024
    s_add_u32 s51, s35, 14336
    buffer_load_dwordx4 v1, s[4:7], s51 offen offset:0 sc1 lds
    buffer_load_dwordx4 v1, s[4:7], s51 offen offset:1024 sc1 lds
    buffer_load_dwordx4 v2, s[4:7], s51 offen offset:2048 sc1 lds
    buffer_load_dwordx4 v2, s[4:7], s51 offen offset:3072 sc1 lds
    s_waitcnt vmcnt(17) lgkmcnt(0)
    s_barrier
    s_mov_b32 s48, 8
    s_mul_i32 s50, s48, 18432
    s_add_u32 s50, s50, s34
    s_add_u32 m0, s30, 0
    s_mov_b32 s53, s50
    buffer_load_dwordx4 v1, s[4:7], s50 offen offset:0  sc1 lds
    buffer_load_dwordx4 v1, s[4:7], s50 offen offset:1024  sc1 lds
    buffer_load_dwordx4 v1, s[4:7], s50 offen offset:2048  sc1 lds
    buffer_load_dwordx4 v1, s[4:7], s50 offen offset:3072  sc1 lds
    s_add_u32 m0, s30, 18432
    s_add_u32 s51, s35, 16384
    buffer_load_dwordx4 v1, s[4:7], s51 offen offset:0 sc1 lds
    buffer_load_dwordx4 v1, s[4:7], s51 offen offset:1024 sc1 lds
    buffer_load_dwordx4 v2, s[4:7], s51 offen offset:2048 sc1 lds
    buffer_load_dwordx4 v2, s[4:7], s51 offen offset:3072 sc1 lds
    s_waitcnt vmcnt(16) lgkmcnt(0)
    s_barrier
    s_mov_b32 s48, 5
    s_mul_i32 s50, s48, 18432
    s_add_u32 s50, s50, s34
    s_add_u32 s50, s50, 165888
    s_cmp_ge_u32 s20, 2
    s_cselect_b32 s52, s50, s53
    s_add_u32 m0, s31, 0
    s_add_u32 s52, s52, s49
    buffer_load_dwordx4 v1, s[4:7], s52 offen  sc1 lds
    s_add_u32 m0, s30, 36864
    s_mov_b32 s53, s50
    buffer_load_dwordx4 v1, s[4:7], s50 offen offset:0  sc1 lds
    buffer_load_dwordx4 v1, s[4:7], s50 offen offset:1024  sc1 lds
    buffer_load_dwordx4 v1, s[4:7], s50 offen offset:2048  sc1 lds
    buffer_load_dwordx4 v1, s[4:7], s50 offen offset:3072  sc1 lds
    s_cmp_lg_u32 s22, 0
    s_cbranch_scc1 L_p5_k6
    s_add_u32 s32, s43, 294912
    buffer_load_dwordx4 v[220:223], v1, s[4:7], s32 offen offset:0 sc1
    buffer_load_dwordx4 v[224:227], v1, s[4:7], s32 offen offset:1024 sc1
    buffer_load_dwordx4 v[228:231], v1, s[4:7], s32 offen offset:2048 sc1
    buffer_load_dwordx4 v[232:235], v1, s[4:7], s32 offen offset:3072 sc1
    s_add_u32 s32, s43, 299008
    buffer_load_dwordx4 v[236:239], v1, s[4:7], s32 offen offset:0 sc1
L_p5_k6:
    s_waitcnt vmcnt(18) lgkmcnt(0)
    s_cmp_eq_u32 s22, 0
    s_cbranch_scc1 L_wv_919
    s_waitcnt vmcnt(13)
L_wv_919:
    s_barrier
    s_mov_b32 s48, 6
    s_mul_i32 s50, s48, 18432
    s_add_u32 s50, s50, s34
    s_add_u32 s50, s50, 165888
    s_add_u32 m0, s30, 73728
    s_mov_b32 s53, s50
    buffer_load_dwordx4 v1, s[4:7], s50 offen offset:0  sc1 lds
    buffer_load_dwordx4 v1, s[4:7], s50 offen offset:1024  sc1 lds
    buffer_load_dwordx4 v1, s[4:7], s50 offen offset:2048  sc1 lds
    buffer_load_dwordx4 v1, s[4:7], s50 offen offset:3072  sc1 lds
    s_cmp_lg_u32 s22, 0
    s_cbranch_scc1 L_p5_k7
    s_add_u32 s32, s43, 299008
    buffer_load_dwordx4 v[240:243], v1, s[4:7], s32 offen offset:1024 sc1
    buffer_load_dwordx4 v[244:247], v1, s[4:7], s32 offen offset:2048 sc1
    buffer_load_dwordx4 v[248:251], v1, s[4:7], s32 offen offset:3072 sc1
    s_add_u32 s32, s43, 303104
    buffer_load_dwordx4 v[252:255], v1, s[4:7], s32 offen offset:0 sc1
    s_add_u32 s32, s43, 258048
    buffer_load_dwordx4 v[184:187], v1, s[4:7], s32 offen offset:0 sc1
L_p5_k7:
    s_waitcnt vmcnt(18) lgkmcnt(0)
    s_cmp_eq_u32 s22, 0
    s_cbranch_scc1 L_wv_946
    s_waitcnt vmcnt(8)
L_wv_946:
    s_barrier
    s_mov_b32 s48, 7
    s_mul_i32 s50, s48, 18432
    s_add_u32 s50, s50, s34
    s_add_u32 s50, s50, 165888
    s_cmp_ge_u32 s20, 2
    s_cselect_b32 s52, s50, s53
    s_add_u32 m0, s31, 73728
    s_add_u32 s52, s52, s49
    buffer_load_dwordx4 v1, s[4:7], s52 offen  sc1 lds
    s_add_u32 m0, s30, 110592
    s_mov_b32 s53, s50
    buffer_load_dwordx4 v1, s[4:7], s50 offen offset:0  sc1 lds
    buffer_load_dwordx4 v1, s[4:7], s50 offen offset:1024  sc1 lds
    buffer_load_dwordx4 v1, s[4:7], s50 offen offset:2048  sc1 lds
    buffer_load_dwordx4 v1, s[4:7], s50 offen offset:3072  sc1 lds
    s_cmp_lg_u32 s22, 0
    s_cbranch_scc1 L_p5_k8
    s_add_u32 s32, s43, 258048
    buffer_load_dwordx4 v[188:191], v1, s[4:7], s32 offen offset:1024 sc1
    buffer_load_dwordx4 v[192:195], v1, s[4:7], s32 offen offset:2048 sc1
    buffer_load_dwordx4 v[196:199], v1, s[4:7], s32 offen offset:3072 sc1
    s_add_u32 s32, s43, 262144
    buffer_load_dwordx4 v[200:203], v1, s[4:7], s32 offen offset:0 sc1
    buffer_load_dwordx4 v[204:207], v1, s[4:7], s32 offen offset:1024 sc1
L_p5_k8:
    s_waitcnt vmcnt(24) lgkmcnt(0)
    s_cmp_eq_u32 s22, 0
    s_cbranch_scc1 L_wv_977
    s_waitcnt vmcnt(9)
L_wv_977:
    s_barrier
    s_mov_b32 s48, 8
    s_mul_i32 s50, s48, 18432
    s_add_u32 s50, s50, s34
    s_add_u32 s50, s50, 165888
    s_add_u32 m0, s30, 0
    s_mov_b32 s53, s50
    buffer_load_dwordx4 v1, s[4:7], s50 offen offset:0  sc1 lds
    buffer_load_dwordx4 v1, s[4:7], s50 offen offset:1024  sc1 lds
    buffer_load_dwordx4 v1, s[4:7], s50 offen offset:2048  sc1 lds
    buffer_load_dwordx4 v1, s[4:7], s50 offen offset:3072  sc1 lds
    s_cmp_lg_u32 s22, 0
    s_cbranch_scc1 L_p5_k9
    s_add_u32 s32, s43, 262144
    buffer_load_dwordx4 v[208:211], v1, s[4:7], s32 offen offset:2048 sc1
    buffer_load_dwordx4 v[212:215], v1, s[4:7], s32 offen offset:3072 sc1
    s_add_u32 s32, s43, 266240
    buffer_load_dwordx4 v[216:219], v1, s[4:7], s32 offen offset:0 sc1
    s_add_u32 s32, s43, 221184
    buffer_load_dwordx4 v[148:151], v1, s[4:7], s32 offen offset:0 sc1
    buffer_load_dwordx4 v[152:155], v1, s[4:7], s32 offen offset:1024 sc1
    buffer_load_dwordx4 v[156:159], v1, s[4:7], s32 offen offset:2048 sc1
    buffer_load_dwordx4 v[160:163], v1, s[4:7], s32 offen offset:3072 sc1
    s_add_u32 s32, s43, 225280
    buffer_load_dwordx4 v[164:167], v1, s[4:7], s32 offen offset:0 sc1
    buffer_load_dwordx4 v[168:171], v1, s[4:7], s32 offen offset:1024 sc1
    buffer_load_dwordx4 v[172:175], v1, s[4:7], s32 offen offset:2048 sc1
    buffer_load_dwordx4 v[176:179], v1, s[4:7], s32 offen offset:3072 sc1
    s_add_u32 s32, s43, 229376
    buffer_load_dwordx4 v[180:183], v1, s[4:7], s32 offen offset:0 sc1
    s_add_u32 s32, s43, 184320
    buffer_load_dwordx4 v[112:115], v1, s[4:7], s32 offen offset:0 sc1
    buffer_load_dwordx4 v[116:119], v1, s[4:7], s32 offen offset:1024 sc1
    buffer_load_dwordx4 v[120:123], v1, s[4:7], s32 offen offset:2048 sc1
    buffer_load_dwordx4 v[124:127], v1, s[4:7], s32 offen offset:3072 sc1
    s_add_u32 s32, s43, 188416
    buffer_load_dwordx4 v[128:131], v1, s[4:7], s32 offen offset:0 sc1
    buffer_load_dwordx4 v[132:135], v1, s[4:7], s32 offen offset:1024 sc1
    buffer_load_dwordx4 v[136:139], v1, s[4:7], s32 offen offset:2048 sc1
    buffer_load_dwordx4 v[140:143], v1, s[4:7], s32 offen offset:3072 sc1
    s_add_u32 s32, s43, 192512
    buffer_load_dwordx4 v[144:147], v1, s[4:7], s32 offen offset:0 sc1
    s_add_u32 s32, s43, 147456
    buffer_load_dwordx4 v[76:79], v1, s[4:7], s32 offen offset:0 sc1
    buffer_load_dwordx4 v[80:83], v1, s[4:7], s32 offen offset:1024 sc1
    buffer_load_dwordx4 v[84:87], v1, s[4:7], s32 offen offset:2048 sc1
    buffer_load_dwordx4 v[88:91], v1, s[4:7], s32 offen offset:3072 sc1
    s_add_u32 s32, s43, 151552
    buffer_load_dwordx4 v[92:95], v1, s[4:7], s32 offen offset:0 sc1
    buffer_load_dwordx4 v[96:99], v1, s[4:7], s32 offen offset:1024 sc1
    buffer_load_dwordx4 v[100:103], v1, s[4:7], s32 offen offset:2048 sc1
    buffer_load_dwordx4 v[104:107], v1, s[4:7], s32 offen offset:3072 sc1
    s_add_u32 s32, s43, 155648
    buffer_load_dwordx4 v[108:111], v1, s[4:7], s32 offen offset:0 sc1
L_p5_k9:
    s_waitcnt vmcnt(43) lgkmcnt(0)
    s_cmp_eq_u32 s22, 0
    s_cbranch_scc1 L_wv_1037
    s_waitcnt vmcnt(8)
L_wv_1037:
    s_barrier
    s_mov_b32 s48, 0
    s_mul_i32 s50, s48, 18432
    s_add_u32 s50, s50, s34
    s_add_u32 s50, s50, 165888
    s_cmp_ge_u32 s20, 2
    s_cselect_b32 s52, s50, s53
    s_add_u32 m0, s31, 0
    s_add_u32 s52, s52, s49
    buffer_load_dwordx4 v1, s[4:7], s52 offen  sc1 lds
    s_add_u32 m0, s30, 36864
    s_mov_b32 s53, s50
    buffer_load_dwordx4 v1, s[4:7], s50 offen offset:0  sc1 lds
    buffer_load_dwordx4 v1, s[4:7], s50 offen offset:1024  sc1 lds
    buffer_load_dwordx4 v1, s[4:7], s50 offen offset:2048  sc1 lds
    buffer_load_dwordx4 v1, s[4:7], s50 offen offset:3072  sc1 lds
    s_add_u32 m0, s30, 55296
    s_add_u32 s51, s35, 0
    buffer_load_dwordx4 v1, s[4:7], s51 offen offset:0 sc1 lds
    buffer_load_dwordx4 v1, s[4:7], s51 offen offset:1024 sc1 lds
    buffer_load_dwordx4 v2, s[4:7], s51 offen offset:2048 sc1 lds
    buffer_load_dwordx4 v2, s[4:7], s51 offen offset:3072 sc1 lds
    s_waitcnt vmcnt(48) lgkmcnt(0)
    s_cmp_eq_u32 s22, 0
    s_cbranch_scc1 L_wv_1064
    s_waitcnt vmcnt(13)
L_wv_1064:
    s_barrier
    buffer_load_dwordx4 v[16:19], v3, s[4:7], s29 offen offset:0 sc1
    buffer_load_dwordx4 v[20:23], v3, s[4:7], s29 offen offset:1024 sc1
    buffer_load_dwordx4 v[24:27], v3, s[4:7], s29 offen offset:2048 sc1
    buffer_load_dwordx4 v[28:31], v3, s[4:7], s29 offen offset:3072 sc1
    s_mov_b32 s48, 1
    s_mul_i32 s50, s48, 18432
    s_add_u32 s50, s50, s34
    s_add_u32 s50, s50, 165888
    s_add_u32 m0, s30, 73728
    s_mov_b32 s53, s50
    buffer_load_dwordx4 v1, s[4:7], s50 offen offset:0  sc1 lds
    buffer_load_dwordx4 v1, s[4:7], s50 offen offset:1024  sc1 lds
    buffer_load_dwordx4 v1, s[4:7], s50 offen offset:2048  sc1 lds
    buffer_load_dwordx4 v1, s[4:7], s50 offen offset:3072  sc1 lds
    s_add_u32 m0, s30, 92160
    s_add_u32 s51, s35, 2048
    buffer_load_dwordx4 v1, s[4:7], s51 offen offset:0 sc1 lds
    buffer_load_dwordx4 v1, s[4:7], s51 offen offset:1024 sc1 lds
    buffer_load_dwordx4 v2, s[4:7], s51 offen offset:2048 sc1 lds
    buffer_load_dwordx4 v2, s[4:7], s51 offen offset:3072 sc1 lds
    s_waitcnt vmcnt(20) lgkmcnt(0)
    s_barrier
    s_mov_b32 s48, 2
    s_mul_i32 s50, s48, 18432
    s_add_u32 s50, s50, s34
    s_add_u32 s50, s50, 165888
    s_cmp_ge_u32 s20, 2
    s_cselect_b32 s52, s50, s53
    s_add_u32 m0, s31, 73728
    s_add_u32 s52, s52, s49
    buffer_load_dwordx4 v1, s[4:7], s52 offen  sc1 lds
    s_add_u32 m0, s30, 110592
    s_mov_b32 s53, s50
    buffer_load_dwordx4 v1, s[4:7], s50 offen offset:0  sc1 lds
    buffer_load_dwordx4 v1, s[4:7], s50 offen offset:1024  sc1 lds
    buffer_load_dwordx4 v1, s[4:7], s50 offen offset:2048  sc1 lds
    buffer_load_dwordx4 v1, s[4:7], s50 offen offset:3072  sc1 lds
    s_add_u32 m0, s30, 129024
    s_add_u32 s51, s35, 4096
    buffer_load_dwordx4 v1, s[4:7], s51 offen offset:0 sc1 lds
    buffer_load_dwordx4 v1, s[4:7], s51 offen offset:1024 sc1 lds
    buffer_load_dwordx4 v2, s[4:7], s51 offen offset:2048 sc1 lds
    buffer_load_dwordx4 v2, s[4:7], s51 offen offset:3072 sc1 lds
    s_mov_b32 s60, 65536
    s_waitcnt vmcnt(17)
L_g_chk:
    v_or3_b32 v32, v17, v19, v21
    v_or3_b32 v33, v23, v25, v27
    v_or3_b32 v32, v29, v31, v32
    v_or_b32 v32, v32, v33
    v_cmp_gt_i32 vcc, 0, v32
    s_sub_u32 s60, s60, 1
    s_cbranch_scc1 L_g_ok
    s_cbranch_vccz L_g_ok
    buffer_load_dwordx4 v[16:19], v3, s[4:7], s29 offen offset:0 sc1
    buffer_load_dwordx4 v[20:23], v3, s[4:7], s29 offen offset:1024 sc1
    buffer_load_dwordx4 v[24:27], v3, s[4:7], s29 offen offset:2048 sc1
    buffer_load_dwordx4 v[28:31], v3, s[4:7], s29 offen offset:3072 sc1
    s_waitcnt vmcnt(0)
    s_branch L_g_chk
L_g_ok:
    v_add_f32 v16, v16, v20
    v_add_f32 v24, v24, v28
    v_add_f32 v17, v17, v21
    v_add_f32 v25, v25, v29
    v_add_f32 v18, v18, v22
    v_add_f32 v26, v26, v30
    v_add_f32 v19, v19, v23
    v_add_f32 v27, v27, v31
    v_add_f32 v16, v16, v24
    v_add_f32 v17, v17, v25
    v_add_f32 v18, v18, v26
    v_add_f32 v19, v19, v27
    v_add_f32_dpp v16, v16, v16 row_ror:4 row_mask:0xf bank_mask:0xf
    v_add_f32_dpp v17, v17, v17 row_ror:4 row_mask:0xf bank_mask:0xf
    v_add_f32_dpp v18, v18, v18 row_ror:4 row_mask:0xf bank_mask:0xf
    v_add_f32_dpp v19, v19, v19 row_ror:4 row_mask:0xf bank_mask:0xf
    v_add_f32_dpp v16, v16, v16 row_ror:8 row_mask:0xf bank_mask:0xf
    v_add_f32_dpp v17, v17, v17 row_ror:8 row_mask:0xf bank_mask:0xf
    v_add_f32_dpp v18, v18, v18 row_ror:8 row_mask:0xf bank_mask:0xf
    v_add_f32_dpp v19, v19, v19 row_ror:8 row_mask:0xf bank_mask:0xf
    v_mul_f32 v16, 0x39e38e39, v16
    v_mul_f32 v17, 0x39e38e39, v17
    v_mul_f32 v18, 0x39e38e39, v18
    v_mul_f32 v19, 0x39e38e39, v19
    v_fma_f32 v17, -v16, v16, v17
    v_fma_f32 v19, -v18, v18, v19
    v_max_f32 v17, 0, v17
    v_max_f32 v19, 0, v19
    v_add_f32 v17, 0x3727c5ac, v17
    v_add_f32 v19, 0x3727c5ac, v19
    v_rsq_f32 v20, v17
    v_rsq_f32 v21, v19
    v_and_b32 v32, 0xff, v3
    s_lshl_b32 s33, s20, 8
    s_add_u32 s33, s33, 148480
    v_add_u32 v32, s33, v32
    v_mul_f32 v22, v16, v20
    v_mul_f32 v23, v18, v21
    ds_write_b128 v32, v[20:23]
    s_waitcnt vmcnt(17) lgkmcnt(0)
    s_barrier
    s_mov_b32 s48, 3
    s_mul_i32 s50, s48, 18432
    s_add_u32 s50, s50, s34
    s_add_u32 s50, s50, 165888
    s_add_u32 m0, s30, 0
    s_mov_b32 s53, s50
    buffer_load_dwordx4 v1, s[4:7], s50 offen offset:0  sc1 lds
    buffer_load_dwordx4 v1, s[4:7], s50 offen offset:1024  sc1 lds
    buffer_load_dwordx4 v1, s[4:7], s50 offen offset:2048  sc1 lds
    buffer_load_dwordx4 v1, s[4:7], s50 offen offset:3072  sc1 lds
    s_add_u32 m0, s30, 18432
    s_add_u32 s51, s35, 6144
    buffer_load_dwordx4 v1, s[4:7], s51 offen offset:0 sc1 lds
    buffer_load_dwordx4 v1, s[4:7], s51 offen offset:1024 sc1 lds
    buffer_load_dwordx4 v2, s[4:7], s51 offen offset:2048 sc1 lds
    buffer_load_dwordx4 v2, s[4:7], s51 offen offset:3072 sc1 lds
    s_waitcnt vmcnt(16) lgkmcnt(0)
    s_barrier
    s_mov_b32 s48, 4
    s_mul_i32 s50, s48, 18432
    s_add_u32 s50, s50, s34
    s_add_u32 s50, s50, 165888
    s_cmp_ge_u32 s20, 2
    s_cselect_b32 s52, s50, s53
    s_add_u32 m0, s31, 0
    s_add_u32 s52, s52, s49
    buffer_load_dwordx4 v1, s[4:7], s52 offen  sc1 lds
    s_add_u32 m0, s30, 36864
    s_mov_b32 s53, s50
    buffer_load_dwordx4 v1, s[4:7], s50 offen offset:0  sc1 lds
    buffer_load_dwordx4 v1, s[4:7], s50 offen offset:1024  sc1 lds
    buffer_load_dwordx4 v1, s[4:7], s50 offen offset:2048  sc1 lds
    buffer_load_dwordx4 v1, s[4:7], s50 offen offset:3072  sc1 lds
    s_add_u32 m0, s30, 55296
    s_add_u32 s51, s35, 8192
    buffer_load_dwordx4 v1, s[4:7], s51 offen offset:0 sc1 lds
    buffer_load_dwordx4 v1, s[4:7], s51 offen offset:1024 sc1 lds
    buffer_load_dwordx4 v2, s[4:7], s51 offen offset:2048 sc1 lds
    buffer_load_dwordx4 v2, s[4:7], s51 offen offset:3072 sc1 lds
    s_waitcnt vmcnt(17) lgkmcnt(0)
    s_barrier
    s_waitcnt vmcnt(8) lgkmcnt(0)
    s_barrier
    s_waitcnt vmcnt(0) lgkmcnt(0)
    s_barrier
    s_barrier
    s_mov_b32 s56, 1
    s_atomic_add s56, s[54:55], 0
    s_mov_b32 s57, 0
    s_atomic_add s57, s[54:55], 0 glc
    s_lshl_b32 s48, s23, 1
    s_add_u32 s48, s48, 0
    s_add_u32 m0, s30, 92160
    s_lshl_b32 s51, s48, 7
    buffer_load_dwordx4 v8, s[8:11], s51 offen offset:0  lds
    buffer_load_dwordx4 v9, s[8:11], s51 offen offset:1024  lds
    buffer_load_dwordx4 v10, s[8:11], s51 offen offset:2048  lds
    buffer_load_dwordx4 v11, s[8:11], s51 offen offset:3072  lds
    s_lshl_b32 s48, s23, 1
    s_add_u32 s48, s48, 1
    s_add_u32 m0, s30, 129024
    s_lshl_b32 s51, s48, 7
    buffer_load_dwordx4 v8, s[8:11], s51 offen offset:0  lds
    buffer_load_dwordx4 v9, s[8:11], s51 offen offset:1024  lds
    buffer_load_dwordx4 v10, s[8:11], s51 offen offset:2048  lds
    buffer_load_dwordx4 v11, s[8:11], s51 offen offset:3072  lds
    s_lshr_b32 s48, s46, 1
    s_cmp_eq_u32 s48, s23
    s_cselect_b32 s48, 1, 31
    s_and_b32 s48, s48, s46
    s_add_u32 m0, s30, 18432
    s_lshl_b32 s51, s48, 7
    buffer_load_dwordx4 v8, s[8:11], s51 offen offset:0  lds
    buffer_load_dwordx4 v9, s[8:11], s51 offen offset:1024  lds
    buffer_load_dwordx4 v10, s[8:11], s51 offen offset:2048  lds
    buffer_load_dwordx4 v11, s[8:11], s51 offen offset:3072  lds
    s_waitcnt lgkmcnt(0)
    s_cmp_ge_u32 s57, 16
    s_cbranch_scc1 L_g_r0
    s_mov_b32 s57, 0
    s_atomic_add s57, s[54:55], 0 glc
    s_waitcnt vmcnt(8)
    s_barrier
    s_waitcnt lgkmcnt(0)
    s_cmp_ge_u32 s57, 16
    s_cbranch_scc1 L_g_r1
    s_waitcnt vmcnt(4)
    s_barrier
    s_mov_b32 s60, 65536
L_poll_z2:
    s_mov_b32 s57, 0
    s_atomic_add s57, s[54:55], 0 glc
    s_waitcnt lgkmcnt(0)
    s_cmp_ge_u32 s57, 16
    s_cbranch_scc1 L_pd_z2
    s_sub_u32 s60, s60, 1
    s_cbranch_scc1 L_pd_z2
    s_sleep 2
    s_branch L_poll_z2
L_pd_z2:
    s_lshr_b32 s48, s46, 1
    s_cmp_eq_u32 s48, s23
    s_cselect_b32 s48, 1, 31
    s_and_b32 s48, s48, s46
    s_mul_i32 s50, s48, 18432
    s_add_u32 s50, s50, s36
    s_add_u32 m0, s30, 0
    s_mov_b32 s53, s50
    buffer_load_dwordx4 v1, s[4:7], s50 offen offset:0 sc1 lds
    buffer_load_dwordx4 v1, s[4:7], s50 offen offset:1024 sc1 lds
    buffer_load_dwordx4 v1, s[4:7], s50 offen offset:2048 sc1 lds
    buffer_load_dwordx4 v1, s[4:7], s50 offen offset:3072 sc1 lds
    s_lshr_b32 s48, s47, 1
    s_cmp_eq_u32 s48, s23
    s_cselect_b32 s48, 1, 31
    s_and_b32 s48, s48, s47
    s_mul_i32 s50, s48, 18432
    s_add_u32 s50, s50, s36
    s_cmp_ge_u32 s20, 2
    s_cselect_b32 s52, s50, s53
    s_add_u32 m0, s31, 0
    s_add_u32 s52, s52, s49
    buffer_load_dwordx4 v1, s[4:7], s52 offen sc1 lds
    s_add_u32 m0, s30, 36864
    s_mov_b32 s53, s50
    buffer_load_dwordx4 v1, s[4:7], s50 offen offset:0 sc1 lds
    buffer_load_dwordx4 v1, s[4:7], s50 offen offset:1024 sc1 lds
    buffer_load_dwordx4 v1, s[4:7], s50 offen offset:2048 sc1 lds
    buffer_load_dwordx4 v1, s[4:7], s50 offen offset:3072 sc1 lds
    s_lshr_b32 s48, s47, 1
    s_cmp_eq_u32 s48, s23
    s_cselect_b32 s48, 1, 31
    s_and_b32 s48, s48, s47
    s_add_u32 m0, s30, 55296
    s_lshl_b32 s51, s48, 7
    buffer_load_dwordx4 v8, s[8:11], s51 offen offset:0  lds
    buffer_load_dwordx4 v9, s[8:11], s51 offen offset:1024  lds
    buffer_load_dwordx4 v10, s[8:11], s51 offen offset:2048  lds
    buffer_load_dwordx4 v11, s[8:11], s51 offen offset:3072  lds
    s_branch L_g_jn
L_g_r0:
    s_lshr_b32 s48, s46, 1
    s_cmp_eq_u32 s48, s23
    s_cselect_b32 s48, 1, 31
    s_and_b32 s48, s48, s46
    s_mul_i32 s50, s48, 18432
    s_add_u32 s50, s50, s36
    s_add_u32 m0, s30, 0
    s_mov_b32 s53, s50
    buffer_load_dwordx4 v1, s[4:7], s50 offen offset:0 sc1 lds
    buffer_load_dwordx4 v1, s[4:7], s50 offen offset:1024 sc1 lds
    buffer_load_dwordx4 v1, s[4:7], s50 offen offset:2048 sc1 lds
    buffer_load_dwordx4 v1, s[4:7], s50 offen offset:3072 sc1 lds
    s_lshr_b32 s48, s47, 1
    s_cmp_eq_u32 s48, s23
    s_cselect_b32 s48, 1, 31
    s_and_b32 s48, s48, s47
    s_mul_i32 s50, s48, 18432
    s_add_u32 s50, s50, s36
    s_cmp_ge_u32 s20, 2
    s_cselect_b32 s52, s50, s53
    s_add_u32 m0, s31, 0
    s_add_u32 s52, s52, s49
    buffer_load_dwordx4 v1, s[4:7], s52 offen sc1 lds
    s_add_u32 m0, s30, 36864
    s_mov_b32 s53, s50
    buffer_load_dwordx4 v1, s[4:7], s50 offen offset:0 sc1 lds
    buffer_load_dwordx4 v1, s[4:7], s50 offen offset:1024 sc1 lds
    buffer_load_dwordx4 v1, s[4:7], s50 offen offset:2048 sc1 lds
    buffer_load_dwordx4 v1, s[4:7], s50 offen offset:3072 sc1 lds
    s_lshr_b32 s48, s47, 1
    s_cmp_eq_u32 s48, s23
    s_cselect_b32 s48, 1, 31
    s_and_b32 s48, s48, s47
    s_add_u32 m0, s30, 55296
    s_lshl_b32 s51, s48, 7
    buffer_load_dwordx4 v8, s[8:11], s51 offen offset:0  lds
    buffer_load_dwordx4 v9, s[8:11], s51 offen offset:1024  lds
    buffer_load_dwordx4 v10, s[8:11], s51 offen offset:2048  lds
    buffer_load_dwordx4 v11, s[8:11], s51 offen offset:3072  lds
    s_waitcnt vmcnt(21)
    s_barrier
    s_waitcnt vmcnt(17)
    s_barrier
    s_branch L_g_jn
L_g_r1:
    s_lshr_b32 s48, s46, 1
    s_cmp_eq_u32 s48, s23
    s_cselect_b32 s48, 1, 31
    s_and_b32 s48, s48, s46
    s_mul_i32 s50, s48, 18432
    s_add_u32 s50, s50, s36
    s_add_u32 m0, s30, 0
    s_mov_b32 s53, s50
    buffer_load_dwordx4 v1, s[4:7], s50 offen offset:0 sc1 lds
    buffer_load_dwordx4 v1, s[4:7], s50 offen offset:1024 sc1 lds
    buffer_load_dwordx4 v1, s[4:7], s50 offen offset:2048 sc1 lds
    buffer_load_dwordx4 v1, s[4:7], s50 offen offset:3072 sc1 lds
    s_lshr_b32 s48, s47, 1
    s_cmp_eq_u32 s48, s23
    s_cselect_b32 s48, 1, 31
    s_and_b32 s48, s48, s47
    s_mul_i32 s50, s48, 18432
    s_add_u32 s50, s50, s36
    s_cmp_ge_u32 s20, 2
    s_cselect_b32 s52, s50, s53
    s_add_u32 m0, s31, 0
    s_add_u32 s52, s52, s49
    buffer_load_dwordx4 v1, s[4:7], s52 offen sc1 lds
    s_add_u32 m0, s30, 36864
    s_mov_b32 s53, s50
    buffer_load_dwordx4 v1, s[4:7], s50 offen offset:0 sc1 lds
    buffer_load_dwordx4 v1, s[4:7], s50 offen offset:1024 sc1 lds
    buffer_load_dwordx4 v1, s[4:7], s50 offen offset:2048 sc1 lds
    buffer_load_dwordx4 v1, s[4:7], s50 offen offset:3072 sc1 lds
    s_lshr_b32 s48, s47, 1
    s_cmp_eq_u32 s48, s23
    s_cselect_b32 s48, 1, 31
    s_and_b32 s48, s48, s47
    s_add_u32 m0, s30, 55296
    s_lshl_b32 s51, s48, 7
    buffer_load_dwordx4 v8, s[8:11], s51 offen offset:0  lds
    buffer_load_dwordx4 v9, s[8:11], s51 offen offset:1024  lds
    buffer_load_dwordx4 v10, s[8:11], s51 offen offset:2048  lds
    buffer_load_dwordx4 v11, s[8:11], s51 offen offset:3072  lds
    s_waitcnt vmcnt(17)
    s_barrier
L_g_jn:
    s_add_u32 s44, s44, 4
    s_cmp_ge_u32 s44, 32
    s_cselect_b32 s44, 4, s44
    s_add_u32 s45, s45, 4
    s_cmp_ge_u32 s45, 32
    s_cselect_b32 s45, 5, s45
    s_add_u32 s46, s46, 4
    s_and_b32 s46, s46, 31
    s_add_u32 s47, s47, 4
    s_and_b32 s47, s47, 31
    s_lshr_b32 s48, s44, 1
    s_cmp_eq_u32 s48, s23
    s_cselect_b32 s48, 1, 31
    s_and_b32 s48, s48, s44
    s_mul_i32 s50, s48, 18432
    s_add_u32 s50, s50, s36
    s_add_u32 m0, s30, 73728
    s_mov_b32 s53, s50
    buffer_load_dwordx4 v1, s[4:7], s50 offen offset:0 sc1 lds
    buffer_load_dwordx4 v1, s[4:7], s50 offen offset:1024 sc1 lds
    buffer_load_dwordx4 v1, s[4:7], s50 offen offset:2048 sc1 lds
    buffer_load_dwordx4 v1, s[4:7], s50 offen offset:3072 sc1 lds
    s_lshr_b32 s48, s44, 1
    s_cmp_eq_u32 s48, s23
    s_cselect_b32 s48, 1, 31
    s_and_b32 s48, s48, s44
    s_add_u32 m0, s30, 92160
    s_lshl_b32 s51, s48, 7
    buffer_load_dwordx4 v8, s[8:11], s51 offen offset:0  lds
    buffer_load_dwordx4 v9, s[8:11], s51 offen offset:1024  lds
    buffer_load_dwordx4 v10, s[8:11], s51 offen offset:2048  lds
    buffer_load_dwordx4 v11, s[8:11], s51 offen offset:3072  lds
    s_add_u32 s44, s44, 4
    s_cmp_ge_u32 s44, 32
    s_cselect_b32 s44, 4, s44
    s_waitcnt vmcnt(16)
    s_barrier
    s_lshr_b32 s48, s45, 1
    s_cmp_eq_u32 s48, s23
    s_cselect_b32 s48, 1, 31
    s_and_b32 s48, s48, s45
    s_mul_i32 s50, s48, 18432
    s_add_u32 s50, s50, s36
    s_cmp_ge_u32 s20, 2
    s_cselect_b32 s52, s50, s53
    s_add_u32 m0, s31, 73728
    s_add_u32 s52, s52, s49
    buffer_load_dwordx4 v1, s[4:7], s52 offen sc1 lds
    s_add_u32 m0, s30, 110592
    s_mov_b32 s53, s50
    buffer_load_dwordx4 v1, s[4:7], s50 offen offset:0 sc1 lds
    buffer_load_dwordx4 v1, s[4:7], s50 offen offset:1024 sc1 lds
    buffer_load_dwordx4 v1, s[4:7], s50 offen offset:2048 sc1 lds
    buffer_load_dwordx4 v1, s[4:7], s50 offen offset:3072 sc1 lds
    s_lshr_b32 s48, s45, 1
    s_cmp_eq_u32 s48, s23
    s_cselect_b32 s48, 1, 31
    s_and_b32 s48, s48, s45
    s_add_u32 m0, s30, 129024
    s_lshl_b32 s51, s48, 7
    buffer_load_dwordx4 v8, s[8:11], s51 offen offset:0  lds
    buffer_load_dwordx4 v9, s[8:11], s51 offen offset:1024  lds
    buffer_load_dwordx4 v10, s[8:11], s51 offen offset:2048  lds
    buffer_load_dwordx4 v11, s[8:11], s51 offen offset:3072  lds
    s_add_u32 s45, s45, 4
    s_cmp_ge_u32 s45, 32
    s_cselect_b32 s45, 5, s45
    s_waitcnt vmcnt(17)
    s_barrier
    s_lshr_b32 s48, s46, 1
    s_cmp_eq_u32 s48, s23
    s_cselect_b32 s48, 1, 31
    s_and_b32 s48, s48, s46
    s_mul_i32 s50, s48, 18432
    s_add_u32 s50, s50, s36
    s_add_u32 m0, s30, 0
    s_mov_b32 s53, s50
    buffer_load_dwordx4 v1, s[4:7], s50 offen offset:0 sc1 lds
    buffer_load_dwordx4 v1, s[4:7], s50 offen offset:1024 sc1 lds
    buffer_load_dwordx4 v1, s[4:7], s50 offen offset:2048 sc1 lds
    buffer_load_dwordx4 v1, s[4:7], s50 offen offset:3072 sc1 lds
    s_lshr_b32 s48, s46, 1
    s_cmp_eq_u32 s48, s23
    s_cselect_b32 s48, 1, 31
    s_and_b32 s48, s48, s46
    s_add_u32 m0, s30, 18432
    s_lshl_b32 s51, s48, 7
    buffer_load_dwordx4 v8, s[8:11], s51 offen offset:0  lds
    buffer_load_dwordx4 v9, s[8:11], s51 offen offset:1024  lds
    buffer_load_dwordx4 v10, s[8:11], s51 offen offset:2048  lds
    buffer_load_dwordx4 v11, s[8:11], s51 offen offset:3072  lds
    s_add_u32 s46, s46, 4
    s_and_b32 s46, s46, 31
    s_waitcnt vmcnt(16)
    s_barrier
    s_lshr_b32 s48, s47, 1
    s_cmp_eq_u32 s48, s23
    s_cselect_b32 s48, 1, 31
    s_and_b32 s48, s48, s47
    s_mul_i32 s50, s48, 18432
    s_add_u32 s50, s50, s36
    s_cmp_ge_u32 s20, 2
    s_cselect_b32 s52, s50, s53
    s_add_u32 m0, s31, 0
    s_add_u32 s52, s52, s49
    buffer_load_dwordx4 v1, s[4:7], s52 offen sc1 lds
    s_add_u32 m0, s30, 36864
    s_mov_b32 s53, s50
    buffer_load_dwordx4 v1, s[4:7], s50 offen offset:0 sc1 lds
    buffer_load_dwordx4 v1, s[4:7], s50 offen offset:1024 sc1 lds
    buffer_load_dwordx4 v1, s[4:7], s50 offen offset:2048 sc1 lds
    buffer_load_dwordx4 v1, s[4:7], s50 offen offset:3072 sc1 lds
    s_lshr_b32 s48, s47, 1
    s_cmp_eq_u32 s48, s23
    s_cselect_b32 s48, 1, 31
    s_and_b32 s48, s48, s47
    s_add_u32 m0, s30, 55296
    s_lshl_b32 s51, s48, 7
    buffer_load_dwordx4 v8, s[8:11], s51 offen offset:0  lds
    buffer_load_dwordx4 v9, s[8:11], s51 offen offset:1024  lds
    buffer_load_dwordx4 v10, s[8:11], s51 offen offset:2048  lds
    buffer_load_dwordx4 v11, s[8:11], s51 offen offset:3072  lds
    s_add_u32 s47, s47, 4
    s_and_b32 s47, s47, 31
    s_mov_b32 s41, 6
L_g_ll:
    s_waitcnt vmcnt(17)
    s_barrier
    s_lshr_b32 s48, s44, 1
    s_cmp_eq_u32 s48, s23
    s_cselect_b32 s48, 1, 31
    s_and_b32 s48, s48, s44
    s_mul_i32 s50, s48, 18432
    s_add_u32 s50, s50, s36
    s_add_u32 m0, s30, 73728
    s_mov_b32 s53, s50
    buffer_load_dwordx4 v1, s[4:7], s50 offen offset:0 sc1 lds
    buffer_load_dwordx4 v1, s[4:7], s50 offen offset:1024 sc1 lds
    buffer_load_dwordx4 v1, s[4:7], s50 offen offset:2048 sc1 lds
    buffer_load_dwordx4 v1, s[4:7], s50 offen offset:3072 sc1 lds
    s_lshr_b32 s48, s44, 1
    s_cmp_eq_u32 s48, s23
    s_cselect_b32 s48, 1, 31
    s_and_b32 s48, s48, s44
    s_add_u32 m0, s30, 92160
    s_lshl_b32 s51, s48, 7
    buffer_load_dwordx4 v8, s[8:11], s51 offen offset:0  lds
    buffer_load_dwordx4 v9, s[8:11], s51 offen offset:1024  lds
    buffer_load_dwordx4 v10, s[8:11], s51 offen offset:2048  lds
    buffer_load_dwordx4 v11, s[8:11], s51 offen offset:3072  lds
    s_add_u32 s44, s44, 4
    s_cmp_ge_u32 s44, 32
    s_cselect_b32 s44, 4, s44
    s_waitcnt vmcnt(16)
    s_barrier
    s_lshr_b32 s48, s45, 1
    s_cmp_eq_u32 s48, s23
    s_cselect_b32 s48, 1, 31
    s_and_b32 s48, s48, s45
    s_mul_i32 s50, s48, 18432
    s_add_u32 s50, s50, s36
    s_cmp_ge_u32 s20, 2
    s_cselect_b32 s52, s50, s53
    s_add_u32 m0, s31, 73728
    s_add_u32 s52, s52, s49
    buffer_load_dwordx4 v1, s[4:7], s52 offen sc1 lds
    s_add_u32 m0, s30, 110592
    s_mov_b32 s53, s50
    buffer_load_dwordx4 v1, s[4:7], s50 offen offset:0 sc1 lds
    buffer_load_dwordx4 v1, s[4:7], s50 offen offset:1024 sc1 lds
    buffer_load_dwordx4 v1, s[4:7], s50 offen offset:2048 sc1 lds
    buffer_load_dwordx4 v1, s[4:7], s50 offen offset:3072 sc1 lds
    s_lshr_b32 s48, s45, 1
    s_cmp_eq_u32 s48, s23
    s_cselect_b32 s48, 1, 31
    s_and_b32 s48, s48, s45
    s_add_u32 m0, s30, 129024
    s_lshl_b32 s51, s48, 7
    buffer_load_dwordx4 v8, s[8:11], s51 offen offset:0  lds
    buffer_load_dwordx4 v9, s[8:11], s51 offen offset:1024  lds
    buffer_load_dwordx4 v10, s[8:11], s51 offen offset:2048  lds
    buffer_load_dwordx4 v11, s[8:11], s51 offen offset:3072  lds
    s_add_u32 s45, s45, 4
    s_cmp_ge_u32 s45, 32
    s_cselect_b32 s45, 5, s45
    s_waitcnt vmcnt(17)
    s_barrier
    s_lshr_b32 s48, s46, 1
    s_cmp_eq_u32 s48, s23
    s_cselect_b32 s48, 1, 31
    s_and_b32 s48, s48, s46
    s_mul_i32 s50, s48, 18432
    s_add_u32 s50, s50, s36
    s_add_u32 m0, s30, 0
    s_mov_b32 s53, s50
    buffer_load_dwordx4 v1, s[4:7], s50 offen offset:0 sc1 lds
    buffer_load_dwordx4 v1, s[4:7], s50 offen offset:1024 sc1 lds
    buffer_load_dwordx4 v1, s[4:7], s50 offen offset:2048 sc1 lds
    buffer_load_dwordx4 v1, s[4:7], s50 offen offset:3072 sc1 lds
    s_lshr_b32 s48, s46, 1
    s_cmp_eq_u32 s48, s23
    s_cselect_b32 s48, 1, 31
    s_and_b32 s48, s48, s46
    s_add_u32 m0, s30, 18432
    s_lshl_b32 s51, s48, 7
    buffer_load_dwordx4 v8, s[8:11], s51 offen offset:0  lds
    buffer_load_dwordx4 v9, s[8:11], s51 offen offset:1024  lds
    buffer_load_dwordx4 v10, s[8:11], s51 offen offset:2048  lds
    buffer_load_dwordx4 v11, s[8:11], s51 offen offset:3072  lds
    s_add_u32 s46, s46, 4
    s_and_b32 s46, s46, 31
    s_waitcnt vmcnt(16)
    s_barrier
    s_lshr_b32 s48, s47, 1
    s_cmp_eq_u32 s48, s23
    s_cselect_b32 s48, 1, 31
    s_and_b32 s48, s48, s47
    s_mul_i32 s50, s48, 18432
    s_add_u32 s50, s50, s36
    s_cmp_ge_u32 s20, 2
    s_cselect_b32 s52, s50, s53
    s_add_u32 m0, s31, 0
    s_add_u32 s52, s52, s49
    buffer_load_dwordx4 v1, s[4:7], s52 offen sc1 lds
    s_add_u32 m0, s30, 36864
    s_mov_b32 s53, s50
    buffer_load_dwordx4 v1, s[4:7], s50 offen offset:0 sc1 lds
    buffer_load_dwordx4 v1, s[4:7], s50 offen offset:1024 sc1 lds
    buffer_load_dwordx4 v1, s[4:7], s50 offen offset:2048 sc1 lds
    buffer_load_dwordx4 v1, s[4:7], s50 offen offset:3072 sc1 lds
    s_lshr_b32 s48, s47, 1
    s_cmp_eq_u32 s48, s23
    s_cselect_b32 s48, 1, 31
    s_and_b32 s48, s48, s47
    s_add_u32 m0, s30, 55296
    s_lshl_b32 s51, s48, 7
    buffer_load_dwordx4 v8, s[8:11], s51 offen offset:0  lds
    buffer_load_dwordx4 v9, s[8:11], s51 offen offset:1024  lds
    buffer_load_dwordx4 v10, s[8:11], s51 offen offset:2048  lds
    buffer_load_dwordx4 v11, s[8:11], s51 offen offset:3072  lds
    s_add_u32 s47, s47, 4
    s_and_b32 s47, s47, 31
    s_sub_u32 s41, s41, 1
    s_cmp_lg_u32 s41, 0
    s_cbranch_scc1 L_g_ll
    s_waitcnt vmcnt(17)
    s_barrier
    s_mov_b32 s32, 0
    s_mul_i32 s32, s32, 36864
    s_add_u32 s32, s32, s43
    s_add_u32 m0, s42, 73728
    s_add_u32 s33, s32, 0
    buffer_load_dwordx4 v1, s[4:7], s33 offen offset:0  sc1 lds
    buffer_load_dwordx4 v1, s[4:7], s33 offen offset:1024  sc1 lds
    buffer_load_dwordx4 v1, s[4:7], s33 offen offset:2048  sc1 lds
    buffer_load_dwordx4 v1, s[4:7], s33 offen offset:3072  sc1 lds
    s_add_u32 m0, s42, 77824
    s_add_u32 s33, s32, 4096
    buffer_load_dwordx4 v1, s[4:7], s33 offen offset:0  sc1 lds
    buffer_load_dwordx4 v1, s[4:7], s33 offen offset:1024  sc1 lds
    buffer_load_dwordx4 v1, s[4:7], s33 offen offset:2048  sc1 lds
    buffer_load_dwordx4 v1, s[4:7], s33 offen offset:3072  sc1 lds
    s_add_u32 m0, s42, 81920
    s_add_u32 s33, s32, 8192
    buffer_load_dwordx4 v1, s[4:7], s33 offen offset:0  sc1 lds
    s_waitcnt vmcnt(9)
    s_barrier
    s_mov_b32 s32, 1
    s_mul_i32 s32, s32, 36864
    s_add_u32 s32, s32, s43
    s_add_u32 m0, s42, 110592
    s_add_u32 s33, s32, 0
    buffer_load_dwordx4 v1, s[4:7], s33 offen offset:0  sc1 lds
    buffer_load_dwordx4 v1, s[4:7], s33 offen offset:1024  sc1 lds
    buffer_load_dwordx4 v1, s[4:7], s33 offen offset:2048  sc1 lds
    buffer_load_dwordx4 v1, s[4:7], s33 offen offset:3072  sc1 lds
    s_add_u32 m0, s42, 114688
    s_add_u32 s33, s32, 4096
    buffer_load_dwordx4 v1, s[4:7], s33 offen offset:0  sc1 lds
    buffer_load_dwordx4 v1, s[4:7], s33 offen offset:1024  sc1 lds
    buffer_load_dwordx4 v1, s[4:7], s33 offen offset:2048  sc1 lds
    buffer_load_dwordx4 v1, s[4:7], s33 offen offset:3072  sc1 lds
    s_add_u32 m0, s42, 118784
    s_add_u32 s33, s32, 8192
    buffer_load_dwordx4 v1, s[4:7], s33 offen offset:0  sc1 lds
    s_barrier
    s_mov_b32 s32, 2
    s_mul_i32 s32, s32, 36864
    s_add_u32 s32, s32, s43
    s_add_u32 m0, s42, 0
    s_add_u32 s33, s32, 0
    buffer_load_dwordx4 v1, s[4:7], s33 offen offset:0  sc1 lds
    buffer_load_dwordx4 v1, s[4:7], s33 offen offset:1024  sc1 lds
    buffer_load_dwordx4 v1, s[4:7], s33 offen offset:2048  sc1 lds
    buffer_load_dwordx4 v1, s[4:7], s33 offen offset:3072  sc1 lds
    s_add_u32 m0, s42, 4096
    s_add_u32 s33, s32, 4096
    buffer_load_dwordx4 v1, s[4:7], s33 offen offset:0  sc1 lds
    buffer_load_dwordx4 v1, s[4:7], s33 offen offset:1024  sc1 lds
    buffer_load_dwordx4 v1, s[4:7], s33 offen offset:2048  sc1 lds
    buffer_load_dwordx4 v1, s[4:7], s33 offen offset:3072  sc1 lds
    s_add_u32 m0, s42, 8192
    s_add_u32 s33, s32, 8192
    buffer_load_dwordx4 v1, s[4:7], s33 offen offset:0  sc1 lds
    s_barrier
    s_mov_b32 s32, 3
    s_mul_i32 s32, s32, 36864
    s_add_u32 s32, s32, s43
    s_add_u32 m0, s42, 36864
    s_add_u32 s33, s32, 0
    buffer_load_dwordx4 v1, s[4:7], s33 offen offset:0  sc1 lds
    buffer_load_dwordx4 v1, s[4:7], s33 offen offset:1024  sc1 lds
    buffer_load_dwordx4 v1, s[4:7], s33 offen offset:2048  sc1 lds
    buffer_load_dwordx4 v1, s[4:7], s33 offen offset:3072  sc1 lds
    s_add_u32 m0, s42, 40960
    s_add_u32 s33, s32, 4096
    buffer_load_dwordx4 v1, s[4:7], s33 offen offset:0  sc1 lds
    buffer_load_dwordx4 v1, s[4:7], s33 offen offset:1024  sc1 lds
    buffer_load_dwordx4 v1, s[4:7], s33 offen offset:2048  sc1 lds
    buffer_load_dwordx4 v1, s[4:7], s33 offen offset:3072  sc1 lds
    s_add_u32 m0, s42, 45056
    s_add_u32 s33, s32, 8192
    buffer_load_dwordx4 v1, s[4:7], s33 offen offset:0  sc1 lds
    s_waitcnt vmcnt(27) lgkmcnt(0)
    s_barrier
    v_add_u32 v12, s42, v1
    v_add_u32 v13, 36864, v12
    v_add_u32 v14, 73728, v12
    v_add_u32 v15, 110592, v12
    s_waitcnt vmcnt(18) lgkmcnt(15)
    s_barrier
    ds_write_b128 v14, v[76:79] offset:0
    ds_write_b128 v14, v[80:83] offset:1024
    ds_write_b128 v14, v[84:87] offset:2048
    ds_write_b128 v14, v[88:91] offset:3072
    ds_write_b128 v14, v[92:95] offset:4096
    ds_write_b128 v14, v[96:99] offset:5120
    ds_write_b128 v14, v[100:103] offset:6144
    s_waitcnt vmcnt(9) lgkmcnt(15)
    s_barrier
    ds_write_b128 v14, v[104:107] offset:7168
    ds_write_b128 v14, v[108:111] offset:8192
    ds_write_b128 v15, v[112:115] offset:0
    ds_write_b128 v15, v[116:119] offset:1024
    ds_write_b128 v15, v[120:123] offset:2048
    ds_write_b128 v15, v[124:127] offset:3072
    ds_write_b128 v15, v[128:131] offset:4096
    s_waitcnt vmcnt(0) lgkmcnt(15)
    s_barrier
    ds_write_b128 v15, v[132:135] offset:5120
    ds_write_b128 v15, v[136:139] offset:6144
    ds_write_b128 v15, v[140:143] offset:7168
    ds_write_b128 v15, v[144:147] offset:8192
    ds_write_b128 v12, v[148:151] offset:0
    ds_write_b128 v12, v[152:155] offset:1024
    ds_write_b128 v12, v[156:159] offset:2048
    s_waitcnt vmcnt(63) lgkmcnt(12)
    s_barrier
    ds_write_b128 v12, v[160:163] offset:3072
    ds_write_b128 v12, v[164:167] offset:4096
    ds_write_b128 v12, v[168:171] offset:5120
    ds_write_b128 v12, v[172:175] offset:6144
    ds_write_b128 v12, v[176:179] offset:7168
    ds_write_b128 v12, v[180:183] offset:8192
    s_waitcnt vmcnt(63) lgkmcnt(9)
    s_barrier
    ds_write_b128 v13, v[184:187] offset:0
    ds_write_b128 v13, v[188:191] offset:1024
    ds_write_b128 v13, v[192:195] offset:2048
    ds_write_b128 v13, v[196:199] offset:3072
    ds_write_b128 v13, v[200:203] offset:4096
    ds_write_b128 v13, v[204:207] offset:5120
    s_waitcnt vmcnt(63) lgkmcnt(6)
    s_barrier
    s_and_b32 s25, s2, 7
    s_lshr_b32 s26, s2, 3
    s_lshr_b32 s23, s25, 1
    s_lshl_b32 s23, s23, 2
    s_lshr_b32 s27, s26, 3
    s_add_u32 s23, s23, s27
    s_and_b32 s24, s25, 1
    s_lshl_b32 s24, s24, 3
    s_and_b32 s27, s26, 7
    s_add_u32 s24, s24, s27
    s_mul_i32 s29, s24, 129024
    s_lshl_b32 s30, s20, 12
    s_add_u32 s29, s29, s30
    s_add_u32 s29, s29, 0x3800000
    s_lshl_b32 s31, s23, 3
    s_max_u32 s31, s31, 1
    s_sub_u32 s31, s31, 1
    s_mul_i32 s31, s31, 18432
    s_add_u32 s31, s31, 0x1c00000
    s_lshl_b32 s35, s20, 10
    s_and_b32 s36, s35, 1024
    ds_write_b128 v13, v[208:211] offset:6144
    ds_write_b128 v13, v[212:215] offset:7168
    ds_write_b128 v13, v[216:219] offset:8192
    ds_write_b128 v14, v[220:223] offset:0
    ds_write_b128 v14, v[224:227] offset:1024
    ds_write_b128 v14, v[228:231] offset:2048
    s_waitcnt vmcnt(63) lgkmcnt(3)
    s_barrier
    ds_write_b128 v14, v[232:235] offset:3072
    ds_write_b128 v14, v[236:239] offset:4096
    ds_write_b128 v14, v[240:243] offset:5120
    ds_write_b128 v14, v[244:247] offset:6144
    ds_write_b128 v14, v[248:251] offset:7168
    ds_write_b128 v14, v[252:255] offset:8192
    s_waitcnt vmcnt(63) lgkmcnt(0)
    s_barrier
    s_cmp_eq_u32 s22, 1
    s_cbranch_scc1 L_m_t8
    s_add_u32 m0, s30, 0
    s_add_u32 s34, s29, 0
    buffer_load_dwordx4 v1, s[4:7], s34 offen offset:0 sc1 lds
    buffer_load_dwordx4 v1, s[4:7], s34 offen offset:1024 sc1 lds
    buffer_load_dwordx4 v1, s[4:7], s34 offen offset:2048 sc1 lds
    buffer_load_dwordx4 v1, s[4:7], s34 offen offset:3072 sc1 lds
    s_add_u32 m0, s30, 16384
    s_add_u32 s34, s29, 16384
    buffer_load_dwordx4 v1, s[4:7], s34 offen offset:0 sc1 lds
    buffer_load_dwordx4 v1, s[4:7], s34 offen offset:1024 sc1 lds
    buffer_load_dwordx4 v1, s[4:7], s34 offen offset:2048 sc1 lds
    buffer_load_dwordx4 v1, s[4:7], s34 offen offset:3072 sc1 lds
L_m_t8:
    s_cmp_eq_u32 s22, 1
    s_cbranch_scc1 L_m_lfin
    s_barrier
    s_add_u32 m0, s30, 32768
    s_add_u32 s34, s29, 32768
    buffer_load_dwordx4 v1, s[4:7], s34 offen offset:0 sc1 lds
    buffer_load_dwordx4 v1, s[4:7], s34 offen offset:1024 sc1 lds
    buffer_load_dwordx4 v1, s[4:7], s34 offen offset:2048 sc1 lds
    buffer_load_dwordx4 v1, s[4:7], s34 offen offset:3072 sc1 lds
    s_add_u32 m0, s30, 114688
    s_add_u32 s34, s29, 114688
    buffer_load_dwordx4 v1, s[4:7], s34 offen offset:0 sc1 lds
    buffer_load_dwordx4 v1, s[4:7], s34 offen offset:1024 sc1 lds
    buffer_load_dwordx4 v1, s[4:7], s34 offen offset:2048 sc1 lds
    buffer_load_dwordx4 v1, s[4:7], s34 offen offset:3072 sc1 lds
    s_mov_b32 s22, 1
    s_mov_b32 s21, 0x1c00000
    s_barrier
    s_barrier
    s_add_u32 m0, s30, 49152
    s_add_u32 s34, s29, 49152
    buffer_load_dwordx4 v1, s[4:7], s34 offen offset:0 sc1 lds
    buffer_load_dwordx4 v1, s[4:7], s34 offen offset:1024 sc1 lds
    buffer_load_dwordx4 v1, s[4:7], s34 offen offset:2048 sc1 lds
    buffer_load_dwordx4 v1, s[4:7], s34 offen offset:3072 sc1 lds
    v_lshrrev_b32 v2, 8, v1
    v_bfe_u32 v3, v1, 7, 1
    v_bfe_u32 v4, v1, 4, 3
    v_cmp_gt_u32 vcc, 3, v2
    v_mul_u32_u24 v3, 80, v3
    v_lshl_add_u32 v3, v4, 3, v3
    v_lshrrev_b32 v5, 1, v4
    v_and_b32 v4, 1, v4
    v_lshl_add_u32 v4, v4, 3, 64
    v_cndmask_b32 v2, v5, v2, vcc
    v_cndmask_b32 v3, v4, v3, vcc
    v_mul_u32_u24 v2, 2304, v2
    v_add_u32 v0, v2, v3
    v_lshrrev_b32 v8, 1, v1
    s_mul_i32 s34, s24, 144
    s_add_u32 s34, s34, 0x4400000
    buffer_load_dwordx2 v[2:3], v0, s[4:7], s34 offen sc1
    s_mul_i32 s34, s24, 144
    s_add_u32 s34, s34, 0x4402000
    buffer_load_dwordx2 v[4:5], v0, s[4:7], s34 offen sc1
    s_mul_i32 s34, s24, 144
    s_add_u32 s34, s34, 0x4404000
    buffer_load_dwordx2 v[6:7], v0, s[4:7], s34 offen sc1
    s_mul_i32 s34, s24, 144
    s_add_u32 s34, s34, 0x4406000
    buffer_load_dwordx2 v[12:13], v0, s[4:7], s34 offen sc1
    s_add_u32 m0, s30, 65536
    s_add_u32 s34, s29, 65536
    buffer_load_dwordx4 v1, s[4:7], s34 offen offset:0 sc1 lds
    buffer_load_dwordx4 v1, s[4:7], s34 offen offset:1024 sc1 lds
    buffer_load_dwordx4 v1, s[4:7], s34 offen offset:2048 sc1 lds
    buffer_load_dwordx4 v1, s[4:7], s34 offen offset:3072 sc1 lds
    s_add_u32 m0, s30, 81920
    s_add_u32 s34, s29, 81920
    buffer_load_dwordx4 v1, s[4:7], s34 offen offset:0 sc1 lds
    buffer_load_dwordx4 v1, s[4:7], s34 offen offset:1024 sc1 lds
    buffer_load_dwordx4 v1, s[4:7], s34 offen offset:2048 sc1 lds
    buffer_load_dwordx4 v1, s[4:7], s34 offen offset:3072 sc1 lds
    s_barrier
    s_add_u32 m0, s35, 131072
    s_add_u32 s34, s31, s35
    s_add_u32 s34, s34, 0
    buffer_load_dwordx4 v1, s[4:7], s34 offen sc1 lds
    s_waitcnt vmcnt(29) lgkmcnt(0)
    s_barrier
    s_add_u32 m0, s35, 135168
    s_add_u32 s34, s31, s35
    s_add_u32 s34, s34, 4096
    buffer_load_dwordx4 v1, s[4:7], s34 offen sc1 lds
    s_add_u32 m0, s35, 139264
    s_add_u32 s34, s31, s35
    s_add_u32 s34, s34, 8192
    buffer_load_dwordx4 v1, s[4:7], s34 offen sc1 lds
    s_add_u32 m0, s35, 143360
    s_add_u32 s34, s31, s35
    s_add_u32 s34, s34, 12288
    buffer_load_dwordx4 v1, s[4:7], s34 offen sc1 lds
    s_add_u32 m0, s30, 98304
    s_add_u32 s34, s29, 98304
    buffer_load_dwordx4 v1, s[4:7], s34 offen offset:0 sc1 lds
    buffer_load_dwordx4 v1, s[4:7], s34 offen offset:1024 sc1 lds
    buffer_load_dwordx4 v1, s[4:7], s34 offen offset:2048 sc1 lds
    buffer_load_dwordx4 v1, s[4:7], s34 offen offset:3072 sc1 lds
    s_add_u32 m0, s36, 147456
    s_add_u32 s34, s31, s36
    s_add_u32 s34, s34, 16384
    buffer_load_dwordx4 v1, s[4:7], s34 offen sc1 lds
    s_waitcnt vmcnt(8) lgkmcnt(0)
    s_barrier
    s_waitcnt vmcnt(8) lgkmcnt(0)
    s_barrier
    s_waitcnt vmcnt(7) lgkmcnt(0)
    s_barrier
    v_add_f32 v2, v2, v4
    v_add_f32 v3, v3, v5
    v_add_f32 v6, v6, v12
    v_add_f32 v7, v7, v13
    v_add_f32 v2, v2, v6
    v_add_f32 v3, v3, v7
    v_cmp_gt_u32 vcc, 864, v1
    v_add_u32 v8, 161792, v8
    s_nop 0
    v_cndmask_b32 v2, 0, v2, vcc
    v_cndmask_b32 v3, 0, v3, vcc
    ds_write_b64 v8, v[2:3]
    s_waitcnt vmcnt(6) lgkmcnt(0)
    s_barrier
    s_waitcnt vmcnt(6) lgkmcnt(0)
    s_barrier
    s_waitcnt vmcnt(1) lgkmcnt(0)
    s_barrier
    s_waitcnt vmcnt(0) lgkmcnt(0)
    s_barrier
    s_barrier
    s_branch L_m_ll
L_m_lfin:
L_end_m:
    s_endpgm

.section .rodata,"a"
.p2align 6
.amdhsa_kernel interleave_layers__sliding_local_dilated__mixer_gmlp__prompt_kernel
  .amdhsa_next_free_vgpr 256
  .amdhsa_next_free_sgpr 102
  .amdhsa_accum_offset 256
  .amdhsa_group_segment_fixed_size 0
  .amdhsa_kernarg_size 88
  .amdhsa_user_sgpr_count 2
  .amdhsa_user_sgpr_kernarg_segment_ptr 1
  .amdhsa_system_sgpr_workgroup_id_x 1
  .amdhsa_float_denorm_mode_32 3
.end_amdhsa_kernel
```

```asm
; @launch grid=(256,1,1) block=(512,1,1) lds=163840
.amdgcn_target "amdgcn-amd-amdhsa--gfx950"
.text
.globl interleave_layers__sliding_local_dilated__mixer_gmlp__prompt_kernel
.p2align 8
.type interleave_layers__sliding_local_dilated__mixer_gmlp__prompt_kernel,@function
interleave_layers__sliding_local_dilated__mixer_gmlp__prompt_kernel:
    s_cmp_ge_u32 s2, 256
    s_cbranch_scc1 L_end_m
    s_load_dwordx16 s[36:51], s[0:1], 0
    s_load_dwordx4 s[56:59], s[0:1], 64
    s_load_dwordx2 s[24:25], s[0:1], 80
    s_getpc_b64 s[26:27]
L_m_pc:
    s_sub_u32 s26, s26, L_m_pc-interleave_layers__sliding_local_dilated__mixer_gmlp__prompt_kernel
    s_subb_u32 s27, s27, 0
    v_lshlrev_b32 v4, 4, v0
    v_mov_b32 v5, s27
    v_add_co_u32 v6, vcc, s26, v4
    s_lshr_b32 s28, s2, 3
    s_lshl_b32 s28, s28, 11
    v_addc_co_u32 v7, vcc, 0, v5, vcc
    global_load_dwordx4 v[60:63], v[6:7], off
    v_lshl_add_u32 v4, v0, 2, s28
    v_min_u32 v4, L_end_m-interleave_layers__sliding_local_dilated__mixer_gmlp__prompt_kernel-4, v4
    v_add_co_u32 v6, vcc, s26, v4
    s_nop 1
    v_addc_co_u32 v7, vcc, 0, v5, vcc
    global_load_dword v64, v[6:7], off
    v_lshrrev_b32 v2, 6, v0
    v_and_b32 v1, 63, v0
    v_lshlrev_b32 v1, 4, v1
    v_readfirstlane_b32 s23, v2
    s_mov_b32 s22, 0
    s_mov_b32 s21, 0
    s_and_b32 s20, s23, 3
    s_waitcnt lgkmcnt(0)
    s_mov_b32 s4, s24
    s_mov_b32 s5, s25
    s_mov_b32 s6, 0x10000000
    s_mov_b32 s7, 0x20000
    s_mov_b32 s8, s46
    s_mov_b32 s9, s47
    s_mov_b32 s10, 0x800000
    s_mov_b32 s11, 0x20000
    s_mov_b32 s12, s48
    s_mov_b32 s13, s49
    s_mov_b32 s14, 0x1000
    s_mov_b32 s15, 0x20000
    s_mov_b32 s16, s56
    s_mov_b32 s17, s57
    s_mov_b32 s18, 0x240000
    s_mov_b32 s19, 0x20000
    s_cmp_ge_u32 s23, 4
    s_cbranch_scc1 L_ld_m
    v_mov_b32 v2, 163808
    v_mov_b32 v4, 0
    v_mov_b32 v5, 0
    ds_write2_b64 v2, v[4:5], v[4:5] offset0:0 offset1:1
    s_waitcnt lgkmcnt(0)
    v_bfe_u32 v2, v1, 4, 4
    v_lshrrev_b32 v3, 8, v1
    v_bfrev_b32 v6, 1
    v_mov_b32 v11, 0x3f803f80
    s_lshl_b32 s30, s20, 12
    s_and_b32 s29, s20, 1
    s_cmp_lt_u32 s2, 128
    s_cbranch_scc1 L_p0_x
    s_cmp_lt_u32 s2, 236
    s_cbranch_scc1 L_p0_wq
    s_cmp_lt_u32 s2, 254
    s_cbranch_scc1 L_p0_wo
    s_mov_b32 s46, 0
    s_mov_b32 s27, 0x800000
    s_barrier
    s_barrier
    s_branch L_p0_cd
L_p0_wo:
    s_mul_i32 s30, s20, 9216
    s_sub_u32 s26, s2, 236
    s_mul_i32 s28, s26, 57
    s_lshr_b32 s28, s28, 9
    s_mul_i32 s27, s28, 9
    s_sub_u32 s27, s26, s27
    s_mov_b32 s32, s40
    s_mov_b32 s33, s41
    s_mov_b32 s34, 0xa2000
    s_mov_b32 s35, 0x20000
    s_mul_i32 s29, s28, 331776
    s_lshl_b32 s31, s27, 7
    s_add_u32 s29, s29, s31
    s_mul_i32 s31, s20, 82944
    s_add_u32 s29, s29, s31
    s_mul_i32 s30, s20, 9216
    v_lshrrev_b32 v4, 7, v1
    v_mul_u32_u24 v4, 1152, v4
    v_and_b32 v5, 0x70, v1
    v_add_u32 v4, v4, v5
    s_add_u32 m0, s30, 0
    s_add_u32 s31, s29, 0
    buffer_load_dwordx4 v4, s[32:35], s31 offen  lds
    s_add_u32 m0, s30, 1024
    s_add_u32 s31, s29, 9216
    buffer_load_dwordx4 v4, s[32:35], s31 offen  lds
    s_add_u32 m0, s30, 2048
    s_add_u32 s31, s29, 18432
    buffer_load_dwordx4 v4, s[32:35], s31 offen  lds
    s_add_u32 m0, s30, 3072
    s_add_u32 s31, s29, 27648
    buffer_load_dwordx4 v4, s[32:35], s31 offen  lds
    s_add_u32 m0, s30, 4096
    s_add_u32 s31, s29, 36864
    buffer_load_dwordx4 v4, s[32:35], s31 offen  lds
    s_add_u32 m0, s30, 5120
    s_add_u32 s31, s29, 46080
    buffer_load_dwordx4 v4, s[32:35], s31 offen  lds
    s_add_u32 m0, s30, 6144
    s_add_u32 s31, s29, 55296
    buffer_load_dwordx4 v4, s[32:35], s31 offen  lds
    s_add_u32 m0, s30, 7168
    s_add_u32 s31, s29, 64512
    buffer_load_dwordx4 v4, s[32:35], s31 offen  lds
    s_add_u32 m0, s30, 8192
    s_add_u32 s31, s29, 73728
    buffer_load_dwordx4 v4, s[32:35], s31 offen  lds
    s_barrier
    v_lshrrev_b32 v7, 2, v2
    v_and_b32 v8, 3, v2
    v_bfe_u32 v9, v1, 7, 0
    v_xor_b32 v9, s20, v9
    v_lshlrev_b32 v9, 5, v9
    v_lshl_add_u32 v9, v7, 7, v9
    v_lshl_add_u32 v9, v8, 3, v9
    v_add_u32 v9, 0, v9
    v_mul_u32_u24 v4, 512, v3
    v_add_u32 v4, v4, v9
    v_mul_u32_u24 v5, 9216, v3
    v_add_u32 v5, v5, v9
    s_lshl_b32 s31, s27, 2
    s_add_u32 s31, s31, s20
    v_lshl_add_u32 v7, s31, 2, v7
    v_lshlrev_b32 v8, 4, v8
    v_lshl_add_u32 v8, v3, 8, v8
    v_mul_u32_u24 v9, 57, v7
    v_lshrrev_b32 v9, 10, v9
    v_mul_u32_u24 v10, 18, v9
    v_sub_u32 v10, v7, v10
    v_lshrrev_b32 v12, 3, v10
    v_and_b32 v13, 1, v10
    v_lshl_add_u32 v12, v12, 1, v13
    v_bfe_u32 v14, v10, 1, 2
    v_cmp_gt_u32 vcc, 16, v10
    v_mul_u32_u24 v9, 82944, v9
    v_add_u32 v9, v9, v8
    v_cndmask_b32 v12, 8, v12, vcc
    v_cndmask_b32 v14, v13, v14, vcc
    v_mov_b32 v15, 0x1000
    v_mov_b32 v13, 0x80
    v_cndmask_b32 v15, v13, v15, vcc
    v_lshl_add_u32 v9, v12, 10, v9
    v_lshl_add_u32 v9, v14, 6, v9
    v_add_u32 v10, v9, v15
    s_and_b32 s31, s28, 1
    s_cmp_eq_u32 s31, 1
    s_cselect_b64 vcc, -1, 0
    v_cndmask_b32 v14, v9, v10, vcc
    s_mul_i32 s31, s28, 36864
    s_add_u32 s37, s31, 0x3a00000
    s_add_u32 s38, s31, 0x3a00000
    s_add_u32 s39, s31, 0x3a02400
    s_add_u32 s40, s31, 0x3a02400
    s_add_u32 s41, s31, 0x3a04800
    s_add_u32 s42, s31, 0x3a04800
    s_add_u32 s43, s31, 0x3a06c00
    s_add_u32 s47, s31, 0x3a06c00
    s_lshr_b32 s31, s28, 1
    s_mul_i32 s31, s31, 9216
    s_add_u32 s48, s31, 0x3a12000
    s_cmp_ge_u32 s26, 4
    s_cbranch_scc1 L_p0_n2
    s_lshl_b32 s31, s26, 2
    s_add_u32 s31, s31, s20
    s_lshl_b32 s31, s31, 12
    s_add_u32 s31, s31, 0x4508000
    v_and_b32 v56, 0x380, v1
    v_add_u32 v56, v56, v1
    v_mov_b32 v52, 0
    v_mov_b32 v53, 0
    v_mov_b32 v54, 0
    v_mov_b32 v55, 0
    buffer_store_dwordx4 v[52:55], v56, s[4:7], s31 offen offset:0 sc1
    buffer_store_dwordx4 v[52:55], v56, s[4:7], s31 offen offset:2048 sc1
L_p0_n2:
    s_waitcnt vmcnt(0)
    s_barrier
    ds_read_b64_tr_b16 v[16:17], v4 offset:0
    ds_read_b64_tr_b16 v[18:19], v4 offset:2560
    ds_read_b64_tr_b16 v[20:21], v4 offset:4608
    ds_read_b64_tr_b16 v[22:23], v4 offset:7168
    ds_read_b64_tr_b16 v[24:25], v4 offset:9216
    ds_read_b64_tr_b16 v[26:27], v4 offset:11776
    ds_read_b64_tr_b16 v[28:29], v4 offset:13824
    ds_read_b64_tr_b16 v[30:31], v4 offset:16384
    ds_read_b64_tr_b16 v[32:33], v4 offset:18432
    ds_read_b64_tr_b16 v[34:35], v4 offset:20992
    ds_read_b64_tr_b16 v[36:37], v4 offset:23040
    ds_read_b64_tr_b16 v[38:39], v4 offset:25600
    ds_read_b64_tr_b16 v[40:41], v4 offset:27648
    ds_read_b64_tr_b16 v[42:43], v4 offset:30208
    ds_read_b64_tr_b16 v[44:45], v4 offset:32256
    ds_read_b64_tr_b16 v[46:47], v4 offset:34816
    ds_read_b64_tr_b16 v[48:49], v5 offset:2048
    ds_read_b64_tr_b16 v[50:51], v5 offset:6656
    s_waitcnt lgkmcnt(15)
    s_mov_b32 s31, s37
    buffer_store_dwordx4 v[16:19], v9, s[4:7], s31 offen sc1
    s_waitcnt lgkmcnt(14)
    s_mov_b32 s31, s38
    buffer_store_dwordx4 v[20:23], v10, s[4:7], s31 offen sc1
    s_waitcnt lgkmcnt(12)
    s_mov_b32 s31, s39
    buffer_store_dwordx4 v[24:27], v9, s[4:7], s31 offen sc1
    s_waitcnt lgkmcnt(10)
    s_mov_b32 s31, s40
    buffer_store_dwordx4 v[28:31], v10, s[4:7], s31 offen sc1
    s_waitcnt lgkmcnt(8)
    s_mov_b32 s31, s41
    buffer_store_dwordx4 v[32:35], v9, s[4:7], s31 offen sc1
    s_waitcnt lgkmcnt(6)
    s_mov_b32 s31, s42
    buffer_store_dwordx4 v[36:39], v10, s[4:7], s31 offen sc1
    s_waitcnt lgkmcnt(4)
    s_mov_b32 s31, s43
    buffer_store_dwordx4 v[40:43], v9, s[4:7], s31 offen sc1
    s_waitcnt lgkmcnt(2)
    s_mov_b32 s31, s47
    buffer_store_dwordx4 v[44:47], v10, s[4:7], s31 offen sc1
    s_waitcnt lgkmcnt(0)
    s_mov_b32 s31, s48
    buffer_store_dwordx4 v[48:51], v14, s[4:7], s31 offen sc1
    s_mov_b32 s46, 1
    s_mov_b32 s27, 32
    s_branch L_p0_cd
L_p0_wq:
    s_mov_b32 s32, s38
    s_mov_b32 s33, s39
    s_mov_b32 s34, 0x1e6000
    s_mov_b32 s35, 0x20000
    s_sub_u32 s23, s2, 128
    s_mul_i32 s25, s23, 19
    s_lshr_b32 s25, s25, 9
    s_mul_i32 s24, s25, 27
    s_sub_u32 s24, s23, s24
    s_mul_i32 s26, s25, 497664
    s_lshl_b32 s31, s24, 7
    s_add_u32 s26, s26, s31
    v_lshrrev_b32 v4, 7, v1
    v_mul_u32_u24 v4, 3456, v4
    v_lshrrev_b32 v5, 4, v1
    v_and_b32 v5, 16, v5
    v_xor_b32 v5, v5, v1
    v_and_b32 v5, 0x70, v5
    v_add_u32 v4, v4, v5
    s_mul_i32 s31, s20, 110592
    s_add_u32 s27, s26, s31
    s_mul_i32 s30, s20, 4224
    s_add_u32 m0, s30, 0
    s_add_u32 s31, s27, 0
    buffer_load_dwordx4 v4, s[32:35], s31 offen  lds
    s_add_u32 m0, s30, 1056
    s_add_u32 s31, s27, 27648
    buffer_load_dwordx4 v4, s[32:35], s31 offen  lds
    s_add_u32 m0, s30, 2112
    s_add_u32 s31, s27, 55296
    buffer_load_dwordx4 v4, s[32:35], s31 offen  lds
    s_add_u32 m0, s30, 3168
    s_add_u32 s31, s27, 82944
    buffer_load_dwordx4 v4, s[32:35], s31 offen  lds
    s_cmp_ge_u32 s20, 2
    s_cbranch_scc1 L_p0_q5
    s_mul_i32 s31, s29, 1056
    s_add_u32 m0, s31, 16896
    s_mul_i32 s31, s29, 27648
    s_add_u32 s31, s31, s26
    s_add_u32 s31, s31, 442368
    buffer_load_dwordx4 v4, s[32:35], s31 offen  lds
L_p0_q5:
    s_barrier
    v_lshrrev_b32 v7, 2, v2
    v_and_b32 v8, 3, v2
    s_lshl_b32 s31, s20, 5
    v_and_b32 v9, 2, v7
    v_xor_b32 v9, v9, v3
    v_lshlrev_b32 v9, 3, v9
    v_lshl_add_u32 v9, v7, 7, v9
    v_add_u32 v9, s31, v9
    v_mul_u32_u24 v4, 1056, v8
    v_add_u32 v4, v4, v9
    v_and_b32 v5, 1, v2
    v_mul_u32_u24 v5, 9504, v5
    v_add_u32 v5, v5, v9
    s_lshl_b32 s31, s24, 2
    s_add_u32 s31, s31, s20
    v_lshlrev_b32 v8, 4, v8
    v_lshl_add_u32 v8, v7, 8, v8
    v_lshl_add_u32 v7, s31, 2, v3
    v_mul_u32_u24 v9, 57, v7
    v_lshrrev_b32 v9, 13, v9
    v_mul_u32_u24 v10, 144, v9
    v_sub_u32 v10, v7, v10
    v_mul_u32_u24 v12, 57, v10
    v_lshrrev_b32 v12, 9, v12
    v_mul_u32_u24 v13, 9, v12
    v_sub_u32 v13, v10, v13
    v_cmp_lt_u32 s[36:37], 4, v13
    v_cmp_eq_u32 s[38:39], 4, v13
    v_cmp_eq_u32 s[40:41], 2, v9
    v_lshlrev_b32 v14, 1, v9
    v_add_u32 v15, 1, v14
    v_subrev_u32 v10, 5, v13
    v_cndmask_b32 v14, v14, v15, s[36:37]
    v_cndmask_b32 v13, v13, v10, s[36:37]
    v_cndmask_b32 v14, v14, 6, s[38:39]
    v_cndmask_b32 v13, v13, v9, s[38:39]
    s_and_b64 s[40:41], s[40:41], s[38:39]
    s_mov_b32 s31, 129024
    v_mul_lo_u32 v9, v12, s31
    v_add_u32 v9, v9, v8
    v_lshl_add_u32 v9, v14, 10, v9
    v_lshl_add_u32 v9, v13, 6, v9
    s_and_b32 s31, s25, 1
    v_lshrrev_b32 v8, 3, v2
    v_cmp_eq_u32 vcc, s31, v8
    v_add_u32 v15, 64, v9
    v_cndmask_b32 v15, v6, v15, s[40:41]
    v_cndmask_b32 v8, v6, v9, vcc
    v_lshlrev_b32 v10, 2, v2
    v_lshl_add_u32 v10, v7, 4, v10
    v_cmp_gt_u32 vcc, 4, v2
    s_lshl_b32 s45, s25, 13
    s_add_u32 s45, s45, 0x4400000
    v_cndmask_b32 v10, v6, v10, vcc
    s_mul_i32 s42, s25, 28672
    s_add_u32 s42, s42, 0x3800000
    s_lshr_b32 s44, s25, 1
    s_mul_i32 s44, s44, 7168
    s_add_u32 s44, s44, 0x381c000
    s_mul_i32 s26, s24, 29
    s_lshr_b32 s26, s26, 8
    s_mul_i32 s27, s26, 9
    s_sub_u32 s27, s24, s27
    s_lshl_b32 s27, s27, 4
    s_add_u32 s28, s27, 16
    v_lshrrev_b32 v254, 4, v1
    v_mul_u32_u24 v7, 9, v254
    v_add_u32 v255, 9, v7
    v_min_u32 v255, s28, v255
    v_max_u32 v7, s27, v7
    v_sub_u32 v255, v255, v7
    v_cmp_lt_i32 vcc, 0, v255
    v_lshlrev_b32 v254, 8, v254
    v_mov_b32 v14, 0x3f003f00
    v_cndmask_b32 v254, v6, v254, vcc
    s_cmp_eq_u64 s[40:41], 0
    s_cbranch_scc1 L_p0_np
    v_mov_b32 v52, 0
    v_mov_b32 v53, 0
    v_mov_b32 v54, 0
    v_mov_b32 v55, 0
    s_add_u32 s31, s42, 0
    buffer_store_dwordx4 v[52:55], v15, s[4:7], s31 offen sc1
    s_add_u32 s31, s42, 7168
    buffer_store_dwordx4 v[52:55], v15, s[4:7], s31 offen sc1
    s_add_u32 s31, s42, 14336
    buffer_store_dwordx4 v[52:55], v15, s[4:7], s31 offen sc1
    s_add_u32 s31, s42, 21504
    buffer_store_dwordx4 v[52:55], v15, s[4:7], s31 offen sc1
    s_mov_b32 s31, s44
    buffer_store_dwordx4 v[52:55], v15, s[4:7], s31 offen sc1
    s_waitcnt vmcnt(5)
    s_branch L_p0_n3
L_p0_np:
    s_waitcnt vmcnt(0)
L_p0_n3:
    s_barrier
    ds_read_b64_tr_b16 v[16:17], v4 offset:0
    ds_read_b64_tr_b16 v[18:19], v4 offset:512
    ds_read_b64_tr_b16 v[20:21], v4 offset:4224
    ds_read_b64_tr_b16 v[22:23], v4 offset:4736
    ds_read_b64_tr_b16 v[24:25], v4 offset:9504
    ds_read_b64_tr_b16 v[26:27], v4 offset:10016
    ds_read_b64_tr_b16 v[28:29], v4 offset:13728
    ds_read_b64_tr_b16 v[30:31], v4 offset:14240
    ds_read_b64_tr_b16 v[32:33], v5 offset:8448
    ds_read_b64_tr_b16 v[34:35], v5 offset:8960
    s_waitcnt lgkmcnt(8)
    s_add_u32 s31, s42, 0
    buffer_store_dwordx4 v[16:19], v9, s[4:7], s31 offen sc1
    s_waitcnt lgkmcnt(6)
    s_add_u32 s31, s42, 7168
    buffer_store_dwordx4 v[20:23], v9, s[4:7], s31 offen sc1
    s_waitcnt lgkmcnt(4)
    s_add_u32 s31, s42, 14336
    buffer_store_dwordx4 v[24:27], v9, s[4:7], s31 offen sc1
    s_waitcnt lgkmcnt(2)
    s_add_u32 s31, s42, 21504
    buffer_store_dwordx4 v[28:31], v9, s[4:7], s31 offen sc1
    s_waitcnt lgkmcnt(0)
    s_mov_b32 s31, s44
    buffer_store_dwordx4 v[32:35], v8, s[4:7], s31 offen sc1
    v_dot2_f32_bf16 v12, v16, v11, 0
    v_dot2_f32_bf16 v13, v17, v11, 0
    v_dot2_f32_bf16 v12, v18, v11, v12
    v_dot2_f32_bf16 v13, v19, v11, v13
    v_dot2_f32_bf16 v12, v20, v11, v12
    v_dot2_f32_bf16 v13, v21, v11, v13
    v_dot2_f32_bf16 v12, v22, v11, v12
    v_dot2_f32_bf16 v13, v23, v11, v13
    v_dot2_f32_bf16 v12, v24, v11, v12
    v_dot2_f32_bf16 v13, v25, v11, v13
    v_dot2_f32_bf16 v12, v26, v11, v12
    v_dot2_f32_bf16 v13, v27, v11, v13
    v_dot2_f32_bf16 v12, v28, v11, v12
    v_dot2_f32_bf16 v13, v29, v11, v13
    v_dot2_f32_bf16 v12, v30, v11, v12
    v_dot2_f32_bf16 v13, v31, v11, v13
    v_dot2_f32_bf16 v12, v32, v14, v12
    v_dot2_f32_bf16 v13, v33, v14, v13
    v_dot2_f32_bf16 v12, v34, v14, v12
    v_dot2_f32_bf16 v13, v35, v14, v13
    s_nop 2
    v_add_f32 v12, v12, v13
    s_nop 1
    v_add_f32_dpp v12, v12, v12 row_ror:4 row_mask:0xf bank_mask:0xf
    s_nop 1
    v_add_f32_dpp v12, v12, v12 row_ror:8 row_mask:0xf bank_mask:0xf
    buffer_store_dword v12, v10, s[4:7], s45 offen sc1
    s_branch L_p0_ce
L_p0_x:
    s_mov_b32 s32, s36
    s_mov_b32 s33, s37
    s_mov_b32 s34, 0x240000
    s_mov_b32 s35, 0x20000
    s_mul_i32 s26, s2, 18432
    s_mul_i32 s31, s20, 288
    s_add_u32 s28, s26, s31
    v_lshrrev_b32 v4, 6, v1
    v_mul_u32_u24 v4, 1152, v4
    v_and_b32 v5, 48, v1
    v_add_u32 v4, v4, v5
    s_add_u32 m0, s30, 0
    s_add_u32 s31, s28, 0
    buffer_load_dwordx4 v4, s[32:35], s31 offen  lds
    s_add_u32 m0, s30, 1024
    s_add_u32 s31, s28, 64
    buffer_load_dwordx4 v4, s[32:35], s31 offen  lds
    s_add_u32 m0, s30, 2048
    s_add_u32 s31, s28, 144
    buffer_load_dwordx4 v4, s[32:35], s31 offen  lds
    s_add_u32 m0, s30, 3072
    s_add_u32 s31, s28, 208
    buffer_load_dwordx4 v4, s[32:35], s31 offen  lds
    s_mul_i32 s31, s29, 576
    s_add_u32 s31, s31, s26
    v_mul_u32_u24 v7, 1152, v2
    v_mul_u32_u24 v5, 144, v3
    v_add_u32 v5, v5, v7
    buffer_load_dwordx4 v[32:35], v5, s[32:35], s31 offen offset:128
    s_lshl_b32 s27, s29, 10
    s_add_u32 s27, s27, 16384
    s_barrier
    s_barrier
    v_lshlrev_b32 v4, 6, v2
    v_lshl_add_u32 v4, v3, 4, v4
    v_add_u32 v4, s30, v4
    s_add_u32 s26, s26, 0x0
    s_add_u32 s42, s26, s30
    s_add_u32 s44, s26, s27
    s_lshl_b32 s45, s2, 10
    s_lshl_b32 s31, s20, 8
    s_add_u32 s45, s45, s31
    s_add_u32 s45, s45, 0x1b00000
    v_cmp_gt_u32 vcc, 2, v3
    v_lshrrev_b32 v10, 1, v1
    s_mov_b32 s46, 2
    v_cndmask_b32 v10, v6, v10, vcc
    s_lshr_b32 s27, s2, 3
    s_add_u32 s27, s27, 48
    s_waitcnt vmcnt(0)
    ds_read_b128 v[16:19], v4 offset:0
    ds_read_b128 v[20:23], v4 offset:1024
    ds_read_b128 v[24:27], v4 offset:2048
    ds_read_b128 v[28:31], v4 offset:3072
    s_waitcnt lgkmcnt(3)
    buffer_store_dwordx4 v[16:19], v1, s[4:7], s42 offen offset:0 sc1
    s_waitcnt lgkmcnt(2)
    buffer_store_dwordx4 v[20:23], v1, s[4:7], s42 offen offset:1024 sc1
    s_waitcnt lgkmcnt(1)
    buffer_store_dwordx4 v[24:27], v1, s[4:7], s42 offen offset:2048 sc1
    s_waitcnt lgkmcnt(0)
    buffer_store_dwordx4 v[28:31], v1, s[4:7], s42 offen offset:3072 sc1
    v_dot2_f32_bf16 v12, v16, v11, 0
    v_dot2_f32_bf16 v13, v16, v16, 0
    v_dot2_f32_bf16 v12, v17, v11, v12
    v_dot2_f32_bf16 v13, v17, v17, v13
    v_dot2_f32_bf16 v12, v18, v11, v12
    v_dot2_f32_bf16 v13, v18, v18, v13
    v_dot2_f32_bf16 v12, v19, v11, v12
    v_dot2_f32_bf16 v13, v19, v19, v13
    v_dot2_f32_bf16 v12, v20, v11, v12
    v_dot2_f32_bf16 v13, v20, v20, v13
    v_dot2_f32_bf16 v12, v21, v11, v12
    v_dot2_f32_bf16 v13, v21, v21, v13
    v_dot2_f32_bf16 v12, v22, v11, v12
    v_dot2_f32_bf16 v13, v22, v22, v13
    v_dot2_f32_bf16 v12, v23, v11, v12
    v_dot2_f32_bf16 v13, v23, v23, v13
    v_dot2_f32_bf16 v12, v24, v11, v12
    v_dot2_f32_bf16 v13, v24, v24, v13
    v_dot2_f32_bf16 v12, v25, v11, v12
    v_dot2_f32_bf16 v13, v25, v25, v13
    v_dot2_f32_bf16 v12, v26, v11, v12
    v_dot2_f32_bf16 v13, v26, v26, v13
    v_dot2_f32_bf16 v12, v27, v11, v12
    v_dot2_f32_bf16 v13, v27, v27, v13
    v_dot2_f32_bf16 v12, v28, v11, v12
    v_dot2_f32_bf16 v13, v28, v28, v13
    v_dot2_f32_bf16 v12, v29, v11, v12
    v_dot2_f32_bf16 v13, v29, v29, v13
    v_dot2_f32_bf16 v12, v30, v11, v12
    v_dot2_f32_bf16 v13, v30, v30, v13
    v_dot2_f32_bf16 v12, v31, v11, v12
    v_dot2_f32_bf16 v13, v31, v31, v13
    s_waitcnt lgkmcnt(0)
    s_cmp_ge_u32 s20, 2
    s_cbranch_scc1 L_p0_xs
    buffer_store_dwordx4 v[32:35], v1, s[4:7], s44 offen sc1
    v_dot2_f32_bf16 v12, v32, v11, v12
    v_dot2_f32_bf16 v13, v32, v32, v13
    v_dot2_f32_bf16 v12, v33, v11, v12
    v_dot2_f32_bf16 v13, v33, v33, v13
    v_dot2_f32_bf16 v12, v34, v11, v12
    v_dot2_f32_bf16 v13, v34, v34, v13
    v_dot2_f32_bf16 v12, v35, v11, v12
    v_dot2_f32_bf16 v13, v35, v35, v13
L_p0_xs:
    s_nop 2
    v_mov_b32 v14, v12
    v_mov_b32 v15, v13
    s_nop 1
    v_permlane32_swap_b32 v12, v14
    v_permlane32_swap_b32 v13, v15
    v_add_f32 v12, v12, v14
    v_add_f32 v13, v13, v15
    buffer_store_dwordx2 v[12:13], v10, s[4:7], s45 offen sc1
L_p0_cd:
    v_cmp_eq_u32 vcc, 0, v1
    s_lshl_b32 s27, s27, 8
    v_mov_b32 v255, s46
    v_mov_b32 v254, s27
    v_cndmask_b32 v254, v6, v254, vcc
L_p0_ce:
    s_mov_b32 s48, s58
    s_mov_b32 s49, s59
    s_mov_b32 s50, 0x100
    s_mov_b32 s51, 0x20000
    v_mov_b32 v4, 0
    buffer_load_dword v246, v4, s[48:51], 0 offen sc1
    s_barrier
    s_branch L_m_cl
L_d1_first:
    v_cmp_gt_u32 vcc, 4, v246
    v_mov_b32 v4, 0
    s_mov_b32 s46, 0x4500000
    s_cbranch_vccz L_pd_dbg
    s_mov_b32 s60, 65536
L_poll_dbg:
    buffer_load_dword v5, v4, s[48:51], 0 offen sc1
    s_waitcnt vmcnt(0)
    v_cmp_gt_u32 vcc, 4, v5
    s_sub_u32 s60, s60, 1
    s_cbranch_scc1 L_pd_dbg
    s_cbranch_vccz L_pd_dbg
    s_sleep 4
    s_branch L_poll_dbg
L_pd_dbg:
    buffer_atomic_add v255, v254, s[4:7], s46 offen sc1
    s_branch L_ns_d1
L_ld_m:
    s_cmp_lg_u32 s2, 0
    s_cbranch_scc1 L_p0_nz
    s_lshl_b32 s31, s20, 12
    s_add_u32 s31, s31, 0x4500000
    v_and_b32 v56, 0x380, v1
    v_add_u32 v56, v56, v1
    v_mov_b32 v52, 0
    v_mov_b32 v53, 0
    v_mov_b32 v54, 0
    v_mov_b32 v55, 0
    buffer_store_dwordx4 v[52:55], v56, s[4:7], s31 offen offset:0 sc1
    buffer_store_dwordx4 v[52:55], v56, s[4:7], s31 offen offset:2048 sc1
    s_waitcnt vmcnt(0)
    s_mov_b32 s53, 1
    s_atomic_add s53, s[58:59], 0
L_p0_nz:
    v_bfe_u32 v2, v1, 4, 4
    v_lshrrev_b32 v3, 8, v1
    v_bfrev_b32 v6, 1
    v_mov_b32 v11, 0x3f803f80
    s_mul_i32 s30, s20, 9216
    s_cmp_lt_u32 s2, 144
    s_cbranch_scc1 L_p0_wi
    s_cmp_lt_u32 s2, 216
    s_cbranch_scc1 L_p0_wu
    v_mov_b32 v9, v6
    v_mov_b32 v10, v6
    v_mov_b32 v14, v6
    v_mov_b32 v15, v6
    s_mov_b32 s37, 0
    s_mov_b32 s38, 0
    s_mov_b32 s39, 0
    s_mov_b32 s40, 0
    s_mov_b32 s41, 0
    s_mov_b32 s42, 0
    s_mov_b32 s43, 0
    s_mov_b32 s47, 0
    s_mov_b32 s48, 0
    s_mov_b32 s49, 0
    s_barrier
    s_barrier
    s_barrier
    s_barrier
    s_barrier
    s_branch L_p0_ld
L_p0_wu:
    s_sub_u32 s26, s2, 144
    s_mul_i32 s28, s26, 57
    s_lshr_b32 s28, s28, 9
    s_mul_i32 s27, s28, 9
    s_sub_u32 s27, s26, s27
    s_mov_b32 s32, s50
    s_mov_b32 s33, s51
    s_mov_b32 s34, 0x288000
    s_mov_b32 s35, 0x20000
    s_mul_i32 s29, s28, 331776
    s_lshl_b32 s31, s27, 7
    s_add_u32 s29, s29, s31
    s_mul_i32 s31, s20, 82944
    s_add_u32 s29, s29, s31
    s_mul_i32 s30, s20, 9216
    v_lshrrev_b32 v4, 7, v1
    v_mul_u32_u24 v4, 1152, v4
    v_and_b32 v5, 0x70, v1
    v_bfe_u32 v7, v1, 8, 2
    v_lshlrev_b32 v7, 5, v7
    v_xor_b32 v5, v5, v7
    v_add_u32 v4, v4, v5
    s_barrier
    s_barrier
    s_barrier
    s_barrier
    s_barrier
    s_add_u32 m0, s30, 91904
    s_add_u32 s31, s29, 0
    buffer_load_dwordx4 v4, s[32:35], s31 offen  lds
    s_add_u32 m0, s30, 92928
    s_add_u32 s31, s29, 9216
    buffer_load_dwordx4 v4, s[32:35], s31 offen  lds
    s_add_u32 m0, s30, 93952
    s_add_u32 s31, s29, 18432
    buffer_load_dwordx4 v4, s[32:35], s31 offen  lds
    s_add_u32 m0, s30, 94976
    s_add_u32 s31, s29, 27648
    buffer_load_dwordx4 v4, s[32:35], s31 offen  lds
    s_add_u32 m0, s30, 96000
    s_add_u32 s31, s29, 36864
    buffer_load_dwordx4 v4, s[32:35], s31 offen  lds
    s_add_u32 m0, s30, 97024
    s_add_u32 s31, s29, 46080
    buffer_load_dwordx4 v4, s[32:35], s31 offen  lds
    s_add_u32 m0, s30, 98048
    s_add_u32 s31, s29, 55296
    buffer_load_dwordx4 v4, s[32:35], s31 offen  lds
    s_add_u32 m0, s30, 99072
    s_add_u32 s31, s29, 64512
    buffer_load_dwordx4 v4, s[32:35], s31 offen  lds
    s_add_u32 m0, s30, 100096
    s_add_u32 s31, s29, 73728
    buffer_load_dwordx4 v4, s[32:35], s31 offen  lds
    v_lshrrev_b32 v7, 2, v2
    v_and_b32 v8, 3, v2
    v_bfe_u32 v9, v1, 7, 2
    v_xor_b32 v9, s20, v9
    v_lshlrev_b32 v9, 5, v9
    v_lshl_add_u32 v9, v7, 7, v9
    v_lshl_add_u32 v9, v8, 3, v9
    v_add_u32 v9, 91904, v9
    v_mul_u32_u24 v4, 512, v3
    v_add_u32 v4, v4, v9
    v_mul_u32_u24 v5, 512, v3
    v_add_u32 v5, v5, v9
    s_lshl_b32 s31, s27, 2
    s_add_u32 s31, s31, s20
    v_lshl_add_u32 v7, s31, 2, v7
    v_lshlrev_b32 v8, 4, v8
    v_lshl_add_u32 v8, v3, 8, v8
    v_mul_u32_u24 v9, 57, v7
    v_lshrrev_b32 v9, 10, v9
    v_mul_u32_u24 v10, 18, v9
    v_sub_u32 v10, v7, v10
    v_lshrrev_b32 v12, 3, v10
    v_and_b32 v13, 1, v10
    v_lshl_add_u32 v12, v12, 1, v13
    v_bfe_u32 v14, v10, 1, 2
    v_cmp_gt_u32 vcc, 16, v10
    v_mul_u32_u24 v9, 331776, v9
    v_add_u32 v9, v9, v8
    v_cndmask_b32 v12, 8, v12, vcc
    v_cndmask_b32 v14, v13, v14, vcc
    v_mov_b32 v15, 0x1000
    v_mov_b32 v13, 0x80
    v_cndmask_b32 v15, v13, v15, vcc
    v_lshl_add_u32 v9, v12, 10, v9
    v_lshl_add_u32 v9, v14, 6, v9
    v_add_u32 v10, v9, v15
    s_and_b32 s31, s28, 1
    s_cmp_eq_u32 s31, 1
    s_cselect_b64 vcc, -1, 0
    v_cndmask_b32 v14, v9, v10, vcc
    s_mul_i32 s31, s28, 9216
    s_add_u32 s37, s31, 0x4100000
    s_add_u32 s38, s31, 0x4100000
    s_add_u32 s39, s31, 0x4112000
    s_add_u32 s40, s31, 0x4112000
    s_add_u32 s41, s31, 0x4124000
    s_add_u32 s42, s31, 0x4124000
    s_add_u32 s43, s31, 0x4136000
    s_add_u32 s47, s31, 0x4136000
    s_lshr_b32 s31, s28, 1
    s_mul_i32 s31, s31, 9216
    s_add_u32 s48, s31, 0x4148000
    v_mov_b32 v15, v6
    s_mov_b32 s49, 0
    s_branch L_p0_ld
L_p0_wi:
    s_mov_b32 s26, s2
    s_mul_i32 s28, s26, 57
    s_lshr_b32 s28, s28, 12
    s_mul_i32 s27, s28, 72
    s_sub_u32 s27, s26, s27
    s_mov_b32 s32, s44
    s_mov_b32 s33, s45
    s_mov_b32 s34, 0x510000
    s_mov_b32 s35, 0x20000
    s_mul_i32 s29, s28, 2654208
    s_lshl_b32 s31, s27, 7
    s_add_u32 s29, s29, s31
    s_mul_i32 s31, s20, 663552
    s_add_u32 s29, s29, s31
    s_mul_i32 s30, s20, 9792
    v_lshrrev_b32 v4, 7, v1
    v_mul_u32_u24 v4, 9216, v4
    v_and_b32 v5, 0x70, v1
    v_bfe_u32 v7, v1, 8, 1
    v_lshlrev_b32 v7, 5, v7
    v_xor_b32 v5, v5, v7
    v_add_u32 v4, v4, v5
    s_barrier
    s_barrier
    s_barrier
    s_barrier
    s_barrier
    s_add_u32 m0, s30, 91904
    s_add_u32 s31, s29, 0
    buffer_load_dwordx4 v4, s[32:35], s31 offen  lds
    s_add_u32 m0, s30, 92992
    s_add_u32 s31, s29, 73728
    buffer_load_dwordx4 v4, s[32:35], s31 offen  lds
    s_add_u32 m0, s30, 94080
    s_add_u32 s31, s29, 147456
    buffer_load_dwordx4 v4, s[32:35], s31 offen  lds
    s_add_u32 m0, s30, 95168
    s_add_u32 s31, s29, 221184
    buffer_load_dwordx4 v4, s[32:35], s31 offen  lds
    s_add_u32 m0, s30, 96256
    s_add_u32 s31, s29, 294912
    buffer_load_dwordx4 v4, s[32:35], s31 offen  lds
    s_add_u32 m0, s30, 97344
    s_add_u32 s31, s29, 368640
    buffer_load_dwordx4 v4, s[32:35], s31 offen  lds
    s_add_u32 m0, s30, 98432
    s_add_u32 s31, s29, 442368
    buffer_load_dwordx4 v4, s[32:35], s31 offen  lds
    s_add_u32 m0, s30, 99520
    s_add_u32 s31, s29, 516096
    buffer_load_dwordx4 v4, s[32:35], s31 offen  lds
    s_add_u32 m0, s30, 100608
    s_add_u32 s31, s29, 589824
    buffer_load_dwordx4 v4, s[32:35], s31 offen  lds
    v_lshrrev_b32 v7, 2, v2
    v_and_b32 v8, 3, v2
    v_bfe_u32 v9, v1, 7, 1
    v_xor_b32 v9, s20, v9
    v_lshlrev_b32 v9, 5, v9
    v_lshl_add_u32 v9, v7, 7, v9
    v_lshl_add_u32 v9, v8, 3, v9
    v_add_u32 v9, 91904, v9
    v_mul_u32_u24 v4, 1088, v3
    v_add_u32 v4, v4, v9
    v_mul_u32_u24 v5, 9792, v3
    v_add_u32 v5, v5, v9
    s_lshl_b32 s31, s27, 2
    s_add_u32 s31, s31, s20
    v_lshl_add_u32 v7, s31, 2, v7
    v_lshlrev_b32 v8, 4, v8
    v_lshl_add_u32 v8, v3, 8, v8
    s_cmp_lt_u32 s31, 144
    s_cselect_b32 s23, 1, 0
    s_cselect_b32 s24, 0, 144
    s_sub_u32 s26, s31, s24
    s_mul_i32 s25, s26, 57
    s_lshr_b32 s25, s25, 9
    s_mul_i32 s24, s25, 9
    s_sub_u32 s24, s26, s24
    s_lshl_b32 s26, s25, 1
    s_add_u32 s26, s26, s23
    s_mul_i32 s26, s26, 165888
    s_lshl_b32 s31, s24, 10
    s_add_u32 s26, s26, s31
    s_add_u32 s26, s26, 0x3b00000
    s_mul_i32 s31, s28, 9216
    s_add_u32 s48, s26, s31
    s_add_u32 s48, s48, 147456
    s_lshl_b32 s31, s31, 3
    s_add_u32 s26, s26, s31
    s_add_u32 s37, s26, 0
    s_add_u32 s38, s26, 9216
    s_add_u32 s39, s26, 18432
    s_add_u32 s40, s26, 27648
    s_add_u32 s41, s26, 36864
    s_add_u32 s42, s26, 46080
    s_add_u32 s43, s26, 55296
    s_add_u32 s47, s26, 64512
    s_lshl_b32 s49, s25, 12
    s_mul_i32 s31, s28, 1152
    s_add_u32 s49, s49, s31
    s_mul_i32 s31, s23, 576
    s_add_u32 s49, s49, s31
    s_lshl_b32 s31, s24, 6
    s_add_u32 s49, s49, s31
    s_add_u32 s49, s49, 0x4410000
    v_cmp_eq_u32 vcc, 0, v3
    v_lshlrev_b32 v15, 2, v2
    v_mov_b32 v9, v1
    v_mov_b32 v10, v1
    v_mov_b32 v14, v1
    v_cndmask_b32 v15, v6, v15, vcc
L_p0_ld:
    s_waitcnt lgkmcnt(0)
    s_branch L_m_l1
L_m_cl:
    s_and_b32 s25, s2, 7
    s_lshr_b32 s26, s2, 3
    s_lshr_b32 s23, s25, 1
    s_lshl_b32 s23, s23, 2
    s_lshr_b32 s27, s26, 3
    s_add_u32 s23, s23, s27
    s_and_b32 s24, s25, 1
    s_lshl_b32 s24, s24, 3
    s_and_b32 s27, s26, 7
    s_add_u32 s24, s24, s27
    s_lshl_b32 s30, s23, 3
    s_lshl_b32 s31, s20, 1
    s_add_u32 s31, s30, s31
    s_mul_i32 s29, s31, 18432
    s_add_u32 s29, s29, s21
    s_add_u32 s35, s29, 0x600000
    s_add_u32 s29, s29, 0x0
    s_max_u32 s30, s30, 1
    s_sub_u32 s30, s30, 1
    s_lshl_b32 s30, s30, 10
    s_add_u32 s30, s30, s21
    s_add_u32 s30, s30, 0x1b00000
    s_lshl_b32 s32, s31, 10
    s_add_u32 s32, s32, s21
    s_add_u32 s32, s32, 0x1b00000
    v_bfe_u32 v2, v1, 4, 4
    v_lshrrev_b32 v3, 8, v1
    s_lshl_b32 s33, s20, 2
    s_lshr_b32 s33, 0x3362, s33
    s_and_b32 s33, s33, 15
    s_min_u32 s34, s20, 1
    s_add_u32 s34, s34, 4
    s_lshl_b32 s36, s33, 10
    s_lshl_b32 s37, s34, 10
    v_add_u32 v247, 64512, v1
    v_add_u32 v248, 131072, v1
    v_add_u32 v249, s36, v1
    v_add_u32 v250, s36, v247
    v_add_u32 v251, s37, v1
    v_add_u32 v252, s37, v247
    v_add_u32 v253, 18432, v1
    v_lshrrev_b32 v0, 1, v1
    s_add_u32 s38, s29, 0
    s_add_u32 s39, s29, 4096
    s_add_u32 s40, s29, 8192
    s_add_u32 s41, s29, 12288
    s_add_u32 s42, s29, 16384
    s_max_u32 s44, s23, 1
    s_sub_u32 s44, s44, 1
    s_lshl_b32 s52, s22, 7
    s_add_u32 s52, s52, s23
    s_lshl_b32 s52, s52, 8
    s_add_u32 s52, s52, 0x4503000
    s_add_u32 s52, s52, s4
    s_addc_u32 s53, s5, 0
    s_lshl_b32 s54, s22, 7
    s_add_u32 s54, s54, s44
    s_lshl_b32 s54, s54, 8
    s_add_u32 s54, s54, 0x4503000
    s_add_u32 s54, s54, s4
    s_addc_u32 s55, s5, 0
    s_lshl_b32 s44, s24, 8
    s_add_u32 s44, s44, 0x4500000
    s_add_u32 s44, s44, s4
    s_addc_u32 s45, s5, 0
    s_waitcnt vmcnt(0)
    s_barrier
    s_cmp_lg_u32 s20, 0
    s_cbranch_scc1 L_ns_d1
    s_cmp_eq_u32 s22, 0
    s_cbranch_scc1 L_d1_first
    s_mov_b32 s56, 1
    s_atomic_add s56, s[50:51], 0
L_ns_d1:
    s_barrier
    s_cmp_lg_u32 s20, 0
    s_cbranch_scc1 L_pd_d1
    s_mov_b32 s60, 65536
L_poll_d1:
    s_mov_b32 s57, 0
    s_atomic_add s57, s[52:53], 0 glc
    s_mov_b32 s58, 0
    s_atomic_add s58, s[54:55], 0 glc
    s_mov_b32 s59, 0
    s_atomic_add s59, s[44:45], 0 glc
    s_waitcnt lgkmcnt(0)
    s_cmp_ge_u32 s59, 108
    s_cselect_b32 s59, 16, 0
    s_min_u32 s57, s57, s58
    s_min_u32 s57, s57, s59
    s_cmp_ge_u32 s57, 16
    s_cbranch_scc1 L_pd_d1
    s_sub_u32 s60, s60, 1
    s_cbranch_scc1 L_pd_d1
    s_sleep 2
    s_branch L_poll_d1
L_pd_d1:
    s_barrier
    buffer_load_dwordx4 v[160:163], v1, s[4:7], s38 offen offset:0 sc1
    buffer_load_dwordx4 v[164:167], v253, s[4:7], s38 offen offset:0 sc1
    buffer_load_dwordx4 v[168:171], v1, s[4:7], s38 offen offset:1024 sc1
    buffer_load_dwordx4 v[172:175], v253, s[4:7], s38 offen offset:1024 sc1
    buffer_load_dwordx4 v[176:179], v1, s[4:7], s38 offen offset:2048 sc1
    buffer_load_dwordx4 v[180:183], v253, s[4:7], s38 offen offset:2048 sc1
    buffer_load_dwordx4 v[184:187], v1, s[4:7], s38 offen offset:3072 sc1
    buffer_load_dwordx4 v[188:191], v253, s[4:7], s38 offen offset:3072 sc1
    s_barrier
    ds_read_b128 v[80:83], v1 offset:0
    ds_read_b128 v[84:87], v1 offset:1024
    ds_read_b128 v[88:91], v1 offset:2048
    ds_read_b128 v[92:95], v1 offset:3072
    ds_read_b128 v[96:99], v1 offset:4096
    ds_read_b128 v[100:103], v1 offset:5120
    ds_read_b128 v[104:107], v1 offset:6144
    buffer_load_dwordx2 v[4:5], v0, s[4:7], s30 offen offset:0 sc1
    buffer_load_dwordx2 v[6:7], v0, s[4:7], s30 offen offset:512 sc1
    buffer_load_dwordx2 v[8:9], v0, s[4:7], s32 offen offset:0 sc1
    buffer_load_dwordx2 v[10:11], v0, s[4:7], s32 offen offset:512 sc1
    buffer_load_dwordx2 v[12:13], v0, s[4:7], s32 offen offset:1024 sc1
    buffer_load_dwordx2 v[14:15], v0, s[4:7], s32 offen offset:1536 sc1
    s_lshl_b32 s50, s22, 7
    s_add_u32 s50, s50, s23
    s_lshl_b32 s50, s50, 8
    s_add_u32 s50, s50, 0x4508000
    s_add_u32 s50, s50, s4
    s_addc_u32 s51, s5, 0
    s_waitcnt vmcnt(12) lgkmcnt(3)
    v_mfma_f32_16x16x32_bf16 v[16:19], v[80:83], v[160:163], 0
    ds_read_b128 v[120:123], v1 offset:7168
    v_mfma_f32_16x16x32_bf16 v[44:47], v[80:83], v[164:167], 0
    ds_read_b128 v[124:127], v1 offset:8192
    v_mfma_f32_16x16x32_bf16 v[20:23], v[84:87], v[160:163], 0
    ds_read_b128 v[128:131], v1 offset:9216
    v_mfma_f32_16x16x32_bf16 v[48:51], v[84:87], v[164:167], 0
    ds_read_b128 v[132:135], v1 offset:10240
    v_mfma_f32_16x16x32_bf16 v[24:27], v[88:91], v[160:163], 0
    ds_read_b128 v[136:139], v1 offset:11264
    v_mfma_f32_16x16x32_bf16 v[52:55], v[88:91], v[164:167], 0
    ds_read_b128 v[140:143], v1 offset:12288
    v_mfma_f32_16x16x32_bf16 v[28:31], v[92:95], v[160:163], 0
    ds_read_b128 v[144:147], v1 offset:13312
    v_mfma_f32_16x16x32_bf16 v[56:59], v[92:95], v[164:167], 0
    s_waitcnt lgkmcnt(7)
    v_mfma_f32_16x16x32_bf16 v[32:35], v[160:163], v[96:99], 0
    v_mfma_f32_16x16x32_bf16 v[60:63], v[164:167], v[96:99], 0
    v_mfma_f32_16x16x32_bf16 v[36:39], v[160:163], v[100:103], 0
    buffer_load_dwordx4 v[192:195], v1, s[4:7], s39 offen offset:0 sc1
    v_mfma_f32_16x16x32_bf16 v[64:67], v[164:167], v[100:103], 0
    buffer_load_dwordx4 v[196:199], v253, s[4:7], s39 offen offset:0 sc1
    v_mfma_f32_16x16x32_bf16 v[40:43], v[104:107], v[160:163], 0
    buffer_load_dwordx4 v[200:203], v1, s[4:7], s39 offen offset:1024 sc1
    v_mfma_f32_16x16x32_bf16 v[68:71], v[104:107], v[164:167], 0
    buffer_load_dwordx4 v[204:207], v253, s[4:7], s39 offen offset:1024 sc1
    s_waitcnt vmcnt(14) lgkmcnt(3)
    s_barrier
    v_mfma_f32_16x16x32_bf16 v[16:19], v[120:123], v[168:171], v[16:19]
    ds_read_b128 v[80:83], v1 offset:14336
    v_mfma_f32_16x16x32_bf16 v[44:47], v[120:123], v[172:175], v[44:47]
    ds_read_b128 v[84:87], v1 offset:15360
    v_mfma_f32_16x16x32_bf16 v[20:23], v[124:127], v[168:171], v[20:23]
    ds_read_b128 v[88:91], v1 offset:16384
    v_mfma_f32_16x16x32_bf16 v[48:51], v[124:127], v[172:175], v[48:51]
    ds_read_b128 v[92:95], v1 offset:17408
    v_mfma_f32_16x16x32_bf16 v[24:27], v[128:131], v[168:171], v[24:27]
    ds_read_b128 v[96:99], v1 offset:18432
    v_mfma_f32_16x16x32_bf16 v[52:55], v[128:131], v[172:175], v[52:55]
    ds_read_b128 v[100:103], v1 offset:19456
    v_mfma_f32_16x16x32_bf16 v[28:31], v[132:135], v[168:171], v[28:31]
    ds_read_b128 v[104:107], v1 offset:20480
    v_mfma_f32_16x16x32_bf16 v[56:59], v[132:135], v[172:175], v[56:59]
    ds_read_b128 v[108:111], v248 offset:0
    s_waitcnt lgkmcnt(8)
    v_mfma_f32_16x16x32_bf16 v[32:35], v[168:171], v[136:139], v[32:35]
    ds_read_b128 v[112:115], v249 offset:0
    v_mfma_f32_16x16x32_bf16 v[60:63], v[172:175], v[136:139], v[60:63]
    ds_read_b128 v[116:119], v251 offset:0
    v_mfma_f32_16x16x32_bf16 v[36:39], v[168:171], v[140:143], v[36:39]
    buffer_load_dwordx4 v[160:163], v1, s[4:7], s39 offen offset:2048 sc1
    v_mfma_f32_16x16x32_bf16 v[64:67], v[172:175], v[140:143], v[64:67]
    buffer_load_dwordx4 v[164:167], v253, s[4:7], s39 offen offset:2048 sc1
    v_mfma_f32_16x16x32_bf16 v[40:43], v[144:147], v[168:171], v[40:43]
    v_mfma_f32_16x16x32_bf16 v[68:71], v[144:147], v[172:175], v[68:71]
    s_waitcnt vmcnt(6) lgkmcnt(6)
    v_mfma_f32_16x16x32_bf16 v[16:19], v[80:83], v[176:179], v[16:19]
    ds_read_b128 v[120:123], v1 offset:21504
    v_mfma_f32_16x16x32_bf16 v[44:47], v[80:83], v[180:183], v[44:47]
    ds_read_b128 v[124:127], v1 offset:22528
    v_add_f32 v240, v4, v6
    v_mfma_f32_16x16x32_bf16 v[20:23], v[84:87], v[176:179], v[20:23]
    ds_read_b128 v[128:131], v1 offset:23552
    v_add_f32 v241, v5, v7
    v_mfma_f32_16x16x32_bf16 v[48:51], v[84:87], v[180:183], v[48:51]
    ds_read_b128 v[132:135], v1 offset:24576
    v_add_f32 v242, v8, v10
    v_mfma_f32_16x16x32_bf16 v[24:27], v[88:91], v[176:179], v[24:27]
    ds_read_b128 v[136:139], v1 offset:25600
    v_add_f32 v243, v9, v11
    v_mfma_f32_16x16x32_bf16 v[52:55], v[88:91], v[180:183], v[52:55]
    ds_read_b128 v[140:143], v1 offset:26624
    v_add_f32 v244, v12, v14
    v_mfma_f32_16x16x32_bf16 v[28:31], v[92:95], v[176:179], v[28:31]
    ds_read_b128 v[144:147], v1 offset:27648
    v_add_f32 v245, v13, v15
    v_mfma_f32_16x16x32_bf16 v[56:59], v[92:95], v[180:183], v[56:59]
    ds_read_b128 v[148:151], v248 offset:1024
    s_waitcnt lgkmcnt(8)
    v_mfma_f32_16x16x32_bf16 v[32:35], v[176:179], v[96:99], v[32:35]
    ds_read_b128 v[152:155], v249 offset:7168
    v_mov_b32 v4, v240
    v_mfma_f32_16x16x32_bf16 v[60:63], v[180:183], v[96:99], v[60:63]
    ds_read_b128 v[156:159], v251 offset:7168
    v_mov_b32 v5, v241
    v_mfma_f32_16x16x32_bf16 v[36:39], v[176:179], v[100:103], v[36:39]
    buffer_load_dwordx4 v[168:171], v1, s[4:7], s39 offen offset:3072 sc1
    v_mfma_f32_16x16x32_bf16 v[64:67], v[180:183], v[100:103], v[64:67]
    buffer_load_dwordx4 v[172:175], v253, s[4:7], s39 offen offset:3072 sc1
    v_mfma_f32_16x16x32_bf16 v[40:43], v[104:107], v[176:179], v[40:43]
    v_mov_b32 v8, v242
    v_mfma_f32_16x16x32_bf16 v[68:71], v[104:107], v[180:183], v[68:71]
    v_mov_b32 v9, v243
    v_mfma_f32_16x16x32_bf16 v[72:75], v[112:115], v[108:111], 0
    v_mov_b32 v12, v244
    v_mov_b32 v13, v245
    v_mfma_f32_16x16x32_bf16 v[76:79], v[108:111], v[116:119], 0
    v_permlane32_swap_b32 v240, v4
    s_waitcnt vmcnt(8) lgkmcnt(6)
    s_barrier
    v_mfma_f32_16x16x32_bf16 v[16:19], v[120:123], v[184:187], v[16:19]
    ds_read_b128 v[80:83], v1 offset:28672
    v_mfma_f32_16x16x32_bf16 v[44:47], v[120:123], v[188:191], v[44:47]
    ds_read_b128 v[84:87], v1 offset:29696
    v_permlane32_swap_b32 v241, v5
    v_mfma_f32_16x16x32_bf16 v[20:23], v[124:127], v[184:187], v[20:23]
    ds_read_b128 v[88:91], v1 offset:30720
    v_permlane32_swap_b32 v242, v8
    v_mfma_f32_16x16x32_bf16 v[48:51], v[124:127], v[188:191], v[48:51]
    ds_read_b128 v[92:95], v1 offset:31744
    v_permlane32_swap_b32 v243, v9
    v_mfma_f32_16x16x32_bf16 v[24:27], v[128:131], v[184:187], v[24:27]
    ds_read_b128 v[96:99], v1 offset:32768
    v_permlane32_swap_b32 v244, v12
    v_mfma_f32_16x16x32_bf16 v[52:55], v[128:131], v[188:191], v[52:55]
    ds_read_b128 v[100:103], v1 offset:33792
    v_permlane32_swap_b32 v245, v13
    v_mfma_f32_16x16x32_bf16 v[28:31], v[132:135], v[184:187], v[28:31]
    ds_read_b128 v[104:107], v1 offset:34816
    v_add_f32 v240, v240, v4
    v_mfma_f32_16x16x32_bf16 v[56:59], v[132:135], v[188:191], v[56:59]
    ds_read_b128 v[108:111], v248 offset:2048
    s_waitcnt lgkmcnt(8)
    v_mfma_f32_16x16x32_bf16 v[32:35], v[184:187], v[136:139], v[32:35]
    ds_read_b128 v[112:115], v249 offset:14336
    v_add_f32 v241, v241, v5
    v_mfma_f32_16x16x32_bf16 v[60:63], v[188:191], v[136:139], v[60:63]
    ds_read_b128 v[116:119], v251 offset:14336
    v_add_f32 v242, v242, v8
    v_mfma_f32_16x16x32_bf16 v[36:39], v[184:187], v[140:143], v[36:39]
    buffer_load_dwordx4 v[176:179], v1, s[4:7], s40 offen offset:0 sc1
    v_mfma_f32_16x16x32_bf16 v[64:67], v[188:191], v[140:143], v[64:67]
    buffer_load_dwordx4 v[180:183], v253, s[4:7], s40 offen offset:0 sc1
    v_mfma_f32_16x16x32_bf16 v[40:43], v[144:147], v[184:187], v[40:43]
    v_add_f32 v243, v243, v9
    v_mfma_f32_16x16x32_bf16 v[68:71], v[144:147], v[188:191], v[68:71]
    v_add_f32 v244, v244, v12
    v_mfma_f32_16x16x32_bf16 v[72:75], v[152:155], v[148:151], v[72:75]
    v_add_f32 v245, v245, v13
    v_mov_b32 v4, v240
    v_mfma_f32_16x16x32_bf16 v[76:79], v[148:151], v[156:159], v[76:79]
    v_mov_b32 v5, v241
    s_waitcnt vmcnt(8) lgkmcnt(6)
    v_mfma_f32_16x16x32_bf16 v[16:19], v[80:83], v[192:195], v[16:19]
    ds_read_b128 v[120:123], v1 offset:35840
    v_mfma_f32_16x16x32_bf16 v[44:47], v[80:83], v[196:199], v[44:47]
    ds_read_b128 v[124:127], v1 offset:36864
    v_mov_b32 v8, v242
    v_mfma_f32_16x16x32_bf16 v[20:23], v[84:87], v[192:195], v[20:23]
    ds_read_b128 v[128:131], v1 offset:37888
    v_mov_b32 v9, v243
    v_mfma_f32_16x16x32_bf16 v[48:51], v[84:87], v[196:199], v[48:51]
    ds_read_b128 v[132:135], v1 offset:38912
    v_mov_b32 v12, v244
    v_mfma_f32_16x16x32_bf16 v[24:27], v[88:91], v[192:195], v[24:27]
    ds_read_b128 v[136:139], v1 offset:39936
    v_mov_b32 v13, v245
    v_mfma_f32_16x16x32_bf16 v[52:55], v[88:91], v[196:199], v[52:55]
    ds_read_b128 v[140:143], v1 offset:40960
    v_permlane16_swap_b32 v240, v4
    v_mfma_f32_16x16x32_bf16 v[28:31], v[92:95], v[192:195], v[28:31]
    ds_read_b128 v[144:147], v1 offset:41984
    v_permlane16_swap_b32 v241, v5
    v_mfma_f32_16x16x32_bf16 v[56:59], v[92:95], v[196:199], v[56:59]
    ds_read_b128 v[148:151], v248 offset:3072
    s_waitcnt lgkmcnt(8)
    v_mfma_f32_16x16x32_bf16 v[32:35], v[192:195], v[96:99], v[32:35]
    ds_read_b128 v[152:155], v249 offset:21504
    v_permlane16_swap_b32 v242, v8
    v_mfma_f32_16x16x32_bf16 v[60:63], v[196:199], v[96:99], v[60:63]
    ds_read_b128 v[156:159], v251 offset:21504
    v_permlane16_swap_b32 v243, v9
    v_mfma_f32_16x16x32_bf16 v[36:39], v[192:195], v[100:103], v[36:39]
    buffer_load_dwordx4 v[184:187], v1, s[4:7], s40 offen offset:1024 sc1
    v_mfma_f32_16x16x32_bf16 v[64:67], v[196:199], v[100:103], v[64:67]
    buffer_load_dwordx4 v[188:191], v253, s[4:7], s40 offen offset:1024 sc1
    v_mfma_f32_16x16x32_bf16 v[40:43], v[104:107], v[192:195], v[40:43]
    v_permlane16_swap_b32 v244, v12
    v_mfma_f32_16x16x32_bf16 v[68:71], v[104:107], v[196:199], v[68:71]
    v_permlane16_swap_b32 v245, v13
    v_mfma_f32_16x16x32_bf16 v[72:75], v[112:115], v[108:111], v[72:75]
    v_add_f32 v240, v240, v4
    v_add_f32 v241, v241, v5
    v_mfma_f32_16x16x32_bf16 v[76:79], v[108:111], v[116:119], v[76:79]
    v_add_f32 v242, v242, v8
    s_waitcnt vmcnt(8) lgkmcnt(6)
    s_barrier
    v_mfma_f32_16x16x32_bf16 v[16:19], v[120:123], v[200:203], v[16:19]
    ds_read_b128 v[80:83], v1 offset:43008
    v_mfma_f32_16x16x32_bf16 v[44:47], v[120:123], v[204:207], v[44:47]
    ds_read_b128 v[84:87], v1 offset:44032
    v_add_f32 v243, v243, v9
    v_mfma_f32_16x16x32_bf16 v[20:23], v[124:127], v[200:203], v[20:23]
    ds_read_b128 v[88:91], v1 offset:45056
    v_add_f32 v244, v244, v12
    v_mfma_f32_16x16x32_bf16 v[48:51], v[124:127], v[204:207], v[48:51]
    ds_read_b128 v[92:95], v1 offset:46080
    v_add_f32 v245, v245, v13
    v_mfma_f32_16x16x32_bf16 v[24:27], v[128:131], v[200:203], v[24:27]
    ds_read_b128 v[96:99], v1 offset:47104
    v_mul_f32 v240, 0x3ae38e39, v240
    v_mfma_f32_16x16x32_bf16 v[52:55], v[128:131], v[204:207], v[52:55]
    ds_read_b128 v[100:103], v1 offset:48128
    v_mul_f32 v241, 0x3ae38e39, v241
    v_mfma_f32_16x16x32_bf16 v[28:31], v[132:135], v[200:203], v[28:31]
    ds_read_b128 v[104:107], v1 offset:49152
    v_mul_f32 v242, 0x3ae38e39, v242
    v_mfma_f32_16x16x32_bf16 v[56:59], v[132:135], v[204:207], v[56:59]
    ds_read_b128 v[108:111], v248 offset:4096
    s_waitcnt lgkmcnt(8)
    v_mfma_f32_16x16x32_bf16 v[32:35], v[200:203], v[136:139], v[32:35]
    ds_read_b128 v[112:115], v249 offset:28672
    v_mul_f32 v243, 0x3ae38e39, v243
    v_mfma_f32_16x16x32_bf16 v[60:63], v[204:207], v[136:139], v[60:63]
    ds_read_b128 v[116:119], v251 offset:28672
    v_mul_f32 v244, 0x3ae38e39, v244
    v_mfma_f32_16x16x32_bf16 v[36:39], v[200:203], v[140:143], v[36:39]
    buffer_load_dwordx4 v[192:195], v1, s[4:7], s40 offen offset:2048 sc1
    v_mfma_f32_16x16x32_bf16 v[64:67], v[204:207], v[140:143], v[64:67]
    buffer_load_dwordx4 v[196:199], v253, s[4:7], s40 offen offset:2048 sc1
    v_mfma_f32_16x16x32_bf16 v[40:43], v[144:147], v[200:203], v[40:43]
    v_mul_f32 v245, 0x3ae38e39, v245
    v_mfma_f32_16x16x32_bf16 v[68:71], v[144:147], v[204:207], v[68:71]
    v_fma_f32 v241, -v240, v240, v241
    v_mfma_f32_16x16x32_bf16 v[72:75], v[152:155], v[148:151], v[72:75]
    v_fma_f32 v243, -v242, v242, v243
    v_fma_f32 v245, -v244, v244, v245
    v_mfma_f32_16x16x32_bf16 v[76:79], v[148:151], v[156:159], v[76:79]
    v_max_f32 v241, 0, v241
    s_waitcnt vmcnt(8) lgkmcnt(6)
    v_mfma_f32_16x16x32_bf16 v[16:19], v[80:83], v[160:163], v[16:19]
    ds_read_b128 v[120:123], v1 offset:50176
    v_mfma_f32_16x16x32_bf16 v[44:47], v[80:83], v[164:167], v[44:47]
    ds_read_b128 v[124:127], v1 offset:51200
    v_max_f32 v243, 0, v243
    v_mfma_f32_16x16x32_bf16 v[20:23], v[84:87], v[160:163], v[20:23]
    ds_read_b128 v[128:131], v1 offset:52224
    v_max_f32 v245, 0, v245
    v_mfma_f32_16x16x32_bf16 v[48:51], v[84:87], v[164:167], v[48:51]
    ds_read_b128 v[132:135], v1 offset:53248
    v_add_f32 v241, 0x3727c5ac, v241
    v_mfma_f32_16x16x32_bf16 v[24:27], v[88:91], v[160:163], v[24:27]
    ds_read_b128 v[136:139], v1 offset:54272
    v_add_f32 v243, 0x3727c5ac, v243
    v_mfma_f32_16x16x32_bf16 v[52:55], v[88:91], v[164:167], v[52:55]
    ds_read_b128 v[140:143], v1 offset:55296
    v_add_f32 v245, 0x3727c5ac, v245
    v_mfma_f32_16x16x32_bf16 v[28:31], v[92:95], v[160:163], v[28:31]
    ds_read_b128 v[144:147], v1 offset:56320
    v_rsq_f32 v241, v241
    v_mfma_f32_16x16x32_bf16 v[56:59], v[92:95], v[164:167], v[56:59]
    ds_read_b128 v[148:151], v248 offset:5120
    s_waitcnt lgkmcnt(8)
    v_mfma_f32_16x16x32_bf16 v[32:35], v[160:163], v[96:99], v[32:35]
    ds_read_b128 v[152:155], v249 offset:35840
    v_rsq_f32 v243, v243
    v_mfma_f32_16x16x32_bf16 v[60:63], v[164:167], v[96:99], v[60:63]
    ds_read_b128 v[156:159], v251 offset:35840
    v_rsq_f32 v245, v245
    v_mfma_f32_16x16x32_bf16 v[36:39], v[160:163], v[100:103], v[36:39]
    buffer_load_dwordx4 v[200:203], v1, s[4:7], s40 offen offset:3072 sc1
    v_mfma_f32_16x16x32_bf16 v[64:67], v[164:167], v[100:103], v[64:67]
    buffer_load_dwordx4 v[204:207], v253, s[4:7], s40 offen offset:3072 sc1
    v_mfma_f32_16x16x32_bf16 v[40:43], v[104:107], v[160:163], v[40:43]
    s_nop 0
    v_mfma_f32_16x16x32_bf16 v[68:71], v[104:107], v[164:167], v[68:71]
    v_lshlrev_b32 v255, 4, v3
    v_mfma_f32_16x16x32_bf16 v[72:75], v[112:115], v[108:111], v[72:75]
    v_add_u32 v236, 161792, v255
    s_lshl_b32 s36, s33, 6
    v_mfma_f32_16x16x32_bf16 v[76:79], v[108:111], v[116:119], v[76:79]
    v_add_u32 v237, s36, v236
    s_waitcnt vmcnt(8) lgkmcnt(6)
    v_mfma_f32_16x16x32_bf16 v[16:19], v[120:123], v[168:171], v[16:19]
    ds_read_b128 v[80:83], v1 offset:57344
    v_mfma_f32_16x16x32_bf16 v[44:47], v[120:123], v[172:175], v[44:47]
    ds_read_b128 v[84:87], v1 offset:58368
    v_lshlrev_b32 v254, 2, v2
    v_mfma_f32_16x16x32_bf16 v[20:23], v[124:127], v[168:171], v[20:23]
    ds_read_b128 v[88:91], v1 offset:59392
    v_add_u32 v238, 161792, v254
    v_mfma_f32_16x16x32_bf16 v[48:51], v[124:127], v[172:175], v[48:51]
    ds_read_b128 v[92:95], v1 offset:60416
    s_lshl_b32 s37, s34, 6
    v_mfma_f32_16x16x32_bf16 v[24:27], v[128:131], v[168:171], v[24:27]
    ds_read_b128 v[96:99], v1 offset:61440
    v_add_u32 v239, s37, v238
    v_mfma_f32_16x16x32_bf16 v[52:55], v[128:131], v[172:175], v[52:55]
    ds_read_b128 v[100:103], v1 offset:62464
    s_mul_i32 s36, s20, 3072
    v_mfma_f32_16x16x32_bf16 v[28:31], v[132:135], v[168:171], v[28:31]
    ds_read_b128 v[104:107], v1 offset:63488
    s_add_u32 s36, s36, 153600
    v_mfma_f32_16x16x32_bf16 v[56:59], v[132:135], v[172:175], v[56:59]
    ds_read_b128 v[108:111], v248 offset:6144
    s_waitcnt lgkmcnt(8)
    v_mfma_f32_16x16x32_bf16 v[32:35], v[168:171], v[136:139], v[32:35]
    ds_read_b128 v[112:115], v249 offset:43008
    v_add_u32 v254, s36, v254
    v_mfma_f32_16x16x32_bf16 v[60:63], v[172:175], v[136:139], v[60:63]
    ds_read_b128 v[116:119], v251 offset:43008
    v_add_u32 v255, s36, v255
    v_mfma_f32_16x16x32_bf16 v[36:39], v[168:171], v[140:143], v[36:39]
    buffer_load_dwordx4 v[160:163], v1, s[4:7], s41 offen offset:0 sc1
    v_mfma_f32_16x16x32_bf16 v[64:67], v[172:175], v[140:143], v[64:67]
    buffer_load_dwordx4 v[164:167], v253, s[4:7], s41 offen offset:0 sc1
    v_mfma_f32_16x16x32_bf16 v[40:43], v[144:147], v[168:171], v[40:43]
    v_mfma_f32_16x16x32_bf16 v[68:71], v[144:147], v[172:175], v[68:71]
    ds_write2_b32 v254, v240, v241 offset0:0 offset1:16
    v_mfma_f32_16x16x32_bf16 v[72:75], v[152:155], v[148:151], v[72:75]
    ds_write2_b32 v254, v242, v243 offset0:32 offset1:48
    v_mfma_f32_16x16x32_bf16 v[76:79], v[148:151], v[156:159], v[76:79]
    ds_write2_b32 v254, v244, v245 offset0:64 offset1:80
    s_waitcnt vmcnt(8) lgkmcnt(9)
    s_barrier
    v_mfma_f32_16x16x32_bf16 v[16:19], v[80:83], v[176:179], v[16:19]
    ds_read_b128 v[120:123], v247 offset:0
    v_mfma_f32_16x16x32_bf16 v[44:47], v[80:83], v[180:183], v[44:47]
    ds_read_b128 v[124:127], v247 offset:1024
    v_mfma_f32_16x16x32_bf16 v[20:23], v[84:87], v[176:179], v[20:23]
    ds_read_b128 v[128:131], v247 offset:2048
    v_mfma_f32_16x16x32_bf16 v[48:51], v[84:87], v[180:183], v[48:51]
    ds_read_b128 v[132:135], v247 offset:3072
    v_mfma_f32_16x16x32_bf16 v[24:27], v[88:91], v[176:179], v[24:27]
    ds_read_b128 v[136:139], v247 offset:4096
    v_mfma_f32_16x16x32_bf16 v[52:55], v[88:91], v[180:183], v[52:55]
    ds_read_b128 v[140:143], v247 offset:5120
    v_mfma_f32_16x16x32_bf16 v[28:31], v[92:95], v[176:179], v[28:31]
    ds_read_b128 v[144:147], v247 offset:6144
    v_mfma_f32_16x16x32_bf16 v[56:59], v[92:95], v[180:183], v[56:59]
    ds_read_b128 v[148:151], v248 offset:7168
    s_waitcnt lgkmcnt(8)
    v_mfma_f32_16x16x32_bf16 v[32:35], v[176:179], v[96:99], v[32:35]
    ds_read_b128 v[152:155], v249 offset:50176
    v_mfma_f32_16x16x32_bf16 v[60:63], v[180:183], v[96:99], v[60:63]
    ds_read_b128 v[156:159], v251 offset:50176
    v_mfma_f32_16x16x32_bf16 v[36:39], v[176:179], v[100:103], v[36:39]
    buffer_load_dwordx4 v[168:171], v1, s[4:7], s41 offen offset:1024 sc1
    ds_read_b128 v[208:211], v236 offset:0
    v_mfma_f32_16x16x32_bf16 v[64:67], v[180:183], v[100:103], v[64:67]
    buffer_load_dwordx4 v[172:175], v253, s[4:7], s41 offen offset:1024 sc1
    ds_read_b128 v[212:215], v236 offset:64
    v_mfma_f32_16x16x32_bf16 v[40:43], v[104:107], v[176:179], v[40:43]
    ds_read_b128 v[216:219], v236 offset:128
    v_mfma_f32_16x16x32_bf16 v[68:71], v[104:107], v[180:183], v[68:71]
    ds_read_b128 v[220:223], v236 offset:192
    v_mfma_f32_16x16x32_bf16 v[72:75], v[112:115], v[108:111], v[72:75]
    ds_read_b128 v[224:227], v236 offset:384
    v_mfma_f32_16x16x32_bf16 v[76:79], v[108:111], v[116:119], v[76:79]
    ds_read_b128 v[228:231], v237
    s_waitcnt vmcnt(8) lgkmcnt(12)
    v_mfma_f32_16x16x32_bf16 v[16:19], v[120:123], v[184:187], v[16:19]
    ds_read_b128 v[80:83], v247 offset:7168
    v_mfma_f32_16x16x32_bf16 v[44:47], v[120:123], v[188:191], v[44:47]
    ds_read_b128 v[84:87], v247 offset:8192
    v_mfma_f32_16x16x32_bf16 v[20:23], v[124:127], v[184:187], v[20:23]
    ds_read_b128 v[88:91], v247 offset:9216
    v_mfma_f32_16x16x32_bf16 v[48:51], v[124:127], v[188:191], v[48:51]
    ds_read_b128 v[92:95], v247 offset:10240
    v_mfma_f32_16x16x32_bf16 v[24:27], v[128:131], v[184:187], v[24:27]
    ds_read_b128 v[96:99], v247 offset:11264
    v_mfma_f32_16x16x32_bf16 v[52:55], v[128:131], v[188:191], v[52:55]
    ds_read_b128 v[100:103], v247 offset:12288
    v_mfma_f32_16x16x32_bf16 v[28:31], v[132:135], v[184:187], v[28:31]
    ds_read_b128 v[104:107], v247 offset:13312
    v_mfma_f32_16x16x32_bf16 v[56:59], v[132:135], v[188:191], v[56:59]
    ds_read_b128 v[108:111], v248 offset:8192
    s_waitcnt lgkmcnt(8)
    v_mfma_f32_16x16x32_bf16 v[32:35], v[184:187], v[136:139], v[32:35]
    ds_read_b128 v[112:115], v249 offset:57344
    v_mfma_f32_16x16x32_bf16 v[60:63], v[188:191], v[136:139], v[60:63]
    ds_read_b128 v[116:119], v251 offset:57344
    v_mfma_f32_16x16x32_bf16 v[36:39], v[184:187], v[140:143], v[36:39]
    buffer_load_dwordx4 v[176:179], v1, s[4:7], s41 offen offset:2048 sc1
    v_mfma_f32_16x16x32_bf16 v[64:67], v[188:191], v[140:143], v[64:67]
    buffer_load_dwordx4 v[180:183], v253, s[4:7], s41 offen offset:2048 sc1
    ds_read2_b32 v[232:233], v238 offset0:64 offset1:80
    v_mfma_f32_16x16x32_bf16 v[40:43], v[144:147], v[184:187], v[40:43]
    ds_read_b32 v234, v239
    v_mfma_f32_16x16x32_bf16 v[68:71], v[144:147], v[188:191], v[68:71]
    ds_read_b128 v[4:7], v255 offset:0
    v_mfma_f32_16x16x32_bf16 v[72:75], v[152:155], v[148:151], v[72:75]
    ds_read_b128 v[8:11], v255 offset:128
    v_mfma_f32_16x16x32_bf16 v[76:79], v[148:151], v[156:159], v[76:79]
    ds_read_b128 v[12:15], v255 offset:256
    s_waitcnt vmcnt(8) lgkmcnt(11)
    s_barrier
    v_mfma_f32_16x16x32_bf16 v[16:19], v[80:83], v[192:195], v[16:19]
    ds_read_b128 v[120:123], v247 offset:14336
    v_mfma_f32_16x16x32_bf16 v[44:47], v[80:83], v[196:199], v[44:47]
    ds_read_b128 v[124:127], v247 offset:15360
    v_mfma_f32_16x16x32_bf16 v[20:23], v[84:87], v[192:195], v[20:23]
    ds_read_b128 v[128:131], v247 offset:16384
    v_mfma_f32_16x16x32_bf16 v[48:51], v[84:87], v[196:199], v[48:51]
    ds_read_b128 v[132:135], v247 offset:17408
    v_mfma_f32_16x16x32_bf16 v[24:27], v[88:91], v[192:195], v[24:27]
    ds_read_b128 v[136:139], v247 offset:18432
    v_mfma_f32_16x16x32_bf16 v[52:55], v[88:91], v[196:199], v[52:55]
    ds_read_b128 v[140:143], v247 offset:19456
    v_mfma_f32_16x16x32_bf16 v[28:31], v[92:95], v[192:195], v[28:31]
    ds_read_b128 v[144:147], v247 offset:20480
    v_mfma_f32_16x16x32_bf16 v[56:59], v[92:95], v[196:199], v[56:59]
    ds_read_b128 v[148:151], v248 offset:9216
    s_waitcnt lgkmcnt(8)
    v_mfma_f32_16x16x32_bf16 v[32:35], v[192:195], v[96:99], v[32:35]
    ds_read_b128 v[152:155], v250 offset:0
    v_mfma_f32_16x16x32_bf16 v[60:63], v[196:199], v[96:99], v[60:63]
    ds_read_b128 v[156:159], v252 offset:0
    v_mfma_f32_16x16x32_bf16 v[36:39], v[192:195], v[100:103], v[36:39]
    buffer_load_dwordx4 v[184:187], v1, s[4:7], s41 offen offset:3072 sc1
    v_mfma_f32_16x16x32_bf16 v[64:67], v[196:199], v[100:103], v[64:67]
    buffer_load_dwordx4 v[188:191], v253, s[4:7], s41 offen offset:3072 sc1
    v_mfma_f32_16x16x32_bf16 v[40:43], v[104:107], v[192:195], v[40:43]
    v_mfma_f32_16x16x32_bf16 v[68:71], v[104:107], v[196:199], v[68:71]
    v_mfma_f32_16x16x32_bf16 v[72:75], v[112:115], v[108:111], v[72:75]
    v_mfma_f32_16x16x32_bf16 v[76:79], v[108:111], v[116:119], v[76:79]
    s_waitcnt vmcnt(8) lgkmcnt(6)
    v_mfma_f32_16x16x32_bf16 v[16:19], v[120:123], v[200:203], v[16:19]
    ds_read_b128 v[80:83], v247 offset:21504
    v_fma_f32 v32, -v8, v232, v32
    v_mfma_f32_16x16x32_bf16 v[44:47], v[120:123], v[204:207], v[44:47]
    ds_read_b128 v[84:87], v247 offset:22528
    v_fma_f32 v60, -v12, v232, v60
    v_mfma_f32_16x16x32_bf16 v[20:23], v[124:127], v[200:203], v[20:23]
    ds_read_b128 v[88:91], v247 offset:23552
    v_fma_f32 v36, -v8, v233, v36
    v_mfma_f32_16x16x32_bf16 v[48:51], v[124:127], v[204:207], v[48:51]
    ds_read_b128 v[92:95], v247 offset:24576
    v_fma_f32 v64, -v12, v233, v64
    v_mfma_f32_16x16x32_bf16 v[24:27], v[128:131], v[200:203], v[24:27]
    ds_read_b128 v[96:99], v247 offset:25600
    v_fma_f32 v40, -v242, v224, v40
    v_mfma_f32_16x16x32_bf16 v[52:55], v[128:131], v[204:207], v[52:55]
    ds_read_b128 v[100:103], v247 offset:26624
    v_fma_f32 v68, -v244, v224, v68
    v_mfma_f32_16x16x32_bf16 v[28:31], v[132:135], v[200:203], v[28:31]
    ds_read_b128 v[104:107], v247 offset:27648
    v_fma_f32 v72, -v240, v228, v72
    v_mfma_f32_16x16x32_bf16 v[56:59], v[132:135], v[204:207], v[56:59]
    ds_read_b128 v[108:111], v248 offset:10240
    s_waitcnt lgkmcnt(8)
    v_fma_f32 v76, -v4, v234, v76
    v_mfma_f32_16x16x32_bf16 v[32:35], v[200:203], v[136:139], v[32:35]
    ds_read_b128 v[112:115], v250 offset:7168
    v_fma_f32 v16, -v242, v208, v16
    v_mfma_f32_16x16x32_bf16 v[60:63], v[204:207], v[136:139], v[60:63]
    ds_read_b128 v[116:119], v252 offset:7168
    v_fma_f32 v44, -v244, v208, v44
    v_mfma_f32_16x16x32_bf16 v[36:39], v[200:203], v[140:143], v[36:39]
    buffer_load_dwordx4 v[192:195], v1, s[4:7], s42 offen offset:0 sc1
    v_fma_f32 v20, -v242, v212, v20
    v_mfma_f32_16x16x32_bf16 v[64:67], v[204:207], v[140:143], v[64:67]
    buffer_load_dwordx4 v[196:199], v253, s[4:7], s42 offen offset:0 sc1
    v_fma_f32 v48, -v244, v212, v48
    v_mfma_f32_16x16x32_bf16 v[40:43], v[144:147], v[200:203], v[40:43]
    v_fma_f32 v24, -v242, v216, v24
    v_mfma_f32_16x16x32_bf16 v[68:71], v[144:147], v[204:207], v[68:71]
    v_fma_f32 v52, -v244, v216, v52
    v_mfma_f32_16x16x32_bf16 v[72:75], v[152:155], v[148:151], v[72:75]
    v_fma_f32 v28, -v242, v220, v28
    v_mfma_f32_16x16x32_bf16 v[76:79], v[148:151], v[156:159], v[76:79]
    v_fma_f32 v56, -v244, v220, v56
    s_waitcnt vmcnt(8) lgkmcnt(6)
    s_barrier
    v_mfma_f32_16x16x32_bf16 v[16:19], v[80:83], v[160:163], v[16:19]
    ds_read_b128 v[120:123], v247 offset:28672
    v_fma_f32 v33, -v9, v232, v33
    v_mfma_f32_16x16x32_bf16 v[44:47], v[80:83], v[164:167], v[44:47]
    ds_read_b128 v[124:127], v247 offset:29696
    v_fma_f32 v61, -v13, v232, v61
    v_mfma_f32_16x16x32_bf16 v[20:23], v[84:87], v[160:163], v[20:23]
    ds_read_b128 v[128:131], v247 offset:30720
    v_fma_f32 v37, -v9, v233, v37
    v_mfma_f32_16x16x32_bf16 v[48:51], v[84:87], v[164:167], v[48:51]
    ds_read_b128 v[132:135], v247 offset:31744
    v_fma_f32 v65, -v13, v233, v65
    v_mfma_f32_16x16x32_bf16 v[24:27], v[88:91], v[160:163], v[24:27]
    ds_read_b128 v[136:139], v247 offset:32768
    v_fma_f32 v41, -v242, v225, v41
    v_mfma_f32_16x16x32_bf16 v[52:55], v[88:91], v[164:167], v[52:55]
    ds_read_b128 v[140:143], v247 offset:33792
    v_fma_f32 v69, -v244, v225, v69
    v_mfma_f32_16x16x32_bf16 v[28:31], v[92:95], v[160:163], v[28:31]
    ds_read_b128 v[144:147], v247 offset:34816
    v_fma_f32 v73, -v240, v229, v73
    v_mfma_f32_16x16x32_bf16 v[56:59], v[92:95], v[164:167], v[56:59]
    ds_read_b128 v[148:151], v248 offset:11264
    s_waitcnt lgkmcnt(8)
    v_fma_f32 v77, -v5, v234, v77
    v_mfma_f32_16x16x32_bf16 v[32:35], v[160:163], v[96:99], v[32:35]
    ds_read_b128 v[152:155], v250 offset:14336
    v_fma_f32 v17, -v242, v209, v17
    v_mfma_f32_16x16x32_bf16 v[60:63], v[164:167], v[96:99], v[60:63]
    ds_read_b128 v[156:159], v252 offset:14336
    v_fma_f32 v45, -v244, v209, v45
    v_mfma_f32_16x16x32_bf16 v[36:39], v[160:163], v[100:103], v[36:39]
    buffer_load_dwordx4 v[200:203], v1, s[4:7], s42 offen offset:1024 sc1
    v_fma_f32 v21, -v242, v213, v21
    v_mfma_f32_16x16x32_bf16 v[64:67], v[164:167], v[100:103], v[64:67]
    buffer_load_dwordx4 v[204:207], v253, s[4:7], s42 offen offset:1024 sc1
    v_fma_f32 v49, -v244, v213, v49
    v_mfma_f32_16x16x32_bf16 v[40:43], v[104:107], v[160:163], v[40:43]
    v_fma_f32 v25, -v242, v217, v25
    v_mfma_f32_16x16x32_bf16 v[68:71], v[104:107], v[164:167], v[68:71]
    v_fma_f32 v53, -v244, v217, v53
    v_mfma_f32_16x16x32_bf16 v[72:75], v[112:115], v[108:111], v[72:75]
    v_fma_f32 v29, -v242, v221, v29
    v_mfma_f32_16x16x32_bf16 v[76:79], v[108:111], v[116:119], v[76:79]
    v_fma_f32 v57, -v244, v221, v57
    s_waitcnt vmcnt(8) lgkmcnt(6)
    v_mfma_f32_16x16x32_bf16 v[16:19], v[120:123], v[168:171], v[16:19]
    ds_read_b128 v[80:83], v247 offset:35840
    v_fma_f32 v34, -v10, v232, v34
    v_mfma_f32_16x16x32_bf16 v[44:47], v[120:123], v[172:175], v[44:47]
    ds_read_b128 v[84:87], v247 offset:36864
    v_fma_f32 v62, -v14, v232, v62
    v_mfma_f32_16x16x32_bf16 v[20:23], v[124:127], v[168:171], v[20:23]
    ds_read_b128 v[88:91], v247 offset:37888
    v_fma_f32 v38, -v10, v233, v38
    v_mfma_f32_16x16x32_bf16 v[48:51], v[124:127], v[172:175], v[48:51]
    ds_read_b128 v[92:95], v247 offset:38912
    v_fma_f32 v66, -v14, v233, v66
    v_mfma_f32_16x16x32_bf16 v[24:27], v[128:131], v[168:171], v[24:27]
    ds_read_b128 v[96:99], v247 offset:39936
    v_fma_f32 v42, -v242, v226, v42
    v_mfma_f32_16x16x32_bf16 v[52:55], v[128:131], v[172:175], v[52:55]
    ds_read_b128 v[100:103], v247 offset:40960
    v_fma_f32 v70, -v244, v226, v70
    v_mfma_f32_16x16x32_bf16 v[28:31], v[132:135], v[168:171], v[28:31]
    ds_read_b128 v[104:107], v247 offset:41984
    v_fma_f32 v74, -v240, v230, v74
    v_mfma_f32_16x16x32_bf16 v[56:59], v[132:135], v[172:175], v[56:59]
    ds_read_b128 v[108:111], v248 offset:12288
    s_waitcnt lgkmcnt(8)
    v_fma_f32 v78, -v6, v234, v78
    v_mfma_f32_16x16x32_bf16 v[32:35], v[168:171], v[136:139], v[32:35]
    ds_read_b128 v[112:115], v250 offset:21504
    v_fma_f32 v18, -v242, v210, v18
    v_mfma_f32_16x16x32_bf16 v[60:63], v[172:175], v[136:139], v[60:63]
    ds_read_b128 v[116:119], v252 offset:21504
    v_fma_f32 v46, -v244, v210, v46
    v_mfma_f32_16x16x32_bf16 v[36:39], v[168:171], v[140:143], v[36:39]
    v_fma_f32 v22, -v242, v214, v22
    v_mfma_f32_16x16x32_bf16 v[64:67], v[172:175], v[140:143], v[64:67]
    v_fma_f32 v50, -v244, v214, v50
    v_mfma_f32_16x16x32_bf16 v[40:43], v[144:147], v[168:171], v[40:43]
    v_fma_f32 v26, -v242, v218, v26
    v_mfma_f32_16x16x32_bf16 v[68:71], v[144:147], v[172:175], v[68:71]
    v_fma_f32 v54, -v244, v218, v54
    v_mfma_f32_16x16x32_bf16 v[72:75], v[152:155], v[148:151], v[72:75]
    v_fma_f32 v30, -v242, v222, v30
    v_mfma_f32_16x16x32_bf16 v[76:79], v[148:151], v[156:159], v[76:79]
    v_fma_f32 v58, -v244, v222, v58
    s_waitcnt vmcnt(6) lgkmcnt(6)
    v_mfma_f32_16x16x32_bf16 v[16:19], v[80:83], v[176:179], v[16:19]
    ds_read_b128 v[120:123], v247 offset:43008
    v_fma_f32 v35, -v11, v232, v35
    v_mfma_f32_16x16x32_bf16 v[44:47], v[80:83], v[180:183], v[44:47]
    ds_read_b128 v[124:127], v247 offset:44032
    v_fma_f32 v63, -v15, v232, v63
    v_mfma_f32_16x16x32_bf16 v[20:23], v[84:87], v[176:179], v[20:23]
    ds_read_b128 v[128:131], v247 offset:45056
    v_fma_f32 v39, -v11, v233, v39
    v_mfma_f32_16x16x32_bf16 v[48:51], v[84:87], v[180:183], v[48:51]
    ds_read_b128 v[132:135], v247 offset:46080
    v_fma_f32 v67, -v15, v233, v67
    v_mfma_f32_16x16x32_bf16 v[24:27], v[88:91], v[176:179], v[24:27]
    ds_read_b128 v[136:139], v247 offset:47104
    v_fma_f32 v43, -v242, v227, v43
    v_mfma_f32_16x16x32_bf16 v[52:55], v[88:91], v[180:183], v[52:55]
    ds_read_b128 v[140:143], v247 offset:48128
    v_fma_f32 v71, -v244, v227, v71
    v_mfma_f32_16x16x32_bf16 v[28:31], v[92:95], v[176:179], v[28:31]
    ds_read_b128 v[144:147], v247 offset:49152
    v_fma_f32 v75, -v240, v231, v75
    v_mfma_f32_16x16x32_bf16 v[56:59], v[92:95], v[180:183], v[56:59]
    ds_read_b128 v[148:151], v248 offset:13312
    s_waitcnt lgkmcnt(8)
    v_fma_f32 v79, -v7, v234, v79
    v_mfma_f32_16x16x32_bf16 v[32:35], v[176:179], v[96:99], v[32:35]
    ds_read_b128 v[152:155], v250 offset:28672
    v_fma_f32 v19, -v242, v211, v19
    v_mfma_f32_16x16x32_bf16 v[60:63], v[180:183], v[96:99], v[60:63]
    ds_read_b128 v[156:159], v252 offset:28672
    v_fma_f32 v47, -v244, v211, v47
    v_mfma_f32_16x16x32_bf16 v[36:39], v[176:179], v[100:103], v[36:39]
    v_fma_f32 v23, -v242, v215, v23
    v_mfma_f32_16x16x32_bf16 v[64:67], v[180:183], v[100:103], v[64:67]
    v_fma_f32 v51, -v244, v215, v51
    v_mfma_f32_16x16x32_bf16 v[40:43], v[104:107], v[176:179], v[40:43]
    v_fma_f32 v27, -v242, v219, v27
    v_mfma_f32_16x16x32_bf16 v[68:71], v[104:107], v[180:183], v[68:71]
    v_fma_f32 v55, -v244, v219, v55
    v_mfma_f32_16x16x32_bf16 v[72:75], v[112:115], v[108:111], v[72:75]
    v_fma_f32 v31, -v242, v223, v31
    v_mfma_f32_16x16x32_bf16 v[76:79], v[108:111], v[116:119], v[76:79]
    v_fma_f32 v59, -v244, v223, v59
    s_waitcnt vmcnt(4) lgkmcnt(6)
    s_barrier
    v_mfma_f32_16x16x32_bf16 v[16:19], v[120:123], v[184:187], v[16:19]
    ds_read_b128 v[80:83], v247 offset:50176
    v_mfma_f32_16x16x32_bf16 v[44:47], v[120:123], v[188:191], v[44:47]
    ds_read_b128 v[84:87], v247 offset:51200
    v_and_b32 v4, 1, v2
    v_mfma_f32_16x16x32_bf16 v[20:23], v[124:127], v[184:187], v[20:23]
    ds_read_b128 v[88:91], v247 offset:52224
    v_lshl_add_u32 v5, v3, 2, v4
    v_mfma_f32_16x16x32_bf16 v[48:51], v[124:127], v[188:191], v[48:51]
    ds_read_b128 v[92:95], v247 offset:53248
    v_add_u32 v6, 2, v5
    v_mfma_f32_16x16x32_bf16 v[24:27], v[128:131], v[184:187], v[24:27]
    ds_read_b128 v[96:99], v247 offset:54272
    v_cmp_eq_u32 s[40:41], 1, v4
    v_mfma_f32_16x16x32_bf16 v[52:55], v[128:131], v[188:191], v[52:55]
    ds_read_b128 v[100:103], v247 offset:55296
    v_cmp_le_u32 s[42:43], v5, v2
    v_mfma_f32_16x16x32_bf16 v[28:31], v[132:135], v[184:187], v[28:31]
    ds_read_b128 v[104:107], v247 offset:56320
    v_cmp_le_u32 s[44:45], v6, v2
    v_mfma_f32_16x16x32_bf16 v[56:59], v[132:135], v[188:191], v[56:59]
    ds_read_b128 v[108:111], v248 offset:14336
    s_waitcnt lgkmcnt(8)
    v_mfma_f32_16x16x32_bf16 v[32:35], v[184:187], v[136:139], v[32:35]
    ds_read_b128 v[112:115], v250 offset:35840
    v_mov_b32 v4, 0x0c0c0100
    v_mfma_f32_16x16x32_bf16 v[60:63], v[188:191], v[136:139], v[60:63]
    ds_read_b128 v[116:119], v252 offset:35840
    v_mov_b32 v5, 0x01000c0c
    v_mfma_f32_16x16x32_bf16 v[36:39], v[184:187], v[140:143], v[36:39]
    v_mov_b32 v6, 0x0c0c0302
    v_mov_b32 v7, 0x03020c0c
    v_mfma_f32_16x16x32_bf16 v[64:67], v[188:191], v[140:143], v[64:67]
    v_mov_b32 v8, 0x0c0c0c0c
    v_cndmask_b32 v4, v4, v5, s[40:41]
    v_mfma_f32_16x16x32_bf16 v[40:43], v[144:147], v[184:187], v[40:43]
    v_cndmask_b32 v6, v6, v7, s[40:41]
    v_cndmask_b32 v12, v4, v8, s[42:43]
    v_mfma_f32_16x16x32_bf16 v[68:71], v[144:147], v[188:191], v[68:71]
    v_cndmask_b32 v13, v6, v8, s[44:45]
    v_cndmask_b32 v14, v8, v4, s[42:43]
    v_mfma_f32_16x16x32_bf16 v[72:75], v[152:155], v[148:151], v[72:75]
    v_cndmask_b32 v15, v8, v6, s[44:45]
    s_cmp_eq_u32 s31, 0
    v_mfma_f32_16x16x32_bf16 v[76:79], v[148:151], v[156:159], v[76:79]
    s_cselect_b64 s[48:49], s[42:43], -1
    s_cselect_b64 s[38:39], s[44:45], -1
    s_waitcnt vmcnt(2) lgkmcnt(6)
    v_mfma_f32_16x16x32_bf16 v[16:19], v[80:83], v[192:195], v[16:19]
    ds_read_b128 v[120:123], v247 offset:57344
    v_mfma_f32_16x16x32_bf16 v[44:47], v[80:83], v[196:199], v[44:47]
    ds_read_b128 v[124:127], v247 offset:58368
    s_mul_i32 s36, s20, 3072
    v_mfma_f32_16x16x32_bf16 v[20:23], v[84:87], v[192:195], v[20:23]
    ds_read_b128 v[128:131], v247 offset:59392
    s_add_u32 s36, s36, 149504
    v_mfma_f32_16x16x32_bf16 v[48:51], v[84:87], v[196:199], v[48:51]
    ds_read_b128 v[132:135], v247 offset:60416
    v_add_u32 v9, s36, v0
    v_mfma_f32_16x16x32_bf16 v[24:27], v[88:91], v[192:195], v[24:27]
    ds_read_b128 v[136:139], v247 offset:61440
    s_lshl_b32 s37, s20, 9
    v_mfma_f32_16x16x32_bf16 v[52:55], v[88:91], v[196:199], v[52:55]
    ds_read_b128 v[140:143], v247 offset:62464
    s_add_u32 s37, s37, 149504
    v_mfma_f32_16x16x32_bf16 v[28:31], v[92:95], v[192:195], v[28:31]
    ds_read_b128 v[144:147], v247 offset:63488
    v_add_u32 v10, s37, v0
    v_mfma_f32_16x16x32_bf16 v[56:59], v[92:95], v[196:199], v[56:59]
    ds_read_b128 v[148:151], v248 offset:15360
    s_waitcnt lgkmcnt(8)
    v_mfma_f32_16x16x32_bf16 v[32:35], v[192:195], v[96:99], v[32:35]
    ds_read_b128 v[152:155], v250 offset:43008
    v_lshlrev_b32 v4, 2, v3
    v_mfma_f32_16x16x32_bf16 v[60:63], v[196:199], v[96:99], v[60:63]
    ds_read_b128 v[156:159], v252 offset:43008
    v_sub_u32 v4, v2, v4
    v_mfma_f32_16x16x32_bf16 v[36:39], v[192:195], v[100:103], v[36:39]
    v_lshlrev_b32 v5, 4, v4
    v_lshrrev_b32 v4, 1, v4
    v_mfma_f32_16x16x32_bf16 v[64:67], v[196:199], v[100:103], v[64:67]
    v_mov_b32 v6, 0x3f80
    v_lshlrev_b32 v5, v5, v6
    v_mfma_f32_16x16x32_bf16 v[40:43], v[104:107], v[192:195], v[40:43]
    v_cmp_eq_u32 vcc, 0, v4
    v_cmp_eq_u32 s[46:47], 1, v4
    v_mfma_f32_16x16x32_bf16 v[68:71], v[104:107], v[196:199], v[68:71]
    ds_read_b128 v[208:211], v255 offset:64
    s_lshl_b32 s36, s24, 10
    v_add_u32 v4, s36, v1
    v_mfma_f32_16x16x32_bf16 v[72:75], v[112:115], v[108:111], v[72:75]
    ds_read_b128 v[212:215], v255 offset:192
    v_cndmask_b32 v234, 0, v5, vcc
    v_cndmask_b32 v235, 0, v5, s[46:47]
    v_mfma_f32_16x16x32_bf16 v[76:79], v[108:111], v[116:119], v[76:79]
    ds_read_b128 v[216:219], v255 offset:320
    v_add_u32 v5, 18432, v4
    s_lshl_b32 s36, s24, 7
    s_waitcnt vmcnt(0) lgkmcnt(9)
    v_mfma_f32_16x16x32_bf16 v[16:19], v[120:123], v[200:203], v[16:19]
    ds_read_b128 v[80:83], v248 offset:16384
    v_mfma_f32_16x16x32_bf16 v[44:47], v[120:123], v[204:207], v[44:47]
    ds_read_b128 v[84:87], v250 offset:50176
    s_add_u32 s36, s36, 16384
    v_mfma_f32_16x16x32_bf16 v[20:23], v[124:127], v[200:203], v[20:23]
    ds_read_b128 v[88:91], v252 offset:50176
    v_cmp_eq_u32 vcc, 2, v3
    v_mfma_f32_16x16x32_bf16 v[48:51], v[124:127], v[204:207], v[48:51]
    ds_read_b128 v[92:95], v248 offset:17408
    v_lshl_add_u32 v6, v2, 3, s36
    v_mfma_f32_16x16x32_bf16 v[24:27], v[128:131], v[200:203], v[24:27]
    ds_read_b128 v[96:99], v250 offset:57344
    v_bfrev_b32 v7, 1
    v_mfma_f32_16x16x32_bf16 v[52:55], v[128:131], v[204:207], v[52:55]
    ds_read_b128 v[100:103], v252 offset:57344
    v_cndmask_b32 v6, v7, v6, vcc
    v_mfma_f32_16x16x32_bf16 v[28:31], v[132:135], v[200:203], v[28:31]
    v_add_u32 v7, 18432, v6
    v_mov_b32 v106, 0
    v_mfma_f32_16x16x32_bf16 v[56:59], v[132:135], v[204:207], v[56:59]
    s_waitcnt lgkmcnt(6)
    v_mov_b32 v107, 0
    v_mfma_f32_16x16x32_bf16 v[32:35], v[200:203], v[136:139], v[32:35]
    v_mov_b32 v8, 0xf149f2ca
    v_mov_b32 v108, 0
    v_mfma_f32_16x16x32_bf16 v[60:63], v[204:207], v[136:139], v[60:63]
    s_mov_b32 s33, 0x3eae1a93
    v_mov_b32 v109, 0
    v_mfma_f32_16x16x32_bf16 v[36:39], v[200:203], v[140:143], v[36:39]
    v_mov_b32 v236, 0x3f803f80
    v_mov_b32 v237, 0x3f803f80
    v_mfma_f32_16x16x32_bf16 v[64:67], v[204:207], v[140:143], v[64:67]
    v_mov_b32 v238, 0x3f803f80
    v_mov_b32 v239, 0x3f803f80
    v_mfma_f32_16x16x32_bf16 v[40:43], v[144:147], v[200:203], v[40:43]
    v_mov_b32 v114, 0
    v_mfma_f32_16x16x32_bf16 v[68:71], v[144:147], v[204:207], v[68:71]
    v_mov_b32 v115, 0
    v_mfma_f32_16x16x32_bf16 v[72:75], v[152:155], v[148:151], v[72:75]
    v_mov_b32 v116, 0
    v_mfma_f32_16x16x32_bf16 v[76:79], v[148:151], v[156:159], v[76:79]
    v_mov_b32 v117, 0
    s_waitcnt lgkmcnt(0)
    v_mfma_f32_16x16x32_bf16 v[72:75], v[84:87], v[80:83], v[72:75]
    v_mfma_f32_16x16x32_bf16 v[76:79], v[80:83], v[88:91], v[76:79]
    v_mfma_f32_16x16x32_bf16 v[72:75], v[96:99], v[92:95], v[72:75]
    v_mfma_f32_16x16x32_bf16 v[76:79], v[92:95], v[100:103], v[76:79]
    v_pk_mul_f32 v[52:53], v[52:53], v[244:245] op_sel:[0,1] op_sel_hi:[1,1]
    v_pk_mul_f32 v[54:55], v[54:55], v[244:245] op_sel:[0,1] op_sel_hi:[1,1]
    v_pk_mul_f32 v[56:57], v[56:57], v[244:245] op_sel:[0,1] op_sel_hi:[1,1]
    v_pk_mul_f32 v[58:59], v[58:59], v[244:245] op_sel:[0,1] op_sel_hi:[1,1]
    v_pk_mul_f32 v[60:61], v[60:61], v[216:217]
    v_pk_mul_f32 v[62:63], v[62:63], v[218:219]
    v_pk_mul_f32 v[64:65], v[64:65], v[216:217]
    v_pk_mul_f32 v[66:67], v[66:67], v[218:219]
    v_pk_mul_f32 v[68:69], v[68:69], v[244:245] op_sel:[0,1] op_sel_hi:[1,1]
    v_pk_mul_f32 v[70:71], v[70:71], v[244:245] op_sel:[0,1] op_sel_hi:[1,1]
    v_pk_mul_f32 v[72:73], v[72:73], v[240:241] op_sel:[0,1] op_sel_hi:[1,1]
    v_pk_mul_f32 v[74:75], v[74:75], v[240:241] op_sel:[0,1] op_sel_hi:[1,1]
    v_pk_mul_f32 v[76:77], v[76:77], v[208:209]
    v_pk_mul_f32 v[78:79], v[78:79], v[210:211]
    v_cvt_pk_bf16_f32 v172, v52, v53
    v_cvt_pk_bf16_f32 v173, v54, v55
    v_cvt_pk_bf16_f32 v176, v56, v57
    v_cvt_pk_bf16_f32 v177, v58, v59
    v_cvt_pk_bf16_f32 v182, v60, v61
    v_cvt_pk_bf16_f32 v183, v62, v63
    v_cvt_pk_bf16_f32 v188, v64, v65
    v_cvt_pk_bf16_f32 v189, v66, v67
    v_cvt_pk_bf16_f32 v174, v68, v69
    v_cvt_pk_bf16_f32 v175, v70, v71
    v_cvt_pk_bf16_f32 v220, v72, v73
    v_cvt_pk_bf16_f32 v221, v74, v75
    v_cvt_pk_bf16_f32 v222, v76, v77
    v_cvt_pk_bf16_f32 v223, v78, v79
    s_cmp_eq_u32 s20, 3
    s_cbranch_scc1 L_a_nw
    ds_write2st64_b64 v9, v[172:173], v[174:175] offset0:6 offset1:7
    ds_write2st64_b64 v9, v[176:177], v[182:183] offset0:8 offset1:9
    ds_write_b64 v9, v[188:189] offset:5120
    ds_write2st64_b64 v10, v[220:221], v[222:223] offset0:0 offset1:3
L_a_nw:
    v_pk_mul_f32 v[24:25], v[24:25], v[242:243] op_sel:[0,1] op_sel_hi:[1,1]
    v_pk_mul_f32 v[26:27], v[26:27], v[242:243] op_sel:[0,1] op_sel_hi:[1,1]
    v_pk_mul_f32 v[28:29], v[28:29], v[242:243] op_sel:[0,1] op_sel_hi:[1,1]
    v_pk_mul_f32 v[30:31], v[30:31], v[242:243] op_sel:[0,1] op_sel_hi:[1,1]
    v_pk_mul_f32 v[32:33], v[32:33], v[212:213]
    v_pk_mul_f32 v[34:35], v[34:35], v[214:215]
    v_pk_mul_f32 v[36:37], v[36:37], v[212:213]
    v_pk_mul_f32 v[38:39], v[38:39], v[214:215]
    v_pk_mul_f32 v[40:41], v[40:41], v[242:243] op_sel:[0,1] op_sel_hi:[1,1]
    v_pk_mul_f32 v[42:43], v[42:43], v[242:243] op_sel:[0,1] op_sel_hi:[1,1]
    v_cvt_pk_bf16_f32 v166, v24, v25
    v_cvt_pk_bf16_f32 v167, v26, v27
    v_cvt_pk_bf16_f32 v170, v28, v29
    v_cvt_pk_bf16_f32 v171, v30, v31
    v_cvt_pk_bf16_f32 v180, v32, v33
    v_cvt_pk_bf16_f32 v181, v34, v35
    v_cvt_pk_bf16_f32 v186, v36, v37
    v_cvt_pk_bf16_f32 v187, v38, v39
    v_cvt_pk_bf16_f32 v168, v40, v41
    v_cvt_pk_bf16_f32 v169, v42, v43
    s_waitcnt lgkmcnt(0)
    s_barrier
    ds_read2st64_b64 v[160:163], v9 offset0:0 offset1:1
    ds_read_b64 v[164:165], v9 offset:1024
    ds_read_b64 v[178:179], v9 offset:1536
    ds_read_b64 v[184:185], v9 offset:2048
    v_mfma_f32_16x16x16_bf16 v[128:131], v[174:175], v[234:235], 0
    v_mfma_f32_16x16x16_bf16 v[124:127], v[168:169], v[234:235], 0
    v_pk_mul_f32 v[44:45], v[44:45], v[244:245] op_sel:[0,1] op_sel_hi:[1,1]
    v_pk_mul_f32 v[46:47], v[46:47], v[244:245] op_sel:[0,1] op_sel_hi:[1,1]
    v_pk_mul_f32 v[48:49], v[48:49], v[244:245] op_sel:[0,1] op_sel_hi:[1,1]
    v_pk_mul_f32 v[50:51], v[50:51], v[244:245] op_sel:[0,1] op_sel_hi:[1,1]
    v_pk_mul_f32 v[16:17], v[16:17], v[242:243] op_sel:[0,1] op_sel_hi:[1,1]
    v_pk_mul_f32 v[18:19], v[18:19], v[242:243] op_sel:[0,1] op_sel_hi:[1,1]
    v_pk_mul_f32 v[20:21], v[20:21], v[242:243] op_sel:[0,1] op_sel_hi:[1,1]
    v_pk_mul_f32 v[22:23], v[22:23], v[242:243] op_sel:[0,1] op_sel_hi:[1,1]
    v_cvt_pk_bf16_f32 v112, v44, v45
    v_cvt_pk_bf16_f32 v113, v46, v47
    v_cvt_pk_bf16_f32 v118, v48, v49
    v_cvt_pk_bf16_f32 v119, v50, v51
    v_cvt_pk_bf16_f32 v104, v16, v17
    v_cvt_pk_bf16_f32 v105, v18, v19
    v_cvt_pk_bf16_f32 v110, v20, v21
    v_cvt_pk_bf16_f32 v111, v22, v23
    v_permlane16_swap_b32 v114, v174
    v_permlane16_swap_b32 v117, v175
    v_permlane16_swap_b32 v106, v168
    v_permlane16_swap_b32 v109, v169
    s_waitcnt lgkmcnt(0)
    v_mfma_f32_16x16x16_bf16 v[120:123], v[162:163], v[234:235], 0
    v_mfma_f32_16x16x32_bf16 v[20:23], v[172:175], v[112:115], 0
    v_mfma_f32_16x16x32_bf16 v[16:19], v[166:169], v[112:115], 0
    v_mfma_f32_16x16x32_bf16 v[28:31], v[174:177], v[116:119], 0
    v_mfma_f32_16x16x32_bf16 v[24:27], v[168:171], v[116:119], 0
    v_mfma_f32_16x16x32_bf16 v[36:39], v[166:169], v[104:107], 0
    v_mfma_f32_16x16x32_bf16 v[32:35], v[160:163], v[104:107], 0
    v_mfma_f32_16x16x32_bf16 v[44:47], v[168:171], v[108:111], 0
    v_mfma_f32_16x16x32_bf16 v[40:43], v[162:165], v[108:111], 0
    v_cvt_pk_bf16_f32 v194, v128, v129
    v_cvt_pk_bf16_f32 v195, v130, v131
    v_cvt_pk_bf16_f32 v192, v124, v125
    v_cvt_pk_bf16_f32 v193, v126, v127
    v_cvt_pk_bf16_f32 v190, v120, v121
    v_cvt_pk_bf16_f32 v191, v122, v123
    v_cndmask_b32 v20, v20, v21, s[40:41]
    v_cndmask_b32 v16, v16, v17, s[40:41]
    v_cndmask_b32 v48, v16, v20, s[42:43]
    v_cndmask_b32 v22, v22, v23, s[40:41]
    v_cndmask_b32 v18, v18, v19, s[40:41]
    v_cndmask_b32 v49, v18, v22, s[44:45]
    v_max_f32 v56, v48, v49
    v_cndmask_b32 v28, v28, v29, s[40:41]
    v_cndmask_b32 v24, v24, v25, s[40:41]
    v_cndmask_b32 v50, v24, v28, s[42:43]
    v_cndmask_b32 v30, v30, v31, s[40:41]
    v_cndmask_b32 v26, v26, v27, s[40:41]
    v_cndmask_b32 v51, v26, v30, s[44:45]
    v_max_f32 v57, v50, v51
    v_cndmask_b32 v36, v36, v37, s[40:41]
    v_cndmask_b32 v32, v32, v33, s[40:41]
    v_cndmask_b32 v52, v32, v36, s[42:43]
    v_cndmask_b32 v52, v8, v52, s[48:49]
    v_cndmask_b32 v38, v38, v39, s[40:41]
    v_cndmask_b32 v34, v34, v35, s[40:41]
    v_cndmask_b32 v53, v34, v38, s[44:45]
    v_cndmask_b32 v53, v8, v53, s[38:39]
    v_max_f32 v58, v52, v53
    v_permlane32_swap_b32 v56, v57
    v_max_f32 v56, v56, v57
    v_cndmask_b32 v44, v44, v45, s[40:41]
    v_cndmask_b32 v40, v40, v41, s[40:41]
    v_cndmask_b32 v54, v40, v44, s[42:43]
    v_cndmask_b32 v54, v8, v54, s[48:49]
    v_cndmask_b32 v46, v46, v47, s[40:41]
    v_cndmask_b32 v42, v42, v43, s[40:41]
    v_cndmask_b32 v55, v42, v46, s[44:45]
    v_cndmask_b32 v55, v8, v55, s[38:39]
    v_max_f32 v59, v54, v55
    s_nop 1
    v_permlane32_swap_b32 v58, v59
    v_max_f32 v58, v58, v59
    s_nop 1
    v_permlane16_swap_b32 v56, v58
    v_max_f32 v57, v56, v58
    v_mul_f32 v56, s33, v57
    v_mul_f32 v58, s33, v57
    s_nop 1
    v_permlane16_swap_b32 v56, v58
    v_mov_b32 v57, v56
    v_mov_b32 v59, v58
    s_nop 0
    v_permlane32_swap_b32 v56, v57
    v_permlane32_swap_b32 v58, v59
    v_fma_f32 v48, v48, s33, -v56
    v_fma_f32 v49, v49, s33, -v56
    v_fma_f32 v50, v50, s33, -v57
    v_fma_f32 v51, v51, s33, -v57
    v_fma_f32 v52, v52, s33, -v58
    v_fma_f32 v53, v53, s33, -v58
    v_fma_f32 v54, v54, s33, -v59
    v_fma_f32 v55, v55, s33, -v59
    v_exp_f32 v48, v48
    v_exp_f32 v49, v49
    v_exp_f32 v50, v50
    v_exp_f32 v51, v51
    v_exp_f32 v52, v52
    v_exp_f32 v53, v53
    v_exp_f32 v54, v54
    v_exp_f32 v55, v55
    v_cvt_pk_bf16_f32 v56, v48, v49
    v_cvt_pk_bf16_f32 v57, v50, v51
    v_cvt_pk_bf16_f32 v58, v52, v53
    v_cvt_pk_bf16_f32 v59, v54, v55
    v_perm_b32 v64, v56, v56, v12
    v_perm_b32 v65, v56, v56, v13
    v_perm_b32 v66, v56, v56, v14
    v_perm_b32 v67, v56, v56, v15
    v_perm_b32 v68, v57, v57, v12
    v_perm_b32 v69, v57, v57, v13
    v_perm_b32 v70, v57, v57, v14
    v_perm_b32 v71, v57, v57, v15
    v_perm_b32 v72, v58, v58, v12
    v_perm_b32 v73, v58, v58, v13
    v_perm_b32 v74, v58, v58, v14
    v_perm_b32 v75, v58, v58, v15
    v_perm_b32 v76, v59, v59, v12
    v_perm_b32 v77, v59, v59, v13
    v_perm_b32 v78, v59, v59, v14
    v_perm_b32 v79, v59, v59, v15
    v_mfma_f32_16x16x32_bf16 v[80:83], v[236:239], v[64:67], 0
    v_mfma_f32_16x16x32_bf16 v[84:87], v[236:239], v[68:71], 0
    v_mfma_f32_16x16x32_bf16 v[88:91], v[236:239], v[72:75], 0
    v_mfma_f32_16x16x32_bf16 v[92:95], v[236:239], v[76:79], 0
    v_mfma_f32_16x16x32_bf16 v[16:19], v[180:183], v[64:67], 0
    v_mfma_f32_16x16x32_bf16 v[20:23], v[192:195], v[64:67], 0
    v_mfma_f32_16x16x32_bf16 v[24:27], v[186:189], v[68:71], 0
    v_mfma_f32_16x16x32_bf16 v[28:31], v[192:195], v[68:71], 0
    v_mfma_f32_16x16x32_bf16 v[32:35], v[178:181], v[72:75], 0
    v_mfma_f32_16x16x32_bf16 v[36:39], v[190:193], v[72:75], 0
    v_mfma_f32_16x16x32_bf16 v[40:43], v[184:187], v[76:79], 0
    v_mfma_f32_16x16x32_bf16 v[44:47], v[190:193], v[76:79], 0
    v_rcp_f32 v80, v80
    v_rcp_f32 v84, v84
    v_rcp_f32 v88, v88
    v_rcp_f32 v92, v92
    v_pk_mul_f32 v[16:17], v[16:17], v[80:81] op_sel_hi:[1,0]
    v_pk_mul_f32 v[18:19], v[18:19], v[80:81] op_sel_hi:[1,0]
    v_pk_mul_f32 v[20:21], v[20:21], v[80:81] op_sel_hi:[1,0]
    v_pk_mul_f32 v[24:25], v[24:25], v[84:85] op_sel_hi:[1,0]
    v_pk_mul_f32 v[26:27], v[26:27], v[84:85] op_sel_hi:[1,0]
    v_pk_mul_f32 v[30:31], v[30:31], v[84:85] op_sel_hi:[1,0]
    v_cvt_pk_bf16_f32 v220, v16, v17
    v_cvt_pk_bf16_f32 v221, v18, v19
    v_cvt_pk_bf16_f32 v224, v20, v21
    v_cvt_pk_bf16_f32 v222, v24, v25
    v_cvt_pk_bf16_f32 v223, v26, v27
    v_cvt_pk_bf16_f32 v225, v30, v31
    buffer_store_dwordx4 v[220:223], v5, s[4:7], s35 offen sc1
    buffer_store_dwordx2 v[224:225], v7, s[4:7], s35 offen sc1
    v_pk_mul_f32 v[32:33], v[32:33], v[88:89] op_sel_hi:[1,0]
    v_pk_mul_f32 v[34:35], v[34:35], v[88:89] op_sel_hi:[1,0]
    v_pk_mul_f32 v[36:37], v[36:37], v[88:89] op_sel_hi:[1,0]
    v_pk_mul_f32 v[40:41], v[40:41], v[92:93] op_sel_hi:[1,0]
    v_pk_mul_f32 v[42:43], v[42:43], v[92:93] op_sel_hi:[1,0]
    v_pk_mul_f32 v[46:47], v[46:47], v[92:93] op_sel_hi:[1,0]
    v_cvt_pk_bf16_f32 v228, v32, v33
    v_cvt_pk_bf16_f32 v229, v34, v35
    v_cvt_pk_bf16_f32 v232, v36, v37
    v_cvt_pk_bf16_f32 v230, v40, v41
    v_cvt_pk_bf16_f32 v231, v42, v43
    v_cvt_pk_bf16_f32 v233, v46, v47
    buffer_store_dwordx4 v[228:231], v4, s[4:7], s35 offen sc1
    buffer_store_dwordx2 v[232:233], v6, s[4:7], s35 offen sc1
    s_and_b32 s25, s2, 7
    s_lshr_b32 s26, s2, 3
    s_lshr_b32 s23, s25, 1
    s_lshl_b32 s23, s23, 3
    s_lshr_b32 s27, s26, 2
    s_add_u32 s23, s23, s27
    s_and_b32 s24, s25, 1
    s_lshl_b32 s24, s24, 2
    s_and_b32 s27, s26, 3
    s_add_u32 s24, s24, s27
    s_add_u32 s25, s23, s24
    s_and_b32 s25, s25, 3
    s_lshl_b32 s30, s23, 2
    s_add_u32 s30, s30, s20
    s_mul_i32 s29, s30, 18432
    s_add_u32 s29, s29, s21
    s_add_u32 s29, s29, 0x600000
    s_mul_i32 s34, s30, 18432
    s_add_u32 s34, s34, s21
    s_add_u32 s34, s34, 0x0
    s_lshl_b32 s35, s24, 11
    s_lshr_b32 s36, s24, 2
    s_lshl_b32 s36, s36, 10
    s_and_b32 s37, s24, 3
    s_lshl_b32 s37, s37, 8
    s_add_u32 s36, s36, s37
    s_add_u32 s36, s36, 16384
    v_bfe_u32 v2, v1, 4, 4
    v_lshrrev_b32 v3, 8, v1
    v_add_u32 v4, s35, v1
    v_lshlrev_b32 v5, 4, v2
    v_lshl_add_u32 v5, v3, 3, v5
    v_add_u32 v5, s36, v5
    v_cmp_gt_u32 s[40:41], 2, v3
    v_bfrev_b32 v6, 1
    v_add_u32 v12, 0, v1
    v_add_u32 v13, 36864, v1
    v_add_u32 v14, 73728, v1
    v_add_u32 v15, 110592, v1
    v_cndmask_b32 v5, v6, v5, s[40:41]
    buffer_load_dwordx4 v[208:211], v4, s[4:7], s34 offen offset:0 sc1
    buffer_load_dwordx4 v[212:215], v4, s[4:7], s34 offen offset:1024 sc1
    buffer_load_dwordx2 v[216:217], v5, s[4:7], s34 offen sc1
    s_add_u32 s34, s34, 0x300000
    s_lshl_b32 s39, s30, 10
    s_add_u32 s39, s39, s21
    s_lshl_b32 s42, s24, 7
    s_add_u32 s39, s39, s42
    s_add_u32 s39, s39, 0x1b20000
    v_cmp_eq_u32 vcc, 0, v3
    v_lshlrev_b32 v10, 3, v2
    v_mov_b32 v11, 0x3f803f80
    v_lshl_add_u32 v7, v3, 8, v10
    v_cndmask_b32 v10, v6, v10, vcc
    s_lshr_b32 s44, s23, 1
    s_lshl_b32 s52, s22, 7
    s_add_u32 s52, s52, s44
    s_lshl_b32 s52, s52, 8
    s_add_u32 s52, s52, 0x4508000
    s_add_u32 s52, s52, s4
    s_addc_u32 s53, s5, 0
    s_waitcnt vmcnt(3)
    s_barrier
    s_cmp_lg_u32 s20, 0
    s_cbranch_scc1 L_ns_d2
    s_mov_b32 s56, 1
    s_atomic_add s56, s[50:51], 0
L_ns_d2:
    s_cmp_lg_u32 s20, 0
    s_cbranch_scc1 L_pd_d2
    s_mov_b32 s60, 65536
L_poll_d2:
    s_mov_b32 s57, 0
    s_atomic_add s57, s[52:53], 0 glc
    s_waitcnt lgkmcnt(0)
    s_cmp_ge_u32 s57, 16
    s_cbranch_scc1 L_pd_d2
    s_sub_u32 s60, s60, 1
    s_cbranch_scc1 L_pd_d2
    s_sleep 2
    s_branch L_poll_d2
L_pd_d2:
    s_barrier
    s_mov_b32 s32, 0
    s_lshl_b32 s32, s32, 13
    s_add_u32 s32, s32, s29
    s_add_u32 s33, s32, 4096
    buffer_load_dwordx4 v[112:115], v1, s[4:7], s32 offen offset:0 sc1
    buffer_load_dwordx4 v[116:119], v1, s[4:7], s32 offen offset:1024 sc1
    buffer_load_dwordx4 v[120:123], v1, s[4:7], s32 offen offset:2048 sc1
    buffer_load_dwordx4 v[124:127], v1, s[4:7], s32 offen offset:3072 sc1
    buffer_load_dwordx4 v[128:131], v1, s[4:7], s33 offen offset:0 sc1
    buffer_load_dwordx4 v[132:135], v1, s[4:7], s33 offen offset:1024 sc1
    buffer_load_dwordx4 v[136:139], v1, s[4:7], s33 offen offset:2048 sc1
    buffer_load_dwordx4 v[140:143], v1, s[4:7], s33 offen offset:3072 sc1
    ds_read_b128 v[40:43], v12 offset:18432
    ds_read_b128 v[44:47], v12 offset:19456
    ds_read_b128 v[48:51], v12 offset:20480
    ds_read_b128 v[52:55], v12 offset:21504
    ds_read_b128 v[72:75], v12 offset:26624
    ds_read_b128 v[56:59], v12 offset:22528
    ds_read_b128 v[60:63], v12 offset:23552
    ds_read_b128 v[64:67], v12 offset:24576
    ds_read_b128 v[68:71], v12 offset:25600
    s_add_u32 s45, s29, 8192
    s_add_u32 s46, s29, 12288
    s_add_u32 s47, s29, 16384
    buffer_load_dwordx4 v[144:147], v1, s[4:7], s45 offen offset:0 sc1
    buffer_load_dwordx4 v[148:151], v1, s[4:7], s45 offen offset:1024 sc1
    s_lshl_b32 s42, s23, 3
    s_add_u32 s42, s42, s24
    s_lshl_b32 s42, s42, 2
    s_add_u32 s42, s42, s20
    s_lshl_b32 s42, s42, 8
    s_add_u32 s42, s42, s21
    s_add_u32 s42, s42, 0x1b40000
    v_mov_b32 v220, -1.0
    v_lshrrev_b32 v221, 2, v1
    buffer_store_dword v220, v221, s[4:7], s42 offen sc1
    s_lshl_b32 s50, s22, 7
    s_add_u32 s50, s50, s44
    s_lshl_b32 s50, s50, 8
    s_add_u32 s50, s50, 0x4509000
    s_add_u32 s50, s50, s4
    s_addc_u32 s51, s5, 0
    s_waitcnt vmcnt(11)
    v_lshlrev_b32 v16, 16, v208
    v_and_b32 v17, 0xffff0000, v208
    v_lshlrev_b32 v18, 16, v209
    v_and_b32 v19, 0xffff0000, v209
    v_lshlrev_b32 v20, 16, v210
    v_and_b32 v21, 0xffff0000, v210
    v_lshlrev_b32 v22, 16, v211
    v_and_b32 v23, 0xffff0000, v211
    v_lshlrev_b32 v24, 16, v212
    v_and_b32 v25, 0xffff0000, v212
    v_lshlrev_b32 v26, 16, v213
    v_and_b32 v27, 0xffff0000, v213
    v_lshlrev_b32 v28, 16, v214
    v_and_b32 v29, 0xffff0000, v214
    v_lshlrev_b32 v30, 16, v215
    v_and_b32 v31, 0xffff0000, v215
    v_lshlrev_b32 v32, 16, v216
    v_and_b32 v33, 0xffff0000, v216
    v_lshlrev_b32 v34, 16, v217
    v_and_b32 v35, 0xffff0000, v217
    s_waitcnt vmcnt(9) lgkmcnt(4)
    v_mfma_f32_16x16x32_bf16 v[16:19], v[40:43], v[112:115], v[16:19]
    ds_read_b128 v[76:79], v12 offset:27648
    v_mfma_f32_16x16x32_bf16 v[20:23], v[44:47], v[112:115], v[20:23]
    ds_read_b128 v[80:83], v12 offset:28672
    buffer_load_dwordx4 v[152:155], v1, s[4:7], s45 offen offset:2048 sc1
    v_mfma_f32_16x16x32_bf16 v[24:27], v[48:51], v[112:115], v[24:27]
    ds_read_b128 v[84:87], v12 offset:29696
    v_mfma_f32_16x16x32_bf16 v[28:31], v[52:55], v[112:115], v[28:31]
    ds_read_b128 v[88:91], v12 offset:30720
    v_mfma_f32_16x16x32_bf16 v[32:35], v[72:75], v[112:115], v[32:35]
    ds_read_b128 v[108:111], v12 offset:35840
    s_waitcnt lgkmcnt(5)
    buffer_load_dwordx4 v[156:159], v1, s[4:7], s45 offen offset:3072 sc1
    v_mfma_f32_16x16x32_bf16 v[16:19], v[56:59], v[116:119], v[16:19]
    ds_read_b128 v[92:95], v12 offset:31744
    v_mfma_f32_16x16x32_bf16 v[20:23], v[60:63], v[116:119], v[20:23]
    ds_read_b128 v[96:99], v12 offset:32768
    v_mfma_f32_16x16x32_bf16 v[24:27], v[64:67], v[116:119], v[24:27]
    ds_read_b128 v[100:103], v12 offset:33792
    buffer_load_dwordx4 v[160:163], v1, s[4:7], s46 offen offset:0 sc1
    v_mfma_f32_16x16x32_bf16 v[28:31], v[68:71], v[116:119], v[28:31]
    ds_read_b128 v[104:107], v12 offset:34816
    v_mfma_f32_16x16x32_bf16 v[36:39], v[72:75], v[116:119], 0
    s_waitcnt vmcnt(10) lgkmcnt(4)
    v_mfma_f32_16x16x32_bf16 v[16:19], v[76:79], v[120:123], v[16:19]
    ds_read_b128 v[40:43], v13 offset:18432
    v_mfma_f32_16x16x32_bf16 v[20:23], v[80:83], v[120:123], v[20:23]
    ds_read_b128 v[44:47], v13 offset:19456
    buffer_load_dwordx4 v[164:167], v1, s[4:7], s46 offen offset:1024 sc1
    v_mfma_f32_16x16x32_bf16 v[24:27], v[84:87], v[120:123], v[24:27]
    ds_read_b128 v[48:51], v13 offset:20480
    v_mfma_f32_16x16x32_bf16 v[28:31], v[88:91], v[120:123], v[28:31]
    ds_read_b128 v[52:55], v13 offset:21504
    v_mfma_f32_16x16x32_bf16 v[32:35], v[108:111], v[120:123], v[32:35]
    ds_read_b128 v[72:75], v13 offset:26624
    s_waitcnt lgkmcnt(5)
    buffer_load_dwordx4 v[168:171], v1, s[4:7], s46 offen offset:2048 sc1
    v_mfma_f32_16x16x32_bf16 v[16:19], v[92:95], v[124:127], v[16:19]
    ds_read_b128 v[56:59], v13 offset:22528
    v_mfma_f32_16x16x32_bf16 v[20:23], v[96:99], v[124:127], v[20:23]
    ds_read_b128 v[60:63], v13 offset:23552
    v_mfma_f32_16x16x32_bf16 v[24:27], v[100:103], v[124:127], v[24:27]
    ds_read_b128 v[64:67], v13 offset:24576
    buffer_load_dwordx4 v[172:175], v1, s[4:7], s46 offen offset:3072 sc1
    v_mfma_f32_16x16x32_bf16 v[28:31], v[104:107], v[124:127], v[28:31]
    ds_read_b128 v[68:71], v13 offset:25600
    v_mfma_f32_16x16x32_bf16 v[36:39], v[108:111], v[124:127], v[36:39]
    s_waitcnt vmcnt(11) lgkmcnt(4)
    v_mfma_f32_16x16x32_bf16 v[16:19], v[40:43], v[128:131], v[16:19]
    ds_read_b128 v[76:79], v13 offset:27648
    v_mfma_f32_16x16x32_bf16 v[20:23], v[44:47], v[128:131], v[20:23]
    ds_read_b128 v[80:83], v13 offset:28672
    buffer_load_dwordx2 v[176:177], v7, s[4:7], s47 offen offset:0 sc1
    v_mfma_f32_16x16x32_bf16 v[24:27], v[48:51], v[128:131], v[24:27]
    ds_read_b128 v[84:87], v13 offset:29696
    v_mfma_f32_16x16x32_bf16 v[28:31], v[52:55], v[128:131], v[28:31]
    ds_read_b128 v[88:91], v13 offset:30720
    v_mfma_f32_16x16x32_bf16 v[32:35], v[72:75], v[128:131], v[32:35]
    ds_read_b128 v[108:111], v13 offset:35840
    s_waitcnt lgkmcnt(5)
    buffer_load_dwordx2 v[178:179], v7, s[4:7], s47 offen offset:128 sc1
    v_mfma_f32_16x16x32_bf16 v[16:19], v[56:59], v[132:135], v[16:19]
    ds_read_b128 v[92:95], v13 offset:31744
    v_mfma_f32_16x16x32_bf16 v[20:23], v[60:63], v[132:135], v[20:23]
    ds_read_b128 v[96:99], v13 offset:32768
    v_mfma_f32_16x16x32_bf16 v[24:27], v[64:67], v[132:135], v[24:27]
    ds_read_b128 v[100:103], v13 offset:33792
    buffer_load_dwordx2 v[180:181], v7, s[4:7], s47 offen offset:1024 sc1
    v_mfma_f32_16x16x32_bf16 v[28:31], v[68:71], v[132:135], v[28:31]
    ds_read_b128 v[104:107], v13 offset:34816
    v_mfma_f32_16x16x32_bf16 v[36:39], v[72:75], v[132:135], v[36:39]
    s_waitcnt vmcnt(12) lgkmcnt(4)
    v_mfma_f32_16x16x32_bf16 v[16:19], v[76:79], v[136:139], v[16:19]
    ds_read_b128 v[40:43], v14 offset:18432
    v_mfma_f32_16x16x32_bf16 v[20:23], v[80:83], v[136:139], v[20:23]
    ds_read_b128 v[44:47], v14 offset:19456
    buffer_load_dwordx2 v[182:183], v7, s[4:7], s47 offen offset:1152 sc1
    v_mfma_f32_16x16x32_bf16 v[24:27], v[84:87], v[136:139], v[24:27]
    ds_read_b128 v[48:51], v14 offset:20480
    v_mfma_f32_16x16x32_bf16 v[28:31], v[88:91], v[136:139], v[28:31]
    ds_read_b128 v[52:55], v14 offset:21504
    v_mfma_f32_16x16x32_bf16 v[32:35], v[108:111], v[136:139], v[32:35]
    ds_read_b128 v[72:75], v14 offset:26624
    s_waitcnt lgkmcnt(5)
    v_mfma_f32_16x16x32_bf16 v[16:19], v[92:95], v[140:143], v[16:19]
    ds_read_b128 v[56:59], v14 offset:22528
    v_mfma_f32_16x16x32_bf16 v[20:23], v[96:99], v[140:143], v[20:23]
    ds_read_b128 v[60:63], v14 offset:23552
    v_mfma_f32_16x16x32_bf16 v[24:27], v[100:103], v[140:143], v[24:27]
    ds_read_b128 v[64:67], v14 offset:24576
    v_mfma_f32_16x16x32_bf16 v[28:31], v[104:107], v[140:143], v[28:31]
    ds_read_b128 v[68:71], v14 offset:25600
    v_mfma_f32_16x16x32_bf16 v[36:39], v[108:111], v[140:143], v[36:39]
    s_waitcnt vmcnt(11) lgkmcnt(4)
    v_mfma_f32_16x16x32_bf16 v[16:19], v[40:43], v[144:147], v[16:19]
    ds_read_b128 v[76:79], v14 offset:27648
    v_mfma_f32_16x16x32_bf16 v[20:23], v[44:47], v[144:147], v[20:23]
    ds_read_b128 v[80:83], v14 offset:28672
    v_mfma_f32_16x16x32_bf16 v[24:27], v[48:51], v[144:147], v[24:27]
    ds_read_b128 v[84:87], v14 offset:29696
    v_mfma_f32_16x16x32_bf16 v[28:31], v[52:55], v[144:147], v[28:31]
    ds_read_b128 v[88:91], v14 offset:30720
    v_mfma_f32_16x16x32_bf16 v[32:35], v[72:75], v[144:147], v[32:35]
    ds_read_b128 v[108:111], v14 offset:35840
    s_waitcnt lgkmcnt(5)
    v_mfma_f32_16x16x32_bf16 v[16:19], v[56:59], v[148:151], v[16:19]
    ds_read_b128 v[92:95], v14 offset:31744
    v_mfma_f32_16x16x32_bf16 v[20:23], v[60:63], v[148:151], v[20:23]
    ds_read_b128 v[96:99], v14 offset:32768
    v_mfma_f32_16x16x32_bf16 v[24:27], v[64:67], v[148:151], v[24:27]
    ds_read_b128 v[100:103], v14 offset:33792
    v_mfma_f32_16x16x32_bf16 v[28:31], v[68:71], v[148:151], v[28:31]
    ds_read_b128 v[104:107], v14 offset:34816
    v_mfma_f32_16x16x32_bf16 v[36:39], v[72:75], v[148:151], v[36:39]
    s_waitcnt vmcnt(8) lgkmcnt(4)
    v_mfma_f32_16x16x32_bf16 v[16:19], v[76:79], v[152:155], v[16:19]
    ds_read_b128 v[40:43], v15 offset:18432
    v_mfma_f32_16x16x32_bf16 v[20:23], v[80:83], v[152:155], v[20:23]
    ds_read_b128 v[44:47], v15 offset:19456
    v_mfma_f32_16x16x32_bf16 v[24:27], v[84:87], v[152:155], v[24:27]
    ds_read_b128 v[48:51], v15 offset:20480
    v_mfma_f32_16x16x32_bf16 v[28:31], v[88:91], v[152:155], v[28:31]
    ds_read_b128 v[52:55], v15 offset:21504
    v_mfma_f32_16x16x32_bf16 v[32:35], v[108:111], v[152:155], v[32:35]
    ds_read_b128 v[72:75], v15 offset:26624
    s_waitcnt lgkmcnt(5)
    v_mfma_f32_16x16x32_bf16 v[16:19], v[92:95], v[156:159], v[16:19]
    ds_read_b128 v[56:59], v15 offset:22528
    v_mfma_f32_16x16x32_bf16 v[20:23], v[96:99], v[156:159], v[20:23]
    ds_read_b128 v[60:63], v15 offset:23552
    v_mfma_f32_16x16x32_bf16 v[24:27], v[100:103], v[156:159], v[24:27]
    ds_read_b128 v[64:67], v15 offset:24576
    v_mfma_f32_16x16x32_bf16 v[28:31], v[104:107], v[156:159], v[28:31]
    ds_read_b128 v[68:71], v15 offset:25600
    v_mfma_f32_16x16x32_bf16 v[36:39], v[108:111], v[156:159], v[36:39]
    s_waitcnt vmcnt(6) lgkmcnt(4)
    v_mfma_f32_16x16x32_bf16 v[16:19], v[40:43], v[160:163], v[16:19]
    ds_read_b128 v[76:79], v15 offset:27648
    v_mfma_f32_16x16x32_bf16 v[20:23], v[44:47], v[160:163], v[20:23]
    ds_read_b128 v[80:83], v15 offset:28672
    v_mfma_f32_16x16x32_bf16 v[24:27], v[48:51], v[160:163], v[24:27]
    ds_read_b128 v[84:87], v15 offset:29696
    v_mfma_f32_16x16x32_bf16 v[28:31], v[52:55], v[160:163], v[28:31]
    ds_read_b128 v[88:91], v15 offset:30720
    v_mfma_f32_16x16x32_bf16 v[32:35], v[72:75], v[160:163], v[32:35]
    ds_read_b128 v[108:111], v15 offset:35840
    s_waitcnt lgkmcnt(5)
    v_mfma_f32_16x16x32_bf16 v[16:19], v[56:59], v[164:167], v[16:19]
    ds_read_b128 v[92:95], v15 offset:31744
    v_mfma_f32_16x16x32_bf16 v[20:23], v[60:63], v[164:167], v[20:23]
    ds_read_b128 v[96:99], v15 offset:32768
    v_mfma_f32_16x16x32_bf16 v[24:27], v[64:67], v[164:167], v[24:27]
    ds_read_b128 v[100:103], v15 offset:33792
    v_mfma_f32_16x16x32_bf16 v[28:31], v[68:71], v[164:167], v[28:31]
    ds_read_b128 v[104:107], v15 offset:34816
    v_mfma_f32_16x16x32_bf16 v[36:39], v[72:75], v[164:167], v[36:39]
    s_waitcnt vmcnt(4) lgkmcnt(4)
    v_mfma_f32_16x16x32_bf16 v[16:19], v[76:79], v[168:171], v[16:19]
    ds_read_b128 v[40:43], v15 offset:36864
    v_mfma_f32_16x16x32_bf16 v[20:23], v[80:83], v[168:171], v[20:23]
    ds_read_b128 v[44:47], v15 offset:37888
    v_mfma_f32_16x16x32_bf16 v[24:27], v[84:87], v[168:171], v[24:27]
    ds_read_b128 v[48:51], v15 offset:38912
    v_mfma_f32_16x16x32_bf16 v[28:31], v[88:91], v[168:171], v[28:31]
    ds_read_b128 v[52:55], v15 offset:39936
    v_mfma_f32_16x16x32_bf16 v[32:35], v[108:111], v[168:171], v[32:35]
    ds_read_b128 v[72:75], v15 offset:45056
    s_waitcnt lgkmcnt(5)
    v_mfma_f32_16x16x32_bf16 v[16:19], v[92:95], v[172:175], v[16:19]
    ds_read_b128 v[56:59], v15 offset:40960
    v_mfma_f32_16x16x32_bf16 v[20:23], v[96:99], v[172:175], v[20:23]
    ds_read_b128 v[60:63], v15 offset:41984
    v_mfma_f32_16x16x32_bf16 v[24:27], v[100:103], v[172:175], v[24:27]
    ds_read_b128 v[64:67], v15 offset:43008
    v_mfma_f32_16x16x32_bf16 v[28:31], v[104:107], v[172:175], v[28:31]
    ds_read_b128 v[68:71], v15 offset:44032
    v_mfma_f32_16x16x32_bf16 v[36:39], v[108:111], v[172:175], v[36:39]
    s_waitcnt vmcnt(0) lgkmcnt(4)
    v_mfma_f32_16x16x32_bf16 v[16:19], v[40:43], v[176:179], v[16:19]
    v_mfma_f32_16x16x32_bf16 v[20:23], v[44:47], v[176:179], v[20:23]
    v_mfma_f32_16x16x32_bf16 v[24:27], v[48:51], v[176:179], v[24:27]
    v_mfma_f32_16x16x32_bf16 v[28:31], v[52:55], v[176:179], v[28:31]
    v_mfma_f32_16x16x32_bf16 v[32:35], v[72:75], v[176:179], v[32:35]
    s_waitcnt lgkmcnt(0)
    v_mfma_f32_16x16x32_bf16 v[16:19], v[56:59], v[180:183], v[16:19]
    v_mfma_f32_16x16x32_bf16 v[20:23], v[60:63], v[180:183], v[20:23]
    v_mfma_f32_16x16x32_bf16 v[24:27], v[64:67], v[180:183], v[24:27]
    v_mfma_f32_16x16x32_bf16 v[28:31], v[68:71], v[180:183], v[28:31]
    v_mfma_f32_16x16x32_bf16 v[36:39], v[72:75], v[180:183], v[36:39]
    s_nop 3
    v_cvt_pk_bf16_f32 v208, v16, v17
    v_cvt_pk_bf16_f32 v209, v18, v19
    v_cvt_pk_bf16_f32 v210, v20, v21
    v_cvt_pk_bf16_f32 v211, v22, v23
    v_cvt_pk_bf16_f32 v212, v24, v25
    v_cvt_pk_bf16_f32 v213, v26, v27
    v_cvt_pk_bf16_f32 v214, v28, v29
    v_cvt_pk_bf16_f32 v215, v30, v31
    buffer_store_dwordx4 v[208:211], v4, s[4:7], s34 offen offset:0 sc1
    buffer_store_dwordx4 v[212:215], v4, s[4:7], s34 offen offset:1024 sc1
    v_permlane32_swap_b32 v36, v220
    v_permlane32_swap_b32 v37, v221
    v_permlane32_swap_b32 v38, v222
    v_permlane32_swap_b32 v39, v223
    v_pk_add_f32 v[32:33], v[32:33], v[220:221]
    v_pk_add_f32 v[34:35], v[34:35], v[222:223]
    v_cvt_pk_bf16_f32 v216, v32, v33
    v_cvt_pk_bf16_f32 v217, v34, v35
    buffer_store_dwordx2 v[216:217], v5, s[4:7], s34 offen sc1
    v_cndmask_b32 v222, 0, v216, s[40:41]
    v_cndmask_b32 v223, 0, v217, s[40:41]
    v_dot2_f32_bf16 v220, v208, v11, 0
    v_dot2_f32_bf16 v221, v208, v208, 0
    v_dot2_f32_bf16 v224, v209, v11, 0
    v_dot2_f32_bf16 v225, v209, v209, 0
    v_dot2_f32_bf16 v220, v210, v11, v220
    v_dot2_f32_bf16 v221, v210, v210, v221
    v_dot2_f32_bf16 v224, v211, v11, v224
    v_dot2_f32_bf16 v225, v211, v211, v225
    v_dot2_f32_bf16 v220, v212, v11, v220
    v_dot2_f32_bf16 v221, v212, v212, v221
    v_dot2_f32_bf16 v224, v213, v11, v224
    v_dot2_f32_bf16 v225, v213, v213, v225
    v_dot2_f32_bf16 v220, v214, v11, v220
    v_dot2_f32_bf16 v221, v214, v214, v221
    v_dot2_f32_bf16 v224, v215, v11, v224
    v_dot2_f32_bf16 v225, v215, v215, v225
    v_dot2_f32_bf16 v220, v222, v11, v220
    v_dot2_f32_bf16 v221, v222, v222, v221
    v_dot2_f32_bf16 v224, v223, v11, v224
    v_dot2_f32_bf16 v225, v223, v223, v225
    s_nop 2
    v_pk_add_f32 v[220:221], v[220:221], v[224:225]
    v_mov_b32 v222, v220
    v_mov_b32 v223, v221
    s_nop 1
    v_permlane32_swap_b32 v220, v222
    v_permlane32_swap_b32 v221, v223
    v_add_f32 v220, v220, v222
    v_add_f32 v221, v221, v223
    v_mov_b32 v222, v220
    v_mov_b32 v223, v221
    s_nop 1
    v_permlane16_swap_b32 v220, v222
    v_permlane16_swap_b32 v221, v223
    v_add_f32 v220, v220, v222
    v_add_f32 v221, v221, v223
    buffer_store_dwordx2 v[220:221], v10, s[4:7], s39 offen sc1
    s_and_b32 s25, s2, 7
    s_lshr_b32 s26, s2, 3
    s_and_b32 s23, s25, 1
    s_lshl_b32 s23, s23, 3
    s_and_b32 s27, s26, 7
    s_add_u32 s23, s23, s27
    s_lshr_b32 s24, s25, 1
    s_lshl_b32 s24, s24, 2
    s_lshr_b32 s27, s26, 3
    s_add_u32 s24, s24, s27
    s_add_u32 s28, s23, s24
    s_and_b32 s28, s28, 3
    s_lshl_b32 s30, s20, 12
    s_lshl_b32 s31, s23, 3
    s_lshl_b32 s33, s20, 1
    s_add_u32 s31, s31, s33
    s_lshl_b32 s32, s31, 10
    s_add_u32 s32, s32, s21
    s_add_u32 s32, s32, 0x1b20000
    v_add_u32 v2, 73728, v1
    s_add_u32 s33, s30, 18432
    v_add_u32 v3, s33, v1
    v_add_u32 v0, s33, v2
    s_lshr_b32 s34, s31, 1
    s_lshl_b32 s35, s34, 12
    s_add_u32 s35, s35, s21
    s_add_u32 s35, s35, 0x1b40000
    s_lshl_b32 s36, s24, 8
    s_add_u32 s36, s36, s35
    s_lshl_b32 s38, s24, 6
    s_add_u32 s38, s38, s34
    s_mul_i32 s38, s38, 9216
    s_add_u32 s38, s38, s21
    s_add_u32 s38, s38, 0x900000
    s_add_u32 s39, s38, 4096
    s_add_u32 s46, s38, 8192
    s_mov_b32 s40, 0xc0135761
    s_mov_b32 s42, 0x3d372713
    s_mov_b32 s44, 0x39e38e39
    s_mov_b32 s45, 0x3727c5ac
    v_lshrrev_b32 v4, 1, v1
    s_lshl_b32 s52, s22, 7
    s_add_u32 s52, s52, s23
    s_lshl_b32 s52, s52, 8
    s_add_u32 s52, s52, 0x4509000
    s_add_u32 s52, s52, s4
    s_addc_u32 s53, s5, 0
    s_waitcnt vmcnt(0)
    s_barrier
    s_cmp_lg_u32 s20, 0
    s_cbranch_scc1 L_ns_d3
    s_mov_b32 s56, 1
    s_atomic_add s56, s[50:51], 0
L_ns_d3:
    s_cmp_lg_u32 s20, 0
    s_cbranch_scc1 L_pd_d3
    s_mov_b32 s60, 65536
L_poll_d3:
    s_mov_b32 s57, 0
    s_atomic_add s57, s[52:53], 0 glc
    s_waitcnt lgkmcnt(0)
    s_cmp_ge_u32 s57, 16
    s_cbranch_scc1 L_pd_d3
    s_sub_u32 s60, s60, 1
    s_cbranch_scc1 L_pd_d3
    s_sleep 2
    s_branch L_poll_d3
L_pd_d3:
    s_barrier
    buffer_load_dwordx2 v[8:9], v4, s[4:7], s32 offen offset:0 sc1
    buffer_load_dwordx2 v[10:11], v4, s[4:7], s32 offen offset:512 sc1
    buffer_load_dwordx2 v[12:13], v4, s[4:7], s32 offen offset:1024 sc1
    buffer_load_dwordx2 v[14:15], v4, s[4:7], s32 offen offset:1536 sc1
    s_lshl_b32 s50, s22, 7
    s_add_u32 s50, s50, s23
    s_lshl_b32 s50, s50, 8
    s_add_u32 s50, s50, 0x450a000
    s_add_u32 s50, s50, s4
    s_addc_u32 s51, s5, 0
    s_barrier
    ds_read_b128 v[160:163], v3 offset:0
    ds_read_b128 v[164:167], v3 offset:2048
    ds_read_b128 v[168:171], v1 offset:0
    ds_read_b128 v[172:175], v1 offset:1024
    ds_read_b128 v[176:179], v1 offset:2048
    ds_read_b128 v[180:183], v1 offset:3072
    ds_read_b128 v[184:187], v1 offset:4096
    ds_read_b128 v[188:191], v1 offset:5120
    ds_read_b128 v[192:195], v1 offset:6144
    ds_read_b128 v[196:199], v1 offset:7168
    ds_read_b128 v[200:203], v1 offset:8192
    s_waitcnt lgkmcnt(5)
    v_mfma_f32_16x16x32_bf16 v[16:19], v[160:163], v[168:171], 0
    ds_read_b128 v[204:207], v3 offset:1024
    v_mfma_f32_16x16x32_bf16 v[20:23], v[164:167], v[168:171], 0
    ds_read_b128 v[208:211], v3 offset:3072
    v_mfma_f32_16x16x32_bf16 v[24:27], v[160:163], v[172:175], 0
    ds_read_b128 v[212:215], v1 offset:9216
    v_mfma_f32_16x16x32_bf16 v[28:31], v[164:167], v[172:175], 0
    ds_read_b128 v[216:219], v1 offset:10240
    v_mfma_f32_16x16x32_bf16 v[32:35], v[160:163], v[176:179], 0
    ds_read_b128 v[220:223], v1 offset:11264
    v_mfma_f32_16x16x32_bf16 v[36:39], v[164:167], v[176:179], 0
    ds_read_b128 v[224:227], v1 offset:12288
    v_mfma_f32_16x16x32_bf16 v[40:43], v[160:163], v[180:183], 0
    ds_read_b128 v[228:231], v1 offset:13312
    v_mfma_f32_16x16x32_bf16 v[44:47], v[164:167], v[180:183], 0
    ds_read_b128 v[232:235], v1 offset:14336
    s_waitcnt lgkmcnt(8)
    v_mfma_f32_16x16x32_bf16 v[48:51], v[160:163], v[184:187], 0
    ds_read_b128 v[236:239], v1 offset:15360
    v_mfma_f32_16x16x32_bf16 v[52:55], v[164:167], v[184:187], 0
    ds_read_b128 v[240:243], v1 offset:16384
    v_mfma_f32_16x16x32_bf16 v[56:59], v[160:163], v[188:191], 0
    ds_read_b128 v[244:247], v1 offset:17408
    v_mfma_f32_16x16x32_bf16 v[60:63], v[164:167], v[188:191], 0
    v_mfma_f32_16x16x32_bf16 v[64:67], v[160:163], v[192:195], 0
    v_mfma_f32_16x16x32_bf16 v[68:71], v[164:167], v[192:195], 0
    v_mfma_f32_16x16x32_bf16 v[72:75], v[160:163], v[196:199], 0
    v_mfma_f32_16x16x32_bf16 v[76:79], v[164:167], v[196:199], 0
    v_mfma_f32_16x16x32_bf16 v[80:83], v[160:163], v[200:203], 0
    v_mfma_f32_16x16x32_bf16 v[84:87], v[164:167], v[200:203], 0
    s_waitcnt lgkmcnt(0)
    s_barrier
    v_mfma_f32_16x16x32_bf16 v[16:19], v[204:207], v[212:215], v[16:19]
    ds_read_b128 v[160:163], v3 offset:36864
    v_mfma_f32_16x16x32_bf16 v[20:23], v[208:211], v[212:215], v[20:23]
    ds_read_b128 v[164:167], v3 offset:38912
    v_mfma_f32_16x16x32_bf16 v[24:27], v[204:207], v[216:219], v[24:27]
    ds_read_b128 v[168:171], v1 offset:36864
    v_mfma_f32_16x16x32_bf16 v[28:31], v[208:211], v[216:219], v[28:31]
    ds_read_b128 v[172:175], v1 offset:37888
    v_mfma_f32_16x16x32_bf16 v[32:35], v[204:207], v[220:223], v[32:35]
    ds_read_b128 v[176:179], v1 offset:38912
    v_mfma_f32_16x16x32_bf16 v[36:39], v[208:211], v[220:223], v[36:39]
    ds_read_b128 v[180:183], v1 offset:39936
    v_mfma_f32_16x16x32_bf16 v[40:43], v[204:207], v[224:227], v[40:43]
    ds_read_b128 v[184:187], v1 offset:40960
    v_mfma_f32_16x16x32_bf16 v[44:47], v[208:211], v[224:227], v[44:47]
    ds_read_b128 v[188:191], v1 offset:41984
    v_mfma_f32_16x16x32_bf16 v[48:51], v[204:207], v[228:231], v[48:51]
    ds_read_b128 v[192:195], v1 offset:43008
    v_mfma_f32_16x16x32_bf16 v[52:55], v[208:211], v[228:231], v[52:55]
    ds_read_b128 v[196:199], v1 offset:44032
    v_lshrrev_b32 v5, 8, v1
    v_mfma_f32_16x16x32_bf16 v[56:59], v[204:207], v[232:235], v[56:59]
    ds_read_b128 v[200:203], v1 offset:45056
    v_bfe_u32 v6, v1, 4, 4
    v_mfma_f32_16x16x32_bf16 v[60:63], v[208:211], v[232:235], v[60:63]
    v_lshlrev_b32 v7, 2, v6
    v_mfma_f32_16x16x32_bf16 v[64:67], v[204:207], v[236:239], v[64:67]
    s_lshl_b32 s33, s20, 8
    v_mfma_f32_16x16x32_bf16 v[68:71], v[208:211], v[236:239], v[68:71]
    s_add_u32 s33, s33, 147456
    v_mfma_f32_16x16x32_bf16 v[72:75], v[204:207], v[240:243], v[72:75]
    v_add_u32 v4, s33, v7
    v_mfma_f32_16x16x32_bf16 v[76:79], v[208:211], v[240:243], v[76:79]
    v_lshl_add_u32 v252, v5, 4, s33
    v_mfma_f32_16x16x32_bf16 v[80:83], v[204:207], v[244:247], v[80:83]
    v_add_u32 v7, 159744, v7
    v_mfma_f32_16x16x32_bf16 v[84:87], v[208:211], v[244:247], v[84:87]
    s_waitcnt vmcnt(0)
    v_add_f32 v248, v8, v10
    s_waitcnt lgkmcnt(5)
    v_mfma_f32_16x16x32_bf16 v[16:19], v[160:163], v[168:171], v[16:19]
    ds_read_b128 v[204:207], v3 offset:37888
    v_mfma_f32_16x16x32_bf16 v[20:23], v[164:167], v[168:171], v[20:23]
    ds_read_b128 v[208:211], v3 offset:39936
    v_mfma_f32_16x16x32_bf16 v[24:27], v[160:163], v[172:175], v[24:27]
    ds_read_b128 v[212:215], v1 offset:46080
    v_mfma_f32_16x16x32_bf16 v[28:31], v[164:167], v[172:175], v[28:31]
    ds_read_b128 v[216:219], v1 offset:47104
    v_mfma_f32_16x16x32_bf16 v[32:35], v[160:163], v[176:179], v[32:35]
    ds_read_b128 v[220:223], v1 offset:48128
    v_mfma_f32_16x16x32_bf16 v[36:39], v[164:167], v[176:179], v[36:39]
    ds_read_b128 v[224:227], v1 offset:49152
    v_mfma_f32_16x16x32_bf16 v[40:43], v[160:163], v[180:183], v[40:43]
    ds_read_b128 v[228:231], v1 offset:50176
    v_mfma_f32_16x16x32_bf16 v[44:47], v[164:167], v[180:183], v[44:47]
    ds_read_b128 v[232:235], v1 offset:51200
    s_waitcnt lgkmcnt(8)
    v_mfma_f32_16x16x32_bf16 v[48:51], v[160:163], v[184:187], v[48:51]
    ds_read_b128 v[236:239], v1 offset:52224
    v_mfma_f32_16x16x32_bf16 v[52:55], v[164:167], v[184:187], v[52:55]
    ds_read_b128 v[240:243], v1 offset:53248
    v_add_f32 v249, v9, v11
    v_mfma_f32_16x16x32_bf16 v[56:59], v[160:163], v[188:191], v[56:59]
    ds_read_b128 v[244:247], v1 offset:54272
    v_add_f32 v250, v12, v14
    v_mfma_f32_16x16x32_bf16 v[60:63], v[164:167], v[188:191], v[60:63]
    v_add_f32 v251, v13, v15
    v_mfma_f32_16x16x32_bf16 v[64:67], v[160:163], v[192:195], v[64:67]
    v_mov_b32 v8, v248
    v_mfma_f32_16x16x32_bf16 v[68:71], v[164:167], v[192:195], v[68:71]
    v_mov_b32 v9, v249
    v_mfma_f32_16x16x32_bf16 v[72:75], v[160:163], v[196:199], v[72:75]
    v_mov_b32 v12, v250
    v_mfma_f32_16x16x32_bf16 v[76:79], v[164:167], v[196:199], v[76:79]
    v_mov_b32 v13, v251
    v_mfma_f32_16x16x32_bf16 v[80:83], v[160:163], v[200:203], v[80:83]
    v_permlane32_swap_b32 v248, v8
    v_mfma_f32_16x16x32_bf16 v[84:87], v[164:167], v[200:203], v[84:87]
    v_permlane32_swap_b32 v249, v9
    v_permlane32_swap_b32 v250, v12
    s_waitcnt lgkmcnt(0)
    s_barrier
    v_mfma_f32_16x16x32_bf16 v[16:19], v[204:207], v[212:215], v[16:19]
    ds_read_b128 v[160:163], v0 offset:0
    v_mfma_f32_16x16x32_bf16 v[20:23], v[208:211], v[212:215], v[20:23]
    ds_read_b128 v[164:167], v0 offset:2048
    v_mfma_f32_16x16x32_bf16 v[24:27], v[204:207], v[216:219], v[24:27]
    ds_read_b128 v[168:171], v2 offset:0
    v_mfma_f32_16x16x32_bf16 v[28:31], v[208:211], v[216:219], v[28:31]
    ds_read_b128 v[172:175], v2 offset:1024
    v_mfma_f32_16x16x32_bf16 v[32:35], v[204:207], v[220:223], v[32:35]
    ds_read_b128 v[176:179], v2 offset:2048
    v_mfma_f32_16x16x32_bf16 v[36:39], v[208:211], v[220:223], v[36:39]
    ds_read_b128 v[180:183], v2 offset:3072
    v_mfma_f32_16x16x32_bf16 v[40:43], v[204:207], v[224:227], v[40:43]
    ds_read_b128 v[184:187], v2 offset:4096
    v_mfma_f32_16x16x32_bf16 v[44:47], v[208:211], v[224:227], v[44:47]
    ds_read_b128 v[188:191], v2 offset:5120
    v_mfma_f32_16x16x32_bf16 v[48:51], v[204:207], v[228:231], v[48:51]
    ds_read_b128 v[192:195], v2 offset:6144
    v_mfma_f32_16x16x32_bf16 v[52:55], v[208:211], v[228:231], v[52:55]
    ds_read_b128 v[196:199], v2 offset:7168
    v_permlane32_swap_b32 v251, v13
    v_mfma_f32_16x16x32_bf16 v[56:59], v[204:207], v[232:235], v[56:59]
    ds_read_b128 v[200:203], v2 offset:8192
    v_add_f32 v248, v248, v8
    v_mfma_f32_16x16x32_bf16 v[60:63], v[208:211], v[232:235], v[60:63]
    ds_read2_b32 v[128:129], v7 offset0:0 offset1:16
    v_add_f32 v249, v249, v9
    v_mfma_f32_16x16x32_bf16 v[64:67], v[204:207], v[236:239], v[64:67]
    ds_read2_b32 v[130:131], v7 offset0:32 offset1:48
    v_add_f32 v250, v250, v12
    v_mfma_f32_16x16x32_bf16 v[68:71], v[208:211], v[236:239], v[68:71]
    ds_read2_b32 v[132:133], v7 offset0:64 offset1:80
    v_add_f32 v251, v251, v13
    v_mfma_f32_16x16x32_bf16 v[72:75], v[204:207], v[240:243], v[72:75]
    ds_read2_b32 v[134:135], v7 offset0:96 offset1:112
    v_mov_b32 v8, v248
    v_mfma_f32_16x16x32_bf16 v[76:79], v[208:211], v[240:243], v[76:79]
    ds_read2_b32 v[136:137], v7 offset0:128 offset1:144
    v_mov_b32 v9, v249
    v_mfma_f32_16x16x32_bf16 v[80:83], v[204:207], v[244:247], v[80:83]
    v_mov_b32 v12, v250
    v_mfma_f32_16x16x32_bf16 v[84:87], v[208:211], v[244:247], v[84:87]
    v_mov_b32 v13, v251
    v_permlane16_swap_b32 v248, v8
    s_waitcnt lgkmcnt(10)
    v_mfma_f32_16x16x32_bf16 v[16:19], v[160:163], v[168:171], v[16:19]
    ds_read_b128 v[204:207], v0 offset:1024
    v_mfma_f32_16x16x32_bf16 v[20:23], v[164:167], v[168:171], v[20:23]
    ds_read_b128 v[208:211], v0 offset:3072
    v_mfma_f32_16x16x32_bf16 v[24:27], v[160:163], v[172:175], v[24:27]
    ds_read_b128 v[212:215], v2 offset:9216
    v_mfma_f32_16x16x32_bf16 v[28:31], v[164:167], v[172:175], v[28:31]
    ds_read_b128 v[216:219], v2 offset:10240
    v_mfma_f32_16x16x32_bf16 v[32:35], v[160:163], v[176:179], v[32:35]
    ds_read_b128 v[220:223], v2 offset:11264
    v_mfma_f32_16x16x32_bf16 v[36:39], v[164:167], v[176:179], v[36:39]
    ds_read_b128 v[224:227], v2 offset:12288
    v_mfma_f32_16x16x32_bf16 v[40:43], v[160:163], v[180:183], v[40:43]
    ds_read_b128 v[228:231], v2 offset:13312
    v_mfma_f32_16x16x32_bf16 v[44:47], v[164:167], v[180:183], v[44:47]
    ds_read_b128 v[232:235], v2 offset:14336
    s_waitcnt lgkmcnt(8)
    v_mfma_f32_16x16x32_bf16 v[48:51], v[160:163], v[184:187], v[48:51]
    ds_read_b128 v[236:239], v2 offset:15360
    v_mfma_f32_16x16x32_bf16 v[52:55], v[164:167], v[184:187], v[52:55]
    ds_read_b128 v[240:243], v2 offset:16384
    v_permlane16_swap_b32 v249, v9
    v_mfma_f32_16x16x32_bf16 v[56:59], v[160:163], v[188:191], v[56:59]
    ds_read_b128 v[244:247], v2 offset:17408
    v_permlane16_swap_b32 v250, v12
    v_mfma_f32_16x16x32_bf16 v[60:63], v[164:167], v[188:191], v[60:63]
    v_permlane16_swap_b32 v251, v13
    v_mfma_f32_16x16x32_bf16 v[64:67], v[160:163], v[192:195], v[64:67]
    v_add_f32 v248, v248, v8
    v_mfma_f32_16x16x32_bf16 v[68:71], v[164:167], v[192:195], v[68:71]
    v_add_f32 v249, v249, v9
    v_mfma_f32_16x16x32_bf16 v[72:75], v[160:163], v[196:199], v[72:75]
    v_add_f32 v250, v250, v12
    v_mfma_f32_16x16x32_bf16 v[76:79], v[164:167], v[196:199], v[76:79]
    v_add_f32 v251, v251, v13
    v_mfma_f32_16x16x32_bf16 v[80:83], v[160:163], v[200:203], v[80:83]
    v_mul_f32 v248, 0x3ae38e39, v248
    v_mfma_f32_16x16x32_bf16 v[84:87], v[164:167], v[200:203], v[84:87]
    v_mul_f32 v249, 0x3ae38e39, v249
    v_mul_f32 v250, 0x3ae38e39, v250
    s_waitcnt lgkmcnt(0)
    s_barrier
    v_mfma_f32_16x16x32_bf16 v[16:19], v[204:207], v[212:215], v[16:19]
    ds_read_b128 v[160:163], v0 offset:36864
    v_mfma_f32_16x16x32_bf16 v[20:23], v[208:211], v[212:215], v[20:23]
    ds_read_b128 v[164:167], v0 offset:38912
    v_mfma_f32_16x16x32_bf16 v[24:27], v[204:207], v[216:219], v[24:27]
    ds_read_b128 v[168:171], v2 offset:36864
    v_mfma_f32_16x16x32_bf16 v[28:31], v[208:211], v[216:219], v[28:31]
    ds_read_b128 v[172:175], v2 offset:37888
    v_mfma_f32_16x16x32_bf16 v[32:35], v[204:207], v[220:223], v[32:35]
    ds_read_b128 v[176:179], v2 offset:38912
    v_mfma_f32_16x16x32_bf16 v[36:39], v[208:211], v[220:223], v[36:39]
    ds_read_b128 v[180:183], v2 offset:39936
    v_mfma_f32_16x16x32_bf16 v[40:43], v[204:207], v[224:227], v[40:43]
    ds_read_b128 v[184:187], v2 offset:40960
    v_mfma_f32_16x16x32_bf16 v[44:47], v[208:211], v[224:227], v[44:47]
    ds_read_b128 v[188:191], v2 offset:41984
    v_mfma_f32_16x16x32_bf16 v[48:51], v[204:207], v[228:231], v[48:51]
    ds_read_b128 v[192:195], v2 offset:43008
    v_mfma_f32_16x16x32_bf16 v[52:55], v[208:211], v[228:231], v[52:55]
    ds_read_b128 v[196:199], v2 offset:44032
    v_mul_f32 v251, 0x3ae38e39, v251
    v_mfma_f32_16x16x32_bf16 v[56:59], v[204:207], v[232:235], v[56:59]
    ds_read_b128 v[200:203], v2 offset:45056
    v_fma_f32 v249, -v248, v248, v249
    v_mfma_f32_16x16x32_bf16 v[60:63], v[208:211], v[232:235], v[60:63]
    v_fma_f32 v251, -v250, v250, v251
    v_mfma_f32_16x16x32_bf16 v[64:67], v[204:207], v[236:239], v[64:67]
    v_max_f32 v249, 0, v249
    v_mfma_f32_16x16x32_bf16 v[68:71], v[208:211], v[236:239], v[68:71]
    v_max_f32 v251, 0, v251
    v_mfma_f32_16x16x32_bf16 v[72:75], v[204:207], v[240:243], v[72:75]
    v_add_f32 v249, 0x3727c5ac, v249
    v_mfma_f32_16x16x32_bf16 v[76:79], v[208:211], v[240:243], v[76:79]
    v_add_f32 v251, 0x3727c5ac, v251
    v_mfma_f32_16x16x32_bf16 v[80:83], v[204:207], v[244:247], v[80:83]
    v_rsq_f32 v249, v249
    v_mfma_f32_16x16x32_bf16 v[84:87], v[208:211], v[244:247], v[84:87]
    v_rsq_f32 v251, v251
    s_nop 0
    s_waitcnt lgkmcnt(5)
    v_mfma_f32_16x16x32_bf16 v[16:19], v[160:163], v[168:171], v[16:19]
    ds_read_b128 v[204:207], v0 offset:37888
    v_mfma_f32_16x16x32_bf16 v[20:23], v[164:167], v[168:171], v[20:23]
    ds_read_b128 v[208:211], v0 offset:39936
    v_mfma_f32_16x16x32_bf16 v[24:27], v[160:163], v[172:175], v[24:27]
    ds_read_b128 v[212:215], v2 offset:46080
    v_mfma_f32_16x16x32_bf16 v[28:31], v[164:167], v[172:175], v[28:31]
    ds_read_b128 v[216:219], v2 offset:47104
    v_mfma_f32_16x16x32_bf16 v[32:35], v[160:163], v[176:179], v[32:35]
    ds_read_b128 v[220:223], v2 offset:48128
    v_mfma_f32_16x16x32_bf16 v[36:39], v[164:167], v[176:179], v[36:39]
    ds_read_b128 v[224:227], v2 offset:49152
    v_mfma_f32_16x16x32_bf16 v[40:43], v[160:163], v[180:183], v[40:43]
    ds_read_b128 v[228:231], v2 offset:50176
    v_mfma_f32_16x16x32_bf16 v[44:47], v[164:167], v[180:183], v[44:47]
    ds_read_b128 v[232:235], v2 offset:51200
    s_waitcnt lgkmcnt(8)
    v_mfma_f32_16x16x32_bf16 v[48:51], v[160:163], v[184:187], v[48:51]
    ds_read_b128 v[236:239], v2 offset:52224
    v_mfma_f32_16x16x32_bf16 v[52:55], v[164:167], v[184:187], v[52:55]
    ds_read_b128 v[240:243], v2 offset:53248
    v_mfma_f32_16x16x32_bf16 v[56:59], v[160:163], v[188:191], v[56:59]
    ds_read_b128 v[244:247], v2 offset:54272
    v_mfma_f32_16x16x32_bf16 v[60:63], v[164:167], v[188:191], v[60:63]
    v_mfma_f32_16x16x32_bf16 v[64:67], v[160:163], v[192:195], v[64:67]
    v_mfma_f32_16x16x32_bf16 v[68:71], v[164:167], v[192:195], v[68:71]
    v_mfma_f32_16x16x32_bf16 v[72:75], v[160:163], v[196:199], v[72:75]
    v_mfma_f32_16x16x32_bf16 v[76:79], v[164:167], v[196:199], v[76:79]
    v_mfma_f32_16x16x32_bf16 v[80:83], v[160:163], v[200:203], v[80:83]
    v_mfma_f32_16x16x32_bf16 v[84:87], v[164:167], v[200:203], v[84:87]
    s_waitcnt lgkmcnt(0)
    s_barrier
    v_mfma_f32_16x16x32_bf16 v[16:19], v[204:207], v[212:215], v[16:19]
    ds_read_b128 v[160:163], v3 offset:0
    v_mfma_f32_16x16x32_bf16 v[20:23], v[208:211], v[212:215], v[20:23]
    ds_read_b128 v[164:167], v3 offset:2048
    v_mfma_f32_16x16x32_bf16 v[24:27], v[204:207], v[216:219], v[24:27]
    ds_read_b128 v[168:171], v1 offset:0
    v_mfma_f32_16x16x32_bf16 v[28:31], v[208:211], v[216:219], v[28:31]
    ds_read_b128 v[172:175], v1 offset:1024
    v_mfma_f32_16x16x32_bf16 v[32:35], v[204:207], v[220:223], v[32:35]
    ds_read_b128 v[176:179], v1 offset:2048
    v_mfma_f32_16x16x32_bf16 v[36:39], v[208:211], v[220:223], v[36:39]
    ds_read_b128 v[180:183], v1 offset:3072
    v_mfma_f32_16x16x32_bf16 v[40:43], v[204:207], v[224:227], v[40:43]
    ds_read_b128 v[184:187], v1 offset:4096
    v_mfma_f32_16x16x32_bf16 v[44:47], v[208:211], v[224:227], v[44:47]
    ds_read_b128 v[188:191], v1 offset:5120
    v_mfma_f32_16x16x32_bf16 v[48:51], v[204:207], v[228:231], v[48:51]
    ds_read_b128 v[192:195], v1 offset:6144
    v_mfma_f32_16x16x32_bf16 v[52:55], v[208:211], v[228:231], v[52:55]
    ds_read_b128 v[196:199], v1 offset:7168
    v_mfma_f32_16x16x32_bf16 v[56:59], v[204:207], v[232:235], v[56:59]
    ds_read_b128 v[200:203], v1 offset:8192
    v_mfma_f32_16x16x32_bf16 v[60:63], v[208:211], v[232:235], v[60:63]
    ds_write2_b32 v4, v248, v249 offset0:0 offset1:32
    v_mfma_f32_16x16x32_bf16 v[64:67], v[204:207], v[236:239], v[64:67]
    ds_write2_b32 v4, v250, v251 offset0:16 offset1:48
    v_mfma_f32_16x16x32_bf16 v[68:71], v[208:211], v[236:239], v[68:71]
    ds_read_b128 v[88:91], v252 offset:0
    v_mfma_f32_16x16x32_bf16 v[72:75], v[204:207], v[240:243], v[72:75]
    ds_read_b128 v[92:95], v252 offset:64
    v_mfma_f32_16x16x32_bf16 v[76:79], v[208:211], v[240:243], v[76:79]
    ds_read_b128 v[96:99], v252 offset:128
    v_mfma_f32_16x16x32_bf16 v[80:83], v[204:207], v[244:247], v[80:83]
    ds_read_b128 v[100:103], v252 offset:192
    v_mfma_f32_16x16x32_bf16 v[84:87], v[208:211], v[244:247], v[84:87]
    s_waitcnt lgkmcnt(11)
    v_mfma_f32_16x16x32_bf16 v[16:19], v[160:163], v[168:171], v[16:19]
    ds_read_b128 v[204:207], v3 offset:1024
    v_mfma_f32_16x16x32_bf16 v[20:23], v[164:167], v[168:171], v[20:23]
    ds_read_b128 v[208:211], v3 offset:3072
    v_mfma_f32_16x16x32_bf16 v[24:27], v[160:163], v[172:175], v[24:27]
    ds_read_b128 v[212:215], v1 offset:9216
    v_mfma_f32_16x16x32_bf16 v[28:31], v[164:167], v[172:175], v[28:31]
    ds_read_b128 v[216:219], v1 offset:10240
    v_mfma_f32_16x16x32_bf16 v[32:35], v[160:163], v[176:179], v[32:35]
    ds_read_b128 v[220:223], v1 offset:11264
    v_mfma_f32_16x16x32_bf16 v[36:39], v[164:167], v[176:179], v[36:39]
    ds_read_b128 v[224:227], v1 offset:12288
    v_mfma_f32_16x16x32_bf16 v[40:43], v[160:163], v[180:183], v[40:43]
    ds_read_b128 v[228:231], v1 offset:13312
    v_mfma_f32_16x16x32_bf16 v[44:47], v[164:167], v[180:183], v[44:47]
    ds_read_b128 v[232:235], v1 offset:14336
    s_waitcnt lgkmcnt(8)
    v_mfma_f32_16x16x32_bf16 v[48:51], v[160:163], v[184:187], v[48:51]
    ds_read_b128 v[236:239], v1 offset:15360
    v_mfma_f32_16x16x32_bf16 v[52:55], v[164:167], v[184:187], v[52:55]
    ds_read_b128 v[240:243], v1 offset:16384
    v_rcp_f32 v120, v96
    v_mfma_f32_16x16x32_bf16 v[56:59], v[160:163], v[188:191], v[56:59]
    ds_read_b128 v[244:247], v1 offset:17408
    v_mul_f32 v104, s40, v96
    v_mfma_f32_16x16x32_bf16 v[60:63], v[164:167], v[188:191], v[60:63]
    v_mul_f32 v112, v96, v96
    v_mfma_f32_16x16x32_bf16 v[64:67], v[160:163], v[192:195], v[64:67]
    v_rcp_f32 v121, v97
    v_mfma_f32_16x16x32_bf16 v[68:71], v[164:167], v[192:195], v[68:71]
    v_mul_f32 v105, s40, v97
    v_mfma_f32_16x16x32_bf16 v[72:75], v[160:163], v[196:199], v[72:75]
    v_mul_f32 v113, v97, v97
    v_mfma_f32_16x16x32_bf16 v[76:79], v[164:167], v[196:199], v[76:79]
    v_rcp_f32 v122, v98
    v_mfma_f32_16x16x32_bf16 v[80:83], v[160:163], v[200:203], v[80:83]
    v_mul_f32 v106, s40, v98
    v_mfma_f32_16x16x32_bf16 v[84:87], v[164:167], v[200:203], v[84:87]
    v_mul_f32 v114, v98, v98
    v_rcp_f32 v123, v99
    s_waitcnt lgkmcnt(0)
    s_barrier
    v_mfma_f32_16x16x32_bf16 v[16:19], v[204:207], v[212:215], v[16:19]
    ds_read_b128 v[160:163], v3 offset:36864
    v_mfma_f32_16x16x32_bf16 v[20:23], v[208:211], v[212:215], v[20:23]
    ds_read_b128 v[164:167], v3 offset:38912
    v_mfma_f32_16x16x32_bf16 v[24:27], v[204:207], v[216:219], v[24:27]
    ds_read_b128 v[168:171], v1 offset:36864
    v_mfma_f32_16x16x32_bf16 v[28:31], v[208:211], v[216:219], v[28:31]
    ds_read_b128 v[172:175], v1 offset:37888
    v_mfma_f32_16x16x32_bf16 v[32:35], v[204:207], v[220:223], v[32:35]
    ds_read_b128 v[176:179], v1 offset:38912
    v_mfma_f32_16x16x32_bf16 v[36:39], v[208:211], v[220:223], v[36:39]
    ds_read_b128 v[180:183], v1 offset:39936
    v_mfma_f32_16x16x32_bf16 v[40:43], v[204:207], v[224:227], v[40:43]
    ds_read_b128 v[184:187], v1 offset:40960
    v_mfma_f32_16x16x32_bf16 v[44:47], v[208:211], v[224:227], v[44:47]
    ds_read_b128 v[188:191], v1 offset:41984
    v_mfma_f32_16x16x32_bf16 v[48:51], v[204:207], v[228:231], v[48:51]
    ds_read_b128 v[192:195], v1 offset:43008
    v_mfma_f32_16x16x32_bf16 v[52:55], v[208:211], v[228:231], v[52:55]
    ds_read_b128 v[196:199], v1 offset:44032
    v_mul_f32 v107, s40, v99
    v_mfma_f32_16x16x32_bf16 v[56:59], v[204:207], v[232:235], v[56:59]
    ds_read_b128 v[200:203], v1 offset:45056
    v_mul_f32 v115, v99, v99
    v_mfma_f32_16x16x32_bf16 v[60:63], v[208:211], v[232:235], v[60:63]
    v_rcp_f32 v124, v100
    v_mfma_f32_16x16x32_bf16 v[64:67], v[204:207], v[236:239], v[64:67]
    v_mul_f32 v108, s40, v100
    v_mfma_f32_16x16x32_bf16 v[68:71], v[208:211], v[236:239], v[68:71]
    v_mul_f32 v116, v100, v100
    v_mfma_f32_16x16x32_bf16 v[72:75], v[204:207], v[240:243], v[72:75]
    v_rcp_f32 v125, v101
    v_mfma_f32_16x16x32_bf16 v[76:79], v[208:211], v[240:243], v[76:79]
    v_mul_f32 v109, s40, v101
    v_mfma_f32_16x16x32_bf16 v[80:83], v[204:207], v[244:247], v[80:83]
    v_mul_f32 v117, v101, v101
    v_mfma_f32_16x16x32_bf16 v[84:87], v[208:211], v[244:247], v[84:87]
    v_rcp_f32 v126, v102
    v_mul_f32 v110, s40, v102
    s_waitcnt lgkmcnt(5)
    v_mfma_f32_16x16x32_bf16 v[16:19], v[160:163], v[168:171], v[16:19]
    ds_read_b128 v[204:207], v3 offset:37888
    v_mfma_f32_16x16x32_bf16 v[20:23], v[164:167], v[168:171], v[20:23]
    ds_read_b128 v[208:211], v3 offset:39936
    v_mfma_f32_16x16x32_bf16 v[24:27], v[160:163], v[172:175], v[24:27]
    ds_read_b128 v[212:215], v1 offset:46080
    v_mfma_f32_16x16x32_bf16 v[28:31], v[164:167], v[172:175], v[28:31]
    ds_read_b128 v[216:219], v1 offset:47104
    v_mfma_f32_16x16x32_bf16 v[32:35], v[160:163], v[176:179], v[32:35]
    ds_read_b128 v[220:223], v1 offset:48128
    v_mfma_f32_16x16x32_bf16 v[36:39], v[164:167], v[176:179], v[36:39]
    ds_read_b128 v[224:227], v1 offset:49152
    v_mfma_f32_16x16x32_bf16 v[40:43], v[160:163], v[180:183], v[40:43]
    ds_read_b128 v[228:231], v1 offset:50176
    v_mfma_f32_16x16x32_bf16 v[44:47], v[164:167], v[180:183], v[44:47]
    ds_read_b128 v[232:235], v1 offset:51200
    s_waitcnt lgkmcnt(8)
    v_mfma_f32_16x16x32_bf16 v[48:51], v[160:163], v[184:187], v[48:51]
    ds_read_b128 v[236:239], v1 offset:52224
    v_mfma_f32_16x16x32_bf16 v[52:55], v[164:167], v[184:187], v[52:55]
    ds_read_b128 v[240:243], v1 offset:53248
    v_mul_f32 v118, v102, v102
    v_mfma_f32_16x16x32_bf16 v[56:59], v[160:163], v[188:191], v[56:59]
    ds_read_b128 v[244:247], v1 offset:54272
    v_rcp_f32 v127, v103
    v_mfma_f32_16x16x32_bf16 v[60:63], v[164:167], v[188:191], v[60:63]
    v_mul_f32 v111, s40, v103
    v_mfma_f32_16x16x32_bf16 v[64:67], v[160:163], v[192:195], v[64:67]
    v_mul_f32 v119, v103, v103
    v_mfma_f32_16x16x32_bf16 v[68:71], v[164:167], v[192:195], v[68:71]
    v_mul_f32 v112, s42, v112
    v_mfma_f32_16x16x32_bf16 v[72:75], v[160:163], v[196:199], v[72:75]
    v_mul_f32 v113, s42, v113
    v_mfma_f32_16x16x32_bf16 v[76:79], v[164:167], v[196:199], v[76:79]
    v_mul_f32 v114, s42, v114
    v_mfma_f32_16x16x32_bf16 v[80:83], v[160:163], v[200:203], v[80:83]
    v_mul_f32 v115, s42, v115
    v_mfma_f32_16x16x32_bf16 v[84:87], v[164:167], v[200:203], v[84:87]
    v_mul_f32 v116, s42, v116
    v_mul_f32 v117, s42, v117
    s_waitcnt lgkmcnt(0)
    s_barrier
    v_mfma_f32_16x16x32_bf16 v[16:19], v[204:207], v[212:215], v[16:19]
    ds_read_b128 v[160:163], v0 offset:0
    v_mfma_f32_16x16x32_bf16 v[20:23], v[208:211], v[212:215], v[20:23]
    ds_read_b128 v[164:167], v0 offset:2048
    v_mfma_f32_16x16x32_bf16 v[24:27], v[204:207], v[216:219], v[24:27]
    ds_read_b128 v[168:171], v2 offset:0
    v_mfma_f32_16x16x32_bf16 v[28:31], v[208:211], v[216:219], v[28:31]
    ds_read_b128 v[172:175], v2 offset:1024
    v_mfma_f32_16x16x32_bf16 v[32:35], v[204:207], v[220:223], v[32:35]
    ds_read_b128 v[176:179], v2 offset:2048
    v_mfma_f32_16x16x32_bf16 v[36:39], v[208:211], v[220:223], v[36:39]
    ds_read_b128 v[180:183], v2 offset:3072
    v_mfma_f32_16x16x32_bf16 v[40:43], v[204:207], v[224:227], v[40:43]
    ds_read_b128 v[184:187], v2 offset:4096
    v_mfma_f32_16x16x32_bf16 v[44:47], v[208:211], v[224:227], v[44:47]
    ds_read_b128 v[188:191], v2 offset:5120
    v_mfma_f32_16x16x32_bf16 v[48:51], v[204:207], v[228:231], v[48:51]
    ds_read_b128 v[192:195], v2 offset:6144
    v_mfma_f32_16x16x32_bf16 v[52:55], v[208:211], v[228:231], v[52:55]
    ds_read_b128 v[196:199], v2 offset:7168
    v_mul_f32 v118, s42, v118
    v_mfma_f32_16x16x32_bf16 v[56:59], v[204:207], v[232:235], v[56:59]
    ds_read_b128 v[200:203], v2 offset:8192
    v_mul_f32 v119, s42, v119
    v_mfma_f32_16x16x32_bf16 v[60:63], v[208:211], v[232:235], v[60:63]
    v_mul_f32 v112, v112, v104
    v_mfma_f32_16x16x32_bf16 v[64:67], v[204:207], v[236:239], v[64:67]
    v_mul_f32 v113, v113, v105
    v_mfma_f32_16x16x32_bf16 v[68:71], v[208:211], v[236:239], v[68:71]
    v_mul_f32 v114, v114, v106
    v_mfma_f32_16x16x32_bf16 v[72:75], v[204:207], v[240:243], v[72:75]
    v_mul_f32 v115, v115, v107
    v_mfma_f32_16x16x32_bf16 v[76:79], v[208:211], v[240:243], v[76:79]
    v_mul_f32 v116, v116, v108
    v_mfma_f32_16x16x32_bf16 v[80:83], v[204:207], v[244:247], v[80:83]
    v_mul_f32 v117, v117, v109
    v_mfma_f32_16x16x32_bf16 v[84:87], v[208:211], v[244:247], v[84:87]
    v_mul_f32 v118, v118, v110
    v_mul_f32 v119, v119, v111
    s_waitcnt lgkmcnt(5)
    v_mfma_f32_16x16x32_bf16 v[16:19], v[160:163], v[168:171], v[16:19]
    ds_read_b128 v[204:207], v0 offset:1024
    v_mfma_f32_16x16x32_bf16 v[20:23], v[164:167], v[168:171], v[20:23]
    ds_read_b128 v[208:211], v0 offset:3072
    v_mfma_f32_16x16x32_bf16 v[24:27], v[160:163], v[172:175], v[24:27]
    ds_read_b128 v[212:215], v2 offset:9216
    v_mfma_f32_16x16x32_bf16 v[28:31], v[164:167], v[172:175], v[28:31]
    ds_read_b128 v[216:219], v2 offset:10240
    v_mfma_f32_16x16x32_bf16 v[32:35], v[160:163], v[176:179], v[32:35]
    ds_read_b128 v[220:223], v2 offset:11264
    v_mfma_f32_16x16x32_bf16 v[36:39], v[164:167], v[176:179], v[36:39]
    ds_read_b128 v[224:227], v2 offset:12288
    v_mfma_f32_16x16x32_bf16 v[40:43], v[160:163], v[180:183], v[40:43]
    ds_read_b128 v[228:231], v2 offset:13312
    v_mfma_f32_16x16x32_bf16 v[44:47], v[164:167], v[180:183], v[44:47]
    ds_read_b128 v[232:235], v2 offset:14336
    s_waitcnt lgkmcnt(8)
    v_mfma_f32_16x16x32_bf16 v[48:51], v[160:163], v[184:187], v[48:51]
    ds_read_b128 v[236:239], v2 offset:15360
    v_mfma_f32_16x16x32_bf16 v[52:55], v[164:167], v[184:187], v[52:55]
    ds_read_b128 v[240:243], v2 offset:16384
    v_lshrrev_b32 v8, 2, v6
    v_mfma_f32_16x16x32_bf16 v[56:59], v[160:163], v[188:191], v[56:59]
    ds_read_b128 v[244:247], v2 offset:17408
    v_lshlrev_b32 v8, 4, v8
    v_mfma_f32_16x16x32_bf16 v[60:63], v[164:167], v[188:191], v[60:63]
    v_lshl_add_u32 v8, v5, 6, v8
    v_mfma_f32_16x16x32_bf16 v[64:67], v[160:163], v[192:195], v[64:67]
    v_and_b32 v9, 3, v6
    v_mfma_f32_16x16x32_bf16 v[68:71], v[164:167], v[192:195], v[68:71]
    v_cmp_eq_u32 vcc, 0, v9
    v_mfma_f32_16x16x32_bf16 v[72:75], v[160:163], v[196:199], v[72:75]
    v_bfrev_b32 v10, 1
    v_mfma_f32_16x16x32_bf16 v[76:79], v[164:167], v[196:199], v[76:79]
    v_lshlrev_b32 v9, 4, v9
    v_mfma_f32_16x16x32_bf16 v[80:83], v[160:163], v[200:203], v[80:83]
    v_cndmask_b32 v8, v10, v8, vcc
    v_mfma_f32_16x16x32_bf16 v[84:87], v[164:167], v[200:203], v[84:87]
    v_lshl_add_u32 v9, v5, 6, v9
    v_lshrrev_b32 v255, 2, v6
    s_waitcnt lgkmcnt(0)
    s_barrier
    v_mfma_f32_16x16x32_bf16 v[16:19], v[204:207], v[212:215], v[16:19]
    ds_read_b128 v[160:163], v0 offset:36864
    v_fma_f32 v52, -v92, v132, v52
    v_mfma_f32_16x16x32_bf16 v[20:23], v[208:211], v[212:215], v[20:23]
    ds_read_b128 v[164:167], v0 offset:38912
    v_fma_f32 v56, -v88, v133, v56
    v_mfma_f32_16x16x32_bf16 v[24:27], v[204:207], v[216:219], v[24:27]
    ds_read_b128 v[168:171], v2 offset:36864
    v_fma_f32 v60, -v92, v133, v60
    v_mfma_f32_16x16x32_bf16 v[28:31], v[208:211], v[216:219], v[28:31]
    ds_read_b128 v[172:175], v2 offset:37888
    v_fma_f32 v64, -v88, v134, v64
    v_mfma_f32_16x16x32_bf16 v[32:35], v[204:207], v[220:223], v[32:35]
    ds_read_b128 v[176:179], v2 offset:38912
    v_fma_f32 v68, -v92, v134, v68
    v_mfma_f32_16x16x32_bf16 v[36:39], v[208:211], v[220:223], v[36:39]
    ds_read_b128 v[180:183], v2 offset:39936
    v_fma_f32 v72, -v88, v135, v72
    v_mfma_f32_16x16x32_bf16 v[40:43], v[204:207], v[224:227], v[40:43]
    ds_read_b128 v[184:187], v2 offset:40960
    v_fma_f32 v76, -v92, v135, v76
    v_mfma_f32_16x16x32_bf16 v[44:47], v[208:211], v[224:227], v[44:47]
    ds_read_b128 v[188:191], v2 offset:41984
    v_fma_f32 v80, -v88, v136, v80
    v_mfma_f32_16x16x32_bf16 v[48:51], v[204:207], v[228:231], v[48:51]
    ds_read_b128 v[192:195], v2 offset:43008
    v_fma_f32 v84, -v92, v136, v84
    v_mfma_f32_16x16x32_bf16 v[52:55], v[208:211], v[228:231], v[52:55]
    ds_read_b128 v[196:199], v2 offset:44032
    v_lshl_add_u32 v255, v255, 8, v9
    v_fma_f32 v16, -v88, v128, v16
    v_mfma_f32_16x16x32_bf16 v[56:59], v[204:207], v[232:235], v[56:59]
    ds_read_b128 v[200:203], v2 offset:45056
    v_fma_f32 v20, -v92, v128, v20
    v_mfma_f32_16x16x32_bf16 v[60:63], v[208:211], v[232:235], v[60:63]
    v_fma_f32 v24, -v88, v129, v24
    v_mfma_f32_16x16x32_bf16 v[64:67], v[204:207], v[236:239], v[64:67]
    v_fma_f32 v28, -v92, v129, v28
    v_mfma_f32_16x16x32_bf16 v[68:71], v[208:211], v[236:239], v[68:71]
    v_fma_f32 v32, -v88, v130, v32
    v_mfma_f32_16x16x32_bf16 v[72:75], v[204:207], v[240:243], v[72:75]
    v_fma_f32 v36, -v92, v130, v36
    v_mfma_f32_16x16x32_bf16 v[76:79], v[208:211], v[240:243], v[76:79]
    v_fma_f32 v40, -v88, v131, v40
    v_mfma_f32_16x16x32_bf16 v[80:83], v[204:207], v[244:247], v[80:83]
    v_fma_f32 v44, -v92, v131, v44
    v_mfma_f32_16x16x32_bf16 v[84:87], v[208:211], v[244:247], v[84:87]
    v_fma_f32 v48, -v88, v132, v48
    s_waitcnt lgkmcnt(5)
    v_mfma_f32_16x16x32_bf16 v[16:19], v[160:163], v[168:171], v[16:19]
    ds_read_b128 v[204:207], v0 offset:37888
    v_fma_f32 v53, -v93, v132, v53
    v_mfma_f32_16x16x32_bf16 v[20:23], v[164:167], v[168:171], v[20:23]
    ds_read_b128 v[208:211], v0 offset:39936
    v_fma_f32 v57, -v89, v133, v57
    v_mfma_f32_16x16x32_bf16 v[24:27], v[160:163], v[172:175], v[24:27]
    ds_read_b128 v[212:215], v2 offset:46080
    v_fma_f32 v61, -v93, v133, v61
    v_mfma_f32_16x16x32_bf16 v[28:31], v[164:167], v[172:175], v[28:31]
    ds_read_b128 v[216:219], v2 offset:47104
    v_fma_f32 v65, -v89, v134, v65
    v_mfma_f32_16x16x32_bf16 v[32:35], v[160:163], v[176:179], v[32:35]
    ds_read_b128 v[220:223], v2 offset:48128
    v_fma_f32 v69, -v93, v134, v69
    v_mfma_f32_16x16x32_bf16 v[36:39], v[164:167], v[176:179], v[36:39]
    ds_read_b128 v[224:227], v2 offset:49152
    v_fma_f32 v73, -v89, v135, v73
    v_mfma_f32_16x16x32_bf16 v[40:43], v[160:163], v[180:183], v[40:43]
    ds_read_b128 v[228:231], v2 offset:50176
    v_fma_f32 v77, -v93, v135, v77
    v_mfma_f32_16x16x32_bf16 v[44:47], v[164:167], v[180:183], v[44:47]
    ds_read_b128 v[232:235], v2 offset:51200
    s_waitcnt lgkmcnt(8)
    v_fma_f32 v81, -v89, v136, v81
    v_mfma_f32_16x16x32_bf16 v[48:51], v[160:163], v[184:187], v[48:51]
    ds_read_b128 v[236:239], v2 offset:52224
    v_fma_f32 v85, -v93, v136, v85
    v_mfma_f32_16x16x32_bf16 v[52:55], v[164:167], v[184:187], v[52:55]
    ds_read_b128 v[240:243], v2 offset:53248
    v_fma_f32 v17, -v89, v128, v17
    v_mfma_f32_16x16x32_bf16 v[56:59], v[160:163], v[188:191], v[56:59]
    ds_read_b128 v[244:247], v2 offset:54272
    v_fma_f32 v21, -v93, v128, v21
    v_mfma_f32_16x16x32_bf16 v[60:63], v[164:167], v[188:191], v[60:63]
    v_fma_f32 v25, -v89, v129, v25
    v_mfma_f32_16x16x32_bf16 v[64:67], v[160:163], v[192:195], v[64:67]
    v_fma_f32 v29, -v93, v129, v29
    v_mfma_f32_16x16x32_bf16 v[68:71], v[164:167], v[192:195], v[68:71]
    v_fma_f32 v33, -v89, v130, v33
    v_mfma_f32_16x16x32_bf16 v[72:75], v[160:163], v[196:199], v[72:75]
    v_fma_f32 v37, -v93, v130, v37
    v_mfma_f32_16x16x32_bf16 v[76:79], v[164:167], v[196:199], v[76:79]
    v_fma_f32 v41, -v89, v131, v41
    v_mfma_f32_16x16x32_bf16 v[80:83], v[160:163], v[200:203], v[80:83]
    v_fma_f32 v45, -v93, v131, v45
    v_mfma_f32_16x16x32_bf16 v[84:87], v[164:167], v[200:203], v[84:87]
    v_fma_f32 v49, -v89, v132, v49
    s_waitcnt lgkmcnt(0)
    s_barrier
    v_mfma_f32_16x16x32_bf16 v[16:19], v[204:207], v[212:215], v[16:19]
    ds_read_b128 v[160:163], v3 offset:0
    v_fma_f32 v54, -v94, v132, v54
    v_mfma_f32_16x16x32_bf16 v[20:23], v[208:211], v[212:215], v[20:23]
    ds_read_b128 v[164:167], v3 offset:2048
    v_fma_f32 v58, -v90, v133, v58
    v_mfma_f32_16x16x32_bf16 v[24:27], v[204:207], v[216:219], v[24:27]
    ds_read_b128 v[168:171], v1 offset:0
    v_fma_f32 v62, -v94, v133, v62
    v_mfma_f32_16x16x32_bf16 v[28:31], v[208:211], v[216:219], v[28:31]
    ds_read_b128 v[172:175], v1 offset:1024
    v_fma_f32 v66, -v90, v134, v66
    v_mfma_f32_16x16x32_bf16 v[32:35], v[204:207], v[220:223], v[32:35]
    ds_read_b128 v[176:179], v1 offset:2048
    v_fma_f32 v70, -v94, v134, v70
    v_mfma_f32_16x16x32_bf16 v[36:39], v[208:211], v[220:223], v[36:39]
    ds_read_b128 v[180:183], v1 offset:3072
    v_fma_f32 v74, -v90, v135, v74
    v_mfma_f32_16x16x32_bf16 v[40:43], v[204:207], v[224:227], v[40:43]
    ds_read_b128 v[184:187], v1 offset:4096
    v_fma_f32 v78, -v94, v135, v78
    v_mfma_f32_16x16x32_bf16 v[44:47], v[208:211], v[224:227], v[44:47]
    ds_read_b128 v[188:191], v1 offset:5120
    v_fma_f32 v82, -v90, v136, v82
    v_mfma_f32_16x16x32_bf16 v[48:51], v[204:207], v[228:231], v[48:51]
    ds_read_b128 v[192:195], v1 offset:6144
    v_fma_f32 v86, -v94, v136, v86
    v_mfma_f32_16x16x32_bf16 v[52:55], v[208:211], v[228:231], v[52:55]
    ds_read_b128 v[196:199], v1 offset:7168
    v_fma_f32 v18, -v90, v128, v18
    v_mfma_f32_16x16x32_bf16 v[56:59], v[204:207], v[232:235], v[56:59]
    ds_read_b128 v[200:203], v1 offset:8192
    v_fma_f32 v22, -v94, v128, v22
    v_mfma_f32_16x16x32_bf16 v[60:63], v[208:211], v[232:235], v[60:63]
    v_fma_f32 v26, -v90, v129, v26
    v_mfma_f32_16x16x32_bf16 v[64:67], v[204:207], v[236:239], v[64:67]
    v_fma_f32 v30, -v94, v129, v30
    v_mfma_f32_16x16x32_bf16 v[68:71], v[208:211], v[236:239], v[68:71]
    v_fma_f32 v34, -v90, v130, v34
    v_mfma_f32_16x16x32_bf16 v[72:75], v[204:207], v[240:243], v[72:75]
    v_fma_f32 v38, -v94, v130, v38
    v_mfma_f32_16x16x32_bf16 v[76:79], v[208:211], v[240:243], v[76:79]
    v_fma_f32 v42, -v90, v131, v42
    v_mfma_f32_16x16x32_bf16 v[80:83], v[204:207], v[244:247], v[80:83]
    v_fma_f32 v46, -v94, v131, v46
    v_mfma_f32_16x16x32_bf16 v[84:87], v[208:211], v[244:247], v[84:87]
    v_fma_f32 v50, -v90, v132, v50
    s_waitcnt lgkmcnt(5)
    v_mfma_f32_16x16x32_bf16 v[16:19], v[160:163], v[168:171], v[16:19]
    ds_read_b128 v[204:207], v3 offset:1024
    v_fma_f32 v55, -v95, v132, v55
    v_mfma_f32_16x16x32_bf16 v[20:23], v[164:167], v[168:171], v[20:23]
    ds_read_b128 v[208:211], v3 offset:3072
    v_fma_f32 v59, -v91, v133, v59
    v_mfma_f32_16x16x32_bf16 v[24:27], v[160:163], v[172:175], v[24:27]
    ds_read_b128 v[212:215], v1 offset:9216
    v_fma_f32 v63, -v95, v133, v63
    v_mfma_f32_16x16x32_bf16 v[28:31], v[164:167], v[172:175], v[28:31]
    ds_read_b128 v[216:219], v1 offset:10240
    v_fma_f32 v67, -v91, v134, v67
    v_mfma_f32_16x16x32_bf16 v[32:35], v[160:163], v[176:179], v[32:35]
    ds_read_b128 v[220:223], v1 offset:11264
    v_fma_f32 v71, -v95, v134, v71
    v_mfma_f32_16x16x32_bf16 v[36:39], v[164:167], v[176:179], v[36:39]
    ds_read_b128 v[224:227], v1 offset:12288
    v_fma_f32 v75, -v91, v135, v75
    v_mfma_f32_16x16x32_bf16 v[40:43], v[160:163], v[180:183], v[40:43]
    ds_read_b128 v[228:231], v1 offset:13312
    v_fma_f32 v79, -v95, v135, v79
    v_mfma_f32_16x16x32_bf16 v[44:47], v[164:167], v[180:183], v[44:47]
    ds_read_b128 v[232:235], v1 offset:14336
    s_waitcnt lgkmcnt(8)
    v_fma_f32 v83, -v91, v136, v83
    v_mfma_f32_16x16x32_bf16 v[48:51], v[160:163], v[184:187], v[48:51]
    ds_read_b128 v[236:239], v1 offset:15360
    v_fma_f32 v87, -v95, v136, v87
    v_mfma_f32_16x16x32_bf16 v[52:55], v[164:167], v[184:187], v[52:55]
    ds_read_b128 v[240:243], v1 offset:16384
    v_fma_f32 v19, -v91, v128, v19
    v_mfma_f32_16x16x32_bf16 v[56:59], v[160:163], v[188:191], v[56:59]
    ds_read_b128 v[244:247], v1 offset:17408
    v_fma_f32 v23, -v95, v128, v23
    v_mfma_f32_16x16x32_bf16 v[60:63], v[164:167], v[188:191], v[60:63]
    v_fma_f32 v27, -v91, v129, v27
    v_mfma_f32_16x16x32_bf16 v[64:67], v[160:163], v[192:195], v[64:67]
    v_fma_f32 v31, -v95, v129, v31
    v_mfma_f32_16x16x32_bf16 v[68:71], v[164:167], v[192:195], v[68:71]
    v_fma_f32 v35, -v91, v130, v35
    v_mfma_f32_16x16x32_bf16 v[72:75], v[160:163], v[196:199], v[72:75]
    v_fma_f32 v39, -v95, v130, v39
    v_mfma_f32_16x16x32_bf16 v[76:79], v[164:167], v[196:199], v[76:79]
    v_fma_f32 v43, -v91, v131, v43
    v_mfma_f32_16x16x32_bf16 v[80:83], v[160:163], v[200:203], v[80:83]
    v_fma_f32 v47, -v95, v131, v47
    v_mfma_f32_16x16x32_bf16 v[84:87], v[164:167], v[200:203], v[84:87]
    v_fma_f32 v51, -v91, v132, v51
    s_waitcnt lgkmcnt(0)
    s_barrier
    v_mfma_f32_16x16x32_bf16 v[16:19], v[204:207], v[212:215], v[16:19]
    ds_read_b128 v[160:163], v3 offset:36864
    v_mfma_f32_16x16x32_bf16 v[20:23], v[208:211], v[212:215], v[20:23]
    ds_read_b128 v[164:167], v3 offset:38912
    v_mfma_f32_16x16x32_bf16 v[24:27], v[204:207], v[216:219], v[24:27]
    ds_read_b128 v[168:171], v1 offset:36864
    v_mfma_f32_16x16x32_bf16 v[28:31], v[208:211], v[216:219], v[28:31]
    ds_read_b128 v[172:175], v1 offset:37888
    v_mfma_f32_16x16x32_bf16 v[32:35], v[204:207], v[220:223], v[32:35]
    ds_read_b128 v[176:179], v1 offset:38912
    v_mfma_f32_16x16x32_bf16 v[36:39], v[208:211], v[220:223], v[36:39]
    ds_read_b128 v[180:183], v1 offset:39936
    v_mfma_f32_16x16x32_bf16 v[40:43], v[204:207], v[224:227], v[40:43]
    ds_read_b128 v[184:187], v1 offset:40960
    v_mfma_f32_16x16x32_bf16 v[44:47], v[208:211], v[224:227], v[44:47]
    ds_read_b128 v[188:191], v1 offset:41984
    v_mfma_f32_16x16x32_bf16 v[48:51], v[204:207], v[228:231], v[48:51]
    ds_read_b128 v[192:195], v1 offset:43008
    v_mfma_f32_16x16x32_bf16 v[52:55], v[208:211], v[228:231], v[52:55]
    ds_read_b128 v[196:199], v1 offset:44032
    v_mfma_f32_16x16x32_bf16 v[56:59], v[204:207], v[232:235], v[56:59]
    ds_read_b128 v[200:203], v1 offset:45056
    v_mfma_f32_16x16x32_bf16 v[60:63], v[208:211], v[232:235], v[60:63]
    v_mfma_f32_16x16x32_bf16 v[64:67], v[204:207], v[236:239], v[64:67]
    v_mfma_f32_16x16x32_bf16 v[68:71], v[208:211], v[236:239], v[68:71]
    v_mfma_f32_16x16x32_bf16 v[72:75], v[204:207], v[240:243], v[72:75]
    v_mfma_f32_16x16x32_bf16 v[76:79], v[208:211], v[240:243], v[76:79]
    v_mfma_f32_16x16x32_bf16 v[80:83], v[204:207], v[244:247], v[80:83]
    v_mfma_f32_16x16x32_bf16 v[84:87], v[208:211], v[244:247], v[84:87]
    v_pk_mul_f32 v[220:221], v[16:17], v[16:17]
    v_pk_mul_f32 v[222:223], v[18:19], v[18:19]
    v_pk_mul_f32 v[224:225], v[20:21], v[20:21]
    v_pk_mul_f32 v[226:227], v[22:23], v[22:23]
    v_pk_fma_f32 v[220:221], v[220:221], v[112:113], v[104:105]
    v_pk_fma_f32 v[222:223], v[222:223], v[114:115], v[106:107]
    v_pk_fma_f32 v[224:225], v[224:225], v[116:117], v[108:109]
    v_pk_fma_f32 v[226:227], v[226:227], v[118:119], v[110:111]
    v_pk_mul_f32 v[220:221], v[220:221], v[16:17]
    v_pk_mul_f32 v[222:223], v[222:223], v[18:19]
    v_pk_mul_f32 v[224:225], v[224:225], v[20:21]
    v_pk_mul_f32 v[226:227], v[226:227], v[22:23]
    v_exp_f32 v220, v220
    v_exp_f32 v221, v221
    v_exp_f32 v222, v222
    v_exp_f32 v223, v223
    v_exp_f32 v224, v224
    v_exp_f32 v225, v225
    v_exp_f32 v226, v226
    v_exp_f32 v227, v227
    v_pk_fma_f32 v[220:221], v[220:221], v[120:121], v[120:121]
    v_pk_fma_f32 v[222:223], v[222:223], v[122:123], v[122:123]
    v_pk_fma_f32 v[224:225], v[224:225], v[124:125], v[124:125]
    v_pk_fma_f32 v[226:227], v[226:227], v[126:127], v[126:127]
    v_rcp_f32 v220, v220
    v_rcp_f32 v221, v221
    v_rcp_f32 v222, v222
    v_rcp_f32 v223, v223
    v_rcp_f32 v224, v224
    v_rcp_f32 v225, v225
    v_rcp_f32 v226, v226
    v_rcp_f32 v227, v227
    v_pk_mul_f32 v[16:17], v[16:17], v[220:221]
    v_pk_mul_f32 v[18:19], v[18:19], v[222:223]
    v_pk_mul_f32 v[20:21], v[20:21], v[224:225]
    v_pk_mul_f32 v[22:23], v[22:23], v[226:227]
    v_pk_mul_f32 v[206:207], v[16:17], v[16:17]
    v_pk_mul_f32 v[210:211], v[18:19], v[18:19]
    v_pk_mul_f32 v[214:215], v[20:21], v[20:21]
    v_pk_mul_f32 v[218:219], v[22:23], v[22:23]
    v_pk_mul_f32 v[228:229], v[24:25], v[24:25]
    v_pk_mul_f32 v[230:231], v[26:27], v[26:27]
    v_pk_mul_f32 v[232:233], v[28:29], v[28:29]
    v_pk_mul_f32 v[234:235], v[30:31], v[30:31]
    v_pk_fma_f32 v[228:229], v[228:229], v[112:113], v[104:105]
    v_pk_fma_f32 v[230:231], v[230:231], v[114:115], v[106:107]
    v_pk_fma_f32 v[232:233], v[232:233], v[116:117], v[108:109]
    v_pk_fma_f32 v[234:235], v[234:235], v[118:119], v[110:111]
    v_pk_mul_f32 v[228:229], v[228:229], v[24:25]
    v_pk_mul_f32 v[230:231], v[230:231], v[26:27]
    v_pk_mul_f32 v[232:233], v[232:233], v[28:29]
    v_pk_mul_f32 v[234:235], v[234:235], v[30:31]
    v_exp_f32 v228, v228
    v_exp_f32 v229, v229
    v_exp_f32 v230, v230
    v_exp_f32 v231, v231
    v_exp_f32 v232, v232
    v_exp_f32 v233, v233
    v_exp_f32 v234, v234
    v_exp_f32 v235, v235
    v_pk_fma_f32 v[228:229], v[228:229], v[120:121], v[120:121]
    v_pk_fma_f32 v[230:231], v[230:231], v[122:123], v[122:123]
    v_pk_fma_f32 v[232:233], v[232:233], v[124:125], v[124:125]
    v_pk_fma_f32 v[234:235], v[234:235], v[126:127], v[126:127]
    v_rcp_f32 v228, v228
    v_rcp_f32 v229, v229
    v_rcp_f32 v230, v230
    v_rcp_f32 v231, v231
    v_rcp_f32 v232, v232
    v_rcp_f32 v233, v233
    v_rcp_f32 v234, v234
    v_rcp_f32 v235, v235
    v_pk_mul_f32 v[24:25], v[24:25], v[228:229]
    v_pk_mul_f32 v[26:27], v[26:27], v[230:231]
    v_pk_mul_f32 v[28:29], v[28:29], v[232:233]
    v_pk_mul_f32 v[30:31], v[30:31], v[234:235]
    v_pk_add_f32 v[204:205], v[16:17], v[24:25]
    v_pk_fma_f32 v[206:207], v[24:25], v[24:25], v[206:207]
    v_pk_add_f32 v[208:209], v[18:19], v[26:27]
    v_pk_fma_f32 v[210:211], v[26:27], v[26:27], v[210:211]
    v_pk_add_f32 v[212:213], v[20:21], v[28:29]
    v_pk_fma_f32 v[214:215], v[28:29], v[28:29], v[214:215]
    v_pk_add_f32 v[216:217], v[22:23], v[30:31]
    v_pk_fma_f32 v[218:219], v[30:31], v[30:31], v[218:219]
    v_pk_mul_f32 v[220:221], v[32:33], v[32:33]
    v_pk_mul_f32 v[222:223], v[34:35], v[34:35]
    v_pk_mul_f32 v[224:225], v[36:37], v[36:37]
    v_pk_mul_f32 v[226:227], v[38:39], v[38:39]
    v_pk_fma_f32 v[220:221], v[220:221], v[112:113], v[104:105]
    v_pk_fma_f32 v[222:223], v[222:223], v[114:115], v[106:107]
    v_pk_fma_f32 v[224:225], v[224:225], v[116:117], v[108:109]
    v_pk_fma_f32 v[226:227], v[226:227], v[118:119], v[110:111]
    v_pk_mul_f32 v[220:221], v[220:221], v[32:33]
    v_pk_mul_f32 v[222:223], v[222:223], v[34:35]
    v_pk_mul_f32 v[224:225], v[224:225], v[36:37]
    v_pk_mul_f32 v[226:227], v[226:227], v[38:39]
    v_exp_f32 v220, v220
    v_exp_f32 v221, v221
    v_exp_f32 v222, v222
    v_exp_f32 v223, v223
    v_exp_f32 v224, v224
    v_exp_f32 v225, v225
    v_exp_f32 v226, v226
    v_exp_f32 v227, v227
    v_pk_fma_f32 v[220:221], v[220:221], v[120:121], v[120:121]
    v_pk_fma_f32 v[222:223], v[222:223], v[122:123], v[122:123]
    v_pk_fma_f32 v[224:225], v[224:225], v[124:125], v[124:125]
    v_pk_fma_f32 v[226:227], v[226:227], v[126:127], v[126:127]
    v_rcp_f32 v220, v220
    v_rcp_f32 v221, v221
    v_rcp_f32 v222, v222
    v_rcp_f32 v223, v223
    v_rcp_f32 v224, v224
    v_rcp_f32 v225, v225
    v_rcp_f32 v226, v226
    v_rcp_f32 v227, v227
    v_pk_mul_f32 v[32:33], v[32:33], v[220:221]
    v_pk_mul_f32 v[34:35], v[34:35], v[222:223]
    v_pk_mul_f32 v[36:37], v[36:37], v[224:225]
    v_pk_mul_f32 v[38:39], v[38:39], v[226:227]
    v_pk_add_f32 v[204:205], v[204:205], v[32:33]
    v_pk_fma_f32 v[206:207], v[32:33], v[32:33], v[206:207]
    v_pk_add_f32 v[208:209], v[208:209], v[34:35]
    v_pk_fma_f32 v[210:211], v[34:35], v[34:35], v[210:211]
    v_pk_add_f32 v[212:213], v[212:213], v[36:37]
    v_pk_fma_f32 v[214:215], v[36:37], v[36:37], v[214:215]
    v_pk_add_f32 v[216:217], v[216:217], v[38:39]
    v_pk_fma_f32 v[218:219], v[38:39], v[38:39], v[218:219]
    v_pk_mul_f32 v[228:229], v[40:41], v[40:41]
    v_pk_mul_f32 v[230:231], v[42:43], v[42:43]
    v_pk_mul_f32 v[232:233], v[44:45], v[44:45]
    v_pk_mul_f32 v[234:235], v[46:47], v[46:47]
    v_pk_fma_f32 v[228:229], v[228:229], v[112:113], v[104:105]
    v_pk_fma_f32 v[230:231], v[230:231], v[114:115], v[106:107]
    v_pk_fma_f32 v[232:233], v[232:233], v[116:117], v[108:109]
    v_pk_fma_f32 v[234:235], v[234:235], v[118:119], v[110:111]
    v_pk_mul_f32 v[228:229], v[228:229], v[40:41]
    v_pk_mul_f32 v[230:231], v[230:231], v[42:43]
    v_pk_mul_f32 v[232:233], v[232:233], v[44:45]
    v_pk_mul_f32 v[234:235], v[234:235], v[46:47]
    v_exp_f32 v228, v228
    v_exp_f32 v229, v229
    v_exp_f32 v230, v230
    v_exp_f32 v231, v231
    v_exp_f32 v232, v232
    v_exp_f32 v233, v233
    v_exp_f32 v234, v234
    v_exp_f32 v235, v235
    v_pk_fma_f32 v[228:229], v[228:229], v[120:121], v[120:121]
    v_pk_fma_f32 v[230:231], v[230:231], v[122:123], v[122:123]
    v_pk_fma_f32 v[232:233], v[232:233], v[124:125], v[124:125]
    v_pk_fma_f32 v[234:235], v[234:235], v[126:127], v[126:127]
    v_rcp_f32 v228, v228
    v_rcp_f32 v229, v229
    v_rcp_f32 v230, v230
    v_rcp_f32 v231, v231
    v_rcp_f32 v232, v232
    v_rcp_f32 v233, v233
    v_rcp_f32 v234, v234
    v_rcp_f32 v235, v235
    v_pk_mul_f32 v[40:41], v[40:41], v[228:229]
    v_pk_mul_f32 v[42:43], v[42:43], v[230:231]
    v_pk_mul_f32 v[44:45], v[44:45], v[232:233]
    v_pk_mul_f32 v[46:47], v[46:47], v[234:235]
    v_pk_add_f32 v[204:205], v[204:205], v[40:41]
    v_pk_fma_f32 v[206:207], v[40:41], v[40:41], v[206:207]
    v_pk_add_f32 v[208:209], v[208:209], v[42:43]
    v_pk_fma_f32 v[210:211], v[42:43], v[42:43], v[210:211]
    v_pk_add_f32 v[212:213], v[212:213], v[44:45]
    v_pk_fma_f32 v[214:215], v[44:45], v[44:45], v[214:215]
    v_pk_add_f32 v[216:217], v[216:217], v[46:47]
    v_pk_fma_f32 v[218:219], v[46:47], v[46:47], v[218:219]
    v_pk_mul_f32 v[220:221], v[48:49], v[48:49]
    v_pk_mul_f32 v[222:223], v[50:51], v[50:51]
    v_pk_mul_f32 v[224:225], v[52:53], v[52:53]
    v_pk_mul_f32 v[226:227], v[54:55], v[54:55]
    v_pk_fma_f32 v[220:221], v[220:221], v[112:113], v[104:105]
    v_pk_fma_f32 v[222:223], v[222:223], v[114:115], v[106:107]
    v_pk_fma_f32 v[224:225], v[224:225], v[116:117], v[108:109]
    v_pk_fma_f32 v[226:227], v[226:227], v[118:119], v[110:111]
    v_pk_mul_f32 v[220:221], v[220:221], v[48:49]
    v_pk_mul_f32 v[222:223], v[222:223], v[50:51]
    v_pk_mul_f32 v[224:225], v[224:225], v[52:53]
    v_pk_mul_f32 v[226:227], v[226:227], v[54:55]
    v_exp_f32 v220, v220
    v_exp_f32 v221, v221
    v_exp_f32 v222, v222
    v_exp_f32 v223, v223
    v_exp_f32 v224, v224
    v_exp_f32 v225, v225
    v_exp_f32 v226, v226
    v_exp_f32 v227, v227
    v_pk_fma_f32 v[220:221], v[220:221], v[120:121], v[120:121]
    v_pk_fma_f32 v[222:223], v[222:223], v[122:123], v[122:123]
    v_pk_fma_f32 v[224:225], v[224:225], v[124:125], v[124:125]
    v_pk_fma_f32 v[226:227], v[226:227], v[126:127], v[126:127]
    v_rcp_f32 v220, v220
    v_rcp_f32 v221, v221
    v_rcp_f32 v222, v222
    v_rcp_f32 v223, v223
    v_rcp_f32 v224, v224
    v_rcp_f32 v225, v225
    v_rcp_f32 v226, v226
    v_rcp_f32 v227, v227
    v_pk_mul_f32 v[48:49], v[48:49], v[220:221]
    v_pk_mul_f32 v[50:51], v[50:51], v[222:223]
    v_pk_mul_f32 v[52:53], v[52:53], v[224:225]
    v_pk_mul_f32 v[54:55], v[54:55], v[226:227]
    v_pk_add_f32 v[204:205], v[204:205], v[48:49]
    v_pk_fma_f32 v[206:207], v[48:49], v[48:49], v[206:207]
    v_pk_add_f32 v[208:209], v[208:209], v[50:51]
    v_pk_fma_f32 v[210:211], v[50:51], v[50:51], v[210:211]
    v_pk_add_f32 v[212:213], v[212:213], v[52:53]
    v_pk_fma_f32 v[214:215], v[52:53], v[52:53], v[214:215]
    v_pk_add_f32 v[216:217], v[216:217], v[54:55]
    v_pk_fma_f32 v[218:219], v[54:55], v[54:55], v[218:219]
    v_pk_mul_f32 v[228:229], v[56:57], v[56:57]
    v_pk_mul_f32 v[230:231], v[58:59], v[58:59]
    v_pk_mul_f32 v[232:233], v[60:61], v[60:61]
    v_pk_mul_f32 v[234:235], v[62:63], v[62:63]
    v_pk_fma_f32 v[228:229], v[228:229], v[112:113], v[104:105]
    v_pk_fma_f32 v[230:231], v[230:231], v[114:115], v[106:107]
    v_pk_fma_f32 v[232:233], v[232:233], v[116:117], v[108:109]
    v_pk_fma_f32 v[234:235], v[234:235], v[118:119], v[110:111]
    v_pk_mul_f32 v[228:229], v[228:229], v[56:57]
    v_pk_mul_f32 v[230:231], v[230:231], v[58:59]
    v_pk_mul_f32 v[232:233], v[232:233], v[60:61]
    v_pk_mul_f32 v[234:235], v[234:235], v[62:63]
    v_exp_f32 v228, v228
    v_exp_f32 v229, v229
    v_exp_f32 v230, v230
    v_exp_f32 v231, v231
    v_exp_f32 v232, v232
    v_exp_f32 v233, v233
    v_exp_f32 v234, v234
    v_exp_f32 v235, v235
    v_pk_fma_f32 v[228:229], v[228:229], v[120:121], v[120:121]
    v_pk_fma_f32 v[230:231], v[230:231], v[122:123], v[122:123]
    v_pk_fma_f32 v[232:233], v[232:233], v[124:125], v[124:125]
    v_pk_fma_f32 v[234:235], v[234:235], v[126:127], v[126:127]
    v_rcp_f32 v228, v228
    v_rcp_f32 v229, v229
    v_rcp_f32 v230, v230
    v_rcp_f32 v231, v231
    v_rcp_f32 v232, v232
    v_rcp_f32 v233, v233
    v_rcp_f32 v234, v234
    v_rcp_f32 v235, v235
    v_pk_mul_f32 v[56:57], v[56:57], v[228:229]
    v_pk_mul_f32 v[58:59], v[58:59], v[230:231]
    v_pk_mul_f32 v[60:61], v[60:61], v[232:233]
    v_pk_mul_f32 v[62:63], v[62:63], v[234:235]
    v_pk_add_f32 v[204:205], v[204:205], v[56:57]
    v_pk_fma_f32 v[206:207], v[56:57], v[56:57], v[206:207]
    v_pk_add_f32 v[208:209], v[208:209], v[58:59]
    v_pk_fma_f32 v[210:211], v[58:59], v[58:59], v[210:211]
    v_pk_add_f32 v[212:213], v[212:213], v[60:61]
    v_pk_fma_f32 v[214:215], v[60:61], v[60:61], v[214:215]
    v_pk_add_f32 v[216:217], v[216:217], v[62:63]
    v_pk_fma_f32 v[218:219], v[62:63], v[62:63], v[218:219]
    v_pk_mul_f32 v[220:221], v[64:65], v[64:65]
    v_pk_mul_f32 v[222:223], v[66:67], v[66:67]
    v_pk_mul_f32 v[224:225], v[68:69], v[68:69]
    v_pk_mul_f32 v[226:227], v[70:71], v[70:71]
    v_pk_fma_f32 v[220:221], v[220:221], v[112:113], v[104:105]
    v_pk_fma_f32 v[222:223], v[222:223], v[114:115], v[106:107]
    v_pk_fma_f32 v[224:225], v[224:225], v[116:117], v[108:109]
    v_pk_fma_f32 v[226:227], v[226:227], v[118:119], v[110:111]
    v_pk_mul_f32 v[220:221], v[220:221], v[64:65]
    v_pk_mul_f32 v[222:223], v[222:223], v[66:67]
    v_pk_mul_f32 v[224:225], v[224:225], v[68:69]
    v_pk_mul_f32 v[226:227], v[226:227], v[70:71]
    v_exp_f32 v220, v220
    v_exp_f32 v221, v221
    v_exp_f32 v222, v222
    v_exp_f32 v223, v223
    v_exp_f32 v224, v224
    v_exp_f32 v225, v225
    v_exp_f32 v226, v226
    v_exp_f32 v227, v227
    v_pk_fma_f32 v[220:221], v[220:221], v[120:121], v[120:121]
    v_pk_fma_f32 v[222:223], v[222:223], v[122:123], v[122:123]
    v_pk_fma_f32 v[224:225], v[224:225], v[124:125], v[124:125]
    v_pk_fma_f32 v[226:227], v[226:227], v[126:127], v[126:127]
    v_rcp_f32 v220, v220
    v_rcp_f32 v221, v221
    v_rcp_f32 v222, v222
    v_rcp_f32 v223, v223
    v_rcp_f32 v224, v224
    v_rcp_f32 v225, v225
    v_rcp_f32 v226, v226
    v_rcp_f32 v227, v227
    v_pk_mul_f32 v[64:65], v[64:65], v[220:221]
    v_pk_mul_f32 v[66:67], v[66:67], v[222:223]
    v_pk_mul_f32 v[68:69], v[68:69], v[224:225]
    v_pk_mul_f32 v[70:71], v[70:71], v[226:227]
    v_pk_add_f32 v[204:205], v[204:205], v[64:65]
    v_pk_fma_f32 v[206:207], v[64:65], v[64:65], v[206:207]
    v_pk_add_f32 v[208:209], v[208:209], v[66:67]
    v_pk_fma_f32 v[210:211], v[66:67], v[66:67], v[210:211]
    v_pk_add_f32 v[212:213], v[212:213], v[68:69]
    v_pk_fma_f32 v[214:215], v[68:69], v[68:69], v[214:215]
    v_pk_add_f32 v[216:217], v[216:217], v[70:71]
    v_pk_fma_f32 v[218:219], v[70:71], v[70:71], v[218:219]
    v_pk_mul_f32 v[228:229], v[72:73], v[72:73]
    v_pk_mul_f32 v[230:231], v[74:75], v[74:75]
    v_pk_mul_f32 v[232:233], v[76:77], v[76:77]
    v_pk_mul_f32 v[234:235], v[78:79], v[78:79]
    v_pk_fma_f32 v[228:229], v[228:229], v[112:113], v[104:105]
    v_pk_fma_f32 v[230:231], v[230:231], v[114:115], v[106:107]
    v_pk_fma_f32 v[232:233], v[232:233], v[116:117], v[108:109]
    v_pk_fma_f32 v[234:235], v[234:235], v[118:119], v[110:111]
    v_pk_mul_f32 v[228:229], v[228:229], v[72:73]
    v_pk_mul_f32 v[230:231], v[230:231], v[74:75]
    v_pk_mul_f32 v[232:233], v[232:233], v[76:77]
    v_pk_mul_f32 v[234:235], v[234:235], v[78:79]
    v_exp_f32 v228, v228
    v_exp_f32 v229, v229
    v_exp_f32 v230, v230
    v_exp_f32 v231, v231
    v_exp_f32 v232, v232
    v_exp_f32 v233, v233
    v_exp_f32 v234, v234
    v_exp_f32 v235, v235
    v_pk_fma_f32 v[228:229], v[228:229], v[120:121], v[120:121]
    v_pk_fma_f32 v[230:231], v[230:231], v[122:123], v[122:123]
    v_pk_fma_f32 v[232:233], v[232:233], v[124:125], v[124:125]
    v_pk_fma_f32 v[234:235], v[234:235], v[126:127], v[126:127]
    v_rcp_f32 v228, v228
    v_rcp_f32 v229, v229
    v_rcp_f32 v230, v230
    v_rcp_f32 v231, v231
    v_rcp_f32 v232, v232
    v_rcp_f32 v233, v233
    v_rcp_f32 v234, v234
    v_rcp_f32 v235, v235
    v_pk_mul_f32 v[72:73], v[72:73], v[228:229]
    v_pk_mul_f32 v[74:75], v[74:75], v[230:231]
    v_pk_mul_f32 v[76:77], v[76:77], v[232:233]
    v_pk_mul_f32 v[78:79], v[78:79], v[234:235]
    v_pk_add_f32 v[204:205], v[204:205], v[72:73]
    v_pk_fma_f32 v[206:207], v[72:73], v[72:73], v[206:207]
    v_pk_add_f32 v[208:209], v[208:209], v[74:75]
    v_pk_fma_f32 v[210:211], v[74:75], v[74:75], v[210:211]
    v_pk_add_f32 v[212:213], v[212:213], v[76:77]
    v_pk_fma_f32 v[214:215], v[76:77], v[76:77], v[214:215]
    v_pk_add_f32 v[216:217], v[216:217], v[78:79]
    v_pk_fma_f32 v[218:219], v[78:79], v[78:79], v[218:219]
    v_pk_mul_f32 v[220:221], v[80:81], v[80:81]
    v_pk_mul_f32 v[222:223], v[82:83], v[82:83]
    v_pk_mul_f32 v[224:225], v[84:85], v[84:85]
    v_pk_mul_f32 v[226:227], v[86:87], v[86:87]
    v_pk_fma_f32 v[220:221], v[220:221], v[112:113], v[104:105]
    v_pk_fma_f32 v[222:223], v[222:223], v[114:115], v[106:107]
    v_pk_fma_f32 v[224:225], v[224:225], v[116:117], v[108:109]
    v_pk_fma_f32 v[226:227], v[226:227], v[118:119], v[110:111]
    v_pk_mul_f32 v[220:221], v[220:221], v[80:81]
    v_pk_mul_f32 v[222:223], v[222:223], v[82:83]
    v_pk_mul_f32 v[224:225], v[224:225], v[84:85]
    v_pk_mul_f32 v[226:227], v[226:227], v[86:87]
    v_exp_f32 v220, v220
    v_exp_f32 v221, v221
    v_exp_f32 v222, v222
    v_exp_f32 v223, v223
    v_exp_f32 v224, v224
    v_exp_f32 v225, v225
    v_exp_f32 v226, v226
    v_exp_f32 v227, v227
    v_pk_fma_f32 v[220:221], v[220:221], v[120:121], v[120:121]
    v_pk_fma_f32 v[222:223], v[222:223], v[122:123], v[122:123]
    v_pk_fma_f32 v[224:225], v[224:225], v[124:125], v[124:125]
    v_pk_fma_f32 v[226:227], v[226:227], v[126:127], v[126:127]
    v_rcp_f32 v220, v220
    v_rcp_f32 v221, v221
    v_rcp_f32 v222, v222
    v_rcp_f32 v223, v223
    v_rcp_f32 v224, v224
    v_rcp_f32 v225, v225
    v_rcp_f32 v226, v226
    v_rcp_f32 v227, v227
    v_pk_mul_f32 v[80:81], v[80:81], v[220:221]
    v_pk_mul_f32 v[82:83], v[82:83], v[222:223]
    v_pk_mul_f32 v[84:85], v[84:85], v[224:225]
    v_pk_mul_f32 v[86:87], v[86:87], v[226:227]
    v_pk_add_f32 v[204:205], v[204:205], v[80:81]
    v_pk_fma_f32 v[206:207], v[80:81], v[80:81], v[206:207]
    v_pk_add_f32 v[208:209], v[208:209], v[82:83]
    v_pk_fma_f32 v[210:211], v[82:83], v[82:83], v[210:211]
    v_pk_add_f32 v[212:213], v[212:213], v[84:85]
    v_pk_fma_f32 v[214:215], v[84:85], v[84:85], v[214:215]
    v_pk_add_f32 v[216:217], v[216:217], v[86:87]
    v_pk_fma_f32 v[218:219], v[86:87], v[86:87], v[218:219]
    v_add_f32_dpp v204, v204, v204 row_mirror row_mask:0xf bank_mask:0x3
    v_add_f32_dpp v205, v205, v205 row_mirror row_mask:0xf bank_mask:0x3
    v_add_f32_dpp v206, v206, v206 row_mirror row_mask:0xf bank_mask:0x3
    v_add_f32_dpp v207, v207, v207 row_mirror row_mask:0xf bank_mask:0x3
    v_add_f32_dpp v208, v208, v208 row_mirror row_mask:0xf bank_mask:0x3
    v_add_f32_dpp v209, v209, v209 row_mirror row_mask:0xf bank_mask:0x3
    v_add_f32_dpp v210, v210, v210 row_mirror row_mask:0xf bank_mask:0x3
    v_add_f32_dpp v211, v211, v211 row_mirror row_mask:0xf bank_mask:0x3
    v_add_f32_dpp v204, v212, v212 row_mirror row_mask:0xf bank_mask:0xc
    v_add_f32_dpp v205, v213, v213 row_mirror row_mask:0xf bank_mask:0xc
    v_add_f32_dpp v206, v214, v214 row_mirror row_mask:0xf bank_mask:0xc
    v_add_f32_dpp v207, v215, v215 row_mirror row_mask:0xf bank_mask:0xc
    v_add_f32_dpp v208, v216, v216 row_mirror row_mask:0xf bank_mask:0xc
    v_add_f32_dpp v209, v217, v217 row_mirror row_mask:0xf bank_mask:0xc
    v_add_f32_dpp v210, v218, v218 row_mirror row_mask:0xf bank_mask:0xc
    v_add_f32_dpp v211, v219, v219 row_mirror row_mask:0xf bank_mask:0xc
    v_add_f32_dpp v204, v204, v204 row_half_mirror row_mask:0xf bank_mask:0x5
    v_add_f32_dpp v205, v205, v205 row_half_mirror row_mask:0xf bank_mask:0x5
    v_add_f32_dpp v206, v206, v206 row_half_mirror row_mask:0xf bank_mask:0x5
    v_add_f32_dpp v207, v207, v207 row_half_mirror row_mask:0xf bank_mask:0x5
    v_add_f32_dpp v204, v208, v208 row_half_mirror row_mask:0xf bank_mask:0xa
    v_add_f32_dpp v205, v209, v209 row_half_mirror row_mask:0xf bank_mask:0xa
    v_add_f32_dpp v206, v210, v210 row_half_mirror row_mask:0xf bank_mask:0xa
    v_add_f32_dpp v207, v211, v211 row_half_mirror row_mask:0xf bank_mask:0xa
    v_add_f32_dpp v204, v204, v204 quad_perm:[1,0,3,2] row_mask:0xf bank_mask:0xf
    v_add_f32_dpp v205, v205, v205 quad_perm:[1,0,3,2] row_mask:0xf bank_mask:0xf
    v_add_f32_dpp v206, v206, v206 quad_perm:[1,0,3,2] row_mask:0xf bank_mask:0xf
    v_add_f32_dpp v207, v207, v207 quad_perm:[1,0,3,2] row_mask:0xf bank_mask:0xf
    v_add_f32_dpp v12, v204, v204 quad_perm:[2,3,0,1] row_mask:0xf bank_mask:0xf
    v_add_f32_dpp v14, v205, v205 quad_perm:[2,3,0,1] row_mask:0xf bank_mask:0xf
    v_add_f32_dpp v13, v206, v206 quad_perm:[2,3,0,1] row_mask:0xf bank_mask:0xf
    v_add_f32_dpp v15, v207, v207 quad_perm:[2,3,0,1] row_mask:0xf bank_mask:0xf
    buffer_store_dwordx4 v[12:15], v8, s[4:7], s36 offen sc1
    s_waitcnt lgkmcnt(5)
    v_mfma_f32_16x16x32_bf16 v[88:91], v[168:171], v[160:163], 0
    ds_read_b128 v[204:207], v3 offset:37888
    v_mfma_f32_16x16x32_bf16 v[92:95], v[168:171], v[164:167], 0
    ds_read_b128 v[208:211], v3 offset:39936
    v_mfma_f32_16x16x32_bf16 v[96:99], v[172:175], v[160:163], 0
    ds_read_b128 v[212:215], v1 offset:46080
    v_mfma_f32_16x16x32_bf16 v[100:103], v[172:175], v[164:167], 0
    ds_read_b128 v[216:219], v1 offset:47104
    v_mfma_f32_16x16x32_bf16 v[104:107], v[176:179], v[160:163], 0
    ds_read_b128 v[220:223], v1 offset:48128
    v_mfma_f32_16x16x32_bf16 v[108:111], v[176:179], v[164:167], 0
    ds_read_b128 v[224:227], v1 offset:49152
    v_mfma_f32_16x16x32_bf16 v[112:115], v[180:183], v[160:163], 0
    ds_read_b128 v[228:231], v1 offset:50176
    v_mfma_f32_16x16x32_bf16 v[116:119], v[180:183], v[164:167], 0
    ds_read_b128 v[232:235], v1 offset:51200
    s_waitcnt lgkmcnt(8)
    v_mfma_f32_16x16x32_bf16 v[120:123], v[184:187], v[160:163], 0
    ds_read_b128 v[236:239], v1 offset:52224
    v_mfma_f32_16x16x32_bf16 v[124:127], v[184:187], v[164:167], 0
    ds_read_b128 v[240:243], v1 offset:53248
    v_mfma_f32_16x16x32_bf16 v[128:131], v[188:191], v[160:163], 0
    ds_read_b128 v[244:247], v1 offset:54272
    v_mfma_f32_16x16x32_bf16 v[132:135], v[188:191], v[164:167], 0
    v_mfma_f32_16x16x32_bf16 v[136:139], v[192:195], v[160:163], 0
    v_lshrrev_b32 v255, 8, v1
    v_mfma_f32_16x16x32_bf16 v[140:143], v[192:195], v[164:167], 0
    v_lshl_add_u32 v255, v255, 6, s33
    v_mfma_f32_16x16x32_bf16 v[144:147], v[196:199], v[160:163], 0
    v_mfma_f32_16x16x32_bf16 v[148:151], v[196:199], v[164:167], 0
    v_mfma_f32_16x16x32_bf16 v[152:155], v[200:203], v[160:163], 0
    v_mfma_f32_16x16x32_bf16 v[156:159], v[200:203], v[164:167], 0
    s_waitcnt lgkmcnt(0)
    s_barrier
    v_mfma_f32_16x16x32_bf16 v[88:91], v[212:215], v[204:207], v[88:91]
    ds_read_b128 v[160:163], v0 offset:0
    v_mfma_f32_16x16x32_bf16 v[92:95], v[212:215], v[208:211], v[92:95]
    ds_read_b128 v[164:167], v0 offset:2048
    v_mfma_f32_16x16x32_bf16 v[96:99], v[216:219], v[204:207], v[96:99]
    ds_read_b128 v[168:171], v2 offset:0
    v_mfma_f32_16x16x32_bf16 v[100:103], v[216:219], v[208:211], v[100:103]
    ds_read_b128 v[172:175], v2 offset:1024
    v_mfma_f32_16x16x32_bf16 v[104:107], v[220:223], v[204:207], v[104:107]
    ds_read_b128 v[176:179], v2 offset:2048
    v_mfma_f32_16x16x32_bf16 v[108:111], v[220:223], v[208:211], v[108:111]
    ds_read_b128 v[180:183], v2 offset:3072
    v_mfma_f32_16x16x32_bf16 v[112:115], v[224:227], v[204:207], v[112:115]
    ds_read_b128 v[184:187], v2 offset:4096
    v_mfma_f32_16x16x32_bf16 v[116:119], v[224:227], v[208:211], v[116:119]
    ds_read_b128 v[188:191], v2 offset:5120
    v_mfma_f32_16x16x32_bf16 v[120:123], v[228:231], v[204:207], v[120:123]
    ds_read_b128 v[192:195], v2 offset:6144
    v_mfma_f32_16x16x32_bf16 v[124:127], v[228:231], v[208:211], v[124:127]
    ds_read_b128 v[196:199], v2 offset:7168
    v_mfma_f32_16x16x32_bf16 v[128:131], v[232:235], v[204:207], v[128:131]
    ds_read_b128 v[200:203], v2 offset:8192
    v_mfma_f32_16x16x32_bf16 v[132:135], v[232:235], v[208:211], v[132:135]
    v_mfma_f32_16x16x32_bf16 v[136:139], v[236:239], v[204:207], v[136:139]
    v_mfma_f32_16x16x32_bf16 v[140:143], v[236:239], v[208:211], v[140:143]
    v_mfma_f32_16x16x32_bf16 v[144:147], v[240:243], v[204:207], v[144:147]
    v_mfma_f32_16x16x32_bf16 v[148:151], v[240:243], v[208:211], v[148:151]
    v_mfma_f32_16x16x32_bf16 v[152:155], v[244:247], v[204:207], v[152:155]
    v_mfma_f32_16x16x32_bf16 v[156:159], v[244:247], v[208:211], v[156:159]
    s_waitcnt lgkmcnt(5)
    v_mfma_f32_16x16x32_bf16 v[88:91], v[168:171], v[160:163], v[88:91]
    ds_read_b128 v[204:207], v0 offset:1024
    v_mfma_f32_16x16x32_bf16 v[92:95], v[168:171], v[164:167], v[92:95]
    ds_read_b128 v[208:211], v0 offset:3072
    v_mfma_f32_16x16x32_bf16 v[96:99], v[172:175], v[160:163], v[96:99]
    ds_read_b128 v[212:215], v2 offset:9216
    v_mfma_f32_16x16x32_bf16 v[100:103], v[172:175], v[164:167], v[100:103]
    ds_read_b128 v[216:219], v2 offset:10240
    v_mfma_f32_16x16x32_bf16 v[104:107], v[176:179], v[160:163], v[104:107]
    ds_read_b128 v[220:223], v2 offset:11264
    v_mfma_f32_16x16x32_bf16 v[108:111], v[176:179], v[164:167], v[108:111]
    ds_read_b128 v[224:227], v2 offset:12288
    v_mfma_f32_16x16x32_bf16 v[112:115], v[180:183], v[160:163], v[112:115]
    ds_read_b128 v[228:231], v2 offset:13312
    v_mfma_f32_16x16x32_bf16 v[116:119], v[180:183], v[164:167], v[116:119]
    ds_read_b128 v[232:235], v2 offset:14336
    s_waitcnt lgkmcnt(8)
    v_mfma_f32_16x16x32_bf16 v[120:123], v[184:187], v[160:163], v[120:123]
    ds_read_b128 v[236:239], v2 offset:15360
    v_mfma_f32_16x16x32_bf16 v[124:127], v[184:187], v[164:167], v[124:127]
    ds_read_b128 v[240:243], v2 offset:16384
    v_mfma_f32_16x16x32_bf16 v[128:131], v[188:191], v[160:163], v[128:131]
    ds_read_b128 v[244:247], v2 offset:17408
    v_mfma_f32_16x16x32_bf16 v[132:135], v[188:191], v[164:167], v[132:135]
    v_mfma_f32_16x16x32_bf16 v[136:139], v[192:195], v[160:163], v[136:139]
    v_mfma_f32_16x16x32_bf16 v[140:143], v[192:195], v[164:167], v[140:143]
    v_mfma_f32_16x16x32_bf16 v[144:147], v[196:199], v[160:163], v[144:147]
    v_mfma_f32_16x16x32_bf16 v[148:151], v[196:199], v[164:167], v[148:151]
    v_mfma_f32_16x16x32_bf16 v[152:155], v[200:203], v[160:163], v[152:155]
    v_mfma_f32_16x16x32_bf16 v[156:159], v[200:203], v[164:167], v[156:159]
    s_waitcnt lgkmcnt(0)
    s_barrier
    v_mfma_f32_16x16x32_bf16 v[88:91], v[212:215], v[204:207], v[88:91]
    ds_read_b128 v[160:163], v0 offset:36864
    v_mfma_f32_16x16x32_bf16 v[92:95], v[212:215], v[208:211], v[92:95]
    ds_read_b128 v[164:167], v0 offset:38912
    v_mfma_f32_16x16x32_bf16 v[96:99], v[216:219], v[204:207], v[96:99]
    ds_read_b128 v[168:171], v2 offset:36864
    v_mfma_f32_16x16x32_bf16 v[100:103], v[216:219], v[208:211], v[100:103]
    ds_read_b128 v[172:175], v2 offset:37888
    v_mfma_f32_16x16x32_bf16 v[104:107], v[220:223], v[204:207], v[104:107]
    ds_read_b128 v[176:179], v2 offset:38912
    v_mfma_f32_16x16x32_bf16 v[108:111], v[220:223], v[208:211], v[108:111]
    ds_read_b128 v[180:183], v2 offset:39936
    v_mfma_f32_16x16x32_bf16 v[112:115], v[224:227], v[204:207], v[112:115]
    ds_read_b128 v[184:187], v2 offset:40960
    v_mfma_f32_16x16x32_bf16 v[116:119], v[224:227], v[208:211], v[116:119]
    ds_read_b128 v[188:191], v2 offset:41984
    v_mfma_f32_16x16x32_bf16 v[120:123], v[228:231], v[204:207], v[120:123]
    ds_read_b128 v[192:195], v2 offset:43008
    v_mfma_f32_16x16x32_bf16 v[124:127], v[228:231], v[208:211], v[124:127]
    ds_read_b128 v[196:199], v2 offset:44032
    v_mfma_f32_16x16x32_bf16 v[128:131], v[232:235], v[204:207], v[128:131]
    ds_read_b128 v[200:203], v2 offset:45056
    v_mfma_f32_16x16x32_bf16 v[132:135], v[232:235], v[208:211], v[132:135]
    v_mfma_f32_16x16x32_bf16 v[136:139], v[236:239], v[204:207], v[136:139]
    v_mfma_f32_16x16x32_bf16 v[140:143], v[236:239], v[208:211], v[140:143]
    v_mfma_f32_16x16x32_bf16 v[144:147], v[240:243], v[204:207], v[144:147]
    v_mfma_f32_16x16x32_bf16 v[148:151], v[240:243], v[208:211], v[148:151]
    v_mfma_f32_16x16x32_bf16 v[152:155], v[244:247], v[204:207], v[152:155]
    v_mfma_f32_16x16x32_bf16 v[156:159], v[244:247], v[208:211], v[156:159]
    s_waitcnt lgkmcnt(5)
    v_mfma_f32_16x16x32_bf16 v[88:91], v[168:171], v[160:163], v[88:91]
    ds_read_b128 v[204:207], v0 offset:37888
    v_mfma_f32_16x16x32_bf16 v[92:95], v[168:171], v[164:167], v[92:95]
    ds_read_b128 v[208:211], v0 offset:39936
    v_mfma_f32_16x16x32_bf16 v[96:99], v[172:175], v[160:163], v[96:99]
    ds_read_b128 v[212:215], v2 offset:46080
    v_mfma_f32_16x16x32_bf16 v[100:103], v[172:175], v[164:167], v[100:103]
    ds_read_b128 v[216:219], v2 offset:47104
    v_mfma_f32_16x16x32_bf16 v[104:107], v[176:179], v[160:163], v[104:107]
    ds_read_b128 v[220:223], v2 offset:48128
    v_mfma_f32_16x16x32_bf16 v[108:111], v[176:179], v[164:167], v[108:111]
    ds_read_b128 v[224:227], v2 offset:49152
    v_mfma_f32_16x16x32_bf16 v[112:115], v[180:183], v[160:163], v[112:115]
    ds_read_b128 v[228:231], v2 offset:50176
    v_mfma_f32_16x16x32_bf16 v[116:119], v[180:183], v[164:167], v[116:119]
    ds_read_b128 v[232:235], v2 offset:51200
    s_waitcnt lgkmcnt(8)
    v_mfma_f32_16x16x32_bf16 v[120:123], v[184:187], v[160:163], v[120:123]
    ds_read_b128 v[236:239], v2 offset:52224
    v_mfma_f32_16x16x32_bf16 v[124:127], v[184:187], v[164:167], v[124:127]
    ds_read_b128 v[240:243], v2 offset:53248
    v_mfma_f32_16x16x32_bf16 v[128:131], v[188:191], v[160:163], v[128:131]
    ds_read_b128 v[244:247], v2 offset:54272
    v_mfma_f32_16x16x32_bf16 v[132:135], v[188:191], v[164:167], v[132:135]
    v_mfma_f32_16x16x32_bf16 v[136:139], v[192:195], v[160:163], v[136:139]
    v_mfma_f32_16x16x32_bf16 v[140:143], v[192:195], v[164:167], v[140:143]
    v_mfma_f32_16x16x32_bf16 v[144:147], v[196:199], v[160:163], v[144:147]
    v_mfma_f32_16x16x32_bf16 v[148:151], v[196:199], v[164:167], v[148:151]
    v_mfma_f32_16x16x32_bf16 v[152:155], v[200:203], v[160:163], v[152:155]
    v_mfma_f32_16x16x32_bf16 v[156:159], v[200:203], v[164:167], v[156:159]
    s_waitcnt lgkmcnt(0)
    s_barrier
    v_mfma_f32_16x16x32_bf16 v[88:91], v[212:215], v[204:207], v[88:91]
    ds_read_b128 v[160:163], v3 offset:0
    v_mfma_f32_16x16x32_bf16 v[92:95], v[212:215], v[208:211], v[92:95]
    ds_read_b128 v[164:167], v3 offset:2048
    v_mfma_f32_16x16x32_bf16 v[96:99], v[216:219], v[204:207], v[96:99]
    ds_read_b128 v[168:171], v1 offset:0
    v_mfma_f32_16x16x32_bf16 v[100:103], v[216:219], v[208:211], v[100:103]
    ds_read_b128 v[172:175], v1 offset:1024
    v_mfma_f32_16x16x32_bf16 v[104:107], v[220:223], v[204:207], v[104:107]
    ds_read_b128 v[176:179], v1 offset:2048
    v_mfma_f32_16x16x32_bf16 v[108:111], v[220:223], v[208:211], v[108:111]
    ds_read_b128 v[180:183], v1 offset:3072
    v_mfma_f32_16x16x32_bf16 v[112:115], v[224:227], v[204:207], v[112:115]
    ds_read_b128 v[184:187], v1 offset:4096
    v_mfma_f32_16x16x32_bf16 v[116:119], v[224:227], v[208:211], v[116:119]
    ds_read_b128 v[188:191], v1 offset:5120
    v_mfma_f32_16x16x32_bf16 v[120:123], v[228:231], v[204:207], v[120:123]
    ds_read_b128 v[192:195], v1 offset:6144
    v_mfma_f32_16x16x32_bf16 v[124:127], v[228:231], v[208:211], v[124:127]
    ds_read_b128 v[196:199], v1 offset:7168
    v_mfma_f32_16x16x32_bf16 v[128:131], v[232:235], v[204:207], v[128:131]
    ds_read_b128 v[200:203], v1 offset:8192
    v_mfma_f32_16x16x32_bf16 v[132:135], v[232:235], v[208:211], v[132:135]
    v_mfma_f32_16x16x32_bf16 v[136:139], v[236:239], v[204:207], v[136:139]
    v_mfma_f32_16x16x32_bf16 v[140:143], v[236:239], v[208:211], v[140:143]
    v_mfma_f32_16x16x32_bf16 v[144:147], v[240:243], v[204:207], v[144:147]
    v_mfma_f32_16x16x32_bf16 v[148:151], v[240:243], v[208:211], v[148:151]
    v_mfma_f32_16x16x32_bf16 v[152:155], v[244:247], v[204:207], v[152:155]
    v_mfma_f32_16x16x32_bf16 v[156:159], v[244:247], v[208:211], v[156:159]
    s_waitcnt lgkmcnt(5)
    v_mfma_f32_16x16x32_bf16 v[88:91], v[168:171], v[160:163], v[88:91]
    ds_read_b128 v[204:207], v3 offset:1024
    v_mfma_f32_16x16x32_bf16 v[92:95], v[168:171], v[164:167], v[92:95]
    ds_read_b128 v[208:211], v3 offset:3072
    v_mfma_f32_16x16x32_bf16 v[96:99], v[172:175], v[160:163], v[96:99]
    ds_read_b128 v[212:215], v1 offset:9216
    v_mfma_f32_16x16x32_bf16 v[100:103], v[172:175], v[164:167], v[100:103]
    ds_read_b128 v[216:219], v1 offset:10240
    v_mfma_f32_16x16x32_bf16 v[104:107], v[176:179], v[160:163], v[104:107]
    ds_read_b128 v[220:223], v1 offset:11264
    v_mfma_f32_16x16x32_bf16 v[108:111], v[176:179], v[164:167], v[108:111]
    ds_read_b128 v[224:227], v1 offset:12288
    v_mfma_f32_16x16x32_bf16 v[112:115], v[180:183], v[160:163], v[112:115]
    ds_read_b128 v[228:231], v1 offset:13312
    v_mfma_f32_16x16x32_bf16 v[116:119], v[180:183], v[164:167], v[116:119]
    ds_read_b128 v[232:235], v1 offset:14336
    s_waitcnt lgkmcnt(8)
    v_mfma_f32_16x16x32_bf16 v[120:123], v[184:187], v[160:163], v[120:123]
    ds_read_b128 v[236:239], v1 offset:15360
    v_mfma_f32_16x16x32_bf16 v[124:127], v[184:187], v[164:167], v[124:127]
    ds_read_b128 v[240:243], v1 offset:16384
    v_mfma_f32_16x16x32_bf16 v[128:131], v[188:191], v[160:163], v[128:131]
    ds_read_b128 v[244:247], v1 offset:17408
    v_mfma_f32_16x16x32_bf16 v[132:135], v[188:191], v[164:167], v[132:135]
    v_mfma_f32_16x16x32_bf16 v[136:139], v[192:195], v[160:163], v[136:139]
    v_mfma_f32_16x16x32_bf16 v[140:143], v[192:195], v[164:167], v[140:143]
    v_mfma_f32_16x16x32_bf16 v[144:147], v[196:199], v[160:163], v[144:147]
    v_mfma_f32_16x16x32_bf16 v[148:151], v[196:199], v[164:167], v[148:151]
    v_mfma_f32_16x16x32_bf16 v[152:155], v[200:203], v[160:163], v[152:155]
    v_mfma_f32_16x16x32_bf16 v[156:159], v[200:203], v[164:167], v[156:159]
    s_waitcnt lgkmcnt(0)
    s_barrier
    v_mfma_f32_16x16x32_bf16 v[88:91], v[212:215], v[204:207], v[88:91]
    ds_read_b128 v[160:163], v3 offset:36864
    v_mfma_f32_16x16x32_bf16 v[92:95], v[212:215], v[208:211], v[92:95]
    ds_read_b128 v[164:167], v3 offset:38912
    v_mfma_f32_16x16x32_bf16 v[96:99], v[216:219], v[204:207], v[96:99]
    ds_read_b128 v[168:171], v1 offset:36864
    v_mfma_f32_16x16x32_bf16 v[100:103], v[216:219], v[208:211], v[100:103]
    ds_read_b128 v[172:175], v1 offset:37888
    v_mfma_f32_16x16x32_bf16 v[104:107], v[220:223], v[204:207], v[104:107]
    ds_read_b128 v[176:179], v1 offset:38912
    v_mfma_f32_16x16x32_bf16 v[108:111], v[220:223], v[208:211], v[108:111]
    ds_read_b128 v[180:183], v1 offset:39936
    v_mfma_f32_16x16x32_bf16 v[112:115], v[224:227], v[204:207], v[112:115]
    ds_read_b128 v[184:187], v1 offset:40960
    v_mfma_f32_16x16x32_bf16 v[116:119], v[224:227], v[208:211], v[116:119]
    ds_read_b128 v[188:191], v1 offset:41984
    v_mfma_f32_16x16x32_bf16 v[120:123], v[228:231], v[204:207], v[120:123]
    ds_read_b128 v[192:195], v1 offset:43008
    v_mfma_f32_16x16x32_bf16 v[124:127], v[228:231], v[208:211], v[124:127]
    ds_read_b128 v[196:199], v1 offset:44032
    v_mfma_f32_16x16x32_bf16 v[128:131], v[232:235], v[204:207], v[128:131]
    ds_read_b128 v[200:203], v1 offset:45056
    v_mfma_f32_16x16x32_bf16 v[132:135], v[232:235], v[208:211], v[132:135]
    ds_read_b128 v[4:7], v255 offset:1024
    v_mfma_f32_16x16x32_bf16 v[136:139], v[236:239], v[204:207], v[136:139]
    ds_read_b128 v[8:11], v255 offset:1040
    v_mfma_f32_16x16x32_bf16 v[140:143], v[236:239], v[208:211], v[140:143]
    ds_read_b128 v[12:15], v255 offset:1056
    v_mfma_f32_16x16x32_bf16 v[144:147], v[240:243], v[204:207], v[144:147]
    ds_read_b128 v[252:255], v255 offset:1072
    v_mfma_f32_16x16x32_bf16 v[148:151], v[240:243], v[208:211], v[148:151]
    v_mfma_f32_16x16x32_bf16 v[152:155], v[244:247], v[204:207], v[152:155]
    v_mfma_f32_16x16x32_bf16 v[156:159], v[244:247], v[208:211], v[156:159]
    s_waitcnt lgkmcnt(9)
    v_mfma_f32_16x16x32_bf16 v[88:91], v[168:171], v[160:163], v[88:91]
    ds_read_b128 v[204:207], v3 offset:37888
    v_mfma_f32_16x16x32_bf16 v[92:95], v[168:171], v[164:167], v[92:95]
    ds_read_b128 v[208:211], v3 offset:39936
    v_mfma_f32_16x16x32_bf16 v[96:99], v[172:175], v[160:163], v[96:99]
    ds_read_b128 v[212:215], v1 offset:46080
    v_mfma_f32_16x16x32_bf16 v[100:103], v[172:175], v[164:167], v[100:103]
    ds_read_b128 v[216:219], v1 offset:47104
    v_mfma_f32_16x16x32_bf16 v[104:107], v[176:179], v[160:163], v[104:107]
    ds_read_b128 v[220:223], v1 offset:48128
    v_mfma_f32_16x16x32_bf16 v[108:111], v[176:179], v[164:167], v[108:111]
    ds_read_b128 v[224:227], v1 offset:49152
    v_mfma_f32_16x16x32_bf16 v[112:115], v[180:183], v[160:163], v[112:115]
    ds_read_b128 v[228:231], v1 offset:50176
    v_mfma_f32_16x16x32_bf16 v[116:119], v[180:183], v[164:167], v[116:119]
    ds_read_b128 v[232:235], v1 offset:51200
    s_waitcnt lgkmcnt(8)
    v_mfma_f32_16x16x32_bf16 v[120:123], v[184:187], v[160:163], v[120:123]
    ds_read_b128 v[236:239], v1 offset:52224
    v_fma_f32 v16, v16, v4, -v6
    v_mfma_f32_16x16x32_bf16 v[124:127], v[184:187], v[164:167], v[124:127]
    ds_read_b128 v[240:243], v1 offset:53248
    v_fma_f32 v17, v17, v5, -v7
    v_mfma_f32_16x16x32_bf16 v[128:131], v[188:191], v[160:163], v[128:131]
    ds_read_b128 v[244:247], v1 offset:54272
    v_fma_f32 v18, v18, v8, -v10
    v_mfma_f32_16x16x32_bf16 v[132:135], v[188:191], v[164:167], v[132:135]
    v_fma_f32 v19, v19, v9, -v11
    v_fma_f32 v20, v20, v12, -v14
    v_mfma_f32_16x16x32_bf16 v[136:139], v[192:195], v[160:163], v[136:139]
    v_fma_f32 v21, v21, v13, -v15
    v_fma_f32 v22, v22, v252, -v254
    v_mfma_f32_16x16x32_bf16 v[140:143], v[192:195], v[164:167], v[140:143]
    v_fma_f32 v23, v23, v253, -v255
    v_cvt_pk_bf16_f32 v16, v16, v17
    v_mfma_f32_16x16x32_bf16 v[144:147], v[196:199], v[160:163], v[144:147]
    v_cvt_pk_bf16_f32 v17, v18, v19
    v_cvt_pk_bf16_f32 v18, v20, v21
    v_mfma_f32_16x16x32_bf16 v[148:151], v[196:199], v[164:167], v[148:151]
    v_cvt_pk_bf16_f32 v19, v22, v23
    v_fma_f32 v24, v24, v4, -v6
    v_mfma_f32_16x16x32_bf16 v[152:155], v[200:203], v[160:163], v[152:155]
    v_fma_f32 v25, v25, v5, -v7
    v_fma_f32 v26, v26, v8, -v10
    v_mfma_f32_16x16x32_bf16 v[156:159], v[200:203], v[164:167], v[156:159]
    v_fma_f32 v27, v27, v9, -v11
    s_waitcnt lgkmcnt(0)
    s_barrier
    v_mfma_f32_16x16x32_bf16 v[88:91], v[212:215], v[204:207], v[88:91]
    ds_read_b128 v[160:163], v0 offset:0
    v_mfma_f32_16x16x32_bf16 v[92:95], v[212:215], v[208:211], v[92:95]
    ds_read_b128 v[164:167], v0 offset:2048
    v_fma_f32 v28, v28, v12, -v14
    v_mfma_f32_16x16x32_bf16 v[96:99], v[216:219], v[204:207], v[96:99]
    ds_read_b128 v[168:171], v2 offset:0
    v_fma_f32 v29, v29, v13, -v15
    v_mfma_f32_16x16x32_bf16 v[100:103], v[216:219], v[208:211], v[100:103]
    ds_read_b128 v[172:175], v2 offset:1024
    v_fma_f32 v30, v30, v252, -v254
    v_mfma_f32_16x16x32_bf16 v[104:107], v[220:223], v[204:207], v[104:107]
    ds_read_b128 v[176:179], v2 offset:2048
    v_fma_f32 v31, v31, v253, -v255
    v_mfma_f32_16x16x32_bf16 v[108:111], v[220:223], v[208:211], v[108:111]
    ds_read_b128 v[180:183], v2 offset:3072
    v_permlane32_swap_b32 v16, v18
    v_mfma_f32_16x16x32_bf16 v[112:115], v[224:227], v[204:207], v[112:115]
    ds_read_b128 v[184:187], v2 offset:4096
    v_permlane32_swap_b32 v17, v19
    v_mfma_f32_16x16x32_bf16 v[116:119], v[224:227], v[208:211], v[116:119]
    ds_read_b128 v[188:191], v2 offset:5120
    v_mfma_f32_16x16x32_bf16 v[120:123], v[228:231], v[204:207], v[120:123]
    ds_read_b128 v[192:195], v2 offset:6144
    v_cvt_pk_bf16_f32 v24, v24, v25
    v_mfma_f32_16x16x32_bf16 v[124:127], v[228:231], v[208:211], v[124:127]
    ds_read_b128 v[196:199], v2 offset:7168
    v_cvt_pk_bf16_f32 v25, v26, v27
    v_mfma_f32_16x16x32_bf16 v[128:131], v[232:235], v[204:207], v[128:131]
    ds_read_b128 v[200:203], v2 offset:8192
    v_cvt_pk_bf16_f32 v26, v28, v29
    v_mfma_f32_16x16x32_bf16 v[132:135], v[232:235], v[208:211], v[132:135]
    v_cvt_pk_bf16_f32 v27, v30, v31
    v_permlane16_swap_b32 v16, v18
    v_mfma_f32_16x16x32_bf16 v[136:139], v[236:239], v[204:207], v[136:139]
    v_permlane16_swap_b32 v17, v19
    v_fma_f32 v32, v32, v4, -v6
    v_mfma_f32_16x16x32_bf16 v[140:143], v[236:239], v[208:211], v[140:143]
    v_fma_f32 v33, v33, v5, -v7
    v_fma_f32 v34, v34, v8, -v10
    v_mfma_f32_16x16x32_bf16 v[144:147], v[240:243], v[204:207], v[144:147]
    v_fma_f32 v35, v35, v9, -v11
    v_fma_f32 v36, v36, v12, -v14
    v_mfma_f32_16x16x32_bf16 v[148:151], v[240:243], v[208:211], v[148:151]
    v_fma_f32 v37, v37, v13, -v15
    v_fma_f32 v38, v38, v252, -v254
    v_mfma_f32_16x16x32_bf16 v[152:155], v[244:247], v[204:207], v[152:155]
    v_fma_f32 v39, v39, v253, -v255
    v_permlane32_swap_b32 v24, v26
    v_mfma_f32_16x16x32_bf16 v[156:159], v[244:247], v[208:211], v[156:159]
    v_permlane32_swap_b32 v25, v27
    s_waitcnt lgkmcnt(5)
    v_mfma_f32_16x16x32_bf16 v[88:91], v[168:171], v[160:163], v[88:91]
    ds_read_b128 v[204:207], v0 offset:1024
    v_mfma_f32_16x16x32_bf16 v[92:95], v[168:171], v[164:167], v[92:95]
    ds_read_b128 v[208:211], v0 offset:3072
    v_cvt_pk_bf16_f32 v32, v32, v33
    v_mfma_f32_16x16x32_bf16 v[96:99], v[172:175], v[160:163], v[96:99]
    ds_read_b128 v[212:215], v2 offset:9216
    v_cvt_pk_bf16_f32 v33, v34, v35
    v_mfma_f32_16x16x32_bf16 v[100:103], v[172:175], v[164:167], v[100:103]
    ds_read_b128 v[216:219], v2 offset:10240
    v_cvt_pk_bf16_f32 v34, v36, v37
    v_mfma_f32_16x16x32_bf16 v[104:107], v[176:179], v[160:163], v[104:107]
    ds_read_b128 v[220:223], v2 offset:11264
    v_cvt_pk_bf16_f32 v35, v38, v39
    v_mfma_f32_16x16x32_bf16 v[108:111], v[176:179], v[164:167], v[108:111]
    ds_read_b128 v[224:227], v2 offset:12288
    v_permlane16_swap_b32 v24, v26
    v_mfma_f32_16x16x32_bf16 v[112:115], v[180:183], v[160:163], v[112:115]
    ds_read_b128 v[228:231], v2 offset:13312
    v_permlane16_swap_b32 v25, v27
    v_mfma_f32_16x16x32_bf16 v[116:119], v[180:183], v[164:167], v[116:119]
    ds_read_b128 v[232:235], v2 offset:14336
    s_waitcnt lgkmcnt(8)
    v_mfma_f32_16x16x32_bf16 v[120:123], v[184:187], v[160:163], v[120:123]
    ds_read_b128 v[236:239], v2 offset:15360
    v_fma_f32 v40, v40, v4, -v6
    v_mfma_f32_16x16x32_bf16 v[124:127], v[184:187], v[164:167], v[124:127]
    ds_read_b128 v[240:243], v2 offset:16384
    v_fma_f32 v41, v41, v5, -v7
    v_mfma_f32_16x16x32_bf16 v[128:131], v[188:191], v[160:163], v[128:131]
    ds_read_b128 v[244:247], v2 offset:17408
    v_fma_f32 v42, v42, v8, -v10
    v_mfma_f32_16x16x32_bf16 v[132:135], v[188:191], v[164:167], v[132:135]
    v_fma_f32 v43, v43, v9, -v11
    v_fma_f32 v44, v44, v12, -v14
    v_mfma_f32_16x16x32_bf16 v[136:139], v[192:195], v[160:163], v[136:139]
    v_fma_f32 v45, v45, v13, -v15
    v_fma_f32 v46, v46, v252, -v254
    v_mfma_f32_16x16x32_bf16 v[140:143], v[192:195], v[164:167], v[140:143]
    v_fma_f32 v47, v47, v253, -v255
    v_permlane32_swap_b32 v32, v34
    v_mfma_f32_16x16x32_bf16 v[144:147], v[196:199], v[160:163], v[144:147]
    v_permlane32_swap_b32 v33, v35
    v_cvt_pk_bf16_f32 v40, v40, v41
    v_mfma_f32_16x16x32_bf16 v[148:151], v[196:199], v[164:167], v[148:151]
    v_cvt_pk_bf16_f32 v41, v42, v43
    v_cvt_pk_bf16_f32 v42, v44, v45
    v_mfma_f32_16x16x32_bf16 v[152:155], v[200:203], v[160:163], v[152:155]
    v_cvt_pk_bf16_f32 v43, v46, v47
    v_permlane16_swap_b32 v32, v34
    v_mfma_f32_16x16x32_bf16 v[156:159], v[200:203], v[164:167], v[156:159]
    v_permlane16_swap_b32 v33, v35
    s_waitcnt lgkmcnt(0)
    s_barrier
    v_mfma_f32_16x16x32_bf16 v[88:91], v[212:215], v[204:207], v[88:91]
    ds_read_b128 v[160:163], v0 offset:36864
    v_mfma_f32_16x16x32_bf16 v[92:95], v[212:215], v[208:211], v[92:95]
    ds_read_b128 v[164:167], v0 offset:38912
    v_fma_f32 v48, v48, v4, -v6
    v_mfma_f32_16x16x32_bf16 v[96:99], v[216:219], v[204:207], v[96:99]
    ds_read_b128 v[168:171], v2 offset:36864
    buffer_store_dwordx4 v[16:19], v1, s[4:7], s38 offen offset:0 sc1
    v_fma_f32 v49, v49, v5, -v7
    v_mfma_f32_16x16x32_bf16 v[100:103], v[216:219], v[208:211], v[100:103]
    ds_read_b128 v[172:175], v2 offset:37888
    v_fma_f32 v50, v50, v8, -v10
    v_mfma_f32_16x16x32_bf16 v[104:107], v[220:223], v[204:207], v[104:107]
    ds_read_b128 v[176:179], v2 offset:38912
    v_fma_f32 v51, v51, v9, -v11
    v_mfma_f32_16x16x32_bf16 v[108:111], v[220:223], v[208:211], v[108:111]
    ds_read_b128 v[180:183], v2 offset:39936
    v_fma_f32 v52, v52, v12, -v14
    v_mfma_f32_16x16x32_bf16 v[112:115], v[224:227], v[204:207], v[112:115]
    ds_read_b128 v[184:187], v2 offset:40960
    v_fma_f32 v53, v53, v13, -v15
    v_mfma_f32_16x16x32_bf16 v[116:119], v[224:227], v[208:211], v[116:119]
    ds_read_b128 v[188:191], v2 offset:41984
    v_mfma_f32_16x16x32_bf16 v[120:123], v[228:231], v[204:207], v[120:123]
    ds_read_b128 v[192:195], v2 offset:43008
    v_fma_f32 v54, v54, v252, -v254
    v_mfma_f32_16x16x32_bf16 v[124:127], v[228:231], v[208:211], v[124:127]
    ds_read_b128 v[196:199], v2 offset:44032
    v_fma_f32 v55, v55, v253, -v255
    v_mfma_f32_16x16x32_bf16 v[128:131], v[232:235], v[204:207], v[128:131]
    ds_read_b128 v[200:203], v2 offset:45056
    buffer_store_dwordx4 v[24:27], v1, s[4:7], s38 offen offset:1024 sc1
    v_permlane32_swap_b32 v40, v42
    v_mfma_f32_16x16x32_bf16 v[132:135], v[232:235], v[208:211], v[132:135]
    v_permlane32_swap_b32 v41, v43
    v_cvt_pk_bf16_f32 v48, v48, v49
    v_mfma_f32_16x16x32_bf16 v[136:139], v[236:239], v[204:207], v[136:139]
    v_cvt_pk_bf16_f32 v49, v50, v51
    v_cvt_pk_bf16_f32 v50, v52, v53
    v_mfma_f32_16x16x32_bf16 v[140:143], v[236:239], v[208:211], v[140:143]
    v_cvt_pk_bf16_f32 v51, v54, v55
    v_permlane16_swap_b32 v40, v42
    v_mfma_f32_16x16x32_bf16 v[144:147], v[240:243], v[204:207], v[144:147]
    v_permlane16_swap_b32 v41, v43
    v_fma_f32 v56, v56, v4, -v6
    v_mfma_f32_16x16x32_bf16 v[148:151], v[240:243], v[208:211], v[148:151]
    v_fma_f32 v57, v57, v5, -v7
    v_fma_f32 v58, v58, v8, -v10
    v_mfma_f32_16x16x32_bf16 v[152:155], v[244:247], v[204:207], v[152:155]
    v_fma_f32 v59, v59, v9, -v11
    v_fma_f32 v60, v60, v12, -v14
    v_mfma_f32_16x16x32_bf16 v[156:159], v[244:247], v[208:211], v[156:159]
    v_fma_f32 v61, v61, v13, -v15
    s_waitcnt lgkmcnt(5)
    v_mfma_f32_16x16x32_bf16 v[88:91], v[168:171], v[160:163], v[88:91]
    ds_read_b128 v[204:207], v0 offset:37888
    v_mfma_f32_16x16x32_bf16 v[92:95], v[168:171], v[164:167], v[92:95]
    ds_read_b128 v[208:211], v0 offset:39936
    v_fma_f32 v62, v62, v252, -v254
    v_mfma_f32_16x16x32_bf16 v[96:99], v[172:175], v[160:163], v[96:99]
    ds_read_b128 v[212:215], v2 offset:46080
    buffer_store_dwordx4 v[32:35], v1, s[4:7], s38 offen offset:2048 sc1
    v_fma_f32 v63, v63, v253, -v255
    v_mfma_f32_16x16x32_bf16 v[100:103], v[172:175], v[164:167], v[100:103]
    ds_read_b128 v[216:219], v2 offset:47104
    v_permlane32_swap_b32 v48, v50
    v_mfma_f32_16x16x32_bf16 v[104:107], v[176:179], v[160:163], v[104:107]
    ds_read_b128 v[220:223], v2 offset:48128
    v_permlane32_swap_b32 v49, v51
    v_mfma_f32_16x16x32_bf16 v[108:111], v[176:179], v[164:167], v[108:111]
    ds_read_b128 v[224:227], v2 offset:49152
    v_cvt_pk_bf16_f32 v56, v56, v57
    v_mfma_f32_16x16x32_bf16 v[112:115], v[180:183], v[160:163], v[112:115]
    ds_read_b128 v[228:231], v2 offset:50176
    v_cvt_pk_bf16_f32 v57, v58, v59
    v_mfma_f32_16x16x32_bf16 v[116:119], v[180:183], v[164:167], v[116:119]
    ds_read_b128 v[232:235], v2 offset:51200
    s_waitcnt lgkmcnt(8)
    v_mfma_f32_16x16x32_bf16 v[120:123], v[184:187], v[160:163], v[120:123]
    ds_read_b128 v[236:239], v2 offset:52224
    v_cvt_pk_bf16_f32 v58, v60, v61
    v_mfma_f32_16x16x32_bf16 v[124:127], v[184:187], v[164:167], v[124:127]
    ds_read_b128 v[240:243], v2 offset:53248
    v_cvt_pk_bf16_f32 v59, v62, v63
    v_mfma_f32_16x16x32_bf16 v[128:131], v[188:191], v[160:163], v[128:131]
    ds_read_b128 v[244:247], v2 offset:54272
    buffer_store_dwordx4 v[40:43], v1, s[4:7], s38 offen offset:3072 sc1
    v_permlane16_swap_b32 v48, v50
    v_mfma_f32_16x16x32_bf16 v[132:135], v[188:191], v[164:167], v[132:135]
    v_permlane16_swap_b32 v49, v51
    v_fma_f32 v64, v64, v4, -v6
    v_mfma_f32_16x16x32_bf16 v[136:139], v[192:195], v[160:163], v[136:139]
    v_fma_f32 v65, v65, v5, -v7
    v_fma_f32 v66, v66, v8, -v10
    v_mfma_f32_16x16x32_bf16 v[140:143], v[192:195], v[164:167], v[140:143]
    v_fma_f32 v67, v67, v9, -v11
    v_fma_f32 v68, v68, v12, -v14
    v_mfma_f32_16x16x32_bf16 v[144:147], v[196:199], v[160:163], v[144:147]
    v_fma_f32 v69, v69, v13, -v15
    v_fma_f32 v70, v70, v252, -v254
    v_mfma_f32_16x16x32_bf16 v[148:151], v[196:199], v[164:167], v[148:151]
    v_fma_f32 v71, v71, v253, -v255
    v_permlane32_swap_b32 v56, v58
    v_mfma_f32_16x16x32_bf16 v[152:155], v[200:203], v[160:163], v[152:155]
    v_permlane32_swap_b32 v57, v59
    v_cvt_pk_bf16_f32 v64, v64, v65
    v_mfma_f32_16x16x32_bf16 v[156:159], v[200:203], v[164:167], v[156:159]
    v_cvt_pk_bf16_f32 v65, v66, v67
    s_waitcnt lgkmcnt(0)
    s_barrier
    v_mfma_f32_16x16x32_bf16 v[88:91], v[212:215], v[204:207], v[88:91]
    ds_read_b128 v[160:163], v3 offset:0
    v_mfma_f32_16x16x32_bf16 v[92:95], v[212:215], v[208:211], v[92:95]
    ds_read_b128 v[164:167], v3 offset:2048
    v_cvt_pk_bf16_f32 v66, v68, v69
    v_mfma_f32_16x16x32_bf16 v[96:99], v[216:219], v[204:207], v[96:99]
    ds_read_b128 v[168:171], v1 offset:0
    buffer_store_dwordx4 v[48:51], v1, s[4:7], s39 offen offset:0 sc1
    v_cvt_pk_bf16_f32 v67, v70, v71
    v_mfma_f32_16x16x32_bf16 v[100:103], v[216:219], v[208:211], v[100:103]
    ds_read_b128 v[172:175], v1 offset:1024
    v_permlane16_swap_b32 v56, v58
    v_mfma_f32_16x16x32_bf16 v[104:107], v[220:223], v[204:207], v[104:107]
    ds_read_b128 v[176:179], v1 offset:2048
    v_permlane16_swap_b32 v57, v59
    v_mfma_f32_16x16x32_bf16 v[108:111], v[220:223], v[208:211], v[108:111]
    ds_read_b128 v[180:183], v1 offset:3072
    v_fma_f32 v72, v72, v4, -v6
    v_mfma_f32_16x16x32_bf16 v[112:115], v[224:227], v[204:207], v[112:115]
    ds_read_b128 v[184:187], v1 offset:4096
    v_fma_f32 v73, v73, v5, -v7
    v_mfma_f32_16x16x32_bf16 v[116:119], v[224:227], v[208:211], v[116:119]
    ds_read_b128 v[188:191], v1 offset:5120
    v_mfma_f32_16x16x32_bf16 v[120:123], v[228:231], v[204:207], v[120:123]
    ds_read_b128 v[192:195], v1 offset:6144
    v_fma_f32 v74, v74, v8, -v10
    v_mfma_f32_16x16x32_bf16 v[124:127], v[228:231], v[208:211], v[124:127]
    ds_read_b128 v[196:199], v1 offset:7168
    v_fma_f32 v75, v75, v9, -v11
    v_mfma_f32_16x16x32_bf16 v[128:131], v[232:235], v[204:207], v[128:131]
    ds_read_b128 v[200:203], v1 offset:8192
    v_fma_f32 v76, v76, v12, -v14
    v_mfma_f32_16x16x32_bf16 v[132:135], v[232:235], v[208:211], v[132:135]
    v_fma_f32 v77, v77, v13, -v15
    v_fma_f32 v78, v78, v252, -v254
    v_mfma_f32_16x16x32_bf16 v[136:139], v[236:239], v[204:207], v[136:139]
    v_fma_f32 v79, v79, v253, -v255
    v_permlane32_swap_b32 v64, v66
    v_mfma_f32_16x16x32_bf16 v[140:143], v[236:239], v[208:211], v[140:143]
    v_permlane32_swap_b32 v65, v67
    v_cvt_pk_bf16_f32 v72, v72, v73
    v_mfma_f32_16x16x32_bf16 v[144:147], v[240:243], v[204:207], v[144:147]
    v_cvt_pk_bf16_f32 v73, v74, v75
    v_cvt_pk_bf16_f32 v74, v76, v77
    v_mfma_f32_16x16x32_bf16 v[148:151], v[240:243], v[208:211], v[148:151]
    v_cvt_pk_bf16_f32 v75, v78, v79
    v_permlane16_swap_b32 v64, v66
    v_mfma_f32_16x16x32_bf16 v[152:155], v[244:247], v[204:207], v[152:155]
    v_permlane16_swap_b32 v65, v67
    v_fma_f32 v80, v80, v4, -v6
    v_mfma_f32_16x16x32_bf16 v[156:159], v[244:247], v[208:211], v[156:159]
    v_fma_f32 v81, v81, v5, -v7
    s_waitcnt lgkmcnt(5)
    v_mfma_f32_16x16x32_bf16 v[88:91], v[168:171], v[160:163], v[88:91]
    ds_read_b128 v[204:207], v3 offset:1024
    v_mfma_f32_16x16x32_bf16 v[92:95], v[168:171], v[164:167], v[92:95]
    ds_read_b128 v[208:211], v3 offset:3072
    v_fma_f32 v82, v82, v8, -v10
    v_mfma_f32_16x16x32_bf16 v[96:99], v[172:175], v[160:163], v[96:99]
    ds_read_b128 v[212:215], v1 offset:9216
    buffer_store_dwordx4 v[56:59], v1, s[4:7], s39 offen offset:1024 sc1
    v_fma_f32 v83, v83, v9, -v11
    v_mfma_f32_16x16x32_bf16 v[100:103], v[172:175], v[164:167], v[100:103]
    ds_read_b128 v[216:219], v1 offset:10240
    v_fma_f32 v84, v84, v12, -v14
    v_mfma_f32_16x16x32_bf16 v[104:107], v[176:179], v[160:163], v[104:107]
    ds_read_b128 v[220:223], v1 offset:11264
    v_fma_f32 v85, v85, v13, -v15
    v_mfma_f32_16x16x32_bf16 v[108:111], v[176:179], v[164:167], v[108:111]
    ds_read_b128 v[224:227], v1 offset:12288
    v_fma_f32 v86, v86, v252, -v254
    v_mfma_f32_16x16x32_bf16 v[112:115], v[180:183], v[160:163], v[112:115]
    ds_read_b128 v[228:231], v1 offset:13312
    v_fma_f32 v87, v87, v253, -v255
    v_mfma_f32_16x16x32_bf16 v[116:119], v[180:183], v[164:167], v[116:119]
    ds_read_b128 v[232:235], v1 offset:14336
    s_waitcnt lgkmcnt(8)
    v_mfma_f32_16x16x32_bf16 v[120:123], v[184:187], v[160:163], v[120:123]
    ds_read_b128 v[236:239], v1 offset:15360
    v_permlane32_swap_b32 v72, v74
    v_mfma_f32_16x16x32_bf16 v[124:127], v[184:187], v[164:167], v[124:127]
    ds_read_b128 v[240:243], v1 offset:16384
    v_permlane32_swap_b32 v73, v75
    v_mfma_f32_16x16x32_bf16 v[128:131], v[188:191], v[160:163], v[128:131]
    ds_read_b128 v[244:247], v1 offset:17408
    buffer_store_dwordx4 v[64:67], v1, s[4:7], s39 offen offset:2048 sc1
    v_cvt_pk_bf16_f32 v80, v80, v81
    v_mfma_f32_16x16x32_bf16 v[132:135], v[188:191], v[164:167], v[132:135]
    v_cvt_pk_bf16_f32 v81, v82, v83
    v_cvt_pk_bf16_f32 v82, v84, v85
    v_mfma_f32_16x16x32_bf16 v[136:139], v[192:195], v[160:163], v[136:139]
    v_cvt_pk_bf16_f32 v83, v86, v87
    v_permlane16_swap_b32 v72, v74
    v_mfma_f32_16x16x32_bf16 v[140:143], v[192:195], v[164:167], v[140:143]
    v_permlane16_swap_b32 v73, v75
    s_nop 0
    v_mfma_f32_16x16x32_bf16 v[144:147], v[196:199], v[160:163], v[144:147]
    v_permlane32_swap_b32 v80, v82
    v_permlane32_swap_b32 v81, v83
    v_mfma_f32_16x16x32_bf16 v[148:151], v[196:199], v[164:167], v[148:151]
    s_nop 0
    v_permlane16_swap_b32 v80, v82
    v_mfma_f32_16x16x32_bf16 v[152:155], v[200:203], v[160:163], v[152:155]
    v_permlane16_swap_b32 v81, v83
    v_mul_f32 v4, s40, v249
    v_mfma_f32_16x16x32_bf16 v[156:159], v[200:203], v[164:167], v[156:159]
    v_mul_f32 v6, s40, v251
    s_waitcnt lgkmcnt(0)
    s_barrier
    v_mfma_f32_16x16x32_bf16 v[88:91], v[212:215], v[204:207], v[88:91]
    ds_read_b128 v[160:163], v3 offset:36864
    v_mfma_f32_16x16x32_bf16 v[92:95], v[212:215], v[208:211], v[92:95]
    ds_read_b128 v[164:167], v3 offset:38912
    v_mul_f32 v5, v249, v249
    v_mfma_f32_16x16x32_bf16 v[96:99], v[216:219], v[204:207], v[96:99]
    ds_read_b128 v[168:171], v1 offset:36864
    buffer_store_dwordx4 v[72:75], v1, s[4:7], s39 offen offset:3072 sc1
    v_mul_f32 v7, v251, v251
    v_mfma_f32_16x16x32_bf16 v[100:103], v[216:219], v[208:211], v[100:103]
    ds_read_b128 v[172:175], v1 offset:37888
    v_rcp_f32 v249, v249
    v_mfma_f32_16x16x32_bf16 v[104:107], v[220:223], v[204:207], v[104:107]
    ds_read_b128 v[176:179], v1 offset:38912
    v_rcp_f32 v251, v251
    v_mfma_f32_16x16x32_bf16 v[108:111], v[220:223], v[208:211], v[108:111]
    ds_read_b128 v[180:183], v1 offset:39936
    v_mul_f32 v5, s42, v5
    v_mfma_f32_16x16x32_bf16 v[112:115], v[224:227], v[204:207], v[112:115]
    ds_read_b128 v[184:187], v1 offset:40960
    v_mul_f32 v7, s42, v7
    v_mfma_f32_16x16x32_bf16 v[116:119], v[224:227], v[208:211], v[116:119]
    ds_read_b128 v[188:191], v1 offset:41984
    v_mfma_f32_16x16x32_bf16 v[120:123], v[228:231], v[204:207], v[120:123]
    ds_read_b128 v[192:195], v1 offset:43008
    v_mul_f32 v5, v5, v4
    v_mfma_f32_16x16x32_bf16 v[124:127], v[228:231], v[208:211], v[124:127]
    ds_read_b128 v[196:199], v1 offset:44032
    v_mul_f32 v7, v7, v6
    v_mfma_f32_16x16x32_bf16 v[128:131], v[232:235], v[204:207], v[128:131]
    ds_read_b128 v[200:203], v1 offset:45056
    buffer_store_dwordx4 v[80:83], v1, s[4:7], s46 offen offset:0 sc1
    v_bfe_u32 v13, v1, 4, 4
    v_mfma_f32_16x16x32_bf16 v[132:135], v[232:235], v[208:211], v[132:135]
    v_lshrrev_b32 v8, 1, v13
    v_lshrrev_b32 v9, 8, v1
    v_mfma_f32_16x16x32_bf16 v[136:139], v[236:239], v[204:207], v[136:139]
    v_xor_b32 v8, v8, v9
    v_lshlrev_b32 v8, 4, v8
    v_mfma_f32_16x16x32_bf16 v[140:143], v[236:239], v[208:211], v[140:143]
    v_lshl_add_u32 v8, v13, 7, v8
    s_add_u32 s33, s30, 18432
    v_mfma_f32_16x16x32_bf16 v[144:147], v[240:243], v[204:207], v[144:147]
    v_add_u32 v8, s33, v8
    v_xor_b32 v9, 64, v8
    v_mfma_f32_16x16x32_bf16 v[148:151], v[240:243], v[208:211], v[148:151]
    v_add_u32 v10, 73728, v8
    v_add_u32 v11, 73728, v9
    v_mfma_f32_16x16x32_bf16 v[152:155], v[244:247], v[204:207], v[152:155]
    s_lshl_b32 s33, s20, 6
    s_add_u32 s33, s33, 161280
    v_mfma_f32_16x16x32_bf16 v[156:159], v[244:247], v[208:211], v[156:159]
    v_lshl_add_u32 v13, v13, 1, s33
    s_waitcnt lgkmcnt(5)
    v_mfma_f32_16x16x32_bf16 v[88:91], v[168:171], v[160:163], v[88:91]
    ds_read_b128 v[204:207], v3 offset:37888
    v_mfma_f32_16x16x32_bf16 v[92:95], v[168:171], v[164:167], v[92:95]
    ds_read_b128 v[208:211], v3 offset:39936
    v_mfma_f32_16x16x32_bf16 v[96:99], v[172:175], v[160:163], v[96:99]
    ds_read_b128 v[212:215], v1 offset:46080
    v_mfma_f32_16x16x32_bf16 v[100:103], v[172:175], v[164:167], v[100:103]
    ds_read_b128 v[216:219], v1 offset:47104
    v_mfma_f32_16x16x32_bf16 v[104:107], v[176:179], v[160:163], v[104:107]
    ds_read_b128 v[220:223], v1 offset:48128
    v_mfma_f32_16x16x32_bf16 v[108:111], v[176:179], v[164:167], v[108:111]
    ds_read_b128 v[224:227], v1 offset:49152
    v_mfma_f32_16x16x32_bf16 v[112:115], v[180:183], v[160:163], v[112:115]
    ds_read_b128 v[228:231], v1 offset:50176
    v_mfma_f32_16x16x32_bf16 v[116:119], v[180:183], v[164:167], v[116:119]
    ds_read_b128 v[232:235], v1 offset:51200
    s_waitcnt lgkmcnt(8)
    v_mfma_f32_16x16x32_bf16 v[120:123], v[184:187], v[160:163], v[120:123]
    ds_read_b128 v[236:239], v1 offset:52224
    v_mfma_f32_16x16x32_bf16 v[124:127], v[184:187], v[164:167], v[124:127]
    ds_read_b128 v[240:243], v1 offset:53248
    v_mfma_f32_16x16x32_bf16 v[128:131], v[188:191], v[160:163], v[128:131]
    ds_read_b128 v[244:247], v1 offset:54272
    v_mfma_f32_16x16x32_bf16 v[132:135], v[188:191], v[164:167], v[132:135]
    v_mfma_f32_16x16x32_bf16 v[136:139], v[192:195], v[160:163], v[136:139]
    v_lshrrev_b32 v0, 4, v1
    v_mfma_f32_16x16x32_bf16 v[140:143], v[192:195], v[164:167], v[140:143]
    v_and_b32 v0, 48, v0
    v_mfma_f32_16x16x32_bf16 v[144:147], v[196:199], v[160:163], v[144:147]
    v_add_u32 v0, 160320, v0
    v_mfma_f32_16x16x32_bf16 v[148:151], v[196:199], v[164:167], v[148:151]
    v_mfma_f32_16x16x32_bf16 v[152:155], v[200:203], v[160:163], v[152:155]
    v_mfma_f32_16x16x32_bf16 v[156:159], v[200:203], v[164:167], v[156:159]
    s_waitcnt lgkmcnt(0)
    v_mfma_f32_16x16x32_bf16 v[88:91], v[212:215], v[204:207], v[88:91]
    ds_read_b128 v[168:171], v0 offset:0
    v_mfma_f32_16x16x32_bf16 v[92:95], v[212:215], v[208:211], v[92:95]
    ds_read_b128 v[172:175], v0 offset:64
    v_mfma_f32_16x16x32_bf16 v[96:99], v[216:219], v[204:207], v[96:99]
    ds_read_b128 v[176:179], v0 offset:128
    v_mfma_f32_16x16x32_bf16 v[100:103], v[216:219], v[208:211], v[100:103]
    ds_read_b128 v[180:183], v0 offset:192
    v_mfma_f32_16x16x32_bf16 v[104:107], v[220:223], v[204:207], v[104:107]
    ds_read_b128 v[184:187], v0 offset:256
    v_mfma_f32_16x16x32_bf16 v[108:111], v[220:223], v[208:211], v[108:111]
    ds_read_b128 v[188:191], v0 offset:320
    v_mfma_f32_16x16x32_bf16 v[112:115], v[224:227], v[204:207], v[112:115]
    ds_read_b128 v[192:195], v0 offset:384
    v_mfma_f32_16x16x32_bf16 v[116:119], v[224:227], v[208:211], v[116:119]
    ds_read_b128 v[196:199], v0 offset:448
    v_mfma_f32_16x16x32_bf16 v[120:123], v[228:231], v[204:207], v[120:123]
    ds_read_b128 v[200:203], v0 offset:512
    v_mfma_f32_16x16x32_bf16 v[124:127], v[228:231], v[208:211], v[124:127]
    ds_read_u16 v12, v13
    v_mfma_f32_16x16x32_bf16 v[128:131], v[232:235], v[204:207], v[128:131]
    ds_read_u16 v252, v13 offset:32
    v_mfma_f32_16x16x32_bf16 v[132:135], v[232:235], v[208:211], v[132:135]
    v_mfma_f32_16x16x32_bf16 v[136:139], v[236:239], v[204:207], v[136:139]
    s_lshr_b32 s35, s20, 1
    s_mul_i32 s35, s35, 36864
    v_mfma_f32_16x16x32_bf16 v[140:143], v[236:239], v[208:211], v[140:143]
    s_and_b32 s34, s20, 1
    s_mul_i32 s34, s34, 9216
    v_mfma_f32_16x16x32_bf16 v[144:147], v[240:243], v[204:207], v[144:147]
    s_add_u32 s35, s35, s34
    v_mfma_f32_16x16x32_bf16 v[148:151], v[240:243], v[208:211], v[148:151]
    v_add_u32 v3, s35, v2
    v_mfma_f32_16x16x32_bf16 v[152:155], v[244:247], v[204:207], v[152:155]
    v_mfma_f32_16x16x32_bf16 v[156:159], v[244:247], v[208:211], v[156:159]
    s_waitcnt vmcnt(0)
    s_barrier
    s_waitcnt lgkmcnt(0)
    v_lshlrev_b32 v15, 16, v12
    v_lshlrev_b32 v255, 16, v252
    v_lshlrev_b32 v14, 16, v12
    v_lshlrev_b32 v254, 16, v252
    v_lshlrev_b32 v13, 16, v12
    v_lshlrev_b32 v253, 16, v252
    v_lshlrev_b32 v12, 16, v12
    v_lshlrev_b32 v252, 16, v252
    ds_write_b128 v3, v[16:19] offset:0
    v_pk_fma_f32 v[88:89], v[248:249], v[168:169], v[88:89] op_sel_hi:[0,1,1] neg_lo:[1,0,0] neg_hi:[1,0,0]
    v_pk_fma_f32 v[90:91], v[248:249], v[170:171], v[90:91] op_sel_hi:[0,1,1] neg_lo:[1,0,0] neg_hi:[1,0,0]
    v_pk_fma_f32 v[92:93], v[250:251], v[168:169], v[92:93] op_sel_hi:[0,1,1] neg_lo:[1,0,0] neg_hi:[1,0,0]
    v_pk_fma_f32 v[94:95], v[250:251], v[170:171], v[94:95] op_sel_hi:[0,1,1] neg_lo:[1,0,0] neg_hi:[1,0,0]
    ds_write_b128 v3, v[24:27] offset:1024
    v_pk_fma_f32 v[96:97], v[248:249], v[172:173], v[96:97] op_sel_hi:[0,1,1] neg_lo:[1,0,0] neg_hi:[1,0,0]
    v_pk_fma_f32 v[98:99], v[248:249], v[174:175], v[98:99] op_sel_hi:[0,1,1] neg_lo:[1,0,0] neg_hi:[1,0,0]
    v_pk_fma_f32 v[100:101], v[250:251], v[172:173], v[100:101] op_sel_hi:[0,1,1] neg_lo:[1,0,0] neg_hi:[1,0,0]
    v_pk_fma_f32 v[102:103], v[250:251], v[174:175], v[102:103] op_sel_hi:[0,1,1] neg_lo:[1,0,0] neg_hi:[1,0,0]
    ds_write_b128 v3, v[32:35] offset:2048
    v_pk_fma_f32 v[104:105], v[248:249], v[176:177], v[104:105] op_sel_hi:[0,1,1] neg_lo:[1,0,0] neg_hi:[1,0,0]
    v_pk_fma_f32 v[106:107], v[248:249], v[178:179], v[106:107] op_sel_hi:[0,1,1] neg_lo:[1,0,0] neg_hi:[1,0,0]
    v_pk_fma_f32 v[108:109], v[250:251], v[176:177], v[108:109] op_sel_hi:[0,1,1] neg_lo:[1,0,0] neg_hi:[1,0,0]
    v_pk_fma_f32 v[110:111], v[250:251], v[178:179], v[110:111] op_sel_hi:[0,1,1] neg_lo:[1,0,0] neg_hi:[1,0,0]
    ds_write_b128 v3, v[40:43] offset:3072
    v_pk_fma_f32 v[112:113], v[248:249], v[180:181], v[112:113] op_sel_hi:[0,1,1] neg_lo:[1,0,0] neg_hi:[1,0,0]
    v_pk_fma_f32 v[114:115], v[248:249], v[182:183], v[114:115] op_sel_hi:[0,1,1] neg_lo:[1,0,0] neg_hi:[1,0,0]
    v_pk_fma_f32 v[116:117], v[250:251], v[180:181], v[116:117] op_sel_hi:[0,1,1] neg_lo:[1,0,0] neg_hi:[1,0,0]
    v_pk_fma_f32 v[118:119], v[250:251], v[182:183], v[118:119] op_sel_hi:[0,1,1] neg_lo:[1,0,0] neg_hi:[1,0,0]
    ds_write_b128 v3, v[48:51] offset:4096
    v_pk_fma_f32 v[120:121], v[248:249], v[184:185], v[120:121] op_sel_hi:[0,1,1] neg_lo:[1,0,0] neg_hi:[1,0,0]
    v_pk_fma_f32 v[122:123], v[248:249], v[186:187], v[122:123] op_sel_hi:[0,1,1] neg_lo:[1,0,0] neg_hi:[1,0,0]
    v_pk_fma_f32 v[124:125], v[250:251], v[184:185], v[124:125] op_sel_hi:[0,1,1] neg_lo:[1,0,0] neg_hi:[1,0,0]
    v_pk_fma_f32 v[126:127], v[250:251], v[186:187], v[126:127] op_sel_hi:[0,1,1] neg_lo:[1,0,0] neg_hi:[1,0,0]
    ds_write_b128 v3, v[56:59] offset:5120
    v_pk_fma_f32 v[128:129], v[248:249], v[188:189], v[128:129] op_sel_hi:[0,1,1] neg_lo:[1,0,0] neg_hi:[1,0,0]
    v_pk_fma_f32 v[130:131], v[248:249], v[190:191], v[130:131] op_sel_hi:[0,1,1] neg_lo:[1,0,0] neg_hi:[1,0,0]
    v_pk_fma_f32 v[132:133], v[250:251], v[188:189], v[132:133] op_sel_hi:[0,1,1] neg_lo:[1,0,0] neg_hi:[1,0,0]
    v_pk_fma_f32 v[134:135], v[250:251], v[190:191], v[134:135] op_sel_hi:[0,1,1] neg_lo:[1,0,0] neg_hi:[1,0,0]
    ds_write_b128 v3, v[64:67] offset:6144
    v_pk_fma_f32 v[136:137], v[248:249], v[192:193], v[136:137] op_sel_hi:[0,1,1] neg_lo:[1,0,0] neg_hi:[1,0,0]
    v_pk_fma_f32 v[138:139], v[248:249], v[194:195], v[138:139] op_sel_hi:[0,1,1] neg_lo:[1,0,0] neg_hi:[1,0,0]
    v_pk_fma_f32 v[140:141], v[250:251], v[192:193], v[140:141] op_sel_hi:[0,1,1] neg_lo:[1,0,0] neg_hi:[1,0,0]
    v_pk_fma_f32 v[142:143], v[250:251], v[194:195], v[142:143] op_sel_hi:[0,1,1] neg_lo:[1,0,0] neg_hi:[1,0,0]
    ds_write_b128 v3, v[72:75] offset:7168
    v_pk_fma_f32 v[144:145], v[248:249], v[196:197], v[144:145] op_sel_hi:[0,1,1] neg_lo:[1,0,0] neg_hi:[1,0,0]
    v_pk_fma_f32 v[146:147], v[248:249], v[198:199], v[146:147] op_sel_hi:[0,1,1] neg_lo:[1,0,0] neg_hi:[1,0,0]
    v_pk_fma_f32 v[148:149], v[250:251], v[196:197], v[148:149] op_sel_hi:[0,1,1] neg_lo:[1,0,0] neg_hi:[1,0,0]
    v_pk_fma_f32 v[150:151], v[250:251], v[198:199], v[150:151] op_sel_hi:[0,1,1] neg_lo:[1,0,0] neg_hi:[1,0,0]
    ds_write_b128 v3, v[80:83] offset:8192
    v_pk_fma_f32 v[152:153], v[248:249], v[200:201], v[152:153] op_sel_hi:[0,1,1] neg_lo:[1,0,0] neg_hi:[1,0,0]
    v_pk_fma_f32 v[154:155], v[248:249], v[202:203], v[154:155] op_sel_hi:[0,1,1] neg_lo:[1,0,0] neg_hi:[1,0,0]
    v_pk_fma_f32 v[156:157], v[250:251], v[200:201], v[156:157] op_sel_hi:[0,1,1] neg_lo:[1,0,0] neg_hi:[1,0,0]
    v_pk_fma_f32 v[158:159], v[250:251], v[202:203], v[158:159] op_sel_hi:[0,1,1] neg_lo:[1,0,0] neg_hi:[1,0,0]
    v_pk_mul_f32 v[204:205], v[88:89], v[88:89]
    v_pk_mul_f32 v[206:207], v[90:91], v[90:91]
    v_pk_mul_f32 v[208:209], v[92:93], v[92:93]
    v_pk_mul_f32 v[210:211], v[94:95], v[94:95]
    v_pk_fma_f32 v[204:205], v[204:205], v[4:5], v[4:5] op_sel:[0,1,0] op_sel_hi:[1,1,0]
    v_pk_fma_f32 v[206:207], v[206:207], v[4:5], v[4:5] op_sel:[0,1,0] op_sel_hi:[1,1,0]
    v_pk_fma_f32 v[208:209], v[208:209], v[6:7], v[6:7] op_sel:[0,1,0] op_sel_hi:[1,1,0]
    v_pk_fma_f32 v[210:211], v[210:211], v[6:7], v[6:7] op_sel:[0,1,0] op_sel_hi:[1,1,0]
    v_pk_mul_f32 v[204:205], v[204:205], v[88:89]
    v_pk_mul_f32 v[206:207], v[206:207], v[90:91]
    v_pk_mul_f32 v[208:209], v[208:209], v[92:93]
    v_pk_mul_f32 v[210:211], v[210:211], v[94:95]
    v_exp_f32 v204, v204
    v_exp_f32 v205, v205
    v_exp_f32 v206, v206
    v_exp_f32 v207, v207
    v_exp_f32 v208, v208
    v_exp_f32 v209, v209
    v_exp_f32 v210, v210
    v_exp_f32 v211, v211
    v_pk_fma_f32 v[204:205], v[204:205], v[248:249], v[248:249] op_sel:[0,1,1] op_sel_hi:[1,1,1]
    v_pk_fma_f32 v[206:207], v[206:207], v[248:249], v[248:249] op_sel:[0,1,1] op_sel_hi:[1,1,1]
    v_pk_fma_f32 v[208:209], v[208:209], v[250:251], v[250:251] op_sel:[0,1,1] op_sel_hi:[1,1,1]
    v_pk_fma_f32 v[210:211], v[210:211], v[250:251], v[250:251] op_sel:[0,1,1] op_sel_hi:[1,1,1]
    v_rcp_f32 v204, v204
    v_rcp_f32 v205, v205
    v_rcp_f32 v206, v206
    v_rcp_f32 v207, v207
    v_rcp_f32 v208, v208
    v_rcp_f32 v209, v209
    v_rcp_f32 v210, v210
    v_rcp_f32 v211, v211
    v_pk_mul_f32 v[88:89], v[88:89], v[204:205]
    v_pk_mul_f32 v[90:91], v[90:91], v[206:207]
    v_pk_mul_f32 v[92:93], v[92:93], v[208:209]
    v_pk_mul_f32 v[94:95], v[94:95], v[210:211]
    v_pk_mul_f32 v[212:213], v[96:97], v[96:97]
    v_pk_mul_f32 v[214:215], v[98:99], v[98:99]
    v_pk_mul_f32 v[216:217], v[100:101], v[100:101]
    v_pk_mul_f32 v[218:219], v[102:103], v[102:103]
    v_pk_fma_f32 v[212:213], v[212:213], v[4:5], v[4:5] op_sel:[0,1,0] op_sel_hi:[1,1,0]
    v_pk_fma_f32 v[214:215], v[214:215], v[4:5], v[4:5] op_sel:[0,1,0] op_sel_hi:[1,1,0]
    v_pk_fma_f32 v[216:217], v[216:217], v[6:7], v[6:7] op_sel:[0,1,0] op_sel_hi:[1,1,0]
    v_pk_fma_f32 v[218:219], v[218:219], v[6:7], v[6:7] op_sel:[0,1,0] op_sel_hi:[1,1,0]
    v_pk_mul_f32 v[212:213], v[212:213], v[96:97]
    v_pk_mul_f32 v[214:215], v[214:215], v[98:99]
    v_pk_mul_f32 v[216:217], v[216:217], v[100:101]
    v_pk_mul_f32 v[218:219], v[218:219], v[102:103]
    v_exp_f32 v212, v212
    v_exp_f32 v213, v213
    v_exp_f32 v214, v214
    v_exp_f32 v215, v215
    v_exp_f32 v216, v216
    v_exp_f32 v217, v217
    v_exp_f32 v218, v218
    v_exp_f32 v219, v219
    v_pk_fma_f32 v[212:213], v[212:213], v[248:249], v[248:249] op_sel:[0,1,1] op_sel_hi:[1,1,1]
    v_pk_fma_f32 v[214:215], v[214:215], v[248:249], v[248:249] op_sel:[0,1,1] op_sel_hi:[1,1,1]
    v_pk_fma_f32 v[216:217], v[216:217], v[250:251], v[250:251] op_sel:[0,1,1] op_sel_hi:[1,1,1]
    v_pk_fma_f32 v[218:219], v[218:219], v[250:251], v[250:251] op_sel:[0,1,1] op_sel_hi:[1,1,1]
    v_rcp_f32 v212, v212
    v_rcp_f32 v213, v213
    v_rcp_f32 v214, v214
    v_rcp_f32 v215, v215
    v_rcp_f32 v216, v216
    v_rcp_f32 v217, v217
    v_rcp_f32 v218, v218
    v_rcp_f32 v219, v219
    v_pk_mul_f32 v[96:97], v[96:97], v[212:213]
    v_pk_mul_f32 v[98:99], v[98:99], v[214:215]
    v_pk_mul_f32 v[100:101], v[100:101], v[216:217]
    v_pk_mul_f32 v[102:103], v[102:103], v[218:219]
    v_pk_mul_f32 v[204:205], v[104:105], v[104:105]
    v_pk_mul_f32 v[206:207], v[106:107], v[106:107]
    v_pk_mul_f32 v[208:209], v[108:109], v[108:109]
    v_pk_mul_f32 v[210:211], v[110:111], v[110:111]
    v_pk_fma_f32 v[204:205], v[204:205], v[4:5], v[4:5] op_sel:[0,1,0] op_sel_hi:[1,1,0]
    v_pk_fma_f32 v[206:207], v[206:207], v[4:5], v[4:5] op_sel:[0,1,0] op_sel_hi:[1,1,0]
    v_pk_fma_f32 v[208:209], v[208:209], v[6:7], v[6:7] op_sel:[0,1,0] op_sel_hi:[1,1,0]
    v_pk_fma_f32 v[210:211], v[210:211], v[6:7], v[6:7] op_sel:[0,1,0] op_sel_hi:[1,1,0]
    v_pk_mul_f32 v[204:205], v[204:205], v[104:105]
    v_pk_mul_f32 v[206:207], v[206:207], v[106:107]
    v_pk_mul_f32 v[208:209], v[208:209], v[108:109]
    v_pk_mul_f32 v[210:211], v[210:211], v[110:111]
    v_exp_f32 v204, v204
    v_exp_f32 v205, v205
    v_exp_f32 v206, v206
    v_exp_f32 v207, v207
    v_exp_f32 v208, v208
    v_exp_f32 v209, v209
    v_exp_f32 v210, v210
    v_exp_f32 v211, v211
    v_pk_fma_f32 v[204:205], v[204:205], v[248:249], v[248:249] op_sel:[0,1,1] op_sel_hi:[1,1,1]
    v_pk_fma_f32 v[206:207], v[206:207], v[248:249], v[248:249] op_sel:[0,1,1] op_sel_hi:[1,1,1]
    v_pk_fma_f32 v[208:209], v[208:209], v[250:251], v[250:251] op_sel:[0,1,1] op_sel_hi:[1,1,1]
    v_pk_fma_f32 v[210:211], v[210:211], v[250:251], v[250:251] op_sel:[0,1,1] op_sel_hi:[1,1,1]
    v_rcp_f32 v204, v204
    v_rcp_f32 v205, v205
    v_rcp_f32 v206, v206
    v_rcp_f32 v207, v207
    v_rcp_f32 v208, v208
    v_rcp_f32 v209, v209
    v_rcp_f32 v210, v210
    v_rcp_f32 v211, v211
    v_pk_mul_f32 v[104:105], v[104:105], v[204:205]
    v_pk_mul_f32 v[106:107], v[106:107], v[206:207]
    v_pk_mul_f32 v[108:109], v[108:109], v[208:209]
    v_pk_mul_f32 v[110:111], v[110:111], v[210:211]
    s_waitcnt lgkmcnt(0)
    s_barrier
    ds_read_b128 v[160:163], v10 offset:0
    ds_read_b128 v[164:167], v10 offset:2048
    ds_read_b128 v[168:171], v2 offset:0
    ds_read_b128 v[172:175], v2 offset:1024
    ds_read_b128 v[176:179], v2 offset:2048
    ds_read_b128 v[180:183], v2 offset:3072
    ds_read_b128 v[184:187], v2 offset:4096
    ds_read_b128 v[188:191], v2 offset:5120
    ds_read_b128 v[192:195], v2 offset:6144
    ds_read_b128 v[196:199], v2 offset:7168
    ds_read_b128 v[200:203], v2 offset:8192
    v_pk_mul_f32 v[212:213], v[112:113], v[112:113]
    v_pk_mul_f32 v[214:215], v[114:115], v[114:115]
    v_pk_mul_f32 v[216:217], v[116:117], v[116:117]
    v_pk_mul_f32 v[218:219], v[118:119], v[118:119]
    v_pk_fma_f32 v[212:213], v[212:213], v[4:5], v[4:5] op_sel:[0,1,0] op_sel_hi:[1,1,0]
    v_pk_fma_f32 v[214:215], v[214:215], v[4:5], v[4:5] op_sel:[0,1,0] op_sel_hi:[1,1,0]
    v_pk_fma_f32 v[216:217], v[216:217], v[6:7], v[6:7] op_sel:[0,1,0] op_sel_hi:[1,1,0]
    v_pk_fma_f32 v[218:219], v[218:219], v[6:7], v[6:7] op_sel:[0,1,0] op_sel_hi:[1,1,0]
    v_pk_mul_f32 v[212:213], v[212:213], v[112:113]
    v_pk_mul_f32 v[214:215], v[214:215], v[114:115]
    v_pk_mul_f32 v[216:217], v[216:217], v[116:117]
    v_pk_mul_f32 v[218:219], v[218:219], v[118:119]
    v_exp_f32 v212, v212
    v_exp_f32 v213, v213
    v_exp_f32 v214, v214
    v_exp_f32 v215, v215
    v_exp_f32 v216, v216
    v_exp_f32 v217, v217
    v_exp_f32 v218, v218
    v_exp_f32 v219, v219
    v_pk_fma_f32 v[212:213], v[212:213], v[248:249], v[248:249] op_sel:[0,1,1] op_sel_hi:[1,1,1]
    v_pk_fma_f32 v[214:215], v[214:215], v[248:249], v[248:249] op_sel:[0,1,1] op_sel_hi:[1,1,1]
    v_pk_fma_f32 v[216:217], v[216:217], v[250:251], v[250:251] op_sel:[0,1,1] op_sel_hi:[1,1,1]
    v_pk_fma_f32 v[218:219], v[218:219], v[250:251], v[250:251] op_sel:[0,1,1] op_sel_hi:[1,1,1]
    v_rcp_f32 v212, v212
    v_rcp_f32 v213, v213
    v_rcp_f32 v214, v214
    v_rcp_f32 v215, v215
    v_rcp_f32 v216, v216
    v_rcp_f32 v217, v217
    v_rcp_f32 v218, v218
    v_rcp_f32 v219, v219
    v_pk_mul_f32 v[112:113], v[112:113], v[212:213]
    v_pk_mul_f32 v[114:115], v[114:115], v[214:215]
    v_pk_mul_f32 v[116:117], v[116:117], v[216:217]
    v_pk_mul_f32 v[118:119], v[118:119], v[218:219]
    s_waitcnt lgkmcnt(5)
    v_mfma_f32_16x16x32_bf16 v[16:19], v[168:171], v[160:163], v[12:15]
    ds_read_b128 v[204:207], v11 offset:0
    v_mfma_f32_16x16x32_bf16 v[20:23], v[168:171], v[164:167], v[252:255]
    ds_read_b128 v[208:211], v11 offset:2048
    v_mfma_f32_16x16x32_bf16 v[24:27], v[172:175], v[160:163], v[12:15]
    ds_read_b128 v[212:215], v2 offset:9216
    v_mfma_f32_16x16x32_bf16 v[28:31], v[172:175], v[164:167], v[252:255]
    ds_read_b128 v[216:219], v2 offset:10240
    v_mfma_f32_16x16x32_bf16 v[32:35], v[176:179], v[160:163], v[12:15]
    ds_read_b128 v[220:223], v2 offset:11264
    v_mfma_f32_16x16x32_bf16 v[36:39], v[176:179], v[164:167], v[252:255]
    ds_read_b128 v[224:227], v2 offset:12288
    v_mfma_f32_16x16x32_bf16 v[40:43], v[180:183], v[160:163], v[12:15]
    ds_read_b128 v[228:231], v2 offset:13312
    v_mfma_f32_16x16x32_bf16 v[44:47], v[180:183], v[164:167], v[252:255]
    ds_read_b128 v[232:235], v2 offset:14336
    s_waitcnt lgkmcnt(8)
    v_mfma_f32_16x16x32_bf16 v[48:51], v[184:187], v[160:163], v[12:15]
    ds_read_b128 v[236:239], v2 offset:15360
    v_mfma_f32_16x16x32_bf16 v[52:55], v[184:187], v[164:167], v[252:255]
    ds_read_b128 v[240:243], v2 offset:16384
    v_mfma_f32_16x16x32_bf16 v[56:59], v[188:191], v[160:163], v[12:15]
    ds_read_b128 v[244:247], v2 offset:17408
    v_mfma_f32_16x16x32_bf16 v[60:63], v[188:191], v[164:167], v[252:255]
    v_mfma_f32_16x16x32_bf16 v[64:67], v[192:195], v[160:163], v[12:15]
    v_mfma_f32_16x16x32_bf16 v[68:71], v[192:195], v[164:167], v[252:255]
    v_mfma_f32_16x16x32_bf16 v[72:75], v[196:199], v[160:163], v[12:15]
    v_mfma_f32_16x16x32_bf16 v[76:79], v[196:199], v[164:167], v[252:255]
    v_mfma_f32_16x16x32_bf16 v[80:83], v[200:203], v[160:163], v[12:15]
    v_mfma_f32_16x16x32_bf16 v[84:87], v[200:203], v[164:167], v[252:255]
    s_waitcnt lgkmcnt(0)
    s_barrier
    v_mfma_f32_16x16x32_bf16 v[16:19], v[212:215], v[204:207], v[16:19]
    ds_read_b128 v[160:163], v10 offset:36864
    v_mfma_f32_16x16x32_bf16 v[20:23], v[212:215], v[208:211], v[20:23]
    ds_read_b128 v[164:167], v10 offset:38912
    v_mfma_f32_16x16x32_bf16 v[24:27], v[216:219], v[204:207], v[24:27]
    ds_read_b128 v[168:171], v2 offset:36864
    v_mfma_f32_16x16x32_bf16 v[28:31], v[216:219], v[208:211], v[28:31]
    ds_read_b128 v[172:175], v2 offset:37888
    v_mul_f32 v12, v120, v120
    v_mfma_f32_16x16x32_bf16 v[32:35], v[220:223], v[204:207], v[32:35]
    ds_read_b128 v[176:179], v2 offset:38912
    v_mul_f32 v13, v121, v121
    v_mfma_f32_16x16x32_bf16 v[36:39], v[220:223], v[208:211], v[36:39]
    ds_read_b128 v[180:183], v2 offset:39936
    v_mul_f32 v14, v122, v122
    v_mfma_f32_16x16x32_bf16 v[40:43], v[224:227], v[204:207], v[40:43]
    ds_read_b128 v[184:187], v2 offset:40960
    v_mul_f32 v15, v123, v123
    v_mfma_f32_16x16x32_bf16 v[44:47], v[224:227], v[208:211], v[44:47]
    ds_read_b128 v[188:191], v2 offset:41984
    v_mfma_f32_16x16x32_bf16 v[48:51], v[228:231], v[204:207], v[48:51]
    ds_read_b128 v[192:195], v2 offset:43008
    v_mul_f32 v252, v124, v124
    v_mfma_f32_16x16x32_bf16 v[52:55], v[228:231], v[208:211], v[52:55]
    ds_read_b128 v[196:199], v2 offset:44032
    v_mul_f32 v253, v125, v125
    v_mfma_f32_16x16x32_bf16 v[56:59], v[232:235], v[204:207], v[56:59]
    ds_read_b128 v[200:203], v2 offset:45056
    v_mul_f32 v254, v126, v126
    v_mfma_f32_16x16x32_bf16 v[60:63], v[232:235], v[208:211], v[60:63]
    v_mul_f32 v255, v127, v127
    v_fma_f32 v12, v12, v5, v4
    v_mfma_f32_16x16x32_bf16 v[64:67], v[236:239], v[204:207], v[64:67]
    v_fma_f32 v13, v13, v5, v4
    v_fma_f32 v14, v14, v5, v4
    v_mfma_f32_16x16x32_bf16 v[68:71], v[236:239], v[208:211], v[68:71]
    v_fma_f32 v15, v15, v5, v4
    v_fma_f32 v252, v252, v7, v6
    v_mfma_f32_16x16x32_bf16 v[72:75], v[240:243], v[204:207], v[72:75]
    v_fma_f32 v253, v253, v7, v6
    v_fma_f32 v254, v254, v7, v6
    v_mfma_f32_16x16x32_bf16 v[76:79], v[240:243], v[208:211], v[76:79]
    v_fma_f32 v255, v255, v7, v6
    v_mul_f32 v12, v12, v120
    v_mfma_f32_16x16x32_bf16 v[80:83], v[244:247], v[204:207], v[80:83]
    v_mul_f32 v13, v13, v121
    v_mul_f32 v14, v14, v122
    v_mfma_f32_16x16x32_bf16 v[84:87], v[244:247], v[208:211], v[84:87]
    v_mul_f32 v15, v15, v123
    s_waitcnt lgkmcnt(5)
    v_mfma_f32_16x16x32_bf16 v[16:19], v[168:171], v[160:163], v[16:19]
    ds_read_b128 v[204:207], v11 offset:36864
    v_mfma_f32_16x16x32_bf16 v[20:23], v[168:171], v[164:167], v[20:23]
    ds_read_b128 v[208:211], v11 offset:38912
    v_mul_f32 v252, v252, v124
    v_mfma_f32_16x16x32_bf16 v[24:27], v[172:175], v[160:163], v[24:27]
    ds_read_b128 v[212:215], v2 offset:46080
    v_mul_f32 v253, v253, v125
    v_mfma_f32_16x16x32_bf16 v[28:31], v[172:175], v[164:167], v[28:31]
    ds_read_b128 v[216:219], v2 offset:47104
    v_mul_f32 v254, v254, v126
    v_mfma_f32_16x16x32_bf16 v[32:35], v[176:179], v[160:163], v[32:35]
    ds_read_b128 v[220:223], v2 offset:48128
    v_mul_f32 v255, v255, v127
    v_mfma_f32_16x16x32_bf16 v[36:39], v[176:179], v[164:167], v[36:39]
    ds_read_b128 v[224:227], v2 offset:49152
    v_exp_f32 v12, v12
    v_mfma_f32_16x16x32_bf16 v[40:43], v[180:183], v[160:163], v[40:43]
    ds_read_b128 v[228:231], v2 offset:50176
    v_exp_f32 v13, v13
    v_mfma_f32_16x16x32_bf16 v[44:47], v[180:183], v[164:167], v[44:47]
    ds_read_b128 v[232:235], v2 offset:51200
    s_waitcnt lgkmcnt(8)
    v_mfma_f32_16x16x32_bf16 v[48:51], v[184:187], v[160:163], v[48:51]
    ds_read_b128 v[236:239], v2 offset:52224
    v_exp_f32 v14, v14
    v_mfma_f32_16x16x32_bf16 v[52:55], v[184:187], v[164:167], v[52:55]
    ds_read_b128 v[240:243], v2 offset:53248
    v_exp_f32 v15, v15
    v_mfma_f32_16x16x32_bf16 v[56:59], v[188:191], v[160:163], v[56:59]
    ds_read_b128 v[244:247], v2 offset:54272
    v_exp_f32 v252, v252
    v_mfma_f32_16x16x32_bf16 v[60:63], v[188:191], v[164:167], v[60:63]
    v_exp_f32 v253, v253
    v_mfma_f32_16x16x32_bf16 v[64:67], v[192:195], v[160:163], v[64:67]
    v_exp_f32 v254, v254
    v_mfma_f32_16x16x32_bf16 v[68:71], v[192:195], v[164:167], v[68:71]
    v_exp_f32 v255, v255
    v_mfma_f32_16x16x32_bf16 v[72:75], v[196:199], v[160:163], v[72:75]
    v_fma_f32 v12, v12, v249, v249
    v_fma_f32 v13, v13, v249, v249
    v_mfma_f32_16x16x32_bf16 v[76:79], v[196:199], v[164:167], v[76:79]
    v_fma_f32 v14, v14, v249, v249
    v_fma_f32 v15, v15, v249, v249
    v_mfma_f32_16x16x32_bf16 v[80:83], v[200:203], v[160:163], v[80:83]
    v_fma_f32 v252, v252, v251, v251
    v_fma_f32 v253, v253, v251, v251
    v_mfma_f32_16x16x32_bf16 v[84:87], v[200:203], v[164:167], v[84:87]
    v_fma_f32 v254, v254, v251, v251
    s_waitcnt lgkmcnt(0)
    s_barrier
    v_mfma_f32_16x16x32_bf16 v[16:19], v[212:215], v[204:207], v[16:19]
    ds_read_b128 v[160:163], v8 offset:0
    v_mfma_f32_16x16x32_bf16 v[20:23], v[212:215], v[208:211], v[20:23]
    ds_read_b128 v[164:167], v8 offset:2048
    v_fma_f32 v255, v255, v251, v251
    v_mfma_f32_16x16x32_bf16 v[24:27], v[216:219], v[204:207], v[24:27]
    ds_read_b128 v[168:171], v1 offset:0
    v_rcp_f32 v12, v12
    v_mfma_f32_16x16x32_bf16 v[28:31], v[216:219], v[208:211], v[28:31]
    ds_read_b128 v[172:175], v1 offset:1024
    v_rcp_f32 v13, v13
    v_mfma_f32_16x16x32_bf16 v[32:35], v[220:223], v[204:207], v[32:35]
    ds_read_b128 v[176:179], v1 offset:2048
    v_rcp_f32 v14, v14
    v_mfma_f32_16x16x32_bf16 v[36:39], v[220:223], v[208:211], v[36:39]
    ds_read_b128 v[180:183], v1 offset:3072
    v_rcp_f32 v15, v15
    v_mfma_f32_16x16x32_bf16 v[40:43], v[224:227], v[204:207], v[40:43]
    ds_read_b128 v[184:187], v1 offset:4096
    v_rcp_f32 v252, v252
    v_mfma_f32_16x16x32_bf16 v[44:47], v[224:227], v[208:211], v[44:47]
    ds_read_b128 v[188:191], v1 offset:5120
    v_mfma_f32_16x16x32_bf16 v[48:51], v[228:231], v[204:207], v[48:51]
    ds_read_b128 v[192:195], v1 offset:6144
    v_rcp_f32 v253, v253
    v_mfma_f32_16x16x32_bf16 v[52:55], v[228:231], v[208:211], v[52:55]
    ds_read_b128 v[196:199], v1 offset:7168
    v_rcp_f32 v254, v254
    v_mfma_f32_16x16x32_bf16 v[56:59], v[232:235], v[204:207], v[56:59]
    ds_read_b128 v[200:203], v1 offset:8192
    v_rcp_f32 v255, v255
    v_mfma_f32_16x16x32_bf16 v[60:63], v[232:235], v[208:211], v[60:63]
    v_mul_f32 v120, v120, v12
    v_mul_f32 v121, v121, v13
    v_mfma_f32_16x16x32_bf16 v[64:67], v[236:239], v[204:207], v[64:67]
    v_mul_f32 v122, v122, v14
    v_mul_f32 v123, v123, v15
    v_mfma_f32_16x16x32_bf16 v[68:71], v[236:239], v[208:211], v[68:71]
    v_mul_f32 v124, v124, v252
    v_mul_f32 v125, v125, v253
    v_mfma_f32_16x16x32_bf16 v[72:75], v[240:243], v[204:207], v[72:75]
    v_mul_f32 v126, v126, v254
    v_mul_f32 v127, v127, v255
    v_mfma_f32_16x16x32_bf16 v[76:79], v[240:243], v[208:211], v[76:79]
    v_mul_f32 v12, v128, v128
    v_mul_f32 v13, v129, v129
    v_mfma_f32_16x16x32_bf16 v[80:83], v[244:247], v[204:207], v[80:83]
    v_mul_f32 v14, v130, v130
    v_mul_f32 v15, v131, v131
    v_mfma_f32_16x16x32_bf16 v[84:87], v[244:247], v[208:211], v[84:87]
    v_mul_f32 v252, v132, v132
    s_waitcnt lgkmcnt(5)
    v_mfma_f32_16x16x32_bf16 v[16:19], v[168:171], v[160:163], v[16:19]
    ds_read_b128 v[204:207], v9 offset:0
    v_mfma_f32_16x16x32_bf16 v[20:23], v[168:171], v[164:167], v[20:23]
    ds_read_b128 v[208:211], v9 offset:2048
    v_mul_f32 v253, v133, v133
    v_mfma_f32_16x16x32_bf16 v[24:27], v[172:175], v[160:163], v[24:27]
    ds_read_b128 v[212:215], v1 offset:9216
    v_mul_f32 v254, v134, v134
    v_mfma_f32_16x16x32_bf16 v[28:31], v[172:175], v[164:167], v[28:31]
    ds_read_b128 v[216:219], v1 offset:10240
    v_mul_f32 v255, v135, v135
    v_mfma_f32_16x16x32_bf16 v[32:35], v[176:179], v[160:163], v[32:35]
    ds_read_b128 v[220:223], v1 offset:11264
    v_fma_f32 v12, v12, v5, v4
    v_mfma_f32_16x16x32_bf16 v[36:39], v[176:179], v[164:167], v[36:39]
    ds_read_b128 v[224:227], v1 offset:12288
    v_fma_f32 v13, v13, v5, v4
    v_mfma_f32_16x16x32_bf16 v[40:43], v[180:183], v[160:163], v[40:43]
    ds_read_b128 v[228:231], v1 offset:13312
    v_fma_f32 v14, v14, v5, v4
    v_mfma_f32_16x16x32_bf16 v[44:47], v[180:183], v[164:167], v[44:47]
    ds_read_b128 v[232:235], v1 offset:14336
    s_waitcnt lgkmcnt(8)
    v_mfma_f32_16x16x32_bf16 v[48:51], v[184:187], v[160:163], v[48:51]
    ds_read_b128 v[236:239], v1 offset:15360
    v_fma_f32 v15, v15, v5, v4
    v_mfma_f32_16x16x32_bf16 v[52:55], v[184:187], v[164:167], v[52:55]
    ds_read_b128 v[240:243], v1 offset:16384
    v_fma_f32 v252, v252, v7, v6
    v_mfma_f32_16x16x32_bf16 v[56:59], v[188:191], v[160:163], v[56:59]
    ds_read_b128 v[244:247], v1 offset:17408
    v_fma_f32 v253, v253, v7, v6
    v_mfma_f32_16x16x32_bf16 v[60:63], v[188:191], v[164:167], v[60:63]
    v_fma_f32 v254, v254, v7, v6
    v_fma_f32 v255, v255, v7, v6
    v_mfma_f32_16x16x32_bf16 v[64:67], v[192:195], v[160:163], v[64:67]
    v_mul_f32 v12, v12, v128
    v_mul_f32 v13, v13, v129
    v_mfma_f32_16x16x32_bf16 v[68:71], v[192:195], v[164:167], v[68:71]
    v_mul_f32 v14, v14, v130
    v_mul_f32 v15, v15, v131
    v_mfma_f32_16x16x32_bf16 v[72:75], v[196:199], v[160:163], v[72:75]
    v_mul_f32 v252, v252, v132
    v_mul_f32 v253, v253, v133
    v_mfma_f32_16x16x32_bf16 v[76:79], v[196:199], v[164:167], v[76:79]
    v_mul_f32 v254, v254, v134
    v_mul_f32 v255, v255, v135
    v_mfma_f32_16x16x32_bf16 v[80:83], v[200:203], v[160:163], v[80:83]
    v_exp_f32 v12, v12
    v_mfma_f32_16x16x32_bf16 v[84:87], v[200:203], v[164:167], v[84:87]
    v_exp_f32 v13, v13
    s_waitcnt lgkmcnt(0)
    s_barrier
    v_mfma_f32_16x16x32_bf16 v[16:19], v[212:215], v[204:207], v[16:19]
    ds_read_b128 v[160:163], v8 offset:36864
    v_mfma_f32_16x16x32_bf16 v[20:23], v[212:215], v[208:211], v[20:23]
    ds_read_b128 v[164:167], v8 offset:38912
    v_exp_f32 v14, v14
    v_mfma_f32_16x16x32_bf16 v[24:27], v[216:219], v[204:207], v[24:27]
    ds_read_b128 v[168:171], v1 offset:36864
    v_exp_f32 v15, v15
    v_mfma_f32_16x16x32_bf16 v[28:31], v[216:219], v[208:211], v[28:31]
    ds_read_b128 v[172:175], v1 offset:37888
    v_exp_f32 v252, v252
    v_mfma_f32_16x16x32_bf16 v[32:35], v[220:223], v[204:207], v[32:35]
    ds_read_b128 v[176:179], v1 offset:38912
    v_exp_f32 v253, v253
    v_mfma_f32_16x16x32_bf16 v[36:39], v[220:223], v[208:211], v[36:39]
    ds_read_b128 v[180:183], v1 offset:39936
    v_exp_f32 v254, v254
    v_mfma_f32_16x16x32_bf16 v[40:43], v[224:227], v[204:207], v[40:43]
    ds_read_b128 v[184:187], v1 offset:40960
    v_exp_f32 v255, v255
    v_mfma_f32_16x16x32_bf16 v[44:47], v[224:227], v[208:211], v[44:47]
    ds_read_b128 v[188:191], v1 offset:41984
    v_mfma_f32_16x16x32_bf16 v[48:51], v[228:231], v[204:207], v[48:51]
    ds_read_b128 v[192:195], v1 offset:43008
    v_fma_f32 v12, v12, v249, v249
    v_mfma_f32_16x16x32_bf16 v[52:55], v[228:231], v[208:211], v[52:55]
    ds_read_b128 v[196:199], v1 offset:44032
    v_fma_f32 v13, v13, v249, v249
    v_mfma_f32_16x16x32_bf16 v[56:59], v[232:235], v[204:207], v[56:59]
    ds_read_b128 v[200:203], v1 offset:45056
    v_fma_f32 v14, v14, v249, v249
    v_mfma_f32_16x16x32_bf16 v[60:63], v[232:235], v[208:211], v[60:63]
    v_fma_f32 v15, v15, v249, v249
    v_fma_f32 v252, v252, v251, v251
    v_mfma_f32_16x16x32_bf16 v[64:67], v[236:239], v[204:207], v[64:67]
    v_fma_f32 v253, v253, v251, v251
    v_fma_f32 v254, v254, v251, v251
    v_mfma_f32_16x16x32_bf16 v[68:71], v[236:239], v[208:211], v[68:71]
    v_fma_f32 v255, v255, v251, v251
    v_rcp_f32 v12, v12
    v_mfma_f32_16x16x32_bf16 v[72:75], v[240:243], v[204:207], v[72:75]
    v_rcp_f32 v13, v13
    v_mfma_f32_16x16x32_bf16 v[76:79], v[240:243], v[208:211], v[76:79]
    v_rcp_f32 v14, v14
    v_mfma_f32_16x16x32_bf16 v[80:83], v[244:247], v[204:207], v[80:83]
    v_rcp_f32 v15, v15
    v_mfma_f32_16x16x32_bf16 v[84:87], v[244:247], v[208:211], v[84:87]
    v_rcp_f32 v252, v252
    s_waitcnt lgkmcnt(5)
    v_mfma_f32_16x16x32_bf16 v[16:19], v[168:171], v[160:163], v[16:19]
    ds_read_b128 v[204:207], v9 offset:36864
    v_mfma_f32_16x16x32_bf16 v[20:23], v[168:171], v[164:167], v[20:23]
    ds_read_b128 v[208:211], v9 offset:38912
    v_rcp_f32 v253, v253
    v_mfma_f32_16x16x32_bf16 v[24:27], v[172:175], v[160:163], v[24:27]
    ds_read_b128 v[212:215], v1 offset:46080
    v_rcp_f32 v254, v254
    v_mfma_f32_16x16x32_bf16 v[28:31], v[172:175], v[164:167], v[28:31]
    ds_read_b128 v[216:219], v1 offset:47104
    v_rcp_f32 v255, v255
    v_mfma_f32_16x16x32_bf16 v[32:35], v[176:179], v[160:163], v[32:35]
    ds_read_b128 v[220:223], v1 offset:48128
    v_mul_f32 v128, v128, v12
    v_mfma_f32_16x16x32_bf16 v[36:39], v[176:179], v[164:167], v[36:39]
    ds_read_b128 v[224:227], v1 offset:49152
    v_mul_f32 v129, v129, v13
    v_mfma_f32_16x16x32_bf16 v[40:43], v[180:183], v[160:163], v[40:43]
    ds_read_b128 v[228:231], v1 offset:50176
    v_mul_f32 v130, v130, v14
    v_mfma_f32_16x16x32_bf16 v[44:47], v[180:183], v[164:167], v[44:47]
    ds_read_b128 v[232:235], v1 offset:51200
    s_waitcnt lgkmcnt(8)
    v_mfma_f32_16x16x32_bf16 v[48:51], v[184:187], v[160:163], v[48:51]
    ds_read_b128 v[236:239], v1 offset:52224
    v_mul_f32 v131, v131, v15
    v_mfma_f32_16x16x32_bf16 v[52:55], v[184:187], v[164:167], v[52:55]
    ds_read_b128 v[240:243], v1 offset:53248
    v_mul_f32 v132, v132, v252
    v_mfma_f32_16x16x32_bf16 v[56:59], v[188:191], v[160:163], v[56:59]
    ds_read_b128 v[244:247], v1 offset:54272
    v_mul_f32 v133, v133, v253
    v_mfma_f32_16x16x32_bf16 v[60:63], v[188:191], v[164:167], v[60:63]
    v_mul_f32 v134, v134, v254
    v_mul_f32 v135, v135, v255
    v_mfma_f32_16x16x32_bf16 v[64:67], v[192:195], v[160:163], v[64:67]
    v_mul_f32 v12, v136, v136
    v_mul_f32 v13, v137, v137
    v_mfma_f32_16x16x32_bf16 v[68:71], v[192:195], v[164:167], v[68:71]
    v_mul_f32 v14, v138, v138
    v_mul_f32 v15, v139, v139
    v_mfma_f32_16x16x32_bf16 v[72:75], v[196:199], v[160:163], v[72:75]
    v_mul_f32 v252, v140, v140
    v_mul_f32 v253, v141, v141
    v_mfma_f32_16x16x32_bf16 v[76:79], v[196:199], v[164:167], v[76:79]
    v_mul_f32 v254, v142, v142
    v_mul_f32 v255, v143, v143
    v_mfma_f32_16x16x32_bf16 v[80:83], v[200:203], v[160:163], v[80:83]
    v_fma_f32 v12, v12, v5, v4
    v_fma_f32 v13, v13, v5, v4
    v_mfma_f32_16x16x32_bf16 v[84:87], v[200:203], v[164:167], v[84:87]
    v_fma_f32 v14, v14, v5, v4
    s_waitcnt lgkmcnt(0)
    s_barrier
    v_mfma_f32_16x16x32_bf16 v[16:19], v[212:215], v[204:207], v[16:19]
    ds_read_b128 v[160:163], v10 offset:0
    v_mfma_f32_16x16x32_bf16 v[20:23], v[212:215], v[208:211], v[20:23]
    ds_read_b128 v[164:167], v10 offset:2048
    v_fma_f32 v15, v15, v5, v4
    v_mfma_f32_16x16x32_bf16 v[24:27], v[216:219], v[204:207], v[24:27]
    ds_read_b128 v[168:171], v2 offset:0
    v_fma_f32 v252, v252, v7, v6
    v_mfma_f32_16x16x32_bf16 v[28:31], v[216:219], v[208:211], v[28:31]
    ds_read_b128 v[172:175], v2 offset:1024
    v_fma_f32 v253, v253, v7, v6
    v_mfma_f32_16x16x32_bf16 v[32:35], v[220:223], v[204:207], v[32:35]
    ds_read_b128 v[176:179], v2 offset:2048
    v_fma_f32 v254, v254, v7, v6
    v_mfma_f32_16x16x32_bf16 v[36:39], v[220:223], v[208:211], v[36:39]
    ds_read_b128 v[180:183], v2 offset:3072
    v_fma_f32 v255, v255, v7, v6
    v_mfma_f32_16x16x32_bf16 v[40:43], v[224:227], v[204:207], v[40:43]
    ds_read_b128 v[184:187], v2 offset:4096
    v_mul_f32 v12, v12, v136
    v_mfma_f32_16x16x32_bf16 v[44:47], v[224:227], v[208:211], v[44:47]
    ds_read_b128 v[188:191], v2 offset:5120
    v_mfma_f32_16x16x32_bf16 v[48:51], v[228:231], v[204:207], v[48:51]
    ds_read_b128 v[192:195], v2 offset:6144
    v_mul_f32 v13, v13, v137
    v_mfma_f32_16x16x32_bf16 v[52:55], v[228:231], v[208:211], v[52:55]
    ds_read_b128 v[196:199], v2 offset:7168
    v_mul_f32 v14, v14, v138
    v_mfma_f32_16x16x32_bf16 v[56:59], v[232:235], v[204:207], v[56:59]
    ds_read_b128 v[200:203], v2 offset:8192
    v_mul_f32 v15, v15, v139
    v_mfma_f32_16x16x32_bf16 v[60:63], v[232:235], v[208:211], v[60:63]
    v_mul_f32 v252, v252, v140
    v_mul_f32 v253, v253, v141
    v_mfma_f32_16x16x32_bf16 v[64:67], v[236:239], v[204:207], v[64:67]
    v_mul_f32 v254, v254, v142
    v_mul_f32 v255, v255, v143
    v_mfma_f32_16x16x32_bf16 v[68:71], v[236:239], v[208:211], v[68:71]
    v_exp_f32 v12, v12
    v_mfma_f32_16x16x32_bf16 v[72:75], v[240:243], v[204:207], v[72:75]
    v_exp_f32 v13, v13
    v_mfma_f32_16x16x32_bf16 v[76:79], v[240:243], v[208:211], v[76:79]
    v_exp_f32 v14, v14
    v_mfma_f32_16x16x32_bf16 v[80:83], v[244:247], v[204:207], v[80:83]
    v_exp_f32 v15, v15
    v_mfma_f32_16x16x32_bf16 v[84:87], v[244:247], v[208:211], v[84:87]
    v_exp_f32 v252, v252
    s_waitcnt lgkmcnt(5)
    v_mfma_f32_16x16x32_bf16 v[16:19], v[168:171], v[160:163], v[16:19]
    ds_read_b128 v[204:207], v11 offset:0
    v_mfma_f32_16x16x32_bf16 v[20:23], v[168:171], v[164:167], v[20:23]
    ds_read_b128 v[208:211], v11 offset:2048
    v_exp_f32 v253, v253
    v_mfma_f32_16x16x32_bf16 v[24:27], v[172:175], v[160:163], v[24:27]
    ds_read_b128 v[212:215], v2 offset:9216
    v_exp_f32 v254, v254
    v_mfma_f32_16x16x32_bf16 v[28:31], v[172:175], v[164:167], v[28:31]
    ds_read_b128 v[216:219], v2 offset:10240
    v_exp_f32 v255, v255
    v_mfma_f32_16x16x32_bf16 v[32:35], v[176:179], v[160:163], v[32:35]
    ds_read_b128 v[220:223], v2 offset:11264
    v_fma_f32 v12, v12, v249, v249
    v_mfma_f32_16x16x32_bf16 v[36:39], v[176:179], v[164:167], v[36:39]
    ds_read_b128 v[224:227], v2 offset:12288
    v_fma_f32 v13, v13, v249, v249
    v_mfma_f32_16x16x32_bf16 v[40:43], v[180:183], v[160:163], v[40:43]
    ds_read_b128 v[228:231], v2 offset:13312
    v_fma_f32 v14, v14, v249, v249
    v_mfma_f32_16x16x32_bf16 v[44:47], v[180:183], v[164:167], v[44:47]
    ds_read_b128 v[232:235], v2 offset:14336
    s_waitcnt lgkmcnt(8)
    v_mfma_f32_16x16x32_bf16 v[48:51], v[184:187], v[160:163], v[48:51]
    ds_read_b128 v[236:239], v2 offset:15360
    v_fma_f32 v15, v15, v249, v249
    v_mfma_f32_16x16x32_bf16 v[52:55], v[184:187], v[164:167], v[52:55]
    ds_read_b128 v[240:243], v2 offset:16384
    v_fma_f32 v252, v252, v251, v251
    v_mfma_f32_16x16x32_bf16 v[56:59], v[188:191], v[160:163], v[56:59]
    ds_read_b128 v[244:247], v2 offset:17408
    v_fma_f32 v253, v253, v251, v251
    v_mfma_f32_16x16x32_bf16 v[60:63], v[188:191], v[164:167], v[60:63]
    v_fma_f32 v254, v254, v251, v251
    v_fma_f32 v255, v255, v251, v251
    v_mfma_f32_16x16x32_bf16 v[64:67], v[192:195], v[160:163], v[64:67]
    v_rcp_f32 v12, v12
    v_mfma_f32_16x16x32_bf16 v[68:71], v[192:195], v[164:167], v[68:71]
    v_rcp_f32 v13, v13
    v_mfma_f32_16x16x32_bf16 v[72:75], v[196:199], v[160:163], v[72:75]
    v_rcp_f32 v14, v14
    v_mfma_f32_16x16x32_bf16 v[76:79], v[196:199], v[164:167], v[76:79]
    v_rcp_f32 v15, v15
    v_mfma_f32_16x16x32_bf16 v[80:83], v[200:203], v[160:163], v[80:83]
    v_rcp_f32 v252, v252
    v_mfma_f32_16x16x32_bf16 v[84:87], v[200:203], v[164:167], v[84:87]
    v_rcp_f32 v253, v253
    s_waitcnt lgkmcnt(0)
    s_barrier
    v_mfma_f32_16x16x32_bf16 v[16:19], v[212:215], v[204:207], v[16:19]
    ds_read_b128 v[160:163], v10 offset:36864
    v_mfma_f32_16x16x32_bf16 v[20:23], v[212:215], v[208:211], v[20:23]
    ds_read_b128 v[164:167], v10 offset:38912
    v_rcp_f32 v254, v254
    v_mfma_f32_16x16x32_bf16 v[24:27], v[216:219], v[204:207], v[24:27]
    ds_read_b128 v[168:171], v2 offset:36864
    v_rcp_f32 v255, v255
    v_mfma_f32_16x16x32_bf16 v[28:31], v[216:219], v[208:211], v[28:31]
    ds_read_b128 v[172:175], v2 offset:37888
    v_mul_f32 v136, v136, v12
    v_mfma_f32_16x16x32_bf16 v[32:35], v[220:223], v[204:207], v[32:35]
    ds_read_b128 v[176:179], v2 offset:38912
    v_mul_f32 v137, v137, v13
    v_mfma_f32_16x16x32_bf16 v[36:39], v[220:223], v[208:211], v[36:39]
    ds_read_b128 v[180:183], v2 offset:39936
    v_mul_f32 v138, v138, v14
    v_mfma_f32_16x16x32_bf16 v[40:43], v[224:227], v[204:207], v[40:43]
    ds_read_b128 v[184:187], v2 offset:40960
    v_mul_f32 v139, v139, v15
    v_mfma_f32_16x16x32_bf16 v[44:47], v[224:227], v[208:211], v[44:47]
    ds_read_b128 v[188:191], v2 offset:41984
    v_mfma_f32_16x16x32_bf16 v[48:51], v[228:231], v[204:207], v[48:51]
    ds_read_b128 v[192:195], v2 offset:43008
    v_mul_f32 v140, v140, v252
    v_mfma_f32_16x16x32_bf16 v[52:55], v[228:231], v[208:211], v[52:55]
    ds_read_b128 v[196:199], v2 offset:44032
    v_mul_f32 v141, v141, v253
    v_mfma_f32_16x16x32_bf16 v[56:59], v[232:235], v[204:207], v[56:59]
    ds_read_b128 v[200:203], v2 offset:45056
    v_mul_f32 v142, v142, v254
    v_mfma_f32_16x16x32_bf16 v[60:63], v[232:235], v[208:211], v[60:63]
    v_mul_f32 v143, v143, v255
    v_mul_f32 v12, v144, v144
    v_mfma_f32_16x16x32_bf16 v[64:67], v[236:239], v[204:207], v[64:67]
    v_mul_f32 v13, v145, v145
    v_mul_f32 v14, v146, v146
    v_mfma_f32_16x16x32_bf16 v[68:71], v[236:239], v[208:211], v[68:71]
    v_mul_f32 v15, v147, v147
    v_mul_f32 v252, v148, v148
    v_mfma_f32_16x16x32_bf16 v[72:75], v[240:243], v[204:207], v[72:75]
    v_mul_f32 v253, v149, v149
    v_mul_f32 v254, v150, v150
    v_mfma_f32_16x16x32_bf16 v[76:79], v[240:243], v[208:211], v[76:79]
    v_mul_f32 v255, v151, v151
    v_fma_f32 v12, v12, v5, v4
    v_mfma_f32_16x16x32_bf16 v[80:83], v[244:247], v[204:207], v[80:83]
    v_fma_f32 v13, v13, v5, v4
    v_fma_f32 v14, v14, v5, v4
    v_mfma_f32_16x16x32_bf16 v[84:87], v[244:247], v[208:211], v[84:87]
    v_fma_f32 v15, v15, v5, v4
    s_waitcnt lgkmcnt(5)
    v_mfma_f32_16x16x32_bf16 v[16:19], v[168:171], v[160:163], v[16:19]
    ds_read_b128 v[204:207], v11 offset:36864
    v_mfma_f32_16x16x32_bf16 v[20:23], v[168:171], v[164:167], v[20:23]
    ds_read_b128 v[208:211], v11 offset:38912
    v_fma_f32 v252, v252, v7, v6
    v_mfma_f32_16x16x32_bf16 v[24:27], v[172:175], v[160:163], v[24:27]
    ds_read_b128 v[212:215], v2 offset:46080
    v_fma_f32 v253, v253, v7, v6
    v_mfma_f32_16x16x32_bf16 v[28:31], v[172:175], v[164:167], v[28:31]
    ds_read_b128 v[216:219], v2 offset:47104
    v_fma_f32 v254, v254, v7, v6
    v_mfma_f32_16x16x32_bf16 v[32:35], v[176:179], v[160:163], v[32:35]
    ds_read_b128 v[220:223], v2 offset:48128
    v_fma_f32 v255, v255, v7, v6
    v_mfma_f32_16x16x32_bf16 v[36:39], v[176:179], v[164:167], v[36:39]
    ds_read_b128 v[224:227], v2 offset:49152
    v_mul_f32 v12, v12, v144
    v_mfma_f32_16x16x32_bf16 v[40:43], v[180:183], v[160:163], v[40:43]
    ds_read_b128 v[228:231], v2 offset:50176
    v_mul_f32 v13, v13, v145
    v_mfma_f32_16x16x32_bf16 v[44:47], v[180:183], v[164:167], v[44:47]
    ds_read_b128 v[232:235], v2 offset:51200
    s_waitcnt lgkmcnt(8)
    v_mfma_f32_16x16x32_bf16 v[48:51], v[184:187], v[160:163], v[48:51]
    ds_read_b128 v[236:239], v2 offset:52224
    v_mul_f32 v14, v14, v146
    v_mfma_f32_16x16x32_bf16 v[52:55], v[184:187], v[164:167], v[52:55]
    ds_read_b128 v[240:243], v2 offset:53248
    v_mul_f32 v15, v15, v147
    v_mfma_f32_16x16x32_bf16 v[56:59], v[188:191], v[160:163], v[56:59]
    ds_read_b128 v[244:247], v2 offset:54272
    v_mul_f32 v252, v252, v148
    v_mfma_f32_16x16x32_bf16 v[60:63], v[188:191], v[164:167], v[60:63]
    v_mul_f32 v253, v253, v149
    v_mul_f32 v254, v254, v150
    v_mfma_f32_16x16x32_bf16 v[64:67], v[192:195], v[160:163], v[64:67]
    v_mul_f32 v255, v255, v151
    v_exp_f32 v12, v12
    v_mfma_f32_16x16x32_bf16 v[68:71], v[192:195], v[164:167], v[68:71]
    v_exp_f32 v13, v13
    v_mfma_f32_16x16x32_bf16 v[72:75], v[196:199], v[160:163], v[72:75]
    v_exp_f32 v14, v14
    v_mfma_f32_16x16x32_bf16 v[76:79], v[196:199], v[164:167], v[76:79]
    v_exp_f32 v15, v15
    v_mfma_f32_16x16x32_bf16 v[80:83], v[200:203], v[160:163], v[80:83]
    v_exp_f32 v252, v252
    v_mfma_f32_16x16x32_bf16 v[84:87], v[200:203], v[164:167], v[84:87]
    v_exp_f32 v253, v253
    s_waitcnt lgkmcnt(0)
    s_barrier
    v_mfma_f32_16x16x32_bf16 v[16:19], v[212:215], v[204:207], v[16:19]
    ds_read_b128 v[160:163], v8 offset:0
    v_mfma_f32_16x16x32_bf16 v[20:23], v[212:215], v[208:211], v[20:23]
    ds_read_b128 v[164:167], v8 offset:2048
    v_exp_f32 v254, v254
    v_mfma_f32_16x16x32_bf16 v[24:27], v[216:219], v[204:207], v[24:27]
    ds_read_b128 v[168:171], v1 offset:0
    v_exp_f32 v255, v255
    v_mfma_f32_16x16x32_bf16 v[28:31], v[216:219], v[208:211], v[28:31]
    ds_read_b128 v[172:175], v1 offset:1024
    v_fma_f32 v12, v12, v249, v249
    v_mfma_f32_16x16x32_bf16 v[32:35], v[220:223], v[204:207], v[32:35]
    ds_read_b128 v[176:179], v1 offset:2048
    v_fma_f32 v13, v13, v249, v249
    v_mfma_f32_16x16x32_bf16 v[36:39], v[220:223], v[208:211], v[36:39]
    ds_read_b128 v[180:183], v1 offset:3072
    v_fma_f32 v14, v14, v249, v249
    v_mfma_f32_16x16x32_bf16 v[40:43], v[224:227], v[204:207], v[40:43]
    ds_read_b128 v[184:187], v1 offset:4096
    v_fma_f32 v15, v15, v249, v249
    v_mfma_f32_16x16x32_bf16 v[44:47], v[224:227], v[208:211], v[44:47]
    ds_read_b128 v[188:191], v1 offset:5120
    v_mfma_f32_16x16x32_bf16 v[48:51], v[228:231], v[204:207], v[48:51]
    ds_read_b128 v[192:195], v1 offset:6144
    v_fma_f32 v252, v252, v251, v251
    v_mfma_f32_16x16x32_bf16 v[52:55], v[228:231], v[208:211], v[52:55]
    ds_read_b128 v[196:199], v1 offset:7168
    v_fma_f32 v253, v253, v251, v251
    v_mfma_f32_16x16x32_bf16 v[56:59], v[232:235], v[204:207], v[56:59]
    ds_read_b128 v[200:203], v1 offset:8192
    v_fma_f32 v254, v254, v251, v251
    v_mfma_f32_16x16x32_bf16 v[60:63], v[232:235], v[208:211], v[60:63]
    v_fma_f32 v255, v255, v251, v251
    v_rcp_f32 v12, v12
    v_mfma_f32_16x16x32_bf16 v[64:67], v[236:239], v[204:207], v[64:67]
    v_rcp_f32 v13, v13
    v_mfma_f32_16x16x32_bf16 v[68:71], v[236:239], v[208:211], v[68:71]
    v_rcp_f32 v14, v14
    v_mfma_f32_16x16x32_bf16 v[72:75], v[240:243], v[204:207], v[72:75]
    v_rcp_f32 v15, v15
    v_mfma_f32_16x16x32_bf16 v[76:79], v[240:243], v[208:211], v[76:79]
    v_rcp_f32 v252, v252
    v_mfma_f32_16x16x32_bf16 v[80:83], v[244:247], v[204:207], v[80:83]
    v_rcp_f32 v253, v253
    v_mfma_f32_16x16x32_bf16 v[84:87], v[244:247], v[208:211], v[84:87]
    v_rcp_f32 v254, v254
    s_waitcnt lgkmcnt(5)
    v_mfma_f32_16x16x32_bf16 v[16:19], v[168:171], v[160:163], v[16:19]
    ds_read_b128 v[204:207], v9 offset:0
    v_mfma_f32_16x16x32_bf16 v[20:23], v[168:171], v[164:167], v[20:23]
    ds_read_b128 v[208:211], v9 offset:2048
    v_rcp_f32 v255, v255
    v_mfma_f32_16x16x32_bf16 v[24:27], v[172:175], v[160:163], v[24:27]
    ds_read_b128 v[212:215], v1 offset:9216
    v_mul_f32 v144, v144, v12
    v_mfma_f32_16x16x32_bf16 v[28:31], v[172:175], v[164:167], v[28:31]
    ds_read_b128 v[216:219], v1 offset:10240
    v_mul_f32 v145, v145, v13
    v_mfma_f32_16x16x32_bf16 v[32:35], v[176:179], v[160:163], v[32:35]
    ds_read_b128 v[220:223], v1 offset:11264
    v_mul_f32 v146, v146, v14
    v_mfma_f32_16x16x32_bf16 v[36:39], v[176:179], v[164:167], v[36:39]
    ds_read_b128 v[224:227], v1 offset:12288
    v_mul_f32 v147, v147, v15
    v_mfma_f32_16x16x32_bf16 v[40:43], v[180:183], v[160:163], v[40:43]
    ds_read_b128 v[228:231], v1 offset:13312
    v_mul_f32 v148, v148, v252
    v_mfma_f32_16x16x32_bf16 v[44:47], v[180:183], v[164:167], v[44:47]
    ds_read_b128 v[232:235], v1 offset:14336
    s_waitcnt lgkmcnt(8)
    v_mfma_f32_16x16x32_bf16 v[48:51], v[184:187], v[160:163], v[48:51]
    ds_read_b128 v[236:239], v1 offset:15360
    v_mul_f32 v149, v149, v253
    v_mfma_f32_16x16x32_bf16 v[52:55], v[184:187], v[164:167], v[52:55]
    ds_read_b128 v[240:243], v1 offset:16384
    v_mul_f32 v150, v150, v254
    v_mfma_f32_16x16x32_bf16 v[56:59], v[188:191], v[160:163], v[56:59]
    ds_read_b128 v[244:247], v1 offset:17408
    v_mul_f32 v151, v151, v255
    v_mfma_f32_16x16x32_bf16 v[60:63], v[188:191], v[164:167], v[60:63]
    v_mul_f32 v12, v152, v152
    v_mul_f32 v13, v153, v153
    v_mfma_f32_16x16x32_bf16 v[64:67], v[192:195], v[160:163], v[64:67]
    v_mul_f32 v14, v154, v154
    v_mul_f32 v15, v155, v155
    v_mfma_f32_16x16x32_bf16 v[68:71], v[192:195], v[164:167], v[68:71]
    v_mul_f32 v252, v156, v156
    v_mul_f32 v253, v157, v157
    v_mfma_f32_16x16x32_bf16 v[72:75], v[196:199], v[160:163], v[72:75]
    v_mul_f32 v254, v158, v158
    v_mul_f32 v255, v159, v159
    v_mfma_f32_16x16x32_bf16 v[76:79], v[196:199], v[164:167], v[76:79]
    v_fma_f32 v12, v12, v5, v4
    v_fma_f32 v13, v13, v5, v4
    v_mfma_f32_16x16x32_bf16 v[80:83], v[200:203], v[160:163], v[80:83]
    v_fma_f32 v14, v14, v5, v4
    v_fma_f32 v15, v15, v5, v4
    v_mfma_f32_16x16x32_bf16 v[84:87], v[200:203], v[164:167], v[84:87]
    v_fma_f32 v252, v252, v7, v6
    s_waitcnt lgkmcnt(0)
    s_barrier
    v_mfma_f32_16x16x32_bf16 v[16:19], v[212:215], v[204:207], v[16:19]
    ds_read_b128 v[160:163], v8 offset:36864
    v_mfma_f32_16x16x32_bf16 v[20:23], v[212:215], v[208:211], v[20:23]
    ds_read_b128 v[164:167], v8 offset:38912
    v_fma_f32 v253, v253, v7, v6
    v_mfma_f32_16x16x32_bf16 v[24:27], v[216:219], v[204:207], v[24:27]
    ds_read_b128 v[168:171], v1 offset:36864
    v_fma_f32 v254, v254, v7, v6
    v_mfma_f32_16x16x32_bf16 v[28:31], v[216:219], v[208:211], v[28:31]
    ds_read_b128 v[172:175], v1 offset:37888
    v_fma_f32 v255, v255, v7, v6
    v_mfma_f32_16x16x32_bf16 v[32:35], v[220:223], v[204:207], v[32:35]
    ds_read_b128 v[176:179], v1 offset:38912
    v_mul_f32 v12, v12, v152
    v_mfma_f32_16x16x32_bf16 v[36:39], v[220:223], v[208:211], v[36:39]
    ds_read_b128 v[180:183], v1 offset:39936
    v_mul_f32 v13, v13, v153
    v_mfma_f32_16x16x32_bf16 v[40:43], v[224:227], v[204:207], v[40:43]
    ds_read_b128 v[184:187], v1 offset:40960
    v_mul_f32 v14, v14, v154
    v_mfma_f32_16x16x32_bf16 v[44:47], v[224:227], v[208:211], v[44:47]
    ds_read_b128 v[188:191], v1 offset:41984
    v_mfma_f32_16x16x32_bf16 v[48:51], v[228:231], v[204:207], v[48:51]
    ds_read_b128 v[192:195], v1 offset:43008
    v_mul_f32 v15, v15, v155
    v_mfma_f32_16x16x32_bf16 v[52:55], v[228:231], v[208:211], v[52:55]
    ds_read_b128 v[196:199], v1 offset:44032
    v_mul_f32 v252, v252, v156
    v_mfma_f32_16x16x32_bf16 v[56:59], v[232:235], v[204:207], v[56:59]
    ds_read_b128 v[200:203], v1 offset:45056
    v_mul_f32 v253, v253, v157
    v_mfma_f32_16x16x32_bf16 v[60:63], v[232:235], v[208:211], v[60:63]
    v_mul_f32 v254, v254, v158
    v_mul_f32 v255, v255, v159
    v_mfma_f32_16x16x32_bf16 v[64:67], v[236:239], v[204:207], v[64:67]
    v_exp_f32 v12, v12
    v_mfma_f32_16x16x32_bf16 v[68:71], v[236:239], v[208:211], v[68:71]
    v_exp_f32 v13, v13
    v_mfma_f32_16x16x32_bf16 v[72:75], v[240:243], v[204:207], v[72:75]
    v_exp_f32 v14, v14
    v_mfma_f32_16x16x32_bf16 v[76:79], v[240:243], v[208:211], v[76:79]
    v_exp_f32 v15, v15
    v_mfma_f32_16x16x32_bf16 v[80:83], v[244:247], v[204:207], v[80:83]
    v_exp_f32 v252, v252
    v_mfma_f32_16x16x32_bf16 v[84:87], v[244:247], v[208:211], v[84:87]
    v_exp_f32 v253, v253
    s_waitcnt lgkmcnt(5)
    v_mfma_f32_16x16x32_bf16 v[16:19], v[168:171], v[160:163], v[16:19]
    ds_read_b128 v[204:207], v9 offset:36864
    v_mfma_f32_16x16x32_bf16 v[20:23], v[168:171], v[164:167], v[20:23]
    ds_read_b128 v[208:211], v9 offset:38912
    v_exp_f32 v254, v254
    v_mfma_f32_16x16x32_bf16 v[24:27], v[172:175], v[160:163], v[24:27]
    ds_read_b128 v[212:215], v1 offset:46080
    v_exp_f32 v255, v255
    v_mfma_f32_16x16x32_bf16 v[28:31], v[172:175], v[164:167], v[28:31]
    ds_read_b128 v[216:219], v1 offset:47104
    v_fma_f32 v12, v12, v249, v249
    v_mfma_f32_16x16x32_bf16 v[32:35], v[176:179], v[160:163], v[32:35]
    ds_read_b128 v[220:223], v1 offset:48128
    v_fma_f32 v13, v13, v249, v249
    v_mfma_f32_16x16x32_bf16 v[36:39], v[176:179], v[164:167], v[36:39]
    ds_read_b128 v[224:227], v1 offset:49152
    v_fma_f32 v14, v14, v249, v249
    v_mfma_f32_16x16x32_bf16 v[40:43], v[180:183], v[160:163], v[40:43]
    ds_read_b128 v[228:231], v1 offset:50176
    v_fma_f32 v15, v15, v249, v249
    v_mfma_f32_16x16x32_bf16 v[44:47], v[180:183], v[164:167], v[44:47]
    ds_read_b128 v[232:235], v1 offset:51200
    s_waitcnt lgkmcnt(8)
    v_mfma_f32_16x16x32_bf16 v[48:51], v[184:187], v[160:163], v[48:51]
    ds_read_b128 v[236:239], v1 offset:52224
    v_fma_f32 v252, v252, v251, v251
    v_mfma_f32_16x16x32_bf16 v[52:55], v[184:187], v[164:167], v[52:55]
    ds_read_b128 v[240:243], v1 offset:53248
    v_fma_f32 v253, v253, v251, v251
    v_mfma_f32_16x16x32_bf16 v[56:59], v[188:191], v[160:163], v[56:59]
    ds_read_b128 v[244:247], v1 offset:54272
    v_fma_f32 v254, v254, v251, v251
    v_mfma_f32_16x16x32_bf16 v[60:63], v[188:191], v[164:167], v[60:63]
    v_fma_f32 v255, v255, v251, v251
    v_rcp_f32 v12, v12
    v_mfma_f32_16x16x32_bf16 v[64:67], v[192:195], v[160:163], v[64:67]
    v_rcp_f32 v13, v13
    v_mfma_f32_16x16x32_bf16 v[68:71], v[192:195], v[164:167], v[68:71]
    v_rcp_f32 v14, v14
    v_mfma_f32_16x16x32_bf16 v[72:75], v[196:199], v[160:163], v[72:75]
    v_rcp_f32 v15, v15
    v_mfma_f32_16x16x32_bf16 v[76:79], v[196:199], v[164:167], v[76:79]
    v_rcp_f32 v252, v252
    v_mfma_f32_16x16x32_bf16 v[80:83], v[200:203], v[160:163], v[80:83]
    v_rcp_f32 v253, v253
    v_mfma_f32_16x16x32_bf16 v[84:87], v[200:203], v[164:167], v[84:87]
    v_rcp_f32 v254, v254
    s_waitcnt lgkmcnt(0)
    s_barrier
    v_mfma_f32_16x16x32_bf16 v[16:19], v[212:215], v[204:207], v[16:19]
    ds_read_b128 v[160:163], v10 offset:0
    v_mfma_f32_16x16x32_bf16 v[20:23], v[212:215], v[208:211], v[20:23]
    ds_read_b128 v[164:167], v10 offset:2048
    v_rcp_f32 v255, v255
    v_mfma_f32_16x16x32_bf16 v[24:27], v[216:219], v[204:207], v[24:27]
    ds_read_b128 v[168:171], v2 offset:0
    v_mul_f32 v152, v152, v12
    v_mfma_f32_16x16x32_bf16 v[28:31], v[216:219], v[208:211], v[28:31]
    ds_read_b128 v[172:175], v2 offset:1024
    v_mul_f32 v153, v153, v13
    v_mfma_f32_16x16x32_bf16 v[32:35], v[220:223], v[204:207], v[32:35]
    ds_read_b128 v[176:179], v2 offset:2048
    v_mul_f32 v154, v154, v14
    v_mfma_f32_16x16x32_bf16 v[36:39], v[220:223], v[208:211], v[36:39]
    ds_read_b128 v[180:183], v2 offset:3072
    v_mul_f32 v155, v155, v15
    v_mfma_f32_16x16x32_bf16 v[40:43], v[224:227], v[204:207], v[40:43]
    ds_read_b128 v[184:187], v2 offset:4096
    v_mul_f32 v156, v156, v252
    v_mfma_f32_16x16x32_bf16 v[44:47], v[224:227], v[208:211], v[44:47]
    ds_read_b128 v[188:191], v2 offset:5120
    v_mfma_f32_16x16x32_bf16 v[48:51], v[228:231], v[204:207], v[48:51]
    ds_read_b128 v[192:195], v2 offset:6144
    v_mul_f32 v157, v157, v253
    v_mfma_f32_16x16x32_bf16 v[52:55], v[228:231], v[208:211], v[52:55]
    ds_read_b128 v[196:199], v2 offset:7168
    v_mul_f32 v158, v158, v254
    v_mfma_f32_16x16x32_bf16 v[56:59], v[232:235], v[204:207], v[56:59]
    ds_read_b128 v[200:203], v2 offset:8192
    v_mul_f32 v159, v159, v255
    v_mfma_f32_16x16x32_bf16 v[60:63], v[232:235], v[208:211], v[60:63]
    s_mul_i32 s36, s31, 73728
    s_add_u32 s36, s36, s21
    v_mfma_f32_16x16x32_bf16 v[64:67], v[236:239], v[204:207], v[64:67]
    s_lshl_b32 s34, s24, 10
    s_lshr_b32 s35, s24, 1
    v_mfma_f32_16x16x32_bf16 v[68:71], v[236:239], v[208:211], v[68:71]
    s_lshl_b32 s35, s35, 10
    s_and_b32 s33, s24, 1
    v_mfma_f32_16x16x32_bf16 v[72:75], v[240:243], v[204:207], v[72:75]
    s_mul_i32 s33, s33, 73728
    s_add_u32 s35, s35, s33
    v_mfma_f32_16x16x32_bf16 v[76:79], v[240:243], v[208:211], v[76:79]
    s_add_u32 s35, s35, 65536
    v_add_u32 v14, s34, v1
    v_mfma_f32_16x16x32_bf16 v[80:83], v[244:247], v[204:207], v[80:83]
    v_add_u32 v15, s35, v1
    s_add_u32 s39, s36, 0x1200000
    v_mfma_f32_16x16x32_bf16 v[84:87], v[244:247], v[208:211], v[84:87]
    s_add_u32 s40, s36, 0x1212000
    s_mov_b32 s41, 5
    .p2align 6
L_g_loop:
    s_waitcnt lgkmcnt(5)
    v_mfma_f32_16x16x32_bf16 v[16:19], v[168:171], v[160:163], v[16:19]
    ds_read_b128 v[204:207], v11 offset:0
    v_mfma_f32_16x16x32_bf16 v[20:23], v[168:171], v[164:167], v[20:23]
    ds_read_b128 v[208:211], v11 offset:2048
    v_mfma_f32_16x16x32_bf16 v[24:27], v[172:175], v[160:163], v[24:27]
    ds_read_b128 v[212:215], v2 offset:9216
    v_mfma_f32_16x16x32_bf16 v[28:31], v[172:175], v[164:167], v[28:31]
    ds_read_b128 v[216:219], v2 offset:10240
    v_mfma_f32_16x16x32_bf16 v[32:35], v[176:179], v[160:163], v[32:35]
    ds_read_b128 v[220:223], v2 offset:11264
    v_mfma_f32_16x16x32_bf16 v[36:39], v[176:179], v[164:167], v[36:39]
    ds_read_b128 v[224:227], v2 offset:12288
    v_mfma_f32_16x16x32_bf16 v[40:43], v[180:183], v[160:163], v[40:43]
    ds_read_b128 v[228:231], v2 offset:13312
    v_mfma_f32_16x16x32_bf16 v[44:47], v[180:183], v[164:167], v[44:47]
    ds_read_b128 v[232:235], v2 offset:14336
    s_waitcnt lgkmcnt(8)
    v_mfma_f32_16x16x32_bf16 v[48:51], v[184:187], v[160:163], v[48:51]
    ds_read_b128 v[236:239], v2 offset:15360
    v_mfma_f32_16x16x32_bf16 v[52:55], v[184:187], v[164:167], v[52:55]
    ds_read_b128 v[240:243], v2 offset:16384
    v_mfma_f32_16x16x32_bf16 v[56:59], v[188:191], v[160:163], v[56:59]
    ds_read_b128 v[244:247], v2 offset:17408
    v_mfma_f32_16x16x32_bf16 v[60:63], v[188:191], v[164:167], v[60:63]
    v_mfma_f32_16x16x32_bf16 v[64:67], v[192:195], v[160:163], v[64:67]
    v_mfma_f32_16x16x32_bf16 v[68:71], v[192:195], v[164:167], v[68:71]
    v_mfma_f32_16x16x32_bf16 v[72:75], v[196:199], v[160:163], v[72:75]
    v_mfma_f32_16x16x32_bf16 v[76:79], v[196:199], v[164:167], v[76:79]
    v_mfma_f32_16x16x32_bf16 v[80:83], v[200:203], v[160:163], v[80:83]
    v_mfma_f32_16x16x32_bf16 v[84:87], v[200:203], v[164:167], v[84:87]
    s_waitcnt lgkmcnt(0)
    s_barrier
    v_mfma_f32_16x16x32_bf16 v[16:19], v[212:215], v[204:207], v[16:19]
    ds_read_b128 v[160:163], v10 offset:36864
    v_mfma_f32_16x16x32_bf16 v[20:23], v[212:215], v[208:211], v[20:23]
    ds_read_b128 v[164:167], v10 offset:38912
    v_mfma_f32_16x16x32_bf16 v[24:27], v[216:219], v[204:207], v[24:27]
    ds_read_b128 v[168:171], v2 offset:36864
    v_mfma_f32_16x16x32_bf16 v[28:31], v[216:219], v[208:211], v[28:31]
    ds_read_b128 v[172:175], v2 offset:37888
    v_mfma_f32_16x16x32_bf16 v[32:35], v[220:223], v[204:207], v[32:35]
    ds_read_b128 v[176:179], v2 offset:38912
    v_mfma_f32_16x16x32_bf16 v[36:39], v[220:223], v[208:211], v[36:39]
    ds_read_b128 v[180:183], v2 offset:39936
    v_mfma_f32_16x16x32_bf16 v[40:43], v[224:227], v[204:207], v[40:43]
    ds_read_b128 v[184:187], v2 offset:40960
    v_mfma_f32_16x16x32_bf16 v[44:47], v[224:227], v[208:211], v[44:47]
    ds_read_b128 v[188:191], v2 offset:41984
    v_mfma_f32_16x16x32_bf16 v[48:51], v[228:231], v[204:207], v[48:51]
    ds_read_b128 v[192:195], v2 offset:43008
    v_mfma_f32_16x16x32_bf16 v[52:55], v[228:231], v[208:211], v[52:55]
    ds_read_b128 v[196:199], v2 offset:44032
    v_mfma_f32_16x16x32_bf16 v[56:59], v[232:235], v[204:207], v[56:59]
    ds_read_b128 v[200:203], v2 offset:45056
    v_mfma_f32_16x16x32_bf16 v[60:63], v[232:235], v[208:211], v[60:63]
    v_mfma_f32_16x16x32_bf16 v[64:67], v[236:239], v[204:207], v[64:67]
    v_mfma_f32_16x16x32_bf16 v[68:71], v[236:239], v[208:211], v[68:71]
    v_mfma_f32_16x16x32_bf16 v[72:75], v[240:243], v[204:207], v[72:75]
    v_mfma_f32_16x16x32_bf16 v[76:79], v[240:243], v[208:211], v[76:79]
    v_mfma_f32_16x16x32_bf16 v[80:83], v[244:247], v[204:207], v[80:83]
    v_mfma_f32_16x16x32_bf16 v[84:87], v[244:247], v[208:211], v[84:87]
    s_waitcnt lgkmcnt(5)
    v_mfma_f32_16x16x32_bf16 v[16:19], v[168:171], v[160:163], v[16:19]
    ds_read_b128 v[204:207], v11 offset:36864
    v_mfma_f32_16x16x32_bf16 v[20:23], v[168:171], v[164:167], v[20:23]
    ds_read_b128 v[208:211], v11 offset:38912
    v_mfma_f32_16x16x32_bf16 v[24:27], v[172:175], v[160:163], v[24:27]
    ds_read_b128 v[212:215], v2 offset:46080
    v_mfma_f32_16x16x32_bf16 v[28:31], v[172:175], v[164:167], v[28:31]
    ds_read_b128 v[216:219], v2 offset:47104
    v_mfma_f32_16x16x32_bf16 v[32:35], v[176:179], v[160:163], v[32:35]
    ds_read_b128 v[220:223], v2 offset:48128
    v_mfma_f32_16x16x32_bf16 v[36:39], v[176:179], v[164:167], v[36:39]
    ds_read_b128 v[224:227], v2 offset:49152
    v_mfma_f32_16x16x32_bf16 v[40:43], v[180:183], v[160:163], v[40:43]
    ds_read_b128 v[228:231], v2 offset:50176
    v_mfma_f32_16x16x32_bf16 v[44:47], v[180:183], v[164:167], v[44:47]
    ds_read_b128 v[232:235], v2 offset:51200
    s_waitcnt lgkmcnt(8)
    v_mfma_f32_16x16x32_bf16 v[48:51], v[184:187], v[160:163], v[48:51]
    ds_read_b128 v[236:239], v2 offset:52224
    v_mfma_f32_16x16x32_bf16 v[52:55], v[184:187], v[164:167], v[52:55]
    ds_read_b128 v[240:243], v2 offset:53248
    v_mfma_f32_16x16x32_bf16 v[56:59], v[188:191], v[160:163], v[56:59]
    ds_read_b128 v[244:247], v2 offset:54272
    v_mfma_f32_16x16x32_bf16 v[60:63], v[188:191], v[164:167], v[60:63]
    v_mfma_f32_16x16x32_bf16 v[64:67], v[192:195], v[160:163], v[64:67]
    v_mfma_f32_16x16x32_bf16 v[68:71], v[192:195], v[164:167], v[68:71]
    v_mfma_f32_16x16x32_bf16 v[72:75], v[196:199], v[160:163], v[72:75]
    v_mfma_f32_16x16x32_bf16 v[76:79], v[196:199], v[164:167], v[76:79]
    v_mfma_f32_16x16x32_bf16 v[80:83], v[200:203], v[160:163], v[80:83]
    v_mfma_f32_16x16x32_bf16 v[84:87], v[200:203], v[164:167], v[84:87]
    s_waitcnt lgkmcnt(0)
    s_barrier
    v_mfma_f32_16x16x32_bf16 v[16:19], v[212:215], v[204:207], v[16:19]
    ds_read_b128 v[160:163], v8 offset:0
    v_mfma_f32_16x16x32_bf16 v[20:23], v[212:215], v[208:211], v[20:23]
    ds_read_b128 v[164:167], v8 offset:2048
    v_mfma_f32_16x16x32_bf16 v[24:27], v[216:219], v[204:207], v[24:27]
    ds_read_b128 v[168:171], v1 offset:0
    v_mfma_f32_16x16x32_bf16 v[28:31], v[216:219], v[208:211], v[28:31]
    ds_read_b128 v[172:175], v1 offset:1024
    v_mfma_f32_16x16x32_bf16 v[32:35], v[220:223], v[204:207], v[32:35]
    ds_read_b128 v[176:179], v1 offset:2048
    v_mfma_f32_16x16x32_bf16 v[36:39], v[220:223], v[208:211], v[36:39]
    ds_read_b128 v[180:183], v1 offset:3072
    v_mfma_f32_16x16x32_bf16 v[40:43], v[224:227], v[204:207], v[40:43]
    ds_read_b128 v[184:187], v1 offset:4096
    v_mfma_f32_16x16x32_bf16 v[44:47], v[224:227], v[208:211], v[44:47]
    ds_read_b128 v[188:191], v1 offset:5120
    v_mfma_f32_16x16x32_bf16 v[48:51], v[228:231], v[204:207], v[48:51]
    ds_read_b128 v[192:195], v1 offset:6144
    v_mfma_f32_16x16x32_bf16 v[52:55], v[228:231], v[208:211], v[52:55]
    ds_read_b128 v[196:199], v1 offset:7168
    v_mfma_f32_16x16x32_bf16 v[56:59], v[232:235], v[204:207], v[56:59]
    ds_read_b128 v[200:203], v1 offset:8192
    v_mfma_f32_16x16x32_bf16 v[60:63], v[232:235], v[208:211], v[60:63]
    v_mfma_f32_16x16x32_bf16 v[64:67], v[236:239], v[204:207], v[64:67]
    v_mfma_f32_16x16x32_bf16 v[68:71], v[236:239], v[208:211], v[68:71]
    v_mfma_f32_16x16x32_bf16 v[72:75], v[240:243], v[204:207], v[72:75]
    v_mfma_f32_16x16x32_bf16 v[76:79], v[240:243], v[208:211], v[76:79]
    v_mfma_f32_16x16x32_bf16 v[80:83], v[244:247], v[204:207], v[80:83]
    v_mfma_f32_16x16x32_bf16 v[84:87], v[244:247], v[208:211], v[84:87]
    s_waitcnt lgkmcnt(5)
    v_mfma_f32_16x16x32_bf16 v[16:19], v[168:171], v[160:163], v[16:19]
    ds_read_b128 v[204:207], v9 offset:0
    v_mfma_f32_16x16x32_bf16 v[20:23], v[168:171], v[164:167], v[20:23]
    ds_read_b128 v[208:211], v9 offset:2048
    v_mfma_f32_16x16x32_bf16 v[24:27], v[172:175], v[160:163], v[24:27]
    ds_read_b128 v[212:215], v1 offset:9216
    v_mfma_f32_16x16x32_bf16 v[28:31], v[172:175], v[164:167], v[28:31]
    ds_read_b128 v[216:219], v1 offset:10240
    v_mfma_f32_16x16x32_bf16 v[32:35], v[176:179], v[160:163], v[32:35]
    ds_read_b128 v[220:223], v1 offset:11264
    v_mfma_f32_16x16x32_bf16 v[36:39], v[176:179], v[164:167], v[36:39]
    ds_read_b128 v[224:227], v1 offset:12288
    v_mfma_f32_16x16x32_bf16 v[40:43], v[180:183], v[160:163], v[40:43]
    ds_read_b128 v[228:231], v1 offset:13312
    v_mfma_f32_16x16x32_bf16 v[44:47], v[180:183], v[164:167], v[44:47]
    ds_read_b128 v[232:235], v1 offset:14336
    s_waitcnt lgkmcnt(8)
    v_mfma_f32_16x16x32_bf16 v[48:51], v[184:187], v[160:163], v[48:51]
    ds_read_b128 v[236:239], v1 offset:15360
    v_mfma_f32_16x16x32_bf16 v[52:55], v[184:187], v[164:167], v[52:55]
    ds_read_b128 v[240:243], v1 offset:16384
    v_mfma_f32_16x16x32_bf16 v[56:59], v[188:191], v[160:163], v[56:59]
    ds_read_b128 v[244:247], v1 offset:17408
    v_mfma_f32_16x16x32_bf16 v[60:63], v[188:191], v[164:167], v[60:63]
    v_mfma_f32_16x16x32_bf16 v[64:67], v[192:195], v[160:163], v[64:67]
    v_mfma_f32_16x16x32_bf16 v[68:71], v[192:195], v[164:167], v[68:71]
    v_mfma_f32_16x16x32_bf16 v[72:75], v[196:199], v[160:163], v[72:75]
    v_mfma_f32_16x16x32_bf16 v[76:79], v[196:199], v[164:167], v[76:79]
    v_mfma_f32_16x16x32_bf16 v[80:83], v[200:203], v[160:163], v[80:83]
    v_mfma_f32_16x16x32_bf16 v[84:87], v[200:203], v[164:167], v[84:87]
    s_waitcnt lgkmcnt(0)
    s_barrier
    v_mfma_f32_16x16x32_bf16 v[16:19], v[212:215], v[204:207], v[16:19]
    ds_read_b128 v[160:163], v8 offset:36864
    v_mfma_f32_16x16x32_bf16 v[20:23], v[212:215], v[208:211], v[20:23]
    ds_read_b128 v[164:167], v8 offset:38912
    v_mfma_f32_16x16x32_bf16 v[24:27], v[216:219], v[204:207], v[24:27]
    ds_read_b128 v[168:171], v1 offset:36864
    v_mfma_f32_16x16x32_bf16 v[28:31], v[216:219], v[208:211], v[28:31]
    ds_read_b128 v[172:175], v1 offset:37888
    v_mfma_f32_16x16x32_bf16 v[32:35], v[220:223], v[204:207], v[32:35]
    ds_read_b128 v[176:179], v1 offset:38912
    v_mfma_f32_16x16x32_bf16 v[36:39], v[220:223], v[208:211], v[36:39]
    ds_read_b128 v[180:183], v1 offset:39936
    v_mfma_f32_16x16x32_bf16 v[40:43], v[224:227], v[204:207], v[40:43]
    ds_read_b128 v[184:187], v1 offset:40960
    v_mfma_f32_16x16x32_bf16 v[44:47], v[224:227], v[208:211], v[44:47]
    ds_read_b128 v[188:191], v1 offset:41984
    v_mfma_f32_16x16x32_bf16 v[48:51], v[228:231], v[204:207], v[48:51]
    ds_read_b128 v[192:195], v1 offset:43008
    v_mfma_f32_16x16x32_bf16 v[52:55], v[228:231], v[208:211], v[52:55]
    ds_read_b128 v[196:199], v1 offset:44032
    v_mfma_f32_16x16x32_bf16 v[56:59], v[232:235], v[204:207], v[56:59]
    ds_read_b128 v[200:203], v1 offset:45056
    v_mfma_f32_16x16x32_bf16 v[60:63], v[232:235], v[208:211], v[60:63]
    v_mfma_f32_16x16x32_bf16 v[64:67], v[236:239], v[204:207], v[64:67]
    v_mfma_f32_16x16x32_bf16 v[68:71], v[236:239], v[208:211], v[68:71]
    v_mfma_f32_16x16x32_bf16 v[72:75], v[240:243], v[204:207], v[72:75]
    v_mfma_f32_16x16x32_bf16 v[76:79], v[240:243], v[208:211], v[76:79]
    v_mfma_f32_16x16x32_bf16 v[80:83], v[244:247], v[204:207], v[80:83]
    v_mfma_f32_16x16x32_bf16 v[84:87], v[244:247], v[208:211], v[84:87]
    s_waitcnt lgkmcnt(5)
    v_mfma_f32_16x16x32_bf16 v[16:19], v[168:171], v[160:163], v[16:19]
    ds_read_b128 v[204:207], v9 offset:36864
    v_mfma_f32_16x16x32_bf16 v[20:23], v[168:171], v[164:167], v[20:23]
    ds_read_b128 v[208:211], v9 offset:38912
    v_mfma_f32_16x16x32_bf16 v[24:27], v[172:175], v[160:163], v[24:27]
    ds_read_b128 v[212:215], v1 offset:46080
    v_mfma_f32_16x16x32_bf16 v[28:31], v[172:175], v[164:167], v[28:31]
    ds_read_b128 v[216:219], v1 offset:47104
    v_mfma_f32_16x16x32_bf16 v[32:35], v[176:179], v[160:163], v[32:35]
    ds_read_b128 v[220:223], v1 offset:48128
    v_mfma_f32_16x16x32_bf16 v[36:39], v[176:179], v[164:167], v[36:39]
    ds_read_b128 v[224:227], v1 offset:49152
    v_mfma_f32_16x16x32_bf16 v[40:43], v[180:183], v[160:163], v[40:43]
    ds_read_b128 v[228:231], v1 offset:50176
    v_mfma_f32_16x16x32_bf16 v[44:47], v[180:183], v[164:167], v[44:47]
    ds_read_b128 v[232:235], v1 offset:51200
    s_waitcnt lgkmcnt(8)
    v_mfma_f32_16x16x32_bf16 v[48:51], v[184:187], v[160:163], v[48:51]
    ds_read_b128 v[236:239], v1 offset:52224
    v_mfma_f32_16x16x32_bf16 v[52:55], v[184:187], v[164:167], v[52:55]
    ds_read_b128 v[240:243], v1 offset:53248
    v_mfma_f32_16x16x32_bf16 v[56:59], v[188:191], v[160:163], v[56:59]
    ds_read_b128 v[244:247], v1 offset:54272
    v_mfma_f32_16x16x32_bf16 v[60:63], v[188:191], v[164:167], v[60:63]
    v_mfma_f32_16x16x32_bf16 v[64:67], v[192:195], v[160:163], v[64:67]
    v_mfma_f32_16x16x32_bf16 v[68:71], v[192:195], v[164:167], v[68:71]
    v_mfma_f32_16x16x32_bf16 v[72:75], v[196:199], v[160:163], v[72:75]
    v_mfma_f32_16x16x32_bf16 v[76:79], v[196:199], v[164:167], v[76:79]
    v_mfma_f32_16x16x32_bf16 v[80:83], v[200:203], v[160:163], v[80:83]
    v_mfma_f32_16x16x32_bf16 v[84:87], v[200:203], v[164:167], v[84:87]
    s_waitcnt lgkmcnt(0)
    s_barrier
    v_mfma_f32_16x16x32_bf16 v[16:19], v[212:215], v[204:207], v[16:19]
    ds_read_b128 v[160:163], v10 offset:0
    v_mfma_f32_16x16x32_bf16 v[20:23], v[212:215], v[208:211], v[20:23]
    ds_read_b128 v[164:167], v10 offset:2048
    v_mfma_f32_16x16x32_bf16 v[24:27], v[216:219], v[204:207], v[24:27]
    ds_read_b128 v[168:171], v2 offset:0
    v_mfma_f32_16x16x32_bf16 v[28:31], v[216:219], v[208:211], v[28:31]
    ds_read_b128 v[172:175], v2 offset:1024
    v_mfma_f32_16x16x32_bf16 v[32:35], v[220:223], v[204:207], v[32:35]
    ds_read_b128 v[176:179], v2 offset:2048
    v_mfma_f32_16x16x32_bf16 v[36:39], v[220:223], v[208:211], v[36:39]
    ds_read_b128 v[180:183], v2 offset:3072
    v_mfma_f32_16x16x32_bf16 v[40:43], v[224:227], v[204:207], v[40:43]
    ds_read_b128 v[184:187], v2 offset:4096
    v_mfma_f32_16x16x32_bf16 v[44:47], v[224:227], v[208:211], v[44:47]
    ds_read_b128 v[188:191], v2 offset:5120
    v_mfma_f32_16x16x32_bf16 v[48:51], v[228:231], v[204:207], v[48:51]
    ds_read_b128 v[192:195], v2 offset:6144
    v_mfma_f32_16x16x32_bf16 v[52:55], v[228:231], v[208:211], v[52:55]
    ds_read_b128 v[196:199], v2 offset:7168
    v_mfma_f32_16x16x32_bf16 v[56:59], v[232:235], v[204:207], v[56:59]
    ds_read_b128 v[200:203], v2 offset:8192
    v_mfma_f32_16x16x32_bf16 v[60:63], v[232:235], v[208:211], v[60:63]
    v_mfma_f32_16x16x32_bf16 v[64:67], v[236:239], v[204:207], v[64:67]
    v_mfma_f32_16x16x32_bf16 v[68:71], v[236:239], v[208:211], v[68:71]
    v_mfma_f32_16x16x32_bf16 v[72:75], v[240:243], v[204:207], v[72:75]
    v_mfma_f32_16x16x32_bf16 v[76:79], v[240:243], v[208:211], v[76:79]
    v_mfma_f32_16x16x32_bf16 v[80:83], v[244:247], v[204:207], v[80:83]
    s_sub_u32 s41, s41, 1
    v_mfma_f32_16x16x32_bf16 v[84:87], v[244:247], v[208:211], v[84:87]
    s_cmp_lg_u32 s41, 0
    s_cbranch_scc1 L_g_loop
    s_waitcnt lgkmcnt(5)
    v_mfma_f32_16x16x32_bf16 v[16:19], v[168:171], v[160:163], v[16:19]
    ds_read_b128 v[204:207], v11 offset:0
    v_mfma_f32_16x16x32_bf16 v[20:23], v[168:171], v[164:167], v[20:23]
    ds_read_b128 v[208:211], v11 offset:2048
    v_mfma_f32_16x16x32_bf16 v[24:27], v[172:175], v[160:163], v[24:27]
    ds_read_b128 v[212:215], v2 offset:9216
    v_mfma_f32_16x16x32_bf16 v[28:31], v[172:175], v[164:167], v[28:31]
    ds_read_b128 v[216:219], v2 offset:10240
    v_mfma_f32_16x16x32_bf16 v[32:35], v[176:179], v[160:163], v[32:35]
    ds_read_b128 v[220:223], v2 offset:11264
    v_mfma_f32_16x16x32_bf16 v[36:39], v[176:179], v[164:167], v[36:39]
    ds_read_b128 v[224:227], v2 offset:12288
    v_mfma_f32_16x16x32_bf16 v[40:43], v[180:183], v[160:163], v[40:43]
    ds_read_b128 v[228:231], v2 offset:13312
    v_mfma_f32_16x16x32_bf16 v[44:47], v[180:183], v[164:167], v[44:47]
    ds_read_b128 v[232:235], v2 offset:14336
    s_waitcnt lgkmcnt(8)
    v_mfma_f32_16x16x32_bf16 v[48:51], v[184:187], v[160:163], v[48:51]
    ds_read_b128 v[236:239], v2 offset:15360
    v_mfma_f32_16x16x32_bf16 v[52:55], v[184:187], v[164:167], v[52:55]
    ds_read_b128 v[240:243], v2 offset:16384
    v_mfma_f32_16x16x32_bf16 v[56:59], v[188:191], v[160:163], v[56:59]
    ds_read_b128 v[244:247], v2 offset:17408
    v_mfma_f32_16x16x32_bf16 v[60:63], v[188:191], v[164:167], v[60:63]
    v_mfma_f32_16x16x32_bf16 v[64:67], v[192:195], v[160:163], v[64:67]
    v_mfma_f32_16x16x32_bf16 v[68:71], v[192:195], v[164:167], v[68:71]
    v_mfma_f32_16x16x32_bf16 v[72:75], v[196:199], v[160:163], v[72:75]
    v_mfma_f32_16x16x32_bf16 v[76:79], v[196:199], v[164:167], v[76:79]
    v_mfma_f32_16x16x32_bf16 v[80:83], v[200:203], v[160:163], v[80:83]
    v_mfma_f32_16x16x32_bf16 v[84:87], v[200:203], v[164:167], v[84:87]
    s_waitcnt lgkmcnt(0)
    s_barrier
    v_mfma_f32_16x16x32_bf16 v[16:19], v[212:215], v[204:207], v[16:19]
    ds_read_b128 v[160:163], v10 offset:36864
    v_mfma_f32_16x16x32_bf16 v[20:23], v[212:215], v[208:211], v[20:23]
    ds_read_b128 v[164:167], v10 offset:38912
    v_mfma_f32_16x16x32_bf16 v[24:27], v[216:219], v[204:207], v[24:27]
    ds_read_b128 v[168:171], v2 offset:36864
    v_mfma_f32_16x16x32_bf16 v[28:31], v[216:219], v[208:211], v[28:31]
    ds_read_b128 v[172:175], v2 offset:37888
    v_mfma_f32_16x16x32_bf16 v[32:35], v[220:223], v[204:207], v[32:35]
    ds_read_b128 v[176:179], v2 offset:38912
    v_mfma_f32_16x16x32_bf16 v[36:39], v[220:223], v[208:211], v[36:39]
    ds_read_b128 v[180:183], v2 offset:39936
    v_mfma_f32_16x16x32_bf16 v[40:43], v[224:227], v[204:207], v[40:43]
    ds_read_b128 v[184:187], v2 offset:40960
    v_mfma_f32_16x16x32_bf16 v[44:47], v[224:227], v[208:211], v[44:47]
    ds_read_b128 v[188:191], v2 offset:41984
    v_mfma_f32_16x16x32_bf16 v[48:51], v[228:231], v[204:207], v[48:51]
    ds_read_b128 v[192:195], v2 offset:43008
    v_mfma_f32_16x16x32_bf16 v[52:55], v[228:231], v[208:211], v[52:55]
    ds_read_b128 v[196:199], v2 offset:44032
    v_mfma_f32_16x16x32_bf16 v[56:59], v[232:235], v[204:207], v[56:59]
    ds_read_b128 v[200:203], v2 offset:45056
    v_mfma_f32_16x16x32_bf16 v[60:63], v[232:235], v[208:211], v[60:63]
    v_mfma_f32_16x16x32_bf16 v[64:67], v[236:239], v[204:207], v[64:67]
    v_mfma_f32_16x16x32_bf16 v[68:71], v[236:239], v[208:211], v[68:71]
    v_mfma_f32_16x16x32_bf16 v[72:75], v[240:243], v[204:207], v[72:75]
    v_mfma_f32_16x16x32_bf16 v[76:79], v[240:243], v[208:211], v[76:79]
    v_mfma_f32_16x16x32_bf16 v[80:83], v[244:247], v[204:207], v[80:83]
    v_mfma_f32_16x16x32_bf16 v[84:87], v[244:247], v[208:211], v[84:87]
    s_waitcnt lgkmcnt(5)
    v_mfma_f32_16x16x32_bf16 v[16:19], v[168:171], v[160:163], v[16:19]
    ds_read_b128 v[204:207], v11 offset:36864
    v_mfma_f32_16x16x32_bf16 v[20:23], v[168:171], v[164:167], v[20:23]
    ds_read_b128 v[208:211], v11 offset:38912
    v_mfma_f32_16x16x32_bf16 v[24:27], v[172:175], v[160:163], v[24:27]
    ds_read_b128 v[212:215], v2 offset:46080
    v_mfma_f32_16x16x32_bf16 v[28:31], v[172:175], v[164:167], v[28:31]
    ds_read_b128 v[216:219], v2 offset:47104
    v_mfma_f32_16x16x32_bf16 v[32:35], v[176:179], v[160:163], v[32:35]
    ds_read_b128 v[220:223], v2 offset:48128
    v_mfma_f32_16x16x32_bf16 v[36:39], v[176:179], v[164:167], v[36:39]
    ds_read_b128 v[224:227], v2 offset:49152
    v_mfma_f32_16x16x32_bf16 v[40:43], v[180:183], v[160:163], v[40:43]
    ds_read_b128 v[228:231], v2 offset:50176
    v_mfma_f32_16x16x32_bf16 v[44:47], v[180:183], v[164:167], v[44:47]
    ds_read_b128 v[232:235], v2 offset:51200
    s_waitcnt lgkmcnt(8)
    v_mfma_f32_16x16x32_bf16 v[48:51], v[184:187], v[160:163], v[48:51]
    ds_read_b128 v[236:239], v2 offset:52224
    v_mfma_f32_16x16x32_bf16 v[52:55], v[184:187], v[164:167], v[52:55]
    ds_read_b128 v[240:243], v2 offset:53248
    v_mfma_f32_16x16x32_bf16 v[56:59], v[188:191], v[160:163], v[56:59]
    ds_read_b128 v[244:247], v2 offset:54272
    v_mfma_f32_16x16x32_bf16 v[60:63], v[188:191], v[164:167], v[60:63]
    v_mfma_f32_16x16x32_bf16 v[64:67], v[192:195], v[160:163], v[64:67]
    v_mfma_f32_16x16x32_bf16 v[68:71], v[192:195], v[164:167], v[68:71]
    v_mfma_f32_16x16x32_bf16 v[72:75], v[196:199], v[160:163], v[72:75]
    v_mfma_f32_16x16x32_bf16 v[76:79], v[196:199], v[164:167], v[76:79]
    v_mfma_f32_16x16x32_bf16 v[80:83], v[200:203], v[160:163], v[80:83]
    v_mfma_f32_16x16x32_bf16 v[84:87], v[200:203], v[164:167], v[84:87]
    s_waitcnt lgkmcnt(0)
    s_barrier
    v_mfma_f32_16x16x32_bf16 v[16:19], v[212:215], v[204:207], v[16:19]
    ds_read_b128 v[160:163], v8 offset:0
    v_mfma_f32_16x16x32_bf16 v[20:23], v[212:215], v[208:211], v[20:23]
    ds_read_b128 v[164:167], v8 offset:2048
    v_mfma_f32_16x16x32_bf16 v[24:27], v[216:219], v[204:207], v[24:27]
    ds_read_b128 v[192:195], v1 offset:0
    v_mfma_f32_16x16x32_bf16 v[28:31], v[216:219], v[208:211], v[28:31]
    ds_read_b128 v[168:171], v9 offset:0
    v_mfma_f32_16x16x32_bf16 v[32:35], v[220:223], v[204:207], v[32:35]
    ds_read_b128 v[172:175], v9 offset:2048
    v_mfma_f32_16x16x32_bf16 v[36:39], v[220:223], v[208:211], v[36:39]
    ds_read_b128 v[176:179], v8 offset:36864
    v_mfma_f32_16x16x32_bf16 v[40:43], v[224:227], v[204:207], v[40:43]
    ds_read_b128 v[180:183], v8 offset:38912
    v_mfma_f32_16x16x32_bf16 v[44:47], v[224:227], v[208:211], v[44:47]
    ds_read_b128 v[184:187], v9 offset:36864
    v_mfma_f32_16x16x32_bf16 v[48:51], v[228:231], v[204:207], v[48:51]
    ds_read_b128 v[188:191], v9 offset:38912
    v_mfma_f32_16x16x32_bf16 v[52:55], v[228:231], v[208:211], v[52:55]
    ds_read_b128 v[196:199], v1 offset:9216
    v_mfma_f32_16x16x32_bf16 v[56:59], v[232:235], v[204:207], v[56:59]
    ds_read_b128 v[200:203], v1 offset:36864
    v_mfma_f32_16x16x32_bf16 v[60:63], v[232:235], v[208:211], v[60:63]
    v_mfma_f32_16x16x32_bf16 v[64:67], v[236:239], v[204:207], v[64:67]
    v_mfma_f32_16x16x32_bf16 v[68:71], v[236:239], v[208:211], v[68:71]
    v_mfma_f32_16x16x32_bf16 v[72:75], v[240:243], v[204:207], v[72:75]
    v_mfma_f32_16x16x32_bf16 v[76:79], v[240:243], v[208:211], v[76:79]
    v_mfma_f32_16x16x32_bf16 v[80:83], v[244:247], v[204:207], v[80:83]
    v_mfma_f32_16x16x32_bf16 v[84:87], v[244:247], v[208:211], v[84:87]
    s_waitcnt lgkmcnt(0)
    v_mfma_f32_16x16x32_bf16 v[16:19], v[192:195], v[160:163], v[16:19]
    ds_read_b128 v[204:207], v1 offset:46080
    v_mfma_f32_16x16x32_bf16 v[20:23], v[192:195], v[164:167], v[20:23]
    ds_read_b128 v[208:211], v1 offset:1024
    s_waitcnt lgkmcnt(3)
    v_mfma_f32_16x16x32_bf16 v[16:19], v[196:199], v[168:171], v[16:19]
    ds_read_b128 v[212:215], v1 offset:10240
    v_mfma_f32_16x16x32_bf16 v[20:23], v[196:199], v[172:175], v[20:23]
    ds_read_b128 v[216:219], v1 offset:37888
    s_waitcnt lgkmcnt(4)
    v_mfma_f32_16x16x32_bf16 v[16:19], v[200:203], v[176:179], v[16:19]
    ds_read_b128 v[220:223], v1 offset:47104
    v_mfma_f32_16x16x32_bf16 v[20:23], v[200:203], v[180:183], v[20:23]
    ds_read_b128 v[224:227], v1 offset:2048
    s_waitcnt lgkmcnt(5)
    v_mfma_f32_16x16x32_bf16 v[16:19], v[204:207], v[184:187], v[16:19]
    ds_read_b128 v[228:231], v1 offset:11264
    v_mfma_f32_16x16x32_bf16 v[20:23], v[204:207], v[188:191], v[20:23]
    ds_read_b128 v[232:235], v1 offset:38912
    s_waitcnt lgkmcnt(6)
    v_mfma_f32_16x16x32_bf16 v[24:27], v[208:211], v[160:163], v[24:27]
    ds_read_b128 v[236:239], v1 offset:48128
    v_mfma_f32_16x16x32_bf16 v[28:31], v[208:211], v[164:167], v[28:31]
    ds_read_b128 v[240:243], v1 offset:3072
    s_waitcnt lgkmcnt(7)
    v_mfma_f32_16x16x32_bf16 v[24:27], v[212:215], v[168:171], v[24:27]
    ds_read_b128 v[244:247], v1 offset:12288
    v_mfma_f32_16x16x32_bf16 v[28:31], v[212:215], v[172:175], v[28:31]
    s_waitcnt lgkmcnt(7)
    v_mfma_f32_16x16x32_bf16 v[24:27], v[216:219], v[176:179], v[24:27]
    ds_read_b128 v[192:195], v1 offset:39936
    v_mul_f32 v16, v16, v88
    v_mfma_f32_16x16x32_bf16 v[28:31], v[216:219], v[180:183], v[28:31]
    v_mul_f32 v17, v17, v89
    v_mul_f32 v18, v18, v90
    s_waitcnt lgkmcnt(7)
    v_mfma_f32_16x16x32_bf16 v[24:27], v[220:223], v[184:187], v[24:27]
    ds_read_b128 v[196:199], v1 offset:49152
    v_mul_f32 v19, v19, v91
    v_mfma_f32_16x16x32_bf16 v[28:31], v[220:223], v[188:191], v[28:31]
    v_cvt_pk_bf16_f32 v88, v16, v17
    v_cvt_pk_bf16_f32 v89, v18, v19
    s_waitcnt lgkmcnt(7)
    v_mfma_f32_16x16x32_bf16 v[32:35], v[224:227], v[160:163], v[32:35]
    ds_read_b128 v[200:203], v1 offset:4096
    v_mul_f32 v20, v20, v92
    v_mfma_f32_16x16x32_bf16 v[36:39], v[224:227], v[164:167], v[36:39]
    v_mul_f32 v21, v21, v93
    v_mul_f32 v22, v22, v94
    s_waitcnt lgkmcnt(7)
    v_mfma_f32_16x16x32_bf16 v[32:35], v[228:231], v[168:171], v[32:35]
    ds_read_b128 v[204:207], v1 offset:13312
    v_mul_f32 v23, v23, v95
    v_mfma_f32_16x16x32_bf16 v[36:39], v[228:231], v[172:175], v[36:39]
    v_cvt_pk_bf16_f32 v92, v20, v21
    v_cvt_pk_bf16_f32 v93, v22, v23
    s_waitcnt lgkmcnt(7)
    v_mfma_f32_16x16x32_bf16 v[32:35], v[232:235], v[176:179], v[32:35]
    ds_read_b128 v[208:211], v1 offset:40960
    v_mul_f32 v24, v24, v96
    v_mfma_f32_16x16x32_bf16 v[36:39], v[232:235], v[180:183], v[36:39]
    v_mul_f32 v25, v25, v97
    v_mul_f32 v26, v26, v98
    v_mul_f32 v27, v27, v99
    s_waitcnt lgkmcnt(7)
    v_mfma_f32_16x16x32_bf16 v[32:35], v[236:239], v[184:187], v[32:35]
    ds_read_b128 v[212:215], v1 offset:50176
    v_cvt_pk_bf16_f32 v90, v24, v25
    v_mfma_f32_16x16x32_bf16 v[36:39], v[236:239], v[188:191], v[36:39]
    v_cvt_pk_bf16_f32 v91, v26, v27
    buffer_store_dwordx4 v[88:91], v14, s[4:7], s39 offen sc1
    s_waitcnt lgkmcnt(7)
    v_mfma_f32_16x16x32_bf16 v[40:43], v[240:243], v[160:163], v[40:43]
    ds_read_b128 v[216:219], v1 offset:5120
    v_mul_f32 v28, v28, v100
    v_mfma_f32_16x16x32_bf16 v[44:47], v[240:243], v[164:167], v[44:47]
    v_mul_f32 v29, v29, v101
    v_mul_f32 v30, v30, v102
    s_waitcnt lgkmcnt(7)
    v_mfma_f32_16x16x32_bf16 v[40:43], v[244:247], v[168:171], v[40:43]
    ds_read_b128 v[220:223], v1 offset:14336
    v_mul_f32 v31, v31, v103
    v_mfma_f32_16x16x32_bf16 v[44:47], v[244:247], v[172:175], v[44:47]
    v_cvt_pk_bf16_f32 v94, v28, v29
    v_cvt_pk_bf16_f32 v95, v30, v31
    s_waitcnt lgkmcnt(7)
    v_mfma_f32_16x16x32_bf16 v[40:43], v[192:195], v[176:179], v[40:43]
    ds_read_b128 v[224:227], v1 offset:41984
    buffer_store_dwordx4 v[92:95], v14, s[4:7], s40 offen sc1
    v_mfma_f32_16x16x32_bf16 v[44:47], v[192:195], v[180:183], v[44:47]
    v_add_u32 v14, 16384, v14
    v_mul_f32 v32, v32, v104
    v_mul_f32 v33, v33, v105
    s_waitcnt lgkmcnt(7)
    v_mfma_f32_16x16x32_bf16 v[40:43], v[196:199], v[184:187], v[40:43]
    ds_read_b128 v[228:231], v1 offset:51200
    v_mul_f32 v34, v34, v106
    v_mfma_f32_16x16x32_bf16 v[44:47], v[196:199], v[188:191], v[44:47]
    v_mul_f32 v35, v35, v107
    v_cvt_pk_bf16_f32 v104, v32, v33
    s_waitcnt lgkmcnt(7)
    v_mfma_f32_16x16x32_bf16 v[48:51], v[200:203], v[160:163], v[48:51]
    ds_read_b128 v[232:235], v1 offset:6144
    v_cvt_pk_bf16_f32 v105, v34, v35
    v_mfma_f32_16x16x32_bf16 v[52:55], v[200:203], v[164:167], v[52:55]
    v_mul_f32 v36, v36, v108
    v_mul_f32 v37, v37, v109
    s_waitcnt lgkmcnt(7)
    v_mfma_f32_16x16x32_bf16 v[48:51], v[204:207], v[168:171], v[48:51]
    ds_read_b128 v[236:239], v1 offset:15360
    v_mul_f32 v38, v38, v110
    v_mfma_f32_16x16x32_bf16 v[52:55], v[204:207], v[172:175], v[52:55]
    v_mul_f32 v39, v39, v111
    v_cvt_pk_bf16_f32 v108, v36, v37
    s_waitcnt lgkmcnt(7)
    v_mfma_f32_16x16x32_bf16 v[48:51], v[208:211], v[176:179], v[48:51]
    ds_read_b128 v[240:243], v1 offset:43008
    v_cvt_pk_bf16_f32 v109, v38, v39
    v_mfma_f32_16x16x32_bf16 v[52:55], v[208:211], v[180:183], v[52:55]
    v_mul_f32 v40, v40, v112
    v_mul_f32 v41, v41, v113
    v_mul_f32 v42, v42, v114
    s_waitcnt lgkmcnt(7)
    v_mfma_f32_16x16x32_bf16 v[48:51], v[212:215], v[184:187], v[48:51]
    ds_read_b128 v[244:247], v1 offset:52224
    v_mul_f32 v43, v43, v115
    v_mfma_f32_16x16x32_bf16 v[52:55], v[212:215], v[188:191], v[52:55]
    v_cvt_pk_bf16_f32 v106, v40, v41
    v_cvt_pk_bf16_f32 v107, v42, v43
    s_waitcnt lgkmcnt(7)
    v_mfma_f32_16x16x32_bf16 v[56:59], v[216:219], v[160:163], v[56:59]
    ds_read_b128 v[192:195], v1 offset:7168
    buffer_store_dwordx4 v[104:107], v14, s[4:7], s39 offen sc1
    v_mfma_f32_16x16x32_bf16 v[60:63], v[216:219], v[164:167], v[60:63]
    v_mul_f32 v44, v44, v116
    v_mul_f32 v45, v45, v117
    s_waitcnt lgkmcnt(7)
    v_mfma_f32_16x16x32_bf16 v[56:59], v[220:223], v[168:171], v[56:59]
    ds_read_b128 v[196:199], v1 offset:16384
    v_mul_f32 v46, v46, v118
    v_mfma_f32_16x16x32_bf16 v[60:63], v[220:223], v[172:175], v[60:63]
    v_mul_f32 v47, v47, v119
    v_cvt_pk_bf16_f32 v110, v44, v45
    s_waitcnt lgkmcnt(7)
    v_mfma_f32_16x16x32_bf16 v[56:59], v[224:227], v[176:179], v[56:59]
    ds_read_b128 v[200:203], v1 offset:44032
    v_cvt_pk_bf16_f32 v111, v46, v47
    v_mfma_f32_16x16x32_bf16 v[60:63], v[224:227], v[180:183], v[60:63]
    buffer_store_dwordx4 v[108:111], v14, s[4:7], s40 offen sc1
    v_add_u32 v14, 16384, v14
    v_mul_f32 v48, v48, v120
    s_waitcnt lgkmcnt(7)
    v_mfma_f32_16x16x32_bf16 v[56:59], v[228:231], v[184:187], v[56:59]
    ds_read_b128 v[204:207], v1 offset:53248
    v_mul_f32 v49, v49, v121
    v_mfma_f32_16x16x32_bf16 v[60:63], v[228:231], v[188:191], v[60:63]
    v_mul_f32 v50, v50, v122
    v_mul_f32 v51, v51, v123
    s_waitcnt lgkmcnt(7)
    v_mfma_f32_16x16x32_bf16 v[64:67], v[232:235], v[160:163], v[64:67]
    ds_read_b128 v[208:211], v1 offset:8192
    v_cvt_pk_bf16_f32 v120, v48, v49
    v_mfma_f32_16x16x32_bf16 v[68:71], v[232:235], v[164:167], v[68:71]
    v_cvt_pk_bf16_f32 v121, v50, v51
    v_mul_f32 v52, v52, v124
    s_waitcnt lgkmcnt(7)
    v_mfma_f32_16x16x32_bf16 v[64:67], v[236:239], v[168:171], v[64:67]
    ds_read_b128 v[212:215], v1 offset:17408
    v_mul_f32 v53, v53, v125
    v_mfma_f32_16x16x32_bf16 v[68:71], v[236:239], v[172:175], v[68:71]
    v_mul_f32 v54, v54, v126
    v_mul_f32 v55, v55, v127
    s_waitcnt lgkmcnt(7)
    v_mfma_f32_16x16x32_bf16 v[64:67], v[240:243], v[176:179], v[64:67]
    ds_read_b128 v[216:219], v1 offset:45056
    v_cvt_pk_bf16_f32 v124, v52, v53
    v_mfma_f32_16x16x32_bf16 v[68:71], v[240:243], v[180:183], v[68:71]
    v_cvt_pk_bf16_f32 v125, v54, v55
    v_mul_f32 v56, v56, v128
    v_mul_f32 v57, v57, v129
    s_waitcnt lgkmcnt(7)
    v_mfma_f32_16x16x32_bf16 v[64:67], v[244:247], v[184:187], v[64:67]
    ds_read_b128 v[220:223], v1 offset:54272
    v_mul_f32 v58, v58, v130
    v_mfma_f32_16x16x32_bf16 v[68:71], v[244:247], v[188:191], v[68:71]
    v_mul_f32 v59, v59, v131
    v_cvt_pk_bf16_f32 v122, v56, v57
    v_cvt_pk_bf16_f32 v123, v58, v59
    s_waitcnt lgkmcnt(7)
    v_mfma_f32_16x16x32_bf16 v[72:75], v[192:195], v[160:163], v[72:75]
    buffer_store_dwordx4 v[120:123], v14, s[4:7], s39 offen sc1
    v_mul_f32 v60, v60, v132
    v_mfma_f32_16x16x32_bf16 v[76:79], v[192:195], v[164:167], v[76:79]
    v_mul_f32 v61, v61, v133
    v_mul_f32 v62, v62, v134
    s_waitcnt lgkmcnt(6)
    v_mfma_f32_16x16x32_bf16 v[72:75], v[196:199], v[168:171], v[72:75]
    v_mul_f32 v63, v63, v135
    v_cvt_pk_bf16_f32 v126, v60, v61
    v_mfma_f32_16x16x32_bf16 v[76:79], v[196:199], v[172:175], v[76:79]
    v_cvt_pk_bf16_f32 v127, v62, v63
    buffer_store_dwordx4 v[124:127], v14, s[4:7], s40 offen sc1
    s_waitcnt lgkmcnt(5)
    v_mfma_f32_16x16x32_bf16 v[72:75], v[200:203], v[176:179], v[72:75]
    v_add_u32 v14, 16384, v14
    v_mul_f32 v64, v64, v136
    v_mfma_f32_16x16x32_bf16 v[76:79], v[200:203], v[180:183], v[76:79]
    v_mul_f32 v65, v65, v137
    v_mul_f32 v66, v66, v138
    v_mul_f32 v67, v67, v139
    s_waitcnt lgkmcnt(4)
    v_mfma_f32_16x16x32_bf16 v[72:75], v[204:207], v[184:187], v[72:75]
    v_cvt_pk_bf16_f32 v136, v64, v65
    v_cvt_pk_bf16_f32 v137, v66, v67
    v_mfma_f32_16x16x32_bf16 v[76:79], v[204:207], v[188:191], v[76:79]
    v_mul_f32 v68, v68, v140
    v_mul_f32 v69, v69, v141
    s_waitcnt lgkmcnt(3)
    v_mfma_f32_16x16x32_bf16 v[80:83], v[208:211], v[160:163], v[80:83]
    v_mul_f32 v70, v70, v142
    v_mul_f32 v71, v71, v143
    v_mfma_f32_16x16x32_bf16 v[84:87], v[208:211], v[164:167], v[84:87]
    v_cvt_pk_bf16_f32 v140, v68, v69
    v_cvt_pk_bf16_f32 v141, v70, v71
    s_waitcnt lgkmcnt(2)
    v_mfma_f32_16x16x32_bf16 v[80:83], v[212:215], v[168:171], v[80:83]
    v_mfma_f32_16x16x32_bf16 v[84:87], v[212:215], v[172:175], v[84:87]
    s_waitcnt lgkmcnt(1)
    v_mfma_f32_16x16x32_bf16 v[80:83], v[216:219], v[176:179], v[80:83]
    v_mul_f32 v72, v72, v144
    v_mul_f32 v73, v73, v145
    v_mfma_f32_16x16x32_bf16 v[84:87], v[216:219], v[180:183], v[84:87]
    v_mul_f32 v74, v74, v146
    v_mul_f32 v75, v75, v147
    v_cvt_pk_bf16_f32 v138, v72, v73
    s_waitcnt lgkmcnt(0)
    v_mfma_f32_16x16x32_bf16 v[80:83], v[220:223], v[184:187], v[80:83]
    v_cvt_pk_bf16_f32 v139, v74, v75
    buffer_store_dwordx4 v[136:139], v14, s[4:7], s39 offen sc1
    v_mfma_f32_16x16x32_bf16 v[84:87], v[220:223], v[188:191], v[84:87]
    v_mul_f32 v76, v76, v148
    v_mul_f32 v77, v77, v149
    v_mul_f32 v78, v78, v150
    v_mul_f32 v79, v79, v151
    v_cvt_pk_bf16_f32 v142, v76, v77
    v_cvt_pk_bf16_f32 v143, v78, v79
    buffer_store_dwordx4 v[140:143], v14, s[4:7], s40 offen sc1
    s_nop 1
    v_mul_f32 v80, v80, v152
    v_mul_f32 v81, v81, v153
    v_mul_f32 v82, v82, v154
    v_mul_f32 v83, v83, v155
    v_cvt_pk_bf16_f32 v152, v80, v81
    v_cvt_pk_bf16_f32 v153, v82, v83
    v_mul_f32 v84, v84, v156
    v_mul_f32 v85, v85, v157
    v_mul_f32 v86, v86, v158
    v_mul_f32 v87, v87, v159
    v_cvt_pk_bf16_f32 v154, v84, v85
    v_cvt_pk_bf16_f32 v155, v86, v87
    s_bitcmp0_b32 s24, 1
    s_cbranch_scc1 L_g_ns
    v_swap_b32 v152, v154
    v_swap_b32 v153, v155
L_g_ns:
    buffer_store_dwordx4 v[152:155], v15, s[4:7], s39 offen sc1
    s_barrier
    s_and_b32 s25, s2, 7
    s_lshr_b32 s26, s2, 3
    s_lshr_b32 s23, s25, 1
    s_lshl_b32 s23, s23, 3
    s_lshr_b32 s27, s26, 2
    s_add_u32 s23, s23, s27
    s_and_b32 s24, s25, 1
    s_lshl_b32 s24, s24, 2
    s_and_b32 s27, s26, 3
    s_add_u32 s24, s24, s27
    s_add_u32 s25, s23, s24
    s_and_b32 s25, s25, 3
    s_lshl_b32 s30, s23, 2
    s_add_u32 s30, s30, s20
    s_and_b32 s31, s20, 1
    s_mul_i32 s34, s30, 18432
    s_add_u32 s34, s34, s21
    s_add_u32 s34, s34, 0x300000
    s_lshl_b32 s35, s24, 11
    s_lshr_b32 s36, s24, 2
    s_lshl_b32 s36, s36, 10
    s_and_b32 s37, s24, 3
    s_lshl_b32 s37, s37, 8
    s_add_u32 s36, s36, s37
    s_add_u32 s36, s36, 16384
    v_bfe_u32 v2, v1, 4, 4
    v_lshrrev_b32 v3, 8, v1
    v_add_u32 v4, s35, v1
    v_lshrrev_b32 v0, 1, v3
    v_and_b32 v9, 1, v3
    v_cmp_eq_u32 s[40:41], s31, v0
    v_bfrev_b32 v6, 1
    v_lshlrev_b32 v5, 4, v2
    v_lshl_add_u32 v5, v9, 3, v5
    v_add_u32 v5, s36, v5
    v_cndmask_b32 v5, v6, v5, s[40:41]
    buffer_load_dwordx4 v[220:223], v4, s[4:7], s34 offen offset:0 sc1
    buffer_load_dwordx4 v[224:227], v4, s[4:7], s34 offen offset:1024 sc1
    buffer_load_dwordx2 v[228:229], v5, s[4:7], s34 offen sc1
    s_and_b32 s29, s30, 0xfffe
    s_mul_i32 s29, s29, 73728
    s_add_u32 s29, s29, s21
    s_lshl_b32 s37, s31, 10
    s_add_u32 s29, s29, s37
    s_add_u32 s29, s29, 0x1200000
    s_mul_i32 s37, s31, 73728
    s_sub_u32 s38, 73728, s37
    v_lshlrev_b32 v10, 3, v2
    v_add_u32 v16, s37, v1
    v_add_u32 v17, s38, v1
    v_mov_b32 v18, v1
    v_add_u32 v19, 73728, v1
    s_lshl_b32 s37, s31, 12
    v_add_u32 v20, 0, v1
    v_add_u32 v12, s37, v20
    v_add_u32 v21, 36864, v1
    v_add_u32 v13, s37, v21
    v_add_u32 v22, 73728, v1
    v_add_u32 v14, s37, v22
    v_add_u32 v23, 110592, v1
    v_add_u32 v15, s37, v23
    s_add_u32 s34, s34, 0x1900000
    s_lshl_b32 s39, s30, 10
    s_add_u32 s39, s39, s21
    s_lshl_b32 s42, s24, 7
    s_add_u32 s39, s39, s42
    s_add_u32 s39, s39, 0x3700000
    v_cmp_eq_u32 vcc, 0, v3
    v_mov_b32 v11, 0x3f803f80
    s_lshr_b32 s44, s23, 1
    v_cndmask_b32 v10, v6, v10, vcc
    s_cmp_eq_u32 s22, 0
    s_cbranch_scc1 L_p5_nf
    v_mul_u32_u24 v8, 1152, v2
    s_mul_i32 s34, s30, 18432
    s_mul_i32 s42, s24, 144
    s_add_u32 s34, s34, s42
    v_lshl_add_u32 v4, v3, 4, v8
    v_lshl_add_u32 v5, v9, 3, v8
    v_cndmask_b32 v5, v6, v5, s[40:41]
L_p5_nf:
    s_lshl_b32 s52, s22, 7
    s_add_u32 s52, s52, s44
    s_lshl_b32 s52, s52, 8
    s_add_u32 s52, s52, 0x450a000
    s_add_u32 s52, s52, s4
    s_addc_u32 s53, s5, 0
    s_waitcnt vmcnt(3)
    s_barrier
    s_cmp_lg_u32 s20, 0
    s_cbranch_scc1 L_ns_d5
    s_mov_b32 s56, 1
    s_atomic_add s56, s[50:51], 0
L_ns_d5:
    s_mul_i32 s37, s20, 4608
    s_add_u32 s37, s37, 131072
    s_xor_b32 s38, s20, 1
    s_mul_i32 s42, s38, 4608
    s_add_u32 s42, s42, 131072
    v_and_b32 v0, 0x1ff, v1
    v_add_u32 v2, s37, v1
    v_add_u32 v3, s37, v0
    v_add_u32 v7, s42, v1
    v_add_u32 v8, s42, v0
    s_lshl_b32 s37, s20, 2
    s_add_u32 s37, s37, 163808
    s_xor_b32 s38, s37, 4
    v_mov_b32 v0, s37
    v_mov_b32 v6, s38
    s_lshl_b32 s43, s22, 1
    s_add_u32 s43, s43, 2
    v_mov_b32 v9, s43
    s_cmp_lg_u32 s20, 0
    s_cbranch_scc1 L_pd_d5
    s_mov_b32 s60, 65536
L_poll_d5:
    s_mov_b32 s57, 0
    s_atomic_add s57, s[52:53], 0 glc
    s_waitcnt lgkmcnt(0)
    s_cmp_ge_u32 s57, 16
    s_cbranch_scc1 L_pd_d5
    s_sub_u32 s60, s60, 1
    s_cbranch_scc1 L_pd_d5
    s_sleep 2
    s_branch L_poll_d5
L_pd_d5:
    s_barrier
    s_mov_b32 s32, 0
    s_lshl_b32 s32, s32, 13
    s_add_u32 s32, s32, s29
    s_add_u32 s33, s32, 4096
    buffer_load_dwordx4 v[124:127], v16, s[4:7], s32 offen offset:0 sc1
    buffer_load_dwordx4 v[128:131], v17, s[4:7], s32 offen offset:0 sc1
    buffer_load_dwordx4 v[132:135], v16, s[4:7], s32 offen offset:2048 sc1
    buffer_load_dwordx4 v[136:139], v17, s[4:7], s32 offen offset:2048 sc1
    buffer_load_dwordx4 v[140:143], v16, s[4:7], s33 offen offset:0 sc1
    buffer_load_dwordx4 v[144:147], v17, s[4:7], s33 offen offset:0 sc1
    buffer_load_dwordx4 v[148:151], v16, s[4:7], s33 offen offset:2048 sc1
    buffer_load_dwordx4 v[152:155], v17, s[4:7], s33 offen offset:2048 sc1
    ds_read_b128 v[64:67], v14 offset:0
    ds_read_b128 v[68:71], v14 offset:1024
    ds_read_b128 v[72:75], v14 offset:2048
    ds_read_b128 v[76:79], v14 offset:3072
    ds_read_b128 v[80:83], v22 offset:8192
    ds_read_b128 v[84:87], v14 offset:9216
    ds_read_b128 v[88:91], v14 offset:10240
    ds_read_b128 v[92:95], v14 offset:11264
    ds_read_b128 v[96:99], v14 offset:12288
    ds_read_b128 v[100:103], v22 offset:17408
    s_add_u32 s45, s29, 8192
    s_add_u32 s46, s29, 12288
    buffer_load_dwordx4 v[156:159], v16, s[4:7], s45 offen offset:0 sc1
    buffer_load_dwordx4 v[160:163], v17, s[4:7], s45 offen offset:0 sc1
    s_lshl_b32 s50, s22, 7
    s_add_u32 s50, s50, s44
    s_lshl_b32 s50, s50, 8
    s_add_u32 s50, s50, 0x450b000
    s_add_u32 s50, s50, s4
    s_addc_u32 s51, s5, 0
    s_waitcnt vmcnt(10)
    v_lshlrev_b32 v24, 16, v220
    v_and_b32 v25, 0xffff0000, v220
    v_lshlrev_b32 v26, 16, v221
    v_and_b32 v27, 0xffff0000, v221
    v_lshlrev_b32 v28, 16, v222
    v_and_b32 v29, 0xffff0000, v222
    v_lshlrev_b32 v30, 16, v223
    v_and_b32 v31, 0xffff0000, v223
    v_lshlrev_b32 v32, 16, v224
    v_and_b32 v33, 0xffff0000, v224
    v_lshlrev_b32 v34, 16, v225
    v_and_b32 v35, 0xffff0000, v225
    v_lshlrev_b32 v36, 16, v226
    v_and_b32 v37, 0xffff0000, v226
    v_lshlrev_b32 v38, 16, v227
    v_and_b32 v39, 0xffff0000, v227
    v_lshlrev_b32 v40, 16, v228
    v_and_b32 v41, 0xffff0000, v228
    v_lshlrev_b32 v42, 16, v229
    v_and_b32 v43, 0xffff0000, v229
    s_waitcnt vmcnt(8) lgkmcnt(5)
    v_mfma_f32_16x16x32_bf16 v[44:47], v[64:67], v[128:131], 0
    ds_read_b128 v[104:107], v14 offset:18432
    s_mov_b32 s32, 2
    s_lshl_b32 s32, s32, 13
    s_add_u32 s32, s32, s29
    s_add_u32 s33, s32, 4096
    v_mfma_f32_16x16x32_bf16 v[24:27], v[64:67], v[124:127], v[24:27]
    ds_read_b128 v[108:111], v14 offset:19456
    buffer_load_dwordx4 v[164:167], v16, s[4:7], s45 offen offset:2048 sc1
    v_mfma_f32_16x16x32_bf16 v[48:51], v[68:71], v[128:131], 0
    ds_read_b128 v[112:115], v14 offset:20480
    v_mfma_f32_16x16x32_bf16 v[28:31], v[68:71], v[124:127], v[28:31]
    ds_read_b128 v[116:119], v14 offset:21504
    buffer_load_dwordx4 v[168:171], v17, s[4:7], s45 offen offset:2048 sc1
    v_mfma_f32_16x16x32_bf16 v[52:55], v[72:75], v[128:131], 0
    ds_read_b128 v[120:123], v22 offset:26624
    v_mfma_f32_16x16x32_bf16 v[32:35], v[72:75], v[124:127], v[32:35]
    buffer_load_dwordx4 v[188:191], v16, s[4:7], s32 offen offset:0 sc1
    v_mfma_f32_16x16x32_bf16 v[56:59], v[76:79], v[128:131], 0
    v_mfma_f32_16x16x32_bf16 v[36:39], v[76:79], v[124:127], v[36:39]
    buffer_load_dwordx4 v[192:195], v17, s[4:7], s32 offen offset:0 sc1
    v_mfma_f32_16x16x32_bf16 v[60:63], v[80:83], v[128:131], 0
    v_mfma_f32_16x16x32_bf16 v[40:43], v[80:83], v[124:127], v[40:43]
    s_waitcnt vmcnt(10) lgkmcnt(5)
    v_mfma_f32_16x16x32_bf16 v[44:47], v[84:87], v[136:139], v[44:47]
    ds_read_b128 v[64:67], v14 offset:27648
    v_mfma_f32_16x16x32_bf16 v[24:27], v[84:87], v[132:135], v[24:27]
    ds_read_b128 v[68:71], v14 offset:28672
    buffer_load_dwordx4 v[172:175], v16, s[4:7], s46 offen offset:0 sc1
    v_mfma_f32_16x16x32_bf16 v[48:51], v[88:91], v[136:139], v[48:51]
    ds_read_b128 v[72:75], v14 offset:29696
    v_mfma_f32_16x16x32_bf16 v[28:31], v[88:91], v[132:135], v[28:31]
    ds_read_b128 v[76:79], v14 offset:30720
    buffer_load_dwordx4 v[176:179], v17, s[4:7], s46 offen offset:0 sc1
    v_mfma_f32_16x16x32_bf16 v[52:55], v[92:95], v[136:139], v[52:55]
    ds_read_b128 v[80:83], v22 offset:35840
    v_mfma_f32_16x16x32_bf16 v[32:35], v[92:95], v[132:135], v[32:35]
    buffer_load_dwordx4 v[196:199], v16, s[4:7], s32 offen offset:2048 sc1
    v_mfma_f32_16x16x32_bf16 v[56:59], v[96:99], v[136:139], v[56:59]
    v_mfma_f32_16x16x32_bf16 v[36:39], v[96:99], v[132:135], v[36:39]
    buffer_load_dwordx4 v[200:203], v17, s[4:7], s32 offen offset:2048 sc1
    v_mfma_f32_16x16x32_bf16 v[60:63], v[100:103], v[136:139], v[60:63]
    v_mfma_f32_16x16x32_bf16 v[40:43], v[100:103], v[132:135], v[40:43]
    s_waitcnt vmcnt(12) lgkmcnt(0)
    s_barrier
    v_mfma_f32_16x16x32_bf16 v[44:47], v[104:107], v[144:147], v[44:47]
    ds_read_b128 v[84:87], v15 offset:0
    v_mfma_f32_16x16x32_bf16 v[24:27], v[104:107], v[140:143], v[24:27]
    ds_read_b128 v[88:91], v15 offset:1024
    buffer_load_dwordx4 v[180:183], v16, s[4:7], s46 offen offset:2048 sc1
    v_mfma_f32_16x16x32_bf16 v[48:51], v[108:111], v[144:147], v[48:51]
    ds_read_b128 v[92:95], v15 offset:2048
    v_mfma_f32_16x16x32_bf16 v[28:31], v[108:111], v[140:143], v[28:31]
    ds_read_b128 v[96:99], v15 offset:3072
    buffer_load_dwordx4 v[184:187], v17, s[4:7], s46 offen offset:2048 sc1
    v_mfma_f32_16x16x32_bf16 v[52:55], v[112:115], v[144:147], v[52:55]
    ds_read_b128 v[100:103], v23 offset:8192
    v_mfma_f32_16x16x32_bf16 v[32:35], v[112:115], v[140:143], v[32:35]
    buffer_load_dwordx4 v[204:207], v16, s[4:7], s33 offen offset:0 sc1
    v_mfma_f32_16x16x32_bf16 v[56:59], v[116:119], v[144:147], v[56:59]
    v_mfma_f32_16x16x32_bf16 v[36:39], v[116:119], v[140:143], v[36:39]
    buffer_load_dwordx4 v[208:211], v17, s[4:7], s33 offen offset:0 sc1
    v_mfma_f32_16x16x32_bf16 v[60:63], v[120:123], v[144:147], v[60:63]
    v_mfma_f32_16x16x32_bf16 v[40:43], v[120:123], v[140:143], v[40:43]
    s_waitcnt vmcnt(14) lgkmcnt(5)
    v_mfma_f32_16x16x32_bf16 v[44:47], v[64:67], v[152:155], v[44:47]
    ds_read_b128 v[104:107], v15 offset:9216
    v_mfma_f32_16x16x32_bf16 v[24:27], v[64:67], v[148:151], v[24:27]
    ds_read_b128 v[108:111], v15 offset:10240
    v_mfma_f32_16x16x32_bf16 v[48:51], v[68:71], v[152:155], v[48:51]
    ds_read_b128 v[112:115], v15 offset:11264
    v_mfma_f32_16x16x32_bf16 v[28:31], v[68:71], v[148:151], v[28:31]
    ds_read_b128 v[116:119], v15 offset:12288
    v_mfma_f32_16x16x32_bf16 v[52:55], v[72:75], v[152:155], v[52:55]
    ds_read_b128 v[120:123], v23 offset:17408
    v_mfma_f32_16x16x32_bf16 v[32:35], v[72:75], v[148:151], v[32:35]
    buffer_load_dwordx4 v[212:215], v16, s[4:7], s33 offen offset:2048 sc1
    v_mfma_f32_16x16x32_bf16 v[56:59], v[76:79], v[152:155], v[56:59]
    v_mfma_f32_16x16x32_bf16 v[36:39], v[76:79], v[148:151], v[36:39]
    buffer_load_dwordx4 v[216:219], v17, s[4:7], s33 offen offset:2048 sc1
    v_mfma_f32_16x16x32_bf16 v[60:63], v[80:83], v[152:155], v[60:63]
    v_mfma_f32_16x16x32_bf16 v[40:43], v[80:83], v[148:151], v[40:43]
    s_waitcnt vmcnt(14) lgkmcnt(5)
    v_mfma_f32_16x16x32_bf16 v[44:47], v[84:87], v[160:163], v[44:47]
    ds_read_b128 v[64:67], v15 offset:18432
    s_mov_b32 s32, 3
    s_lshl_b32 s32, s32, 13
    s_add_u32 s32, s32, s29
    s_add_u32 s33, s32, 4096
    v_mfma_f32_16x16x32_bf16 v[24:27], v[84:87], v[156:159], v[24:27]
    ds_read_b128 v[68:71], v15 offset:19456
    v_mfma_f32_16x16x32_bf16 v[48:51], v[88:91], v[160:163], v[48:51]
    ds_read_b128 v[72:75], v15 offset:20480
    v_mfma_f32_16x16x32_bf16 v[28:31], v[88:91], v[156:159], v[28:31]
    ds_read_b128 v[76:79], v15 offset:21504
    v_mfma_f32_16x16x32_bf16 v[52:55], v[92:95], v[160:163], v[52:55]
    ds_read_b128 v[80:83], v23 offset:26624
    v_mfma_f32_16x16x32_bf16 v[32:35], v[92:95], v[156:159], v[32:35]
    buffer_load_dwordx4 v[124:127], v16, s[4:7], s32 offen offset:0 sc1
    v_mfma_f32_16x16x32_bf16 v[56:59], v[96:99], v[160:163], v[56:59]
    v_mfma_f32_16x16x32_bf16 v[36:39], v[96:99], v[156:159], v[36:39]
    buffer_load_dwordx4 v[128:131], v17, s[4:7], s32 offen offset:0 sc1
    v_mfma_f32_16x16x32_bf16 v[60:63], v[100:103], v[160:163], v[60:63]
    v_mfma_f32_16x16x32_bf16 v[40:43], v[100:103], v[156:159], v[40:43]
    s_waitcnt vmcnt(14) lgkmcnt(5)
    v_mfma_f32_16x16x32_bf16 v[44:47], v[104:107], v[168:171], v[44:47]
    ds_read_b128 v[84:87], v15 offset:27648
    v_mfma_f32_16x16x32_bf16 v[24:27], v[104:107], v[164:167], v[24:27]
    ds_read_b128 v[88:91], v15 offset:28672
    v_mfma_f32_16x16x32_bf16 v[48:51], v[108:111], v[168:171], v[48:51]
    ds_read_b128 v[92:95], v15 offset:29696
    v_mfma_f32_16x16x32_bf16 v[28:31], v[108:111], v[164:167], v[28:31]
    ds_read_b128 v[96:99], v15 offset:30720
    v_mfma_f32_16x16x32_bf16 v[52:55], v[112:115], v[168:171], v[52:55]
    ds_read_b128 v[100:103], v23 offset:35840
    v_mfma_f32_16x16x32_bf16 v[32:35], v[112:115], v[164:167], v[32:35]
    buffer_load_dwordx4 v[132:135], v16, s[4:7], s32 offen offset:2048 sc1
    v_mfma_f32_16x16x32_bf16 v[56:59], v[116:119], v[168:171], v[56:59]
    v_mfma_f32_16x16x32_bf16 v[36:39], v[116:119], v[164:167], v[36:39]
    buffer_load_dwordx4 v[136:139], v17, s[4:7], s32 offen offset:2048 sc1
    v_mfma_f32_16x16x32_bf16 v[60:63], v[120:123], v[168:171], v[60:63]
    v_mfma_f32_16x16x32_bf16 v[40:43], v[120:123], v[164:167], v[40:43]
    s_waitcnt vmcnt(12) lgkmcnt(0)
    s_barrier
    v_mfma_f32_16x16x32_bf16 v[44:47], v[64:67], v[176:179], v[44:47]
    ds_read_b128 v[104:107], v12 offset:0
    v_mfma_f32_16x16x32_bf16 v[24:27], v[64:67], v[172:175], v[24:27]
    ds_read_b128 v[108:111], v12 offset:1024
    v_mfma_f32_16x16x32_bf16 v[48:51], v[68:71], v[176:179], v[48:51]
    ds_read_b128 v[112:115], v12 offset:2048
    v_mfma_f32_16x16x32_bf16 v[28:31], v[68:71], v[172:175], v[28:31]
    ds_read_b128 v[116:119], v12 offset:3072
    v_mfma_f32_16x16x32_bf16 v[52:55], v[72:75], v[176:179], v[52:55]
    ds_read_b128 v[120:123], v20 offset:8192
    v_mfma_f32_16x16x32_bf16 v[32:35], v[72:75], v[172:175], v[32:35]
    buffer_load_dwordx4 v[140:143], v16, s[4:7], s33 offen offset:0 sc1
    v_mfma_f32_16x16x32_bf16 v[56:59], v[76:79], v[176:179], v[56:59]
    v_mfma_f32_16x16x32_bf16 v[36:39], v[76:79], v[172:175], v[36:39]
    buffer_load_dwordx4 v[144:147], v17, s[4:7], s33 offen offset:0 sc1
    v_mfma_f32_16x16x32_bf16 v[60:63], v[80:83], v[176:179], v[60:63]
    v_mfma_f32_16x16x32_bf16 v[40:43], v[80:83], v[172:175], v[40:43]
    s_waitcnt vmcnt(10) lgkmcnt(5)
    v_mfma_f32_16x16x32_bf16 v[44:47], v[84:87], v[184:187], v[44:47]
    ds_read_b128 v[64:67], v12 offset:9216
    v_mfma_f32_16x16x32_bf16 v[24:27], v[84:87], v[180:183], v[24:27]
    ds_read_b128 v[68:71], v12 offset:10240
    v_mfma_f32_16x16x32_bf16 v[48:51], v[88:91], v[184:187], v[48:51]
    ds_read_b128 v[72:75], v12 offset:11264
    v_mfma_f32_16x16x32_bf16 v[28:31], v[88:91], v[180:183], v[28:31]
    ds_read_b128 v[76:79], v12 offset:12288
    v_mfma_f32_16x16x32_bf16 v[52:55], v[92:95], v[184:187], v[52:55]
    ds_read_b128 v[80:83], v20 offset:17408
    v_mfma_f32_16x16x32_bf16 v[32:35], v[92:95], v[180:183], v[32:35]
    buffer_load_dwordx4 v[148:151], v16, s[4:7], s33 offen offset:2048 sc1
    v_mfma_f32_16x16x32_bf16 v[56:59], v[96:99], v[184:187], v[56:59]
    v_mfma_f32_16x16x32_bf16 v[36:39], v[96:99], v[180:183], v[36:39]
    buffer_load_dwordx4 v[152:155], v17, s[4:7], s33 offen offset:2048 sc1
    v_mfma_f32_16x16x32_bf16 v[60:63], v[100:103], v[184:187], v[60:63]
    v_mfma_f32_16x16x32_bf16 v[40:43], v[100:103], v[180:183], v[40:43]
    s_waitcnt vmcnt(12) lgkmcnt(5)
    v_mfma_f32_16x16x32_bf16 v[44:47], v[104:107], v[192:195], v[44:47]
    ds_read_b128 v[84:87], v12 offset:18432
    s_mov_b32 s32, 4
    s_lshl_b32 s32, s32, 13
    s_add_u32 s32, s32, s29
    s_add_u32 s33, s32, 4096
    v_mfma_f32_16x16x32_bf16 v[24:27], v[104:107], v[188:191], v[24:27]
    ds_read_b128 v[88:91], v12 offset:19456
    v_mfma_f32_16x16x32_bf16 v[48:51], v[108:111], v[192:195], v[48:51]
    ds_read_b128 v[92:95], v12 offset:20480
    v_mfma_f32_16x16x32_bf16 v[28:31], v[108:111], v[188:191], v[28:31]
    ds_read_b128 v[96:99], v12 offset:21504
    v_mfma_f32_16x16x32_bf16 v[52:55], v[112:115], v[192:195], v[52:55]
    ds_read_b128 v[100:103], v20 offset:26624
    v_mfma_f32_16x16x32_bf16 v[32:35], v[112:115], v[188:191], v[32:35]
    buffer_load_dwordx4 v[156:159], v16, s[4:7], s32 offen offset:0 sc1
    v_mfma_f32_16x16x32_bf16 v[56:59], v[116:119], v[192:195], v[56:59]
    v_mfma_f32_16x16x32_bf16 v[36:39], v[116:119], v[188:191], v[36:39]
    buffer_load_dwordx4 v[160:163], v17, s[4:7], s32 offen offset:0 sc1
    v_mfma_f32_16x16x32_bf16 v[60:63], v[120:123], v[192:195], v[60:63]
    v_mfma_f32_16x16x32_bf16 v[40:43], v[120:123], v[188:191], v[40:43]
    s_waitcnt vmcnt(14) lgkmcnt(5)
    v_mfma_f32_16x16x32_bf16 v[44:47], v[64:67], v[200:203], v[44:47]
    ds_read_b128 v[104:107], v12 offset:27648
    v_mfma_f32_16x16x32_bf16 v[24:27], v[64:67], v[196:199], v[24:27]
    ds_read_b128 v[108:111], v12 offset:28672
    v_mfma_f32_16x16x32_bf16 v[48:51], v[68:71], v[200:203], v[48:51]
    ds_read_b128 v[112:115], v12 offset:29696
    v_mfma_f32_16x16x32_bf16 v[28:31], v[68:71], v[196:199], v[28:31]
    ds_read_b128 v[116:119], v12 offset:30720
    v_mfma_f32_16x16x32_bf16 v[52:55], v[72:75], v[200:203], v[52:55]
    ds_read_b128 v[120:123], v20 offset:35840
    v_mfma_f32_16x16x32_bf16 v[32:35], v[72:75], v[196:199], v[32:35]
    buffer_load_dwordx4 v[164:167], v16, s[4:7], s32 offen offset:2048 sc1
    v_mfma_f32_16x16x32_bf16 v[56:59], v[76:79], v[200:203], v[56:59]
    v_mfma_f32_16x16x32_bf16 v[36:39], v[76:79], v[196:199], v[36:39]
    buffer_load_dwordx4 v[168:171], v17, s[4:7], s32 offen offset:2048 sc1
    v_mfma_f32_16x16x32_bf16 v[60:63], v[80:83], v[200:203], v[60:63]
    v_mfma_f32_16x16x32_bf16 v[40:43], v[80:83], v[196:199], v[40:43]
    s_waitcnt vmcnt(14) lgkmcnt(0)
    s_barrier
    v_mfma_f32_16x16x32_bf16 v[44:47], v[84:87], v[208:211], v[44:47]
    ds_read_b128 v[64:67], v13 offset:0
    v_mfma_f32_16x16x32_bf16 v[24:27], v[84:87], v[204:207], v[24:27]
    ds_read_b128 v[68:71], v13 offset:1024
    v_mfma_f32_16x16x32_bf16 v[48:51], v[88:91], v[208:211], v[48:51]
    ds_read_b128 v[72:75], v13 offset:2048
    v_mfma_f32_16x16x32_bf16 v[28:31], v[88:91], v[204:207], v[28:31]
    ds_read_b128 v[76:79], v13 offset:3072
    v_mfma_f32_16x16x32_bf16 v[52:55], v[92:95], v[208:211], v[52:55]
    ds_read_b128 v[80:83], v21 offset:8192
    v_mfma_f32_16x16x32_bf16 v[32:35], v[92:95], v[204:207], v[32:35]
    buffer_load_dwordx4 v[172:175], v16, s[4:7], s33 offen offset:0 sc1
    v_mfma_f32_16x16x32_bf16 v[56:59], v[96:99], v[208:211], v[56:59]
    v_mfma_f32_16x16x32_bf16 v[36:39], v[96:99], v[204:207], v[36:39]
    buffer_load_dwordx4 v[176:179], v17, s[4:7], s33 offen offset:0 sc1
    v_mfma_f32_16x16x32_bf16 v[60:63], v[100:103], v[208:211], v[60:63]
    v_mfma_f32_16x16x32_bf16 v[40:43], v[100:103], v[204:207], v[40:43]
    s_waitcnt vmcnt(14) lgkmcnt(5)
    v_mfma_f32_16x16x32_bf16 v[44:47], v[104:107], v[216:219], v[44:47]
    ds_read_b128 v[84:87], v13 offset:9216
    v_mfma_f32_16x16x32_bf16 v[24:27], v[104:107], v[212:215], v[24:27]
    ds_read_b128 v[88:91], v13 offset:10240
    v_mfma_f32_16x16x32_bf16 v[48:51], v[108:111], v[216:219], v[48:51]
    ds_read_b128 v[92:95], v13 offset:11264
    v_mfma_f32_16x16x32_bf16 v[28:31], v[108:111], v[212:215], v[28:31]
    ds_read_b128 v[96:99], v13 offset:12288
    v_mfma_f32_16x16x32_bf16 v[52:55], v[112:115], v[216:219], v[52:55]
    ds_read_b128 v[100:103], v21 offset:17408
    v_mfma_f32_16x16x32_bf16 v[32:35], v[112:115], v[212:215], v[32:35]
    buffer_load_dwordx4 v[180:183], v16, s[4:7], s33 offen offset:2048 sc1
    v_mfma_f32_16x16x32_bf16 v[56:59], v[116:119], v[216:219], v[56:59]
    v_mfma_f32_16x16x32_bf16 v[36:39], v[116:119], v[212:215], v[36:39]
    buffer_load_dwordx4 v[184:187], v17, s[4:7], s33 offen offset:2048 sc1
    v_mfma_f32_16x16x32_bf16 v[60:63], v[120:123], v[216:219], v[60:63]
    v_mfma_f32_16x16x32_bf16 v[40:43], v[120:123], v[212:215], v[40:43]
    s_waitcnt vmcnt(14) lgkmcnt(5)
    v_mfma_f32_16x16x32_bf16 v[44:47], v[64:67], v[128:131], v[44:47]
    ds_read_b128 v[104:107], v13 offset:18432
    s_mov_b32 s32, 5
    s_lshl_b32 s32, s32, 13
    s_add_u32 s32, s32, s29
    s_add_u32 s33, s32, 4096
    v_mfma_f32_16x16x32_bf16 v[24:27], v[64:67], v[124:127], v[24:27]
    ds_read_b128 v[108:111], v13 offset:19456
    v_mfma_f32_16x16x32_bf16 v[48:51], v[68:71], v[128:131], v[48:51]
    ds_read_b128 v[112:115], v13 offset:20480
    v_mfma_f32_16x16x32_bf16 v[28:31], v[68:71], v[124:127], v[28:31]
    ds_read_b128 v[116:119], v13 offset:21504
    v_mfma_f32_16x16x32_bf16 v[52:55], v[72:75], v[128:131], v[52:55]
    ds_read_b128 v[120:123], v21 offset:26624
    v_mfma_f32_16x16x32_bf16 v[32:35], v[72:75], v[124:127], v[32:35]
    buffer_load_dwordx4 v[188:191], v16, s[4:7], s32 offen offset:0 sc1
    v_mfma_f32_16x16x32_bf16 v[56:59], v[76:79], v[128:131], v[56:59]
    v_mfma_f32_16x16x32_bf16 v[36:39], v[76:79], v[124:127], v[36:39]
    buffer_load_dwordx4 v[192:195], v17, s[4:7], s32 offen offset:0 sc1
    v_mfma_f32_16x16x32_bf16 v[60:63], v[80:83], v[128:131], v[60:63]
    v_mfma_f32_16x16x32_bf16 v[40:43], v[80:83], v[124:127], v[40:43]
    s_waitcnt vmcnt(14) lgkmcnt(5)
    v_mfma_f32_16x16x32_bf16 v[44:47], v[84:87], v[136:139], v[44:47]
    ds_read_b128 v[64:67], v13 offset:27648
    v_mfma_f32_16x16x32_bf16 v[24:27], v[84:87], v[132:135], v[24:27]
    ds_read_b128 v[68:71], v13 offset:28672
    v_mfma_f32_16x16x32_bf16 v[48:51], v[88:91], v[136:139], v[48:51]
    ds_read_b128 v[72:75], v13 offset:29696
    v_mfma_f32_16x16x32_bf16 v[28:31], v[88:91], v[132:135], v[28:31]
    ds_read_b128 v[76:79], v13 offset:30720
    v_mfma_f32_16x16x32_bf16 v[52:55], v[92:95], v[136:139], v[52:55]
    ds_read_b128 v[80:83], v21 offset:35840
    v_mfma_f32_16x16x32_bf16 v[32:35], v[92:95], v[132:135], v[32:35]
    buffer_load_dwordx4 v[196:199], v16, s[4:7], s32 offen offset:2048 sc1
    v_mfma_f32_16x16x32_bf16 v[56:59], v[96:99], v[136:139], v[56:59]
    v_mfma_f32_16x16x32_bf16 v[36:39], v[96:99], v[132:135], v[36:39]
    buffer_load_dwordx4 v[200:203], v17, s[4:7], s32 offen offset:2048 sc1
    v_mfma_f32_16x16x32_bf16 v[60:63], v[100:103], v[136:139], v[60:63]
    v_mfma_f32_16x16x32_bf16 v[40:43], v[100:103], v[132:135], v[40:43]
    s_waitcnt vmcnt(14) lgkmcnt(0)
    s_barrier
    v_mfma_f32_16x16x32_bf16 v[44:47], v[104:107], v[144:147], v[44:47]
    ds_read_b128 v[84:87], v14 offset:0
    v_mfma_f32_16x16x32_bf16 v[24:27], v[104:107], v[140:143], v[24:27]
    ds_read_b128 v[88:91], v14 offset:1024
    v_mfma_f32_16x16x32_bf16 v[48:51], v[108:111], v[144:147], v[48:51]
    ds_read_b128 v[92:95], v14 offset:2048
    v_mfma_f32_16x16x32_bf16 v[28:31], v[108:111], v[140:143], v[28:31]
    ds_read_b128 v[96:99], v14 offset:3072
    v_mfma_f32_16x16x32_bf16 v[52:55], v[112:115], v[144:147], v[52:55]
    ds_read_b128 v[100:103], v22 offset:8192
    v_mfma_f32_16x16x32_bf16 v[32:35], v[112:115], v[140:143], v[32:35]
    buffer_load_dwordx4 v[204:207], v16, s[4:7], s33 offen offset:0 sc1
    v_mfma_f32_16x16x32_bf16 v[56:59], v[116:119], v[144:147], v[56:59]
    v_mfma_f32_16x16x32_bf16 v[36:39], v[116:119], v[140:143], v[36:39]
    buffer_load_dwordx4 v[208:211], v17, s[4:7], s33 offen offset:0 sc1
    v_mfma_f32_16x16x32_bf16 v[60:63], v[120:123], v[144:147], v[60:63]
    v_mfma_f32_16x16x32_bf16 v[40:43], v[120:123], v[140:143], v[40:43]
    s_waitcnt vmcnt(14) lgkmcnt(5)
    v_mfma_f32_16x16x32_bf16 v[44:47], v[64:67], v[152:155], v[44:47]
    ds_read_b128 v[104:107], v14 offset:9216
    v_mfma_f32_16x16x32_bf16 v[24:27], v[64:67], v[148:151], v[24:27]
    ds_read_b128 v[108:111], v14 offset:10240
    v_mfma_f32_16x16x32_bf16 v[48:51], v[68:71], v[152:155], v[48:51]
    ds_read_b128 v[112:115], v14 offset:11264
    v_mfma_f32_16x16x32_bf16 v[28:31], v[68:71], v[148:151], v[28:31]
    ds_read_b128 v[116:119], v14 offset:12288
    v_mfma_f32_16x16x32_bf16 v[52:55], v[72:75], v[152:155], v[52:55]
    ds_read_b128 v[120:123], v22 offset:17408
    v_mfma_f32_16x16x32_bf16 v[32:35], v[72:75], v[148:151], v[32:35]
    buffer_load_dwordx4 v[212:215], v16, s[4:7], s33 offen offset:2048 sc1
    v_mfma_f32_16x16x32_bf16 v[56:59], v[76:79], v[152:155], v[56:59]
    v_mfma_f32_16x16x32_bf16 v[36:39], v[76:79], v[148:151], v[36:39]
    buffer_load_dwordx4 v[216:219], v17, s[4:7], s33 offen offset:2048 sc1
    v_mfma_f32_16x16x32_bf16 v[60:63], v[80:83], v[152:155], v[60:63]
    v_mfma_f32_16x16x32_bf16 v[40:43], v[80:83], v[148:151], v[40:43]
    s_waitcnt vmcnt(14) lgkmcnt(5)
    v_mfma_f32_16x16x32_bf16 v[44:47], v[84:87], v[160:163], v[44:47]
    ds_read_b128 v[64:67], v14 offset:18432
    s_mov_b32 s32, 6
    s_lshl_b32 s32, s32, 13
    s_add_u32 s32, s32, s29
    s_add_u32 s33, s32, 4096
    v_mfma_f32_16x16x32_bf16 v[24:27], v[84:87], v[156:159], v[24:27]
    ds_read_b128 v[68:71], v14 offset:19456
    v_mfma_f32_16x16x32_bf16 v[48:51], v[88:91], v[160:163], v[48:51]
    ds_read_b128 v[72:75], v14 offset:20480
    v_mfma_f32_16x16x32_bf16 v[28:31], v[88:91], v[156:159], v[28:31]
    ds_read_b128 v[76:79], v14 offset:21504
    v_mfma_f32_16x16x32_bf16 v[52:55], v[92:95], v[160:163], v[52:55]
    ds_read_b128 v[80:83], v22 offset:26624
    v_mfma_f32_16x16x32_bf16 v[32:35], v[92:95], v[156:159], v[32:35]
    buffer_load_dwordx4 v[124:127], v16, s[4:7], s32 offen offset:0 sc1
    v_mfma_f32_16x16x32_bf16 v[56:59], v[96:99], v[160:163], v[56:59]
    v_mfma_f32_16x16x32_bf16 v[36:39], v[96:99], v[156:159], v[36:39]
    buffer_load_dwordx4 v[128:131], v17, s[4:7], s32 offen offset:0 sc1
    v_mfma_f32_16x16x32_bf16 v[60:63], v[100:103], v[160:163], v[60:63]
    v_mfma_f32_16x16x32_bf16 v[40:43], v[100:103], v[156:159], v[40:43]
    s_waitcnt vmcnt(14) lgkmcnt(5)
    v_mfma_f32_16x16x32_bf16 v[44:47], v[104:107], v[168:171], v[44:47]
    ds_read_b128 v[84:87], v14 offset:27648
    v_mfma_f32_16x16x32_bf16 v[24:27], v[104:107], v[164:167], v[24:27]
    ds_read_b128 v[88:91], v14 offset:28672
    v_mfma_f32_16x16x32_bf16 v[48:51], v[108:111], v[168:171], v[48:51]
    ds_read_b128 v[92:95], v14 offset:29696
    v_mfma_f32_16x16x32_bf16 v[28:31], v[108:111], v[164:167], v[28:31]
    ds_read_b128 v[96:99], v14 offset:30720
    v_mfma_f32_16x16x32_bf16 v[52:55], v[112:115], v[168:171], v[52:55]
    ds_read_b128 v[100:103], v22 offset:35840
    v_mfma_f32_16x16x32_bf16 v[32:35], v[112:115], v[164:167], v[32:35]
    buffer_load_dwordx4 v[132:135], v16, s[4:7], s32 offen offset:2048 sc1
    v_mfma_f32_16x16x32_bf16 v[56:59], v[116:119], v[168:171], v[56:59]
    v_mfma_f32_16x16x32_bf16 v[36:39], v[116:119], v[164:167], v[36:39]
    buffer_load_dwordx4 v[136:139], v17, s[4:7], s32 offen offset:2048 sc1
    v_mfma_f32_16x16x32_bf16 v[60:63], v[120:123], v[168:171], v[60:63]
    v_mfma_f32_16x16x32_bf16 v[40:43], v[120:123], v[164:167], v[40:43]
    s_waitcnt vmcnt(14) lgkmcnt(0)
    s_barrier
    v_mfma_f32_16x16x32_bf16 v[44:47], v[64:67], v[176:179], v[44:47]
    ds_read_b128 v[104:107], v15 offset:0
    v_mfma_f32_16x16x32_bf16 v[24:27], v[64:67], v[172:175], v[24:27]
    ds_read_b128 v[108:111], v15 offset:1024
    v_mfma_f32_16x16x32_bf16 v[48:51], v[68:71], v[176:179], v[48:51]
    ds_read_b128 v[112:115], v15 offset:2048
    v_mfma_f32_16x16x32_bf16 v[28:31], v[68:71], v[172:175], v[28:31]
    ds_read_b128 v[116:119], v15 offset:3072
    v_mfma_f32_16x16x32_bf16 v[52:55], v[72:75], v[176:179], v[52:55]
    ds_read_b128 v[120:123], v23 offset:8192
    v_mfma_f32_16x16x32_bf16 v[32:35], v[72:75], v[172:175], v[32:35]
    buffer_load_dwordx4 v[140:143], v16, s[4:7], s33 offen offset:0 sc1
    v_mfma_f32_16x16x32_bf16 v[56:59], v[76:79], v[176:179], v[56:59]
    v_mfma_f32_16x16x32_bf16 v[36:39], v[76:79], v[172:175], v[36:39]
    buffer_load_dwordx4 v[144:147], v17, s[4:7], s33 offen offset:0 sc1
    v_mfma_f32_16x16x32_bf16 v[60:63], v[80:83], v[176:179], v[60:63]
    v_mfma_f32_16x16x32_bf16 v[40:43], v[80:83], v[172:175], v[40:43]
    s_waitcnt vmcnt(14) lgkmcnt(5)
    v_mfma_f32_16x16x32_bf16 v[44:47], v[84:87], v[184:187], v[44:47]
    ds_read_b128 v[64:67], v15 offset:9216
    v_mfma_f32_16x16x32_bf16 v[24:27], v[84:87], v[180:183], v[24:27]
    ds_read_b128 v[68:71], v15 offset:10240
    v_mfma_f32_16x16x32_bf16 v[48:51], v[88:91], v[184:187], v[48:51]
    ds_read_b128 v[72:75], v15 offset:11264
    v_mfma_f32_16x16x32_bf16 v[28:31], v[88:91], v[180:183], v[28:31]
    ds_read_b128 v[76:79], v15 offset:12288
    v_mfma_f32_16x16x32_bf16 v[52:55], v[92:95], v[184:187], v[52:55]
    ds_read_b128 v[80:83], v23 offset:17408
    v_mfma_f32_16x16x32_bf16 v[32:35], v[92:95], v[180:183], v[32:35]
    buffer_load_dwordx4 v[148:151], v16, s[4:7], s33 offen offset:2048 sc1
    v_mfma_f32_16x16x32_bf16 v[56:59], v[96:99], v[184:187], v[56:59]
    v_mfma_f32_16x16x32_bf16 v[36:39], v[96:99], v[180:183], v[36:39]
    buffer_load_dwordx4 v[152:155], v17, s[4:7], s33 offen offset:2048 sc1
    v_mfma_f32_16x16x32_bf16 v[60:63], v[100:103], v[184:187], v[60:63]
    v_mfma_f32_16x16x32_bf16 v[40:43], v[100:103], v[180:183], v[40:43]
    s_waitcnt vmcnt(14) lgkmcnt(5)
    v_mfma_f32_16x16x32_bf16 v[44:47], v[104:107], v[192:195], v[44:47]
    ds_read_b128 v[84:87], v15 offset:18432
    s_mov_b32 s32, 7
    s_lshl_b32 s32, s32, 13
    s_add_u32 s32, s32, s29
    s_add_u32 s33, s32, 4096
    v_mfma_f32_16x16x32_bf16 v[24:27], v[104:107], v[188:191], v[24:27]
    ds_read_b128 v[88:91], v15 offset:19456
    v_mfma_f32_16x16x32_bf16 v[48:51], v[108:111], v[192:195], v[48:51]
    ds_read_b128 v[92:95], v15 offset:20480
    v_mfma_f32_16x16x32_bf16 v[28:31], v[108:111], v[188:191], v[28:31]
    ds_read_b128 v[96:99], v15 offset:21504
    v_mfma_f32_16x16x32_bf16 v[52:55], v[112:115], v[192:195], v[52:55]
    ds_read_b128 v[100:103], v23 offset:26624
    v_mfma_f32_16x16x32_bf16 v[32:35], v[112:115], v[188:191], v[32:35]
    buffer_load_dwordx4 v[156:159], v16, s[4:7], s32 offen offset:0 sc1
    v_mfma_f32_16x16x32_bf16 v[56:59], v[116:119], v[192:195], v[56:59]
    v_mfma_f32_16x16x32_bf16 v[36:39], v[116:119], v[188:191], v[36:39]
    buffer_load_dwordx4 v[160:163], v17, s[4:7], s32 offen offset:0 sc1
    v_mfma_f32_16x16x32_bf16 v[60:63], v[120:123], v[192:195], v[60:63]
    v_mfma_f32_16x16x32_bf16 v[40:43], v[120:123], v[188:191], v[40:43]
    s_waitcnt vmcnt(14) lgkmcnt(5)
    v_mfma_f32_16x16x32_bf16 v[44:47], v[64:67], v[200:203], v[44:47]
    ds_read_b128 v[104:107], v15 offset:27648
    v_mfma_f32_16x16x32_bf16 v[24:27], v[64:67], v[196:199], v[24:27]
    ds_read_b128 v[108:111], v15 offset:28672
    v_mfma_f32_16x16x32_bf16 v[48:51], v[68:71], v[200:203], v[48:51]
    ds_read_b128 v[112:115], v15 offset:29696
    v_mfma_f32_16x16x32_bf16 v[28:31], v[68:71], v[196:199], v[28:31]
    ds_read_b128 v[116:119], v15 offset:30720
    v_mfma_f32_16x16x32_bf16 v[52:55], v[72:75], v[200:203], v[52:55]
    ds_read_b128 v[120:123], v23 offset:35840
    v_mfma_f32_16x16x32_bf16 v[32:35], v[72:75], v[196:199], v[32:35]
    buffer_load_dwordx4 v[164:167], v16, s[4:7], s32 offen offset:2048 sc1
    v_mfma_f32_16x16x32_bf16 v[56:59], v[76:79], v[200:203], v[56:59]
    v_mfma_f32_16x16x32_bf16 v[36:39], v[76:79], v[196:199], v[36:39]
    buffer_load_dwordx4 v[168:171], v17, s[4:7], s32 offen offset:2048 sc1
    v_mfma_f32_16x16x32_bf16 v[60:63], v[80:83], v[200:203], v[60:63]
    v_mfma_f32_16x16x32_bf16 v[40:43], v[80:83], v[196:199], v[40:43]
    s_waitcnt vmcnt(14) lgkmcnt(0)
    s_barrier
    v_mfma_f32_16x16x32_bf16 v[44:47], v[84:87], v[208:211], v[44:47]
    ds_read_b128 v[64:67], v12 offset:0
    v_mfma_f32_16x16x32_bf16 v[24:27], v[84:87], v[204:207], v[24:27]
    ds_read_b128 v[68:71], v12 offset:1024
    v_mfma_f32_16x16x32_bf16 v[48:51], v[88:91], v[208:211], v[48:51]
    ds_read_b128 v[72:75], v12 offset:2048
    v_mfma_f32_16x16x32_bf16 v[28:31], v[88:91], v[204:207], v[28:31]
    ds_read_b128 v[76:79], v12 offset:3072
    v_mfma_f32_16x16x32_bf16 v[52:55], v[92:95], v[208:211], v[52:55]
    ds_read_b128 v[80:83], v20 offset:8192
    v_mfma_f32_16x16x32_bf16 v[32:35], v[92:95], v[204:207], v[32:35]
    buffer_load_dwordx4 v[172:175], v16, s[4:7], s33 offen offset:0 sc1
    v_mfma_f32_16x16x32_bf16 v[56:59], v[96:99], v[208:211], v[56:59]
    v_mfma_f32_16x16x32_bf16 v[36:39], v[96:99], v[204:207], v[36:39]
    buffer_load_dwordx4 v[176:179], v17, s[4:7], s33 offen offset:0 sc1
    v_mfma_f32_16x16x32_bf16 v[60:63], v[100:103], v[208:211], v[60:63]
    v_mfma_f32_16x16x32_bf16 v[40:43], v[100:103], v[204:207], v[40:43]
    s_waitcnt vmcnt(14) lgkmcnt(5)
    v_mfma_f32_16x16x32_bf16 v[44:47], v[104:107], v[216:219], v[44:47]
    ds_read_b128 v[84:87], v12 offset:9216
    v_mfma_f32_16x16x32_bf16 v[24:27], v[104:107], v[212:215], v[24:27]
    ds_read_b128 v[88:91], v12 offset:10240
    v_mfma_f32_16x16x32_bf16 v[48:51], v[108:111], v[216:219], v[48:51]
    ds_read_b128 v[92:95], v12 offset:11264
    v_mfma_f32_16x16x32_bf16 v[28:31], v[108:111], v[212:215], v[28:31]
    ds_read_b128 v[96:99], v12 offset:12288
    v_mfma_f32_16x16x32_bf16 v[52:55], v[112:115], v[216:219], v[52:55]
    ds_read_b128 v[100:103], v20 offset:17408
    v_mfma_f32_16x16x32_bf16 v[32:35], v[112:115], v[212:215], v[32:35]
    buffer_load_dwordx4 v[180:183], v16, s[4:7], s33 offen offset:2048 sc1
    v_mfma_f32_16x16x32_bf16 v[56:59], v[116:119], v[216:219], v[56:59]
    v_mfma_f32_16x16x32_bf16 v[36:39], v[116:119], v[212:215], v[36:39]
    buffer_load_dwordx4 v[184:187], v17, s[4:7], s33 offen offset:2048 sc1
    v_mfma_f32_16x16x32_bf16 v[60:63], v[120:123], v[216:219], v[60:63]
    v_mfma_f32_16x16x32_bf16 v[40:43], v[120:123], v[212:215], v[40:43]
    s_waitcnt vmcnt(14) lgkmcnt(5)
    v_mfma_f32_16x16x32_bf16 v[44:47], v[64:67], v[128:131], v[44:47]
    ds_read_b128 v[104:107], v12 offset:18432
    s_mov_b32 s32, 8
    s_lshl_b32 s32, s32, 13
    s_add_u32 s32, s32, s29
    s_add_u32 s33, s32, 4096
    v_mfma_f32_16x16x32_bf16 v[24:27], v[64:67], v[124:127], v[24:27]
    ds_read_b128 v[108:111], v12 offset:19456
    v_mfma_f32_16x16x32_bf16 v[48:51], v[68:71], v[128:131], v[48:51]
    ds_read_b128 v[112:115], v12 offset:20480
    v_mfma_f32_16x16x32_bf16 v[28:31], v[68:71], v[124:127], v[28:31]
    ds_read_b128 v[116:119], v12 offset:21504
    v_mfma_f32_16x16x32_bf16 v[52:55], v[72:75], v[128:131], v[52:55]
    ds_read_b128 v[120:123], v20 offset:26624
    v_mfma_f32_16x16x32_bf16 v[32:35], v[72:75], v[124:127], v[32:35]
    buffer_load_dwordx4 v[188:191], v18, s[4:7], s32 offen offset:0 sc1
    v_mfma_f32_16x16x32_bf16 v[56:59], v[76:79], v[128:131], v[56:59]
    v_mfma_f32_16x16x32_bf16 v[36:39], v[76:79], v[124:127], v[36:39]
    buffer_load_dwordx4 v[192:195], v19, s[4:7], s32 offen offset:0 sc1
    v_mfma_f32_16x16x32_bf16 v[60:63], v[80:83], v[128:131], v[60:63]
    v_mfma_f32_16x16x32_bf16 v[40:43], v[80:83], v[124:127], v[40:43]
    s_waitcnt vmcnt(14) lgkmcnt(5)
    v_mfma_f32_16x16x32_bf16 v[44:47], v[84:87], v[136:139], v[44:47]
    ds_read_b128 v[64:67], v12 offset:27648
    v_mfma_f32_16x16x32_bf16 v[24:27], v[84:87], v[132:135], v[24:27]
    ds_read_b128 v[68:71], v12 offset:28672
    v_mfma_f32_16x16x32_bf16 v[48:51], v[88:91], v[136:139], v[48:51]
    ds_read_b128 v[72:75], v12 offset:29696
    v_mfma_f32_16x16x32_bf16 v[28:31], v[88:91], v[132:135], v[28:31]
    ds_read_b128 v[76:79], v12 offset:30720
    v_mfma_f32_16x16x32_bf16 v[52:55], v[92:95], v[136:139], v[52:55]
    ds_read_b128 v[80:83], v20 offset:35840
    v_mfma_f32_16x16x32_bf16 v[32:35], v[92:95], v[132:135], v[32:35]
    buffer_load_dwordx4 v[196:199], v18, s[4:7], s32 offen offset:2048 sc1
    v_mfma_f32_16x16x32_bf16 v[56:59], v[96:99], v[136:139], v[56:59]
    v_mfma_f32_16x16x32_bf16 v[36:39], v[96:99], v[132:135], v[36:39]
    buffer_load_dwordx4 v[200:203], v19, s[4:7], s32 offen offset:2048 sc1
    v_mfma_f32_16x16x32_bf16 v[60:63], v[100:103], v[136:139], v[60:63]
    v_mfma_f32_16x16x32_bf16 v[40:43], v[100:103], v[132:135], v[40:43]
    s_waitcnt vmcnt(14) lgkmcnt(0)
    s_barrier
    v_mfma_f32_16x16x32_bf16 v[44:47], v[104:107], v[144:147], v[44:47]
    ds_read_b128 v[84:87], v13 offset:0
    v_mfma_f32_16x16x32_bf16 v[24:27], v[104:107], v[140:143], v[24:27]
    ds_read_b128 v[88:91], v13 offset:1024
    v_mfma_f32_16x16x32_bf16 v[48:51], v[108:111], v[144:147], v[48:51]
    ds_read_b128 v[92:95], v13 offset:2048
    v_mfma_f32_16x16x32_bf16 v[28:31], v[108:111], v[140:143], v[28:31]
    ds_read_b128 v[96:99], v13 offset:3072
    v_mfma_f32_16x16x32_bf16 v[52:55], v[112:115], v[144:147], v[52:55]
    ds_read_b128 v[100:103], v21 offset:8192
    v_mfma_f32_16x16x32_bf16 v[32:35], v[112:115], v[140:143], v[32:35]
    buffer_load_dwordx4 v[204:207], v18, s[4:7], s33 offen offset:0 sc1
    v_mfma_f32_16x16x32_bf16 v[56:59], v[116:119], v[144:147], v[56:59]
    v_mfma_f32_16x16x32_bf16 v[36:39], v[116:119], v[140:143], v[36:39]
    buffer_load_dwordx4 v[208:211], v19, s[4:7], s33 offen offset:0 sc1
    v_mfma_f32_16x16x32_bf16 v[60:63], v[120:123], v[144:147], v[60:63]
    v_mfma_f32_16x16x32_bf16 v[40:43], v[120:123], v[140:143], v[40:43]
    s_waitcnt vmcnt(14) lgkmcnt(5)
    v_mfma_f32_16x16x32_bf16 v[44:47], v[64:67], v[152:155], v[44:47]
    ds_read_b128 v[104:107], v13 offset:9216
    v_mfma_f32_16x16x32_bf16 v[24:27], v[64:67], v[148:151], v[24:27]
    ds_read_b128 v[108:111], v13 offset:10240
    v_mfma_f32_16x16x32_bf16 v[48:51], v[68:71], v[152:155], v[48:51]
    ds_read_b128 v[112:115], v13 offset:11264
    v_mfma_f32_16x16x32_bf16 v[28:31], v[68:71], v[148:151], v[28:31]
    ds_read_b128 v[116:119], v13 offset:12288
    v_mfma_f32_16x16x32_bf16 v[52:55], v[72:75], v[152:155], v[52:55]
    ds_read_b128 v[120:123], v21 offset:17408
    v_mfma_f32_16x16x32_bf16 v[32:35], v[72:75], v[148:151], v[32:35]
    buffer_load_dwordx4 v[212:215], v18, s[4:7], s33 offen offset:2048 sc1
    v_mfma_f32_16x16x32_bf16 v[56:59], v[76:79], v[152:155], v[56:59]
    v_mfma_f32_16x16x32_bf16 v[36:39], v[76:79], v[148:151], v[36:39]
    buffer_load_dwordx4 v[216:219], v19, s[4:7], s33 offen offset:2048 sc1
    v_mfma_f32_16x16x32_bf16 v[60:63], v[80:83], v[152:155], v[60:63]
    v_mfma_f32_16x16x32_bf16 v[40:43], v[80:83], v[148:151], v[40:43]
    s_waitcnt vmcnt(14) lgkmcnt(5)
    v_mfma_f32_16x16x32_bf16 v[44:47], v[84:87], v[160:163], v[44:47]
    ds_read_b128 v[64:67], v13 offset:18432
    v_mfma_f32_16x16x32_bf16 v[24:27], v[84:87], v[156:159], v[24:27]
    ds_read_b128 v[68:71], v13 offset:19456
    v_mfma_f32_16x16x32_bf16 v[48:51], v[88:91], v[160:163], v[48:51]
    ds_read_b128 v[72:75], v13 offset:20480
    v_mfma_f32_16x16x32_bf16 v[28:31], v[88:91], v[156:159], v[28:31]
    ds_read_b128 v[76:79], v13 offset:21504
    v_mfma_f32_16x16x32_bf16 v[52:55], v[92:95], v[160:163], v[52:55]
    ds_read_b128 v[80:83], v21 offset:26624
    v_mfma_f32_16x16x32_bf16 v[32:35], v[92:95], v[156:159], v[32:35]
    v_mfma_f32_16x16x32_bf16 v[56:59], v[96:99], v[160:163], v[56:59]
    v_mfma_f32_16x16x32_bf16 v[36:39], v[96:99], v[156:159], v[36:39]
    v_mfma_f32_16x16x32_bf16 v[60:63], v[100:103], v[160:163], v[60:63]
    v_mfma_f32_16x16x32_bf16 v[40:43], v[100:103], v[156:159], v[40:43]
    s_waitcnt vmcnt(12) lgkmcnt(5)
    v_mfma_f32_16x16x32_bf16 v[44:47], v[104:107], v[168:171], v[44:47]
    ds_read_b128 v[84:87], v13 offset:27648
    v_mfma_f32_16x16x32_bf16 v[24:27], v[104:107], v[164:167], v[24:27]
    ds_read_b128 v[88:91], v13 offset:28672
    v_mfma_f32_16x16x32_bf16 v[48:51], v[108:111], v[168:171], v[48:51]
    ds_read_b128 v[92:95], v13 offset:29696
    v_mfma_f32_16x16x32_bf16 v[28:31], v[108:111], v[164:167], v[28:31]
    ds_read_b128 v[96:99], v13 offset:30720
    v_mfma_f32_16x16x32_bf16 v[52:55], v[112:115], v[168:171], v[52:55]
    ds_read_b128 v[100:103], v21 offset:35840
    v_mfma_f32_16x16x32_bf16 v[32:35], v[112:115], v[164:167], v[32:35]
    v_mfma_f32_16x16x32_bf16 v[56:59], v[116:119], v[168:171], v[56:59]
    v_mfma_f32_16x16x32_bf16 v[36:39], v[116:119], v[164:167], v[36:39]
    v_mfma_f32_16x16x32_bf16 v[60:63], v[120:123], v[168:171], v[60:63]
    v_mfma_f32_16x16x32_bf16 v[40:43], v[120:123], v[164:167], v[40:43]
    s_waitcnt vmcnt(10) lgkmcnt(0)
    s_barrier
    v_mfma_f32_16x16x32_bf16 v[44:47], v[64:67], v[176:179], v[44:47]
    ds_read_b128 v[104:107], v14 offset:0
    v_mfma_f32_16x16x32_bf16 v[24:27], v[64:67], v[172:175], v[24:27]
    ds_read_b128 v[108:111], v14 offset:1024
    v_mfma_f32_16x16x32_bf16 v[48:51], v[68:71], v[176:179], v[48:51]
    ds_read_b128 v[112:115], v14 offset:2048
    v_mfma_f32_16x16x32_bf16 v[28:31], v[68:71], v[172:175], v[28:31]
    ds_read_b128 v[116:119], v14 offset:3072
    v_mfma_f32_16x16x32_bf16 v[52:55], v[72:75], v[176:179], v[52:55]
    ds_read_b128 v[120:123], v22 offset:8192
    v_mfma_f32_16x16x32_bf16 v[32:35], v[72:75], v[172:175], v[32:35]
    v_mfma_f32_16x16x32_bf16 v[56:59], v[76:79], v[176:179], v[56:59]
    v_mfma_f32_16x16x32_bf16 v[36:39], v[76:79], v[172:175], v[36:39]
    v_mfma_f32_16x16x32_bf16 v[60:63], v[80:83], v[176:179], v[60:63]
    v_mfma_f32_16x16x32_bf16 v[40:43], v[80:83], v[172:175], v[40:43]
    s_waitcnt vmcnt(8) lgkmcnt(5)
    v_mfma_f32_16x16x32_bf16 v[44:47], v[84:87], v[184:187], v[44:47]
    ds_read_b128 v[64:67], v14 offset:9216
    v_mfma_f32_16x16x32_bf16 v[24:27], v[84:87], v[180:183], v[24:27]
    ds_read_b128 v[68:71], v14 offset:10240
    v_mfma_f32_16x16x32_bf16 v[48:51], v[88:91], v[184:187], v[48:51]
    ds_read_b128 v[72:75], v14 offset:11264
    v_mfma_f32_16x16x32_bf16 v[28:31], v[88:91], v[180:183], v[28:31]
    ds_read_b128 v[76:79], v14 offset:12288
    v_mfma_f32_16x16x32_bf16 v[52:55], v[92:95], v[184:187], v[52:55]
    ds_read_b128 v[80:83], v22 offset:17408
    v_mfma_f32_16x16x32_bf16 v[32:35], v[92:95], v[180:183], v[32:35]
    s_waitcnt vmcnt(6)
    v_mfma_f32_16x16x32_bf16 v[56:59], v[96:99], v[184:187], v[56:59]
    v_swap_b32 v190, v192
    v_mfma_f32_16x16x32_bf16 v[36:39], v[96:99], v[180:183], v[36:39]
    v_swap_b32 v191, v193
    v_mfma_f32_16x16x32_bf16 v[60:63], v[100:103], v[184:187], v[60:63]
    v_mfma_f32_16x16x32_bf16 v[40:43], v[100:103], v[180:183], v[40:43]
    s_waitcnt vmcnt(6) lgkmcnt(5)
    v_mfma_f32_16x16x32_bf16 v[44:47], v[104:107], v[192:195], v[44:47]
    ds_read_b128 v[84:87], v14 offset:18432
    v_mfma_f32_16x16x32_bf16 v[24:27], v[104:107], v[188:191], v[24:27]
    ds_read_b128 v[88:91], v14 offset:19456
    v_mfma_f32_16x16x32_bf16 v[48:51], v[108:111], v[192:195], v[48:51]
    ds_read_b128 v[92:95], v14 offset:20480
    v_mfma_f32_16x16x32_bf16 v[28:31], v[108:111], v[188:191], v[28:31]
    ds_read_b128 v[96:99], v14 offset:21504
    v_mfma_f32_16x16x32_bf16 v[52:55], v[112:115], v[192:195], v[52:55]
    ds_read_b128 v[100:103], v22 offset:26624
    v_mfma_f32_16x16x32_bf16 v[32:35], v[112:115], v[188:191], v[32:35]
    s_waitcnt vmcnt(4)
    v_mfma_f32_16x16x32_bf16 v[56:59], v[116:119], v[192:195], v[56:59]
    v_swap_b32 v198, v200
    v_mfma_f32_16x16x32_bf16 v[36:39], v[116:119], v[188:191], v[36:39]
    v_swap_b32 v199, v201
    v_mfma_f32_16x16x32_bf16 v[60:63], v[120:123], v[192:195], v[60:63]
    v_mfma_f32_16x16x32_bf16 v[40:43], v[120:123], v[188:191], v[40:43]
    s_waitcnt vmcnt(4) lgkmcnt(5)
    v_mfma_f32_16x16x32_bf16 v[44:47], v[64:67], v[200:203], v[44:47]
    ds_read_b128 v[104:107], v14 offset:27648
    v_mfma_f32_16x16x32_bf16 v[24:27], v[64:67], v[196:199], v[24:27]
    ds_read_b128 v[108:111], v14 offset:28672
    v_mfma_f32_16x16x32_bf16 v[48:51], v[68:71], v[200:203], v[48:51]
    ds_read_b128 v[112:115], v14 offset:29696
    v_mfma_f32_16x16x32_bf16 v[28:31], v[68:71], v[196:199], v[28:31]
    ds_read_b128 v[116:119], v14 offset:30720
    v_mfma_f32_16x16x32_bf16 v[52:55], v[72:75], v[200:203], v[52:55]
    ds_read_b128 v[120:123], v22 offset:35840
    v_mfma_f32_16x16x32_bf16 v[32:35], v[72:75], v[196:199], v[32:35]
    s_waitcnt vmcnt(2)
    v_mfma_f32_16x16x32_bf16 v[56:59], v[76:79], v[200:203], v[56:59]
    v_swap_b32 v206, v208
    v_mfma_f32_16x16x32_bf16 v[36:39], v[76:79], v[196:199], v[36:39]
    v_swap_b32 v207, v209
    v_mfma_f32_16x16x32_bf16 v[60:63], v[80:83], v[200:203], v[60:63]
    v_mfma_f32_16x16x32_bf16 v[40:43], v[80:83], v[196:199], v[40:43]
    s_waitcnt vmcnt(2) lgkmcnt(5)
    v_mfma_f32_16x16x32_bf16 v[44:47], v[84:87], v[208:211], v[44:47]
    v_mfma_f32_16x16x32_bf16 v[24:27], v[84:87], v[204:207], v[24:27]
    v_mfma_f32_16x16x32_bf16 v[48:51], v[88:91], v[208:211], v[48:51]
    v_mfma_f32_16x16x32_bf16 v[28:31], v[88:91], v[204:207], v[28:31]
    v_mfma_f32_16x16x32_bf16 v[52:55], v[92:95], v[208:211], v[52:55]
    v_mfma_f32_16x16x32_bf16 v[32:35], v[92:95], v[204:207], v[32:35]
    s_waitcnt vmcnt(0)
    v_mfma_f32_16x16x32_bf16 v[56:59], v[96:99], v[208:211], v[56:59]
    v_swap_b32 v214, v216
    v_mfma_f32_16x16x32_bf16 v[36:39], v[96:99], v[204:207], v[36:39]
    v_swap_b32 v215, v217
    v_mfma_f32_16x16x32_bf16 v[60:63], v[100:103], v[208:211], v[60:63]
    v_mfma_f32_16x16x32_bf16 v[40:43], v[100:103], v[204:207], v[40:43]
    s_waitcnt vmcnt(0) lgkmcnt(0)
    v_mfma_f32_16x16x32_bf16 v[44:47], v[104:107], v[216:219], v[44:47]
    v_mfma_f32_16x16x32_bf16 v[48:51], v[108:111], v[216:219], v[48:51]
    v_mfma_f32_16x16x32_bf16 v[52:55], v[112:115], v[216:219], v[52:55]
    v_mfma_f32_16x16x32_bf16 v[56:59], v[116:119], v[216:219], v[56:59]
    v_mfma_f32_16x16x32_bf16 v[60:63], v[120:123], v[216:219], v[60:63]
    v_mfma_f32_16x16x32_bf16 v[24:27], v[104:107], v[212:215], v[24:27]
    v_mfma_f32_16x16x32_bf16 v[28:31], v[108:111], v[212:215], v[28:31]
    v_mfma_f32_16x16x32_bf16 v[32:35], v[112:115], v[212:215], v[32:35]
    v_mfma_f32_16x16x32_bf16 v[36:39], v[116:119], v[212:215], v[36:39]
    v_mfma_f32_16x16x32_bf16 v[40:43], v[120:123], v[212:215], v[40:43]
    ds_write_b128 v2, v[44:47] offset:0
    ds_write_b128 v2, v[48:51] offset:1024
    ds_write_b128 v2, v[52:55] offset:2048
    ds_write_b128 v2, v[56:59] offset:3072
    s_mov_b64 exec, s[40:41]
    ds_write_b128 v3, v[60:63] offset:4096
    s_mov_b64 exec, -1
    ds_write_b32 v0, v9
    s_mov_b32 s60, 1048576
L_px_p5:
    ds_read_b32 v232, v6
    ds_read_b128 v[64:67], v7 offset:0
    ds_read_b128 v[68:71], v7 offset:1024
    ds_read_b128 v[72:75], v7 offset:2048
    ds_read_b128 v[76:79], v7 offset:3072
    ds_read_b128 v[80:83], v8 offset:4096
    s_waitcnt lgkmcnt(5)
    v_cmp_ne_u32 vcc, s43, v232
    s_sub_u32 s60, s60, 1
    s_cbranch_scc1 L_py_p5
    s_cbranch_vccnz L_px_p5
L_py_p5:
    s_waitcnt lgkmcnt(4)
    v_pk_add_f32 v[24:25], v[24:25], v[64:65]
    v_pk_add_f32 v[26:27], v[26:27], v[66:67]
    v_cvt_pk_bf16_f32 v220, v24, v25
    v_cvt_pk_bf16_f32 v221, v26, v27
    s_waitcnt lgkmcnt(3)
    v_pk_add_f32 v[28:29], v[28:29], v[68:69]
    v_pk_add_f32 v[30:31], v[30:31], v[70:71]
    v_cvt_pk_bf16_f32 v222, v28, v29
    v_cvt_pk_bf16_f32 v223, v30, v31
    s_waitcnt lgkmcnt(2)
    v_pk_add_f32 v[32:33], v[32:33], v[72:73]
    v_pk_add_f32 v[34:35], v[34:35], v[74:75]
    v_cvt_pk_bf16_f32 v224, v32, v33
    v_cvt_pk_bf16_f32 v225, v34, v35
    s_waitcnt lgkmcnt(1)
    v_pk_add_f32 v[36:37], v[36:37], v[76:77]
    v_pk_add_f32 v[38:39], v[38:39], v[78:79]
    v_cvt_pk_bf16_f32 v226, v36, v37
    v_cvt_pk_bf16_f32 v227, v38, v39
    s_waitcnt lgkmcnt(0)
    v_pk_add_f32 v[40:41], v[40:41], v[80:81]
    v_pk_add_f32 v[42:43], v[42:43], v[82:83]
    v_cvt_pk_bf16_f32 v228, v40, v41
    v_cvt_pk_bf16_f32 v229, v42, v43
    s_cmp_eq_u32 s22, 1
    s_cbranch_scc1 L_fin_p5
    buffer_store_dwordx4 v[220:223], v4, s[4:7], s34 offen offset:0 sc1
    buffer_store_dwordx4 v[224:227], v4, s[4:7], s34 offen offset:1024 sc1
    buffer_store_dwordx2 v[228:229], v5, s[4:7], s34 offen sc1
    v_cndmask_b32 v234, 0, v228, s[40:41]
    v_cndmask_b32 v235, 0, v229, s[40:41]
    v_dot2_f32_bf16 v232, v220, v11, 0
    v_dot2_f32_bf16 v233, v220, v220, 0
    v_dot2_f32_bf16 v232, v221, v11, v232
    v_dot2_f32_bf16 v233, v221, v221, v233
    v_dot2_f32_bf16 v232, v222, v11, v232
    v_dot2_f32_bf16 v233, v222, v222, v233
    v_dot2_f32_bf16 v232, v223, v11, v232
    v_dot2_f32_bf16 v233, v223, v223, v233
    v_dot2_f32_bf16 v232, v224, v11, v232
    v_dot2_f32_bf16 v233, v224, v224, v233
    v_dot2_f32_bf16 v232, v225, v11, v232
    v_dot2_f32_bf16 v233, v225, v225, v233
    v_dot2_f32_bf16 v232, v226, v11, v232
    v_dot2_f32_bf16 v233, v226, v226, v233
    v_dot2_f32_bf16 v232, v227, v11, v232
    v_dot2_f32_bf16 v233, v227, v227, v233
    v_dot2_f32_bf16 v232, v234, v11, v232
    v_dot2_f32_bf16 v233, v234, v234, v233
    v_dot2_f32_bf16 v232, v235, v11, v232
    v_dot2_f32_bf16 v233, v235, v235, v233
    s_nop 2
    v_mov_b32 v234, v232
    v_mov_b32 v235, v233
    s_nop 1
    v_permlane32_swap_b32 v232, v234
    v_permlane32_swap_b32 v233, v235
    v_add_f32 v232, v232, v234
    v_add_f32 v233, v233, v235
    v_mov_b32 v234, v232
    v_mov_b32 v235, v233
    s_nop 1
    v_permlane16_swap_b32 v232, v234
    v_permlane16_swap_b32 v233, v235
    v_add_f32 v232, v232, v234
    v_add_f32 v233, v233, v235
    buffer_store_dwordx2 v[232:233], v10, s[4:7], s39 offen sc1
    s_barrier
    s_mov_b32 s22, 1
    s_mov_b32 s21, 0x1c00000
    s_branch L_m_cl
L_fin_p5:
    buffer_store_dwordx4 v[220:223], v4, s[16:19], s34 offen offset:0
    buffer_store_dwordx4 v[224:227], v4, s[16:19], s34 offen offset:64
    buffer_store_dwordx2 v[228:229], v5, s[16:19], s34 offen offset:128
    s_endpgm
L_m_l1:
    s_and_b32 s25, s2, 7
    s_lshr_b32 s26, s2, 3
    s_lshr_b32 s23, s25, 1
    s_lshl_b32 s23, s23, 2
    s_lshr_b32 s27, s26, 3
    s_add_u32 s23, s23, s27
    s_and_b32 s24, s25, 1
    s_lshl_b32 s24, s24, 3
    s_and_b32 s27, s26, 7
    s_add_u32 s24, s24, s27
    s_mul_i32 s29, s24, 129024
    s_lshl_b32 s30, s20, 12
    s_add_u32 s29, s29, s30
    s_add_u32 s29, s29, 0x3800000
    s_lshl_b32 s31, s23, 3
    s_max_u32 s31, s31, 1
    s_sub_u32 s31, s31, 1
    s_mul_i32 s31, s31, 18432
    s_add_u32 s31, s31, 0x0
    s_lshl_b32 s35, s20, 10
    s_and_b32 s36, s35, 1024
    s_barrier
    s_add_u32 m0, s35, 131072
    s_add_u32 s34, s31, s35
    s_add_u32 s34, s34, 0
    buffer_load_dwordx4 v1, s[4:7], s34 offen sc1 lds
    s_add_u32 m0, s30, 0
    s_add_u32 s34, s29, 0
    buffer_load_dwordx4 v1, s[4:7], s34 offen offset:0 sc1 lds
    buffer_load_dwordx4 v1, s[4:7], s34 offen offset:1024 sc1 lds
    buffer_load_dwordx4 v1, s[4:7], s34 offen offset:2048 sc1 lds
    buffer_load_dwordx4 v1, s[4:7], s34 offen offset:3072 sc1 lds
    s_add_u32 m0, s30, 16384
    s_add_u32 s34, s29, 16384
    buffer_load_dwordx4 v1, s[4:7], s34 offen offset:0 sc1 lds
    buffer_load_dwordx4 v1, s[4:7], s34 offen offset:1024 sc1 lds
    buffer_load_dwordx4 v1, s[4:7], s34 offen offset:2048 sc1 lds
    buffer_load_dwordx4 v1, s[4:7], s34 offen offset:3072 sc1 lds
    s_waitcnt vmcnt(4) lgkmcnt(0)
    s_barrier
    s_add_u32 m0, s35, 135168
    s_add_u32 s34, s31, s35
    s_add_u32 s34, s34, 4096
    buffer_load_dwordx4 v1, s[4:7], s34 offen sc1 lds
    s_add_u32 m0, s30, 32768
    s_add_u32 s34, s29, 32768
    buffer_load_dwordx4 v1, s[4:7], s34 offen offset:0 sc1 lds
    buffer_load_dwordx4 v1, s[4:7], s34 offen offset:1024 sc1 lds
    buffer_load_dwordx4 v1, s[4:7], s34 offen offset:2048 sc1 lds
    buffer_load_dwordx4 v1, s[4:7], s34 offen offset:3072 sc1 lds
    s_add_u32 m0, s30, 49152
    s_add_u32 s34, s29, 49152
    buffer_load_dwordx4 v1, s[4:7], s34 offen offset:0 sc1 lds
    buffer_load_dwordx4 v1, s[4:7], s34 offen offset:1024 sc1 lds
    buffer_load_dwordx4 v1, s[4:7], s34 offen offset:2048 sc1 lds
    buffer_load_dwordx4 v1, s[4:7], s34 offen offset:3072 sc1 lds
    s_cmp_lt_u32 s2, 144
    s_cbranch_scc1 L_p0_t1
    s_cmp_ge_u32 s2, 216
    s_cbranch_scc1 L_p0_t2
    ds_read_b64_tr_b16 v[16:17], v4 offset:0
    ds_read_b64_tr_b16 v[18:19], v4 offset:2048
    ds_read_b64_tr_b16 v[20:21], v4 offset:18432
    ds_read_b64_tr_b16 v[22:23], v4 offset:20480
    ds_read_b64_tr_b16 v[24:25], v4 offset:4096
    ds_read_b64_tr_b16 v[26:27], v4 offset:6144
    ds_read_b64_tr_b16 v[28:29], v4 offset:22528
    ds_read_b64_tr_b16 v[30:31], v4 offset:24576
    ds_read_b64_tr_b16 v[32:33], v4 offset:8192
    ds_read_b64_tr_b16 v[34:35], v4 offset:10240
    ds_read_b64_tr_b16 v[36:37], v4 offset:26624
    ds_read_b64_tr_b16 v[38:39], v4 offset:28672
    ds_read_b64_tr_b16 v[40:41], v4 offset:12288
    ds_read_b64_tr_b16 v[42:43], v4 offset:14336
    ds_read_b64_tr_b16 v[44:45], v4 offset:30720
    ds_read_b64_tr_b16 v[46:47], v4 offset:32768
    ds_read_b64_tr_b16 v[48:49], v5 offset:16384
    ds_read_b64_tr_b16 v[50:51], v5 offset:34816
    s_branch L_p0_t2
L_p0_t1:
    ds_read_b64_tr_b16 v[16:17], v4 offset:0
    ds_read_b64_tr_b16 v[18:19], v4 offset:512
    ds_read_b64_tr_b16 v[20:21], v4 offset:4352
    ds_read_b64_tr_b16 v[22:23], v4 offset:4864
    ds_read_b64_tr_b16 v[24:25], v4 offset:9792
    ds_read_b64_tr_b16 v[26:27], v4 offset:10304
    ds_read_b64_tr_b16 v[28:29], v4 offset:14144
    ds_read_b64_tr_b16 v[30:31], v4 offset:14656
    ds_read_b64_tr_b16 v[32:33], v4 offset:19584
    ds_read_b64_tr_b16 v[34:35], v4 offset:20096
    ds_read_b64_tr_b16 v[36:37], v4 offset:23936
    ds_read_b64_tr_b16 v[38:39], v4 offset:24448
    ds_read_b64_tr_b16 v[40:41], v4 offset:29376
    ds_read_b64_tr_b16 v[42:43], v4 offset:29888
    ds_read_b64_tr_b16 v[44:45], v4 offset:33728
    ds_read_b64_tr_b16 v[46:47], v4 offset:34240
    ds_read_b64_tr_b16 v[48:49], v5 offset:8704
    ds_read_b64_tr_b16 v[50:51], v5 offset:9216
L_p0_t2:
    s_waitcnt lgkmcnt(0)
    s_waitcnt vmcnt(9) lgkmcnt(0)
    s_barrier
    s_add_u32 m0, s35, 139264
    s_add_u32 s34, s31, s35
    s_add_u32 s34, s34, 8192
    buffer_load_dwordx4 v1, s[4:7], s34 offen sc1 lds
    v_lshrrev_b32 v2, 8, v1
    v_bfe_u32 v3, v1, 7, 1
    v_bfe_u32 v4, v1, 4, 3
    v_cmp_gt_u32 vcc, 3, v2
    v_mul_u32_u24 v3, 80, v3
    v_lshl_add_u32 v3, v4, 3, v3
    v_lshrrev_b32 v5, 1, v4
    v_and_b32 v4, 1, v4
    v_lshl_add_u32 v4, v4, 3, 64
    v_cndmask_b32 v2, v5, v2, vcc
    v_cndmask_b32 v3, v4, v3, vcc
    v_mul_u32_u24 v2, 2304, v2
    v_add_u32 v0, v2, v3
    v_lshrrev_b32 v8, 1, v1
    s_mul_i32 s34, s24, 144
    s_add_u32 s34, s34, 0x4400000
    buffer_load_dwordx2 v[2:3], v0, s[4:7], s34 offen sc1
    s_mul_i32 s34, s24, 144
    s_add_u32 s34, s34, 0x4402000
    buffer_load_dwordx2 v[4:5], v0, s[4:7], s34 offen sc1
    s_mul_i32 s34, s24, 144
    s_add_u32 s34, s34, 0x4404000
    buffer_load_dwordx2 v[6:7], v0, s[4:7], s34 offen sc1
    s_mul_i32 s34, s24, 144
    s_add_u32 s34, s34, 0x4406000
    buffer_load_dwordx2 v[12:13], v0, s[4:7], s34 offen sc1
    s_add_u32 m0, s30, 65536
    s_add_u32 s34, s29, 65536
    buffer_load_dwordx4 v1, s[4:7], s34 offen offset:0 sc1 lds
    buffer_load_dwordx4 v1, s[4:7], s34 offen offset:1024 sc1 lds
    buffer_load_dwordx4 v1, s[4:7], s34 offen offset:2048 sc1 lds
    buffer_load_dwordx4 v1, s[4:7], s34 offen offset:3072 sc1 lds
    s_waitcnt vmcnt(13) lgkmcnt(0)
    s_barrier
    s_add_u32 m0, s30, 81920
    s_add_u32 s34, s29, 81920
    buffer_load_dwordx4 v1, s[4:7], s34 offen offset:0 sc1 lds
    buffer_load_dwordx4 v1, s[4:7], s34 offen offset:1024 sc1 lds
    buffer_load_dwordx4 v1, s[4:7], s34 offen offset:2048 sc1 lds
    buffer_load_dwordx4 v1, s[4:7], s34 offen offset:3072 sc1 lds
    s_waitcnt vmcnt(13) lgkmcnt(0)
    s_barrier
    s_add_u32 m0, s35, 143360
    s_add_u32 s34, s31, s35
    s_add_u32 s34, s34, 12288
    buffer_load_dwordx4 v1, s[4:7], s34 offen sc1 lds
    s_add_u32 m0, s30, 98304
    s_add_u32 s34, s29, 98304
    buffer_load_dwordx4 v1, s[4:7], s34 offen offset:0 sc1 lds
    buffer_load_dwordx4 v1, s[4:7], s34 offen offset:1024 sc1 lds
    buffer_load_dwordx4 v1, s[4:7], s34 offen offset:2048 sc1 lds
    buffer_load_dwordx4 v1, s[4:7], s34 offen offset:3072 sc1 lds
    s_waitcnt vmcnt(13)
    v_add_f32 v2, v2, v4
    v_add_f32 v3, v3, v5
    v_add_f32 v6, v6, v12
    v_add_f32 v7, v7, v13
    v_add_f32 v2, v2, v6
    v_add_f32 v3, v3, v7
    v_cmp_gt_u32 vcc, 864, v1
    v_add_u32 v8, 161792, v8
    s_nop 0
    v_cndmask_b32 v2, 0, v2, vcc
    v_cndmask_b32 v3, 0, v3, vcc
    ds_write_b64 v8, v[2:3]
    s_waitcnt vmcnt(9) lgkmcnt(0)
    s_barrier
    s_add_u32 m0, s36, 147456
    s_add_u32 s34, s31, s36
    s_add_u32 s34, s34, 16384
    buffer_load_dwordx4 v1, s[4:7], s34 offen sc1 lds
    s_add_u32 m0, s30, 114688
    s_add_u32 s34, s29, 114688
    buffer_load_dwordx4 v1, s[4:7], s34 offen offset:0 sc1 lds
    buffer_load_dwordx4 v1, s[4:7], s34 offen offset:1024 sc1 lds
    buffer_load_dwordx4 v1, s[4:7], s34 offen offset:2048 sc1 lds
    buffer_load_dwordx4 v1, s[4:7], s34 offen offset:3072 sc1 lds
    s_waitcnt vmcnt(10) lgkmcnt(0)
    s_barrier
    buffer_store_dwordx4 v[16:19], v9, s[4:7], s37 offen sc1
    buffer_store_dwordx4 v[20:23], v10, s[4:7], s38 offen sc1
    buffer_store_dwordx4 v[24:27], v9, s[4:7], s39 offen sc1
    buffer_store_dwordx4 v[28:31], v10, s[4:7], s40 offen sc1
    s_waitcnt vmcnt(9) lgkmcnt(0)
    s_barrier
    buffer_store_dwordx4 v[32:35], v9, s[4:7], s41 offen sc1
    buffer_store_dwordx4 v[36:39], v10, s[4:7], s42 offen sc1
    buffer_store_dwordx4 v[40:43], v9, s[4:7], s43 offen sc1
    s_waitcnt vmcnt(7) lgkmcnt(0)
    s_barrier
    s_mov_b32 s46, 0x4502000
    v_mov_b32 v4, 0
    s_mov_b32 s60, 65536
L_poll_wo:
    buffer_load_dword v5, v4, s[4:7], s46 offen sc1
    s_waitcnt vmcnt(0)
    v_cmp_gt_u32 vcc, 18, v5
    s_sub_u32 s60, s60, 1
    s_cbranch_scc1 L_pd_wo
    s_cbranch_vccz L_pd_wo
    s_sleep 4
    s_branch L_poll_wo
L_pd_wo:
    buffer_store_dwordx4 v[44:47], v10, s[4:7], s47 offen sc1
    buffer_store_dwordx4 v[48:51], v14, s[4:7], s48 offen sc1
    v_dot2_f32_bf16 v12, v16, v11, 0
    v_dot2_f32_bf16 v13, v17, v11, 0
    v_dot2_f32_bf16 v12, v18, v11, v12
    v_dot2_f32_bf16 v13, v19, v11, v13
    v_dot2_f32_bf16 v12, v20, v11, v12
    v_dot2_f32_bf16 v13, v21, v11, v13
    v_dot2_f32_bf16 v12, v22, v11, v12
    v_dot2_f32_bf16 v13, v23, v11, v13
    v_dot2_f32_bf16 v12, v24, v11, v12
    v_dot2_f32_bf16 v13, v25, v11, v13
    v_dot2_f32_bf16 v12, v26, v11, v12
    v_dot2_f32_bf16 v13, v27, v11, v13
    v_dot2_f32_bf16 v12, v28, v11, v12
    v_dot2_f32_bf16 v13, v29, v11, v13
    v_dot2_f32_bf16 v12, v30, v11, v12
    v_dot2_f32_bf16 v13, v31, v11, v13
    v_dot2_f32_bf16 v12, v32, v11, v12
    v_dot2_f32_bf16 v13, v33, v11, v13
    v_dot2_f32_bf16 v12, v34, v11, v12
    v_dot2_f32_bf16 v13, v35, v11, v13
    v_dot2_f32_bf16 v12, v36, v11, v12
    v_dot2_f32_bf16 v13, v37, v11, v13
    v_dot2_f32_bf16 v12, v38, v11, v12
    v_dot2_f32_bf16 v13, v39, v11, v13
    v_dot2_f32_bf16 v12, v40, v11, v12
    v_dot2_f32_bf16 v13, v41, v11, v13
    v_dot2_f32_bf16 v12, v42, v11, v12
    v_dot2_f32_bf16 v13, v43, v11, v13
    v_dot2_f32_bf16 v12, v44, v11, v12
    v_dot2_f32_bf16 v13, v45, v11, v13
    v_dot2_f32_bf16 v12, v46, v11, v12
    v_dot2_f32_bf16 v13, v47, v11, v13
    v_dot2_f32_bf16 v12, v48, v11, v12
    v_dot2_f32_bf16 v13, v49, v11, v13
    v_dot2_f32_bf16 v12, v50, v11, v12
    v_dot2_f32_bf16 v13, v51, v11, v13
    s_nop 2
    v_add_f32 v12, v12, v13
    v_mov_b32 v13, v12
    s_nop 1
    v_permlane32_swap_b32 v12, v13
    v_add_f32 v12, v12, v13
    v_mov_b32 v13, v12
    s_nop 1
    v_permlane16_swap_b32 v12, v13
    v_add_f32 v12, v12, v13
    buffer_store_dword v12, v15, s[4:7], s49 offen sc1
    s_barrier
L_m_ll:
    s_and_b32 s25, s2, 7
    s_lshr_b32 s26, s2, 3
    s_lshr_b32 s23, s25, 1
    s_lshl_b32 s23, s23, 3
    s_lshr_b32 s27, s26, 2
    s_add_u32 s23, s23, s27
    s_and_b32 s24, s25, 1
    s_lshl_b32 s24, s24, 2
    s_and_b32 s27, s26, 3
    s_add_u32 s24, s24, s27
    s_add_u32 s25, s23, s24
    s_and_b32 s25, s25, 3
    s_mul_i32 s29, s24, 82944
    s_add_u32 s29, s29, 0x3a00000
    s_mul_i32 s30, s20, 36864
    s_mul_i32 s31, s20, 18432
    s_add_u32 s31, s31, s29
    s_add_u32 m0, s30, 18432
    s_add_u32 s33, s31, 0
    buffer_load_dwordx4 v1, s[4:7], s33 offen offset:0  sc1 lds
    buffer_load_dwordx4 v1, s[4:7], s33 offen offset:1024  sc1 lds
    buffer_load_dwordx4 v1, s[4:7], s33 offen offset:2048  sc1 lds
    buffer_load_dwordx4 v1, s[4:7], s33 offen offset:3072  sc1 lds
    s_add_u32 m0, s30, 22528
    s_add_u32 s33, s31, 4096
    buffer_load_dwordx4 v1, s[4:7], s33 offen offset:0  sc1 lds
    buffer_load_dwordx4 v1, s[4:7], s33 offen offset:1024  sc1 lds
    buffer_load_dwordx4 v1, s[4:7], s33 offen offset:2048  sc1 lds
    buffer_load_dwordx4 v1, s[4:7], s33 offen offset:3072  sc1 lds
    s_add_u32 m0, s30, 26624
    s_add_u32 s33, s31, 8192
    buffer_load_dwordx4 v1, s[4:7], s33 offen offset:0  sc1 lds
    buffer_load_dwordx4 v1, s[4:7], s33 offen offset:1024  sc1 lds
    buffer_load_dwordx4 v1, s[4:7], s33 offen offset:2048  sc1 lds
    buffer_load_dwordx4 v1, s[4:7], s33 offen offset:3072  sc1 lds
    s_add_u32 m0, s30, 30720
    s_add_u32 s33, s31, 12288
    buffer_load_dwordx4 v1, s[4:7], s33 offen offset:0  sc1 lds
    buffer_load_dwordx4 v1, s[4:7], s33 offen offset:1024  sc1 lds
    buffer_load_dwordx4 v1, s[4:7], s33 offen offset:2048  sc1 lds
    buffer_load_dwordx4 v1, s[4:7], s33 offen offset:3072  sc1 lds
    s_add_u32 m0, s30, 34816
    s_add_u32 s33, s31, 16384
    buffer_load_dwordx4 v1, s[4:7], s33 offen offset:0  sc1 lds
    buffer_load_dwordx4 v1, s[4:7], s33 offen offset:1024  sc1 lds
    s_mul_i32 s30, s20, 3072
    s_add_u32 s31, s30, s29
    s_waitcnt vmcnt(18)
    s_barrier
    s_add_u32 m0, s30, 147456
    s_add_u32 s33, s31, 73728
    buffer_load_dwordx4 v1, s[4:7], s33 offen offset:0  sc1 lds
    buffer_load_dwordx4 v1, s[4:7], s33 offen offset:1024  sc1 lds
    buffer_load_dwordx4 v1, s[4:7], s33 offen offset:2048  sc1 lds
    s_or_b32 s44, s20, s22
    s_cbranch_scc1 L_p2_ns
    s_and_b32 s44, s2, 15
    s_lshl_b32 s44, s44, 8
    s_add_u32 s44, s44, 0x4501000
    s_add_u32 s44, s44, s4
    s_addc_u32 s45, s5, 0
    s_mov_b32 s56, 1
    s_atomic_add s56, s[44:45], 0
L_p2_ns:
    s_waitcnt vmcnt(0)
    s_barrier
    s_and_b32 s25, s2, 7
    s_lshr_b32 s26, s2, 3
    s_and_b32 s23, s25, 1
    s_lshl_b32 s23, s23, 3
    s_and_b32 s27, s26, 7
    s_add_u32 s23, s23, s27
    s_lshr_b32 s24, s25, 1
    s_lshl_b32 s24, s24, 2
    s_lshr_b32 s27, s26, 3
    s_add_u32 s24, s24, s27
    s_add_u32 s28, s23, s24
    s_and_b32 s28, s28, 3
    s_lshl_b32 s30, s20, 12
    s_lshr_b32 s33, s20, 1
    s_mul_i32 s31, s33, 36864
    s_and_b32 s33, s20, 1
    s_lshl_b32 s33, s33, 10
    s_add_u32 s33, s33, 16384
    s_add_u32 s31, s31, s33
    s_sub_u32 s49, s33, s30
    s_mul_i32 s34, s24, 331776
    s_add_u32 s34, s34, s30
    s_add_u32 s34, s34, 0x3b00000
    s_lshl_b32 s35, s23, 3
    s_lshl_b32 s33, s20, 1
    s_add_u32 s35, s35, s33
    s_mul_i32 s35, s35, 18432
    s_add_u32 s35, s35, s21
    s_add_u32 s35, s35, 0x300000
    s_mul_i32 s36, s24, 589824
    s_add_u32 s36, s36, s30
    s_add_u32 s36, s36, s21
    s_add_u32 s36, s36, 0x900000
    v_add_u32 v2, 16384, v1
    s_add_u32 s33, s30, 18432
    v_add_u32 v6, s33, v1
    v_add_u32 v7, 73728, v6
    s_lshl_b32 s29, s23, 2
    s_add_u32 s29, s29, s20
    s_lshl_b32 s29, s29, 12
    s_add_u32 s29, s29, s21
    s_add_u32 s29, s29, 0x1b40000
    v_and_b32 v3, 48, v1
    v_lshrrev_b32 v8, 8, v1
    v_lshl_add_u32 v3, v8, 6, v3
    v_bfe_u32 v8, v1, 6, 2
    v_lshl_add_u32 v3, v8, 8, v3
    s_lshl_b32 s33, s23, 7
    s_lshl_b32 s37, s20, 5
    s_add_u32 s33, s33, s37
    v_lshrrev_b32 v8, 7, v1
    v_add_u32 v8, s33, v8
    v_lshlrev_b32 v8, 12, v8
    v_lshrrev_b32 v9, 8, v1
    v_bfe_u32 v10, v1, 4, 3
    v_xor_b32 v9, v9, v10
    v_lshl_add_u32 v8, v9, 4, v8
    v_xor_b32 v9, 64, v8
    v_add_u32 v9, 31744, v9
    v_add_u32 v10, 63488, v8
    v_add_u32 v11, 63488, v9
    s_cmp_eq_u32 s28, 0
    s_cselect_b32 s44, 4, 0
    s_cmp_eq_u32 s28, 1
    s_cselect_b32 s45, 5, 1
    s_cmp_eq_u32 s28, 2
    s_cselect_b32 s46, 6, 2
    s_cmp_eq_u32 s28, 3
    s_cselect_b32 s47, 7, 3
    s_lshl_b32 s33, s20, 4
    s_add_u32 s33, s33, s24
    s_lshl_b32 s54, s22, 7
    s_add_u32 s54, s54, s33
    s_lshl_b32 s54, s54, 8
    s_add_u32 s54, s54, 0x450c000
    s_add_u32 s54, s54, s4
    s_addc_u32 s55, s5, 0
    s_mov_b32 s33, 0x4501000
    v_and_b32 v4, 0xf0, v1
    v_lshlrev_b32 v4, 4, v4
    s_mov_b32 s60, 65536
L_poll_wr:
    buffer_load_dword v5, v4, s[4:7], s33 offen sc1
    s_waitcnt vmcnt(0)
    v_cmp_gt_u32 vcc, 16, v5
    s_sub_u32 s60, s60, 1
    s_cbranch_scc1 L_pd_wr
    s_cbranch_vccz L_pd_wr
    s_sleep 4
    s_branch L_poll_wr
L_pd_wr:
    s_min_u32 s33, s20, 2
    s_lshl_b32 s33, s33, 9
    v_lshrrev_b32 v4, 1, v1
    v_add_u32 v4, s33, v4
    s_lshl_b32 s51, s24, 12
    s_add_u32 s51, s51, 0x4410000
    buffer_load_dwordx2 v[16:17], v4, s[4:7], s51 offen offset:0 sc1
    buffer_load_dwordx2 v[18:19], v4, s[4:7], s51 offen offset:1152 sc1
    s_mov_b32 s48, 0
    s_mul_i32 s50, s48, 18432
    s_add_u32 s50, s50, s34
    s_add_u32 m0, s30, 0
    s_mov_b32 s53, s50
    buffer_load_dwordx4 v1, s[4:7], s50 offen offset:0  sc1 lds
    buffer_load_dwordx4 v1, s[4:7], s50 offen offset:1024  sc1 lds
    buffer_load_dwordx4 v1, s[4:7], s50 offen offset:2048  sc1 lds
    buffer_load_dwordx4 v1, s[4:7], s50 offen offset:3072  sc1 lds
    s_mov_b32 s48, 1
    s_mul_i32 s50, s48, 18432
    s_add_u32 s50, s50, s34
    s_cmp_ge_u32 s20, 2
    s_cselect_b32 s52, s50, s53
    s_add_u32 m0, s31, 0
    s_add_u32 s52, s52, s49
    buffer_load_dwordx4 v1, s[4:7], s52 offen  sc1 lds
    s_add_u32 m0, s30, 36864
    s_mov_b32 s53, s50
    buffer_load_dwordx4 v1, s[4:7], s50 offen offset:0  sc1 lds
    buffer_load_dwordx4 v1, s[4:7], s50 offen offset:1024  sc1 lds
    buffer_load_dwordx4 v1, s[4:7], s50 offen offset:2048  sc1 lds
    buffer_load_dwordx4 v1, s[4:7], s50 offen offset:3072  sc1 lds
    s_mov_b32 m0, 161280
    v_lshrrev_b32 v5, 2, v1
    s_lshl_b32 s33, s23, 8
    buffer_load_dword v5, s[12:15], s33 offen lds
    s_waitcnt vmcnt(10)
    v_add_u32 v4, 159744, v4
    v_add_f32 v16, v16, v18
    v_add_f32 v17, v17, v19
    ds_write_b64 v4, v[16:17]
    s_waitcnt lgkmcnt(0)
    s_barrier
    s_mov_b32 s48, 2
    s_mul_i32 s50, s48, 18432
    s_add_u32 s50, s50, s34
    s_add_u32 m0, s30, 73728
    s_mov_b32 s53, s50
    buffer_load_dwordx4 v1, s[4:7], s50 offen offset:0  sc1 lds
    buffer_load_dwordx4 v1, s[4:7], s50 offen offset:1024  sc1 lds
    buffer_load_dwordx4 v1, s[4:7], s50 offen offset:2048  sc1 lds
    buffer_load_dwordx4 v1, s[4:7], s50 offen offset:3072  sc1 lds
    s_mov_b32 s48, 3
    s_mul_i32 s50, s48, 18432
    s_add_u32 s50, s50, s34
    s_cmp_ge_u32 s20, 2
    s_cselect_b32 s52, s50, s53
    s_add_u32 m0, s31, 73728
    s_add_u32 s52, s52, s49
    buffer_load_dwordx4 v1, s[4:7], s52 offen  sc1 lds
    s_add_u32 m0, s30, 110592
    s_mov_b32 s53, s50
    buffer_load_dwordx4 v1, s[4:7], s50 offen offset:0  sc1 lds
    buffer_load_dwordx4 v1, s[4:7], s50 offen offset:1024  sc1 lds
    buffer_load_dwordx4 v1, s[4:7], s50 offen offset:2048  sc1 lds
    buffer_load_dwordx4 v1, s[4:7], s50 offen offset:3072  sc1 lds
    s_barrier
    s_add_u32 m0, s30, 18432
    s_add_u32 s51, s35, 0
    buffer_load_dwordx4 v1, s[4:7], s51 offen offset:0 sc1 lds
    buffer_load_dwordx4 v1, s[4:7], s51 offen offset:1024 sc1 lds
    buffer_load_dwordx4 v2, s[4:7], s51 offen offset:2048 sc1 lds
    buffer_load_dwordx4 v2, s[4:7], s51 offen offset:3072 sc1 lds
    s_add_u32 m0, s30, 55296
    s_add_u32 s51, s35, 2048
    buffer_load_dwordx4 v1, s[4:7], s51 offen offset:0 sc1 lds
    buffer_load_dwordx4 v1, s[4:7], s51 offen offset:1024 sc1 lds
    buffer_load_dwordx4 v2, s[4:7], s51 offen offset:2048 sc1 lds
    buffer_load_dwordx4 v2, s[4:7], s51 offen offset:3072 sc1 lds
    s_add_u32 m0, s30, 92160
    s_add_u32 s51, s35, 4096
    buffer_load_dwordx4 v1, s[4:7], s51 offen offset:0 sc1 lds
    buffer_load_dwordx4 v1, s[4:7], s51 offen offset:1024 sc1 lds
    buffer_load_dwordx4 v2, s[4:7], s51 offen offset:2048 sc1 lds
    buffer_load_dwordx4 v2, s[4:7], s51 offen offset:3072 sc1 lds
    s_waitcnt vmcnt(8)
    s_barrier
    s_add_u32 m0, s30, 129024
    s_add_u32 s51, s35, 6144
    buffer_load_dwordx4 v1, s[4:7], s51 offen offset:0 sc1 lds
    buffer_load_dwordx4 v1, s[4:7], s51 offen offset:1024 sc1 lds
    buffer_load_dwordx4 v2, s[4:7], s51 offen offset:2048 sc1 lds
    buffer_load_dwordx4 v2, s[4:7], s51 offen offset:3072 sc1 lds
    s_and_b32 s40, s2, 7
    s_lshr_b32 s26, s2, 3
    s_lshr_b32 s38, s40, 1
    s_lshl_b32 s38, s38, 3
    s_lshr_b32 s27, s26, 2
    s_add_u32 s38, s38, s27
    s_and_b32 s39, s40, 1
    s_lshl_b32 s39, s39, 2
    s_and_b32 s27, s26, 3
    s_add_u32 s39, s39, s27
    s_add_u32 s40, s38, s39
    s_and_b32 s40, s40, 3
    s_mul_i32 s42, s20, 9216
    s_mul_i32 s43, s39, 331776
    s_add_u32 s43, s43, s42
    s_add_u32 s43, s43, 0x4100000
    s_waitcnt vmcnt(8) lgkmcnt(0)
    s_barrier
    s_mov_b32 s48, 4
    s_mul_i32 s50, s48, 18432
    s_add_u32 s50, s50, s34
    s_add_u32 m0, s30, 0
    s_mov_b32 s53, s50
    buffer_load_dwordx4 v1, s[4:7], s50 offen offset:0  sc1 lds
    buffer_load_dwordx4 v1, s[4:7], s50 offen offset:1024  sc1 lds
    buffer_load_dwordx4 v1, s[4:7], s50 offen offset:2048  sc1 lds
    buffer_load_dwordx4 v1, s[4:7], s50 offen offset:3072  sc1 lds
    s_add_u32 m0, s30, 18432
    s_add_u32 s51, s35, 8192
    buffer_load_dwordx4 v1, s[4:7], s51 offen offset:0 sc1 lds
    buffer_load_dwordx4 v1, s[4:7], s51 offen offset:1024 sc1 lds
    buffer_load_dwordx4 v2, s[4:7], s51 offen offset:2048 sc1 lds
    buffer_load_dwordx4 v2, s[4:7], s51 offen offset:3072 sc1 lds
    s_waitcnt vmcnt(12) lgkmcnt(0)
    s_barrier
    s_mov_b32 s48, 5
    s_mul_i32 s50, s48, 18432
    s_add_u32 s50, s50, s34
    s_cmp_ge_u32 s20, 2
    s_cselect_b32 s52, s50, s53
    s_add_u32 m0, s31, 0
    s_add_u32 s52, s52, s49
    buffer_load_dwordx4 v1, s[4:7], s52 offen  sc1 lds
    s_add_u32 m0, s30, 36864
    s_mov_b32 s53, s50
    buffer_load_dwordx4 v1, s[4:7], s50 offen offset:0  sc1 lds
    buffer_load_dwordx4 v1, s[4:7], s50 offen offset:1024  sc1 lds
    buffer_load_dwordx4 v1, s[4:7], s50 offen offset:2048  sc1 lds
    buffer_load_dwordx4 v1, s[4:7], s50 offen offset:3072  sc1 lds
    s_add_u32 m0, s30, 55296
    s_add_u32 s51, s35, 10240
    buffer_load_dwordx4 v1, s[4:7], s51 offen offset:0 sc1 lds
    buffer_load_dwordx4 v1, s[4:7], s51 offen offset:1024 sc1 lds
    buffer_load_dwordx4 v2, s[4:7], s51 offen offset:2048 sc1 lds
    buffer_load_dwordx4 v2, s[4:7], s51 offen offset:3072 sc1 lds
    s_waitcnt vmcnt(17) lgkmcnt(0)
    s_barrier
    s_mov_b32 s48, 6
    s_mul_i32 s50, s48, 18432
    s_add_u32 s50, s50, s34
    s_add_u32 m0, s30, 73728
    s_mov_b32 s53, s50
    buffer_load_dwordx4 v1, s[4:7], s50 offen offset:0  sc1 lds
    buffer_load_dwordx4 v1, s[4:7], s50 offen offset:1024  sc1 lds
    buffer_load_dwordx4 v1, s[4:7], s50 offen offset:2048  sc1 lds
    buffer_load_dwordx4 v1, s[4:7], s50 offen offset:3072  sc1 lds
    s_add_u32 m0, s30, 92160
    s_add_u32 s51, s35, 12288
    buffer_load_dwordx4 v1, s[4:7], s51 offen offset:0 sc1 lds
    buffer_load_dwordx4 v1, s[4:7], s51 offen offset:1024 sc1 lds
    buffer_load_dwordx4 v2, s[4:7], s51 offen offset:2048 sc1 lds
    buffer_load_dwordx4 v2, s[4:7], s51 offen offset:3072 sc1 lds
    s_waitcnt vmcnt(16) lgkmcnt(0)
    s_barrier
    s_mov_b32 s48, 7
    s_mul_i32 s50, s48, 18432
    s_add_u32 s50, s50, s34
    s_cmp_ge_u32 s20, 2
    s_cselect_b32 s52, s50, s53
    s_add_u32 m0, s31, 73728
    s_add_u32 s52, s52, s49
    buffer_load_dwordx4 v1, s[4:7], s52 offen  sc1 lds
    s_add_u32 m0, s30, 110592
    s_mov_b32 s53, s50
    buffer_load_dwordx4 v1, s[4:7], s50 offen offset:0  sc1 lds
    buffer_load_dwordx4 v1, s[4:7], s50 offen offset:1024  sc1 lds
    buffer_load_dwordx4 v1, s[4:7], s50 offen offset:2048  sc1 lds
    buffer_load_dwordx4 v1, s[4:7], s50 offen offset:3072  sc1 lds
    s_add_u32 m0, s30, 129024
    s_add_u32 s51, s35, 14336
    buffer_load_dwordx4 v1, s[4:7], s51 offen offset:0 sc1 lds
    buffer_load_dwordx4 v1, s[4:7], s51 offen offset:1024 sc1 lds
    buffer_load_dwordx4 v2, s[4:7], s51 offen offset:2048 sc1 lds
    buffer_load_dwordx4 v2, s[4:7], s51 offen offset:3072 sc1 lds
    s_waitcnt vmcnt(17) lgkmcnt(0)
    s_barrier
    s_mov_b32 s48, 8
    s_mul_i32 s50, s48, 18432
    s_add_u32 s50, s50, s34
    s_add_u32 m0, s30, 0
    s_mov_b32 s53, s50
    buffer_load_dwordx4 v1, s[4:7], s50 offen offset:0  sc1 lds
    buffer_load_dwordx4 v1, s[4:7], s50 offen offset:1024  sc1 lds
    buffer_load_dwordx4 v1, s[4:7], s50 offen offset:2048  sc1 lds
    buffer_load_dwordx4 v1, s[4:7], s50 offen offset:3072  sc1 lds
    s_add_u32 m0, s30, 18432
    s_add_u32 s51, s35, 16384
    buffer_load_dwordx4 v1, s[4:7], s51 offen offset:0 sc1 lds
    buffer_load_dwordx4 v1, s[4:7], s51 offen offset:1024 sc1 lds
    buffer_load_dwordx4 v2, s[4:7], s51 offen offset:2048 sc1 lds
    buffer_load_dwordx4 v2, s[4:7], s51 offen offset:3072 sc1 lds
    s_waitcnt vmcnt(16) lgkmcnt(0)
    s_barrier
    s_mov_b32 s48, 5
    s_mul_i32 s50, s48, 18432
    s_add_u32 s50, s50, s34
    s_add_u32 s50, s50, 165888
    s_cmp_ge_u32 s20, 2
    s_cselect_b32 s52, s50, s53
    s_add_u32 m0, s31, 0
    s_add_u32 s52, s52, s49
    buffer_load_dwordx4 v1, s[4:7], s52 offen  sc1 lds
    s_add_u32 m0, s30, 36864
    s_mov_b32 s53, s50
    buffer_load_dwordx4 v1, s[4:7], s50 offen offset:0  sc1 lds
    buffer_load_dwordx4 v1, s[4:7], s50 offen offset:1024  sc1 lds
    buffer_load_dwordx4 v1, s[4:7], s50 offen offset:2048  sc1 lds
    buffer_load_dwordx4 v1, s[4:7], s50 offen offset:3072  sc1 lds
    s_cmp_lg_u32 s22, 0
    s_cbranch_scc1 L_p5_k6
    s_add_u32 s32, s43, 294912
    buffer_load_dwordx4 v[220:223], v1, s[4:7], s32 offen offset:0 sc1
    buffer_load_dwordx4 v[224:227], v1, s[4:7], s32 offen offset:1024 sc1
    buffer_load_dwordx4 v[228:231], v1, s[4:7], s32 offen offset:2048 sc1
    buffer_load_dwordx4 v[232:235], v1, s[4:7], s32 offen offset:3072 sc1
    s_add_u32 s32, s43, 299008
    buffer_load_dwordx4 v[236:239], v1, s[4:7], s32 offen offset:0 sc1
L_p5_k6:
    s_waitcnt vmcnt(18) lgkmcnt(0)
    s_cmp_eq_u32 s22, 0
    s_cbranch_scc1 L_wv_919
    s_waitcnt vmcnt(13)
L_wv_919:
    s_barrier
    s_mov_b32 s48, 6
    s_mul_i32 s50, s48, 18432
    s_add_u32 s50, s50, s34
    s_add_u32 s50, s50, 165888
    s_add_u32 m0, s30, 73728
    s_mov_b32 s53, s50
    buffer_load_dwordx4 v1, s[4:7], s50 offen offset:0  sc1 lds
    buffer_load_dwordx4 v1, s[4:7], s50 offen offset:1024  sc1 lds
    buffer_load_dwordx4 v1, s[4:7], s50 offen offset:2048  sc1 lds
    buffer_load_dwordx4 v1, s[4:7], s50 offen offset:3072  sc1 lds
    s_cmp_lg_u32 s22, 0
    s_cbranch_scc1 L_p5_k7
    s_add_u32 s32, s43, 299008
    buffer_load_dwordx4 v[240:243], v1, s[4:7], s32 offen offset:1024 sc1
    buffer_load_dwordx4 v[244:247], v1, s[4:7], s32 offen offset:2048 sc1
    buffer_load_dwordx4 v[248:251], v1, s[4:7], s32 offen offset:3072 sc1
    s_add_u32 s32, s43, 303104
    buffer_load_dwordx4 v[252:255], v1, s[4:7], s32 offen offset:0 sc1
    s_add_u32 s32, s43, 258048
    buffer_load_dwordx4 v[184:187], v1, s[4:7], s32 offen offset:0 sc1
L_p5_k7:
    s_waitcnt vmcnt(18) lgkmcnt(0)
    s_cmp_eq_u32 s22, 0
    s_cbranch_scc1 L_wv_946
    s_waitcnt vmcnt(8)
L_wv_946:
    s_barrier
    s_mov_b32 s48, 7
    s_mul_i32 s50, s48, 18432
    s_add_u32 s50, s50, s34
    s_add_u32 s50, s50, 165888
    s_cmp_ge_u32 s20, 2
    s_cselect_b32 s52, s50, s53
    s_add_u32 m0, s31, 73728
    s_add_u32 s52, s52, s49
    buffer_load_dwordx4 v1, s[4:7], s52 offen  sc1 lds
    s_add_u32 m0, s30, 110592
    s_mov_b32 s53, s50
    buffer_load_dwordx4 v1, s[4:7], s50 offen offset:0  sc1 lds
    buffer_load_dwordx4 v1, s[4:7], s50 offen offset:1024  sc1 lds
    buffer_load_dwordx4 v1, s[4:7], s50 offen offset:2048  sc1 lds
    buffer_load_dwordx4 v1, s[4:7], s50 offen offset:3072  sc1 lds
    s_cmp_lg_u32 s22, 0
    s_cbranch_scc1 L_p5_k8
    s_add_u32 s32, s43, 258048
    buffer_load_dwordx4 v[188:191], v1, s[4:7], s32 offen offset:1024 sc1
    buffer_load_dwordx4 v[192:195], v1, s[4:7], s32 offen offset:2048 sc1
    buffer_load_dwordx4 v[196:199], v1, s[4:7], s32 offen offset:3072 sc1
    s_add_u32 s32, s43, 262144
    buffer_load_dwordx4 v[200:203], v1, s[4:7], s32 offen offset:0 sc1
    buffer_load_dwordx4 v[204:207], v1, s[4:7], s32 offen offset:1024 sc1
L_p5_k8:
    s_waitcnt vmcnt(24) lgkmcnt(0)
    s_cmp_eq_u32 s22, 0
    s_cbranch_scc1 L_wv_977
    s_waitcnt vmcnt(9)
L_wv_977:
    s_barrier
    s_mov_b32 s48, 8
    s_mul_i32 s50, s48, 18432
    s_add_u32 s50, s50, s34
    s_add_u32 s50, s50, 165888
    s_add_u32 m0, s30, 0
    s_mov_b32 s53, s50
    buffer_load_dwordx4 v1, s[4:7], s50 offen offset:0  sc1 lds
    buffer_load_dwordx4 v1, s[4:7], s50 offen offset:1024  sc1 lds
    buffer_load_dwordx4 v1, s[4:7], s50 offen offset:2048  sc1 lds
    buffer_load_dwordx4 v1, s[4:7], s50 offen offset:3072  sc1 lds
    s_cmp_lg_u32 s22, 0
    s_cbranch_scc1 L_p5_k9
    s_add_u32 s32, s43, 262144
    buffer_load_dwordx4 v[208:211], v1, s[4:7], s32 offen offset:2048 sc1
    buffer_load_dwordx4 v[212:215], v1, s[4:7], s32 offen offset:3072 sc1
    s_add_u32 s32, s43, 266240
    buffer_load_dwordx4 v[216:219], v1, s[4:7], s32 offen offset:0 sc1
    s_add_u32 s32, s43, 221184
    buffer_load_dwordx4 v[148:151], v1, s[4:7], s32 offen offset:0 sc1
    buffer_load_dwordx4 v[152:155], v1, s[4:7], s32 offen offset:1024 sc1
    buffer_load_dwordx4 v[156:159], v1, s[4:7], s32 offen offset:2048 sc1
    buffer_load_dwordx4 v[160:163], v1, s[4:7], s32 offen offset:3072 sc1
    s_add_u32 s32, s43, 225280
    buffer_load_dwordx4 v[164:167], v1, s[4:7], s32 offen offset:0 sc1
    buffer_load_dwordx4 v[168:171], v1, s[4:7], s32 offen offset:1024 sc1
    buffer_load_dwordx4 v[172:175], v1, s[4:7], s32 offen offset:2048 sc1
    buffer_load_dwordx4 v[176:179], v1, s[4:7], s32 offen offset:3072 sc1
    s_add_u32 s32, s43, 229376
    buffer_load_dwordx4 v[180:183], v1, s[4:7], s32 offen offset:0 sc1
    s_add_u32 s32, s43, 184320
    buffer_load_dwordx4 v[112:115], v1, s[4:7], s32 offen offset:0 sc1
    buffer_load_dwordx4 v[116:119], v1, s[4:7], s32 offen offset:1024 sc1
    buffer_load_dwordx4 v[120:123], v1, s[4:7], s32 offen offset:2048 sc1
    buffer_load_dwordx4 v[124:127], v1, s[4:7], s32 offen offset:3072 sc1
    s_add_u32 s32, s43, 188416
    buffer_load_dwordx4 v[128:131], v1, s[4:7], s32 offen offset:0 sc1
    buffer_load_dwordx4 v[132:135], v1, s[4:7], s32 offen offset:1024 sc1
    buffer_load_dwordx4 v[136:139], v1, s[4:7], s32 offen offset:2048 sc1
    buffer_load_dwordx4 v[140:143], v1, s[4:7], s32 offen offset:3072 sc1
    s_add_u32 s32, s43, 192512
    buffer_load_dwordx4 v[144:147], v1, s[4:7], s32 offen offset:0 sc1
    s_add_u32 s32, s43, 147456
    buffer_load_dwordx4 v[76:79], v1, s[4:7], s32 offen offset:0 sc1
    buffer_load_dwordx4 v[80:83], v1, s[4:7], s32 offen offset:1024 sc1
    buffer_load_dwordx4 v[84:87], v1, s[4:7], s32 offen offset:2048 sc1
    buffer_load_dwordx4 v[88:91], v1, s[4:7], s32 offen offset:3072 sc1
    s_add_u32 s32, s43, 151552
    buffer_load_dwordx4 v[92:95], v1, s[4:7], s32 offen offset:0 sc1
    buffer_load_dwordx4 v[96:99], v1, s[4:7], s32 offen offset:1024 sc1
    buffer_load_dwordx4 v[100:103], v1, s[4:7], s32 offen offset:2048 sc1
    buffer_load_dwordx4 v[104:107], v1, s[4:7], s32 offen offset:3072 sc1
    s_add_u32 s32, s43, 155648
    buffer_load_dwordx4 v[108:111], v1, s[4:7], s32 offen offset:0 sc1
L_p5_k9:
    s_waitcnt vmcnt(43) lgkmcnt(0)
    s_cmp_eq_u32 s22, 0
    s_cbranch_scc1 L_wv_1037
    s_waitcnt vmcnt(8)
L_wv_1037:
    s_barrier
    s_mov_b32 s48, 0
    s_mul_i32 s50, s48, 18432
    s_add_u32 s50, s50, s34
    s_add_u32 s50, s50, 165888
    s_cmp_ge_u32 s20, 2
    s_cselect_b32 s52, s50, s53
    s_add_u32 m0, s31, 0
    s_add_u32 s52, s52, s49
    buffer_load_dwordx4 v1, s[4:7], s52 offen  sc1 lds
    s_add_u32 m0, s30, 36864
    s_mov_b32 s53, s50
    buffer_load_dwordx4 v1, s[4:7], s50 offen offset:0  sc1 lds
    buffer_load_dwordx4 v1, s[4:7], s50 offen offset:1024  sc1 lds
    buffer_load_dwordx4 v1, s[4:7], s50 offen offset:2048  sc1 lds
    buffer_load_dwordx4 v1, s[4:7], s50 offen offset:3072  sc1 lds
    s_add_u32 m0, s30, 55296
    s_add_u32 s51, s35, 0
    buffer_load_dwordx4 v1, s[4:7], s51 offen offset:0 sc1 lds
    buffer_load_dwordx4 v1, s[4:7], s51 offen offset:1024 sc1 lds
    buffer_load_dwordx4 v2, s[4:7], s51 offen offset:2048 sc1 lds
    buffer_load_dwordx4 v2, s[4:7], s51 offen offset:3072 sc1 lds
    s_waitcnt vmcnt(48) lgkmcnt(0)
    s_cmp_eq_u32 s22, 0
    s_cbranch_scc1 L_wv_1064
    s_waitcnt vmcnt(13)
L_wv_1064:
    s_barrier
    buffer_load_dwordx4 v[16:19], v3, s[4:7], s29 offen offset:0 sc1
    buffer_load_dwordx4 v[20:23], v3, s[4:7], s29 offen offset:1024 sc1
    buffer_load_dwordx4 v[24:27], v3, s[4:7], s29 offen offset:2048 sc1
    buffer_load_dwordx4 v[28:31], v3, s[4:7], s29 offen offset:3072 sc1
    s_mov_b32 s48, 1
    s_mul_i32 s50, s48, 18432
    s_add_u32 s50, s50, s34
    s_add_u32 s50, s50, 165888
    s_add_u32 m0, s30, 73728
    s_mov_b32 s53, s50
    buffer_load_dwordx4 v1, s[4:7], s50 offen offset:0  sc1 lds
    buffer_load_dwordx4 v1, s[4:7], s50 offen offset:1024  sc1 lds
    buffer_load_dwordx4 v1, s[4:7], s50 offen offset:2048  sc1 lds
    buffer_load_dwordx4 v1, s[4:7], s50 offen offset:3072  sc1 lds
    s_add_u32 m0, s30, 92160
    s_add_u32 s51, s35, 2048
    buffer_load_dwordx4 v1, s[4:7], s51 offen offset:0 sc1 lds
    buffer_load_dwordx4 v1, s[4:7], s51 offen offset:1024 sc1 lds
    buffer_load_dwordx4 v2, s[4:7], s51 offen offset:2048 sc1 lds
    buffer_load_dwordx4 v2, s[4:7], s51 offen offset:3072 sc1 lds
    s_waitcnt vmcnt(20) lgkmcnt(0)
    s_barrier
    s_mov_b32 s48, 2
    s_mul_i32 s50, s48, 18432
    s_add_u32 s50, s50, s34
    s_add_u32 s50, s50, 165888
    s_cmp_ge_u32 s20, 2
    s_cselect_b32 s52, s50, s53
    s_add_u32 m0, s31, 73728
    s_add_u32 s52, s52, s49
    buffer_load_dwordx4 v1, s[4:7], s52 offen  sc1 lds
    s_add_u32 m0, s30, 110592
    s_mov_b32 s53, s50
    buffer_load_dwordx4 v1, s[4:7], s50 offen offset:0  sc1 lds
    buffer_load_dwordx4 v1, s[4:7], s50 offen offset:1024  sc1 lds
    buffer_load_dwordx4 v1, s[4:7], s50 offen offset:2048  sc1 lds
    buffer_load_dwordx4 v1, s[4:7], s50 offen offset:3072  sc1 lds
    s_add_u32 m0, s30, 129024
    s_add_u32 s51, s35, 4096
    buffer_load_dwordx4 v1, s[4:7], s51 offen offset:0 sc1 lds
    buffer_load_dwordx4 v1, s[4:7], s51 offen offset:1024 sc1 lds
    buffer_load_dwordx4 v2, s[4:7], s51 offen offset:2048 sc1 lds
    buffer_load_dwordx4 v2, s[4:7], s51 offen offset:3072 sc1 lds
    s_mov_b32 s60, 65536
    s_waitcnt vmcnt(17)
L_g_chk:
    v_or3_b32 v32, v17, v19, v21
    v_or3_b32 v33, v23, v25, v27
    v_or3_b32 v32, v29, v31, v32
    v_or_b32 v32, v32, v33
    v_cmp_gt_i32 vcc, 0, v32
    s_sub_u32 s60, s60, 1
    s_cbranch_scc1 L_g_ok
    s_cbranch_vccz L_g_ok
    buffer_load_dwordx4 v[16:19], v3, s[4:7], s29 offen offset:0 sc1
    buffer_load_dwordx4 v[20:23], v3, s[4:7], s29 offen offset:1024 sc1
    buffer_load_dwordx4 v[24:27], v3, s[4:7], s29 offen offset:2048 sc1
    buffer_load_dwordx4 v[28:31], v3, s[4:7], s29 offen offset:3072 sc1
    s_waitcnt vmcnt(0)
    s_branch L_g_chk
L_g_ok:
    v_add_f32 v16, v16, v20
    v_add_f32 v24, v24, v28
    v_add_f32 v17, v17, v21
    v_add_f32 v25, v25, v29
    v_add_f32 v18, v18, v22
    v_add_f32 v26, v26, v30
    v_add_f32 v19, v19, v23
    v_add_f32 v27, v27, v31
    v_add_f32 v16, v16, v24
    v_add_f32 v17, v17, v25
    v_add_f32 v18, v18, v26
    v_add_f32 v19, v19, v27
    v_add_f32_dpp v16, v16, v16 row_ror:4 row_mask:0xf bank_mask:0xf
    v_add_f32_dpp v17, v17, v17 row_ror:4 row_mask:0xf bank_mask:0xf
    v_add_f32_dpp v18, v18, v18 row_ror:4 row_mask:0xf bank_mask:0xf
    v_add_f32_dpp v19, v19, v19 row_ror:4 row_mask:0xf bank_mask:0xf
    v_add_f32_dpp v16, v16, v16 row_ror:8 row_mask:0xf bank_mask:0xf
    v_add_f32_dpp v17, v17, v17 row_ror:8 row_mask:0xf bank_mask:0xf
    v_add_f32_dpp v18, v18, v18 row_ror:8 row_mask:0xf bank_mask:0xf
    v_add_f32_dpp v19, v19, v19 row_ror:8 row_mask:0xf bank_mask:0xf
    v_mul_f32 v16, 0x39e38e39, v16
    v_mul_f32 v17, 0x39e38e39, v17
    v_mul_f32 v18, 0x39e38e39, v18
    v_mul_f32 v19, 0x39e38e39, v19
    v_fma_f32 v17, -v16, v16, v17
    v_fma_f32 v19, -v18, v18, v19
    v_max_f32 v17, 0, v17
    v_max_f32 v19, 0, v19
    v_add_f32 v17, 0x3727c5ac, v17
    v_add_f32 v19, 0x3727c5ac, v19
    v_rsq_f32 v20, v17
    v_rsq_f32 v21, v19
    v_and_b32 v32, 0xff, v3
    s_lshl_b32 s33, s20, 8
    s_add_u32 s33, s33, 148480
    v_add_u32 v32, s33, v32
    v_mul_f32 v22, v16, v20
    v_mul_f32 v23, v18, v21
    ds_write_b128 v32, v[20:23]
    s_waitcnt vmcnt(17) lgkmcnt(0)
    s_barrier
    s_mov_b32 s48, 3
    s_mul_i32 s50, s48, 18432
    s_add_u32 s50, s50, s34
    s_add_u32 s50, s50, 165888
    s_add_u32 m0, s30, 0
    s_mov_b32 s53, s50
    buffer_load_dwordx4 v1, s[4:7], s50 offen offset:0  sc1 lds
    buffer_load_dwordx4 v1, s[4:7], s50 offen offset:1024  sc1 lds
    buffer_load_dwordx4 v1, s[4:7], s50 offen offset:2048  sc1 lds
    buffer_load_dwordx4 v1, s[4:7], s50 offen offset:3072  sc1 lds
    s_add_u32 m0, s30, 18432
    s_add_u32 s51, s35, 6144
    buffer_load_dwordx4 v1, s[4:7], s51 offen offset:0 sc1 lds
    buffer_load_dwordx4 v1, s[4:7], s51 offen offset:1024 sc1 lds
    buffer_load_dwordx4 v2, s[4:7], s51 offen offset:2048 sc1 lds
    buffer_load_dwordx4 v2, s[4:7], s51 offen offset:3072 sc1 lds
    s_waitcnt vmcnt(16) lgkmcnt(0)
    s_barrier
    s_mov_b32 s48, 4
    s_mul_i32 s50, s48, 18432
    s_add_u32 s50, s50, s34
    s_add_u32 s50, s50, 165888
    s_cmp_ge_u32 s20, 2
    s_cselect_b32 s52, s50, s53
    s_add_u32 m0, s31, 0
    s_add_u32 s52, s52, s49
    buffer_load_dwordx4 v1, s[4:7], s52 offen  sc1 lds
    s_add_u32 m0, s30, 36864
    s_mov_b32 s53, s50
    buffer_load_dwordx4 v1, s[4:7], s50 offen offset:0  sc1 lds
    buffer_load_dwordx4 v1, s[4:7], s50 offen offset:1024  sc1 lds
    buffer_load_dwordx4 v1, s[4:7], s50 offen offset:2048  sc1 lds
    buffer_load_dwordx4 v1, s[4:7], s50 offen offset:3072  sc1 lds
    s_add_u32 m0, s30, 55296
    s_add_u32 s51, s35, 8192
    buffer_load_dwordx4 v1, s[4:7], s51 offen offset:0 sc1 lds
    buffer_load_dwordx4 v1, s[4:7], s51 offen offset:1024 sc1 lds
    buffer_load_dwordx4 v2, s[4:7], s51 offen offset:2048 sc1 lds
    buffer_load_dwordx4 v2, s[4:7], s51 offen offset:3072 sc1 lds
    s_waitcnt vmcnt(17) lgkmcnt(0)
    s_barrier
    s_waitcnt vmcnt(8) lgkmcnt(0)
    s_barrier
    s_waitcnt vmcnt(0) lgkmcnt(0)
    s_barrier
    s_barrier
    s_mov_b32 s56, 1
    s_atomic_add s56, s[54:55], 0
    s_mov_b32 s57, 0
    s_atomic_add s57, s[54:55], 0 glc
    s_lshl_b32 s48, s23, 1
    s_add_u32 s48, s48, 0
    s_add_u32 m0, s30, 92160
    s_lshl_b32 s51, s48, 7
    buffer_load_dwordx4 v8, s[8:11], s51 offen offset:0  lds
    buffer_load_dwordx4 v9, s[8:11], s51 offen offset:1024  lds
    buffer_load_dwordx4 v10, s[8:11], s51 offen offset:2048  lds
    buffer_load_dwordx4 v11, s[8:11], s51 offen offset:3072  lds
    s_lshl_b32 s48, s23, 1
    s_add_u32 s48, s48, 1
    s_add_u32 m0, s30, 129024
    s_lshl_b32 s51, s48, 7
    buffer_load_dwordx4 v8, s[8:11], s51 offen offset:0  lds
    buffer_load_dwordx4 v9, s[8:11], s51 offen offset:1024  lds
    buffer_load_dwordx4 v10, s[8:11], s51 offen offset:2048  lds
    buffer_load_dwordx4 v11, s[8:11], s51 offen offset:3072  lds
    s_lshr_b32 s48, s46, 1
    s_cmp_eq_u32 s48, s23
    s_cselect_b32 s48, 1, 31
    s_and_b32 s48, s48, s46
    s_add_u32 m0, s30, 18432
    s_lshl_b32 s51, s48, 7
    buffer_load_dwordx4 v8, s[8:11], s51 offen offset:0  lds
    buffer_load_dwordx4 v9, s[8:11], s51 offen offset:1024  lds
    buffer_load_dwordx4 v10, s[8:11], s51 offen offset:2048  lds
    buffer_load_dwordx4 v11, s[8:11], s51 offen offset:3072  lds
    s_waitcnt lgkmcnt(0)
    s_cmp_ge_u32 s57, 16
    s_cbranch_scc1 L_g_r0
    s_mov_b32 s57, 0
    s_atomic_add s57, s[54:55], 0 glc
    s_waitcnt vmcnt(8)
    s_barrier
    s_waitcnt lgkmcnt(0)
    s_cmp_ge_u32 s57, 16
    s_cbranch_scc1 L_g_r1
    s_waitcnt vmcnt(4)
    s_barrier
    s_mov_b32 s60, 65536
L_poll_z2:
    s_mov_b32 s57, 0
    s_atomic_add s57, s[54:55], 0 glc
    s_waitcnt lgkmcnt(0)
    s_cmp_ge_u32 s57, 16
    s_cbranch_scc1 L_pd_z2
    s_sub_u32 s60, s60, 1
    s_cbranch_scc1 L_pd_z2
    s_sleep 2
    s_branch L_poll_z2
L_pd_z2:
    s_lshr_b32 s48, s46, 1
    s_cmp_eq_u32 s48, s23
    s_cselect_b32 s48, 1, 31
    s_and_b32 s48, s48, s46
    s_mul_i32 s50, s48, 18432
    s_add_u32 s50, s50, s36
    s_add_u32 m0, s30, 0
    s_mov_b32 s53, s50
    buffer_load_dwordx4 v1, s[4:7], s50 offen offset:0 sc1 lds
    buffer_load_dwordx4 v1, s[4:7], s50 offen offset:1024 sc1 lds
    buffer_load_dwordx4 v1, s[4:7], s50 offen offset:2048 sc1 lds
    buffer_load_dwordx4 v1, s[4:7], s50 offen offset:3072 sc1 lds
    s_lshr_b32 s48, s47, 1
    s_cmp_eq_u32 s48, s23
    s_cselect_b32 s48, 1, 31
    s_and_b32 s48, s48, s47
    s_mul_i32 s50, s48, 18432
    s_add_u32 s50, s50, s36
    s_cmp_ge_u32 s20, 2
    s_cselect_b32 s52, s50, s53
    s_add_u32 m0, s31, 0
    s_add_u32 s52, s52, s49
    buffer_load_dwordx4 v1, s[4:7], s52 offen sc1 lds
    s_add_u32 m0, s30, 36864
    s_mov_b32 s53, s50
    buffer_load_dwordx4 v1, s[4:7], s50 offen offset:0 sc1 lds
    buffer_load_dwordx4 v1, s[4:7], s50 offen offset:1024 sc1 lds
    buffer_load_dwordx4 v1, s[4:7], s50 offen offset:2048 sc1 lds
    buffer_load_dwordx4 v1, s[4:7], s50 offen offset:3072 sc1 lds
    s_lshr_b32 s48, s47, 1
    s_cmp_eq_u32 s48, s23
    s_cselect_b32 s48, 1, 31
    s_and_b32 s48, s48, s47
    s_add_u32 m0, s30, 55296
    s_lshl_b32 s51, s48, 7
    buffer_load_dwordx4 v8, s[8:11], s51 offen offset:0  lds
    buffer_load_dwordx4 v9, s[8:11], s51 offen offset:1024  lds
    buffer_load_dwordx4 v10, s[8:11], s51 offen offset:2048  lds
    buffer_load_dwordx4 v11, s[8:11], s51 offen offset:3072  lds
    s_branch L_g_jn
L_g_r0:
    s_lshr_b32 s48, s46, 1
    s_cmp_eq_u32 s48, s23
    s_cselect_b32 s48, 1, 31
    s_and_b32 s48, s48, s46
    s_mul_i32 s50, s48, 18432
    s_add_u32 s50, s50, s36
    s_add_u32 m0, s30, 0
    s_mov_b32 s53, s50
    buffer_load_dwordx4 v1, s[4:7], s50 offen offset:0 sc1 lds
    buffer_load_dwordx4 v1, s[4:7], s50 offen offset:1024 sc1 lds
    buffer_load_dwordx4 v1, s[4:7], s50 offen offset:2048 sc1 lds
    buffer_load_dwordx4 v1, s[4:7], s50 offen offset:3072 sc1 lds
    s_lshr_b32 s48, s47, 1
    s_cmp_eq_u32 s48, s23
    s_cselect_b32 s48, 1, 31
    s_and_b32 s48, s48, s47
    s_mul_i32 s50, s48, 18432
    s_add_u32 s50, s50, s36
    s_cmp_ge_u32 s20, 2
    s_cselect_b32 s52, s50, s53
    s_add_u32 m0, s31, 0
    s_add_u32 s52, s52, s49
    buffer_load_dwordx4 v1, s[4:7], s52 offen sc1 lds
    s_add_u32 m0, s30, 36864
    s_mov_b32 s53, s50
    buffer_load_dwordx4 v1, s[4:7], s50 offen offset:0 sc1 lds
    buffer_load_dwordx4 v1, s[4:7], s50 offen offset:1024 sc1 lds
    buffer_load_dwordx4 v1, s[4:7], s50 offen offset:2048 sc1 lds
    buffer_load_dwordx4 v1, s[4:7], s50 offen offset:3072 sc1 lds
    s_lshr_b32 s48, s47, 1
    s_cmp_eq_u32 s48, s23
    s_cselect_b32 s48, 1, 31
    s_and_b32 s48, s48, s47
    s_add_u32 m0, s30, 55296
    s_lshl_b32 s51, s48, 7
    buffer_load_dwordx4 v8, s[8:11], s51 offen offset:0  lds
    buffer_load_dwordx4 v9, s[8:11], s51 offen offset:1024  lds
    buffer_load_dwordx4 v10, s[8:11], s51 offen offset:2048  lds
    buffer_load_dwordx4 v11, s[8:11], s51 offen offset:3072  lds
    s_waitcnt vmcnt(21)
    s_barrier
    s_waitcnt vmcnt(17)
    s_barrier
    s_branch L_g_jn
L_g_r1:
    s_lshr_b32 s48, s46, 1
    s_cmp_eq_u32 s48, s23
    s_cselect_b32 s48, 1, 31
    s_and_b32 s48, s48, s46
    s_mul_i32 s50, s48, 18432
    s_add_u32 s50, s50, s36
    s_add_u32 m0, s30, 0
    s_mov_b32 s53, s50
    buffer_load_dwordx4 v1, s[4:7], s50 offen offset:0 sc1 lds
    buffer_load_dwordx4 v1, s[4:7], s50 offen offset:1024 sc1 lds
    buffer_load_dwordx4 v1, s[4:7], s50 offen offset:2048 sc1 lds
    buffer_load_dwordx4 v1, s[4:7], s50 offen offset:3072 sc1 lds
    s_lshr_b32 s48, s47, 1
    s_cmp_eq_u32 s48, s23
    s_cselect_b32 s48, 1, 31
    s_and_b32 s48, s48, s47
    s_mul_i32 s50, s48, 18432
    s_add_u32 s50, s50, s36
    s_cmp_ge_u32 s20, 2
    s_cselect_b32 s52, s50, s53
    s_add_u32 m0, s31, 0
    s_add_u32 s52, s52, s49
    buffer_load_dwordx4 v1, s[4:7], s52 offen sc1 lds
    s_add_u32 m0, s30, 36864
    s_mov_b32 s53, s50
    buffer_load_dwordx4 v1, s[4:7], s50 offen offset:0 sc1 lds
    buffer_load_dwordx4 v1, s[4:7], s50 offen offset:1024 sc1 lds
    buffer_load_dwordx4 v1, s[4:7], s50 offen offset:2048 sc1 lds
    buffer_load_dwordx4 v1, s[4:7], s50 offen offset:3072 sc1 lds
    s_lshr_b32 s48, s47, 1
    s_cmp_eq_u32 s48, s23
    s_cselect_b32 s48, 1, 31
    s_and_b32 s48, s48, s47
    s_add_u32 m0, s30, 55296
    s_lshl_b32 s51, s48, 7
    buffer_load_dwordx4 v8, s[8:11], s51 offen offset:0  lds
    buffer_load_dwordx4 v9, s[8:11], s51 offen offset:1024  lds
    buffer_load_dwordx4 v10, s[8:11], s51 offen offset:2048  lds
    buffer_load_dwordx4 v11, s[8:11], s51 offen offset:3072  lds
    s_waitcnt vmcnt(17)
    s_barrier
L_g_jn:
    s_add_u32 s44, s44, 4
    s_cmp_ge_u32 s44, 32
    s_cselect_b32 s44, 4, s44
    s_add_u32 s45, s45, 4
    s_cmp_ge_u32 s45, 32
    s_cselect_b32 s45, 5, s45
    s_add_u32 s46, s46, 4
    s_and_b32 s46, s46, 31
    s_add_u32 s47, s47, 4
    s_and_b32 s47, s47, 31
    s_lshr_b32 s48, s44, 1
    s_cmp_eq_u32 s48, s23
    s_cselect_b32 s48, 1, 31
    s_and_b32 s48, s48, s44
    s_mul_i32 s50, s48, 18432
    s_add_u32 s50, s50, s36
    s_add_u32 m0, s30, 73728
    s_mov_b32 s53, s50
    buffer_load_dwordx4 v1, s[4:7], s50 offen offset:0 sc1 lds
    buffer_load_dwordx4 v1, s[4:7], s50 offen offset:1024 sc1 lds
    buffer_load_dwordx4 v1, s[4:7], s50 offen offset:2048 sc1 lds
    buffer_load_dwordx4 v1, s[4:7], s50 offen offset:3072 sc1 lds
    s_lshr_b32 s48, s44, 1
    s_cmp_eq_u32 s48, s23
    s_cselect_b32 s48, 1, 31
    s_and_b32 s48, s48, s44
    s_add_u32 m0, s30, 92160
    s_lshl_b32 s51, s48, 7
    buffer_load_dwordx4 v8, s[8:11], s51 offen offset:0  lds
    buffer_load_dwordx4 v9, s[8:11], s51 offen offset:1024  lds
    buffer_load_dwordx4 v10, s[8:11], s51 offen offset:2048  lds
    buffer_load_dwordx4 v11, s[8:11], s51 offen offset:3072  lds
    s_add_u32 s44, s44, 4
    s_cmp_ge_u32 s44, 32
    s_cselect_b32 s44, 4, s44
    s_waitcnt vmcnt(16)
    s_barrier
    s_lshr_b32 s48, s45, 1
    s_cmp_eq_u32 s48, s23
    s_cselect_b32 s48, 1, 31
    s_and_b32 s48, s48, s45
    s_mul_i32 s50, s48, 18432
    s_add_u32 s50, s50, s36
    s_cmp_ge_u32 s20, 2
    s_cselect_b32 s52, s50, s53
    s_add_u32 m0, s31, 73728
    s_add_u32 s52, s52, s49
    buffer_load_dwordx4 v1, s[4:7], s52 offen sc1 lds
    s_add_u32 m0, s30, 110592
    s_mov_b32 s53, s50
    buffer_load_dwordx4 v1, s[4:7], s50 offen offset:0 sc1 lds
    buffer_load_dwordx4 v1, s[4:7], s50 offen offset:1024 sc1 lds
    buffer_load_dwordx4 v1, s[4:7], s50 offen offset:2048 sc1 lds
    buffer_load_dwordx4 v1, s[4:7], s50 offen offset:3072 sc1 lds
    s_lshr_b32 s48, s45, 1
    s_cmp_eq_u32 s48, s23
    s_cselect_b32 s48, 1, 31
    s_and_b32 s48, s48, s45
    s_add_u32 m0, s30, 129024
    s_lshl_b32 s51, s48, 7
    buffer_load_dwordx4 v8, s[8:11], s51 offen offset:0  lds
    buffer_load_dwordx4 v9, s[8:11], s51 offen offset:1024  lds
    buffer_load_dwordx4 v10, s[8:11], s51 offen offset:2048  lds
    buffer_load_dwordx4 v11, s[8:11], s51 offen offset:3072  lds
    s_add_u32 s45, s45, 4
    s_cmp_ge_u32 s45, 32
    s_cselect_b32 s45, 5, s45
    s_waitcnt vmcnt(17)
    s_barrier
    s_lshr_b32 s48, s46, 1
    s_cmp_eq_u32 s48, s23
    s_cselect_b32 s48, 1, 31
    s_and_b32 s48, s48, s46
    s_mul_i32 s50, s48, 18432
    s_add_u32 s50, s50, s36
    s_add_u32 m0, s30, 0
    s_mov_b32 s53, s50
    buffer_load_dwordx4 v1, s[4:7], s50 offen offset:0 sc1 lds
    buffer_load_dwordx4 v1, s[4:7], s50 offen offset:1024 sc1 lds
    buffer_load_dwordx4 v1, s[4:7], s50 offen offset:2048 sc1 lds
    buffer_load_dwordx4 v1, s[4:7], s50 offen offset:3072 sc1 lds
    s_lshr_b32 s48, s46, 1
    s_cmp_eq_u32 s48, s23
    s_cselect_b32 s48, 1, 31
    s_and_b32 s48, s48, s46
    s_add_u32 m0, s30, 18432
    s_lshl_b32 s51, s48, 7
    buffer_load_dwordx4 v8, s[8:11], s51 offen offset:0  lds
    buffer_load_dwordx4 v9, s[8:11], s51 offen offset:1024  lds
    buffer_load_dwordx4 v10, s[8:11], s51 offen offset:2048  lds
    buffer_load_dwordx4 v11, s[8:11], s51 offen offset:3072  lds
    s_add_u32 s46, s46, 4
    s_and_b32 s46, s46, 31
    s_waitcnt vmcnt(16)
    s_barrier
    s_lshr_b32 s48, s47, 1
    s_cmp_eq_u32 s48, s23
    s_cselect_b32 s48, 1, 31
    s_and_b32 s48, s48, s47
    s_mul_i32 s50, s48, 18432
    s_add_u32 s50, s50, s36
    s_cmp_ge_u32 s20, 2
    s_cselect_b32 s52, s50, s53
    s_add_u32 m0, s31, 0
    s_add_u32 s52, s52, s49
    buffer_load_dwordx4 v1, s[4:7], s52 offen sc1 lds
    s_add_u32 m0, s30, 36864
    s_mov_b32 s53, s50
    buffer_load_dwordx4 v1, s[4:7], s50 offen offset:0 sc1 lds
    buffer_load_dwordx4 v1, s[4:7], s50 offen offset:1024 sc1 lds
    buffer_load_dwordx4 v1, s[4:7], s50 offen offset:2048 sc1 lds
    buffer_load_dwordx4 v1, s[4:7], s50 offen offset:3072 sc1 lds
    s_lshr_b32 s48, s47, 1
    s_cmp_eq_u32 s48, s23
    s_cselect_b32 s48, 1, 31
    s_and_b32 s48, s48, s47
    s_add_u32 m0, s30, 55296
    s_lshl_b32 s51, s48, 7
    buffer_load_dwordx4 v8, s[8:11], s51 offen offset:0  lds
    buffer_load_dwordx4 v9, s[8:11], s51 offen offset:1024  lds
    buffer_load_dwordx4 v10, s[8:11], s51 offen offset:2048  lds
    buffer_load_dwordx4 v11, s[8:11], s51 offen offset:3072  lds
    s_add_u32 s47, s47, 4
    s_and_b32 s47, s47, 31
    s_mov_b32 s41, 6
L_g_ll:
    s_waitcnt vmcnt(17)
    s_barrier
    s_lshr_b32 s48, s44, 1
    s_cmp_eq_u32 s48, s23
    s_cselect_b32 s48, 1, 31
    s_and_b32 s48, s48, s44
    s_mul_i32 s50, s48, 18432
    s_add_u32 s50, s50, s36
    s_add_u32 m0, s30, 73728
    s_mov_b32 s53, s50
    buffer_load_dwordx4 v1, s[4:7], s50 offen offset:0 sc1 lds
    buffer_load_dwordx4 v1, s[4:7], s50 offen offset:1024 sc1 lds
    buffer_load_dwordx4 v1, s[4:7], s50 offen offset:2048 sc1 lds
    buffer_load_dwordx4 v1, s[4:7], s50 offen offset:3072 sc1 lds
    s_lshr_b32 s48, s44, 1
    s_cmp_eq_u32 s48, s23
    s_cselect_b32 s48, 1, 31
    s_and_b32 s48, s48, s44
    s_add_u32 m0, s30, 92160
    s_lshl_b32 s51, s48, 7
    buffer_load_dwordx4 v8, s[8:11], s51 offen offset:0  lds
    buffer_load_dwordx4 v9, s[8:11], s51 offen offset:1024  lds
    buffer_load_dwordx4 v10, s[8:11], s51 offen offset:2048  lds
    buffer_load_dwordx4 v11, s[8:11], s51 offen offset:3072  lds
    s_add_u32 s44, s44, 4
    s_cmp_ge_u32 s44, 32
    s_cselect_b32 s44, 4, s44
    s_waitcnt vmcnt(16)
    s_barrier
    s_lshr_b32 s48, s45, 1
    s_cmp_eq_u32 s48, s23
    s_cselect_b32 s48, 1, 31
    s_and_b32 s48, s48, s45
    s_mul_i32 s50, s48, 18432
    s_add_u32 s50, s50, s36
    s_cmp_ge_u32 s20, 2
    s_cselect_b32 s52, s50, s53
    s_add_u32 m0, s31, 73728
    s_add_u32 s52, s52, s49
    buffer_load_dwordx4 v1, s[4:7], s52 offen sc1 lds
    s_add_u32 m0, s30, 110592
    s_mov_b32 s53, s50
    buffer_load_dwordx4 v1, s[4:7], s50 offen offset:0 sc1 lds
    buffer_load_dwordx4 v1, s[4:7], s50 offen offset:1024 sc1 lds
    buffer_load_dwordx4 v1, s[4:7], s50 offen offset:2048 sc1 lds
    buffer_load_dwordx4 v1, s[4:7], s50 offen offset:3072 sc1 lds
    s_lshr_b32 s48, s45, 1
    s_cmp_eq_u32 s48, s23
    s_cselect_b32 s48, 1, 31
    s_and_b32 s48, s48, s45
    s_add_u32 m0, s30, 129024
    s_lshl_b32 s51, s48, 7
    buffer_load_dwordx4 v8, s[8:11], s51 offen offset:0  lds
    buffer_load_dwordx4 v9, s[8:11], s51 offen offset:1024  lds
    buffer_load_dwordx4 v10, s[8:11], s51 offen offset:2048  lds
    buffer_load_dwordx4 v11, s[8:11], s51 offen offset:3072  lds
    s_add_u32 s45, s45, 4
    s_cmp_ge_u32 s45, 32
    s_cselect_b32 s45, 5, s45
    s_waitcnt vmcnt(17)
    s_barrier
    s_lshr_b32 s48, s46, 1
    s_cmp_eq_u32 s48, s23
    s_cselect_b32 s48, 1, 31
    s_and_b32 s48, s48, s46
    s_mul_i32 s50, s48, 18432
    s_add_u32 s50, s50, s36
    s_add_u32 m0, s30, 0
    s_mov_b32 s53, s50
    buffer_load_dwordx4 v1, s[4:7], s50 offen offset:0 sc1 lds
    buffer_load_dwordx4 v1, s[4:7], s50 offen offset:1024 sc1 lds
    buffer_load_dwordx4 v1, s[4:7], s50 offen offset:2048 sc1 lds
    buffer_load_dwordx4 v1, s[4:7], s50 offen offset:3072 sc1 lds
    s_lshr_b32 s48, s46, 1
    s_cmp_eq_u32 s48, s23
    s_cselect_b32 s48, 1, 31
    s_and_b32 s48, s48, s46
    s_add_u32 m0, s30, 18432
    s_lshl_b32 s51, s48, 7
    buffer_load_dwordx4 v8, s[8:11], s51 offen offset:0  lds
    buffer_load_dwordx4 v9, s[8:11], s51 offen offset:1024  lds
    buffer_load_dwordx4 v10, s[8:11], s51 offen offset:2048  lds
    buffer_load_dwordx4 v11, s[8:11], s51 offen offset:3072  lds
    s_add_u32 s46, s46, 4
    s_and_b32 s46, s46, 31
    s_waitcnt vmcnt(16)
    s_barrier
    s_lshr_b32 s48, s47, 1
    s_cmp_eq_u32 s48, s23
    s_cselect_b32 s48, 1, 31
    s_and_b32 s48, s48, s47
    s_mul_i32 s50, s48, 18432
    s_add_u32 s50, s50, s36
    s_cmp_ge_u32 s20, 2
    s_cselect_b32 s52, s50, s53
    s_add_u32 m0, s31, 0
    s_add_u32 s52, s52, s49
    buffer_load_dwordx4 v1, s[4:7], s52 offen sc1 lds
    s_add_u32 m0, s30, 36864
    s_mov_b32 s53, s50
    buffer_load_dwordx4 v1, s[4:7], s50 offen offset:0 sc1 lds
    buffer_load_dwordx4 v1, s[4:7], s50 offen offset:1024 sc1 lds
    buffer_load_dwordx4 v1, s[4:7], s50 offen offset:2048 sc1 lds
    buffer_load_dwordx4 v1, s[4:7], s50 offen offset:3072 sc1 lds
    s_lshr_b32 s48, s47, 1
    s_cmp_eq_u32 s48, s23
    s_cselect_b32 s48, 1, 31
    s_and_b32 s48, s48, s47
    s_add_u32 m0, s30, 55296
    s_lshl_b32 s51, s48, 7
    buffer_load_dwordx4 v8, s[8:11], s51 offen offset:0  lds
    buffer_load_dwordx4 v9, s[8:11], s51 offen offset:1024  lds
    buffer_load_dwordx4 v10, s[8:11], s51 offen offset:2048  lds
    buffer_load_dwordx4 v11, s[8:11], s51 offen offset:3072  lds
    s_add_u32 s47, s47, 4
    s_and_b32 s47, s47, 31
    s_sub_u32 s41, s41, 1
    s_cmp_lg_u32 s41, 0
    s_cbranch_scc1 L_g_ll
    s_waitcnt vmcnt(17)
    s_barrier
    s_mov_b32 s32, 0
    s_mul_i32 s32, s32, 36864
    s_add_u32 s32, s32, s43
    s_add_u32 m0, s42, 73728
    s_add_u32 s33, s32, 0
    buffer_load_dwordx4 v1, s[4:7], s33 offen offset:0  sc1 lds
    buffer_load_dwordx4 v1, s[4:7], s33 offen offset:1024  sc1 lds
    buffer_load_dwordx4 v1, s[4:7], s33 offen offset:2048  sc1 lds
    buffer_load_dwordx4 v1, s[4:7], s33 offen offset:3072  sc1 lds
    s_add_u32 m0, s42, 77824
    s_add_u32 s33, s32, 4096
    buffer_load_dwordx4 v1, s[4:7], s33 offen offset:0  sc1 lds
    buffer_load_dwordx4 v1, s[4:7], s33 offen offset:1024  sc1 lds
    buffer_load_dwordx4 v1, s[4:7], s33 offen offset:2048  sc1 lds
    buffer_load_dwordx4 v1, s[4:7], s33 offen offset:3072  sc1 lds
    s_add_u32 m0, s42, 81920
    s_add_u32 s33, s32, 8192
    buffer_load_dwordx4 v1, s[4:7], s33 offen offset:0  sc1 lds
    s_waitcnt vmcnt(9)
    s_barrier
    s_mov_b32 s32, 1
    s_mul_i32 s32, s32, 36864
    s_add_u32 s32, s32, s43
    s_add_u32 m0, s42, 110592
    s_add_u32 s33, s32, 0
    buffer_load_dwordx4 v1, s[4:7], s33 offen offset:0  sc1 lds
    buffer_load_dwordx4 v1, s[4:7], s33 offen offset:1024  sc1 lds
    buffer_load_dwordx4 v1, s[4:7], s33 offen offset:2048  sc1 lds
    buffer_load_dwordx4 v1, s[4:7], s33 offen offset:3072  sc1 lds
    s_add_u32 m0, s42, 114688
    s_add_u32 s33, s32, 4096
    buffer_load_dwordx4 v1, s[4:7], s33 offen offset:0  sc1 lds
    buffer_load_dwordx4 v1, s[4:7], s33 offen offset:1024  sc1 lds
    buffer_load_dwordx4 v1, s[4:7], s33 offen offset:2048  sc1 lds
    buffer_load_dwordx4 v1, s[4:7], s33 offen offset:3072  sc1 lds
    s_add_u32 m0, s42, 118784
    s_add_u32 s33, s32, 8192
    buffer_load_dwordx4 v1, s[4:7], s33 offen offset:0  sc1 lds
    s_barrier
    s_mov_b32 s32, 2
    s_mul_i32 s32, s32, 36864
    s_add_u32 s32, s32, s43
    s_add_u32 m0, s42, 0
    s_add_u32 s33, s32, 0
    buffer_load_dwordx4 v1, s[4:7], s33 offen offset:0  sc1 lds
    buffer_load_dwordx4 v1, s[4:7], s33 offen offset:1024  sc1 lds
    buffer_load_dwordx4 v1, s[4:7], s33 offen offset:2048  sc1 lds
    buffer_load_dwordx4 v1, s[4:7], s33 offen offset:3072  sc1 lds
    s_add_u32 m0, s42, 4096
    s_add_u32 s33, s32, 4096
    buffer_load_dwordx4 v1, s[4:7], s33 offen offset:0  sc1 lds
    buffer_load_dwordx4 v1, s[4:7], s33 offen offset:1024  sc1 lds
    buffer_load_dwordx4 v1, s[4:7], s33 offen offset:2048  sc1 lds
    buffer_load_dwordx4 v1, s[4:7], s33 offen offset:3072  sc1 lds
    s_add_u32 m0, s42, 8192
    s_add_u32 s33, s32, 8192
    buffer_load_dwordx4 v1, s[4:7], s33 offen offset:0  sc1 lds
    s_barrier
    s_mov_b32 s32, 3
    s_mul_i32 s32, s32, 36864
    s_add_u32 s32, s32, s43
    s_add_u32 m0, s42, 36864
    s_add_u32 s33, s32, 0
    buffer_load_dwordx4 v1, s[4:7], s33 offen offset:0  sc1 lds
    buffer_load_dwordx4 v1, s[4:7], s33 offen offset:1024  sc1 lds
    buffer_load_dwordx4 v1, s[4:7], s33 offen offset:2048  sc1 lds
    buffer_load_dwordx4 v1, s[4:7], s33 offen offset:3072  sc1 lds
    s_add_u32 m0, s42, 40960
    s_add_u32 s33, s32, 4096
    buffer_load_dwordx4 v1, s[4:7], s33 offen offset:0  sc1 lds
    buffer_load_dwordx4 v1, s[4:7], s33 offen offset:1024  sc1 lds
    buffer_load_dwordx4 v1, s[4:7], s33 offen offset:2048  sc1 lds
    buffer_load_dwordx4 v1, s[4:7], s33 offen offset:3072  sc1 lds
    s_add_u32 m0, s42, 45056
    s_add_u32 s33, s32, 8192
    buffer_load_dwordx4 v1, s[4:7], s33 offen offset:0  sc1 lds
    s_waitcnt vmcnt(27) lgkmcnt(0)
    s_barrier
    v_add_u32 v12, s42, v1
    v_add_u32 v13, 36864, v12
    v_add_u32 v14, 73728, v12
    v_add_u32 v15, 110592, v12
    s_waitcnt vmcnt(18) lgkmcnt(15)
    s_barrier
    ds_write_b128 v14, v[76:79] offset:0
    ds_write_b128 v14, v[80:83] offset:1024
    ds_write_b128 v14, v[84:87] offset:2048
    ds_write_b128 v14, v[88:91] offset:3072
    ds_write_b128 v14, v[92:95] offset:4096
    ds_write_b128 v14, v[96:99] offset:5120
    ds_write_b128 v14, v[100:103] offset:6144
    s_waitcnt vmcnt(9) lgkmcnt(15)
    s_barrier
    ds_write_b128 v14, v[104:107] offset:7168
    ds_write_b128 v14, v[108:111] offset:8192
    ds_write_b128 v15, v[112:115] offset:0
    ds_write_b128 v15, v[116:119] offset:1024
    ds_write_b128 v15, v[120:123] offset:2048
    ds_write_b128 v15, v[124:127] offset:3072
    ds_write_b128 v15, v[128:131] offset:4096
    s_waitcnt vmcnt(0) lgkmcnt(15)
    s_barrier
    ds_write_b128 v15, v[132:135] offset:5120
    ds_write_b128 v15, v[136:139] offset:6144
    ds_write_b128 v15, v[140:143] offset:7168
    ds_write_b128 v15, v[144:147] offset:8192
    ds_write_b128 v12, v[148:151] offset:0
    ds_write_b128 v12, v[152:155] offset:1024
    ds_write_b128 v12, v[156:159] offset:2048
    s_waitcnt vmcnt(63) lgkmcnt(12)
    s_barrier
    ds_write_b128 v12, v[160:163] offset:3072
    ds_write_b128 v12, v[164:167] offset:4096
    ds_write_b128 v12, v[168:171] offset:5120
    ds_write_b128 v12, v[172:175] offset:6144
    ds_write_b128 v12, v[176:179] offset:7168
    ds_write_b128 v12, v[180:183] offset:8192
    s_waitcnt vmcnt(63) lgkmcnt(9)
    s_barrier
    ds_write_b128 v13, v[184:187] offset:0
    ds_write_b128 v13, v[188:191] offset:1024
    ds_write_b128 v13, v[192:195] offset:2048
    ds_write_b128 v13, v[196:199] offset:3072
    ds_write_b128 v13, v[200:203] offset:4096
    ds_write_b128 v13, v[204:207] offset:5120
    s_waitcnt vmcnt(63) lgkmcnt(6)
    s_barrier
    s_and_b32 s25, s2, 7
    s_lshr_b32 s26, s2, 3
    s_lshr_b32 s23, s25, 1
    s_lshl_b32 s23, s23, 2
    s_lshr_b32 s27, s26, 3
    s_add_u32 s23, s23, s27
    s_and_b32 s24, s25, 1
    s_lshl_b32 s24, s24, 3
    s_and_b32 s27, s26, 7
    s_add_u32 s24, s24, s27
    s_mul_i32 s29, s24, 129024
    s_lshl_b32 s30, s20, 12
    s_add_u32 s29, s29, s30
    s_add_u32 s29, s29, 0x3800000
    s_lshl_b32 s31, s23, 3
    s_max_u32 s31, s31, 1
    s_sub_u32 s31, s31, 1
    s_mul_i32 s31, s31, 18432
    s_add_u32 s31, s31, 0x1c00000
    s_lshl_b32 s35, s20, 10
    s_and_b32 s36, s35, 1024
    ds_write_b128 v13, v[208:211] offset:6144
    ds_write_b128 v13, v[212:215] offset:7168
    ds_write_b128 v13, v[216:219] offset:8192
    ds_write_b128 v14, v[220:223] offset:0
    ds_write_b128 v14, v[224:227] offset:1024
    ds_write_b128 v14, v[228:231] offset:2048
    s_waitcnt vmcnt(63) lgkmcnt(3)
    s_barrier
    ds_write_b128 v14, v[232:235] offset:3072
    ds_write_b128 v14, v[236:239] offset:4096
    ds_write_b128 v14, v[240:243] offset:5120
    ds_write_b128 v14, v[244:247] offset:6144
    ds_write_b128 v14, v[248:251] offset:7168
    ds_write_b128 v14, v[252:255] offset:8192
    s_waitcnt vmcnt(63) lgkmcnt(0)
    s_barrier
    s_cmp_eq_u32 s22, 1
    s_cbranch_scc1 L_m_t8
    s_add_u32 m0, s30, 0
    s_add_u32 s34, s29, 0
    buffer_load_dwordx4 v1, s[4:7], s34 offen offset:0 sc1 lds
    buffer_load_dwordx4 v1, s[4:7], s34 offen offset:1024 sc1 lds
    buffer_load_dwordx4 v1, s[4:7], s34 offen offset:2048 sc1 lds
    buffer_load_dwordx4 v1, s[4:7], s34 offen offset:3072 sc1 lds
    s_add_u32 m0, s30, 16384
    s_add_u32 s34, s29, 16384
    buffer_load_dwordx4 v1, s[4:7], s34 offen offset:0 sc1 lds
    buffer_load_dwordx4 v1, s[4:7], s34 offen offset:1024 sc1 lds
    buffer_load_dwordx4 v1, s[4:7], s34 offen offset:2048 sc1 lds
    buffer_load_dwordx4 v1, s[4:7], s34 offen offset:3072 sc1 lds
L_m_t8:
    s_cmp_eq_u32 s22, 1
    s_cbranch_scc1 L_m_lfin
    s_barrier
    s_add_u32 m0, s30, 32768
    s_add_u32 s34, s29, 32768
    buffer_load_dwordx4 v1, s[4:7], s34 offen offset:0 sc1 lds
    buffer_load_dwordx4 v1, s[4:7], s34 offen offset:1024 sc1 lds
    buffer_load_dwordx4 v1, s[4:7], s34 offen offset:2048 sc1 lds
    buffer_load_dwordx4 v1, s[4:7], s34 offen offset:3072 sc1 lds
    s_add_u32 m0, s30, 114688
    s_add_u32 s34, s29, 114688
    buffer_load_dwordx4 v1, s[4:7], s34 offen offset:0 sc1 lds
    buffer_load_dwordx4 v1, s[4:7], s34 offen offset:1024 sc1 lds
    buffer_load_dwordx4 v1, s[4:7], s34 offen offset:2048 sc1 lds
    buffer_load_dwordx4 v1, s[4:7], s34 offen offset:3072 sc1 lds
    s_mov_b32 s22, 1
    s_mov_b32 s21, 0x1c00000
    s_barrier
    s_barrier
    s_add_u32 m0, s30, 49152
    s_add_u32 s34, s29, 49152
    buffer_load_dwordx4 v1, s[4:7], s34 offen offset:0 sc1 lds
    buffer_load_dwordx4 v1, s[4:7], s34 offen offset:1024 sc1 lds
    buffer_load_dwordx4 v1, s[4:7], s34 offen offset:2048 sc1 lds
    buffer_load_dwordx4 v1, s[4:7], s34 offen offset:3072 sc1 lds
    v_lshrrev_b32 v2, 8, v1
    v_bfe_u32 v3, v1, 7, 1
    v_bfe_u32 v4, v1, 4, 3
    v_cmp_gt_u32 vcc, 3, v2
    v_mul_u32_u24 v3, 80, v3
    v_lshl_add_u32 v3, v4, 3, v3
    v_lshrrev_b32 v5, 1, v4
    v_and_b32 v4, 1, v4
    v_lshl_add_u32 v4, v4, 3, 64
    v_cndmask_b32 v2, v5, v2, vcc
    v_cndmask_b32 v3, v4, v3, vcc
    v_mul_u32_u24 v2, 2304, v2
    v_add_u32 v0, v2, v3
    v_lshrrev_b32 v8, 1, v1
    s_mul_i32 s34, s24, 144
    s_add_u32 s34, s34, 0x4400000
    buffer_load_dwordx2 v[2:3], v0, s[4:7], s34 offen sc1
    s_mul_i32 s34, s24, 144
    s_add_u32 s34, s34, 0x4402000
    buffer_load_dwordx2 v[4:5], v0, s[4:7], s34 offen sc1
    s_mul_i32 s34, s24, 144
    s_add_u32 s34, s34, 0x4404000
    buffer_load_dwordx2 v[6:7], v0, s[4:7], s34 offen sc1
    s_mul_i32 s34, s24, 144
    s_add_u32 s34, s34, 0x4406000
    buffer_load_dwordx2 v[12:13], v0, s[4:7], s34 offen sc1
    s_add_u32 m0, s30, 65536
    s_add_u32 s34, s29, 65536
    buffer_load_dwordx4 v1, s[4:7], s34 offen offset:0 sc1 lds
    buffer_load_dwordx4 v1, s[4:7], s34 offen offset:1024 sc1 lds
    buffer_load_dwordx4 v1, s[4:7], s34 offen offset:2048 sc1 lds
    buffer_load_dwordx4 v1, s[4:7], s34 offen offset:3072 sc1 lds
    s_add_u32 m0, s30, 81920
    s_add_u32 s34, s29, 81920
    buffer_load_dwordx4 v1, s[4:7], s34 offen offset:0 sc1 lds
    buffer_load_dwordx4 v1, s[4:7], s34 offen offset:1024 sc1 lds
    buffer_load_dwordx4 v1, s[4:7], s34 offen offset:2048 sc1 lds
    buffer_load_dwordx4 v1, s[4:7], s34 offen offset:3072 sc1 lds
    s_barrier
    s_add_u32 m0, s35, 131072
    s_add_u32 s34, s31, s35
    s_add_u32 s34, s34, 0
    buffer_load_dwordx4 v1, s[4:7], s34 offen sc1 lds
    s_waitcnt vmcnt(29) lgkmcnt(0)
    s_barrier
    s_add_u32 m0, s35, 135168
    s_add_u32 s34, s31, s35
    s_add_u32 s34, s34, 4096
    buffer_load_dwordx4 v1, s[4:7], s34 offen sc1 lds
    s_add_u32 m0, s35, 139264
    s_add_u32 s34, s31, s35
    s_add_u32 s34, s34, 8192
    buffer_load_dwordx4 v1, s[4:7], s34 offen sc1 lds
    s_add_u32 m0, s35, 143360
    s_add_u32 s34, s31, s35
    s_add_u32 s34, s34, 12288
    buffer_load_dwordx4 v1, s[4:7], s34 offen sc1 lds
    s_add_u32 m0, s30, 98304
    s_add_u32 s34, s29, 98304
    buffer_load_dwordx4 v1, s[4:7], s34 offen offset:0 sc1 lds
    buffer_load_dwordx4 v1, s[4:7], s34 offen offset:1024 sc1 lds
    buffer_load_dwordx4 v1, s[4:7], s34 offen offset:2048 sc1 lds
    buffer_load_dwordx4 v1, s[4:7], s34 offen offset:3072 sc1 lds
    s_add_u32 m0, s36, 147456
    s_add_u32 s34, s31, s36
    s_add_u32 s34, s34, 16384
    buffer_load_dwordx4 v1, s[4:7], s34 offen sc1 lds
    s_waitcnt vmcnt(8) lgkmcnt(0)
    s_barrier
    s_waitcnt vmcnt(8) lgkmcnt(0)
    s_barrier
    s_waitcnt vmcnt(7) lgkmcnt(0)
    s_barrier
    v_add_f32 v2, v2, v4
    v_add_f32 v3, v3, v5
    v_add_f32 v6, v6, v12
    v_add_f32 v7, v7, v13
    v_add_f32 v2, v2, v6
    v_add_f32 v3, v3, v7
    v_cmp_gt_u32 vcc, 864, v1
    v_add_u32 v8, 161792, v8
    s_nop 0
    v_cndmask_b32 v2, 0, v2, vcc
    v_cndmask_b32 v3, 0, v3, vcc
    ds_write_b64 v8, v[2:3]
    s_waitcnt vmcnt(6) lgkmcnt(0)
    s_barrier
    s_waitcnt vmcnt(6) lgkmcnt(0)
    s_barrier
    s_waitcnt vmcnt(1) lgkmcnt(0)
    s_barrier
    s_waitcnt vmcnt(0) lgkmcnt(0)
    s_barrier
    s_barrier
    s_branch L_m_ll
L_m_lfin:
L_end_m:
    s_endpgm

.section .rodata,"a"
.p2align 6
.amdhsa_kernel interleave_layers__sliding_local_dilated__mixer_gmlp__prompt_kernel
  .amdhsa_next_free_vgpr 256
  .amdhsa_next_free_sgpr 102
  .amdhsa_accum_offset 256
  .amdhsa_group_segment_fixed_size 0
  .amdhsa_kernarg_size 88
  .amdhsa_user_sgpr_count 2
  .amdhsa_user_sgpr_kernarg_segment_ptr 1
  .amdhsa_system_sgpr_workgroup_id_x 1
  .amdhsa_float_denorm_mode_32 3
.end_amdhsa_kernel
```

```asm
; @launch grid=(256,1,1) block=(512,1,1) lds=163840
.amdgcn_target "amdgcn-amd-amdhsa--gfx950"
.text
.globl interleave_layers__sliding_local_dilated__mixer_gmlp__prompt_kernel
.p2align 8
.type interleave_layers__sliding_local_dilated__mixer_gmlp__prompt_kernel,@function
interleave_layers__sliding_local_dilated__mixer_gmlp__prompt_kernel:
    s_cmp_ge_u32 s2, 256
    s_cbranch_scc1 L_end_m
    s_load_dwordx16 s[36:51], s[0:1], 0
    s_load_dwordx4 s[56:59], s[0:1], 64
    s_load_dwordx2 s[24:25], s[0:1], 80
    s_getpc_b64 s[26:27]
L_m_pc:
    s_sub_u32 s26, s26, L_m_pc-interleave_layers__sliding_local_dilated__mixer_gmlp__prompt_kernel
    s_subb_u32 s27, s27, 0
    v_lshlrev_b32 v4, 4, v0
    v_mov_b32 v5, s27
    v_add_co_u32 v6, vcc, s26, v4
    s_lshr_b32 s28, s2, 3
    s_lshl_b32 s28, s28, 11
    v_addc_co_u32 v7, vcc, 0, v5, vcc
    global_load_dwordx4 v[60:63], v[6:7], off
    v_lshl_add_u32 v4, v0, 2, s28
    v_min_u32 v4, L_end_m-interleave_layers__sliding_local_dilated__mixer_gmlp__prompt_kernel-4, v4
    v_add_co_u32 v6, vcc, s26, v4
    s_nop 1
    v_addc_co_u32 v7, vcc, 0, v5, vcc
    global_load_dword v64, v[6:7], off
    v_lshrrev_b32 v2, 6, v0
    v_and_b32 v1, 63, v0
    v_lshlrev_b32 v1, 4, v1
    v_readfirstlane_b32 s23, v2
    s_mov_b32 s22, 0
    s_mov_b32 s21, 0
    s_and_b32 s20, s23, 3
    s_waitcnt lgkmcnt(0)
    s_mov_b32 s4, s24
    s_mov_b32 s5, s25
    s_mov_b32 s6, 0x10000000
    s_mov_b32 s7, 0x20000
    s_cmp_ge_u32 s23, 4
    s_cbranch_scc1 L_ld_m
    v_bfe_u32 v2, v1, 4, 4
    v_lshrrev_b32 v3, 8, v1
    v_bfrev_b32 v6, 1
    v_mov_b32 v11, 0x3f803f80
    s_lshl_b32 s30, s20, 12
    s_and_b32 s29, s20, 1
    s_cmp_lt_u32 s2, 128
    s_cbranch_scc1 L_p0_x
    s_cmp_lt_u32 s2, 236
    s_cbranch_scc1 L_p0_wq
    s_cmp_lt_u32 s2, 254
    s_cbranch_scc1 L_p0_wo
    s_mov_b32 s46, 0
    s_mov_b32 s27, 0x800000
    s_barrier
    s_branch L_p0_cd
L_p0_wo:
    s_mul_i32 s30, s20, 9216
    s_sub_u32 s26, s2, 236
    s_mul_i32 s28, s26, 57
    s_lshr_b32 s28, s28, 9
    s_mul_i32 s27, s28, 9
    s_sub_u32 s27, s26, s27
    s_mov_b32 s32, s40
    s_mov_b32 s33, s41
    s_mov_b32 s34, 0xa2000
    s_mov_b32 s35, 0x20000
    s_mul_i32 s29, s28, 331776
    s_lshl_b32 s31, s27, 7
    s_add_u32 s29, s29, s31
    s_mul_i32 s31, s20, 82944
    s_add_u32 s29, s29, s31
    s_mul_i32 s30, s20, 9216
    v_lshrrev_b32 v4, 7, v1
    v_mul_u32_u24 v4, 1152, v4
    v_and_b32 v5, 0x70, v1
    v_add_u32 v4, v4, v5
    s_add_u32 m0, s30, 0
    s_add_u32 s31, s29, 0
    buffer_load_dwordx4 v4, s[32:35], s31 offen  lds
    s_add_u32 m0, s30, 1024
    s_add_u32 s31, s29, 9216
    buffer_load_dwordx4 v4, s[32:35], s31 offen  lds
    s_add_u32 m0, s30, 2048
    s_add_u32 s31, s29, 18432
    buffer_load_dwordx4 v4, s[32:35], s31 offen  lds
    s_add_u32 m0, s30, 3072
    s_add_u32 s31, s29, 27648
    buffer_load_dwordx4 v4, s[32:35], s31 offen  lds
    s_add_u32 m0, s30, 4096
    s_add_u32 s31, s29, 36864
    buffer_load_dwordx4 v4, s[32:35], s31 offen  lds
    s_add_u32 m0, s30, 5120
    s_add_u32 s31, s29, 46080
    buffer_load_dwordx4 v4, s[32:35], s31 offen  lds
    s_add_u32 m0, s30, 6144
    s_add_u32 s31, s29, 55296
    buffer_load_dwordx4 v4, s[32:35], s31 offen  lds
    s_add_u32 m0, s30, 7168
    s_add_u32 s31, s29, 64512
    buffer_load_dwordx4 v4, s[32:35], s31 offen  lds
    s_add_u32 m0, s30, 8192
    s_add_u32 s31, s29, 73728
    buffer_load_dwordx4 v4, s[32:35], s31 offen  lds
    v_lshrrev_b32 v7, 2, v2
    v_and_b32 v8, 3, v2
    v_bfe_u32 v9, v1, 7, 0
    v_xor_b32 v9, s20, v9
    v_lshlrev_b32 v9, 5, v9
    v_lshl_add_u32 v9, v7, 7, v9
    v_lshl_add_u32 v9, v8, 3, v9
    v_add_u32 v9, 0, v9
    v_mul_u32_u24 v4, 512, v3
    v_add_u32 v4, v4, v9
    v_mul_u32_u24 v5, 9216, v3
    v_add_u32 v5, v5, v9
    s_lshl_b32 s31, s27, 2
    s_add_u32 s31, s31, s20
    v_lshl_add_u32 v7, s31, 2, v7
    v_lshlrev_b32 v8, 4, v8
    v_lshl_add_u32 v8, v3, 8, v8
    v_mul_u32_u24 v9, 57, v7
    v_lshrrev_b32 v9, 10, v9
    v_mul_u32_u24 v10, 18, v9
    v_sub_u32 v10, v7, v10
    v_lshrrev_b32 v12, 3, v10
    v_and_b32 v13, 1, v10
    v_lshl_add_u32 v12, v12, 1, v13
    v_bfe_u32 v14, v10, 1, 2
    v_cmp_gt_u32 vcc, 16, v10
    v_mul_u32_u24 v9, 82944, v9
    v_add_u32 v9, v9, v8
    v_cndmask_b32 v12, 8, v12, vcc
    v_cndmask_b32 v14, v13, v14, vcc
    v_mov_b32 v15, 0x1000
    v_mov_b32 v13, 0x80
    v_cndmask_b32 v15, v13, v15, vcc
    v_lshl_add_u32 v9, v12, 10, v9
    v_lshl_add_u32 v9, v14, 6, v9
    v_add_u32 v10, v9, v15
    s_and_b32 s31, s28, 1
    s_cmp_eq_u32 s31, 1
    s_cselect_b64 vcc, -1, 0
    v_cndmask_b32 v14, v9, v10, vcc
    s_mul_i32 s31, s28, 36864
    s_add_u32 s37, s31, 0x3a00000
    s_add_u32 s38, s31, 0x3a00000
    s_add_u32 s39, s31, 0x3a02400
    s_add_u32 s40, s31, 0x3a02400
    s_add_u32 s41, s31, 0x3a04800
    s_add_u32 s42, s31, 0x3a04800
    s_add_u32 s43, s31, 0x3a06c00
    s_add_u32 s47, s31, 0x3a06c00
    s_lshr_b32 s31, s28, 1
    s_mul_i32 s31, s31, 9216
    s_add_u32 s48, s31, 0x3a12000
    s_cmp_ge_u32 s26, 4
    s_cbranch_scc1 L_p0_n2
    s_lshl_b32 s31, s26, 2
    s_add_u32 s31, s31, s20
    s_lshl_b32 s31, s31, 12
    s_add_u32 s31, s31, 0x4508000
    v_and_b32 v56, 0x380, v1
    v_add_u32 v56, v56, v1
    v_mov_b32 v52, 0
    v_mov_b32 v53, 0
    v_mov_b32 v54, 0
    v_mov_b32 v55, 0
    buffer_store_dwordx4 v[52:55], v56, s[4:7], s31 offen offset:0 sc1
    buffer_store_dwordx4 v[52:55], v56, s[4:7], s31 offen offset:2048 sc1
L_p0_n2:
    s_waitcnt vmcnt(0)
    s_barrier
    ds_read_b64_tr_b16 v[16:17], v4 offset:0
    ds_read_b64_tr_b16 v[18:19], v4 offset:2560
    ds_read_b64_tr_b16 v[20:21], v4 offset:4608
    ds_read_b64_tr_b16 v[22:23], v4 offset:7168
    ds_read_b64_tr_b16 v[24:25], v4 offset:9216
    ds_read_b64_tr_b16 v[26:27], v4 offset:11776
    ds_read_b64_tr_b16 v[28:29], v4 offset:13824
    ds_read_b64_tr_b16 v[30:31], v4 offset:16384
    ds_read_b64_tr_b16 v[32:33], v4 offset:18432
    ds_read_b64_tr_b16 v[34:35], v4 offset:20992
    ds_read_b64_tr_b16 v[36:37], v4 offset:23040
    ds_read_b64_tr_b16 v[38:39], v4 offset:25600
    ds_read_b64_tr_b16 v[40:41], v4 offset:27648
    ds_read_b64_tr_b16 v[42:43], v4 offset:30208
    ds_read_b64_tr_b16 v[44:45], v4 offset:32256
    ds_read_b64_tr_b16 v[46:47], v4 offset:34816
    ds_read_b64_tr_b16 v[48:49], v5 offset:2048
    ds_read_b64_tr_b16 v[50:51], v5 offset:6656
    s_waitcnt lgkmcnt(15)
    s_mov_b32 s31, s37
    buffer_store_dwordx4 v[16:19], v9, s[4:7], s31 offen sc1
    s_waitcnt lgkmcnt(14)
    s_mov_b32 s31, s38
    buffer_store_dwordx4 v[20:23], v10, s[4:7], s31 offen sc1
    s_waitcnt lgkmcnt(12)
    s_mov_b32 s31, s39
    buffer_store_dwordx4 v[24:27], v9, s[4:7], s31 offen sc1
    s_waitcnt lgkmcnt(10)
    s_mov_b32 s31, s40
    buffer_store_dwordx4 v[28:31], v10, s[4:7], s31 offen sc1
    s_waitcnt lgkmcnt(8)
    s_mov_b32 s31, s41
    buffer_store_dwordx4 v[32:35], v9, s[4:7], s31 offen sc1
    s_waitcnt lgkmcnt(6)
    s_mov_b32 s31, s42
    buffer_store_dwordx4 v[36:39], v10, s[4:7], s31 offen sc1
    s_waitcnt lgkmcnt(4)
    s_mov_b32 s31, s43
    buffer_store_dwordx4 v[40:43], v9, s[4:7], s31 offen sc1
    s_waitcnt lgkmcnt(2)
    s_mov_b32 s31, s47
    buffer_store_dwordx4 v[44:47], v10, s[4:7], s31 offen sc1
    s_waitcnt lgkmcnt(0)
    s_mov_b32 s31, s48
    buffer_store_dwordx4 v[48:51], v14, s[4:7], s31 offen sc1
    s_mov_b32 s46, 1
    s_mov_b32 s27, 32
    s_branch L_p0_cd
L_p0_wq:
    s_mov_b32 s32, s38
    s_mov_b32 s33, s39
    s_mov_b32 s34, 0x1e6000
    s_mov_b32 s35, 0x20000
    s_sub_u32 s23, s2, 128
    s_mul_i32 s25, s23, 19
    s_lshr_b32 s25, s25, 9
    s_mul_i32 s24, s25, 27
    s_sub_u32 s24, s23, s24
    s_mul_i32 s26, s25, 497664
    s_lshl_b32 s31, s24, 7
    s_add_u32 s26, s26, s31
    v_lshrrev_b32 v4, 7, v1
    v_mul_u32_u24 v4, 3456, v4
    v_lshrrev_b32 v5, 4, v1
    v_and_b32 v5, 16, v5
    v_xor_b32 v5, v5, v1
    v_and_b32 v5, 0x70, v5
    v_add_u32 v4, v4, v5
    s_mul_i32 s31, s20, 110592
    s_add_u32 s27, s26, s31
    s_mul_i32 s30, s20, 4224
    s_add_u32 m0, s30, 0
    s_add_u32 s31, s27, 0
    buffer_load_dwordx4 v4, s[32:35], s31 offen  lds
    s_add_u32 m0, s30, 1056
    s_add_u32 s31, s27, 27648
    buffer_load_dwordx4 v4, s[32:35], s31 offen  lds
    s_add_u32 m0, s30, 2112
    s_add_u32 s31, s27, 55296
    buffer_load_dwordx4 v4, s[32:35], s31 offen  lds
    s_add_u32 m0, s30, 3168
    s_add_u32 s31, s27, 82944
    buffer_load_dwordx4 v4, s[32:35], s31 offen  lds
    s_cmp_ge_u32 s20, 2
    s_cbranch_scc1 L_p0_q5
    s_mul_i32 s31, s29, 1056
    s_add_u32 m0, s31, 16896
    s_mul_i32 s31, s29, 27648
    s_add_u32 s31, s31, s26
    s_add_u32 s31, s31, 442368
    buffer_load_dwordx4 v4, s[32:35], s31 offen  lds
L_p0_q5:
    v_lshrrev_b32 v7, 2, v2
    v_and_b32 v8, 3, v2
    s_lshl_b32 s31, s20, 5
    v_and_b32 v9, 2, v7
    v_xor_b32 v9, v9, v3
    v_lshlrev_b32 v9, 3, v9
    v_lshl_add_u32 v9, v7, 7, v9
    v_add_u32 v9, s31, v9
    v_mul_u32_u24 v4, 1056, v8
    v_add_u32 v4, v4, v9
    v_and_b32 v5, 1, v2
    v_mul_u32_u24 v5, 9504, v5
    v_add_u32 v5, v5, v9
    s_lshl_b32 s31, s24, 2
    s_add_u32 s31, s31, s20
    v_lshlrev_b32 v8, 4, v8
    v_lshl_add_u32 v8, v7, 8, v8
    v_lshl_add_u32 v7, s31, 2, v3
    v_mul_u32_u24 v9, 57, v7
    v_lshrrev_b32 v9, 13, v9
    v_mul_u32_u24 v10, 144, v9
    v_sub_u32 v10, v7, v10
    v_mul_u32_u24 v12, 57, v10
    v_lshrrev_b32 v12, 9, v12
    v_mul_u32_u24 v13, 9, v12
    v_sub_u32 v13, v10, v13
    v_cmp_lt_u32 s[36:37], 4, v13
    v_cmp_eq_u32 s[38:39], 4, v13
    v_cmp_eq_u32 s[40:41], 2, v9
    v_lshlrev_b32 v14, 1, v9
    v_add_u32 v15, 1, v14
    v_subrev_u32 v10, 5, v13
    v_cndmask_b32 v14, v14, v15, s[36:37]
    v_cndmask_b32 v13, v13, v10, s[36:37]
    v_cndmask_b32 v14, v14, 6, s[38:39]
    v_cndmask_b32 v13, v13, v9, s[38:39]
    s_and_b64 s[40:41], s[40:41], s[38:39]
    s_mov_b32 s31, 129024
    v_mul_lo_u32 v9, v12, s31
    v_add_u32 v9, v9, v8
    v_lshl_add_u32 v9, v14, 10, v9
    v_lshl_add_u32 v9, v13, 6, v9
    s_and_b32 s31, s25, 1
    v_lshrrev_b32 v8, 3, v2
    v_cmp_eq_u32 vcc, s31, v8
    v_add_u32 v15, 64, v9
    v_cndmask_b32 v15, v6, v15, s[40:41]
    v_cndmask_b32 v8, v6, v9, vcc
    v_lshlrev_b32 v10, 2, v2
    v_lshl_add_u32 v10, v7, 4, v10
    v_cmp_gt_u32 vcc, 4, v2
    s_lshl_b32 s45, s25, 13
    s_add_u32 s45, s45, 0x4400000
    v_cndmask_b32 v10, v6, v10, vcc
    s_mul_i32 s42, s25, 28672
    s_add_u32 s42, s42, 0x3800000
    s_lshr_b32 s44, s25, 1
    s_mul_i32 s44, s44, 7168
    s_add_u32 s44, s44, 0x381c000
    s_mul_i32 s26, s24, 29
    s_lshr_b32 s26, s26, 8
    s_mul_i32 s27, s26, 9
    s_sub_u32 s27, s24, s27
    s_lshl_b32 s27, s27, 4
    s_add_u32 s28, s27, 16
    v_lshrrev_b32 v254, 4, v1
    v_mul_u32_u24 v7, 9, v254
    v_add_u32 v255, 9, v7
    v_min_u32 v255, s28, v255
    v_max_u32 v7, s27, v7
    v_sub_u32 v255, v255, v7
    v_cmp_lt_i32 vcc, 0, v255
    v_lshlrev_b32 v254, 8, v254
    v_mov_b32 v14, 0x3f003f00
    v_cndmask_b32 v254, v6, v254, vcc
    s_cmp_eq_u64 s[40:41], 0
    s_cbranch_scc1 L_p0_np
    v_mov_b32 v52, 0
    v_mov_b32 v53, 0
    v_mov_b32 v54, 0
    v_mov_b32 v55, 0
    s_add_u32 s31, s42, 0
    buffer_store_dwordx4 v[52:55], v15, s[4:7], s31 offen sc1
    s_add_u32 s31, s42, 7168
    buffer_store_dwordx4 v[52:55], v15, s[4:7], s31 offen sc1
    s_add_u32 s31, s42, 14336
    buffer_store_dwordx4 v[52:55], v15, s[4:7], s31 offen sc1
    s_add_u32 s31, s42, 21504
    buffer_store_dwordx4 v[52:55], v15, s[4:7], s31 offen sc1
    s_mov_b32 s31, s44
    buffer_store_dwordx4 v[52:55], v15, s[4:7], s31 offen sc1
    s_waitcnt vmcnt(5)
    s_branch L_p0_n3
L_p0_np:
    s_waitcnt vmcnt(0)
L_p0_n3:
    s_barrier
    ds_read_b64_tr_b16 v[16:17], v4 offset:0
    ds_read_b64_tr_b16 v[18:19], v4 offset:512
    ds_read_b64_tr_b16 v[20:21], v4 offset:4224
    ds_read_b64_tr_b16 v[22:23], v4 offset:4736
    ds_read_b64_tr_b16 v[24:25], v4 offset:9504
    ds_read_b64_tr_b16 v[26:27], v4 offset:10016
    ds_read_b64_tr_b16 v[28:29], v4 offset:13728
    ds_read_b64_tr_b16 v[30:31], v4 offset:14240
    ds_read_b64_tr_b16 v[32:33], v5 offset:8448
    ds_read_b64_tr_b16 v[34:35], v5 offset:8960
    s_waitcnt lgkmcnt(8)
    s_add_u32 s31, s42, 0
    buffer_store_dwordx4 v[16:19], v9, s[4:7], s31 offen sc1
    s_waitcnt lgkmcnt(6)
    s_add_u32 s31, s42, 7168
    buffer_store_dwordx4 v[20:23], v9, s[4:7], s31 offen sc1
    s_waitcnt lgkmcnt(4)
    s_add_u32 s31, s42, 14336
    buffer_store_dwordx4 v[24:27], v9, s[4:7], s31 offen sc1
    s_waitcnt lgkmcnt(2)
    s_add_u32 s31, s42, 21504
    buffer_store_dwordx4 v[28:31], v9, s[4:7], s31 offen sc1
    s_waitcnt lgkmcnt(0)
    s_mov_b32 s31, s44
    buffer_store_dwordx4 v[32:35], v8, s[4:7], s31 offen sc1
    v_dot2_f32_bf16 v12, v16, v11, 0
    v_dot2_f32_bf16 v13, v17, v11, 0
    v_dot2_f32_bf16 v12, v18, v11, v12
    v_dot2_f32_bf16 v13, v19, v11, v13
    v_dot2_f32_bf16 v12, v20, v11, v12
    v_dot2_f32_bf16 v13, v21, v11, v13
    v_dot2_f32_bf16 v12, v22, v11, v12
    v_dot2_f32_bf16 v13, v23, v11, v13
    v_dot2_f32_bf16 v12, v24, v11, v12
    v_dot2_f32_bf16 v13, v25, v11, v13
    v_dot2_f32_bf16 v12, v26, v11, v12
    v_dot2_f32_bf16 v13, v27, v11, v13
    v_dot2_f32_bf16 v12, v28, v11, v12
    v_dot2_f32_bf16 v13, v29, v11, v13
    v_dot2_f32_bf16 v12, v30, v11, v12
    v_dot2_f32_bf16 v13, v31, v11, v13
    v_dot2_f32_bf16 v12, v32, v14, v12
    v_dot2_f32_bf16 v13, v33, v14, v13
    v_dot2_f32_bf16 v12, v34, v14, v12
    v_dot2_f32_bf16 v13, v35, v14, v13
    s_nop 2
    v_add_f32 v12, v12, v13
    s_nop 1
    v_add_f32_dpp v12, v12, v12 row_ror:4 row_mask:0xf bank_mask:0xf
    s_nop 1
    v_add_f32_dpp v12, v12, v12 row_ror:8 row_mask:0xf bank_mask:0xf
    buffer_store_dword v12, v10, s[4:7], s45 offen sc1
    s_branch L_p0_ce
L_p0_x:
    s_mov_b32 s32, s36
    s_mov_b32 s33, s37
    s_mov_b32 s34, 0x240000
    s_mov_b32 s35, 0x20000
    s_mul_i32 s26, s2, 18432
    s_mul_i32 s31, s20, 288
    s_add_u32 s28, s26, s31
    v_lshrrev_b32 v4, 6, v1
    v_mul_u32_u24 v4, 1152, v4
    v_and_b32 v5, 48, v1
    v_add_u32 v4, v4, v5
    s_add_u32 m0, s30, 0
    s_add_u32 s31, s28, 0
    buffer_load_dwordx4 v4, s[32:35], s31 offen  lds
    s_add_u32 m0, s30, 1024
    s_add_u32 s31, s28, 64
    buffer_load_dwordx4 v4, s[32:35], s31 offen  lds
    s_add_u32 m0, s30, 2048
    s_add_u32 s31, s28, 144
    buffer_load_dwordx4 v4, s[32:35], s31 offen  lds
    s_add_u32 m0, s30, 3072
    s_add_u32 s31, s28, 208
    buffer_load_dwordx4 v4, s[32:35], s31 offen  lds
    s_mul_i32 s31, s29, 576
    s_add_u32 s31, s31, s26
    v_mul_u32_u24 v7, 1152, v2
    v_mul_u32_u24 v5, 144, v3
    v_add_u32 v5, v5, v7
    buffer_load_dwordx4 v[32:35], v5, s[32:35], s31 offen offset:128
    s_lshl_b32 s27, s29, 10
    s_add_u32 s27, s27, 16384
    s_barrier
    v_lshlrev_b32 v4, 6, v2
    v_lshl_add_u32 v4, v3, 4, v4
    v_add_u32 v4, s30, v4
    s_add_u32 s26, s26, 0x0
    s_add_u32 s42, s26, s30
    s_add_u32 s44, s26, s27
    s_lshl_b32 s45, s2, 10
    s_lshl_b32 s31, s20, 8
    s_add_u32 s45, s45, s31
    s_add_u32 s45, s45, 0x1b00000
    v_cmp_gt_u32 vcc, 2, v3
    v_lshrrev_b32 v10, 1, v1
    s_mov_b32 s46, 2
    v_cndmask_b32 v10, v6, v10, vcc
    s_lshr_b32 s27, s2, 3
    s_add_u32 s27, s27, 48
    s_waitcnt vmcnt(0)
    ds_read_b128 v[16:19], v4 offset:0
    ds_read_b128 v[20:23], v4 offset:1024
    ds_read_b128 v[24:27], v4 offset:2048
    ds_read_b128 v[28:31], v4 offset:3072
    s_waitcnt lgkmcnt(3)
    buffer_store_dwordx4 v[16:19], v1, s[4:7], s42 offen offset:0 sc1
    s_waitcnt lgkmcnt(2)
    buffer_store_dwordx4 v[20:23], v1, s[4:7], s42 offen offset:1024 sc1
    s_waitcnt lgkmcnt(1)
    buffer_store_dwordx4 v[24:27], v1, s[4:7], s42 offen offset:2048 sc1
    s_waitcnt lgkmcnt(0)
    buffer_store_dwordx4 v[28:31], v1, s[4:7], s42 offen offset:3072 sc1
    v_dot2_f32_bf16 v12, v16, v11, 0
    v_dot2_f32_bf16 v13, v16, v16, 0
    v_dot2_f32_bf16 v12, v17, v11, v12
    v_dot2_f32_bf16 v13, v17, v17, v13
    v_dot2_f32_bf16 v12, v18, v11, v12
    v_dot2_f32_bf16 v13, v18, v18, v13
    v_dot2_f32_bf16 v12, v19, v11, v12
    v_dot2_f32_bf16 v13, v19, v19, v13
    v_dot2_f32_bf16 v12, v20, v11, v12
    v_dot2_f32_bf16 v13, v20, v20, v13
    v_dot2_f32_bf16 v12, v21, v11, v12
    v_dot2_f32_bf16 v13, v21, v21, v13
    v_dot2_f32_bf16 v12, v22, v11, v12
    v_dot2_f32_bf16 v13, v22, v22, v13
    v_dot2_f32_bf16 v12, v23, v11, v12
    v_dot2_f32_bf16 v13, v23, v23, v13
    v_dot2_f32_bf16 v12, v24, v11, v12
    v_dot2_f32_bf16 v13, v24, v24, v13
    v_dot2_f32_bf16 v12, v25, v11, v12
    v_dot2_f32_bf16 v13, v25, v25, v13
    v_dot2_f32_bf16 v12, v26, v11, v12
    v_dot2_f32_bf16 v13, v26, v26, v13
    v_dot2_f32_bf16 v12, v27, v11, v12
    v_dot2_f32_bf16 v13, v27, v27, v13
    v_dot2_f32_bf16 v12, v28, v11, v12
    v_dot2_f32_bf16 v13, v28, v28, v13
    v_dot2_f32_bf16 v12, v29, v11, v12
    v_dot2_f32_bf16 v13, v29, v29, v13
    v_dot2_f32_bf16 v12, v30, v11, v12
    v_dot2_f32_bf16 v13, v30, v30, v13
    v_dot2_f32_bf16 v12, v31, v11, v12
    v_dot2_f32_bf16 v13, v31, v31, v13
    s_waitcnt lgkmcnt(0)
    s_cmp_ge_u32 s20, 2
    s_cbranch_scc1 L_p0_xs
    buffer_store_dwordx4 v[32:35], v1, s[4:7], s44 offen sc1
    v_dot2_f32_bf16 v12, v32, v11, v12
    v_dot2_f32_bf16 v13, v32, v32, v13
    v_dot2_f32_bf16 v12, v33, v11, v12
    v_dot2_f32_bf16 v13, v33, v33, v13
    v_dot2_f32_bf16 v12, v34, v11, v12
    v_dot2_f32_bf16 v13, v34, v34, v13
    v_dot2_f32_bf16 v12, v35, v11, v12
    v_dot2_f32_bf16 v13, v35, v35, v13
L_p0_xs:
    s_nop 2
    v_mov_b32 v14, v12
    v_mov_b32 v15, v13
    s_nop 1
    v_permlane32_swap_b32 v12, v14
    v_permlane32_swap_b32 v13, v15
    v_add_f32 v12, v12, v14
    v_add_f32 v13, v13, v15
    buffer_store_dwordx2 v[12:13], v10, s[4:7], s45 offen sc1
L_p0_cd:
    v_cmp_eq_u32 vcc, 0, v1
    s_lshl_b32 s27, s27, 8
    v_mov_b32 v255, s46
    v_mov_b32 v254, s27
    v_cndmask_b32 v254, v6, v254, vcc
L_p0_ce:
    s_mov_b32 s48, s58
    s_mov_b32 s49, s59
    s_mov_b32 s50, 0x100
    s_mov_b32 s51, 0x20000
    v_mov_b32 v4, 0
    buffer_load_dword v246, v4, s[48:51], 0 offen sc1
    s_mov_b32 s16, s56
    s_mov_b32 s17, s57
    s_mov_b32 s18, 0x240000
    s_mov_b32 s19, 0x20000
    s_branch L_m_cl
L_d1_first:
    v_cmp_gt_u32 vcc, 4, v246
    v_mov_b32 v4, 0
    s_mov_b32 s46, 0x4500000
    s_cbranch_vccz L_pd_dbg
    s_mov_b32 s60, 65536
L_poll_dbg:
    buffer_load_dword v5, v4, s[48:51], 0 offen sc1
    s_waitcnt vmcnt(0)
    v_cmp_gt_u32 vcc, 4, v5
    s_sub_u32 s60, s60, 1
    s_cbranch_scc1 L_pd_dbg
    s_cbranch_vccz L_pd_dbg
    s_sleep 4
    s_branch L_poll_dbg
L_pd_dbg:
    buffer_atomic_add v255, v254, s[4:7], s46 offen sc1
    s_branch L_ns_d1
L_ld_m:
    s_cmp_lg_u32 s2, 254
    s_cbranch_scc1 L_p0_nz
    s_lshl_b32 s31, s20, 12
    s_add_u32 s31, s31, 0x4500000
    v_and_b32 v56, 0x380, v1
    v_add_u32 v56, v56, v1
    v_mov_b32 v52, 0
    v_mov_b32 v53, 0
    v_mov_b32 v54, 0
    v_mov_b32 v55, 0
    buffer_store_dwordx4 v[52:55], v56, s[4:7], s31 offen offset:0 sc1
    buffer_store_dwordx4 v[52:55], v56, s[4:7], s31 offen offset:2048 sc1
    s_waitcnt vmcnt(0)
    s_mov_b32 s53, 1
    s_atomic_add s53, s[58:59], 0
L_p0_nz:
    s_mov_b32 s8, s46
    s_mov_b32 s9, s47
    s_mov_b32 s10, 0x800000
    s_mov_b32 s11, 0x20000
    s_mov_b32 s12, s48
    s_mov_b32 s13, s49
    s_mov_b32 s14, 0x1000
    s_mov_b32 s15, 0x20000
    v_mov_b32 v2, 163808
    v_mov_b32 v4, 0
    v_mov_b32 v5, 0
    ds_write2_b64 v2, v[4:5], v[4:5] offset0:0 offset1:1
    s_waitcnt lgkmcnt(0)
    v_bfe_u32 v2, v1, 4, 4
    v_lshrrev_b32 v3, 8, v1
    v_bfrev_b32 v6, 1
    v_mov_b32 v11, 0x3f803f80
    s_mul_i32 s30, s20, 9216
    s_cmp_lt_u32 s2, 144
    s_cbranch_scc1 L_p0_wi
    s_cmp_lt_u32 s2, 216
    s_cbranch_scc1 L_p0_wu
    v_mov_b32 v9, v6
    v_mov_b32 v10, v6
    v_mov_b32 v14, v6
    v_mov_b32 v15, v6
    s_mov_b32 s37, 0
    s_mov_b32 s38, 0
    s_mov_b32 s39, 0
    s_mov_b32 s40, 0
    s_mov_b32 s41, 0
    s_mov_b32 s42, 0
    s_mov_b32 s43, 0
    s_mov_b32 s47, 0
    s_mov_b32 s48, 0
    s_mov_b32 s49, 0
    s_barrier
    s_barrier
    s_barrier
    s_branch L_p0_ld
L_p0_wu:
    s_sub_u32 s26, s2, 144
    s_mul_i32 s28, s26, 57
    s_lshr_b32 s28, s28, 9
    s_mul_i32 s27, s28, 9
    s_sub_u32 s27, s26, s27
    s_mov_b32 s32, s50
    s_mov_b32 s33, s51
    s_mov_b32 s34, 0x288000
    s_mov_b32 s35, 0x20000
    s_mul_i32 s29, s28, 331776
    s_lshl_b32 s31, s27, 7
    s_add_u32 s29, s29, s31
    s_mul_i32 s31, s20, 82944
    s_add_u32 s29, s29, s31
    s_mul_i32 s30, s20, 9216
    v_lshrrev_b32 v4, 7, v1
    v_mul_u32_u24 v4, 1152, v4
    v_and_b32 v5, 0x70, v1
    v_bfe_u32 v7, v1, 8, 2
    v_lshlrev_b32 v7, 5, v7
    v_xor_b32 v5, v5, v7
    v_add_u32 v4, v4, v5
    s_barrier
    s_barrier
    s_barrier
    s_add_u32 m0, s30, 91904
    s_add_u32 s31, s29, 0
    buffer_load_dwordx4 v4, s[32:35], s31 offen  lds
    s_add_u32 m0, s30, 92928
    s_add_u32 s31, s29, 9216
    buffer_load_dwordx4 v4, s[32:35], s31 offen  lds
    s_add_u32 m0, s30, 93952
    s_add_u32 s31, s29, 18432
    buffer_load_dwordx4 v4, s[32:35], s31 offen  lds
    s_add_u32 m0, s30, 94976
    s_add_u32 s31, s29, 27648
    buffer_load_dwordx4 v4, s[32:35], s31 offen  lds
    s_add_u32 m0, s30, 96000
    s_add_u32 s31, s29, 36864
    buffer_load_dwordx4 v4, s[32:35], s31 offen  lds
    s_add_u32 m0, s30, 97024
    s_add_u32 s31, s29, 46080
    buffer_load_dwordx4 v4, s[32:35], s31 offen  lds
    s_add_u32 m0, s30, 98048
    s_add_u32 s31, s29, 55296
    buffer_load_dwordx4 v4, s[32:35], s31 offen  lds
    s_add_u32 m0, s30, 99072
    s_add_u32 s31, s29, 64512
    buffer_load_dwordx4 v4, s[32:35], s31 offen  lds
    s_add_u32 m0, s30, 100096
    s_add_u32 s31, s29, 73728
    buffer_load_dwordx4 v4, s[32:35], s31 offen  lds
    v_lshrrev_b32 v7, 2, v2
    v_and_b32 v8, 3, v2
    v_bfe_u32 v9, v1, 7, 2
    v_xor_b32 v9, s20, v9
    v_lshlrev_b32 v9, 5, v9
    v_lshl_add_u32 v9, v7, 7, v9
    v_lshl_add_u32 v9, v8, 3, v9
    v_add_u32 v9, 91904, v9
    v_mul_u32_u24 v4, 512, v3
    v_add_u32 v4, v4, v9
    v_mul_u32_u24 v5, 512, v3
    v_add_u32 v5, v5, v9
    s_lshl_b32 s31, s27, 2
    s_add_u32 s31, s31, s20
    v_lshl_add_u32 v7, s31, 2, v7
    v_lshlrev_b32 v8, 4, v8
    v_lshl_add_u32 v8, v3, 8, v8
    v_mul_u32_u24 v9, 57, v7
    v_lshrrev_b32 v9, 10, v9
    v_mul_u32_u24 v10, 18, v9
    v_sub_u32 v10, v7, v10
    v_lshrrev_b32 v12, 3, v10
    v_and_b32 v13, 1, v10
    v_lshl_add_u32 v12, v12, 1, v13
    v_bfe_u32 v14, v10, 1, 2
    v_cmp_gt_u32 vcc, 16, v10
    v_mul_u32_u24 v9, 331776, v9
    v_add_u32 v9, v9, v8
    v_cndmask_b32 v12, 8, v12, vcc
    v_cndmask_b32 v14, v13, v14, vcc
    v_mov_b32 v15, 0x1000
    v_mov_b32 v13, 0x80
    v_cndmask_b32 v15, v13, v15, vcc
    v_lshl_add_u32 v9, v12, 10, v9
    v_lshl_add_u32 v9, v14, 6, v9
    v_add_u32 v10, v9, v15
    s_and_b32 s31, s28, 1
    s_cmp_eq_u32 s31, 1
    s_cselect_b64 vcc, -1, 0
    v_cndmask_b32 v14, v9, v10, vcc
    s_mul_i32 s31, s28, 9216
    s_add_u32 s37, s31, 0x4100000
    s_add_u32 s38, s31, 0x4100000
    s_add_u32 s39, s31, 0x4112000
    s_add_u32 s40, s31, 0x4112000
    s_add_u32 s41, s31, 0x4124000
    s_add_u32 s42, s31, 0x4124000
    s_add_u32 s43, s31, 0x4136000
    s_add_u32 s47, s31, 0x4136000
    s_lshr_b32 s31, s28, 1
    s_mul_i32 s31, s31, 9216
    s_add_u32 s48, s31, 0x4148000
    v_mov_b32 v15, v6
    s_mov_b32 s49, 0
    s_branch L_p0_ld
L_p0_wi:
    s_mov_b32 s26, s2
    s_mul_i32 s28, s26, 57
    s_lshr_b32 s28, s28, 12
    s_mul_i32 s27, s28, 72
    s_sub_u32 s27, s26, s27
    s_mov_b32 s32, s44
    s_mov_b32 s33, s45
    s_mov_b32 s34, 0x510000
    s_mov_b32 s35, 0x20000
    s_mul_i32 s29, s28, 2654208
    s_lshl_b32 s31, s27, 7
    s_add_u32 s29, s29, s31
    s_mul_i32 s31, s20, 663552
    s_add_u32 s29, s29, s31
    s_mul_i32 s30, s20, 9792
    v_lshrrev_b32 v4, 7, v1
    v_mul_u32_u24 v4, 9216, v4
    v_and_b32 v5, 0x70, v1
    v_bfe_u32 v7, v1, 8, 1
    v_lshlrev_b32 v7, 5, v7
    v_xor_b32 v5, v5, v7
    v_add_u32 v4, v4, v5
    s_barrier
    s_barrier
    s_barrier
    s_add_u32 m0, s30, 91904
    s_add_u32 s31, s29, 0
    buffer_load_dwordx4 v4, s[32:35], s31 offen  lds
    s_add_u32 m0, s30, 92992
    s_add_u32 s31, s29, 73728
    buffer_load_dwordx4 v4, s[32:35], s31 offen  lds
    s_add_u32 m0, s30, 94080
    s_add_u32 s31, s29, 147456
    buffer_load_dwordx4 v4, s[32:35], s31 offen  lds
    s_add_u32 m0, s30, 95168
    s_add_u32 s31, s29, 221184
    buffer_load_dwordx4 v4, s[32:35], s31 offen  lds
    s_add_u32 m0, s30, 96256
    s_add_u32 s31, s29, 294912
    buffer_load_dwordx4 v4, s[32:35], s31 offen  lds
    s_add_u32 m0, s30, 97344
    s_add_u32 s31, s29, 368640
    buffer_load_dwordx4 v4, s[32:35], s31 offen  lds
    s_add_u32 m0, s30, 98432
    s_add_u32 s31, s29, 442368
    buffer_load_dwordx4 v4, s[32:35], s31 offen  lds
    s_add_u32 m0, s30, 99520
    s_add_u32 s31, s29, 516096
    buffer_load_dwordx4 v4, s[32:35], s31 offen  lds
    s_add_u32 m0, s30, 100608
    s_add_u32 s31, s29, 589824
    buffer_load_dwordx4 v4, s[32:35], s31 offen  lds
    v_lshrrev_b32 v7, 2, v2
    v_and_b32 v8, 3, v2
    v_bfe_u32 v9, v1, 7, 1
    v_xor_b32 v9, s20, v9
    v_lshlrev_b32 v9, 5, v9
    v_lshl_add_u32 v9, v7, 7, v9
    v_lshl_add_u32 v9, v8, 3, v9
    v_add_u32 v9, 91904, v9
    v_mul_u32_u24 v4, 1088, v3
    v_add_u32 v4, v4, v9
    v_mul_u32_u24 v5, 9792, v3
    v_add_u32 v5, v5, v9
    s_lshl_b32 s31, s27, 2
    s_add_u32 s31, s31, s20
    v_lshl_add_u32 v7, s31, 2, v7
    v_lshlrev_b32 v8, 4, v8
    v_lshl_add_u32 v8, v3, 8, v8
    s_cmp_lt_u32 s31, 144
    s_cselect_b32 s23, 1, 0
    s_cselect_b32 s24, 0, 144
    s_sub_u32 s26, s31, s24
    s_mul_i32 s25, s26, 57
    s_lshr_b32 s25, s25, 9
    s_mul_i32 s24, s25, 9
    s_sub_u32 s24, s26, s24
    s_lshl_b32 s26, s25, 1
    s_add_u32 s26, s26, s23
    s_mul_i32 s26, s26, 165888
    s_lshl_b32 s31, s24, 10
    s_add_u32 s26, s26, s31
    s_add_u32 s26, s26, 0x3b00000
    s_mul_i32 s31, s28, 9216
    s_add_u32 s48, s26, s31
    s_add_u32 s48, s48, 147456
    s_lshl_b32 s31, s31, 3
    s_add_u32 s26, s26, s31
    s_add_u32 s37, s26, 0
    s_add_u32 s38, s26, 9216
    s_add_u32 s39, s26, 18432
    s_add_u32 s40, s26, 27648
    s_add_u32 s41, s26, 36864
    s_add_u32 s42, s26, 46080
    s_add_u32 s43, s26, 55296
    s_add_u32 s47, s26, 64512
    s_lshl_b32 s49, s25, 12
    s_mul_i32 s31, s28, 1152
    s_add_u32 s49, s49, s31
    s_mul_i32 s31, s23, 576
    s_add_u32 s49, s49, s31
    s_lshl_b32 s31, s24, 6
    s_add_u32 s49, s49, s31
    s_add_u32 s49, s49, 0x4410000
    v_cmp_eq_u32 vcc, 0, v3
    v_lshlrev_b32 v15, 2, v2
    v_mov_b32 v9, v1
    v_mov_b32 v10, v1
    v_mov_b32 v14, v1
    v_cndmask_b32 v15, v6, v15, vcc
L_p0_ld:
    s_waitcnt lgkmcnt(0)
    s_branch L_m_l1
L_m_cl:
    s_and_b32 s25, s2, 7
    s_lshr_b32 s26, s2, 3
    s_lshr_b32 s23, s25, 1
    s_lshl_b32 s23, s23, 2
    s_lshr_b32 s27, s26, 3
    s_add_u32 s23, s23, s27
    s_and_b32 s24, s25, 1
    s_lshl_b32 s24, s24, 3
    s_and_b32 s27, s26, 7
    s_add_u32 s24, s24, s27
    s_lshl_b32 s30, s23, 3
    s_lshl_b32 s31, s20, 1
    s_add_u32 s31, s30, s31
    s_mul_i32 s29, s31, 18432
    s_add_u32 s29, s29, s21
    s_add_u32 s35, s29, 0x600000
    s_add_u32 s29, s29, 0x0
    s_max_u32 s30, s30, 1
    s_sub_u32 s30, s30, 1
    s_lshl_b32 s30, s30, 10
    s_add_u32 s30, s30, s21
    s_add_u32 s30, s30, 0x1b00000
    s_lshl_b32 s32, s31, 10
    s_add_u32 s32, s32, s21
    s_add_u32 s32, s32, 0x1b00000
    v_bfe_u32 v2, v1, 4, 4
    v_lshrrev_b32 v3, 8, v1
    s_lshl_b32 s33, s20, 2
    s_lshr_b32 s33, 0x3362, s33
    s_and_b32 s33, s33, 15
    s_min_u32 s34, s20, 1
    s_add_u32 s34, s34, 4
    s_lshl_b32 s36, s33, 10
    s_lshl_b32 s37, s34, 10
    v_add_u32 v247, 64512, v1
    v_add_u32 v248, 131072, v1
    v_add_u32 v249, s36, v1
    v_add_u32 v250, s36, v247
    v_add_u32 v251, s37, v1
    v_add_u32 v252, s37, v247
    v_add_u32 v253, 18432, v1
    v_lshrrev_b32 v0, 1, v1
    s_add_u32 s38, s29, 0
    s_add_u32 s39, s29, 4096
    s_add_u32 s40, s29, 8192
    s_add_u32 s41, s29, 12288
    s_add_u32 s42, s29, 16384
    s_max_u32 s44, s23, 1
    s_sub_u32 s44, s44, 1
    s_lshl_b32 s52, s22, 7
    s_add_u32 s52, s52, s23
    s_lshl_b32 s52, s52, 8
    s_add_u32 s52, s52, 0x4503000
    s_add_u32 s52, s52, s4
    s_addc_u32 s53, s5, 0
    s_lshl_b32 s54, s22, 7
    s_add_u32 s54, s54, s44
    s_lshl_b32 s54, s54, 8
    s_add_u32 s54, s54, 0x4503000
    s_add_u32 s54, s54, s4
    s_addc_u32 s55, s5, 0
    s_lshl_b32 s44, s24, 8
    s_add_u32 s44, s44, 0x4500000
    s_add_u32 s44, s44, s4
    s_addc_u32 s45, s5, 0
    s_waitcnt vmcnt(0)
    s_barrier
    s_cmp_lg_u32 s20, 0
    s_cbranch_scc1 L_ns_d1
    s_cmp_eq_u32 s22, 0
    s_cbranch_scc1 L_d1_first
    s_mov_b32 s56, 1
    s_atomic_add s56, s[50:51], 0
L_ns_d1:
    s_barrier
    s_cmp_lg_u32 s20, 0
    s_cbranch_scc1 L_pd_d1
    s_mov_b32 s60, 65536
L_poll_d1:
    s_mov_b32 s57, 0
    s_atomic_add s57, s[52:53], 0 glc
    s_mov_b32 s58, 0
    s_atomic_add s58, s[54:55], 0 glc
    s_mov_b32 s59, 0
    s_atomic_add s59, s[44:45], 0 glc
    s_waitcnt lgkmcnt(0)
    s_cmp_ge_u32 s59, 108
    s_cselect_b32 s59, 16, 0
    s_min_u32 s57, s57, s58
    s_min_u32 s57, s57, s59
    s_cmp_ge_u32 s57, 16
    s_cbranch_scc1 L_pd_d1
    s_sub_u32 s60, s60, 1
    s_cbranch_scc1 L_pd_d1
    s_sleep 2
    s_branch L_poll_d1
L_pd_d1:
    s_barrier
    buffer_load_dwordx4 v[160:163], v1, s[4:7], s38 offen offset:0 sc1
    buffer_load_dwordx4 v[164:167], v253, s[4:7], s38 offen offset:0 sc1
    buffer_load_dwordx4 v[168:171], v1, s[4:7], s38 offen offset:1024 sc1
    buffer_load_dwordx4 v[172:175], v253, s[4:7], s38 offen offset:1024 sc1
    buffer_load_dwordx4 v[176:179], v1, s[4:7], s38 offen offset:2048 sc1
    buffer_load_dwordx4 v[180:183], v253, s[4:7], s38 offen offset:2048 sc1
    buffer_load_dwordx4 v[184:187], v1, s[4:7], s38 offen offset:3072 sc1
    buffer_load_dwordx4 v[188:191], v253, s[4:7], s38 offen offset:3072 sc1
    s_barrier
    ds_read_b128 v[80:83], v1 offset:0
    ds_read_b128 v[84:87], v1 offset:1024
    ds_read_b128 v[88:91], v1 offset:2048
    ds_read_b128 v[92:95], v1 offset:3072
    ds_read_b128 v[96:99], v1 offset:4096
    ds_read_b128 v[100:103], v1 offset:5120
    ds_read_b128 v[104:107], v1 offset:6144
    buffer_load_dwordx2 v[4:5], v0, s[4:7], s30 offen offset:0 sc1
    buffer_load_dwordx2 v[6:7], v0, s[4:7], s30 offen offset:512 sc1
    buffer_load_dwordx2 v[8:9], v0, s[4:7], s32 offen offset:0 sc1
    buffer_load_dwordx2 v[10:11], v0, s[4:7], s32 offen offset:512 sc1
    buffer_load_dwordx2 v[12:13], v0, s[4:7], s32 offen offset:1024 sc1
    buffer_load_dwordx2 v[14:15], v0, s[4:7], s32 offen offset:1536 sc1
    s_lshl_b32 s50, s22, 7
    s_add_u32 s50, s50, s23
    s_lshl_b32 s50, s50, 8
    s_add_u32 s50, s50, 0x4508000
    s_add_u32 s50, s50, s4
    s_addc_u32 s51, s5, 0
    s_waitcnt vmcnt(12) lgkmcnt(3)
    v_mfma_f32_16x16x32_bf16 v[16:19], v[80:83], v[160:163], 0
    ds_read_b128 v[120:123], v1 offset:7168
    v_mfma_f32_16x16x32_bf16 v[44:47], v[80:83], v[164:167], 0
    ds_read_b128 v[124:127], v1 offset:8192
    v_mfma_f32_16x16x32_bf16 v[20:23], v[84:87], v[160:163], 0
    ds_read_b128 v[128:131], v1 offset:9216
    v_mfma_f32_16x16x32_bf16 v[48:51], v[84:87], v[164:167], 0
    ds_read_b128 v[132:135], v1 offset:10240
    v_mfma_f32_16x16x32_bf16 v[24:27], v[88:91], v[160:163], 0
    ds_read_b128 v[136:139], v1 offset:11264
    v_mfma_f32_16x16x32_bf16 v[52:55], v[88:91], v[164:167], 0
    ds_read_b128 v[140:143], v1 offset:12288
    v_mfma_f32_16x16x32_bf16 v[28:31], v[92:95], v[160:163], 0
    ds_read_b128 v[144:147], v1 offset:13312
    v_mfma_f32_16x16x32_bf16 v[56:59], v[92:95], v[164:167], 0
    s_waitcnt lgkmcnt(7)
    v_mfma_f32_16x16x32_bf16 v[32:35], v[160:163], v[96:99], 0
    v_mfma_f32_16x16x32_bf16 v[60:63], v[164:167], v[96:99], 0
    v_mfma_f32_16x16x32_bf16 v[36:39], v[160:163], v[100:103], 0
    buffer_load_dwordx4 v[192:195], v1, s[4:7], s39 offen offset:0 sc1
    v_mfma_f32_16x16x32_bf16 v[64:67], v[164:167], v[100:103], 0
    buffer_load_dwordx4 v[196:199], v253, s[4:7], s39 offen offset:0 sc1
    v_mfma_f32_16x16x32_bf16 v[40:43], v[104:107], v[160:163], 0
    buffer_load_dwordx4 v[200:203], v1, s[4:7], s39 offen offset:1024 sc1
    v_mfma_f32_16x16x32_bf16 v[68:71], v[104:107], v[164:167], 0
    buffer_load_dwordx4 v[204:207], v253, s[4:7], s39 offen offset:1024 sc1
    s_waitcnt vmcnt(14) lgkmcnt(3)
    s_barrier
    v_mfma_f32_16x16x32_bf16 v[16:19], v[120:123], v[168:171], v[16:19]
    ds_read_b128 v[80:83], v1 offset:14336
    v_mfma_f32_16x16x32_bf16 v[44:47], v[120:123], v[172:175], v[44:47]
    ds_read_b128 v[84:87], v1 offset:15360
    v_mfma_f32_16x16x32_bf16 v[20:23], v[124:127], v[168:171], v[20:23]
    ds_read_b128 v[88:91], v1 offset:16384
    v_mfma_f32_16x16x32_bf16 v[48:51], v[124:127], v[172:175], v[48:51]
    ds_read_b128 v[92:95], v1 offset:17408
    v_mfma_f32_16x16x32_bf16 v[24:27], v[128:131], v[168:171], v[24:27]
    ds_read_b128 v[96:99], v1 offset:18432
    v_mfma_f32_16x16x32_bf16 v[52:55], v[128:131], v[172:175], v[52:55]
    ds_read_b128 v[100:103], v1 offset:19456
    v_mfma_f32_16x16x32_bf16 v[28:31], v[132:135], v[168:171], v[28:31]
    ds_read_b128 v[104:107], v1 offset:20480
    v_mfma_f32_16x16x32_bf16 v[56:59], v[132:135], v[172:175], v[56:59]
    ds_read_b128 v[108:111], v248 offset:0
    s_waitcnt lgkmcnt(8)
    v_mfma_f32_16x16x32_bf16 v[32:35], v[168:171], v[136:139], v[32:35]
    ds_read_b128 v[112:115], v249 offset:0
    v_mfma_f32_16x16x32_bf16 v[60:63], v[172:175], v[136:139], v[60:63]
    ds_read_b128 v[116:119], v251 offset:0
    v_mfma_f32_16x16x32_bf16 v[36:39], v[168:171], v[140:143], v[36:39]
    buffer_load_dwordx4 v[160:163], v1, s[4:7], s39 offen offset:2048 sc1
    v_mfma_f32_16x16x32_bf16 v[64:67], v[172:175], v[140:143], v[64:67]
    buffer_load_dwordx4 v[164:167], v253, s[4:7], s39 offen offset:2048 sc1
    v_mfma_f32_16x16x32_bf16 v[40:43], v[144:147], v[168:171], v[40:43]
    v_mfma_f32_16x16x32_bf16 v[68:71], v[144:147], v[172:175], v[68:71]
    s_waitcnt vmcnt(6) lgkmcnt(6)
    v_mfma_f32_16x16x32_bf16 v[16:19], v[80:83], v[176:179], v[16:19]
    ds_read_b128 v[120:123], v1 offset:21504
    v_mfma_f32_16x16x32_bf16 v[44:47], v[80:83], v[180:183], v[44:47]
    ds_read_b128 v[124:127], v1 offset:22528
    v_add_f32 v240, v4, v6
    v_mfma_f32_16x16x32_bf16 v[20:23], v[84:87], v[176:179], v[20:23]
    ds_read_b128 v[128:131], v1 offset:23552
    v_add_f32 v241, v5, v7
    v_mfma_f32_16x16x32_bf16 v[48:51], v[84:87], v[180:183], v[48:51]
    ds_read_b128 v[132:135], v1 offset:24576
    v_add_f32 v242, v8, v10
    v_mfma_f32_16x16x32_bf16 v[24:27], v[88:91], v[176:179], v[24:27]
    ds_read_b128 v[136:139], v1 offset:25600
    v_add_f32 v243, v9, v11
    v_mfma_f32_16x16x32_bf16 v[52:55], v[88:91], v[180:183], v[52:55]
    ds_read_b128 v[140:143], v1 offset:26624
    v_add_f32 v244, v12, v14
    v_mfma_f32_16x16x32_bf16 v[28:31], v[92:95], v[176:179], v[28:31]
    ds_read_b128 v[144:147], v1 offset:27648
    v_add_f32 v245, v13, v15
    v_mfma_f32_16x16x32_bf16 v[56:59], v[92:95], v[180:183], v[56:59]
    ds_read_b128 v[148:151], v248 offset:1024
    s_waitcnt lgkmcnt(8)
    v_mfma_f32_16x16x32_bf16 v[32:35], v[176:179], v[96:99], v[32:35]
    ds_read_b128 v[152:155], v249 offset:7168
    v_mov_b32 v4, v240
    v_mfma_f32_16x16x32_bf16 v[60:63], v[180:183], v[96:99], v[60:63]
    ds_read_b128 v[156:159], v251 offset:7168
    v_mov_b32 v5, v241
    v_mfma_f32_16x16x32_bf16 v[36:39], v[176:179], v[100:103], v[36:39]
    buffer_load_dwordx4 v[168:171], v1, s[4:7], s39 offen offset:3072 sc1
    v_mfma_f32_16x16x32_bf16 v[64:67], v[180:183], v[100:103], v[64:67]
    buffer_load_dwordx4 v[172:175], v253, s[4:7], s39 offen offset:3072 sc1
    v_mfma_f32_16x16x32_bf16 v[40:43], v[104:107], v[176:179], v[40:43]
    v_mov_b32 v8, v242
    v_mfma_f32_16x16x32_bf16 v[68:71], v[104:107], v[180:183], v[68:71]
    v_mov_b32 v9, v243
    v_mfma_f32_16x16x32_bf16 v[72:75], v[112:115], v[108:111], 0
    v_mov_b32 v12, v244
    v_mov_b32 v13, v245
    v_mfma_f32_16x16x32_bf16 v[76:79], v[108:111], v[116:119], 0
    v_permlane32_swap_b32 v240, v4
    s_waitcnt vmcnt(8) lgkmcnt(6)
    s_barrier
    v_mfma_f32_16x16x32_bf16 v[16:19], v[120:123], v[184:187], v[16:19]
    ds_read_b128 v[80:83], v1 offset:28672
    v_mfma_f32_16x16x32_bf16 v[44:47], v[120:123], v[188:191], v[44:47]
    ds_read_b128 v[84:87], v1 offset:29696
    v_permlane32_swap_b32 v241, v5
    v_mfma_f32_16x16x32_bf16 v[20:23], v[124:127], v[184:187], v[20:23]
    ds_read_b128 v[88:91], v1 offset:30720
    v_permlane32_swap_b32 v242, v8
    v_mfma_f32_16x16x32_bf16 v[48:51], v[124:127], v[188:191], v[48:51]
    ds_read_b128 v[92:95], v1 offset:31744
    v_permlane32_swap_b32 v243, v9
    v_mfma_f32_16x16x32_bf16 v[24:27], v[128:131], v[184:187], v[24:27]
    ds_read_b128 v[96:99], v1 offset:32768
    v_permlane32_swap_b32 v244, v12
    v_mfma_f32_16x16x32_bf16 v[52:55], v[128:131], v[188:191], v[52:55]
    ds_read_b128 v[100:103], v1 offset:33792
    v_permlane32_swap_b32 v245, v13
    v_mfma_f32_16x16x32_bf16 v[28:31], v[132:135], v[184:187], v[28:31]
    ds_read_b128 v[104:107], v1 offset:34816
    v_add_f32 v240, v240, v4
    v_mfma_f32_16x16x32_bf16 v[56:59], v[132:135], v[188:191], v[56:59]
    ds_read_b128 v[108:111], v248 offset:2048
    s_waitcnt lgkmcnt(8)
    v_mfma_f32_16x16x32_bf16 v[32:35], v[184:187], v[136:139], v[32:35]
    ds_read_b128 v[112:115], v249 offset:14336
    v_add_f32 v241, v241, v5
    v_mfma_f32_16x16x32_bf16 v[60:63], v[188:191], v[136:139], v[60:63]
    ds_read_b128 v[116:119], v251 offset:14336
    v_add_f32 v242, v242, v8
    v_mfma_f32_16x16x32_bf16 v[36:39], v[184:187], v[140:143], v[36:39]
    buffer_load_dwordx4 v[176:179], v1, s[4:7], s40 offen offset:0 sc1
    v_mfma_f32_16x16x32_bf16 v[64:67], v[188:191], v[140:143], v[64:67]
    buffer_load_dwordx4 v[180:183], v253, s[4:7], s40 offen offset:0 sc1
    v_mfma_f32_16x16x32_bf16 v[40:43], v[144:147], v[184:187], v[40:43]
    v_add_f32 v243, v243, v9
    v_mfma_f32_16x16x32_bf16 v[68:71], v[144:147], v[188:191], v[68:71]
    v_add_f32 v244, v244, v12
    v_mfma_f32_16x16x32_bf16 v[72:75], v[152:155], v[148:151], v[72:75]
    v_add_f32 v245, v245, v13
    v_mov_b32 v4, v240
    v_mfma_f32_16x16x32_bf16 v[76:79], v[148:151], v[156:159], v[76:79]
    v_mov_b32 v5, v241
    s_waitcnt vmcnt(8) lgkmcnt(6)
    v_mfma_f32_16x16x32_bf16 v[16:19], v[80:83], v[192:195], v[16:19]
    ds_read_b128 v[120:123], v1 offset:35840
    v_mfma_f32_16x16x32_bf16 v[44:47], v[80:83], v[196:199], v[44:47]
    ds_read_b128 v[124:127], v1 offset:36864
    v_mov_b32 v8, v242
    v_mfma_f32_16x16x32_bf16 v[20:23], v[84:87], v[192:195], v[20:23]
    ds_read_b128 v[128:131], v1 offset:37888
    v_mov_b32 v9, v243
    v_mfma_f32_16x16x32_bf16 v[48:51], v[84:87], v[196:199], v[48:51]
    ds_read_b128 v[132:135], v1 offset:38912
    v_mov_b32 v12, v244
    v_mfma_f32_16x16x32_bf16 v[24:27], v[88:91], v[192:195], v[24:27]
    ds_read_b128 v[136:139], v1 offset:39936
    v_mov_b32 v13, v245
    v_mfma_f32_16x16x32_bf16 v[52:55], v[88:91], v[196:199], v[52:55]
    ds_read_b128 v[140:143], v1 offset:40960
    v_permlane16_swap_b32 v240, v4
    v_mfma_f32_16x16x32_bf16 v[28:31], v[92:95], v[192:195], v[28:31]
    ds_read_b128 v[144:147], v1 offset:41984
    v_permlane16_swap_b32 v241, v5
    v_mfma_f32_16x16x32_bf16 v[56:59], v[92:95], v[196:199], v[56:59]
    ds_read_b128 v[148:151], v248 offset:3072
    s_waitcnt lgkmcnt(8)
    v_mfma_f32_16x16x32_bf16 v[32:35], v[192:195], v[96:99], v[32:35]
    ds_read_b128 v[152:155], v249 offset:21504
    v_permlane16_swap_b32 v242, v8
    v_mfma_f32_16x16x32_bf16 v[60:63], v[196:199], v[96:99], v[60:63]
    ds_read_b128 v[156:159], v251 offset:21504
    v_permlane16_swap_b32 v243, v9
    v_mfma_f32_16x16x32_bf16 v[36:39], v[192:195], v[100:103], v[36:39]
    buffer_load_dwordx4 v[184:187], v1, s[4:7], s40 offen offset:1024 sc1
    v_mfma_f32_16x16x32_bf16 v[64:67], v[196:199], v[100:103], v[64:67]
    buffer_load_dwordx4 v[188:191], v253, s[4:7], s40 offen offset:1024 sc1
    v_mfma_f32_16x16x32_bf16 v[40:43], v[104:107], v[192:195], v[40:43]
    v_permlane16_swap_b32 v244, v12
    v_mfma_f32_16x16x32_bf16 v[68:71], v[104:107], v[196:199], v[68:71]
    v_permlane16_swap_b32 v245, v13
    v_mfma_f32_16x16x32_bf16 v[72:75], v[112:115], v[108:111], v[72:75]
    v_add_f32 v240, v240, v4
    v_add_f32 v241, v241, v5
    v_mfma_f32_16x16x32_bf16 v[76:79], v[108:111], v[116:119], v[76:79]
    v_add_f32 v242, v242, v8
    s_waitcnt vmcnt(8) lgkmcnt(6)
    s_barrier
    v_mfma_f32_16x16x32_bf16 v[16:19], v[120:123], v[200:203], v[16:19]
    ds_read_b128 v[80:83], v1 offset:43008
    v_mfma_f32_16x16x32_bf16 v[44:47], v[120:123], v[204:207], v[44:47]
    ds_read_b128 v[84:87], v1 offset:44032
    v_add_f32 v243, v243, v9
    v_mfma_f32_16x16x32_bf16 v[20:23], v[124:127], v[200:203], v[20:23]
    ds_read_b128 v[88:91], v1 offset:45056
    v_add_f32 v244, v244, v12
    v_mfma_f32_16x16x32_bf16 v[48:51], v[124:127], v[204:207], v[48:51]
    ds_read_b128 v[92:95], v1 offset:46080
    v_add_f32 v245, v245, v13
    v_mfma_f32_16x16x32_bf16 v[24:27], v[128:131], v[200:203], v[24:27]
    ds_read_b128 v[96:99], v1 offset:47104
    v_mul_f32 v240, 0x3ae38e39, v240
    v_mfma_f32_16x16x32_bf16 v[52:55], v[128:131], v[204:207], v[52:55]
    ds_read_b128 v[100:103], v1 offset:48128
    v_mul_f32 v241, 0x3ae38e39, v241
    v_mfma_f32_16x16x32_bf16 v[28:31], v[132:135], v[200:203], v[28:31]
    ds_read_b128 v[104:107], v1 offset:49152
    v_mul_f32 v242, 0x3ae38e39, v242
    v_mfma_f32_16x16x32_bf16 v[56:59], v[132:135], v[204:207], v[56:59]
    ds_read_b128 v[108:111], v248 offset:4096
    s_waitcnt lgkmcnt(8)
    v_mfma_f32_16x16x32_bf16 v[32:35], v[200:203], v[136:139], v[32:35]
    ds_read_b128 v[112:115], v249 offset:28672
    v_mul_f32 v243, 0x3ae38e39, v243
    v_mfma_f32_16x16x32_bf16 v[60:63], v[204:207], v[136:139], v[60:63]
    ds_read_b128 v[116:119], v251 offset:28672
    v_mul_f32 v244, 0x3ae38e39, v244
    v_mfma_f32_16x16x32_bf16 v[36:39], v[200:203], v[140:143], v[36:39]
    buffer_load_dwordx4 v[192:195], v1, s[4:7], s40 offen offset:2048 sc1
    v_mfma_f32_16x16x32_bf16 v[64:67], v[204:207], v[140:143], v[64:67]
    buffer_load_dwordx4 v[196:199], v253, s[4:7], s40 offen offset:2048 sc1
    v_mfma_f32_16x16x32_bf16 v[40:43], v[144:147], v[200:203], v[40:43]
    v_mul_f32 v245, 0x3ae38e39, v245
    v_mfma_f32_16x16x32_bf16 v[68:71], v[144:147], v[204:207], v[68:71]
    v_fma_f32 v241, -v240, v240, v241
    v_mfma_f32_16x16x32_bf16 v[72:75], v[152:155], v[148:151], v[72:75]
    v_fma_f32 v243, -v242, v242, v243
    v_fma_f32 v245, -v244, v244, v245
    v_mfma_f32_16x16x32_bf16 v[76:79], v[148:151], v[156:159], v[76:79]
    v_max_f32 v241, 0, v241
    s_waitcnt vmcnt(8) lgkmcnt(6)
    v_mfma_f32_16x16x32_bf16 v[16:19], v[80:83], v[160:163], v[16:19]
    ds_read_b128 v[120:123], v1 offset:50176
    v_mfma_f32_16x16x32_bf16 v[44:47], v[80:83], v[164:167], v[44:47]
    ds_read_b128 v[124:127], v1 offset:51200
    v_max_f32 v243, 0, v243
    v_mfma_f32_16x16x32_bf16 v[20:23], v[84:87], v[160:163], v[20:23]
    ds_read_b128 v[128:131], v1 offset:52224
    v_max_f32 v245, 0, v245
    v_mfma_f32_16x16x32_bf16 v[48:51], v[84:87], v[164:167], v[48:51]
    ds_read_b128 v[132:135], v1 offset:53248
    v_add_f32 v241, 0x3727c5ac, v241
    v_mfma_f32_16x16x32_bf16 v[24:27], v[88:91], v[160:163], v[24:27]
    ds_read_b128 v[136:139], v1 offset:54272
    v_add_f32 v243, 0x3727c5ac, v243
    v_mfma_f32_16x16x32_bf16 v[52:55], v[88:91], v[164:167], v[52:55]
    ds_read_b128 v[140:143], v1 offset:55296
    v_add_f32 v245, 0x3727c5ac, v245
    v_mfma_f32_16x16x32_bf16 v[28:31], v[92:95], v[160:163], v[28:31]
    ds_read_b128 v[144:147], v1 offset:56320
    v_rsq_f32 v241, v241
    v_mfma_f32_16x16x32_bf16 v[56:59], v[92:95], v[164:167], v[56:59]
    ds_read_b128 v[148:151], v248 offset:5120
    s_waitcnt lgkmcnt(8)
    v_mfma_f32_16x16x32_bf16 v[32:35], v[160:163], v[96:99], v[32:35]
    ds_read_b128 v[152:155], v249 offset:35840
    v_rsq_f32 v243, v243
    v_mfma_f32_16x16x32_bf16 v[60:63], v[164:167], v[96:99], v[60:63]
    ds_read_b128 v[156:159], v251 offset:35840
    v_rsq_f32 v245, v245
    v_mfma_f32_16x16x32_bf16 v[36:39], v[160:163], v[100:103], v[36:39]
    buffer_load_dwordx4 v[200:203], v1, s[4:7], s40 offen offset:3072 sc1
    v_mfma_f32_16x16x32_bf16 v[64:67], v[164:167], v[100:103], v[64:67]
    buffer_load_dwordx4 v[204:207], v253, s[4:7], s40 offen offset:3072 sc1
    v_mfma_f32_16x16x32_bf16 v[40:43], v[104:107], v[160:163], v[40:43]
    s_nop 0
    v_mfma_f32_16x16x32_bf16 v[68:71], v[104:107], v[164:167], v[68:71]
    v_lshlrev_b32 v255, 4, v3
    v_mfma_f32_16x16x32_bf16 v[72:75], v[112:115], v[108:111], v[72:75]
    v_add_u32 v236, 161792, v255
    s_lshl_b32 s36, s33, 6
    v_mfma_f32_16x16x32_bf16 v[76:79], v[108:111], v[116:119], v[76:79]
    v_add_u32 v237, s36, v236
    s_waitcnt vmcnt(8) lgkmcnt(6)
    v_mfma_f32_16x16x32_bf16 v[16:19], v[120:123], v[168:171], v[16:19]
    ds_read_b128 v[80:83], v1 offset:57344
    v_mfma_f32_16x16x32_bf16 v[44:47], v[120:123], v[172:175], v[44:47]
    ds_read_b128 v[84:87], v1 offset:58368
    v_lshlrev_b32 v254, 2, v2
    v_mfma_f32_16x16x32_bf16 v[20:23], v[124:127], v[168:171], v[20:23]
    ds_read_b128 v[88:91], v1 offset:59392
    v_add_u32 v238, 161792, v254
    v_mfma_f32_16x16x32_bf16 v[48:51], v[124:127], v[172:175], v[48:51]
    ds_read_b128 v[92:95], v1 offset:60416
    s_lshl_b32 s37, s34, 6
    v_mfma_f32_16x16x32_bf16 v[24:27], v[128:131], v[168:171], v[24:27]
    ds_read_b128 v[96:99], v1 offset:61440
    v_add_u32 v239, s37, v238
    v_mfma_f32_16x16x32_bf16 v[52:55], v[128:131], v[172:175], v[52:55]
    ds_read_b128 v[100:103], v1 offset:62464
    s_mul_i32 s36, s20, 3072
    v_mfma_f32_16x16x32_bf16 v[28:31], v[132:135], v[168:171], v[28:31]
    ds_read_b128 v[104:107], v1 offset:63488
    s_add_u32 s36, s36, 153600
    v_mfma_f32_16x16x32_bf16 v[56:59], v[132:135], v[172:175], v[56:59]
    ds_read_b128 v[108:111], v248 offset:6144
    s_waitcnt lgkmcnt(8)
    v_mfma_f32_16x16x32_bf16 v[32:35], v[168:171], v[136:139], v[32:35]
    ds_read_b128 v[112:115], v249 offset:43008
    v_add_u32 v254, s36, v254
    v_mfma_f32_16x16x32_bf16 v[60:63], v[172:175], v[136:139], v[60:63]
    ds_read_b128 v[116:119], v251 offset:43008
    v_add_u32 v255, s36, v255
    v_mfma_f32_16x16x32_bf16 v[36:39], v[168:171], v[140:143], v[36:39]
    buffer_load_dwordx4 v[160:163], v1, s[4:7], s41 offen offset:0 sc1
    v_mfma_f32_16x16x32_bf16 v[64:67], v[172:175], v[140:143], v[64:67]
    buffer_load_dwordx4 v[164:167], v253, s[4:7], s41 offen offset:0 sc1
    v_mfma_f32_16x16x32_bf16 v[40:43], v[144:147], v[168:171], v[40:43]
    v_mfma_f32_16x16x32_bf16 v[68:71], v[144:147], v[172:175], v[68:71]
    ds_write2_b32 v254, v240, v241 offset0:0 offset1:16
    v_mfma_f32_16x16x32_bf16 v[72:75], v[152:155], v[148:151], v[72:75]
    ds_write2_b32 v254, v242, v243 offset0:32 offset1:48
    v_mfma_f32_16x16x32_bf16 v[76:79], v[148:151], v[156:159], v[76:79]
    ds_write2_b32 v254, v244, v245 offset0:64 offset1:80
    s_waitcnt vmcnt(8) lgkmcnt(9)
    s_barrier
    v_mfma_f32_16x16x32_bf16 v[16:19], v[80:83], v[176:179], v[16:19]
    ds_read_b128 v[120:123], v247 offset:0
    v_mfma_f32_16x16x32_bf16 v[44:47], v[80:83], v[180:183], v[44:47]
    ds_read_b128 v[124:127], v247 offset:1024
    v_mfma_f32_16x16x32_bf16 v[20:23], v[84:87], v[176:179], v[20:23]
    ds_read_b128 v[128:131], v247 offset:2048
    v_mfma_f32_16x16x32_bf16 v[48:51], v[84:87], v[180:183], v[48:51]
    ds_read_b128 v[132:135], v247 offset:3072
    v_mfma_f32_16x16x32_bf16 v[24:27], v[88:91], v[176:179], v[24:27]
    ds_read_b128 v[136:139], v247 offset:4096
    v_mfma_f32_16x16x32_bf16 v[52:55], v[88:91], v[180:183], v[52:55]
    ds_read_b128 v[140:143], v247 offset:5120
    v_mfma_f32_16x16x32_bf16 v[28:31], v[92:95], v[176:179], v[28:31]
    ds_read_b128 v[144:147], v247 offset:6144
    v_mfma_f32_16x16x32_bf16 v[56:59], v[92:95], v[180:183], v[56:59]
    ds_read_b128 v[148:151], v248 offset:7168
    s_waitcnt lgkmcnt(8)
    v_mfma_f32_16x16x32_bf16 v[32:35], v[176:179], v[96:99], v[32:35]
    ds_read_b128 v[152:155], v249 offset:50176
    v_mfma_f32_16x16x32_bf16 v[60:63], v[180:183], v[96:99], v[60:63]
    ds_read_b128 v[156:159], v251 offset:50176
    v_mfma_f32_16x16x32_bf16 v[36:39], v[176:179], v[100:103], v[36:39]
    buffer_load_dwordx4 v[168:171], v1, s[4:7], s41 offen offset:1024 sc1
    ds_read_b128 v[208:211], v236 offset:0
    v_mfma_f32_16x16x32_bf16 v[64:67], v[180:183], v[100:103], v[64:67]
    buffer_load_dwordx4 v[172:175], v253, s[4:7], s41 offen offset:1024 sc1
    ds_read_b128 v[212:215], v236 offset:64
    v_mfma_f32_16x16x32_bf16 v[40:43], v[104:107], v[176:179], v[40:43]
    ds_read_b128 v[216:219], v236 offset:128
    v_mfma_f32_16x16x32_bf16 v[68:71], v[104:107], v[180:183], v[68:71]
    ds_read_b128 v[220:223], v236 offset:192
    v_mfma_f32_16x16x32_bf16 v[72:75], v[112:115], v[108:111], v[72:75]
    ds_read_b128 v[224:227], v236 offset:384
    v_mfma_f32_16x16x32_bf16 v[76:79], v[108:111], v[116:119], v[76:79]
    ds_read_b128 v[228:231], v237
    s_waitcnt vmcnt(8) lgkmcnt(12)
    v_mfma_f32_16x16x32_bf16 v[16:19], v[120:123], v[184:187], v[16:19]
    ds_read_b128 v[80:83], v247 offset:7168
    v_mfma_f32_16x16x32_bf16 v[44:47], v[120:123], v[188:191], v[44:47]
    ds_read_b128 v[84:87], v247 offset:8192
    v_mfma_f32_16x16x32_bf16 v[20:23], v[124:127], v[184:187], v[20:23]
    ds_read_b128 v[88:91], v247 offset:9216
    v_mfma_f32_16x16x32_bf16 v[48:51], v[124:127], v[188:191], v[48:51]
    ds_read_b128 v[92:95], v247 offset:10240
    v_mfma_f32_16x16x32_bf16 v[24:27], v[128:131], v[184:187], v[24:27]
    ds_read_b128 v[96:99], v247 offset:11264
    v_mfma_f32_16x16x32_bf16 v[52:55], v[128:131], v[188:191], v[52:55]
    ds_read_b128 v[100:103], v247 offset:12288
    v_mfma_f32_16x16x32_bf16 v[28:31], v[132:135], v[184:187], v[28:31]
    ds_read_b128 v[104:107], v247 offset:13312
    v_mfma_f32_16x16x32_bf16 v[56:59], v[132:135], v[188:191], v[56:59]
    ds_read_b128 v[108:111], v248 offset:8192
    s_waitcnt lgkmcnt(8)
    v_mfma_f32_16x16x32_bf16 v[32:35], v[184:187], v[136:139], v[32:35]
    ds_read_b128 v[112:115], v249 offset:57344
    v_mfma_f32_16x16x32_bf16 v[60:63], v[188:191], v[136:139], v[60:63]
    ds_read_b128 v[116:119], v251 offset:57344
    v_mfma_f32_16x16x32_bf16 v[36:39], v[184:187], v[140:143], v[36:39]
    buffer_load_dwordx4 v[176:179], v1, s[4:7], s41 offen offset:2048 sc1
    v_mfma_f32_16x16x32_bf16 v[64:67], v[188:191], v[140:143], v[64:67]
    buffer_load_dwordx4 v[180:183], v253, s[4:7], s41 offen offset:2048 sc1
    ds_read2_b32 v[232:233], v238 offset0:64 offset1:80
    v_mfma_f32_16x16x32_bf16 v[40:43], v[144:147], v[184:187], v[40:43]
    ds_read_b32 v234, v239
    v_mfma_f32_16x16x32_bf16 v[68:71], v[144:147], v[188:191], v[68:71]
    ds_read_b128 v[4:7], v255 offset:0
    v_mfma_f32_16x16x32_bf16 v[72:75], v[152:155], v[148:151], v[72:75]
    ds_read_b128 v[8:11], v255 offset:128
    v_mfma_f32_16x16x32_bf16 v[76:79], v[148:151], v[156:159], v[76:79]
    ds_read_b128 v[12:15], v255 offset:256
    s_waitcnt vmcnt(8) lgkmcnt(11)
    s_barrier
    v_mfma_f32_16x16x32_bf16 v[16:19], v[80:83], v[192:195], v[16:19]
    ds_read_b128 v[120:123], v247 offset:14336
    v_mfma_f32_16x16x32_bf16 v[44:47], v[80:83], v[196:199], v[44:47]
    ds_read_b128 v[124:127], v247 offset:15360
    v_mfma_f32_16x16x32_bf16 v[20:23], v[84:87], v[192:195], v[20:23]
    ds_read_b128 v[128:131], v247 offset:16384
    v_mfma_f32_16x16x32_bf16 v[48:51], v[84:87], v[196:199], v[48:51]
    ds_read_b128 v[132:135], v247 offset:17408
    v_mfma_f32_16x16x32_bf16 v[24:27], v[88:91], v[192:195], v[24:27]
    ds_read_b128 v[136:139], v247 offset:18432
    v_mfma_f32_16x16x32_bf16 v[52:55], v[88:91], v[196:199], v[52:55]
    ds_read_b128 v[140:143], v247 offset:19456
    v_mfma_f32_16x16x32_bf16 v[28:31], v[92:95], v[192:195], v[28:31]
    ds_read_b128 v[144:147], v247 offset:20480
    v_mfma_f32_16x16x32_bf16 v[56:59], v[92:95], v[196:199], v[56:59]
    ds_read_b128 v[148:151], v248 offset:9216
    s_waitcnt lgkmcnt(8)
    v_mfma_f32_16x16x32_bf16 v[32:35], v[192:195], v[96:99], v[32:35]
    ds_read_b128 v[152:155], v250 offset:0
    v_mfma_f32_16x16x32_bf16 v[60:63], v[196:199], v[96:99], v[60:63]
    ds_read_b128 v[156:159], v252 offset:0
    v_mfma_f32_16x16x32_bf16 v[36:39], v[192:195], v[100:103], v[36:39]
    buffer_load_dwordx4 v[184:187], v1, s[4:7], s41 offen offset:3072 sc1
    v_mfma_f32_16x16x32_bf16 v[64:67], v[196:199], v[100:103], v[64:67]
    buffer_load_dwordx4 v[188:191], v253, s[4:7], s41 offen offset:3072 sc1
    v_mfma_f32_16x16x32_bf16 v[40:43], v[104:107], v[192:195], v[40:43]
    v_mfma_f32_16x16x32_bf16 v[68:71], v[104:107], v[196:199], v[68:71]
    v_mfma_f32_16x16x32_bf16 v[72:75], v[112:115], v[108:111], v[72:75]
    v_mfma_f32_16x16x32_bf16 v[76:79], v[108:111], v[116:119], v[76:79]
    s_waitcnt vmcnt(8) lgkmcnt(6)
    v_mfma_f32_16x16x32_bf16 v[16:19], v[120:123], v[200:203], v[16:19]
    ds_read_b128 v[80:83], v247 offset:21504
    v_fma_f32 v32, -v8, v232, v32
    v_mfma_f32_16x16x32_bf16 v[44:47], v[120:123], v[204:207], v[44:47]
    ds_read_b128 v[84:87], v247 offset:22528
    v_fma_f32 v60, -v12, v232, v60
    v_mfma_f32_16x16x32_bf16 v[20:23], v[124:127], v[200:203], v[20:23]
    ds_read_b128 v[88:91], v247 offset:23552
    v_fma_f32 v36, -v8, v233, v36
    v_mfma_f32_16x16x32_bf16 v[48:51], v[124:127], v[204:207], v[48:51]
    ds_read_b128 v[92:95], v247 offset:24576
    v_fma_f32 v64, -v12, v233, v64
    v_mfma_f32_16x16x32_bf16 v[24:27], v[128:131], v[200:203], v[24:27]
    ds_read_b128 v[96:99], v247 offset:25600
    v_fma_f32 v40, -v242, v224, v40
    v_mfma_f32_16x16x32_bf16 v[52:55], v[128:131], v[204:207], v[52:55]
    ds_read_b128 v[100:103], v247 offset:26624
    v_fma_f32 v68, -v244, v224, v68
    v_mfma_f32_16x16x32_bf16 v[28:31], v[132:135], v[200:203], v[28:31]
    ds_read_b128 v[104:107], v247 offset:27648
    v_fma_f32 v72, -v240, v228, v72
    v_mfma_f32_16x16x32_bf16 v[56:59], v[132:135], v[204:207], v[56:59]
    ds_read_b128 v[108:111], v248 offset:10240
    s_waitcnt lgkmcnt(8)
    v_fma_f32 v76, -v4, v234, v76
    v_mfma_f32_16x16x32_bf16 v[32:35], v[200:203], v[136:139], v[32:35]
    ds_read_b128 v[112:115], v250 offset:7168
    v_fma_f32 v16, -v242, v208, v16
    v_mfma_f32_16x16x32_bf16 v[60:63], v[204:207], v[136:139], v[60:63]
    ds_read_b128 v[116:119], v252 offset:7168
    v_fma_f32 v44, -v244, v208, v44
    v_mfma_f32_16x16x32_bf16 v[36:39], v[200:203], v[140:143], v[36:39]
    buffer_load_dwordx4 v[192:195], v1, s[4:7], s42 offen offset:0 sc1
    v_fma_f32 v20, -v242, v212, v20
    v_mfma_f32_16x16x32_bf16 v[64:67], v[204:207], v[140:143], v[64:67]
    buffer_load_dwordx4 v[196:199], v253, s[4:7], s42 offen offset:0 sc1
    v_fma_f32 v48, -v244, v212, v48
    v_mfma_f32_16x16x32_bf16 v[40:43], v[144:147], v[200:203], v[40:43]
    v_fma_f32 v24, -v242, v216, v24
    v_mfma_f32_16x16x32_bf16 v[68:71], v[144:147], v[204:207], v[68:71]
    v_fma_f32 v52, -v244, v216, v52
    v_mfma_f32_16x16x32_bf16 v[72:75], v[152:155], v[148:151], v[72:75]
    v_fma_f32 v28, -v242, v220, v28
    v_mfma_f32_16x16x32_bf16 v[76:79], v[148:151], v[156:159], v[76:79]
    v_fma_f32 v56, -v244, v220, v56
    s_waitcnt vmcnt(8) lgkmcnt(6)
    s_barrier
    v_mfma_f32_16x16x32_bf16 v[16:19], v[80:83], v[160:163], v[16:19]
    ds_read_b128 v[120:123], v247 offset:28672
    v_fma_f32 v33, -v9, v232, v33
    v_mfma_f32_16x16x32_bf16 v[44:47], v[80:83], v[164:167], v[44:47]
    ds_read_b128 v[124:127], v247 offset:29696
    v_fma_f32 v61, -v13, v232, v61
    v_mfma_f32_16x16x32_bf16 v[20:23], v[84:87], v[160:163], v[20:23]
    ds_read_b128 v[128:131], v247 offset:30720
    v_fma_f32 v37, -v9, v233, v37
    v_mfma_f32_16x16x32_bf16 v[48:51], v[84:87], v[164:167], v[48:51]
    ds_read_b128 v[132:135], v247 offset:31744
    v_fma_f32 v65, -v13, v233, v65
    v_mfma_f32_16x16x32_bf16 v[24:27], v[88:91], v[160:163], v[24:27]
    ds_read_b128 v[136:139], v247 offset:32768
    v_fma_f32 v41, -v242, v225, v41
    v_mfma_f32_16x16x32_bf16 v[52:55], v[88:91], v[164:167], v[52:55]
    ds_read_b128 v[140:143], v247 offset:33792
    v_fma_f32 v69, -v244, v225, v69
    v_mfma_f32_16x16x32_bf16 v[28:31], v[92:95], v[160:163], v[28:31]
    ds_read_b128 v[144:147], v247 offset:34816
    v_fma_f32 v73, -v240, v229, v73
    v_mfma_f32_16x16x32_bf16 v[56:59], v[92:95], v[164:167], v[56:59]
    ds_read_b128 v[148:151], v248 offset:11264
    s_waitcnt lgkmcnt(8)
    v_fma_f32 v77, -v5, v234, v77
    v_mfma_f32_16x16x32_bf16 v[32:35], v[160:163], v[96:99], v[32:35]
    ds_read_b128 v[152:155], v250 offset:14336
    v_fma_f32 v17, -v242, v209, v17
    v_mfma_f32_16x16x32_bf16 v[60:63], v[164:167], v[96:99], v[60:63]
    ds_read_b128 v[156:159], v252 offset:14336
    v_fma_f32 v45, -v244, v209, v45
    v_mfma_f32_16x16x32_bf16 v[36:39], v[160:163], v[100:103], v[36:39]
    buffer_load_dwordx4 v[200:203], v1, s[4:7], s42 offen offset:1024 sc1
    v_fma_f32 v21, -v242, v213, v21
    v_mfma_f32_16x16x32_bf16 v[64:67], v[164:167], v[100:103], v[64:67]
    buffer_load_dwordx4 v[204:207], v253, s[4:7], s42 offen offset:1024 sc1
    v_fma_f32 v49, -v244, v213, v49
    v_mfma_f32_16x16x32_bf16 v[40:43], v[104:107], v[160:163], v[40:43]
    v_fma_f32 v25, -v242, v217, v25
    v_mfma_f32_16x16x32_bf16 v[68:71], v[104:107], v[164:167], v[68:71]
    v_fma_f32 v53, -v244, v217, v53
    v_mfma_f32_16x16x32_bf16 v[72:75], v[112:115], v[108:111], v[72:75]
    v_fma_f32 v29, -v242, v221, v29
    v_mfma_f32_16x16x32_bf16 v[76:79], v[108:111], v[116:119], v[76:79]
    v_fma_f32 v57, -v244, v221, v57
    s_waitcnt vmcnt(8) lgkmcnt(6)
    v_mfma_f32_16x16x32_bf16 v[16:19], v[120:123], v[168:171], v[16:19]
    ds_read_b128 v[80:83], v247 offset:35840
    v_fma_f32 v34, -v10, v232, v34
    v_mfma_f32_16x16x32_bf16 v[44:47], v[120:123], v[172:175], v[44:47]
    ds_read_b128 v[84:87], v247 offset:36864
    v_fma_f32 v62, -v14, v232, v62
    v_mfma_f32_16x16x32_bf16 v[20:23], v[124:127], v[168:171], v[20:23]
    ds_read_b128 v[88:91], v247 offset:37888
    v_fma_f32 v38, -v10, v233, v38
    v_mfma_f32_16x16x32_bf16 v[48:51], v[124:127], v[172:175], v[48:51]
    ds_read_b128 v[92:95], v247 offset:38912
    v_fma_f32 v66, -v14, v233, v66
    v_mfma_f32_16x16x32_bf16 v[24:27], v[128:131], v[168:171], v[24:27]
    ds_read_b128 v[96:99], v247 offset:39936
    v_fma_f32 v42, -v242, v226, v42
    v_mfma_f32_16x16x32_bf16 v[52:55], v[128:131], v[172:175], v[52:55]
    ds_read_b128 v[100:103], v247 offset:40960
    v_fma_f32 v70, -v244, v226, v70
    v_mfma_f32_16x16x32_bf16 v[28:31], v[132:135], v[168:171], v[28:31]
    ds_read_b128 v[104:107], v247 offset:41984
    v_fma_f32 v74, -v240, v230, v74
    v_mfma_f32_16x16x32_bf16 v[56:59], v[132:135], v[172:175], v[56:59]
    ds_read_b128 v[108:111], v248 offset:12288
    s_waitcnt lgkmcnt(8)
    v_fma_f32 v78, -v6, v234, v78
    v_mfma_f32_16x16x32_bf16 v[32:35], v[168:171], v[136:139], v[32:35]
    ds_read_b128 v[112:115], v250 offset:21504
    v_fma_f32 v18, -v242, v210, v18
    v_mfma_f32_16x16x32_bf16 v[60:63], v[172:175], v[136:139], v[60:63]
    ds_read_b128 v[116:119], v252 offset:21504
    v_fma_f32 v46, -v244, v210, v46
    v_mfma_f32_16x16x32_bf16 v[36:39], v[168:171], v[140:143], v[36:39]
    v_fma_f32 v22, -v242, v214, v22
    v_mfma_f32_16x16x32_bf16 v[64:67], v[172:175], v[140:143], v[64:67]
    v_fma_f32 v50, -v244, v214, v50
    v_mfma_f32_16x16x32_bf16 v[40:43], v[144:147], v[168:171], v[40:43]
    v_fma_f32 v26, -v242, v218, v26
    v_mfma_f32_16x16x32_bf16 v[68:71], v[144:147], v[172:175], v[68:71]
    v_fma_f32 v54, -v244, v218, v54
    v_mfma_f32_16x16x32_bf16 v[72:75], v[152:155], v[148:151], v[72:75]
    v_fma_f32 v30, -v242, v222, v30
    v_mfma_f32_16x16x32_bf16 v[76:79], v[148:151], v[156:159], v[76:79]
    v_fma_f32 v58, -v244, v222, v58
    s_waitcnt vmcnt(6) lgkmcnt(6)
    v_mfma_f32_16x16x32_bf16 v[16:19], v[80:83], v[176:179], v[16:19]
    ds_read_b128 v[120:123], v247 offset:43008
    v_fma_f32 v35, -v11, v232, v35
    v_mfma_f32_16x16x32_bf16 v[44:47], v[80:83], v[180:183], v[44:47]
    ds_read_b128 v[124:127], v247 offset:44032
    v_fma_f32 v63, -v15, v232, v63
    v_mfma_f32_16x16x32_bf16 v[20:23], v[84:87], v[176:179], v[20:23]
    ds_read_b128 v[128:131], v247 offset:45056
    v_fma_f32 v39, -v11, v233, v39
    v_mfma_f32_16x16x32_bf16 v[48:51], v[84:87], v[180:183], v[48:51]
    ds_read_b128 v[132:135], v247 offset:46080
    v_fma_f32 v67, -v15, v233, v67
    v_mfma_f32_16x16x32_bf16 v[24:27], v[88:91], v[176:179], v[24:27]
    ds_read_b128 v[136:139], v247 offset:47104
    v_fma_f32 v43, -v242, v227, v43
    v_mfma_f32_16x16x32_bf16 v[52:55], v[88:91], v[180:183], v[52:55]
    ds_read_b128 v[140:143], v247 offset:48128
    v_fma_f32 v71, -v244, v227, v71
    v_mfma_f32_16x16x32_bf16 v[28:31], v[92:95], v[176:179], v[28:31]
    ds_read_b128 v[144:147], v247 offset:49152
    v_fma_f32 v75, -v240, v231, v75
    v_mfma_f32_16x16x32_bf16 v[56:59], v[92:95], v[180:183], v[56:59]
    ds_read_b128 v[148:151], v248 offset:13312
    s_waitcnt lgkmcnt(8)
    v_fma_f32 v79, -v7, v234, v79
    v_mfma_f32_16x16x32_bf16 v[32:35], v[176:179], v[96:99], v[32:35]
    ds_read_b128 v[152:155], v250 offset:28672
    v_fma_f32 v19, -v242, v211, v19
    v_mfma_f32_16x16x32_bf16 v[60:63], v[180:183], v[96:99], v[60:63]
    ds_read_b128 v[156:159], v252 offset:28672
    v_fma_f32 v47, -v244, v211, v47
    v_mfma_f32_16x16x32_bf16 v[36:39], v[176:179], v[100:103], v[36:39]
    v_fma_f32 v23, -v242, v215, v23
    v_mfma_f32_16x16x32_bf16 v[64:67], v[180:183], v[100:103], v[64:67]
    v_fma_f32 v51, -v244, v215, v51
    v_mfma_f32_16x16x32_bf16 v[40:43], v[104:107], v[176:179], v[40:43]
    v_fma_f32 v27, -v242, v219, v27
    v_mfma_f32_16x16x32_bf16 v[68:71], v[104:107], v[180:183], v[68:71]
    v_fma_f32 v55, -v244, v219, v55
    v_mfma_f32_16x16x32_bf16 v[72:75], v[112:115], v[108:111], v[72:75]
    v_fma_f32 v31, -v242, v223, v31
    v_mfma_f32_16x16x32_bf16 v[76:79], v[108:111], v[116:119], v[76:79]
    v_fma_f32 v59, -v244, v223, v59
    s_waitcnt vmcnt(4) lgkmcnt(6)
    s_barrier
    v_mfma_f32_16x16x32_bf16 v[16:19], v[120:123], v[184:187], v[16:19]
    ds_read_b128 v[80:83], v247 offset:50176
    v_mfma_f32_16x16x32_bf16 v[44:47], v[120:123], v[188:191], v[44:47]
    ds_read_b128 v[84:87], v247 offset:51200
    v_and_b32 v4, 1, v2
    v_mfma_f32_16x16x32_bf16 v[20:23], v[124:127], v[184:187], v[20:23]
    ds_read_b128 v[88:91], v247 offset:52224
    v_lshl_add_u32 v5, v3, 2, v4
    v_mfma_f32_16x16x32_bf16 v[48:51], v[124:127], v[188:191], v[48:51]
    ds_read_b128 v[92:95], v247 offset:53248
    v_add_u32 v6, 2, v5
    v_mfma_f32_16x16x32_bf16 v[24:27], v[128:131], v[184:187], v[24:27]
    ds_read_b128 v[96:99], v247 offset:54272
    v_cmp_eq_u32 s[40:41], 1, v4
    v_mfma_f32_16x16x32_bf16 v[52:55], v[128:131], v[188:191], v[52:55]
    ds_read_b128 v[100:103], v247 offset:55296
    v_cmp_le_u32 s[42:43], v5, v2
    v_mfma_f32_16x16x32_bf16 v[28:31], v[132:135], v[184:187], v[28:31]
    ds_read_b128 v[104:107], v247 offset:56320
    v_cmp_le_u32 s[44:45], v6, v2
    v_mfma_f32_16x16x32_bf16 v[56:59], v[132:135], v[188:191], v[56:59]
    ds_read_b128 v[108:111], v248 offset:14336
    s_waitcnt lgkmcnt(8)
    v_mfma_f32_16x16x32_bf16 v[32:35], v[184:187], v[136:139], v[32:35]
    ds_read_b128 v[112:115], v250 offset:35840
    v_mov_b32 v4, 0x0c0c0100
    v_mfma_f32_16x16x32_bf16 v[60:63], v[188:191], v[136:139], v[60:63]
    ds_read_b128 v[116:119], v252 offset:35840
    v_mov_b32 v5, 0x01000c0c
    v_mfma_f32_16x16x32_bf16 v[36:39], v[184:187], v[140:143], v[36:39]
    v_mov_b32 v6, 0x0c0c0302
    v_mov_b32 v7, 0x03020c0c
    v_mfma_f32_16x16x32_bf16 v[64:67], v[188:191], v[140:143], v[64:67]
    v_mov_b32 v8, 0x0c0c0c0c
    v_cndmask_b32 v4, v4, v5, s[40:41]
    v_mfma_f32_16x16x32_bf16 v[40:43], v[144:147], v[184:187], v[40:43]
    v_cndmask_b32 v6, v6, v7, s[40:41]
    v_cndmask_b32 v12, v4, v8, s[42:43]
    v_mfma_f32_16x16x32_bf16 v[68:71], v[144:147], v[188:191], v[68:71]
    v_cndmask_b32 v13, v6, v8, s[44:45]
    v_cndmask_b32 v14, v8, v4, s[42:43]
    v_mfma_f32_16x16x32_bf16 v[72:75], v[152:155], v[148:151], v[72:75]
    v_cndmask_b32 v15, v8, v6, s[44:45]
    s_cmp_eq_u32 s31, 0
    v_mfma_f32_16x16x32_bf16 v[76:79], v[148:151], v[156:159], v[76:79]
    s_cselect_b64 s[48:49], s[42:43], -1
    s_cselect_b64 s[38:39], s[44:45], -1
    s_waitcnt vmcnt(2) lgkmcnt(6)
    v_mfma_f32_16x16x32_bf16 v[16:19], v[80:83], v[192:195], v[16:19]
    ds_read_b128 v[120:123], v247 offset:57344
    v_mfma_f32_16x16x32_bf16 v[44:47], v[80:83], v[196:199], v[44:47]
    ds_read_b128 v[124:127], v247 offset:58368
    s_mul_i32 s36, s20, 3072
    v_mfma_f32_16x16x32_bf16 v[20:23], v[84:87], v[192:195], v[20:23]
    ds_read_b128 v[128:131], v247 offset:59392
    s_add_u32 s36, s36, 149504
    v_mfma_f32_16x16x32_bf16 v[48:51], v[84:87], v[196:199], v[48:51]
    ds_read_b128 v[132:135], v247 offset:60416
    v_add_u32 v9, s36, v0
    v_mfma_f32_16x16x32_bf16 v[24:27], v[88:91], v[192:195], v[24:27]
    ds_read_b128 v[136:139], v247 offset:61440
    s_lshl_b32 s37, s20, 9
    v_mfma_f32_16x16x32_bf16 v[52:55], v[88:91], v[196:199], v[52:55]
    ds_read_b128 v[140:143], v247 offset:62464
    s_add_u32 s37, s37, 149504
    v_mfma_f32_16x16x32_bf16 v[28:31], v[92:95], v[192:195], v[28:31]
    ds_read_b128 v[144:147], v247 offset:63488
    v_add_u32 v10, s37, v0
    v_mfma_f32_16x16x32_bf16 v[56:59], v[92:95], v[196:199], v[56:59]
    ds_read_b128 v[148:151], v248 offset:15360
    s_waitcnt lgkmcnt(8)
    v_mfma_f32_16x16x32_bf16 v[32:35], v[192:195], v[96:99], v[32:35]
    ds_read_b128 v[152:155], v250 offset:43008
    v_lshlrev_b32 v4, 2, v3
    v_mfma_f32_16x16x32_bf16 v[60:63], v[196:199], v[96:99], v[60:63]
    ds_read_b128 v[156:159], v252 offset:43008
    v_sub_u32 v4, v2, v4
    v_mfma_f32_16x16x32_bf16 v[36:39], v[192:195], v[100:103], v[36:39]
    v_lshlrev_b32 v5, 4, v4
    v_lshrrev_b32 v4, 1, v4
    v_mfma_f32_16x16x32_bf16 v[64:67], v[196:199], v[100:103], v[64:67]
    v_mov_b32 v6, 0x3f80
    v_lshlrev_b32 v5, v5, v6
    v_mfma_f32_16x16x32_bf16 v[40:43], v[104:107], v[192:195], v[40:43]
    v_cmp_eq_u32 vcc, 0, v4
    v_cmp_eq_u32 s[46:47], 1, v4
    v_mfma_f32_16x16x32_bf16 v[68:71], v[104:107], v[196:199], v[68:71]
    ds_read_b128 v[208:211], v255 offset:64
    s_lshl_b32 s36, s24, 10
    v_add_u32 v4, s36, v1
    v_mfma_f32_16x16x32_bf16 v[72:75], v[112:115], v[108:111], v[72:75]
    ds_read_b128 v[212:215], v255 offset:192
    v_cndmask_b32 v234, 0, v5, vcc
    v_cndmask_b32 v235, 0, v5, s[46:47]
    v_mfma_f32_16x16x32_bf16 v[76:79], v[108:111], v[116:119], v[76:79]
    ds_read_b128 v[216:219], v255 offset:320
    v_add_u32 v5, 18432, v4
    s_lshl_b32 s36, s24, 7
    s_waitcnt vmcnt(0) lgkmcnt(9)
    v_mfma_f32_16x16x32_bf16 v[16:19], v[120:123], v[200:203], v[16:19]
    ds_read_b128 v[80:83], v248 offset:16384
    v_mfma_f32_16x16x32_bf16 v[44:47], v[120:123], v[204:207], v[44:47]
    ds_read_b128 v[84:87], v250 offset:50176
    s_add_u32 s36, s36, 16384
    v_mfma_f32_16x16x32_bf16 v[20:23], v[124:127], v[200:203], v[20:23]
    ds_read_b128 v[88:91], v252 offset:50176
    v_cmp_eq_u32 vcc, 2, v3
    v_mfma_f32_16x16x32_bf16 v[48:51], v[124:127], v[204:207], v[48:51]
    ds_read_b128 v[92:95], v248 offset:17408
    v_lshl_add_u32 v6, v2, 3, s36
    v_mfma_f32_16x16x32_bf16 v[24:27], v[128:131], v[200:203], v[24:27]
    ds_read_b128 v[96:99], v250 offset:57344
    v_bfrev_b32 v7, 1
    v_mfma_f32_16x16x32_bf16 v[52:55], v[128:131], v[204:207], v[52:55]
    ds_read_b128 v[100:103], v252 offset:57344
    v_cndmask_b32 v6, v7, v6, vcc
    v_mfma_f32_16x16x32_bf16 v[28:31], v[132:135], v[200:203], v[28:31]
    v_add_u32 v7, 18432, v6
    v_mov_b32 v106, 0
    v_mfma_f32_16x16x32_bf16 v[56:59], v[132:135], v[204:207], v[56:59]
    s_waitcnt lgkmcnt(6)
    v_mov_b32 v107, 0
    v_mfma_f32_16x16x32_bf16 v[32:35], v[200:203], v[136:139], v[32:35]
    v_mov_b32 v8, 0xf149f2ca
    v_mov_b32 v108, 0
    v_mfma_f32_16x16x32_bf16 v[60:63], v[204:207], v[136:139], v[60:63]
    s_mov_b32 s33, 0x3eae1a93
    v_mov_b32 v109, 0
    v_mfma_f32_16x16x32_bf16 v[36:39], v[200:203], v[140:143], v[36:39]
    v_mov_b32 v236, 0x3f803f80
    v_mov_b32 v237, 0x3f803f80
    v_mfma_f32_16x16x32_bf16 v[64:67], v[204:207], v[140:143], v[64:67]
    v_mov_b32 v238, 0x3f803f80
    v_mov_b32 v239, 0x3f803f80
    v_mfma_f32_16x16x32_bf16 v[40:43], v[144:147], v[200:203], v[40:43]
    v_mov_b32 v114, 0
    v_mfma_f32_16x16x32_bf16 v[68:71], v[144:147], v[204:207], v[68:71]
    v_mov_b32 v115, 0
    v_mfma_f32_16x16x32_bf16 v[72:75], v[152:155], v[148:151], v[72:75]
    v_mov_b32 v116, 0
    v_mfma_f32_16x16x32_bf16 v[76:79], v[148:151], v[156:159], v[76:79]
    v_mov_b32 v117, 0
    s_waitcnt lgkmcnt(0)
    v_mfma_f32_16x16x32_bf16 v[72:75], v[84:87], v[80:83], v[72:75]
    v_mfma_f32_16x16x32_bf16 v[76:79], v[80:83], v[88:91], v[76:79]
    v_mfma_f32_16x16x32_bf16 v[72:75], v[96:99], v[92:95], v[72:75]
    v_mfma_f32_16x16x32_bf16 v[76:79], v[92:95], v[100:103], v[76:79]
    v_pk_mul_f32 v[52:53], v[52:53], v[244:245] op_sel:[0,1] op_sel_hi:[1,1]
    v_pk_mul_f32 v[54:55], v[54:55], v[244:245] op_sel:[0,1] op_sel_hi:[1,1]
    v_pk_mul_f32 v[56:57], v[56:57], v[244:245] op_sel:[0,1] op_sel_hi:[1,1]
    v_pk_mul_f32 v[58:59], v[58:59], v[244:245] op_sel:[0,1] op_sel_hi:[1,1]
    v_pk_mul_f32 v[60:61], v[60:61], v[216:217]
    v_pk_mul_f32 v[62:63], v[62:63], v[218:219]
    v_pk_mul_f32 v[64:65], v[64:65], v[216:217]
    v_pk_mul_f32 v[66:67], v[66:67], v[218:219]
    v_pk_mul_f32 v[68:69], v[68:69], v[244:245] op_sel:[0,1] op_sel_hi:[1,1]
    v_pk_mul_f32 v[70:71], v[70:71], v[244:245] op_sel:[0,1] op_sel_hi:[1,1]
    v_pk_mul_f32 v[72:73], v[72:73], v[240:241] op_sel:[0,1] op_sel_hi:[1,1]
    v_pk_mul_f32 v[74:75], v[74:75], v[240:241] op_sel:[0,1] op_sel_hi:[1,1]
    v_pk_mul_f32 v[76:77], v[76:77], v[208:209]
    v_pk_mul_f32 v[78:79], v[78:79], v[210:211]
    v_cvt_pk_bf16_f32 v172, v52, v53
    v_cvt_pk_bf16_f32 v173, v54, v55
    v_cvt_pk_bf16_f32 v176, v56, v57
    v_cvt_pk_bf16_f32 v177, v58, v59
    v_cvt_pk_bf16_f32 v182, v60, v61
    v_cvt_pk_bf16_f32 v183, v62, v63
    v_cvt_pk_bf16_f32 v188, v64, v65
    v_cvt_pk_bf16_f32 v189, v66, v67
    v_cvt_pk_bf16_f32 v174, v68, v69
    v_cvt_pk_bf16_f32 v175, v70, v71
    v_cvt_pk_bf16_f32 v220, v72, v73
    v_cvt_pk_bf16_f32 v221, v74, v75
    v_cvt_pk_bf16_f32 v222, v76, v77
    v_cvt_pk_bf16_f32 v223, v78, v79
    s_cmp_eq_u32 s20, 3
    s_cbranch_scc1 L_a_nw
    ds_write2st64_b64 v9, v[172:173], v[174:175] offset0:6 offset1:7
    ds_write2st64_b64 v9, v[176:177], v[182:183] offset0:8 offset1:9
    ds_write_b64 v9, v[188:189] offset:5120
    ds_write2st64_b64 v10, v[220:221], v[222:223] offset0:0 offset1:3
L_a_nw:
    v_pk_mul_f32 v[24:25], v[24:25], v[242:243] op_sel:[0,1] op_sel_hi:[1,1]
    v_pk_mul_f32 v[26:27], v[26:27], v[242:243] op_sel:[0,1] op_sel_hi:[1,1]
    v_pk_mul_f32 v[28:29], v[28:29], v[242:243] op_sel:[0,1] op_sel_hi:[1,1]
    v_pk_mul_f32 v[30:31], v[30:31], v[242:243] op_sel:[0,1] op_sel_hi:[1,1]
    v_pk_mul_f32 v[32:33], v[32:33], v[212:213]
    v_pk_mul_f32 v[34:35], v[34:35], v[214:215]
    v_pk_mul_f32 v[36:37], v[36:37], v[212:213]
    v_pk_mul_f32 v[38:39], v[38:39], v[214:215]
    v_pk_mul_f32 v[40:41], v[40:41], v[242:243] op_sel:[0,1] op_sel_hi:[1,1]
    v_pk_mul_f32 v[42:43], v[42:43], v[242:243] op_sel:[0,1] op_sel_hi:[1,1]
    v_cvt_pk_bf16_f32 v166, v24, v25
    v_cvt_pk_bf16_f32 v167, v26, v27
    v_cvt_pk_bf16_f32 v170, v28, v29
    v_cvt_pk_bf16_f32 v171, v30, v31
    v_cvt_pk_bf16_f32 v180, v32, v33
    v_cvt_pk_bf16_f32 v181, v34, v35
    v_cvt_pk_bf16_f32 v186, v36, v37
    v_cvt_pk_bf16_f32 v187, v38, v39
    v_cvt_pk_bf16_f32 v168, v40, v41
    v_cvt_pk_bf16_f32 v169, v42, v43
    s_waitcnt lgkmcnt(0)
    s_barrier
    ds_read2st64_b64 v[160:163], v9 offset0:0 offset1:1
    ds_read_b64 v[164:165], v9 offset:1024
    ds_read_b64 v[178:179], v9 offset:1536
    ds_read_b64 v[184:185], v9 offset:2048
    v_mfma_f32_16x16x16_bf16 v[128:131], v[174:175], v[234:235], 0
    v_mfma_f32_16x16x16_bf16 v[124:127], v[168:169], v[234:235], 0
    v_pk_mul_f32 v[44:45], v[44:45], v[244:245] op_sel:[0,1] op_sel_hi:[1,1]
    v_pk_mul_f32 v[46:47], v[46:47], v[244:245] op_sel:[0,1] op_sel_hi:[1,1]
    v_pk_mul_f32 v[48:49], v[48:49], v[244:245] op_sel:[0,1] op_sel_hi:[1,1]
    v_pk_mul_f32 v[50:51], v[50:51], v[244:245] op_sel:[0,1] op_sel_hi:[1,1]
    v_pk_mul_f32 v[16:17], v[16:17], v[242:243] op_sel:[0,1] op_sel_hi:[1,1]
    v_pk_mul_f32 v[18:19], v[18:19], v[242:243] op_sel:[0,1] op_sel_hi:[1,1]
    v_pk_mul_f32 v[20:21], v[20:21], v[242:243] op_sel:[0,1] op_sel_hi:[1,1]
    v_pk_mul_f32 v[22:23], v[22:23], v[242:243] op_sel:[0,1] op_sel_hi:[1,1]
    v_cvt_pk_bf16_f32 v112, v44, v45
    v_cvt_pk_bf16_f32 v113, v46, v47
    v_cvt_pk_bf16_f32 v118, v48, v49
    v_cvt_pk_bf16_f32 v119, v50, v51
    v_cvt_pk_bf16_f32 v104, v16, v17
    v_cvt_pk_bf16_f32 v105, v18, v19
    v_cvt_pk_bf16_f32 v110, v20, v21
    v_cvt_pk_bf16_f32 v111, v22, v23
    v_permlane16_swap_b32 v114, v174
    v_permlane16_swap_b32 v117, v175
    v_permlane16_swap_b32 v106, v168
    v_permlane16_swap_b32 v109, v169
    s_waitcnt lgkmcnt(0)
    v_mfma_f32_16x16x16_bf16 v[120:123], v[162:163], v[234:235], 0
    v_mfma_f32_16x16x32_bf16 v[20:23], v[172:175], v[112:115], 0
    v_mfma_f32_16x16x32_bf16 v[16:19], v[166:169], v[112:115], 0
    v_mfma_f32_16x16x32_bf16 v[28:31], v[174:177], v[116:119], 0
    v_mfma_f32_16x16x32_bf16 v[24:27], v[168:171], v[116:119], 0
    v_mfma_f32_16x16x32_bf16 v[36:39], v[166:169], v[104:107], 0
    v_mfma_f32_16x16x32_bf16 v[32:35], v[160:163], v[104:107], 0
    v_mfma_f32_16x16x32_bf16 v[44:47], v[168:171], v[108:111], 0
    v_mfma_f32_16x16x32_bf16 v[40:43], v[162:165], v[108:111], 0
    v_cvt_pk_bf16_f32 v194, v128, v129
    v_cvt_pk_bf16_f32 v195, v130, v131
    v_cvt_pk_bf16_f32 v192, v124, v125
    v_cvt_pk_bf16_f32 v193, v126, v127
    v_cvt_pk_bf16_f32 v190, v120, v121
    v_cvt_pk_bf16_f32 v191, v122, v123
    v_cndmask_b32 v20, v20, v21, s[40:41]
    v_cndmask_b32 v16, v16, v17, s[40:41]
    v_cndmask_b32 v48, v16, v20, s[42:43]
    v_cndmask_b32 v22, v22, v23, s[40:41]
    v_cndmask_b32 v18, v18, v19, s[40:41]
    v_cndmask_b32 v49, v18, v22, s[44:45]
    v_max_f32 v56, v48, v49
    v_cndmask_b32 v28, v28, v29, s[40:41]
    v_cndmask_b32 v24, v24, v25, s[40:41]
    v_cndmask_b32 v50, v24, v28, s[42:43]
    v_cndmask_b32 v30, v30, v31, s[40:41]
    v_cndmask_b32 v26, v26, v27, s[40:41]
    v_cndmask_b32 v51, v26, v30, s[44:45]
    v_max_f32 v57, v50, v51
    v_cndmask_b32 v36, v36, v37, s[40:41]
    v_cndmask_b32 v32, v32, v33, s[40:41]
    v_cndmask_b32 v52, v32, v36, s[42:43]
    v_cndmask_b32 v52, v8, v52, s[48:49]
    v_cndmask_b32 v38, v38, v39, s[40:41]
    v_cndmask_b32 v34, v34, v35, s[40:41]
    v_cndmask_b32 v53, v34, v38, s[44:45]
    v_cndmask_b32 v53, v8, v53, s[38:39]
    v_max_f32 v58, v52, v53
    v_permlane32_swap_b32 v56, v57
    v_max_f32 v56, v56, v57
    v_cndmask_b32 v44, v44, v45, s[40:41]
    v_cndmask_b32 v40, v40, v41, s[40:41]
    v_cndmask_b32 v54, v40, v44, s[42:43]
    v_cndmask_b32 v54, v8, v54, s[48:49]
    v_cndmask_b32 v46, v46, v47, s[40:41]
    v_cndmask_b32 v42, v42, v43, s[40:41]
    v_cndmask_b32 v55, v42, v46, s[44:45]
    v_cndmask_b32 v55, v8, v55, s[38:39]
    v_max_f32 v59, v54, v55
    s_nop 1
    v_permlane32_swap_b32 v58, v59
    v_max_f32 v58, v58, v59
    s_nop 1
    v_permlane16_swap_b32 v56, v58
    v_max_f32 v57, v56, v58
    v_mul_f32 v56, s33, v57
    v_mul_f32 v58, s33, v57
    s_nop 1
    v_permlane16_swap_b32 v56, v58
    v_mov_b32 v57, v56
    v_mov_b32 v59, v58
    s_nop 0
    v_permlane32_swap_b32 v56, v57
    v_permlane32_swap_b32 v58, v59
    v_fma_f32 v48, v48, s33, -v56
    v_fma_f32 v49, v49, s33, -v56
    v_fma_f32 v50, v50, s33, -v57
    v_fma_f32 v51, v51, s33, -v57
    v_fma_f32 v52, v52, s33, -v58
    v_fma_f32 v53, v53, s33, -v58
    v_fma_f32 v54, v54, s33, -v59
    v_fma_f32 v55, v55, s33, -v59
    v_exp_f32 v48, v48
    v_exp_f32 v49, v49
    v_exp_f32 v50, v50
    v_exp_f32 v51, v51
    v_exp_f32 v52, v52
    v_exp_f32 v53, v53
    v_exp_f32 v54, v54
    v_exp_f32 v55, v55
    v_cvt_pk_bf16_f32 v56, v48, v49
    v_cvt_pk_bf16_f32 v57, v50, v51
    v_cvt_pk_bf16_f32 v58, v52, v53
    v_cvt_pk_bf16_f32 v59, v54, v55
    v_perm_b32 v64, v56, v56, v12
    v_perm_b32 v65, v56, v56, v13
    v_perm_b32 v66, v56, v56, v14
    v_perm_b32 v67, v56, v56, v15
    v_perm_b32 v68, v57, v57, v12
    v_perm_b32 v69, v57, v57, v13
    v_perm_b32 v70, v57, v57, v14
    v_perm_b32 v71, v57, v57, v15
    v_perm_b32 v72, v58, v58, v12
    v_perm_b32 v73, v58, v58, v13
    v_perm_b32 v74, v58, v58, v14
    v_perm_b32 v75, v58, v58, v15
    v_perm_b32 v76, v59, v59, v12
    v_perm_b32 v77, v59, v59, v13
    v_perm_b32 v78, v59, v59, v14
    v_perm_b32 v79, v59, v59, v15
    v_mfma_f32_16x16x32_bf16 v[80:83], v[236:239], v[64:67], 0
    v_mfma_f32_16x16x32_bf16 v[84:87], v[236:239], v[68:71], 0
    v_mfma_f32_16x16x32_bf16 v[88:91], v[236:239], v[72:75], 0
    v_mfma_f32_16x16x32_bf16 v[92:95], v[236:239], v[76:79], 0
    v_mfma_f32_16x16x32_bf16 v[16:19], v[180:183], v[64:67], 0
    v_mfma_f32_16x16x32_bf16 v[20:23], v[192:195], v[64:67], 0
    v_mfma_f32_16x16x32_bf16 v[24:27], v[186:189], v[68:71], 0
    v_mfma_f32_16x16x32_bf16 v[28:31], v[192:195], v[68:71], 0
    v_mfma_f32_16x16x32_bf16 v[32:35], v[178:181], v[72:75], 0
    v_mfma_f32_16x16x32_bf16 v[36:39], v[190:193], v[72:75], 0
    v_mfma_f32_16x16x32_bf16 v[40:43], v[184:187], v[76:79], 0
    v_mfma_f32_16x16x32_bf16 v[44:47], v[190:193], v[76:79], 0
    v_rcp_f32 v80, v80
    v_rcp_f32 v84, v84
    v_rcp_f32 v88, v88
    v_rcp_f32 v92, v92
    v_pk_mul_f32 v[16:17], v[16:17], v[80:81] op_sel_hi:[1,0]
    v_pk_mul_f32 v[18:19], v[18:19], v[80:81] op_sel_hi:[1,0]
    v_pk_mul_f32 v[20:21], v[20:21], v[80:81] op_sel_hi:[1,0]
    v_pk_mul_f32 v[24:25], v[24:25], v[84:85] op_sel_hi:[1,0]
    v_pk_mul_f32 v[26:27], v[26:27], v[84:85] op_sel_hi:[1,0]
    v_pk_mul_f32 v[30:31], v[30:31], v[84:85] op_sel_hi:[1,0]
    v_cvt_pk_bf16_f32 v220, v16, v17
    v_cvt_pk_bf16_f32 v221, v18, v19
    v_cvt_pk_bf16_f32 v224, v20, v21
    v_cvt_pk_bf16_f32 v222, v24, v25
    v_cvt_pk_bf16_f32 v223, v26, v27
    v_cvt_pk_bf16_f32 v225, v30, v31
    buffer_store_dwordx4 v[220:223], v5, s[4:7], s35 offen sc1
    buffer_store_dwordx2 v[224:225], v7, s[4:7], s35 offen sc1
    v_pk_mul_f32 v[32:33], v[32:33], v[88:89] op_sel_hi:[1,0]
    v_pk_mul_f32 v[34:35], v[34:35], v[88:89] op_sel_hi:[1,0]
    v_pk_mul_f32 v[36:37], v[36:37], v[88:89] op_sel_hi:[1,0]
    v_pk_mul_f32 v[40:41], v[40:41], v[92:93] op_sel_hi:[1,0]
    v_pk_mul_f32 v[42:43], v[42:43], v[92:93] op_sel_hi:[1,0]
    v_pk_mul_f32 v[46:47], v[46:47], v[92:93] op_sel_hi:[1,0]
    v_cvt_pk_bf16_f32 v228, v32, v33
    v_cvt_pk_bf16_f32 v229, v34, v35
    v_cvt_pk_bf16_f32 v232, v36, v37
    v_cvt_pk_bf16_f32 v230, v40, v41
    v_cvt_pk_bf16_f32 v231, v42, v43
    v_cvt_pk_bf16_f32 v233, v46, v47
    buffer_store_dwordx4 v[228:231], v4, s[4:7], s35 offen sc1
    buffer_store_dwordx2 v[232:233], v6, s[4:7], s35 offen sc1
    s_and_b32 s25, s2, 7
    s_lshr_b32 s26, s2, 3
    s_lshr_b32 s23, s25, 1
    s_lshl_b32 s23, s23, 3
    s_lshr_b32 s27, s26, 2
    s_add_u32 s23, s23, s27
    s_and_b32 s24, s25, 1
    s_lshl_b32 s24, s24, 2
    s_and_b32 s27, s26, 3
    s_add_u32 s24, s24, s27
    s_add_u32 s25, s23, s24
    s_and_b32 s25, s25, 3
    s_lshl_b32 s30, s23, 2
    s_add_u32 s30, s30, s20
    s_mul_i32 s29, s30, 18432
    s_add_u32 s29, s29, s21
    s_add_u32 s29, s29, 0x600000
    s_mul_i32 s34, s30, 18432
    s_add_u32 s34, s34, s21
    s_add_u32 s34, s34, 0x0
    s_lshl_b32 s35, s24, 11
    s_lshr_b32 s36, s24, 2
    s_lshl_b32 s36, s36, 10
    s_and_b32 s37, s24, 3
    s_lshl_b32 s37, s37, 8
    s_add_u32 s36, s36, s37
    s_add_u32 s36, s36, 16384
    v_bfe_u32 v2, v1, 4, 4
    v_lshrrev_b32 v3, 8, v1
    v_add_u32 v4, s35, v1
    v_lshlrev_b32 v5, 4, v2
    v_lshl_add_u32 v5, v3, 3, v5
    v_add_u32 v5, s36, v5
    v_cmp_gt_u32 s[40:41], 2, v3
    v_bfrev_b32 v6, 1
    v_add_u32 v12, 0, v1
    v_add_u32 v13, 36864, v1
    v_add_u32 v14, 73728, v1
    v_add_u32 v15, 110592, v1
    v_cndmask_b32 v5, v6, v5, s[40:41]
    buffer_load_dwordx4 v[208:211], v4, s[4:7], s34 offen offset:0 sc1
    buffer_load_dwordx4 v[212:215], v4, s[4:7], s34 offen offset:1024 sc1
    buffer_load_dwordx2 v[216:217], v5, s[4:7], s34 offen sc1
    s_add_u32 s34, s34, 0x300000
    s_lshl_b32 s39, s30, 10
    s_add_u32 s39, s39, s21
    s_lshl_b32 s42, s24, 7
    s_add_u32 s39, s39, s42
    s_add_u32 s39, s39, 0x1b20000
    v_cmp_eq_u32 vcc, 0, v3
    v_lshlrev_b32 v10, 3, v2
    v_mov_b32 v11, 0x3f803f80
    v_lshl_add_u32 v7, v3, 8, v10
    v_cndmask_b32 v10, v6, v10, vcc
    s_lshr_b32 s44, s23, 1
    s_lshl_b32 s52, s22, 7
    s_add_u32 s52, s52, s44
    s_lshl_b32 s52, s52, 8
    s_add_u32 s52, s52, 0x4508000
    s_add_u32 s52, s52, s4
    s_addc_u32 s53, s5, 0
    s_waitcnt vmcnt(3)
    s_barrier
    s_cmp_lg_u32 s20, 0
    s_cbranch_scc1 L_ns_d2
    s_mov_b32 s56, 1
    s_atomic_add s56, s[50:51], 0
L_ns_d2:
    s_cmp_lg_u32 s20, 0
    s_cbranch_scc1 L_pd_d2
    s_mov_b32 s60, 65536
L_poll_d2:
    s_mov_b32 s57, 0
    s_atomic_add s57, s[52:53], 0 glc
    s_waitcnt lgkmcnt(0)
    s_cmp_ge_u32 s57, 16
    s_cbranch_scc1 L_pd_d2
    s_sub_u32 s60, s60, 1
    s_cbranch_scc1 L_pd_d2
    s_sleep 2
    s_branch L_poll_d2
L_pd_d2:
    s_barrier
    s_mov_b32 s32, 0
    s_lshl_b32 s32, s32, 13
    s_add_u32 s32, s32, s29
    s_add_u32 s33, s32, 4096
    buffer_load_dwordx4 v[112:115], v1, s[4:7], s32 offen offset:0 sc1
    buffer_load_dwordx4 v[116:119], v1, s[4:7], s32 offen offset:1024 sc1
    buffer_load_dwordx4 v[120:123], v1, s[4:7], s32 offen offset:2048 sc1
    buffer_load_dwordx4 v[124:127], v1, s[4:7], s32 offen offset:3072 sc1
    buffer_load_dwordx4 v[128:131], v1, s[4:7], s33 offen offset:0 sc1
    buffer_load_dwordx4 v[132:135], v1, s[4:7], s33 offen offset:1024 sc1
    buffer_load_dwordx4 v[136:139], v1, s[4:7], s33 offen offset:2048 sc1
    buffer_load_dwordx4 v[140:143], v1, s[4:7], s33 offen offset:3072 sc1
    ds_read_b128 v[40:43], v12 offset:18432
    ds_read_b128 v[44:47], v12 offset:19456
    ds_read_b128 v[48:51], v12 offset:20480
    ds_read_b128 v[52:55], v12 offset:21504
    ds_read_b128 v[72:75], v12 offset:26624
    ds_read_b128 v[56:59], v12 offset:22528
    ds_read_b128 v[60:63], v12 offset:23552
    ds_read_b128 v[64:67], v12 offset:24576
    ds_read_b128 v[68:71], v12 offset:25600
    s_add_u32 s45, s29, 8192
    s_add_u32 s46, s29, 12288
    s_add_u32 s47, s29, 16384
    buffer_load_dwordx4 v[144:147], v1, s[4:7], s45 offen offset:0 sc1
    buffer_load_dwordx4 v[148:151], v1, s[4:7], s45 offen offset:1024 sc1
    s_lshl_b32 s42, s23, 3
    s_add_u32 s42, s42, s24
    s_lshl_b32 s42, s42, 2
    s_add_u32 s42, s42, s20
    s_lshl_b32 s42, s42, 8
    s_add_u32 s42, s42, s21
    s_add_u32 s42, s42, 0x1b40000
    v_mov_b32 v220, -1.0
    v_lshrrev_b32 v221, 2, v1
    buffer_store_dword v220, v221, s[4:7], s42 offen sc1
    s_lshl_b32 s50, s22, 7
    s_add_u32 s50, s50, s44
    s_lshl_b32 s50, s50, 8
    s_add_u32 s50, s50, 0x4509000
    s_add_u32 s50, s50, s4
    s_addc_u32 s51, s5, 0
    s_waitcnt vmcnt(11)
    v_lshlrev_b32 v16, 16, v208
    v_and_b32 v17, 0xffff0000, v208
    v_lshlrev_b32 v18, 16, v209
    v_and_b32 v19, 0xffff0000, v209
    v_lshlrev_b32 v20, 16, v210
    v_and_b32 v21, 0xffff0000, v210
    v_lshlrev_b32 v22, 16, v211
    v_and_b32 v23, 0xffff0000, v211
    v_lshlrev_b32 v24, 16, v212
    v_and_b32 v25, 0xffff0000, v212
    v_lshlrev_b32 v26, 16, v213
    v_and_b32 v27, 0xffff0000, v213
    v_lshlrev_b32 v28, 16, v214
    v_and_b32 v29, 0xffff0000, v214
    v_lshlrev_b32 v30, 16, v215
    v_and_b32 v31, 0xffff0000, v215
    v_lshlrev_b32 v32, 16, v216
    v_and_b32 v33, 0xffff0000, v216
    v_lshlrev_b32 v34, 16, v217
    v_and_b32 v35, 0xffff0000, v217
    s_waitcnt vmcnt(9) lgkmcnt(4)
    v_mfma_f32_16x16x32_bf16 v[16:19], v[40:43], v[112:115], v[16:19]
    ds_read_b128 v[76:79], v12 offset:27648
    v_mfma_f32_16x16x32_bf16 v[20:23], v[44:47], v[112:115], v[20:23]
    ds_read_b128 v[80:83], v12 offset:28672
    buffer_load_dwordx4 v[152:155], v1, s[4:7], s45 offen offset:2048 sc1
    v_mfma_f32_16x16x32_bf16 v[24:27], v[48:51], v[112:115], v[24:27]
    ds_read_b128 v[84:87], v12 offset:29696
    v_mfma_f32_16x16x32_bf16 v[28:31], v[52:55], v[112:115], v[28:31]
    ds_read_b128 v[88:91], v12 offset:30720
    v_mfma_f32_16x16x32_bf16 v[32:35], v[72:75], v[112:115], v[32:35]
    ds_read_b128 v[108:111], v12 offset:35840
    s_waitcnt lgkmcnt(5)
    buffer_load_dwordx4 v[156:159], v1, s[4:7], s45 offen offset:3072 sc1
    v_mfma_f32_16x16x32_bf16 v[16:19], v[56:59], v[116:119], v[16:19]
    ds_read_b128 v[92:95], v12 offset:31744
    v_mfma_f32_16x16x32_bf16 v[20:23], v[60:63], v[116:119], v[20:23]
    ds_read_b128 v[96:99], v12 offset:32768
    v_mfma_f32_16x16x32_bf16 v[24:27], v[64:67], v[116:119], v[24:27]
    ds_read_b128 v[100:103], v12 offset:33792
    buffer_load_dwordx4 v[160:163], v1, s[4:7], s46 offen offset:0 sc1
    v_mfma_f32_16x16x32_bf16 v[28:31], v[68:71], v[116:119], v[28:31]
    ds_read_b128 v[104:107], v12 offset:34816
    v_mfma_f32_16x16x32_bf16 v[36:39], v[72:75], v[116:119], 0
    s_waitcnt vmcnt(10) lgkmcnt(4)
    v_mfma_f32_16x16x32_bf16 v[16:19], v[76:79], v[120:123], v[16:19]
    ds_read_b128 v[40:43], v13 offset:18432
    v_mfma_f32_16x16x32_bf16 v[20:23], v[80:83], v[120:123], v[20:23]
    ds_read_b128 v[44:47], v13 offset:19456
    buffer_load_dwordx4 v[164:167], v1, s[4:7], s46 offen offset:1024 sc1
    v_mfma_f32_16x16x32_bf16 v[24:27], v[84:87], v[120:123], v[24:27]
    ds_read_b128 v[48:51], v13 offset:20480
    v_mfma_f32_16x16x32_bf16 v[28:31], v[88:91], v[120:123], v[28:31]
    ds_read_b128 v[52:55], v13 offset:21504
    v_mfma_f32_16x16x32_bf16 v[32:35], v[108:111], v[120:123], v[32:35]
    ds_read_b128 v[72:75], v13 offset:26624
    s_waitcnt lgkmcnt(5)
    buffer_load_dwordx4 v[168:171], v1, s[4:7], s46 offen offset:2048 sc1
    v_mfma_f32_16x16x32_bf16 v[16:19], v[92:95], v[124:127], v[16:19]
    ds_read_b128 v[56:59], v13 offset:22528
    v_mfma_f32_16x16x32_bf16 v[20:23], v[96:99], v[124:127], v[20:23]
    ds_read_b128 v[60:63], v13 offset:23552
    v_mfma_f32_16x16x32_bf16 v[24:27], v[100:103], v[124:127], v[24:27]
    ds_read_b128 v[64:67], v13 offset:24576
    buffer_load_dwordx4 v[172:175], v1, s[4:7], s46 offen offset:3072 sc1
    v_mfma_f32_16x16x32_bf16 v[28:31], v[104:107], v[124:127], v[28:31]
    ds_read_b128 v[68:71], v13 offset:25600
    v_mfma_f32_16x16x32_bf16 v[36:39], v[108:111], v[124:127], v[36:39]
    s_waitcnt vmcnt(11) lgkmcnt(4)
    v_mfma_f32_16x16x32_bf16 v[16:19], v[40:43], v[128:131], v[16:19]
    ds_read_b128 v[76:79], v13 offset:27648
    v_mfma_f32_16x16x32_bf16 v[20:23], v[44:47], v[128:131], v[20:23]
    ds_read_b128 v[80:83], v13 offset:28672
    buffer_load_dwordx2 v[176:177], v7, s[4:7], s47 offen offset:0 sc1
    v_mfma_f32_16x16x32_bf16 v[24:27], v[48:51], v[128:131], v[24:27]
    ds_read_b128 v[84:87], v13 offset:29696
    v_mfma_f32_16x16x32_bf16 v[28:31], v[52:55], v[128:131], v[28:31]
    ds_read_b128 v[88:91], v13 offset:30720
    v_mfma_f32_16x16x32_bf16 v[32:35], v[72:75], v[128:131], v[32:35]
    ds_read_b128 v[108:111], v13 offset:35840
    s_waitcnt lgkmcnt(5)
    buffer_load_dwordx2 v[178:179], v7, s[4:7], s47 offen offset:128 sc1
    v_mfma_f32_16x16x32_bf16 v[16:19], v[56:59], v[132:135], v[16:19]
    ds_read_b128 v[92:95], v13 offset:31744
    v_mfma_f32_16x16x32_bf16 v[20:23], v[60:63], v[132:135], v[20:23]
    ds_read_b128 v[96:99], v13 offset:32768
    v_mfma_f32_16x16x32_bf16 v[24:27], v[64:67], v[132:135], v[24:27]
    ds_read_b128 v[100:103], v13 offset:33792
    buffer_load_dwordx2 v[180:181], v7, s[4:7], s47 offen offset:1024 sc1
    v_mfma_f32_16x16x32_bf16 v[28:31], v[68:71], v[132:135], v[28:31]
    ds_read_b128 v[104:107], v13 offset:34816
    v_mfma_f32_16x16x32_bf16 v[36:39], v[72:75], v[132:135], v[36:39]
    s_waitcnt vmcnt(12) lgkmcnt(4)
    v_mfma_f32_16x16x32_bf16 v[16:19], v[76:79], v[136:139], v[16:19]
    ds_read_b128 v[40:43], v14 offset:18432
    v_mfma_f32_16x16x32_bf16 v[20:23], v[80:83], v[136:139], v[20:23]
    ds_read_b128 v[44:47], v14 offset:19456
    buffer_load_dwordx2 v[182:183], v7, s[4:7], s47 offen offset:1152 sc1
    v_mfma_f32_16x16x32_bf16 v[24:27], v[84:87], v[136:139], v[24:27]
    ds_read_b128 v[48:51], v14 offset:20480
    v_mfma_f32_16x16x32_bf16 v[28:31], v[88:91], v[136:139], v[28:31]
    ds_read_b128 v[52:55], v14 offset:21504
    v_mfma_f32_16x16x32_bf16 v[32:35], v[108:111], v[136:139], v[32:35]
    ds_read_b128 v[72:75], v14 offset:26624
    s_waitcnt lgkmcnt(5)
    v_mfma_f32_16x16x32_bf16 v[16:19], v[92:95], v[140:143], v[16:19]
    ds_read_b128 v[56:59], v14 offset:22528
    v_mfma_f32_16x16x32_bf16 v[20:23], v[96:99], v[140:143], v[20:23]
    ds_read_b128 v[60:63], v14 offset:23552
    v_mfma_f32_16x16x32_bf16 v[24:27], v[100:103], v[140:143], v[24:27]
    ds_read_b128 v[64:67], v14 offset:24576
    v_mfma_f32_16x16x32_bf16 v[28:31], v[104:107], v[140:143], v[28:31]
    ds_read_b128 v[68:71], v14 offset:25600
    v_mfma_f32_16x16x32_bf16 v[36:39], v[108:111], v[140:143], v[36:39]
    s_waitcnt vmcnt(11) lgkmcnt(4)
    v_mfma_f32_16x16x32_bf16 v[16:19], v[40:43], v[144:147], v[16:19]
    ds_read_b128 v[76:79], v14 offset:27648
    v_mfma_f32_16x16x32_bf16 v[20:23], v[44:47], v[144:147], v[20:23]
    ds_read_b128 v[80:83], v14 offset:28672
    v_mfma_f32_16x16x32_bf16 v[24:27], v[48:51], v[144:147], v[24:27]
    ds_read_b128 v[84:87], v14 offset:29696
    v_mfma_f32_16x16x32_bf16 v[28:31], v[52:55], v[144:147], v[28:31]
    ds_read_b128 v[88:91], v14 offset:30720
    v_mfma_f32_16x16x32_bf16 v[32:35], v[72:75], v[144:147], v[32:35]
    ds_read_b128 v[108:111], v14 offset:35840
    s_waitcnt lgkmcnt(5)
    v_mfma_f32_16x16x32_bf16 v[16:19], v[56:59], v[148:151], v[16:19]
    ds_read_b128 v[92:95], v14 offset:31744
    v_mfma_f32_16x16x32_bf16 v[20:23], v[60:63], v[148:151], v[20:23]
    ds_read_b128 v[96:99], v14 offset:32768
    v_mfma_f32_16x16x32_bf16 v[24:27], v[64:67], v[148:151], v[24:27]
    ds_read_b128 v[100:103], v14 offset:33792
    v_mfma_f32_16x16x32_bf16 v[28:31], v[68:71], v[148:151], v[28:31]
    ds_read_b128 v[104:107], v14 offset:34816
    v_mfma_f32_16x16x32_bf16 v[36:39], v[72:75], v[148:151], v[36:39]
    s_waitcnt vmcnt(8) lgkmcnt(4)
    v_mfma_f32_16x16x32_bf16 v[16:19], v[76:79], v[152:155], v[16:19]
    ds_read_b128 v[40:43], v15 offset:18432
    v_mfma_f32_16x16x32_bf16 v[20:23], v[80:83], v[152:155], v[20:23]
    ds_read_b128 v[44:47], v15 offset:19456
    v_mfma_f32_16x16x32_bf16 v[24:27], v[84:87], v[152:155], v[24:27]
    ds_read_b128 v[48:51], v15 offset:20480
    v_mfma_f32_16x16x32_bf16 v[28:31], v[88:91], v[152:155], v[28:31]
    ds_read_b128 v[52:55], v15 offset:21504
    v_mfma_f32_16x16x32_bf16 v[32:35], v[108:111], v[152:155], v[32:35]
    ds_read_b128 v[72:75], v15 offset:26624
    s_waitcnt lgkmcnt(5)
    v_mfma_f32_16x16x32_bf16 v[16:19], v[92:95], v[156:159], v[16:19]
    ds_read_b128 v[56:59], v15 offset:22528
    v_mfma_f32_16x16x32_bf16 v[20:23], v[96:99], v[156:159], v[20:23]
    ds_read_b128 v[60:63], v15 offset:23552
    v_mfma_f32_16x16x32_bf16 v[24:27], v[100:103], v[156:159], v[24:27]
    ds_read_b128 v[64:67], v15 offset:24576
    v_mfma_f32_16x16x32_bf16 v[28:31], v[104:107], v[156:159], v[28:31]
    ds_read_b128 v[68:71], v15 offset:25600
    v_mfma_f32_16x16x32_bf16 v[36:39], v[108:111], v[156:159], v[36:39]
    s_waitcnt vmcnt(6) lgkmcnt(4)
    v_mfma_f32_16x16x32_bf16 v[16:19], v[40:43], v[160:163], v[16:19]
    ds_read_b128 v[76:79], v15 offset:27648
    v_mfma_f32_16x16x32_bf16 v[20:23], v[44:47], v[160:163], v[20:23]
    ds_read_b128 v[80:83], v15 offset:28672
    v_mfma_f32_16x16x32_bf16 v[24:27], v[48:51], v[160:163], v[24:27]
    ds_read_b128 v[84:87], v15 offset:29696
    v_mfma_f32_16x16x32_bf16 v[28:31], v[52:55], v[160:163], v[28:31]
    ds_read_b128 v[88:91], v15 offset:30720
    v_mfma_f32_16x16x32_bf16 v[32:35], v[72:75], v[160:163], v[32:35]
    ds_read_b128 v[108:111], v15 offset:35840
    s_waitcnt lgkmcnt(5)
    v_mfma_f32_16x16x32_bf16 v[16:19], v[56:59], v[164:167], v[16:19]
    ds_read_b128 v[92:95], v15 offset:31744
    v_mfma_f32_16x16x32_bf16 v[20:23], v[60:63], v[164:167], v[20:23]
    ds_read_b128 v[96:99], v15 offset:32768
    v_mfma_f32_16x16x32_bf16 v[24:27], v[64:67], v[164:167], v[24:27]
    ds_read_b128 v[100:103], v15 offset:33792
    v_mfma_f32_16x16x32_bf16 v[28:31], v[68:71], v[164:167], v[28:31]
    ds_read_b128 v[104:107], v15 offset:34816
    v_mfma_f32_16x16x32_bf16 v[36:39], v[72:75], v[164:167], v[36:39]
    s_waitcnt vmcnt(4) lgkmcnt(4)
    v_mfma_f32_16x16x32_bf16 v[16:19], v[76:79], v[168:171], v[16:19]
    ds_read_b128 v[40:43], v15 offset:36864
    v_mfma_f32_16x16x32_bf16 v[20:23], v[80:83], v[168:171], v[20:23]
    ds_read_b128 v[44:47], v15 offset:37888
    v_mfma_f32_16x16x32_bf16 v[24:27], v[84:87], v[168:171], v[24:27]
    ds_read_b128 v[48:51], v15 offset:38912
    v_mfma_f32_16x16x32_bf16 v[28:31], v[88:91], v[168:171], v[28:31]
    ds_read_b128 v[52:55], v15 offset:39936
    v_mfma_f32_16x16x32_bf16 v[32:35], v[108:111], v[168:171], v[32:35]
    ds_read_b128 v[72:75], v15 offset:45056
    s_waitcnt lgkmcnt(5)
    v_mfma_f32_16x16x32_bf16 v[16:19], v[92:95], v[172:175], v[16:19]
    ds_read_b128 v[56:59], v15 offset:40960
    v_mfma_f32_16x16x32_bf16 v[20:23], v[96:99], v[172:175], v[20:23]
    ds_read_b128 v[60:63], v15 offset:41984
    v_mfma_f32_16x16x32_bf16 v[24:27], v[100:103], v[172:175], v[24:27]
    ds_read_b128 v[64:67], v15 offset:43008
    v_mfma_f32_16x16x32_bf16 v[28:31], v[104:107], v[172:175], v[28:31]
    ds_read_b128 v[68:71], v15 offset:44032
    v_mfma_f32_16x16x32_bf16 v[36:39], v[108:111], v[172:175], v[36:39]
    s_waitcnt vmcnt(0) lgkmcnt(4)
    v_mfma_f32_16x16x32_bf16 v[16:19], v[40:43], v[176:179], v[16:19]
    v_mfma_f32_16x16x32_bf16 v[20:23], v[44:47], v[176:179], v[20:23]
    v_mfma_f32_16x16x32_bf16 v[24:27], v[48:51], v[176:179], v[24:27]
    v_mfma_f32_16x16x32_bf16 v[28:31], v[52:55], v[176:179], v[28:31]
    v_mfma_f32_16x16x32_bf16 v[32:35], v[72:75], v[176:179], v[32:35]
    s_waitcnt lgkmcnt(0)
    v_mfma_f32_16x16x32_bf16 v[16:19], v[56:59], v[180:183], v[16:19]
    v_mfma_f32_16x16x32_bf16 v[20:23], v[60:63], v[180:183], v[20:23]
    v_mfma_f32_16x16x32_bf16 v[24:27], v[64:67], v[180:183], v[24:27]
    v_mfma_f32_16x16x32_bf16 v[28:31], v[68:71], v[180:183], v[28:31]
    v_mfma_f32_16x16x32_bf16 v[36:39], v[72:75], v[180:183], v[36:39]
    s_nop 3
    v_cvt_pk_bf16_f32 v208, v16, v17
    v_cvt_pk_bf16_f32 v209, v18, v19
    v_cvt_pk_bf16_f32 v210, v20, v21
    v_cvt_pk_bf16_f32 v211, v22, v23
    v_cvt_pk_bf16_f32 v212, v24, v25
    v_cvt_pk_bf16_f32 v213, v26, v27
    v_cvt_pk_bf16_f32 v214, v28, v29
    v_cvt_pk_bf16_f32 v215, v30, v31
    buffer_store_dwordx4 v[208:211], v4, s[4:7], s34 offen offset:0 sc1
    buffer_store_dwordx4 v[212:215], v4, s[4:7], s34 offen offset:1024 sc1
    v_permlane32_swap_b32 v36, v220
    v_permlane32_swap_b32 v37, v221
    v_permlane32_swap_b32 v38, v222
    v_permlane32_swap_b32 v39, v223
    v_pk_add_f32 v[32:33], v[32:33], v[220:221]
    v_pk_add_f32 v[34:35], v[34:35], v[222:223]
    v_cvt_pk_bf16_f32 v216, v32, v33
    v_cvt_pk_bf16_f32 v217, v34, v35
    buffer_store_dwordx2 v[216:217], v5, s[4:7], s34 offen sc1
    v_cndmask_b32 v222, 0, v216, s[40:41]
    v_cndmask_b32 v223, 0, v217, s[40:41]
    v_dot2_f32_bf16 v220, v208, v11, 0
    v_dot2_f32_bf16 v221, v208, v208, 0
    v_dot2_f32_bf16 v224, v209, v11, 0
    v_dot2_f32_bf16 v225, v209, v209, 0
    v_dot2_f32_bf16 v220, v210, v11, v220
    v_dot2_f32_bf16 v221, v210, v210, v221
    v_dot2_f32_bf16 v224, v211, v11, v224
    v_dot2_f32_bf16 v225, v211, v211, v225
    v_dot2_f32_bf16 v220, v212, v11, v220
    v_dot2_f32_bf16 v221, v212, v212, v221
    v_dot2_f32_bf16 v224, v213, v11, v224
    v_dot2_f32_bf16 v225, v213, v213, v225
    v_dot2_f32_bf16 v220, v214, v11, v220
    v_dot2_f32_bf16 v221, v214, v214, v221
    v_dot2_f32_bf16 v224, v215, v11, v224
    v_dot2_f32_bf16 v225, v215, v215, v225
    v_dot2_f32_bf16 v220, v222, v11, v220
    v_dot2_f32_bf16 v221, v222, v222, v221
    v_dot2_f32_bf16 v224, v223, v11, v224
    v_dot2_f32_bf16 v225, v223, v223, v225
    s_nop 2
    v_pk_add_f32 v[220:221], v[220:221], v[224:225]
    v_mov_b32 v222, v220
    v_mov_b32 v223, v221
    s_nop 1
    v_permlane32_swap_b32 v220, v222
    v_permlane32_swap_b32 v221, v223
    v_add_f32 v220, v220, v222
    v_add_f32 v221, v221, v223
    v_mov_b32 v222, v220
    v_mov_b32 v223, v221
    s_nop 1
    v_permlane16_swap_b32 v220, v222
    v_permlane16_swap_b32 v221, v223
    v_add_f32 v220, v220, v222
    v_add_f32 v221, v221, v223
    buffer_store_dwordx2 v[220:221], v10, s[4:7], s39 offen sc1
    s_and_b32 s25, s2, 7
    s_lshr_b32 s26, s2, 3
    s_and_b32 s23, s25, 1
    s_lshl_b32 s23, s23, 3
    s_and_b32 s27, s26, 7
    s_add_u32 s23, s23, s27
    s_lshr_b32 s24, s25, 1
    s_lshl_b32 s24, s24, 2
    s_lshr_b32 s27, s26, 3
    s_add_u32 s24, s24, s27
    s_add_u32 s28, s23, s24
    s_and_b32 s28, s28, 3
    s_lshl_b32 s30, s20, 12
    s_lshl_b32 s31, s23, 3
    s_lshl_b32 s33, s20, 1
    s_add_u32 s31, s31, s33
    s_lshl_b32 s32, s31, 10
    s_add_u32 s32, s32, s21
    s_add_u32 s32, s32, 0x1b20000
    v_add_u32 v2, 73728, v1
    s_add_u32 s33, s30, 18432
    v_add_u32 v3, s33, v1
    v_add_u32 v0, s33, v2
    s_lshr_b32 s34, s31, 1
    s_lshl_b32 s35, s34, 12
    s_add_u32 s35, s35, s21
    s_add_u32 s35, s35, 0x1b40000
    s_lshl_b32 s36, s24, 8
    s_add_u32 s36, s36, s35
    s_lshl_b32 s38, s24, 6
    s_add_u32 s38, s38, s34
    s_mul_i32 s38, s38, 9216
    s_add_u32 s38, s38, s21
    s_add_u32 s38, s38, 0x900000
    s_add_u32 s39, s38, 4096
    s_add_u32 s46, s38, 8192
    s_mov_b32 s40, 0xc0135761
    s_mov_b32 s42, 0x3d372713
    s_mov_b32 s44, 0x39e38e39
    s_mov_b32 s45, 0x3727c5ac
    v_lshrrev_b32 v4, 1, v1
    s_lshl_b32 s52, s22, 7
    s_add_u32 s52, s52, s23
    s_lshl_b32 s52, s52, 8
    s_add_u32 s52, s52, 0x4509000
    s_add_u32 s52, s52, s4
    s_addc_u32 s53, s5, 0
    s_waitcnt vmcnt(0)
    s_barrier
    s_cmp_lg_u32 s20, 0
    s_cbranch_scc1 L_ns_d3
    s_mov_b32 s56, 1
    s_atomic_add s56, s[50:51], 0
L_ns_d3:
    s_cmp_lg_u32 s20, 0
    s_cbranch_scc1 L_pd_d3
    s_mov_b32 s60, 65536
L_poll_d3:
    s_mov_b32 s57, 0
    s_atomic_add s57, s[52:53], 0 glc
    s_waitcnt lgkmcnt(0)
    s_cmp_ge_u32 s57, 16
    s_cbranch_scc1 L_pd_d3
    s_sub_u32 s60, s60, 1
    s_cbranch_scc1 L_pd_d3
    s_sleep 2
    s_branch L_poll_d3
L_pd_d3:
    s_barrier
    buffer_load_dwordx2 v[8:9], v4, s[4:7], s32 offen offset:0 sc1
    buffer_load_dwordx2 v[10:11], v4, s[4:7], s32 offen offset:512 sc1
    buffer_load_dwordx2 v[12:13], v4, s[4:7], s32 offen offset:1024 sc1
    buffer_load_dwordx2 v[14:15], v4, s[4:7], s32 offen offset:1536 sc1
    s_lshl_b32 s50, s22, 7
    s_add_u32 s50, s50, s23
    s_lshl_b32 s50, s50, 8
    s_add_u32 s50, s50, 0x450a000
    s_add_u32 s50, s50, s4
    s_addc_u32 s51, s5, 0
    s_barrier
    ds_read_b128 v[160:163], v3 offset:0
    ds_read_b128 v[164:167], v3 offset:2048
    ds_read_b128 v[168:171], v1 offset:0
    ds_read_b128 v[172:175], v1 offset:1024
    ds_read_b128 v[176:179], v1 offset:2048
    ds_read_b128 v[180:183], v1 offset:3072
    ds_read_b128 v[184:187], v1 offset:4096
    ds_read_b128 v[188:191], v1 offset:5120
    ds_read_b128 v[192:195], v1 offset:6144
    ds_read_b128 v[196:199], v1 offset:7168
    ds_read_b128 v[200:203], v1 offset:8192
    s_waitcnt lgkmcnt(5)
    v_mfma_f32_16x16x32_bf16 v[16:19], v[160:163], v[168:171], 0
    ds_read_b128 v[204:207], v3 offset:1024
    v_mfma_f32_16x16x32_bf16 v[20:23], v[164:167], v[168:171], 0
    ds_read_b128 v[208:211], v3 offset:3072
    v_mfma_f32_16x16x32_bf16 v[24:27], v[160:163], v[172:175], 0
    ds_read_b128 v[212:215], v1 offset:9216
    v_mfma_f32_16x16x32_bf16 v[28:31], v[164:167], v[172:175], 0
    ds_read_b128 v[216:219], v1 offset:10240
    v_mfma_f32_16x16x32_bf16 v[32:35], v[160:163], v[176:179], 0
    ds_read_b128 v[220:223], v1 offset:11264
    v_mfma_f32_16x16x32_bf16 v[36:39], v[164:167], v[176:179], 0
    ds_read_b128 v[224:227], v1 offset:12288
    v_mfma_f32_16x16x32_bf16 v[40:43], v[160:163], v[180:183], 0
    ds_read_b128 v[228:231], v1 offset:13312
    v_mfma_f32_16x16x32_bf16 v[44:47], v[164:167], v[180:183], 0
    ds_read_b128 v[232:235], v1 offset:14336
    s_waitcnt lgkmcnt(8)
    v_mfma_f32_16x16x32_bf16 v[48:51], v[160:163], v[184:187], 0
    ds_read_b128 v[236:239], v1 offset:15360
    v_mfma_f32_16x16x32_bf16 v[52:55], v[164:167], v[184:187], 0
    ds_read_b128 v[240:243], v1 offset:16384
    v_mfma_f32_16x16x32_bf16 v[56:59], v[160:163], v[188:191], 0
    ds_read_b128 v[244:247], v1 offset:17408
    v_mfma_f32_16x16x32_bf16 v[60:63], v[164:167], v[188:191], 0
    v_mfma_f32_16x16x32_bf16 v[64:67], v[160:163], v[192:195], 0
    v_mfma_f32_16x16x32_bf16 v[68:71], v[164:167], v[192:195], 0
    v_mfma_f32_16x16x32_bf16 v[72:75], v[160:163], v[196:199], 0
    v_mfma_f32_16x16x32_bf16 v[76:79], v[164:167], v[196:199], 0
    v_mfma_f32_16x16x32_bf16 v[80:83], v[160:163], v[200:203], 0
    v_mfma_f32_16x16x32_bf16 v[84:87], v[164:167], v[200:203], 0
    s_waitcnt lgkmcnt(0)
    s_barrier
    v_mfma_f32_16x16x32_bf16 v[16:19], v[204:207], v[212:215], v[16:19]
    ds_read_b128 v[160:163], v3 offset:36864
    v_mfma_f32_16x16x32_bf16 v[20:23], v[208:211], v[212:215], v[20:23]
    ds_read_b128 v[164:167], v3 offset:38912
    v_mfma_f32_16x16x32_bf16 v[24:27], v[204:207], v[216:219], v[24:27]
    ds_read_b128 v[168:171], v1 offset:36864
    v_mfma_f32_16x16x32_bf16 v[28:31], v[208:211], v[216:219], v[28:31]
    ds_read_b128 v[172:175], v1 offset:37888
    v_mfma_f32_16x16x32_bf16 v[32:35], v[204:207], v[220:223], v[32:35]
    ds_read_b128 v[176:179], v1 offset:38912
    v_mfma_f32_16x16x32_bf16 v[36:39], v[208:211], v[220:223], v[36:39]
    ds_read_b128 v[180:183], v1 offset:39936
    v_mfma_f32_16x16x32_bf16 v[40:43], v[204:207], v[224:227], v[40:43]
    ds_read_b128 v[184:187], v1 offset:40960
    v_mfma_f32_16x16x32_bf16 v[44:47], v[208:211], v[224:227], v[44:47]
    ds_read_b128 v[188:191], v1 offset:41984
    v_mfma_f32_16x16x32_bf16 v[48:51], v[204:207], v[228:231], v[48:51]
    ds_read_b128 v[192:195], v1 offset:43008
    v_mfma_f32_16x16x32_bf16 v[52:55], v[208:211], v[228:231], v[52:55]
    ds_read_b128 v[196:199], v1 offset:44032
    v_lshrrev_b32 v5, 8, v1
    v_mfma_f32_16x16x32_bf16 v[56:59], v[204:207], v[232:235], v[56:59]
    ds_read_b128 v[200:203], v1 offset:45056
    v_bfe_u32 v6, v1, 4, 4
    v_mfma_f32_16x16x32_bf16 v[60:63], v[208:211], v[232:235], v[60:63]
    v_lshlrev_b32 v7, 2, v6
    v_mfma_f32_16x16x32_bf16 v[64:67], v[204:207], v[236:239], v[64:67]
    s_lshl_b32 s33, s20, 8
    v_mfma_f32_16x16x32_bf16 v[68:71], v[208:211], v[236:239], v[68:71]
    s_add_u32 s33, s33, 147456
    v_mfma_f32_16x16x32_bf16 v[72:75], v[204:207], v[240:243], v[72:75]
    v_add_u32 v4, s33, v7
    v_mfma_f32_16x16x32_bf16 v[76:79], v[208:211], v[240:243], v[76:79]
    v_lshl_add_u32 v252, v5, 4, s33
    v_mfma_f32_16x16x32_bf16 v[80:83], v[204:207], v[244:247], v[80:83]
    v_add_u32 v7, 159744, v7
    v_mfma_f32_16x16x32_bf16 v[84:87], v[208:211], v[244:247], v[84:87]
    s_waitcnt vmcnt(0)
    v_add_f32 v248, v8, v10
    s_waitcnt lgkmcnt(5)
    v_mfma_f32_16x16x32_bf16 v[16:19], v[160:163], v[168:171], v[16:19]
    ds_read_b128 v[204:207], v3 offset:37888
    v_mfma_f32_16x16x32_bf16 v[20:23], v[164:167], v[168:171], v[20:23]
    ds_read_b128 v[208:211], v3 offset:39936
    v_mfma_f32_16x16x32_bf16 v[24:27], v[160:163], v[172:175], v[24:27]
    ds_read_b128 v[212:215], v1 offset:46080
    v_mfma_f32_16x16x32_bf16 v[28:31], v[164:167], v[172:175], v[28:31]
    ds_read_b128 v[216:219], v1 offset:47104
    v_mfma_f32_16x16x32_bf16 v[32:35], v[160:163], v[176:179], v[32:35]
    ds_read_b128 v[220:223], v1 offset:48128
    v_mfma_f32_16x16x32_bf16 v[36:39], v[164:167], v[176:179], v[36:39]
    ds_read_b128 v[224:227], v1 offset:49152
    v_mfma_f32_16x16x32_bf16 v[40:43], v[160:163], v[180:183], v[40:43]
    ds_read_b128 v[228:231], v1 offset:50176
    v_mfma_f32_16x16x32_bf16 v[44:47], v[164:167], v[180:183], v[44:47]
    ds_read_b128 v[232:235], v1 offset:51200
    s_waitcnt lgkmcnt(8)
    v_mfma_f32_16x16x32_bf16 v[48:51], v[160:163], v[184:187], v[48:51]
    ds_read_b128 v[236:239], v1 offset:52224
    v_mfma_f32_16x16x32_bf16 v[52:55], v[164:167], v[184:187], v[52:55]
    ds_read_b128 v[240:243], v1 offset:53248
    v_add_f32 v249, v9, v11
    v_mfma_f32_16x16x32_bf16 v[56:59], v[160:163], v[188:191], v[56:59]
    ds_read_b128 v[244:247], v1 offset:54272
    v_add_f32 v250, v12, v14
    v_mfma_f32_16x16x32_bf16 v[60:63], v[164:167], v[188:191], v[60:63]
    v_add_f32 v251, v13, v15
    v_mfma_f32_16x16x32_bf16 v[64:67], v[160:163], v[192:195], v[64:67]
    v_mov_b32 v8, v248
    v_mfma_f32_16x16x32_bf16 v[68:71], v[164:167], v[192:195], v[68:71]
    v_mov_b32 v9, v249
    v_mfma_f32_16x16x32_bf16 v[72:75], v[160:163], v[196:199], v[72:75]
    v_mov_b32 v12, v250
    v_mfma_f32_16x16x32_bf16 v[76:79], v[164:167], v[196:199], v[76:79]
    v_mov_b32 v13, v251
    v_mfma_f32_16x16x32_bf16 v[80:83], v[160:163], v[200:203], v[80:83]
    v_permlane32_swap_b32 v248, v8
    v_mfma_f32_16x16x32_bf16 v[84:87], v[164:167], v[200:203], v[84:87]
    v_permlane32_swap_b32 v249, v9
    v_permlane32_swap_b32 v250, v12
    s_waitcnt lgkmcnt(0)
    s_barrier
    v_mfma_f32_16x16x32_bf16 v[16:19], v[204:207], v[212:215], v[16:19]
    ds_read_b128 v[160:163], v0 offset:0
    v_mfma_f32_16x16x32_bf16 v[20:23], v[208:211], v[212:215], v[20:23]
    ds_read_b128 v[164:167], v0 offset:2048
    v_mfma_f32_16x16x32_bf16 v[24:27], v[204:207], v[216:219], v[24:27]
    ds_read_b128 v[168:171], v2 offset:0
    v_mfma_f32_16x16x32_bf16 v[28:31], v[208:211], v[216:219], v[28:31]
    ds_read_b128 v[172:175], v2 offset:1024
    v_mfma_f32_16x16x32_bf16 v[32:35], v[204:207], v[220:223], v[32:35]
    ds_read_b128 v[176:179], v2 offset:2048
    v_mfma_f32_16x16x32_bf16 v[36:39], v[208:211], v[220:223], v[36:39]
    ds_read_b128 v[180:183], v2 offset:3072
    v_mfma_f32_16x16x32_bf16 v[40:43], v[204:207], v[224:227], v[40:43]
    ds_read_b128 v[184:187], v2 offset:4096
    v_mfma_f32_16x16x32_bf16 v[44:47], v[208:211], v[224:227], v[44:47]
    ds_read_b128 v[188:191], v2 offset:5120
    v_mfma_f32_16x16x32_bf16 v[48:51], v[204:207], v[228:231], v[48:51]
    ds_read_b128 v[192:195], v2 offset:6144
    v_mfma_f32_16x16x32_bf16 v[52:55], v[208:211], v[228:231], v[52:55]
    ds_read_b128 v[196:199], v2 offset:7168
    v_permlane32_swap_b32 v251, v13
    v_mfma_f32_16x16x32_bf16 v[56:59], v[204:207], v[232:235], v[56:59]
    ds_read_b128 v[200:203], v2 offset:8192
    v_add_f32 v248, v248, v8
    v_mfma_f32_16x16x32_bf16 v[60:63], v[208:211], v[232:235], v[60:63]
    ds_read2_b32 v[128:129], v7 offset0:0 offset1:16
    v_add_f32 v249, v249, v9
    v_mfma_f32_16x16x32_bf16 v[64:67], v[204:207], v[236:239], v[64:67]
    ds_read2_b32 v[130:131], v7 offset0:32 offset1:48
    v_add_f32 v250, v250, v12
    v_mfma_f32_16x16x32_bf16 v[68:71], v[208:211], v[236:239], v[68:71]
    ds_read2_b32 v[132:133], v7 offset0:64 offset1:80
    v_add_f32 v251, v251, v13
    v_mfma_f32_16x16x32_bf16 v[72:75], v[204:207], v[240:243], v[72:75]
    ds_read2_b32 v[134:135], v7 offset0:96 offset1:112
    v_mov_b32 v8, v248
    v_mfma_f32_16x16x32_bf16 v[76:79], v[208:211], v[240:243], v[76:79]
    ds_read2_b32 v[136:137], v7 offset0:128 offset1:144
    v_mov_b32 v9, v249
    v_mfma_f32_16x16x32_bf16 v[80:83], v[204:207], v[244:247], v[80:83]
    v_mov_b32 v12, v250
    v_mfma_f32_16x16x32_bf16 v[84:87], v[208:211], v[244:247], v[84:87]
    v_mov_b32 v13, v251
    v_permlane16_swap_b32 v248, v8
    s_waitcnt lgkmcnt(10)
    v_mfma_f32_16x16x32_bf16 v[16:19], v[160:163], v[168:171], v[16:19]
    ds_read_b128 v[204:207], v0 offset:1024
    v_mfma_f32_16x16x32_bf16 v[20:23], v[164:167], v[168:171], v[20:23]
    ds_read_b128 v[208:211], v0 offset:3072
    v_mfma_f32_16x16x32_bf16 v[24:27], v[160:163], v[172:175], v[24:27]
    ds_read_b128 v[212:215], v2 offset:9216
    v_mfma_f32_16x16x32_bf16 v[28:31], v[164:167], v[172:175], v[28:31]
    ds_read_b128 v[216:219], v2 offset:10240
    v_mfma_f32_16x16x32_bf16 v[32:35], v[160:163], v[176:179], v[32:35]
    ds_read_b128 v[220:223], v2 offset:11264
    v_mfma_f32_16x16x32_bf16 v[36:39], v[164:167], v[176:179], v[36:39]
    ds_read_b128 v[224:227], v2 offset:12288
    v_mfma_f32_16x16x32_bf16 v[40:43], v[160:163], v[180:183], v[40:43]
    ds_read_b128 v[228:231], v2 offset:13312
    v_mfma_f32_16x16x32_bf16 v[44:47], v[164:167], v[180:183], v[44:47]
    ds_read_b128 v[232:235], v2 offset:14336
    s_waitcnt lgkmcnt(8)
    v_mfma_f32_16x16x32_bf16 v[48:51], v[160:163], v[184:187], v[48:51]
    ds_read_b128 v[236:239], v2 offset:15360
    v_mfma_f32_16x16x32_bf16 v[52:55], v[164:167], v[184:187], v[52:55]
    ds_read_b128 v[240:243], v2 offset:16384
    v_permlane16_swap_b32 v249, v9
    v_mfma_f32_16x16x32_bf16 v[56:59], v[160:163], v[188:191], v[56:59]
    ds_read_b128 v[244:247], v2 offset:17408
    v_permlane16_swap_b32 v250, v12
    v_mfma_f32_16x16x32_bf16 v[60:63], v[164:167], v[188:191], v[60:63]
    v_permlane16_swap_b32 v251, v13
    v_mfma_f32_16x16x32_bf16 v[64:67], v[160:163], v[192:195], v[64:67]
    v_add_f32 v248, v248, v8
    v_mfma_f32_16x16x32_bf16 v[68:71], v[164:167], v[192:195], v[68:71]
    v_add_f32 v249, v249, v9
    v_mfma_f32_16x16x32_bf16 v[72:75], v[160:163], v[196:199], v[72:75]
    v_add_f32 v250, v250, v12
    v_mfma_f32_16x16x32_bf16 v[76:79], v[164:167], v[196:199], v[76:79]
    v_add_f32 v251, v251, v13
    v_mfma_f32_16x16x32_bf16 v[80:83], v[160:163], v[200:203], v[80:83]
    v_mul_f32 v248, 0x3ae38e39, v248
    v_mfma_f32_16x16x32_bf16 v[84:87], v[164:167], v[200:203], v[84:87]
    v_mul_f32 v249, 0x3ae38e39, v249
    v_mul_f32 v250, 0x3ae38e39, v250
    s_waitcnt lgkmcnt(0)
    s_barrier
    v_mfma_f32_16x16x32_bf16 v[16:19], v[204:207], v[212:215], v[16:19]
    ds_read_b128 v[160:163], v0 offset:36864
    v_mfma_f32_16x16x32_bf16 v[20:23], v[208:211], v[212:215], v[20:23]
    ds_read_b128 v[164:167], v0 offset:38912
    v_mfma_f32_16x16x32_bf16 v[24:27], v[204:207], v[216:219], v[24:27]
    ds_read_b128 v[168:171], v2 offset:36864
    v_mfma_f32_16x16x32_bf16 v[28:31], v[208:211], v[216:219], v[28:31]
    ds_read_b128 v[172:175], v2 offset:37888
    v_mfma_f32_16x16x32_bf16 v[32:35], v[204:207], v[220:223], v[32:35]
    ds_read_b128 v[176:179], v2 offset:38912
    v_mfma_f32_16x16x32_bf16 v[36:39], v[208:211], v[220:223], v[36:39]
    ds_read_b128 v[180:183], v2 offset:39936
    v_mfma_f32_16x16x32_bf16 v[40:43], v[204:207], v[224:227], v[40:43]
    ds_read_b128 v[184:187], v2 offset:40960
    v_mfma_f32_16x16x32_bf16 v[44:47], v[208:211], v[224:227], v[44:47]
    ds_read_b128 v[188:191], v2 offset:41984
    v_mfma_f32_16x16x32_bf16 v[48:51], v[204:207], v[228:231], v[48:51]
    ds_read_b128 v[192:195], v2 offset:43008
    v_mfma_f32_16x16x32_bf16 v[52:55], v[208:211], v[228:231], v[52:55]
    ds_read_b128 v[196:199], v2 offset:44032
    v_mul_f32 v251, 0x3ae38e39, v251
    v_mfma_f32_16x16x32_bf16 v[56:59], v[204:207], v[232:235], v[56:59]
    ds_read_b128 v[200:203], v2 offset:45056
    v_fma_f32 v249, -v248, v248, v249
    v_mfma_f32_16x16x32_bf16 v[60:63], v[208:211], v[232:235], v[60:63]
    v_fma_f32 v251, -v250, v250, v251
    v_mfma_f32_16x16x32_bf16 v[64:67], v[204:207], v[236:239], v[64:67]
    v_max_f32 v249, 0, v249
    v_mfma_f32_16x16x32_bf16 v[68:71], v[208:211], v[236:239], v[68:71]
    v_max_f32 v251, 0, v251
    v_mfma_f32_16x16x32_bf16 v[72:75], v[204:207], v[240:243], v[72:75]
    v_add_f32 v249, 0x3727c5ac, v249
    v_mfma_f32_16x16x32_bf16 v[76:79], v[208:211], v[240:243], v[76:79]
    v_add_f32 v251, 0x3727c5ac, v251
    v_mfma_f32_16x16x32_bf16 v[80:83], v[204:207], v[244:247], v[80:83]
    v_rsq_f32 v249, v249
    v_mfma_f32_16x16x32_bf16 v[84:87], v[208:211], v[244:247], v[84:87]
    v_rsq_f32 v251, v251
    s_nop 0
    s_waitcnt lgkmcnt(5)
    v_mfma_f32_16x16x32_bf16 v[16:19], v[160:163], v[168:171], v[16:19]
    ds_read_b128 v[204:207], v0 offset:37888
    v_mfma_f32_16x16x32_bf16 v[20:23], v[164:167], v[168:171], v[20:23]
    ds_read_b128 v[208:211], v0 offset:39936
    v_mfma_f32_16x16x32_bf16 v[24:27], v[160:163], v[172:175], v[24:27]
    ds_read_b128 v[212:215], v2 offset:46080
    v_mfma_f32_16x16x32_bf16 v[28:31], v[164:167], v[172:175], v[28:31]
    ds_read_b128 v[216:219], v2 offset:47104
    v_mfma_f32_16x16x32_bf16 v[32:35], v[160:163], v[176:179], v[32:35]
    ds_read_b128 v[220:223], v2 offset:48128
    v_mfma_f32_16x16x32_bf16 v[36:39], v[164:167], v[176:179], v[36:39]
    ds_read_b128 v[224:227], v2 offset:49152
    v_mfma_f32_16x16x32_bf16 v[40:43], v[160:163], v[180:183], v[40:43]
    ds_read_b128 v[228:231], v2 offset:50176
    v_mfma_f32_16x16x32_bf16 v[44:47], v[164:167], v[180:183], v[44:47]
    ds_read_b128 v[232:235], v2 offset:51200
    s_waitcnt lgkmcnt(8)
    v_mfma_f32_16x16x32_bf16 v[48:51], v[160:163], v[184:187], v[48:51]
    ds_read_b128 v[236:239], v2 offset:52224
    v_mfma_f32_16x16x32_bf16 v[52:55], v[164:167], v[184:187], v[52:55]
    ds_read_b128 v[240:243], v2 offset:53248
    v_mfma_f32_16x16x32_bf16 v[56:59], v[160:163], v[188:191], v[56:59]
    ds_read_b128 v[244:247], v2 offset:54272
    v_mfma_f32_16x16x32_bf16 v[60:63], v[164:167], v[188:191], v[60:63]
    v_mfma_f32_16x16x32_bf16 v[64:67], v[160:163], v[192:195], v[64:67]
    v_mfma_f32_16x16x32_bf16 v[68:71], v[164:167], v[192:195], v[68:71]
    v_mfma_f32_16x16x32_bf16 v[72:75], v[160:163], v[196:199], v[72:75]
    v_mfma_f32_16x16x32_bf16 v[76:79], v[164:167], v[196:199], v[76:79]
    v_mfma_f32_16x16x32_bf16 v[80:83], v[160:163], v[200:203], v[80:83]
    v_mfma_f32_16x16x32_bf16 v[84:87], v[164:167], v[200:203], v[84:87]
    s_waitcnt lgkmcnt(0)
    s_barrier
    v_mfma_f32_16x16x32_bf16 v[16:19], v[204:207], v[212:215], v[16:19]
    ds_read_b128 v[160:163], v3 offset:0
    v_mfma_f32_16x16x32_bf16 v[20:23], v[208:211], v[212:215], v[20:23]
    ds_read_b128 v[164:167], v3 offset:2048
    v_mfma_f32_16x16x32_bf16 v[24:27], v[204:207], v[216:219], v[24:27]
    ds_read_b128 v[168:171], v1 offset:0
    v_mfma_f32_16x16x32_bf16 v[28:31], v[208:211], v[216:219], v[28:31]
    ds_read_b128 v[172:175], v1 offset:1024
    v_mfma_f32_16x16x32_bf16 v[32:35], v[204:207], v[220:223], v[32:35]
    ds_read_b128 v[176:179], v1 offset:2048
    v_mfma_f32_16x16x32_bf16 v[36:39], v[208:211], v[220:223], v[36:39]
    ds_read_b128 v[180:183], v1 offset:3072
    v_mfma_f32_16x16x32_bf16 v[40:43], v[204:207], v[224:227], v[40:43]
    ds_read_b128 v[184:187], v1 offset:4096
    v_mfma_f32_16x16x32_bf16 v[44:47], v[208:211], v[224:227], v[44:47]
    ds_read_b128 v[188:191], v1 offset:5120
    v_mfma_f32_16x16x32_bf16 v[48:51], v[204:207], v[228:231], v[48:51]
    ds_read_b128 v[192:195], v1 offset:6144
    v_mfma_f32_16x16x32_bf16 v[52:55], v[208:211], v[228:231], v[52:55]
    ds_read_b128 v[196:199], v1 offset:7168
    v_mfma_f32_16x16x32_bf16 v[56:59], v[204:207], v[232:235], v[56:59]
    ds_read_b128 v[200:203], v1 offset:8192
    v_mfma_f32_16x16x32_bf16 v[60:63], v[208:211], v[232:235], v[60:63]
    ds_write2_b32 v4, v248, v249 offset0:0 offset1:32
    v_mfma_f32_16x16x32_bf16 v[64:67], v[204:207], v[236:239], v[64:67]
    ds_write2_b32 v4, v250, v251 offset0:16 offset1:48
    v_mfma_f32_16x16x32_bf16 v[68:71], v[208:211], v[236:239], v[68:71]
    ds_read_b128 v[88:91], v252 offset:0
    v_mfma_f32_16x16x32_bf16 v[72:75], v[204:207], v[240:243], v[72:75]
    ds_read_b128 v[92:95], v252 offset:64
    v_mfma_f32_16x16x32_bf16 v[76:79], v[208:211], v[240:243], v[76:79]
    ds_read_b128 v[96:99], v252 offset:128
    v_mfma_f32_16x16x32_bf16 v[80:83], v[204:207], v[244:247], v[80:83]
    ds_read_b128 v[100:103], v252 offset:192
    v_mfma_f32_16x16x32_bf16 v[84:87], v[208:211], v[244:247], v[84:87]
    s_waitcnt lgkmcnt(11)
    v_mfma_f32_16x16x32_bf16 v[16:19], v[160:163], v[168:171], v[16:19]
    ds_read_b128 v[204:207], v3 offset:1024
    v_mfma_f32_16x16x32_bf16 v[20:23], v[164:167], v[168:171], v[20:23]
    ds_read_b128 v[208:211], v3 offset:3072
    v_mfma_f32_16x16x32_bf16 v[24:27], v[160:163], v[172:175], v[24:27]
    ds_read_b128 v[212:215], v1 offset:9216
    v_mfma_f32_16x16x32_bf16 v[28:31], v[164:167], v[172:175], v[28:31]
    ds_read_b128 v[216:219], v1 offset:10240
    v_mfma_f32_16x16x32_bf16 v[32:35], v[160:163], v[176:179], v[32:35]
    ds_read_b128 v[220:223], v1 offset:11264
    v_mfma_f32_16x16x32_bf16 v[36:39], v[164:167], v[176:179], v[36:39]
    ds_read_b128 v[224:227], v1 offset:12288
    v_mfma_f32_16x16x32_bf16 v[40:43], v[160:163], v[180:183], v[40:43]
    ds_read_b128 v[228:231], v1 offset:13312
    v_mfma_f32_16x16x32_bf16 v[44:47], v[164:167], v[180:183], v[44:47]
    ds_read_b128 v[232:235], v1 offset:14336
    s_waitcnt lgkmcnt(8)
    v_mfma_f32_16x16x32_bf16 v[48:51], v[160:163], v[184:187], v[48:51]
    ds_read_b128 v[236:239], v1 offset:15360
    v_mfma_f32_16x16x32_bf16 v[52:55], v[164:167], v[184:187], v[52:55]
    ds_read_b128 v[240:243], v1 offset:16384
    v_rcp_f32 v120, v96
    v_mfma_f32_16x16x32_bf16 v[56:59], v[160:163], v[188:191], v[56:59]
    ds_read_b128 v[244:247], v1 offset:17408
    v_mul_f32 v104, s40, v96
    v_mfma_f32_16x16x32_bf16 v[60:63], v[164:167], v[188:191], v[60:63]
    v_mul_f32 v112, v96, v96
    v_mfma_f32_16x16x32_bf16 v[64:67], v[160:163], v[192:195], v[64:67]
    v_rcp_f32 v121, v97
    v_mfma_f32_16x16x32_bf16 v[68:71], v[164:167], v[192:195], v[68:71]
    v_mul_f32 v105, s40, v97
    v_mfma_f32_16x16x32_bf16 v[72:75], v[160:163], v[196:199], v[72:75]
    v_mul_f32 v113, v97, v97
    v_mfma_f32_16x16x32_bf16 v[76:79], v[164:167], v[196:199], v[76:79]
    v_rcp_f32 v122, v98
    v_mfma_f32_16x16x32_bf16 v[80:83], v[160:163], v[200:203], v[80:83]
    v_mul_f32 v106, s40, v98
    v_mfma_f32_16x16x32_bf16 v[84:87], v[164:167], v[200:203], v[84:87]
    v_mul_f32 v114, v98, v98
    v_rcp_f32 v123, v99
    s_waitcnt lgkmcnt(0)
    s_barrier
    v_mfma_f32_16x16x32_bf16 v[16:19], v[204:207], v[212:215], v[16:19]
    ds_read_b128 v[160:163], v3 offset:36864
    v_mfma_f32_16x16x32_bf16 v[20:23], v[208:211], v[212:215], v[20:23]
    ds_read_b128 v[164:167], v3 offset:38912
    v_mfma_f32_16x16x32_bf16 v[24:27], v[204:207], v[216:219], v[24:27]
    ds_read_b128 v[168:171], v1 offset:36864
    v_mfma_f32_16x16x32_bf16 v[28:31], v[208:211], v[216:219], v[28:31]
    ds_read_b128 v[172:175], v1 offset:37888
    v_mfma_f32_16x16x32_bf16 v[32:35], v[204:207], v[220:223], v[32:35]
    ds_read_b128 v[176:179], v1 offset:38912
    v_mfma_f32_16x16x32_bf16 v[36:39], v[208:211], v[220:223], v[36:39]
    ds_read_b128 v[180:183], v1 offset:39936
    v_mfma_f32_16x16x32_bf16 v[40:43], v[204:207], v[224:227], v[40:43]
    ds_read_b128 v[184:187], v1 offset:40960
    v_mfma_f32_16x16x32_bf16 v[44:47], v[208:211], v[224:227], v[44:47]
    ds_read_b128 v[188:191], v1 offset:41984
    v_mfma_f32_16x16x32_bf16 v[48:51], v[204:207], v[228:231], v[48:51]
    ds_read_b128 v[192:195], v1 offset:43008
    v_mfma_f32_16x16x32_bf16 v[52:55], v[208:211], v[228:231], v[52:55]
    ds_read_b128 v[196:199], v1 offset:44032
    v_mul_f32 v107, s40, v99
    v_mfma_f32_16x16x32_bf16 v[56:59], v[204:207], v[232:235], v[56:59]
    ds_read_b128 v[200:203], v1 offset:45056
    v_mul_f32 v115, v99, v99
    v_mfma_f32_16x16x32_bf16 v[60:63], v[208:211], v[232:235], v[60:63]
    v_rcp_f32 v124, v100
    v_mfma_f32_16x16x32_bf16 v[64:67], v[204:207], v[236:239], v[64:67]
    v_mul_f32 v108, s40, v100
    v_mfma_f32_16x16x32_bf16 v[68:71], v[208:211], v[236:239], v[68:71]
    v_mul_f32 v116, v100, v100
    v_mfma_f32_16x16x32_bf16 v[72:75], v[204:207], v[240:243], v[72:75]
    v_rcp_f32 v125, v101
    v_mfma_f32_16x16x32_bf16 v[76:79], v[208:211], v[240:243], v[76:79]
    v_mul_f32 v109, s40, v101
    v_mfma_f32_16x16x32_bf16 v[80:83], v[204:207], v[244:247], v[80:83]
    v_mul_f32 v117, v101, v101
    v_mfma_f32_16x16x32_bf16 v[84:87], v[208:211], v[244:247], v[84:87]
    v_rcp_f32 v126, v102
    v_mul_f32 v110, s40, v102
    s_waitcnt lgkmcnt(5)
    v_mfma_f32_16x16x32_bf16 v[16:19], v[160:163], v[168:171], v[16:19]
    ds_read_b128 v[204:207], v3 offset:37888
    v_mfma_f32_16x16x32_bf16 v[20:23], v[164:167], v[168:171], v[20:23]
    ds_read_b128 v[208:211], v3 offset:39936
    v_mfma_f32_16x16x32_bf16 v[24:27], v[160:163], v[172:175], v[24:27]
    ds_read_b128 v[212:215], v1 offset:46080
    v_mfma_f32_16x16x32_bf16 v[28:31], v[164:167], v[172:175], v[28:31]
    ds_read_b128 v[216:219], v1 offset:47104
    v_mfma_f32_16x16x32_bf16 v[32:35], v[160:163], v[176:179], v[32:35]
    ds_read_b128 v[220:223], v1 offset:48128
    v_mfma_f32_16x16x32_bf16 v[36:39], v[164:167], v[176:179], v[36:39]
    ds_read_b128 v[224:227], v1 offset:49152
    v_mfma_f32_16x16x32_bf16 v[40:43], v[160:163], v[180:183], v[40:43]
    ds_read_b128 v[228:231], v1 offset:50176
    v_mfma_f32_16x16x32_bf16 v[44:47], v[164:167], v[180:183], v[44:47]
    ds_read_b128 v[232:235], v1 offset:51200
    s_waitcnt lgkmcnt(8)
    v_mfma_f32_16x16x32_bf16 v[48:51], v[160:163], v[184:187], v[48:51]
    ds_read_b128 v[236:239], v1 offset:52224
    v_mfma_f32_16x16x32_bf16 v[52:55], v[164:167], v[184:187], v[52:55]
    ds_read_b128 v[240:243], v1 offset:53248
    v_mul_f32 v118, v102, v102
    v_mfma_f32_16x16x32_bf16 v[56:59], v[160:163], v[188:191], v[56:59]
    ds_read_b128 v[244:247], v1 offset:54272
    v_rcp_f32 v127, v103
    v_mfma_f32_16x16x32_bf16 v[60:63], v[164:167], v[188:191], v[60:63]
    v_mul_f32 v111, s40, v103
    v_mfma_f32_16x16x32_bf16 v[64:67], v[160:163], v[192:195], v[64:67]
    v_mul_f32 v119, v103, v103
    v_mfma_f32_16x16x32_bf16 v[68:71], v[164:167], v[192:195], v[68:71]
    v_mul_f32 v112, s42, v112
    v_mfma_f32_16x16x32_bf16 v[72:75], v[160:163], v[196:199], v[72:75]
    v_mul_f32 v113, s42, v113
    v_mfma_f32_16x16x32_bf16 v[76:79], v[164:167], v[196:199], v[76:79]
    v_mul_f32 v114, s42, v114
    v_mfma_f32_16x16x32_bf16 v[80:83], v[160:163], v[200:203], v[80:83]
    v_mul_f32 v115, s42, v115
    v_mfma_f32_16x16x32_bf16 v[84:87], v[164:167], v[200:203], v[84:87]
    v_mul_f32 v116, s42, v116
    v_mul_f32 v117, s42, v117
    s_waitcnt lgkmcnt(0)
    s_barrier
    v_mfma_f32_16x16x32_bf16 v[16:19], v[204:207], v[212:215], v[16:19]
    ds_read_b128 v[160:163], v0 offset:0
    v_mfma_f32_16x16x32_bf16 v[20:23], v[208:211], v[212:215], v[20:23]
    ds_read_b128 v[164:167], v0 offset:2048
    v_mfma_f32_16x16x32_bf16 v[24:27], v[204:207], v[216:219], v[24:27]
    ds_read_b128 v[168:171], v2 offset:0
    v_mfma_f32_16x16x32_bf16 v[28:31], v[208:211], v[216:219], v[28:31]
    ds_read_b128 v[172:175], v2 offset:1024
    v_mfma_f32_16x16x32_bf16 v[32:35], v[204:207], v[220:223], v[32:35]
    ds_read_b128 v[176:179], v2 offset:2048
    v_mfma_f32_16x16x32_bf16 v[36:39], v[208:211], v[220:223], v[36:39]
    ds_read_b128 v[180:183], v2 offset:3072
    v_mfma_f32_16x16x32_bf16 v[40:43], v[204:207], v[224:227], v[40:43]
    ds_read_b128 v[184:187], v2 offset:4096
    v_mfma_f32_16x16x32_bf16 v[44:47], v[208:211], v[224:227], v[44:47]
    ds_read_b128 v[188:191], v2 offset:5120
    v_mfma_f32_16x16x32_bf16 v[48:51], v[204:207], v[228:231], v[48:51]
    ds_read_b128 v[192:195], v2 offset:6144
    v_mfma_f32_16x16x32_bf16 v[52:55], v[208:211], v[228:231], v[52:55]
    ds_read_b128 v[196:199], v2 offset:7168
    v_mul_f32 v118, s42, v118
    v_mfma_f32_16x16x32_bf16 v[56:59], v[204:207], v[232:235], v[56:59]
    ds_read_b128 v[200:203], v2 offset:8192
    v_mul_f32 v119, s42, v119
    v_mfma_f32_16x16x32_bf16 v[60:63], v[208:211], v[232:235], v[60:63]
    v_mul_f32 v112, v112, v104
    v_mfma_f32_16x16x32_bf16 v[64:67], v[204:207], v[236:239], v[64:67]
    v_mul_f32 v113, v113, v105
    v_mfma_f32_16x16x32_bf16 v[68:71], v[208:211], v[236:239], v[68:71]
    v_mul_f32 v114, v114, v106
    v_mfma_f32_16x16x32_bf16 v[72:75], v[204:207], v[240:243], v[72:75]
    v_mul_f32 v115, v115, v107
    v_mfma_f32_16x16x32_bf16 v[76:79], v[208:211], v[240:243], v[76:79]
    v_mul_f32 v116, v116, v108
    v_mfma_f32_16x16x32_bf16 v[80:83], v[204:207], v[244:247], v[80:83]
    v_mul_f32 v117, v117, v109
    v_mfma_f32_16x16x32_bf16 v[84:87], v[208:211], v[244:247], v[84:87]
    v_mul_f32 v118, v118, v110
    v_mul_f32 v119, v119, v111
    s_waitcnt lgkmcnt(5)
    v_mfma_f32_16x16x32_bf16 v[16:19], v[160:163], v[168:171], v[16:19]
    ds_read_b128 v[204:207], v0 offset:1024
    v_mfma_f32_16x16x32_bf16 v[20:23], v[164:167], v[168:171], v[20:23]
    ds_read_b128 v[208:211], v0 offset:3072
    v_mfma_f32_16x16x32_bf16 v[24:27], v[160:163], v[172:175], v[24:27]
    ds_read_b128 v[212:215], v2 offset:9216
    v_mfma_f32_16x16x32_bf16 v[28:31], v[164:167], v[172:175], v[28:31]
    ds_read_b128 v[216:219], v2 offset:10240
    v_mfma_f32_16x16x32_bf16 v[32:35], v[160:163], v[176:179], v[32:35]
    ds_read_b128 v[220:223], v2 offset:11264
    v_mfma_f32_16x16x32_bf16 v[36:39], v[164:167], v[176:179], v[36:39]
    ds_read_b128 v[224:227], v2 offset:12288
    v_mfma_f32_16x16x32_bf16 v[40:43], v[160:163], v[180:183], v[40:43]
    ds_read_b128 v[228:231], v2 offset:13312
    v_mfma_f32_16x16x32_bf16 v[44:47], v[164:167], v[180:183], v[44:47]
    ds_read_b128 v[232:235], v2 offset:14336
    s_waitcnt lgkmcnt(8)
    v_mfma_f32_16x16x32_bf16 v[48:51], v[160:163], v[184:187], v[48:51]
    ds_read_b128 v[236:239], v2 offset:15360
    v_mfma_f32_16x16x32_bf16 v[52:55], v[164:167], v[184:187], v[52:55]
    ds_read_b128 v[240:243], v2 offset:16384
    v_lshrrev_b32 v8, 2, v6
    v_mfma_f32_16x16x32_bf16 v[56:59], v[160:163], v[188:191], v[56:59]
    ds_read_b128 v[244:247], v2 offset:17408
    v_lshlrev_b32 v8, 4, v8
    v_mfma_f32_16x16x32_bf16 v[60:63], v[164:167], v[188:191], v[60:63]
    v_lshl_add_u32 v8, v5, 6, v8
    v_mfma_f32_16x16x32_bf16 v[64:67], v[160:163], v[192:195], v[64:67]
    v_and_b32 v9, 3, v6
    v_mfma_f32_16x16x32_bf16 v[68:71], v[164:167], v[192:195], v[68:71]
    v_cmp_eq_u32 vcc, 0, v9
    v_mfma_f32_16x16x32_bf16 v[72:75], v[160:163], v[196:199], v[72:75]
    v_bfrev_b32 v10, 1
    v_mfma_f32_16x16x32_bf16 v[76:79], v[164:167], v[196:199], v[76:79]
    v_lshlrev_b32 v9, 4, v9
    v_mfma_f32_16x16x32_bf16 v[80:83], v[160:163], v[200:203], v[80:83]
    v_cndmask_b32 v8, v10, v8, vcc
    v_mfma_f32_16x16x32_bf16 v[84:87], v[164:167], v[200:203], v[84:87]
    v_lshl_add_u32 v9, v5, 6, v9
    v_lshrrev_b32 v255, 2, v6
    s_waitcnt lgkmcnt(0)
    s_barrier
    v_mfma_f32_16x16x32_bf16 v[16:19], v[204:207], v[212:215], v[16:19]
    ds_read_b128 v[160:163], v0 offset:36864
    v_fma_f32 v52, -v92, v132, v52
    v_mfma_f32_16x16x32_bf16 v[20:23], v[208:211], v[212:215], v[20:23]
    ds_read_b128 v[164:167], v0 offset:38912
    v_fma_f32 v56, -v88, v133, v56
    v_mfma_f32_16x16x32_bf16 v[24:27], v[204:207], v[216:219], v[24:27]
    ds_read_b128 v[168:171], v2 offset:36864
    v_fma_f32 v60, -v92, v133, v60
    v_mfma_f32_16x16x32_bf16 v[28:31], v[208:211], v[216:219], v[28:31]
    ds_read_b128 v[172:175], v2 offset:37888
    v_fma_f32 v64, -v88, v134, v64
    v_mfma_f32_16x16x32_bf16 v[32:35], v[204:207], v[220:223], v[32:35]
    ds_read_b128 v[176:179], v2 offset:38912
    v_fma_f32 v68, -v92, v134, v68
    v_mfma_f32_16x16x32_bf16 v[36:39], v[208:211], v[220:223], v[36:39]
    ds_read_b128 v[180:183], v2 offset:39936
    v_fma_f32 v72, -v88, v135, v72
    v_mfma_f32_16x16x32_bf16 v[40:43], v[204:207], v[224:227], v[40:43]
    ds_read_b128 v[184:187], v2 offset:40960
    v_fma_f32 v76, -v92, v135, v76
    v_mfma_f32_16x16x32_bf16 v[44:47], v[208:211], v[224:227], v[44:47]
    ds_read_b128 v[188:191], v2 offset:41984
    v_fma_f32 v80, -v88, v136, v80
    v_mfma_f32_16x16x32_bf16 v[48:51], v[204:207], v[228:231], v[48:51]
    ds_read_b128 v[192:195], v2 offset:43008
    v_fma_f32 v84, -v92, v136, v84
    v_mfma_f32_16x16x32_bf16 v[52:55], v[208:211], v[228:231], v[52:55]
    ds_read_b128 v[196:199], v2 offset:44032
    v_lshl_add_u32 v255, v255, 8, v9
    v_fma_f32 v16, -v88, v128, v16
    v_mfma_f32_16x16x32_bf16 v[56:59], v[204:207], v[232:235], v[56:59]
    ds_read_b128 v[200:203], v2 offset:45056
    v_fma_f32 v20, -v92, v128, v20
    v_mfma_f32_16x16x32_bf16 v[60:63], v[208:211], v[232:235], v[60:63]
    v_fma_f32 v24, -v88, v129, v24
    v_mfma_f32_16x16x32_bf16 v[64:67], v[204:207], v[236:239], v[64:67]
    v_fma_f32 v28, -v92, v129, v28
    v_mfma_f32_16x16x32_bf16 v[68:71], v[208:211], v[236:239], v[68:71]
    v_fma_f32 v32, -v88, v130, v32
    v_mfma_f32_16x16x32_bf16 v[72:75], v[204:207], v[240:243], v[72:75]
    v_fma_f32 v36, -v92, v130, v36
    v_mfma_f32_16x16x32_bf16 v[76:79], v[208:211], v[240:243], v[76:79]
    v_fma_f32 v40, -v88, v131, v40
    v_mfma_f32_16x16x32_bf16 v[80:83], v[204:207], v[244:247], v[80:83]
    v_fma_f32 v44, -v92, v131, v44
    v_mfma_f32_16x16x32_bf16 v[84:87], v[208:211], v[244:247], v[84:87]
    v_fma_f32 v48, -v88, v132, v48
    s_waitcnt lgkmcnt(5)
    v_mfma_f32_16x16x32_bf16 v[16:19], v[160:163], v[168:171], v[16:19]
    ds_read_b128 v[204:207], v0 offset:37888
    v_fma_f32 v53, -v93, v132, v53
    v_mfma_f32_16x16x32_bf16 v[20:23], v[164:167], v[168:171], v[20:23]
    ds_read_b128 v[208:211], v0 offset:39936
    v_fma_f32 v57, -v89, v133, v57
    v_mfma_f32_16x16x32_bf16 v[24:27], v[160:163], v[172:175], v[24:27]
    ds_read_b128 v[212:215], v2 offset:46080
    v_fma_f32 v61, -v93, v133, v61
    v_mfma_f32_16x16x32_bf16 v[28:31], v[164:167], v[172:175], v[28:31]
    ds_read_b128 v[216:219], v2 offset:47104
    v_fma_f32 v65, -v89, v134, v65
    v_mfma_f32_16x16x32_bf16 v[32:35], v[160:163], v[176:179], v[32:35]
    ds_read_b128 v[220:223], v2 offset:48128
    v_fma_f32 v69, -v93, v134, v69
    v_mfma_f32_16x16x32_bf16 v[36:39], v[164:167], v[176:179], v[36:39]
    ds_read_b128 v[224:227], v2 offset:49152
    v_fma_f32 v73, -v89, v135, v73
    v_mfma_f32_16x16x32_bf16 v[40:43], v[160:163], v[180:183], v[40:43]
    ds_read_b128 v[228:231], v2 offset:50176
    v_fma_f32 v77, -v93, v135, v77
    v_mfma_f32_16x16x32_bf16 v[44:47], v[164:167], v[180:183], v[44:47]
    ds_read_b128 v[232:235], v2 offset:51200
    s_waitcnt lgkmcnt(8)
    v_fma_f32 v81, -v89, v136, v81
    v_mfma_f32_16x16x32_bf16 v[48:51], v[160:163], v[184:187], v[48:51]
    ds_read_b128 v[236:239], v2 offset:52224
    v_fma_f32 v85, -v93, v136, v85
    v_mfma_f32_16x16x32_bf16 v[52:55], v[164:167], v[184:187], v[52:55]
    ds_read_b128 v[240:243], v2 offset:53248
    v_fma_f32 v17, -v89, v128, v17
    v_mfma_f32_16x16x32_bf16 v[56:59], v[160:163], v[188:191], v[56:59]
    ds_read_b128 v[244:247], v2 offset:54272
    v_fma_f32 v21, -v93, v128, v21
    v_mfma_f32_16x16x32_bf16 v[60:63], v[164:167], v[188:191], v[60:63]
    v_fma_f32 v25, -v89, v129, v25
    v_mfma_f32_16x16x32_bf16 v[64:67], v[160:163], v[192:195], v[64:67]
    v_fma_f32 v29, -v93, v129, v29
    v_mfma_f32_16x16x32_bf16 v[68:71], v[164:167], v[192:195], v[68:71]
    v_fma_f32 v33, -v89, v130, v33
    v_mfma_f32_16x16x32_bf16 v[72:75], v[160:163], v[196:199], v[72:75]
    v_fma_f32 v37, -v93, v130, v37
    v_mfma_f32_16x16x32_bf16 v[76:79], v[164:167], v[196:199], v[76:79]
    v_fma_f32 v41, -v89, v131, v41
    v_mfma_f32_16x16x32_bf16 v[80:83], v[160:163], v[200:203], v[80:83]
    v_fma_f32 v45, -v93, v131, v45
    v_mfma_f32_16x16x32_bf16 v[84:87], v[164:167], v[200:203], v[84:87]
    v_fma_f32 v49, -v89, v132, v49
    s_waitcnt lgkmcnt(0)
    s_barrier
    v_mfma_f32_16x16x32_bf16 v[16:19], v[204:207], v[212:215], v[16:19]
    ds_read_b128 v[160:163], v3 offset:0
    v_fma_f32 v54, -v94, v132, v54
    v_mfma_f32_16x16x32_bf16 v[20:23], v[208:211], v[212:215], v[20:23]
    ds_read_b128 v[164:167], v3 offset:2048
    v_fma_f32 v58, -v90, v133, v58
    v_mfma_f32_16x16x32_bf16 v[24:27], v[204:207], v[216:219], v[24:27]
    ds_read_b128 v[168:171], v1 offset:0
    v_fma_f32 v62, -v94, v133, v62
    v_mfma_f32_16x16x32_bf16 v[28:31], v[208:211], v[216:219], v[28:31]
    ds_read_b128 v[172:175], v1 offset:1024
    v_fma_f32 v66, -v90, v134, v66
    v_mfma_f32_16x16x32_bf16 v[32:35], v[204:207], v[220:223], v[32:35]
    ds_read_b128 v[176:179], v1 offset:2048
    v_fma_f32 v70, -v94, v134, v70
    v_mfma_f32_16x16x32_bf16 v[36:39], v[208:211], v[220:223], v[36:39]
    ds_read_b128 v[180:183], v1 offset:3072
    v_fma_f32 v74, -v90, v135, v74
    v_mfma_f32_16x16x32_bf16 v[40:43], v[204:207], v[224:227], v[40:43]
    ds_read_b128 v[184:187], v1 offset:4096
    v_fma_f32 v78, -v94, v135, v78
    v_mfma_f32_16x16x32_bf16 v[44:47], v[208:211], v[224:227], v[44:47]
    ds_read_b128 v[188:191], v1 offset:5120
    v_fma_f32 v82, -v90, v136, v82
    v_mfma_f32_16x16x32_bf16 v[48:51], v[204:207], v[228:231], v[48:51]
    ds_read_b128 v[192:195], v1 offset:6144
    v_fma_f32 v86, -v94, v136, v86
    v_mfma_f32_16x16x32_bf16 v[52:55], v[208:211], v[228:231], v[52:55]
    ds_read_b128 v[196:199], v1 offset:7168
    v_fma_f32 v18, -v90, v128, v18
    v_mfma_f32_16x16x32_bf16 v[56:59], v[204:207], v[232:235], v[56:59]
    ds_read_b128 v[200:203], v1 offset:8192
    v_fma_f32 v22, -v94, v128, v22
    v_mfma_f32_16x16x32_bf16 v[60:63], v[208:211], v[232:235], v[60:63]
    v_fma_f32 v26, -v90, v129, v26
    v_mfma_f32_16x16x32_bf16 v[64:67], v[204:207], v[236:239], v[64:67]
    v_fma_f32 v30, -v94, v129, v30
    v_mfma_f32_16x16x32_bf16 v[68:71], v[208:211], v[236:239], v[68:71]
    v_fma_f32 v34, -v90, v130, v34
    v_mfma_f32_16x16x32_bf16 v[72:75], v[204:207], v[240:243], v[72:75]
    v_fma_f32 v38, -v94, v130, v38
    v_mfma_f32_16x16x32_bf16 v[76:79], v[208:211], v[240:243], v[76:79]
    v_fma_f32 v42, -v90, v131, v42
    v_mfma_f32_16x16x32_bf16 v[80:83], v[204:207], v[244:247], v[80:83]
    v_fma_f32 v46, -v94, v131, v46
    v_mfma_f32_16x16x32_bf16 v[84:87], v[208:211], v[244:247], v[84:87]
    v_fma_f32 v50, -v90, v132, v50
    s_waitcnt lgkmcnt(5)
    v_mfma_f32_16x16x32_bf16 v[16:19], v[160:163], v[168:171], v[16:19]
    ds_read_b128 v[204:207], v3 offset:1024
    v_fma_f32 v55, -v95, v132, v55
    v_mfma_f32_16x16x32_bf16 v[20:23], v[164:167], v[168:171], v[20:23]
    ds_read_b128 v[208:211], v3 offset:3072
    v_fma_f32 v59, -v91, v133, v59
    v_mfma_f32_16x16x32_bf16 v[24:27], v[160:163], v[172:175], v[24:27]
    ds_read_b128 v[212:215], v1 offset:9216
    v_fma_f32 v63, -v95, v133, v63
    v_mfma_f32_16x16x32_bf16 v[28:31], v[164:167], v[172:175], v[28:31]
    ds_read_b128 v[216:219], v1 offset:10240
    v_fma_f32 v67, -v91, v134, v67
    v_mfma_f32_16x16x32_bf16 v[32:35], v[160:163], v[176:179], v[32:35]
    ds_read_b128 v[220:223], v1 offset:11264
    v_fma_f32 v71, -v95, v134, v71
    v_mfma_f32_16x16x32_bf16 v[36:39], v[164:167], v[176:179], v[36:39]
    ds_read_b128 v[224:227], v1 offset:12288
    v_fma_f32 v75, -v91, v135, v75
    v_mfma_f32_16x16x32_bf16 v[40:43], v[160:163], v[180:183], v[40:43]
    ds_read_b128 v[228:231], v1 offset:13312
    v_fma_f32 v79, -v95, v135, v79
    v_mfma_f32_16x16x32_bf16 v[44:47], v[164:167], v[180:183], v[44:47]
    ds_read_b128 v[232:235], v1 offset:14336
    s_waitcnt lgkmcnt(8)
    v_fma_f32 v83, -v91, v136, v83
    v_mfma_f32_16x16x32_bf16 v[48:51], v[160:163], v[184:187], v[48:51]
    ds_read_b128 v[236:239], v1 offset:15360
    v_fma_f32 v87, -v95, v136, v87
    v_mfma_f32_16x16x32_bf16 v[52:55], v[164:167], v[184:187], v[52:55]
    ds_read_b128 v[240:243], v1 offset:16384
    v_fma_f32 v19, -v91, v128, v19
    v_mfma_f32_16x16x32_bf16 v[56:59], v[160:163], v[188:191], v[56:59]
    ds_read_b128 v[244:247], v1 offset:17408
    v_fma_f32 v23, -v95, v128, v23
    v_mfma_f32_16x16x32_bf16 v[60:63], v[164:167], v[188:191], v[60:63]
    v_fma_f32 v27, -v91, v129, v27
    v_mfma_f32_16x16x32_bf16 v[64:67], v[160:163], v[192:195], v[64:67]
    v_fma_f32 v31, -v95, v129, v31
    v_mfma_f32_16x16x32_bf16 v[68:71], v[164:167], v[192:195], v[68:71]
    v_fma_f32 v35, -v91, v130, v35
    v_mfma_f32_16x16x32_bf16 v[72:75], v[160:163], v[196:199], v[72:75]
    v_fma_f32 v39, -v95, v130, v39
    v_mfma_f32_16x16x32_bf16 v[76:79], v[164:167], v[196:199], v[76:79]
    v_fma_f32 v43, -v91, v131, v43
    v_mfma_f32_16x16x32_bf16 v[80:83], v[160:163], v[200:203], v[80:83]
    v_fma_f32 v47, -v95, v131, v47
    v_mfma_f32_16x16x32_bf16 v[84:87], v[164:167], v[200:203], v[84:87]
    v_fma_f32 v51, -v91, v132, v51
    s_waitcnt lgkmcnt(0)
    s_barrier
    v_mfma_f32_16x16x32_bf16 v[16:19], v[204:207], v[212:215], v[16:19]
    ds_read_b128 v[160:163], v3 offset:36864
    v_mfma_f32_16x16x32_bf16 v[20:23], v[208:211], v[212:215], v[20:23]
    ds_read_b128 v[164:167], v3 offset:38912
    v_mfma_f32_16x16x32_bf16 v[24:27], v[204:207], v[216:219], v[24:27]
    ds_read_b128 v[168:171], v1 offset:36864
    v_mfma_f32_16x16x32_bf16 v[28:31], v[208:211], v[216:219], v[28:31]
    ds_read_b128 v[172:175], v1 offset:37888
    v_mfma_f32_16x16x32_bf16 v[32:35], v[204:207], v[220:223], v[32:35]
    ds_read_b128 v[176:179], v1 offset:38912
    v_mfma_f32_16x16x32_bf16 v[36:39], v[208:211], v[220:223], v[36:39]
    ds_read_b128 v[180:183], v1 offset:39936
    v_mfma_f32_16x16x32_bf16 v[40:43], v[204:207], v[224:227], v[40:43]
    ds_read_b128 v[184:187], v1 offset:40960
    v_mfma_f32_16x16x32_bf16 v[44:47], v[208:211], v[224:227], v[44:47]
    ds_read_b128 v[188:191], v1 offset:41984
    v_mfma_f32_16x16x32_bf16 v[48:51], v[204:207], v[228:231], v[48:51]
    ds_read_b128 v[192:195], v1 offset:43008
    v_mfma_f32_16x16x32_bf16 v[52:55], v[208:211], v[228:231], v[52:55]
    ds_read_b128 v[196:199], v1 offset:44032
    v_mfma_f32_16x16x32_bf16 v[56:59], v[204:207], v[232:235], v[56:59]
    ds_read_b128 v[200:203], v1 offset:45056
    v_mfma_f32_16x16x32_bf16 v[60:63], v[208:211], v[232:235], v[60:63]
    v_mfma_f32_16x16x32_bf16 v[64:67], v[204:207], v[236:239], v[64:67]
    v_mfma_f32_16x16x32_bf16 v[68:71], v[208:211], v[236:239], v[68:71]
    v_mfma_f32_16x16x32_bf16 v[72:75], v[204:207], v[240:243], v[72:75]
    v_mfma_f32_16x16x32_bf16 v[76:79], v[208:211], v[240:243], v[76:79]
    v_mfma_f32_16x16x32_bf16 v[80:83], v[204:207], v[244:247], v[80:83]
    v_mfma_f32_16x16x32_bf16 v[84:87], v[208:211], v[244:247], v[84:87]
    v_pk_mul_f32 v[220:221], v[16:17], v[16:17]
    v_pk_mul_f32 v[222:223], v[18:19], v[18:19]
    v_pk_mul_f32 v[224:225], v[20:21], v[20:21]
    v_pk_mul_f32 v[226:227], v[22:23], v[22:23]
    v_pk_fma_f32 v[220:221], v[220:221], v[112:113], v[104:105]
    v_pk_fma_f32 v[222:223], v[222:223], v[114:115], v[106:107]
    v_pk_fma_f32 v[224:225], v[224:225], v[116:117], v[108:109]
    v_pk_fma_f32 v[226:227], v[226:227], v[118:119], v[110:111]
    v_pk_mul_f32 v[220:221], v[220:221], v[16:17]
    v_pk_mul_f32 v[222:223], v[222:223], v[18:19]
    v_pk_mul_f32 v[224:225], v[224:225], v[20:21]
    v_pk_mul_f32 v[226:227], v[226:227], v[22:23]
    v_exp_f32 v220, v220
    v_exp_f32 v221, v221
    v_exp_f32 v222, v222
    v_exp_f32 v223, v223
    v_exp_f32 v224, v224
    v_exp_f32 v225, v225
    v_exp_f32 v226, v226
    v_exp_f32 v227, v227
    v_pk_fma_f32 v[220:221], v[220:221], v[120:121], v[120:121]
    v_pk_fma_f32 v[222:223], v[222:223], v[122:123], v[122:123]
    v_pk_fma_f32 v[224:225], v[224:225], v[124:125], v[124:125]
    v_pk_fma_f32 v[226:227], v[226:227], v[126:127], v[126:127]
    v_rcp_f32 v220, v220
    v_rcp_f32 v221, v221
    v_rcp_f32 v222, v222
    v_rcp_f32 v223, v223
    v_rcp_f32 v224, v224
    v_rcp_f32 v225, v225
    v_rcp_f32 v226, v226
    v_rcp_f32 v227, v227
    v_pk_mul_f32 v[16:17], v[16:17], v[220:221]
    v_pk_mul_f32 v[18:19], v[18:19], v[222:223]
    v_pk_mul_f32 v[20:21], v[20:21], v[224:225]
    v_pk_mul_f32 v[22:23], v[22:23], v[226:227]
    v_pk_mul_f32 v[206:207], v[16:17], v[16:17]
    v_pk_mul_f32 v[210:211], v[18:19], v[18:19]
    v_pk_mul_f32 v[214:215], v[20:21], v[20:21]
    v_pk_mul_f32 v[218:219], v[22:23], v[22:23]
    v_pk_mul_f32 v[228:229], v[24:25], v[24:25]
    v_pk_mul_f32 v[230:231], v[26:27], v[26:27]
    v_pk_mul_f32 v[232:233], v[28:29], v[28:29]
    v_pk_mul_f32 v[234:235], v[30:31], v[30:31]
    v_pk_fma_f32 v[228:229], v[228:229], v[112:113], v[104:105]
    v_pk_fma_f32 v[230:231], v[230:231], v[114:115], v[106:107]
    v_pk_fma_f32 v[232:233], v[232:233], v[116:117], v[108:109]
    v_pk_fma_f32 v[234:235], v[234:235], v[118:119], v[110:111]
    v_pk_mul_f32 v[228:229], v[228:229], v[24:25]
    v_pk_mul_f32 v[230:231], v[230:231], v[26:27]
    v_pk_mul_f32 v[232:233], v[232:233], v[28:29]
    v_pk_mul_f32 v[234:235], v[234:235], v[30:31]
    v_exp_f32 v228, v228
    v_exp_f32 v229, v229
    v_exp_f32 v230, v230
    v_exp_f32 v231, v231
    v_exp_f32 v232, v232
    v_exp_f32 v233, v233
    v_exp_f32 v234, v234
    v_exp_f32 v235, v235
    v_pk_fma_f32 v[228:229], v[228:229], v[120:121], v[120:121]
    v_pk_fma_f32 v[230:231], v[230:231], v[122:123], v[122:123]
    v_pk_fma_f32 v[232:233], v[232:233], v[124:125], v[124:125]
    v_pk_fma_f32 v[234:235], v[234:235], v[126:127], v[126:127]
    v_rcp_f32 v228, v228
    v_rcp_f32 v229, v229
    v_rcp_f32 v230, v230
    v_rcp_f32 v231, v231
    v_rcp_f32 v232, v232
    v_rcp_f32 v233, v233
    v_rcp_f32 v234, v234
    v_rcp_f32 v235, v235
    v_pk_mul_f32 v[24:25], v[24:25], v[228:229]
    v_pk_mul_f32 v[26:27], v[26:27], v[230:231]
    v_pk_mul_f32 v[28:29], v[28:29], v[232:233]
    v_pk_mul_f32 v[30:31], v[30:31], v[234:235]
    v_pk_add_f32 v[204:205], v[16:17], v[24:25]
    v_pk_fma_f32 v[206:207], v[24:25], v[24:25], v[206:207]
    v_pk_add_f32 v[208:209], v[18:19], v[26:27]
    v_pk_fma_f32 v[210:211], v[26:27], v[26:27], v[210:211]
    v_pk_add_f32 v[212:213], v[20:21], v[28:29]
    v_pk_fma_f32 v[214:215], v[28:29], v[28:29], v[214:215]
    v_pk_add_f32 v[216:217], v[22:23], v[30:31]
    v_pk_fma_f32 v[218:219], v[30:31], v[30:31], v[218:219]
    v_pk_mul_f32 v[220:221], v[32:33], v[32:33]
    v_pk_mul_f32 v[222:223], v[34:35], v[34:35]
    v_pk_mul_f32 v[224:225], v[36:37], v[36:37]
    v_pk_mul_f32 v[226:227], v[38:39], v[38:39]
    v_pk_fma_f32 v[220:221], v[220:221], v[112:113], v[104:105]
    v_pk_fma_f32 v[222:223], v[222:223], v[114:115], v[106:107]
    v_pk_fma_f32 v[224:225], v[224:225], v[116:117], v[108:109]
    v_pk_fma_f32 v[226:227], v[226:227], v[118:119], v[110:111]
    v_pk_mul_f32 v[220:221], v[220:221], v[32:33]
    v_pk_mul_f32 v[222:223], v[222:223], v[34:35]
    v_pk_mul_f32 v[224:225], v[224:225], v[36:37]
    v_pk_mul_f32 v[226:227], v[226:227], v[38:39]
    v_exp_f32 v220, v220
    v_exp_f32 v221, v221
    v_exp_f32 v222, v222
    v_exp_f32 v223, v223
    v_exp_f32 v224, v224
    v_exp_f32 v225, v225
    v_exp_f32 v226, v226
    v_exp_f32 v227, v227
    v_pk_fma_f32 v[220:221], v[220:221], v[120:121], v[120:121]
    v_pk_fma_f32 v[222:223], v[222:223], v[122:123], v[122:123]
    v_pk_fma_f32 v[224:225], v[224:225], v[124:125], v[124:125]
    v_pk_fma_f32 v[226:227], v[226:227], v[126:127], v[126:127]
    v_rcp_f32 v220, v220
    v_rcp_f32 v221, v221
    v_rcp_f32 v222, v222
    v_rcp_f32 v223, v223
    v_rcp_f32 v224, v224
    v_rcp_f32 v225, v225
    v_rcp_f32 v226, v226
    v_rcp_f32 v227, v227
    v_pk_mul_f32 v[32:33], v[32:33], v[220:221]
    v_pk_mul_f32 v[34:35], v[34:35], v[222:223]
    v_pk_mul_f32 v[36:37], v[36:37], v[224:225]
    v_pk_mul_f32 v[38:39], v[38:39], v[226:227]
    v_pk_add_f32 v[204:205], v[204:205], v[32:33]
    v_pk_fma_f32 v[206:207], v[32:33], v[32:33], v[206:207]
    v_pk_add_f32 v[208:209], v[208:209], v[34:35]
    v_pk_fma_f32 v[210:211], v[34:35], v[34:35], v[210:211]
    v_pk_add_f32 v[212:213], v[212:213], v[36:37]
    v_pk_fma_f32 v[214:215], v[36:37], v[36:37], v[214:215]
    v_pk_add_f32 v[216:217], v[216:217], v[38:39]
    v_pk_fma_f32 v[218:219], v[38:39], v[38:39], v[218:219]
    v_pk_mul_f32 v[228:229], v[40:41], v[40:41]
    v_pk_mul_f32 v[230:231], v[42:43], v[42:43]
    v_pk_mul_f32 v[232:233], v[44:45], v[44:45]
    v_pk_mul_f32 v[234:235], v[46:47], v[46:47]
    v_pk_fma_f32 v[228:229], v[228:229], v[112:113], v[104:105]
    v_pk_fma_f32 v[230:231], v[230:231], v[114:115], v[106:107]
    v_pk_fma_f32 v[232:233], v[232:233], v[116:117], v[108:109]
    v_pk_fma_f32 v[234:235], v[234:235], v[118:119], v[110:111]
    v_pk_mul_f32 v[228:229], v[228:229], v[40:41]
    v_pk_mul_f32 v[230:231], v[230:231], v[42:43]
    v_pk_mul_f32 v[232:233], v[232:233], v[44:45]
    v_pk_mul_f32 v[234:235], v[234:235], v[46:47]
    v_exp_f32 v228, v228
    v_exp_f32 v229, v229
    v_exp_f32 v230, v230
    v_exp_f32 v231, v231
    v_exp_f32 v232, v232
    v_exp_f32 v233, v233
    v_exp_f32 v234, v234
    v_exp_f32 v235, v235
    v_pk_fma_f32 v[228:229], v[228:229], v[120:121], v[120:121]
    v_pk_fma_f32 v[230:231], v[230:231], v[122:123], v[122:123]
    v_pk_fma_f32 v[232:233], v[232:233], v[124:125], v[124:125]
    v_pk_fma_f32 v[234:235], v[234:235], v[126:127], v[126:127]
    v_rcp_f32 v228, v228
    v_rcp_f32 v229, v229
    v_rcp_f32 v230, v230
    v_rcp_f32 v231, v231
    v_rcp_f32 v232, v232
    v_rcp_f32 v233, v233
    v_rcp_f32 v234, v234
    v_rcp_f32 v235, v235
    v_pk_mul_f32 v[40:41], v[40:41], v[228:229]
    v_pk_mul_f32 v[42:43], v[42:43], v[230:231]
    v_pk_mul_f32 v[44:45], v[44:45], v[232:233]
    v_pk_mul_f32 v[46:47], v[46:47], v[234:235]
    v_pk_add_f32 v[204:205], v[204:205], v[40:41]
    v_pk_fma_f32 v[206:207], v[40:41], v[40:41], v[206:207]
    v_pk_add_f32 v[208:209], v[208:209], v[42:43]
    v_pk_fma_f32 v[210:211], v[42:43], v[42:43], v[210:211]
    v_pk_add_f32 v[212:213], v[212:213], v[44:45]
    v_pk_fma_f32 v[214:215], v[44:45], v[44:45], v[214:215]
    v_pk_add_f32 v[216:217], v[216:217], v[46:47]
    v_pk_fma_f32 v[218:219], v[46:47], v[46:47], v[218:219]
    v_pk_mul_f32 v[220:221], v[48:49], v[48:49]
    v_pk_mul_f32 v[222:223], v[50:51], v[50:51]
    v_pk_mul_f32 v[224:225], v[52:53], v[52:53]
    v_pk_mul_f32 v[226:227], v[54:55], v[54:55]
    v_pk_fma_f32 v[220:221], v[220:221], v[112:113], v[104:105]
    v_pk_fma_f32 v[222:223], v[222:223], v[114:115], v[106:107]
    v_pk_fma_f32 v[224:225], v[224:225], v[116:117], v[108:109]
    v_pk_fma_f32 v[226:227], v[226:227], v[118:119], v[110:111]
    v_pk_mul_f32 v[220:221], v[220:221], v[48:49]
    v_pk_mul_f32 v[222:223], v[222:223], v[50:51]
    v_pk_mul_f32 v[224:225], v[224:225], v[52:53]
    v_pk_mul_f32 v[226:227], v[226:227], v[54:55]
    v_exp_f32 v220, v220
    v_exp_f32 v221, v221
    v_exp_f32 v222, v222
    v_exp_f32 v223, v223
    v_exp_f32 v224, v224
    v_exp_f32 v225, v225
    v_exp_f32 v226, v226
    v_exp_f32 v227, v227
    v_pk_fma_f32 v[220:221], v[220:221], v[120:121], v[120:121]
    v_pk_fma_f32 v[222:223], v[222:223], v[122:123], v[122:123]
    v_pk_fma_f32 v[224:225], v[224:225], v[124:125], v[124:125]
    v_pk_fma_f32 v[226:227], v[226:227], v[126:127], v[126:127]
    v_rcp_f32 v220, v220
    v_rcp_f32 v221, v221
    v_rcp_f32 v222, v222
    v_rcp_f32 v223, v223
    v_rcp_f32 v224, v224
    v_rcp_f32 v225, v225
    v_rcp_f32 v226, v226
    v_rcp_f32 v227, v227
    v_pk_mul_f32 v[48:49], v[48:49], v[220:221]
    v_pk_mul_f32 v[50:51], v[50:51], v[222:223]
    v_pk_mul_f32 v[52:53], v[52:53], v[224:225]
    v_pk_mul_f32 v[54:55], v[54:55], v[226:227]
    v_pk_add_f32 v[204:205], v[204:205], v[48:49]
    v_pk_fma_f32 v[206:207], v[48:49], v[48:49], v[206:207]
    v_pk_add_f32 v[208:209], v[208:209], v[50:51]
    v_pk_fma_f32 v[210:211], v[50:51], v[50:51], v[210:211]
    v_pk_add_f32 v[212:213], v[212:213], v[52:53]
    v_pk_fma_f32 v[214:215], v[52:53], v[52:53], v[214:215]
    v_pk_add_f32 v[216:217], v[216:217], v[54:55]
    v_pk_fma_f32 v[218:219], v[54:55], v[54:55], v[218:219]
    v_pk_mul_f32 v[228:229], v[56:57], v[56:57]
    v_pk_mul_f32 v[230:231], v[58:59], v[58:59]
    v_pk_mul_f32 v[232:233], v[60:61], v[60:61]
    v_pk_mul_f32 v[234:235], v[62:63], v[62:63]
    v_pk_fma_f32 v[228:229], v[228:229], v[112:113], v[104:105]
    v_pk_fma_f32 v[230:231], v[230:231], v[114:115], v[106:107]
    v_pk_fma_f32 v[232:233], v[232:233], v[116:117], v[108:109]
    v_pk_fma_f32 v[234:235], v[234:235], v[118:119], v[110:111]
    v_pk_mul_f32 v[228:229], v[228:229], v[56:57]
    v_pk_mul_f32 v[230:231], v[230:231], v[58:59]
    v_pk_mul_f32 v[232:233], v[232:233], v[60:61]
    v_pk_mul_f32 v[234:235], v[234:235], v[62:63]
    v_exp_f32 v228, v228
    v_exp_f32 v229, v229
    v_exp_f32 v230, v230
    v_exp_f32 v231, v231
    v_exp_f32 v232, v232
    v_exp_f32 v233, v233
    v_exp_f32 v234, v234
    v_exp_f32 v235, v235
    v_pk_fma_f32 v[228:229], v[228:229], v[120:121], v[120:121]
    v_pk_fma_f32 v[230:231], v[230:231], v[122:123], v[122:123]
    v_pk_fma_f32 v[232:233], v[232:233], v[124:125], v[124:125]
    v_pk_fma_f32 v[234:235], v[234:235], v[126:127], v[126:127]
    v_rcp_f32 v228, v228
    v_rcp_f32 v229, v229
    v_rcp_f32 v230, v230
    v_rcp_f32 v231, v231
    v_rcp_f32 v232, v232
    v_rcp_f32 v233, v233
    v_rcp_f32 v234, v234
    v_rcp_f32 v235, v235
    v_pk_mul_f32 v[56:57], v[56:57], v[228:229]
    v_pk_mul_f32 v[58:59], v[58:59], v[230:231]
    v_pk_mul_f32 v[60:61], v[60:61], v[232:233]
    v_pk_mul_f32 v[62:63], v[62:63], v[234:235]
    v_pk_add_f32 v[204:205], v[204:205], v[56:57]
    v_pk_fma_f32 v[206:207], v[56:57], v[56:57], v[206:207]
    v_pk_add_f32 v[208:209], v[208:209], v[58:59]
    v_pk_fma_f32 v[210:211], v[58:59], v[58:59], v[210:211]
    v_pk_add_f32 v[212:213], v[212:213], v[60:61]
    v_pk_fma_f32 v[214:215], v[60:61], v[60:61], v[214:215]
    v_pk_add_f32 v[216:217], v[216:217], v[62:63]
    v_pk_fma_f32 v[218:219], v[62:63], v[62:63], v[218:219]
    v_pk_mul_f32 v[220:221], v[64:65], v[64:65]
    v_pk_mul_f32 v[222:223], v[66:67], v[66:67]
    v_pk_mul_f32 v[224:225], v[68:69], v[68:69]
    v_pk_mul_f32 v[226:227], v[70:71], v[70:71]
    v_pk_fma_f32 v[220:221], v[220:221], v[112:113], v[104:105]
    v_pk_fma_f32 v[222:223], v[222:223], v[114:115], v[106:107]
    v_pk_fma_f32 v[224:225], v[224:225], v[116:117], v[108:109]
    v_pk_fma_f32 v[226:227], v[226:227], v[118:119], v[110:111]
    v_pk_mul_f32 v[220:221], v[220:221], v[64:65]
    v_pk_mul_f32 v[222:223], v[222:223], v[66:67]
    v_pk_mul_f32 v[224:225], v[224:225], v[68:69]
    v_pk_mul_f32 v[226:227], v[226:227], v[70:71]
    v_exp_f32 v220, v220
    v_exp_f32 v221, v221
    v_exp_f32 v222, v222
    v_exp_f32 v223, v223
    v_exp_f32 v224, v224
    v_exp_f32 v225, v225
    v_exp_f32 v226, v226
    v_exp_f32 v227, v227
    v_pk_fma_f32 v[220:221], v[220:221], v[120:121], v[120:121]
    v_pk_fma_f32 v[222:223], v[222:223], v[122:123], v[122:123]
    v_pk_fma_f32 v[224:225], v[224:225], v[124:125], v[124:125]
    v_pk_fma_f32 v[226:227], v[226:227], v[126:127], v[126:127]
    v_rcp_f32 v220, v220
    v_rcp_f32 v221, v221
    v_rcp_f32 v222, v222
    v_rcp_f32 v223, v223
    v_rcp_f32 v224, v224
    v_rcp_f32 v225, v225
    v_rcp_f32 v226, v226
    v_rcp_f32 v227, v227
    v_pk_mul_f32 v[64:65], v[64:65], v[220:221]
    v_pk_mul_f32 v[66:67], v[66:67], v[222:223]
    v_pk_mul_f32 v[68:69], v[68:69], v[224:225]
    v_pk_mul_f32 v[70:71], v[70:71], v[226:227]
    v_pk_add_f32 v[204:205], v[204:205], v[64:65]
    v_pk_fma_f32 v[206:207], v[64:65], v[64:65], v[206:207]
    v_pk_add_f32 v[208:209], v[208:209], v[66:67]
    v_pk_fma_f32 v[210:211], v[66:67], v[66:67], v[210:211]
    v_pk_add_f32 v[212:213], v[212:213], v[68:69]
    v_pk_fma_f32 v[214:215], v[68:69], v[68:69], v[214:215]
    v_pk_add_f32 v[216:217], v[216:217], v[70:71]
    v_pk_fma_f32 v[218:219], v[70:71], v[70:71], v[218:219]
    v_pk_mul_f32 v[228:229], v[72:73], v[72:73]
    v_pk_mul_f32 v[230:231], v[74:75], v[74:75]
    v_pk_mul_f32 v[232:233], v[76:77], v[76:77]
    v_pk_mul_f32 v[234:235], v[78:79], v[78:79]
    v_pk_fma_f32 v[228:229], v[228:229], v[112:113], v[104:105]
    v_pk_fma_f32 v[230:231], v[230:231], v[114:115], v[106:107]
    v_pk_fma_f32 v[232:233], v[232:233], v[116:117], v[108:109]
    v_pk_fma_f32 v[234:235], v[234:235], v[118:119], v[110:111]
    v_pk_mul_f32 v[228:229], v[228:229], v[72:73]
    v_pk_mul_f32 v[230:231], v[230:231], v[74:75]
    v_pk_mul_f32 v[232:233], v[232:233], v[76:77]
    v_pk_mul_f32 v[234:235], v[234:235], v[78:79]
    v_exp_f32 v228, v228
    v_exp_f32 v229, v229
    v_exp_f32 v230, v230
    v_exp_f32 v231, v231
    v_exp_f32 v232, v232
    v_exp_f32 v233, v233
    v_exp_f32 v234, v234
    v_exp_f32 v235, v235
    v_pk_fma_f32 v[228:229], v[228:229], v[120:121], v[120:121]
    v_pk_fma_f32 v[230:231], v[230:231], v[122:123], v[122:123]
    v_pk_fma_f32 v[232:233], v[232:233], v[124:125], v[124:125]
    v_pk_fma_f32 v[234:235], v[234:235], v[126:127], v[126:127]
    v_rcp_f32 v228, v228
    v_rcp_f32 v229, v229
    v_rcp_f32 v230, v230
    v_rcp_f32 v231, v231
    v_rcp_f32 v232, v232
    v_rcp_f32 v233, v233
    v_rcp_f32 v234, v234
    v_rcp_f32 v235, v235
    v_pk_mul_f32 v[72:73], v[72:73], v[228:229]
    v_pk_mul_f32 v[74:75], v[74:75], v[230:231]
    v_pk_mul_f32 v[76:77], v[76:77], v[232:233]
    v_pk_mul_f32 v[78:79], v[78:79], v[234:235]
    v_pk_add_f32 v[204:205], v[204:205], v[72:73]
    v_pk_fma_f32 v[206:207], v[72:73], v[72:73], v[206:207]
    v_pk_add_f32 v[208:209], v[208:209], v[74:75]
    v_pk_fma_f32 v[210:211], v[74:75], v[74:75], v[210:211]
    v_pk_add_f32 v[212:213], v[212:213], v[76:77]
    v_pk_fma_f32 v[214:215], v[76:77], v[76:77], v[214:215]
    v_pk_add_f32 v[216:217], v[216:217], v[78:79]
    v_pk_fma_f32 v[218:219], v[78:79], v[78:79], v[218:219]
    v_pk_mul_f32 v[220:221], v[80:81], v[80:81]
    v_pk_mul_f32 v[222:223], v[82:83], v[82:83]
    v_pk_mul_f32 v[224:225], v[84:85], v[84:85]
    v_pk_mul_f32 v[226:227], v[86:87], v[86:87]
    v_pk_fma_f32 v[220:221], v[220:221], v[112:113], v[104:105]
    v_pk_fma_f32 v[222:223], v[222:223], v[114:115], v[106:107]
    v_pk_fma_f32 v[224:225], v[224:225], v[116:117], v[108:109]
    v_pk_fma_f32 v[226:227], v[226:227], v[118:119], v[110:111]
    v_pk_mul_f32 v[220:221], v[220:221], v[80:81]
    v_pk_mul_f32 v[222:223], v[222:223], v[82:83]
    v_pk_mul_f32 v[224:225], v[224:225], v[84:85]
    v_pk_mul_f32 v[226:227], v[226:227], v[86:87]
    v_exp_f32 v220, v220
    v_exp_f32 v221, v221
    v_exp_f32 v222, v222
    v_exp_f32 v223, v223
    v_exp_f32 v224, v224
    v_exp_f32 v225, v225
    v_exp_f32 v226, v226
    v_exp_f32 v227, v227
    v_pk_fma_f32 v[220:221], v[220:221], v[120:121], v[120:121]
    v_pk_fma_f32 v[222:223], v[222:223], v[122:123], v[122:123]
    v_pk_fma_f32 v[224:225], v[224:225], v[124:125], v[124:125]
    v_pk_fma_f32 v[226:227], v[226:227], v[126:127], v[126:127]
    v_rcp_f32 v220, v220
    v_rcp_f32 v221, v221
    v_rcp_f32 v222, v222
    v_rcp_f32 v223, v223
    v_rcp_f32 v224, v224
    v_rcp_f32 v225, v225
    v_rcp_f32 v226, v226
    v_rcp_f32 v227, v227
    v_pk_mul_f32 v[80:81], v[80:81], v[220:221]
    v_pk_mul_f32 v[82:83], v[82:83], v[222:223]
    v_pk_mul_f32 v[84:85], v[84:85], v[224:225]
    v_pk_mul_f32 v[86:87], v[86:87], v[226:227]
    v_pk_add_f32 v[204:205], v[204:205], v[80:81]
    v_pk_fma_f32 v[206:207], v[80:81], v[80:81], v[206:207]
    v_pk_add_f32 v[208:209], v[208:209], v[82:83]
    v_pk_fma_f32 v[210:211], v[82:83], v[82:83], v[210:211]
    v_pk_add_f32 v[212:213], v[212:213], v[84:85]
    v_pk_fma_f32 v[214:215], v[84:85], v[84:85], v[214:215]
    v_pk_add_f32 v[216:217], v[216:217], v[86:87]
    v_pk_fma_f32 v[218:219], v[86:87], v[86:87], v[218:219]
    v_add_f32_dpp v204, v204, v204 row_mirror row_mask:0xf bank_mask:0x3
    v_add_f32_dpp v205, v205, v205 row_mirror row_mask:0xf bank_mask:0x3
    v_add_f32_dpp v206, v206, v206 row_mirror row_mask:0xf bank_mask:0x3
    v_add_f32_dpp v207, v207, v207 row_mirror row_mask:0xf bank_mask:0x3
    v_add_f32_dpp v208, v208, v208 row_mirror row_mask:0xf bank_mask:0x3
    v_add_f32_dpp v209, v209, v209 row_mirror row_mask:0xf bank_mask:0x3
    v_add_f32_dpp v210, v210, v210 row_mirror row_mask:0xf bank_mask:0x3
    v_add_f32_dpp v211, v211, v211 row_mirror row_mask:0xf bank_mask:0x3
    v_add_f32_dpp v204, v212, v212 row_mirror row_mask:0xf bank_mask:0xc
    v_add_f32_dpp v205, v213, v213 row_mirror row_mask:0xf bank_mask:0xc
    v_add_f32_dpp v206, v214, v214 row_mirror row_mask:0xf bank_mask:0xc
    v_add_f32_dpp v207, v215, v215 row_mirror row_mask:0xf bank_mask:0xc
    v_add_f32_dpp v208, v216, v216 row_mirror row_mask:0xf bank_mask:0xc
    v_add_f32_dpp v209, v217, v217 row_mirror row_mask:0xf bank_mask:0xc
    v_add_f32_dpp v210, v218, v218 row_mirror row_mask:0xf bank_mask:0xc
    v_add_f32_dpp v211, v219, v219 row_mirror row_mask:0xf bank_mask:0xc
    v_add_f32_dpp v204, v204, v204 row_half_mirror row_mask:0xf bank_mask:0x5
    v_add_f32_dpp v205, v205, v205 row_half_mirror row_mask:0xf bank_mask:0x5
    v_add_f32_dpp v206, v206, v206 row_half_mirror row_mask:0xf bank_mask:0x5
    v_add_f32_dpp v207, v207, v207 row_half_mirror row_mask:0xf bank_mask:0x5
    v_add_f32_dpp v204, v208, v208 row_half_mirror row_mask:0xf bank_mask:0xa
    v_add_f32_dpp v205, v209, v209 row_half_mirror row_mask:0xf bank_mask:0xa
    v_add_f32_dpp v206, v210, v210 row_half_mirror row_mask:0xf bank_mask:0xa
    v_add_f32_dpp v207, v211, v211 row_half_mirror row_mask:0xf bank_mask:0xa
    v_add_f32_dpp v204, v204, v204 quad_perm:[1,0,3,2] row_mask:0xf bank_mask:0xf
    v_add_f32_dpp v205, v205, v205 quad_perm:[1,0,3,2] row_mask:0xf bank_mask:0xf
    v_add_f32_dpp v206, v206, v206 quad_perm:[1,0,3,2] row_mask:0xf bank_mask:0xf
    v_add_f32_dpp v207, v207, v207 quad_perm:[1,0,3,2] row_mask:0xf bank_mask:0xf
    v_add_f32_dpp v12, v204, v204 quad_perm:[2,3,0,1] row_mask:0xf bank_mask:0xf
    v_add_f32_dpp v14, v205, v205 quad_perm:[2,3,0,1] row_mask:0xf bank_mask:0xf
    v_add_f32_dpp v13, v206, v206 quad_perm:[2,3,0,1] row_mask:0xf bank_mask:0xf
    v_add_f32_dpp v15, v207, v207 quad_perm:[2,3,0,1] row_mask:0xf bank_mask:0xf
    buffer_store_dwordx4 v[12:15], v8, s[4:7], s36 offen sc1
    s_waitcnt lgkmcnt(5)
    v_mfma_f32_16x16x32_bf16 v[88:91], v[168:171], v[160:163], 0
    ds_read_b128 v[204:207], v3 offset:37888
    v_mfma_f32_16x16x32_bf16 v[92:95], v[168:171], v[164:167], 0
    ds_read_b128 v[208:211], v3 offset:39936
    v_mfma_f32_16x16x32_bf16 v[96:99], v[172:175], v[160:163], 0
    ds_read_b128 v[212:215], v1 offset:46080
    v_mfma_f32_16x16x32_bf16 v[100:103], v[172:175], v[164:167], 0
    ds_read_b128 v[216:219], v1 offset:47104
    v_mfma_f32_16x16x32_bf16 v[104:107], v[176:179], v[160:163], 0
    ds_read_b128 v[220:223], v1 offset:48128
    v_mfma_f32_16x16x32_bf16 v[108:111], v[176:179], v[164:167], 0
    ds_read_b128 v[224:227], v1 offset:49152
    v_mfma_f32_16x16x32_bf16 v[112:115], v[180:183], v[160:163], 0
    ds_read_b128 v[228:231], v1 offset:50176
    v_mfma_f32_16x16x32_bf16 v[116:119], v[180:183], v[164:167], 0
    ds_read_b128 v[232:235], v1 offset:51200
    s_waitcnt lgkmcnt(8)
    v_mfma_f32_16x16x32_bf16 v[120:123], v[184:187], v[160:163], 0
    ds_read_b128 v[236:239], v1 offset:52224
    v_mfma_f32_16x16x32_bf16 v[124:127], v[184:187], v[164:167], 0
    ds_read_b128 v[240:243], v1 offset:53248
    v_mfma_f32_16x16x32_bf16 v[128:131], v[188:191], v[160:163], 0
    ds_read_b128 v[244:247], v1 offset:54272
    v_mfma_f32_16x16x32_bf16 v[132:135], v[188:191], v[164:167], 0
    v_mfma_f32_16x16x32_bf16 v[136:139], v[192:195], v[160:163], 0
    v_lshrrev_b32 v255, 8, v1
    v_mfma_f32_16x16x32_bf16 v[140:143], v[192:195], v[164:167], 0
    v_lshl_add_u32 v255, v255, 6, s33
    v_mfma_f32_16x16x32_bf16 v[144:147], v[196:199], v[160:163], 0
    v_mfma_f32_16x16x32_bf16 v[148:151], v[196:199], v[164:167], 0
    v_mfma_f32_16x16x32_bf16 v[152:155], v[200:203], v[160:163], 0
    v_mfma_f32_16x16x32_bf16 v[156:159], v[200:203], v[164:167], 0
    s_waitcnt lgkmcnt(0)
    s_barrier
    v_mfma_f32_16x16x32_bf16 v[88:91], v[212:215], v[204:207], v[88:91]
    ds_read_b128 v[160:163], v0 offset:0
    v_mfma_f32_16x16x32_bf16 v[92:95], v[212:215], v[208:211], v[92:95]
    ds_read_b128 v[164:167], v0 offset:2048
    v_mfma_f32_16x16x32_bf16 v[96:99], v[216:219], v[204:207], v[96:99]
    ds_read_b128 v[168:171], v2 offset:0
    v_mfma_f32_16x16x32_bf16 v[100:103], v[216:219], v[208:211], v[100:103]
    ds_read_b128 v[172:175], v2 offset:1024
    v_mfma_f32_16x16x32_bf16 v[104:107], v[220:223], v[204:207], v[104:107]
    ds_read_b128 v[176:179], v2 offset:2048
    v_mfma_f32_16x16x32_bf16 v[108:111], v[220:223], v[208:211], v[108:111]
    ds_read_b128 v[180:183], v2 offset:3072
    v_mfma_f32_16x16x32_bf16 v[112:115], v[224:227], v[204:207], v[112:115]
    ds_read_b128 v[184:187], v2 offset:4096
    v_mfma_f32_16x16x32_bf16 v[116:119], v[224:227], v[208:211], v[116:119]
    ds_read_b128 v[188:191], v2 offset:5120
    v_mfma_f32_16x16x32_bf16 v[120:123], v[228:231], v[204:207], v[120:123]
    ds_read_b128 v[192:195], v2 offset:6144
    v_mfma_f32_16x16x32_bf16 v[124:127], v[228:231], v[208:211], v[124:127]
    ds_read_b128 v[196:199], v2 offset:7168
    v_mfma_f32_16x16x32_bf16 v[128:131], v[232:235], v[204:207], v[128:131]
    ds_read_b128 v[200:203], v2 offset:8192
    v_mfma_f32_16x16x32_bf16 v[132:135], v[232:235], v[208:211], v[132:135]
    v_mfma_f32_16x16x32_bf16 v[136:139], v[236:239], v[204:207], v[136:139]
    v_mfma_f32_16x16x32_bf16 v[140:143], v[236:239], v[208:211], v[140:143]
    v_mfma_f32_16x16x32_bf16 v[144:147], v[240:243], v[204:207], v[144:147]
    v_mfma_f32_16x16x32_bf16 v[148:151], v[240:243], v[208:211], v[148:151]
    v_mfma_f32_16x16x32_bf16 v[152:155], v[244:247], v[204:207], v[152:155]
    v_mfma_f32_16x16x32_bf16 v[156:159], v[244:247], v[208:211], v[156:159]
    s_waitcnt lgkmcnt(5)
    v_mfma_f32_16x16x32_bf16 v[88:91], v[168:171], v[160:163], v[88:91]
    ds_read_b128 v[204:207], v0 offset:1024
    v_mfma_f32_16x16x32_bf16 v[92:95], v[168:171], v[164:167], v[92:95]
    ds_read_b128 v[208:211], v0 offset:3072
    v_mfma_f32_16x16x32_bf16 v[96:99], v[172:175], v[160:163], v[96:99]
    ds_read_b128 v[212:215], v2 offset:9216
    v_mfma_f32_16x16x32_bf16 v[100:103], v[172:175], v[164:167], v[100:103]
    ds_read_b128 v[216:219], v2 offset:10240
    v_mfma_f32_16x16x32_bf16 v[104:107], v[176:179], v[160:163], v[104:107]
    ds_read_b128 v[220:223], v2 offset:11264
    v_mfma_f32_16x16x32_bf16 v[108:111], v[176:179], v[164:167], v[108:111]
    ds_read_b128 v[224:227], v2 offset:12288
    v_mfma_f32_16x16x32_bf16 v[112:115], v[180:183], v[160:163], v[112:115]
    ds_read_b128 v[228:231], v2 offset:13312
    v_mfma_f32_16x16x32_bf16 v[116:119], v[180:183], v[164:167], v[116:119]
    ds_read_b128 v[232:235], v2 offset:14336
    s_waitcnt lgkmcnt(8)
    v_mfma_f32_16x16x32_bf16 v[120:123], v[184:187], v[160:163], v[120:123]
    ds_read_b128 v[236:239], v2 offset:15360
    v_mfma_f32_16x16x32_bf16 v[124:127], v[184:187], v[164:167], v[124:127]
    ds_read_b128 v[240:243], v2 offset:16384
    v_mfma_f32_16x16x32_bf16 v[128:131], v[188:191], v[160:163], v[128:131]
    ds_read_b128 v[244:247], v2 offset:17408
    v_mfma_f32_16x16x32_bf16 v[132:135], v[188:191], v[164:167], v[132:135]
    v_mfma_f32_16x16x32_bf16 v[136:139], v[192:195], v[160:163], v[136:139]
    v_mfma_f32_16x16x32_bf16 v[140:143], v[192:195], v[164:167], v[140:143]
    v_mfma_f32_16x16x32_bf16 v[144:147], v[196:199], v[160:163], v[144:147]
    v_mfma_f32_16x16x32_bf16 v[148:151], v[196:199], v[164:167], v[148:151]
    v_mfma_f32_16x16x32_bf16 v[152:155], v[200:203], v[160:163], v[152:155]
    v_mfma_f32_16x16x32_bf16 v[156:159], v[200:203], v[164:167], v[156:159]
    s_waitcnt lgkmcnt(0)
    s_barrier
    v_mfma_f32_16x16x32_bf16 v[88:91], v[212:215], v[204:207], v[88:91]
    ds_read_b128 v[160:163], v0 offset:36864
    v_mfma_f32_16x16x32_bf16 v[92:95], v[212:215], v[208:211], v[92:95]
    ds_read_b128 v[164:167], v0 offset:38912
    v_mfma_f32_16x16x32_bf16 v[96:99], v[216:219], v[204:207], v[96:99]
    ds_read_b128 v[168:171], v2 offset:36864
    v_mfma_f32_16x16x32_bf16 v[100:103], v[216:219], v[208:211], v[100:103]
    ds_read_b128 v[172:175], v2 offset:37888
    v_mfma_f32_16x16x32_bf16 v[104:107], v[220:223], v[204:207], v[104:107]
    ds_read_b128 v[176:179], v2 offset:38912
    v_mfma_f32_16x16x32_bf16 v[108:111], v[220:223], v[208:211], v[108:111]
    ds_read_b128 v[180:183], v2 offset:39936
    v_mfma_f32_16x16x32_bf16 v[112:115], v[224:227], v[204:207], v[112:115]
    ds_read_b128 v[184:187], v2 offset:40960
    v_mfma_f32_16x16x32_bf16 v[116:119], v[224:227], v[208:211], v[116:119]
    ds_read_b128 v[188:191], v2 offset:41984
    v_mfma_f32_16x16x32_bf16 v[120:123], v[228:231], v[204:207], v[120:123]
    ds_read_b128 v[192:195], v2 offset:43008
    v_mfma_f32_16x16x32_bf16 v[124:127], v[228:231], v[208:211], v[124:127]
    ds_read_b128 v[196:199], v2 offset:44032
    v_mfma_f32_16x16x32_bf16 v[128:131], v[232:235], v[204:207], v[128:131]
    ds_read_b128 v[200:203], v2 offset:45056
    v_mfma_f32_16x16x32_bf16 v[132:135], v[232:235], v[208:211], v[132:135]
    v_mfma_f32_16x16x32_bf16 v[136:139], v[236:239], v[204:207], v[136:139]
    v_mfma_f32_16x16x32_bf16 v[140:143], v[236:239], v[208:211], v[140:143]
    v_mfma_f32_16x16x32_bf16 v[144:147], v[240:243], v[204:207], v[144:147]
    v_mfma_f32_16x16x32_bf16 v[148:151], v[240:243], v[208:211], v[148:151]
    v_mfma_f32_16x16x32_bf16 v[152:155], v[244:247], v[204:207], v[152:155]
    v_mfma_f32_16x16x32_bf16 v[156:159], v[244:247], v[208:211], v[156:159]
    s_waitcnt lgkmcnt(5)
    v_mfma_f32_16x16x32_bf16 v[88:91], v[168:171], v[160:163], v[88:91]
    ds_read_b128 v[204:207], v0 offset:37888
    v_mfma_f32_16x16x32_bf16 v[92:95], v[168:171], v[164:167], v[92:95]
    ds_read_b128 v[208:211], v0 offset:39936
    v_mfma_f32_16x16x32_bf16 v[96:99], v[172:175], v[160:163], v[96:99]
    ds_read_b128 v[212:215], v2 offset:46080
    v_mfma_f32_16x16x32_bf16 v[100:103], v[172:175], v[164:167], v[100:103]
    ds_read_b128 v[216:219], v2 offset:47104
    v_mfma_f32_16x16x32_bf16 v[104:107], v[176:179], v[160:163], v[104:107]
    ds_read_b128 v[220:223], v2 offset:48128
    v_mfma_f32_16x16x32_bf16 v[108:111], v[176:179], v[164:167], v[108:111]
    ds_read_b128 v[224:227], v2 offset:49152
    v_mfma_f32_16x16x32_bf16 v[112:115], v[180:183], v[160:163], v[112:115]
    ds_read_b128 v[228:231], v2 offset:50176
    v_mfma_f32_16x16x32_bf16 v[116:119], v[180:183], v[164:167], v[116:119]
    ds_read_b128 v[232:235], v2 offset:51200
    s_waitcnt lgkmcnt(8)
    v_mfma_f32_16x16x32_bf16 v[120:123], v[184:187], v[160:163], v[120:123]
    ds_read_b128 v[236:239], v2 offset:52224
    v_mfma_f32_16x16x32_bf16 v[124:127], v[184:187], v[164:167], v[124:127]
    ds_read_b128 v[240:243], v2 offset:53248
    v_mfma_f32_16x16x32_bf16 v[128:131], v[188:191], v[160:163], v[128:131]
    ds_read_b128 v[244:247], v2 offset:54272
    v_mfma_f32_16x16x32_bf16 v[132:135], v[188:191], v[164:167], v[132:135]
    v_mfma_f32_16x16x32_bf16 v[136:139], v[192:195], v[160:163], v[136:139]
    v_mfma_f32_16x16x32_bf16 v[140:143], v[192:195], v[164:167], v[140:143]
    v_mfma_f32_16x16x32_bf16 v[144:147], v[196:199], v[160:163], v[144:147]
    v_mfma_f32_16x16x32_bf16 v[148:151], v[196:199], v[164:167], v[148:151]
    v_mfma_f32_16x16x32_bf16 v[152:155], v[200:203], v[160:163], v[152:155]
    v_mfma_f32_16x16x32_bf16 v[156:159], v[200:203], v[164:167], v[156:159]
    s_waitcnt lgkmcnt(0)
    s_barrier
    v_mfma_f32_16x16x32_bf16 v[88:91], v[212:215], v[204:207], v[88:91]
    ds_read_b128 v[160:163], v3 offset:0
    v_mfma_f32_16x16x32_bf16 v[92:95], v[212:215], v[208:211], v[92:95]
    ds_read_b128 v[164:167], v3 offset:2048
    v_mfma_f32_16x16x32_bf16 v[96:99], v[216:219], v[204:207], v[96:99]
    ds_read_b128 v[168:171], v1 offset:0
    v_mfma_f32_16x16x32_bf16 v[100:103], v[216:219], v[208:211], v[100:103]
    ds_read_b128 v[172:175], v1 offset:1024
    v_mfma_f32_16x16x32_bf16 v[104:107], v[220:223], v[204:207], v[104:107]
    ds_read_b128 v[176:179], v1 offset:2048
    v_mfma_f32_16x16x32_bf16 v[108:111], v[220:223], v[208:211], v[108:111]
    ds_read_b128 v[180:183], v1 offset:3072
    v_mfma_f32_16x16x32_bf16 v[112:115], v[224:227], v[204:207], v[112:115]
    ds_read_b128 v[184:187], v1 offset:4096
    v_mfma_f32_16x16x32_bf16 v[116:119], v[224:227], v[208:211], v[116:119]
    ds_read_b128 v[188:191], v1 offset:5120
    v_mfma_f32_16x16x32_bf16 v[120:123], v[228:231], v[204:207], v[120:123]
    ds_read_b128 v[192:195], v1 offset:6144
    v_mfma_f32_16x16x32_bf16 v[124:127], v[228:231], v[208:211], v[124:127]
    ds_read_b128 v[196:199], v1 offset:7168
    v_mfma_f32_16x16x32_bf16 v[128:131], v[232:235], v[204:207], v[128:131]
    ds_read_b128 v[200:203], v1 offset:8192
    v_mfma_f32_16x16x32_bf16 v[132:135], v[232:235], v[208:211], v[132:135]
    v_mfma_f32_16x16x32_bf16 v[136:139], v[236:239], v[204:207], v[136:139]
    v_mfma_f32_16x16x32_bf16 v[140:143], v[236:239], v[208:211], v[140:143]
    v_mfma_f32_16x16x32_bf16 v[144:147], v[240:243], v[204:207], v[144:147]
    v_mfma_f32_16x16x32_bf16 v[148:151], v[240:243], v[208:211], v[148:151]
    v_mfma_f32_16x16x32_bf16 v[152:155], v[244:247], v[204:207], v[152:155]
    v_mfma_f32_16x16x32_bf16 v[156:159], v[244:247], v[208:211], v[156:159]
    s_waitcnt lgkmcnt(5)
    v_mfma_f32_16x16x32_bf16 v[88:91], v[168:171], v[160:163], v[88:91]
    ds_read_b128 v[204:207], v3 offset:1024
    v_mfma_f32_16x16x32_bf16 v[92:95], v[168:171], v[164:167], v[92:95]
    ds_read_b128 v[208:211], v3 offset:3072
    v_mfma_f32_16x16x32_bf16 v[96:99], v[172:175], v[160:163], v[96:99]
    ds_read_b128 v[212:215], v1 offset:9216
    v_mfma_f32_16x16x32_bf16 v[100:103], v[172:175], v[164:167], v[100:103]
    ds_read_b128 v[216:219], v1 offset:10240
    v_mfma_f32_16x16x32_bf16 v[104:107], v[176:179], v[160:163], v[104:107]
    ds_read_b128 v[220:223], v1 offset:11264
    v_mfma_f32_16x16x32_bf16 v[108:111], v[176:179], v[164:167], v[108:111]
    ds_read_b128 v[224:227], v1 offset:12288
    v_mfma_f32_16x16x32_bf16 v[112:115], v[180:183], v[160:163], v[112:115]
    ds_read_b128 v[228:231], v1 offset:13312
    v_mfma_f32_16x16x32_bf16 v[116:119], v[180:183], v[164:167], v[116:119]
    ds_read_b128 v[232:235], v1 offset:14336
    s_waitcnt lgkmcnt(8)
    v_mfma_f32_16x16x32_bf16 v[120:123], v[184:187], v[160:163], v[120:123]
    ds_read_b128 v[236:239], v1 offset:15360
    v_mfma_f32_16x16x32_bf16 v[124:127], v[184:187], v[164:167], v[124:127]
    ds_read_b128 v[240:243], v1 offset:16384
    v_mfma_f32_16x16x32_bf16 v[128:131], v[188:191], v[160:163], v[128:131]
    ds_read_b128 v[244:247], v1 offset:17408
    v_mfma_f32_16x16x32_bf16 v[132:135], v[188:191], v[164:167], v[132:135]
    v_mfma_f32_16x16x32_bf16 v[136:139], v[192:195], v[160:163], v[136:139]
    v_mfma_f32_16x16x32_bf16 v[140:143], v[192:195], v[164:167], v[140:143]
    v_mfma_f32_16x16x32_bf16 v[144:147], v[196:199], v[160:163], v[144:147]
    v_mfma_f32_16x16x32_bf16 v[148:151], v[196:199], v[164:167], v[148:151]
    v_mfma_f32_16x16x32_bf16 v[152:155], v[200:203], v[160:163], v[152:155]
    v_mfma_f32_16x16x32_bf16 v[156:159], v[200:203], v[164:167], v[156:159]
    s_waitcnt lgkmcnt(0)
    s_barrier
    v_mfma_f32_16x16x32_bf16 v[88:91], v[212:215], v[204:207], v[88:91]
    ds_read_b128 v[160:163], v3 offset:36864
    v_mfma_f32_16x16x32_bf16 v[92:95], v[212:215], v[208:211], v[92:95]
    ds_read_b128 v[164:167], v3 offset:38912
    v_mfma_f32_16x16x32_bf16 v[96:99], v[216:219], v[204:207], v[96:99]
    ds_read_b128 v[168:171], v1 offset:36864
    v_mfma_f32_16x16x32_bf16 v[100:103], v[216:219], v[208:211], v[100:103]
    ds_read_b128 v[172:175], v1 offset:37888
    v_mfma_f32_16x16x32_bf16 v[104:107], v[220:223], v[204:207], v[104:107]
    ds_read_b128 v[176:179], v1 offset:38912
    v_mfma_f32_16x16x32_bf16 v[108:111], v[220:223], v[208:211], v[108:111]
    ds_read_b128 v[180:183], v1 offset:39936
    v_mfma_f32_16x16x32_bf16 v[112:115], v[224:227], v[204:207], v[112:115]
    ds_read_b128 v[184:187], v1 offset:40960
    v_mfma_f32_16x16x32_bf16 v[116:119], v[224:227], v[208:211], v[116:119]
    ds_read_b128 v[188:191], v1 offset:41984
    v_mfma_f32_16x16x32_bf16 v[120:123], v[228:231], v[204:207], v[120:123]
    ds_read_b128 v[192:195], v1 offset:43008
    v_mfma_f32_16x16x32_bf16 v[124:127], v[228:231], v[208:211], v[124:127]
    ds_read_b128 v[196:199], v1 offset:44032
    v_mfma_f32_16x16x32_bf16 v[128:131], v[232:235], v[204:207], v[128:131]
    ds_read_b128 v[200:203], v1 offset:45056
    v_mfma_f32_16x16x32_bf16 v[132:135], v[232:235], v[208:211], v[132:135]
    ds_read_b128 v[4:7], v255 offset:1024
    v_mfma_f32_16x16x32_bf16 v[136:139], v[236:239], v[204:207], v[136:139]
    ds_read_b128 v[8:11], v255 offset:1040
    v_mfma_f32_16x16x32_bf16 v[140:143], v[236:239], v[208:211], v[140:143]
    ds_read_b128 v[12:15], v255 offset:1056
    v_mfma_f32_16x16x32_bf16 v[144:147], v[240:243], v[204:207], v[144:147]
    ds_read_b128 v[252:255], v255 offset:1072
    v_mfma_f32_16x16x32_bf16 v[148:151], v[240:243], v[208:211], v[148:151]
    v_mfma_f32_16x16x32_bf16 v[152:155], v[244:247], v[204:207], v[152:155]
    v_mfma_f32_16x16x32_bf16 v[156:159], v[244:247], v[208:211], v[156:159]
    s_waitcnt lgkmcnt(9)
    v_mfma_f32_16x16x32_bf16 v[88:91], v[168:171], v[160:163], v[88:91]
    ds_read_b128 v[204:207], v3 offset:37888
    v_mfma_f32_16x16x32_bf16 v[92:95], v[168:171], v[164:167], v[92:95]
    ds_read_b128 v[208:211], v3 offset:39936
    v_mfma_f32_16x16x32_bf16 v[96:99], v[172:175], v[160:163], v[96:99]
    ds_read_b128 v[212:215], v1 offset:46080
    v_mfma_f32_16x16x32_bf16 v[100:103], v[172:175], v[164:167], v[100:103]
    ds_read_b128 v[216:219], v1 offset:47104
    v_mfma_f32_16x16x32_bf16 v[104:107], v[176:179], v[160:163], v[104:107]
    ds_read_b128 v[220:223], v1 offset:48128
    v_mfma_f32_16x16x32_bf16 v[108:111], v[176:179], v[164:167], v[108:111]
    ds_read_b128 v[224:227], v1 offset:49152
    v_mfma_f32_16x16x32_bf16 v[112:115], v[180:183], v[160:163], v[112:115]
    ds_read_b128 v[228:231], v1 offset:50176
    v_mfma_f32_16x16x32_bf16 v[116:119], v[180:183], v[164:167], v[116:119]
    ds_read_b128 v[232:235], v1 offset:51200
    s_waitcnt lgkmcnt(8)
    v_mfma_f32_16x16x32_bf16 v[120:123], v[184:187], v[160:163], v[120:123]
    ds_read_b128 v[236:239], v1 offset:52224
    v_fma_f32 v16, v16, v4, -v6
    v_mfma_f32_16x16x32_bf16 v[124:127], v[184:187], v[164:167], v[124:127]
    ds_read_b128 v[240:243], v1 offset:53248
    v_fma_f32 v17, v17, v5, -v7
    v_mfma_f32_16x16x32_bf16 v[128:131], v[188:191], v[160:163], v[128:131]
    ds_read_b128 v[244:247], v1 offset:54272
    v_fma_f32 v18, v18, v8, -v10
    v_mfma_f32_16x16x32_bf16 v[132:135], v[188:191], v[164:167], v[132:135]
    v_fma_f32 v19, v19, v9, -v11
    v_fma_f32 v20, v20, v12, -v14
    v_mfma_f32_16x16x32_bf16 v[136:139], v[192:195], v[160:163], v[136:139]
    v_fma_f32 v21, v21, v13, -v15
    v_fma_f32 v22, v22, v252, -v254
    v_mfma_f32_16x16x32_bf16 v[140:143], v[192:195], v[164:167], v[140:143]
    v_fma_f32 v23, v23, v253, -v255
    v_cvt_pk_bf16_f32 v16, v16, v17
    v_mfma_f32_16x16x32_bf16 v[144:147], v[196:199], v[160:163], v[144:147]
    v_cvt_pk_bf16_f32 v17, v18, v19
    v_cvt_pk_bf16_f32 v18, v20, v21
    v_mfma_f32_16x16x32_bf16 v[148:151], v[196:199], v[164:167], v[148:151]
    v_cvt_pk_bf16_f32 v19, v22, v23
    v_fma_f32 v24, v24, v4, -v6
    v_mfma_f32_16x16x32_bf16 v[152:155], v[200:203], v[160:163], v[152:155]
    v_fma_f32 v25, v25, v5, -v7
    v_fma_f32 v26, v26, v8, -v10
    v_mfma_f32_16x16x32_bf16 v[156:159], v[200:203], v[164:167], v[156:159]
    v_fma_f32 v27, v27, v9, -v11
    s_waitcnt lgkmcnt(0)
    s_barrier
    v_mfma_f32_16x16x32_bf16 v[88:91], v[212:215], v[204:207], v[88:91]
    ds_read_b128 v[160:163], v0 offset:0
    v_mfma_f32_16x16x32_bf16 v[92:95], v[212:215], v[208:211], v[92:95]
    ds_read_b128 v[164:167], v0 offset:2048
    v_fma_f32 v28, v28, v12, -v14
    v_mfma_f32_16x16x32_bf16 v[96:99], v[216:219], v[204:207], v[96:99]
    ds_read_b128 v[168:171], v2 offset:0
    v_fma_f32 v29, v29, v13, -v15
    v_mfma_f32_16x16x32_bf16 v[100:103], v[216:219], v[208:211], v[100:103]
    ds_read_b128 v[172:175], v2 offset:1024
    v_fma_f32 v30, v30, v252, -v254
    v_mfma_f32_16x16x32_bf16 v[104:107], v[220:223], v[204:207], v[104:107]
    ds_read_b128 v[176:179], v2 offset:2048
    v_fma_f32 v31, v31, v253, -v255
    v_mfma_f32_16x16x32_bf16 v[108:111], v[220:223], v[208:211], v[108:111]
    ds_read_b128 v[180:183], v2 offset:3072
    v_permlane32_swap_b32 v16, v18
    v_mfma_f32_16x16x32_bf16 v[112:115], v[224:227], v[204:207], v[112:115]
    ds_read_b128 v[184:187], v2 offset:4096
    v_permlane32_swap_b32 v17, v19
    v_mfma_f32_16x16x32_bf16 v[116:119], v[224:227], v[208:211], v[116:119]
    ds_read_b128 v[188:191], v2 offset:5120
    v_mfma_f32_16x16x32_bf16 v[120:123], v[228:231], v[204:207], v[120:123]
    ds_read_b128 v[192:195], v2 offset:6144
    v_cvt_pk_bf16_f32 v24, v24, v25
    v_mfma_f32_16x16x32_bf16 v[124:127], v[228:231], v[208:211], v[124:127]
    ds_read_b128 v[196:199], v2 offset:7168
    v_cvt_pk_bf16_f32 v25, v26, v27
    v_mfma_f32_16x16x32_bf16 v[128:131], v[232:235], v[204:207], v[128:131]
    ds_read_b128 v[200:203], v2 offset:8192
    v_cvt_pk_bf16_f32 v26, v28, v29
    v_mfma_f32_16x16x32_bf16 v[132:135], v[232:235], v[208:211], v[132:135]
    v_cvt_pk_bf16_f32 v27, v30, v31
    v_permlane16_swap_b32 v16, v18
    v_mfma_f32_16x16x32_bf16 v[136:139], v[236:239], v[204:207], v[136:139]
    v_permlane16_swap_b32 v17, v19
    v_fma_f32 v32, v32, v4, -v6
    v_mfma_f32_16x16x32_bf16 v[140:143], v[236:239], v[208:211], v[140:143]
    v_fma_f32 v33, v33, v5, -v7
    v_fma_f32 v34, v34, v8, -v10
    v_mfma_f32_16x16x32_bf16 v[144:147], v[240:243], v[204:207], v[144:147]
    v_fma_f32 v35, v35, v9, -v11
    v_fma_f32 v36, v36, v12, -v14
    v_mfma_f32_16x16x32_bf16 v[148:151], v[240:243], v[208:211], v[148:151]
    v_fma_f32 v37, v37, v13, -v15
    v_fma_f32 v38, v38, v252, -v254
    v_mfma_f32_16x16x32_bf16 v[152:155], v[244:247], v[204:207], v[152:155]
    v_fma_f32 v39, v39, v253, -v255
    v_permlane32_swap_b32 v24, v26
    v_mfma_f32_16x16x32_bf16 v[156:159], v[244:247], v[208:211], v[156:159]
    v_permlane32_swap_b32 v25, v27
    s_waitcnt lgkmcnt(5)
    v_mfma_f32_16x16x32_bf16 v[88:91], v[168:171], v[160:163], v[88:91]
    ds_read_b128 v[204:207], v0 offset:1024
    v_mfma_f32_16x16x32_bf16 v[92:95], v[168:171], v[164:167], v[92:95]
    ds_read_b128 v[208:211], v0 offset:3072
    v_cvt_pk_bf16_f32 v32, v32, v33
    v_mfma_f32_16x16x32_bf16 v[96:99], v[172:175], v[160:163], v[96:99]
    ds_read_b128 v[212:215], v2 offset:9216
    v_cvt_pk_bf16_f32 v33, v34, v35
    v_mfma_f32_16x16x32_bf16 v[100:103], v[172:175], v[164:167], v[100:103]
    ds_read_b128 v[216:219], v2 offset:10240
    v_cvt_pk_bf16_f32 v34, v36, v37
    v_mfma_f32_16x16x32_bf16 v[104:107], v[176:179], v[160:163], v[104:107]
    ds_read_b128 v[220:223], v2 offset:11264
    v_cvt_pk_bf16_f32 v35, v38, v39
    v_mfma_f32_16x16x32_bf16 v[108:111], v[176:179], v[164:167], v[108:111]
    ds_read_b128 v[224:227], v2 offset:12288
    v_permlane16_swap_b32 v24, v26
    v_mfma_f32_16x16x32_bf16 v[112:115], v[180:183], v[160:163], v[112:115]
    ds_read_b128 v[228:231], v2 offset:13312
    v_permlane16_swap_b32 v25, v27
    v_mfma_f32_16x16x32_bf16 v[116:119], v[180:183], v[164:167], v[116:119]
    ds_read_b128 v[232:235], v2 offset:14336
    s_waitcnt lgkmcnt(8)
    v_mfma_f32_16x16x32_bf16 v[120:123], v[184:187], v[160:163], v[120:123]
    ds_read_b128 v[236:239], v2 offset:15360
    v_fma_f32 v40, v40, v4, -v6
    v_mfma_f32_16x16x32_bf16 v[124:127], v[184:187], v[164:167], v[124:127]
    ds_read_b128 v[240:243], v2 offset:16384
    v_fma_f32 v41, v41, v5, -v7
    v_mfma_f32_16x16x32_bf16 v[128:131], v[188:191], v[160:163], v[128:131]
    ds_read_b128 v[244:247], v2 offset:17408
    v_fma_f32 v42, v42, v8, -v10
    v_mfma_f32_16x16x32_bf16 v[132:135], v[188:191], v[164:167], v[132:135]
    v_fma_f32 v43, v43, v9, -v11
    v_fma_f32 v44, v44, v12, -v14
    v_mfma_f32_16x16x32_bf16 v[136:139], v[192:195], v[160:163], v[136:139]
    v_fma_f32 v45, v45, v13, -v15
    v_fma_f32 v46, v46, v252, -v254
    v_mfma_f32_16x16x32_bf16 v[140:143], v[192:195], v[164:167], v[140:143]
    v_fma_f32 v47, v47, v253, -v255
    v_permlane32_swap_b32 v32, v34
    v_mfma_f32_16x16x32_bf16 v[144:147], v[196:199], v[160:163], v[144:147]
    v_permlane32_swap_b32 v33, v35
    v_cvt_pk_bf16_f32 v40, v40, v41
    v_mfma_f32_16x16x32_bf16 v[148:151], v[196:199], v[164:167], v[148:151]
    v_cvt_pk_bf16_f32 v41, v42, v43
    v_cvt_pk_bf16_f32 v42, v44, v45
    v_mfma_f32_16x16x32_bf16 v[152:155], v[200:203], v[160:163], v[152:155]
    v_cvt_pk_bf16_f32 v43, v46, v47
    v_permlane16_swap_b32 v32, v34
    v_mfma_f32_16x16x32_bf16 v[156:159], v[200:203], v[164:167], v[156:159]
    v_permlane16_swap_b32 v33, v35
    s_waitcnt lgkmcnt(0)
    s_barrier
    v_mfma_f32_16x16x32_bf16 v[88:91], v[212:215], v[204:207], v[88:91]
    ds_read_b128 v[160:163], v0 offset:36864
    v_mfma_f32_16x16x32_bf16 v[92:95], v[212:215], v[208:211], v[92:95]
    ds_read_b128 v[164:167], v0 offset:38912
    v_fma_f32 v48, v48, v4, -v6
    v_mfma_f32_16x16x32_bf16 v[96:99], v[216:219], v[204:207], v[96:99]
    ds_read_b128 v[168:171], v2 offset:36864
    buffer_store_dwordx4 v[16:19], v1, s[4:7], s38 offen offset:0 sc1
    v_fma_f32 v49, v49, v5, -v7
    v_mfma_f32_16x16x32_bf16 v[100:103], v[216:219], v[208:211], v[100:103]
    ds_read_b128 v[172:175], v2 offset:37888
    v_fma_f32 v50, v50, v8, -v10
    v_mfma_f32_16x16x32_bf16 v[104:107], v[220:223], v[204:207], v[104:107]
    ds_read_b128 v[176:179], v2 offset:38912
    v_fma_f32 v51, v51, v9, -v11
    v_mfma_f32_16x16x32_bf16 v[108:111], v[220:223], v[208:211], v[108:111]
    ds_read_b128 v[180:183], v2 offset:39936
    v_fma_f32 v52, v52, v12, -v14
    v_mfma_f32_16x16x32_bf16 v[112:115], v[224:227], v[204:207], v[112:115]
    ds_read_b128 v[184:187], v2 offset:40960
    v_fma_f32 v53, v53, v13, -v15
    v_mfma_f32_16x16x32_bf16 v[116:119], v[224:227], v[208:211], v[116:119]
    ds_read_b128 v[188:191], v2 offset:41984
    v_mfma_f32_16x16x32_bf16 v[120:123], v[228:231], v[204:207], v[120:123]
    ds_read_b128 v[192:195], v2 offset:43008
    v_fma_f32 v54, v54, v252, -v254
    v_mfma_f32_16x16x32_bf16 v[124:127], v[228:231], v[208:211], v[124:127]
    ds_read_b128 v[196:199], v2 offset:44032
    v_fma_f32 v55, v55, v253, -v255
    v_mfma_f32_16x16x32_bf16 v[128:131], v[232:235], v[204:207], v[128:131]
    ds_read_b128 v[200:203], v2 offset:45056
    buffer_store_dwordx4 v[24:27], v1, s[4:7], s38 offen offset:1024 sc1
    v_permlane32_swap_b32 v40, v42
    v_mfma_f32_16x16x32_bf16 v[132:135], v[232:235], v[208:211], v[132:135]
    v_permlane32_swap_b32 v41, v43
    v_cvt_pk_bf16_f32 v48, v48, v49
    v_mfma_f32_16x16x32_bf16 v[136:139], v[236:239], v[204:207], v[136:139]
    v_cvt_pk_bf16_f32 v49, v50, v51
    v_cvt_pk_bf16_f32 v50, v52, v53
    v_mfma_f32_16x16x32_bf16 v[140:143], v[236:239], v[208:211], v[140:143]
    v_cvt_pk_bf16_f32 v51, v54, v55
    v_permlane16_swap_b32 v40, v42
    v_mfma_f32_16x16x32_bf16 v[144:147], v[240:243], v[204:207], v[144:147]
    v_permlane16_swap_b32 v41, v43
    v_fma_f32 v56, v56, v4, -v6
    v_mfma_f32_16x16x32_bf16 v[148:151], v[240:243], v[208:211], v[148:151]
    v_fma_f32 v57, v57, v5, -v7
    v_fma_f32 v58, v58, v8, -v10
    v_mfma_f32_16x16x32_bf16 v[152:155], v[244:247], v[204:207], v[152:155]
    v_fma_f32 v59, v59, v9, -v11
    v_fma_f32 v60, v60, v12, -v14
    v_mfma_f32_16x16x32_bf16 v[156:159], v[244:247], v[208:211], v[156:159]
    v_fma_f32 v61, v61, v13, -v15
    s_waitcnt lgkmcnt(5)
    v_mfma_f32_16x16x32_bf16 v[88:91], v[168:171], v[160:163], v[88:91]
    ds_read_b128 v[204:207], v0 offset:37888
    v_mfma_f32_16x16x32_bf16 v[92:95], v[168:171], v[164:167], v[92:95]
    ds_read_b128 v[208:211], v0 offset:39936
    v_fma_f32 v62, v62, v252, -v254
    v_mfma_f32_16x16x32_bf16 v[96:99], v[172:175], v[160:163], v[96:99]
    ds_read_b128 v[212:215], v2 offset:46080
    buffer_store_dwordx4 v[32:35], v1, s[4:7], s38 offen offset:2048 sc1
    v_fma_f32 v63, v63, v253, -v255
    v_mfma_f32_16x16x32_bf16 v[100:103], v[172:175], v[164:167], v[100:103]
    ds_read_b128 v[216:219], v2 offset:47104
    v_permlane32_swap_b32 v48, v50
    v_mfma_f32_16x16x32_bf16 v[104:107], v[176:179], v[160:163], v[104:107]
    ds_read_b128 v[220:223], v2 offset:48128
    v_permlane32_swap_b32 v49, v51
    v_mfma_f32_16x16x32_bf16 v[108:111], v[176:179], v[164:167], v[108:111]
    ds_read_b128 v[224:227], v2 offset:49152
    v_cvt_pk_bf16_f32 v56, v56, v57
    v_mfma_f32_16x16x32_bf16 v[112:115], v[180:183], v[160:163], v[112:115]
    ds_read_b128 v[228:231], v2 offset:50176
    v_cvt_pk_bf16_f32 v57, v58, v59
    v_mfma_f32_16x16x32_bf16 v[116:119], v[180:183], v[164:167], v[116:119]
    ds_read_b128 v[232:235], v2 offset:51200
    s_waitcnt lgkmcnt(8)
    v_mfma_f32_16x16x32_bf16 v[120:123], v[184:187], v[160:163], v[120:123]
    ds_read_b128 v[236:239], v2 offset:52224
    v_cvt_pk_bf16_f32 v58, v60, v61
    v_mfma_f32_16x16x32_bf16 v[124:127], v[184:187], v[164:167], v[124:127]
    ds_read_b128 v[240:243], v2 offset:53248
    v_cvt_pk_bf16_f32 v59, v62, v63
    v_mfma_f32_16x16x32_bf16 v[128:131], v[188:191], v[160:163], v[128:131]
    ds_read_b128 v[244:247], v2 offset:54272
    buffer_store_dwordx4 v[40:43], v1, s[4:7], s38 offen offset:3072 sc1
    v_permlane16_swap_b32 v48, v50
    v_mfma_f32_16x16x32_bf16 v[132:135], v[188:191], v[164:167], v[132:135]
    v_permlane16_swap_b32 v49, v51
    v_fma_f32 v64, v64, v4, -v6
    v_mfma_f32_16x16x32_bf16 v[136:139], v[192:195], v[160:163], v[136:139]
    v_fma_f32 v65, v65, v5, -v7
    v_fma_f32 v66, v66, v8, -v10
    v_mfma_f32_16x16x32_bf16 v[140:143], v[192:195], v[164:167], v[140:143]
    v_fma_f32 v67, v67, v9, -v11
    v_fma_f32 v68, v68, v12, -v14
    v_mfma_f32_16x16x32_bf16 v[144:147], v[196:199], v[160:163], v[144:147]
    v_fma_f32 v69, v69, v13, -v15
    v_fma_f32 v70, v70, v252, -v254
    v_mfma_f32_16x16x32_bf16 v[148:151], v[196:199], v[164:167], v[148:151]
    v_fma_f32 v71, v71, v253, -v255
    v_permlane32_swap_b32 v56, v58
    v_mfma_f32_16x16x32_bf16 v[152:155], v[200:203], v[160:163], v[152:155]
    v_permlane32_swap_b32 v57, v59
    v_cvt_pk_bf16_f32 v64, v64, v65
    v_mfma_f32_16x16x32_bf16 v[156:159], v[200:203], v[164:167], v[156:159]
    v_cvt_pk_bf16_f32 v65, v66, v67
    s_waitcnt lgkmcnt(0)
    s_barrier
    v_mfma_f32_16x16x32_bf16 v[88:91], v[212:215], v[204:207], v[88:91]
    ds_read_b128 v[160:163], v3 offset:0
    v_mfma_f32_16x16x32_bf16 v[92:95], v[212:215], v[208:211], v[92:95]
    ds_read_b128 v[164:167], v3 offset:2048
    v_cvt_pk_bf16_f32 v66, v68, v69
    v_mfma_f32_16x16x32_bf16 v[96:99], v[216:219], v[204:207], v[96:99]
    ds_read_b128 v[168:171], v1 offset:0
    buffer_store_dwordx4 v[48:51], v1, s[4:7], s39 offen offset:0 sc1
    v_cvt_pk_bf16_f32 v67, v70, v71
    v_mfma_f32_16x16x32_bf16 v[100:103], v[216:219], v[208:211], v[100:103]
    ds_read_b128 v[172:175], v1 offset:1024
    v_permlane16_swap_b32 v56, v58
    v_mfma_f32_16x16x32_bf16 v[104:107], v[220:223], v[204:207], v[104:107]
    ds_read_b128 v[176:179], v1 offset:2048
    v_permlane16_swap_b32 v57, v59
    v_mfma_f32_16x16x32_bf16 v[108:111], v[220:223], v[208:211], v[108:111]
    ds_read_b128 v[180:183], v1 offset:3072
    v_fma_f32 v72, v72, v4, -v6
    v_mfma_f32_16x16x32_bf16 v[112:115], v[224:227], v[204:207], v[112:115]
    ds_read_b128 v[184:187], v1 offset:4096
    v_fma_f32 v73, v73, v5, -v7
    v_mfma_f32_16x16x32_bf16 v[116:119], v[224:227], v[208:211], v[116:119]
    ds_read_b128 v[188:191], v1 offset:5120
    v_mfma_f32_16x16x32_bf16 v[120:123], v[228:231], v[204:207], v[120:123]
    ds_read_b128 v[192:195], v1 offset:6144
    v_fma_f32 v74, v74, v8, -v10
    v_mfma_f32_16x16x32_bf16 v[124:127], v[228:231], v[208:211], v[124:127]
    ds_read_b128 v[196:199], v1 offset:7168
    v_fma_f32 v75, v75, v9, -v11
    v_mfma_f32_16x16x32_bf16 v[128:131], v[232:235], v[204:207], v[128:131]
    ds_read_b128 v[200:203], v1 offset:8192
    v_fma_f32 v76, v76, v12, -v14
    v_mfma_f32_16x16x32_bf16 v[132:135], v[232:235], v[208:211], v[132:135]
    v_fma_f32 v77, v77, v13, -v15
    v_fma_f32 v78, v78, v252, -v254
    v_mfma_f32_16x16x32_bf16 v[136:139], v[236:239], v[204:207], v[136:139]
    v_fma_f32 v79, v79, v253, -v255
    v_permlane32_swap_b32 v64, v66
    v_mfma_f32_16x16x32_bf16 v[140:143], v[236:239], v[208:211], v[140:143]
    v_permlane32_swap_b32 v65, v67
    v_cvt_pk_bf16_f32 v72, v72, v73
    v_mfma_f32_16x16x32_bf16 v[144:147], v[240:243], v[204:207], v[144:147]
    v_cvt_pk_bf16_f32 v73, v74, v75
    v_cvt_pk_bf16_f32 v74, v76, v77
    v_mfma_f32_16x16x32_bf16 v[148:151], v[240:243], v[208:211], v[148:151]
    v_cvt_pk_bf16_f32 v75, v78, v79
    v_permlane16_swap_b32 v64, v66
    v_mfma_f32_16x16x32_bf16 v[152:155], v[244:247], v[204:207], v[152:155]
    v_permlane16_swap_b32 v65, v67
    v_fma_f32 v80, v80, v4, -v6
    v_mfma_f32_16x16x32_bf16 v[156:159], v[244:247], v[208:211], v[156:159]
    v_fma_f32 v81, v81, v5, -v7
    s_waitcnt lgkmcnt(5)
    v_mfma_f32_16x16x32_bf16 v[88:91], v[168:171], v[160:163], v[88:91]
    ds_read_b128 v[204:207], v3 offset:1024
    v_mfma_f32_16x16x32_bf16 v[92:95], v[168:171], v[164:167], v[92:95]
    ds_read_b128 v[208:211], v3 offset:3072
    v_fma_f32 v82, v82, v8, -v10
    v_mfma_f32_16x16x32_bf16 v[96:99], v[172:175], v[160:163], v[96:99]
    ds_read_b128 v[212:215], v1 offset:9216
    buffer_store_dwordx4 v[56:59], v1, s[4:7], s39 offen offset:1024 sc1
    v_fma_f32 v83, v83, v9, -v11
    v_mfma_f32_16x16x32_bf16 v[100:103], v[172:175], v[164:167], v[100:103]
    ds_read_b128 v[216:219], v1 offset:10240
    v_fma_f32 v84, v84, v12, -v14
    v_mfma_f32_16x16x32_bf16 v[104:107], v[176:179], v[160:163], v[104:107]
    ds_read_b128 v[220:223], v1 offset:11264
    v_fma_f32 v85, v85, v13, -v15
    v_mfma_f32_16x16x32_bf16 v[108:111], v[176:179], v[164:167], v[108:111]
    ds_read_b128 v[224:227], v1 offset:12288
    v_fma_f32 v86, v86, v252, -v254
    v_mfma_f32_16x16x32_bf16 v[112:115], v[180:183], v[160:163], v[112:115]
    ds_read_b128 v[228:231], v1 offset:13312
    v_fma_f32 v87, v87, v253, -v255
    v_mfma_f32_16x16x32_bf16 v[116:119], v[180:183], v[164:167], v[116:119]
    ds_read_b128 v[232:235], v1 offset:14336
    s_waitcnt lgkmcnt(8)
    v_mfma_f32_16x16x32_bf16 v[120:123], v[184:187], v[160:163], v[120:123]
    ds_read_b128 v[236:239], v1 offset:15360
    v_permlane32_swap_b32 v72, v74
    v_mfma_f32_16x16x32_bf16 v[124:127], v[184:187], v[164:167], v[124:127]
    ds_read_b128 v[240:243], v1 offset:16384
    v_permlane32_swap_b32 v73, v75
    v_mfma_f32_16x16x32_bf16 v[128:131], v[188:191], v[160:163], v[128:131]
    ds_read_b128 v[244:247], v1 offset:17408
    buffer_store_dwordx4 v[64:67], v1, s[4:7], s39 offen offset:2048 sc1
    v_cvt_pk_bf16_f32 v80, v80, v81
    v_mfma_f32_16x16x32_bf16 v[132:135], v[188:191], v[164:167], v[132:135]
    v_cvt_pk_bf16_f32 v81, v82, v83
    v_cvt_pk_bf16_f32 v82, v84, v85
    v_mfma_f32_16x16x32_bf16 v[136:139], v[192:195], v[160:163], v[136:139]
    v_cvt_pk_bf16_f32 v83, v86, v87
    v_permlane16_swap_b32 v72, v74
    v_mfma_f32_16x16x32_bf16 v[140:143], v[192:195], v[164:167], v[140:143]
    v_permlane16_swap_b32 v73, v75
    s_nop 0
    v_mfma_f32_16x16x32_bf16 v[144:147], v[196:199], v[160:163], v[144:147]
    v_permlane32_swap_b32 v80, v82
    v_permlane32_swap_b32 v81, v83
    v_mfma_f32_16x16x32_bf16 v[148:151], v[196:199], v[164:167], v[148:151]
    s_nop 0
    v_permlane16_swap_b32 v80, v82
    v_mfma_f32_16x16x32_bf16 v[152:155], v[200:203], v[160:163], v[152:155]
    v_permlane16_swap_b32 v81, v83
    v_mul_f32 v4, s40, v249
    v_mfma_f32_16x16x32_bf16 v[156:159], v[200:203], v[164:167], v[156:159]
    v_mul_f32 v6, s40, v251
    s_waitcnt lgkmcnt(0)
    s_barrier
    v_mfma_f32_16x16x32_bf16 v[88:91], v[212:215], v[204:207], v[88:91]
    ds_read_b128 v[160:163], v3 offset:36864
    v_mfma_f32_16x16x32_bf16 v[92:95], v[212:215], v[208:211], v[92:95]
    ds_read_b128 v[164:167], v3 offset:38912
    v_mul_f32 v5, v249, v249
    v_mfma_f32_16x16x32_bf16 v[96:99], v[216:219], v[204:207], v[96:99]
    ds_read_b128 v[168:171], v1 offset:36864
    buffer_store_dwordx4 v[72:75], v1, s[4:7], s39 offen offset:3072 sc1
    v_mul_f32 v7, v251, v251
    v_mfma_f32_16x16x32_bf16 v[100:103], v[216:219], v[208:211], v[100:103]
    ds_read_b128 v[172:175], v1 offset:37888
    v_rcp_f32 v249, v249
    v_mfma_f32_16x16x32_bf16 v[104:107], v[220:223], v[204:207], v[104:107]
    ds_read_b128 v[176:179], v1 offset:38912
    v_rcp_f32 v251, v251
    v_mfma_f32_16x16x32_bf16 v[108:111], v[220:223], v[208:211], v[108:111]
    ds_read_b128 v[180:183], v1 offset:39936
    v_mul_f32 v5, s42, v5
    v_mfma_f32_16x16x32_bf16 v[112:115], v[224:227], v[204:207], v[112:115]
    ds_read_b128 v[184:187], v1 offset:40960
    v_mul_f32 v7, s42, v7
    v_mfma_f32_16x16x32_bf16 v[116:119], v[224:227], v[208:211], v[116:119]
    ds_read_b128 v[188:191], v1 offset:41984
    v_mfma_f32_16x16x32_bf16 v[120:123], v[228:231], v[204:207], v[120:123]
    ds_read_b128 v[192:195], v1 offset:43008
    v_mul_f32 v5, v5, v4
    v_mfma_f32_16x16x32_bf16 v[124:127], v[228:231], v[208:211], v[124:127]
    ds_read_b128 v[196:199], v1 offset:44032
    v_mul_f32 v7, v7, v6
    v_mfma_f32_16x16x32_bf16 v[128:131], v[232:235], v[204:207], v[128:131]
    ds_read_b128 v[200:203], v1 offset:45056
    buffer_store_dwordx4 v[80:83], v1, s[4:7], s46 offen offset:0 sc1
    v_bfe_u32 v13, v1, 4, 4
    v_mfma_f32_16x16x32_bf16 v[132:135], v[232:235], v[208:211], v[132:135]
    v_lshrrev_b32 v8, 1, v13
    v_lshrrev_b32 v9, 8, v1
    v_mfma_f32_16x16x32_bf16 v[136:139], v[236:239], v[204:207], v[136:139]
    v_xor_b32 v8, v8, v9
    v_lshlrev_b32 v8, 4, v8
    v_mfma_f32_16x16x32_bf16 v[140:143], v[236:239], v[208:211], v[140:143]
    v_lshl_add_u32 v8, v13, 7, v8
    s_add_u32 s33, s30, 18432
    v_mfma_f32_16x16x32_bf16 v[144:147], v[240:243], v[204:207], v[144:147]
    v_add_u32 v8, s33, v8
    v_xor_b32 v9, 64, v8
    v_mfma_f32_16x16x32_bf16 v[148:151], v[240:243], v[208:211], v[148:151]
    v_add_u32 v10, 73728, v8
    v_add_u32 v11, 73728, v9
    v_mfma_f32_16x16x32_bf16 v[152:155], v[244:247], v[204:207], v[152:155]
    s_lshl_b32 s33, s20, 6
    s_add_u32 s33, s33, 161280
    v_mfma_f32_16x16x32_bf16 v[156:159], v[244:247], v[208:211], v[156:159]
    v_lshl_add_u32 v13, v13, 1, s33
    s_waitcnt lgkmcnt(5)
    v_mfma_f32_16x16x32_bf16 v[88:91], v[168:171], v[160:163], v[88:91]
    ds_read_b128 v[204:207], v3 offset:37888
    v_mfma_f32_16x16x32_bf16 v[92:95], v[168:171], v[164:167], v[92:95]
    ds_read_b128 v[208:211], v3 offset:39936
    v_mfma_f32_16x16x32_bf16 v[96:99], v[172:175], v[160:163], v[96:99]
    ds_read_b128 v[212:215], v1 offset:46080
    v_mfma_f32_16x16x32_bf16 v[100:103], v[172:175], v[164:167], v[100:103]
    ds_read_b128 v[216:219], v1 offset:47104
    v_mfma_f32_16x16x32_bf16 v[104:107], v[176:179], v[160:163], v[104:107]
    ds_read_b128 v[220:223], v1 offset:48128
    v_mfma_f32_16x16x32_bf16 v[108:111], v[176:179], v[164:167], v[108:111]
    ds_read_b128 v[224:227], v1 offset:49152
    v_mfma_f32_16x16x32_bf16 v[112:115], v[180:183], v[160:163], v[112:115]
    ds_read_b128 v[228:231], v1 offset:50176
    v_mfma_f32_16x16x32_bf16 v[116:119], v[180:183], v[164:167], v[116:119]
    ds_read_b128 v[232:235], v1 offset:51200
    s_waitcnt lgkmcnt(8)
    v_mfma_f32_16x16x32_bf16 v[120:123], v[184:187], v[160:163], v[120:123]
    ds_read_b128 v[236:239], v1 offset:52224
    v_mfma_f32_16x16x32_bf16 v[124:127], v[184:187], v[164:167], v[124:127]
    ds_read_b128 v[240:243], v1 offset:53248
    v_mfma_f32_16x16x32_bf16 v[128:131], v[188:191], v[160:163], v[128:131]
    ds_read_b128 v[244:247], v1 offset:54272
    v_mfma_f32_16x16x32_bf16 v[132:135], v[188:191], v[164:167], v[132:135]
    v_mfma_f32_16x16x32_bf16 v[136:139], v[192:195], v[160:163], v[136:139]
    v_lshrrev_b32 v0, 4, v1
    v_mfma_f32_16x16x32_bf16 v[140:143], v[192:195], v[164:167], v[140:143]
    v_and_b32 v0, 48, v0
    v_mfma_f32_16x16x32_bf16 v[144:147], v[196:199], v[160:163], v[144:147]
    v_add_u32 v0, 160320, v0
    v_mfma_f32_16x16x32_bf16 v[148:151], v[196:199], v[164:167], v[148:151]
    v_mfma_f32_16x16x32_bf16 v[152:155], v[200:203], v[160:163], v[152:155]
    v_mfma_f32_16x16x32_bf16 v[156:159], v[200:203], v[164:167], v[156:159]
    s_waitcnt lgkmcnt(0)
    v_mfma_f32_16x16x32_bf16 v[88:91], v[212:215], v[204:207], v[88:91]
    ds_read_b128 v[168:171], v0 offset:0
    v_mfma_f32_16x16x32_bf16 v[92:95], v[212:215], v[208:211], v[92:95]
    ds_read_b128 v[172:175], v0 offset:64
    v_mfma_f32_16x16x32_bf16 v[96:99], v[216:219], v[204:207], v[96:99]
    ds_read_b128 v[176:179], v0 offset:128
    v_mfma_f32_16x16x32_bf16 v[100:103], v[216:219], v[208:211], v[100:103]
    ds_read_b128 v[180:183], v0 offset:192
    v_mfma_f32_16x16x32_bf16 v[104:107], v[220:223], v[204:207], v[104:107]
    ds_read_b128 v[184:187], v0 offset:256
    v_mfma_f32_16x16x32_bf16 v[108:111], v[220:223], v[208:211], v[108:111]
    ds_read_b128 v[188:191], v0 offset:320
    v_mfma_f32_16x16x32_bf16 v[112:115], v[224:227], v[204:207], v[112:115]
    ds_read_b128 v[192:195], v0 offset:384
    v_mfma_f32_16x16x32_bf16 v[116:119], v[224:227], v[208:211], v[116:119]
    ds_read_b128 v[196:199], v0 offset:448
    v_mfma_f32_16x16x32_bf16 v[120:123], v[228:231], v[204:207], v[120:123]
    ds_read_b128 v[200:203], v0 offset:512
    v_mfma_f32_16x16x32_bf16 v[124:127], v[228:231], v[208:211], v[124:127]
    ds_read_u16 v12, v13
    v_mfma_f32_16x16x32_bf16 v[128:131], v[232:235], v[204:207], v[128:131]
    ds_read_u16 v252, v13 offset:32
    v_mfma_f32_16x16x32_bf16 v[132:135], v[232:235], v[208:211], v[132:135]
    v_mfma_f32_16x16x32_bf16 v[136:139], v[236:239], v[204:207], v[136:139]
    s_lshr_b32 s35, s20, 1
    s_mul_i32 s35, s35, 36864
    v_mfma_f32_16x16x32_bf16 v[140:143], v[236:239], v[208:211], v[140:143]
    s_and_b32 s34, s20, 1
    s_mul_i32 s34, s34, 9216
    v_mfma_f32_16x16x32_bf16 v[144:147], v[240:243], v[204:207], v[144:147]
    s_add_u32 s35, s35, s34
    v_mfma_f32_16x16x32_bf16 v[148:151], v[240:243], v[208:211], v[148:151]
    v_add_u32 v3, s35, v2
    v_mfma_f32_16x16x32_bf16 v[152:155], v[244:247], v[204:207], v[152:155]
    v_mfma_f32_16x16x32_bf16 v[156:159], v[244:247], v[208:211], v[156:159]
    s_waitcnt vmcnt(0)
    s_barrier
    s_waitcnt lgkmcnt(0)
    v_lshlrev_b32 v15, 16, v12
    v_lshlrev_b32 v255, 16, v252
    v_lshlrev_b32 v14, 16, v12
    v_lshlrev_b32 v254, 16, v252
    v_lshlrev_b32 v13, 16, v12
    v_lshlrev_b32 v253, 16, v252
    v_lshlrev_b32 v12, 16, v12
    v_lshlrev_b32 v252, 16, v252
    ds_write_b128 v3, v[16:19] offset:0
    v_pk_fma_f32 v[88:89], v[248:249], v[168:169], v[88:89] op_sel_hi:[0,1,1] neg_lo:[1,0,0] neg_hi:[1,0,0]
    v_pk_fma_f32 v[90:91], v[248:249], v[170:171], v[90:91] op_sel_hi:[0,1,1] neg_lo:[1,0,0] neg_hi:[1,0,0]
    v_pk_fma_f32 v[92:93], v[250:251], v[168:169], v[92:93] op_sel_hi:[0,1,1] neg_lo:[1,0,0] neg_hi:[1,0,0]
    v_pk_fma_f32 v[94:95], v[250:251], v[170:171], v[94:95] op_sel_hi:[0,1,1] neg_lo:[1,0,0] neg_hi:[1,0,0]
    ds_write_b128 v3, v[24:27] offset:1024
    v_pk_fma_f32 v[96:97], v[248:249], v[172:173], v[96:97] op_sel_hi:[0,1,1] neg_lo:[1,0,0] neg_hi:[1,0,0]
    v_pk_fma_f32 v[98:99], v[248:249], v[174:175], v[98:99] op_sel_hi:[0,1,1] neg_lo:[1,0,0] neg_hi:[1,0,0]
    v_pk_fma_f32 v[100:101], v[250:251], v[172:173], v[100:101] op_sel_hi:[0,1,1] neg_lo:[1,0,0] neg_hi:[1,0,0]
    v_pk_fma_f32 v[102:103], v[250:251], v[174:175], v[102:103] op_sel_hi:[0,1,1] neg_lo:[1,0,0] neg_hi:[1,0,0]
    ds_write_b128 v3, v[32:35] offset:2048
    v_pk_fma_f32 v[104:105], v[248:249], v[176:177], v[104:105] op_sel_hi:[0,1,1] neg_lo:[1,0,0] neg_hi:[1,0,0]
    v_pk_fma_f32 v[106:107], v[248:249], v[178:179], v[106:107] op_sel_hi:[0,1,1] neg_lo:[1,0,0] neg_hi:[1,0,0]
    v_pk_fma_f32 v[108:109], v[250:251], v[176:177], v[108:109] op_sel_hi:[0,1,1] neg_lo:[1,0,0] neg_hi:[1,0,0]
    v_pk_fma_f32 v[110:111], v[250:251], v[178:179], v[110:111] op_sel_hi:[0,1,1] neg_lo:[1,0,0] neg_hi:[1,0,0]
    ds_write_b128 v3, v[40:43] offset:3072
    v_pk_fma_f32 v[112:113], v[248:249], v[180:181], v[112:113] op_sel_hi:[0,1,1] neg_lo:[1,0,0] neg_hi:[1,0,0]
    v_pk_fma_f32 v[114:115], v[248:249], v[182:183], v[114:115] op_sel_hi:[0,1,1] neg_lo:[1,0,0] neg_hi:[1,0,0]
    v_pk_fma_f32 v[116:117], v[250:251], v[180:181], v[116:117] op_sel_hi:[0,1,1] neg_lo:[1,0,0] neg_hi:[1,0,0]
    v_pk_fma_f32 v[118:119], v[250:251], v[182:183], v[118:119] op_sel_hi:[0,1,1] neg_lo:[1,0,0] neg_hi:[1,0,0]
    ds_write_b128 v3, v[48:51] offset:4096
    v_pk_fma_f32 v[120:121], v[248:249], v[184:185], v[120:121] op_sel_hi:[0,1,1] neg_lo:[1,0,0] neg_hi:[1,0,0]
    v_pk_fma_f32 v[122:123], v[248:249], v[186:187], v[122:123] op_sel_hi:[0,1,1] neg_lo:[1,0,0] neg_hi:[1,0,0]
    v_pk_fma_f32 v[124:125], v[250:251], v[184:185], v[124:125] op_sel_hi:[0,1,1] neg_lo:[1,0,0] neg_hi:[1,0,0]
    v_pk_fma_f32 v[126:127], v[250:251], v[186:187], v[126:127] op_sel_hi:[0,1,1] neg_lo:[1,0,0] neg_hi:[1,0,0]
    ds_write_b128 v3, v[56:59] offset:5120
    v_pk_fma_f32 v[128:129], v[248:249], v[188:189], v[128:129] op_sel_hi:[0,1,1] neg_lo:[1,0,0] neg_hi:[1,0,0]
    v_pk_fma_f32 v[130:131], v[248:249], v[190:191], v[130:131] op_sel_hi:[0,1,1] neg_lo:[1,0,0] neg_hi:[1,0,0]
    v_pk_fma_f32 v[132:133], v[250:251], v[188:189], v[132:133] op_sel_hi:[0,1,1] neg_lo:[1,0,0] neg_hi:[1,0,0]
    v_pk_fma_f32 v[134:135], v[250:251], v[190:191], v[134:135] op_sel_hi:[0,1,1] neg_lo:[1,0,0] neg_hi:[1,0,0]
    ds_write_b128 v3, v[64:67] offset:6144
    v_pk_fma_f32 v[136:137], v[248:249], v[192:193], v[136:137] op_sel_hi:[0,1,1] neg_lo:[1,0,0] neg_hi:[1,0,0]
    v_pk_fma_f32 v[138:139], v[248:249], v[194:195], v[138:139] op_sel_hi:[0,1,1] neg_lo:[1,0,0] neg_hi:[1,0,0]
    v_pk_fma_f32 v[140:141], v[250:251], v[192:193], v[140:141] op_sel_hi:[0,1,1] neg_lo:[1,0,0] neg_hi:[1,0,0]
    v_pk_fma_f32 v[142:143], v[250:251], v[194:195], v[142:143] op_sel_hi:[0,1,1] neg_lo:[1,0,0] neg_hi:[1,0,0]
    ds_write_b128 v3, v[72:75] offset:7168
    v_pk_fma_f32 v[144:145], v[248:249], v[196:197], v[144:145] op_sel_hi:[0,1,1] neg_lo:[1,0,0] neg_hi:[1,0,0]
    v_pk_fma_f32 v[146:147], v[248:249], v[198:199], v[146:147] op_sel_hi:[0,1,1] neg_lo:[1,0,0] neg_hi:[1,0,0]
    v_pk_fma_f32 v[148:149], v[250:251], v[196:197], v[148:149] op_sel_hi:[0,1,1] neg_lo:[1,0,0] neg_hi:[1,0,0]
    v_pk_fma_f32 v[150:151], v[250:251], v[198:199], v[150:151] op_sel_hi:[0,1,1] neg_lo:[1,0,0] neg_hi:[1,0,0]
    ds_write_b128 v3, v[80:83] offset:8192
    v_pk_fma_f32 v[152:153], v[248:249], v[200:201], v[152:153] op_sel_hi:[0,1,1] neg_lo:[1,0,0] neg_hi:[1,0,0]
    v_pk_fma_f32 v[154:155], v[248:249], v[202:203], v[154:155] op_sel_hi:[0,1,1] neg_lo:[1,0,0] neg_hi:[1,0,0]
    v_pk_fma_f32 v[156:157], v[250:251], v[200:201], v[156:157] op_sel_hi:[0,1,1] neg_lo:[1,0,0] neg_hi:[1,0,0]
    v_pk_fma_f32 v[158:159], v[250:251], v[202:203], v[158:159] op_sel_hi:[0,1,1] neg_lo:[1,0,0] neg_hi:[1,0,0]
    v_pk_mul_f32 v[204:205], v[88:89], v[88:89]
    v_pk_mul_f32 v[206:207], v[90:91], v[90:91]
    v_pk_mul_f32 v[208:209], v[92:93], v[92:93]
    v_pk_mul_f32 v[210:211], v[94:95], v[94:95]
    v_pk_fma_f32 v[204:205], v[204:205], v[4:5], v[4:5] op_sel:[0,1,0] op_sel_hi:[1,1,0]
    v_pk_fma_f32 v[206:207], v[206:207], v[4:5], v[4:5] op_sel:[0,1,0] op_sel_hi:[1,1,0]
    v_pk_fma_f32 v[208:209], v[208:209], v[6:7], v[6:7] op_sel:[0,1,0] op_sel_hi:[1,1,0]
    v_pk_fma_f32 v[210:211], v[210:211], v[6:7], v[6:7] op_sel:[0,1,0] op_sel_hi:[1,1,0]
    v_pk_mul_f32 v[204:205], v[204:205], v[88:89]
    v_pk_mul_f32 v[206:207], v[206:207], v[90:91]
    v_pk_mul_f32 v[208:209], v[208:209], v[92:93]
    v_pk_mul_f32 v[210:211], v[210:211], v[94:95]
    v_exp_f32 v204, v204
    v_exp_f32 v205, v205
    v_exp_f32 v206, v206
    v_exp_f32 v207, v207
    v_exp_f32 v208, v208
    v_exp_f32 v209, v209
    v_exp_f32 v210, v210
    v_exp_f32 v211, v211
    v_pk_fma_f32 v[204:205], v[204:205], v[248:249], v[248:249] op_sel:[0,1,1] op_sel_hi:[1,1,1]
    v_pk_fma_f32 v[206:207], v[206:207], v[248:249], v[248:249] op_sel:[0,1,1] op_sel_hi:[1,1,1]
    v_pk_fma_f32 v[208:209], v[208:209], v[250:251], v[250:251] op_sel:[0,1,1] op_sel_hi:[1,1,1]
    v_pk_fma_f32 v[210:211], v[210:211], v[250:251], v[250:251] op_sel:[0,1,1] op_sel_hi:[1,1,1]
    v_rcp_f32 v204, v204
    v_rcp_f32 v205, v205
    v_rcp_f32 v206, v206
    v_rcp_f32 v207, v207
    v_rcp_f32 v208, v208
    v_rcp_f32 v209, v209
    v_rcp_f32 v210, v210
    v_rcp_f32 v211, v211
    v_pk_mul_f32 v[88:89], v[88:89], v[204:205]
    v_pk_mul_f32 v[90:91], v[90:91], v[206:207]
    v_pk_mul_f32 v[92:93], v[92:93], v[208:209]
    v_pk_mul_f32 v[94:95], v[94:95], v[210:211]
    v_pk_mul_f32 v[212:213], v[96:97], v[96:97]
    v_pk_mul_f32 v[214:215], v[98:99], v[98:99]
    v_pk_mul_f32 v[216:217], v[100:101], v[100:101]
    v_pk_mul_f32 v[218:219], v[102:103], v[102:103]
    v_pk_fma_f32 v[212:213], v[212:213], v[4:5], v[4:5] op_sel:[0,1,0] op_sel_hi:[1,1,0]
    v_pk_fma_f32 v[214:215], v[214:215], v[4:5], v[4:5] op_sel:[0,1,0] op_sel_hi:[1,1,0]
    v_pk_fma_f32 v[216:217], v[216:217], v[6:7], v[6:7] op_sel:[0,1,0] op_sel_hi:[1,1,0]
    v_pk_fma_f32 v[218:219], v[218:219], v[6:7], v[6:7] op_sel:[0,1,0] op_sel_hi:[1,1,0]
    v_pk_mul_f32 v[212:213], v[212:213], v[96:97]
    v_pk_mul_f32 v[214:215], v[214:215], v[98:99]
    v_pk_mul_f32 v[216:217], v[216:217], v[100:101]
    v_pk_mul_f32 v[218:219], v[218:219], v[102:103]
    v_exp_f32 v212, v212
    v_exp_f32 v213, v213
    v_exp_f32 v214, v214
    v_exp_f32 v215, v215
    v_exp_f32 v216, v216
    v_exp_f32 v217, v217
    v_exp_f32 v218, v218
    v_exp_f32 v219, v219
    v_pk_fma_f32 v[212:213], v[212:213], v[248:249], v[248:249] op_sel:[0,1,1] op_sel_hi:[1,1,1]
    v_pk_fma_f32 v[214:215], v[214:215], v[248:249], v[248:249] op_sel:[0,1,1] op_sel_hi:[1,1,1]
    v_pk_fma_f32 v[216:217], v[216:217], v[250:251], v[250:251] op_sel:[0,1,1] op_sel_hi:[1,1,1]
    v_pk_fma_f32 v[218:219], v[218:219], v[250:251], v[250:251] op_sel:[0,1,1] op_sel_hi:[1,1,1]
    v_rcp_f32 v212, v212
    v_rcp_f32 v213, v213
    v_rcp_f32 v214, v214
    v_rcp_f32 v215, v215
    v_rcp_f32 v216, v216
    v_rcp_f32 v217, v217
    v_rcp_f32 v218, v218
    v_rcp_f32 v219, v219
    v_pk_mul_f32 v[96:97], v[96:97], v[212:213]
    v_pk_mul_f32 v[98:99], v[98:99], v[214:215]
    v_pk_mul_f32 v[100:101], v[100:101], v[216:217]
    v_pk_mul_f32 v[102:103], v[102:103], v[218:219]
    v_pk_mul_f32 v[204:205], v[104:105], v[104:105]
    v_pk_mul_f32 v[206:207], v[106:107], v[106:107]
    v_pk_mul_f32 v[208:209], v[108:109], v[108:109]
    v_pk_mul_f32 v[210:211], v[110:111], v[110:111]
    v_pk_fma_f32 v[204:205], v[204:205], v[4:5], v[4:5] op_sel:[0,1,0] op_sel_hi:[1,1,0]
    v_pk_fma_f32 v[206:207], v[206:207], v[4:5], v[4:5] op_sel:[0,1,0] op_sel_hi:[1,1,0]
    v_pk_fma_f32 v[208:209], v[208:209], v[6:7], v[6:7] op_sel:[0,1,0] op_sel_hi:[1,1,0]
    v_pk_fma_f32 v[210:211], v[210:211], v[6:7], v[6:7] op_sel:[0,1,0] op_sel_hi:[1,1,0]
    v_pk_mul_f32 v[204:205], v[204:205], v[104:105]
    v_pk_mul_f32 v[206:207], v[206:207], v[106:107]
    v_pk_mul_f32 v[208:209], v[208:209], v[108:109]
    v_pk_mul_f32 v[210:211], v[210:211], v[110:111]
    v_exp_f32 v204, v204
    v_exp_f32 v205, v205
    v_exp_f32 v206, v206
    v_exp_f32 v207, v207
    v_exp_f32 v208, v208
    v_exp_f32 v209, v209
    v_exp_f32 v210, v210
    v_exp_f32 v211, v211
    v_pk_fma_f32 v[204:205], v[204:205], v[248:249], v[248:249] op_sel:[0,1,1] op_sel_hi:[1,1,1]
    v_pk_fma_f32 v[206:207], v[206:207], v[248:249], v[248:249] op_sel:[0,1,1] op_sel_hi:[1,1,1]
    v_pk_fma_f32 v[208:209], v[208:209], v[250:251], v[250:251] op_sel:[0,1,1] op_sel_hi:[1,1,1]
    v_pk_fma_f32 v[210:211], v[210:211], v[250:251], v[250:251] op_sel:[0,1,1] op_sel_hi:[1,1,1]
    v_rcp_f32 v204, v204
    v_rcp_f32 v205, v205
    v_rcp_f32 v206, v206
    v_rcp_f32 v207, v207
    v_rcp_f32 v208, v208
    v_rcp_f32 v209, v209
    v_rcp_f32 v210, v210
    v_rcp_f32 v211, v211
    v_pk_mul_f32 v[104:105], v[104:105], v[204:205]
    v_pk_mul_f32 v[106:107], v[106:107], v[206:207]
    v_pk_mul_f32 v[108:109], v[108:109], v[208:209]
    v_pk_mul_f32 v[110:111], v[110:111], v[210:211]
    s_waitcnt lgkmcnt(0)
    s_barrier
    ds_read_b128 v[160:163], v10 offset:0
    ds_read_b128 v[164:167], v10 offset:2048
    ds_read_b128 v[168:171], v2 offset:0
    ds_read_b128 v[172:175], v2 offset:1024
    ds_read_b128 v[176:179], v2 offset:2048
    ds_read_b128 v[180:183], v2 offset:3072
    ds_read_b128 v[184:187], v2 offset:4096
    ds_read_b128 v[188:191], v2 offset:5120
    ds_read_b128 v[192:195], v2 offset:6144
    ds_read_b128 v[196:199], v2 offset:7168
    ds_read_b128 v[200:203], v2 offset:8192
    v_pk_mul_f32 v[212:213], v[112:113], v[112:113]
    v_pk_mul_f32 v[214:215], v[114:115], v[114:115]
    v_pk_mul_f32 v[216:217], v[116:117], v[116:117]
    v_pk_mul_f32 v[218:219], v[118:119], v[118:119]
    v_pk_fma_f32 v[212:213], v[212:213], v[4:5], v[4:5] op_sel:[0,1,0] op_sel_hi:[1,1,0]
    v_pk_fma_f32 v[214:215], v[214:215], v[4:5], v[4:5] op_sel:[0,1,0] op_sel_hi:[1,1,0]
    v_pk_fma_f32 v[216:217], v[216:217], v[6:7], v[6:7] op_sel:[0,1,0] op_sel_hi:[1,1,0]
    v_pk_fma_f32 v[218:219], v[218:219], v[6:7], v[6:7] op_sel:[0,1,0] op_sel_hi:[1,1,0]
    v_pk_mul_f32 v[212:213], v[212:213], v[112:113]
    v_pk_mul_f32 v[214:215], v[214:215], v[114:115]
    v_pk_mul_f32 v[216:217], v[216:217], v[116:117]
    v_pk_mul_f32 v[218:219], v[218:219], v[118:119]
    v_exp_f32 v212, v212
    v_exp_f32 v213, v213
    v_exp_f32 v214, v214
    v_exp_f32 v215, v215
    v_exp_f32 v216, v216
    v_exp_f32 v217, v217
    v_exp_f32 v218, v218
    v_exp_f32 v219, v219
    v_pk_fma_f32 v[212:213], v[212:213], v[248:249], v[248:249] op_sel:[0,1,1] op_sel_hi:[1,1,1]
    v_pk_fma_f32 v[214:215], v[214:215], v[248:249], v[248:249] op_sel:[0,1,1] op_sel_hi:[1,1,1]
    v_pk_fma_f32 v[216:217], v[216:217], v[250:251], v[250:251] op_sel:[0,1,1] op_sel_hi:[1,1,1]
    v_pk_fma_f32 v[218:219], v[218:219], v[250:251], v[250:251] op_sel:[0,1,1] op_sel_hi:[1,1,1]
    v_rcp_f32 v212, v212
    v_rcp_f32 v213, v213
    v_rcp_f32 v214, v214
    v_rcp_f32 v215, v215
    v_rcp_f32 v216, v216
    v_rcp_f32 v217, v217
    v_rcp_f32 v218, v218
    v_rcp_f32 v219, v219
    v_pk_mul_f32 v[112:113], v[112:113], v[212:213]
    v_pk_mul_f32 v[114:115], v[114:115], v[214:215]
    v_pk_mul_f32 v[116:117], v[116:117], v[216:217]
    v_pk_mul_f32 v[118:119], v[118:119], v[218:219]
    s_waitcnt lgkmcnt(5)
    v_mfma_f32_16x16x32_bf16 v[16:19], v[168:171], v[160:163], v[12:15]
    ds_read_b128 v[204:207], v11 offset:0
    v_mfma_f32_16x16x32_bf16 v[20:23], v[168:171], v[164:167], v[252:255]
    ds_read_b128 v[208:211], v11 offset:2048
    v_mfma_f32_16x16x32_bf16 v[24:27], v[172:175], v[160:163], v[12:15]
    ds_read_b128 v[212:215], v2 offset:9216
    v_mfma_f32_16x16x32_bf16 v[28:31], v[172:175], v[164:167], v[252:255]
    ds_read_b128 v[216:219], v2 offset:10240
    v_mfma_f32_16x16x32_bf16 v[32:35], v[176:179], v[160:163], v[12:15]
    ds_read_b128 v[220:223], v2 offset:11264
    v_mfma_f32_16x16x32_bf16 v[36:39], v[176:179], v[164:167], v[252:255]
    ds_read_b128 v[224:227], v2 offset:12288
    v_mfma_f32_16x16x32_bf16 v[40:43], v[180:183], v[160:163], v[12:15]
    ds_read_b128 v[228:231], v2 offset:13312
    v_mfma_f32_16x16x32_bf16 v[44:47], v[180:183], v[164:167], v[252:255]
    ds_read_b128 v[232:235], v2 offset:14336
    s_waitcnt lgkmcnt(8)
    v_mfma_f32_16x16x32_bf16 v[48:51], v[184:187], v[160:163], v[12:15]
    ds_read_b128 v[236:239], v2 offset:15360
    v_mfma_f32_16x16x32_bf16 v[52:55], v[184:187], v[164:167], v[252:255]
    ds_read_b128 v[240:243], v2 offset:16384
    v_mfma_f32_16x16x32_bf16 v[56:59], v[188:191], v[160:163], v[12:15]
    ds_read_b128 v[244:247], v2 offset:17408
    v_mfma_f32_16x16x32_bf16 v[60:63], v[188:191], v[164:167], v[252:255]
    v_mfma_f32_16x16x32_bf16 v[64:67], v[192:195], v[160:163], v[12:15]
    v_mfma_f32_16x16x32_bf16 v[68:71], v[192:195], v[164:167], v[252:255]
    v_mfma_f32_16x16x32_bf16 v[72:75], v[196:199], v[160:163], v[12:15]
    v_mfma_f32_16x16x32_bf16 v[76:79], v[196:199], v[164:167], v[252:255]
    v_mfma_f32_16x16x32_bf16 v[80:83], v[200:203], v[160:163], v[12:15]
    v_mfma_f32_16x16x32_bf16 v[84:87], v[200:203], v[164:167], v[252:255]
    s_waitcnt lgkmcnt(0)
    s_barrier
    v_mfma_f32_16x16x32_bf16 v[16:19], v[212:215], v[204:207], v[16:19]
    ds_read_b128 v[160:163], v10 offset:36864
    v_mfma_f32_16x16x32_bf16 v[20:23], v[212:215], v[208:211], v[20:23]
    ds_read_b128 v[164:167], v10 offset:38912
    v_mfma_f32_16x16x32_bf16 v[24:27], v[216:219], v[204:207], v[24:27]
    ds_read_b128 v[168:171], v2 offset:36864
    v_mfma_f32_16x16x32_bf16 v[28:31], v[216:219], v[208:211], v[28:31]
    ds_read_b128 v[172:175], v2 offset:37888
    v_mul_f32 v12, v120, v120
    v_mfma_f32_16x16x32_bf16 v[32:35], v[220:223], v[204:207], v[32:35]
    ds_read_b128 v[176:179], v2 offset:38912
    v_mul_f32 v13, v121, v121
    v_mfma_f32_16x16x32_bf16 v[36:39], v[220:223], v[208:211], v[36:39]
    ds_read_b128 v[180:183], v2 offset:39936
    v_mul_f32 v14, v122, v122
    v_mfma_f32_16x16x32_bf16 v[40:43], v[224:227], v[204:207], v[40:43]
    ds_read_b128 v[184:187], v2 offset:40960
    v_mul_f32 v15, v123, v123
    v_mfma_f32_16x16x32_bf16 v[44:47], v[224:227], v[208:211], v[44:47]
    ds_read_b128 v[188:191], v2 offset:41984
    v_mfma_f32_16x16x32_bf16 v[48:51], v[228:231], v[204:207], v[48:51]
    ds_read_b128 v[192:195], v2 offset:43008
    v_mul_f32 v252, v124, v124
    v_mfma_f32_16x16x32_bf16 v[52:55], v[228:231], v[208:211], v[52:55]
    ds_read_b128 v[196:199], v2 offset:44032
    v_mul_f32 v253, v125, v125
    v_mfma_f32_16x16x32_bf16 v[56:59], v[232:235], v[204:207], v[56:59]
    ds_read_b128 v[200:203], v2 offset:45056
    v_mul_f32 v254, v126, v126
    v_mfma_f32_16x16x32_bf16 v[60:63], v[232:235], v[208:211], v[60:63]
    v_mul_f32 v255, v127, v127
    v_fma_f32 v12, v12, v5, v4
    v_mfma_f32_16x16x32_bf16 v[64:67], v[236:239], v[204:207], v[64:67]
    v_fma_f32 v13, v13, v5, v4
    v_fma_f32 v14, v14, v5, v4
    v_mfma_f32_16x16x32_bf16 v[68:71], v[236:239], v[208:211], v[68:71]
    v_fma_f32 v15, v15, v5, v4
    v_fma_f32 v252, v252, v7, v6
    v_mfma_f32_16x16x32_bf16 v[72:75], v[240:243], v[204:207], v[72:75]
    v_fma_f32 v253, v253, v7, v6
    v_fma_f32 v254, v254, v7, v6
    v_mfma_f32_16x16x32_bf16 v[76:79], v[240:243], v[208:211], v[76:79]
    v_fma_f32 v255, v255, v7, v6
    v_mul_f32 v12, v12, v120
    v_mfma_f32_16x16x32_bf16 v[80:83], v[244:247], v[204:207], v[80:83]
    v_mul_f32 v13, v13, v121
    v_mul_f32 v14, v14, v122
    v_mfma_f32_16x16x32_bf16 v[84:87], v[244:247], v[208:211], v[84:87]
    v_mul_f32 v15, v15, v123
    s_waitcnt lgkmcnt(5)
    v_mfma_f32_16x16x32_bf16 v[16:19], v[168:171], v[160:163], v[16:19]
    ds_read_b128 v[204:207], v11 offset:36864
    v_mfma_f32_16x16x32_bf16 v[20:23], v[168:171], v[164:167], v[20:23]
    ds_read_b128 v[208:211], v11 offset:38912
    v_mul_f32 v252, v252, v124
    v_mfma_f32_16x16x32_bf16 v[24:27], v[172:175], v[160:163], v[24:27]
    ds_read_b128 v[212:215], v2 offset:46080
    v_mul_f32 v253, v253, v125
    v_mfma_f32_16x16x32_bf16 v[28:31], v[172:175], v[164:167], v[28:31]
    ds_read_b128 v[216:219], v2 offset:47104
    v_mul_f32 v254, v254, v126
    v_mfma_f32_16x16x32_bf16 v[32:35], v[176:179], v[160:163], v[32:35]
    ds_read_b128 v[220:223], v2 offset:48128
    v_mul_f32 v255, v255, v127
    v_mfma_f32_16x16x32_bf16 v[36:39], v[176:179], v[164:167], v[36:39]
    ds_read_b128 v[224:227], v2 offset:49152
    v_exp_f32 v12, v12
    v_mfma_f32_16x16x32_bf16 v[40:43], v[180:183], v[160:163], v[40:43]
    ds_read_b128 v[228:231], v2 offset:50176
    v_exp_f32 v13, v13
    v_mfma_f32_16x16x32_bf16 v[44:47], v[180:183], v[164:167], v[44:47]
    ds_read_b128 v[232:235], v2 offset:51200
    s_waitcnt lgkmcnt(8)
    v_mfma_f32_16x16x32_bf16 v[48:51], v[184:187], v[160:163], v[48:51]
    ds_read_b128 v[236:239], v2 offset:52224
    v_exp_f32 v14, v14
    v_mfma_f32_16x16x32_bf16 v[52:55], v[184:187], v[164:167], v[52:55]
    ds_read_b128 v[240:243], v2 offset:53248
    v_exp_f32 v15, v15
    v_mfma_f32_16x16x32_bf16 v[56:59], v[188:191], v[160:163], v[56:59]
    ds_read_b128 v[244:247], v2 offset:54272
    v_exp_f32 v252, v252
    v_mfma_f32_16x16x32_bf16 v[60:63], v[188:191], v[164:167], v[60:63]
    v_exp_f32 v253, v253
    v_mfma_f32_16x16x32_bf16 v[64:67], v[192:195], v[160:163], v[64:67]
    v_exp_f32 v254, v254
    v_mfma_f32_16x16x32_bf16 v[68:71], v[192:195], v[164:167], v[68:71]
    v_exp_f32 v255, v255
    v_mfma_f32_16x16x32_bf16 v[72:75], v[196:199], v[160:163], v[72:75]
    v_fma_f32 v12, v12, v249, v249
    v_fma_f32 v13, v13, v249, v249
    v_mfma_f32_16x16x32_bf16 v[76:79], v[196:199], v[164:167], v[76:79]
    v_fma_f32 v14, v14, v249, v249
    v_fma_f32 v15, v15, v249, v249
    v_mfma_f32_16x16x32_bf16 v[80:83], v[200:203], v[160:163], v[80:83]
    v_fma_f32 v252, v252, v251, v251
    v_fma_f32 v253, v253, v251, v251
    v_mfma_f32_16x16x32_bf16 v[84:87], v[200:203], v[164:167], v[84:87]
    v_fma_f32 v254, v254, v251, v251
    s_waitcnt lgkmcnt(0)
    s_barrier
    v_mfma_f32_16x16x32_bf16 v[16:19], v[212:215], v[204:207], v[16:19]
    ds_read_b128 v[160:163], v8 offset:0
    v_mfma_f32_16x16x32_bf16 v[20:23], v[212:215], v[208:211], v[20:23]
    ds_read_b128 v[164:167], v8 offset:2048
    v_fma_f32 v255, v255, v251, v251
    v_mfma_f32_16x16x32_bf16 v[24:27], v[216:219], v[204:207], v[24:27]
    ds_read_b128 v[168:171], v1 offset:0
    v_rcp_f32 v12, v12
    v_mfma_f32_16x16x32_bf16 v[28:31], v[216:219], v[208:211], v[28:31]
    ds_read_b128 v[172:175], v1 offset:1024
    v_rcp_f32 v13, v13
    v_mfma_f32_16x16x32_bf16 v[32:35], v[220:223], v[204:207], v[32:35]
    ds_read_b128 v[176:179], v1 offset:2048
    v_rcp_f32 v14, v14
    v_mfma_f32_16x16x32_bf16 v[36:39], v[220:223], v[208:211], v[36:39]
    ds_read_b128 v[180:183], v1 offset:3072
    v_rcp_f32 v15, v15
    v_mfma_f32_16x16x32_bf16 v[40:43], v[224:227], v[204:207], v[40:43]
    ds_read_b128 v[184:187], v1 offset:4096
    v_rcp_f32 v252, v252
    v_mfma_f32_16x16x32_bf16 v[44:47], v[224:227], v[208:211], v[44:47]
    ds_read_b128 v[188:191], v1 offset:5120
    v_mfma_f32_16x16x32_bf16 v[48:51], v[228:231], v[204:207], v[48:51]
    ds_read_b128 v[192:195], v1 offset:6144
    v_rcp_f32 v253, v253
    v_mfma_f32_16x16x32_bf16 v[52:55], v[228:231], v[208:211], v[52:55]
    ds_read_b128 v[196:199], v1 offset:7168
    v_rcp_f32 v254, v254
    v_mfma_f32_16x16x32_bf16 v[56:59], v[232:235], v[204:207], v[56:59]
    ds_read_b128 v[200:203], v1 offset:8192
    v_rcp_f32 v255, v255
    v_mfma_f32_16x16x32_bf16 v[60:63], v[232:235], v[208:211], v[60:63]
    v_mul_f32 v120, v120, v12
    v_mul_f32 v121, v121, v13
    v_mfma_f32_16x16x32_bf16 v[64:67], v[236:239], v[204:207], v[64:67]
    v_mul_f32 v122, v122, v14
    v_mul_f32 v123, v123, v15
    v_mfma_f32_16x16x32_bf16 v[68:71], v[236:239], v[208:211], v[68:71]
    v_mul_f32 v124, v124, v252
    v_mul_f32 v125, v125, v253
    v_mfma_f32_16x16x32_bf16 v[72:75], v[240:243], v[204:207], v[72:75]
    v_mul_f32 v126, v126, v254
    v_mul_f32 v127, v127, v255
    v_mfma_f32_16x16x32_bf16 v[76:79], v[240:243], v[208:211], v[76:79]
    v_mul_f32 v12, v128, v128
    v_mul_f32 v13, v129, v129
    v_mfma_f32_16x16x32_bf16 v[80:83], v[244:247], v[204:207], v[80:83]
    v_mul_f32 v14, v130, v130
    v_mul_f32 v15, v131, v131
    v_mfma_f32_16x16x32_bf16 v[84:87], v[244:247], v[208:211], v[84:87]
    v_mul_f32 v252, v132, v132
    s_waitcnt lgkmcnt(5)
    v_mfma_f32_16x16x32_bf16 v[16:19], v[168:171], v[160:163], v[16:19]
    ds_read_b128 v[204:207], v9 offset:0
    v_mfma_f32_16x16x32_bf16 v[20:23], v[168:171], v[164:167], v[20:23]
    ds_read_b128 v[208:211], v9 offset:2048
    v_mul_f32 v253, v133, v133
    v_mfma_f32_16x16x32_bf16 v[24:27], v[172:175], v[160:163], v[24:27]
    ds_read_b128 v[212:215], v1 offset:9216
    v_mul_f32 v254, v134, v134
    v_mfma_f32_16x16x32_bf16 v[28:31], v[172:175], v[164:167], v[28:31]
    ds_read_b128 v[216:219], v1 offset:10240
    v_mul_f32 v255, v135, v135
    v_mfma_f32_16x16x32_bf16 v[32:35], v[176:179], v[160:163], v[32:35]
    ds_read_b128 v[220:223], v1 offset:11264
    v_fma_f32 v12, v12, v5, v4
    v_mfma_f32_16x16x32_bf16 v[36:39], v[176:179], v[164:167], v[36:39]
    ds_read_b128 v[224:227], v1 offset:12288
    v_fma_f32 v13, v13, v5, v4
    v_mfma_f32_16x16x32_bf16 v[40:43], v[180:183], v[160:163], v[40:43]
    ds_read_b128 v[228:231], v1 offset:13312
    v_fma_f32 v14, v14, v5, v4
    v_mfma_f32_16x16x32_bf16 v[44:47], v[180:183], v[164:167], v[44:47]
    ds_read_b128 v[232:235], v1 offset:14336
    s_waitcnt lgkmcnt(8)
    v_mfma_f32_16x16x32_bf16 v[48:51], v[184:187], v[160:163], v[48:51]
    ds_read_b128 v[236:239], v1 offset:15360
    v_fma_f32 v15, v15, v5, v4
    v_mfma_f32_16x16x32_bf16 v[52:55], v[184:187], v[164:167], v[52:55]
    ds_read_b128 v[240:243], v1 offset:16384
    v_fma_f32 v252, v252, v7, v6
    v_mfma_f32_16x16x32_bf16 v[56:59], v[188:191], v[160:163], v[56:59]
    ds_read_b128 v[244:247], v1 offset:17408
    v_fma_f32 v253, v253, v7, v6
    v_mfma_f32_16x16x32_bf16 v[60:63], v[188:191], v[164:167], v[60:63]
    v_fma_f32 v254, v254, v7, v6
    v_fma_f32 v255, v255, v7, v6
    v_mfma_f32_16x16x32_bf16 v[64:67], v[192:195], v[160:163], v[64:67]
    v_mul_f32 v12, v12, v128
    v_mul_f32 v13, v13, v129
    v_mfma_f32_16x16x32_bf16 v[68:71], v[192:195], v[164:167], v[68:71]
    v_mul_f32 v14, v14, v130
    v_mul_f32 v15, v15, v131
    v_mfma_f32_16x16x32_bf16 v[72:75], v[196:199], v[160:163], v[72:75]
    v_mul_f32 v252, v252, v132
    v_mul_f32 v253, v253, v133
    v_mfma_f32_16x16x32_bf16 v[76:79], v[196:199], v[164:167], v[76:79]
    v_mul_f32 v254, v254, v134
    v_mul_f32 v255, v255, v135
    v_mfma_f32_16x16x32_bf16 v[80:83], v[200:203], v[160:163], v[80:83]
    v_exp_f32 v12, v12
    v_mfma_f32_16x16x32_bf16 v[84:87], v[200:203], v[164:167], v[84:87]
    v_exp_f32 v13, v13
    s_waitcnt lgkmcnt(0)
    s_barrier
    v_mfma_f32_16x16x32_bf16 v[16:19], v[212:215], v[204:207], v[16:19]
    ds_read_b128 v[160:163], v8 offset:36864
    v_mfma_f32_16x16x32_bf16 v[20:23], v[212:215], v[208:211], v[20:23]
    ds_read_b128 v[164:167], v8 offset:38912
    v_exp_f32 v14, v14
    v_mfma_f32_16x16x32_bf16 v[24:27], v[216:219], v[204:207], v[24:27]
    ds_read_b128 v[168:171], v1 offset:36864
    v_exp_f32 v15, v15
    v_mfma_f32_16x16x32_bf16 v[28:31], v[216:219], v[208:211], v[28:31]
    ds_read_b128 v[172:175], v1 offset:37888
    v_exp_f32 v252, v252
    v_mfma_f32_16x16x32_bf16 v[32:35], v[220:223], v[204:207], v[32:35]
    ds_read_b128 v[176:179], v1 offset:38912
    v_exp_f32 v253, v253
    v_mfma_f32_16x16x32_bf16 v[36:39], v[220:223], v[208:211], v[36:39]
    ds_read_b128 v[180:183], v1 offset:39936
    v_exp_f32 v254, v254
    v_mfma_f32_16x16x32_bf16 v[40:43], v[224:227], v[204:207], v[40:43]
    ds_read_b128 v[184:187], v1 offset:40960
    v_exp_f32 v255, v255
    v_mfma_f32_16x16x32_bf16 v[44:47], v[224:227], v[208:211], v[44:47]
    ds_read_b128 v[188:191], v1 offset:41984
    v_mfma_f32_16x16x32_bf16 v[48:51], v[228:231], v[204:207], v[48:51]
    ds_read_b128 v[192:195], v1 offset:43008
    v_fma_f32 v12, v12, v249, v249
    v_mfma_f32_16x16x32_bf16 v[52:55], v[228:231], v[208:211], v[52:55]
    ds_read_b128 v[196:199], v1 offset:44032
    v_fma_f32 v13, v13, v249, v249
    v_mfma_f32_16x16x32_bf16 v[56:59], v[232:235], v[204:207], v[56:59]
    ds_read_b128 v[200:203], v1 offset:45056
    v_fma_f32 v14, v14, v249, v249
    v_mfma_f32_16x16x32_bf16 v[60:63], v[232:235], v[208:211], v[60:63]
    v_fma_f32 v15, v15, v249, v249
    v_fma_f32 v252, v252, v251, v251
    v_mfma_f32_16x16x32_bf16 v[64:67], v[236:239], v[204:207], v[64:67]
    v_fma_f32 v253, v253, v251, v251
    v_fma_f32 v254, v254, v251, v251
    v_mfma_f32_16x16x32_bf16 v[68:71], v[236:239], v[208:211], v[68:71]
    v_fma_f32 v255, v255, v251, v251
    v_rcp_f32 v12, v12
    v_mfma_f32_16x16x32_bf16 v[72:75], v[240:243], v[204:207], v[72:75]
    v_rcp_f32 v13, v13
    v_mfma_f32_16x16x32_bf16 v[76:79], v[240:243], v[208:211], v[76:79]
    v_rcp_f32 v14, v14
    v_mfma_f32_16x16x32_bf16 v[80:83], v[244:247], v[204:207], v[80:83]
    v_rcp_f32 v15, v15
    v_mfma_f32_16x16x32_bf16 v[84:87], v[244:247], v[208:211], v[84:87]
    v_rcp_f32 v252, v252
    s_waitcnt lgkmcnt(5)
    v_mfma_f32_16x16x32_bf16 v[16:19], v[168:171], v[160:163], v[16:19]
    ds_read_b128 v[204:207], v9 offset:36864
    v_mfma_f32_16x16x32_bf16 v[20:23], v[168:171], v[164:167], v[20:23]
    ds_read_b128 v[208:211], v9 offset:38912
    v_rcp_f32 v253, v253
    v_mfma_f32_16x16x32_bf16 v[24:27], v[172:175], v[160:163], v[24:27]
    ds_read_b128 v[212:215], v1 offset:46080
    v_rcp_f32 v254, v254
    v_mfma_f32_16x16x32_bf16 v[28:31], v[172:175], v[164:167], v[28:31]
    ds_read_b128 v[216:219], v1 offset:47104
    v_rcp_f32 v255, v255
    v_mfma_f32_16x16x32_bf16 v[32:35], v[176:179], v[160:163], v[32:35]
    ds_read_b128 v[220:223], v1 offset:48128
    v_mul_f32 v128, v128, v12
    v_mfma_f32_16x16x32_bf16 v[36:39], v[176:179], v[164:167], v[36:39]
    ds_read_b128 v[224:227], v1 offset:49152
    v_mul_f32 v129, v129, v13
    v_mfma_f32_16x16x32_bf16 v[40:43], v[180:183], v[160:163], v[40:43]
    ds_read_b128 v[228:231], v1 offset:50176
    v_mul_f32 v130, v130, v14
    v_mfma_f32_16x16x32_bf16 v[44:47], v[180:183], v[164:167], v[44:47]
    ds_read_b128 v[232:235], v1 offset:51200
    s_waitcnt lgkmcnt(8)
    v_mfma_f32_16x16x32_bf16 v[48:51], v[184:187], v[160:163], v[48:51]
    ds_read_b128 v[236:239], v1 offset:52224
    v_mul_f32 v131, v131, v15
    v_mfma_f32_16x16x32_bf16 v[52:55], v[184:187], v[164:167], v[52:55]
    ds_read_b128 v[240:243], v1 offset:53248
    v_mul_f32 v132, v132, v252
    v_mfma_f32_16x16x32_bf16 v[56:59], v[188:191], v[160:163], v[56:59]
    ds_read_b128 v[244:247], v1 offset:54272
    v_mul_f32 v133, v133, v253
    v_mfma_f32_16x16x32_bf16 v[60:63], v[188:191], v[164:167], v[60:63]
    v_mul_f32 v134, v134, v254
    v_mul_f32 v135, v135, v255
    v_mfma_f32_16x16x32_bf16 v[64:67], v[192:195], v[160:163], v[64:67]
    v_mul_f32 v12, v136, v136
    v_mul_f32 v13, v137, v137
    v_mfma_f32_16x16x32_bf16 v[68:71], v[192:195], v[164:167], v[68:71]
    v_mul_f32 v14, v138, v138
    v_mul_f32 v15, v139, v139
    v_mfma_f32_16x16x32_bf16 v[72:75], v[196:199], v[160:163], v[72:75]
    v_mul_f32 v252, v140, v140
    v_mul_f32 v253, v141, v141
    v_mfma_f32_16x16x32_bf16 v[76:79], v[196:199], v[164:167], v[76:79]
    v_mul_f32 v254, v142, v142
    v_mul_f32 v255, v143, v143
    v_mfma_f32_16x16x32_bf16 v[80:83], v[200:203], v[160:163], v[80:83]
    v_fma_f32 v12, v12, v5, v4
    v_fma_f32 v13, v13, v5, v4
    v_mfma_f32_16x16x32_bf16 v[84:87], v[200:203], v[164:167], v[84:87]
    v_fma_f32 v14, v14, v5, v4
    s_waitcnt lgkmcnt(0)
    s_barrier
    v_mfma_f32_16x16x32_bf16 v[16:19], v[212:215], v[204:207], v[16:19]
    ds_read_b128 v[160:163], v10 offset:0
    v_mfma_f32_16x16x32_bf16 v[20:23], v[212:215], v[208:211], v[20:23]
    ds_read_b128 v[164:167], v10 offset:2048
    v_fma_f32 v15, v15, v5, v4
    v_mfma_f32_16x16x32_bf16 v[24:27], v[216:219], v[204:207], v[24:27]
    ds_read_b128 v[168:171], v2 offset:0
    v_fma_f32 v252, v252, v7, v6
    v_mfma_f32_16x16x32_bf16 v[28:31], v[216:219], v[208:211], v[28:31]
    ds_read_b128 v[172:175], v2 offset:1024
    v_fma_f32 v253, v253, v7, v6
    v_mfma_f32_16x16x32_bf16 v[32:35], v[220:223], v[204:207], v[32:35]
    ds_read_b128 v[176:179], v2 offset:2048
    v_fma_f32 v254, v254, v7, v6
    v_mfma_f32_16x16x32_bf16 v[36:39], v[220:223], v[208:211], v[36:39]
    ds_read_b128 v[180:183], v2 offset:3072
    v_fma_f32 v255, v255, v7, v6
    v_mfma_f32_16x16x32_bf16 v[40:43], v[224:227], v[204:207], v[40:43]
    ds_read_b128 v[184:187], v2 offset:4096
    v_mul_f32 v12, v12, v136
    v_mfma_f32_16x16x32_bf16 v[44:47], v[224:227], v[208:211], v[44:47]
    ds_read_b128 v[188:191], v2 offset:5120
    v_mfma_f32_16x16x32_bf16 v[48:51], v[228:231], v[204:207], v[48:51]
    ds_read_b128 v[192:195], v2 offset:6144
    v_mul_f32 v13, v13, v137
    v_mfma_f32_16x16x32_bf16 v[52:55], v[228:231], v[208:211], v[52:55]
    ds_read_b128 v[196:199], v2 offset:7168
    v_mul_f32 v14, v14, v138
    v_mfma_f32_16x16x32_bf16 v[56:59], v[232:235], v[204:207], v[56:59]
    ds_read_b128 v[200:203], v2 offset:8192
    v_mul_f32 v15, v15, v139
    v_mfma_f32_16x16x32_bf16 v[60:63], v[232:235], v[208:211], v[60:63]
    v_mul_f32 v252, v252, v140
    v_mul_f32 v253, v253, v141
    v_mfma_f32_16x16x32_bf16 v[64:67], v[236:239], v[204:207], v[64:67]
    v_mul_f32 v254, v254, v142
    v_mul_f32 v255, v255, v143
    v_mfma_f32_16x16x32_bf16 v[68:71], v[236:239], v[208:211], v[68:71]
    v_exp_f32 v12, v12
    v_mfma_f32_16x16x32_bf16 v[72:75], v[240:243], v[204:207], v[72:75]
    v_exp_f32 v13, v13
    v_mfma_f32_16x16x32_bf16 v[76:79], v[240:243], v[208:211], v[76:79]
    v_exp_f32 v14, v14
    v_mfma_f32_16x16x32_bf16 v[80:83], v[244:247], v[204:207], v[80:83]
    v_exp_f32 v15, v15
    v_mfma_f32_16x16x32_bf16 v[84:87], v[244:247], v[208:211], v[84:87]
    v_exp_f32 v252, v252
    s_waitcnt lgkmcnt(5)
    v_mfma_f32_16x16x32_bf16 v[16:19], v[168:171], v[160:163], v[16:19]
    ds_read_b128 v[204:207], v11 offset:0
    v_mfma_f32_16x16x32_bf16 v[20:23], v[168:171], v[164:167], v[20:23]
    ds_read_b128 v[208:211], v11 offset:2048
    v_exp_f32 v253, v253
    v_mfma_f32_16x16x32_bf16 v[24:27], v[172:175], v[160:163], v[24:27]
    ds_read_b128 v[212:215], v2 offset:9216
    v_exp_f32 v254, v254
    v_mfma_f32_16x16x32_bf16 v[28:31], v[172:175], v[164:167], v[28:31]
    ds_read_b128 v[216:219], v2 offset:10240
    v_exp_f32 v255, v255
    v_mfma_f32_16x16x32_bf16 v[32:35], v[176:179], v[160:163], v[32:35]
    ds_read_b128 v[220:223], v2 offset:11264
    v_fma_f32 v12, v12, v249, v249
    v_mfma_f32_16x16x32_bf16 v[36:39], v[176:179], v[164:167], v[36:39]
    ds_read_b128 v[224:227], v2 offset:12288
    v_fma_f32 v13, v13, v249, v249
    v_mfma_f32_16x16x32_bf16 v[40:43], v[180:183], v[160:163], v[40:43]
    ds_read_b128 v[228:231], v2 offset:13312
    v_fma_f32 v14, v14, v249, v249
    v_mfma_f32_16x16x32_bf16 v[44:47], v[180:183], v[164:167], v[44:47]
    ds_read_b128 v[232:235], v2 offset:14336
    s_waitcnt lgkmcnt(8)
    v_mfma_f32_16x16x32_bf16 v[48:51], v[184:187], v[160:163], v[48:51]
    ds_read_b128 v[236:239], v2 offset:15360
    v_fma_f32 v15, v15, v249, v249
    v_mfma_f32_16x16x32_bf16 v[52:55], v[184:187], v[164:167], v[52:55]
    ds_read_b128 v[240:243], v2 offset:16384
    v_fma_f32 v252, v252, v251, v251
    v_mfma_f32_16x16x32_bf16 v[56:59], v[188:191], v[160:163], v[56:59]
    ds_read_b128 v[244:247], v2 offset:17408
    v_fma_f32 v253, v253, v251, v251
    v_mfma_f32_16x16x32_bf16 v[60:63], v[188:191], v[164:167], v[60:63]
    v_fma_f32 v254, v254, v251, v251
    v_fma_f32 v255, v255, v251, v251
    v_mfma_f32_16x16x32_bf16 v[64:67], v[192:195], v[160:163], v[64:67]
    v_rcp_f32 v12, v12
    v_mfma_f32_16x16x32_bf16 v[68:71], v[192:195], v[164:167], v[68:71]
    v_rcp_f32 v13, v13
    v_mfma_f32_16x16x32_bf16 v[72:75], v[196:199], v[160:163], v[72:75]
    v_rcp_f32 v14, v14
    v_mfma_f32_16x16x32_bf16 v[76:79], v[196:199], v[164:167], v[76:79]
    v_rcp_f32 v15, v15
    v_mfma_f32_16x16x32_bf16 v[80:83], v[200:203], v[160:163], v[80:83]
    v_rcp_f32 v252, v252
    v_mfma_f32_16x16x32_bf16 v[84:87], v[200:203], v[164:167], v[84:87]
    v_rcp_f32 v253, v253
    s_waitcnt lgkmcnt(0)
    s_barrier
    v_mfma_f32_16x16x32_bf16 v[16:19], v[212:215], v[204:207], v[16:19]
    ds_read_b128 v[160:163], v10 offset:36864
    v_mfma_f32_16x16x32_bf16 v[20:23], v[212:215], v[208:211], v[20:23]
    ds_read_b128 v[164:167], v10 offset:38912
    v_rcp_f32 v254, v254
    v_mfma_f32_16x16x32_bf16 v[24:27], v[216:219], v[204:207], v[24:27]
    ds_read_b128 v[168:171], v2 offset:36864
    v_rcp_f32 v255, v255
    v_mfma_f32_16x16x32_bf16 v[28:31], v[216:219], v[208:211], v[28:31]
    ds_read_b128 v[172:175], v2 offset:37888
    v_mul_f32 v136, v136, v12
    v_mfma_f32_16x16x32_bf16 v[32:35], v[220:223], v[204:207], v[32:35]
    ds_read_b128 v[176:179], v2 offset:38912
    v_mul_f32 v137, v137, v13
    v_mfma_f32_16x16x32_bf16 v[36:39], v[220:223], v[208:211], v[36:39]
    ds_read_b128 v[180:183], v2 offset:39936
    v_mul_f32 v138, v138, v14
    v_mfma_f32_16x16x32_bf16 v[40:43], v[224:227], v[204:207], v[40:43]
    ds_read_b128 v[184:187], v2 offset:40960
    v_mul_f32 v139, v139, v15
    v_mfma_f32_16x16x32_bf16 v[44:47], v[224:227], v[208:211], v[44:47]
    ds_read_b128 v[188:191], v2 offset:41984
    v_mfma_f32_16x16x32_bf16 v[48:51], v[228:231], v[204:207], v[48:51]
    ds_read_b128 v[192:195], v2 offset:43008
    v_mul_f32 v140, v140, v252
    v_mfma_f32_16x16x32_bf16 v[52:55], v[228:231], v[208:211], v[52:55]
    ds_read_b128 v[196:199], v2 offset:44032
    v_mul_f32 v141, v141, v253
    v_mfma_f32_16x16x32_bf16 v[56:59], v[232:235], v[204:207], v[56:59]
    ds_read_b128 v[200:203], v2 offset:45056
    v_mul_f32 v142, v142, v254
    v_mfma_f32_16x16x32_bf16 v[60:63], v[232:235], v[208:211], v[60:63]
    v_mul_f32 v143, v143, v255
    v_mul_f32 v12, v144, v144
    v_mfma_f32_16x16x32_bf16 v[64:67], v[236:239], v[204:207], v[64:67]
    v_mul_f32 v13, v145, v145
    v_mul_f32 v14, v146, v146
    v_mfma_f32_16x16x32_bf16 v[68:71], v[236:239], v[208:211], v[68:71]
    v_mul_f32 v15, v147, v147
    v_mul_f32 v252, v148, v148
    v_mfma_f32_16x16x32_bf16 v[72:75], v[240:243], v[204:207], v[72:75]
    v_mul_f32 v253, v149, v149
    v_mul_f32 v254, v150, v150
    v_mfma_f32_16x16x32_bf16 v[76:79], v[240:243], v[208:211], v[76:79]
    v_mul_f32 v255, v151, v151
    v_fma_f32 v12, v12, v5, v4
    v_mfma_f32_16x16x32_bf16 v[80:83], v[244:247], v[204:207], v[80:83]
    v_fma_f32 v13, v13, v5, v4
    v_fma_f32 v14, v14, v5, v4
    v_mfma_f32_16x16x32_bf16 v[84:87], v[244:247], v[208:211], v[84:87]
    v_fma_f32 v15, v15, v5, v4
    s_waitcnt lgkmcnt(5)
    v_mfma_f32_16x16x32_bf16 v[16:19], v[168:171], v[160:163], v[16:19]
    ds_read_b128 v[204:207], v11 offset:36864
    v_mfma_f32_16x16x32_bf16 v[20:23], v[168:171], v[164:167], v[20:23]
    ds_read_b128 v[208:211], v11 offset:38912
    v_fma_f32 v252, v252, v7, v6
    v_mfma_f32_16x16x32_bf16 v[24:27], v[172:175], v[160:163], v[24:27]
    ds_read_b128 v[212:215], v2 offset:46080
    v_fma_f32 v253, v253, v7, v6
    v_mfma_f32_16x16x32_bf16 v[28:31], v[172:175], v[164:167], v[28:31]
    ds_read_b128 v[216:219], v2 offset:47104
    v_fma_f32 v254, v254, v7, v6
    v_mfma_f32_16x16x32_bf16 v[32:35], v[176:179], v[160:163], v[32:35]
    ds_read_b128 v[220:223], v2 offset:48128
    v_fma_f32 v255, v255, v7, v6
    v_mfma_f32_16x16x32_bf16 v[36:39], v[176:179], v[164:167], v[36:39]
    ds_read_b128 v[224:227], v2 offset:49152
    v_mul_f32 v12, v12, v144
    v_mfma_f32_16x16x32_bf16 v[40:43], v[180:183], v[160:163], v[40:43]
    ds_read_b128 v[228:231], v2 offset:50176
    v_mul_f32 v13, v13, v145
    v_mfma_f32_16x16x32_bf16 v[44:47], v[180:183], v[164:167], v[44:47]
    ds_read_b128 v[232:235], v2 offset:51200
    s_waitcnt lgkmcnt(8)
    v_mfma_f32_16x16x32_bf16 v[48:51], v[184:187], v[160:163], v[48:51]
    ds_read_b128 v[236:239], v2 offset:52224
    v_mul_f32 v14, v14, v146
    v_mfma_f32_16x16x32_bf16 v[52:55], v[184:187], v[164:167], v[52:55]
    ds_read_b128 v[240:243], v2 offset:53248
    v_mul_f32 v15, v15, v147
    v_mfma_f32_16x16x32_bf16 v[56:59], v[188:191], v[160:163], v[56:59]
    ds_read_b128 v[244:247], v2 offset:54272
    v_mul_f32 v252, v252, v148
    v_mfma_f32_16x16x32_bf16 v[60:63], v[188:191], v[164:167], v[60:63]
    v_mul_f32 v253, v253, v149
    v_mul_f32 v254, v254, v150
    v_mfma_f32_16x16x32_bf16 v[64:67], v[192:195], v[160:163], v[64:67]
    v_mul_f32 v255, v255, v151
    v_exp_f32 v12, v12
    v_mfma_f32_16x16x32_bf16 v[68:71], v[192:195], v[164:167], v[68:71]
    v_exp_f32 v13, v13
    v_mfma_f32_16x16x32_bf16 v[72:75], v[196:199], v[160:163], v[72:75]
    v_exp_f32 v14, v14
    v_mfma_f32_16x16x32_bf16 v[76:79], v[196:199], v[164:167], v[76:79]
    v_exp_f32 v15, v15
    v_mfma_f32_16x16x32_bf16 v[80:83], v[200:203], v[160:163], v[80:83]
    v_exp_f32 v252, v252
    v_mfma_f32_16x16x32_bf16 v[84:87], v[200:203], v[164:167], v[84:87]
    v_exp_f32 v253, v253
    s_waitcnt lgkmcnt(0)
    s_barrier
    v_mfma_f32_16x16x32_bf16 v[16:19], v[212:215], v[204:207], v[16:19]
    ds_read_b128 v[160:163], v8 offset:0
    v_mfma_f32_16x16x32_bf16 v[20:23], v[212:215], v[208:211], v[20:23]
    ds_read_b128 v[164:167], v8 offset:2048
    v_exp_f32 v254, v254
    v_mfma_f32_16x16x32_bf16 v[24:27], v[216:219], v[204:207], v[24:27]
    ds_read_b128 v[168:171], v1 offset:0
    v_exp_f32 v255, v255
    v_mfma_f32_16x16x32_bf16 v[28:31], v[216:219], v[208:211], v[28:31]
    ds_read_b128 v[172:175], v1 offset:1024
    v_fma_f32 v12, v12, v249, v249
    v_mfma_f32_16x16x32_bf16 v[32:35], v[220:223], v[204:207], v[32:35]
    ds_read_b128 v[176:179], v1 offset:2048
    v_fma_f32 v13, v13, v249, v249
    v_mfma_f32_16x16x32_bf16 v[36:39], v[220:223], v[208:211], v[36:39]
    ds_read_b128 v[180:183], v1 offset:3072
    v_fma_f32 v14, v14, v249, v249
    v_mfma_f32_16x16x32_bf16 v[40:43], v[224:227], v[204:207], v[40:43]
    ds_read_b128 v[184:187], v1 offset:4096
    v_fma_f32 v15, v15, v249, v249
    v_mfma_f32_16x16x32_bf16 v[44:47], v[224:227], v[208:211], v[44:47]
    ds_read_b128 v[188:191], v1 offset:5120
    v_mfma_f32_16x16x32_bf16 v[48:51], v[228:231], v[204:207], v[48:51]
    ds_read_b128 v[192:195], v1 offset:6144
    v_fma_f32 v252, v252, v251, v251
    v_mfma_f32_16x16x32_bf16 v[52:55], v[228:231], v[208:211], v[52:55]
    ds_read_b128 v[196:199], v1 offset:7168
    v_fma_f32 v253, v253, v251, v251
    v_mfma_f32_16x16x32_bf16 v[56:59], v[232:235], v[204:207], v[56:59]
    ds_read_b128 v[200:203], v1 offset:8192
    v_fma_f32 v254, v254, v251, v251
    v_mfma_f32_16x16x32_bf16 v[60:63], v[232:235], v[208:211], v[60:63]
    v_fma_f32 v255, v255, v251, v251
    v_rcp_f32 v12, v12
    v_mfma_f32_16x16x32_bf16 v[64:67], v[236:239], v[204:207], v[64:67]
    v_rcp_f32 v13, v13
    v_mfma_f32_16x16x32_bf16 v[68:71], v[236:239], v[208:211], v[68:71]
    v_rcp_f32 v14, v14
    v_mfma_f32_16x16x32_bf16 v[72:75], v[240:243], v[204:207], v[72:75]
    v_rcp_f32 v15, v15
    v_mfma_f32_16x16x32_bf16 v[76:79], v[240:243], v[208:211], v[76:79]
    v_rcp_f32 v252, v252
    v_mfma_f32_16x16x32_bf16 v[80:83], v[244:247], v[204:207], v[80:83]
    v_rcp_f32 v253, v253
    v_mfma_f32_16x16x32_bf16 v[84:87], v[244:247], v[208:211], v[84:87]
    v_rcp_f32 v254, v254
    s_waitcnt lgkmcnt(5)
    v_mfma_f32_16x16x32_bf16 v[16:19], v[168:171], v[160:163], v[16:19]
    ds_read_b128 v[204:207], v9 offset:0
    v_mfma_f32_16x16x32_bf16 v[20:23], v[168:171], v[164:167], v[20:23]
    ds_read_b128 v[208:211], v9 offset:2048
    v_rcp_f32 v255, v255
    v_mfma_f32_16x16x32_bf16 v[24:27], v[172:175], v[160:163], v[24:27]
    ds_read_b128 v[212:215], v1 offset:9216
    v_mul_f32 v144, v144, v12
    v_mfma_f32_16x16x32_bf16 v[28:31], v[172:175], v[164:167], v[28:31]
    ds_read_b128 v[216:219], v1 offset:10240
    v_mul_f32 v145, v145, v13
    v_mfma_f32_16x16x32_bf16 v[32:35], v[176:179], v[160:163], v[32:35]
    ds_read_b128 v[220:223], v1 offset:11264
    v_mul_f32 v146, v146, v14
    v_mfma_f32_16x16x32_bf16 v[36:39], v[176:179], v[164:167], v[36:39]
    ds_read_b128 v[224:227], v1 offset:12288
    v_mul_f32 v147, v147, v15
    v_mfma_f32_16x16x32_bf16 v[40:43], v[180:183], v[160:163], v[40:43]
    ds_read_b128 v[228:231], v1 offset:13312
    v_mul_f32 v148, v148, v252
    v_mfma_f32_16x16x32_bf16 v[44:47], v[180:183], v[164:167], v[44:47]
    ds_read_b128 v[232:235], v1 offset:14336
    s_waitcnt lgkmcnt(8)
    v_mfma_f32_16x16x32_bf16 v[48:51], v[184:187], v[160:163], v[48:51]
    ds_read_b128 v[236:239], v1 offset:15360
    v_mul_f32 v149, v149, v253
    v_mfma_f32_16x16x32_bf16 v[52:55], v[184:187], v[164:167], v[52:55]
    ds_read_b128 v[240:243], v1 offset:16384
    v_mul_f32 v150, v150, v254
    v_mfma_f32_16x16x32_bf16 v[56:59], v[188:191], v[160:163], v[56:59]
    ds_read_b128 v[244:247], v1 offset:17408
    v_mul_f32 v151, v151, v255
    v_mfma_f32_16x16x32_bf16 v[60:63], v[188:191], v[164:167], v[60:63]
    v_mul_f32 v12, v152, v152
    v_mul_f32 v13, v153, v153
    v_mfma_f32_16x16x32_bf16 v[64:67], v[192:195], v[160:163], v[64:67]
    v_mul_f32 v14, v154, v154
    v_mul_f32 v15, v155, v155
    v_mfma_f32_16x16x32_bf16 v[68:71], v[192:195], v[164:167], v[68:71]
    v_mul_f32 v252, v156, v156
    v_mul_f32 v253, v157, v157
    v_mfma_f32_16x16x32_bf16 v[72:75], v[196:199], v[160:163], v[72:75]
    v_mul_f32 v254, v158, v158
    v_mul_f32 v255, v159, v159
    v_mfma_f32_16x16x32_bf16 v[76:79], v[196:199], v[164:167], v[76:79]
    v_fma_f32 v12, v12, v5, v4
    v_fma_f32 v13, v13, v5, v4
    v_mfma_f32_16x16x32_bf16 v[80:83], v[200:203], v[160:163], v[80:83]
    v_fma_f32 v14, v14, v5, v4
    v_fma_f32 v15, v15, v5, v4
    v_mfma_f32_16x16x32_bf16 v[84:87], v[200:203], v[164:167], v[84:87]
    v_fma_f32 v252, v252, v7, v6
    s_waitcnt lgkmcnt(0)
    s_barrier
    v_mfma_f32_16x16x32_bf16 v[16:19], v[212:215], v[204:207], v[16:19]
    ds_read_b128 v[160:163], v8 offset:36864
    v_mfma_f32_16x16x32_bf16 v[20:23], v[212:215], v[208:211], v[20:23]
    ds_read_b128 v[164:167], v8 offset:38912
    v_fma_f32 v253, v253, v7, v6
    v_mfma_f32_16x16x32_bf16 v[24:27], v[216:219], v[204:207], v[24:27]
    ds_read_b128 v[168:171], v1 offset:36864
    v_fma_f32 v254, v254, v7, v6
    v_mfma_f32_16x16x32_bf16 v[28:31], v[216:219], v[208:211], v[28:31]
    ds_read_b128 v[172:175], v1 offset:37888
    v_fma_f32 v255, v255, v7, v6
    v_mfma_f32_16x16x32_bf16 v[32:35], v[220:223], v[204:207], v[32:35]
    ds_read_b128 v[176:179], v1 offset:38912
    v_mul_f32 v12, v12, v152
    v_mfma_f32_16x16x32_bf16 v[36:39], v[220:223], v[208:211], v[36:39]
    ds_read_b128 v[180:183], v1 offset:39936
    v_mul_f32 v13, v13, v153
    v_mfma_f32_16x16x32_bf16 v[40:43], v[224:227], v[204:207], v[40:43]
    ds_read_b128 v[184:187], v1 offset:40960
    v_mul_f32 v14, v14, v154
    v_mfma_f32_16x16x32_bf16 v[44:47], v[224:227], v[208:211], v[44:47]
    ds_read_b128 v[188:191], v1 offset:41984
    v_mfma_f32_16x16x32_bf16 v[48:51], v[228:231], v[204:207], v[48:51]
    ds_read_b128 v[192:195], v1 offset:43008
    v_mul_f32 v15, v15, v155
    v_mfma_f32_16x16x32_bf16 v[52:55], v[228:231], v[208:211], v[52:55]
    ds_read_b128 v[196:199], v1 offset:44032
    v_mul_f32 v252, v252, v156
    v_mfma_f32_16x16x32_bf16 v[56:59], v[232:235], v[204:207], v[56:59]
    ds_read_b128 v[200:203], v1 offset:45056
    v_mul_f32 v253, v253, v157
    v_mfma_f32_16x16x32_bf16 v[60:63], v[232:235], v[208:211], v[60:63]
    v_mul_f32 v254, v254, v158
    v_mul_f32 v255, v255, v159
    v_mfma_f32_16x16x32_bf16 v[64:67], v[236:239], v[204:207], v[64:67]
    v_exp_f32 v12, v12
    v_mfma_f32_16x16x32_bf16 v[68:71], v[236:239], v[208:211], v[68:71]
    v_exp_f32 v13, v13
    v_mfma_f32_16x16x32_bf16 v[72:75], v[240:243], v[204:207], v[72:75]
    v_exp_f32 v14, v14
    v_mfma_f32_16x16x32_bf16 v[76:79], v[240:243], v[208:211], v[76:79]
    v_exp_f32 v15, v15
    v_mfma_f32_16x16x32_bf16 v[80:83], v[244:247], v[204:207], v[80:83]
    v_exp_f32 v252, v252
    v_mfma_f32_16x16x32_bf16 v[84:87], v[244:247], v[208:211], v[84:87]
    v_exp_f32 v253, v253
    s_waitcnt lgkmcnt(5)
    v_mfma_f32_16x16x32_bf16 v[16:19], v[168:171], v[160:163], v[16:19]
    ds_read_b128 v[204:207], v9 offset:36864
    v_mfma_f32_16x16x32_bf16 v[20:23], v[168:171], v[164:167], v[20:23]
    ds_read_b128 v[208:211], v9 offset:38912
    v_exp_f32 v254, v254
    v_mfma_f32_16x16x32_bf16 v[24:27], v[172:175], v[160:163], v[24:27]
    ds_read_b128 v[212:215], v1 offset:46080
    v_exp_f32 v255, v255
    v_mfma_f32_16x16x32_bf16 v[28:31], v[172:175], v[164:167], v[28:31]
    ds_read_b128 v[216:219], v1 offset:47104
    v_fma_f32 v12, v12, v249, v249
    v_mfma_f32_16x16x32_bf16 v[32:35], v[176:179], v[160:163], v[32:35]
    ds_read_b128 v[220:223], v1 offset:48128
    v_fma_f32 v13, v13, v249, v249
    v_mfma_f32_16x16x32_bf16 v[36:39], v[176:179], v[164:167], v[36:39]
    ds_read_b128 v[224:227], v1 offset:49152
    v_fma_f32 v14, v14, v249, v249
    v_mfma_f32_16x16x32_bf16 v[40:43], v[180:183], v[160:163], v[40:43]
    ds_read_b128 v[228:231], v1 offset:50176
    v_fma_f32 v15, v15, v249, v249
    v_mfma_f32_16x16x32_bf16 v[44:47], v[180:183], v[164:167], v[44:47]
    ds_read_b128 v[232:235], v1 offset:51200
    s_waitcnt lgkmcnt(8)
    v_mfma_f32_16x16x32_bf16 v[48:51], v[184:187], v[160:163], v[48:51]
    ds_read_b128 v[236:239], v1 offset:52224
    v_fma_f32 v252, v252, v251, v251
    v_mfma_f32_16x16x32_bf16 v[52:55], v[184:187], v[164:167], v[52:55]
    ds_read_b128 v[240:243], v1 offset:53248
    v_fma_f32 v253, v253, v251, v251
    v_mfma_f32_16x16x32_bf16 v[56:59], v[188:191], v[160:163], v[56:59]
    ds_read_b128 v[244:247], v1 offset:54272
    v_fma_f32 v254, v254, v251, v251
    v_mfma_f32_16x16x32_bf16 v[60:63], v[188:191], v[164:167], v[60:63]
    v_fma_f32 v255, v255, v251, v251
    v_rcp_f32 v12, v12
    v_mfma_f32_16x16x32_bf16 v[64:67], v[192:195], v[160:163], v[64:67]
    v_rcp_f32 v13, v13
    v_mfma_f32_16x16x32_bf16 v[68:71], v[192:195], v[164:167], v[68:71]
    v_rcp_f32 v14, v14
    v_mfma_f32_16x16x32_bf16 v[72:75], v[196:199], v[160:163], v[72:75]
    v_rcp_f32 v15, v15
    v_mfma_f32_16x16x32_bf16 v[76:79], v[196:199], v[164:167], v[76:79]
    v_rcp_f32 v252, v252
    v_mfma_f32_16x16x32_bf16 v[80:83], v[200:203], v[160:163], v[80:83]
    v_rcp_f32 v253, v253
    v_mfma_f32_16x16x32_bf16 v[84:87], v[200:203], v[164:167], v[84:87]
    v_rcp_f32 v254, v254
    s_waitcnt lgkmcnt(0)
    s_barrier
    v_mfma_f32_16x16x32_bf16 v[16:19], v[212:215], v[204:207], v[16:19]
    ds_read_b128 v[160:163], v10 offset:0
    v_mfma_f32_16x16x32_bf16 v[20:23], v[212:215], v[208:211], v[20:23]
    ds_read_b128 v[164:167], v10 offset:2048
    v_rcp_f32 v255, v255
    v_mfma_f32_16x16x32_bf16 v[24:27], v[216:219], v[204:207], v[24:27]
    ds_read_b128 v[168:171], v2 offset:0
    v_mul_f32 v152, v152, v12
    v_mfma_f32_16x16x32_bf16 v[28:31], v[216:219], v[208:211], v[28:31]
    ds_read_b128 v[172:175], v2 offset:1024
    v_mul_f32 v153, v153, v13
    v_mfma_f32_16x16x32_bf16 v[32:35], v[220:223], v[204:207], v[32:35]
    ds_read_b128 v[176:179], v2 offset:2048
    v_mul_f32 v154, v154, v14
    v_mfma_f32_16x16x32_bf16 v[36:39], v[220:223], v[208:211], v[36:39]
    ds_read_b128 v[180:183], v2 offset:3072
    v_mul_f32 v155, v155, v15
    v_mfma_f32_16x16x32_bf16 v[40:43], v[224:227], v[204:207], v[40:43]
    ds_read_b128 v[184:187], v2 offset:4096
    v_mul_f32 v156, v156, v252
    v_mfma_f32_16x16x32_bf16 v[44:47], v[224:227], v[208:211], v[44:47]
    ds_read_b128 v[188:191], v2 offset:5120
    v_mfma_f32_16x16x32_bf16 v[48:51], v[228:231], v[204:207], v[48:51]
    ds_read_b128 v[192:195], v2 offset:6144
    v_mul_f32 v157, v157, v253
    v_mfma_f32_16x16x32_bf16 v[52:55], v[228:231], v[208:211], v[52:55]
    ds_read_b128 v[196:199], v2 offset:7168
    v_mul_f32 v158, v158, v254
    v_mfma_f32_16x16x32_bf16 v[56:59], v[232:235], v[204:207], v[56:59]
    ds_read_b128 v[200:203], v2 offset:8192
    v_mul_f32 v159, v159, v255
    v_mfma_f32_16x16x32_bf16 v[60:63], v[232:235], v[208:211], v[60:63]
    s_mul_i32 s36, s31, 73728
    s_add_u32 s36, s36, s21
    v_mfma_f32_16x16x32_bf16 v[64:67], v[236:239], v[204:207], v[64:67]
    s_lshl_b32 s34, s24, 10
    s_lshr_b32 s35, s24, 1
    v_mfma_f32_16x16x32_bf16 v[68:71], v[236:239], v[208:211], v[68:71]
    s_lshl_b32 s35, s35, 10
    s_and_b32 s33, s24, 1
    v_mfma_f32_16x16x32_bf16 v[72:75], v[240:243], v[204:207], v[72:75]
    s_mul_i32 s33, s33, 73728
    s_add_u32 s35, s35, s33
    v_mfma_f32_16x16x32_bf16 v[76:79], v[240:243], v[208:211], v[76:79]
    s_add_u32 s35, s35, 65536
    v_add_u32 v14, s34, v1
    v_mfma_f32_16x16x32_bf16 v[80:83], v[244:247], v[204:207], v[80:83]
    v_add_u32 v15, s35, v1
    s_add_u32 s39, s36, 0x1200000
    v_mfma_f32_16x16x32_bf16 v[84:87], v[244:247], v[208:211], v[84:87]
    s_add_u32 s40, s36, 0x1212000
    s_mov_b32 s41, 5
    .p2align 6
L_g_loop:
    s_waitcnt lgkmcnt(5)
    v_mfma_f32_16x16x32_bf16 v[16:19], v[168:171], v[160:163], v[16:19]
    ds_read_b128 v[204:207], v11 offset:0
    v_mfma_f32_16x16x32_bf16 v[20:23], v[168:171], v[164:167], v[20:23]
    ds_read_b128 v[208:211], v11 offset:2048
    v_mfma_f32_16x16x32_bf16 v[24:27], v[172:175], v[160:163], v[24:27]
    ds_read_b128 v[212:215], v2 offset:9216
    v_mfma_f32_16x16x32_bf16 v[28:31], v[172:175], v[164:167], v[28:31]
    ds_read_b128 v[216:219], v2 offset:10240
    v_mfma_f32_16x16x32_bf16 v[32:35], v[176:179], v[160:163], v[32:35]
    ds_read_b128 v[220:223], v2 offset:11264
    v_mfma_f32_16x16x32_bf16 v[36:39], v[176:179], v[164:167], v[36:39]
    ds_read_b128 v[224:227], v2 offset:12288
    v_mfma_f32_16x16x32_bf16 v[40:43], v[180:183], v[160:163], v[40:43]
    ds_read_b128 v[228:231], v2 offset:13312
    v_mfma_f32_16x16x32_bf16 v[44:47], v[180:183], v[164:167], v[44:47]
    ds_read_b128 v[232:235], v2 offset:14336
    s_waitcnt lgkmcnt(8)
    v_mfma_f32_16x16x32_bf16 v[48:51], v[184:187], v[160:163], v[48:51]
    ds_read_b128 v[236:239], v2 offset:15360
    v_mfma_f32_16x16x32_bf16 v[52:55], v[184:187], v[164:167], v[52:55]
    ds_read_b128 v[240:243], v2 offset:16384
    v_mfma_f32_16x16x32_bf16 v[56:59], v[188:191], v[160:163], v[56:59]
    ds_read_b128 v[244:247], v2 offset:17408
    v_mfma_f32_16x16x32_bf16 v[60:63], v[188:191], v[164:167], v[60:63]
    v_mfma_f32_16x16x32_bf16 v[64:67], v[192:195], v[160:163], v[64:67]
    v_mfma_f32_16x16x32_bf16 v[68:71], v[192:195], v[164:167], v[68:71]
    v_mfma_f32_16x16x32_bf16 v[72:75], v[196:199], v[160:163], v[72:75]
    v_mfma_f32_16x16x32_bf16 v[76:79], v[196:199], v[164:167], v[76:79]
    v_mfma_f32_16x16x32_bf16 v[80:83], v[200:203], v[160:163], v[80:83]
    v_mfma_f32_16x16x32_bf16 v[84:87], v[200:203], v[164:167], v[84:87]
    s_waitcnt lgkmcnt(0)
    s_barrier
    v_mfma_f32_16x16x32_bf16 v[16:19], v[212:215], v[204:207], v[16:19]
    ds_read_b128 v[160:163], v10 offset:36864
    v_mfma_f32_16x16x32_bf16 v[20:23], v[212:215], v[208:211], v[20:23]
    ds_read_b128 v[164:167], v10 offset:38912
    v_mfma_f32_16x16x32_bf16 v[24:27], v[216:219], v[204:207], v[24:27]
    ds_read_b128 v[168:171], v2 offset:36864
    v_mfma_f32_16x16x32_bf16 v[28:31], v[216:219], v[208:211], v[28:31]
    ds_read_b128 v[172:175], v2 offset:37888
    v_mfma_f32_16x16x32_bf16 v[32:35], v[220:223], v[204:207], v[32:35]
    ds_read_b128 v[176:179], v2 offset:38912
    v_mfma_f32_16x16x32_bf16 v[36:39], v[220:223], v[208:211], v[36:39]
    ds_read_b128 v[180:183], v2 offset:39936
    v_mfma_f32_16x16x32_bf16 v[40:43], v[224:227], v[204:207], v[40:43]
    ds_read_b128 v[184:187], v2 offset:40960
    v_mfma_f32_16x16x32_bf16 v[44:47], v[224:227], v[208:211], v[44:47]
    ds_read_b128 v[188:191], v2 offset:41984
    v_mfma_f32_16x16x32_bf16 v[48:51], v[228:231], v[204:207], v[48:51]
    ds_read_b128 v[192:195], v2 offset:43008
    v_mfma_f32_16x16x32_bf16 v[52:55], v[228:231], v[208:211], v[52:55]
    ds_read_b128 v[196:199], v2 offset:44032
    v_mfma_f32_16x16x32_bf16 v[56:59], v[232:235], v[204:207], v[56:59]
    ds_read_b128 v[200:203], v2 offset:45056
    v_mfma_f32_16x16x32_bf16 v[60:63], v[232:235], v[208:211], v[60:63]
    v_mfma_f32_16x16x32_bf16 v[64:67], v[236:239], v[204:207], v[64:67]
    v_mfma_f32_16x16x32_bf16 v[68:71], v[236:239], v[208:211], v[68:71]
    v_mfma_f32_16x16x32_bf16 v[72:75], v[240:243], v[204:207], v[72:75]
    v_mfma_f32_16x16x32_bf16 v[76:79], v[240:243], v[208:211], v[76:79]
    v_mfma_f32_16x16x32_bf16 v[80:83], v[244:247], v[204:207], v[80:83]
    v_mfma_f32_16x16x32_bf16 v[84:87], v[244:247], v[208:211], v[84:87]
    s_waitcnt lgkmcnt(5)
    v_mfma_f32_16x16x32_bf16 v[16:19], v[168:171], v[160:163], v[16:19]
    ds_read_b128 v[204:207], v11 offset:36864
    v_mfma_f32_16x16x32_bf16 v[20:23], v[168:171], v[164:167], v[20:23]
    ds_read_b128 v[208:211], v11 offset:38912
    v_mfma_f32_16x16x32_bf16 v[24:27], v[172:175], v[160:163], v[24:27]
    ds_read_b128 v[212:215], v2 offset:46080
    v_mfma_f32_16x16x32_bf16 v[28:31], v[172:175], v[164:167], v[28:31]
    ds_read_b128 v[216:219], v2 offset:47104
    v_mfma_f32_16x16x32_bf16 v[32:35], v[176:179], v[160:163], v[32:35]
    ds_read_b128 v[220:223], v2 offset:48128
    v_mfma_f32_16x16x32_bf16 v[36:39], v[176:179], v[164:167], v[36:39]
    ds_read_b128 v[224:227], v2 offset:49152
    v_mfma_f32_16x16x32_bf16 v[40:43], v[180:183], v[160:163], v[40:43]
    ds_read_b128 v[228:231], v2 offset:50176
    v_mfma_f32_16x16x32_bf16 v[44:47], v[180:183], v[164:167], v[44:47]
    ds_read_b128 v[232:235], v2 offset:51200
    s_waitcnt lgkmcnt(8)
    v_mfma_f32_16x16x32_bf16 v[48:51], v[184:187], v[160:163], v[48:51]
    ds_read_b128 v[236:239], v2 offset:52224
    v_mfma_f32_16x16x32_bf16 v[52:55], v[184:187], v[164:167], v[52:55]
    ds_read_b128 v[240:243], v2 offset:53248
    v_mfma_f32_16x16x32_bf16 v[56:59], v[188:191], v[160:163], v[56:59]
    ds_read_b128 v[244:247], v2 offset:54272
    v_mfma_f32_16x16x32_bf16 v[60:63], v[188:191], v[164:167], v[60:63]
    v_mfma_f32_16x16x32_bf16 v[64:67], v[192:195], v[160:163], v[64:67]
    v_mfma_f32_16x16x32_bf16 v[68:71], v[192:195], v[164:167], v[68:71]
    v_mfma_f32_16x16x32_bf16 v[72:75], v[196:199], v[160:163], v[72:75]
    v_mfma_f32_16x16x32_bf16 v[76:79], v[196:199], v[164:167], v[76:79]
    v_mfma_f32_16x16x32_bf16 v[80:83], v[200:203], v[160:163], v[80:83]
    v_mfma_f32_16x16x32_bf16 v[84:87], v[200:203], v[164:167], v[84:87]
    s_waitcnt lgkmcnt(0)
    s_barrier
    v_mfma_f32_16x16x32_bf16 v[16:19], v[212:215], v[204:207], v[16:19]
    ds_read_b128 v[160:163], v8 offset:0
    v_mfma_f32_16x16x32_bf16 v[20:23], v[212:215], v[208:211], v[20:23]
    ds_read_b128 v[164:167], v8 offset:2048
    v_mfma_f32_16x16x32_bf16 v[24:27], v[216:219], v[204:207], v[24:27]
    ds_read_b128 v[168:171], v1 offset:0
    v_mfma_f32_16x16x32_bf16 v[28:31], v[216:219], v[208:211], v[28:31]
    ds_read_b128 v[172:175], v1 offset:1024
    v_mfma_f32_16x16x32_bf16 v[32:35], v[220:223], v[204:207], v[32:35]
    ds_read_b128 v[176:179], v1 offset:2048
    v_mfma_f32_16x16x32_bf16 v[36:39], v[220:223], v[208:211], v[36:39]
    ds_read_b128 v[180:183], v1 offset:3072
    v_mfma_f32_16x16x32_bf16 v[40:43], v[224:227], v[204:207], v[40:43]
    ds_read_b128 v[184:187], v1 offset:4096
    v_mfma_f32_16x16x32_bf16 v[44:47], v[224:227], v[208:211], v[44:47]
    ds_read_b128 v[188:191], v1 offset:5120
    v_mfma_f32_16x16x32_bf16 v[48:51], v[228:231], v[204:207], v[48:51]
    ds_read_b128 v[192:195], v1 offset:6144
    v_mfma_f32_16x16x32_bf16 v[52:55], v[228:231], v[208:211], v[52:55]
    ds_read_b128 v[196:199], v1 offset:7168
    v_mfma_f32_16x16x32_bf16 v[56:59], v[232:235], v[204:207], v[56:59]
    ds_read_b128 v[200:203], v1 offset:8192
    v_mfma_f32_16x16x32_bf16 v[60:63], v[232:235], v[208:211], v[60:63]
    v_mfma_f32_16x16x32_bf16 v[64:67], v[236:239], v[204:207], v[64:67]
    v_mfma_f32_16x16x32_bf16 v[68:71], v[236:239], v[208:211], v[68:71]
    v_mfma_f32_16x16x32_bf16 v[72:75], v[240:243], v[204:207], v[72:75]
    v_mfma_f32_16x16x32_bf16 v[76:79], v[240:243], v[208:211], v[76:79]
    v_mfma_f32_16x16x32_bf16 v[80:83], v[244:247], v[204:207], v[80:83]
    v_mfma_f32_16x16x32_bf16 v[84:87], v[244:247], v[208:211], v[84:87]
    s_waitcnt lgkmcnt(5)
    v_mfma_f32_16x16x32_bf16 v[16:19], v[168:171], v[160:163], v[16:19]
    ds_read_b128 v[204:207], v9 offset:0
    v_mfma_f32_16x16x32_bf16 v[20:23], v[168:171], v[164:167], v[20:23]
    ds_read_b128 v[208:211], v9 offset:2048
    v_mfma_f32_16x16x32_bf16 v[24:27], v[172:175], v[160:163], v[24:27]
    ds_read_b128 v[212:215], v1 offset:9216
    v_mfma_f32_16x16x32_bf16 v[28:31], v[172:175], v[164:167], v[28:31]
    ds_read_b128 v[216:219], v1 offset:10240
    v_mfma_f32_16x16x32_bf16 v[32:35], v[176:179], v[160:163], v[32:35]
    ds_read_b128 v[220:223], v1 offset:11264
    v_mfma_f32_16x16x32_bf16 v[36:39], v[176:179], v[164:167], v[36:39]
    ds_read_b128 v[224:227], v1 offset:12288
    v_mfma_f32_16x16x32_bf16 v[40:43], v[180:183], v[160:163], v[40:43]
    ds_read_b128 v[228:231], v1 offset:13312
    v_mfma_f32_16x16x32_bf16 v[44:47], v[180:183], v[164:167], v[44:47]
    ds_read_b128 v[232:235], v1 offset:14336
    s_waitcnt lgkmcnt(8)
    v_mfma_f32_16x16x32_bf16 v[48:51], v[184:187], v[160:163], v[48:51]
    ds_read_b128 v[236:239], v1 offset:15360
    v_mfma_f32_16x16x32_bf16 v[52:55], v[184:187], v[164:167], v[52:55]
    ds_read_b128 v[240:243], v1 offset:16384
    v_mfma_f32_16x16x32_bf16 v[56:59], v[188:191], v[160:163], v[56:59]
    ds_read_b128 v[244:247], v1 offset:17408
    v_mfma_f32_16x16x32_bf16 v[60:63], v[188:191], v[164:167], v[60:63]
    v_mfma_f32_16x16x32_bf16 v[64:67], v[192:195], v[160:163], v[64:67]
    v_mfma_f32_16x16x32_bf16 v[68:71], v[192:195], v[164:167], v[68:71]
    v_mfma_f32_16x16x32_bf16 v[72:75], v[196:199], v[160:163], v[72:75]
    v_mfma_f32_16x16x32_bf16 v[76:79], v[196:199], v[164:167], v[76:79]
    v_mfma_f32_16x16x32_bf16 v[80:83], v[200:203], v[160:163], v[80:83]
    v_mfma_f32_16x16x32_bf16 v[84:87], v[200:203], v[164:167], v[84:87]
    s_waitcnt lgkmcnt(0)
    s_barrier
    v_mfma_f32_16x16x32_bf16 v[16:19], v[212:215], v[204:207], v[16:19]
    ds_read_b128 v[160:163], v8 offset:36864
    v_mfma_f32_16x16x32_bf16 v[20:23], v[212:215], v[208:211], v[20:23]
    ds_read_b128 v[164:167], v8 offset:38912
    v_mfma_f32_16x16x32_bf16 v[24:27], v[216:219], v[204:207], v[24:27]
    ds_read_b128 v[168:171], v1 offset:36864
    v_mfma_f32_16x16x32_bf16 v[28:31], v[216:219], v[208:211], v[28:31]
    ds_read_b128 v[172:175], v1 offset:37888
    v_mfma_f32_16x16x32_bf16 v[32:35], v[220:223], v[204:207], v[32:35]
    ds_read_b128 v[176:179], v1 offset:38912
    v_mfma_f32_16x16x32_bf16 v[36:39], v[220:223], v[208:211], v[36:39]
    ds_read_b128 v[180:183], v1 offset:39936
    v_mfma_f32_16x16x32_bf16 v[40:43], v[224:227], v[204:207], v[40:43]
    ds_read_b128 v[184:187], v1 offset:40960
    v_mfma_f32_16x16x32_bf16 v[44:47], v[224:227], v[208:211], v[44:47]
    ds_read_b128 v[188:191], v1 offset:41984
    v_mfma_f32_16x16x32_bf16 v[48:51], v[228:231], v[204:207], v[48:51]
    ds_read_b128 v[192:195], v1 offset:43008
    v_mfma_f32_16x16x32_bf16 v[52:55], v[228:231], v[208:211], v[52:55]
    ds_read_b128 v[196:199], v1 offset:44032
    v_mfma_f32_16x16x32_bf16 v[56:59], v[232:235], v[204:207], v[56:59]
    ds_read_b128 v[200:203], v1 offset:45056
    v_mfma_f32_16x16x32_bf16 v[60:63], v[232:235], v[208:211], v[60:63]
    v_mfma_f32_16x16x32_bf16 v[64:67], v[236:239], v[204:207], v[64:67]
    v_mfma_f32_16x16x32_bf16 v[68:71], v[236:239], v[208:211], v[68:71]
    v_mfma_f32_16x16x32_bf16 v[72:75], v[240:243], v[204:207], v[72:75]
    v_mfma_f32_16x16x32_bf16 v[76:79], v[240:243], v[208:211], v[76:79]
    v_mfma_f32_16x16x32_bf16 v[80:83], v[244:247], v[204:207], v[80:83]
    v_mfma_f32_16x16x32_bf16 v[84:87], v[244:247], v[208:211], v[84:87]
    s_waitcnt lgkmcnt(5)
    v_mfma_f32_16x16x32_bf16 v[16:19], v[168:171], v[160:163], v[16:19]
    ds_read_b128 v[204:207], v9 offset:36864
    v_mfma_f32_16x16x32_bf16 v[20:23], v[168:171], v[164:167], v[20:23]
    ds_read_b128 v[208:211], v9 offset:38912
    v_mfma_f32_16x16x32_bf16 v[24:27], v[172:175], v[160:163], v[24:27]
    ds_read_b128 v[212:215], v1 offset:46080
    v_mfma_f32_16x16x32_bf16 v[28:31], v[172:175], v[164:167], v[28:31]
    ds_read_b128 v[216:219], v1 offset:47104
    v_mfma_f32_16x16x32_bf16 v[32:35], v[176:179], v[160:163], v[32:35]
    ds_read_b128 v[220:223], v1 offset:48128
    v_mfma_f32_16x16x32_bf16 v[36:39], v[176:179], v[164:167], v[36:39]
    ds_read_b128 v[224:227], v1 offset:49152
    v_mfma_f32_16x16x32_bf16 v[40:43], v[180:183], v[160:163], v[40:43]
    ds_read_b128 v[228:231], v1 offset:50176
    v_mfma_f32_16x16x32_bf16 v[44:47], v[180:183], v[164:167], v[44:47]
    ds_read_b128 v[232:235], v1 offset:51200
    s_waitcnt lgkmcnt(8)
    v_mfma_f32_16x16x32_bf16 v[48:51], v[184:187], v[160:163], v[48:51]
    ds_read_b128 v[236:239], v1 offset:52224
    v_mfma_f32_16x16x32_bf16 v[52:55], v[184:187], v[164:167], v[52:55]
    ds_read_b128 v[240:243], v1 offset:53248
    v_mfma_f32_16x16x32_bf16 v[56:59], v[188:191], v[160:163], v[56:59]
    ds_read_b128 v[244:247], v1 offset:54272
    v_mfma_f32_16x16x32_bf16 v[60:63], v[188:191], v[164:167], v[60:63]
    v_mfma_f32_16x16x32_bf16 v[64:67], v[192:195], v[160:163], v[64:67]
    v_mfma_f32_16x16x32_bf16 v[68:71], v[192:195], v[164:167], v[68:71]
    v_mfma_f32_16x16x32_bf16 v[72:75], v[196:199], v[160:163], v[72:75]
    v_mfma_f32_16x16x32_bf16 v[76:79], v[196:199], v[164:167], v[76:79]
    v_mfma_f32_16x16x32_bf16 v[80:83], v[200:203], v[160:163], v[80:83]
    v_mfma_f32_16x16x32_bf16 v[84:87], v[200:203], v[164:167], v[84:87]
    s_waitcnt lgkmcnt(0)
    s_barrier
    v_mfma_f32_16x16x32_bf16 v[16:19], v[212:215], v[204:207], v[16:19]
    ds_read_b128 v[160:163], v10 offset:0
    v_mfma_f32_16x16x32_bf16 v[20:23], v[212:215], v[208:211], v[20:23]
    ds_read_b128 v[164:167], v10 offset:2048
    v_mfma_f32_16x16x32_bf16 v[24:27], v[216:219], v[204:207], v[24:27]
    ds_read_b128 v[168:171], v2 offset:0
    v_mfma_f32_16x16x32_bf16 v[28:31], v[216:219], v[208:211], v[28:31]
    ds_read_b128 v[172:175], v2 offset:1024
    v_mfma_f32_16x16x32_bf16 v[32:35], v[220:223], v[204:207], v[32:35]
    ds_read_b128 v[176:179], v2 offset:2048
    v_mfma_f32_16x16x32_bf16 v[36:39], v[220:223], v[208:211], v[36:39]
    ds_read_b128 v[180:183], v2 offset:3072
    v_mfma_f32_16x16x32_bf16 v[40:43], v[224:227], v[204:207], v[40:43]
    ds_read_b128 v[184:187], v2 offset:4096
    v_mfma_f32_16x16x32_bf16 v[44:47], v[224:227], v[208:211], v[44:47]
    ds_read_b128 v[188:191], v2 offset:5120
    v_mfma_f32_16x16x32_bf16 v[48:51], v[228:231], v[204:207], v[48:51]
    ds_read_b128 v[192:195], v2 offset:6144
    v_mfma_f32_16x16x32_bf16 v[52:55], v[228:231], v[208:211], v[52:55]
    ds_read_b128 v[196:199], v2 offset:7168
    v_mfma_f32_16x16x32_bf16 v[56:59], v[232:235], v[204:207], v[56:59]
    ds_read_b128 v[200:203], v2 offset:8192
    v_mfma_f32_16x16x32_bf16 v[60:63], v[232:235], v[208:211], v[60:63]
    v_mfma_f32_16x16x32_bf16 v[64:67], v[236:239], v[204:207], v[64:67]
    v_mfma_f32_16x16x32_bf16 v[68:71], v[236:239], v[208:211], v[68:71]
    v_mfma_f32_16x16x32_bf16 v[72:75], v[240:243], v[204:207], v[72:75]
    v_mfma_f32_16x16x32_bf16 v[76:79], v[240:243], v[208:211], v[76:79]
    v_mfma_f32_16x16x32_bf16 v[80:83], v[244:247], v[204:207], v[80:83]
    s_sub_u32 s41, s41, 1
    v_mfma_f32_16x16x32_bf16 v[84:87], v[244:247], v[208:211], v[84:87]
    s_cmp_lg_u32 s41, 0
    s_cbranch_scc1 L_g_loop
    s_waitcnt lgkmcnt(5)
    v_mfma_f32_16x16x32_bf16 v[16:19], v[168:171], v[160:163], v[16:19]
    ds_read_b128 v[204:207], v11 offset:0
    v_mfma_f32_16x16x32_bf16 v[20:23], v[168:171], v[164:167], v[20:23]
    ds_read_b128 v[208:211], v11 offset:2048
    v_mfma_f32_16x16x32_bf16 v[24:27], v[172:175], v[160:163], v[24:27]
    ds_read_b128 v[212:215], v2 offset:9216
    v_mfma_f32_16x16x32_bf16 v[28:31], v[172:175], v[164:167], v[28:31]
    ds_read_b128 v[216:219], v2 offset:10240
    v_mfma_f32_16x16x32_bf16 v[32:35], v[176:179], v[160:163], v[32:35]
    ds_read_b128 v[220:223], v2 offset:11264
    v_mfma_f32_16x16x32_bf16 v[36:39], v[176:179], v[164:167], v[36:39]
    ds_read_b128 v[224:227], v2 offset:12288
    v_mfma_f32_16x16x32_bf16 v[40:43], v[180:183], v[160:163], v[40:43]
    ds_read_b128 v[228:231], v2 offset:13312
    v_mfma_f32_16x16x32_bf16 v[44:47], v[180:183], v[164:167], v[44:47]
    ds_read_b128 v[232:235], v2 offset:14336
    s_waitcnt lgkmcnt(8)
    v_mfma_f32_16x16x32_bf16 v[48:51], v[184:187], v[160:163], v[48:51]
    ds_read_b128 v[236:239], v2 offset:15360
    v_mfma_f32_16x16x32_bf16 v[52:55], v[184:187], v[164:167], v[52:55]
    ds_read_b128 v[240:243], v2 offset:16384
    v_mfma_f32_16x16x32_bf16 v[56:59], v[188:191], v[160:163], v[56:59]
    ds_read_b128 v[244:247], v2 offset:17408
    v_mfma_f32_16x16x32_bf16 v[60:63], v[188:191], v[164:167], v[60:63]
    v_mfma_f32_16x16x32_bf16 v[64:67], v[192:195], v[160:163], v[64:67]
    v_mfma_f32_16x16x32_bf16 v[68:71], v[192:195], v[164:167], v[68:71]
    v_mfma_f32_16x16x32_bf16 v[72:75], v[196:199], v[160:163], v[72:75]
    v_mfma_f32_16x16x32_bf16 v[76:79], v[196:199], v[164:167], v[76:79]
    v_mfma_f32_16x16x32_bf16 v[80:83], v[200:203], v[160:163], v[80:83]
    v_mfma_f32_16x16x32_bf16 v[84:87], v[200:203], v[164:167], v[84:87]
    s_waitcnt lgkmcnt(0)
    s_barrier
    v_mfma_f32_16x16x32_bf16 v[16:19], v[212:215], v[204:207], v[16:19]
    ds_read_b128 v[160:163], v10 offset:36864
    v_mfma_f32_16x16x32_bf16 v[20:23], v[212:215], v[208:211], v[20:23]
    ds_read_b128 v[164:167], v10 offset:38912
    v_mfma_f32_16x16x32_bf16 v[24:27], v[216:219], v[204:207], v[24:27]
    ds_read_b128 v[168:171], v2 offset:36864
    v_mfma_f32_16x16x32_bf16 v[28:31], v[216:219], v[208:211], v[28:31]
    ds_read_b128 v[172:175], v2 offset:37888
    v_mfma_f32_16x16x32_bf16 v[32:35], v[220:223], v[204:207], v[32:35]
    ds_read_b128 v[176:179], v2 offset:38912
    v_mfma_f32_16x16x32_bf16 v[36:39], v[220:223], v[208:211], v[36:39]
    ds_read_b128 v[180:183], v2 offset:39936
    v_mfma_f32_16x16x32_bf16 v[40:43], v[224:227], v[204:207], v[40:43]
    ds_read_b128 v[184:187], v2 offset:40960
    v_mfma_f32_16x16x32_bf16 v[44:47], v[224:227], v[208:211], v[44:47]
    ds_read_b128 v[188:191], v2 offset:41984
    v_mfma_f32_16x16x32_bf16 v[48:51], v[228:231], v[204:207], v[48:51]
    ds_read_b128 v[192:195], v2 offset:43008
    v_mfma_f32_16x16x32_bf16 v[52:55], v[228:231], v[208:211], v[52:55]
    ds_read_b128 v[196:199], v2 offset:44032
    v_mfma_f32_16x16x32_bf16 v[56:59], v[232:235], v[204:207], v[56:59]
    ds_read_b128 v[200:203], v2 offset:45056
    v_mfma_f32_16x16x32_bf16 v[60:63], v[232:235], v[208:211], v[60:63]
    v_mfma_f32_16x16x32_bf16 v[64:67], v[236:239], v[204:207], v[64:67]
    v_mfma_f32_16x16x32_bf16 v[68:71], v[236:239], v[208:211], v[68:71]
    v_mfma_f32_16x16x32_bf16 v[72:75], v[240:243], v[204:207], v[72:75]
    v_mfma_f32_16x16x32_bf16 v[76:79], v[240:243], v[208:211], v[76:79]
    v_mfma_f32_16x16x32_bf16 v[80:83], v[244:247], v[204:207], v[80:83]
    v_mfma_f32_16x16x32_bf16 v[84:87], v[244:247], v[208:211], v[84:87]
    s_waitcnt lgkmcnt(5)
    v_mfma_f32_16x16x32_bf16 v[16:19], v[168:171], v[160:163], v[16:19]
    ds_read_b128 v[204:207], v11 offset:36864
    v_mfma_f32_16x16x32_bf16 v[20:23], v[168:171], v[164:167], v[20:23]
    ds_read_b128 v[208:211], v11 offset:38912
    v_mfma_f32_16x16x32_bf16 v[24:27], v[172:175], v[160:163], v[24:27]
    ds_read_b128 v[212:215], v2 offset:46080
    v_mfma_f32_16x16x32_bf16 v[28:31], v[172:175], v[164:167], v[28:31]
    ds_read_b128 v[216:219], v2 offset:47104
    v_mfma_f32_16x16x32_bf16 v[32:35], v[176:179], v[160:163], v[32:35]
    ds_read_b128 v[220:223], v2 offset:48128
    v_mfma_f32_16x16x32_bf16 v[36:39], v[176:179], v[164:167], v[36:39]
    ds_read_b128 v[224:227], v2 offset:49152
    v_mfma_f32_16x16x32_bf16 v[40:43], v[180:183], v[160:163], v[40:43]
    ds_read_b128 v[228:231], v2 offset:50176
    v_mfma_f32_16x16x32_bf16 v[44:47], v[180:183], v[164:167], v[44:47]
    ds_read_b128 v[232:235], v2 offset:51200
    s_waitcnt lgkmcnt(8)
    v_mfma_f32_16x16x32_bf16 v[48:51], v[184:187], v[160:163], v[48:51]
    ds_read_b128 v[236:239], v2 offset:52224
    v_mfma_f32_16x16x32_bf16 v[52:55], v[184:187], v[164:167], v[52:55]
    ds_read_b128 v[240:243], v2 offset:53248
    v_mfma_f32_16x16x32_bf16 v[56:59], v[188:191], v[160:163], v[56:59]
    ds_read_b128 v[244:247], v2 offset:54272
    v_mfma_f32_16x16x32_bf16 v[60:63], v[188:191], v[164:167], v[60:63]
    v_mfma_f32_16x16x32_bf16 v[64:67], v[192:195], v[160:163], v[64:67]
    v_mfma_f32_16x16x32_bf16 v[68:71], v[192:195], v[164:167], v[68:71]
    v_mfma_f32_16x16x32_bf16 v[72:75], v[196:199], v[160:163], v[72:75]
    v_mfma_f32_16x16x32_bf16 v[76:79], v[196:199], v[164:167], v[76:79]
    v_mfma_f32_16x16x32_bf16 v[80:83], v[200:203], v[160:163], v[80:83]
    v_mfma_f32_16x16x32_bf16 v[84:87], v[200:203], v[164:167], v[84:87]
    s_waitcnt lgkmcnt(0)
    s_barrier
    v_mfma_f32_16x16x32_bf16 v[16:19], v[212:215], v[204:207], v[16:19]
    ds_read_b128 v[160:163], v8 offset:0
    v_mfma_f32_16x16x32_bf16 v[20:23], v[212:215], v[208:211], v[20:23]
    ds_read_b128 v[164:167], v8 offset:2048
    v_mfma_f32_16x16x32_bf16 v[24:27], v[216:219], v[204:207], v[24:27]
    ds_read_b128 v[192:195], v1 offset:0
    v_mfma_f32_16x16x32_bf16 v[28:31], v[216:219], v[208:211], v[28:31]
    ds_read_b128 v[168:171], v9 offset:0
    v_mfma_f32_16x16x32_bf16 v[32:35], v[220:223], v[204:207], v[32:35]
    ds_read_b128 v[172:175], v9 offset:2048
    v_mfma_f32_16x16x32_bf16 v[36:39], v[220:223], v[208:211], v[36:39]
    ds_read_b128 v[176:179], v8 offset:36864
    v_mfma_f32_16x16x32_bf16 v[40:43], v[224:227], v[204:207], v[40:43]
    ds_read_b128 v[180:183], v8 offset:38912
    v_mfma_f32_16x16x32_bf16 v[44:47], v[224:227], v[208:211], v[44:47]
    ds_read_b128 v[184:187], v9 offset:36864
    v_mfma_f32_16x16x32_bf16 v[48:51], v[228:231], v[204:207], v[48:51]
    ds_read_b128 v[188:191], v9 offset:38912
    v_mfma_f32_16x16x32_bf16 v[52:55], v[228:231], v[208:211], v[52:55]
    ds_read_b128 v[196:199], v1 offset:9216
    v_mfma_f32_16x16x32_bf16 v[56:59], v[232:235], v[204:207], v[56:59]
    ds_read_b128 v[200:203], v1 offset:36864
    v_mfma_f32_16x16x32_bf16 v[60:63], v[232:235], v[208:211], v[60:63]
    v_mfma_f32_16x16x32_bf16 v[64:67], v[236:239], v[204:207], v[64:67]
    v_mfma_f32_16x16x32_bf16 v[68:71], v[236:239], v[208:211], v[68:71]
    v_mfma_f32_16x16x32_bf16 v[72:75], v[240:243], v[204:207], v[72:75]
    v_mfma_f32_16x16x32_bf16 v[76:79], v[240:243], v[208:211], v[76:79]
    v_mfma_f32_16x16x32_bf16 v[80:83], v[244:247], v[204:207], v[80:83]
    v_mfma_f32_16x16x32_bf16 v[84:87], v[244:247], v[208:211], v[84:87]
    s_waitcnt lgkmcnt(0)
    v_mfma_f32_16x16x32_bf16 v[16:19], v[192:195], v[160:163], v[16:19]
    ds_read_b128 v[204:207], v1 offset:46080
    v_mfma_f32_16x16x32_bf16 v[20:23], v[192:195], v[164:167], v[20:23]
    ds_read_b128 v[208:211], v1 offset:1024
    s_waitcnt lgkmcnt(3)
    v_mfma_f32_16x16x32_bf16 v[16:19], v[196:199], v[168:171], v[16:19]
    ds_read_b128 v[212:215], v1 offset:10240
    v_mfma_f32_16x16x32_bf16 v[20:23], v[196:199], v[172:175], v[20:23]
    ds_read_b128 v[216:219], v1 offset:37888
    s_waitcnt lgkmcnt(4)
    v_mfma_f32_16x16x32_bf16 v[16:19], v[200:203], v[176:179], v[16:19]
    ds_read_b128 v[220:223], v1 offset:47104
    v_mfma_f32_16x16x32_bf16 v[20:23], v[200:203], v[180:183], v[20:23]
    ds_read_b128 v[224:227], v1 offset:2048
    s_waitcnt lgkmcnt(5)
    v_mfma_f32_16x16x32_bf16 v[16:19], v[204:207], v[184:187], v[16:19]
    ds_read_b128 v[228:231], v1 offset:11264
    v_mfma_f32_16x16x32_bf16 v[20:23], v[204:207], v[188:191], v[20:23]
    ds_read_b128 v[232:235], v1 offset:38912
    s_waitcnt lgkmcnt(6)
    v_mfma_f32_16x16x32_bf16 v[24:27], v[208:211], v[160:163], v[24:27]
    ds_read_b128 v[236:239], v1 offset:48128
    v_mfma_f32_16x16x32_bf16 v[28:31], v[208:211], v[164:167], v[28:31]
    ds_read_b128 v[240:243], v1 offset:3072
    s_waitcnt lgkmcnt(7)
    v_mfma_f32_16x16x32_bf16 v[24:27], v[212:215], v[168:171], v[24:27]
    ds_read_b128 v[244:247], v1 offset:12288
    v_mfma_f32_16x16x32_bf16 v[28:31], v[212:215], v[172:175], v[28:31]
    s_waitcnt lgkmcnt(7)
    v_mfma_f32_16x16x32_bf16 v[24:27], v[216:219], v[176:179], v[24:27]
    ds_read_b128 v[192:195], v1 offset:39936
    v_mul_f32 v16, v16, v88
    v_mfma_f32_16x16x32_bf16 v[28:31], v[216:219], v[180:183], v[28:31]
    v_mul_f32 v17, v17, v89
    v_mul_f32 v18, v18, v90
    s_waitcnt lgkmcnt(7)
    v_mfma_f32_16x16x32_bf16 v[24:27], v[220:223], v[184:187], v[24:27]
    ds_read_b128 v[196:199], v1 offset:49152
    v_mul_f32 v19, v19, v91
    v_mfma_f32_16x16x32_bf16 v[28:31], v[220:223], v[188:191], v[28:31]
    v_cvt_pk_bf16_f32 v88, v16, v17
    v_cvt_pk_bf16_f32 v89, v18, v19
    s_waitcnt lgkmcnt(7)
    v_mfma_f32_16x16x32_bf16 v[32:35], v[224:227], v[160:163], v[32:35]
    ds_read_b128 v[200:203], v1 offset:4096
    v_mul_f32 v20, v20, v92
    v_mfma_f32_16x16x32_bf16 v[36:39], v[224:227], v[164:167], v[36:39]
    v_mul_f32 v21, v21, v93
    v_mul_f32 v22, v22, v94
    s_waitcnt lgkmcnt(7)
    v_mfma_f32_16x16x32_bf16 v[32:35], v[228:231], v[168:171], v[32:35]
    ds_read_b128 v[204:207], v1 offset:13312
    v_mul_f32 v23, v23, v95
    v_mfma_f32_16x16x32_bf16 v[36:39], v[228:231], v[172:175], v[36:39]
    v_cvt_pk_bf16_f32 v92, v20, v21
    v_cvt_pk_bf16_f32 v93, v22, v23
    s_waitcnt lgkmcnt(7)
    v_mfma_f32_16x16x32_bf16 v[32:35], v[232:235], v[176:179], v[32:35]
    ds_read_b128 v[208:211], v1 offset:40960
    v_mul_f32 v24, v24, v96
    v_mfma_f32_16x16x32_bf16 v[36:39], v[232:235], v[180:183], v[36:39]
    v_mul_f32 v25, v25, v97
    v_mul_f32 v26, v26, v98
    v_mul_f32 v27, v27, v99
    s_waitcnt lgkmcnt(7)
    v_mfma_f32_16x16x32_bf16 v[32:35], v[236:239], v[184:187], v[32:35]
    ds_read_b128 v[212:215], v1 offset:50176
    v_cvt_pk_bf16_f32 v90, v24, v25
    v_mfma_f32_16x16x32_bf16 v[36:39], v[236:239], v[188:191], v[36:39]
    v_cvt_pk_bf16_f32 v91, v26, v27
    buffer_store_dwordx4 v[88:91], v14, s[4:7], s39 offen sc1
    s_waitcnt lgkmcnt(7)
    v_mfma_f32_16x16x32_bf16 v[40:43], v[240:243], v[160:163], v[40:43]
    ds_read_b128 v[216:219], v1 offset:5120
    v_mul_f32 v28, v28, v100
    v_mfma_f32_16x16x32_bf16 v[44:47], v[240:243], v[164:167], v[44:47]
    v_mul_f32 v29, v29, v101
    v_mul_f32 v30, v30, v102
    s_waitcnt lgkmcnt(7)
    v_mfma_f32_16x16x32_bf16 v[40:43], v[244:247], v[168:171], v[40:43]
    ds_read_b128 v[220:223], v1 offset:14336
    v_mul_f32 v31, v31, v103
    v_mfma_f32_16x16x32_bf16 v[44:47], v[244:247], v[172:175], v[44:47]
    v_cvt_pk_bf16_f32 v94, v28, v29
    v_cvt_pk_bf16_f32 v95, v30, v31
    s_waitcnt lgkmcnt(7)
    v_mfma_f32_16x16x32_bf16 v[40:43], v[192:195], v[176:179], v[40:43]
    ds_read_b128 v[224:227], v1 offset:41984
    buffer_store_dwordx4 v[92:95], v14, s[4:7], s40 offen sc1
    v_mfma_f32_16x16x32_bf16 v[44:47], v[192:195], v[180:183], v[44:47]
    v_add_u32 v14, 16384, v14
    v_mul_f32 v32, v32, v104
    v_mul_f32 v33, v33, v105
    s_waitcnt lgkmcnt(7)
    v_mfma_f32_16x16x32_bf16 v[40:43], v[196:199], v[184:187], v[40:43]
    ds_read_b128 v[228:231], v1 offset:51200
    v_mul_f32 v34, v34, v106
    v_mfma_f32_16x16x32_bf16 v[44:47], v[196:199], v[188:191], v[44:47]
    v_mul_f32 v35, v35, v107
    v_cvt_pk_bf16_f32 v104, v32, v33
    s_waitcnt lgkmcnt(7)
    v_mfma_f32_16x16x32_bf16 v[48:51], v[200:203], v[160:163], v[48:51]
    ds_read_b128 v[232:235], v1 offset:6144
    v_cvt_pk_bf16_f32 v105, v34, v35
    v_mfma_f32_16x16x32_bf16 v[52:55], v[200:203], v[164:167], v[52:55]
    v_mul_f32 v36, v36, v108
    v_mul_f32 v37, v37, v109
    s_waitcnt lgkmcnt(7)
    v_mfma_f32_16x16x32_bf16 v[48:51], v[204:207], v[168:171], v[48:51]
    ds_read_b128 v[236:239], v1 offset:15360
    v_mul_f32 v38, v38, v110
    v_mfma_f32_16x16x32_bf16 v[52:55], v[204:207], v[172:175], v[52:55]
    v_mul_f32 v39, v39, v111
    v_cvt_pk_bf16_f32 v108, v36, v37
    s_waitcnt lgkmcnt(7)
    v_mfma_f32_16x16x32_bf16 v[48:51], v[208:211], v[176:179], v[48:51]
    ds_read_b128 v[240:243], v1 offset:43008
    v_cvt_pk_bf16_f32 v109, v38, v39
    v_mfma_f32_16x16x32_bf16 v[52:55], v[208:211], v[180:183], v[52:55]
    v_mul_f32 v40, v40, v112
    v_mul_f32 v41, v41, v113
    v_mul_f32 v42, v42, v114
    s_waitcnt lgkmcnt(7)
    v_mfma_f32_16x16x32_bf16 v[48:51], v[212:215], v[184:187], v[48:51]
    ds_read_b128 v[244:247], v1 offset:52224
    v_mul_f32 v43, v43, v115
    v_mfma_f32_16x16x32_bf16 v[52:55], v[212:215], v[188:191], v[52:55]
    v_cvt_pk_bf16_f32 v106, v40, v41
    v_cvt_pk_bf16_f32 v107, v42, v43
    s_waitcnt lgkmcnt(7)
    v_mfma_f32_16x16x32_bf16 v[56:59], v[216:219], v[160:163], v[56:59]
    ds_read_b128 v[192:195], v1 offset:7168
    buffer_store_dwordx4 v[104:107], v14, s[4:7], s39 offen sc1
    v_mfma_f32_16x16x32_bf16 v[60:63], v[216:219], v[164:167], v[60:63]
    v_mul_f32 v44, v44, v116
    v_mul_f32 v45, v45, v117
    s_waitcnt lgkmcnt(7)
    v_mfma_f32_16x16x32_bf16 v[56:59], v[220:223], v[168:171], v[56:59]
    ds_read_b128 v[196:199], v1 offset:16384
    v_mul_f32 v46, v46, v118
    v_mfma_f32_16x16x32_bf16 v[60:63], v[220:223], v[172:175], v[60:63]
    v_mul_f32 v47, v47, v119
    v_cvt_pk_bf16_f32 v110, v44, v45
    s_waitcnt lgkmcnt(7)
    v_mfma_f32_16x16x32_bf16 v[56:59], v[224:227], v[176:179], v[56:59]
    ds_read_b128 v[200:203], v1 offset:44032
    v_cvt_pk_bf16_f32 v111, v46, v47
    v_mfma_f32_16x16x32_bf16 v[60:63], v[224:227], v[180:183], v[60:63]
    buffer_store_dwordx4 v[108:111], v14, s[4:7], s40 offen sc1
    v_add_u32 v14, 16384, v14
    v_mul_f32 v48, v48, v120
    s_waitcnt lgkmcnt(7)
    v_mfma_f32_16x16x32_bf16 v[56:59], v[228:231], v[184:187], v[56:59]
    ds_read_b128 v[204:207], v1 offset:53248
    v_mul_f32 v49, v49, v121
    v_mfma_f32_16x16x32_bf16 v[60:63], v[228:231], v[188:191], v[60:63]
    v_mul_f32 v50, v50, v122
    v_mul_f32 v51, v51, v123
    s_waitcnt lgkmcnt(7)
    v_mfma_f32_16x16x32_bf16 v[64:67], v[232:235], v[160:163], v[64:67]
    ds_read_b128 v[208:211], v1 offset:8192
    v_cvt_pk_bf16_f32 v120, v48, v49
    v_mfma_f32_16x16x32_bf16 v[68:71], v[232:235], v[164:167], v[68:71]
    v_cvt_pk_bf16_f32 v121, v50, v51
    v_mul_f32 v52, v52, v124
    s_waitcnt lgkmcnt(7)
    v_mfma_f32_16x16x32_bf16 v[64:67], v[236:239], v[168:171], v[64:67]
    ds_read_b128 v[212:215], v1 offset:17408
    v_mul_f32 v53, v53, v125
    v_mfma_f32_16x16x32_bf16 v[68:71], v[236:239], v[172:175], v[68:71]
    v_mul_f32 v54, v54, v126
    v_mul_f32 v55, v55, v127
    s_waitcnt lgkmcnt(7)
    v_mfma_f32_16x16x32_bf16 v[64:67], v[240:243], v[176:179], v[64:67]
    ds_read_b128 v[216:219], v1 offset:45056
    v_cvt_pk_bf16_f32 v124, v52, v53
    v_mfma_f32_16x16x32_bf16 v[68:71], v[240:243], v[180:183], v[68:71]
    v_cvt_pk_bf16_f32 v125, v54, v55
    v_mul_f32 v56, v56, v128
    v_mul_f32 v57, v57, v129
    s_waitcnt lgkmcnt(7)
    v_mfma_f32_16x16x32_bf16 v[64:67], v[244:247], v[184:187], v[64:67]
    ds_read_b128 v[220:223], v1 offset:54272
    v_mul_f32 v58, v58, v130
    v_mfma_f32_16x16x32_bf16 v[68:71], v[244:247], v[188:191], v[68:71]
    v_mul_f32 v59, v59, v131
    v_cvt_pk_bf16_f32 v122, v56, v57
    v_cvt_pk_bf16_f32 v123, v58, v59
    s_waitcnt lgkmcnt(7)
    v_mfma_f32_16x16x32_bf16 v[72:75], v[192:195], v[160:163], v[72:75]
    buffer_store_dwordx4 v[120:123], v14, s[4:7], s39 offen sc1
    v_mul_f32 v60, v60, v132
    v_mfma_f32_16x16x32_bf16 v[76:79], v[192:195], v[164:167], v[76:79]
    v_mul_f32 v61, v61, v133
    v_mul_f32 v62, v62, v134
    s_waitcnt lgkmcnt(6)
    v_mfma_f32_16x16x32_bf16 v[72:75], v[196:199], v[168:171], v[72:75]
    v_mul_f32 v63, v63, v135
    v_cvt_pk_bf16_f32 v126, v60, v61
    v_mfma_f32_16x16x32_bf16 v[76:79], v[196:199], v[172:175], v[76:79]
    v_cvt_pk_bf16_f32 v127, v62, v63
    buffer_store_dwordx4 v[124:127], v14, s[4:7], s40 offen sc1
    s_waitcnt lgkmcnt(5)
    v_mfma_f32_16x16x32_bf16 v[72:75], v[200:203], v[176:179], v[72:75]
    v_add_u32 v14, 16384, v14
    v_mul_f32 v64, v64, v136
    v_mfma_f32_16x16x32_bf16 v[76:79], v[200:203], v[180:183], v[76:79]
    v_mul_f32 v65, v65, v137
    v_mul_f32 v66, v66, v138
    v_mul_f32 v67, v67, v139
    s_waitcnt lgkmcnt(4)
    v_mfma_f32_16x16x32_bf16 v[72:75], v[204:207], v[184:187], v[72:75]
    v_cvt_pk_bf16_f32 v136, v64, v65
    v_cvt_pk_bf16_f32 v137, v66, v67
    v_mfma_f32_16x16x32_bf16 v[76:79], v[204:207], v[188:191], v[76:79]
    v_mul_f32 v68, v68, v140
    v_mul_f32 v69, v69, v141
    s_waitcnt lgkmcnt(3)
    v_mfma_f32_16x16x32_bf16 v[80:83], v[208:211], v[160:163], v[80:83]
    v_mul_f32 v70, v70, v142
    v_mul_f32 v71, v71, v143
    v_mfma_f32_16x16x32_bf16 v[84:87], v[208:211], v[164:167], v[84:87]
    v_cvt_pk_bf16_f32 v140, v68, v69
    v_cvt_pk_bf16_f32 v141, v70, v71
    s_waitcnt lgkmcnt(2)
    v_mfma_f32_16x16x32_bf16 v[80:83], v[212:215], v[168:171], v[80:83]
    v_mfma_f32_16x16x32_bf16 v[84:87], v[212:215], v[172:175], v[84:87]
    s_waitcnt lgkmcnt(1)
    v_mfma_f32_16x16x32_bf16 v[80:83], v[216:219], v[176:179], v[80:83]
    v_mul_f32 v72, v72, v144
    v_mul_f32 v73, v73, v145
    v_mfma_f32_16x16x32_bf16 v[84:87], v[216:219], v[180:183], v[84:87]
    v_mul_f32 v74, v74, v146
    v_mul_f32 v75, v75, v147
    v_cvt_pk_bf16_f32 v138, v72, v73
    s_waitcnt lgkmcnt(0)
    v_mfma_f32_16x16x32_bf16 v[80:83], v[220:223], v[184:187], v[80:83]
    v_cvt_pk_bf16_f32 v139, v74, v75
    buffer_store_dwordx4 v[136:139], v14, s[4:7], s39 offen sc1
    v_mfma_f32_16x16x32_bf16 v[84:87], v[220:223], v[188:191], v[84:87]
    v_mul_f32 v76, v76, v148
    v_mul_f32 v77, v77, v149
    v_mul_f32 v78, v78, v150
    v_mul_f32 v79, v79, v151
    v_cvt_pk_bf16_f32 v142, v76, v77
    v_cvt_pk_bf16_f32 v143, v78, v79
    buffer_store_dwordx4 v[140:143], v14, s[4:7], s40 offen sc1
    s_nop 1
    v_mul_f32 v80, v80, v152
    v_mul_f32 v81, v81, v153
    v_mul_f32 v82, v82, v154
    v_mul_f32 v83, v83, v155
    v_cvt_pk_bf16_f32 v152, v80, v81
    v_cvt_pk_bf16_f32 v153, v82, v83
    v_mul_f32 v84, v84, v156
    v_mul_f32 v85, v85, v157
    v_mul_f32 v86, v86, v158
    v_mul_f32 v87, v87, v159
    v_cvt_pk_bf16_f32 v154, v84, v85
    v_cvt_pk_bf16_f32 v155, v86, v87
    s_bitcmp0_b32 s24, 1
    s_cbranch_scc1 L_g_ns
    v_swap_b32 v152, v154
    v_swap_b32 v153, v155
L_g_ns:
    buffer_store_dwordx4 v[152:155], v15, s[4:7], s39 offen sc1
    s_barrier
    s_and_b32 s25, s2, 7
    s_lshr_b32 s26, s2, 3
    s_lshr_b32 s23, s25, 1
    s_lshl_b32 s23, s23, 3
    s_lshr_b32 s27, s26, 2
    s_add_u32 s23, s23, s27
    s_and_b32 s24, s25, 1
    s_lshl_b32 s24, s24, 2
    s_and_b32 s27, s26, 3
    s_add_u32 s24, s24, s27
    s_add_u32 s25, s23, s24
    s_and_b32 s25, s25, 3
    s_lshl_b32 s30, s23, 2
    s_add_u32 s30, s30, s20
    s_and_b32 s31, s20, 1
    s_mul_i32 s34, s30, 18432
    s_add_u32 s34, s34, s21
    s_add_u32 s34, s34, 0x300000
    s_lshl_b32 s35, s24, 11
    s_lshr_b32 s36, s24, 2
    s_lshl_b32 s36, s36, 10
    s_and_b32 s37, s24, 3
    s_lshl_b32 s37, s37, 8
    s_add_u32 s36, s36, s37
    s_add_u32 s36, s36, 16384
    v_bfe_u32 v2, v1, 4, 4
    v_lshrrev_b32 v3, 8, v1
    v_add_u32 v4, s35, v1
    v_lshrrev_b32 v0, 1, v3
    v_and_b32 v9, 1, v3
    v_cmp_eq_u32 s[40:41], s31, v0
    v_bfrev_b32 v6, 1
    v_lshlrev_b32 v5, 4, v2
    v_lshl_add_u32 v5, v9, 3, v5
    v_add_u32 v5, s36, v5
    v_cndmask_b32 v5, v6, v5, s[40:41]
    buffer_load_dwordx4 v[220:223], v4, s[4:7], s34 offen offset:0 sc1
    buffer_load_dwordx4 v[224:227], v4, s[4:7], s34 offen offset:1024 sc1
    buffer_load_dwordx2 v[228:229], v5, s[4:7], s34 offen sc1
    s_and_b32 s29, s30, 0xfffe
    s_mul_i32 s29, s29, 73728
    s_add_u32 s29, s29, s21
    s_lshl_b32 s37, s31, 10
    s_add_u32 s29, s29, s37
    s_add_u32 s29, s29, 0x1200000
    s_mul_i32 s37, s31, 73728
    s_sub_u32 s38, 73728, s37
    v_lshlrev_b32 v10, 3, v2
    v_add_u32 v16, s37, v1
    v_add_u32 v17, s38, v1
    v_mov_b32 v18, v1
    v_add_u32 v19, 73728, v1
    s_lshl_b32 s37, s31, 12
    v_add_u32 v20, 0, v1
    v_add_u32 v12, s37, v20
    v_add_u32 v21, 36864, v1
    v_add_u32 v13, s37, v21
    v_add_u32 v22, 73728, v1
    v_add_u32 v14, s37, v22
    v_add_u32 v23, 110592, v1
    v_add_u32 v15, s37, v23
    s_add_u32 s34, s34, 0x1900000
    s_lshl_b32 s39, s30, 10
    s_add_u32 s39, s39, s21
    s_lshl_b32 s42, s24, 7
    s_add_u32 s39, s39, s42
    s_add_u32 s39, s39, 0x3700000
    v_cmp_eq_u32 vcc, 0, v3
    v_mov_b32 v11, 0x3f803f80
    s_lshr_b32 s44, s23, 1
    v_cndmask_b32 v10, v6, v10, vcc
    s_cmp_eq_u32 s22, 0
    s_cbranch_scc1 L_p5_nf
    v_mul_u32_u24 v8, 1152, v2
    s_mul_i32 s34, s30, 18432
    s_mul_i32 s42, s24, 144
    s_add_u32 s34, s34, s42
    v_lshl_add_u32 v4, v3, 4, v8
    v_lshl_add_u32 v5, v9, 3, v8
    v_cndmask_b32 v5, v6, v5, s[40:41]
L_p5_nf:
    s_lshl_b32 s52, s22, 7
    s_add_u32 s52, s52, s44
    s_lshl_b32 s52, s52, 8
    s_add_u32 s52, s52, 0x450a000
    s_add_u32 s52, s52, s4
    s_addc_u32 s53, s5, 0
    s_waitcnt vmcnt(3)
    s_barrier
    s_cmp_lg_u32 s20, 0
    s_cbranch_scc1 L_ns_d5
    s_mov_b32 s56, 1
    s_atomic_add s56, s[50:51], 0
L_ns_d5:
    s_mul_i32 s37, s20, 4608
    s_add_u32 s37, s37, 131072
    s_xor_b32 s38, s20, 1
    s_mul_i32 s42, s38, 4608
    s_add_u32 s42, s42, 131072
    v_and_b32 v0, 0x1ff, v1
    v_add_u32 v2, s37, v1
    v_add_u32 v3, s37, v0
    v_add_u32 v7, s42, v1
    v_add_u32 v8, s42, v0
    s_lshl_b32 s37, s20, 2
    s_add_u32 s37, s37, 163808
    s_xor_b32 s38, s37, 4
    v_mov_b32 v0, s37
    v_mov_b32 v6, s38
    s_lshl_b32 s43, s22, 1
    s_add_u32 s43, s43, 2
    v_mov_b32 v9, s43
    s_cmp_lg_u32 s20, 0
    s_cbranch_scc1 L_pd_d5
    s_mov_b32 s60, 65536
L_poll_d5:
    s_mov_b32 s57, 0
    s_atomic_add s57, s[52:53], 0 glc
    s_waitcnt lgkmcnt(0)
    s_cmp_ge_u32 s57, 16
    s_cbranch_scc1 L_pd_d5
    s_sub_u32 s60, s60, 1
    s_cbranch_scc1 L_pd_d5
    s_sleep 2
    s_branch L_poll_d5
L_pd_d5:
    s_barrier
    s_mov_b32 s32, 0
    s_lshl_b32 s32, s32, 13
    s_add_u32 s32, s32, s29
    s_add_u32 s33, s32, 4096
    buffer_load_dwordx4 v[124:127], v16, s[4:7], s32 offen offset:0 sc1
    buffer_load_dwordx4 v[128:131], v17, s[4:7], s32 offen offset:0 sc1
    buffer_load_dwordx4 v[132:135], v16, s[4:7], s32 offen offset:2048 sc1
    buffer_load_dwordx4 v[136:139], v17, s[4:7], s32 offen offset:2048 sc1
    buffer_load_dwordx4 v[140:143], v16, s[4:7], s33 offen offset:0 sc1
    buffer_load_dwordx4 v[144:147], v17, s[4:7], s33 offen offset:0 sc1
    buffer_load_dwordx4 v[148:151], v16, s[4:7], s33 offen offset:2048 sc1
    buffer_load_dwordx4 v[152:155], v17, s[4:7], s33 offen offset:2048 sc1
    ds_read_b128 v[64:67], v14 offset:0
    ds_read_b128 v[68:71], v14 offset:1024
    ds_read_b128 v[72:75], v14 offset:2048
    ds_read_b128 v[76:79], v14 offset:3072
    ds_read_b128 v[80:83], v22 offset:8192
    ds_read_b128 v[84:87], v14 offset:9216
    ds_read_b128 v[88:91], v14 offset:10240
    ds_read_b128 v[92:95], v14 offset:11264
    ds_read_b128 v[96:99], v14 offset:12288
    ds_read_b128 v[100:103], v22 offset:17408
    s_add_u32 s45, s29, 8192
    s_add_u32 s46, s29, 12288
    buffer_load_dwordx4 v[156:159], v16, s[4:7], s45 offen offset:0 sc1
    buffer_load_dwordx4 v[160:163], v17, s[4:7], s45 offen offset:0 sc1
    s_lshl_b32 s50, s22, 7
    s_add_u32 s50, s50, s44
    s_lshl_b32 s50, s50, 8
    s_add_u32 s50, s50, 0x450b000
    s_add_u32 s50, s50, s4
    s_addc_u32 s51, s5, 0
    s_waitcnt vmcnt(10)
    v_lshlrev_b32 v24, 16, v220
    v_and_b32 v25, 0xffff0000, v220
    v_lshlrev_b32 v26, 16, v221
    v_and_b32 v27, 0xffff0000, v221
    v_lshlrev_b32 v28, 16, v222
    v_and_b32 v29, 0xffff0000, v222
    v_lshlrev_b32 v30, 16, v223
    v_and_b32 v31, 0xffff0000, v223
    v_lshlrev_b32 v32, 16, v224
    v_and_b32 v33, 0xffff0000, v224
    v_lshlrev_b32 v34, 16, v225
    v_and_b32 v35, 0xffff0000, v225
    v_lshlrev_b32 v36, 16, v226
    v_and_b32 v37, 0xffff0000, v226
    v_lshlrev_b32 v38, 16, v227
    v_and_b32 v39, 0xffff0000, v227
    v_lshlrev_b32 v40, 16, v228
    v_and_b32 v41, 0xffff0000, v228
    v_lshlrev_b32 v42, 16, v229
    v_and_b32 v43, 0xffff0000, v229
    s_waitcnt vmcnt(8) lgkmcnt(5)
    v_mfma_f32_16x16x32_bf16 v[44:47], v[64:67], v[128:131], 0
    ds_read_b128 v[104:107], v14 offset:18432
    s_mov_b32 s32, 2
    s_lshl_b32 s32, s32, 13
    s_add_u32 s32, s32, s29
    s_add_u32 s33, s32, 4096
    v_mfma_f32_16x16x32_bf16 v[24:27], v[64:67], v[124:127], v[24:27]
    ds_read_b128 v[108:111], v14 offset:19456
    buffer_load_dwordx4 v[164:167], v16, s[4:7], s45 offen offset:2048 sc1
    v_mfma_f32_16x16x32_bf16 v[48:51], v[68:71], v[128:131], 0
    ds_read_b128 v[112:115], v14 offset:20480
    v_mfma_f32_16x16x32_bf16 v[28:31], v[68:71], v[124:127], v[28:31]
    ds_read_b128 v[116:119], v14 offset:21504
    buffer_load_dwordx4 v[168:171], v17, s[4:7], s45 offen offset:2048 sc1
    v_mfma_f32_16x16x32_bf16 v[52:55], v[72:75], v[128:131], 0
    ds_read_b128 v[120:123], v22 offset:26624
    v_mfma_f32_16x16x32_bf16 v[32:35], v[72:75], v[124:127], v[32:35]
    buffer_load_dwordx4 v[188:191], v16, s[4:7], s32 offen offset:0 sc1
    v_mfma_f32_16x16x32_bf16 v[56:59], v[76:79], v[128:131], 0
    v_mfma_f32_16x16x32_bf16 v[36:39], v[76:79], v[124:127], v[36:39]
    buffer_load_dwordx4 v[192:195], v17, s[4:7], s32 offen offset:0 sc1
    v_mfma_f32_16x16x32_bf16 v[60:63], v[80:83], v[128:131], 0
    v_mfma_f32_16x16x32_bf16 v[40:43], v[80:83], v[124:127], v[40:43]
    s_waitcnt vmcnt(10) lgkmcnt(5)
    v_mfma_f32_16x16x32_bf16 v[44:47], v[84:87], v[136:139], v[44:47]
    ds_read_b128 v[64:67], v14 offset:27648
    v_mfma_f32_16x16x32_bf16 v[24:27], v[84:87], v[132:135], v[24:27]
    ds_read_b128 v[68:71], v14 offset:28672
    buffer_load_dwordx4 v[172:175], v16, s[4:7], s46 offen offset:0 sc1
    v_mfma_f32_16x16x32_bf16 v[48:51], v[88:91], v[136:139], v[48:51]
    ds_read_b128 v[72:75], v14 offset:29696
    v_mfma_f32_16x16x32_bf16 v[28:31], v[88:91], v[132:135], v[28:31]
    ds_read_b128 v[76:79], v14 offset:30720
    buffer_load_dwordx4 v[176:179], v17, s[4:7], s46 offen offset:0 sc1
    v_mfma_f32_16x16x32_bf16 v[52:55], v[92:95], v[136:139], v[52:55]
    ds_read_b128 v[80:83], v22 offset:35840
    v_mfma_f32_16x16x32_bf16 v[32:35], v[92:95], v[132:135], v[32:35]
    buffer_load_dwordx4 v[196:199], v16, s[4:7], s32 offen offset:2048 sc1
    v_mfma_f32_16x16x32_bf16 v[56:59], v[96:99], v[136:139], v[56:59]
    v_mfma_f32_16x16x32_bf16 v[36:39], v[96:99], v[132:135], v[36:39]
    buffer_load_dwordx4 v[200:203], v17, s[4:7], s32 offen offset:2048 sc1
    v_mfma_f32_16x16x32_bf16 v[60:63], v[100:103], v[136:139], v[60:63]
    v_mfma_f32_16x16x32_bf16 v[40:43], v[100:103], v[132:135], v[40:43]
    s_waitcnt vmcnt(12) lgkmcnt(0)
    s_barrier
    v_mfma_f32_16x16x32_bf16 v[44:47], v[104:107], v[144:147], v[44:47]
    ds_read_b128 v[84:87], v15 offset:0
    v_mfma_f32_16x16x32_bf16 v[24:27], v[104:107], v[140:143], v[24:27]
    ds_read_b128 v[88:91], v15 offset:1024
    buffer_load_dwordx4 v[180:183], v16, s[4:7], s46 offen offset:2048 sc1
    v_mfma_f32_16x16x32_bf16 v[48:51], v[108:111], v[144:147], v[48:51]
    ds_read_b128 v[92:95], v15 offset:2048
    v_mfma_f32_16x16x32_bf16 v[28:31], v[108:111], v[140:143], v[28:31]
    ds_read_b128 v[96:99], v15 offset:3072
    buffer_load_dwordx4 v[184:187], v17, s[4:7], s46 offen offset:2048 sc1
    v_mfma_f32_16x16x32_bf16 v[52:55], v[112:115], v[144:147], v[52:55]
    ds_read_b128 v[100:103], v23 offset:8192
    v_mfma_f32_16x16x32_bf16 v[32:35], v[112:115], v[140:143], v[32:35]
    buffer_load_dwordx4 v[204:207], v16, s[4:7], s33 offen offset:0 sc1
    v_mfma_f32_16x16x32_bf16 v[56:59], v[116:119], v[144:147], v[56:59]
    v_mfma_f32_16x16x32_bf16 v[36:39], v[116:119], v[140:143], v[36:39]
    buffer_load_dwordx4 v[208:211], v17, s[4:7], s33 offen offset:0 sc1
    v_mfma_f32_16x16x32_bf16 v[60:63], v[120:123], v[144:147], v[60:63]
    v_mfma_f32_16x16x32_bf16 v[40:43], v[120:123], v[140:143], v[40:43]
    s_waitcnt vmcnt(14) lgkmcnt(5)
    v_mfma_f32_16x16x32_bf16 v[44:47], v[64:67], v[152:155], v[44:47]
    ds_read_b128 v[104:107], v15 offset:9216
    v_mfma_f32_16x16x32_bf16 v[24:27], v[64:67], v[148:151], v[24:27]
    ds_read_b128 v[108:111], v15 offset:10240
    v_mfma_f32_16x16x32_bf16 v[48:51], v[68:71], v[152:155], v[48:51]
    ds_read_b128 v[112:115], v15 offset:11264
    v_mfma_f32_16x16x32_bf16 v[28:31], v[68:71], v[148:151], v[28:31]
    ds_read_b128 v[116:119], v15 offset:12288
    v_mfma_f32_16x16x32_bf16 v[52:55], v[72:75], v[152:155], v[52:55]
    ds_read_b128 v[120:123], v23 offset:17408
    v_mfma_f32_16x16x32_bf16 v[32:35], v[72:75], v[148:151], v[32:35]
    buffer_load_dwordx4 v[212:215], v16, s[4:7], s33 offen offset:2048 sc1
    v_mfma_f32_16x16x32_bf16 v[56:59], v[76:79], v[152:155], v[56:59]
    v_mfma_f32_16x16x32_bf16 v[36:39], v[76:79], v[148:151], v[36:39]
    buffer_load_dwordx4 v[216:219], v17, s[4:7], s33 offen offset:2048 sc1
    v_mfma_f32_16x16x32_bf16 v[60:63], v[80:83], v[152:155], v[60:63]
    v_mfma_f32_16x16x32_bf16 v[40:43], v[80:83], v[148:151], v[40:43]
    s_waitcnt vmcnt(14) lgkmcnt(5)
    v_mfma_f32_16x16x32_bf16 v[44:47], v[84:87], v[160:163], v[44:47]
    ds_read_b128 v[64:67], v15 offset:18432
    s_mov_b32 s32, 3
    s_lshl_b32 s32, s32, 13
    s_add_u32 s32, s32, s29
    s_add_u32 s33, s32, 4096
    v_mfma_f32_16x16x32_bf16 v[24:27], v[84:87], v[156:159], v[24:27]
    ds_read_b128 v[68:71], v15 offset:19456
    v_mfma_f32_16x16x32_bf16 v[48:51], v[88:91], v[160:163], v[48:51]
    ds_read_b128 v[72:75], v15 offset:20480
    v_mfma_f32_16x16x32_bf16 v[28:31], v[88:91], v[156:159], v[28:31]
    ds_read_b128 v[76:79], v15 offset:21504
    v_mfma_f32_16x16x32_bf16 v[52:55], v[92:95], v[160:163], v[52:55]
    ds_read_b128 v[80:83], v23 offset:26624
    v_mfma_f32_16x16x32_bf16 v[32:35], v[92:95], v[156:159], v[32:35]
    buffer_load_dwordx4 v[124:127], v16, s[4:7], s32 offen offset:0 sc1
    v_mfma_f32_16x16x32_bf16 v[56:59], v[96:99], v[160:163], v[56:59]
    v_mfma_f32_16x16x32_bf16 v[36:39], v[96:99], v[156:159], v[36:39]
    buffer_load_dwordx4 v[128:131], v17, s[4:7], s32 offen offset:0 sc1
    v_mfma_f32_16x16x32_bf16 v[60:63], v[100:103], v[160:163], v[60:63]
    v_mfma_f32_16x16x32_bf16 v[40:43], v[100:103], v[156:159], v[40:43]
    s_waitcnt vmcnt(14) lgkmcnt(5)
    v_mfma_f32_16x16x32_bf16 v[44:47], v[104:107], v[168:171], v[44:47]
    ds_read_b128 v[84:87], v15 offset:27648
    v_mfma_f32_16x16x32_bf16 v[24:27], v[104:107], v[164:167], v[24:27]
    ds_read_b128 v[88:91], v15 offset:28672
    v_mfma_f32_16x16x32_bf16 v[48:51], v[108:111], v[168:171], v[48:51]
    ds_read_b128 v[92:95], v15 offset:29696
    v_mfma_f32_16x16x32_bf16 v[28:31], v[108:111], v[164:167], v[28:31]
    ds_read_b128 v[96:99], v15 offset:30720
    v_mfma_f32_16x16x32_bf16 v[52:55], v[112:115], v[168:171], v[52:55]
    ds_read_b128 v[100:103], v23 offset:35840
    v_mfma_f32_16x16x32_bf16 v[32:35], v[112:115], v[164:167], v[32:35]
    buffer_load_dwordx4 v[132:135], v16, s[4:7], s32 offen offset:2048 sc1
    v_mfma_f32_16x16x32_bf16 v[56:59], v[116:119], v[168:171], v[56:59]
    v_mfma_f32_16x16x32_bf16 v[36:39], v[116:119], v[164:167], v[36:39]
    buffer_load_dwordx4 v[136:139], v17, s[4:7], s32 offen offset:2048 sc1
    v_mfma_f32_16x16x32_bf16 v[60:63], v[120:123], v[168:171], v[60:63]
    v_mfma_f32_16x16x32_bf16 v[40:43], v[120:123], v[164:167], v[40:43]
    s_waitcnt vmcnt(12) lgkmcnt(0)
    s_barrier
    v_mfma_f32_16x16x32_bf16 v[44:47], v[64:67], v[176:179], v[44:47]
    ds_read_b128 v[104:107], v12 offset:0
    v_mfma_f32_16x16x32_bf16 v[24:27], v[64:67], v[172:175], v[24:27]
    ds_read_b128 v[108:111], v12 offset:1024
    v_mfma_f32_16x16x32_bf16 v[48:51], v[68:71], v[176:179], v[48:51]
    ds_read_b128 v[112:115], v12 offset:2048
    v_mfma_f32_16x16x32_bf16 v[28:31], v[68:71], v[172:175], v[28:31]
    ds_read_b128 v[116:119], v12 offset:3072
    v_mfma_f32_16x16x32_bf16 v[52:55], v[72:75], v[176:179], v[52:55]
    ds_read_b128 v[120:123], v20 offset:8192
    v_mfma_f32_16x16x32_bf16 v[32:35], v[72:75], v[172:175], v[32:35]
    buffer_load_dwordx4 v[140:143], v16, s[4:7], s33 offen offset:0 sc1
    v_mfma_f32_16x16x32_bf16 v[56:59], v[76:79], v[176:179], v[56:59]
    v_mfma_f32_16x16x32_bf16 v[36:39], v[76:79], v[172:175], v[36:39]
    buffer_load_dwordx4 v[144:147], v17, s[4:7], s33 offen offset:0 sc1
    v_mfma_f32_16x16x32_bf16 v[60:63], v[80:83], v[176:179], v[60:63]
    v_mfma_f32_16x16x32_bf16 v[40:43], v[80:83], v[172:175], v[40:43]
    s_waitcnt vmcnt(10) lgkmcnt(5)
    v_mfma_f32_16x16x32_bf16 v[44:47], v[84:87], v[184:187], v[44:47]
    ds_read_b128 v[64:67], v12 offset:9216
    v_mfma_f32_16x16x32_bf16 v[24:27], v[84:87], v[180:183], v[24:27]
    ds_read_b128 v[68:71], v12 offset:10240
    v_mfma_f32_16x16x32_bf16 v[48:51], v[88:91], v[184:187], v[48:51]
    ds_read_b128 v[72:75], v12 offset:11264
    v_mfma_f32_16x16x32_bf16 v[28:31], v[88:91], v[180:183], v[28:31]
    ds_read_b128 v[76:79], v12 offset:12288
    v_mfma_f32_16x16x32_bf16 v[52:55], v[92:95], v[184:187], v[52:55]
    ds_read_b128 v[80:83], v20 offset:17408
    v_mfma_f32_16x16x32_bf16 v[32:35], v[92:95], v[180:183], v[32:35]
    buffer_load_dwordx4 v[148:151], v16, s[4:7], s33 offen offset:2048 sc1
    v_mfma_f32_16x16x32_bf16 v[56:59], v[96:99], v[184:187], v[56:59]
    v_mfma_f32_16x16x32_bf16 v[36:39], v[96:99], v[180:183], v[36:39]
    buffer_load_dwordx4 v[152:155], v17, s[4:7], s33 offen offset:2048 sc1
    v_mfma_f32_16x16x32_bf16 v[60:63], v[100:103], v[184:187], v[60:63]
    v_mfma_f32_16x16x32_bf16 v[40:43], v[100:103], v[180:183], v[40:43]
    s_waitcnt vmcnt(12) lgkmcnt(5)
    v_mfma_f32_16x16x32_bf16 v[44:47], v[104:107], v[192:195], v[44:47]
    ds_read_b128 v[84:87], v12 offset:18432
    s_mov_b32 s32, 4
    s_lshl_b32 s32, s32, 13
    s_add_u32 s32, s32, s29
    s_add_u32 s33, s32, 4096
    v_mfma_f32_16x16x32_bf16 v[24:27], v[104:107], v[188:191], v[24:27]
    ds_read_b128 v[88:91], v12 offset:19456
    v_mfma_f32_16x16x32_bf16 v[48:51], v[108:111], v[192:195], v[48:51]
    ds_read_b128 v[92:95], v12 offset:20480
    v_mfma_f32_16x16x32_bf16 v[28:31], v[108:111], v[188:191], v[28:31]
    ds_read_b128 v[96:99], v12 offset:21504
    v_mfma_f32_16x16x32_bf16 v[52:55], v[112:115], v[192:195], v[52:55]
    ds_read_b128 v[100:103], v20 offset:26624
    v_mfma_f32_16x16x32_bf16 v[32:35], v[112:115], v[188:191], v[32:35]
    buffer_load_dwordx4 v[156:159], v16, s[4:7], s32 offen offset:0 sc1
    v_mfma_f32_16x16x32_bf16 v[56:59], v[116:119], v[192:195], v[56:59]
    v_mfma_f32_16x16x32_bf16 v[36:39], v[116:119], v[188:191], v[36:39]
    buffer_load_dwordx4 v[160:163], v17, s[4:7], s32 offen offset:0 sc1
    v_mfma_f32_16x16x32_bf16 v[60:63], v[120:123], v[192:195], v[60:63]
    v_mfma_f32_16x16x32_bf16 v[40:43], v[120:123], v[188:191], v[40:43]
    s_waitcnt vmcnt(14) lgkmcnt(5)
    v_mfma_f32_16x16x32_bf16 v[44:47], v[64:67], v[200:203], v[44:47]
    ds_read_b128 v[104:107], v12 offset:27648
    v_mfma_f32_16x16x32_bf16 v[24:27], v[64:67], v[196:199], v[24:27]
    ds_read_b128 v[108:111], v12 offset:28672
    v_mfma_f32_16x16x32_bf16 v[48:51], v[68:71], v[200:203], v[48:51]
    ds_read_b128 v[112:115], v12 offset:29696
    v_mfma_f32_16x16x32_bf16 v[28:31], v[68:71], v[196:199], v[28:31]
    ds_read_b128 v[116:119], v12 offset:30720
    v_mfma_f32_16x16x32_bf16 v[52:55], v[72:75], v[200:203], v[52:55]
    ds_read_b128 v[120:123], v20 offset:35840
    v_mfma_f32_16x16x32_bf16 v[32:35], v[72:75], v[196:199], v[32:35]
    buffer_load_dwordx4 v[164:167], v16, s[4:7], s32 offen offset:2048 sc1
    v_mfma_f32_16x16x32_bf16 v[56:59], v[76:79], v[200:203], v[56:59]
    v_mfma_f32_16x16x32_bf16 v[36:39], v[76:79], v[196:199], v[36:39]
    buffer_load_dwordx4 v[168:171], v17, s[4:7], s32 offen offset:2048 sc1
    v_mfma_f32_16x16x32_bf16 v[60:63], v[80:83], v[200:203], v[60:63]
    v_mfma_f32_16x16x32_bf16 v[40:43], v[80:83], v[196:199], v[40:43]
    s_waitcnt vmcnt(14) lgkmcnt(0)
    s_barrier
    v_mfma_f32_16x16x32_bf16 v[44:47], v[84:87], v[208:211], v[44:47]
    ds_read_b128 v[64:67], v13 offset:0
    v_mfma_f32_16x16x32_bf16 v[24:27], v[84:87], v[204:207], v[24:27]
    ds_read_b128 v[68:71], v13 offset:1024
    v_mfma_f32_16x16x32_bf16 v[48:51], v[88:91], v[208:211], v[48:51]
    ds_read_b128 v[72:75], v13 offset:2048
    v_mfma_f32_16x16x32_bf16 v[28:31], v[88:91], v[204:207], v[28:31]
    ds_read_b128 v[76:79], v13 offset:3072
    v_mfma_f32_16x16x32_bf16 v[52:55], v[92:95], v[208:211], v[52:55]
    ds_read_b128 v[80:83], v21 offset:8192
    v_mfma_f32_16x16x32_bf16 v[32:35], v[92:95], v[204:207], v[32:35]
    buffer_load_dwordx4 v[172:175], v16, s[4:7], s33 offen offset:0 sc1
    v_mfma_f32_16x16x32_bf16 v[56:59], v[96:99], v[208:211], v[56:59]
    v_mfma_f32_16x16x32_bf16 v[36:39], v[96:99], v[204:207], v[36:39]
    buffer_load_dwordx4 v[176:179], v17, s[4:7], s33 offen offset:0 sc1
    v_mfma_f32_16x16x32_bf16 v[60:63], v[100:103], v[208:211], v[60:63]
    v_mfma_f32_16x16x32_bf16 v[40:43], v[100:103], v[204:207], v[40:43]
    s_waitcnt vmcnt(14) lgkmcnt(5)
    v_mfma_f32_16x16x32_bf16 v[44:47], v[104:107], v[216:219], v[44:47]
    ds_read_b128 v[84:87], v13 offset:9216
    v_mfma_f32_16x16x32_bf16 v[24:27], v[104:107], v[212:215], v[24:27]
    ds_read_b128 v[88:91], v13 offset:10240
    v_mfma_f32_16x16x32_bf16 v[48:51], v[108:111], v[216:219], v[48:51]
    ds_read_b128 v[92:95], v13 offset:11264
    v_mfma_f32_16x16x32_bf16 v[28:31], v[108:111], v[212:215], v[28:31]
    ds_read_b128 v[96:99], v13 offset:12288
    v_mfma_f32_16x16x32_bf16 v[52:55], v[112:115], v[216:219], v[52:55]
    ds_read_b128 v[100:103], v21 offset:17408
    v_mfma_f32_16x16x32_bf16 v[32:35], v[112:115], v[212:215], v[32:35]
    buffer_load_dwordx4 v[180:183], v16, s[4:7], s33 offen offset:2048 sc1
    v_mfma_f32_16x16x32_bf16 v[56:59], v[116:119], v[216:219], v[56:59]
    v_mfma_f32_16x16x32_bf16 v[36:39], v[116:119], v[212:215], v[36:39]
    buffer_load_dwordx4 v[184:187], v17, s[4:7], s33 offen offset:2048 sc1
    v_mfma_f32_16x16x32_bf16 v[60:63], v[120:123], v[216:219], v[60:63]
    v_mfma_f32_16x16x32_bf16 v[40:43], v[120:123], v[212:215], v[40:43]
    s_waitcnt vmcnt(14) lgkmcnt(5)
    v_mfma_f32_16x16x32_bf16 v[44:47], v[64:67], v[128:131], v[44:47]
    ds_read_b128 v[104:107], v13 offset:18432
    s_mov_b32 s32, 5
    s_lshl_b32 s32, s32, 13
    s_add_u32 s32, s32, s29
    s_add_u32 s33, s32, 4096
    v_mfma_f32_16x16x32_bf16 v[24:27], v[64:67], v[124:127], v[24:27]
    ds_read_b128 v[108:111], v13 offset:19456
    v_mfma_f32_16x16x32_bf16 v[48:51], v[68:71], v[128:131], v[48:51]
    ds_read_b128 v[112:115], v13 offset:20480
    v_mfma_f32_16x16x32_bf16 v[28:31], v[68:71], v[124:127], v[28:31]
    ds_read_b128 v[116:119], v13 offset:21504
    v_mfma_f32_16x16x32_bf16 v[52:55], v[72:75], v[128:131], v[52:55]
    ds_read_b128 v[120:123], v21 offset:26624
    v_mfma_f32_16x16x32_bf16 v[32:35], v[72:75], v[124:127], v[32:35]
    buffer_load_dwordx4 v[188:191], v16, s[4:7], s32 offen offset:0 sc1
    v_mfma_f32_16x16x32_bf16 v[56:59], v[76:79], v[128:131], v[56:59]
    v_mfma_f32_16x16x32_bf16 v[36:39], v[76:79], v[124:127], v[36:39]
    buffer_load_dwordx4 v[192:195], v17, s[4:7], s32 offen offset:0 sc1
    v_mfma_f32_16x16x32_bf16 v[60:63], v[80:83], v[128:131], v[60:63]
    v_mfma_f32_16x16x32_bf16 v[40:43], v[80:83], v[124:127], v[40:43]
    s_waitcnt vmcnt(14) lgkmcnt(5)
    v_mfma_f32_16x16x32_bf16 v[44:47], v[84:87], v[136:139], v[44:47]
    ds_read_b128 v[64:67], v13 offset:27648
    v_mfma_f32_16x16x32_bf16 v[24:27], v[84:87], v[132:135], v[24:27]
    ds_read_b128 v[68:71], v13 offset:28672
    v_mfma_f32_16x16x32_bf16 v[48:51], v[88:91], v[136:139], v[48:51]
    ds_read_b128 v[72:75], v13 offset:29696
    v_mfma_f32_16x16x32_bf16 v[28:31], v[88:91], v[132:135], v[28:31]
    ds_read_b128 v[76:79], v13 offset:30720
    v_mfma_f32_16x16x32_bf16 v[52:55], v[92:95], v[136:139], v[52:55]
    ds_read_b128 v[80:83], v21 offset:35840
    v_mfma_f32_16x16x32_bf16 v[32:35], v[92:95], v[132:135], v[32:35]
    buffer_load_dwordx4 v[196:199], v16, s[4:7], s32 offen offset:2048 sc1
    v_mfma_f32_16x16x32_bf16 v[56:59], v[96:99], v[136:139], v[56:59]
    v_mfma_f32_16x16x32_bf16 v[36:39], v[96:99], v[132:135], v[36:39]
    buffer_load_dwordx4 v[200:203], v17, s[4:7], s32 offen offset:2048 sc1
    v_mfma_f32_16x16x32_bf16 v[60:63], v[100:103], v[136:139], v[60:63]
    v_mfma_f32_16x16x32_bf16 v[40:43], v[100:103], v[132:135], v[40:43]
    s_waitcnt vmcnt(14) lgkmcnt(0)
    s_barrier
    v_mfma_f32_16x16x32_bf16 v[44:47], v[104:107], v[144:147], v[44:47]
    ds_read_b128 v[84:87], v14 offset:0
    v_mfma_f32_16x16x32_bf16 v[24:27], v[104:107], v[140:143], v[24:27]
    ds_read_b128 v[88:91], v14 offset:1024
    v_mfma_f32_16x16x32_bf16 v[48:51], v[108:111], v[144:147], v[48:51]
    ds_read_b128 v[92:95], v14 offset:2048
    v_mfma_f32_16x16x32_bf16 v[28:31], v[108:111], v[140:143], v[28:31]
    ds_read_b128 v[96:99], v14 offset:3072
    v_mfma_f32_16x16x32_bf16 v[52:55], v[112:115], v[144:147], v[52:55]
    ds_read_b128 v[100:103], v22 offset:8192
    v_mfma_f32_16x16x32_bf16 v[32:35], v[112:115], v[140:143], v[32:35]
    buffer_load_dwordx4 v[204:207], v16, s[4:7], s33 offen offset:0 sc1
    v_mfma_f32_16x16x32_bf16 v[56:59], v[116:119], v[144:147], v[56:59]
    v_mfma_f32_16x16x32_bf16 v[36:39], v[116:119], v[140:143], v[36:39]
    buffer_load_dwordx4 v[208:211], v17, s[4:7], s33 offen offset:0 sc1
    v_mfma_f32_16x16x32_bf16 v[60:63], v[120:123], v[144:147], v[60:63]
    v_mfma_f32_16x16x32_bf16 v[40:43], v[120:123], v[140:143], v[40:43]
    s_waitcnt vmcnt(14) lgkmcnt(5)
    v_mfma_f32_16x16x32_bf16 v[44:47], v[64:67], v[152:155], v[44:47]
    ds_read_b128 v[104:107], v14 offset:9216
    v_mfma_f32_16x16x32_bf16 v[24:27], v[64:67], v[148:151], v[24:27]
    ds_read_b128 v[108:111], v14 offset:10240
    v_mfma_f32_16x16x32_bf16 v[48:51], v[68:71], v[152:155], v[48:51]
    ds_read_b128 v[112:115], v14 offset:11264
    v_mfma_f32_16x16x32_bf16 v[28:31], v[68:71], v[148:151], v[28:31]
    ds_read_b128 v[116:119], v14 offset:12288
    v_mfma_f32_16x16x32_bf16 v[52:55], v[72:75], v[152:155], v[52:55]
    ds_read_b128 v[120:123], v22 offset:17408
    v_mfma_f32_16x16x32_bf16 v[32:35], v[72:75], v[148:151], v[32:35]
    buffer_load_dwordx4 v[212:215], v16, s[4:7], s33 offen offset:2048 sc1
    v_mfma_f32_16x16x32_bf16 v[56:59], v[76:79], v[152:155], v[56:59]
    v_mfma_f32_16x16x32_bf16 v[36:39], v[76:79], v[148:151], v[36:39]
    buffer_load_dwordx4 v[216:219], v17, s[4:7], s33 offen offset:2048 sc1
    v_mfma_f32_16x16x32_bf16 v[60:63], v[80:83], v[152:155], v[60:63]
    v_mfma_f32_16x16x32_bf16 v[40:43], v[80:83], v[148:151], v[40:43]
    s_waitcnt vmcnt(14) lgkmcnt(5)
    v_mfma_f32_16x16x32_bf16 v[44:47], v[84:87], v[160:163], v[44:47]
    ds_read_b128 v[64:67], v14 offset:18432
    s_mov_b32 s32, 6
    s_lshl_b32 s32, s32, 13
    s_add_u32 s32, s32, s29
    s_add_u32 s33, s32, 4096
    v_mfma_f32_16x16x32_bf16 v[24:27], v[84:87], v[156:159], v[24:27]
    ds_read_b128 v[68:71], v14 offset:19456
    v_mfma_f32_16x16x32_bf16 v[48:51], v[88:91], v[160:163], v[48:51]
    ds_read_b128 v[72:75], v14 offset:20480
    v_mfma_f32_16x16x32_bf16 v[28:31], v[88:91], v[156:159], v[28:31]
    ds_read_b128 v[76:79], v14 offset:21504
    v_mfma_f32_16x16x32_bf16 v[52:55], v[92:95], v[160:163], v[52:55]
    ds_read_b128 v[80:83], v22 offset:26624
    v_mfma_f32_16x16x32_bf16 v[32:35], v[92:95], v[156:159], v[32:35]
    buffer_load_dwordx4 v[124:127], v16, s[4:7], s32 offen offset:0 sc1
    v_mfma_f32_16x16x32_bf16 v[56:59], v[96:99], v[160:163], v[56:59]
    v_mfma_f32_16x16x32_bf16 v[36:39], v[96:99], v[156:159], v[36:39]
    buffer_load_dwordx4 v[128:131], v17, s[4:7], s32 offen offset:0 sc1
    v_mfma_f32_16x16x32_bf16 v[60:63], v[100:103], v[160:163], v[60:63]
    v_mfma_f32_16x16x32_bf16 v[40:43], v[100:103], v[156:159], v[40:43]
    s_waitcnt vmcnt(14) lgkmcnt(5)
    v_mfma_f32_16x16x32_bf16 v[44:47], v[104:107], v[168:171], v[44:47]
    ds_read_b128 v[84:87], v14 offset:27648
    v_mfma_f32_16x16x32_bf16 v[24:27], v[104:107], v[164:167], v[24:27]
    ds_read_b128 v[88:91], v14 offset:28672
    v_mfma_f32_16x16x32_bf16 v[48:51], v[108:111], v[168:171], v[48:51]
    ds_read_b128 v[92:95], v14 offset:29696
    v_mfma_f32_16x16x32_bf16 v[28:31], v[108:111], v[164:167], v[28:31]
    ds_read_b128 v[96:99], v14 offset:30720
    v_mfma_f32_16x16x32_bf16 v[52:55], v[112:115], v[168:171], v[52:55]
    ds_read_b128 v[100:103], v22 offset:35840
    v_mfma_f32_16x16x32_bf16 v[32:35], v[112:115], v[164:167], v[32:35]
    buffer_load_dwordx4 v[132:135], v16, s[4:7], s32 offen offset:2048 sc1
    v_mfma_f32_16x16x32_bf16 v[56:59], v[116:119], v[168:171], v[56:59]
    v_mfma_f32_16x16x32_bf16 v[36:39], v[116:119], v[164:167], v[36:39]
    buffer_load_dwordx4 v[136:139], v17, s[4:7], s32 offen offset:2048 sc1
    v_mfma_f32_16x16x32_bf16 v[60:63], v[120:123], v[168:171], v[60:63]
    v_mfma_f32_16x16x32_bf16 v[40:43], v[120:123], v[164:167], v[40:43]
    s_waitcnt vmcnt(14) lgkmcnt(0)
    s_barrier
    v_mfma_f32_16x16x32_bf16 v[44:47], v[64:67], v[176:179], v[44:47]
    ds_read_b128 v[104:107], v15 offset:0
    v_mfma_f32_16x16x32_bf16 v[24:27], v[64:67], v[172:175], v[24:27]
    ds_read_b128 v[108:111], v15 offset:1024
    v_mfma_f32_16x16x32_bf16 v[48:51], v[68:71], v[176:179], v[48:51]
    ds_read_b128 v[112:115], v15 offset:2048
    v_mfma_f32_16x16x32_bf16 v[28:31], v[68:71], v[172:175], v[28:31]
    ds_read_b128 v[116:119], v15 offset:3072
    v_mfma_f32_16x16x32_bf16 v[52:55], v[72:75], v[176:179], v[52:55]
    ds_read_b128 v[120:123], v23 offset:8192
    v_mfma_f32_16x16x32_bf16 v[32:35], v[72:75], v[172:175], v[32:35]
    buffer_load_dwordx4 v[140:143], v16, s[4:7], s33 offen offset:0 sc1
    v_mfma_f32_16x16x32_bf16 v[56:59], v[76:79], v[176:179], v[56:59]
    v_mfma_f32_16x16x32_bf16 v[36:39], v[76:79], v[172:175], v[36:39]
    buffer_load_dwordx4 v[144:147], v17, s[4:7], s33 offen offset:0 sc1
    v_mfma_f32_16x16x32_bf16 v[60:63], v[80:83], v[176:179], v[60:63]
    v_mfma_f32_16x16x32_bf16 v[40:43], v[80:83], v[172:175], v[40:43]
    s_waitcnt vmcnt(14) lgkmcnt(5)
    v_mfma_f32_16x16x32_bf16 v[44:47], v[84:87], v[184:187], v[44:47]
    ds_read_b128 v[64:67], v15 offset:9216
    v_mfma_f32_16x16x32_bf16 v[24:27], v[84:87], v[180:183], v[24:27]
    ds_read_b128 v[68:71], v15 offset:10240
    v_mfma_f32_16x16x32_bf16 v[48:51], v[88:91], v[184:187], v[48:51]
    ds_read_b128 v[72:75], v15 offset:11264
    v_mfma_f32_16x16x32_bf16 v[28:31], v[88:91], v[180:183], v[28:31]
    ds_read_b128 v[76:79], v15 offset:12288
    v_mfma_f32_16x16x32_bf16 v[52:55], v[92:95], v[184:187], v[52:55]
    ds_read_b128 v[80:83], v23 offset:17408
    v_mfma_f32_16x16x32_bf16 v[32:35], v[92:95], v[180:183], v[32:35]
    buffer_load_dwordx4 v[148:151], v16, s[4:7], s33 offen offset:2048 sc1
    v_mfma_f32_16x16x32_bf16 v[56:59], v[96:99], v[184:187], v[56:59]
    v_mfma_f32_16x16x32_bf16 v[36:39], v[96:99], v[180:183], v[36:39]
    buffer_load_dwordx4 v[152:155], v17, s[4:7], s33 offen offset:2048 sc1
    v_mfma_f32_16x16x32_bf16 v[60:63], v[100:103], v[184:187], v[60:63]
    v_mfma_f32_16x16x32_bf16 v[40:43], v[100:103], v[180:183], v[40:43]
    s_waitcnt vmcnt(14) lgkmcnt(5)
    v_mfma_f32_16x16x32_bf16 v[44:47], v[104:107], v[192:195], v[44:47]
    ds_read_b128 v[84:87], v15 offset:18432
    s_mov_b32 s32, 7
    s_lshl_b32 s32, s32, 13
    s_add_u32 s32, s32, s29
    s_add_u32 s33, s32, 4096
    v_mfma_f32_16x16x32_bf16 v[24:27], v[104:107], v[188:191], v[24:27]
    ds_read_b128 v[88:91], v15 offset:19456
    v_mfma_f32_16x16x32_bf16 v[48:51], v[108:111], v[192:195], v[48:51]
    ds_read_b128 v[92:95], v15 offset:20480
    v_mfma_f32_16x16x32_bf16 v[28:31], v[108:111], v[188:191], v[28:31]
    ds_read_b128 v[96:99], v15 offset:21504
    v_mfma_f32_16x16x32_bf16 v[52:55], v[112:115], v[192:195], v[52:55]
    ds_read_b128 v[100:103], v23 offset:26624
    v_mfma_f32_16x16x32_bf16 v[32:35], v[112:115], v[188:191], v[32:35]
    buffer_load_dwordx4 v[156:159], v16, s[4:7], s32 offen offset:0 sc1
    v_mfma_f32_16x16x32_bf16 v[56:59], v[116:119], v[192:195], v[56:59]
    v_mfma_f32_16x16x32_bf16 v[36:39], v[116:119], v[188:191], v[36:39]
    buffer_load_dwordx4 v[160:163], v17, s[4:7], s32 offen offset:0 sc1
    v_mfma_f32_16x16x32_bf16 v[60:63], v[120:123], v[192:195], v[60:63]
    v_mfma_f32_16x16x32_bf16 v[40:43], v[120:123], v[188:191], v[40:43]
    s_waitcnt vmcnt(14) lgkmcnt(5)
    v_mfma_f32_16x16x32_bf16 v[44:47], v[64:67], v[200:203], v[44:47]
    ds_read_b128 v[104:107], v15 offset:27648
    v_mfma_f32_16x16x32_bf16 v[24:27], v[64:67], v[196:199], v[24:27]
    ds_read_b128 v[108:111], v15 offset:28672
    v_mfma_f32_16x16x32_bf16 v[48:51], v[68:71], v[200:203], v[48:51]
    ds_read_b128 v[112:115], v15 offset:29696
    v_mfma_f32_16x16x32_bf16 v[28:31], v[68:71], v[196:199], v[28:31]
    ds_read_b128 v[116:119], v15 offset:30720
    v_mfma_f32_16x16x32_bf16 v[52:55], v[72:75], v[200:203], v[52:55]
    ds_read_b128 v[120:123], v23 offset:35840
    v_mfma_f32_16x16x32_bf16 v[32:35], v[72:75], v[196:199], v[32:35]
    buffer_load_dwordx4 v[164:167], v16, s[4:7], s32 offen offset:2048 sc1
    v_mfma_f32_16x16x32_bf16 v[56:59], v[76:79], v[200:203], v[56:59]
    v_mfma_f32_16x16x32_bf16 v[36:39], v[76:79], v[196:199], v[36:39]
    buffer_load_dwordx4 v[168:171], v17, s[4:7], s32 offen offset:2048 sc1
    v_mfma_f32_16x16x32_bf16 v[60:63], v[80:83], v[200:203], v[60:63]
    v_mfma_f32_16x16x32_bf16 v[40:43], v[80:83], v[196:199], v[40:43]
    s_waitcnt vmcnt(14) lgkmcnt(0)
    s_barrier
    v_mfma_f32_16x16x32_bf16 v[44:47], v[84:87], v[208:211], v[44:47]
    ds_read_b128 v[64:67], v12 offset:0
    v_mfma_f32_16x16x32_bf16 v[24:27], v[84:87], v[204:207], v[24:27]
    ds_read_b128 v[68:71], v12 offset:1024
    v_mfma_f32_16x16x32_bf16 v[48:51], v[88:91], v[208:211], v[48:51]
    ds_read_b128 v[72:75], v12 offset:2048
    v_mfma_f32_16x16x32_bf16 v[28:31], v[88:91], v[204:207], v[28:31]
    ds_read_b128 v[76:79], v12 offset:3072
    v_mfma_f32_16x16x32_bf16 v[52:55], v[92:95], v[208:211], v[52:55]
    ds_read_b128 v[80:83], v20 offset:8192
    v_mfma_f32_16x16x32_bf16 v[32:35], v[92:95], v[204:207], v[32:35]
    buffer_load_dwordx4 v[172:175], v16, s[4:7], s33 offen offset:0 sc1
    v_mfma_f32_16x16x32_bf16 v[56:59], v[96:99], v[208:211], v[56:59]
    v_mfma_f32_16x16x32_bf16 v[36:39], v[96:99], v[204:207], v[36:39]
    buffer_load_dwordx4 v[176:179], v17, s[4:7], s33 offen offset:0 sc1
    v_mfma_f32_16x16x32_bf16 v[60:63], v[100:103], v[208:211], v[60:63]
    v_mfma_f32_16x16x32_bf16 v[40:43], v[100:103], v[204:207], v[40:43]
    s_waitcnt vmcnt(14) lgkmcnt(5)
    v_mfma_f32_16x16x32_bf16 v[44:47], v[104:107], v[216:219], v[44:47]
    ds_read_b128 v[84:87], v12 offset:9216
    v_mfma_f32_16x16x32_bf16 v[24:27], v[104:107], v[212:215], v[24:27]
    ds_read_b128 v[88:91], v12 offset:10240
    v_mfma_f32_16x16x32_bf16 v[48:51], v[108:111], v[216:219], v[48:51]
    ds_read_b128 v[92:95], v12 offset:11264
    v_mfma_f32_16x16x32_bf16 v[28:31], v[108:111], v[212:215], v[28:31]
    ds_read_b128 v[96:99], v12 offset:12288
    v_mfma_f32_16x16x32_bf16 v[52:55], v[112:115], v[216:219], v[52:55]
    ds_read_b128 v[100:103], v20 offset:17408
    v_mfma_f32_16x16x32_bf16 v[32:35], v[112:115], v[212:215], v[32:35]
    buffer_load_dwordx4 v[180:183], v16, s[4:7], s33 offen offset:2048 sc1
    v_mfma_f32_16x16x32_bf16 v[56:59], v[116:119], v[216:219], v[56:59]
    v_mfma_f32_16x16x32_bf16 v[36:39], v[116:119], v[212:215], v[36:39]
    buffer_load_dwordx4 v[184:187], v17, s[4:7], s33 offen offset:2048 sc1
    v_mfma_f32_16x16x32_bf16 v[60:63], v[120:123], v[216:219], v[60:63]
    v_mfma_f32_16x16x32_bf16 v[40:43], v[120:123], v[212:215], v[40:43]
    s_waitcnt vmcnt(14) lgkmcnt(5)
    v_mfma_f32_16x16x32_bf16 v[44:47], v[64:67], v[128:131], v[44:47]
    ds_read_b128 v[104:107], v12 offset:18432
    s_mov_b32 s32, 8
    s_lshl_b32 s32, s32, 13
    s_add_u32 s32, s32, s29
    s_add_u32 s33, s32, 4096
    v_mfma_f32_16x16x32_bf16 v[24:27], v[64:67], v[124:127], v[24:27]
    ds_read_b128 v[108:111], v12 offset:19456
    v_mfma_f32_16x16x32_bf16 v[48:51], v[68:71], v[128:131], v[48:51]
    ds_read_b128 v[112:115], v12 offset:20480
    v_mfma_f32_16x16x32_bf16 v[28:31], v[68:71], v[124:127], v[28:31]
    ds_read_b128 v[116:119], v12 offset:21504
    v_mfma_f32_16x16x32_bf16 v[52:55], v[72:75], v[128:131], v[52:55]
    ds_read_b128 v[120:123], v20 offset:26624
    v_mfma_f32_16x16x32_bf16 v[32:35], v[72:75], v[124:127], v[32:35]
    buffer_load_dwordx4 v[188:191], v18, s[4:7], s32 offen offset:0 sc1
    v_mfma_f32_16x16x32_bf16 v[56:59], v[76:79], v[128:131], v[56:59]
    v_mfma_f32_16x16x32_bf16 v[36:39], v[76:79], v[124:127], v[36:39]
    buffer_load_dwordx4 v[192:195], v19, s[4:7], s32 offen offset:0 sc1
    v_mfma_f32_16x16x32_bf16 v[60:63], v[80:83], v[128:131], v[60:63]
    v_mfma_f32_16x16x32_bf16 v[40:43], v[80:83], v[124:127], v[40:43]
    s_waitcnt vmcnt(14) lgkmcnt(5)
    v_mfma_f32_16x16x32_bf16 v[44:47], v[84:87], v[136:139], v[44:47]
    ds_read_b128 v[64:67], v12 offset:27648
    v_mfma_f32_16x16x32_bf16 v[24:27], v[84:87], v[132:135], v[24:27]
    ds_read_b128 v[68:71], v12 offset:28672
    v_mfma_f32_16x16x32_bf16 v[48:51], v[88:91], v[136:139], v[48:51]
    ds_read_b128 v[72:75], v12 offset:29696
    v_mfma_f32_16x16x32_bf16 v[28:31], v[88:91], v[132:135], v[28:31]
    ds_read_b128 v[76:79], v12 offset:30720
    v_mfma_f32_16x16x32_bf16 v[52:55], v[92:95], v[136:139], v[52:55]
    ds_read_b128 v[80:83], v20 offset:35840
    v_mfma_f32_16x16x32_bf16 v[32:35], v[92:95], v[132:135], v[32:35]
    buffer_load_dwordx4 v[196:199], v18, s[4:7], s32 offen offset:2048 sc1
    v_mfma_f32_16x16x32_bf16 v[56:59], v[96:99], v[136:139], v[56:59]
    v_mfma_f32_16x16x32_bf16 v[36:39], v[96:99], v[132:135], v[36:39]
    buffer_load_dwordx4 v[200:203], v19, s[4:7], s32 offen offset:2048 sc1
    v_mfma_f32_16x16x32_bf16 v[60:63], v[100:103], v[136:139], v[60:63]
    v_mfma_f32_16x16x32_bf16 v[40:43], v[100:103], v[132:135], v[40:43]
    s_waitcnt vmcnt(14) lgkmcnt(0)
    s_barrier
    v_mfma_f32_16x16x32_bf16 v[44:47], v[104:107], v[144:147], v[44:47]
    ds_read_b128 v[84:87], v13 offset:0
    v_mfma_f32_16x16x32_bf16 v[24:27], v[104:107], v[140:143], v[24:27]
    ds_read_b128 v[88:91], v13 offset:1024
    v_mfma_f32_16x16x32_bf16 v[48:51], v[108:111], v[144:147], v[48:51]
    ds_read_b128 v[92:95], v13 offset:2048
    v_mfma_f32_16x16x32_bf16 v[28:31], v[108:111], v[140:143], v[28:31]
    ds_read_b128 v[96:99], v13 offset:3072
    v_mfma_f32_16x16x32_bf16 v[52:55], v[112:115], v[144:147], v[52:55]
    ds_read_b128 v[100:103], v21 offset:8192
    v_mfma_f32_16x16x32_bf16 v[32:35], v[112:115], v[140:143], v[32:35]
    buffer_load_dwordx4 v[204:207], v18, s[4:7], s33 offen offset:0 sc1
    v_mfma_f32_16x16x32_bf16 v[56:59], v[116:119], v[144:147], v[56:59]
    v_mfma_f32_16x16x32_bf16 v[36:39], v[116:119], v[140:143], v[36:39]
    buffer_load_dwordx4 v[208:211], v19, s[4:7], s33 offen offset:0 sc1
    v_mfma_f32_16x16x32_bf16 v[60:63], v[120:123], v[144:147], v[60:63]
    v_mfma_f32_16x16x32_bf16 v[40:43], v[120:123], v[140:143], v[40:43]
    s_waitcnt vmcnt(14) lgkmcnt(5)
    v_mfma_f32_16x16x32_bf16 v[44:47], v[64:67], v[152:155], v[44:47]
    ds_read_b128 v[104:107], v13 offset:9216
    v_mfma_f32_16x16x32_bf16 v[24:27], v[64:67], v[148:151], v[24:27]
    ds_read_b128 v[108:111], v13 offset:10240
    v_mfma_f32_16x16x32_bf16 v[48:51], v[68:71], v[152:155], v[48:51]
    ds_read_b128 v[112:115], v13 offset:11264
    v_mfma_f32_16x16x32_bf16 v[28:31], v[68:71], v[148:151], v[28:31]
    ds_read_b128 v[116:119], v13 offset:12288
    v_mfma_f32_16x16x32_bf16 v[52:55], v[72:75], v[152:155], v[52:55]
    ds_read_b128 v[120:123], v21 offset:17408
    v_mfma_f32_16x16x32_bf16 v[32:35], v[72:75], v[148:151], v[32:35]
    buffer_load_dwordx4 v[212:215], v18, s[4:7], s33 offen offset:2048 sc1
    v_mfma_f32_16x16x32_bf16 v[56:59], v[76:79], v[152:155], v[56:59]
    v_mfma_f32_16x16x32_bf16 v[36:39], v[76:79], v[148:151], v[36:39]
    buffer_load_dwordx4 v[216:219], v19, s[4:7], s33 offen offset:2048 sc1
    v_mfma_f32_16x16x32_bf16 v[60:63], v[80:83], v[152:155], v[60:63]
    v_mfma_f32_16x16x32_bf16 v[40:43], v[80:83], v[148:151], v[40:43]
    s_waitcnt vmcnt(14) lgkmcnt(5)
    v_mfma_f32_16x16x32_bf16 v[44:47], v[84:87], v[160:163], v[44:47]
    ds_read_b128 v[64:67], v13 offset:18432
    v_mfma_f32_16x16x32_bf16 v[24:27], v[84:87], v[156:159], v[24:27]
    ds_read_b128 v[68:71], v13 offset:19456
    v_mfma_f32_16x16x32_bf16 v[48:51], v[88:91], v[160:163], v[48:51]
    ds_read_b128 v[72:75], v13 offset:20480
    v_mfma_f32_16x16x32_bf16 v[28:31], v[88:91], v[156:159], v[28:31]
    ds_read_b128 v[76:79], v13 offset:21504
    v_mfma_f32_16x16x32_bf16 v[52:55], v[92:95], v[160:163], v[52:55]
    ds_read_b128 v[80:83], v21 offset:26624
    v_mfma_f32_16x16x32_bf16 v[32:35], v[92:95], v[156:159], v[32:35]
    v_mfma_f32_16x16x32_bf16 v[56:59], v[96:99], v[160:163], v[56:59]
    v_mfma_f32_16x16x32_bf16 v[36:39], v[96:99], v[156:159], v[36:39]
    v_mfma_f32_16x16x32_bf16 v[60:63], v[100:103], v[160:163], v[60:63]
    v_mfma_f32_16x16x32_bf16 v[40:43], v[100:103], v[156:159], v[40:43]
    s_waitcnt vmcnt(12) lgkmcnt(5)
    v_mfma_f32_16x16x32_bf16 v[44:47], v[104:107], v[168:171], v[44:47]
    ds_read_b128 v[84:87], v13 offset:27648
    v_mfma_f32_16x16x32_bf16 v[24:27], v[104:107], v[164:167], v[24:27]
    ds_read_b128 v[88:91], v13 offset:28672
    v_mfma_f32_16x16x32_bf16 v[48:51], v[108:111], v[168:171], v[48:51]
    ds_read_b128 v[92:95], v13 offset:29696
    v_mfma_f32_16x16x32_bf16 v[28:31], v[108:111], v[164:167], v[28:31]
    ds_read_b128 v[96:99], v13 offset:30720
    v_mfma_f32_16x16x32_bf16 v[52:55], v[112:115], v[168:171], v[52:55]
    ds_read_b128 v[100:103], v21 offset:35840
    v_mfma_f32_16x16x32_bf16 v[32:35], v[112:115], v[164:167], v[32:35]
    v_mfma_f32_16x16x32_bf16 v[56:59], v[116:119], v[168:171], v[56:59]
    v_mfma_f32_16x16x32_bf16 v[36:39], v[116:119], v[164:167], v[36:39]
    v_mfma_f32_16x16x32_bf16 v[60:63], v[120:123], v[168:171], v[60:63]
    v_mfma_f32_16x16x32_bf16 v[40:43], v[120:123], v[164:167], v[40:43]
    s_waitcnt vmcnt(10) lgkmcnt(0)
    s_barrier
    v_mfma_f32_16x16x32_bf16 v[44:47], v[64:67], v[176:179], v[44:47]
    ds_read_b128 v[104:107], v14 offset:0
    v_mfma_f32_16x16x32_bf16 v[24:27], v[64:67], v[172:175], v[24:27]
    ds_read_b128 v[108:111], v14 offset:1024
    v_mfma_f32_16x16x32_bf16 v[48:51], v[68:71], v[176:179], v[48:51]
    ds_read_b128 v[112:115], v14 offset:2048
    v_mfma_f32_16x16x32_bf16 v[28:31], v[68:71], v[172:175], v[28:31]
    ds_read_b128 v[116:119], v14 offset:3072
    v_mfma_f32_16x16x32_bf16 v[52:55], v[72:75], v[176:179], v[52:55]
    ds_read_b128 v[120:123], v22 offset:8192
    v_mfma_f32_16x16x32_bf16 v[32:35], v[72:75], v[172:175], v[32:35]
    v_mfma_f32_16x16x32_bf16 v[56:59], v[76:79], v[176:179], v[56:59]
    v_mfma_f32_16x16x32_bf16 v[36:39], v[76:79], v[172:175], v[36:39]
    v_mfma_f32_16x16x32_bf16 v[60:63], v[80:83], v[176:179], v[60:63]
    v_mfma_f32_16x16x32_bf16 v[40:43], v[80:83], v[172:175], v[40:43]
    s_waitcnt vmcnt(8) lgkmcnt(5)
    v_mfma_f32_16x16x32_bf16 v[44:47], v[84:87], v[184:187], v[44:47]
    ds_read_b128 v[64:67], v14 offset:9216
    v_mfma_f32_16x16x32_bf16 v[24:27], v[84:87], v[180:183], v[24:27]
    ds_read_b128 v[68:71], v14 offset:10240
    v_mfma_f32_16x16x32_bf16 v[48:51], v[88:91], v[184:187], v[48:51]
    ds_read_b128 v[72:75], v14 offset:11264
    v_mfma_f32_16x16x32_bf16 v[28:31], v[88:91], v[180:183], v[28:31]
    ds_read_b128 v[76:79], v14 offset:12288
    v_mfma_f32_16x16x32_bf16 v[52:55], v[92:95], v[184:187], v[52:55]
    ds_read_b128 v[80:83], v22 offset:17408
    v_mfma_f32_16x16x32_bf16 v[32:35], v[92:95], v[180:183], v[32:35]
    s_waitcnt vmcnt(6)
    v_mfma_f32_16x16x32_bf16 v[56:59], v[96:99], v[184:187], v[56:59]
    v_swap_b32 v190, v192
    v_mfma_f32_16x16x32_bf16 v[36:39], v[96:99], v[180:183], v[36:39]
    v_swap_b32 v191, v193
    v_mfma_f32_16x16x32_bf16 v[60:63], v[100:103], v[184:187], v[60:63]
    v_mfma_f32_16x16x32_bf16 v[40:43], v[100:103], v[180:183], v[40:43]
    s_waitcnt vmcnt(6) lgkmcnt(5)
    v_mfma_f32_16x16x32_bf16 v[44:47], v[104:107], v[192:195], v[44:47]
    ds_read_b128 v[84:87], v14 offset:18432
    v_mfma_f32_16x16x32_bf16 v[24:27], v[104:107], v[188:191], v[24:27]
    ds_read_b128 v[88:91], v14 offset:19456
    v_mfma_f32_16x16x32_bf16 v[48:51], v[108:111], v[192:195], v[48:51]
    ds_read_b128 v[92:95], v14 offset:20480
    v_mfma_f32_16x16x32_bf16 v[28:31], v[108:111], v[188:191], v[28:31]
    ds_read_b128 v[96:99], v14 offset:21504
    v_mfma_f32_16x16x32_bf16 v[52:55], v[112:115], v[192:195], v[52:55]
    ds_read_b128 v[100:103], v22 offset:26624
    v_mfma_f32_16x16x32_bf16 v[32:35], v[112:115], v[188:191], v[32:35]
    s_waitcnt vmcnt(4)
    v_mfma_f32_16x16x32_bf16 v[56:59], v[116:119], v[192:195], v[56:59]
    v_swap_b32 v198, v200
    v_mfma_f32_16x16x32_bf16 v[36:39], v[116:119], v[188:191], v[36:39]
    v_swap_b32 v199, v201
    v_mfma_f32_16x16x32_bf16 v[60:63], v[120:123], v[192:195], v[60:63]
    v_mfma_f32_16x16x32_bf16 v[40:43], v[120:123], v[188:191], v[40:43]
    s_waitcnt vmcnt(4) lgkmcnt(5)
    v_mfma_f32_16x16x32_bf16 v[44:47], v[64:67], v[200:203], v[44:47]
    ds_read_b128 v[104:107], v14 offset:27648
    v_mfma_f32_16x16x32_bf16 v[24:27], v[64:67], v[196:199], v[24:27]
    ds_read_b128 v[108:111], v14 offset:28672
    v_mfma_f32_16x16x32_bf16 v[48:51], v[68:71], v[200:203], v[48:51]
    ds_read_b128 v[112:115], v14 offset:29696
    v_mfma_f32_16x16x32_bf16 v[28:31], v[68:71], v[196:199], v[28:31]
    ds_read_b128 v[116:119], v14 offset:30720
    v_mfma_f32_16x16x32_bf16 v[52:55], v[72:75], v[200:203], v[52:55]
    ds_read_b128 v[120:123], v22 offset:35840
    v_mfma_f32_16x16x32_bf16 v[32:35], v[72:75], v[196:199], v[32:35]
    s_waitcnt vmcnt(2)
    v_mfma_f32_16x16x32_bf16 v[56:59], v[76:79], v[200:203], v[56:59]
    v_swap_b32 v206, v208
    v_mfma_f32_16x16x32_bf16 v[36:39], v[76:79], v[196:199], v[36:39]
    v_swap_b32 v207, v209
    v_mfma_f32_16x16x32_bf16 v[60:63], v[80:83], v[200:203], v[60:63]
    v_mfma_f32_16x16x32_bf16 v[40:43], v[80:83], v[196:199], v[40:43]
    s_waitcnt vmcnt(2) lgkmcnt(5)
    v_mfma_f32_16x16x32_bf16 v[44:47], v[84:87], v[208:211], v[44:47]
    v_mfma_f32_16x16x32_bf16 v[24:27], v[84:87], v[204:207], v[24:27]
    v_mfma_f32_16x16x32_bf16 v[48:51], v[88:91], v[208:211], v[48:51]
    v_mfma_f32_16x16x32_bf16 v[28:31], v[88:91], v[204:207], v[28:31]
    v_mfma_f32_16x16x32_bf16 v[52:55], v[92:95], v[208:211], v[52:55]
    v_mfma_f32_16x16x32_bf16 v[32:35], v[92:95], v[204:207], v[32:35]
    s_waitcnt vmcnt(0)
    v_mfma_f32_16x16x32_bf16 v[56:59], v[96:99], v[208:211], v[56:59]
    v_swap_b32 v214, v216
    v_mfma_f32_16x16x32_bf16 v[36:39], v[96:99], v[204:207], v[36:39]
    v_swap_b32 v215, v217
    v_mfma_f32_16x16x32_bf16 v[60:63], v[100:103], v[208:211], v[60:63]
    v_mfma_f32_16x16x32_bf16 v[40:43], v[100:103], v[204:207], v[40:43]
    s_waitcnt vmcnt(0) lgkmcnt(0)
    v_mfma_f32_16x16x32_bf16 v[44:47], v[104:107], v[216:219], v[44:47]
    v_mfma_f32_16x16x32_bf16 v[48:51], v[108:111], v[216:219], v[48:51]
    v_mfma_f32_16x16x32_bf16 v[52:55], v[112:115], v[216:219], v[52:55]
    v_mfma_f32_16x16x32_bf16 v[56:59], v[116:119], v[216:219], v[56:59]
    v_mfma_f32_16x16x32_bf16 v[60:63], v[120:123], v[216:219], v[60:63]
    v_mfma_f32_16x16x32_bf16 v[24:27], v[104:107], v[212:215], v[24:27]
    v_mfma_f32_16x16x32_bf16 v[28:31], v[108:111], v[212:215], v[28:31]
    v_mfma_f32_16x16x32_bf16 v[32:35], v[112:115], v[212:215], v[32:35]
    v_mfma_f32_16x16x32_bf16 v[36:39], v[116:119], v[212:215], v[36:39]
    v_mfma_f32_16x16x32_bf16 v[40:43], v[120:123], v[212:215], v[40:43]
    ds_write_b128 v2, v[44:47] offset:0
    ds_write_b128 v2, v[48:51] offset:1024
    ds_write_b128 v2, v[52:55] offset:2048
    ds_write_b128 v2, v[56:59] offset:3072
    s_mov_b64 exec, s[40:41]
    ds_write_b128 v3, v[60:63] offset:4096
    s_mov_b64 exec, -1
    ds_write_b32 v0, v9
    s_mov_b32 s60, 1048576
L_px_p5:
    ds_read_b32 v232, v6
    ds_read_b128 v[64:67], v7 offset:0
    ds_read_b128 v[68:71], v7 offset:1024
    ds_read_b128 v[72:75], v7 offset:2048
    ds_read_b128 v[76:79], v7 offset:3072
    ds_read_b128 v[80:83], v8 offset:4096
    s_waitcnt lgkmcnt(5)
    v_cmp_ne_u32 vcc, s43, v232
    s_sub_u32 s60, s60, 1
    s_cbranch_scc1 L_py_p5
    s_cbranch_vccnz L_px_p5
L_py_p5:
    s_waitcnt lgkmcnt(4)
    v_pk_add_f32 v[24:25], v[24:25], v[64:65]
    v_pk_add_f32 v[26:27], v[26:27], v[66:67]
    v_cvt_pk_bf16_f32 v220, v24, v25
    v_cvt_pk_bf16_f32 v221, v26, v27
    s_waitcnt lgkmcnt(3)
    v_pk_add_f32 v[28:29], v[28:29], v[68:69]
    v_pk_add_f32 v[30:31], v[30:31], v[70:71]
    v_cvt_pk_bf16_f32 v222, v28, v29
    v_cvt_pk_bf16_f32 v223, v30, v31
    s_waitcnt lgkmcnt(2)
    v_pk_add_f32 v[32:33], v[32:33], v[72:73]
    v_pk_add_f32 v[34:35], v[34:35], v[74:75]
    v_cvt_pk_bf16_f32 v224, v32, v33
    v_cvt_pk_bf16_f32 v225, v34, v35
    s_waitcnt lgkmcnt(1)
    v_pk_add_f32 v[36:37], v[36:37], v[76:77]
    v_pk_add_f32 v[38:39], v[38:39], v[78:79]
    v_cvt_pk_bf16_f32 v226, v36, v37
    v_cvt_pk_bf16_f32 v227, v38, v39
    s_waitcnt lgkmcnt(0)
    v_pk_add_f32 v[40:41], v[40:41], v[80:81]
    v_pk_add_f32 v[42:43], v[42:43], v[82:83]
    v_cvt_pk_bf16_f32 v228, v40, v41
    v_cvt_pk_bf16_f32 v229, v42, v43
    s_cmp_eq_u32 s22, 1
    s_cbranch_scc1 L_fin_p5
    buffer_store_dwordx4 v[220:223], v4, s[4:7], s34 offen offset:0 sc1
    buffer_store_dwordx4 v[224:227], v4, s[4:7], s34 offen offset:1024 sc1
    buffer_store_dwordx2 v[228:229], v5, s[4:7], s34 offen sc1
    v_cndmask_b32 v234, 0, v228, s[40:41]
    v_cndmask_b32 v235, 0, v229, s[40:41]
    v_dot2_f32_bf16 v232, v220, v11, 0
    v_dot2_f32_bf16 v233, v220, v220, 0
    v_dot2_f32_bf16 v232, v221, v11, v232
    v_dot2_f32_bf16 v233, v221, v221, v233
    v_dot2_f32_bf16 v232, v222, v11, v232
    v_dot2_f32_bf16 v233, v222, v222, v233
    v_dot2_f32_bf16 v232, v223, v11, v232
    v_dot2_f32_bf16 v233, v223, v223, v233
    v_dot2_f32_bf16 v232, v224, v11, v232
    v_dot2_f32_bf16 v233, v224, v224, v233
    v_dot2_f32_bf16 v232, v225, v11, v232
    v_dot2_f32_bf16 v233, v225, v225, v233
    v_dot2_f32_bf16 v232, v226, v11, v232
    v_dot2_f32_bf16 v233, v226, v226, v233
    v_dot2_f32_bf16 v232, v227, v11, v232
    v_dot2_f32_bf16 v233, v227, v227, v233
    v_dot2_f32_bf16 v232, v234, v11, v232
    v_dot2_f32_bf16 v233, v234, v234, v233
    v_dot2_f32_bf16 v232, v235, v11, v232
    v_dot2_f32_bf16 v233, v235, v235, v233
    s_nop 2
    v_mov_b32 v234, v232
    v_mov_b32 v235, v233
    s_nop 1
    v_permlane32_swap_b32 v232, v234
    v_permlane32_swap_b32 v233, v235
    v_add_f32 v232, v232, v234
    v_add_f32 v233, v233, v235
    v_mov_b32 v234, v232
    v_mov_b32 v235, v233
    s_nop 1
    v_permlane16_swap_b32 v232, v234
    v_permlane16_swap_b32 v233, v235
    v_add_f32 v232, v232, v234
    v_add_f32 v233, v233, v235
    buffer_store_dwordx2 v[232:233], v10, s[4:7], s39 offen sc1
    s_barrier
    s_mov_b32 s22, 1
    s_mov_b32 s21, 0x1c00000
    s_branch L_m_cl
L_fin_p5:
    buffer_store_dwordx4 v[220:223], v4, s[16:19], s34 offen offset:0
    buffer_store_dwordx4 v[224:227], v4, s[16:19], s34 offen offset:64
    buffer_store_dwordx2 v[228:229], v5, s[16:19], s34 offen offset:128
    s_endpgm
L_m_l1:
    s_and_b32 s25, s2, 7
    s_lshr_b32 s26, s2, 3
    s_lshr_b32 s23, s25, 1
    s_lshl_b32 s23, s23, 2
    s_lshr_b32 s27, s26, 3
    s_add_u32 s23, s23, s27
    s_and_b32 s24, s25, 1
    s_lshl_b32 s24, s24, 3
    s_and_b32 s27, s26, 7
    s_add_u32 s24, s24, s27
    s_mul_i32 s29, s24, 129024
    s_lshl_b32 s30, s20, 12
    s_add_u32 s29, s29, s30
    s_add_u32 s29, s29, 0x3800000
    s_lshl_b32 s31, s23, 3
    s_max_u32 s31, s31, 1
    s_sub_u32 s31, s31, 1
    s_mul_i32 s31, s31, 18432
    s_add_u32 s31, s31, 0x0
    s_lshl_b32 s35, s20, 10
    s_and_b32 s36, s35, 1024
    s_barrier
    s_add_u32 m0, s35, 131072
    s_add_u32 s34, s31, s35
    s_add_u32 s34, s34, 0
    buffer_load_dwordx4 v1, s[4:7], s34 offen sc1 lds
    s_add_u32 m0, s30, 0
    s_add_u32 s34, s29, 0
    buffer_load_dwordx4 v1, s[4:7], s34 offen offset:0 sc1 lds
    buffer_load_dwordx4 v1, s[4:7], s34 offen offset:1024 sc1 lds
    buffer_load_dwordx4 v1, s[4:7], s34 offen offset:2048 sc1 lds
    buffer_load_dwordx4 v1, s[4:7], s34 offen offset:3072 sc1 lds
    s_add_u32 m0, s30, 16384
    s_add_u32 s34, s29, 16384
    buffer_load_dwordx4 v1, s[4:7], s34 offen offset:0 sc1 lds
    buffer_load_dwordx4 v1, s[4:7], s34 offen offset:1024 sc1 lds
    buffer_load_dwordx4 v1, s[4:7], s34 offen offset:2048 sc1 lds
    buffer_load_dwordx4 v1, s[4:7], s34 offen offset:3072 sc1 lds
    s_waitcnt vmcnt(4) lgkmcnt(0)
    s_barrier
    s_add_u32 m0, s35, 135168
    s_add_u32 s34, s31, s35
    s_add_u32 s34, s34, 4096
    buffer_load_dwordx4 v1, s[4:7], s34 offen sc1 lds
    s_add_u32 m0, s30, 32768
    s_add_u32 s34, s29, 32768
    buffer_load_dwordx4 v1, s[4:7], s34 offen offset:0 sc1 lds
    buffer_load_dwordx4 v1, s[4:7], s34 offen offset:1024 sc1 lds
    buffer_load_dwordx4 v1, s[4:7], s34 offen offset:2048 sc1 lds
    buffer_load_dwordx4 v1, s[4:7], s34 offen offset:3072 sc1 lds
    s_add_u32 m0, s30, 49152
    s_add_u32 s34, s29, 49152
    buffer_load_dwordx4 v1, s[4:7], s34 offen offset:0 sc1 lds
    buffer_load_dwordx4 v1, s[4:7], s34 offen offset:1024 sc1 lds
    buffer_load_dwordx4 v1, s[4:7], s34 offen offset:2048 sc1 lds
    buffer_load_dwordx4 v1, s[4:7], s34 offen offset:3072 sc1 lds
    s_cmp_lt_u32 s2, 144
    s_cbranch_scc1 L_p0_t1
    s_cmp_ge_u32 s2, 216
    s_cbranch_scc1 L_p0_t2
    ds_read_b64_tr_b16 v[16:17], v4 offset:0
    ds_read_b64_tr_b16 v[18:19], v4 offset:2048
    ds_read_b64_tr_b16 v[20:21], v4 offset:18432
    ds_read_b64_tr_b16 v[22:23], v4 offset:20480
    ds_read_b64_tr_b16 v[24:25], v4 offset:4096
    ds_read_b64_tr_b16 v[26:27], v4 offset:6144
    ds_read_b64_tr_b16 v[28:29], v4 offset:22528
    ds_read_b64_tr_b16 v[30:31], v4 offset:24576
    ds_read_b64_tr_b16 v[32:33], v4 offset:8192
    ds_read_b64_tr_b16 v[34:35], v4 offset:10240
    ds_read_b64_tr_b16 v[36:37], v4 offset:26624
    ds_read_b64_tr_b16 v[38:39], v4 offset:28672
    ds_read_b64_tr_b16 v[40:41], v4 offset:12288
    ds_read_b64_tr_b16 v[42:43], v4 offset:14336
    ds_read_b64_tr_b16 v[44:45], v4 offset:30720
    ds_read_b64_tr_b16 v[46:47], v4 offset:32768
    ds_read_b64_tr_b16 v[48:49], v5 offset:16384
    ds_read_b64_tr_b16 v[50:51], v5 offset:34816
    s_branch L_p0_t2
L_p0_t1:
    ds_read_b64_tr_b16 v[16:17], v4 offset:0
    ds_read_b64_tr_b16 v[18:19], v4 offset:512
    ds_read_b64_tr_b16 v[20:21], v4 offset:4352
    ds_read_b64_tr_b16 v[22:23], v4 offset:4864
    ds_read_b64_tr_b16 v[24:25], v4 offset:9792
    ds_read_b64_tr_b16 v[26:27], v4 offset:10304
    ds_read_b64_tr_b16 v[28:29], v4 offset:14144
    ds_read_b64_tr_b16 v[30:31], v4 offset:14656
    ds_read_b64_tr_b16 v[32:33], v4 offset:19584
    ds_read_b64_tr_b16 v[34:35], v4 offset:20096
    ds_read_b64_tr_b16 v[36:37], v4 offset:23936
    ds_read_b64_tr_b16 v[38:39], v4 offset:24448
    ds_read_b64_tr_b16 v[40:41], v4 offset:29376
    ds_read_b64_tr_b16 v[42:43], v4 offset:29888
    ds_read_b64_tr_b16 v[44:45], v4 offset:33728
    ds_read_b64_tr_b16 v[46:47], v4 offset:34240
    ds_read_b64_tr_b16 v[48:49], v5 offset:8704
    ds_read_b64_tr_b16 v[50:51], v5 offset:9216
L_p0_t2:
    s_waitcnt lgkmcnt(0)
    s_waitcnt vmcnt(9) lgkmcnt(0)
    s_barrier
    s_add_u32 m0, s35, 139264
    s_add_u32 s34, s31, s35
    s_add_u32 s34, s34, 8192
    buffer_load_dwordx4 v1, s[4:7], s34 offen sc1 lds
    v_lshrrev_b32 v2, 8, v1
    v_bfe_u32 v3, v1, 7, 1
    v_bfe_u32 v4, v1, 4, 3
    v_cmp_gt_u32 vcc, 3, v2
    v_mul_u32_u24 v3, 80, v3
    v_lshl_add_u32 v3, v4, 3, v3
    v_lshrrev_b32 v5, 1, v4
    v_and_b32 v4, 1, v4
    v_lshl_add_u32 v4, v4, 3, 64
    v_cndmask_b32 v2, v5, v2, vcc
    v_cndmask_b32 v3, v4, v3, vcc
    v_mul_u32_u24 v2, 2304, v2
    v_add_u32 v0, v2, v3
    v_lshrrev_b32 v8, 1, v1
    s_mul_i32 s34, s24, 144
    s_add_u32 s34, s34, 0x4400000
    buffer_load_dwordx2 v[2:3], v0, s[4:7], s34 offen sc1
    s_mul_i32 s34, s24, 144
    s_add_u32 s34, s34, 0x4402000
    buffer_load_dwordx2 v[4:5], v0, s[4:7], s34 offen sc1
    s_mul_i32 s34, s24, 144
    s_add_u32 s34, s34, 0x4404000
    buffer_load_dwordx2 v[6:7], v0, s[4:7], s34 offen sc1
    s_mul_i32 s34, s24, 144
    s_add_u32 s34, s34, 0x4406000
    buffer_load_dwordx2 v[12:13], v0, s[4:7], s34 offen sc1
    s_add_u32 m0, s30, 65536
    s_add_u32 s34, s29, 65536
    buffer_load_dwordx4 v1, s[4:7], s34 offen offset:0 sc1 lds
    buffer_load_dwordx4 v1, s[4:7], s34 offen offset:1024 sc1 lds
    buffer_load_dwordx4 v1, s[4:7], s34 offen offset:2048 sc1 lds
    buffer_load_dwordx4 v1, s[4:7], s34 offen offset:3072 sc1 lds
    s_waitcnt vmcnt(13) lgkmcnt(0)
    s_barrier
    s_add_u32 m0, s30, 81920
    s_add_u32 s34, s29, 81920
    buffer_load_dwordx4 v1, s[4:7], s34 offen offset:0 sc1 lds
    buffer_load_dwordx4 v1, s[4:7], s34 offen offset:1024 sc1 lds
    buffer_load_dwordx4 v1, s[4:7], s34 offen offset:2048 sc1 lds
    buffer_load_dwordx4 v1, s[4:7], s34 offen offset:3072 sc1 lds
    s_waitcnt vmcnt(13) lgkmcnt(0)
    s_barrier
    s_add_u32 m0, s35, 143360
    s_add_u32 s34, s31, s35
    s_add_u32 s34, s34, 12288
    buffer_load_dwordx4 v1, s[4:7], s34 offen sc1 lds
    s_add_u32 m0, s30, 98304
    s_add_u32 s34, s29, 98304
    buffer_load_dwordx4 v1, s[4:7], s34 offen offset:0 sc1 lds
    buffer_load_dwordx4 v1, s[4:7], s34 offen offset:1024 sc1 lds
    buffer_load_dwordx4 v1, s[4:7], s34 offen offset:2048 sc1 lds
    buffer_load_dwordx4 v1, s[4:7], s34 offen offset:3072 sc1 lds
    s_waitcnt vmcnt(13)
    v_add_f32 v2, v2, v4
    v_add_f32 v3, v3, v5
    v_add_f32 v6, v6, v12
    v_add_f32 v7, v7, v13
    v_add_f32 v2, v2, v6
    v_add_f32 v3, v3, v7
    v_cmp_gt_u32 vcc, 864, v1
    v_add_u32 v8, 161792, v8
    s_nop 0
    v_cndmask_b32 v2, 0, v2, vcc
    v_cndmask_b32 v3, 0, v3, vcc
    ds_write_b64 v8, v[2:3]
    s_waitcnt vmcnt(9) lgkmcnt(0)
    s_barrier
    s_add_u32 m0, s36, 147456
    s_add_u32 s34, s31, s36
    s_add_u32 s34, s34, 16384
    buffer_load_dwordx4 v1, s[4:7], s34 offen sc1 lds
    s_add_u32 m0, s30, 114688
    s_add_u32 s34, s29, 114688
    buffer_load_dwordx4 v1, s[4:7], s34 offen offset:0 sc1 lds
    buffer_load_dwordx4 v1, s[4:7], s34 offen offset:1024 sc1 lds
    buffer_load_dwordx4 v1, s[4:7], s34 offen offset:2048 sc1 lds
    buffer_load_dwordx4 v1, s[4:7], s34 offen offset:3072 sc1 lds
    s_waitcnt vmcnt(10) lgkmcnt(0)
    s_barrier
    buffer_store_dwordx4 v[16:19], v9, s[4:7], s37 offen sc1
    buffer_store_dwordx4 v[20:23], v10, s[4:7], s38 offen sc1
    buffer_store_dwordx4 v[24:27], v9, s[4:7], s39 offen sc1
    buffer_store_dwordx4 v[28:31], v10, s[4:7], s40 offen sc1
    s_waitcnt vmcnt(9) lgkmcnt(0)
    s_barrier
    buffer_store_dwordx4 v[32:35], v9, s[4:7], s41 offen sc1
    buffer_store_dwordx4 v[36:39], v10, s[4:7], s42 offen sc1
    buffer_store_dwordx4 v[40:43], v9, s[4:7], s43 offen sc1
    s_waitcnt vmcnt(7) lgkmcnt(0)
    s_barrier
    s_mov_b32 s46, 0x4502000
    v_mov_b32 v4, 0
    s_mov_b32 s60, 65536
L_poll_wo:
    buffer_load_dword v5, v4, s[4:7], s46 offen sc1
    s_waitcnt vmcnt(0)
    v_cmp_gt_u32 vcc, 18, v5
    s_sub_u32 s60, s60, 1
    s_cbranch_scc1 L_pd_wo
    s_cbranch_vccz L_pd_wo
    s_sleep 4
    s_branch L_poll_wo
L_pd_wo:
    buffer_store_dwordx4 v[44:47], v10, s[4:7], s47 offen sc1
    buffer_store_dwordx4 v[48:51], v14, s[4:7], s48 offen sc1
    v_dot2_f32_bf16 v12, v16, v11, 0
    v_dot2_f32_bf16 v13, v17, v11, 0
    v_dot2_f32_bf16 v12, v18, v11, v12
    v_dot2_f32_bf16 v13, v19, v11, v13
    v_dot2_f32_bf16 v12, v20, v11, v12
    v_dot2_f32_bf16 v13, v21, v11, v13
    v_dot2_f32_bf16 v12, v22, v11, v12
    v_dot2_f32_bf16 v13, v23, v11, v13
    v_dot2_f32_bf16 v12, v24, v11, v12
    v_dot2_f32_bf16 v13, v25, v11, v13
    v_dot2_f32_bf16 v12, v26, v11, v12
    v_dot2_f32_bf16 v13, v27, v11, v13
    v_dot2_f32_bf16 v12, v28, v11, v12
    v_dot2_f32_bf16 v13, v29, v11, v13
    v_dot2_f32_bf16 v12, v30, v11, v12
    v_dot2_f32_bf16 v13, v31, v11, v13
    v_dot2_f32_bf16 v12, v32, v11, v12
    v_dot2_f32_bf16 v13, v33, v11, v13
    v_dot2_f32_bf16 v12, v34, v11, v12
    v_dot2_f32_bf16 v13, v35, v11, v13
    v_dot2_f32_bf16 v12, v36, v11, v12
    v_dot2_f32_bf16 v13, v37, v11, v13
    v_dot2_f32_bf16 v12, v38, v11, v12
    v_dot2_f32_bf16 v13, v39, v11, v13
    v_dot2_f32_bf16 v12, v40, v11, v12
    v_dot2_f32_bf16 v13, v41, v11, v13
    v_dot2_f32_bf16 v12, v42, v11, v12
    v_dot2_f32_bf16 v13, v43, v11, v13
    v_dot2_f32_bf16 v12, v44, v11, v12
    v_dot2_f32_bf16 v13, v45, v11, v13
    v_dot2_f32_bf16 v12, v46, v11, v12
    v_dot2_f32_bf16 v13, v47, v11, v13
    v_dot2_f32_bf16 v12, v48, v11, v12
    v_dot2_f32_bf16 v13, v49, v11, v13
    v_dot2_f32_bf16 v12, v50, v11, v12
    v_dot2_f32_bf16 v13, v51, v11, v13
    s_nop 2
    v_add_f32 v12, v12, v13
    v_mov_b32 v13, v12
    s_nop 1
    v_permlane32_swap_b32 v12, v13
    v_add_f32 v12, v12, v13
    v_mov_b32 v13, v12
    s_nop 1
    v_permlane16_swap_b32 v12, v13
    v_add_f32 v12, v12, v13
    buffer_store_dword v12, v15, s[4:7], s49 offen sc1
    s_barrier
L_m_ll:
    s_and_b32 s25, s2, 7
    s_lshr_b32 s26, s2, 3
    s_lshr_b32 s23, s25, 1
    s_lshl_b32 s23, s23, 3
    s_lshr_b32 s27, s26, 2
    s_add_u32 s23, s23, s27
    s_and_b32 s24, s25, 1
    s_lshl_b32 s24, s24, 2
    s_and_b32 s27, s26, 3
    s_add_u32 s24, s24, s27
    s_add_u32 s25, s23, s24
    s_and_b32 s25, s25, 3
    s_mul_i32 s29, s24, 82944
    s_add_u32 s29, s29, 0x3a00000
    s_mul_i32 s30, s20, 36864
    s_mul_i32 s31, s20, 18432
    s_add_u32 s31, s31, s29
    s_add_u32 m0, s30, 18432
    s_add_u32 s33, s31, 0
    buffer_load_dwordx4 v1, s[4:7], s33 offen offset:0  sc1 lds
    buffer_load_dwordx4 v1, s[4:7], s33 offen offset:1024  sc1 lds
    buffer_load_dwordx4 v1, s[4:7], s33 offen offset:2048  sc1 lds
    buffer_load_dwordx4 v1, s[4:7], s33 offen offset:3072  sc1 lds
    s_add_u32 m0, s30, 22528
    s_add_u32 s33, s31, 4096
    buffer_load_dwordx4 v1, s[4:7], s33 offen offset:0  sc1 lds
    buffer_load_dwordx4 v1, s[4:7], s33 offen offset:1024  sc1 lds
    buffer_load_dwordx4 v1, s[4:7], s33 offen offset:2048  sc1 lds
    buffer_load_dwordx4 v1, s[4:7], s33 offen offset:3072  sc1 lds
    s_add_u32 m0, s30, 26624
    s_add_u32 s33, s31, 8192
    buffer_load_dwordx4 v1, s[4:7], s33 offen offset:0  sc1 lds
    buffer_load_dwordx4 v1, s[4:7], s33 offen offset:1024  sc1 lds
    buffer_load_dwordx4 v1, s[4:7], s33 offen offset:2048  sc1 lds
    buffer_load_dwordx4 v1, s[4:7], s33 offen offset:3072  sc1 lds
    s_add_u32 m0, s30, 30720
    s_add_u32 s33, s31, 12288
    buffer_load_dwordx4 v1, s[4:7], s33 offen offset:0  sc1 lds
    buffer_load_dwordx4 v1, s[4:7], s33 offen offset:1024  sc1 lds
    buffer_load_dwordx4 v1, s[4:7], s33 offen offset:2048  sc1 lds
    buffer_load_dwordx4 v1, s[4:7], s33 offen offset:3072  sc1 lds
    s_add_u32 m0, s30, 34816
    s_add_u32 s33, s31, 16384
    buffer_load_dwordx4 v1, s[4:7], s33 offen offset:0  sc1 lds
    buffer_load_dwordx4 v1, s[4:7], s33 offen offset:1024  sc1 lds
    s_mul_i32 s30, s20, 3072
    s_add_u32 s31, s30, s29
    s_waitcnt vmcnt(18)
    s_barrier
    s_add_u32 m0, s30, 147456
    s_add_u32 s33, s31, 73728
    buffer_load_dwordx4 v1, s[4:7], s33 offen offset:0  sc1 lds
    buffer_load_dwordx4 v1, s[4:7], s33 offen offset:1024  sc1 lds
    buffer_load_dwordx4 v1, s[4:7], s33 offen offset:2048  sc1 lds
    s_or_b32 s44, s20, s22
    s_cbranch_scc1 L_p2_ns
    s_and_b32 s44, s2, 15
    s_lshl_b32 s44, s44, 8
    s_add_u32 s44, s44, 0x4501000
    s_add_u32 s44, s44, s4
    s_addc_u32 s45, s5, 0
    s_mov_b32 s56, 1
    s_atomic_add s56, s[44:45], 0
L_p2_ns:
    s_waitcnt vmcnt(0)
    s_barrier
    s_and_b32 s25, s2, 7
    s_lshr_b32 s26, s2, 3
    s_and_b32 s23, s25, 1
    s_lshl_b32 s23, s23, 3
    s_and_b32 s27, s26, 7
    s_add_u32 s23, s23, s27
    s_lshr_b32 s24, s25, 1
    s_lshl_b32 s24, s24, 2
    s_lshr_b32 s27, s26, 3
    s_add_u32 s24, s24, s27
    s_add_u32 s28, s23, s24
    s_and_b32 s28, s28, 3
    s_lshl_b32 s30, s20, 12
    s_lshr_b32 s33, s20, 1
    s_mul_i32 s31, s33, 36864
    s_and_b32 s33, s20, 1
    s_lshl_b32 s33, s33, 10
    s_add_u32 s33, s33, 16384
    s_add_u32 s31, s31, s33
    s_sub_u32 s49, s33, s30
    s_mul_i32 s34, s24, 331776
    s_add_u32 s34, s34, s30
    s_add_u32 s34, s34, 0x3b00000
    s_lshl_b32 s35, s23, 3
    s_lshl_b32 s33, s20, 1
    s_add_u32 s35, s35, s33
    s_mul_i32 s35, s35, 18432
    s_add_u32 s35, s35, s21
    s_add_u32 s35, s35, 0x300000
    s_mul_i32 s36, s24, 589824
    s_add_u32 s36, s36, s30
    s_add_u32 s36, s36, s21
    s_add_u32 s36, s36, 0x900000
    v_add_u32 v2, 16384, v1
    s_add_u32 s33, s30, 18432
    v_add_u32 v6, s33, v1
    v_add_u32 v7, 73728, v6
    s_lshl_b32 s29, s23, 2
    s_add_u32 s29, s29, s20
    s_lshl_b32 s29, s29, 12
    s_add_u32 s29, s29, s21
    s_add_u32 s29, s29, 0x1b40000
    v_and_b32 v3, 48, v1
    v_lshrrev_b32 v8, 8, v1
    v_lshl_add_u32 v3, v8, 6, v3
    v_bfe_u32 v8, v1, 6, 2
    v_lshl_add_u32 v3, v8, 8, v3
    s_lshl_b32 s33, s23, 7
    s_lshl_b32 s37, s20, 5
    s_add_u32 s33, s33, s37
    v_lshrrev_b32 v8, 7, v1
    v_add_u32 v8, s33, v8
    v_lshlrev_b32 v8, 12, v8
    v_lshrrev_b32 v9, 8, v1
    v_bfe_u32 v10, v1, 4, 3
    v_xor_b32 v9, v9, v10
    v_lshl_add_u32 v8, v9, 4, v8
    v_xor_b32 v9, 64, v8
    v_add_u32 v9, 31744, v9
    v_add_u32 v10, 63488, v8
    v_add_u32 v11, 63488, v9
    s_cmp_eq_u32 s28, 0
    s_cselect_b32 s44, 4, 0
    s_cmp_eq_u32 s28, 1
    s_cselect_b32 s45, 5, 1
    s_cmp_eq_u32 s28, 2
    s_cselect_b32 s46, 6, 2
    s_cmp_eq_u32 s28, 3
    s_cselect_b32 s47, 7, 3
    s_lshl_b32 s33, s20, 4
    s_add_u32 s33, s33, s24
    s_lshl_b32 s54, s22, 7
    s_add_u32 s54, s54, s33
    s_lshl_b32 s54, s54, 8
    s_add_u32 s54, s54, 0x450c000
    s_add_u32 s54, s54, s4
    s_addc_u32 s55, s5, 0
    s_mov_b32 s33, 0x4501000
    v_and_b32 v4, 0xf0, v1
    v_lshlrev_b32 v4, 4, v4
    s_mov_b32 s60, 65536
L_poll_wr:
    buffer_load_dword v5, v4, s[4:7], s33 offen sc1
    s_waitcnt vmcnt(0)
    v_cmp_gt_u32 vcc, 16, v5
    s_sub_u32 s60, s60, 1
    s_cbranch_scc1 L_pd_wr
    s_cbranch_vccz L_pd_wr
    s_sleep 4
    s_branch L_poll_wr
L_pd_wr:
    s_min_u32 s33, s20, 2
    s_lshl_b32 s33, s33, 9
    v_lshrrev_b32 v4, 1, v1
    v_add_u32 v4, s33, v4
    s_lshl_b32 s51, s24, 12
    s_add_u32 s51, s51, 0x4410000
    buffer_load_dwordx2 v[16:17], v4, s[4:7], s51 offen offset:0 sc1
    buffer_load_dwordx2 v[18:19], v4, s[4:7], s51 offen offset:1152 sc1
    s_mov_b32 s48, 0
    s_mul_i32 s50, s48, 18432
    s_add_u32 s50, s50, s34
    s_add_u32 m0, s30, 0
    s_mov_b32 s53, s50
    buffer_load_dwordx4 v1, s[4:7], s50 offen offset:0  sc1 lds
    buffer_load_dwordx4 v1, s[4:7], s50 offen offset:1024  sc1 lds
    buffer_load_dwordx4 v1, s[4:7], s50 offen offset:2048  sc1 lds
    buffer_load_dwordx4 v1, s[4:7], s50 offen offset:3072  sc1 lds
    s_mov_b32 s48, 1
    s_mul_i32 s50, s48, 18432
    s_add_u32 s50, s50, s34
    s_cmp_ge_u32 s20, 2
    s_cselect_b32 s52, s50, s53
    s_add_u32 m0, s31, 0
    s_add_u32 s52, s52, s49
    buffer_load_dwordx4 v1, s[4:7], s52 offen  sc1 lds
    s_add_u32 m0, s30, 36864
    s_mov_b32 s53, s50
    buffer_load_dwordx4 v1, s[4:7], s50 offen offset:0  sc1 lds
    buffer_load_dwordx4 v1, s[4:7], s50 offen offset:1024  sc1 lds
    buffer_load_dwordx4 v1, s[4:7], s50 offen offset:2048  sc1 lds
    buffer_load_dwordx4 v1, s[4:7], s50 offen offset:3072  sc1 lds
    s_mov_b32 m0, 161280
    v_lshrrev_b32 v5, 2, v1
    s_lshl_b32 s33, s23, 8
    buffer_load_dword v5, s[12:15], s33 offen lds
    s_waitcnt vmcnt(10)
    v_add_u32 v4, 159744, v4
    v_add_f32 v16, v16, v18
    v_add_f32 v17, v17, v19
    ds_write_b64 v4, v[16:17]
    s_waitcnt lgkmcnt(0)
    s_barrier
    s_mov_b32 s48, 2
    s_mul_i32 s50, s48, 18432
    s_add_u32 s50, s50, s34
    s_add_u32 m0, s30, 73728
    s_mov_b32 s53, s50
    buffer_load_dwordx4 v1, s[4:7], s50 offen offset:0  sc1 lds
    buffer_load_dwordx4 v1, s[4:7], s50 offen offset:1024  sc1 lds
    buffer_load_dwordx4 v1, s[4:7], s50 offen offset:2048  sc1 lds
    buffer_load_dwordx4 v1, s[4:7], s50 offen offset:3072  sc1 lds
    s_mov_b32 s48, 3
    s_mul_i32 s50, s48, 18432
    s_add_u32 s50, s50, s34
    s_cmp_ge_u32 s20, 2
    s_cselect_b32 s52, s50, s53
    s_add_u32 m0, s31, 73728
    s_add_u32 s52, s52, s49
    buffer_load_dwordx4 v1, s[4:7], s52 offen  sc1 lds
    s_add_u32 m0, s30, 110592
    s_mov_b32 s53, s50
    buffer_load_dwordx4 v1, s[4:7], s50 offen offset:0  sc1 lds
    buffer_load_dwordx4 v1, s[4:7], s50 offen offset:1024  sc1 lds
    buffer_load_dwordx4 v1, s[4:7], s50 offen offset:2048  sc1 lds
    buffer_load_dwordx4 v1, s[4:7], s50 offen offset:3072  sc1 lds
    s_barrier
    s_add_u32 m0, s30, 18432
    s_add_u32 s51, s35, 0
    buffer_load_dwordx4 v1, s[4:7], s51 offen offset:0 sc1 lds
    buffer_load_dwordx4 v1, s[4:7], s51 offen offset:1024 sc1 lds
    buffer_load_dwordx4 v2, s[4:7], s51 offen offset:2048 sc1 lds
    buffer_load_dwordx4 v2, s[4:7], s51 offen offset:3072 sc1 lds
    s_add_u32 m0, s30, 55296
    s_add_u32 s51, s35, 2048
    buffer_load_dwordx4 v1, s[4:7], s51 offen offset:0 sc1 lds
    buffer_load_dwordx4 v1, s[4:7], s51 offen offset:1024 sc1 lds
    buffer_load_dwordx4 v2, s[4:7], s51 offen offset:2048 sc1 lds
    buffer_load_dwordx4 v2, s[4:7], s51 offen offset:3072 sc1 lds
    s_add_u32 m0, s30, 92160
    s_add_u32 s51, s35, 4096
    buffer_load_dwordx4 v1, s[4:7], s51 offen offset:0 sc1 lds
    buffer_load_dwordx4 v1, s[4:7], s51 offen offset:1024 sc1 lds
    buffer_load_dwordx4 v2, s[4:7], s51 offen offset:2048 sc1 lds
    buffer_load_dwordx4 v2, s[4:7], s51 offen offset:3072 sc1 lds
    s_waitcnt vmcnt(8)
    s_barrier
    s_add_u32 m0, s30, 129024
    s_add_u32 s51, s35, 6144
    buffer_load_dwordx4 v1, s[4:7], s51 offen offset:0 sc1 lds
    buffer_load_dwordx4 v1, s[4:7], s51 offen offset:1024 sc1 lds
    buffer_load_dwordx4 v2, s[4:7], s51 offen offset:2048 sc1 lds
    buffer_load_dwordx4 v2, s[4:7], s51 offen offset:3072 sc1 lds
    s_and_b32 s40, s2, 7
    s_lshr_b32 s26, s2, 3
    s_lshr_b32 s38, s40, 1
    s_lshl_b32 s38, s38, 3
    s_lshr_b32 s27, s26, 2
    s_add_u32 s38, s38, s27
    s_and_b32 s39, s40, 1
    s_lshl_b32 s39, s39, 2
    s_and_b32 s27, s26, 3
    s_add_u32 s39, s39, s27
    s_add_u32 s40, s38, s39
    s_and_b32 s40, s40, 3
    s_mul_i32 s42, s20, 9216
    s_mul_i32 s43, s39, 331776
    s_add_u32 s43, s43, s42
    s_add_u32 s43, s43, 0x4100000
    s_waitcnt vmcnt(8) lgkmcnt(0)
    s_barrier
    s_mov_b32 s48, 4
    s_mul_i32 s50, s48, 18432
    s_add_u32 s50, s50, s34
    s_add_u32 m0, s30, 0
    s_mov_b32 s53, s50
    buffer_load_dwordx4 v1, s[4:7], s50 offen offset:0  sc1 lds
    buffer_load_dwordx4 v1, s[4:7], s50 offen offset:1024  sc1 lds
    buffer_load_dwordx4 v1, s[4:7], s50 offen offset:2048  sc1 lds
    buffer_load_dwordx4 v1, s[4:7], s50 offen offset:3072  sc1 lds
    s_add_u32 m0, s30, 18432
    s_add_u32 s51, s35, 8192
    buffer_load_dwordx4 v1, s[4:7], s51 offen offset:0 sc1 lds
    buffer_load_dwordx4 v1, s[4:7], s51 offen offset:1024 sc1 lds
    buffer_load_dwordx4 v2, s[4:7], s51 offen offset:2048 sc1 lds
    buffer_load_dwordx4 v2, s[4:7], s51 offen offset:3072 sc1 lds
    s_waitcnt vmcnt(12) lgkmcnt(0)
    s_barrier
    s_mov_b32 s48, 5
    s_mul_i32 s50, s48, 18432
    s_add_u32 s50, s50, s34
    s_cmp_ge_u32 s20, 2
    s_cselect_b32 s52, s50, s53
    s_add_u32 m0, s31, 0
    s_add_u32 s52, s52, s49
    buffer_load_dwordx4 v1, s[4:7], s52 offen  sc1 lds
    s_add_u32 m0, s30, 36864
    s_mov_b32 s53, s50
    buffer_load_dwordx4 v1, s[4:7], s50 offen offset:0  sc1 lds
    buffer_load_dwordx4 v1, s[4:7], s50 offen offset:1024  sc1 lds
    buffer_load_dwordx4 v1, s[4:7], s50 offen offset:2048  sc1 lds
    buffer_load_dwordx4 v1, s[4:7], s50 offen offset:3072  sc1 lds
    s_add_u32 m0, s30, 55296
    s_add_u32 s51, s35, 10240
    buffer_load_dwordx4 v1, s[4:7], s51 offen offset:0 sc1 lds
    buffer_load_dwordx4 v1, s[4:7], s51 offen offset:1024 sc1 lds
    buffer_load_dwordx4 v2, s[4:7], s51 offen offset:2048 sc1 lds
    buffer_load_dwordx4 v2, s[4:7], s51 offen offset:3072 sc1 lds
    s_waitcnt vmcnt(17) lgkmcnt(0)
    s_barrier
    s_mov_b32 s48, 6
    s_mul_i32 s50, s48, 18432
    s_add_u32 s50, s50, s34
    s_add_u32 m0, s30, 73728
    s_mov_b32 s53, s50
    buffer_load_dwordx4 v1, s[4:7], s50 offen offset:0  sc1 lds
    buffer_load_dwordx4 v1, s[4:7], s50 offen offset:1024  sc1 lds
    buffer_load_dwordx4 v1, s[4:7], s50 offen offset:2048  sc1 lds
    buffer_load_dwordx4 v1, s[4:7], s50 offen offset:3072  sc1 lds
    s_add_u32 m0, s30, 92160
    s_add_u32 s51, s35, 12288
    buffer_load_dwordx4 v1, s[4:7], s51 offen offset:0 sc1 lds
    buffer_load_dwordx4 v1, s[4:7], s51 offen offset:1024 sc1 lds
    buffer_load_dwordx4 v2, s[4:7], s51 offen offset:2048 sc1 lds
    buffer_load_dwordx4 v2, s[4:7], s51 offen offset:3072 sc1 lds
    s_waitcnt vmcnt(16) lgkmcnt(0)
    s_barrier
    s_mov_b32 s48, 7
    s_mul_i32 s50, s48, 18432
    s_add_u32 s50, s50, s34
    s_cmp_ge_u32 s20, 2
    s_cselect_b32 s52, s50, s53
    s_add_u32 m0, s31, 73728
    s_add_u32 s52, s52, s49
    buffer_load_dwordx4 v1, s[4:7], s52 offen  sc1 lds
    s_add_u32 m0, s30, 110592
    s_mov_b32 s53, s50
    buffer_load_dwordx4 v1, s[4:7], s50 offen offset:0  sc1 lds
    buffer_load_dwordx4 v1, s[4:7], s50 offen offset:1024  sc1 lds
    buffer_load_dwordx4 v1, s[4:7], s50 offen offset:2048  sc1 lds
    buffer_load_dwordx4 v1, s[4:7], s50 offen offset:3072  sc1 lds
    s_add_u32 m0, s30, 129024
    s_add_u32 s51, s35, 14336
    buffer_load_dwordx4 v1, s[4:7], s51 offen offset:0 sc1 lds
    buffer_load_dwordx4 v1, s[4:7], s51 offen offset:1024 sc1 lds
    buffer_load_dwordx4 v2, s[4:7], s51 offen offset:2048 sc1 lds
    buffer_load_dwordx4 v2, s[4:7], s51 offen offset:3072 sc1 lds
    s_waitcnt vmcnt(17) lgkmcnt(0)
    s_barrier
    s_mov_b32 s48, 8
    s_mul_i32 s50, s48, 18432
    s_add_u32 s50, s50, s34
    s_add_u32 m0, s30, 0
    s_mov_b32 s53, s50
    buffer_load_dwordx4 v1, s[4:7], s50 offen offset:0  sc1 lds
    buffer_load_dwordx4 v1, s[4:7], s50 offen offset:1024  sc1 lds
    buffer_load_dwordx4 v1, s[4:7], s50 offen offset:2048  sc1 lds
    buffer_load_dwordx4 v1, s[4:7], s50 offen offset:3072  sc1 lds
    s_add_u32 m0, s30, 18432
    s_add_u32 s51, s35, 16384
    buffer_load_dwordx4 v1, s[4:7], s51 offen offset:0 sc1 lds
    buffer_load_dwordx4 v1, s[4:7], s51 offen offset:1024 sc1 lds
    buffer_load_dwordx4 v2, s[4:7], s51 offen offset:2048 sc1 lds
    buffer_load_dwordx4 v2, s[4:7], s51 offen offset:3072 sc1 lds
    s_waitcnt vmcnt(16) lgkmcnt(0)
    s_barrier
    s_mov_b32 s48, 5
    s_mul_i32 s50, s48, 18432
    s_add_u32 s50, s50, s34
    s_add_u32 s50, s50, 165888
    s_cmp_ge_u32 s20, 2
    s_cselect_b32 s52, s50, s53
    s_add_u32 m0, s31, 0
    s_add_u32 s52, s52, s49
    buffer_load_dwordx4 v1, s[4:7], s52 offen  sc1 lds
    s_add_u32 m0, s30, 36864
    s_mov_b32 s53, s50
    buffer_load_dwordx4 v1, s[4:7], s50 offen offset:0  sc1 lds
    buffer_load_dwordx4 v1, s[4:7], s50 offen offset:1024  sc1 lds
    buffer_load_dwordx4 v1, s[4:7], s50 offen offset:2048  sc1 lds
    buffer_load_dwordx4 v1, s[4:7], s50 offen offset:3072  sc1 lds
    s_cmp_lg_u32 s22, 0
    s_cbranch_scc1 L_p5_k6
    s_add_u32 s32, s43, 294912
    buffer_load_dwordx4 v[220:223], v1, s[4:7], s32 offen offset:0 sc1
    buffer_load_dwordx4 v[224:227], v1, s[4:7], s32 offen offset:1024 sc1
    buffer_load_dwordx4 v[228:231], v1, s[4:7], s32 offen offset:2048 sc1
    buffer_load_dwordx4 v[232:235], v1, s[4:7], s32 offen offset:3072 sc1
    s_add_u32 s32, s43, 299008
    buffer_load_dwordx4 v[236:239], v1, s[4:7], s32 offen offset:0 sc1
L_p5_k6:
    s_waitcnt vmcnt(18) lgkmcnt(0)
    s_cmp_eq_u32 s22, 0
    s_cbranch_scc1 L_wv_926
    s_waitcnt vmcnt(13)
L_wv_926:
    s_barrier
    s_mov_b32 s48, 6
    s_mul_i32 s50, s48, 18432
    s_add_u32 s50, s50, s34
    s_add_u32 s50, s50, 165888
    s_add_u32 m0, s30, 73728
    s_mov_b32 s53, s50
    buffer_load_dwordx4 v1, s[4:7], s50 offen offset:0  sc1 lds
    buffer_load_dwordx4 v1, s[4:7], s50 offen offset:1024  sc1 lds
    buffer_load_dwordx4 v1, s[4:7], s50 offen offset:2048  sc1 lds
    buffer_load_dwordx4 v1, s[4:7], s50 offen offset:3072  sc1 lds
    s_cmp_lg_u32 s22, 0
    s_cbranch_scc1 L_p5_k7
    s_add_u32 s32, s43, 299008
    buffer_load_dwordx4 v[240:243], v1, s[4:7], s32 offen offset:1024 sc1
    buffer_load_dwordx4 v[244:247], v1, s[4:7], s32 offen offset:2048 sc1
    buffer_load_dwordx4 v[248:251], v1, s[4:7], s32 offen offset:3072 sc1
    s_add_u32 s32, s43, 303104
    buffer_load_dwordx4 v[252:255], v1, s[4:7], s32 offen offset:0 sc1
    s_add_u32 s32, s43, 258048
    buffer_load_dwordx4 v[184:187], v1, s[4:7], s32 offen offset:0 sc1
L_p5_k7:
    s_waitcnt vmcnt(18) lgkmcnt(0)
    s_cmp_eq_u32 s22, 0
    s_cbranch_scc1 L_wv_953
    s_waitcnt vmcnt(8)
L_wv_953:
    s_barrier
    s_mov_b32 s48, 7
    s_mul_i32 s50, s48, 18432
    s_add_u32 s50, s50, s34
    s_add_u32 s50, s50, 165888
    s_cmp_ge_u32 s20, 2
    s_cselect_b32 s52, s50, s53
    s_add_u32 m0, s31, 73728
    s_add_u32 s52, s52, s49
    buffer_load_dwordx4 v1, s[4:7], s52 offen  sc1 lds
    s_add_u32 m0, s30, 110592
    s_mov_b32 s53, s50
    buffer_load_dwordx4 v1, s[4:7], s50 offen offset:0  sc1 lds
    buffer_load_dwordx4 v1, s[4:7], s50 offen offset:1024  sc1 lds
    buffer_load_dwordx4 v1, s[4:7], s50 offen offset:2048  sc1 lds
    buffer_load_dwordx4 v1, s[4:7], s50 offen offset:3072  sc1 lds
    s_cmp_lg_u32 s22, 0
    s_cbranch_scc1 L_p5_k8
    s_add_u32 s32, s43, 258048
    buffer_load_dwordx4 v[188:191], v1, s[4:7], s32 offen offset:1024 sc1
    buffer_load_dwordx4 v[192:195], v1, s[4:7], s32 offen offset:2048 sc1
    buffer_load_dwordx4 v[196:199], v1, s[4:7], s32 offen offset:3072 sc1
    s_add_u32 s32, s43, 262144
    buffer_load_dwordx4 v[200:203], v1, s[4:7], s32 offen offset:0 sc1
    buffer_load_dwordx4 v[204:207], v1, s[4:7], s32 offen offset:1024 sc1
L_p5_k8:
    s_waitcnt vmcnt(24) lgkmcnt(0)
    s_cmp_eq_u32 s22, 0
    s_cbranch_scc1 L_wv_984
    s_waitcnt vmcnt(9)
L_wv_984:
    s_barrier
    s_mov_b32 s48, 8
    s_mul_i32 s50, s48, 18432
    s_add_u32 s50, s50, s34
    s_add_u32 s50, s50, 165888
    s_add_u32 m0, s30, 0
    s_mov_b32 s53, s50
    buffer_load_dwordx4 v1, s[4:7], s50 offen offset:0  sc1 lds
    buffer_load_dwordx4 v1, s[4:7], s50 offen offset:1024  sc1 lds
    buffer_load_dwordx4 v1, s[4:7], s50 offen offset:2048  sc1 lds
    buffer_load_dwordx4 v1, s[4:7], s50 offen offset:3072  sc1 lds
    s_cmp_lg_u32 s22, 0
    s_cbranch_scc1 L_p5_k9
    s_add_u32 s32, s43, 262144
    buffer_load_dwordx4 v[208:211], v1, s[4:7], s32 offen offset:2048 sc1
    buffer_load_dwordx4 v[212:215], v1, s[4:7], s32 offen offset:3072 sc1
    s_add_u32 s32, s43, 266240
    buffer_load_dwordx4 v[216:219], v1, s[4:7], s32 offen offset:0 sc1
    s_add_u32 s32, s43, 221184
    buffer_load_dwordx4 v[148:151], v1, s[4:7], s32 offen offset:0 sc1
    buffer_load_dwordx4 v[152:155], v1, s[4:7], s32 offen offset:1024 sc1
    buffer_load_dwordx4 v[156:159], v1, s[4:7], s32 offen offset:2048 sc1
    buffer_load_dwordx4 v[160:163], v1, s[4:7], s32 offen offset:3072 sc1
    s_add_u32 s32, s43, 225280
    buffer_load_dwordx4 v[164:167], v1, s[4:7], s32 offen offset:0 sc1
    buffer_load_dwordx4 v[168:171], v1, s[4:7], s32 offen offset:1024 sc1
    buffer_load_dwordx4 v[172:175], v1, s[4:7], s32 offen offset:2048 sc1
    buffer_load_dwordx4 v[176:179], v1, s[4:7], s32 offen offset:3072 sc1
    s_add_u32 s32, s43, 229376
    buffer_load_dwordx4 v[180:183], v1, s[4:7], s32 offen offset:0 sc1
    s_add_u32 s32, s43, 184320
    buffer_load_dwordx4 v[112:115], v1, s[4:7], s32 offen offset:0 sc1
    buffer_load_dwordx4 v[116:119], v1, s[4:7], s32 offen offset:1024 sc1
    buffer_load_dwordx4 v[120:123], v1, s[4:7], s32 offen offset:2048 sc1
    buffer_load_dwordx4 v[124:127], v1, s[4:7], s32 offen offset:3072 sc1
    s_add_u32 s32, s43, 188416
    buffer_load_dwordx4 v[128:131], v1, s[4:7], s32 offen offset:0 sc1
    buffer_load_dwordx4 v[132:135], v1, s[4:7], s32 offen offset:1024 sc1
    buffer_load_dwordx4 v[136:139], v1, s[4:7], s32 offen offset:2048 sc1
    buffer_load_dwordx4 v[140:143], v1, s[4:7], s32 offen offset:3072 sc1
    s_add_u32 s32, s43, 192512
    buffer_load_dwordx4 v[144:147], v1, s[4:7], s32 offen offset:0 sc1
    s_add_u32 s32, s43, 147456
    buffer_load_dwordx4 v[76:79], v1, s[4:7], s32 offen offset:0 sc1
    buffer_load_dwordx4 v[80:83], v1, s[4:7], s32 offen offset:1024 sc1
    buffer_load_dwordx4 v[84:87], v1, s[4:7], s32 offen offset:2048 sc1
    buffer_load_dwordx4 v[88:91], v1, s[4:7], s32 offen offset:3072 sc1
    s_add_u32 s32, s43, 151552
    buffer_load_dwordx4 v[92:95], v1, s[4:7], s32 offen offset:0 sc1
    buffer_load_dwordx4 v[96:99], v1, s[4:7], s32 offen offset:1024 sc1
    buffer_load_dwordx4 v[100:103], v1, s[4:7], s32 offen offset:2048 sc1
    buffer_load_dwordx4 v[104:107], v1, s[4:7], s32 offen offset:3072 sc1
    s_add_u32 s32, s43, 155648
    buffer_load_dwordx4 v[108:111], v1, s[4:7], s32 offen offset:0 sc1
L_p5_k9:
    s_waitcnt vmcnt(43) lgkmcnt(0)
    s_cmp_eq_u32 s22, 0
    s_cbranch_scc1 L_wv_1044
    s_waitcnt vmcnt(8)
L_wv_1044:
    s_barrier
    s_mov_b32 s48, 0
    s_mul_i32 s50, s48, 18432
    s_add_u32 s50, s50, s34
    s_add_u32 s50, s50, 165888
    s_cmp_ge_u32 s20, 2
    s_cselect_b32 s52, s50, s53
    s_add_u32 m0, s31, 0
    s_add_u32 s52, s52, s49
    buffer_load_dwordx4 v1, s[4:7], s52 offen  sc1 lds
    s_add_u32 m0, s30, 36864
    s_mov_b32 s53, s50
    buffer_load_dwordx4 v1, s[4:7], s50 offen offset:0  sc1 lds
    buffer_load_dwordx4 v1, s[4:7], s50 offen offset:1024  sc1 lds
    buffer_load_dwordx4 v1, s[4:7], s50 offen offset:2048  sc1 lds
    buffer_load_dwordx4 v1, s[4:7], s50 offen offset:3072  sc1 lds
    s_add_u32 m0, s30, 55296
    s_add_u32 s51, s35, 0
    buffer_load_dwordx4 v1, s[4:7], s51 offen offset:0 sc1 lds
    buffer_load_dwordx4 v1, s[4:7], s51 offen offset:1024 sc1 lds
    buffer_load_dwordx4 v2, s[4:7], s51 offen offset:2048 sc1 lds
    buffer_load_dwordx4 v2, s[4:7], s51 offen offset:3072 sc1 lds
    s_waitcnt vmcnt(48) lgkmcnt(0)
    s_cmp_eq_u32 s22, 0
    s_cbranch_scc1 L_wv_1071
    s_waitcnt vmcnt(13)
L_wv_1071:
    s_barrier
    buffer_load_dwordx4 v[16:19], v3, s[4:7], s29 offen offset:0 sc1
    buffer_load_dwordx4 v[20:23], v3, s[4:7], s29 offen offset:1024 sc1
    buffer_load_dwordx4 v[24:27], v3, s[4:7], s29 offen offset:2048 sc1
    buffer_load_dwordx4 v[28:31], v3, s[4:7], s29 offen offset:3072 sc1
    s_mov_b32 s48, 1
    s_mul_i32 s50, s48, 18432
    s_add_u32 s50, s50, s34
    s_add_u32 s50, s50, 165888
    s_add_u32 m0, s30, 73728
    s_mov_b32 s53, s50
    buffer_load_dwordx4 v1, s[4:7], s50 offen offset:0  sc1 lds
    buffer_load_dwordx4 v1, s[4:7], s50 offen offset:1024  sc1 lds
    buffer_load_dwordx4 v1, s[4:7], s50 offen offset:2048  sc1 lds
    buffer_load_dwordx4 v1, s[4:7], s50 offen offset:3072  sc1 lds
    s_add_u32 m0, s30, 92160
    s_add_u32 s51, s35, 2048
    buffer_load_dwordx4 v1, s[4:7], s51 offen offset:0 sc1 lds
    buffer_load_dwordx4 v1, s[4:7], s51 offen offset:1024 sc1 lds
    buffer_load_dwordx4 v2, s[4:7], s51 offen offset:2048 sc1 lds
    buffer_load_dwordx4 v2, s[4:7], s51 offen offset:3072 sc1 lds
    s_waitcnt vmcnt(20) lgkmcnt(0)
    s_barrier
    s_mov_b32 s48, 2
    s_mul_i32 s50, s48, 18432
    s_add_u32 s50, s50, s34
    s_add_u32 s50, s50, 165888
    s_cmp_ge_u32 s20, 2
    s_cselect_b32 s52, s50, s53
    s_add_u32 m0, s31, 73728
    s_add_u32 s52, s52, s49
    buffer_load_dwordx4 v1, s[4:7], s52 offen  sc1 lds
    s_add_u32 m0, s30, 110592
    s_mov_b32 s53, s50
    buffer_load_dwordx4 v1, s[4:7], s50 offen offset:0  sc1 lds
    buffer_load_dwordx4 v1, s[4:7], s50 offen offset:1024  sc1 lds
    buffer_load_dwordx4 v1, s[4:7], s50 offen offset:2048  sc1 lds
    buffer_load_dwordx4 v1, s[4:7], s50 offen offset:3072  sc1 lds
    s_add_u32 m0, s30, 129024
    s_add_u32 s51, s35, 4096
    buffer_load_dwordx4 v1, s[4:7], s51 offen offset:0 sc1 lds
    buffer_load_dwordx4 v1, s[4:7], s51 offen offset:1024 sc1 lds
    buffer_load_dwordx4 v2, s[4:7], s51 offen offset:2048 sc1 lds
    buffer_load_dwordx4 v2, s[4:7], s51 offen offset:3072 sc1 lds
    s_mov_b32 s60, 65536
    s_waitcnt vmcnt(17)
L_g_chk:
    v_or3_b32 v32, v17, v19, v21
    v_or3_b32 v33, v23, v25, v27
    v_or3_b32 v32, v29, v31, v32
    v_or_b32 v32, v32, v33
    v_cmp_gt_i32 vcc, 0, v32
    s_sub_u32 s60, s60, 1
    s_cbranch_scc1 L_g_ok
    s_cbranch_vccz L_g_ok
    buffer_load_dwordx4 v[16:19], v3, s[4:7], s29 offen offset:0 sc1
    buffer_load_dwordx4 v[20:23], v3, s[4:7], s29 offen offset:1024 sc1
    buffer_load_dwordx4 v[24:27], v3, s[4:7], s29 offen offset:2048 sc1
    buffer_load_dwordx4 v[28:31], v3, s[4:7], s29 offen offset:3072 sc1
    s_waitcnt vmcnt(0)
    s_branch L_g_chk
L_g_ok:
    v_add_f32 v16, v16, v20
    v_add_f32 v24, v24, v28
    v_add_f32 v17, v17, v21
    v_add_f32 v25, v25, v29
    v_add_f32 v18, v18, v22
    v_add_f32 v26, v26, v30
    v_add_f32 v19, v19, v23
    v_add_f32 v27, v27, v31
    v_add_f32 v16, v16, v24
    v_add_f32 v17, v17, v25
    v_add_f32 v18, v18, v26
    v_add_f32 v19, v19, v27
    v_add_f32_dpp v16, v16, v16 row_ror:4 row_mask:0xf bank_mask:0xf
    v_add_f32_dpp v17, v17, v17 row_ror:4 row_mask:0xf bank_mask:0xf
    v_add_f32_dpp v18, v18, v18 row_ror:4 row_mask:0xf bank_mask:0xf
    v_add_f32_dpp v19, v19, v19 row_ror:4 row_mask:0xf bank_mask:0xf
    v_add_f32_dpp v16, v16, v16 row_ror:8 row_mask:0xf bank_mask:0xf
    v_add_f32_dpp v17, v17, v17 row_ror:8 row_mask:0xf bank_mask:0xf
    v_add_f32_dpp v18, v18, v18 row_ror:8 row_mask:0xf bank_mask:0xf
    v_add_f32_dpp v19, v19, v19 row_ror:8 row_mask:0xf bank_mask:0xf
    v_mul_f32 v16, 0x39e38e39, v16
    v_mul_f32 v17, 0x39e38e39, v17
    v_mul_f32 v18, 0x39e38e39, v18
    v_mul_f32 v19, 0x39e38e39, v19
    v_fma_f32 v17, -v16, v16, v17
    v_fma_f32 v19, -v18, v18, v19
    v_max_f32 v17, 0, v17
    v_max_f32 v19, 0, v19
    v_add_f32 v17, 0x3727c5ac, v17
    v_add_f32 v19, 0x3727c5ac, v19
    v_rsq_f32 v20, v17
    v_rsq_f32 v21, v19
    v_and_b32 v32, 0xff, v3
    s_lshl_b32 s33, s20, 8
    s_add_u32 s33, s33, 148480
    v_add_u32 v32, s33, v32
    v_mul_f32 v22, v16, v20
    v_mul_f32 v23, v18, v21
    ds_write_b128 v32, v[20:23]
    s_waitcnt vmcnt(17) lgkmcnt(0)
    s_barrier
    s_mov_b32 s48, 3
    s_mul_i32 s50, s48, 18432
    s_add_u32 s50, s50, s34
    s_add_u32 s50, s50, 165888
    s_add_u32 m0, s30, 0
    s_mov_b32 s53, s50
    buffer_load_dwordx4 v1, s[4:7], s50 offen offset:0  sc1 lds
    buffer_load_dwordx4 v1, s[4:7], s50 offen offset:1024  sc1 lds
    buffer_load_dwordx4 v1, s[4:7], s50 offen offset:2048  sc1 lds
    buffer_load_dwordx4 v1, s[4:7], s50 offen offset:3072  sc1 lds
    s_add_u32 m0, s30, 18432
    s_add_u32 s51, s35, 6144
    buffer_load_dwordx4 v1, s[4:7], s51 offen offset:0 sc1 lds
    buffer_load_dwordx4 v1, s[4:7], s51 offen offset:1024 sc1 lds
    buffer_load_dwordx4 v2, s[4:7], s51 offen offset:2048 sc1 lds
    buffer_load_dwordx4 v2, s[4:7], s51 offen offset:3072 sc1 lds
    s_waitcnt vmcnt(16) lgkmcnt(0)
    s_barrier
    s_mov_b32 s48, 4
    s_mul_i32 s50, s48, 18432
    s_add_u32 s50, s50, s34
    s_add_u32 s50, s50, 165888
    s_cmp_ge_u32 s20, 2
    s_cselect_b32 s52, s50, s53
    s_add_u32 m0, s31, 0
    s_add_u32 s52, s52, s49
    buffer_load_dwordx4 v1, s[4:7], s52 offen  sc1 lds
    s_add_u32 m0, s30, 36864
    s_mov_b32 s53, s50
    buffer_load_dwordx4 v1, s[4:7], s50 offen offset:0  sc1 lds
    buffer_load_dwordx4 v1, s[4:7], s50 offen offset:1024  sc1 lds
    buffer_load_dwordx4 v1, s[4:7], s50 offen offset:2048  sc1 lds
    buffer_load_dwordx4 v1, s[4:7], s50 offen offset:3072  sc1 lds
    s_add_u32 m0, s30, 55296
    s_add_u32 s51, s35, 8192
    buffer_load_dwordx4 v1, s[4:7], s51 offen offset:0 sc1 lds
    buffer_load_dwordx4 v1, s[4:7], s51 offen offset:1024 sc1 lds
    buffer_load_dwordx4 v2, s[4:7], s51 offen offset:2048 sc1 lds
    buffer_load_dwordx4 v2, s[4:7], s51 offen offset:3072 sc1 lds
    s_waitcnt vmcnt(17) lgkmcnt(0)
    s_barrier
    s_waitcnt vmcnt(8) lgkmcnt(0)
    s_barrier
    s_waitcnt vmcnt(0) lgkmcnt(0)
    s_barrier
    s_barrier
    s_mov_b32 s56, 1
    s_atomic_add s56, s[54:55], 0
    s_mov_b32 s57, 0
    s_atomic_add s57, s[54:55], 0 glc
    s_lshl_b32 s48, s23, 1
    s_add_u32 s48, s48, 0
    s_add_u32 m0, s30, 92160
    s_lshl_b32 s51, s48, 7
    buffer_load_dwordx4 v8, s[8:11], s51 offen offset:0  lds
    buffer_load_dwordx4 v9, s[8:11], s51 offen offset:1024  lds
    buffer_load_dwordx4 v10, s[8:11], s51 offen offset:2048  lds
    buffer_load_dwordx4 v11, s[8:11], s51 offen offset:3072  lds
    s_lshl_b32 s48, s23, 1
    s_add_u32 s48, s48, 1
    s_add_u32 m0, s30, 129024
    s_lshl_b32 s51, s48, 7
    buffer_load_dwordx4 v8, s[8:11], s51 offen offset:0  lds
    buffer_load_dwordx4 v9, s[8:11], s51 offen offset:1024  lds
    buffer_load_dwordx4 v10, s[8:11], s51 offen offset:2048  lds
    buffer_load_dwordx4 v11, s[8:11], s51 offen offset:3072  lds
    s_lshr_b32 s48, s46, 1
    s_cmp_eq_u32 s48, s23
    s_cselect_b32 s48, 1, 31
    s_and_b32 s48, s48, s46
    s_add_u32 m0, s30, 18432
    s_lshl_b32 s51, s48, 7
    buffer_load_dwordx4 v8, s[8:11], s51 offen offset:0  lds
    buffer_load_dwordx4 v9, s[8:11], s51 offen offset:1024  lds
    buffer_load_dwordx4 v10, s[8:11], s51 offen offset:2048  lds
    buffer_load_dwordx4 v11, s[8:11], s51 offen offset:3072  lds
    s_waitcnt lgkmcnt(0)
    s_cmp_ge_u32 s57, 16
    s_cbranch_scc1 L_g_r0
    s_mov_b32 s57, 0
    s_atomic_add s57, s[54:55], 0 glc
    s_waitcnt vmcnt(8)
    s_barrier
    s_waitcnt lgkmcnt(0)
    s_cmp_ge_u32 s57, 16
    s_cbranch_scc1 L_g_r1
    s_waitcnt vmcnt(4)
    s_barrier
    s_mov_b32 s60, 65536
L_poll_z2:
    s_mov_b32 s57, 0
    s_atomic_add s57, s[54:55], 0 glc
    s_waitcnt lgkmcnt(0)
    s_cmp_ge_u32 s57, 16
    s_cbranch_scc1 L_pd_z2
    s_sub_u32 s60, s60, 1
    s_cbranch_scc1 L_pd_z2
    s_sleep 2
    s_branch L_poll_z2
L_pd_z2:
    s_lshr_b32 s48, s46, 1
    s_cmp_eq_u32 s48, s23
    s_cselect_b32 s48, 1, 31
    s_and_b32 s48, s48, s46
    s_mul_i32 s50, s48, 18432
    s_add_u32 s50, s50, s36
    s_add_u32 m0, s30, 0
    s_mov_b32 s53, s50
    buffer_load_dwordx4 v1, s[4:7], s50 offen offset:0 sc1 lds
    buffer_load_dwordx4 v1, s[4:7], s50 offen offset:1024 sc1 lds
    buffer_load_dwordx4 v1, s[4:7], s50 offen offset:2048 sc1 lds
    buffer_load_dwordx4 v1, s[4:7], s50 offen offset:3072 sc1 lds
    s_lshr_b32 s48, s47, 1
    s_cmp_eq_u32 s48, s23
    s_cselect_b32 s48, 1, 31
    s_and_b32 s48, s48, s47
    s_mul_i32 s50, s48, 18432
    s_add_u32 s50, s50, s36
    s_cmp_ge_u32 s20, 2
    s_cselect_b32 s52, s50, s53
    s_add_u32 m0, s31, 0
    s_add_u32 s52, s52, s49
    buffer_load_dwordx4 v1, s[4:7], s52 offen sc1 lds
    s_add_u32 m0, s30, 36864
    s_mov_b32 s53, s50
    buffer_load_dwordx4 v1, s[4:7], s50 offen offset:0 sc1 lds
    buffer_load_dwordx4 v1, s[4:7], s50 offen offset:1024 sc1 lds
    buffer_load_dwordx4 v1, s[4:7], s50 offen offset:2048 sc1 lds
    buffer_load_dwordx4 v1, s[4:7], s50 offen offset:3072 sc1 lds
    s_lshr_b32 s48, s47, 1
    s_cmp_eq_u32 s48, s23
    s_cselect_b32 s48, 1, 31
    s_and_b32 s48, s48, s47
    s_add_u32 m0, s30, 55296
    s_lshl_b32 s51, s48, 7
    buffer_load_dwordx4 v8, s[8:11], s51 offen offset:0  lds
    buffer_load_dwordx4 v9, s[8:11], s51 offen offset:1024  lds
    buffer_load_dwordx4 v10, s[8:11], s51 offen offset:2048  lds
    buffer_load_dwordx4 v11, s[8:11], s51 offen offset:3072  lds
    s_branch L_g_jn
L_g_r0:
    s_lshr_b32 s48, s46, 1
    s_cmp_eq_u32 s48, s23
    s_cselect_b32 s48, 1, 31
    s_and_b32 s48, s48, s46
    s_mul_i32 s50, s48, 18432
    s_add_u32 s50, s50, s36
    s_add_u32 m0, s30, 0
    s_mov_b32 s53, s50
    buffer_load_dwordx4 v1, s[4:7], s50 offen offset:0 sc1 lds
    buffer_load_dwordx4 v1, s[4:7], s50 offen offset:1024 sc1 lds
    buffer_load_dwordx4 v1, s[4:7], s50 offen offset:2048 sc1 lds
    buffer_load_dwordx4 v1, s[4:7], s50 offen offset:3072 sc1 lds
    s_lshr_b32 s48, s47, 1
    s_cmp_eq_u32 s48, s23
    s_cselect_b32 s48, 1, 31
    s_and_b32 s48, s48, s47
    s_mul_i32 s50, s48, 18432
    s_add_u32 s50, s50, s36
    s_cmp_ge_u32 s20, 2
    s_cselect_b32 s52, s50, s53
    s_add_u32 m0, s31, 0
    s_add_u32 s52, s52, s49
    buffer_load_dwordx4 v1, s[4:7], s52 offen sc1 lds
    s_add_u32 m0, s30, 36864
    s_mov_b32 s53, s50
    buffer_load_dwordx4 v1, s[4:7], s50 offen offset:0 sc1 lds
    buffer_load_dwordx4 v1, s[4:7], s50 offen offset:1024 sc1 lds
    buffer_load_dwordx4 v1, s[4:7], s50 offen offset:2048 sc1 lds
    buffer_load_dwordx4 v1, s[4:7], s50 offen offset:3072 sc1 lds
    s_lshr_b32 s48, s47, 1
    s_cmp_eq_u32 s48, s23
    s_cselect_b32 s48, 1, 31
    s_and_b32 s48, s48, s47
    s_add_u32 m0, s30, 55296
    s_lshl_b32 s51, s48, 7
    buffer_load_dwordx4 v8, s[8:11], s51 offen offset:0  lds
    buffer_load_dwordx4 v9, s[8:11], s51 offen offset:1024  lds
    buffer_load_dwordx4 v10, s[8:11], s51 offen offset:2048  lds
    buffer_load_dwordx4 v11, s[8:11], s51 offen offset:3072  lds
    s_waitcnt vmcnt(21)
    s_barrier
    s_waitcnt vmcnt(17)
    s_barrier
    s_branch L_g_jn
L_g_r1:
    s_lshr_b32 s48, s46, 1
    s_cmp_eq_u32 s48, s23
    s_cselect_b32 s48, 1, 31
    s_and_b32 s48, s48, s46
    s_mul_i32 s50, s48, 18432
    s_add_u32 s50, s50, s36
    s_add_u32 m0, s30, 0
    s_mov_b32 s53, s50
    buffer_load_dwordx4 v1, s[4:7], s50 offen offset:0 sc1 lds
    buffer_load_dwordx4 v1, s[4:7], s50 offen offset:1024 sc1 lds
    buffer_load_dwordx4 v1, s[4:7], s50 offen offset:2048 sc1 lds
    buffer_load_dwordx4 v1, s[4:7], s50 offen offset:3072 sc1 lds
    s_lshr_b32 s48, s47, 1
    s_cmp_eq_u32 s48, s23
    s_cselect_b32 s48, 1, 31
    s_and_b32 s48, s48, s47
    s_mul_i32 s50, s48, 18432
    s_add_u32 s50, s50, s36
    s_cmp_ge_u32 s20, 2
    s_cselect_b32 s52, s50, s53
    s_add_u32 m0, s31, 0
    s_add_u32 s52, s52, s49
    buffer_load_dwordx4 v1, s[4:7], s52 offen sc1 lds
    s_add_u32 m0, s30, 36864
    s_mov_b32 s53, s50
    buffer_load_dwordx4 v1, s[4:7], s50 offen offset:0 sc1 lds
    buffer_load_dwordx4 v1, s[4:7], s50 offen offset:1024 sc1 lds
    buffer_load_dwordx4 v1, s[4:7], s50 offen offset:2048 sc1 lds
    buffer_load_dwordx4 v1, s[4:7], s50 offen offset:3072 sc1 lds
    s_lshr_b32 s48, s47, 1
    s_cmp_eq_u32 s48, s23
    s_cselect_b32 s48, 1, 31
    s_and_b32 s48, s48, s47
    s_add_u32 m0, s30, 55296
    s_lshl_b32 s51, s48, 7
    buffer_load_dwordx4 v8, s[8:11], s51 offen offset:0  lds
    buffer_load_dwordx4 v9, s[8:11], s51 offen offset:1024  lds
    buffer_load_dwordx4 v10, s[8:11], s51 offen offset:2048  lds
    buffer_load_dwordx4 v11, s[8:11], s51 offen offset:3072  lds
    s_waitcnt vmcnt(17)
    s_barrier
L_g_jn:
    s_add_u32 s44, s44, 4
    s_cmp_ge_u32 s44, 32
    s_cselect_b32 s44, 4, s44
    s_add_u32 s45, s45, 4
    s_cmp_ge_u32 s45, 32
    s_cselect_b32 s45, 5, s45
    s_add_u32 s46, s46, 4
    s_and_b32 s46, s46, 31
    s_add_u32 s47, s47, 4
    s_and_b32 s47, s47, 31
    s_lshr_b32 s48, s44, 1
    s_cmp_eq_u32 s48, s23
    s_cselect_b32 s48, 1, 31
    s_and_b32 s48, s48, s44
    s_mul_i32 s50, s48, 18432
    s_add_u32 s50, s50, s36
    s_add_u32 m0, s30, 73728
    s_mov_b32 s53, s50
    buffer_load_dwordx4 v1, s[4:7], s50 offen offset:0 sc1 lds
    buffer_load_dwordx4 v1, s[4:7], s50 offen offset:1024 sc1 lds
    buffer_load_dwordx4 v1, s[4:7], s50 offen offset:2048 sc1 lds
    buffer_load_dwordx4 v1, s[4:7], s50 offen offset:3072 sc1 lds
    s_lshr_b32 s48, s44, 1
    s_cmp_eq_u32 s48, s23
    s_cselect_b32 s48, 1, 31
    s_and_b32 s48, s48, s44
    s_add_u32 m0, s30, 92160
    s_lshl_b32 s51, s48, 7
    buffer_load_dwordx4 v8, s[8:11], s51 offen offset:0  lds
    buffer_load_dwordx4 v9, s[8:11], s51 offen offset:1024  lds
    buffer_load_dwordx4 v10, s[8:11], s51 offen offset:2048  lds
    buffer_load_dwordx4 v11, s[8:11], s51 offen offset:3072  lds
    s_add_u32 s44, s44, 4
    s_cmp_ge_u32 s44, 32
    s_cselect_b32 s44, 4, s44
    s_waitcnt vmcnt(16)
    s_barrier
    s_lshr_b32 s48, s45, 1
    s_cmp_eq_u32 s48, s23
    s_cselect_b32 s48, 1, 31
    s_and_b32 s48, s48, s45
    s_mul_i32 s50, s48, 18432
    s_add_u32 s50, s50, s36
    s_cmp_ge_u32 s20, 2
    s_cselect_b32 s52, s50, s53
    s_add_u32 m0, s31, 73728
    s_add_u32 s52, s52, s49
    buffer_load_dwordx4 v1, s[4:7], s52 offen sc1 lds
    s_add_u32 m0, s30, 110592
    s_mov_b32 s53, s50
    buffer_load_dwordx4 v1, s[4:7], s50 offen offset:0 sc1 lds
    buffer_load_dwordx4 v1, s[4:7], s50 offen offset:1024 sc1 lds
    buffer_load_dwordx4 v1, s[4:7], s50 offen offset:2048 sc1 lds
    buffer_load_dwordx4 v1, s[4:7], s50 offen offset:3072 sc1 lds
    s_lshr_b32 s48, s45, 1
    s_cmp_eq_u32 s48, s23
    s_cselect_b32 s48, 1, 31
    s_and_b32 s48, s48, s45
    s_add_u32 m0, s30, 129024
    s_lshl_b32 s51, s48, 7
    buffer_load_dwordx4 v8, s[8:11], s51 offen offset:0  lds
    buffer_load_dwordx4 v9, s[8:11], s51 offen offset:1024  lds
    buffer_load_dwordx4 v10, s[8:11], s51 offen offset:2048  lds
    buffer_load_dwordx4 v11, s[8:11], s51 offen offset:3072  lds
    s_add_u32 s45, s45, 4
    s_cmp_ge_u32 s45, 32
    s_cselect_b32 s45, 5, s45
    s_waitcnt vmcnt(17)
    s_barrier
    s_lshr_b32 s48, s46, 1
    s_cmp_eq_u32 s48, s23
    s_cselect_b32 s48, 1, 31
    s_and_b32 s48, s48, s46
    s_mul_i32 s50, s48, 18432
    s_add_u32 s50, s50, s36
    s_add_u32 m0, s30, 0
    s_mov_b32 s53, s50
    buffer_load_dwordx4 v1, s[4:7], s50 offen offset:0 sc1 lds
    buffer_load_dwordx4 v1, s[4:7], s50 offen offset:1024 sc1 lds
    buffer_load_dwordx4 v1, s[4:7], s50 offen offset:2048 sc1 lds
    buffer_load_dwordx4 v1, s[4:7], s50 offen offset:3072 sc1 lds
    s_lshr_b32 s48, s46, 1
    s_cmp_eq_u32 s48, s23
    s_cselect_b32 s48, 1, 31
    s_and_b32 s48, s48, s46
    s_add_u32 m0, s30, 18432
    s_lshl_b32 s51, s48, 7
    buffer_load_dwordx4 v8, s[8:11], s51 offen offset:0  lds
    buffer_load_dwordx4 v9, s[8:11], s51 offen offset:1024  lds
    buffer_load_dwordx4 v10, s[8:11], s51 offen offset:2048  lds
    buffer_load_dwordx4 v11, s[8:11], s51 offen offset:3072  lds
    s_add_u32 s46, s46, 4
    s_and_b32 s46, s46, 31
    s_waitcnt vmcnt(16)
    s_barrier
    s_lshr_b32 s48, s47, 1
    s_cmp_eq_u32 s48, s23
    s_cselect_b32 s48, 1, 31
    s_and_b32 s48, s48, s47
    s_mul_i32 s50, s48, 18432
    s_add_u32 s50, s50, s36
    s_cmp_ge_u32 s20, 2
    s_cselect_b32 s52, s50, s53
    s_add_u32 m0, s31, 0
    s_add_u32 s52, s52, s49
    buffer_load_dwordx4 v1, s[4:7], s52 offen sc1 lds
    s_add_u32 m0, s30, 36864
    s_mov_b32 s53, s50
    buffer_load_dwordx4 v1, s[4:7], s50 offen offset:0 sc1 lds
    buffer_load_dwordx4 v1, s[4:7], s50 offen offset:1024 sc1 lds
    buffer_load_dwordx4 v1, s[4:7], s50 offen offset:2048 sc1 lds
    buffer_load_dwordx4 v1, s[4:7], s50 offen offset:3072 sc1 lds
    s_lshr_b32 s48, s47, 1
    s_cmp_eq_u32 s48, s23
    s_cselect_b32 s48, 1, 31
    s_and_b32 s48, s48, s47
    s_add_u32 m0, s30, 55296
    s_lshl_b32 s51, s48, 7
    buffer_load_dwordx4 v8, s[8:11], s51 offen offset:0  lds
    buffer_load_dwordx4 v9, s[8:11], s51 offen offset:1024  lds
    buffer_load_dwordx4 v10, s[8:11], s51 offen offset:2048  lds
    buffer_load_dwordx4 v11, s[8:11], s51 offen offset:3072  lds
    s_add_u32 s47, s47, 4
    s_and_b32 s47, s47, 31
    s_mov_b32 s41, 6
L_g_ll:
    s_waitcnt vmcnt(17)
    s_barrier
    s_lshr_b32 s48, s44, 1
    s_cmp_eq_u32 s48, s23
    s_cselect_b32 s48, 1, 31
    s_and_b32 s48, s48, s44
    s_mul_i32 s50, s48, 18432
    s_add_u32 s50, s50, s36
    s_add_u32 m0, s30, 73728
    s_mov_b32 s53, s50
    buffer_load_dwordx4 v1, s[4:7], s50 offen offset:0 sc1 lds
    buffer_load_dwordx4 v1, s[4:7], s50 offen offset:1024 sc1 lds
    buffer_load_dwordx4 v1, s[4:7], s50 offen offset:2048 sc1 lds
    buffer_load_dwordx4 v1, s[4:7], s50 offen offset:3072 sc1 lds
    s_lshr_b32 s48, s44, 1
    s_cmp_eq_u32 s48, s23
    s_cselect_b32 s48, 1, 31
    s_and_b32 s48, s48, s44
    s_add_u32 m0, s30, 92160
    s_lshl_b32 s51, s48, 7
    buffer_load_dwordx4 v8, s[8:11], s51 offen offset:0  lds
    buffer_load_dwordx4 v9, s[8:11], s51 offen offset:1024  lds
    buffer_load_dwordx4 v10, s[8:11], s51 offen offset:2048  lds
    buffer_load_dwordx4 v11, s[8:11], s51 offen offset:3072  lds
    s_add_u32 s44, s44, 4
    s_cmp_ge_u32 s44, 32
    s_cselect_b32 s44, 4, s44
    s_waitcnt vmcnt(16)
    s_barrier
    s_lshr_b32 s48, s45, 1
    s_cmp_eq_u32 s48, s23
    s_cselect_b32 s48, 1, 31
    s_and_b32 s48, s48, s45
    s_mul_i32 s50, s48, 18432
    s_add_u32 s50, s50, s36
    s_cmp_ge_u32 s20, 2
    s_cselect_b32 s52, s50, s53
    s_add_u32 m0, s31, 73728
    s_add_u32 s52, s52, s49
    buffer_load_dwordx4 v1, s[4:7], s52 offen sc1 lds
    s_add_u32 m0, s30, 110592
    s_mov_b32 s53, s50
    buffer_load_dwordx4 v1, s[4:7], s50 offen offset:0 sc1 lds
    buffer_load_dwordx4 v1, s[4:7], s50 offen offset:1024 sc1 lds
    buffer_load_dwordx4 v1, s[4:7], s50 offen offset:2048 sc1 lds
    buffer_load_dwordx4 v1, s[4:7], s50 offen offset:3072 sc1 lds
    s_lshr_b32 s48, s45, 1
    s_cmp_eq_u32 s48, s23
    s_cselect_b32 s48, 1, 31
    s_and_b32 s48, s48, s45
    s_add_u32 m0, s30, 129024
    s_lshl_b32 s51, s48, 7
    buffer_load_dwordx4 v8, s[8:11], s51 offen offset:0  lds
    buffer_load_dwordx4 v9, s[8:11], s51 offen offset:1024  lds
    buffer_load_dwordx4 v10, s[8:11], s51 offen offset:2048  lds
    buffer_load_dwordx4 v11, s[8:11], s51 offen offset:3072  lds
    s_add_u32 s45, s45, 4
    s_cmp_ge_u32 s45, 32
    s_cselect_b32 s45, 5, s45
    s_waitcnt vmcnt(17)
    s_barrier
    s_lshr_b32 s48, s46, 1
    s_cmp_eq_u32 s48, s23
    s_cselect_b32 s48, 1, 31
    s_and_b32 s48, s48, s46
    s_mul_i32 s50, s48, 18432
    s_add_u32 s50, s50, s36
    s_add_u32 m0, s30, 0
    s_mov_b32 s53, s50
    buffer_load_dwordx4 v1, s[4:7], s50 offen offset:0 sc1 lds
    buffer_load_dwordx4 v1, s[4:7], s50 offen offset:1024 sc1 lds
    buffer_load_dwordx4 v1, s[4:7], s50 offen offset:2048 sc1 lds
    buffer_load_dwordx4 v1, s[4:7], s50 offen offset:3072 sc1 lds
    s_lshr_b32 s48, s46, 1
    s_cmp_eq_u32 s48, s23
    s_cselect_b32 s48, 1, 31
    s_and_b32 s48, s48, s46
    s_add_u32 m0, s30, 18432
    s_lshl_b32 s51, s48, 7
    buffer_load_dwordx4 v8, s[8:11], s51 offen offset:0  lds
    buffer_load_dwordx4 v9, s[8:11], s51 offen offset:1024  lds
    buffer_load_dwordx4 v10, s[8:11], s51 offen offset:2048  lds
    buffer_load_dwordx4 v11, s[8:11], s51 offen offset:3072  lds
    s_add_u32 s46, s46, 4
    s_and_b32 s46, s46, 31
    s_waitcnt vmcnt(16)
    s_barrier
    s_lshr_b32 s48, s47, 1
    s_cmp_eq_u32 s48, s23
    s_cselect_b32 s48, 1, 31
    s_and_b32 s48, s48, s47
    s_mul_i32 s50, s48, 18432
    s_add_u32 s50, s50, s36
    s_cmp_ge_u32 s20, 2
    s_cselect_b32 s52, s50, s53
    s_add_u32 m0, s31, 0
    s_add_u32 s52, s52, s49
    buffer_load_dwordx4 v1, s[4:7], s52 offen sc1 lds
    s_add_u32 m0, s30, 36864
    s_mov_b32 s53, s50
    buffer_load_dwordx4 v1, s[4:7], s50 offen offset:0 sc1 lds
    buffer_load_dwordx4 v1, s[4:7], s50 offen offset:1024 sc1 lds
    buffer_load_dwordx4 v1, s[4:7], s50 offen offset:2048 sc1 lds
    buffer_load_dwordx4 v1, s[4:7], s50 offen offset:3072 sc1 lds
    s_lshr_b32 s48, s47, 1
    s_cmp_eq_u32 s48, s23
    s_cselect_b32 s48, 1, 31
    s_and_b32 s48, s48, s47
    s_add_u32 m0, s30, 55296
    s_lshl_b32 s51, s48, 7
    buffer_load_dwordx4 v8, s[8:11], s51 offen offset:0  lds
    buffer_load_dwordx4 v9, s[8:11], s51 offen offset:1024  lds
    buffer_load_dwordx4 v10, s[8:11], s51 offen offset:2048  lds
    buffer_load_dwordx4 v11, s[8:11], s51 offen offset:3072  lds
    s_add_u32 s47, s47, 4
    s_and_b32 s47, s47, 31
    s_sub_u32 s41, s41, 1
    s_cmp_lg_u32 s41, 0
    s_cbranch_scc1 L_g_ll
    s_waitcnt vmcnt(17)
    s_barrier
    s_mov_b32 s32, 0
    s_mul_i32 s32, s32, 36864
    s_add_u32 s32, s32, s43
    s_add_u32 m0, s42, 73728
    s_add_u32 s33, s32, 0
    buffer_load_dwordx4 v1, s[4:7], s33 offen offset:0  sc1 lds
    buffer_load_dwordx4 v1, s[4:7], s33 offen offset:1024  sc1 lds
    buffer_load_dwordx4 v1, s[4:7], s33 offen offset:2048  sc1 lds
    buffer_load_dwordx4 v1, s[4:7], s33 offen offset:3072  sc1 lds
    s_add_u32 m0, s42, 77824
    s_add_u32 s33, s32, 4096
    buffer_load_dwordx4 v1, s[4:7], s33 offen offset:0  sc1 lds
    buffer_load_dwordx4 v1, s[4:7], s33 offen offset:1024  sc1 lds
    buffer_load_dwordx4 v1, s[4:7], s33 offen offset:2048  sc1 lds
    buffer_load_dwordx4 v1, s[4:7], s33 offen offset:3072  sc1 lds
    s_add_u32 m0, s42, 81920
    s_add_u32 s33, s32, 8192
    buffer_load_dwordx4 v1, s[4:7], s33 offen offset:0  sc1 lds
    s_waitcnt vmcnt(9)
    s_barrier
    s_mov_b32 s32, 1
    s_mul_i32 s32, s32, 36864
    s_add_u32 s32, s32, s43
    s_add_u32 m0, s42, 110592
    s_add_u32 s33, s32, 0
    buffer_load_dwordx4 v1, s[4:7], s33 offen offset:0  sc1 lds
    buffer_load_dwordx4 v1, s[4:7], s33 offen offset:1024  sc1 lds
    buffer_load_dwordx4 v1, s[4:7], s33 offen offset:2048  sc1 lds
    buffer_load_dwordx4 v1, s[4:7], s33 offen offset:3072  sc1 lds
    s_add_u32 m0, s42, 114688
    s_add_u32 s33, s32, 4096
    buffer_load_dwordx4 v1, s[4:7], s33 offen offset:0  sc1 lds
    buffer_load_dwordx4 v1, s[4:7], s33 offen offset:1024  sc1 lds
    buffer_load_dwordx4 v1, s[4:7], s33 offen offset:2048  sc1 lds
    buffer_load_dwordx4 v1, s[4:7], s33 offen offset:3072  sc1 lds
    s_add_u32 m0, s42, 118784
    s_add_u32 s33, s32, 8192
    buffer_load_dwordx4 v1, s[4:7], s33 offen offset:0  sc1 lds
    s_barrier
    s_mov_b32 s32, 2
    s_mul_i32 s32, s32, 36864
    s_add_u32 s32, s32, s43
    s_add_u32 m0, s42, 0
    s_add_u32 s33, s32, 0
    buffer_load_dwordx4 v1, s[4:7], s33 offen offset:0  sc1 lds
    buffer_load_dwordx4 v1, s[4:7], s33 offen offset:1024  sc1 lds
    buffer_load_dwordx4 v1, s[4:7], s33 offen offset:2048  sc1 lds
    buffer_load_dwordx4 v1, s[4:7], s33 offen offset:3072  sc1 lds
    s_add_u32 m0, s42, 4096
    s_add_u32 s33, s32, 4096
    buffer_load_dwordx4 v1, s[4:7], s33 offen offset:0  sc1 lds
    buffer_load_dwordx4 v1, s[4:7], s33 offen offset:1024  sc1 lds
    buffer_load_dwordx4 v1, s[4:7], s33 offen offset:2048  sc1 lds
    buffer_load_dwordx4 v1, s[4:7], s33 offen offset:3072  sc1 lds
    s_add_u32 m0, s42, 8192
    s_add_u32 s33, s32, 8192
    buffer_load_dwordx4 v1, s[4:7], s33 offen offset:0  sc1 lds
    s_barrier
    s_mov_b32 s32, 3
    s_mul_i32 s32, s32, 36864
    s_add_u32 s32, s32, s43
    s_add_u32 m0, s42, 36864
    s_add_u32 s33, s32, 0
    buffer_load_dwordx4 v1, s[4:7], s33 offen offset:0  sc1 lds
    buffer_load_dwordx4 v1, s[4:7], s33 offen offset:1024  sc1 lds
    buffer_load_dwordx4 v1, s[4:7], s33 offen offset:2048  sc1 lds
    buffer_load_dwordx4 v1, s[4:7], s33 offen offset:3072  sc1 lds
    s_add_u32 m0, s42, 40960
    s_add_u32 s33, s32, 4096
    buffer_load_dwordx4 v1, s[4:7], s33 offen offset:0  sc1 lds
    buffer_load_dwordx4 v1, s[4:7], s33 offen offset:1024  sc1 lds
    buffer_load_dwordx4 v1, s[4:7], s33 offen offset:2048  sc1 lds
    buffer_load_dwordx4 v1, s[4:7], s33 offen offset:3072  sc1 lds
    s_add_u32 m0, s42, 45056
    s_add_u32 s33, s32, 8192
    buffer_load_dwordx4 v1, s[4:7], s33 offen offset:0  sc1 lds
    s_waitcnt vmcnt(27) lgkmcnt(0)
    s_barrier
    v_add_u32 v12, s42, v1
    v_add_u32 v13, 36864, v12
    v_add_u32 v14, 73728, v12
    v_add_u32 v15, 110592, v12
    s_waitcnt vmcnt(18) lgkmcnt(15)
    s_barrier
    ds_write_b128 v14, v[76:79] offset:0
    ds_write_b128 v14, v[80:83] offset:1024
    ds_write_b128 v14, v[84:87] offset:2048
    ds_write_b128 v14, v[88:91] offset:3072
    ds_write_b128 v14, v[92:95] offset:4096
    ds_write_b128 v14, v[96:99] offset:5120
    ds_write_b128 v14, v[100:103] offset:6144
    s_waitcnt vmcnt(9) lgkmcnt(15)
    s_barrier
    ds_write_b128 v14, v[104:107] offset:7168
    ds_write_b128 v14, v[108:111] offset:8192
    ds_write_b128 v15, v[112:115] offset:0
    ds_write_b128 v15, v[116:119] offset:1024
    ds_write_b128 v15, v[120:123] offset:2048
    ds_write_b128 v15, v[124:127] offset:3072
    ds_write_b128 v15, v[128:131] offset:4096
    s_waitcnt vmcnt(0) lgkmcnt(15)
    s_barrier
    ds_write_b128 v15, v[132:135] offset:5120
    ds_write_b128 v15, v[136:139] offset:6144
    ds_write_b128 v15, v[140:143] offset:7168
    ds_write_b128 v15, v[144:147] offset:8192
    ds_write_b128 v12, v[148:151] offset:0
    ds_write_b128 v12, v[152:155] offset:1024
    ds_write_b128 v12, v[156:159] offset:2048
    s_waitcnt vmcnt(63) lgkmcnt(12)
    s_barrier
    ds_write_b128 v12, v[160:163] offset:3072
    ds_write_b128 v12, v[164:167] offset:4096
    ds_write_b128 v12, v[168:171] offset:5120
    ds_write_b128 v12, v[172:175] offset:6144
    ds_write_b128 v12, v[176:179] offset:7168
    ds_write_b128 v12, v[180:183] offset:8192
    s_waitcnt vmcnt(63) lgkmcnt(9)
    s_barrier
    ds_write_b128 v13, v[184:187] offset:0
    ds_write_b128 v13, v[188:191] offset:1024
    ds_write_b128 v13, v[192:195] offset:2048
    ds_write_b128 v13, v[196:199] offset:3072
    ds_write_b128 v13, v[200:203] offset:4096
    ds_write_b128 v13, v[204:207] offset:5120
    s_waitcnt vmcnt(63) lgkmcnt(6)
    s_barrier
    s_and_b32 s25, s2, 7
    s_lshr_b32 s26, s2, 3
    s_lshr_b32 s23, s25, 1
    s_lshl_b32 s23, s23, 2
    s_lshr_b32 s27, s26, 3
    s_add_u32 s23, s23, s27
    s_and_b32 s24, s25, 1
    s_lshl_b32 s24, s24, 3
    s_and_b32 s27, s26, 7
    s_add_u32 s24, s24, s27
    s_mul_i32 s29, s24, 129024
    s_lshl_b32 s30, s20, 12
    s_add_u32 s29, s29, s30
    s_add_u32 s29, s29, 0x3800000
    s_lshl_b32 s31, s23, 3
    s_max_u32 s31, s31, 1
    s_sub_u32 s31, s31, 1
    s_mul_i32 s31, s31, 18432
    s_add_u32 s31, s31, 0x1c00000
    s_lshl_b32 s35, s20, 10
    s_and_b32 s36, s35, 1024
    ds_write_b128 v13, v[208:211] offset:6144
    ds_write_b128 v13, v[212:215] offset:7168
    ds_write_b128 v13, v[216:219] offset:8192
    ds_write_b128 v14, v[220:223] offset:0
    ds_write_b128 v14, v[224:227] offset:1024
    ds_write_b128 v14, v[228:231] offset:2048
    s_waitcnt vmcnt(63) lgkmcnt(3)
    s_barrier
    ds_write_b128 v14, v[232:235] offset:3072
    ds_write_b128 v14, v[236:239] offset:4096
    ds_write_b128 v14, v[240:243] offset:5120
    ds_write_b128 v14, v[244:247] offset:6144
    ds_write_b128 v14, v[248:251] offset:7168
    ds_write_b128 v14, v[252:255] offset:8192
    s_waitcnt vmcnt(63) lgkmcnt(0)
    s_barrier
    s_cmp_eq_u32 s22, 1
    s_cbranch_scc1 L_m_t8
    s_add_u32 m0, s30, 0
    s_add_u32 s34, s29, 0
    buffer_load_dwordx4 v1, s[4:7], s34 offen offset:0 sc1 lds
    buffer_load_dwordx4 v1, s[4:7], s34 offen offset:1024 sc1 lds
    buffer_load_dwordx4 v1, s[4:7], s34 offen offset:2048 sc1 lds
    buffer_load_dwordx4 v1, s[4:7], s34 offen offset:3072 sc1 lds
    s_add_u32 m0, s30, 16384
    s_add_u32 s34, s29, 16384
    buffer_load_dwordx4 v1, s[4:7], s34 offen offset:0 sc1 lds
    buffer_load_dwordx4 v1, s[4:7], s34 offen offset:1024 sc1 lds
    buffer_load_dwordx4 v1, s[4:7], s34 offen offset:2048 sc1 lds
    buffer_load_dwordx4 v1, s[4:7], s34 offen offset:3072 sc1 lds
L_m_t8:
    s_cmp_eq_u32 s22, 1
    s_cbranch_scc1 L_m_lfin
    s_barrier
    s_add_u32 m0, s30, 32768
    s_add_u32 s34, s29, 32768
    buffer_load_dwordx4 v1, s[4:7], s34 offen offset:0 sc1 lds
    buffer_load_dwordx4 v1, s[4:7], s34 offen offset:1024 sc1 lds
    buffer_load_dwordx4 v1, s[4:7], s34 offen offset:2048 sc1 lds
    buffer_load_dwordx4 v1, s[4:7], s34 offen offset:3072 sc1 lds
    s_add_u32 m0, s30, 114688
    s_add_u32 s34, s29, 114688
    buffer_load_dwordx4 v1, s[4:7], s34 offen offset:0 sc1 lds
    buffer_load_dwordx4 v1, s[4:7], s34 offen offset:1024 sc1 lds
    buffer_load_dwordx4 v1, s[4:7], s34 offen offset:2048 sc1 lds
    buffer_load_dwordx4 v1, s[4:7], s34 offen offset:3072 sc1 lds
    s_mov_b32 s22, 1
    s_mov_b32 s21, 0x1c00000
    s_barrier
    s_barrier
    s_add_u32 m0, s30, 49152
    s_add_u32 s34, s29, 49152
    buffer_load_dwordx4 v1, s[4:7], s34 offen offset:0 sc1 lds
    buffer_load_dwordx4 v1, s[4:7], s34 offen offset:1024 sc1 lds
    buffer_load_dwordx4 v1, s[4:7], s34 offen offset:2048 sc1 lds
    buffer_load_dwordx4 v1, s[4:7], s34 offen offset:3072 sc1 lds
    v_lshrrev_b32 v2, 8, v1
    v_bfe_u32 v3, v1, 7, 1
    v_bfe_u32 v4, v1, 4, 3
    v_cmp_gt_u32 vcc, 3, v2
    v_mul_u32_u24 v3, 80, v3
    v_lshl_add_u32 v3, v4, 3, v3
    v_lshrrev_b32 v5, 1, v4
    v_and_b32 v4, 1, v4
    v_lshl_add_u32 v4, v4, 3, 64
    v_cndmask_b32 v2, v5, v2, vcc
    v_cndmask_b32 v3, v4, v3, vcc
    v_mul_u32_u24 v2, 2304, v2
    v_add_u32 v0, v2, v3
    v_lshrrev_b32 v8, 1, v1
    s_mul_i32 s34, s24, 144
    s_add_u32 s34, s34, 0x4400000
    buffer_load_dwordx2 v[2:3], v0, s[4:7], s34 offen sc1
    s_mul_i32 s34, s24, 144
    s_add_u32 s34, s34, 0x4402000
    buffer_load_dwordx2 v[4:5], v0, s[4:7], s34 offen sc1
    s_mul_i32 s34, s24, 144
    s_add_u32 s34, s34, 0x4404000
    buffer_load_dwordx2 v[6:7], v0, s[4:7], s34 offen sc1
    s_mul_i32 s34, s24, 144
    s_add_u32 s34, s34, 0x4406000
    buffer_load_dwordx2 v[12:13], v0, s[4:7], s34 offen sc1
    s_add_u32 m0, s30, 65536
    s_add_u32 s34, s29, 65536
    buffer_load_dwordx4 v1, s[4:7], s34 offen offset:0 sc1 lds
    buffer_load_dwordx4 v1, s[4:7], s34 offen offset:1024 sc1 lds
    buffer_load_dwordx4 v1, s[4:7], s34 offen offset:2048 sc1 lds
    buffer_load_dwordx4 v1, s[4:7], s34 offen offset:3072 sc1 lds
    s_add_u32 m0, s30, 81920
    s_add_u32 s34, s29, 81920
    buffer_load_dwordx4 v1, s[4:7], s34 offen offset:0 sc1 lds
    buffer_load_dwordx4 v1, s[4:7], s34 offen offset:1024 sc1 lds
    buffer_load_dwordx4 v1, s[4:7], s34 offen offset:2048 sc1 lds
    buffer_load_dwordx4 v1, s[4:7], s34 offen offset:3072 sc1 lds
    s_barrier
    s_add_u32 m0, s35, 131072
    s_add_u32 s34, s31, s35
    s_add_u32 s34, s34, 0
    buffer_load_dwordx4 v1, s[4:7], s34 offen sc1 lds
    s_waitcnt vmcnt(29) lgkmcnt(0)
    s_barrier
    s_add_u32 m0, s35, 135168
    s_add_u32 s34, s31, s35
    s_add_u32 s34, s34, 4096
    buffer_load_dwordx4 v1, s[4:7], s34 offen sc1 lds
    s_add_u32 m0, s35, 139264
    s_add_u32 s34, s31, s35
    s_add_u32 s34, s34, 8192
    buffer_load_dwordx4 v1, s[4:7], s34 offen sc1 lds
    s_add_u32 m0, s35, 143360
    s_add_u32 s34, s31, s35
    s_add_u32 s34, s34, 12288
    buffer_load_dwordx4 v1, s[4:7], s34 offen sc1 lds
    s_add_u32 m0, s30, 98304
    s_add_u32 s34, s29, 98304
    buffer_load_dwordx4 v1, s[4:7], s34 offen offset:0 sc1 lds
    buffer_load_dwordx4 v1, s[4:7], s34 offen offset:1024 sc1 lds
    buffer_load_dwordx4 v1, s[4:7], s34 offen offset:2048 sc1 lds
    buffer_load_dwordx4 v1, s[4:7], s34 offen offset:3072 sc1 lds
    s_add_u32 m0, s36, 147456
    s_add_u32 s34, s31, s36
    s_add_u32 s34, s34, 16384
    buffer_load_dwordx4 v1, s[4:7], s34 offen sc1 lds
    s_waitcnt vmcnt(8) lgkmcnt(0)
    s_barrier
    s_waitcnt vmcnt(8) lgkmcnt(0)
    s_barrier
    s_waitcnt vmcnt(7) lgkmcnt(0)
    s_barrier
    v_add_f32 v2, v2, v4
    v_add_f32 v3, v3, v5
    v_add_f32 v6, v6, v12
    v_add_f32 v7, v7, v13
    v_add_f32 v2, v2, v6
    v_add_f32 v3, v3, v7
    v_cmp_gt_u32 vcc, 864, v1
    v_add_u32 v8, 161792, v8
    s_nop 0
    v_cndmask_b32 v2, 0, v2, vcc
    v_cndmask_b32 v3, 0, v3, vcc
    ds_write_b64 v8, v[2:3]
    s_waitcnt vmcnt(6) lgkmcnt(0)
    s_barrier
    s_waitcnt vmcnt(6) lgkmcnt(0)
    s_barrier
    s_waitcnt vmcnt(1) lgkmcnt(0)
    s_barrier
    s_waitcnt vmcnt(0) lgkmcnt(0)
    s_barrier
    s_barrier
    s_branch L_m_ll
L_m_lfin:
L_end_m:
    s_endpgm

.section .rodata,"a"
.p2align 6
.amdhsa_kernel interleave_layers__sliding_local_dilated__mixer_gmlp__prompt_kernel
  .amdhsa_next_free_vgpr 256
  .amdhsa_next_free_sgpr 102
  .amdhsa_accum_offset 256
  .amdhsa_group_segment_fixed_size 0
  .amdhsa_kernarg_size 88
  .amdhsa_user_sgpr_count 2
  .amdhsa_user_sgpr_kernarg_segment_ptr 1
  .amdhsa_system_sgpr_workgroup_id_x 1
  .amdhsa_float_denorm_mode_32 3
.end_amdhsa_kernel
```

```asm
; @launch grid=(256,1,1) block=(512,1,1) lds=163840
.amdgcn_target "amdgcn-amd-amdhsa--gfx950"
.text
.globl interleave_layers__sliding_local_dilated__mixer_gmlp__prompt_kernel
.p2align 8
.type interleave_layers__sliding_local_dilated__mixer_gmlp__prompt_kernel,@function
interleave_layers__sliding_local_dilated__mixer_gmlp__prompt_kernel:
    s_cmp_ge_u32 s2, 256
    s_cbranch_scc1 L_end_m
    s_load_dwordx16 s[36:51], s[0:1], 0
    s_load_dwordx4 s[56:59], s[0:1], 64
    s_load_dwordx2 s[24:25], s[0:1], 80
    s_getpc_b64 s[26:27]
L_m_pc:
    s_sub_u32 s26, s26, L_m_pc-interleave_layers__sliding_local_dilated__mixer_gmlp__prompt_kernel
    s_subb_u32 s27, s27, 0
    v_lshlrev_b32 v4, 4, v0
    v_mov_b32 v5, s27
    v_add_co_u32 v6, vcc, s26, v4
    s_lshr_b32 s28, s2, 3
    s_lshl_b32 s28, s28, 11
    v_addc_co_u32 v7, vcc, 0, v5, vcc
    global_load_dwordx4 v[60:63], v[6:7], off
    v_lshl_add_u32 v4, v0, 2, s28
    v_min_u32 v4, L_end_m-interleave_layers__sliding_local_dilated__mixer_gmlp__prompt_kernel-4, v4
    v_add_co_u32 v6, vcc, s26, v4
    s_nop 1
    v_addc_co_u32 v7, vcc, 0, v5, vcc
    global_load_dword v64, v[6:7], off
    v_lshrrev_b32 v2, 6, v0
    v_and_b32 v1, 63, v0
    v_lshlrev_b32 v1, 4, v1
    v_readfirstlane_b32 s23, v2
    s_mov_b32 s22, 0
    s_mov_b32 s21, 0
    s_and_b32 s20, s23, 3
    s_waitcnt lgkmcnt(0)
    s_mov_b32 s4, s24
    s_mov_b32 s5, s25
    s_mov_b32 s6, 0x10000000
    s_mov_b32 s7, 0x20000
    s_cmp_ge_u32 s23, 4
    s_cbranch_scc1 L_ld_m
    v_bfe_u32 v2, v1, 4, 4
    v_lshrrev_b32 v3, 8, v1
    v_bfrev_b32 v6, 1
    v_mov_b32 v11, 0x3f803f80
    s_lshl_b32 s30, s20, 12
    s_and_b32 s29, s20, 1
    s_cmp_lt_u32 s2, 128
    s_cbranch_scc1 L_p0_x
    s_cmp_lt_u32 s2, 236
    s_cbranch_scc1 L_p0_wq
    s_cmp_lt_u32 s2, 254
    s_cbranch_scc1 L_p0_wo
    s_mov_b32 s46, 0
    s_mov_b32 s27, 0x800000
    s_barrier
    s_branch L_p0_cd
L_p0_wo:
    s_mul_i32 s30, s20, 9216
    s_sub_u32 s26, s2, 236
    s_mul_i32 s28, s26, 57
    s_lshr_b32 s28, s28, 9
    s_mul_i32 s27, s28, 9
    s_sub_u32 s27, s26, s27
    s_mov_b32 s32, s40
    s_mov_b32 s33, s41
    s_mov_b32 s34, 0xa2000
    s_mov_b32 s35, 0x20000
    s_mul_i32 s29, s28, 331776
    s_lshl_b32 s31, s27, 7
    s_add_u32 s29, s29, s31
    s_mul_i32 s31, s20, 82944
    s_add_u32 s29, s29, s31
    s_mul_i32 s30, s20, 9216
    v_lshrrev_b32 v4, 7, v1
    v_mul_u32_u24 v4, 1152, v4
    v_and_b32 v5, 0x70, v1
    v_add_u32 v4, v4, v5
    s_add_u32 m0, s30, 0
    s_add_u32 s31, s29, 0
    buffer_load_dwordx4 v4, s[32:35], s31 offen  lds
    s_add_u32 m0, s30, 1024
    s_add_u32 s31, s29, 9216
    buffer_load_dwordx4 v4, s[32:35], s31 offen  lds
    s_add_u32 m0, s30, 2048
    s_add_u32 s31, s29, 18432
    buffer_load_dwordx4 v4, s[32:35], s31 offen  lds
    s_add_u32 m0, s30, 3072
    s_add_u32 s31, s29, 27648
    buffer_load_dwordx4 v4, s[32:35], s31 offen  lds
    s_add_u32 m0, s30, 4096
    s_add_u32 s31, s29, 36864
    buffer_load_dwordx4 v4, s[32:35], s31 offen  lds
    s_add_u32 m0, s30, 5120
    s_add_u32 s31, s29, 46080
    buffer_load_dwordx4 v4, s[32:35], s31 offen  lds
    s_add_u32 m0, s30, 6144
    s_add_u32 s31, s29, 55296
    buffer_load_dwordx4 v4, s[32:35], s31 offen  lds
    s_add_u32 m0, s30, 7168
    s_add_u32 s31, s29, 64512
    buffer_load_dwordx4 v4, s[32:35], s31 offen  lds
    s_add_u32 m0, s30, 8192
    s_add_u32 s31, s29, 73728
    buffer_load_dwordx4 v4, s[32:35], s31 offen  lds
    v_lshrrev_b32 v7, 2, v2
    v_and_b32 v8, 3, v2
    v_bfe_u32 v9, v1, 7, 0
    v_xor_b32 v9, s20, v9
    v_lshlrev_b32 v9, 5, v9
    v_lshl_add_u32 v9, v7, 7, v9
    v_lshl_add_u32 v9, v8, 3, v9
    v_add_u32 v9, 0, v9
    v_mul_u32_u24 v4, 512, v3
    v_add_u32 v4, v4, v9
    v_mul_u32_u24 v5, 9216, v3
    v_add_u32 v5, v5, v9
    s_lshl_b32 s31, s27, 2
    s_add_u32 s31, s31, s20
    v_lshl_add_u32 v7, s31, 2, v7
    v_lshlrev_b32 v8, 4, v8
    v_lshl_add_u32 v8, v3, 8, v8
    v_mul_u32_u24 v9, 57, v7
    v_lshrrev_b32 v9, 10, v9
    v_mul_u32_u24 v10, 18, v9
    v_sub_u32 v10, v7, v10
    v_lshrrev_b32 v12, 3, v10
    v_and_b32 v13, 1, v10
    v_lshl_add_u32 v12, v12, 1, v13
    v_bfe_u32 v14, v10, 1, 2
    v_cmp_gt_u32 vcc, 16, v10
    v_mul_u32_u24 v9, 82944, v9
    v_add_u32 v9, v9, v8
    v_cndmask_b32 v12, 8, v12, vcc
    v_cndmask_b32 v14, v13, v14, vcc
    v_mov_b32 v15, 0x1000
    v_mov_b32 v13, 0x80
    v_cndmask_b32 v15, v13, v15, vcc
    v_lshl_add_u32 v9, v12, 10, v9
    v_lshl_add_u32 v9, v14, 6, v9
    v_add_u32 v10, v9, v15
    s_and_b32 s31, s28, 1
    s_cmp_eq_u32 s31, 1
    s_cselect_b64 vcc, -1, 0
    v_cndmask_b32 v14, v9, v10, vcc
    s_mul_i32 s31, s28, 36864
    s_add_u32 s37, s31, 0x3a00000
    s_add_u32 s38, s31, 0x3a00000
    s_add_u32 s39, s31, 0x3a02400
    s_add_u32 s40, s31, 0x3a02400
    s_add_u32 s41, s31, 0x3a04800
    s_add_u32 s42, s31, 0x3a04800
    s_add_u32 s43, s31, 0x3a06c00
    s_add_u32 s47, s31, 0x3a06c00
    s_lshr_b32 s31, s28, 1
    s_mul_i32 s31, s31, 9216
    s_add_u32 s48, s31, 0x3a12000
    s_cmp_ge_u32 s26, 4
    s_cbranch_scc1 L_p0_n2
    s_lshl_b32 s31, s26, 2
    s_add_u32 s31, s31, s20
    s_lshl_b32 s31, s31, 12
    s_add_u32 s31, s31, 0x4508000
    v_and_b32 v56, 0x380, v1
    v_add_u32 v56, v56, v1
    v_mov_b32 v52, 0
    v_mov_b32 v53, 0
    v_mov_b32 v54, 0
    v_mov_b32 v55, 0
    buffer_store_dwordx4 v[52:55], v56, s[4:7], s31 offen offset:0 sc1
    buffer_store_dwordx4 v[52:55], v56, s[4:7], s31 offen offset:2048 sc1
L_p0_n2:
    s_waitcnt vmcnt(0)
    s_barrier
    ds_read_b64_tr_b16 v[16:17], v4 offset:0
    ds_read_b64_tr_b16 v[18:19], v4 offset:2560
    ds_read_b64_tr_b16 v[20:21], v4 offset:4608
    ds_read_b64_tr_b16 v[22:23], v4 offset:7168
    ds_read_b64_tr_b16 v[24:25], v4 offset:9216
    ds_read_b64_tr_b16 v[26:27], v4 offset:11776
    ds_read_b64_tr_b16 v[28:29], v4 offset:13824
    ds_read_b64_tr_b16 v[30:31], v4 offset:16384
    ds_read_b64_tr_b16 v[32:33], v4 offset:18432
    ds_read_b64_tr_b16 v[34:35], v4 offset:20992
    ds_read_b64_tr_b16 v[36:37], v4 offset:23040
    ds_read_b64_tr_b16 v[38:39], v4 offset:25600
    ds_read_b64_tr_b16 v[40:41], v4 offset:27648
    ds_read_b64_tr_b16 v[42:43], v4 offset:30208
    ds_read_b64_tr_b16 v[44:45], v4 offset:32256
    ds_read_b64_tr_b16 v[46:47], v4 offset:34816
    ds_read_b64_tr_b16 v[48:49], v5 offset:2048
    ds_read_b64_tr_b16 v[50:51], v5 offset:6656
    s_waitcnt lgkmcnt(15)
    s_mov_b32 s31, s37
    buffer_store_dwordx4 v[16:19], v9, s[4:7], s31 offen sc1
    s_waitcnt lgkmcnt(14)
    s_mov_b32 s31, s38
    buffer_store_dwordx4 v[20:23], v10, s[4:7], s31 offen sc1
    s_waitcnt lgkmcnt(12)
    s_mov_b32 s31, s39
    buffer_store_dwordx4 v[24:27], v9, s[4:7], s31 offen sc1
    s_waitcnt lgkmcnt(10)
    s_mov_b32 s31, s40
    buffer_store_dwordx4 v[28:31], v10, s[4:7], s31 offen sc1
    s_waitcnt lgkmcnt(8)
    s_mov_b32 s31, s41
    buffer_store_dwordx4 v[32:35], v9, s[4:7], s31 offen sc1
    s_waitcnt lgkmcnt(6)
    s_mov_b32 s31, s42
    buffer_store_dwordx4 v[36:39], v10, s[4:7], s31 offen sc1
    s_waitcnt lgkmcnt(4)
    s_mov_b32 s31, s43
    buffer_store_dwordx4 v[40:43], v9, s[4:7], s31 offen sc1
    s_waitcnt lgkmcnt(2)
    s_mov_b32 s31, s47
    buffer_store_dwordx4 v[44:47], v10, s[4:7], s31 offen sc1
    s_waitcnt lgkmcnt(0)
    s_mov_b32 s31, s48
    buffer_store_dwordx4 v[48:51], v14, s[4:7], s31 offen sc1
    s_mov_b32 s46, 1
    s_mov_b32 s27, 32
    s_branch L_p0_cd
L_p0_wq:
    s_mov_b32 s32, s38
    s_mov_b32 s33, s39
    s_mov_b32 s34, 0x1e6000
    s_mov_b32 s35, 0x20000
    s_sub_u32 s23, s2, 128
    s_mul_i32 s25, s23, 19
    s_lshr_b32 s25, s25, 9
    s_mul_i32 s24, s25, 27
    s_sub_u32 s24, s23, s24
    s_mul_i32 s26, s25, 497664
    s_lshl_b32 s31, s24, 7
    s_add_u32 s26, s26, s31
    v_lshrrev_b32 v4, 7, v1
    v_mul_u32_u24 v4, 3456, v4
    v_lshrrev_b32 v5, 4, v1
    v_and_b32 v5, 16, v5
    v_xor_b32 v5, v5, v1
    v_and_b32 v5, 0x70, v5
    v_add_u32 v4, v4, v5
    s_mul_i32 s31, s20, 110592
    s_add_u32 s27, s26, s31
    s_mul_i32 s30, s20, 4224
    s_add_u32 m0, s30, 0
    s_add_u32 s31, s27, 0
    buffer_load_dwordx4 v4, s[32:35], s31 offen  lds
    s_add_u32 m0, s30, 1056
    s_add_u32 s31, s27, 27648
    buffer_load_dwordx4 v4, s[32:35], s31 offen  lds
    s_add_u32 m0, s30, 2112
    s_add_u32 s31, s27, 55296
    buffer_load_dwordx4 v4, s[32:35], s31 offen  lds
    s_add_u32 m0, s30, 3168
    s_add_u32 s31, s27, 82944
    buffer_load_dwordx4 v4, s[32:35], s31 offen  lds
    s_cmp_ge_u32 s20, 2
    s_cbranch_scc1 L_p0_q5
    s_mul_i32 s31, s29, 1056
    s_add_u32 m0, s31, 16896
    s_mul_i32 s31, s29, 27648
    s_add_u32 s31, s31, s26
    s_add_u32 s31, s31, 442368
    buffer_load_dwordx4 v4, s[32:35], s31 offen  lds
L_p0_q5:
    v_lshrrev_b32 v7, 2, v2
    v_and_b32 v8, 3, v2
    s_lshl_b32 s31, s20, 5
    v_and_b32 v9, 2, v7
    v_xor_b32 v9, v9, v3
    v_lshlrev_b32 v9, 3, v9
    v_lshl_add_u32 v9, v7, 7, v9
    v_add_u32 v9, s31, v9
    v_mul_u32_u24 v4, 1056, v8
    v_add_u32 v4, v4, v9
    v_and_b32 v5, 1, v2
    v_mul_u32_u24 v5, 9504, v5
    v_add_u32 v5, v5, v9
    s_lshl_b32 s31, s24, 2
    s_add_u32 s31, s31, s20
    v_lshlrev_b32 v8, 4, v8
    v_lshl_add_u32 v8, v7, 8, v8
    v_lshl_add_u32 v7, s31, 2, v3
    v_mul_u32_u24 v9, 57, v7
    v_lshrrev_b32 v9, 13, v9
    v_mul_u32_u24 v10, 144, v9
    v_sub_u32 v10, v7, v10
    v_mul_u32_u24 v12, 57, v10
    v_lshrrev_b32 v12, 9, v12
    v_mul_u32_u24 v13, 9, v12
    v_sub_u32 v13, v10, v13
    v_cmp_lt_u32 s[36:37], 4, v13
    v_cmp_eq_u32 s[38:39], 4, v13
    v_cmp_eq_u32 s[40:41], 2, v9
    v_lshlrev_b32 v14, 1, v9
    v_add_u32 v15, 1, v14
    v_subrev_u32 v10, 5, v13
    v_cndmask_b32 v14, v14, v15, s[36:37]
    v_cndmask_b32 v13, v13, v10, s[36:37]
    v_cndmask_b32 v14, v14, 6, s[38:39]
    v_cndmask_b32 v13, v13, v9, s[38:39]
    s_and_b64 s[40:41], s[40:41], s[38:39]
    s_mov_b32 s31, 129024
    v_mul_lo_u32 v9, v12, s31
    v_add_u32 v9, v9, v8
    v_lshl_add_u32 v9, v14, 10, v9
    v_lshl_add_u32 v9, v13, 6, v9
    s_and_b32 s31, s25, 1
    v_lshrrev_b32 v8, 3, v2
    v_cmp_eq_u32 vcc, s31, v8
    v_add_u32 v15, 64, v9
    v_cndmask_b32 v15, v6, v15, s[40:41]
    v_cndmask_b32 v8, v6, v9, vcc
    v_lshlrev_b32 v10, 2, v2
    v_lshl_add_u32 v10, v7, 4, v10
    v_cmp_gt_u32 vcc, 4, v2
    s_lshl_b32 s45, s25, 13
    s_add_u32 s45, s45, 0x4400000
    v_cndmask_b32 v10, v6, v10, vcc
    s_mul_i32 s42, s25, 28672
    s_add_u32 s42, s42, 0x3800000
    s_lshr_b32 s44, s25, 1
    s_mul_i32 s44, s44, 7168
    s_add_u32 s44, s44, 0x381c000
    s_mul_i32 s26, s24, 29
    s_lshr_b32 s26, s26, 8
    s_mul_i32 s27, s26, 9
    s_sub_u32 s27, s24, s27
    s_lshl_b32 s27, s27, 4
    s_add_u32 s28, s27, 16
    v_lshrrev_b32 v254, 4, v1
    v_mul_u32_u24 v7, 9, v254
    v_add_u32 v255, 9, v7
    v_min_u32 v255, s28, v255
    v_max_u32 v7, s27, v7
    v_sub_u32 v255, v255, v7
    v_cmp_lt_i32 vcc, 0, v255
    v_lshlrev_b32 v254, 8, v254
    v_mov_b32 v14, 0x3f003f00
    v_cndmask_b32 v254, v6, v254, vcc
    s_cmp_eq_u64 s[40:41], 0
    s_cbranch_scc1 L_p0_np
    v_mov_b32 v52, 0
    v_mov_b32 v53, 0
    v_mov_b32 v54, 0
    v_mov_b32 v55, 0
    s_add_u32 s31, s42, 0
    buffer_store_dwordx4 v[52:55], v15, s[4:7], s31 offen sc1
    s_add_u32 s31, s42, 7168
    buffer_store_dwordx4 v[52:55], v15, s[4:7], s31 offen sc1
    s_add_u32 s31, s42, 14336
    buffer_store_dwordx4 v[52:55], v15, s[4:7], s31 offen sc1
    s_add_u32 s31, s42, 21504
    buffer_store_dwordx4 v[52:55], v15, s[4:7], s31 offen sc1
    s_mov_b32 s31, s44
    buffer_store_dwordx4 v[52:55], v15, s[4:7], s31 offen sc1
    s_waitcnt vmcnt(5)
    s_branch L_p0_n3
L_p0_np:
    s_waitcnt vmcnt(0)
L_p0_n3:
    s_barrier
    ds_read_b64_tr_b16 v[16:17], v4 offset:0
    ds_read_b64_tr_b16 v[18:19], v4 offset:512
    ds_read_b64_tr_b16 v[20:21], v4 offset:4224
    ds_read_b64_tr_b16 v[22:23], v4 offset:4736
    ds_read_b64_tr_b16 v[24:25], v4 offset:9504
    ds_read_b64_tr_b16 v[26:27], v4 offset:10016
    ds_read_b64_tr_b16 v[28:29], v4 offset:13728
    ds_read_b64_tr_b16 v[30:31], v4 offset:14240
    ds_read_b64_tr_b16 v[32:33], v5 offset:8448
    ds_read_b64_tr_b16 v[34:35], v5 offset:8960
    s_waitcnt lgkmcnt(8)
    s_add_u32 s31, s42, 0
    buffer_store_dwordx4 v[16:19], v9, s[4:7], s31 offen sc1
    s_waitcnt lgkmcnt(6)
    s_add_u32 s31, s42, 7168
    buffer_store_dwordx4 v[20:23], v9, s[4:7], s31 offen sc1
    s_waitcnt lgkmcnt(4)
    s_add_u32 s31, s42, 14336
    buffer_store_dwordx4 v[24:27], v9, s[4:7], s31 offen sc1
    s_waitcnt lgkmcnt(2)
    s_add_u32 s31, s42, 21504
    buffer_store_dwordx4 v[28:31], v9, s[4:7], s31 offen sc1
    s_waitcnt lgkmcnt(0)
    s_mov_b32 s31, s44
    buffer_store_dwordx4 v[32:35], v8, s[4:7], s31 offen sc1
    v_dot2_f32_bf16 v12, v16, v11, 0
    v_dot2_f32_bf16 v13, v17, v11, 0
    v_dot2_f32_bf16 v12, v18, v11, v12
    v_dot2_f32_bf16 v13, v19, v11, v13
    v_dot2_f32_bf16 v12, v20, v11, v12
    v_dot2_f32_bf16 v13, v21, v11, v13
    v_dot2_f32_bf16 v12, v22, v11, v12
    v_dot2_f32_bf16 v13, v23, v11, v13
    v_dot2_f32_bf16 v12, v24, v11, v12
    v_dot2_f32_bf16 v13, v25, v11, v13
    v_dot2_f32_bf16 v12, v26, v11, v12
    v_dot2_f32_bf16 v13, v27, v11, v13
    v_dot2_f32_bf16 v12, v28, v11, v12
    v_dot2_f32_bf16 v13, v29, v11, v13
    v_dot2_f32_bf16 v12, v30, v11, v12
    v_dot2_f32_bf16 v13, v31, v11, v13
    v_dot2_f32_bf16 v12, v32, v14, v12
    v_dot2_f32_bf16 v13, v33, v14, v13
    v_dot2_f32_bf16 v12, v34, v14, v12
    v_dot2_f32_bf16 v13, v35, v14, v13
    s_nop 2
    v_add_f32 v12, v12, v13
    s_nop 1
    v_add_f32_dpp v12, v12, v12 row_ror:4 row_mask:0xf bank_mask:0xf
    s_nop 1
    v_add_f32_dpp v12, v12, v12 row_ror:8 row_mask:0xf bank_mask:0xf
    buffer_store_dword v12, v10, s[4:7], s45 offen sc1
    s_branch L_p0_ce
L_p0_x:
    s_mov_b32 s32, s36
    s_mov_b32 s33, s37
    s_mov_b32 s34, 0x240000
    s_mov_b32 s35, 0x20000
    s_mul_i32 s26, s2, 18432
    s_mul_i32 s31, s20, 288
    s_add_u32 s28, s26, s31
    v_lshrrev_b32 v4, 6, v1
    v_mul_u32_u24 v4, 1152, v4
    v_and_b32 v5, 48, v1
    v_add_u32 v4, v4, v5
    s_add_u32 m0, s30, 0
    s_add_u32 s31, s28, 0
    buffer_load_dwordx4 v4, s[32:35], s31 offen  lds
    s_add_u32 m0, s30, 1024
    s_add_u32 s31, s28, 64
    buffer_load_dwordx4 v4, s[32:35], s31 offen  lds
    s_add_u32 m0, s30, 2048
    s_add_u32 s31, s28, 144
    buffer_load_dwordx4 v4, s[32:35], s31 offen  lds
    s_add_u32 m0, s30, 3072
    s_add_u32 s31, s28, 208
    buffer_load_dwordx4 v4, s[32:35], s31 offen  lds
    s_mul_i32 s31, s29, 576
    s_add_u32 s31, s31, s26
    v_mul_u32_u24 v7, 1152, v2
    v_mul_u32_u24 v5, 144, v3
    v_add_u32 v5, v5, v7
    buffer_load_dwordx4 v[32:35], v5, s[32:35], s31 offen offset:128
    s_lshl_b32 s27, s29, 10
    s_add_u32 s27, s27, 16384
    s_barrier
    v_lshlrev_b32 v4, 6, v2
    v_lshl_add_u32 v4, v3, 4, v4
    v_add_u32 v4, s30, v4
    s_add_u32 s26, s26, 0x0
    s_add_u32 s42, s26, s30
    s_add_u32 s44, s26, s27
    s_lshl_b32 s45, s2, 10
    s_lshl_b32 s31, s20, 8
    s_add_u32 s45, s45, s31
    s_add_u32 s45, s45, 0x1b00000
    v_cmp_gt_u32 vcc, 2, v3
    v_lshrrev_b32 v10, 1, v1
    s_mov_b32 s46, 2
    v_cndmask_b32 v10, v6, v10, vcc
    s_lshr_b32 s27, s2, 3
    s_add_u32 s27, s27, 48
    s_waitcnt vmcnt(0)
    ds_read_b128 v[16:19], v4 offset:0
    ds_read_b128 v[20:23], v4 offset:1024
    ds_read_b128 v[24:27], v4 offset:2048
    ds_read_b128 v[28:31], v4 offset:3072
    s_waitcnt lgkmcnt(3)
    buffer_store_dwordx4 v[16:19], v1, s[4:7], s42 offen offset:0 sc1
    s_waitcnt lgkmcnt(2)
    buffer_store_dwordx4 v[20:23], v1, s[4:7], s42 offen offset:1024 sc1
    s_waitcnt lgkmcnt(1)
    buffer_store_dwordx4 v[24:27], v1, s[4:7], s42 offen offset:2048 sc1
    s_waitcnt lgkmcnt(0)
    buffer_store_dwordx4 v[28:31], v1, s[4:7], s42 offen offset:3072 sc1
    v_dot2_f32_bf16 v12, v16, v11, 0
    v_dot2_f32_bf16 v13, v16, v16, 0
    v_dot2_f32_bf16 v12, v17, v11, v12
    v_dot2_f32_bf16 v13, v17, v17, v13
    v_dot2_f32_bf16 v12, v18, v11, v12
    v_dot2_f32_bf16 v13, v18, v18, v13
    v_dot2_f32_bf16 v12, v19, v11, v12
    v_dot2_f32_bf16 v13, v19, v19, v13
    v_dot2_f32_bf16 v12, v20, v11, v12
    v_dot2_f32_bf16 v13, v20, v20, v13
    v_dot2_f32_bf16 v12, v21, v11, v12
    v_dot2_f32_bf16 v13, v21, v21, v13
    v_dot2_f32_bf16 v12, v22, v11, v12
    v_dot2_f32_bf16 v13, v22, v22, v13
    v_dot2_f32_bf16 v12, v23, v11, v12
    v_dot2_f32_bf16 v13, v23, v23, v13
    v_dot2_f32_bf16 v12, v24, v11, v12
    v_dot2_f32_bf16 v13, v24, v24, v13
    v_dot2_f32_bf16 v12, v25, v11, v12
    v_dot2_f32_bf16 v13, v25, v25, v13
    v_dot2_f32_bf16 v12, v26, v11, v12
    v_dot2_f32_bf16 v13, v26, v26, v13
    v_dot2_f32_bf16 v12, v27, v11, v12
    v_dot2_f32_bf16 v13, v27, v27, v13
    v_dot2_f32_bf16 v12, v28, v11, v12
    v_dot2_f32_bf16 v13, v28, v28, v13
    v_dot2_f32_bf16 v12, v29, v11, v12
    v_dot2_f32_bf16 v13, v29, v29, v13
    v_dot2_f32_bf16 v12, v30, v11, v12
    v_dot2_f32_bf16 v13, v30, v30, v13
    v_dot2_f32_bf16 v12, v31, v11, v12
    v_dot2_f32_bf16 v13, v31, v31, v13
    s_waitcnt lgkmcnt(0)
    s_cmp_ge_u32 s20, 2
    s_cbranch_scc1 L_p0_xs
    buffer_store_dwordx4 v[32:35], v1, s[4:7], s44 offen sc1
    v_dot2_f32_bf16 v12, v32, v11, v12
    v_dot2_f32_bf16 v13, v32, v32, v13
    v_dot2_f32_bf16 v12, v33, v11, v12
    v_dot2_f32_bf16 v13, v33, v33, v13
    v_dot2_f32_bf16 v12, v34, v11, v12
    v_dot2_f32_bf16 v13, v34, v34, v13
    v_dot2_f32_bf16 v12, v35, v11, v12
    v_dot2_f32_bf16 v13, v35, v35, v13
L_p0_xs:
    s_nop 2
    v_mov_b32 v14, v12
    v_mov_b32 v15, v13
    s_nop 1
    v_permlane32_swap_b32 v12, v14
    v_permlane32_swap_b32 v13, v15
    v_add_f32 v12, v12, v14
    v_add_f32 v13, v13, v15
    buffer_store_dwordx2 v[12:13], v10, s[4:7], s45 offen sc1
L_p0_cd:
    v_cmp_eq_u32 vcc, 0, v1
    s_lshl_b32 s27, s27, 8
    v_mov_b32 v255, s46
    v_mov_b32 v254, s27
    v_cndmask_b32 v254, v6, v254, vcc
L_p0_ce:
    s_mov_b32 s48, s58
    s_mov_b32 s49, s59
    s_mov_b32 s50, 0x100
    s_mov_b32 s51, 0x20000
    v_mov_b32 v4, 0
    buffer_load_dword v246, v4, s[48:51], 0 offen sc1
    s_mov_b32 s16, s56
    s_mov_b32 s17, s57
    s_mov_b32 s18, 0x240000
    s_mov_b32 s19, 0x20000
    s_branch L_m_cl
L_d1_first:
    v_cmp_gt_u32 vcc, 4, v246
    v_mov_b32 v4, 0
    s_mov_b32 s46, 0x4500000
    s_cbranch_vccz L_pd_dbg
    s_mov_b32 s60, 65536
L_poll_dbg:
    buffer_load_dword v5, v4, s[48:51], 0 offen sc1
    s_waitcnt vmcnt(0)
    v_cmp_gt_u32 vcc, 4, v5
    s_sub_u32 s60, s60, 1
    s_cbranch_scc1 L_pd_dbg
    s_cbranch_vccz L_pd_dbg
    s_sleep 4
    s_branch L_poll_dbg
L_pd_dbg:
    buffer_atomic_add v255, v254, s[4:7], s46 offen sc1
    s_branch L_ns_d1
L_ld_m:
    s_cmp_lg_u32 s2, 254
    s_cbranch_scc1 L_p0_nz
    s_lshl_b32 s31, s20, 12
    s_add_u32 s31, s31, 0x4500000
    v_and_b32 v56, 0x380, v1
    v_add_u32 v56, v56, v1
    v_mov_b32 v52, 0
    v_mov_b32 v53, 0
    v_mov_b32 v54, 0
    v_mov_b32 v55, 0
    buffer_store_dwordx4 v[52:55], v56, s[4:7], s31 offen offset:0 sc1
    buffer_store_dwordx4 v[52:55], v56, s[4:7], s31 offen offset:2048 sc1
    s_waitcnt vmcnt(0)
    s_mov_b32 s53, 1
    s_atomic_add s53, s[58:59], 0
L_p0_nz:
    s_mov_b32 s8, s46
    s_mov_b32 s9, s47
    s_mov_b32 s10, 0x800000
    s_mov_b32 s11, 0x20000
    s_mov_b32 s12, s48
    s_mov_b32 s13, s49
    s_mov_b32 s14, 0x1000
    s_mov_b32 s15, 0x20000
    v_mov_b32 v2, 163808
    v_mov_b32 v4, 0
    v_mov_b32 v5, 0
    ds_write2_b64 v2, v[4:5], v[4:5] offset0:0 offset1:1
    s_waitcnt lgkmcnt(0)
    v_bfe_u32 v2, v1, 4, 4
    v_lshrrev_b32 v3, 8, v1
    v_bfrev_b32 v6, 1
    v_mov_b32 v11, 0x3f803f80
    s_mul_i32 s30, s20, 9216
    s_cmp_lt_u32 s2, 144
    s_cbranch_scc1 L_p0_wi
    s_cmp_lt_u32 s2, 216
    s_cbranch_scc1 L_p0_wu
    v_mov_b32 v9, v6
    v_mov_b32 v10, v6
    v_mov_b32 v14, v6
    v_mov_b32 v15, v6
    s_mov_b32 s37, 0
    s_mov_b32 s38, 0
    s_mov_b32 s39, 0
    s_mov_b32 s40, 0
    s_mov_b32 s41, 0
    s_mov_b32 s42, 0
    s_mov_b32 s43, 0
    s_mov_b32 s47, 0
    s_mov_b32 s48, 0
    s_mov_b32 s49, 0
    s_barrier
    s_barrier
    s_barrier
    s_branch L_p0_ld
L_p0_wu:
    s_sub_u32 s26, s2, 144
    s_mul_i32 s28, s26, 57
    s_lshr_b32 s28, s28, 9
    s_mul_i32 s27, s28, 9
    s_sub_u32 s27, s26, s27
    s_mov_b32 s32, s50
    s_mov_b32 s33, s51
    s_mov_b32 s34, 0x288000
    s_mov_b32 s35, 0x20000
    s_mul_i32 s29, s28, 331776
    s_lshl_b32 s31, s27, 7
    s_add_u32 s29, s29, s31
    s_mul_i32 s31, s20, 82944
    s_add_u32 s29, s29, s31
    s_mul_i32 s30, s20, 9216
    v_lshrrev_b32 v4, 7, v1
    v_mul_u32_u24 v4, 1152, v4
    v_and_b32 v5, 0x70, v1
    v_bfe_u32 v7, v1, 8, 2
    v_lshlrev_b32 v7, 5, v7
    v_xor_b32 v5, v5, v7
    v_add_u32 v4, v4, v5
    s_barrier
    s_barrier
    s_barrier
    s_add_u32 m0, s30, 91904
    s_add_u32 s31, s29, 0
    buffer_load_dwordx4 v4, s[32:35], s31 offen  lds
    s_add_u32 m0, s30, 92928
    s_add_u32 s31, s29, 9216
    buffer_load_dwordx4 v4, s[32:35], s31 offen  lds
    s_add_u32 m0, s30, 93952
    s_add_u32 s31, s29, 18432
    buffer_load_dwordx4 v4, s[32:35], s31 offen  lds
    s_add_u32 m0, s30, 94976
    s_add_u32 s31, s29, 27648
    buffer_load_dwordx4 v4, s[32:35], s31 offen  lds
    s_add_u32 m0, s30, 96000
    s_add_u32 s31, s29, 36864
    buffer_load_dwordx4 v4, s[32:35], s31 offen  lds
    s_add_u32 m0, s30, 97024
    s_add_u32 s31, s29, 46080
    buffer_load_dwordx4 v4, s[32:35], s31 offen  lds
    s_add_u32 m0, s30, 98048
    s_add_u32 s31, s29, 55296
    buffer_load_dwordx4 v4, s[32:35], s31 offen  lds
    s_add_u32 m0, s30, 99072
    s_add_u32 s31, s29, 64512
    buffer_load_dwordx4 v4, s[32:35], s31 offen  lds
    s_add_u32 m0, s30, 100096
    s_add_u32 s31, s29, 73728
    buffer_load_dwordx4 v4, s[32:35], s31 offen  lds
    v_lshrrev_b32 v7, 2, v2
    v_and_b32 v8, 3, v2
    v_bfe_u32 v9, v1, 7, 2
    v_xor_b32 v9, s20, v9
    v_lshlrev_b32 v9, 5, v9
    v_lshl_add_u32 v9, v7, 7, v9
    v_lshl_add_u32 v9, v8, 3, v9
    v_add_u32 v9, 91904, v9
    v_mul_u32_u24 v4, 512, v3
    v_add_u32 v4, v4, v9
    v_mul_u32_u24 v5, 512, v3
    v_add_u32 v5, v5, v9
    s_lshl_b32 s31, s27, 2
    s_add_u32 s31, s31, s20
    v_lshl_add_u32 v7, s31, 2, v7
    v_lshlrev_b32 v8, 4, v8
    v_lshl_add_u32 v8, v3, 8, v8
    v_mul_u32_u24 v9, 57, v7
    v_lshrrev_b32 v9, 10, v9
    v_mul_u32_u24 v10, 18, v9
    v_sub_u32 v10, v7, v10
    v_lshrrev_b32 v12, 3, v10
    v_and_b32 v13, 1, v10
    v_lshl_add_u32 v12, v12, 1, v13
    v_bfe_u32 v14, v10, 1, 2
    v_cmp_gt_u32 vcc, 16, v10
    v_mul_u32_u24 v9, 331776, v9
    v_add_u32 v9, v9, v8
    v_cndmask_b32 v12, 8, v12, vcc
    v_cndmask_b32 v14, v13, v14, vcc
    v_mov_b32 v15, 0x1000
    v_mov_b32 v13, 0x80
    v_cndmask_b32 v15, v13, v15, vcc
    v_lshl_add_u32 v9, v12, 10, v9
    v_lshl_add_u32 v9, v14, 6, v9
    v_add_u32 v10, v9, v15
    s_and_b32 s31, s28, 1
    s_cmp_eq_u32 s31, 1
    s_cselect_b64 vcc, -1, 0
    v_cndmask_b32 v14, v9, v10, vcc
    s_mul_i32 s31, s28, 9216
    s_add_u32 s37, s31, 0x4100000
    s_add_u32 s38, s31, 0x4100000
    s_add_u32 s39, s31, 0x4112000
    s_add_u32 s40, s31, 0x4112000
    s_add_u32 s41, s31, 0x4124000
    s_add_u32 s42, s31, 0x4124000
    s_add_u32 s43, s31, 0x4136000
    s_add_u32 s47, s31, 0x4136000
    s_lshr_b32 s31, s28, 1
    s_mul_i32 s31, s31, 9216
    s_add_u32 s48, s31, 0x4148000
    v_mov_b32 v15, v6
    s_mov_b32 s49, 0
    s_branch L_p0_ld
L_p0_wi:
    s_mov_b32 s26, s2
    s_mul_i32 s28, s26, 57
    s_lshr_b32 s28, s28, 12
    s_mul_i32 s27, s28, 72
    s_sub_u32 s27, s26, s27
    s_mov_b32 s32, s44
    s_mov_b32 s33, s45
    s_mov_b32 s34, 0x510000
    s_mov_b32 s35, 0x20000
    s_mul_i32 s29, s28, 2654208
    s_lshl_b32 s31, s27, 7
    s_add_u32 s29, s29, s31
    s_mul_i32 s31, s20, 663552
    s_add_u32 s29, s29, s31
    s_mul_i32 s30, s20, 9792
    v_lshrrev_b32 v4, 7, v1
    v_mul_u32_u24 v4, 9216, v4
    v_and_b32 v5, 0x70, v1
    v_bfe_u32 v7, v1, 8, 1
    v_lshlrev_b32 v7, 5, v7
    v_xor_b32 v5, v5, v7
    v_add_u32 v4, v4, v5
    s_barrier
    s_barrier
    s_barrier
    s_add_u32 m0, s30, 91904
    s_add_u32 s31, s29, 0
    buffer_load_dwordx4 v4, s[32:35], s31 offen  lds
    s_add_u32 m0, s30, 92992
    s_add_u32 s31, s29, 73728
    buffer_load_dwordx4 v4, s[32:35], s31 offen  lds
    s_add_u32 m0, s30, 94080
    s_add_u32 s31, s29, 147456
    buffer_load_dwordx4 v4, s[32:35], s31 offen  lds
    s_add_u32 m0, s30, 95168
    s_add_u32 s31, s29, 221184
    buffer_load_dwordx4 v4, s[32:35], s31 offen  lds
    s_add_u32 m0, s30, 96256
    s_add_u32 s31, s29, 294912
    buffer_load_dwordx4 v4, s[32:35], s31 offen  lds
    s_add_u32 m0, s30, 97344
    s_add_u32 s31, s29, 368640
    buffer_load_dwordx4 v4, s[32:35], s31 offen  lds
    s_add_u32 m0, s30, 98432
    s_add_u32 s31, s29, 442368
    buffer_load_dwordx4 v4, s[32:35], s31 offen  lds
    s_add_u32 m0, s30, 99520
    s_add_u32 s31, s29, 516096
    buffer_load_dwordx4 v4, s[32:35], s31 offen  lds
    s_add_u32 m0, s30, 100608
    s_add_u32 s31, s29, 589824
    buffer_load_dwordx4 v4, s[32:35], s31 offen  lds
    v_lshrrev_b32 v7, 2, v2
    v_and_b32 v8, 3, v2
    v_bfe_u32 v9, v1, 7, 1
    v_xor_b32 v9, s20, v9
    v_lshlrev_b32 v9, 5, v9
    v_lshl_add_u32 v9, v7, 7, v9
    v_lshl_add_u32 v9, v8, 3, v9
    v_add_u32 v9, 91904, v9
    v_mul_u32_u24 v4, 1088, v3
    v_add_u32 v4, v4, v9
    v_mul_u32_u24 v5, 9792, v3
    v_add_u32 v5, v5, v9
    s_lshl_b32 s31, s27, 2
    s_add_u32 s31, s31, s20
    v_lshl_add_u32 v7, s31, 2, v7
    v_lshlrev_b32 v8, 4, v8
    v_lshl_add_u32 v8, v3, 8, v8
    s_cmp_lt_u32 s31, 144
    s_cselect_b32 s23, 1, 0
    s_cselect_b32 s24, 0, 144
    s_sub_u32 s26, s31, s24
    s_mul_i32 s25, s26, 57
    s_lshr_b32 s25, s25, 9
    s_mul_i32 s24, s25, 9
    s_sub_u32 s24, s26, s24
    s_lshl_b32 s26, s25, 1
    s_add_u32 s26, s26, s23
    s_mul_i32 s26, s26, 165888
    s_lshl_b32 s31, s24, 10
    s_add_u32 s26, s26, s31
    s_add_u32 s26, s26, 0x3b00000
    s_mul_i32 s31, s28, 9216
    s_add_u32 s48, s26, s31
    s_add_u32 s48, s48, 147456
    s_lshl_b32 s31, s31, 3
    s_add_u32 s26, s26, s31
    s_add_u32 s37, s26, 0
    s_add_u32 s38, s26, 9216
    s_add_u32 s39, s26, 18432
    s_add_u32 s40, s26, 27648
    s_add_u32 s41, s26, 36864
    s_add_u32 s42, s26, 46080
    s_add_u32 s43, s26, 55296
    s_add_u32 s47, s26, 64512
    s_lshl_b32 s49, s25, 12
    s_mul_i32 s31, s28, 1152
    s_add_u32 s49, s49, s31
    s_mul_i32 s31, s23, 576
    s_add_u32 s49, s49, s31
    s_lshl_b32 s31, s24, 6
    s_add_u32 s49, s49, s31
    s_add_u32 s49, s49, 0x4410000
    v_cmp_eq_u32 vcc, 0, v3
    v_lshlrev_b32 v15, 2, v2
    v_mov_b32 v9, v1
    v_mov_b32 v10, v1
    v_mov_b32 v14, v1
    v_cndmask_b32 v15, v6, v15, vcc
L_p0_ld:
    s_waitcnt lgkmcnt(0)
    s_branch L_m_l1
L_m_cl:
    s_and_b32 s25, s2, 7
    s_lshr_b32 s26, s2, 3
    s_lshr_b32 s23, s25, 1
    s_lshl_b32 s23, s23, 2
    s_lshr_b32 s27, s26, 3
    s_add_u32 s23, s23, s27
    s_and_b32 s24, s25, 1
    s_lshl_b32 s24, s24, 3
    s_and_b32 s27, s26, 7
    s_add_u32 s24, s24, s27
    s_lshl_b32 s30, s23, 3
    s_lshl_b32 s31, s20, 1
    s_add_u32 s31, s30, s31
    s_mul_i32 s29, s31, 18432
    s_add_u32 s29, s29, s21
    s_add_u32 s35, s29, 0x600000
    s_add_u32 s29, s29, 0x0
    s_max_u32 s30, s30, 1
    s_sub_u32 s30, s30, 1
    s_lshl_b32 s30, s30, 10
    s_add_u32 s30, s30, s21
    s_add_u32 s30, s30, 0x1b00000
    s_lshl_b32 s32, s31, 10
    s_add_u32 s32, s32, s21
    s_add_u32 s32, s32, 0x1b00000
    v_bfe_u32 v2, v1, 4, 4
    v_lshrrev_b32 v3, 8, v1
    s_lshl_b32 s33, s20, 2
    s_lshr_b32 s33, 0x3362, s33
    s_and_b32 s33, s33, 15
    s_min_u32 s34, s20, 1
    s_add_u32 s34, s34, 4
    s_lshl_b32 s36, s33, 10
    s_lshl_b32 s37, s34, 10
    v_add_u32 v247, 64512, v1
    v_add_u32 v248, 131072, v1
    v_add_u32 v249, s36, v1
    v_add_u32 v250, s36, v247
    v_add_u32 v251, s37, v1
    v_add_u32 v252, s37, v247
    v_add_u32 v253, 18432, v1
    v_lshrrev_b32 v0, 1, v1
    s_add_u32 s38, s29, 0
    s_add_u32 s39, s29, 4096
    s_add_u32 s40, s29, 8192
    s_add_u32 s41, s29, 12288
    s_add_u32 s42, s29, 16384
    s_max_u32 s44, s23, 1
    s_sub_u32 s44, s44, 1
    s_lshl_b32 s52, s22, 7
    s_add_u32 s52, s52, s23
    s_lshl_b32 s52, s52, 8
    s_add_u32 s52, s52, 0x4503000
    s_add_u32 s52, s52, s4
    s_addc_u32 s53, s5, 0
    s_lshl_b32 s54, s22, 7
    s_add_u32 s54, s54, s44
    s_lshl_b32 s54, s54, 8
    s_add_u32 s54, s54, 0x4503000
    s_add_u32 s54, s54, s4
    s_addc_u32 s55, s5, 0
    s_lshl_b32 s44, s24, 8
    s_add_u32 s44, s44, 0x4500000
    s_add_u32 s44, s44, s4
    s_addc_u32 s45, s5, 0
    s_waitcnt vmcnt(0)
    s_barrier
    s_cmp_lg_u32 s20, 0
    s_cbranch_scc1 L_ns_d1
    s_cmp_eq_u32 s22, 0
    s_cbranch_scc1 L_d1_first
    s_mov_b32 s56, 1
    s_atomic_add s56, s[50:51], 0
L_ns_d1:
    s_barrier
    s_cmp_lg_u32 s20, 0
    s_cbranch_scc1 L_pd_d1
    s_mov_b32 s60, 65536
L_poll_d1:
    s_mov_b32 s57, 0
    s_atomic_add s57, s[52:53], 0 glc
    s_mov_b32 s58, 0
    s_atomic_add s58, s[54:55], 0 glc
    s_mov_b32 s59, 0
    s_atomic_add s59, s[44:45], 0 glc
    s_waitcnt lgkmcnt(0)
    s_cmp_ge_u32 s59, 108
    s_cselect_b32 s59, 16, 0
    s_min_u32 s57, s57, s58
    s_min_u32 s57, s57, s59
    s_cmp_ge_u32 s57, 16
    s_cbranch_scc1 L_pd_d1
    s_sub_u32 s60, s60, 1
    s_cbranch_scc1 L_pd_d1
    s_sleep 2
    s_branch L_poll_d1
L_pd_d1:
    s_barrier
    buffer_load_dwordx4 v[160:163], v1, s[4:7], s38 offen offset:0 sc1
    buffer_load_dwordx4 v[164:167], v253, s[4:7], s38 offen offset:0 sc1
    buffer_load_dwordx4 v[168:171], v1, s[4:7], s38 offen offset:1024 sc1
    buffer_load_dwordx4 v[172:175], v253, s[4:7], s38 offen offset:1024 sc1
    buffer_load_dwordx4 v[176:179], v1, s[4:7], s38 offen offset:2048 sc1
    buffer_load_dwordx4 v[180:183], v253, s[4:7], s38 offen offset:2048 sc1
    buffer_load_dwordx4 v[184:187], v1, s[4:7], s38 offen offset:3072 sc1
    buffer_load_dwordx4 v[188:191], v253, s[4:7], s38 offen offset:3072 sc1
    s_barrier
    ds_read_b128 v[80:83], v1 offset:0
    ds_read_b128 v[84:87], v1 offset:1024
    ds_read_b128 v[88:91], v1 offset:2048
    ds_read_b128 v[92:95], v1 offset:3072
    ds_read_b128 v[96:99], v1 offset:4096
    ds_read_b128 v[100:103], v1 offset:5120
    ds_read_b128 v[104:107], v1 offset:6144
    s_lshl_b32 s50, s22, 7
    s_add_u32 s50, s50, s23
    s_lshl_b32 s50, s50, 8
    s_add_u32 s50, s50, 0x4508000
    s_add_u32 s50, s50, s4
    s_addc_u32 s51, s5, 0
    s_waitcnt vmcnt(6) lgkmcnt(3)
    v_mfma_f32_16x16x32_bf16 v[16:19], v[80:83], v[160:163], 0
    ds_read_b128 v[120:123], v1 offset:7168
    v_mfma_f32_16x16x32_bf16 v[44:47], v[80:83], v[164:167], 0
    ds_read_b128 v[124:127], v1 offset:8192
    v_mfma_f32_16x16x32_bf16 v[20:23], v[84:87], v[160:163], 0
    ds_read_b128 v[128:131], v1 offset:9216
    v_mfma_f32_16x16x32_bf16 v[48:51], v[84:87], v[164:167], 0
    ds_read_b128 v[132:135], v1 offset:10240
    v_mfma_f32_16x16x32_bf16 v[24:27], v[88:91], v[160:163], 0
    ds_read_b128 v[136:139], v1 offset:11264
    buffer_load_dwordx2 v[4:5], v0, s[4:7], s30 offen offset:0 sc1
    v_mfma_f32_16x16x32_bf16 v[52:55], v[88:91], v[164:167], 0
    ds_read_b128 v[140:143], v1 offset:12288
    buffer_load_dwordx2 v[6:7], v0, s[4:7], s30 offen offset:512 sc1
    v_mfma_f32_16x16x32_bf16 v[28:31], v[92:95], v[160:163], 0
    ds_read_b128 v[144:147], v1 offset:13312
    buffer_load_dwordx2 v[8:9], v0, s[4:7], s32 offen offset:0 sc1
    v_mfma_f32_16x16x32_bf16 v[56:59], v[92:95], v[164:167], 0
    s_waitcnt lgkmcnt(7)
    buffer_load_dwordx2 v[10:11], v0, s[4:7], s32 offen offset:512 sc1
    v_mfma_f32_16x16x32_bf16 v[32:35], v[160:163], v[96:99], 0
    buffer_load_dwordx2 v[12:13], v0, s[4:7], s32 offen offset:1024 sc1
    v_mfma_f32_16x16x32_bf16 v[60:63], v[164:167], v[96:99], 0
    buffer_load_dwordx2 v[14:15], v0, s[4:7], s32 offen offset:1536 sc1
    v_mfma_f32_16x16x32_bf16 v[36:39], v[160:163], v[100:103], 0
    buffer_load_dwordx4 v[192:195], v1, s[4:7], s39 offen offset:0 sc1
    v_mfma_f32_16x16x32_bf16 v[64:67], v[164:167], v[100:103], 0
    buffer_load_dwordx4 v[196:199], v253, s[4:7], s39 offen offset:0 sc1
    v_mfma_f32_16x16x32_bf16 v[40:43], v[104:107], v[160:163], 0
    buffer_load_dwordx4 v[200:203], v1, s[4:7], s39 offen offset:1024 sc1
    v_mfma_f32_16x16x32_bf16 v[68:71], v[104:107], v[164:167], 0
    buffer_load_dwordx4 v[204:207], v253, s[4:7], s39 offen offset:1024 sc1
    s_waitcnt vmcnt(14) lgkmcnt(3)
    s_barrier
    v_mfma_f32_16x16x32_bf16 v[16:19], v[120:123], v[168:171], v[16:19]
    ds_read_b128 v[80:83], v1 offset:14336
    v_mfma_f32_16x16x32_bf16 v[44:47], v[120:123], v[172:175], v[44:47]
    ds_read_b128 v[84:87], v1 offset:15360
    v_mfma_f32_16x16x32_bf16 v[20:23], v[124:127], v[168:171], v[20:23]
    ds_read_b128 v[88:91], v1 offset:16384
    v_mfma_f32_16x16x32_bf16 v[48:51], v[124:127], v[172:175], v[48:51]
    ds_read_b128 v[92:95], v1 offset:17408
    v_mfma_f32_16x16x32_bf16 v[24:27], v[128:131], v[168:171], v[24:27]
    ds_read_b128 v[96:99], v1 offset:18432
    v_mfma_f32_16x16x32_bf16 v[52:55], v[128:131], v[172:175], v[52:55]
    ds_read_b128 v[100:103], v1 offset:19456
    v_mfma_f32_16x16x32_bf16 v[28:31], v[132:135], v[168:171], v[28:31]
    ds_read_b128 v[104:107], v1 offset:20480
    v_mfma_f32_16x16x32_bf16 v[56:59], v[132:135], v[172:175], v[56:59]
    ds_read_b128 v[108:111], v248 offset:0
    s_waitcnt lgkmcnt(8)
    v_mfma_f32_16x16x32_bf16 v[32:35], v[168:171], v[136:139], v[32:35]
    ds_read_b128 v[112:115], v249 offset:0
    v_mfma_f32_16x16x32_bf16 v[60:63], v[172:175], v[136:139], v[60:63]
    ds_read_b128 v[116:119], v251 offset:0
    v_mfma_f32_16x16x32_bf16 v[36:39], v[168:171], v[140:143], v[36:39]
    buffer_load_dwordx4 v[160:163], v1, s[4:7], s39 offen offset:2048 sc1
    v_mfma_f32_16x16x32_bf16 v[64:67], v[172:175], v[140:143], v[64:67]
    buffer_load_dwordx4 v[164:167], v253, s[4:7], s39 offen offset:2048 sc1
    v_mfma_f32_16x16x32_bf16 v[40:43], v[144:147], v[168:171], v[40:43]
    v_mfma_f32_16x16x32_bf16 v[68:71], v[144:147], v[172:175], v[68:71]
    s_waitcnt vmcnt(14) lgkmcnt(6)
    v_mfma_f32_16x16x32_bf16 v[16:19], v[80:83], v[176:179], v[16:19]
    ds_read_b128 v[120:123], v1 offset:21504
    v_mfma_f32_16x16x32_bf16 v[44:47], v[80:83], v[180:183], v[44:47]
    ds_read_b128 v[124:127], v1 offset:22528
    v_mfma_f32_16x16x32_bf16 v[20:23], v[84:87], v[176:179], v[20:23]
    ds_read_b128 v[128:131], v1 offset:23552
    v_mfma_f32_16x16x32_bf16 v[48:51], v[84:87], v[180:183], v[48:51]
    ds_read_b128 v[132:135], v1 offset:24576
    v_mfma_f32_16x16x32_bf16 v[24:27], v[88:91], v[176:179], v[24:27]
    ds_read_b128 v[136:139], v1 offset:25600
    v_mfma_f32_16x16x32_bf16 v[52:55], v[88:91], v[180:183], v[52:55]
    ds_read_b128 v[140:143], v1 offset:26624
    v_mfma_f32_16x16x32_bf16 v[28:31], v[92:95], v[176:179], v[28:31]
    ds_read_b128 v[144:147], v1 offset:27648
    v_mfma_f32_16x16x32_bf16 v[56:59], v[92:95], v[180:183], v[56:59]
    ds_read_b128 v[148:151], v248 offset:1024
    s_waitcnt lgkmcnt(8)
    v_mfma_f32_16x16x32_bf16 v[32:35], v[176:179], v[96:99], v[32:35]
    ds_read_b128 v[152:155], v249 offset:7168
    v_mfma_f32_16x16x32_bf16 v[60:63], v[180:183], v[96:99], v[60:63]
    ds_read_b128 v[156:159], v251 offset:7168
    v_mfma_f32_16x16x32_bf16 v[36:39], v[176:179], v[100:103], v[36:39]
    buffer_load_dwordx4 v[168:171], v1, s[4:7], s39 offen offset:3072 sc1
    v_mfma_f32_16x16x32_bf16 v[64:67], v[180:183], v[100:103], v[64:67]
    buffer_load_dwordx4 v[172:175], v253, s[4:7], s39 offen offset:3072 sc1
    v_mfma_f32_16x16x32_bf16 v[40:43], v[104:107], v[176:179], v[40:43]
    v_mfma_f32_16x16x32_bf16 v[68:71], v[104:107], v[180:183], v[68:71]
    v_mfma_f32_16x16x32_bf16 v[72:75], v[112:115], v[108:111], 0
    v_mfma_f32_16x16x32_bf16 v[76:79], v[108:111], v[116:119], 0
    s_waitcnt vmcnt(8) lgkmcnt(6)
    s_barrier
    v_mfma_f32_16x16x32_bf16 v[16:19], v[120:123], v[184:187], v[16:19]
    ds_read_b128 v[80:83], v1 offset:28672
    v_mfma_f32_16x16x32_bf16 v[44:47], v[120:123], v[188:191], v[44:47]
    ds_read_b128 v[84:87], v1 offset:29696
    v_add_f32 v240, v4, v6
    v_mfma_f32_16x16x32_bf16 v[20:23], v[124:127], v[184:187], v[20:23]
    ds_read_b128 v[88:91], v1 offset:30720
    v_add_f32 v241, v5, v7
    v_mfma_f32_16x16x32_bf16 v[48:51], v[124:127], v[188:191], v[48:51]
    ds_read_b128 v[92:95], v1 offset:31744
    v_add_f32 v242, v8, v10
    v_mfma_f32_16x16x32_bf16 v[24:27], v[128:131], v[184:187], v[24:27]
    ds_read_b128 v[96:99], v1 offset:32768
    v_add_f32 v243, v9, v11
    v_mfma_f32_16x16x32_bf16 v[52:55], v[128:131], v[188:191], v[52:55]
    ds_read_b128 v[100:103], v1 offset:33792
    v_add_f32 v244, v12, v14
    v_mfma_f32_16x16x32_bf16 v[28:31], v[132:135], v[184:187], v[28:31]
    ds_read_b128 v[104:107], v1 offset:34816
    v_add_f32 v245, v13, v15
    v_mfma_f32_16x16x32_bf16 v[56:59], v[132:135], v[188:191], v[56:59]
    ds_read_b128 v[108:111], v248 offset:2048
    s_waitcnt lgkmcnt(8)
    v_mfma_f32_16x16x32_bf16 v[32:35], v[184:187], v[136:139], v[32:35]
    ds_read_b128 v[112:115], v249 offset:14336
    v_mov_b32 v4, v240
    v_mfma_f32_16x16x32_bf16 v[60:63], v[188:191], v[136:139], v[60:63]
    ds_read_b128 v[116:119], v251 offset:14336
    v_mov_b32 v5, v241
    v_mfma_f32_16x16x32_bf16 v[36:39], v[184:187], v[140:143], v[36:39]
    buffer_load_dwordx4 v[176:179], v1, s[4:7], s40 offen offset:0 sc1
    v_mov_b32 v8, v242
    v_mfma_f32_16x16x32_bf16 v[64:67], v[188:191], v[140:143], v[64:67]
    buffer_load_dwordx4 v[180:183], v253, s[4:7], s40 offen offset:0 sc1
    v_mov_b32 v9, v243
    v_mfma_f32_16x16x32_bf16 v[40:43], v[144:147], v[184:187], v[40:43]
    v_mov_b32 v12, v244
    v_mov_b32 v13, v245
    v_mfma_f32_16x16x32_bf16 v[68:71], v[144:147], v[188:191], v[68:71]
    v_permlane32_swap_b32 v240, v4
    v_permlane32_swap_b32 v241, v5
    v_mfma_f32_16x16x32_bf16 v[72:75], v[152:155], v[148:151], v[72:75]
    v_permlane32_swap_b32 v242, v8
    v_mfma_f32_16x16x32_bf16 v[76:79], v[148:151], v[156:159], v[76:79]
    v_permlane32_swap_b32 v243, v9
    s_waitcnt vmcnt(8) lgkmcnt(6)
    v_mfma_f32_16x16x32_bf16 v[16:19], v[80:83], v[192:195], v[16:19]
    ds_read_b128 v[120:123], v1 offset:35840
    v_mfma_f32_16x16x32_bf16 v[44:47], v[80:83], v[196:199], v[44:47]
    ds_read_b128 v[124:127], v1 offset:36864
    v_permlane32_swap_b32 v244, v12
    v_mfma_f32_16x16x32_bf16 v[20:23], v[84:87], v[192:195], v[20:23]
    ds_read_b128 v[128:131], v1 offset:37888
    v_permlane32_swap_b32 v245, v13
    v_mfma_f32_16x16x32_bf16 v[48:51], v[84:87], v[196:199], v[48:51]
    ds_read_b128 v[132:135], v1 offset:38912
    v_add_f32 v240, v240, v4
    v_mfma_f32_16x16x32_bf16 v[24:27], v[88:91], v[192:195], v[24:27]
    ds_read_b128 v[136:139], v1 offset:39936
    v_add_f32 v241, v241, v5
    v_mfma_f32_16x16x32_bf16 v[52:55], v[88:91], v[196:199], v[52:55]
    ds_read_b128 v[140:143], v1 offset:40960
    v_add_f32 v242, v242, v8
    v_mfma_f32_16x16x32_bf16 v[28:31], v[92:95], v[192:195], v[28:31]
    ds_read_b128 v[144:147], v1 offset:41984
    v_add_f32 v243, v243, v9
    v_mfma_f32_16x16x32_bf16 v[56:59], v[92:95], v[196:199], v[56:59]
    ds_read_b128 v[148:151], v248 offset:3072
    s_waitcnt lgkmcnt(8)
    v_mfma_f32_16x16x32_bf16 v[32:35], v[192:195], v[96:99], v[32:35]
    ds_read_b128 v[152:155], v249 offset:21504
    v_add_f32 v244, v244, v12
    v_mfma_f32_16x16x32_bf16 v[60:63], v[196:199], v[96:99], v[60:63]
    ds_read_b128 v[156:159], v251 offset:21504
    v_add_f32 v245, v245, v13
    v_mfma_f32_16x16x32_bf16 v[36:39], v[192:195], v[100:103], v[36:39]
    buffer_load_dwordx4 v[184:187], v1, s[4:7], s40 offen offset:1024 sc1
    v_mov_b32 v4, v240
    v_mfma_f32_16x16x32_bf16 v[64:67], v[196:199], v[100:103], v[64:67]
    buffer_load_dwordx4 v[188:191], v253, s[4:7], s40 offen offset:1024 sc1
    v_mov_b32 v5, v241
    v_mfma_f32_16x16x32_bf16 v[40:43], v[104:107], v[192:195], v[40:43]
    v_mov_b32 v8, v242
    v_mov_b32 v9, v243
    v_mfma_f32_16x16x32_bf16 v[68:71], v[104:107], v[196:199], v[68:71]
    v_mov_b32 v12, v244
    v_mov_b32 v13, v245
    v_mfma_f32_16x16x32_bf16 v[72:75], v[112:115], v[108:111], v[72:75]
    v_permlane16_swap_b32 v240, v4
    v_mfma_f32_16x16x32_bf16 v[76:79], v[108:111], v[116:119], v[76:79]
    v_permlane16_swap_b32 v241, v5
    s_waitcnt vmcnt(8) lgkmcnt(6)
    s_barrier
    v_mfma_f32_16x16x32_bf16 v[16:19], v[120:123], v[200:203], v[16:19]
    ds_read_b128 v[80:83], v1 offset:43008
    v_mfma_f32_16x16x32_bf16 v[44:47], v[120:123], v[204:207], v[44:47]
    ds_read_b128 v[84:87], v1 offset:44032
    v_permlane16_swap_b32 v242, v8
    v_mfma_f32_16x16x32_bf16 v[20:23], v[124:127], v[200:203], v[20:23]
    ds_read_b128 v[88:91], v1 offset:45056
    v_permlane16_swap_b32 v243, v9
    v_mfma_f32_16x16x32_bf16 v[48:51], v[124:127], v[204:207], v[48:51]
    ds_read_b128 v[92:95], v1 offset:46080
    v_permlane16_swap_b32 v244, v12
    v_mfma_f32_16x16x32_bf16 v[24:27], v[128:131], v[200:203], v[24:27]
    ds_read_b128 v[96:99], v1 offset:47104
    v_permlane16_swap_b32 v245, v13
    v_mfma_f32_16x16x32_bf16 v[52:55], v[128:131], v[204:207], v[52:55]
    ds_read_b128 v[100:103], v1 offset:48128
    v_add_f32 v240, v240, v4
    v_mfma_f32_16x16x32_bf16 v[28:31], v[132:135], v[200:203], v[28:31]
    ds_read_b128 v[104:107], v1 offset:49152
    v_add_f32 v241, v241, v5
    v_mfma_f32_16x16x32_bf16 v[56:59], v[132:135], v[204:207], v[56:59]
    ds_read_b128 v[108:111], v248 offset:4096
    s_waitcnt lgkmcnt(8)
    v_mfma_f32_16x16x32_bf16 v[32:35], v[200:203], v[136:139], v[32:35]
    ds_read_b128 v[112:115], v249 offset:28672
    v_add_f32 v242, v242, v8
    v_mfma_f32_16x16x32_bf16 v[60:63], v[204:207], v[136:139], v[60:63]
    ds_read_b128 v[116:119], v251 offset:28672
    v_add_f32 v243, v243, v9
    v_mfma_f32_16x16x32_bf16 v[36:39], v[200:203], v[140:143], v[36:39]
    buffer_load_dwordx4 v[192:195], v1, s[4:7], s40 offen offset:2048 sc1
    v_add_f32 v244, v244, v12
    v_mfma_f32_16x16x32_bf16 v[64:67], v[204:207], v[140:143], v[64:67]
    buffer_load_dwordx4 v[196:199], v253, s[4:7], s40 offen offset:2048 sc1
    v_add_f32 v245, v245, v13
    v_mfma_f32_16x16x32_bf16 v[40:43], v[144:147], v[200:203], v[40:43]
    v_mul_f32 v240, 0x3ae38e39, v240
    v_mul_f32 v241, 0x3ae38e39, v241
    v_mfma_f32_16x16x32_bf16 v[68:71], v[144:147], v[204:207], v[68:71]
    v_mul_f32 v242, 0x3ae38e39, v242
    v_mul_f32 v243, 0x3ae38e39, v243
    v_mfma_f32_16x16x32_bf16 v[72:75], v[152:155], v[148:151], v[72:75]
    v_mul_f32 v244, 0x3ae38e39, v244
    v_mfma_f32_16x16x32_bf16 v[76:79], v[148:151], v[156:159], v[76:79]
    v_mul_f32 v245, 0x3ae38e39, v245
    s_waitcnt vmcnt(8) lgkmcnt(6)
    v_mfma_f32_16x16x32_bf16 v[16:19], v[80:83], v[160:163], v[16:19]
    ds_read_b128 v[120:123], v1 offset:50176
    v_mfma_f32_16x16x32_bf16 v[44:47], v[80:83], v[164:167], v[44:47]
    ds_read_b128 v[124:127], v1 offset:51200
    v_fma_f32 v241, -v240, v240, v241
    v_mfma_f32_16x16x32_bf16 v[20:23], v[84:87], v[160:163], v[20:23]
    ds_read_b128 v[128:131], v1 offset:52224
    v_fma_f32 v243, -v242, v242, v243
    v_mfma_f32_16x16x32_bf16 v[48:51], v[84:87], v[164:167], v[48:51]
    ds_read_b128 v[132:135], v1 offset:53248
    v_fma_f32 v245, -v244, v244, v245
    v_mfma_f32_16x16x32_bf16 v[24:27], v[88:91], v[160:163], v[24:27]
    ds_read_b128 v[136:139], v1 offset:54272
    v_max_f32 v241, 0, v241
    v_mfma_f32_16x16x32_bf16 v[52:55], v[88:91], v[164:167], v[52:55]
    ds_read_b128 v[140:143], v1 offset:55296
    v_max_f32 v243, 0, v243
    v_mfma_f32_16x16x32_bf16 v[28:31], v[92:95], v[160:163], v[28:31]
    ds_read_b128 v[144:147], v1 offset:56320
    v_max_f32 v245, 0, v245
    v_mfma_f32_16x16x32_bf16 v[56:59], v[92:95], v[164:167], v[56:59]
    ds_read_b128 v[148:151], v248 offset:5120
    s_waitcnt lgkmcnt(8)
    v_mfma_f32_16x16x32_bf16 v[32:35], v[160:163], v[96:99], v[32:35]
    ds_read_b128 v[152:155], v249 offset:35840
    v_add_f32 v241, 0x3727c5ac, v241
    v_mfma_f32_16x16x32_bf16 v[60:63], v[164:167], v[96:99], v[60:63]
    ds_read_b128 v[156:159], v251 offset:35840
    v_add_f32 v243, 0x3727c5ac, v243
    v_mfma_f32_16x16x32_bf16 v[36:39], v[160:163], v[100:103], v[36:39]
    buffer_load_dwordx4 v[200:203], v1, s[4:7], s40 offen offset:3072 sc1
    v_add_f32 v245, 0x3727c5ac, v245
    v_mfma_f32_16x16x32_bf16 v[64:67], v[164:167], v[100:103], v[64:67]
    buffer_load_dwordx4 v[204:207], v253, s[4:7], s40 offen offset:3072 sc1
    v_rsq_f32 v241, v241
    v_mfma_f32_16x16x32_bf16 v[40:43], v[104:107], v[160:163], v[40:43]
    v_rsq_f32 v243, v243
    v_rsq_f32 v245, v245
    v_mfma_f32_16x16x32_bf16 v[68:71], v[104:107], v[164:167], v[68:71]
    s_nop 0
    v_lshlrev_b32 v255, 4, v3
    v_mfma_f32_16x16x32_bf16 v[72:75], v[112:115], v[108:111], v[72:75]
    v_add_u32 v236, 161792, v255
    v_mfma_f32_16x16x32_bf16 v[76:79], v[108:111], v[116:119], v[76:79]
    s_lshl_b32 s36, s33, 6
    s_waitcnt vmcnt(8) lgkmcnt(6)
    v_mfma_f32_16x16x32_bf16 v[16:19], v[120:123], v[168:171], v[16:19]
    ds_read_b128 v[80:83], v1 offset:57344
    v_mfma_f32_16x16x32_bf16 v[44:47], v[120:123], v[172:175], v[44:47]
    ds_read_b128 v[84:87], v1 offset:58368
    v_add_u32 v237, s36, v236
    v_mfma_f32_16x16x32_bf16 v[20:23], v[124:127], v[168:171], v[20:23]
    ds_read_b128 v[88:91], v1 offset:59392
    v_lshlrev_b32 v254, 2, v2
    v_mfma_f32_16x16x32_bf16 v[48:51], v[124:127], v[172:175], v[48:51]
    ds_read_b128 v[92:95], v1 offset:60416
    v_add_u32 v238, 161792, v254
    v_mfma_f32_16x16x32_bf16 v[24:27], v[128:131], v[168:171], v[24:27]
    ds_read_b128 v[96:99], v1 offset:61440
    s_lshl_b32 s37, s34, 6
    v_mfma_f32_16x16x32_bf16 v[52:55], v[128:131], v[172:175], v[52:55]
    ds_read_b128 v[100:103], v1 offset:62464
    v_add_u32 v239, s37, v238
    v_mfma_f32_16x16x32_bf16 v[28:31], v[132:135], v[168:171], v[28:31]
    ds_read_b128 v[104:107], v1 offset:63488
    s_mul_i32 s36, s20, 3072
    v_mfma_f32_16x16x32_bf16 v[56:59], v[132:135], v[172:175], v[56:59]
    ds_read_b128 v[108:111], v248 offset:6144
    s_waitcnt lgkmcnt(8)
    v_mfma_f32_16x16x32_bf16 v[32:35], v[168:171], v[136:139], v[32:35]
    ds_read_b128 v[112:115], v249 offset:43008
    s_add_u32 s36, s36, 153600
    v_mfma_f32_16x16x32_bf16 v[60:63], v[172:175], v[136:139], v[60:63]
    ds_read_b128 v[116:119], v251 offset:43008
    v_add_u32 v254, s36, v254
    v_mfma_f32_16x16x32_bf16 v[36:39], v[168:171], v[140:143], v[36:39]
    buffer_load_dwordx4 v[160:163], v1, s[4:7], s41 offen offset:0 sc1
    v_add_u32 v255, s36, v255
    v_mfma_f32_16x16x32_bf16 v[64:67], v[172:175], v[140:143], v[64:67]
    buffer_load_dwordx4 v[164:167], v253, s[4:7], s41 offen offset:0 sc1
    v_mfma_f32_16x16x32_bf16 v[40:43], v[144:147], v[168:171], v[40:43]
    v_mfma_f32_16x16x32_bf16 v[68:71], v[144:147], v[172:175], v[68:71]
    ds_write2_b32 v254, v240, v241 offset0:0 offset1:16
    v_mfma_f32_16x16x32_bf16 v[72:75], v[152:155], v[148:151], v[72:75]
    ds_write2_b32 v254, v242, v243 offset0:32 offset1:48
    v_mfma_f32_16x16x32_bf16 v[76:79], v[148:151], v[156:159], v[76:79]
    ds_write2_b32 v254, v244, v245 offset0:64 offset1:80
    s_waitcnt vmcnt(8) lgkmcnt(9)
    s_barrier
    v_mfma_f32_16x16x32_bf16 v[16:19], v[80:83], v[176:179], v[16:19]
    ds_read_b128 v[120:123], v247 offset:0
    v_mfma_f32_16x16x32_bf16 v[44:47], v[80:83], v[180:183], v[44:47]
    ds_read_b128 v[124:127], v247 offset:1024
    v_mfma_f32_16x16x32_bf16 v[20:23], v[84:87], v[176:179], v[20:23]
    ds_read_b128 v[128:131], v247 offset:2048
    v_mfma_f32_16x16x32_bf16 v[48:51], v[84:87], v[180:183], v[48:51]
    ds_read_b128 v[132:135], v247 offset:3072
    v_mfma_f32_16x16x32_bf16 v[24:27], v[88:91], v[176:179], v[24:27]
    ds_read_b128 v[136:139], v247 offset:4096
    v_mfma_f32_16x16x32_bf16 v[52:55], v[88:91], v[180:183], v[52:55]
    ds_read_b128 v[140:143], v247 offset:5120
    v_mfma_f32_16x16x32_bf16 v[28:31], v[92:95], v[176:179], v[28:31]
    ds_read_b128 v[144:147], v247 offset:6144
    v_mfma_f32_16x16x32_bf16 v[56:59], v[92:95], v[180:183], v[56:59]
    ds_read_b128 v[148:151], v248 offset:7168
    s_waitcnt lgkmcnt(8)
    v_mfma_f32_16x16x32_bf16 v[32:35], v[176:179], v[96:99], v[32:35]
    ds_read_b128 v[152:155], v249 offset:50176
    v_mfma_f32_16x16x32_bf16 v[60:63], v[180:183], v[96:99], v[60:63]
    ds_read_b128 v[156:159], v251 offset:50176
    v_mfma_f32_16x16x32_bf16 v[36:39], v[176:179], v[100:103], v[36:39]
    buffer_load_dwordx4 v[168:171], v1, s[4:7], s41 offen offset:1024 sc1
    ds_read_b128 v[208:211], v236 offset:0
    v_mfma_f32_16x16x32_bf16 v[64:67], v[180:183], v[100:103], v[64:67]
    buffer_load_dwordx4 v[172:175], v253, s[4:7], s41 offen offset:1024 sc1
    ds_read_b128 v[212:215], v236 offset:64
    v_mfma_f32_16x16x32_bf16 v[40:43], v[104:107], v[176:179], v[40:43]
    ds_read_b128 v[216:219], v236 offset:128
    v_mfma_f32_16x16x32_bf16 v[68:71], v[104:107], v[180:183], v[68:71]
    ds_read_b128 v[220:223], v236 offset:192
    v_mfma_f32_16x16x32_bf16 v[72:75], v[112:115], v[108:111], v[72:75]
    ds_read_b128 v[224:227], v236 offset:384
    v_mfma_f32_16x16x32_bf16 v[76:79], v[108:111], v[116:119], v[76:79]
    ds_read_b128 v[228:231], v237
    s_waitcnt vmcnt(8) lgkmcnt(12)
    v_mfma_f32_16x16x32_bf16 v[16:19], v[120:123], v[184:187], v[16:19]
    ds_read_b128 v[80:83], v247 offset:7168
    v_mfma_f32_16x16x32_bf16 v[44:47], v[120:123], v[188:191], v[44:47]
    ds_read_b128 v[84:87], v247 offset:8192
    v_mfma_f32_16x16x32_bf16 v[20:23], v[124:127], v[184:187], v[20:23]
    ds_read_b128 v[88:91], v247 offset:9216
    v_mfma_f32_16x16x32_bf16 v[48:51], v[124:127], v[188:191], v[48:51]
    ds_read_b128 v[92:95], v247 offset:10240
    v_mfma_f32_16x16x32_bf16 v[24:27], v[128:131], v[184:187], v[24:27]
    ds_read_b128 v[96:99], v247 offset:11264
    v_mfma_f32_16x16x32_bf16 v[52:55], v[128:131], v[188:191], v[52:55]
    ds_read_b128 v[100:103], v247 offset:12288
    v_mfma_f32_16x16x32_bf16 v[28:31], v[132:135], v[184:187], v[28:31]
    ds_read_b128 v[104:107], v247 offset:13312
    v_mfma_f32_16x16x32_bf16 v[56:59], v[132:135], v[188:191], v[56:59]
    ds_read_b128 v[108:111], v248 offset:8192
    s_waitcnt lgkmcnt(8)
    v_mfma_f32_16x16x32_bf16 v[32:35], v[184:187], v[136:139], v[32:35]
    ds_read_b128 v[112:115], v249 offset:57344
    v_mfma_f32_16x16x32_bf16 v[60:63], v[188:191], v[136:139], v[60:63]
    ds_read_b128 v[116:119], v251 offset:57344
    v_mfma_f32_16x16x32_bf16 v[36:39], v[184:187], v[140:143], v[36:39]
    buffer_load_dwordx4 v[176:179], v1, s[4:7], s41 offen offset:2048 sc1
    v_mfma_f32_16x16x32_bf16 v[64:67], v[188:191], v[140:143], v[64:67]
    buffer_load_dwordx4 v[180:183], v253, s[4:7], s41 offen offset:2048 sc1
    ds_read2_b32 v[232:233], v238 offset0:64 offset1:80
    v_mfma_f32_16x16x32_bf16 v[40:43], v[144:147], v[184:187], v[40:43]
    ds_read_b32 v234, v239
    v_mfma_f32_16x16x32_bf16 v[68:71], v[144:147], v[188:191], v[68:71]
    ds_read_b128 v[4:7], v255 offset:0
    v_mfma_f32_16x16x32_bf16 v[72:75], v[152:155], v[148:151], v[72:75]
    ds_read_b128 v[8:11], v255 offset:128
    v_mfma_f32_16x16x32_bf16 v[76:79], v[148:151], v[156:159], v[76:79]
    ds_read_b128 v[12:15], v255 offset:256
    s_waitcnt vmcnt(8) lgkmcnt(11)
    s_barrier
    v_mfma_f32_16x16x32_bf16 v[16:19], v[80:83], v[192:195], v[16:19]
    ds_read_b128 v[120:123], v247 offset:14336
    v_mfma_f32_16x16x32_bf16 v[44:47], v[80:83], v[196:199], v[44:47]
    ds_read_b128 v[124:127], v247 offset:15360
    v_mfma_f32_16x16x32_bf16 v[20:23], v[84:87], v[192:195], v[20:23]
    ds_read_b128 v[128:131], v247 offset:16384
    v_mfma_f32_16x16x32_bf16 v[48:51], v[84:87], v[196:199], v[48:51]
    ds_read_b128 v[132:135], v247 offset:17408
    v_mfma_f32_16x16x32_bf16 v[24:27], v[88:91], v[192:195], v[24:27]
    ds_read_b128 v[136:139], v247 offset:18432
    v_mfma_f32_16x16x32_bf16 v[52:55], v[88:91], v[196:199], v[52:55]
    ds_read_b128 v[140:143], v247 offset:19456
    v_mfma_f32_16x16x32_bf16 v[28:31], v[92:95], v[192:195], v[28:31]
    ds_read_b128 v[144:147], v247 offset:20480
    v_mfma_f32_16x16x32_bf16 v[56:59], v[92:95], v[196:199], v[56:59]
    ds_read_b128 v[148:151], v248 offset:9216
    s_waitcnt lgkmcnt(8)
    v_mfma_f32_16x16x32_bf16 v[32:35], v[192:195], v[96:99], v[32:35]
    ds_read_b128 v[152:155], v250 offset:0
    v_mfma_f32_16x16x32_bf16 v[60:63], v[196:199], v[96:99], v[60:63]
    ds_read_b128 v[156:159], v252 offset:0
    v_mfma_f32_16x16x32_bf16 v[36:39], v[192:195], v[100:103], v[36:39]
    buffer_load_dwordx4 v[184:187], v1, s[4:7], s41 offen offset:3072 sc1
    v_mfma_f32_16x16x32_bf16 v[64:67], v[196:199], v[100:103], v[64:67]
    buffer_load_dwordx4 v[188:191], v253, s[4:7], s41 offen offset:3072 sc1
    v_mfma_f32_16x16x32_bf16 v[40:43], v[104:107], v[192:195], v[40:43]
    v_mfma_f32_16x16x32_bf16 v[68:71], v[104:107], v[196:199], v[68:71]
    v_mfma_f32_16x16x32_bf16 v[72:75], v[112:115], v[108:111], v[72:75]
    v_mfma_f32_16x16x32_bf16 v[76:79], v[108:111], v[116:119], v[76:79]
    s_waitcnt vmcnt(8) lgkmcnt(6)
    v_mfma_f32_16x16x32_bf16 v[16:19], v[120:123], v[200:203], v[16:19]
    ds_read_b128 v[80:83], v247 offset:21504
    v_fma_f32 v32, -v8, v232, v32
    v_mfma_f32_16x16x32_bf16 v[44:47], v[120:123], v[204:207], v[44:47]
    ds_read_b128 v[84:87], v247 offset:22528
    v_fma_f32 v60, -v12, v232, v60
    v_mfma_f32_16x16x32_bf16 v[20:23], v[124:127], v[200:203], v[20:23]
    ds_read_b128 v[88:91], v247 offset:23552
    v_fma_f32 v36, -v8, v233, v36
    v_mfma_f32_16x16x32_bf16 v[48:51], v[124:127], v[204:207], v[48:51]
    ds_read_b128 v[92:95], v247 offset:24576
    v_fma_f32 v64, -v12, v233, v64
    v_mfma_f32_16x16x32_bf16 v[24:27], v[128:131], v[200:203], v[24:27]
    ds_read_b128 v[96:99], v247 offset:25600
    v_fma_f32 v40, -v242, v224, v40
    v_mfma_f32_16x16x32_bf16 v[52:55], v[128:131], v[204:207], v[52:55]
    ds_read_b128 v[100:103], v247 offset:26624
    v_fma_f32 v68, -v244, v224, v68
    v_mfma_f32_16x16x32_bf16 v[28:31], v[132:135], v[200:203], v[28:31]
    ds_read_b128 v[104:107], v247 offset:27648
    v_fma_f32 v72, -v240, v228, v72
    v_mfma_f32_16x16x32_bf16 v[56:59], v[132:135], v[204:207], v[56:59]
    ds_read_b128 v[108:111], v248 offset:10240
    s_waitcnt lgkmcnt(8)
    v_fma_f32 v76, -v4, v234, v76
    v_mfma_f32_16x16x32_bf16 v[32:35], v[200:203], v[136:139], v[32:35]
    ds_read_b128 v[112:115], v250 offset:7168
    v_fma_f32 v16, -v242, v208, v16
    v_mfma_f32_16x16x32_bf16 v[60:63], v[204:207], v[136:139], v[60:63]
    ds_read_b128 v[116:119], v252 offset:7168
    v_fma_f32 v44, -v244, v208, v44
    v_mfma_f32_16x16x32_bf16 v[36:39], v[200:203], v[140:143], v[36:39]
    buffer_load_dwordx4 v[192:195], v1, s[4:7], s42 offen offset:0 sc1
    v_fma_f32 v20, -v242, v212, v20
    v_mfma_f32_16x16x32_bf16 v[64:67], v[204:207], v[140:143], v[64:67]
    buffer_load_dwordx4 v[196:199], v253, s[4:7], s42 offen offset:0 sc1
    v_fma_f32 v48, -v244, v212, v48
    v_mfma_f32_16x16x32_bf16 v[40:43], v[144:147], v[200:203], v[40:43]
    v_fma_f32 v24, -v242, v216, v24
    v_mfma_f32_16x16x32_bf16 v[68:71], v[144:147], v[204:207], v[68:71]
    v_fma_f32 v52, -v244, v216, v52
    v_mfma_f32_16x16x32_bf16 v[72:75], v[152:155], v[148:151], v[72:75]
    v_fma_f32 v28, -v242, v220, v28
    v_mfma_f32_16x16x32_bf16 v[76:79], v[148:151], v[156:159], v[76:79]
    v_fma_f32 v56, -v244, v220, v56
    s_waitcnt vmcnt(8) lgkmcnt(6)
    s_barrier
    v_mfma_f32_16x16x32_bf16 v[16:19], v[80:83], v[160:163], v[16:19]
    ds_read_b128 v[120:123], v247 offset:28672
    v_fma_f32 v33, -v9, v232, v33
    v_mfma_f32_16x16x32_bf16 v[44:47], v[80:83], v[164:167], v[44:47]
    ds_read_b128 v[124:127], v247 offset:29696
    v_fma_f32 v61, -v13, v232, v61
    v_mfma_f32_16x16x32_bf16 v[20:23], v[84:87], v[160:163], v[20:23]
    ds_read_b128 v[128:131], v247 offset:30720
    v_fma_f32 v37, -v9, v233, v37
    v_mfma_f32_16x16x32_bf16 v[48:51], v[84:87], v[164:167], v[48:51]
    ds_read_b128 v[132:135], v247 offset:31744
    v_fma_f32 v65, -v13, v233, v65
    v_mfma_f32_16x16x32_bf16 v[24:27], v[88:91], v[160:163], v[24:27]
    ds_read_b128 v[136:139], v247 offset:32768
    v_fma_f32 v41, -v242, v225, v41
    v_mfma_f32_16x16x32_bf16 v[52:55], v[88:91], v[164:167], v[52:55]
    ds_read_b128 v[140:143], v247 offset:33792
    v_fma_f32 v69, -v244, v225, v69
    v_mfma_f32_16x16x32_bf16 v[28:31], v[92:95], v[160:163], v[28:31]
    ds_read_b128 v[144:147], v247 offset:34816
    v_fma_f32 v73, -v240, v229, v73
    v_mfma_f32_16x16x32_bf16 v[56:59], v[92:95], v[164:167], v[56:59]
    ds_read_b128 v[148:151], v248 offset:11264
    s_waitcnt lgkmcnt(8)
    v_fma_f32 v77, -v5, v234, v77
    v_mfma_f32_16x16x32_bf16 v[32:35], v[160:163], v[96:99], v[32:35]
    ds_read_b128 v[152:155], v250 offset:14336
    v_fma_f32 v17, -v242, v209, v17
    v_mfma_f32_16x16x32_bf16 v[60:63], v[164:167], v[96:99], v[60:63]
    ds_read_b128 v[156:159], v252 offset:14336
    v_fma_f32 v45, -v244, v209, v45
    v_mfma_f32_16x16x32_bf16 v[36:39], v[160:163], v[100:103], v[36:39]
    buffer_load_dwordx4 v[200:203], v1, s[4:7], s42 offen offset:1024 sc1
    v_fma_f32 v21, -v242, v213, v21
    v_mfma_f32_16x16x32_bf16 v[64:67], v[164:167], v[100:103], v[64:67]
    buffer_load_dwordx4 v[204:207], v253, s[4:7], s42 offen offset:1024 sc1
    v_fma_f32 v49, -v244, v213, v49
    v_mfma_f32_16x16x32_bf16 v[40:43], v[104:107], v[160:163], v[40:43]
    v_fma_f32 v25, -v242, v217, v25
    v_mfma_f32_16x16x32_bf16 v[68:71], v[104:107], v[164:167], v[68:71]
    v_fma_f32 v53, -v244, v217, v53
    v_mfma_f32_16x16x32_bf16 v[72:75], v[112:115], v[108:111], v[72:75]
    v_fma_f32 v29, -v242, v221, v29
    v_mfma_f32_16x16x32_bf16 v[76:79], v[108:111], v[116:119], v[76:79]
    v_fma_f32 v57, -v244, v221, v57
    s_waitcnt vmcnt(8) lgkmcnt(6)
    v_mfma_f32_16x16x32_bf16 v[16:19], v[120:123], v[168:171], v[16:19]
    ds_read_b128 v[80:83], v247 offset:35840
    v_fma_f32 v34, -v10, v232, v34
    v_mfma_f32_16x16x32_bf16 v[44:47], v[120:123], v[172:175], v[44:47]
    ds_read_b128 v[84:87], v247 offset:36864
    v_fma_f32 v62, -v14, v232, v62
    v_mfma_f32_16x16x32_bf16 v[20:23], v[124:127], v[168:171], v[20:23]
    ds_read_b128 v[88:91], v247 offset:37888
    v_fma_f32 v38, -v10, v233, v38
    v_mfma_f32_16x16x32_bf16 v[48:51], v[124:127], v[172:175], v[48:51]
    ds_read_b128 v[92:95], v247 offset:38912
    v_fma_f32 v66, -v14, v233, v66
    v_mfma_f32_16x16x32_bf16 v[24:27], v[128:131], v[168:171], v[24:27]
    ds_read_b128 v[96:99], v247 offset:39936
    v_fma_f32 v42, -v242, v226, v42
    v_mfma_f32_16x16x32_bf16 v[52:55], v[128:131], v[172:175], v[52:55]
    ds_read_b128 v[100:103], v247 offset:40960
    v_fma_f32 v70, -v244, v226, v70
    v_mfma_f32_16x16x32_bf16 v[28:31], v[132:135], v[168:171], v[28:31]
    ds_read_b128 v[104:107], v247 offset:41984
    v_fma_f32 v74, -v240, v230, v74
    v_mfma_f32_16x16x32_bf16 v[56:59], v[132:135], v[172:175], v[56:59]
    ds_read_b128 v[108:111], v248 offset:12288
    s_waitcnt lgkmcnt(8)
    v_fma_f32 v78, -v6, v234, v78
    v_mfma_f32_16x16x32_bf16 v[32:35], v[168:171], v[136:139], v[32:35]
    ds_read_b128 v[112:115], v250 offset:21504
    v_fma_f32 v18, -v242, v210, v18
    v_mfma_f32_16x16x32_bf16 v[60:63], v[172:175], v[136:139], v[60:63]
    ds_read_b128 v[116:119], v252 offset:21504
    v_fma_f32 v46, -v244, v210, v46
    v_mfma_f32_16x16x32_bf16 v[36:39], v[168:171], v[140:143], v[36:39]
    v_fma_f32 v22, -v242, v214, v22
    v_mfma_f32_16x16x32_bf16 v[64:67], v[172:175], v[140:143], v[64:67]
    v_fma_f32 v50, -v244, v214, v50
    v_mfma_f32_16x16x32_bf16 v[40:43], v[144:147], v[168:171], v[40:43]
    v_fma_f32 v26, -v242, v218, v26
    v_mfma_f32_16x16x32_bf16 v[68:71], v[144:147], v[172:175], v[68:71]
    v_fma_f32 v54, -v244, v218, v54
    v_mfma_f32_16x16x32_bf16 v[72:75], v[152:155], v[148:151], v[72:75]
    v_fma_f32 v30, -v242, v222, v30
    v_mfma_f32_16x16x32_bf16 v[76:79], v[148:151], v[156:159], v[76:79]
    v_fma_f32 v58, -v244, v222, v58
    s_waitcnt vmcnt(6) lgkmcnt(6)
    v_mfma_f32_16x16x32_bf16 v[16:19], v[80:83], v[176:179], v[16:19]
    ds_read_b128 v[120:123], v247 offset:43008
    v_fma_f32 v35, -v11, v232, v35
    v_mfma_f32_16x16x32_bf16 v[44:47], v[80:83], v[180:183], v[44:47]
    ds_read_b128 v[124:127], v247 offset:44032
    v_fma_f32 v63, -v15, v232, v63
    v_mfma_f32_16x16x32_bf16 v[20:23], v[84:87], v[176:179], v[20:23]
    ds_read_b128 v[128:131], v247 offset:45056
    v_fma_f32 v39, -v11, v233, v39
    v_mfma_f32_16x16x32_bf16 v[48:51], v[84:87], v[180:183], v[48:51]
    ds_read_b128 v[132:135], v247 offset:46080
    v_fma_f32 v67, -v15, v233, v67
    v_mfma_f32_16x16x32_bf16 v[24:27], v[88:91], v[176:179], v[24:27]
    ds_read_b128 v[136:139], v247 offset:47104
    v_fma_f32 v43, -v242, v227, v43
    v_mfma_f32_16x16x32_bf16 v[52:55], v[88:91], v[180:183], v[52:55]
    ds_read_b128 v[140:143], v247 offset:48128
    v_fma_f32 v71, -v244, v227, v71
    v_mfma_f32_16x16x32_bf16 v[28:31], v[92:95], v[176:179], v[28:31]
    ds_read_b128 v[144:147], v247 offset:49152
    v_fma_f32 v75, -v240, v231, v75
    v_mfma_f32_16x16x32_bf16 v[56:59], v[92:95], v[180:183], v[56:59]
    ds_read_b128 v[148:151], v248 offset:13312
    s_waitcnt lgkmcnt(8)
    v_fma_f32 v79, -v7, v234, v79
    v_mfma_f32_16x16x32_bf16 v[32:35], v[176:179], v[96:99], v[32:35]
    ds_read_b128 v[152:155], v250 offset:28672
    v_fma_f32 v19, -v242, v211, v19
    v_mfma_f32_16x16x32_bf16 v[60:63], v[180:183], v[96:99], v[60:63]
    ds_read_b128 v[156:159], v252 offset:28672
    v_fma_f32 v47, -v244, v211, v47
    v_mfma_f32_16x16x32_bf16 v[36:39], v[176:179], v[100:103], v[36:39]
    v_fma_f32 v23, -v242, v215, v23
    v_mfma_f32_16x16x32_bf16 v[64:67], v[180:183], v[100:103], v[64:67]
    v_fma_f32 v51, -v244, v215, v51
    v_mfma_f32_16x16x32_bf16 v[40:43], v[104:107], v[176:179], v[40:43]
    v_fma_f32 v27, -v242, v219, v27
    v_mfma_f32_16x16x32_bf16 v[68:71], v[104:107], v[180:183], v[68:71]
    v_fma_f32 v55, -v244, v219, v55
    v_mfma_f32_16x16x32_bf16 v[72:75], v[112:115], v[108:111], v[72:75]
    v_fma_f32 v31, -v242, v223, v31
    v_mfma_f32_16x16x32_bf16 v[76:79], v[108:111], v[116:119], v[76:79]
    v_fma_f32 v59, -v244, v223, v59
    s_waitcnt vmcnt(4) lgkmcnt(6)
    s_barrier
    v_mfma_f32_16x16x32_bf16 v[16:19], v[120:123], v[184:187], v[16:19]
    ds_read_b128 v[80:83], v247 offset:50176
    v_mfma_f32_16x16x32_bf16 v[44:47], v[120:123], v[188:191], v[44:47]
    ds_read_b128 v[84:87], v247 offset:51200
    v_and_b32 v4, 1, v2
    v_mfma_f32_16x16x32_bf16 v[20:23], v[124:127], v[184:187], v[20:23]
    ds_read_b128 v[88:91], v247 offset:52224
    v_lshl_add_u32 v5, v3, 2, v4
    v_mfma_f32_16x16x32_bf16 v[48:51], v[124:127], v[188:191], v[48:51]
    ds_read_b128 v[92:95], v247 offset:53248
    v_add_u32 v6, 2, v5
    v_mfma_f32_16x16x32_bf16 v[24:27], v[128:131], v[184:187], v[24:27]
    ds_read_b128 v[96:99], v247 offset:54272
    v_cmp_eq_u32 s[40:41], 1, v4
    v_mfma_f32_16x16x32_bf16 v[52:55], v[128:131], v[188:191], v[52:55]
    ds_read_b128 v[100:103], v247 offset:55296
    v_cmp_le_u32 s[42:43], v5, v2
    v_mfma_f32_16x16x32_bf16 v[28:31], v[132:135], v[184:187], v[28:31]
    ds_read_b128 v[104:107], v247 offset:56320
    v_cmp_le_u32 s[44:45], v6, v2
    v_mfma_f32_16x16x32_bf16 v[56:59], v[132:135], v[188:191], v[56:59]
    ds_read_b128 v[108:111], v248 offset:14336
    s_waitcnt lgkmcnt(8)
    v_mfma_f32_16x16x32_bf16 v[32:35], v[184:187], v[136:139], v[32:35]
    ds_read_b128 v[112:115], v250 offset:35840
    v_mov_b32 v4, 0x0c0c0100
    v_mfma_f32_16x16x32_bf16 v[60:63], v[188:191], v[136:139], v[60:63]
    ds_read_b128 v[116:119], v252 offset:35840
    v_mov_b32 v5, 0x01000c0c
    v_mfma_f32_16x16x32_bf16 v[36:39], v[184:187], v[140:143], v[36:39]
    v_mov_b32 v6, 0x0c0c0302
    v_mov_b32 v7, 0x03020c0c
    v_mfma_f32_16x16x32_bf16 v[64:67], v[188:191], v[140:143], v[64:67]
    v_mov_b32 v8, 0x0c0c0c0c
    v_cndmask_b32 v4, v4, v5, s[40:41]
    v_mfma_f32_16x16x32_bf16 v[40:43], v[144:147], v[184:187], v[40:43]
    v_cndmask_b32 v6, v6, v7, s[40:41]
    v_cndmask_b32 v12, v4, v8, s[42:43]
    v_mfma_f32_16x16x32_bf16 v[68:71], v[144:147], v[188:191], v[68:71]
    v_cndmask_b32 v13, v6, v8, s[44:45]
    v_cndmask_b32 v14, v8, v4, s[42:43]
    v_mfma_f32_16x16x32_bf16 v[72:75], v[152:155], v[148:151], v[72:75]
    v_cndmask_b32 v15, v8, v6, s[44:45]
    s_cmp_eq_u32 s31, 0
    v_mfma_f32_16x16x32_bf16 v[76:79], v[148:151], v[156:159], v[76:79]
    s_cselect_b64 s[48:49], s[42:43], -1
    s_cselect_b64 s[38:39], s[44:45], -1
    s_waitcnt vmcnt(2) lgkmcnt(6)
    v_mfma_f32_16x16x32_bf16 v[16:19], v[80:83], v[192:195], v[16:19]
    ds_read_b128 v[120:123], v247 offset:57344
    v_mfma_f32_16x16x32_bf16 v[44:47], v[80:83], v[196:199], v[44:47]
    ds_read_b128 v[124:127], v247 offset:58368
    s_mul_i32 s36, s20, 3072
    v_mfma_f32_16x16x32_bf16 v[20:23], v[84:87], v[192:195], v[20:23]
    ds_read_b128 v[128:131], v247 offset:59392
    s_add_u32 s36, s36, 149504
    v_mfma_f32_16x16x32_bf16 v[48:51], v[84:87], v[196:199], v[48:51]
    ds_read_b128 v[132:135], v247 offset:60416
    v_add_u32 v9, s36, v0
    v_mfma_f32_16x16x32_bf16 v[24:27], v[88:91], v[192:195], v[24:27]
    ds_read_b128 v[136:139], v247 offset:61440
    s_lshl_b32 s37, s20, 9
    v_mfma_f32_16x16x32_bf16 v[52:55], v[88:91], v[196:199], v[52:55]
    ds_read_b128 v[140:143], v247 offset:62464
    s_add_u32 s37, s37, 149504
    v_mfma_f32_16x16x32_bf16 v[28:31], v[92:95], v[192:195], v[28:31]
    ds_read_b128 v[144:147], v247 offset:63488
    v_add_u32 v10, s37, v0
    v_mfma_f32_16x16x32_bf16 v[56:59], v[92:95], v[196:199], v[56:59]
    ds_read_b128 v[148:151], v248 offset:15360
    s_waitcnt lgkmcnt(8)
    v_mfma_f32_16x16x32_bf16 v[32:35], v[192:195], v[96:99], v[32:35]
    ds_read_b128 v[152:155], v250 offset:43008
    v_lshlrev_b32 v4, 2, v3
    v_mfma_f32_16x16x32_bf16 v[60:63], v[196:199], v[96:99], v[60:63]
    ds_read_b128 v[156:159], v252 offset:43008
    v_sub_u32 v4, v2, v4
    v_mfma_f32_16x16x32_bf16 v[36:39], v[192:195], v[100:103], v[36:39]
    v_lshlrev_b32 v5, 4, v4
    v_lshrrev_b32 v4, 1, v4
    v_mfma_f32_16x16x32_bf16 v[64:67], v[196:199], v[100:103], v[64:67]
    v_mov_b32 v6, 0x3f80
    v_lshlrev_b32 v5, v5, v6
    v_mfma_f32_16x16x32_bf16 v[40:43], v[104:107], v[192:195], v[40:43]
    v_cmp_eq_u32 vcc, 0, v4
    v_cmp_eq_u32 s[46:47], 1, v4
    v_mfma_f32_16x16x32_bf16 v[68:71], v[104:107], v[196:199], v[68:71]
    ds_read_b128 v[208:211], v255 offset:64
    s_lshl_b32 s36, s24, 10
    v_add_u32 v4, s36, v1
    v_mfma_f32_16x16x32_bf16 v[72:75], v[112:115], v[108:111], v[72:75]
    ds_read_b128 v[212:215], v255 offset:192
    v_cndmask_b32 v234, 0, v5, vcc
    v_cndmask_b32 v235, 0, v5, s[46:47]
    v_mfma_f32_16x16x32_bf16 v[76:79], v[108:111], v[116:119], v[76:79]
    ds_read_b128 v[216:219], v255 offset:320
    v_add_u32 v5, 18432, v4
    s_lshl_b32 s36, s24, 7
    s_waitcnt vmcnt(0) lgkmcnt(9)
    v_mfma_f32_16x16x32_bf16 v[16:19], v[120:123], v[200:203], v[16:19]
    ds_read_b128 v[80:83], v248 offset:16384
    v_mfma_f32_16x16x32_bf16 v[44:47], v[120:123], v[204:207], v[44:47]
    ds_read_b128 v[84:87], v250 offset:50176
    s_add_u32 s36, s36, 16384
    v_mfma_f32_16x16x32_bf16 v[20:23], v[124:127], v[200:203], v[20:23]
    ds_read_b128 v[88:91], v252 offset:50176
    v_cmp_eq_u32 vcc, 2, v3
    v_mfma_f32_16x16x32_bf16 v[48:51], v[124:127], v[204:207], v[48:51]
    ds_read_b128 v[92:95], v248 offset:17408
    v_lshl_add_u32 v6, v2, 3, s36
    v_mfma_f32_16x16x32_bf16 v[24:27], v[128:131], v[200:203], v[24:27]
    ds_read_b128 v[96:99], v250 offset:57344
    v_bfrev_b32 v7, 1
    v_mfma_f32_16x16x32_bf16 v[52:55], v[128:131], v[204:207], v[52:55]
    ds_read_b128 v[100:103], v252 offset:57344
    v_cndmask_b32 v6, v7, v6, vcc
    v_mfma_f32_16x16x32_bf16 v[28:31], v[132:135], v[200:203], v[28:31]
    v_add_u32 v7, 18432, v6
    v_mov_b32 v106, 0
    v_mfma_f32_16x16x32_bf16 v[56:59], v[132:135], v[204:207], v[56:59]
    s_waitcnt lgkmcnt(6)
    v_mov_b32 v107, 0
    v_mfma_f32_16x16x32_bf16 v[32:35], v[200:203], v[136:139], v[32:35]
    v_mov_b32 v8, 0xf149f2ca
    v_mov_b32 v108, 0
    v_mfma_f32_16x16x32_bf16 v[60:63], v[204:207], v[136:139], v[60:63]
    s_mov_b32 s33, 0x3eae1a93
    v_mov_b32 v109, 0
    v_mfma_f32_16x16x32_bf16 v[36:39], v[200:203], v[140:143], v[36:39]
    v_mov_b32 v236, 0x3f803f80
    v_mov_b32 v237, 0x3f803f80
    v_mfma_f32_16x16x32_bf16 v[64:67], v[204:207], v[140:143], v[64:67]
    v_mov_b32 v238, 0x3f803f80
    v_mov_b32 v239, 0x3f803f80
    v_mfma_f32_16x16x32_bf16 v[40:43], v[144:147], v[200:203], v[40:43]
    v_mov_b32 v114, 0
    v_mfma_f32_16x16x32_bf16 v[68:71], v[144:147], v[204:207], v[68:71]
    v_mov_b32 v115, 0
    v_mfma_f32_16x16x32_bf16 v[72:75], v[152:155], v[148:151], v[72:75]
    v_mov_b32 v116, 0
    v_mfma_f32_16x16x32_bf16 v[76:79], v[148:151], v[156:159], v[76:79]
    v_mov_b32 v117, 0
    s_waitcnt lgkmcnt(0)
    v_mfma_f32_16x16x32_bf16 v[72:75], v[84:87], v[80:83], v[72:75]
    v_mfma_f32_16x16x32_bf16 v[76:79], v[80:83], v[88:91], v[76:79]
    v_mfma_f32_16x16x32_bf16 v[72:75], v[96:99], v[92:95], v[72:75]
    v_mfma_f32_16x16x32_bf16 v[76:79], v[92:95], v[100:103], v[76:79]
    v_pk_mul_f32 v[52:53], v[52:53], v[244:245] op_sel:[0,1] op_sel_hi:[1,1]
    v_pk_mul_f32 v[54:55], v[54:55], v[244:245] op_sel:[0,1] op_sel_hi:[1,1]
    v_pk_mul_f32 v[56:57], v[56:57], v[244:245] op_sel:[0,1] op_sel_hi:[1,1]
    v_pk_mul_f32 v[58:59], v[58:59], v[244:245] op_sel:[0,1] op_sel_hi:[1,1]
    v_pk_mul_f32 v[60:61], v[60:61], v[216:217]
    v_pk_mul_f32 v[62:63], v[62:63], v[218:219]
    v_pk_mul_f32 v[64:65], v[64:65], v[216:217]
    v_pk_mul_f32 v[66:67], v[66:67], v[218:219]
    v_pk_mul_f32 v[68:69], v[68:69], v[244:245] op_sel:[0,1] op_sel_hi:[1,1]
    v_pk_mul_f32 v[70:71], v[70:71], v[244:245] op_sel:[0,1] op_sel_hi:[1,1]
    v_pk_mul_f32 v[72:73], v[72:73], v[240:241] op_sel:[0,1] op_sel_hi:[1,1]
    v_pk_mul_f32 v[74:75], v[74:75], v[240:241] op_sel:[0,1] op_sel_hi:[1,1]
    v_pk_mul_f32 v[76:77], v[76:77], v[208:209]
    v_pk_mul_f32 v[78:79], v[78:79], v[210:211]
    v_cvt_pk_bf16_f32 v172, v52, v53
    v_cvt_pk_bf16_f32 v173, v54, v55
    v_cvt_pk_bf16_f32 v176, v56, v57
    v_cvt_pk_bf16_f32 v177, v58, v59
    v_cvt_pk_bf16_f32 v182, v60, v61
    v_cvt_pk_bf16_f32 v183, v62, v63
    v_cvt_pk_bf16_f32 v188, v64, v65
    v_cvt_pk_bf16_f32 v189, v66, v67
    v_cvt_pk_bf16_f32 v174, v68, v69
    v_cvt_pk_bf16_f32 v175, v70, v71
    v_cvt_pk_bf16_f32 v220, v72, v73
    v_cvt_pk_bf16_f32 v221, v74, v75
    v_cvt_pk_bf16_f32 v222, v76, v77
    v_cvt_pk_bf16_f32 v223, v78, v79
    s_cmp_eq_u32 s20, 3
    s_cbranch_scc1 L_a_nw
    ds_write2st64_b64 v9, v[172:173], v[174:175] offset0:6 offset1:7
    ds_write2st64_b64 v9, v[176:177], v[182:183] offset0:8 offset1:9
    ds_write_b64 v9, v[188:189] offset:5120
    ds_write2st64_b64 v10, v[220:221], v[222:223] offset0:0 offset1:3
L_a_nw:
    v_pk_mul_f32 v[24:25], v[24:25], v[242:243] op_sel:[0,1] op_sel_hi:[1,1]
    v_pk_mul_f32 v[26:27], v[26:27], v[242:243] op_sel:[0,1] op_sel_hi:[1,1]
    v_pk_mul_f32 v[28:29], v[28:29], v[242:243] op_sel:[0,1] op_sel_hi:[1,1]
    v_pk_mul_f32 v[30:31], v[30:31], v[242:243] op_sel:[0,1] op_sel_hi:[1,1]
    v_pk_mul_f32 v[32:33], v[32:33], v[212:213]
    v_pk_mul_f32 v[34:35], v[34:35], v[214:215]
    v_pk_mul_f32 v[36:37], v[36:37], v[212:213]
    v_pk_mul_f32 v[38:39], v[38:39], v[214:215]
    v_pk_mul_f32 v[40:41], v[40:41], v[242:243] op_sel:[0,1] op_sel_hi:[1,1]
    v_pk_mul_f32 v[42:43], v[42:43], v[242:243] op_sel:[0,1] op_sel_hi:[1,1]
    v_cvt_pk_bf16_f32 v166, v24, v25
    v_cvt_pk_bf16_f32 v167, v26, v27
    v_cvt_pk_bf16_f32 v170, v28, v29
    v_cvt_pk_bf16_f32 v171, v30, v31
    v_cvt_pk_bf16_f32 v180, v32, v33
    v_cvt_pk_bf16_f32 v181, v34, v35
    v_cvt_pk_bf16_f32 v186, v36, v37
    v_cvt_pk_bf16_f32 v187, v38, v39
    v_cvt_pk_bf16_f32 v168, v40, v41
    v_cvt_pk_bf16_f32 v169, v42, v43
    s_waitcnt lgkmcnt(0)
    s_barrier
    ds_read2st64_b64 v[160:163], v9 offset0:0 offset1:1
    ds_read_b64 v[164:165], v9 offset:1024
    ds_read_b64 v[178:179], v9 offset:1536
    ds_read_b64 v[184:185], v9 offset:2048
    v_mfma_f32_16x16x16_bf16 v[128:131], v[174:175], v[234:235], 0
    v_mfma_f32_16x16x16_bf16 v[124:127], v[168:169], v[234:235], 0
    v_pk_mul_f32 v[44:45], v[44:45], v[244:245] op_sel:[0,1] op_sel_hi:[1,1]
    v_pk_mul_f32 v[46:47], v[46:47], v[244:245] op_sel:[0,1] op_sel_hi:[1,1]
    v_pk_mul_f32 v[48:49], v[48:49], v[244:245] op_sel:[0,1] op_sel_hi:[1,1]
    v_pk_mul_f32 v[50:51], v[50:51], v[244:245] op_sel:[0,1] op_sel_hi:[1,1]
    v_pk_mul_f32 v[16:17], v[16:17], v[242:243] op_sel:[0,1] op_sel_hi:[1,1]
    v_pk_mul_f32 v[18:19], v[18:19], v[242:243] op_sel:[0,1] op_sel_hi:[1,1]
    v_pk_mul_f32 v[20:21], v[20:21], v[242:243] op_sel:[0,1] op_sel_hi:[1,1]
    v_pk_mul_f32 v[22:23], v[22:23], v[242:243] op_sel:[0,1] op_sel_hi:[1,1]
    v_cvt_pk_bf16_f32 v112, v44, v45
    v_cvt_pk_bf16_f32 v113, v46, v47
    v_cvt_pk_bf16_f32 v118, v48, v49
    v_cvt_pk_bf16_f32 v119, v50, v51
    v_cvt_pk_bf16_f32 v104, v16, v17
    v_cvt_pk_bf16_f32 v105, v18, v19
    v_cvt_pk_bf16_f32 v110, v20, v21
    v_cvt_pk_bf16_f32 v111, v22, v23
    v_permlane16_swap_b32 v114, v174
    v_permlane16_swap_b32 v117, v175
    v_permlane16_swap_b32 v106, v168
    v_permlane16_swap_b32 v109, v169
    s_waitcnt lgkmcnt(0)
    v_mfma_f32_16x16x16_bf16 v[120:123], v[162:163], v[234:235], 0
    v_mfma_f32_16x16x32_bf16 v[20:23], v[172:175], v[112:115], 0
    v_mfma_f32_16x16x32_bf16 v[16:19], v[166:169], v[112:115], 0
    v_mfma_f32_16x16x32_bf16 v[28:31], v[174:177], v[116:119], 0
    v_mfma_f32_16x16x32_bf16 v[24:27], v[168:171], v[116:119], 0
    v_mfma_f32_16x16x32_bf16 v[36:39], v[166:169], v[104:107], 0
    v_mfma_f32_16x16x32_bf16 v[32:35], v[160:163], v[104:107], 0
    v_mfma_f32_16x16x32_bf16 v[44:47], v[168:171], v[108:111], 0
    v_mfma_f32_16x16x32_bf16 v[40:43], v[162:165], v[108:111], 0
    v_cvt_pk_bf16_f32 v194, v128, v129
    v_cvt_pk_bf16_f32 v195, v130, v131
    v_cvt_pk_bf16_f32 v192, v124, v125
    v_cvt_pk_bf16_f32 v193, v126, v127
    v_cvt_pk_bf16_f32 v190, v120, v121
    v_cvt_pk_bf16_f32 v191, v122, v123
    v_cndmask_b32 v20, v20, v21, s[40:41]
    v_cndmask_b32 v16, v16, v17, s[40:41]
    v_cndmask_b32 v48, v16, v20, s[42:43]
    v_cndmask_b32 v22, v22, v23, s[40:41]
    v_cndmask_b32 v18, v18, v19, s[40:41]
    v_cndmask_b32 v49, v18, v22, s[44:45]
    v_max_f32 v56, v48, v49
    v_cndmask_b32 v28, v28, v29, s[40:41]
    v_cndmask_b32 v24, v24, v25, s[40:41]
    v_cndmask_b32 v50, v24, v28, s[42:43]
    v_cndmask_b32 v30, v30, v31, s[40:41]
    v_cndmask_b32 v26, v26, v27, s[40:41]
    v_cndmask_b32 v51, v26, v30, s[44:45]
    v_max_f32 v57, v50, v51
    v_cndmask_b32 v36, v36, v37, s[40:41]
    v_cndmask_b32 v32, v32, v33, s[40:41]
    v_cndmask_b32 v52, v32, v36, s[42:43]
    v_cndmask_b32 v52, v8, v52, s[48:49]
    v_cndmask_b32 v38, v38, v39, s[40:41]
    v_cndmask_b32 v34, v34, v35, s[40:41]
    v_cndmask_b32 v53, v34, v38, s[44:45]
    v_cndmask_b32 v53, v8, v53, s[38:39]
    v_max_f32 v58, v52, v53
    v_permlane32_swap_b32 v56, v57
    v_max_f32 v56, v56, v57
    v_cndmask_b32 v44, v44, v45, s[40:41]
    v_cndmask_b32 v40, v40, v41, s[40:41]
    v_cndmask_b32 v54, v40, v44, s[42:43]
    v_cndmask_b32 v54, v8, v54, s[48:49]
    v_cndmask_b32 v46, v46, v47, s[40:41]
    v_cndmask_b32 v42, v42, v43, s[40:41]
    v_cndmask_b32 v55, v42, v46, s[44:45]
    v_cndmask_b32 v55, v8, v55, s[38:39]
    v_max_f32 v59, v54, v55
    s_nop 1
    v_permlane32_swap_b32 v58, v59
    v_max_f32 v58, v58, v59
    s_nop 1
    v_permlane16_swap_b32 v56, v58
    v_max_f32 v57, v56, v58
    v_mul_f32 v56, s33, v57
    v_mul_f32 v58, s33, v57
    s_nop 1
    v_permlane16_swap_b32 v56, v58
    v_mov_b32 v57, v56
    v_mov_b32 v59, v58
    s_nop 0
    v_permlane32_swap_b32 v56, v57
    v_permlane32_swap_b32 v58, v59
    v_fma_f32 v48, v48, s33, -v56
    v_fma_f32 v49, v49, s33, -v56
    v_fma_f32 v50, v50, s33, -v57
    v_fma_f32 v51, v51, s33, -v57
    v_fma_f32 v52, v52, s33, -v58
    v_fma_f32 v53, v53, s33, -v58
    v_fma_f32 v54, v54, s33, -v59
    v_fma_f32 v55, v55, s33, -v59
    v_exp_f32 v48, v48
    v_exp_f32 v49, v49
    v_exp_f32 v50, v50
    v_exp_f32 v51, v51
    v_exp_f32 v52, v52
    v_exp_f32 v53, v53
    v_exp_f32 v54, v54
    v_exp_f32 v55, v55
    v_cvt_pk_bf16_f32 v56, v48, v49
    v_cvt_pk_bf16_f32 v57, v50, v51
    v_cvt_pk_bf16_f32 v58, v52, v53
    v_cvt_pk_bf16_f32 v59, v54, v55
    v_perm_b32 v64, v56, v56, v12
    v_perm_b32 v65, v56, v56, v13
    v_perm_b32 v66, v56, v56, v14
    v_perm_b32 v67, v56, v56, v15
    v_perm_b32 v68, v57, v57, v12
    v_perm_b32 v69, v57, v57, v13
    v_perm_b32 v70, v57, v57, v14
    v_perm_b32 v71, v57, v57, v15
    v_perm_b32 v72, v58, v58, v12
    v_perm_b32 v73, v58, v58, v13
    v_perm_b32 v74, v58, v58, v14
    v_perm_b32 v75, v58, v58, v15
    v_perm_b32 v76, v59, v59, v12
    v_perm_b32 v77, v59, v59, v13
    v_perm_b32 v78, v59, v59, v14
    v_perm_b32 v79, v59, v59, v15
    v_mfma_f32_16x16x32_bf16 v[80:83], v[236:239], v[64:67], 0
    v_mfma_f32_16x16x32_bf16 v[84:87], v[236:239], v[68:71], 0
    v_mfma_f32_16x16x32_bf16 v[88:91], v[236:239], v[72:75], 0
    v_mfma_f32_16x16x32_bf16 v[92:95], v[236:239], v[76:79], 0
    v_mfma_f32_16x16x32_bf16 v[16:19], v[180:183], v[64:67], 0
    v_mfma_f32_16x16x32_bf16 v[20:23], v[192:195], v[64:67], 0
    v_mfma_f32_16x16x32_bf16 v[24:27], v[186:189], v[68:71], 0
    v_mfma_f32_16x16x32_bf16 v[28:31], v[192:195], v[68:71], 0
    v_mfma_f32_16x16x32_bf16 v[32:35], v[178:181], v[72:75], 0
    v_mfma_f32_16x16x32_bf16 v[36:39], v[190:193], v[72:75], 0
    v_mfma_f32_16x16x32_bf16 v[40:43], v[184:187], v[76:79], 0
    v_mfma_f32_16x16x32_bf16 v[44:47], v[190:193], v[76:79], 0
    v_rcp_f32 v80, v80
    v_rcp_f32 v84, v84
    v_rcp_f32 v88, v88
    v_rcp_f32 v92, v92
    v_pk_mul_f32 v[16:17], v[16:17], v[80:81] op_sel_hi:[1,0]
    v_pk_mul_f32 v[18:19], v[18:19], v[80:81] op_sel_hi:[1,0]
    v_pk_mul_f32 v[20:21], v[20:21], v[80:81] op_sel_hi:[1,0]
    v_pk_mul_f32 v[24:25], v[24:25], v[84:85] op_sel_hi:[1,0]
    v_pk_mul_f32 v[26:27], v[26:27], v[84:85] op_sel_hi:[1,0]
    v_pk_mul_f32 v[30:31], v[30:31], v[84:85] op_sel_hi:[1,0]
    v_cvt_pk_bf16_f32 v220, v16, v17
    v_cvt_pk_bf16_f32 v221, v18, v19
    v_cvt_pk_bf16_f32 v224, v20, v21
    v_cvt_pk_bf16_f32 v222, v24, v25
    v_cvt_pk_bf16_f32 v223, v26, v27
    v_cvt_pk_bf16_f32 v225, v30, v31
    buffer_store_dwordx4 v[220:223], v5, s[4:7], s35 offen sc1
    buffer_store_dwordx2 v[224:225], v7, s[4:7], s35 offen sc1
    v_pk_mul_f32 v[32:33], v[32:33], v[88:89] op_sel_hi:[1,0]
    v_pk_mul_f32 v[34:35], v[34:35], v[88:89] op_sel_hi:[1,0]
    v_pk_mul_f32 v[36:37], v[36:37], v[88:89] op_sel_hi:[1,0]
    v_pk_mul_f32 v[40:41], v[40:41], v[92:93] op_sel_hi:[1,0]
    v_pk_mul_f32 v[42:43], v[42:43], v[92:93] op_sel_hi:[1,0]
    v_pk_mul_f32 v[46:47], v[46:47], v[92:93] op_sel_hi:[1,0]
    v_cvt_pk_bf16_f32 v228, v32, v33
    v_cvt_pk_bf16_f32 v229, v34, v35
    v_cvt_pk_bf16_f32 v232, v36, v37
    v_cvt_pk_bf16_f32 v230, v40, v41
    v_cvt_pk_bf16_f32 v231, v42, v43
    v_cvt_pk_bf16_f32 v233, v46, v47
    buffer_store_dwordx4 v[228:231], v4, s[4:7], s35 offen sc1
    buffer_store_dwordx2 v[232:233], v6, s[4:7], s35 offen sc1
    s_and_b32 s25, s2, 7
    s_lshr_b32 s26, s2, 3
    s_lshr_b32 s23, s25, 1
    s_lshl_b32 s23, s23, 3
    s_lshr_b32 s27, s26, 2
    s_add_u32 s23, s23, s27
    s_and_b32 s24, s25, 1
    s_lshl_b32 s24, s24, 2
    s_and_b32 s27, s26, 3
    s_add_u32 s24, s24, s27
    s_add_u32 s25, s23, s24
    s_and_b32 s25, s25, 3
    s_lshl_b32 s30, s23, 2
    s_add_u32 s30, s30, s20
    s_mul_i32 s29, s30, 18432
    s_add_u32 s29, s29, s21
    s_add_u32 s29, s29, 0x600000
    s_mul_i32 s34, s30, 18432
    s_add_u32 s34, s34, s21
    s_add_u32 s34, s34, 0x0
    s_lshl_b32 s35, s24, 11
    s_lshr_b32 s36, s24, 2
    s_lshl_b32 s36, s36, 10
    s_and_b32 s37, s24, 3
    s_lshl_b32 s37, s37, 8
    s_add_u32 s36, s36, s37
    s_add_u32 s36, s36, 16384
    v_bfe_u32 v2, v1, 4, 4
    v_lshrrev_b32 v3, 8, v1
    v_add_u32 v4, s35, v1
    v_lshlrev_b32 v5, 4, v2
    v_lshl_add_u32 v5, v3, 3, v5
    v_add_u32 v5, s36, v5
    v_cmp_gt_u32 s[40:41], 2, v3
    v_bfrev_b32 v6, 1
    v_add_u32 v12, 0, v1
    v_add_u32 v13, 36864, v1
    v_add_u32 v14, 73728, v1
    v_add_u32 v15, 110592, v1
    v_cndmask_b32 v5, v6, v5, s[40:41]
    buffer_load_dwordx4 v[208:211], v4, s[4:7], s34 offen offset:0 sc1
    buffer_load_dwordx4 v[212:215], v4, s[4:7], s34 offen offset:1024 sc1
    buffer_load_dwordx2 v[216:217], v5, s[4:7], s34 offen sc1
    s_add_u32 s34, s34, 0x300000
    s_lshl_b32 s39, s30, 10
    s_add_u32 s39, s39, s21
    s_lshl_b32 s42, s24, 7
    s_add_u32 s39, s39, s42
    s_add_u32 s39, s39, 0x1b20000
    v_cmp_eq_u32 vcc, 0, v3
    v_lshlrev_b32 v10, 3, v2
    v_mov_b32 v11, 0x3f803f80
    v_lshl_add_u32 v7, v3, 8, v10
    v_cndmask_b32 v10, v6, v10, vcc
    s_lshr_b32 s44, s23, 1
    s_lshl_b32 s52, s22, 7
    s_add_u32 s52, s52, s44
    s_lshl_b32 s52, s52, 8
    s_add_u32 s52, s52, 0x4508000
    s_add_u32 s52, s52, s4
    s_addc_u32 s53, s5, 0
    s_waitcnt vmcnt(3)
    s_barrier
    s_cmp_lg_u32 s20, 0
    s_cbranch_scc1 L_ns_d2
    s_mov_b32 s56, 1
    s_atomic_add s56, s[50:51], 0
L_ns_d2:
    s_cmp_lg_u32 s20, 0
    s_cbranch_scc1 L_pd_d2
    s_mov_b32 s60, 65536
L_poll_d2:
    s_mov_b32 s57, 0
    s_atomic_add s57, s[52:53], 0 glc
    s_waitcnt lgkmcnt(0)
    s_cmp_ge_u32 s57, 16
    s_cbranch_scc1 L_pd_d2
    s_sub_u32 s60, s60, 1
    s_cbranch_scc1 L_pd_d2
    s_sleep 2
    s_branch L_poll_d2
L_pd_d2:
    s_barrier
    s_mov_b32 s32, 0
    s_lshl_b32 s32, s32, 13
    s_add_u32 s32, s32, s29
    s_add_u32 s33, s32, 4096
    buffer_load_dwordx4 v[112:115], v1, s[4:7], s32 offen offset:0 sc1
    buffer_load_dwordx4 v[116:119], v1, s[4:7], s32 offen offset:1024 sc1
    buffer_load_dwordx4 v[120:123], v1, s[4:7], s32 offen offset:2048 sc1
    buffer_load_dwordx4 v[124:127], v1, s[4:7], s32 offen offset:3072 sc1
    buffer_load_dwordx4 v[128:131], v1, s[4:7], s33 offen offset:0 sc1
    buffer_load_dwordx4 v[132:135], v1, s[4:7], s33 offen offset:1024 sc1
    buffer_load_dwordx4 v[136:139], v1, s[4:7], s33 offen offset:2048 sc1
    buffer_load_dwordx4 v[140:143], v1, s[4:7], s33 offen offset:3072 sc1
    ds_read_b128 v[40:43], v12 offset:18432
    ds_read_b128 v[44:47], v12 offset:19456
    ds_read_b128 v[48:51], v12 offset:20480
    ds_read_b128 v[52:55], v12 offset:21504
    ds_read_b128 v[72:75], v12 offset:26624
    ds_read_b128 v[56:59], v12 offset:22528
    ds_read_b128 v[60:63], v12 offset:23552
    ds_read_b128 v[64:67], v12 offset:24576
    ds_read_b128 v[68:71], v12 offset:25600
    s_add_u32 s45, s29, 8192
    s_add_u32 s46, s29, 12288
    s_add_u32 s47, s29, 16384
    buffer_load_dwordx4 v[144:147], v1, s[4:7], s45 offen offset:0 sc1
    buffer_load_dwordx4 v[148:151], v1, s[4:7], s45 offen offset:1024 sc1
    s_lshl_b32 s42, s23, 3
    s_add_u32 s42, s42, s24
    s_lshl_b32 s42, s42, 2
    s_add_u32 s42, s42, s20
    s_lshl_b32 s42, s42, 8
    s_add_u32 s42, s42, s21
    s_add_u32 s42, s42, 0x1b40000
    v_mov_b32 v220, -1.0
    v_lshrrev_b32 v221, 2, v1
    buffer_store_dword v220, v221, s[4:7], s42 offen sc1
    s_lshl_b32 s50, s22, 7
    s_add_u32 s50, s50, s44
    s_lshl_b32 s50, s50, 8
    s_add_u32 s50, s50, 0x4509000
    s_add_u32 s50, s50, s4
    s_addc_u32 s51, s5, 0
    s_waitcnt vmcnt(11)
    v_lshlrev_b32 v16, 16, v208
    v_and_b32 v17, 0xffff0000, v208
    v_lshlrev_b32 v18, 16, v209
    v_and_b32 v19, 0xffff0000, v209
    v_lshlrev_b32 v20, 16, v210
    v_and_b32 v21, 0xffff0000, v210
    v_lshlrev_b32 v22, 16, v211
    v_and_b32 v23, 0xffff0000, v211
    v_lshlrev_b32 v24, 16, v212
    v_and_b32 v25, 0xffff0000, v212
    v_lshlrev_b32 v26, 16, v213
    v_and_b32 v27, 0xffff0000, v213
    v_lshlrev_b32 v28, 16, v214
    v_and_b32 v29, 0xffff0000, v214
    v_lshlrev_b32 v30, 16, v215
    v_and_b32 v31, 0xffff0000, v215
    v_lshlrev_b32 v32, 16, v216
    v_and_b32 v33, 0xffff0000, v216
    v_lshlrev_b32 v34, 16, v217
    v_and_b32 v35, 0xffff0000, v217
    s_waitcnt vmcnt(9) lgkmcnt(4)
    v_mfma_f32_16x16x32_bf16 v[16:19], v[40:43], v[112:115], v[16:19]
    ds_read_b128 v[76:79], v12 offset:27648
    v_mfma_f32_16x16x32_bf16 v[20:23], v[44:47], v[112:115], v[20:23]
    ds_read_b128 v[80:83], v12 offset:28672
    buffer_load_dwordx4 v[152:155], v1, s[4:7], s45 offen offset:2048 sc1
    v_mfma_f32_16x16x32_bf16 v[24:27], v[48:51], v[112:115], v[24:27]
    ds_read_b128 v[84:87], v12 offset:29696
    v_mfma_f32_16x16x32_bf16 v[28:31], v[52:55], v[112:115], v[28:31]
    ds_read_b128 v[88:91], v12 offset:30720
    v_mfma_f32_16x16x32_bf16 v[32:35], v[72:75], v[112:115], v[32:35]
    ds_read_b128 v[108:111], v12 offset:35840
    s_waitcnt lgkmcnt(5)
    buffer_load_dwordx4 v[156:159], v1, s[4:7], s45 offen offset:3072 sc1
    v_mfma_f32_16x16x32_bf16 v[16:19], v[56:59], v[116:119], v[16:19]
    ds_read_b128 v[92:95], v12 offset:31744
    v_mfma_f32_16x16x32_bf16 v[20:23], v[60:63], v[116:119], v[20:23]
    ds_read_b128 v[96:99], v12 offset:32768
    v_mfma_f32_16x16x32_bf16 v[24:27], v[64:67], v[116:119], v[24:27]
    ds_read_b128 v[100:103], v12 offset:33792
    buffer_load_dwordx4 v[160:163], v1, s[4:7], s46 offen offset:0 sc1
    v_mfma_f32_16x16x32_bf16 v[28:31], v[68:71], v[116:119], v[28:31]
    ds_read_b128 v[104:107], v12 offset:34816
    v_mfma_f32_16x16x32_bf16 v[36:39], v[72:75], v[116:119], 0
    s_waitcnt vmcnt(10) lgkmcnt(4)
    v_mfma_f32_16x16x32_bf16 v[16:19], v[76:79], v[120:123], v[16:19]
    ds_read_b128 v[40:43], v13 offset:18432
    v_mfma_f32_16x16x32_bf16 v[20:23], v[80:83], v[120:123], v[20:23]
    ds_read_b128 v[44:47], v13 offset:19456
    buffer_load_dwordx4 v[164:167], v1, s[4:7], s46 offen offset:1024 sc1
    v_mfma_f32_16x16x32_bf16 v[24:27], v[84:87], v[120:123], v[24:27]
    ds_read_b128 v[48:51], v13 offset:20480
    v_mfma_f32_16x16x32_bf16 v[28:31], v[88:91], v[120:123], v[28:31]
    ds_read_b128 v[52:55], v13 offset:21504
    v_mfma_f32_16x16x32_bf16 v[32:35], v[108:111], v[120:123], v[32:35]
    ds_read_b128 v[72:75], v13 offset:26624
    s_waitcnt lgkmcnt(5)
    buffer_load_dwordx4 v[168:171], v1, s[4:7], s46 offen offset:2048 sc1
    v_mfma_f32_16x16x32_bf16 v[16:19], v[92:95], v[124:127], v[16:19]
    ds_read_b128 v[56:59], v13 offset:22528
    v_mfma_f32_16x16x32_bf16 v[20:23], v[96:99], v[124:127], v[20:23]
    ds_read_b128 v[60:63], v13 offset:23552
    v_mfma_f32_16x16x32_bf16 v[24:27], v[100:103], v[124:127], v[24:27]
    ds_read_b128 v[64:67], v13 offset:24576
    buffer_load_dwordx4 v[172:175], v1, s[4:7], s46 offen offset:3072 sc1
    v_mfma_f32_16x16x32_bf16 v[28:31], v[104:107], v[124:127], v[28:31]
    ds_read_b128 v[68:71], v13 offset:25600
    v_mfma_f32_16x16x32_bf16 v[36:39], v[108:111], v[124:127], v[36:39]
    s_waitcnt vmcnt(11) lgkmcnt(4)
    v_mfma_f32_16x16x32_bf16 v[16:19], v[40:43], v[128:131], v[16:19]
    ds_read_b128 v[76:79], v13 offset:27648
    v_mfma_f32_16x16x32_bf16 v[20:23], v[44:47], v[128:131], v[20:23]
    ds_read_b128 v[80:83], v13 offset:28672
    buffer_load_dwordx2 v[176:177], v7, s[4:7], s47 offen offset:0 sc1
    v_mfma_f32_16x16x32_bf16 v[24:27], v[48:51], v[128:131], v[24:27]
    ds_read_b128 v[84:87], v13 offset:29696
    v_mfma_f32_16x16x32_bf16 v[28:31], v[52:55], v[128:131], v[28:31]
    ds_read_b128 v[88:91], v13 offset:30720
    v_mfma_f32_16x16x32_bf16 v[32:35], v[72:75], v[128:131], v[32:35]
    ds_read_b128 v[108:111], v13 offset:35840
    s_waitcnt lgkmcnt(5)
    buffer_load_dwordx2 v[178:179], v7, s[4:7], s47 offen offset:128 sc1
    v_mfma_f32_16x16x32_bf16 v[16:19], v[56:59], v[132:135], v[16:19]
    ds_read_b128 v[92:95], v13 offset:31744
    v_mfma_f32_16x16x32_bf16 v[20:23], v[60:63], v[132:135], v[20:23]
    ds_read_b128 v[96:99], v13 offset:32768
    v_mfma_f32_16x16x32_bf16 v[24:27], v[64:67], v[132:135], v[24:27]
    ds_read_b128 v[100:103], v13 offset:33792
    buffer_load_dwordx2 v[180:181], v7, s[4:7], s47 offen offset:1024 sc1
    v_mfma_f32_16x16x32_bf16 v[28:31], v[68:71], v[132:135], v[28:31]
    ds_read_b128 v[104:107], v13 offset:34816
    v_mfma_f32_16x16x32_bf16 v[36:39], v[72:75], v[132:135], v[36:39]
    s_waitcnt vmcnt(12) lgkmcnt(4)
    v_mfma_f32_16x16x32_bf16 v[16:19], v[76:79], v[136:139], v[16:19]
    ds_read_b128 v[40:43], v14 offset:18432
    v_mfma_f32_16x16x32_bf16 v[20:23], v[80:83], v[136:139], v[20:23]
    ds_read_b128 v[44:47], v14 offset:19456
    buffer_load_dwordx2 v[182:183], v7, s[4:7], s47 offen offset:1152 sc1
    v_mfma_f32_16x16x32_bf16 v[24:27], v[84:87], v[136:139], v[24:27]
    ds_read_b128 v[48:51], v14 offset:20480
    v_mfma_f32_16x16x32_bf16 v[28:31], v[88:91], v[136:139], v[28:31]
    ds_read_b128 v[52:55], v14 offset:21504
    v_mfma_f32_16x16x32_bf16 v[32:35], v[108:111], v[136:139], v[32:35]
    ds_read_b128 v[72:75], v14 offset:26624
    s_waitcnt lgkmcnt(5)
    v_mfma_f32_16x16x32_bf16 v[16:19], v[92:95], v[140:143], v[16:19]
    ds_read_b128 v[56:59], v14 offset:22528
    v_mfma_f32_16x16x32_bf16 v[20:23], v[96:99], v[140:143], v[20:23]
    ds_read_b128 v[60:63], v14 offset:23552
    v_mfma_f32_16x16x32_bf16 v[24:27], v[100:103], v[140:143], v[24:27]
    ds_read_b128 v[64:67], v14 offset:24576
    v_mfma_f32_16x16x32_bf16 v[28:31], v[104:107], v[140:143], v[28:31]
    ds_read_b128 v[68:71], v14 offset:25600
    v_mfma_f32_16x16x32_bf16 v[36:39], v[108:111], v[140:143], v[36:39]
    s_waitcnt vmcnt(11) lgkmcnt(4)
    v_mfma_f32_16x16x32_bf16 v[16:19], v[40:43], v[144:147], v[16:19]
    ds_read_b128 v[76:79], v14 offset:27648
    v_mfma_f32_16x16x32_bf16 v[20:23], v[44:47], v[144:147], v[20:23]
    ds_read_b128 v[80:83], v14 offset:28672
    v_mfma_f32_16x16x32_bf16 v[24:27], v[48:51], v[144:147], v[24:27]
    ds_read_b128 v[84:87], v14 offset:29696
    v_mfma_f32_16x16x32_bf16 v[28:31], v[52:55], v[144:147], v[28:31]
    ds_read_b128 v[88:91], v14 offset:30720
    v_mfma_f32_16x16x32_bf16 v[32:35], v[72:75], v[144:147], v[32:35]
    ds_read_b128 v[108:111], v14 offset:35840
    s_waitcnt lgkmcnt(5)
    v_mfma_f32_16x16x32_bf16 v[16:19], v[56:59], v[148:151], v[16:19]
    ds_read_b128 v[92:95], v14 offset:31744
    v_mfma_f32_16x16x32_bf16 v[20:23], v[60:63], v[148:151], v[20:23]
    ds_read_b128 v[96:99], v14 offset:32768
    v_mfma_f32_16x16x32_bf16 v[24:27], v[64:67], v[148:151], v[24:27]
    ds_read_b128 v[100:103], v14 offset:33792
    v_mfma_f32_16x16x32_bf16 v[28:31], v[68:71], v[148:151], v[28:31]
    ds_read_b128 v[104:107], v14 offset:34816
    v_mfma_f32_16x16x32_bf16 v[36:39], v[72:75], v[148:151], v[36:39]
    s_waitcnt vmcnt(8) lgkmcnt(4)
    v_mfma_f32_16x16x32_bf16 v[16:19], v[76:79], v[152:155], v[16:19]
    ds_read_b128 v[40:43], v15 offset:18432
    v_mfma_f32_16x16x32_bf16 v[20:23], v[80:83], v[152:155], v[20:23]
    ds_read_b128 v[44:47], v15 offset:19456
    v_mfma_f32_16x16x32_bf16 v[24:27], v[84:87], v[152:155], v[24:27]
    ds_read_b128 v[48:51], v15 offset:20480
    v_mfma_f32_16x16x32_bf16 v[28:31], v[88:91], v[152:155], v[28:31]
    ds_read_b128 v[52:55], v15 offset:21504
    v_mfma_f32_16x16x32_bf16 v[32:35], v[108:111], v[152:155], v[32:35]
    ds_read_b128 v[72:75], v15 offset:26624
    s_waitcnt lgkmcnt(5)
    v_mfma_f32_16x16x32_bf16 v[16:19], v[92:95], v[156:159], v[16:19]
    ds_read_b128 v[56:59], v15 offset:22528
    v_mfma_f32_16x16x32_bf16 v[20:23], v[96:99], v[156:159], v[20:23]
    ds_read_b128 v[60:63], v15 offset:23552
    v_mfma_f32_16x16x32_bf16 v[24:27], v[100:103], v[156:159], v[24:27]
    ds_read_b128 v[64:67], v15 offset:24576
    v_mfma_f32_16x16x32_bf16 v[28:31], v[104:107], v[156:159], v[28:31]
    ds_read_b128 v[68:71], v15 offset:25600
    v_mfma_f32_16x16x32_bf16 v[36:39], v[108:111], v[156:159], v[36:39]
    s_waitcnt vmcnt(6) lgkmcnt(4)
    v_mfma_f32_16x16x32_bf16 v[16:19], v[40:43], v[160:163], v[16:19]
    ds_read_b128 v[76:79], v15 offset:27648
    v_mfma_f32_16x16x32_bf16 v[20:23], v[44:47], v[160:163], v[20:23]
    ds_read_b128 v[80:83], v15 offset:28672
    v_mfma_f32_16x16x32_bf16 v[24:27], v[48:51], v[160:163], v[24:27]
    ds_read_b128 v[84:87], v15 offset:29696
    v_mfma_f32_16x16x32_bf16 v[28:31], v[52:55], v[160:163], v[28:31]
    ds_read_b128 v[88:91], v15 offset:30720
    v_mfma_f32_16x16x32_bf16 v[32:35], v[72:75], v[160:163], v[32:35]
    ds_read_b128 v[108:111], v15 offset:35840
    s_waitcnt lgkmcnt(5)
    v_mfma_f32_16x16x32_bf16 v[16:19], v[56:59], v[164:167], v[16:19]
    ds_read_b128 v[92:95], v15 offset:31744
    v_mfma_f32_16x16x32_bf16 v[20:23], v[60:63], v[164:167], v[20:23]
    ds_read_b128 v[96:99], v15 offset:32768
    v_mfma_f32_16x16x32_bf16 v[24:27], v[64:67], v[164:167], v[24:27]
    ds_read_b128 v[100:103], v15 offset:33792
    v_mfma_f32_16x16x32_bf16 v[28:31], v[68:71], v[164:167], v[28:31]
    ds_read_b128 v[104:107], v15 offset:34816
    v_mfma_f32_16x16x32_bf16 v[36:39], v[72:75], v[164:167], v[36:39]
    s_waitcnt vmcnt(4) lgkmcnt(4)
    v_mfma_f32_16x16x32_bf16 v[16:19], v[76:79], v[168:171], v[16:19]
    ds_read_b128 v[40:43], v15 offset:36864
    v_mfma_f32_16x16x32_bf16 v[20:23], v[80:83], v[168:171], v[20:23]
    ds_read_b128 v[44:47], v15 offset:37888
    v_mfma_f32_16x16x32_bf16 v[24:27], v[84:87], v[168:171], v[24:27]
    ds_read_b128 v[48:51], v15 offset:38912
    v_mfma_f32_16x16x32_bf16 v[28:31], v[88:91], v[168:171], v[28:31]
    ds_read_b128 v[52:55], v15 offset:39936
    v_mfma_f32_16x16x32_bf16 v[32:35], v[108:111], v[168:171], v[32:35]
    ds_read_b128 v[72:75], v15 offset:45056
    s_waitcnt lgkmcnt(5)
    v_mfma_f32_16x16x32_bf16 v[16:19], v[92:95], v[172:175], v[16:19]
    ds_read_b128 v[56:59], v15 offset:40960
    v_mfma_f32_16x16x32_bf16 v[20:23], v[96:99], v[172:175], v[20:23]
    ds_read_b128 v[60:63], v15 offset:41984
    v_mfma_f32_16x16x32_bf16 v[24:27], v[100:103], v[172:175], v[24:27]
    ds_read_b128 v[64:67], v15 offset:43008
    v_mfma_f32_16x16x32_bf16 v[28:31], v[104:107], v[172:175], v[28:31]
    ds_read_b128 v[68:71], v15 offset:44032
    v_mfma_f32_16x16x32_bf16 v[36:39], v[108:111], v[172:175], v[36:39]
    s_waitcnt vmcnt(0) lgkmcnt(4)
    v_mfma_f32_16x16x32_bf16 v[16:19], v[40:43], v[176:179], v[16:19]
    v_mfma_f32_16x16x32_bf16 v[20:23], v[44:47], v[176:179], v[20:23]
    v_mfma_f32_16x16x32_bf16 v[24:27], v[48:51], v[176:179], v[24:27]
    v_mfma_f32_16x16x32_bf16 v[28:31], v[52:55], v[176:179], v[28:31]
    v_mfma_f32_16x16x32_bf16 v[32:35], v[72:75], v[176:179], v[32:35]
    s_waitcnt lgkmcnt(0)
    v_mfma_f32_16x16x32_bf16 v[16:19], v[56:59], v[180:183], v[16:19]
    v_mfma_f32_16x16x32_bf16 v[20:23], v[60:63], v[180:183], v[20:23]
    v_mfma_f32_16x16x32_bf16 v[24:27], v[64:67], v[180:183], v[24:27]
    v_mfma_f32_16x16x32_bf16 v[28:31], v[68:71], v[180:183], v[28:31]
    v_mfma_f32_16x16x32_bf16 v[36:39], v[72:75], v[180:183], v[36:39]
    s_nop 3
    v_cvt_pk_bf16_f32 v208, v16, v17
    v_cvt_pk_bf16_f32 v209, v18, v19
    v_cvt_pk_bf16_f32 v210, v20, v21
    v_cvt_pk_bf16_f32 v211, v22, v23
    v_cvt_pk_bf16_f32 v212, v24, v25
    v_cvt_pk_bf16_f32 v213, v26, v27
    v_cvt_pk_bf16_f32 v214, v28, v29
    v_cvt_pk_bf16_f32 v215, v30, v31
    buffer_store_dwordx4 v[208:211], v4, s[4:7], s34 offen offset:0 sc1
    buffer_store_dwordx4 v[212:215], v4, s[4:7], s34 offen offset:1024 sc1
    v_permlane32_swap_b32 v36, v220
    v_permlane32_swap_b32 v37, v221
    v_permlane32_swap_b32 v38, v222
    v_permlane32_swap_b32 v39, v223
    v_pk_add_f32 v[32:33], v[32:33], v[220:221]
    v_pk_add_f32 v[34:35], v[34:35], v[222:223]
    v_cvt_pk_bf16_f32 v216, v32, v33
    v_cvt_pk_bf16_f32 v217, v34, v35
    buffer_store_dwordx2 v[216:217], v5, s[4:7], s34 offen sc1
    v_cndmask_b32 v222, 0, v216, s[40:41]
    v_cndmask_b32 v223, 0, v217, s[40:41]
    v_dot2_f32_bf16 v220, v208, v11, 0
    v_dot2_f32_bf16 v221, v208, v208, 0
    v_dot2_f32_bf16 v224, v209, v11, 0
    v_dot2_f32_bf16 v225, v209, v209, 0
    v_dot2_f32_bf16 v220, v210, v11, v220
    v_dot2_f32_bf16 v221, v210, v210, v221
    v_dot2_f32_bf16 v224, v211, v11, v224
    v_dot2_f32_bf16 v225, v211, v211, v225
    v_dot2_f32_bf16 v220, v212, v11, v220
    v_dot2_f32_bf16 v221, v212, v212, v221
    v_dot2_f32_bf16 v224, v213, v11, v224
    v_dot2_f32_bf16 v225, v213, v213, v225
    v_dot2_f32_bf16 v220, v214, v11, v220
    v_dot2_f32_bf16 v221, v214, v214, v221
    v_dot2_f32_bf16 v224, v215, v11, v224
    v_dot2_f32_bf16 v225, v215, v215, v225
    v_dot2_f32_bf16 v220, v222, v11, v220
    v_dot2_f32_bf16 v221, v222, v222, v221
    v_dot2_f32_bf16 v224, v223, v11, v224
    v_dot2_f32_bf16 v225, v223, v223, v225
    s_nop 2
    v_pk_add_f32 v[220:221], v[220:221], v[224:225]
    v_mov_b32 v222, v220
    v_mov_b32 v223, v221
    s_nop 1
    v_permlane32_swap_b32 v220, v222
    v_permlane32_swap_b32 v221, v223
    v_add_f32 v220, v220, v222
    v_add_f32 v221, v221, v223
    v_mov_b32 v222, v220
    v_mov_b32 v223, v221
    s_nop 1
    v_permlane16_swap_b32 v220, v222
    v_permlane16_swap_b32 v221, v223
    v_add_f32 v220, v220, v222
    v_add_f32 v221, v221, v223
    buffer_store_dwordx2 v[220:221], v10, s[4:7], s39 offen sc1
    s_and_b32 s25, s2, 7
    s_lshr_b32 s26, s2, 3
    s_and_b32 s23, s25, 1
    s_lshl_b32 s23, s23, 3
    s_and_b32 s27, s26, 7
    s_add_u32 s23, s23, s27
    s_lshr_b32 s24, s25, 1
    s_lshl_b32 s24, s24, 2
    s_lshr_b32 s27, s26, 3
    s_add_u32 s24, s24, s27
    s_add_u32 s28, s23, s24
    s_and_b32 s28, s28, 3
    s_lshl_b32 s30, s20, 12
    s_lshl_b32 s31, s23, 3
    s_lshl_b32 s33, s20, 1
    s_add_u32 s31, s31, s33
    s_lshl_b32 s32, s31, 10
    s_add_u32 s32, s32, s21
    s_add_u32 s32, s32, 0x1b20000
    v_add_u32 v2, 73728, v1
    s_add_u32 s33, s30, 18432
    v_add_u32 v3, s33, v1
    v_add_u32 v0, s33, v2
    s_lshr_b32 s34, s31, 1
    s_lshl_b32 s35, s34, 12
    s_add_u32 s35, s35, s21
    s_add_u32 s35, s35, 0x1b40000
    s_lshl_b32 s36, s24, 8
    s_add_u32 s36, s36, s35
    s_lshl_b32 s38, s24, 6
    s_add_u32 s38, s38, s34
    s_mul_i32 s38, s38, 9216
    s_add_u32 s38, s38, s21
    s_add_u32 s38, s38, 0x900000
    s_add_u32 s39, s38, 4096
    s_add_u32 s46, s38, 8192
    s_mov_b32 s40, 0xc0135761
    s_mov_b32 s42, 0x3d372713
    s_mov_b32 s44, 0x39e38e39
    s_mov_b32 s45, 0x3727c5ac
    v_lshrrev_b32 v4, 1, v1
    s_lshl_b32 s52, s22, 7
    s_add_u32 s52, s52, s23
    s_lshl_b32 s52, s52, 8
    s_add_u32 s52, s52, 0x4509000
    s_add_u32 s52, s52, s4
    s_addc_u32 s53, s5, 0
    s_waitcnt vmcnt(0)
    s_barrier
    s_cmp_lg_u32 s20, 0
    s_cbranch_scc1 L_ns_d3
    s_mov_b32 s56, 1
    s_atomic_add s56, s[50:51], 0
L_ns_d3:
    s_cmp_lg_u32 s20, 0
    s_cbranch_scc1 L_pd_d3
    s_mov_b32 s60, 65536
L_poll_d3:
    s_mov_b32 s57, 0
    s_atomic_add s57, s[52:53], 0 glc
    s_waitcnt lgkmcnt(0)
    s_cmp_ge_u32 s57, 16
    s_cbranch_scc1 L_pd_d3
    s_sub_u32 s60, s60, 1
    s_cbranch_scc1 L_pd_d3
    s_sleep 2
    s_branch L_poll_d3
L_pd_d3:
    s_barrier
    buffer_load_dwordx2 v[8:9], v4, s[4:7], s32 offen offset:0 sc1
    buffer_load_dwordx2 v[10:11], v4, s[4:7], s32 offen offset:512 sc1
    buffer_load_dwordx2 v[12:13], v4, s[4:7], s32 offen offset:1024 sc1
    buffer_load_dwordx2 v[14:15], v4, s[4:7], s32 offen offset:1536 sc1
    s_lshl_b32 s50, s22, 7
    s_add_u32 s50, s50, s23
    s_lshl_b32 s50, s50, 8
    s_add_u32 s50, s50, 0x450a000
    s_add_u32 s50, s50, s4
    s_addc_u32 s51, s5, 0
    s_barrier
    ds_read_b128 v[160:163], v3 offset:0
    ds_read_b128 v[164:167], v3 offset:2048
    ds_read_b128 v[168:171], v1 offset:0
    ds_read_b128 v[172:175], v1 offset:1024
    ds_read_b128 v[176:179], v1 offset:2048
    ds_read_b128 v[180:183], v1 offset:3072
    ds_read_b128 v[184:187], v1 offset:4096
    ds_read_b128 v[188:191], v1 offset:5120
    ds_read_b128 v[192:195], v1 offset:6144
    ds_read_b128 v[196:199], v1 offset:7168
    ds_read_b128 v[200:203], v1 offset:8192
    s_waitcnt lgkmcnt(5)
    v_mfma_f32_16x16x32_bf16 v[16:19], v[160:163], v[168:171], 0
    ds_read_b128 v[204:207], v3 offset:1024
    v_mfma_f32_16x16x32_bf16 v[20:23], v[164:167], v[168:171], 0
    ds_read_b128 v[208:211], v3 offset:3072
    v_mfma_f32_16x16x32_bf16 v[24:27], v[160:163], v[172:175], 0
    ds_read_b128 v[212:215], v1 offset:9216
    v_mfma_f32_16x16x32_bf16 v[28:31], v[164:167], v[172:175], 0
    ds_read_b128 v[216:219], v1 offset:10240
    v_mfma_f32_16x16x32_bf16 v[32:35], v[160:163], v[176:179], 0
    ds_read_b128 v[220:223], v1 offset:11264
    v_mfma_f32_16x16x32_bf16 v[36:39], v[164:167], v[176:179], 0
    ds_read_b128 v[224:227], v1 offset:12288
    v_mfma_f32_16x16x32_bf16 v[40:43], v[160:163], v[180:183], 0
    ds_read_b128 v[228:231], v1 offset:13312
    v_mfma_f32_16x16x32_bf16 v[44:47], v[164:167], v[180:183], 0
    ds_read_b128 v[232:235], v1 offset:14336
    s_waitcnt lgkmcnt(8)
    v_mfma_f32_16x16x32_bf16 v[48:51], v[160:163], v[184:187], 0
    ds_read_b128 v[236:239], v1 offset:15360
    v_mfma_f32_16x16x32_bf16 v[52:55], v[164:167], v[184:187], 0
    ds_read_b128 v[240:243], v1 offset:16384
    v_mfma_f32_16x16x32_bf16 v[56:59], v[160:163], v[188:191], 0
    ds_read_b128 v[244:247], v1 offset:17408
    v_mfma_f32_16x16x32_bf16 v[60:63], v[164:167], v[188:191], 0
    v_mfma_f32_16x16x32_bf16 v[64:67], v[160:163], v[192:195], 0
    v_mfma_f32_16x16x32_bf16 v[68:71], v[164:167], v[192:195], 0
    v_mfma_f32_16x16x32_bf16 v[72:75], v[160:163], v[196:199], 0
    v_mfma_f32_16x16x32_bf16 v[76:79], v[164:167], v[196:199], 0
    v_mfma_f32_16x16x32_bf16 v[80:83], v[160:163], v[200:203], 0
    v_mfma_f32_16x16x32_bf16 v[84:87], v[164:167], v[200:203], 0
    s_waitcnt lgkmcnt(0)
    s_barrier
    v_mfma_f32_16x16x32_bf16 v[16:19], v[204:207], v[212:215], v[16:19]
    ds_read_b128 v[160:163], v3 offset:36864
    v_mfma_f32_16x16x32_bf16 v[20:23], v[208:211], v[212:215], v[20:23]
    ds_read_b128 v[164:167], v3 offset:38912
    v_mfma_f32_16x16x32_bf16 v[24:27], v[204:207], v[216:219], v[24:27]
    ds_read_b128 v[168:171], v1 offset:36864
    v_mfma_f32_16x16x32_bf16 v[28:31], v[208:211], v[216:219], v[28:31]
    ds_read_b128 v[172:175], v1 offset:37888
    v_mfma_f32_16x16x32_bf16 v[32:35], v[204:207], v[220:223], v[32:35]
    ds_read_b128 v[176:179], v1 offset:38912
    v_mfma_f32_16x16x32_bf16 v[36:39], v[208:211], v[220:223], v[36:39]
    ds_read_b128 v[180:183], v1 offset:39936
    v_mfma_f32_16x16x32_bf16 v[40:43], v[204:207], v[224:227], v[40:43]
    ds_read_b128 v[184:187], v1 offset:40960
    v_mfma_f32_16x16x32_bf16 v[44:47], v[208:211], v[224:227], v[44:47]
    ds_read_b128 v[188:191], v1 offset:41984
    v_mfma_f32_16x16x32_bf16 v[48:51], v[204:207], v[228:231], v[48:51]
    ds_read_b128 v[192:195], v1 offset:43008
    v_mfma_f32_16x16x32_bf16 v[52:55], v[208:211], v[228:231], v[52:55]
    ds_read_b128 v[196:199], v1 offset:44032
    v_lshrrev_b32 v5, 8, v1
    v_mfma_f32_16x16x32_bf16 v[56:59], v[204:207], v[232:235], v[56:59]
    ds_read_b128 v[200:203], v1 offset:45056
    v_bfe_u32 v6, v1, 4, 4
    v_mfma_f32_16x16x32_bf16 v[60:63], v[208:211], v[232:235], v[60:63]
    v_lshlrev_b32 v7, 2, v6
    v_mfma_f32_16x16x32_bf16 v[64:67], v[204:207], v[236:239], v[64:67]
    s_lshl_b32 s33, s20, 8
    v_mfma_f32_16x16x32_bf16 v[68:71], v[208:211], v[236:239], v[68:71]
    s_add_u32 s33, s33, 147456
    v_mfma_f32_16x16x32_bf16 v[72:75], v[204:207], v[240:243], v[72:75]
    v_add_u32 v4, s33, v7
    v_mfma_f32_16x16x32_bf16 v[76:79], v[208:211], v[240:243], v[76:79]
    v_lshl_add_u32 v252, v5, 4, s33
    v_mfma_f32_16x16x32_bf16 v[80:83], v[204:207], v[244:247], v[80:83]
    v_add_u32 v7, 159744, v7
    v_mfma_f32_16x16x32_bf16 v[84:87], v[208:211], v[244:247], v[84:87]
    s_waitcnt vmcnt(0)
    v_add_f32 v248, v8, v10
    s_waitcnt lgkmcnt(5)
    v_mfma_f32_16x16x32_bf16 v[16:19], v[160:163], v[168:171], v[16:19]
    ds_read_b128 v[204:207], v3 offset:37888
    v_mfma_f32_16x16x32_bf16 v[20:23], v[164:167], v[168:171], v[20:23]
    ds_read_b128 v[208:211], v3 offset:39936
    v_mfma_f32_16x16x32_bf16 v[24:27], v[160:163], v[172:175], v[24:27]
    ds_read_b128 v[212:215], v1 offset:46080
    v_mfma_f32_16x16x32_bf16 v[28:31], v[164:167], v[172:175], v[28:31]
    ds_read_b128 v[216:219], v1 offset:47104
    v_mfma_f32_16x16x32_bf16 v[32:35], v[160:163], v[176:179], v[32:35]
    ds_read_b128 v[220:223], v1 offset:48128
    v_mfma_f32_16x16x32_bf16 v[36:39], v[164:167], v[176:179], v[36:39]
    ds_read_b128 v[224:227], v1 offset:49152
    v_mfma_f32_16x16x32_bf16 v[40:43], v[160:163], v[180:183], v[40:43]
    ds_read_b128 v[228:231], v1 offset:50176
    v_mfma_f32_16x16x32_bf16 v[44:47], v[164:167], v[180:183], v[44:47]
    ds_read_b128 v[232:235], v1 offset:51200
    s_waitcnt lgkmcnt(8)
    v_mfma_f32_16x16x32_bf16 v[48:51], v[160:163], v[184:187], v[48:51]
    ds_read_b128 v[236:239], v1 offset:52224
    v_mfma_f32_16x16x32_bf16 v[52:55], v[164:167], v[184:187], v[52:55]
    ds_read_b128 v[240:243], v1 offset:53248
    v_add_f32 v249, v9, v11
    v_mfma_f32_16x16x32_bf16 v[56:59], v[160:163], v[188:191], v[56:59]
    ds_read_b128 v[244:247], v1 offset:54272
    v_add_f32 v250, v12, v14
    v_mfma_f32_16x16x32_bf16 v[60:63], v[164:167], v[188:191], v[60:63]
    v_add_f32 v251, v13, v15
    v_mfma_f32_16x16x32_bf16 v[64:67], v[160:163], v[192:195], v[64:67]
    v_mov_b32 v8, v248
    v_mfma_f32_16x16x32_bf16 v[68:71], v[164:167], v[192:195], v[68:71]
    v_mov_b32 v9, v249
    v_mfma_f32_16x16x32_bf16 v[72:75], v[160:163], v[196:199], v[72:75]
    v_mov_b32 v12, v250
    v_mfma_f32_16x16x32_bf16 v[76:79], v[164:167], v[196:199], v[76:79]
    v_mov_b32 v13, v251
    v_mfma_f32_16x16x32_bf16 v[80:83], v[160:163], v[200:203], v[80:83]
    v_permlane32_swap_b32 v248, v8
    v_mfma_f32_16x16x32_bf16 v[84:87], v[164:167], v[200:203], v[84:87]
    v_permlane32_swap_b32 v249, v9
    v_permlane32_swap_b32 v250, v12
    s_waitcnt lgkmcnt(0)
    s_barrier
    v_mfma_f32_16x16x32_bf16 v[16:19], v[204:207], v[212:215], v[16:19]
    ds_read_b128 v[160:163], v0 offset:0
    v_mfma_f32_16x16x32_bf16 v[20:23], v[208:211], v[212:215], v[20:23]
    ds_read_b128 v[164:167], v0 offset:2048
    v_mfma_f32_16x16x32_bf16 v[24:27], v[204:207], v[216:219], v[24:27]
    ds_read_b128 v[168:171], v2 offset:0
    v_mfma_f32_16x16x32_bf16 v[28:31], v[208:211], v[216:219], v[28:31]
    ds_read_b128 v[172:175], v2 offset:1024
    v_mfma_f32_16x16x32_bf16 v[32:35], v[204:207], v[220:223], v[32:35]
    ds_read_b128 v[176:179], v2 offset:2048
    v_mfma_f32_16x16x32_bf16 v[36:39], v[208:211], v[220:223], v[36:39]
    ds_read_b128 v[180:183], v2 offset:3072
    v_mfma_f32_16x16x32_bf16 v[40:43], v[204:207], v[224:227], v[40:43]
    ds_read_b128 v[184:187], v2 offset:4096
    v_mfma_f32_16x16x32_bf16 v[44:47], v[208:211], v[224:227], v[44:47]
    ds_read_b128 v[188:191], v2 offset:5120
    v_mfma_f32_16x16x32_bf16 v[48:51], v[204:207], v[228:231], v[48:51]
    ds_read_b128 v[192:195], v2 offset:6144
    v_mfma_f32_16x16x32_bf16 v[52:55], v[208:211], v[228:231], v[52:55]
    ds_read_b128 v[196:199], v2 offset:7168
    v_permlane32_swap_b32 v251, v13
    v_mfma_f32_16x16x32_bf16 v[56:59], v[204:207], v[232:235], v[56:59]
    ds_read_b128 v[200:203], v2 offset:8192
    v_add_f32 v248, v248, v8
    v_mfma_f32_16x16x32_bf16 v[60:63], v[208:211], v[232:235], v[60:63]
    ds_read2_b32 v[128:129], v7 offset0:0 offset1:16
    v_add_f32 v249, v249, v9
    v_mfma_f32_16x16x32_bf16 v[64:67], v[204:207], v[236:239], v[64:67]
    ds_read2_b32 v[130:131], v7 offset0:32 offset1:48
    v_add_f32 v250, v250, v12
    v_mfma_f32_16x16x32_bf16 v[68:71], v[208:211], v[236:239], v[68:71]
    ds_read2_b32 v[132:133], v7 offset0:64 offset1:80
    v_add_f32 v251, v251, v13
    v_mfma_f32_16x16x32_bf16 v[72:75], v[204:207], v[240:243], v[72:75]
    ds_read2_b32 v[134:135], v7 offset0:96 offset1:112
    v_mov_b32 v8, v248
    v_mfma_f32_16x16x32_bf16 v[76:79], v[208:211], v[240:243], v[76:79]
    ds_read2_b32 v[136:137], v7 offset0:128 offset1:144
    v_mov_b32 v9, v249
    v_mfma_f32_16x16x32_bf16 v[80:83], v[204:207], v[244:247], v[80:83]
    v_mov_b32 v12, v250
    v_mfma_f32_16x16x32_bf16 v[84:87], v[208:211], v[244:247], v[84:87]
    v_mov_b32 v13, v251
    v_permlane16_swap_b32 v248, v8
    s_waitcnt lgkmcnt(10)
    v_mfma_f32_16x16x32_bf16 v[16:19], v[160:163], v[168:171], v[16:19]
    ds_read_b128 v[204:207], v0 offset:1024
    v_mfma_f32_16x16x32_bf16 v[20:23], v[164:167], v[168:171], v[20:23]
    ds_read_b128 v[208:211], v0 offset:3072
    v_mfma_f32_16x16x32_bf16 v[24:27], v[160:163], v[172:175], v[24:27]
    ds_read_b128 v[212:215], v2 offset:9216
    v_mfma_f32_16x16x32_bf16 v[28:31], v[164:167], v[172:175], v[28:31]
    ds_read_b128 v[216:219], v2 offset:10240
    v_mfma_f32_16x16x32_bf16 v[32:35], v[160:163], v[176:179], v[32:35]
    ds_read_b128 v[220:223], v2 offset:11264
    v_mfma_f32_16x16x32_bf16 v[36:39], v[164:167], v[176:179], v[36:39]
    ds_read_b128 v[224:227], v2 offset:12288
    v_mfma_f32_16x16x32_bf16 v[40:43], v[160:163], v[180:183], v[40:43]
    ds_read_b128 v[228:231], v2 offset:13312
    v_mfma_f32_16x16x32_bf16 v[44:47], v[164:167], v[180:183], v[44:47]
    ds_read_b128 v[232:235], v2 offset:14336
    s_waitcnt lgkmcnt(8)
    v_mfma_f32_16x16x32_bf16 v[48:51], v[160:163], v[184:187], v[48:51]
    ds_read_b128 v[236:239], v2 offset:15360
    v_mfma_f32_16x16x32_bf16 v[52:55], v[164:167], v[184:187], v[52:55]
    ds_read_b128 v[240:243], v2 offset:16384
    v_permlane16_swap_b32 v249, v9
    v_mfma_f32_16x16x32_bf16 v[56:59], v[160:163], v[188:191], v[56:59]
    ds_read_b128 v[244:247], v2 offset:17408
    v_permlane16_swap_b32 v250, v12
    v_mfma_f32_16x16x32_bf16 v[60:63], v[164:167], v[188:191], v[60:63]
    v_permlane16_swap_b32 v251, v13
    v_mfma_f32_16x16x32_bf16 v[64:67], v[160:163], v[192:195], v[64:67]
    v_add_f32 v248, v248, v8
    v_mfma_f32_16x16x32_bf16 v[68:71], v[164:167], v[192:195], v[68:71]
    v_add_f32 v249, v249, v9
    v_mfma_f32_16x16x32_bf16 v[72:75], v[160:163], v[196:199], v[72:75]
    v_add_f32 v250, v250, v12
    v_mfma_f32_16x16x32_bf16 v[76:79], v[164:167], v[196:199], v[76:79]
    v_add_f32 v251, v251, v13
    v_mfma_f32_16x16x32_bf16 v[80:83], v[160:163], v[200:203], v[80:83]
    v_mul_f32 v248, 0x3ae38e39, v248
    v_mfma_f32_16x16x32_bf16 v[84:87], v[164:167], v[200:203], v[84:87]
    v_mul_f32 v249, 0x3ae38e39, v249
    v_mul_f32 v250, 0x3ae38e39, v250
    s_waitcnt lgkmcnt(0)
    s_barrier
    v_mfma_f32_16x16x32_bf16 v[16:19], v[204:207], v[212:215], v[16:19]
    ds_read_b128 v[160:163], v0 offset:36864
    v_mfma_f32_16x16x32_bf16 v[20:23], v[208:211], v[212:215], v[20:23]
    ds_read_b128 v[164:167], v0 offset:38912
    v_mfma_f32_16x16x32_bf16 v[24:27], v[204:207], v[216:219], v[24:27]
    ds_read_b128 v[168:171], v2 offset:36864
    v_mfma_f32_16x16x32_bf16 v[28:31], v[208:211], v[216:219], v[28:31]
    ds_read_b128 v[172:175], v2 offset:37888
    v_mfma_f32_16x16x32_bf16 v[32:35], v[204:207], v[220:223], v[32:35]
    ds_read_b128 v[176:179], v2 offset:38912
    v_mfma_f32_16x16x32_bf16 v[36:39], v[208:211], v[220:223], v[36:39]
    ds_read_b128 v[180:183], v2 offset:39936
    v_mfma_f32_16x16x32_bf16 v[40:43], v[204:207], v[224:227], v[40:43]
    ds_read_b128 v[184:187], v2 offset:40960
    v_mfma_f32_16x16x32_bf16 v[44:47], v[208:211], v[224:227], v[44:47]
    ds_read_b128 v[188:191], v2 offset:41984
    v_mfma_f32_16x16x32_bf16 v[48:51], v[204:207], v[228:231], v[48:51]
    ds_read_b128 v[192:195], v2 offset:43008
    v_mfma_f32_16x16x32_bf16 v[52:55], v[208:211], v[228:231], v[52:55]
    ds_read_b128 v[196:199], v2 offset:44032
    v_mul_f32 v251, 0x3ae38e39, v251
    v_mfma_f32_16x16x32_bf16 v[56:59], v[204:207], v[232:235], v[56:59]
    ds_read_b128 v[200:203], v2 offset:45056
    v_fma_f32 v249, -v248, v248, v249
    v_mfma_f32_16x16x32_bf16 v[60:63], v[208:211], v[232:235], v[60:63]
    v_fma_f32 v251, -v250, v250, v251
    v_mfma_f32_16x16x32_bf16 v[64:67], v[204:207], v[236:239], v[64:67]
    v_max_f32 v249, 0, v249
    v_mfma_f32_16x16x32_bf16 v[68:71], v[208:211], v[236:239], v[68:71]
    v_max_f32 v251, 0, v251
    v_mfma_f32_16x16x32_bf16 v[72:75], v[204:207], v[240:243], v[72:75]
    v_add_f32 v249, 0x3727c5ac, v249
    v_mfma_f32_16x16x32_bf16 v[76:79], v[208:211], v[240:243], v[76:79]
    v_add_f32 v251, 0x3727c5ac, v251
    v_mfma_f32_16x16x32_bf16 v[80:83], v[204:207], v[244:247], v[80:83]
    v_rsq_f32 v249, v249
    v_mfma_f32_16x16x32_bf16 v[84:87], v[208:211], v[244:247], v[84:87]
    v_rsq_f32 v251, v251
    s_nop 0
    s_waitcnt lgkmcnt(5)
    v_mfma_f32_16x16x32_bf16 v[16:19], v[160:163], v[168:171], v[16:19]
    ds_read_b128 v[204:207], v0 offset:37888
    v_mfma_f32_16x16x32_bf16 v[20:23], v[164:167], v[168:171], v[20:23]
    ds_read_b128 v[208:211], v0 offset:39936
    v_mfma_f32_16x16x32_bf16 v[24:27], v[160:163], v[172:175], v[24:27]
    ds_read_b128 v[212:215], v2 offset:46080
    v_mfma_f32_16x16x32_bf16 v[28:31], v[164:167], v[172:175], v[28:31]
    ds_read_b128 v[216:219], v2 offset:47104
    v_mfma_f32_16x16x32_bf16 v[32:35], v[160:163], v[176:179], v[32:35]
    ds_read_b128 v[220:223], v2 offset:48128
    v_mfma_f32_16x16x32_bf16 v[36:39], v[164:167], v[176:179], v[36:39]
    ds_read_b128 v[224:227], v2 offset:49152
    v_mfma_f32_16x16x32_bf16 v[40:43], v[160:163], v[180:183], v[40:43]
    ds_read_b128 v[228:231], v2 offset:50176
    v_mfma_f32_16x16x32_bf16 v[44:47], v[164:167], v[180:183], v[44:47]
    ds_read_b128 v[232:235], v2 offset:51200
    s_waitcnt lgkmcnt(8)
    v_mfma_f32_16x16x32_bf16 v[48:51], v[160:163], v[184:187], v[48:51]
    ds_read_b128 v[236:239], v2 offset:52224
    v_mfma_f32_16x16x32_bf16 v[52:55], v[164:167], v[184:187], v[52:55]
    ds_read_b128 v[240:243], v2 offset:53248
    v_mfma_f32_16x16x32_bf16 v[56:59], v[160:163], v[188:191], v[56:59]
    ds_read_b128 v[244:247], v2 offset:54272
    v_mfma_f32_16x16x32_bf16 v[60:63], v[164:167], v[188:191], v[60:63]
    v_mfma_f32_16x16x32_bf16 v[64:67], v[160:163], v[192:195], v[64:67]
    v_mfma_f32_16x16x32_bf16 v[68:71], v[164:167], v[192:195], v[68:71]
    v_mfma_f32_16x16x32_bf16 v[72:75], v[160:163], v[196:199], v[72:75]
    v_mfma_f32_16x16x32_bf16 v[76:79], v[164:167], v[196:199], v[76:79]
    v_mfma_f32_16x16x32_bf16 v[80:83], v[160:163], v[200:203], v[80:83]
    v_mfma_f32_16x16x32_bf16 v[84:87], v[164:167], v[200:203], v[84:87]
    s_waitcnt lgkmcnt(0)
    s_barrier
    v_mfma_f32_16x16x32_bf16 v[16:19], v[204:207], v[212:215], v[16:19]
    ds_read_b128 v[160:163], v3 offset:0
    v_mfma_f32_16x16x32_bf16 v[20:23], v[208:211], v[212:215], v[20:23]
    ds_read_b128 v[164:167], v3 offset:2048
    v_mfma_f32_16x16x32_bf16 v[24:27], v[204:207], v[216:219], v[24:27]
    ds_read_b128 v[168:171], v1 offset:0
    v_mfma_f32_16x16x32_bf16 v[28:31], v[208:211], v[216:219], v[28:31]
    ds_read_b128 v[172:175], v1 offset:1024
    v_mfma_f32_16x16x32_bf16 v[32:35], v[204:207], v[220:223], v[32:35]
    ds_read_b128 v[176:179], v1 offset:2048
    v_mfma_f32_16x16x32_bf16 v[36:39], v[208:211], v[220:223], v[36:39]
    ds_read_b128 v[180:183], v1 offset:3072
    v_mfma_f32_16x16x32_bf16 v[40:43], v[204:207], v[224:227], v[40:43]
    ds_read_b128 v[184:187], v1 offset:4096
    v_mfma_f32_16x16x32_bf16 v[44:47], v[208:211], v[224:227], v[44:47]
    ds_read_b128 v[188:191], v1 offset:5120
    v_mfma_f32_16x16x32_bf16 v[48:51], v[204:207], v[228:231], v[48:51]
    ds_read_b128 v[192:195], v1 offset:6144
    v_mfma_f32_16x16x32_bf16 v[52:55], v[208:211], v[228:231], v[52:55]
    ds_read_b128 v[196:199], v1 offset:7168
    v_mfma_f32_16x16x32_bf16 v[56:59], v[204:207], v[232:235], v[56:59]
    ds_read_b128 v[200:203], v1 offset:8192
    v_mfma_f32_16x16x32_bf16 v[60:63], v[208:211], v[232:235], v[60:63]
    ds_write2_b32 v4, v248, v249 offset0:0 offset1:32
    v_mfma_f32_16x16x32_bf16 v[64:67], v[204:207], v[236:239], v[64:67]
    ds_write2_b32 v4, v250, v251 offset0:16 offset1:48
    v_mfma_f32_16x16x32_bf16 v[68:71], v[208:211], v[236:239], v[68:71]
    ds_read_b128 v[88:91], v252 offset:0
    v_mfma_f32_16x16x32_bf16 v[72:75], v[204:207], v[240:243], v[72:75]
    ds_read_b128 v[92:95], v252 offset:64
    v_mfma_f32_16x16x32_bf16 v[76:79], v[208:211], v[240:243], v[76:79]
    ds_read_b128 v[96:99], v252 offset:128
    v_mfma_f32_16x16x32_bf16 v[80:83], v[204:207], v[244:247], v[80:83]
    ds_read_b128 v[100:103], v252 offset:192
    v_mfma_f32_16x16x32_bf16 v[84:87], v[208:211], v[244:247], v[84:87]
    s_waitcnt lgkmcnt(11)
    v_mfma_f32_16x16x32_bf16 v[16:19], v[160:163], v[168:171], v[16:19]
    ds_read_b128 v[204:207], v3 offset:1024
    v_mfma_f32_16x16x32_bf16 v[20:23], v[164:167], v[168:171], v[20:23]
    ds_read_b128 v[208:211], v3 offset:3072
    v_mfma_f32_16x16x32_bf16 v[24:27], v[160:163], v[172:175], v[24:27]
    ds_read_b128 v[212:215], v1 offset:9216
    v_mfma_f32_16x16x32_bf16 v[28:31], v[164:167], v[172:175], v[28:31]
    ds_read_b128 v[216:219], v1 offset:10240
    v_mfma_f32_16x16x32_bf16 v[32:35], v[160:163], v[176:179], v[32:35]
    ds_read_b128 v[220:223], v1 offset:11264
    v_mfma_f32_16x16x32_bf16 v[36:39], v[164:167], v[176:179], v[36:39]
    ds_read_b128 v[224:227], v1 offset:12288
    v_mfma_f32_16x16x32_bf16 v[40:43], v[160:163], v[180:183], v[40:43]
    ds_read_b128 v[228:231], v1 offset:13312
    v_mfma_f32_16x16x32_bf16 v[44:47], v[164:167], v[180:183], v[44:47]
    ds_read_b128 v[232:235], v1 offset:14336
    s_waitcnt lgkmcnt(8)
    v_mfma_f32_16x16x32_bf16 v[48:51], v[160:163], v[184:187], v[48:51]
    ds_read_b128 v[236:239], v1 offset:15360
    v_mfma_f32_16x16x32_bf16 v[52:55], v[164:167], v[184:187], v[52:55]
    ds_read_b128 v[240:243], v1 offset:16384
    v_rcp_f32 v120, v96
    v_mfma_f32_16x16x32_bf16 v[56:59], v[160:163], v[188:191], v[56:59]
    ds_read_b128 v[244:247], v1 offset:17408
    v_mul_f32 v104, s40, v96
    v_mfma_f32_16x16x32_bf16 v[60:63], v[164:167], v[188:191], v[60:63]
    v_mul_f32 v112, v96, v96
    v_mfma_f32_16x16x32_bf16 v[64:67], v[160:163], v[192:195], v[64:67]
    v_rcp_f32 v121, v97
    v_mfma_f32_16x16x32_bf16 v[68:71], v[164:167], v[192:195], v[68:71]
    v_mul_f32 v105, s40, v97
    v_mfma_f32_16x16x32_bf16 v[72:75], v[160:163], v[196:199], v[72:75]
    v_mul_f32 v113, v97, v97
    v_mfma_f32_16x16x32_bf16 v[76:79], v[164:167], v[196:199], v[76:79]
    v_rcp_f32 v122, v98
    v_mfma_f32_16x16x32_bf16 v[80:83], v[160:163], v[200:203], v[80:83]
    v_mul_f32 v106, s40, v98
    v_mfma_f32_16x16x32_bf16 v[84:87], v[164:167], v[200:203], v[84:87]
    v_mul_f32 v114, v98, v98
    v_rcp_f32 v123, v99
    s_waitcnt lgkmcnt(0)
    s_barrier
    v_mfma_f32_16x16x32_bf16 v[16:19], v[204:207], v[212:215], v[16:19]
    ds_read_b128 v[160:163], v3 offset:36864
    v_mfma_f32_16x16x32_bf16 v[20:23], v[208:211], v[212:215], v[20:23]
    ds_read_b128 v[164:167], v3 offset:38912
    v_mfma_f32_16x16x32_bf16 v[24:27], v[204:207], v[216:219], v[24:27]
    ds_read_b128 v[168:171], v1 offset:36864
    v_mfma_f32_16x16x32_bf16 v[28:31], v[208:211], v[216:219], v[28:31]
    ds_read_b128 v[172:175], v1 offset:37888
    v_mfma_f32_16x16x32_bf16 v[32:35], v[204:207], v[220:223], v[32:35]
    ds_read_b128 v[176:179], v1 offset:38912
    v_mfma_f32_16x16x32_bf16 v[36:39], v[208:211], v[220:223], v[36:39]
    ds_read_b128 v[180:183], v1 offset:39936
    v_mfma_f32_16x16x32_bf16 v[40:43], v[204:207], v[224:227], v[40:43]
    ds_read_b128 v[184:187], v1 offset:40960
    v_mfma_f32_16x16x32_bf16 v[44:47], v[208:211], v[224:227], v[44:47]
    ds_read_b128 v[188:191], v1 offset:41984
    v_mfma_f32_16x16x32_bf16 v[48:51], v[204:207], v[228:231], v[48:51]
    ds_read_b128 v[192:195], v1 offset:43008
    v_mfma_f32_16x16x32_bf16 v[52:55], v[208:211], v[228:231], v[52:55]
    ds_read_b128 v[196:199], v1 offset:44032
    v_mul_f32 v107, s40, v99
    v_mfma_f32_16x16x32_bf16 v[56:59], v[204:207], v[232:235], v[56:59]
    ds_read_b128 v[200:203], v1 offset:45056
    v_mul_f32 v115, v99, v99
    v_mfma_f32_16x16x32_bf16 v[60:63], v[208:211], v[232:235], v[60:63]
    v_rcp_f32 v124, v100
    v_mfma_f32_16x16x32_bf16 v[64:67], v[204:207], v[236:239], v[64:67]
    v_mul_f32 v108, s40, v100
    v_mfma_f32_16x16x32_bf16 v[68:71], v[208:211], v[236:239], v[68:71]
    v_mul_f32 v116, v100, v100
    v_mfma_f32_16x16x32_bf16 v[72:75], v[204:207], v[240:243], v[72:75]
    v_rcp_f32 v125, v101
    v_mfma_f32_16x16x32_bf16 v[76:79], v[208:211], v[240:243], v[76:79]
    v_mul_f32 v109, s40, v101
    v_mfma_f32_16x16x32_bf16 v[80:83], v[204:207], v[244:247], v[80:83]
    v_mul_f32 v117, v101, v101
    v_mfma_f32_16x16x32_bf16 v[84:87], v[208:211], v[244:247], v[84:87]
    v_rcp_f32 v126, v102
    v_mul_f32 v110, s40, v102
    s_waitcnt lgkmcnt(5)
    v_mfma_f32_16x16x32_bf16 v[16:19], v[160:163], v[168:171], v[16:19]
    ds_read_b128 v[204:207], v3 offset:37888
    v_mfma_f32_16x16x32_bf16 v[20:23], v[164:167], v[168:171], v[20:23]
    ds_read_b128 v[208:211], v3 offset:39936
    v_mfma_f32_16x16x32_bf16 v[24:27], v[160:163], v[172:175], v[24:27]
    ds_read_b128 v[212:215], v1 offset:46080
    v_mfma_f32_16x16x32_bf16 v[28:31], v[164:167], v[172:175], v[28:31]
    ds_read_b128 v[216:219], v1 offset:47104
    v_mfma_f32_16x16x32_bf16 v[32:35], v[160:163], v[176:179], v[32:35]
    ds_read_b128 v[220:223], v1 offset:48128
    v_mfma_f32_16x16x32_bf16 v[36:39], v[164:167], v[176:179], v[36:39]
    ds_read_b128 v[224:227], v1 offset:49152
    v_mfma_f32_16x16x32_bf16 v[40:43], v[160:163], v[180:183], v[40:43]
    ds_read_b128 v[228:231], v1 offset:50176
    v_mfma_f32_16x16x32_bf16 v[44:47], v[164:167], v[180:183], v[44:47]
    ds_read_b128 v[232:235], v1 offset:51200
    s_waitcnt lgkmcnt(8)
    v_mfma_f32_16x16x32_bf16 v[48:51], v[160:163], v[184:187], v[48:51]
    ds_read_b128 v[236:239], v1 offset:52224
    v_mfma_f32_16x16x32_bf16 v[52:55], v[164:167], v[184:187], v[52:55]
    ds_read_b128 v[240:243], v1 offset:53248
    v_mul_f32 v118, v102, v102
    v_mfma_f32_16x16x32_bf16 v[56:59], v[160:163], v[188:191], v[56:59]
    ds_read_b128 v[244:247], v1 offset:54272
    v_rcp_f32 v127, v103
    v_mfma_f32_16x16x32_bf16 v[60:63], v[164:167], v[188:191], v[60:63]
    v_mul_f32 v111, s40, v103
    v_mfma_f32_16x16x32_bf16 v[64:67], v[160:163], v[192:195], v[64:67]
    v_mul_f32 v119, v103, v103
    v_mfma_f32_16x16x32_bf16 v[68:71], v[164:167], v[192:195], v[68:71]
    v_mul_f32 v112, s42, v112
    v_mfma_f32_16x16x32_bf16 v[72:75], v[160:163], v[196:199], v[72:75]
    v_mul_f32 v113, s42, v113
    v_mfma_f32_16x16x32_bf16 v[76:79], v[164:167], v[196:199], v[76:79]
    v_mul_f32 v114, s42, v114
    v_mfma_f32_16x16x32_bf16 v[80:83], v[160:163], v[200:203], v[80:83]
    v_mul_f32 v115, s42, v115
    v_mfma_f32_16x16x32_bf16 v[84:87], v[164:167], v[200:203], v[84:87]
    v_mul_f32 v116, s42, v116
    v_mul_f32 v117, s42, v117
    s_waitcnt lgkmcnt(0)
    s_barrier
    v_mfma_f32_16x16x32_bf16 v[16:19], v[204:207], v[212:215], v[16:19]
    ds_read_b128 v[160:163], v0 offset:0
    v_mfma_f32_16x16x32_bf16 v[20:23], v[208:211], v[212:215], v[20:23]
    ds_read_b128 v[164:167], v0 offset:2048
    v_mfma_f32_16x16x32_bf16 v[24:27], v[204:207], v[216:219], v[24:27]
    ds_read_b128 v[168:171], v2 offset:0
    v_mfma_f32_16x16x32_bf16 v[28:31], v[208:211], v[216:219], v[28:31]
    ds_read_b128 v[172:175], v2 offset:1024
    v_mfma_f32_16x16x32_bf16 v[32:35], v[204:207], v[220:223], v[32:35]
    ds_read_b128 v[176:179], v2 offset:2048
    v_mfma_f32_16x16x32_bf16 v[36:39], v[208:211], v[220:223], v[36:39]
    ds_read_b128 v[180:183], v2 offset:3072
    v_mfma_f32_16x16x32_bf16 v[40:43], v[204:207], v[224:227], v[40:43]
    ds_read_b128 v[184:187], v2 offset:4096
    v_mfma_f32_16x16x32_bf16 v[44:47], v[208:211], v[224:227], v[44:47]
    ds_read_b128 v[188:191], v2 offset:5120
    v_mfma_f32_16x16x32_bf16 v[48:51], v[204:207], v[228:231], v[48:51]
    ds_read_b128 v[192:195], v2 offset:6144
    v_mfma_f32_16x16x32_bf16 v[52:55], v[208:211], v[228:231], v[52:55]
    ds_read_b128 v[196:199], v2 offset:7168
    v_mul_f32 v118, s42, v118
    v_mfma_f32_16x16x32_bf16 v[56:59], v[204:207], v[232:235], v[56:59]
    ds_read_b128 v[200:203], v2 offset:8192
    v_mul_f32 v119, s42, v119
    v_mfma_f32_16x16x32_bf16 v[60:63], v[208:211], v[232:235], v[60:63]
    v_mul_f32 v112, v112, v104
    v_mfma_f32_16x16x32_bf16 v[64:67], v[204:207], v[236:239], v[64:67]
    v_mul_f32 v113, v113, v105
    v_mfma_f32_16x16x32_bf16 v[68:71], v[208:211], v[236:239], v[68:71]
    v_mul_f32 v114, v114, v106
    v_mfma_f32_16x16x32_bf16 v[72:75], v[204:207], v[240:243], v[72:75]
    v_mul_f32 v115, v115, v107
    v_mfma_f32_16x16x32_bf16 v[76:79], v[208:211], v[240:243], v[76:79]
    v_mul_f32 v116, v116, v108
    v_mfma_f32_16x16x32_bf16 v[80:83], v[204:207], v[244:247], v[80:83]
    v_mul_f32 v117, v117, v109
    v_mfma_f32_16x16x32_bf16 v[84:87], v[208:211], v[244:247], v[84:87]
    v_mul_f32 v118, v118, v110
    v_mul_f32 v119, v119, v111
    s_waitcnt lgkmcnt(5)
    v_mfma_f32_16x16x32_bf16 v[16:19], v[160:163], v[168:171], v[16:19]
    ds_read_b128 v[204:207], v0 offset:1024
    v_mfma_f32_16x16x32_bf16 v[20:23], v[164:167], v[168:171], v[20:23]
    ds_read_b128 v[208:211], v0 offset:3072
    v_mfma_f32_16x16x32_bf16 v[24:27], v[160:163], v[172:175], v[24:27]
    ds_read_b128 v[212:215], v2 offset:9216
    v_mfma_f32_16x16x32_bf16 v[28:31], v[164:167], v[172:175], v[28:31]
    ds_read_b128 v[216:219], v2 offset:10240
    v_mfma_f32_16x16x32_bf16 v[32:35], v[160:163], v[176:179], v[32:35]
    ds_read_b128 v[220:223], v2 offset:11264
    v_mfma_f32_16x16x32_bf16 v[36:39], v[164:167], v[176:179], v[36:39]
    ds_read_b128 v[224:227], v2 offset:12288
    v_mfma_f32_16x16x32_bf16 v[40:43], v[160:163], v[180:183], v[40:43]
    ds_read_b128 v[228:231], v2 offset:13312
    v_mfma_f32_16x16x32_bf16 v[44:47], v[164:167], v[180:183], v[44:47]
    ds_read_b128 v[232:235], v2 offset:14336
    s_waitcnt lgkmcnt(8)
    v_mfma_f32_16x16x32_bf16 v[48:51], v[160:163], v[184:187], v[48:51]
    ds_read_b128 v[236:239], v2 offset:15360
    v_mfma_f32_16x16x32_bf16 v[52:55], v[164:167], v[184:187], v[52:55]
    ds_read_b128 v[240:243], v2 offset:16384
    v_lshrrev_b32 v8, 2, v6
    v_mfma_f32_16x16x32_bf16 v[56:59], v[160:163], v[188:191], v[56:59]
    ds_read_b128 v[244:247], v2 offset:17408
    v_lshlrev_b32 v8, 4, v8
    v_mfma_f32_16x16x32_bf16 v[60:63], v[164:167], v[188:191], v[60:63]
    v_lshl_add_u32 v8, v5, 6, v8
    v_mfma_f32_16x16x32_bf16 v[64:67], v[160:163], v[192:195], v[64:67]
    v_and_b32 v9, 3, v6
    v_mfma_f32_16x16x32_bf16 v[68:71], v[164:167], v[192:195], v[68:71]
    v_cmp_eq_u32 vcc, 0, v9
    v_mfma_f32_16x16x32_bf16 v[72:75], v[160:163], v[196:199], v[72:75]
    v_bfrev_b32 v10, 1
    v_mfma_f32_16x16x32_bf16 v[76:79], v[164:167], v[196:199], v[76:79]
    v_lshlrev_b32 v9, 4, v9
    v_mfma_f32_16x16x32_bf16 v[80:83], v[160:163], v[200:203], v[80:83]
    v_cndmask_b32 v8, v10, v8, vcc
    v_mfma_f32_16x16x32_bf16 v[84:87], v[164:167], v[200:203], v[84:87]
    v_lshl_add_u32 v9, v5, 6, v9
    v_lshrrev_b32 v255, 2, v6
    s_waitcnt lgkmcnt(0)
    s_barrier
    v_mfma_f32_16x16x32_bf16 v[16:19], v[204:207], v[212:215], v[16:19]
    ds_read_b128 v[160:163], v0 offset:36864
    v_fma_f32 v52, -v92, v132, v52
    v_mfma_f32_16x16x32_bf16 v[20:23], v[208:211], v[212:215], v[20:23]
    ds_read_b128 v[164:167], v0 offset:38912
    v_fma_f32 v56, -v88, v133, v56
    v_mfma_f32_16x16x32_bf16 v[24:27], v[204:207], v[216:219], v[24:27]
    ds_read_b128 v[168:171], v2 offset:36864
    v_fma_f32 v60, -v92, v133, v60
    v_mfma_f32_16x16x32_bf16 v[28:31], v[208:211], v[216:219], v[28:31]
    ds_read_b128 v[172:175], v2 offset:37888
    v_fma_f32 v64, -v88, v134, v64
    v_mfma_f32_16x16x32_bf16 v[32:35], v[204:207], v[220:223], v[32:35]
    ds_read_b128 v[176:179], v2 offset:38912
    v_fma_f32 v68, -v92, v134, v68
    v_mfma_f32_16x16x32_bf16 v[36:39], v[208:211], v[220:223], v[36:39]
    ds_read_b128 v[180:183], v2 offset:39936
    v_fma_f32 v72, -v88, v135, v72
    v_mfma_f32_16x16x32_bf16 v[40:43], v[204:207], v[224:227], v[40:43]
    ds_read_b128 v[184:187], v2 offset:40960
    v_fma_f32 v76, -v92, v135, v76
    v_mfma_f32_16x16x32_bf16 v[44:47], v[208:211], v[224:227], v[44:47]
    ds_read_b128 v[188:191], v2 offset:41984
    v_fma_f32 v80, -v88, v136, v80
    v_mfma_f32_16x16x32_bf16 v[48:51], v[204:207], v[228:231], v[48:51]
    ds_read_b128 v[192:195], v2 offset:43008
    v_fma_f32 v84, -v92, v136, v84
    v_mfma_f32_16x16x32_bf16 v[52:55], v[208:211], v[228:231], v[52:55]
    ds_read_b128 v[196:199], v2 offset:44032
    v_lshl_add_u32 v255, v255, 8, v9
    v_fma_f32 v16, -v88, v128, v16
    v_mfma_f32_16x16x32_bf16 v[56:59], v[204:207], v[232:235], v[56:59]
    ds_read_b128 v[200:203], v2 offset:45056
    v_fma_f32 v20, -v92, v128, v20
    v_mfma_f32_16x16x32_bf16 v[60:63], v[208:211], v[232:235], v[60:63]
    v_fma_f32 v24, -v88, v129, v24
    v_mfma_f32_16x16x32_bf16 v[64:67], v[204:207], v[236:239], v[64:67]
    v_fma_f32 v28, -v92, v129, v28
    v_mfma_f32_16x16x32_bf16 v[68:71], v[208:211], v[236:239], v[68:71]
    v_fma_f32 v32, -v88, v130, v32
    v_mfma_f32_16x16x32_bf16 v[72:75], v[204:207], v[240:243], v[72:75]
    v_fma_f32 v36, -v92, v130, v36
    v_mfma_f32_16x16x32_bf16 v[76:79], v[208:211], v[240:243], v[76:79]
    v_fma_f32 v40, -v88, v131, v40
    v_mfma_f32_16x16x32_bf16 v[80:83], v[204:207], v[244:247], v[80:83]
    v_fma_f32 v44, -v92, v131, v44
    v_mfma_f32_16x16x32_bf16 v[84:87], v[208:211], v[244:247], v[84:87]
    v_fma_f32 v48, -v88, v132, v48
    s_waitcnt lgkmcnt(5)
    v_mfma_f32_16x16x32_bf16 v[16:19], v[160:163], v[168:171], v[16:19]
    ds_read_b128 v[204:207], v0 offset:37888
    v_fma_f32 v53, -v93, v132, v53
    v_mfma_f32_16x16x32_bf16 v[20:23], v[164:167], v[168:171], v[20:23]
    ds_read_b128 v[208:211], v0 offset:39936
    v_fma_f32 v57, -v89, v133, v57
    v_mfma_f32_16x16x32_bf16 v[24:27], v[160:163], v[172:175], v[24:27]
    ds_read_b128 v[212:215], v2 offset:46080
    v_fma_f32 v61, -v93, v133, v61
    v_mfma_f32_16x16x32_bf16 v[28:31], v[164:167], v[172:175], v[28:31]
    ds_read_b128 v[216:219], v2 offset:47104
    v_fma_f32 v65, -v89, v134, v65
    v_mfma_f32_16x16x32_bf16 v[32:35], v[160:163], v[176:179], v[32:35]
    ds_read_b128 v[220:223], v2 offset:48128
    v_fma_f32 v69, -v93, v134, v69
    v_mfma_f32_16x16x32_bf16 v[36:39], v[164:167], v[176:179], v[36:39]
    ds_read_b128 v[224:227], v2 offset:49152
    v_fma_f32 v73, -v89, v135, v73
    v_mfma_f32_16x16x32_bf16 v[40:43], v[160:163], v[180:183], v[40:43]
    ds_read_b128 v[228:231], v2 offset:50176
    v_fma_f32 v77, -v93, v135, v77
    v_mfma_f32_16x16x32_bf16 v[44:47], v[164:167], v[180:183], v[44:47]
    ds_read_b128 v[232:235], v2 offset:51200
    s_waitcnt lgkmcnt(8)
    v_fma_f32 v81, -v89, v136, v81
    v_mfma_f32_16x16x32_bf16 v[48:51], v[160:163], v[184:187], v[48:51]
    ds_read_b128 v[236:239], v2 offset:52224
    v_fma_f32 v85, -v93, v136, v85
    v_mfma_f32_16x16x32_bf16 v[52:55], v[164:167], v[184:187], v[52:55]
    ds_read_b128 v[240:243], v2 offset:53248
    v_fma_f32 v17, -v89, v128, v17
    v_mfma_f32_16x16x32_bf16 v[56:59], v[160:163], v[188:191], v[56:59]
    ds_read_b128 v[244:247], v2 offset:54272
    v_fma_f32 v21, -v93, v128, v21
    v_mfma_f32_16x16x32_bf16 v[60:63], v[164:167], v[188:191], v[60:63]
    v_fma_f32 v25, -v89, v129, v25
    v_mfma_f32_16x16x32_bf16 v[64:67], v[160:163], v[192:195], v[64:67]
    v_fma_f32 v29, -v93, v129, v29
    v_mfma_f32_16x16x32_bf16 v[68:71], v[164:167], v[192:195], v[68:71]
    v_fma_f32 v33, -v89, v130, v33
    v_mfma_f32_16x16x32_bf16 v[72:75], v[160:163], v[196:199], v[72:75]
    v_fma_f32 v37, -v93, v130, v37
    v_mfma_f32_16x16x32_bf16 v[76:79], v[164:167], v[196:199], v[76:79]
    v_fma_f32 v41, -v89, v131, v41
    v_mfma_f32_16x16x32_bf16 v[80:83], v[160:163], v[200:203], v[80:83]
    v_fma_f32 v45, -v93, v131, v45
    v_mfma_f32_16x16x32_bf16 v[84:87], v[164:167], v[200:203], v[84:87]
    v_fma_f32 v49, -v89, v132, v49
    s_waitcnt lgkmcnt(0)
    s_barrier
    v_mfma_f32_16x16x32_bf16 v[16:19], v[204:207], v[212:215], v[16:19]
    ds_read_b128 v[160:163], v3 offset:0
    v_fma_f32 v54, -v94, v132, v54
    v_mfma_f32_16x16x32_bf16 v[20:23], v[208:211], v[212:215], v[20:23]
    ds_read_b128 v[164:167], v3 offset:2048
    v_fma_f32 v58, -v90, v133, v58
    v_mfma_f32_16x16x32_bf16 v[24:27], v[204:207], v[216:219], v[24:27]
    ds_read_b128 v[168:171], v1 offset:0
    v_fma_f32 v62, -v94, v133, v62
    v_mfma_f32_16x16x32_bf16 v[28:31], v[208:211], v[216:219], v[28:31]
    ds_read_b128 v[172:175], v1 offset:1024
    v_fma_f32 v66, -v90, v134, v66
    v_mfma_f32_16x16x32_bf16 v[32:35], v[204:207], v[220:223], v[32:35]
    ds_read_b128 v[176:179], v1 offset:2048
    v_fma_f32 v70, -v94, v134, v70
    v_mfma_f32_16x16x32_bf16 v[36:39], v[208:211], v[220:223], v[36:39]
    ds_read_b128 v[180:183], v1 offset:3072
    v_fma_f32 v74, -v90, v135, v74
    v_mfma_f32_16x16x32_bf16 v[40:43], v[204:207], v[224:227], v[40:43]
    ds_read_b128 v[184:187], v1 offset:4096
    v_fma_f32 v78, -v94, v135, v78
    v_mfma_f32_16x16x32_bf16 v[44:47], v[208:211], v[224:227], v[44:47]
    ds_read_b128 v[188:191], v1 offset:5120
    v_fma_f32 v82, -v90, v136, v82
    v_mfma_f32_16x16x32_bf16 v[48:51], v[204:207], v[228:231], v[48:51]
    ds_read_b128 v[192:195], v1 offset:6144
    v_fma_f32 v86, -v94, v136, v86
    v_mfma_f32_16x16x32_bf16 v[52:55], v[208:211], v[228:231], v[52:55]
    ds_read_b128 v[196:199], v1 offset:7168
    v_fma_f32 v18, -v90, v128, v18
    v_mfma_f32_16x16x32_bf16 v[56:59], v[204:207], v[232:235], v[56:59]
    ds_read_b128 v[200:203], v1 offset:8192
    v_fma_f32 v22, -v94, v128, v22
    v_mfma_f32_16x16x32_bf16 v[60:63], v[208:211], v[232:235], v[60:63]
    v_fma_f32 v26, -v90, v129, v26
    v_mfma_f32_16x16x32_bf16 v[64:67], v[204:207], v[236:239], v[64:67]
    v_fma_f32 v30, -v94, v129, v30
    v_mfma_f32_16x16x32_bf16 v[68:71], v[208:211], v[236:239], v[68:71]
    v_fma_f32 v34, -v90, v130, v34
    v_mfma_f32_16x16x32_bf16 v[72:75], v[204:207], v[240:243], v[72:75]
    v_fma_f32 v38, -v94, v130, v38
    v_mfma_f32_16x16x32_bf16 v[76:79], v[208:211], v[240:243], v[76:79]
    v_fma_f32 v42, -v90, v131, v42
    v_mfma_f32_16x16x32_bf16 v[80:83], v[204:207], v[244:247], v[80:83]
    v_fma_f32 v46, -v94, v131, v46
    v_mfma_f32_16x16x32_bf16 v[84:87], v[208:211], v[244:247], v[84:87]
    v_fma_f32 v50, -v90, v132, v50
    s_waitcnt lgkmcnt(5)
    v_mfma_f32_16x16x32_bf16 v[16:19], v[160:163], v[168:171], v[16:19]
    ds_read_b128 v[204:207], v3 offset:1024
    v_fma_f32 v55, -v95, v132, v55
    v_mfma_f32_16x16x32_bf16 v[20:23], v[164:167], v[168:171], v[20:23]
    ds_read_b128 v[208:211], v3 offset:3072
    v_fma_f32 v59, -v91, v133, v59
    v_mfma_f32_16x16x32_bf16 v[24:27], v[160:163], v[172:175], v[24:27]
    ds_read_b128 v[212:215], v1 offset:9216
    v_fma_f32 v63, -v95, v133, v63
    v_mfma_f32_16x16x32_bf16 v[28:31], v[164:167], v[172:175], v[28:31]
    ds_read_b128 v[216:219], v1 offset:10240
    v_fma_f32 v67, -v91, v134, v67
    v_mfma_f32_16x16x32_bf16 v[32:35], v[160:163], v[176:179], v[32:35]
    ds_read_b128 v[220:223], v1 offset:11264
    v_fma_f32 v71, -v95, v134, v71
    v_mfma_f32_16x16x32_bf16 v[36:39], v[164:167], v[176:179], v[36:39]
    ds_read_b128 v[224:227], v1 offset:12288
    v_fma_f32 v75, -v91, v135, v75
    v_mfma_f32_16x16x32_bf16 v[40:43], v[160:163], v[180:183], v[40:43]
    ds_read_b128 v[228:231], v1 offset:13312
    v_fma_f32 v79, -v95, v135, v79
    v_mfma_f32_16x16x32_bf16 v[44:47], v[164:167], v[180:183], v[44:47]
    ds_read_b128 v[232:235], v1 offset:14336
    s_waitcnt lgkmcnt(8)
    v_fma_f32 v83, -v91, v136, v83
    v_mfma_f32_16x16x32_bf16 v[48:51], v[160:163], v[184:187], v[48:51]
    ds_read_b128 v[236:239], v1 offset:15360
    v_fma_f32 v87, -v95, v136, v87
    v_mfma_f32_16x16x32_bf16 v[52:55], v[164:167], v[184:187], v[52:55]
    ds_read_b128 v[240:243], v1 offset:16384
    v_fma_f32 v19, -v91, v128, v19
    v_mfma_f32_16x16x32_bf16 v[56:59], v[160:163], v[188:191], v[56:59]
    ds_read_b128 v[244:247], v1 offset:17408
    v_fma_f32 v23, -v95, v128, v23
    v_mfma_f32_16x16x32_bf16 v[60:63], v[164:167], v[188:191], v[60:63]
    v_fma_f32 v27, -v91, v129, v27
    v_mfma_f32_16x16x32_bf16 v[64:67], v[160:163], v[192:195], v[64:67]
    v_fma_f32 v31, -v95, v129, v31
    v_mfma_f32_16x16x32_bf16 v[68:71], v[164:167], v[192:195], v[68:71]
    v_fma_f32 v35, -v91, v130, v35
    v_mfma_f32_16x16x32_bf16 v[72:75], v[160:163], v[196:199], v[72:75]
    v_fma_f32 v39, -v95, v130, v39
    v_mfma_f32_16x16x32_bf16 v[76:79], v[164:167], v[196:199], v[76:79]
    v_fma_f32 v43, -v91, v131, v43
    v_mfma_f32_16x16x32_bf16 v[80:83], v[160:163], v[200:203], v[80:83]
    v_fma_f32 v47, -v95, v131, v47
    v_mfma_f32_16x16x32_bf16 v[84:87], v[164:167], v[200:203], v[84:87]
    v_fma_f32 v51, -v91, v132, v51
    s_waitcnt lgkmcnt(0)
    s_barrier
    v_mfma_f32_16x16x32_bf16 v[16:19], v[204:207], v[212:215], v[16:19]
    ds_read_b128 v[160:163], v3 offset:36864
    v_mfma_f32_16x16x32_bf16 v[20:23], v[208:211], v[212:215], v[20:23]
    ds_read_b128 v[164:167], v3 offset:38912
    v_mfma_f32_16x16x32_bf16 v[24:27], v[204:207], v[216:219], v[24:27]
    ds_read_b128 v[168:171], v1 offset:36864
    v_mfma_f32_16x16x32_bf16 v[28:31], v[208:211], v[216:219], v[28:31]
    ds_read_b128 v[172:175], v1 offset:37888
    v_mfma_f32_16x16x32_bf16 v[32:35], v[204:207], v[220:223], v[32:35]
    ds_read_b128 v[176:179], v1 offset:38912
    v_mfma_f32_16x16x32_bf16 v[36:39], v[208:211], v[220:223], v[36:39]
    ds_read_b128 v[180:183], v1 offset:39936
    v_mfma_f32_16x16x32_bf16 v[40:43], v[204:207], v[224:227], v[40:43]
    ds_read_b128 v[184:187], v1 offset:40960
    v_mfma_f32_16x16x32_bf16 v[44:47], v[208:211], v[224:227], v[44:47]
    ds_read_b128 v[188:191], v1 offset:41984
    v_mfma_f32_16x16x32_bf16 v[48:51], v[204:207], v[228:231], v[48:51]
    ds_read_b128 v[192:195], v1 offset:43008
    v_mfma_f32_16x16x32_bf16 v[52:55], v[208:211], v[228:231], v[52:55]
    ds_read_b128 v[196:199], v1 offset:44032
    v_mfma_f32_16x16x32_bf16 v[56:59], v[204:207], v[232:235], v[56:59]
    ds_read_b128 v[200:203], v1 offset:45056
    v_mfma_f32_16x16x32_bf16 v[60:63], v[208:211], v[232:235], v[60:63]
    v_mfma_f32_16x16x32_bf16 v[64:67], v[204:207], v[236:239], v[64:67]
    v_mfma_f32_16x16x32_bf16 v[68:71], v[208:211], v[236:239], v[68:71]
    v_mfma_f32_16x16x32_bf16 v[72:75], v[204:207], v[240:243], v[72:75]
    v_mfma_f32_16x16x32_bf16 v[76:79], v[208:211], v[240:243], v[76:79]
    v_mfma_f32_16x16x32_bf16 v[80:83], v[204:207], v[244:247], v[80:83]
    v_mfma_f32_16x16x32_bf16 v[84:87], v[208:211], v[244:247], v[84:87]
    v_pk_mul_f32 v[220:221], v[16:17], v[16:17]
    v_pk_mul_f32 v[222:223], v[18:19], v[18:19]
    v_pk_mul_f32 v[224:225], v[20:21], v[20:21]
    v_pk_mul_f32 v[226:227], v[22:23], v[22:23]
    v_pk_fma_f32 v[220:221], v[220:221], v[112:113], v[104:105]
    v_pk_fma_f32 v[222:223], v[222:223], v[114:115], v[106:107]
    v_pk_fma_f32 v[224:225], v[224:225], v[116:117], v[108:109]
    v_pk_fma_f32 v[226:227], v[226:227], v[118:119], v[110:111]
    v_pk_mul_f32 v[220:221], v[220:221], v[16:17]
    v_pk_mul_f32 v[222:223], v[222:223], v[18:19]
    v_pk_mul_f32 v[224:225], v[224:225], v[20:21]
    v_pk_mul_f32 v[226:227], v[226:227], v[22:23]
    v_exp_f32 v220, v220
    v_exp_f32 v221, v221
    v_exp_f32 v222, v222
    v_exp_f32 v223, v223
    v_exp_f32 v224, v224
    v_exp_f32 v225, v225
    v_exp_f32 v226, v226
    v_exp_f32 v227, v227
    v_pk_fma_f32 v[220:221], v[220:221], v[120:121], v[120:121]
    v_pk_fma_f32 v[222:223], v[222:223], v[122:123], v[122:123]
    v_pk_fma_f32 v[224:225], v[224:225], v[124:125], v[124:125]
    v_pk_fma_f32 v[226:227], v[226:227], v[126:127], v[126:127]
    v_rcp_f32 v220, v220
    v_rcp_f32 v221, v221
    v_rcp_f32 v222, v222
    v_rcp_f32 v223, v223
    v_rcp_f32 v224, v224
    v_rcp_f32 v225, v225
    v_rcp_f32 v226, v226
    v_rcp_f32 v227, v227
    v_pk_mul_f32 v[16:17], v[16:17], v[220:221]
    v_pk_mul_f32 v[18:19], v[18:19], v[222:223]
    v_pk_mul_f32 v[20:21], v[20:21], v[224:225]
    v_pk_mul_f32 v[22:23], v[22:23], v[226:227]
    v_pk_mul_f32 v[206:207], v[16:17], v[16:17]
    v_pk_mul_f32 v[210:211], v[18:19], v[18:19]
    v_pk_mul_f32 v[214:215], v[20:21], v[20:21]
    v_pk_mul_f32 v[218:219], v[22:23], v[22:23]
    v_pk_mul_f32 v[228:229], v[24:25], v[24:25]
    v_pk_mul_f32 v[230:231], v[26:27], v[26:27]
    v_pk_mul_f32 v[232:233], v[28:29], v[28:29]
    v_pk_mul_f32 v[234:235], v[30:31], v[30:31]
    v_pk_fma_f32 v[228:229], v[228:229], v[112:113], v[104:105]
    v_pk_fma_f32 v[230:231], v[230:231], v[114:115], v[106:107]
    v_pk_fma_f32 v[232:233], v[232:233], v[116:117], v[108:109]
    v_pk_fma_f32 v[234:235], v[234:235], v[118:119], v[110:111]
    v_pk_mul_f32 v[228:229], v[228:229], v[24:25]
    v_pk_mul_f32 v[230:231], v[230:231], v[26:27]
    v_pk_mul_f32 v[232:233], v[232:233], v[28:29]
    v_pk_mul_f32 v[234:235], v[234:235], v[30:31]
    v_exp_f32 v228, v228
    v_exp_f32 v229, v229
    v_exp_f32 v230, v230
    v_exp_f32 v231, v231
    v_exp_f32 v232, v232
    v_exp_f32 v233, v233
    v_exp_f32 v234, v234
    v_exp_f32 v235, v235
    v_pk_fma_f32 v[228:229], v[228:229], v[120:121], v[120:121]
    v_pk_fma_f32 v[230:231], v[230:231], v[122:123], v[122:123]
    v_pk_fma_f32 v[232:233], v[232:233], v[124:125], v[124:125]
    v_pk_fma_f32 v[234:235], v[234:235], v[126:127], v[126:127]
    v_rcp_f32 v228, v228
    v_rcp_f32 v229, v229
    v_rcp_f32 v230, v230
    v_rcp_f32 v231, v231
    v_rcp_f32 v232, v232
    v_rcp_f32 v233, v233
    v_rcp_f32 v234, v234
    v_rcp_f32 v235, v235
    v_pk_mul_f32 v[24:25], v[24:25], v[228:229]
    v_pk_mul_f32 v[26:27], v[26:27], v[230:231]
    v_pk_mul_f32 v[28:29], v[28:29], v[232:233]
    v_pk_mul_f32 v[30:31], v[30:31], v[234:235]
    v_pk_add_f32 v[204:205], v[16:17], v[24:25]
    v_pk_fma_f32 v[206:207], v[24:25], v[24:25], v[206:207]
    v_pk_add_f32 v[208:209], v[18:19], v[26:27]
    v_pk_fma_f32 v[210:211], v[26:27], v[26:27], v[210:211]
    v_pk_add_f32 v[212:213], v[20:21], v[28:29]
    v_pk_fma_f32 v[214:215], v[28:29], v[28:29], v[214:215]
    v_pk_add_f32 v[216:217], v[22:23], v[30:31]
    v_pk_fma_f32 v[218:219], v[30:31], v[30:31], v[218:219]
    v_pk_mul_f32 v[220:221], v[32:33], v[32:33]
    v_pk_mul_f32 v[222:223], v[34:35], v[34:35]
    v_pk_mul_f32 v[224:225], v[36:37], v[36:37]
    v_pk_mul_f32 v[226:227], v[38:39], v[38:39]
    v_pk_fma_f32 v[220:221], v[220:221], v[112:113], v[104:105]
    v_pk_fma_f32 v[222:223], v[222:223], v[114:115], v[106:107]
    v_pk_fma_f32 v[224:225], v[224:225], v[116:117], v[108:109]
    v_pk_fma_f32 v[226:227], v[226:227], v[118:119], v[110:111]
    v_pk_mul_f32 v[220:221], v[220:221], v[32:33]
    v_pk_mul_f32 v[222:223], v[222:223], v[34:35]
    v_pk_mul_f32 v[224:225], v[224:225], v[36:37]
    v_pk_mul_f32 v[226:227], v[226:227], v[38:39]
    v_exp_f32 v220, v220
    v_exp_f32 v221, v221
    v_exp_f32 v222, v222
    v_exp_f32 v223, v223
    v_exp_f32 v224, v224
    v_exp_f32 v225, v225
    v_exp_f32 v226, v226
    v_exp_f32 v227, v227
    v_pk_fma_f32 v[220:221], v[220:221], v[120:121], v[120:121]
    v_pk_fma_f32 v[222:223], v[222:223], v[122:123], v[122:123]
    v_pk_fma_f32 v[224:225], v[224:225], v[124:125], v[124:125]
    v_pk_fma_f32 v[226:227], v[226:227], v[126:127], v[126:127]
    v_rcp_f32 v220, v220
    v_rcp_f32 v221, v221
    v_rcp_f32 v222, v222
    v_rcp_f32 v223, v223
    v_rcp_f32 v224, v224
    v_rcp_f32 v225, v225
    v_rcp_f32 v226, v226
    v_rcp_f32 v227, v227
    v_pk_mul_f32 v[32:33], v[32:33], v[220:221]
    v_pk_mul_f32 v[34:35], v[34:35], v[222:223]
    v_pk_mul_f32 v[36:37], v[36:37], v[224:225]
    v_pk_mul_f32 v[38:39], v[38:39], v[226:227]
    v_pk_add_f32 v[204:205], v[204:205], v[32:33]
    v_pk_fma_f32 v[206:207], v[32:33], v[32:33], v[206:207]
    v_pk_add_f32 v[208:209], v[208:209], v[34:35]
    v_pk_fma_f32 v[210:211], v[34:35], v[34:35], v[210:211]
    v_pk_add_f32 v[212:213], v[212:213], v[36:37]
    v_pk_fma_f32 v[214:215], v[36:37], v[36:37], v[214:215]
    v_pk_add_f32 v[216:217], v[216:217], v[38:39]
    v_pk_fma_f32 v[218:219], v[38:39], v[38:39], v[218:219]
    v_pk_mul_f32 v[228:229], v[40:41], v[40:41]
    v_pk_mul_f32 v[230:231], v[42:43], v[42:43]
    v_pk_mul_f32 v[232:233], v[44:45], v[44:45]
    v_pk_mul_f32 v[234:235], v[46:47], v[46:47]
    v_pk_fma_f32 v[228:229], v[228:229], v[112:113], v[104:105]
    v_pk_fma_f32 v[230:231], v[230:231], v[114:115], v[106:107]
    v_pk_fma_f32 v[232:233], v[232:233], v[116:117], v[108:109]
    v_pk_fma_f32 v[234:235], v[234:235], v[118:119], v[110:111]
    v_pk_mul_f32 v[228:229], v[228:229], v[40:41]
    v_pk_mul_f32 v[230:231], v[230:231], v[42:43]
    v_pk_mul_f32 v[232:233], v[232:233], v[44:45]
    v_pk_mul_f32 v[234:235], v[234:235], v[46:47]
    v_exp_f32 v228, v228
    v_exp_f32 v229, v229
    v_exp_f32 v230, v230
    v_exp_f32 v231, v231
    v_exp_f32 v232, v232
    v_exp_f32 v233, v233
    v_exp_f32 v234, v234
    v_exp_f32 v235, v235
    v_pk_fma_f32 v[228:229], v[228:229], v[120:121], v[120:121]
    v_pk_fma_f32 v[230:231], v[230:231], v[122:123], v[122:123]
    v_pk_fma_f32 v[232:233], v[232:233], v[124:125], v[124:125]
    v_pk_fma_f32 v[234:235], v[234:235], v[126:127], v[126:127]
    v_rcp_f32 v228, v228
    v_rcp_f32 v229, v229
    v_rcp_f32 v230, v230
    v_rcp_f32 v231, v231
    v_rcp_f32 v232, v232
    v_rcp_f32 v233, v233
    v_rcp_f32 v234, v234
    v_rcp_f32 v235, v235
    v_pk_mul_f32 v[40:41], v[40:41], v[228:229]
    v_pk_mul_f32 v[42:43], v[42:43], v[230:231]
    v_pk_mul_f32 v[44:45], v[44:45], v[232:233]
    v_pk_mul_f32 v[46:47], v[46:47], v[234:235]
    v_pk_add_f32 v[204:205], v[204:205], v[40:41]
    v_pk_fma_f32 v[206:207], v[40:41], v[40:41], v[206:207]
    v_pk_add_f32 v[208:209], v[208:209], v[42:43]
    v_pk_fma_f32 v[210:211], v[42:43], v[42:43], v[210:211]
    v_pk_add_f32 v[212:213], v[212:213], v[44:45]
    v_pk_fma_f32 v[214:215], v[44:45], v[44:45], v[214:215]
    v_pk_add_f32 v[216:217], v[216:217], v[46:47]
    v_pk_fma_f32 v[218:219], v[46:47], v[46:47], v[218:219]
    v_pk_mul_f32 v[220:221], v[48:49], v[48:49]
    v_pk_mul_f32 v[222:223], v[50:51], v[50:51]
    v_pk_mul_f32 v[224:225], v[52:53], v[52:53]
    v_pk_mul_f32 v[226:227], v[54:55], v[54:55]
    v_pk_fma_f32 v[220:221], v[220:221], v[112:113], v[104:105]
    v_pk_fma_f32 v[222:223], v[222:223], v[114:115], v[106:107]
    v_pk_fma_f32 v[224:225], v[224:225], v[116:117], v[108:109]
    v_pk_fma_f32 v[226:227], v[226:227], v[118:119], v[110:111]
    v_pk_mul_f32 v[220:221], v[220:221], v[48:49]
    v_pk_mul_f32 v[222:223], v[222:223], v[50:51]
    v_pk_mul_f32 v[224:225], v[224:225], v[52:53]
    v_pk_mul_f32 v[226:227], v[226:227], v[54:55]
    v_exp_f32 v220, v220
    v_exp_f32 v221, v221
    v_exp_f32 v222, v222
    v_exp_f32 v223, v223
    v_exp_f32 v224, v224
    v_exp_f32 v225, v225
    v_exp_f32 v226, v226
    v_exp_f32 v227, v227
    v_pk_fma_f32 v[220:221], v[220:221], v[120:121], v[120:121]
    v_pk_fma_f32 v[222:223], v[222:223], v[122:123], v[122:123]
    v_pk_fma_f32 v[224:225], v[224:225], v[124:125], v[124:125]
    v_pk_fma_f32 v[226:227], v[226:227], v[126:127], v[126:127]
    v_rcp_f32 v220, v220
    v_rcp_f32 v221, v221
    v_rcp_f32 v222, v222
    v_rcp_f32 v223, v223
    v_rcp_f32 v224, v224
    v_rcp_f32 v225, v225
    v_rcp_f32 v226, v226
    v_rcp_f32 v227, v227
    v_pk_mul_f32 v[48:49], v[48:49], v[220:221]
    v_pk_mul_f32 v[50:51], v[50:51], v[222:223]
    v_pk_mul_f32 v[52:53], v[52:53], v[224:225]
    v_pk_mul_f32 v[54:55], v[54:55], v[226:227]
    v_pk_add_f32 v[204:205], v[204:205], v[48:49]
    v_pk_fma_f32 v[206:207], v[48:49], v[48:49], v[206:207]
    v_pk_add_f32 v[208:209], v[208:209], v[50:51]
    v_pk_fma_f32 v[210:211], v[50:51], v[50:51], v[210:211]
    v_pk_add_f32 v[212:213], v[212:213], v[52:53]
    v_pk_fma_f32 v[214:215], v[52:53], v[52:53], v[214:215]
    v_pk_add_f32 v[216:217], v[216:217], v[54:55]
    v_pk_fma_f32 v[218:219], v[54:55], v[54:55], v[218:219]
    v_pk_mul_f32 v[228:229], v[56:57], v[56:57]
    v_pk_mul_f32 v[230:231], v[58:59], v[58:59]
    v_pk_mul_f32 v[232:233], v[60:61], v[60:61]
    v_pk_mul_f32 v[234:235], v[62:63], v[62:63]
    v_pk_fma_f32 v[228:229], v[228:229], v[112:113], v[104:105]
    v_pk_fma_f32 v[230:231], v[230:231], v[114:115], v[106:107]
    v_pk_fma_f32 v[232:233], v[232:233], v[116:117], v[108:109]
    v_pk_fma_f32 v[234:235], v[234:235], v[118:119], v[110:111]
    v_pk_mul_f32 v[228:229], v[228:229], v[56:57]
    v_pk_mul_f32 v[230:231], v[230:231], v[58:59]
    v_pk_mul_f32 v[232:233], v[232:233], v[60:61]
    v_pk_mul_f32 v[234:235], v[234:235], v[62:63]
    v_exp_f32 v228, v228
    v_exp_f32 v229, v229
    v_exp_f32 v230, v230
    v_exp_f32 v231, v231
    v_exp_f32 v232, v232
    v_exp_f32 v233, v233
    v_exp_f32 v234, v234
    v_exp_f32 v235, v235
    v_pk_fma_f32 v[228:229], v[228:229], v[120:121], v[120:121]
    v_pk_fma_f32 v[230:231], v[230:231], v[122:123], v[122:123]
    v_pk_fma_f32 v[232:233], v[232:233], v[124:125], v[124:125]
    v_pk_fma_f32 v[234:235], v[234:235], v[126:127], v[126:127]
    v_rcp_f32 v228, v228
    v_rcp_f32 v229, v229
    v_rcp_f32 v230, v230
    v_rcp_f32 v231, v231
    v_rcp_f32 v232, v232
    v_rcp_f32 v233, v233
    v_rcp_f32 v234, v234
    v_rcp_f32 v235, v235
    v_pk_mul_f32 v[56:57], v[56:57], v[228:229]
    v_pk_mul_f32 v[58:59], v[58:59], v[230:231]
    v_pk_mul_f32 v[60:61], v[60:61], v[232:233]
    v_pk_mul_f32 v[62:63], v[62:63], v[234:235]
    v_pk_add_f32 v[204:205], v[204:205], v[56:57]
    v_pk_fma_f32 v[206:207], v[56:57], v[56:57], v[206:207]
    v_pk_add_f32 v[208:209], v[208:209], v[58:59]
    v_pk_fma_f32 v[210:211], v[58:59], v[58:59], v[210:211]
    v_pk_add_f32 v[212:213], v[212:213], v[60:61]
    v_pk_fma_f32 v[214:215], v[60:61], v[60:61], v[214:215]
    v_pk_add_f32 v[216:217], v[216:217], v[62:63]
    v_pk_fma_f32 v[218:219], v[62:63], v[62:63], v[218:219]
    v_pk_mul_f32 v[220:221], v[64:65], v[64:65]
    v_pk_mul_f32 v[222:223], v[66:67], v[66:67]
    v_pk_mul_f32 v[224:225], v[68:69], v[68:69]
    v_pk_mul_f32 v[226:227], v[70:71], v[70:71]
    v_pk_fma_f32 v[220:221], v[220:221], v[112:113], v[104:105]
    v_pk_fma_f32 v[222:223], v[222:223], v[114:115], v[106:107]
    v_pk_fma_f32 v[224:225], v[224:225], v[116:117], v[108:109]
    v_pk_fma_f32 v[226:227], v[226:227], v[118:119], v[110:111]
    v_pk_mul_f32 v[220:221], v[220:221], v[64:65]
    v_pk_mul_f32 v[222:223], v[222:223], v[66:67]
    v_pk_mul_f32 v[224:225], v[224:225], v[68:69]
    v_pk_mul_f32 v[226:227], v[226:227], v[70:71]
    v_exp_f32 v220, v220
    v_exp_f32 v221, v221
    v_exp_f32 v222, v222
    v_exp_f32 v223, v223
    v_exp_f32 v224, v224
    v_exp_f32 v225, v225
    v_exp_f32 v226, v226
    v_exp_f32 v227, v227
    v_pk_fma_f32 v[220:221], v[220:221], v[120:121], v[120:121]
    v_pk_fma_f32 v[222:223], v[222:223], v[122:123], v[122:123]
    v_pk_fma_f32 v[224:225], v[224:225], v[124:125], v[124:125]
    v_pk_fma_f32 v[226:227], v[226:227], v[126:127], v[126:127]
    v_rcp_f32 v220, v220
    v_rcp_f32 v221, v221
    v_rcp_f32 v222, v222
    v_rcp_f32 v223, v223
    v_rcp_f32 v224, v224
    v_rcp_f32 v225, v225
    v_rcp_f32 v226, v226
    v_rcp_f32 v227, v227
    v_pk_mul_f32 v[64:65], v[64:65], v[220:221]
    v_pk_mul_f32 v[66:67], v[66:67], v[222:223]
    v_pk_mul_f32 v[68:69], v[68:69], v[224:225]
    v_pk_mul_f32 v[70:71], v[70:71], v[226:227]
    v_pk_add_f32 v[204:205], v[204:205], v[64:65]
    v_pk_fma_f32 v[206:207], v[64:65], v[64:65], v[206:207]
    v_pk_add_f32 v[208:209], v[208:209], v[66:67]
    v_pk_fma_f32 v[210:211], v[66:67], v[66:67], v[210:211]
    v_pk_add_f32 v[212:213], v[212:213], v[68:69]
    v_pk_fma_f32 v[214:215], v[68:69], v[68:69], v[214:215]
    v_pk_add_f32 v[216:217], v[216:217], v[70:71]
    v_pk_fma_f32 v[218:219], v[70:71], v[70:71], v[218:219]
    v_pk_mul_f32 v[228:229], v[72:73], v[72:73]
    v_pk_mul_f32 v[230:231], v[74:75], v[74:75]
    v_pk_mul_f32 v[232:233], v[76:77], v[76:77]
    v_pk_mul_f32 v[234:235], v[78:79], v[78:79]
    v_pk_fma_f32 v[228:229], v[228:229], v[112:113], v[104:105]
    v_pk_fma_f32 v[230:231], v[230:231], v[114:115], v[106:107]
    v_pk_fma_f32 v[232:233], v[232:233], v[116:117], v[108:109]
    v_pk_fma_f32 v[234:235], v[234:235], v[118:119], v[110:111]
    v_pk_mul_f32 v[228:229], v[228:229], v[72:73]
    v_pk_mul_f32 v[230:231], v[230:231], v[74:75]
    v_pk_mul_f32 v[232:233], v[232:233], v[76:77]
    v_pk_mul_f32 v[234:235], v[234:235], v[78:79]
    v_exp_f32 v228, v228
    v_exp_f32 v229, v229
    v_exp_f32 v230, v230
    v_exp_f32 v231, v231
    v_exp_f32 v232, v232
    v_exp_f32 v233, v233
    v_exp_f32 v234, v234
    v_exp_f32 v235, v235
    v_pk_fma_f32 v[228:229], v[228:229], v[120:121], v[120:121]
    v_pk_fma_f32 v[230:231], v[230:231], v[122:123], v[122:123]
    v_pk_fma_f32 v[232:233], v[232:233], v[124:125], v[124:125]
    v_pk_fma_f32 v[234:235], v[234:235], v[126:127], v[126:127]
    v_rcp_f32 v228, v228
    v_rcp_f32 v229, v229
    v_rcp_f32 v230, v230
    v_rcp_f32 v231, v231
    v_rcp_f32 v232, v232
    v_rcp_f32 v233, v233
    v_rcp_f32 v234, v234
    v_rcp_f32 v235, v235
    v_pk_mul_f32 v[72:73], v[72:73], v[228:229]
    v_pk_mul_f32 v[74:75], v[74:75], v[230:231]
    v_pk_mul_f32 v[76:77], v[76:77], v[232:233]
    v_pk_mul_f32 v[78:79], v[78:79], v[234:235]
    v_pk_add_f32 v[204:205], v[204:205], v[72:73]
    v_pk_fma_f32 v[206:207], v[72:73], v[72:73], v[206:207]
    v_pk_add_f32 v[208:209], v[208:209], v[74:75]
    v_pk_fma_f32 v[210:211], v[74:75], v[74:75], v[210:211]
    v_pk_add_f32 v[212:213], v[212:213], v[76:77]
    v_pk_fma_f32 v[214:215], v[76:77], v[76:77], v[214:215]
    v_pk_add_f32 v[216:217], v[216:217], v[78:79]
    v_pk_fma_f32 v[218:219], v[78:79], v[78:79], v[218:219]
    v_pk_mul_f32 v[220:221], v[80:81], v[80:81]
    v_pk_mul_f32 v[222:223], v[82:83], v[82:83]
    v_pk_mul_f32 v[224:225], v[84:85], v[84:85]
    v_pk_mul_f32 v[226:227], v[86:87], v[86:87]
    v_pk_fma_f32 v[220:221], v[220:221], v[112:113], v[104:105]
    v_pk_fma_f32 v[222:223], v[222:223], v[114:115], v[106:107]
    v_pk_fma_f32 v[224:225], v[224:225], v[116:117], v[108:109]
    v_pk_fma_f32 v[226:227], v[226:227], v[118:119], v[110:111]
    v_pk_mul_f32 v[220:221], v[220:221], v[80:81]
    v_pk_mul_f32 v[222:223], v[222:223], v[82:83]
    v_pk_mul_f32 v[224:225], v[224:225], v[84:85]
    v_pk_mul_f32 v[226:227], v[226:227], v[86:87]
    v_exp_f32 v220, v220
    v_exp_f32 v221, v221
    v_exp_f32 v222, v222
    v_exp_f32 v223, v223
    v_exp_f32 v224, v224
    v_exp_f32 v225, v225
    v_exp_f32 v226, v226
    v_exp_f32 v227, v227
    v_pk_fma_f32 v[220:221], v[220:221], v[120:121], v[120:121]
    v_pk_fma_f32 v[222:223], v[222:223], v[122:123], v[122:123]
    v_pk_fma_f32 v[224:225], v[224:225], v[124:125], v[124:125]
    v_pk_fma_f32 v[226:227], v[226:227], v[126:127], v[126:127]
    v_rcp_f32 v220, v220
    v_rcp_f32 v221, v221
    v_rcp_f32 v222, v222
    v_rcp_f32 v223, v223
    v_rcp_f32 v224, v224
    v_rcp_f32 v225, v225
    v_rcp_f32 v226, v226
    v_rcp_f32 v227, v227
    v_pk_mul_f32 v[80:81], v[80:81], v[220:221]
    v_pk_mul_f32 v[82:83], v[82:83], v[222:223]
    v_pk_mul_f32 v[84:85], v[84:85], v[224:225]
    v_pk_mul_f32 v[86:87], v[86:87], v[226:227]
    v_pk_add_f32 v[204:205], v[204:205], v[80:81]
    v_pk_fma_f32 v[206:207], v[80:81], v[80:81], v[206:207]
    v_pk_add_f32 v[208:209], v[208:209], v[82:83]
    v_pk_fma_f32 v[210:211], v[82:83], v[82:83], v[210:211]
    v_pk_add_f32 v[212:213], v[212:213], v[84:85]
    v_pk_fma_f32 v[214:215], v[84:85], v[84:85], v[214:215]
    v_pk_add_f32 v[216:217], v[216:217], v[86:87]
    v_pk_fma_f32 v[218:219], v[86:87], v[86:87], v[218:219]
    v_add_f32_dpp v204, v204, v204 row_mirror row_mask:0xf bank_mask:0x3
    v_add_f32_dpp v205, v205, v205 row_mirror row_mask:0xf bank_mask:0x3
    v_add_f32_dpp v206, v206, v206 row_mirror row_mask:0xf bank_mask:0x3
    v_add_f32_dpp v207, v207, v207 row_mirror row_mask:0xf bank_mask:0x3
    v_add_f32_dpp v208, v208, v208 row_mirror row_mask:0xf bank_mask:0x3
    v_add_f32_dpp v209, v209, v209 row_mirror row_mask:0xf bank_mask:0x3
    v_add_f32_dpp v210, v210, v210 row_mirror row_mask:0xf bank_mask:0x3
    v_add_f32_dpp v211, v211, v211 row_mirror row_mask:0xf bank_mask:0x3
    v_add_f32_dpp v204, v212, v212 row_mirror row_mask:0xf bank_mask:0xc
    v_add_f32_dpp v205, v213, v213 row_mirror row_mask:0xf bank_mask:0xc
    v_add_f32_dpp v206, v214, v214 row_mirror row_mask:0xf bank_mask:0xc
    v_add_f32_dpp v207, v215, v215 row_mirror row_mask:0xf bank_mask:0xc
    v_add_f32_dpp v208, v216, v216 row_mirror row_mask:0xf bank_mask:0xc
    v_add_f32_dpp v209, v217, v217 row_mirror row_mask:0xf bank_mask:0xc
    v_add_f32_dpp v210, v218, v218 row_mirror row_mask:0xf bank_mask:0xc
    v_add_f32_dpp v211, v219, v219 row_mirror row_mask:0xf bank_mask:0xc
    v_add_f32_dpp v204, v204, v204 row_half_mirror row_mask:0xf bank_mask:0x5
    v_add_f32_dpp v205, v205, v205 row_half_mirror row_mask:0xf bank_mask:0x5
    v_add_f32_dpp v206, v206, v206 row_half_mirror row_mask:0xf bank_mask:0x5
    v_add_f32_dpp v207, v207, v207 row_half_mirror row_mask:0xf bank_mask:0x5
    v_add_f32_dpp v204, v208, v208 row_half_mirror row_mask:0xf bank_mask:0xa
    v_add_f32_dpp v205, v209, v209 row_half_mirror row_mask:0xf bank_mask:0xa
    v_add_f32_dpp v206, v210, v210 row_half_mirror row_mask:0xf bank_mask:0xa
    v_add_f32_dpp v207, v211, v211 row_half_mirror row_mask:0xf bank_mask:0xa
    v_add_f32_dpp v204, v204, v204 quad_perm:[1,0,3,2] row_mask:0xf bank_mask:0xf
    v_add_f32_dpp v205, v205, v205 quad_perm:[1,0,3,2] row_mask:0xf bank_mask:0xf
    v_add_f32_dpp v206, v206, v206 quad_perm:[1,0,3,2] row_mask:0xf bank_mask:0xf
    v_add_f32_dpp v207, v207, v207 quad_perm:[1,0,3,2] row_mask:0xf bank_mask:0xf
    v_add_f32_dpp v12, v204, v204 quad_perm:[2,3,0,1] row_mask:0xf bank_mask:0xf
    v_add_f32_dpp v14, v205, v205 quad_perm:[2,3,0,1] row_mask:0xf bank_mask:0xf
    v_add_f32_dpp v13, v206, v206 quad_perm:[2,3,0,1] row_mask:0xf bank_mask:0xf
    v_add_f32_dpp v15, v207, v207 quad_perm:[2,3,0,1] row_mask:0xf bank_mask:0xf
    buffer_store_dwordx4 v[12:15], v8, s[4:7], s36 offen sc1
    s_waitcnt lgkmcnt(5)
    v_mfma_f32_16x16x32_bf16 v[88:91], v[168:171], v[160:163], 0
    ds_read_b128 v[204:207], v3 offset:37888
    v_mfma_f32_16x16x32_bf16 v[92:95], v[168:171], v[164:167], 0
    ds_read_b128 v[208:211], v3 offset:39936
    v_mfma_f32_16x16x32_bf16 v[96:99], v[172:175], v[160:163], 0
    ds_read_b128 v[212:215], v1 offset:46080
    v_mfma_f32_16x16x32_bf16 v[100:103], v[172:175], v[164:167], 0
    ds_read_b128 v[216:219], v1 offset:47104
    v_mfma_f32_16x16x32_bf16 v[104:107], v[176:179], v[160:163], 0
    ds_read_b128 v[220:223], v1 offset:48128
    v_mfma_f32_16x16x32_bf16 v[108:111], v[176:179], v[164:167], 0
    ds_read_b128 v[224:227], v1 offset:49152
    v_mfma_f32_16x16x32_bf16 v[112:115], v[180:183], v[160:163], 0
    ds_read_b128 v[228:231], v1 offset:50176
    v_mfma_f32_16x16x32_bf16 v[116:119], v[180:183], v[164:167], 0
    ds_read_b128 v[232:235], v1 offset:51200
    s_waitcnt lgkmcnt(8)
    v_mfma_f32_16x16x32_bf16 v[120:123], v[184:187], v[160:163], 0
    ds_read_b128 v[236:239], v1 offset:52224
    v_mfma_f32_16x16x32_bf16 v[124:127], v[184:187], v[164:167], 0
    ds_read_b128 v[240:243], v1 offset:53248
    v_mfma_f32_16x16x32_bf16 v[128:131], v[188:191], v[160:163], 0
    ds_read_b128 v[244:247], v1 offset:54272
    v_mfma_f32_16x16x32_bf16 v[132:135], v[188:191], v[164:167], 0
    v_mfma_f32_16x16x32_bf16 v[136:139], v[192:195], v[160:163], 0
    v_lshrrev_b32 v255, 8, v1
    v_mfma_f32_16x16x32_bf16 v[140:143], v[192:195], v[164:167], 0
    v_lshl_add_u32 v255, v255, 6, s33
    v_mfma_f32_16x16x32_bf16 v[144:147], v[196:199], v[160:163], 0
    v_mfma_f32_16x16x32_bf16 v[148:151], v[196:199], v[164:167], 0
    v_mfma_f32_16x16x32_bf16 v[152:155], v[200:203], v[160:163], 0
    v_mfma_f32_16x16x32_bf16 v[156:159], v[200:203], v[164:167], 0
    s_waitcnt lgkmcnt(0)
    s_barrier
    v_mfma_f32_16x16x32_bf16 v[88:91], v[212:215], v[204:207], v[88:91]
    ds_read_b128 v[160:163], v0 offset:0
    v_mfma_f32_16x16x32_bf16 v[92:95], v[212:215], v[208:211], v[92:95]
    ds_read_b128 v[164:167], v0 offset:2048
    v_mfma_f32_16x16x32_bf16 v[96:99], v[216:219], v[204:207], v[96:99]
    ds_read_b128 v[168:171], v2 offset:0
    v_mfma_f32_16x16x32_bf16 v[100:103], v[216:219], v[208:211], v[100:103]
    ds_read_b128 v[172:175], v2 offset:1024
    v_mfma_f32_16x16x32_bf16 v[104:107], v[220:223], v[204:207], v[104:107]
    ds_read_b128 v[176:179], v2 offset:2048
    v_mfma_f32_16x16x32_bf16 v[108:111], v[220:223], v[208:211], v[108:111]
    ds_read_b128 v[180:183], v2 offset:3072
    v_mfma_f32_16x16x32_bf16 v[112:115], v[224:227], v[204:207], v[112:115]
    ds_read_b128 v[184:187], v2 offset:4096
    v_mfma_f32_16x16x32_bf16 v[116:119], v[224:227], v[208:211], v[116:119]
    ds_read_b128 v[188:191], v2 offset:5120
    v_mfma_f32_16x16x32_bf16 v[120:123], v[228:231], v[204:207], v[120:123]
    ds_read_b128 v[192:195], v2 offset:6144
    v_mfma_f32_16x16x32_bf16 v[124:127], v[228:231], v[208:211], v[124:127]
    ds_read_b128 v[196:199], v2 offset:7168
    v_mfma_f32_16x16x32_bf16 v[128:131], v[232:235], v[204:207], v[128:131]
    ds_read_b128 v[200:203], v2 offset:8192
    v_mfma_f32_16x16x32_bf16 v[132:135], v[232:235], v[208:211], v[132:135]
    v_mfma_f32_16x16x32_bf16 v[136:139], v[236:239], v[204:207], v[136:139]
    v_mfma_f32_16x16x32_bf16 v[140:143], v[236:239], v[208:211], v[140:143]
    v_mfma_f32_16x16x32_bf16 v[144:147], v[240:243], v[204:207], v[144:147]
    v_mfma_f32_16x16x32_bf16 v[148:151], v[240:243], v[208:211], v[148:151]
    v_mfma_f32_16x16x32_bf16 v[152:155], v[244:247], v[204:207], v[152:155]
    v_mfma_f32_16x16x32_bf16 v[156:159], v[244:247], v[208:211], v[156:159]
    s_waitcnt lgkmcnt(5)
    v_mfma_f32_16x16x32_bf16 v[88:91], v[168:171], v[160:163], v[88:91]
    ds_read_b128 v[204:207], v0 offset:1024
    v_mfma_f32_16x16x32_bf16 v[92:95], v[168:171], v[164:167], v[92:95]
    ds_read_b128 v[208:211], v0 offset:3072
    v_mfma_f32_16x16x32_bf16 v[96:99], v[172:175], v[160:163], v[96:99]
    ds_read_b128 v[212:215], v2 offset:9216
    v_mfma_f32_16x16x32_bf16 v[100:103], v[172:175], v[164:167], v[100:103]
    ds_read_b128 v[216:219], v2 offset:10240
    v_mfma_f32_16x16x32_bf16 v[104:107], v[176:179], v[160:163], v[104:107]
    ds_read_b128 v[220:223], v2 offset:11264
    v_mfma_f32_16x16x32_bf16 v[108:111], v[176:179], v[164:167], v[108:111]
    ds_read_b128 v[224:227], v2 offset:12288
    v_mfma_f32_16x16x32_bf16 v[112:115], v[180:183], v[160:163], v[112:115]
    ds_read_b128 v[228:231], v2 offset:13312
    v_mfma_f32_16x16x32_bf16 v[116:119], v[180:183], v[164:167], v[116:119]
    ds_read_b128 v[232:235], v2 offset:14336
    s_waitcnt lgkmcnt(8)
    v_mfma_f32_16x16x32_bf16 v[120:123], v[184:187], v[160:163], v[120:123]
    ds_read_b128 v[236:239], v2 offset:15360
    v_mfma_f32_16x16x32_bf16 v[124:127], v[184:187], v[164:167], v[124:127]
    ds_read_b128 v[240:243], v2 offset:16384
    v_mfma_f32_16x16x32_bf16 v[128:131], v[188:191], v[160:163], v[128:131]
    ds_read_b128 v[244:247], v2 offset:17408
    v_mfma_f32_16x16x32_bf16 v[132:135], v[188:191], v[164:167], v[132:135]
    v_mfma_f32_16x16x32_bf16 v[136:139], v[192:195], v[160:163], v[136:139]
    v_mfma_f32_16x16x32_bf16 v[140:143], v[192:195], v[164:167], v[140:143]
    v_mfma_f32_16x16x32_bf16 v[144:147], v[196:199], v[160:163], v[144:147]
    v_mfma_f32_16x16x32_bf16 v[148:151], v[196:199], v[164:167], v[148:151]
    v_mfma_f32_16x16x32_bf16 v[152:155], v[200:203], v[160:163], v[152:155]
    v_mfma_f32_16x16x32_bf16 v[156:159], v[200:203], v[164:167], v[156:159]
    s_waitcnt lgkmcnt(0)
    s_barrier
    v_mfma_f32_16x16x32_bf16 v[88:91], v[212:215], v[204:207], v[88:91]
    ds_read_b128 v[160:163], v0 offset:36864
    v_mfma_f32_16x16x32_bf16 v[92:95], v[212:215], v[208:211], v[92:95]
    ds_read_b128 v[164:167], v0 offset:38912
    v_mfma_f32_16x16x32_bf16 v[96:99], v[216:219], v[204:207], v[96:99]
    ds_read_b128 v[168:171], v2 offset:36864
    v_mfma_f32_16x16x32_bf16 v[100:103], v[216:219], v[208:211], v[100:103]
    ds_read_b128 v[172:175], v2 offset:37888
    v_mfma_f32_16x16x32_bf16 v[104:107], v[220:223], v[204:207], v[104:107]
    ds_read_b128 v[176:179], v2 offset:38912
    v_mfma_f32_16x16x32_bf16 v[108:111], v[220:223], v[208:211], v[108:111]
    ds_read_b128 v[180:183], v2 offset:39936
    v_mfma_f32_16x16x32_bf16 v[112:115], v[224:227], v[204:207], v[112:115]
    ds_read_b128 v[184:187], v2 offset:40960
    v_mfma_f32_16x16x32_bf16 v[116:119], v[224:227], v[208:211], v[116:119]
    ds_read_b128 v[188:191], v2 offset:41984
    v_mfma_f32_16x16x32_bf16 v[120:123], v[228:231], v[204:207], v[120:123]
    ds_read_b128 v[192:195], v2 offset:43008
    v_mfma_f32_16x16x32_bf16 v[124:127], v[228:231], v[208:211], v[124:127]
    ds_read_b128 v[196:199], v2 offset:44032
    v_mfma_f32_16x16x32_bf16 v[128:131], v[232:235], v[204:207], v[128:131]
    ds_read_b128 v[200:203], v2 offset:45056
    v_mfma_f32_16x16x32_bf16 v[132:135], v[232:235], v[208:211], v[132:135]
    v_mfma_f32_16x16x32_bf16 v[136:139], v[236:239], v[204:207], v[136:139]
    v_mfma_f32_16x16x32_bf16 v[140:143], v[236:239], v[208:211], v[140:143]
    v_mfma_f32_16x16x32_bf16 v[144:147], v[240:243], v[204:207], v[144:147]
    v_mfma_f32_16x16x32_bf16 v[148:151], v[240:243], v[208:211], v[148:151]
    v_mfma_f32_16x16x32_bf16 v[152:155], v[244:247], v[204:207], v[152:155]
    v_mfma_f32_16x16x32_bf16 v[156:159], v[244:247], v[208:211], v[156:159]
    s_waitcnt lgkmcnt(5)
    v_mfma_f32_16x16x32_bf16 v[88:91], v[168:171], v[160:163], v[88:91]
    ds_read_b128 v[204:207], v0 offset:37888
    v_mfma_f32_16x16x32_bf16 v[92:95], v[168:171], v[164:167], v[92:95]
    ds_read_b128 v[208:211], v0 offset:39936
    v_mfma_f32_16x16x32_bf16 v[96:99], v[172:175], v[160:163], v[96:99]
    ds_read_b128 v[212:215], v2 offset:46080
    v_mfma_f32_16x16x32_bf16 v[100:103], v[172:175], v[164:167], v[100:103]
    ds_read_b128 v[216:219], v2 offset:47104
    v_mfma_f32_16x16x32_bf16 v[104:107], v[176:179], v[160:163], v[104:107]
    ds_read_b128 v[220:223], v2 offset:48128
    v_mfma_f32_16x16x32_bf16 v[108:111], v[176:179], v[164:167], v[108:111]
    ds_read_b128 v[224:227], v2 offset:49152
    v_mfma_f32_16x16x32_bf16 v[112:115], v[180:183], v[160:163], v[112:115]
    ds_read_b128 v[228:231], v2 offset:50176
    v_mfma_f32_16x16x32_bf16 v[116:119], v[180:183], v[164:167], v[116:119]
    ds_read_b128 v[232:235], v2 offset:51200
    s_waitcnt lgkmcnt(8)
    v_mfma_f32_16x16x32_bf16 v[120:123], v[184:187], v[160:163], v[120:123]
    ds_read_b128 v[236:239], v2 offset:52224
    v_mfma_f32_16x16x32_bf16 v[124:127], v[184:187], v[164:167], v[124:127]
    ds_read_b128 v[240:243], v2 offset:53248
    v_mfma_f32_16x16x32_bf16 v[128:131], v[188:191], v[160:163], v[128:131]
    ds_read_b128 v[244:247], v2 offset:54272
    v_mfma_f32_16x16x32_bf16 v[132:135], v[188:191], v[164:167], v[132:135]
    v_mfma_f32_16x16x32_bf16 v[136:139], v[192:195], v[160:163], v[136:139]
    v_mfma_f32_16x16x32_bf16 v[140:143], v[192:195], v[164:167], v[140:143]
    v_mfma_f32_16x16x32_bf16 v[144:147], v[196:199], v[160:163], v[144:147]
    v_mfma_f32_16x16x32_bf16 v[148:151], v[196:199], v[164:167], v[148:151]
    v_mfma_f32_16x16x32_bf16 v[152:155], v[200:203], v[160:163], v[152:155]
    v_mfma_f32_16x16x32_bf16 v[156:159], v[200:203], v[164:167], v[156:159]
    s_waitcnt lgkmcnt(0)
    s_barrier
    v_mfma_f32_16x16x32_bf16 v[88:91], v[212:215], v[204:207], v[88:91]
    ds_read_b128 v[160:163], v3 offset:0
    v_mfma_f32_16x16x32_bf16 v[92:95], v[212:215], v[208:211], v[92:95]
    ds_read_b128 v[164:167], v3 offset:2048
    v_mfma_f32_16x16x32_bf16 v[96:99], v[216:219], v[204:207], v[96:99]
    ds_read_b128 v[168:171], v1 offset:0
    v_mfma_f32_16x16x32_bf16 v[100:103], v[216:219], v[208:211], v[100:103]
    ds_read_b128 v[172:175], v1 offset:1024
    v_mfma_f32_16x16x32_bf16 v[104:107], v[220:223], v[204:207], v[104:107]
    ds_read_b128 v[176:179], v1 offset:2048
    v_mfma_f32_16x16x32_bf16 v[108:111], v[220:223], v[208:211], v[108:111]
    ds_read_b128 v[180:183], v1 offset:3072
    v_mfma_f32_16x16x32_bf16 v[112:115], v[224:227], v[204:207], v[112:115]
    ds_read_b128 v[184:187], v1 offset:4096
    v_mfma_f32_16x16x32_bf16 v[116:119], v[224:227], v[208:211], v[116:119]
    ds_read_b128 v[188:191], v1 offset:5120
    v_mfma_f32_16x16x32_bf16 v[120:123], v[228:231], v[204:207], v[120:123]
    ds_read_b128 v[192:195], v1 offset:6144
    v_mfma_f32_16x16x32_bf16 v[124:127], v[228:231], v[208:211], v[124:127]
    ds_read_b128 v[196:199], v1 offset:7168
    v_mfma_f32_16x16x32_bf16 v[128:131], v[232:235], v[204:207], v[128:131]
    ds_read_b128 v[200:203], v1 offset:8192
    v_mfma_f32_16x16x32_bf16 v[132:135], v[232:235], v[208:211], v[132:135]
    v_mfma_f32_16x16x32_bf16 v[136:139], v[236:239], v[204:207], v[136:139]
    v_mfma_f32_16x16x32_bf16 v[140:143], v[236:239], v[208:211], v[140:143]
    v_mfma_f32_16x16x32_bf16 v[144:147], v[240:243], v[204:207], v[144:147]
    v_mfma_f32_16x16x32_bf16 v[148:151], v[240:243], v[208:211], v[148:151]
    v_mfma_f32_16x16x32_bf16 v[152:155], v[244:247], v[204:207], v[152:155]
    v_mfma_f32_16x16x32_bf16 v[156:159], v[244:247], v[208:211], v[156:159]
    s_waitcnt lgkmcnt(5)
    v_mfma_f32_16x16x32_bf16 v[88:91], v[168:171], v[160:163], v[88:91]
    ds_read_b128 v[204:207], v3 offset:1024
    v_mfma_f32_16x16x32_bf16 v[92:95], v[168:171], v[164:167], v[92:95]
    ds_read_b128 v[208:211], v3 offset:3072
    v_mfma_f32_16x16x32_bf16 v[96:99], v[172:175], v[160:163], v[96:99]
    ds_read_b128 v[212:215], v1 offset:9216
    v_mfma_f32_16x16x32_bf16 v[100:103], v[172:175], v[164:167], v[100:103]
    ds_read_b128 v[216:219], v1 offset:10240
    v_mfma_f32_16x16x32_bf16 v[104:107], v[176:179], v[160:163], v[104:107]
    ds_read_b128 v[220:223], v1 offset:11264
    v_mfma_f32_16x16x32_bf16 v[108:111], v[176:179], v[164:167], v[108:111]
    ds_read_b128 v[224:227], v1 offset:12288
    v_mfma_f32_16x16x32_bf16 v[112:115], v[180:183], v[160:163], v[112:115]
    ds_read_b128 v[228:231], v1 offset:13312
    v_mfma_f32_16x16x32_bf16 v[116:119], v[180:183], v[164:167], v[116:119]
    ds_read_b128 v[232:235], v1 offset:14336
    s_waitcnt lgkmcnt(8)
    v_mfma_f32_16x16x32_bf16 v[120:123], v[184:187], v[160:163], v[120:123]
    ds_read_b128 v[236:239], v1 offset:15360
    v_mfma_f32_16x16x32_bf16 v[124:127], v[184:187], v[164:167], v[124:127]
    ds_read_b128 v[240:243], v1 offset:16384
    v_mfma_f32_16x16x32_bf16 v[128:131], v[188:191], v[160:163], v[128:131]
    ds_read_b128 v[244:247], v1 offset:17408
    v_mfma_f32_16x16x32_bf16 v[132:135], v[188:191], v[164:167], v[132:135]
    v_mfma_f32_16x16x32_bf16 v[136:139], v[192:195], v[160:163], v[136:139]
    v_mfma_f32_16x16x32_bf16 v[140:143], v[192:195], v[164:167], v[140:143]
    v_mfma_f32_16x16x32_bf16 v[144:147], v[196:199], v[160:163], v[144:147]
    v_mfma_f32_16x16x32_bf16 v[148:151], v[196:199], v[164:167], v[148:151]
    v_mfma_f32_16x16x32_bf16 v[152:155], v[200:203], v[160:163], v[152:155]
    v_mfma_f32_16x16x32_bf16 v[156:159], v[200:203], v[164:167], v[156:159]
    s_waitcnt lgkmcnt(0)
    s_barrier
    v_mfma_f32_16x16x32_bf16 v[88:91], v[212:215], v[204:207], v[88:91]
    ds_read_b128 v[160:163], v3 offset:36864
    v_mfma_f32_16x16x32_bf16 v[92:95], v[212:215], v[208:211], v[92:95]
    ds_read_b128 v[164:167], v3 offset:38912
    v_mfma_f32_16x16x32_bf16 v[96:99], v[216:219], v[204:207], v[96:99]
    ds_read_b128 v[168:171], v1 offset:36864
    v_mfma_f32_16x16x32_bf16 v[100:103], v[216:219], v[208:211], v[100:103]
    ds_read_b128 v[172:175], v1 offset:37888
    v_mfma_f32_16x16x32_bf16 v[104:107], v[220:223], v[204:207], v[104:107]
    ds_read_b128 v[176:179], v1 offset:38912
    v_mfma_f32_16x16x32_bf16 v[108:111], v[220:223], v[208:211], v[108:111]
    ds_read_b128 v[180:183], v1 offset:39936
    v_mfma_f32_16x16x32_bf16 v[112:115], v[224:227], v[204:207], v[112:115]
    ds_read_b128 v[184:187], v1 offset:40960
    v_mfma_f32_16x16x32_bf16 v[116:119], v[224:227], v[208:211], v[116:119]
    ds_read_b128 v[188:191], v1 offset:41984
    v_mfma_f32_16x16x32_bf16 v[120:123], v[228:231], v[204:207], v[120:123]
    ds_read_b128 v[192:195], v1 offset:43008
    v_mfma_f32_16x16x32_bf16 v[124:127], v[228:231], v[208:211], v[124:127]
    ds_read_b128 v[196:199], v1 offset:44032
    v_mfma_f32_16x16x32_bf16 v[128:131], v[232:235], v[204:207], v[128:131]
    ds_read_b128 v[200:203], v1 offset:45056
    v_mfma_f32_16x16x32_bf16 v[132:135], v[232:235], v[208:211], v[132:135]
    ds_read_b128 v[4:7], v255 offset:1024
    v_mfma_f32_16x16x32_bf16 v[136:139], v[236:239], v[204:207], v[136:139]
    ds_read_b128 v[8:11], v255 offset:1040
    v_mfma_f32_16x16x32_bf16 v[140:143], v[236:239], v[208:211], v[140:143]
    ds_read_b128 v[12:15], v255 offset:1056
    v_mfma_f32_16x16x32_bf16 v[144:147], v[240:243], v[204:207], v[144:147]
    ds_read_b128 v[252:255], v255 offset:1072
    v_mfma_f32_16x16x32_bf16 v[148:151], v[240:243], v[208:211], v[148:151]
    v_mfma_f32_16x16x32_bf16 v[152:155], v[244:247], v[204:207], v[152:155]
    v_mfma_f32_16x16x32_bf16 v[156:159], v[244:247], v[208:211], v[156:159]
    s_waitcnt lgkmcnt(9)
    v_mfma_f32_16x16x32_bf16 v[88:91], v[168:171], v[160:163], v[88:91]
    ds_read_b128 v[204:207], v3 offset:37888
    v_mfma_f32_16x16x32_bf16 v[92:95], v[168:171], v[164:167], v[92:95]
    ds_read_b128 v[208:211], v3 offset:39936
    v_mfma_f32_16x16x32_bf16 v[96:99], v[172:175], v[160:163], v[96:99]
    ds_read_b128 v[212:215], v1 offset:46080
    v_mfma_f32_16x16x32_bf16 v[100:103], v[172:175], v[164:167], v[100:103]
    ds_read_b128 v[216:219], v1 offset:47104
    v_mfma_f32_16x16x32_bf16 v[104:107], v[176:179], v[160:163], v[104:107]
    ds_read_b128 v[220:223], v1 offset:48128
    v_mfma_f32_16x16x32_bf16 v[108:111], v[176:179], v[164:167], v[108:111]
    ds_read_b128 v[224:227], v1 offset:49152
    v_mfma_f32_16x16x32_bf16 v[112:115], v[180:183], v[160:163], v[112:115]
    ds_read_b128 v[228:231], v1 offset:50176
    v_mfma_f32_16x16x32_bf16 v[116:119], v[180:183], v[164:167], v[116:119]
    ds_read_b128 v[232:235], v1 offset:51200
    s_waitcnt lgkmcnt(8)
    v_mfma_f32_16x16x32_bf16 v[120:123], v[184:187], v[160:163], v[120:123]
    ds_read_b128 v[236:239], v1 offset:52224
    v_fma_f32 v16, v16, v4, -v6
    v_mfma_f32_16x16x32_bf16 v[124:127], v[184:187], v[164:167], v[124:127]
    ds_read_b128 v[240:243], v1 offset:53248
    v_fma_f32 v17, v17, v5, -v7
    v_mfma_f32_16x16x32_bf16 v[128:131], v[188:191], v[160:163], v[128:131]
    ds_read_b128 v[244:247], v1 offset:54272
    v_fma_f32 v18, v18, v8, -v10
    v_mfma_f32_16x16x32_bf16 v[132:135], v[188:191], v[164:167], v[132:135]
    v_fma_f32 v19, v19, v9, -v11
    v_fma_f32 v20, v20, v12, -v14
    v_mfma_f32_16x16x32_bf16 v[136:139], v[192:195], v[160:163], v[136:139]
    v_fma_f32 v21, v21, v13, -v15
    v_fma_f32 v22, v22, v252, -v254
    v_mfma_f32_16x16x32_bf16 v[140:143], v[192:195], v[164:167], v[140:143]
    v_fma_f32 v23, v23, v253, -v255
    v_cvt_pk_bf16_f32 v16, v16, v17
    v_mfma_f32_16x16x32_bf16 v[144:147], v[196:199], v[160:163], v[144:147]
    v_cvt_pk_bf16_f32 v17, v18, v19
    v_cvt_pk_bf16_f32 v18, v20, v21
    v_mfma_f32_16x16x32_bf16 v[148:151], v[196:199], v[164:167], v[148:151]
    v_cvt_pk_bf16_f32 v19, v22, v23
    v_fma_f32 v24, v24, v4, -v6
    v_mfma_f32_16x16x32_bf16 v[152:155], v[200:203], v[160:163], v[152:155]
    v_fma_f32 v25, v25, v5, -v7
    v_fma_f32 v26, v26, v8, -v10
    v_mfma_f32_16x16x32_bf16 v[156:159], v[200:203], v[164:167], v[156:159]
    v_fma_f32 v27, v27, v9, -v11
    s_waitcnt lgkmcnt(0)
    s_barrier
    v_mfma_f32_16x16x32_bf16 v[88:91], v[212:215], v[204:207], v[88:91]
    ds_read_b128 v[160:163], v0 offset:0
    v_mfma_f32_16x16x32_bf16 v[92:95], v[212:215], v[208:211], v[92:95]
    ds_read_b128 v[164:167], v0 offset:2048
    v_fma_f32 v28, v28, v12, -v14
    v_mfma_f32_16x16x32_bf16 v[96:99], v[216:219], v[204:207], v[96:99]
    ds_read_b128 v[168:171], v2 offset:0
    v_fma_f32 v29, v29, v13, -v15
    v_mfma_f32_16x16x32_bf16 v[100:103], v[216:219], v[208:211], v[100:103]
    ds_read_b128 v[172:175], v2 offset:1024
    v_fma_f32 v30, v30, v252, -v254
    v_mfma_f32_16x16x32_bf16 v[104:107], v[220:223], v[204:207], v[104:107]
    ds_read_b128 v[176:179], v2 offset:2048
    v_fma_f32 v31, v31, v253, -v255
    v_mfma_f32_16x16x32_bf16 v[108:111], v[220:223], v[208:211], v[108:111]
    ds_read_b128 v[180:183], v2 offset:3072
    v_permlane32_swap_b32 v16, v18
    v_mfma_f32_16x16x32_bf16 v[112:115], v[224:227], v[204:207], v[112:115]
    ds_read_b128 v[184:187], v2 offset:4096
    v_permlane32_swap_b32 v17, v19
    v_mfma_f32_16x16x32_bf16 v[116:119], v[224:227], v[208:211], v[116:119]
    ds_read_b128 v[188:191], v2 offset:5120
    v_mfma_f32_16x16x32_bf16 v[120:123], v[228:231], v[204:207], v[120:123]
    ds_read_b128 v[192:195], v2 offset:6144
    v_cvt_pk_bf16_f32 v24, v24, v25
    v_mfma_f32_16x16x32_bf16 v[124:127], v[228:231], v[208:211], v[124:127]
    ds_read_b128 v[196:199], v2 offset:7168
    v_cvt_pk_bf16_f32 v25, v26, v27
    v_mfma_f32_16x16x32_bf16 v[128:131], v[232:235], v[204:207], v[128:131]
    ds_read_b128 v[200:203], v2 offset:8192
    v_cvt_pk_bf16_f32 v26, v28, v29
    v_mfma_f32_16x16x32_bf16 v[132:135], v[232:235], v[208:211], v[132:135]
    v_cvt_pk_bf16_f32 v27, v30, v31
    v_permlane16_swap_b32 v16, v18
    v_mfma_f32_16x16x32_bf16 v[136:139], v[236:239], v[204:207], v[136:139]
    v_permlane16_swap_b32 v17, v19
    v_fma_f32 v32, v32, v4, -v6
    v_mfma_f32_16x16x32_bf16 v[140:143], v[236:239], v[208:211], v[140:143]
    v_fma_f32 v33, v33, v5, -v7
    v_fma_f32 v34, v34, v8, -v10
    v_mfma_f32_16x16x32_bf16 v[144:147], v[240:243], v[204:207], v[144:147]
    v_fma_f32 v35, v35, v9, -v11
    v_fma_f32 v36, v36, v12, -v14
    v_mfma_f32_16x16x32_bf16 v[148:151], v[240:243], v[208:211], v[148:151]
    v_fma_f32 v37, v37, v13, -v15
    v_fma_f32 v38, v38, v252, -v254
    v_mfma_f32_16x16x32_bf16 v[152:155], v[244:247], v[204:207], v[152:155]
    v_fma_f32 v39, v39, v253, -v255
    v_permlane32_swap_b32 v24, v26
    v_mfma_f32_16x16x32_bf16 v[156:159], v[244:247], v[208:211], v[156:159]
    v_permlane32_swap_b32 v25, v27
    s_waitcnt lgkmcnt(5)
    v_mfma_f32_16x16x32_bf16 v[88:91], v[168:171], v[160:163], v[88:91]
    ds_read_b128 v[204:207], v0 offset:1024
    v_mfma_f32_16x16x32_bf16 v[92:95], v[168:171], v[164:167], v[92:95]
    ds_read_b128 v[208:211], v0 offset:3072
    v_cvt_pk_bf16_f32 v32, v32, v33
    v_mfma_f32_16x16x32_bf16 v[96:99], v[172:175], v[160:163], v[96:99]
    ds_read_b128 v[212:215], v2 offset:9216
    v_cvt_pk_bf16_f32 v33, v34, v35
    v_mfma_f32_16x16x32_bf16 v[100:103], v[172:175], v[164:167], v[100:103]
    ds_read_b128 v[216:219], v2 offset:10240
    v_cvt_pk_bf16_f32 v34, v36, v37
    v_mfma_f32_16x16x32_bf16 v[104:107], v[176:179], v[160:163], v[104:107]
    ds_read_b128 v[220:223], v2 offset:11264
    v_cvt_pk_bf16_f32 v35, v38, v39
    v_mfma_f32_16x16x32_bf16 v[108:111], v[176:179], v[164:167], v[108:111]
    ds_read_b128 v[224:227], v2 offset:12288
    v_permlane16_swap_b32 v24, v26
    v_mfma_f32_16x16x32_bf16 v[112:115], v[180:183], v[160:163], v[112:115]
    ds_read_b128 v[228:231], v2 offset:13312
    v_permlane16_swap_b32 v25, v27
    v_mfma_f32_16x16x32_bf16 v[116:119], v[180:183], v[164:167], v[116:119]
    ds_read_b128 v[232:235], v2 offset:14336
    s_waitcnt lgkmcnt(8)
    v_mfma_f32_16x16x32_bf16 v[120:123], v[184:187], v[160:163], v[120:123]
    ds_read_b128 v[236:239], v2 offset:15360
    v_fma_f32 v40, v40, v4, -v6
    v_mfma_f32_16x16x32_bf16 v[124:127], v[184:187], v[164:167], v[124:127]
    ds_read_b128 v[240:243], v2 offset:16384
    v_fma_f32 v41, v41, v5, -v7
    v_mfma_f32_16x16x32_bf16 v[128:131], v[188:191], v[160:163], v[128:131]
    ds_read_b128 v[244:247], v2 offset:17408
    v_fma_f32 v42, v42, v8, -v10
    v_mfma_f32_16x16x32_bf16 v[132:135], v[188:191], v[164:167], v[132:135]
    v_fma_f32 v43, v43, v9, -v11
    v_fma_f32 v44, v44, v12, -v14
    v_mfma_f32_16x16x32_bf16 v[136:139], v[192:195], v[160:163], v[136:139]
    v_fma_f32 v45, v45, v13, -v15
    v_fma_f32 v46, v46, v252, -v254
    v_mfma_f32_16x16x32_bf16 v[140:143], v[192:195], v[164:167], v[140:143]
    v_fma_f32 v47, v47, v253, -v255
    v_permlane32_swap_b32 v32, v34
    v_mfma_f32_16x16x32_bf16 v[144:147], v[196:199], v[160:163], v[144:147]
    v_permlane32_swap_b32 v33, v35
    v_cvt_pk_bf16_f32 v40, v40, v41
    v_mfma_f32_16x16x32_bf16 v[148:151], v[196:199], v[164:167], v[148:151]
    v_cvt_pk_bf16_f32 v41, v42, v43
    v_cvt_pk_bf16_f32 v42, v44, v45
    v_mfma_f32_16x16x32_bf16 v[152:155], v[200:203], v[160:163], v[152:155]
    v_cvt_pk_bf16_f32 v43, v46, v47
    v_permlane16_swap_b32 v32, v34
    v_mfma_f32_16x16x32_bf16 v[156:159], v[200:203], v[164:167], v[156:159]
    v_permlane16_swap_b32 v33, v35
    s_waitcnt lgkmcnt(0)
    s_barrier
    v_mfma_f32_16x16x32_bf16 v[88:91], v[212:215], v[204:207], v[88:91]
    ds_read_b128 v[160:163], v0 offset:36864
    v_mfma_f32_16x16x32_bf16 v[92:95], v[212:215], v[208:211], v[92:95]
    ds_read_b128 v[164:167], v0 offset:38912
    v_fma_f32 v48, v48, v4, -v6
    v_mfma_f32_16x16x32_bf16 v[96:99], v[216:219], v[204:207], v[96:99]
    ds_read_b128 v[168:171], v2 offset:36864
    buffer_store_dwordx4 v[16:19], v1, s[4:7], s38 offen offset:0 sc1
    v_fma_f32 v49, v49, v5, -v7
    v_mfma_f32_16x16x32_bf16 v[100:103], v[216:219], v[208:211], v[100:103]
    ds_read_b128 v[172:175], v2 offset:37888
    v_fma_f32 v50, v50, v8, -v10
    v_mfma_f32_16x16x32_bf16 v[104:107], v[220:223], v[204:207], v[104:107]
    ds_read_b128 v[176:179], v2 offset:38912
    v_fma_f32 v51, v51, v9, -v11
    v_mfma_f32_16x16x32_bf16 v[108:111], v[220:223], v[208:211], v[108:111]
    ds_read_b128 v[180:183], v2 offset:39936
    v_fma_f32 v52, v52, v12, -v14
    v_mfma_f32_16x16x32_bf16 v[112:115], v[224:227], v[204:207], v[112:115]
    ds_read_b128 v[184:187], v2 offset:40960
    v_fma_f32 v53, v53, v13, -v15
    v_mfma_f32_16x16x32_bf16 v[116:119], v[224:227], v[208:211], v[116:119]
    ds_read_b128 v[188:191], v2 offset:41984
    v_mfma_f32_16x16x32_bf16 v[120:123], v[228:231], v[204:207], v[120:123]
    ds_read_b128 v[192:195], v2 offset:43008
    v_fma_f32 v54, v54, v252, -v254
    v_mfma_f32_16x16x32_bf16 v[124:127], v[228:231], v[208:211], v[124:127]
    ds_read_b128 v[196:199], v2 offset:44032
    v_fma_f32 v55, v55, v253, -v255
    v_mfma_f32_16x16x32_bf16 v[128:131], v[232:235], v[204:207], v[128:131]
    ds_read_b128 v[200:203], v2 offset:45056
    buffer_store_dwordx4 v[24:27], v1, s[4:7], s38 offen offset:1024 sc1
    v_permlane32_swap_b32 v40, v42
    v_mfma_f32_16x16x32_bf16 v[132:135], v[232:235], v[208:211], v[132:135]
    v_permlane32_swap_b32 v41, v43
    v_cvt_pk_bf16_f32 v48, v48, v49
    v_mfma_f32_16x16x32_bf16 v[136:139], v[236:239], v[204:207], v[136:139]
    v_cvt_pk_bf16_f32 v49, v50, v51
    v_cvt_pk_bf16_f32 v50, v52, v53
    v_mfma_f32_16x16x32_bf16 v[140:143], v[236:239], v[208:211], v[140:143]
    v_cvt_pk_bf16_f32 v51, v54, v55
    v_permlane16_swap_b32 v40, v42
    v_mfma_f32_16x16x32_bf16 v[144:147], v[240:243], v[204:207], v[144:147]
    v_permlane16_swap_b32 v41, v43
    v_fma_f32 v56, v56, v4, -v6
    v_mfma_f32_16x16x32_bf16 v[148:151], v[240:243], v[208:211], v[148:151]
    v_fma_f32 v57, v57, v5, -v7
    v_fma_f32 v58, v58, v8, -v10
    v_mfma_f32_16x16x32_bf16 v[152:155], v[244:247], v[204:207], v[152:155]
    v_fma_f32 v59, v59, v9, -v11
    v_fma_f32 v60, v60, v12, -v14
    v_mfma_f32_16x16x32_bf16 v[156:159], v[244:247], v[208:211], v[156:159]
    v_fma_f32 v61, v61, v13, -v15
    s_waitcnt lgkmcnt(5)
    v_mfma_f32_16x16x32_bf16 v[88:91], v[168:171], v[160:163], v[88:91]
    ds_read_b128 v[204:207], v0 offset:37888
    v_mfma_f32_16x16x32_bf16 v[92:95], v[168:171], v[164:167], v[92:95]
    ds_read_b128 v[208:211], v0 offset:39936
    v_fma_f32 v62, v62, v252, -v254
    v_mfma_f32_16x16x32_bf16 v[96:99], v[172:175], v[160:163], v[96:99]
    ds_read_b128 v[212:215], v2 offset:46080
    buffer_store_dwordx4 v[32:35], v1, s[4:7], s38 offen offset:2048 sc1
    v_fma_f32 v63, v63, v253, -v255
    v_mfma_f32_16x16x32_bf16 v[100:103], v[172:175], v[164:167], v[100:103]
    ds_read_b128 v[216:219], v2 offset:47104
    v_permlane32_swap_b32 v48, v50
    v_mfma_f32_16x16x32_bf16 v[104:107], v[176:179], v[160:163], v[104:107]
    ds_read_b128 v[220:223], v2 offset:48128
    v_permlane32_swap_b32 v49, v51
    v_mfma_f32_16x16x32_bf16 v[108:111], v[176:179], v[164:167], v[108:111]
    ds_read_b128 v[224:227], v2 offset:49152
    v_cvt_pk_bf16_f32 v56, v56, v57
    v_mfma_f32_16x16x32_bf16 v[112:115], v[180:183], v[160:163], v[112:115]
    ds_read_b128 v[228:231], v2 offset:50176
    v_cvt_pk_bf16_f32 v57, v58, v59
    v_mfma_f32_16x16x32_bf16 v[116:119], v[180:183], v[164:167], v[116:119]
    ds_read_b128 v[232:235], v2 offset:51200
    s_waitcnt lgkmcnt(8)
    v_mfma_f32_16x16x32_bf16 v[120:123], v[184:187], v[160:163], v[120:123]
    ds_read_b128 v[236:239], v2 offset:52224
    v_cvt_pk_bf16_f32 v58, v60, v61
    v_mfma_f32_16x16x32_bf16 v[124:127], v[184:187], v[164:167], v[124:127]
    ds_read_b128 v[240:243], v2 offset:53248
    v_cvt_pk_bf16_f32 v59, v62, v63
    v_mfma_f32_16x16x32_bf16 v[128:131], v[188:191], v[160:163], v[128:131]
    ds_read_b128 v[244:247], v2 offset:54272
    buffer_store_dwordx4 v[40:43], v1, s[4:7], s38 offen offset:3072 sc1
    v_permlane16_swap_b32 v48, v50
    v_mfma_f32_16x16x32_bf16 v[132:135], v[188:191], v[164:167], v[132:135]
    v_permlane16_swap_b32 v49, v51
    v_fma_f32 v64, v64, v4, -v6
    v_mfma_f32_16x16x32_bf16 v[136:139], v[192:195], v[160:163], v[136:139]
    v_fma_f32 v65, v65, v5, -v7
    v_fma_f32 v66, v66, v8, -v10
    v_mfma_f32_16x16x32_bf16 v[140:143], v[192:195], v[164:167], v[140:143]
    v_fma_f32 v67, v67, v9, -v11
    v_fma_f32 v68, v68, v12, -v14
    v_mfma_f32_16x16x32_bf16 v[144:147], v[196:199], v[160:163], v[144:147]
    v_fma_f32 v69, v69, v13, -v15
    v_fma_f32 v70, v70, v252, -v254
    v_mfma_f32_16x16x32_bf16 v[148:151], v[196:199], v[164:167], v[148:151]
    v_fma_f32 v71, v71, v253, -v255
    v_permlane32_swap_b32 v56, v58
    v_mfma_f32_16x16x32_bf16 v[152:155], v[200:203], v[160:163], v[152:155]
    v_permlane32_swap_b32 v57, v59
    v_cvt_pk_bf16_f32 v64, v64, v65
    v_mfma_f32_16x16x32_bf16 v[156:159], v[200:203], v[164:167], v[156:159]
    v_cvt_pk_bf16_f32 v65, v66, v67
    s_waitcnt lgkmcnt(0)
    s_barrier
    v_mfma_f32_16x16x32_bf16 v[88:91], v[212:215], v[204:207], v[88:91]
    ds_read_b128 v[160:163], v3 offset:0
    v_mfma_f32_16x16x32_bf16 v[92:95], v[212:215], v[208:211], v[92:95]
    ds_read_b128 v[164:167], v3 offset:2048
    v_cvt_pk_bf16_f32 v66, v68, v69
    v_mfma_f32_16x16x32_bf16 v[96:99], v[216:219], v[204:207], v[96:99]
    ds_read_b128 v[168:171], v1 offset:0
    buffer_store_dwordx4 v[48:51], v1, s[4:7], s39 offen offset:0 sc1
    v_cvt_pk_bf16_f32 v67, v70, v71
    v_mfma_f32_16x16x32_bf16 v[100:103], v[216:219], v[208:211], v[100:103]
    ds_read_b128 v[172:175], v1 offset:1024
    v_permlane16_swap_b32 v56, v58
    v_mfma_f32_16x16x32_bf16 v[104:107], v[220:223], v[204:207], v[104:107]
    ds_read_b128 v[176:179], v1 offset:2048
    v_permlane16_swap_b32 v57, v59
    v_mfma_f32_16x16x32_bf16 v[108:111], v[220:223], v[208:211], v[108:111]
    ds_read_b128 v[180:183], v1 offset:3072
    v_fma_f32 v72, v72, v4, -v6
    v_mfma_f32_16x16x32_bf16 v[112:115], v[224:227], v[204:207], v[112:115]
    ds_read_b128 v[184:187], v1 offset:4096
    v_fma_f32 v73, v73, v5, -v7
    v_mfma_f32_16x16x32_bf16 v[116:119], v[224:227], v[208:211], v[116:119]
    ds_read_b128 v[188:191], v1 offset:5120
    v_mfma_f32_16x16x32_bf16 v[120:123], v[228:231], v[204:207], v[120:123]
    ds_read_b128 v[192:195], v1 offset:6144
    v_fma_f32 v74, v74, v8, -v10
    v_mfma_f32_16x16x32_bf16 v[124:127], v[228:231], v[208:211], v[124:127]
    ds_read_b128 v[196:199], v1 offset:7168
    v_fma_f32 v75, v75, v9, -v11
    v_mfma_f32_16x16x32_bf16 v[128:131], v[232:235], v[204:207], v[128:131]
    ds_read_b128 v[200:203], v1 offset:8192
    v_fma_f32 v76, v76, v12, -v14
    v_mfma_f32_16x16x32_bf16 v[132:135], v[232:235], v[208:211], v[132:135]
    v_fma_f32 v77, v77, v13, -v15
    v_fma_f32 v78, v78, v252, -v254
    v_mfma_f32_16x16x32_bf16 v[136:139], v[236:239], v[204:207], v[136:139]
    v_fma_f32 v79, v79, v253, -v255
    v_permlane32_swap_b32 v64, v66
    v_mfma_f32_16x16x32_bf16 v[140:143], v[236:239], v[208:211], v[140:143]
    v_permlane32_swap_b32 v65, v67
    v_cvt_pk_bf16_f32 v72, v72, v73
    v_mfma_f32_16x16x32_bf16 v[144:147], v[240:243], v[204:207], v[144:147]
    v_cvt_pk_bf16_f32 v73, v74, v75
    v_cvt_pk_bf16_f32 v74, v76, v77
    v_mfma_f32_16x16x32_bf16 v[148:151], v[240:243], v[208:211], v[148:151]
    v_cvt_pk_bf16_f32 v75, v78, v79
    v_permlane16_swap_b32 v64, v66
    v_mfma_f32_16x16x32_bf16 v[152:155], v[244:247], v[204:207], v[152:155]
    v_permlane16_swap_b32 v65, v67
    v_fma_f32 v80, v80, v4, -v6
    v_mfma_f32_16x16x32_bf16 v[156:159], v[244:247], v[208:211], v[156:159]
    v_fma_f32 v81, v81, v5, -v7
    s_waitcnt lgkmcnt(5)
    v_mfma_f32_16x16x32_bf16 v[88:91], v[168:171], v[160:163], v[88:91]
    ds_read_b128 v[204:207], v3 offset:1024
    v_mfma_f32_16x16x32_bf16 v[92:95], v[168:171], v[164:167], v[92:95]
    ds_read_b128 v[208:211], v3 offset:3072
    v_fma_f32 v82, v82, v8, -v10
    v_mfma_f32_16x16x32_bf16 v[96:99], v[172:175], v[160:163], v[96:99]
    ds_read_b128 v[212:215], v1 offset:9216
    buffer_store_dwordx4 v[56:59], v1, s[4:7], s39 offen offset:1024 sc1
    v_fma_f32 v83, v83, v9, -v11
    v_mfma_f32_16x16x32_bf16 v[100:103], v[172:175], v[164:167], v[100:103]
    ds_read_b128 v[216:219], v1 offset:10240
    v_fma_f32 v84, v84, v12, -v14
    v_mfma_f32_16x16x32_bf16 v[104:107], v[176:179], v[160:163], v[104:107]
    ds_read_b128 v[220:223], v1 offset:11264
    v_fma_f32 v85, v85, v13, -v15
    v_mfma_f32_16x16x32_bf16 v[108:111], v[176:179], v[164:167], v[108:111]
    ds_read_b128 v[224:227], v1 offset:12288
    v_fma_f32 v86, v86, v252, -v254
    v_mfma_f32_16x16x32_bf16 v[112:115], v[180:183], v[160:163], v[112:115]
    ds_read_b128 v[228:231], v1 offset:13312
    v_fma_f32 v87, v87, v253, -v255
    v_mfma_f32_16x16x32_bf16 v[116:119], v[180:183], v[164:167], v[116:119]
    ds_read_b128 v[232:235], v1 offset:14336
    s_waitcnt lgkmcnt(8)
    v_mfma_f32_16x16x32_bf16 v[120:123], v[184:187], v[160:163], v[120:123]
    ds_read_b128 v[236:239], v1 offset:15360
    v_permlane32_swap_b32 v72, v74
    v_mfma_f32_16x16x32_bf16 v[124:127], v[184:187], v[164:167], v[124:127]
    ds_read_b128 v[240:243], v1 offset:16384
    v_permlane32_swap_b32 v73, v75
    v_mfma_f32_16x16x32_bf16 v[128:131], v[188:191], v[160:163], v[128:131]
    ds_read_b128 v[244:247], v1 offset:17408
    buffer_store_dwordx4 v[64:67], v1, s[4:7], s39 offen offset:2048 sc1
    v_cvt_pk_bf16_f32 v80, v80, v81
    v_mfma_f32_16x16x32_bf16 v[132:135], v[188:191], v[164:167], v[132:135]
    v_cvt_pk_bf16_f32 v81, v82, v83
    v_cvt_pk_bf16_f32 v82, v84, v85
    v_mfma_f32_16x16x32_bf16 v[136:139], v[192:195], v[160:163], v[136:139]
    v_cvt_pk_bf16_f32 v83, v86, v87
    v_permlane16_swap_b32 v72, v74
    v_mfma_f32_16x16x32_bf16 v[140:143], v[192:195], v[164:167], v[140:143]
    v_permlane16_swap_b32 v73, v75
    s_nop 0
    v_mfma_f32_16x16x32_bf16 v[144:147], v[196:199], v[160:163], v[144:147]
    v_permlane32_swap_b32 v80, v82
    v_permlane32_swap_b32 v81, v83
    v_mfma_f32_16x16x32_bf16 v[148:151], v[196:199], v[164:167], v[148:151]
    s_nop 0
    v_permlane16_swap_b32 v80, v82
    v_mfma_f32_16x16x32_bf16 v[152:155], v[200:203], v[160:163], v[152:155]
    v_permlane16_swap_b32 v81, v83
    v_mul_f32 v4, s40, v249
    v_mfma_f32_16x16x32_bf16 v[156:159], v[200:203], v[164:167], v[156:159]
    v_mul_f32 v6, s40, v251
    s_waitcnt lgkmcnt(0)
    s_barrier
    v_mfma_f32_16x16x32_bf16 v[88:91], v[212:215], v[204:207], v[88:91]
    ds_read_b128 v[160:163], v3 offset:36864
    v_mfma_f32_16x16x32_bf16 v[92:95], v[212:215], v[208:211], v[92:95]
    ds_read_b128 v[164:167], v3 offset:38912
    v_mul_f32 v5, v249, v249
    v_mfma_f32_16x16x32_bf16 v[96:99], v[216:219], v[204:207], v[96:99]
    ds_read_b128 v[168:171], v1 offset:36864
    buffer_store_dwordx4 v[72:75], v1, s[4:7], s39 offen offset:3072 sc1
    v_mul_f32 v7, v251, v251
    v_mfma_f32_16x16x32_bf16 v[100:103], v[216:219], v[208:211], v[100:103]
    ds_read_b128 v[172:175], v1 offset:37888
    v_rcp_f32 v249, v249
    v_mfma_f32_16x16x32_bf16 v[104:107], v[220:223], v[204:207], v[104:107]
    ds_read_b128 v[176:179], v1 offset:38912
    v_rcp_f32 v251, v251
    v_mfma_f32_16x16x32_bf16 v[108:111], v[220:223], v[208:211], v[108:111]
    ds_read_b128 v[180:183], v1 offset:39936
    v_mul_f32 v5, s42, v5
    v_mfma_f32_16x16x32_bf16 v[112:115], v[224:227], v[204:207], v[112:115]
    ds_read_b128 v[184:187], v1 offset:40960
    v_mul_f32 v7, s42, v7
    v_mfma_f32_16x16x32_bf16 v[116:119], v[224:227], v[208:211], v[116:119]
    ds_read_b128 v[188:191], v1 offset:41984
    v_mfma_f32_16x16x32_bf16 v[120:123], v[228:231], v[204:207], v[120:123]
    ds_read_b128 v[192:195], v1 offset:43008
    v_mul_f32 v5, v5, v4
    v_mfma_f32_16x16x32_bf16 v[124:127], v[228:231], v[208:211], v[124:127]
    ds_read_b128 v[196:199], v1 offset:44032
    v_mul_f32 v7, v7, v6
    v_mfma_f32_16x16x32_bf16 v[128:131], v[232:235], v[204:207], v[128:131]
    ds_read_b128 v[200:203], v1 offset:45056
    buffer_store_dwordx4 v[80:83], v1, s[4:7], s46 offen offset:0 sc1
    v_bfe_u32 v13, v1, 4, 4
    v_mfma_f32_16x16x32_bf16 v[132:135], v[232:235], v[208:211], v[132:135]
    v_lshrrev_b32 v8, 1, v13
    v_lshrrev_b32 v9, 8, v1
    v_mfma_f32_16x16x32_bf16 v[136:139], v[236:239], v[204:207], v[136:139]
    v_xor_b32 v8, v8, v9
    v_lshlrev_b32 v8, 4, v8
    v_mfma_f32_16x16x32_bf16 v[140:143], v[236:239], v[208:211], v[140:143]
    v_lshl_add_u32 v8, v13, 7, v8
    s_add_u32 s33, s30, 18432
    v_mfma_f32_16x16x32_bf16 v[144:147], v[240:243], v[204:207], v[144:147]
    v_add_u32 v8, s33, v8
    v_xor_b32 v9, 64, v8
    v_mfma_f32_16x16x32_bf16 v[148:151], v[240:243], v[208:211], v[148:151]
    v_add_u32 v10, 73728, v8
    v_add_u32 v11, 73728, v9
    v_mfma_f32_16x16x32_bf16 v[152:155], v[244:247], v[204:207], v[152:155]
    s_lshl_b32 s33, s20, 6
    s_add_u32 s33, s33, 161280
    v_mfma_f32_16x16x32_bf16 v[156:159], v[244:247], v[208:211], v[156:159]
    v_lshl_add_u32 v13, v13, 1, s33
    s_waitcnt lgkmcnt(5)
    v_mfma_f32_16x16x32_bf16 v[88:91], v[168:171], v[160:163], v[88:91]
    ds_read_b128 v[204:207], v3 offset:37888
    v_mfma_f32_16x16x32_bf16 v[92:95], v[168:171], v[164:167], v[92:95]
    ds_read_b128 v[208:211], v3 offset:39936
    v_mfma_f32_16x16x32_bf16 v[96:99], v[172:175], v[160:163], v[96:99]
    ds_read_b128 v[212:215], v1 offset:46080
    v_mfma_f32_16x16x32_bf16 v[100:103], v[172:175], v[164:167], v[100:103]
    ds_read_b128 v[216:219], v1 offset:47104
    v_mfma_f32_16x16x32_bf16 v[104:107], v[176:179], v[160:163], v[104:107]
    ds_read_b128 v[220:223], v1 offset:48128
    v_mfma_f32_16x16x32_bf16 v[108:111], v[176:179], v[164:167], v[108:111]
    ds_read_b128 v[224:227], v1 offset:49152
    v_mfma_f32_16x16x32_bf16 v[112:115], v[180:183], v[160:163], v[112:115]
    ds_read_b128 v[228:231], v1 offset:50176
    v_mfma_f32_16x16x32_bf16 v[116:119], v[180:183], v[164:167], v[116:119]
    ds_read_b128 v[232:235], v1 offset:51200
    s_waitcnt lgkmcnt(8)
    v_mfma_f32_16x16x32_bf16 v[120:123], v[184:187], v[160:163], v[120:123]
    ds_read_b128 v[236:239], v1 offset:52224
    v_mfma_f32_16x16x32_bf16 v[124:127], v[184:187], v[164:167], v[124:127]
    ds_read_b128 v[240:243], v1 offset:53248
    v_mfma_f32_16x16x32_bf16 v[128:131], v[188:191], v[160:163], v[128:131]
    ds_read_b128 v[244:247], v1 offset:54272
    v_mfma_f32_16x16x32_bf16 v[132:135], v[188:191], v[164:167], v[132:135]
    v_mfma_f32_16x16x32_bf16 v[136:139], v[192:195], v[160:163], v[136:139]
    v_lshrrev_b32 v0, 4, v1
    v_mfma_f32_16x16x32_bf16 v[140:143], v[192:195], v[164:167], v[140:143]
    v_and_b32 v0, 48, v0
    v_mfma_f32_16x16x32_bf16 v[144:147], v[196:199], v[160:163], v[144:147]
    v_add_u32 v0, 160320, v0
    v_mfma_f32_16x16x32_bf16 v[148:151], v[196:199], v[164:167], v[148:151]
    v_mfma_f32_16x16x32_bf16 v[152:155], v[200:203], v[160:163], v[152:155]
    v_mfma_f32_16x16x32_bf16 v[156:159], v[200:203], v[164:167], v[156:159]
    s_waitcnt lgkmcnt(0)
    v_mfma_f32_16x16x32_bf16 v[88:91], v[212:215], v[204:207], v[88:91]
    ds_read_b128 v[168:171], v0 offset:0
    v_mfma_f32_16x16x32_bf16 v[92:95], v[212:215], v[208:211], v[92:95]
    ds_read_b128 v[172:175], v0 offset:64
    v_mfma_f32_16x16x32_bf16 v[96:99], v[216:219], v[204:207], v[96:99]
    ds_read_b128 v[176:179], v0 offset:128
    v_mfma_f32_16x16x32_bf16 v[100:103], v[216:219], v[208:211], v[100:103]
    ds_read_b128 v[180:183], v0 offset:192
    v_mfma_f32_16x16x32_bf16 v[104:107], v[220:223], v[204:207], v[104:107]
    ds_read_b128 v[184:187], v0 offset:256
    v_mfma_f32_16x16x32_bf16 v[108:111], v[220:223], v[208:211], v[108:111]
    ds_read_b128 v[188:191], v0 offset:320
    v_mfma_f32_16x16x32_bf16 v[112:115], v[224:227], v[204:207], v[112:115]
    ds_read_b128 v[192:195], v0 offset:384
    v_mfma_f32_16x16x32_bf16 v[116:119], v[224:227], v[208:211], v[116:119]
    ds_read_b128 v[196:199], v0 offset:448
    v_mfma_f32_16x16x32_bf16 v[120:123], v[228:231], v[204:207], v[120:123]
    ds_read_b128 v[200:203], v0 offset:512
    v_mfma_f32_16x16x32_bf16 v[124:127], v[228:231], v[208:211], v[124:127]
    ds_read_u16 v12, v13
    v_mfma_f32_16x16x32_bf16 v[128:131], v[232:235], v[204:207], v[128:131]
    ds_read_u16 v252, v13 offset:32
    v_mfma_f32_16x16x32_bf16 v[132:135], v[232:235], v[208:211], v[132:135]
    v_mfma_f32_16x16x32_bf16 v[136:139], v[236:239], v[204:207], v[136:139]
    s_lshr_b32 s35, s20, 1
    s_mul_i32 s35, s35, 36864
    v_mfma_f32_16x16x32_bf16 v[140:143], v[236:239], v[208:211], v[140:143]
    s_and_b32 s34, s20, 1
    s_mul_i32 s34, s34, 9216
    v_mfma_f32_16x16x32_bf16 v[144:147], v[240:243], v[204:207], v[144:147]
    s_add_u32 s35, s35, s34
    v_mfma_f32_16x16x32_bf16 v[148:151], v[240:243], v[208:211], v[148:151]
    v_add_u32 v3, s35, v2
    v_mfma_f32_16x16x32_bf16 v[152:155], v[244:247], v[204:207], v[152:155]
    v_mfma_f32_16x16x32_bf16 v[156:159], v[244:247], v[208:211], v[156:159]
    s_waitcnt vmcnt(0)
    s_barrier
    s_waitcnt lgkmcnt(0)
    v_lshlrev_b32 v15, 16, v12
    v_lshlrev_b32 v255, 16, v252
    v_lshlrev_b32 v14, 16, v12
    v_lshlrev_b32 v254, 16, v252
    v_lshlrev_b32 v13, 16, v12
    v_lshlrev_b32 v253, 16, v252
    v_lshlrev_b32 v12, 16, v12
    v_lshlrev_b32 v252, 16, v252
    ds_write_b128 v3, v[16:19] offset:0
    v_pk_fma_f32 v[88:89], v[248:249], v[168:169], v[88:89] op_sel_hi:[0,1,1] neg_lo:[1,0,0] neg_hi:[1,0,0]
    v_pk_fma_f32 v[90:91], v[248:249], v[170:171], v[90:91] op_sel_hi:[0,1,1] neg_lo:[1,0,0] neg_hi:[1,0,0]
    v_pk_fma_f32 v[92:93], v[250:251], v[168:169], v[92:93] op_sel_hi:[0,1,1] neg_lo:[1,0,0] neg_hi:[1,0,0]
    v_pk_fma_f32 v[94:95], v[250:251], v[170:171], v[94:95] op_sel_hi:[0,1,1] neg_lo:[1,0,0] neg_hi:[1,0,0]
    ds_write_b128 v3, v[24:27] offset:1024
    v_pk_fma_f32 v[96:97], v[248:249], v[172:173], v[96:97] op_sel_hi:[0,1,1] neg_lo:[1,0,0] neg_hi:[1,0,0]
    v_pk_fma_f32 v[98:99], v[248:249], v[174:175], v[98:99] op_sel_hi:[0,1,1] neg_lo:[1,0,0] neg_hi:[1,0,0]
    v_pk_fma_f32 v[100:101], v[250:251], v[172:173], v[100:101] op_sel_hi:[0,1,1] neg_lo:[1,0,0] neg_hi:[1,0,0]
    v_pk_fma_f32 v[102:103], v[250:251], v[174:175], v[102:103] op_sel_hi:[0,1,1] neg_lo:[1,0,0] neg_hi:[1,0,0]
    ds_write_b128 v3, v[32:35] offset:2048
    v_pk_fma_f32 v[104:105], v[248:249], v[176:177], v[104:105] op_sel_hi:[0,1,1] neg_lo:[1,0,0] neg_hi:[1,0,0]
    v_pk_fma_f32 v[106:107], v[248:249], v[178:179], v[106:107] op_sel_hi:[0,1,1] neg_lo:[1,0,0] neg_hi:[1,0,0]
    v_pk_fma_f32 v[108:109], v[250:251], v[176:177], v[108:109] op_sel_hi:[0,1,1] neg_lo:[1,0,0] neg_hi:[1,0,0]
    v_pk_fma_f32 v[110:111], v[250:251], v[178:179], v[110:111] op_sel_hi:[0,1,1] neg_lo:[1,0,0] neg_hi:[1,0,0]
    ds_write_b128 v3, v[40:43] offset:3072
    v_pk_fma_f32 v[112:113], v[248:249], v[180:181], v[112:113] op_sel_hi:[0,1,1] neg_lo:[1,0,0] neg_hi:[1,0,0]
    v_pk_fma_f32 v[114:115], v[248:249], v[182:183], v[114:115] op_sel_hi:[0,1,1] neg_lo:[1,0,0] neg_hi:[1,0,0]
    v_pk_fma_f32 v[116:117], v[250:251], v[180:181], v[116:117] op_sel_hi:[0,1,1] neg_lo:[1,0,0] neg_hi:[1,0,0]
    v_pk_fma_f32 v[118:119], v[250:251], v[182:183], v[118:119] op_sel_hi:[0,1,1] neg_lo:[1,0,0] neg_hi:[1,0,0]
    ds_write_b128 v3, v[48:51] offset:4096
    v_pk_fma_f32 v[120:121], v[248:249], v[184:185], v[120:121] op_sel_hi:[0,1,1] neg_lo:[1,0,0] neg_hi:[1,0,0]
    v_pk_fma_f32 v[122:123], v[248:249], v[186:187], v[122:123] op_sel_hi:[0,1,1] neg_lo:[1,0,0] neg_hi:[1,0,0]
    v_pk_fma_f32 v[124:125], v[250:251], v[184:185], v[124:125] op_sel_hi:[0,1,1] neg_lo:[1,0,0] neg_hi:[1,0,0]
    v_pk_fma_f32 v[126:127], v[250:251], v[186:187], v[126:127] op_sel_hi:[0,1,1] neg_lo:[1,0,0] neg_hi:[1,0,0]
    ds_write_b128 v3, v[56:59] offset:5120
    v_pk_fma_f32 v[128:129], v[248:249], v[188:189], v[128:129] op_sel_hi:[0,1,1] neg_lo:[1,0,0] neg_hi:[1,0,0]
    v_pk_fma_f32 v[130:131], v[248:249], v[190:191], v[130:131] op_sel_hi:[0,1,1] neg_lo:[1,0,0] neg_hi:[1,0,0]
    v_pk_fma_f32 v[132:133], v[250:251], v[188:189], v[132:133] op_sel_hi:[0,1,1] neg_lo:[1,0,0] neg_hi:[1,0,0]
    v_pk_fma_f32 v[134:135], v[250:251], v[190:191], v[134:135] op_sel_hi:[0,1,1] neg_lo:[1,0,0] neg_hi:[1,0,0]
    ds_write_b128 v3, v[64:67] offset:6144
    v_pk_fma_f32 v[136:137], v[248:249], v[192:193], v[136:137] op_sel_hi:[0,1,1] neg_lo:[1,0,0] neg_hi:[1,0,0]
    v_pk_fma_f32 v[138:139], v[248:249], v[194:195], v[138:139] op_sel_hi:[0,1,1] neg_lo:[1,0,0] neg_hi:[1,0,0]
    v_pk_fma_f32 v[140:141], v[250:251], v[192:193], v[140:141] op_sel_hi:[0,1,1] neg_lo:[1,0,0] neg_hi:[1,0,0]
    v_pk_fma_f32 v[142:143], v[250:251], v[194:195], v[142:143] op_sel_hi:[0,1,1] neg_lo:[1,0,0] neg_hi:[1,0,0]
    ds_write_b128 v3, v[72:75] offset:7168
    v_pk_fma_f32 v[144:145], v[248:249], v[196:197], v[144:145] op_sel_hi:[0,1,1] neg_lo:[1,0,0] neg_hi:[1,0,0]
    v_pk_fma_f32 v[146:147], v[248:249], v[198:199], v[146:147] op_sel_hi:[0,1,1] neg_lo:[1,0,0] neg_hi:[1,0,0]
    v_pk_fma_f32 v[148:149], v[250:251], v[196:197], v[148:149] op_sel_hi:[0,1,1] neg_lo:[1,0,0] neg_hi:[1,0,0]
    v_pk_fma_f32 v[150:151], v[250:251], v[198:199], v[150:151] op_sel_hi:[0,1,1] neg_lo:[1,0,0] neg_hi:[1,0,0]
    ds_write_b128 v3, v[80:83] offset:8192
    v_pk_fma_f32 v[152:153], v[248:249], v[200:201], v[152:153] op_sel_hi:[0,1,1] neg_lo:[1,0,0] neg_hi:[1,0,0]
    v_pk_fma_f32 v[154:155], v[248:249], v[202:203], v[154:155] op_sel_hi:[0,1,1] neg_lo:[1,0,0] neg_hi:[1,0,0]
    v_pk_fma_f32 v[156:157], v[250:251], v[200:201], v[156:157] op_sel_hi:[0,1,1] neg_lo:[1,0,0] neg_hi:[1,0,0]
    v_pk_fma_f32 v[158:159], v[250:251], v[202:203], v[158:159] op_sel_hi:[0,1,1] neg_lo:[1,0,0] neg_hi:[1,0,0]
    v_pk_mul_f32 v[204:205], v[88:89], v[88:89]
    v_pk_mul_f32 v[206:207], v[90:91], v[90:91]
    v_pk_mul_f32 v[208:209], v[92:93], v[92:93]
    v_pk_mul_f32 v[210:211], v[94:95], v[94:95]
    v_pk_fma_f32 v[204:205], v[204:205], v[4:5], v[4:5] op_sel:[0,1,0] op_sel_hi:[1,1,0]
    v_pk_fma_f32 v[206:207], v[206:207], v[4:5], v[4:5] op_sel:[0,1,0] op_sel_hi:[1,1,0]
    v_pk_fma_f32 v[208:209], v[208:209], v[6:7], v[6:7] op_sel:[0,1,0] op_sel_hi:[1,1,0]
    v_pk_fma_f32 v[210:211], v[210:211], v[6:7], v[6:7] op_sel:[0,1,0] op_sel_hi:[1,1,0]
    v_pk_mul_f32 v[204:205], v[204:205], v[88:89]
    v_pk_mul_f32 v[206:207], v[206:207], v[90:91]
    v_pk_mul_f32 v[208:209], v[208:209], v[92:93]
    v_pk_mul_f32 v[210:211], v[210:211], v[94:95]
    v_exp_f32 v204, v204
    v_exp_f32 v205, v205
    v_exp_f32 v206, v206
    v_exp_f32 v207, v207
    v_exp_f32 v208, v208
    v_exp_f32 v209, v209
    v_exp_f32 v210, v210
    v_exp_f32 v211, v211
    v_pk_fma_f32 v[204:205], v[204:205], v[248:249], v[248:249] op_sel:[0,1,1] op_sel_hi:[1,1,1]
    v_pk_fma_f32 v[206:207], v[206:207], v[248:249], v[248:249] op_sel:[0,1,1] op_sel_hi:[1,1,1]
    v_pk_fma_f32 v[208:209], v[208:209], v[250:251], v[250:251] op_sel:[0,1,1] op_sel_hi:[1,1,1]
    v_pk_fma_f32 v[210:211], v[210:211], v[250:251], v[250:251] op_sel:[0,1,1] op_sel_hi:[1,1,1]
    v_rcp_f32 v204, v204
    v_rcp_f32 v205, v205
    v_rcp_f32 v206, v206
    v_rcp_f32 v207, v207
    v_rcp_f32 v208, v208
    v_rcp_f32 v209, v209
    v_rcp_f32 v210, v210
    v_rcp_f32 v211, v211
    v_pk_mul_f32 v[88:89], v[88:89], v[204:205]
    v_pk_mul_f32 v[90:91], v[90:91], v[206:207]
    v_pk_mul_f32 v[92:93], v[92:93], v[208:209]
    v_pk_mul_f32 v[94:95], v[94:95], v[210:211]
    v_pk_mul_f32 v[212:213], v[96:97], v[96:97]
    v_pk_mul_f32 v[214:215], v[98:99], v[98:99]
    v_pk_mul_f32 v[216:217], v[100:101], v[100:101]
    v_pk_mul_f32 v[218:219], v[102:103], v[102:103]
    v_pk_fma_f32 v[212:213], v[212:213], v[4:5], v[4:5] op_sel:[0,1,0] op_sel_hi:[1,1,0]
    v_pk_fma_f32 v[214:215], v[214:215], v[4:5], v[4:5] op_sel:[0,1,0] op_sel_hi:[1,1,0]
    v_pk_fma_f32 v[216:217], v[216:217], v[6:7], v[6:7] op_sel:[0,1,0] op_sel_hi:[1,1,0]
    v_pk_fma_f32 v[218:219], v[218:219], v[6:7], v[6:7] op_sel:[0,1,0] op_sel_hi:[1,1,0]
    v_pk_mul_f32 v[212:213], v[212:213], v[96:97]
    v_pk_mul_f32 v[214:215], v[214:215], v[98:99]
    v_pk_mul_f32 v[216:217], v[216:217], v[100:101]
    v_pk_mul_f32 v[218:219], v[218:219], v[102:103]
    v_exp_f32 v212, v212
    v_exp_f32 v213, v213
    v_exp_f32 v214, v214
    v_exp_f32 v215, v215
    v_exp_f32 v216, v216
    v_exp_f32 v217, v217
    v_exp_f32 v218, v218
    v_exp_f32 v219, v219
    v_pk_fma_f32 v[212:213], v[212:213], v[248:249], v[248:249] op_sel:[0,1,1] op_sel_hi:[1,1,1]
    v_pk_fma_f32 v[214:215], v[214:215], v[248:249], v[248:249] op_sel:[0,1,1] op_sel_hi:[1,1,1]
    v_pk_fma_f32 v[216:217], v[216:217], v[250:251], v[250:251] op_sel:[0,1,1] op_sel_hi:[1,1,1]
    v_pk_fma_f32 v[218:219], v[218:219], v[250:251], v[250:251] op_sel:[0,1,1] op_sel_hi:[1,1,1]
    v_rcp_f32 v212, v212
    v_rcp_f32 v213, v213
    v_rcp_f32 v214, v214
    v_rcp_f32 v215, v215
    v_rcp_f32 v216, v216
    v_rcp_f32 v217, v217
    v_rcp_f32 v218, v218
    v_rcp_f32 v219, v219
    v_pk_mul_f32 v[96:97], v[96:97], v[212:213]
    v_pk_mul_f32 v[98:99], v[98:99], v[214:215]
    v_pk_mul_f32 v[100:101], v[100:101], v[216:217]
    v_pk_mul_f32 v[102:103], v[102:103], v[218:219]
    v_pk_mul_f32 v[204:205], v[104:105], v[104:105]
    v_pk_mul_f32 v[206:207], v[106:107], v[106:107]
    v_pk_mul_f32 v[208:209], v[108:109], v[108:109]
    v_pk_mul_f32 v[210:211], v[110:111], v[110:111]
    v_pk_fma_f32 v[204:205], v[204:205], v[4:5], v[4:5] op_sel:[0,1,0] op_sel_hi:[1,1,0]
    v_pk_fma_f32 v[206:207], v[206:207], v[4:5], v[4:5] op_sel:[0,1,0] op_sel_hi:[1,1,0]
    v_pk_fma_f32 v[208:209], v[208:209], v[6:7], v[6:7] op_sel:[0,1,0] op_sel_hi:[1,1,0]
    v_pk_fma_f32 v[210:211], v[210:211], v[6:7], v[6:7] op_sel:[0,1,0] op_sel_hi:[1,1,0]
    v_pk_mul_f32 v[204:205], v[204:205], v[104:105]
    v_pk_mul_f32 v[206:207], v[206:207], v[106:107]
    v_pk_mul_f32 v[208:209], v[208:209], v[108:109]
    v_pk_mul_f32 v[210:211], v[210:211], v[110:111]
    v_exp_f32 v204, v204
    v_exp_f32 v205, v205
    v_exp_f32 v206, v206
    v_exp_f32 v207, v207
    v_exp_f32 v208, v208
    v_exp_f32 v209, v209
    v_exp_f32 v210, v210
    v_exp_f32 v211, v211
    v_pk_fma_f32 v[204:205], v[204:205], v[248:249], v[248:249] op_sel:[0,1,1] op_sel_hi:[1,1,1]
    v_pk_fma_f32 v[206:207], v[206:207], v[248:249], v[248:249] op_sel:[0,1,1] op_sel_hi:[1,1,1]
    v_pk_fma_f32 v[208:209], v[208:209], v[250:251], v[250:251] op_sel:[0,1,1] op_sel_hi:[1,1,1]
    v_pk_fma_f32 v[210:211], v[210:211], v[250:251], v[250:251] op_sel:[0,1,1] op_sel_hi:[1,1,1]
    v_rcp_f32 v204, v204
    v_rcp_f32 v205, v205
    v_rcp_f32 v206, v206
    v_rcp_f32 v207, v207
    v_rcp_f32 v208, v208
    v_rcp_f32 v209, v209
    v_rcp_f32 v210, v210
    v_rcp_f32 v211, v211
    v_pk_mul_f32 v[104:105], v[104:105], v[204:205]
    v_pk_mul_f32 v[106:107], v[106:107], v[206:207]
    v_pk_mul_f32 v[108:109], v[108:109], v[208:209]
    v_pk_mul_f32 v[110:111], v[110:111], v[210:211]
    s_waitcnt lgkmcnt(0)
    s_barrier
    ds_read_b128 v[160:163], v10 offset:0
    ds_read_b128 v[164:167], v10 offset:2048
    ds_read_b128 v[168:171], v2 offset:0
    ds_read_b128 v[172:175], v2 offset:1024
    ds_read_b128 v[176:179], v2 offset:2048
    ds_read_b128 v[180:183], v2 offset:3072
    ds_read_b128 v[184:187], v2 offset:4096
    ds_read_b128 v[188:191], v2 offset:5120
    ds_read_b128 v[192:195], v2 offset:6144
    ds_read_b128 v[196:199], v2 offset:7168
    ds_read_b128 v[200:203], v2 offset:8192
    v_pk_mul_f32 v[212:213], v[112:113], v[112:113]
    v_pk_mul_f32 v[214:215], v[114:115], v[114:115]
    v_pk_mul_f32 v[216:217], v[116:117], v[116:117]
    v_pk_mul_f32 v[218:219], v[118:119], v[118:119]
    v_pk_fma_f32 v[212:213], v[212:213], v[4:5], v[4:5] op_sel:[0,1,0] op_sel_hi:[1,1,0]
    v_pk_fma_f32 v[214:215], v[214:215], v[4:5], v[4:5] op_sel:[0,1,0] op_sel_hi:[1,1,0]
    v_pk_fma_f32 v[216:217], v[216:217], v[6:7], v[6:7] op_sel:[0,1,0] op_sel_hi:[1,1,0]
    v_pk_fma_f32 v[218:219], v[218:219], v[6:7], v[6:7] op_sel:[0,1,0] op_sel_hi:[1,1,0]
    v_pk_mul_f32 v[212:213], v[212:213], v[112:113]
    v_pk_mul_f32 v[214:215], v[214:215], v[114:115]
    v_pk_mul_f32 v[216:217], v[216:217], v[116:117]
    v_pk_mul_f32 v[218:219], v[218:219], v[118:119]
    v_exp_f32 v212, v212
    v_exp_f32 v213, v213
    v_exp_f32 v214, v214
    v_exp_f32 v215, v215
    v_exp_f32 v216, v216
    v_exp_f32 v217, v217
    v_exp_f32 v218, v218
    v_exp_f32 v219, v219
    v_pk_fma_f32 v[212:213], v[212:213], v[248:249], v[248:249] op_sel:[0,1,1] op_sel_hi:[1,1,1]
    v_pk_fma_f32 v[214:215], v[214:215], v[248:249], v[248:249] op_sel:[0,1,1] op_sel_hi:[1,1,1]
    v_pk_fma_f32 v[216:217], v[216:217], v[250:251], v[250:251] op_sel:[0,1,1] op_sel_hi:[1,1,1]
    v_pk_fma_f32 v[218:219], v[218:219], v[250:251], v[250:251] op_sel:[0,1,1] op_sel_hi:[1,1,1]
    v_rcp_f32 v212, v212
    v_rcp_f32 v213, v213
    v_rcp_f32 v214, v214
    v_rcp_f32 v215, v215
    v_rcp_f32 v216, v216
    v_rcp_f32 v217, v217
    v_rcp_f32 v218, v218
    v_rcp_f32 v219, v219
    v_pk_mul_f32 v[112:113], v[112:113], v[212:213]
    v_pk_mul_f32 v[114:115], v[114:115], v[214:215]
    v_pk_mul_f32 v[116:117], v[116:117], v[216:217]
    v_pk_mul_f32 v[118:119], v[118:119], v[218:219]
    s_waitcnt lgkmcnt(5)
    v_mfma_f32_16x16x32_bf16 v[16:19], v[168:171], v[160:163], v[12:15]
    ds_read_b128 v[204:207], v11 offset:0
    v_mfma_f32_16x16x32_bf16 v[20:23], v[168:171], v[164:167], v[252:255]
    ds_read_b128 v[208:211], v11 offset:2048
    v_mfma_f32_16x16x32_bf16 v[24:27], v[172:175], v[160:163], v[12:15]
    ds_read_b128 v[212:215], v2 offset:9216
    v_mfma_f32_16x16x32_bf16 v[28:31], v[172:175], v[164:167], v[252:255]
    ds_read_b128 v[216:219], v2 offset:10240
    v_mfma_f32_16x16x32_bf16 v[32:35], v[176:179], v[160:163], v[12:15]
    ds_read_b128 v[220:223], v2 offset:11264
    v_mfma_f32_16x16x32_bf16 v[36:39], v[176:179], v[164:167], v[252:255]
    ds_read_b128 v[224:227], v2 offset:12288
    v_mfma_f32_16x16x32_bf16 v[40:43], v[180:183], v[160:163], v[12:15]
    ds_read_b128 v[228:231], v2 offset:13312
    v_mfma_f32_16x16x32_bf16 v[44:47], v[180:183], v[164:167], v[252:255]
    ds_read_b128 v[232:235], v2 offset:14336
    s_waitcnt lgkmcnt(8)
    v_mfma_f32_16x16x32_bf16 v[48:51], v[184:187], v[160:163], v[12:15]
    ds_read_b128 v[236:239], v2 offset:15360
    v_mfma_f32_16x16x32_bf16 v[52:55], v[184:187], v[164:167], v[252:255]
    ds_read_b128 v[240:243], v2 offset:16384
    v_mfma_f32_16x16x32_bf16 v[56:59], v[188:191], v[160:163], v[12:15]
    ds_read_b128 v[244:247], v2 offset:17408
    v_mfma_f32_16x16x32_bf16 v[60:63], v[188:191], v[164:167], v[252:255]
    v_mfma_f32_16x16x32_bf16 v[64:67], v[192:195], v[160:163], v[12:15]
    v_mfma_f32_16x16x32_bf16 v[68:71], v[192:195], v[164:167], v[252:255]
    v_mfma_f32_16x16x32_bf16 v[72:75], v[196:199], v[160:163], v[12:15]
    v_mfma_f32_16x16x32_bf16 v[76:79], v[196:199], v[164:167], v[252:255]
    v_mfma_f32_16x16x32_bf16 v[80:83], v[200:203], v[160:163], v[12:15]
    v_mfma_f32_16x16x32_bf16 v[84:87], v[200:203], v[164:167], v[252:255]
    s_waitcnt lgkmcnt(0)
    s_barrier
    v_mfma_f32_16x16x32_bf16 v[16:19], v[212:215], v[204:207], v[16:19]
    ds_read_b128 v[160:163], v10 offset:36864
    v_mfma_f32_16x16x32_bf16 v[20:23], v[212:215], v[208:211], v[20:23]
    ds_read_b128 v[164:167], v10 offset:38912
    v_mfma_f32_16x16x32_bf16 v[24:27], v[216:219], v[204:207], v[24:27]
    ds_read_b128 v[168:171], v2 offset:36864
    v_mfma_f32_16x16x32_bf16 v[28:31], v[216:219], v[208:211], v[28:31]
    ds_read_b128 v[172:175], v2 offset:37888
    v_mul_f32 v12, v120, v120
    v_mfma_f32_16x16x32_bf16 v[32:35], v[220:223], v[204:207], v[32:35]
    ds_read_b128 v[176:179], v2 offset:38912
    v_mul_f32 v13, v121, v121
    v_mfma_f32_16x16x32_bf16 v[36:39], v[220:223], v[208:211], v[36:39]
    ds_read_b128 v[180:183], v2 offset:39936
    v_mul_f32 v14, v122, v122
    v_mfma_f32_16x16x32_bf16 v[40:43], v[224:227], v[204:207], v[40:43]
    ds_read_b128 v[184:187], v2 offset:40960
    v_mul_f32 v15, v123, v123
    v_mfma_f32_16x16x32_bf16 v[44:47], v[224:227], v[208:211], v[44:47]
    ds_read_b128 v[188:191], v2 offset:41984
    v_mfma_f32_16x16x32_bf16 v[48:51], v[228:231], v[204:207], v[48:51]
    ds_read_b128 v[192:195], v2 offset:43008
    v_mul_f32 v252, v124, v124
    v_mfma_f32_16x16x32_bf16 v[52:55], v[228:231], v[208:211], v[52:55]
    ds_read_b128 v[196:199], v2 offset:44032
    v_mul_f32 v253, v125, v125
    v_mfma_f32_16x16x32_bf16 v[56:59], v[232:235], v[204:207], v[56:59]
    ds_read_b128 v[200:203], v2 offset:45056
    v_mul_f32 v254, v126, v126
    v_mfma_f32_16x16x32_bf16 v[60:63], v[232:235], v[208:211], v[60:63]
    v_mul_f32 v255, v127, v127
    v_fma_f32 v12, v12, v5, v4
    v_mfma_f32_16x16x32_bf16 v[64:67], v[236:239], v[204:207], v[64:67]
    v_fma_f32 v13, v13, v5, v4
    v_fma_f32 v14, v14, v5, v4
    v_mfma_f32_16x16x32_bf16 v[68:71], v[236:239], v[208:211], v[68:71]
    v_fma_f32 v15, v15, v5, v4
    v_fma_f32 v252, v252, v7, v6
    v_mfma_f32_16x16x32_bf16 v[72:75], v[240:243], v[204:207], v[72:75]
    v_fma_f32 v253, v253, v7, v6
    v_fma_f32 v254, v254, v7, v6
    v_mfma_f32_16x16x32_bf16 v[76:79], v[240:243], v[208:211], v[76:79]
    v_fma_f32 v255, v255, v7, v6
    v_mul_f32 v12, v12, v120
    v_mfma_f32_16x16x32_bf16 v[80:83], v[244:247], v[204:207], v[80:83]
    v_mul_f32 v13, v13, v121
    v_mul_f32 v14, v14, v122
    v_mfma_f32_16x16x32_bf16 v[84:87], v[244:247], v[208:211], v[84:87]
    v_mul_f32 v15, v15, v123
    s_waitcnt lgkmcnt(5)
    v_mfma_f32_16x16x32_bf16 v[16:19], v[168:171], v[160:163], v[16:19]
    ds_read_b128 v[204:207], v11 offset:36864
    v_mfma_f32_16x16x32_bf16 v[20:23], v[168:171], v[164:167], v[20:23]
    ds_read_b128 v[208:211], v11 offset:38912
    v_mul_f32 v252, v252, v124
    v_mfma_f32_16x16x32_bf16 v[24:27], v[172:175], v[160:163], v[24:27]
    ds_read_b128 v[212:215], v2 offset:46080
    v_mul_f32 v253, v253, v125
    v_mfma_f32_16x16x32_bf16 v[28:31], v[172:175], v[164:167], v[28:31]
    ds_read_b128 v[216:219], v2 offset:47104
    v_mul_f32 v254, v254, v126
    v_mfma_f32_16x16x32_bf16 v[32:35], v[176:179], v[160:163], v[32:35]
    ds_read_b128 v[220:223], v2 offset:48128
    v_mul_f32 v255, v255, v127
    v_mfma_f32_16x16x32_bf16 v[36:39], v[176:179], v[164:167], v[36:39]
    ds_read_b128 v[224:227], v2 offset:49152
    v_exp_f32 v12, v12
    v_mfma_f32_16x16x32_bf16 v[40:43], v[180:183], v[160:163], v[40:43]
    ds_read_b128 v[228:231], v2 offset:50176
    v_exp_f32 v13, v13
    v_mfma_f32_16x16x32_bf16 v[44:47], v[180:183], v[164:167], v[44:47]
    ds_read_b128 v[232:235], v2 offset:51200
    s_waitcnt lgkmcnt(8)
    v_mfma_f32_16x16x32_bf16 v[48:51], v[184:187], v[160:163], v[48:51]
    ds_read_b128 v[236:239], v2 offset:52224
    v_exp_f32 v14, v14
    v_mfma_f32_16x16x32_bf16 v[52:55], v[184:187], v[164:167], v[52:55]
    ds_read_b128 v[240:243], v2 offset:53248
    v_exp_f32 v15, v15
    v_mfma_f32_16x16x32_bf16 v[56:59], v[188:191], v[160:163], v[56:59]
    ds_read_b128 v[244:247], v2 offset:54272
    v_exp_f32 v252, v252
    v_mfma_f32_16x16x32_bf16 v[60:63], v[188:191], v[164:167], v[60:63]
    v_exp_f32 v253, v253
    v_mfma_f32_16x16x32_bf16 v[64:67], v[192:195], v[160:163], v[64:67]
    v_exp_f32 v254, v254
    v_mfma_f32_16x16x32_bf16 v[68:71], v[192:195], v[164:167], v[68:71]
    v_exp_f32 v255, v255
    v_mfma_f32_16x16x32_bf16 v[72:75], v[196:199], v[160:163], v[72:75]
    v_fma_f32 v12, v12, v249, v249
    v_fma_f32 v13, v13, v249, v249
    v_mfma_f32_16x16x32_bf16 v[76:79], v[196:199], v[164:167], v[76:79]
    v_fma_f32 v14, v14, v249, v249
    v_fma_f32 v15, v15, v249, v249
    v_mfma_f32_16x16x32_bf16 v[80:83], v[200:203], v[160:163], v[80:83]
    v_fma_f32 v252, v252, v251, v251
    v_fma_f32 v253, v253, v251, v251
    v_mfma_f32_16x16x32_bf16 v[84:87], v[200:203], v[164:167], v[84:87]
    v_fma_f32 v254, v254, v251, v251
    s_waitcnt lgkmcnt(0)
    s_barrier
    v_mfma_f32_16x16x32_bf16 v[16:19], v[212:215], v[204:207], v[16:19]
    ds_read_b128 v[160:163], v8 offset:0
    v_mfma_f32_16x16x32_bf16 v[20:23], v[212:215], v[208:211], v[20:23]
    ds_read_b128 v[164:167], v8 offset:2048
    v_fma_f32 v255, v255, v251, v251
    v_mfma_f32_16x16x32_bf16 v[24:27], v[216:219], v[204:207], v[24:27]
    ds_read_b128 v[168:171], v1 offset:0
    v_rcp_f32 v12, v12
    v_mfma_f32_16x16x32_bf16 v[28:31], v[216:219], v[208:211], v[28:31]
    ds_read_b128 v[172:175], v1 offset:1024
    v_rcp_f32 v13, v13
    v_mfma_f32_16x16x32_bf16 v[32:35], v[220:223], v[204:207], v[32:35]
    ds_read_b128 v[176:179], v1 offset:2048
    v_rcp_f32 v14, v14
    v_mfma_f32_16x16x32_bf16 v[36:39], v[220:223], v[208:211], v[36:39]
    ds_read_b128 v[180:183], v1 offset:3072
    v_rcp_f32 v15, v15
    v_mfma_f32_16x16x32_bf16 v[40:43], v[224:227], v[204:207], v[40:43]
    ds_read_b128 v[184:187], v1 offset:4096
    v_rcp_f32 v252, v252
    v_mfma_f32_16x16x32_bf16 v[44:47], v[224:227], v[208:211], v[44:47]
    ds_read_b128 v[188:191], v1 offset:5120
    v_mfma_f32_16x16x32_bf16 v[48:51], v[228:231], v[204:207], v[48:51]
    ds_read_b128 v[192:195], v1 offset:6144
    v_rcp_f32 v253, v253
    v_mfma_f32_16x16x32_bf16 v[52:55], v[228:231], v[208:211], v[52:55]
    ds_read_b128 v[196:199], v1 offset:7168
    v_rcp_f32 v254, v254
    v_mfma_f32_16x16x32_bf16 v[56:59], v[232:235], v[204:207], v[56:59]
    ds_read_b128 v[200:203], v1 offset:8192
    v_rcp_f32 v255, v255
    v_mfma_f32_16x16x32_bf16 v[60:63], v[232:235], v[208:211], v[60:63]
    v_mul_f32 v120, v120, v12
    v_mul_f32 v121, v121, v13
    v_mfma_f32_16x16x32_bf16 v[64:67], v[236:239], v[204:207], v[64:67]
    v_mul_f32 v122, v122, v14
    v_mul_f32 v123, v123, v15
    v_mfma_f32_16x16x32_bf16 v[68:71], v[236:239], v[208:211], v[68:71]
    v_mul_f32 v124, v124, v252
    v_mul_f32 v125, v125, v253
    v_mfma_f32_16x16x32_bf16 v[72:75], v[240:243], v[204:207], v[72:75]
    v_mul_f32 v126, v126, v254
    v_mul_f32 v127, v127, v255
    v_mfma_f32_16x16x32_bf16 v[76:79], v[240:243], v[208:211], v[76:79]
    v_mul_f32 v12, v128, v128
    v_mul_f32 v13, v129, v129
    v_mfma_f32_16x16x32_bf16 v[80:83], v[244:247], v[204:207], v[80:83]
    v_mul_f32 v14, v130, v130
    v_mul_f32 v15, v131, v131
    v_mfma_f32_16x16x32_bf16 v[84:87], v[244:247], v[208:211], v[84:87]
    v_mul_f32 v252, v132, v132
    s_waitcnt lgkmcnt(5)
    v_mfma_f32_16x16x32_bf16 v[16:19], v[168:171], v[160:163], v[16:19]
    ds_read_b128 v[204:207], v9 offset:0
    v_mfma_f32_16x16x32_bf16 v[20:23], v[168:171], v[164:167], v[20:23]
    ds_read_b128 v[208:211], v9 offset:2048
    v_mul_f32 v253, v133, v133
    v_mfma_f32_16x16x32_bf16 v[24:27], v[172:175], v[160:163], v[24:27]
    ds_read_b128 v[212:215], v1 offset:9216
    v_mul_f32 v254, v134, v134
    v_mfma_f32_16x16x32_bf16 v[28:31], v[172:175], v[164:167], v[28:31]
    ds_read_b128 v[216:219], v1 offset:10240
    v_mul_f32 v255, v135, v135
    v_mfma_f32_16x16x32_bf16 v[32:35], v[176:179], v[160:163], v[32:35]
    ds_read_b128 v[220:223], v1 offset:11264
    v_fma_f32 v12, v12, v5, v4
    v_mfma_f32_16x16x32_bf16 v[36:39], v[176:179], v[164:167], v[36:39]
    ds_read_b128 v[224:227], v1 offset:12288
    v_fma_f32 v13, v13, v5, v4
    v_mfma_f32_16x16x32_bf16 v[40:43], v[180:183], v[160:163], v[40:43]
    ds_read_b128 v[228:231], v1 offset:13312
    v_fma_f32 v14, v14, v5, v4
    v_mfma_f32_16x16x32_bf16 v[44:47], v[180:183], v[164:167], v[44:47]
    ds_read_b128 v[232:235], v1 offset:14336
    s_waitcnt lgkmcnt(8)
    v_mfma_f32_16x16x32_bf16 v[48:51], v[184:187], v[160:163], v[48:51]
    ds_read_b128 v[236:239], v1 offset:15360
    v_fma_f32 v15, v15, v5, v4
    v_mfma_f32_16x16x32_bf16 v[52:55], v[184:187], v[164:167], v[52:55]
    ds_read_b128 v[240:243], v1 offset:16384
    v_fma_f32 v252, v252, v7, v6
    v_mfma_f32_16x16x32_bf16 v[56:59], v[188:191], v[160:163], v[56:59]
    ds_read_b128 v[244:247], v1 offset:17408
    v_fma_f32 v253, v253, v7, v6
    v_mfma_f32_16x16x32_bf16 v[60:63], v[188:191], v[164:167], v[60:63]
    v_fma_f32 v254, v254, v7, v6
    v_fma_f32 v255, v255, v7, v6
    v_mfma_f32_16x16x32_bf16 v[64:67], v[192:195], v[160:163], v[64:67]
    v_mul_f32 v12, v12, v128
    v_mul_f32 v13, v13, v129
    v_mfma_f32_16x16x32_bf16 v[68:71], v[192:195], v[164:167], v[68:71]
    v_mul_f32 v14, v14, v130
    v_mul_f32 v15, v15, v131
    v_mfma_f32_16x16x32_bf16 v[72:75], v[196:199], v[160:163], v[72:75]
    v_mul_f32 v252, v252, v132
    v_mul_f32 v253, v253, v133
    v_mfma_f32_16x16x32_bf16 v[76:79], v[196:199], v[164:167], v[76:79]
    v_mul_f32 v254, v254, v134
    v_mul_f32 v255, v255, v135
    v_mfma_f32_16x16x32_bf16 v[80:83], v[200:203], v[160:163], v[80:83]
    v_exp_f32 v12, v12
    v_mfma_f32_16x16x32_bf16 v[84:87], v[200:203], v[164:167], v[84:87]
    v_exp_f32 v13, v13
    s_waitcnt lgkmcnt(0)
    s_barrier
    v_mfma_f32_16x16x32_bf16 v[16:19], v[212:215], v[204:207], v[16:19]
    ds_read_b128 v[160:163], v8 offset:36864
    v_mfma_f32_16x16x32_bf16 v[20:23], v[212:215], v[208:211], v[20:23]
    ds_read_b128 v[164:167], v8 offset:38912
    v_exp_f32 v14, v14
    v_mfma_f32_16x16x32_bf16 v[24:27], v[216:219], v[204:207], v[24:27]
    ds_read_b128 v[168:171], v1 offset:36864
    v_exp_f32 v15, v15
    v_mfma_f32_16x16x32_bf16 v[28:31], v[216:219], v[208:211], v[28:31]
    ds_read_b128 v[172:175], v1 offset:37888
    v_exp_f32 v252, v252
    v_mfma_f32_16x16x32_bf16 v[32:35], v[220:223], v[204:207], v[32:35]
    ds_read_b128 v[176:179], v1 offset:38912
    v_exp_f32 v253, v253
    v_mfma_f32_16x16x32_bf16 v[36:39], v[220:223], v[208:211], v[36:39]
    ds_read_b128 v[180:183], v1 offset:39936
    v_exp_f32 v254, v254
    v_mfma_f32_16x16x32_bf16 v[40:43], v[224:227], v[204:207], v[40:43]
    ds_read_b128 v[184:187], v1 offset:40960
    v_exp_f32 v255, v255
    v_mfma_f32_16x16x32_bf16 v[44:47], v[224:227], v[208:211], v[44:47]
    ds_read_b128 v[188:191], v1 offset:41984
    v_mfma_f32_16x16x32_bf16 v[48:51], v[228:231], v[204:207], v[48:51]
    ds_read_b128 v[192:195], v1 offset:43008
    v_fma_f32 v12, v12, v249, v249
    v_mfma_f32_16x16x32_bf16 v[52:55], v[228:231], v[208:211], v[52:55]
    ds_read_b128 v[196:199], v1 offset:44032
    v_fma_f32 v13, v13, v249, v249
    v_mfma_f32_16x16x32_bf16 v[56:59], v[232:235], v[204:207], v[56:59]
    ds_read_b128 v[200:203], v1 offset:45056
    v_fma_f32 v14, v14, v249, v249
    v_mfma_f32_16x16x32_bf16 v[60:63], v[232:235], v[208:211], v[60:63]
    v_fma_f32 v15, v15, v249, v249
    v_fma_f32 v252, v252, v251, v251
    v_mfma_f32_16x16x32_bf16 v[64:67], v[236:239], v[204:207], v[64:67]
    v_fma_f32 v253, v253, v251, v251
    v_fma_f32 v254, v254, v251, v251
    v_mfma_f32_16x16x32_bf16 v[68:71], v[236:239], v[208:211], v[68:71]
    v_fma_f32 v255, v255, v251, v251
    v_rcp_f32 v12, v12
    v_mfma_f32_16x16x32_bf16 v[72:75], v[240:243], v[204:207], v[72:75]
    v_rcp_f32 v13, v13
    v_mfma_f32_16x16x32_bf16 v[76:79], v[240:243], v[208:211], v[76:79]
    v_rcp_f32 v14, v14
    v_mfma_f32_16x16x32_bf16 v[80:83], v[244:247], v[204:207], v[80:83]
    v_rcp_f32 v15, v15
    v_mfma_f32_16x16x32_bf16 v[84:87], v[244:247], v[208:211], v[84:87]
    v_rcp_f32 v252, v252
    s_waitcnt lgkmcnt(5)
    v_mfma_f32_16x16x32_bf16 v[16:19], v[168:171], v[160:163], v[16:19]
    ds_read_b128 v[204:207], v9 offset:36864
    v_mfma_f32_16x16x32_bf16 v[20:23], v[168:171], v[164:167], v[20:23]
    ds_read_b128 v[208:211], v9 offset:38912
    v_rcp_f32 v253, v253
    v_mfma_f32_16x16x32_bf16 v[24:27], v[172:175], v[160:163], v[24:27]
    ds_read_b128 v[212:215], v1 offset:46080
    v_rcp_f32 v254, v254
    v_mfma_f32_16x16x32_bf16 v[28:31], v[172:175], v[164:167], v[28:31]
    ds_read_b128 v[216:219], v1 offset:47104
    v_rcp_f32 v255, v255
    v_mfma_f32_16x16x32_bf16 v[32:35], v[176:179], v[160:163], v[32:35]
    ds_read_b128 v[220:223], v1 offset:48128
    v_mul_f32 v128, v128, v12
    v_mfma_f32_16x16x32_bf16 v[36:39], v[176:179], v[164:167], v[36:39]
    ds_read_b128 v[224:227], v1 offset:49152
    v_mul_f32 v129, v129, v13
    v_mfma_f32_16x16x32_bf16 v[40:43], v[180:183], v[160:163], v[40:43]
    ds_read_b128 v[228:231], v1 offset:50176
    v_mul_f32 v130, v130, v14
    v_mfma_f32_16x16x32_bf16 v[44:47], v[180:183], v[164:167], v[44:47]
    ds_read_b128 v[232:235], v1 offset:51200
    s_waitcnt lgkmcnt(8)
    v_mfma_f32_16x16x32_bf16 v[48:51], v[184:187], v[160:163], v[48:51]
    ds_read_b128 v[236:239], v1 offset:52224
    v_mul_f32 v131, v131, v15
    v_mfma_f32_16x16x32_bf16 v[52:55], v[184:187], v[164:167], v[52:55]
    ds_read_b128 v[240:243], v1 offset:53248
    v_mul_f32 v132, v132, v252
    v_mfma_f32_16x16x32_bf16 v[56:59], v[188:191], v[160:163], v[56:59]
    ds_read_b128 v[244:247], v1 offset:54272
    v_mul_f32 v133, v133, v253
    v_mfma_f32_16x16x32_bf16 v[60:63], v[188:191], v[164:167], v[60:63]
    v_mul_f32 v134, v134, v254
    v_mul_f32 v135, v135, v255
    v_mfma_f32_16x16x32_bf16 v[64:67], v[192:195], v[160:163], v[64:67]
    v_mul_f32 v12, v136, v136
    v_mul_f32 v13, v137, v137
    v_mfma_f32_16x16x32_bf16 v[68:71], v[192:195], v[164:167], v[68:71]
    v_mul_f32 v14, v138, v138
    v_mul_f32 v15, v139, v139
    v_mfma_f32_16x16x32_bf16 v[72:75], v[196:199], v[160:163], v[72:75]
    v_mul_f32 v252, v140, v140
    v_mul_f32 v253, v141, v141
    v_mfma_f32_16x16x32_bf16 v[76:79], v[196:199], v[164:167], v[76:79]
    v_mul_f32 v254, v142, v142
    v_mul_f32 v255, v143, v143
    v_mfma_f32_16x16x32_bf16 v[80:83], v[200:203], v[160:163], v[80:83]
    v_fma_f32 v12, v12, v5, v4
    v_fma_f32 v13, v13, v5, v4
    v_mfma_f32_16x16x32_bf16 v[84:87], v[200:203], v[164:167], v[84:87]
    v_fma_f32 v14, v14, v5, v4
    s_waitcnt lgkmcnt(0)
    s_barrier
    v_mfma_f32_16x16x32_bf16 v[16:19], v[212:215], v[204:207], v[16:19]
    ds_read_b128 v[160:163], v10 offset:0
    v_mfma_f32_16x16x32_bf16 v[20:23], v[212:215], v[208:211], v[20:23]
    ds_read_b128 v[164:167], v10 offset:2048
    v_fma_f32 v15, v15, v5, v4
    v_mfma_f32_16x16x32_bf16 v[24:27], v[216:219], v[204:207], v[24:27]
    ds_read_b128 v[168:171], v2 offset:0
    v_fma_f32 v252, v252, v7, v6
    v_mfma_f32_16x16x32_bf16 v[28:31], v[216:219], v[208:211], v[28:31]
    ds_read_b128 v[172:175], v2 offset:1024
    v_fma_f32 v253, v253, v7, v6
    v_mfma_f32_16x16x32_bf16 v[32:35], v[220:223], v[204:207], v[32:35]
    ds_read_b128 v[176:179], v2 offset:2048
    v_fma_f32 v254, v254, v7, v6
    v_mfma_f32_16x16x32_bf16 v[36:39], v[220:223], v[208:211], v[36:39]
    ds_read_b128 v[180:183], v2 offset:3072
    v_fma_f32 v255, v255, v7, v6
    v_mfma_f32_16x16x32_bf16 v[40:43], v[224:227], v[204:207], v[40:43]
    ds_read_b128 v[184:187], v2 offset:4096
    v_mul_f32 v12, v12, v136
    v_mfma_f32_16x16x32_bf16 v[44:47], v[224:227], v[208:211], v[44:47]
    ds_read_b128 v[188:191], v2 offset:5120
    v_mfma_f32_16x16x32_bf16 v[48:51], v[228:231], v[204:207], v[48:51]
    ds_read_b128 v[192:195], v2 offset:6144
    v_mul_f32 v13, v13, v137
    v_mfma_f32_16x16x32_bf16 v[52:55], v[228:231], v[208:211], v[52:55]
    ds_read_b128 v[196:199], v2 offset:7168
    v_mul_f32 v14, v14, v138
    v_mfma_f32_16x16x32_bf16 v[56:59], v[232:235], v[204:207], v[56:59]
    ds_read_b128 v[200:203], v2 offset:8192
    v_mul_f32 v15, v15, v139
    v_mfma_f32_16x16x32_bf16 v[60:63], v[232:235], v[208:211], v[60:63]
    v_mul_f32 v252, v252, v140
    v_mul_f32 v253, v253, v141
    v_mfma_f32_16x16x32_bf16 v[64:67], v[236:239], v[204:207], v[64:67]
    v_mul_f32 v254, v254, v142
    v_mul_f32 v255, v255, v143
    v_mfma_f32_16x16x32_bf16 v[68:71], v[236:239], v[208:211], v[68:71]
    v_exp_f32 v12, v12
    v_mfma_f32_16x16x32_bf16 v[72:75], v[240:243], v[204:207], v[72:75]
    v_exp_f32 v13, v13
    v_mfma_f32_16x16x32_bf16 v[76:79], v[240:243], v[208:211], v[76:79]
    v_exp_f32 v14, v14
    v_mfma_f32_16x16x32_bf16 v[80:83], v[244:247], v[204:207], v[80:83]
    v_exp_f32 v15, v15
    v_mfma_f32_16x16x32_bf16 v[84:87], v[244:247], v[208:211], v[84:87]
    v_exp_f32 v252, v252
    s_waitcnt lgkmcnt(5)
    v_mfma_f32_16x16x32_bf16 v[16:19], v[168:171], v[160:163], v[16:19]
    ds_read_b128 v[204:207], v11 offset:0
    v_mfma_f32_16x16x32_bf16 v[20:23], v[168:171], v[164:167], v[20:23]
    ds_read_b128 v[208:211], v11 offset:2048
    v_exp_f32 v253, v253
    v_mfma_f32_16x16x32_bf16 v[24:27], v[172:175], v[160:163], v[24:27]
    ds_read_b128 v[212:215], v2 offset:9216
    v_exp_f32 v254, v254
    v_mfma_f32_16x16x32_bf16 v[28:31], v[172:175], v[164:167], v[28:31]
    ds_read_b128 v[216:219], v2 offset:10240
    v_exp_f32 v255, v255
    v_mfma_f32_16x16x32_bf16 v[32:35], v[176:179], v[160:163], v[32:35]
    ds_read_b128 v[220:223], v2 offset:11264
    v_fma_f32 v12, v12, v249, v249
    v_mfma_f32_16x16x32_bf16 v[36:39], v[176:179], v[164:167], v[36:39]
    ds_read_b128 v[224:227], v2 offset:12288
    v_fma_f32 v13, v13, v249, v249
    v_mfma_f32_16x16x32_bf16 v[40:43], v[180:183], v[160:163], v[40:43]
    ds_read_b128 v[228:231], v2 offset:13312
    v_fma_f32 v14, v14, v249, v249
    v_mfma_f32_16x16x32_bf16 v[44:47], v[180:183], v[164:167], v[44:47]
    ds_read_b128 v[232:235], v2 offset:14336
    s_waitcnt lgkmcnt(8)
    v_mfma_f32_16x16x32_bf16 v[48:51], v[184:187], v[160:163], v[48:51]
    ds_read_b128 v[236:239], v2 offset:15360
    v_fma_f32 v15, v15, v249, v249
    v_mfma_f32_16x16x32_bf16 v[52:55], v[184:187], v[164:167], v[52:55]
    ds_read_b128 v[240:243], v2 offset:16384
    v_fma_f32 v252, v252, v251, v251
    v_mfma_f32_16x16x32_bf16 v[56:59], v[188:191], v[160:163], v[56:59]
    ds_read_b128 v[244:247], v2 offset:17408
    v_fma_f32 v253, v253, v251, v251
    v_mfma_f32_16x16x32_bf16 v[60:63], v[188:191], v[164:167], v[60:63]
    v_fma_f32 v254, v254, v251, v251
    v_fma_f32 v255, v255, v251, v251
    v_mfma_f32_16x16x32_bf16 v[64:67], v[192:195], v[160:163], v[64:67]
    v_rcp_f32 v12, v12
    v_mfma_f32_16x16x32_bf16 v[68:71], v[192:195], v[164:167], v[68:71]
    v_rcp_f32 v13, v13
    v_mfma_f32_16x16x32_bf16 v[72:75], v[196:199], v[160:163], v[72:75]
    v_rcp_f32 v14, v14
    v_mfma_f32_16x16x32_bf16 v[76:79], v[196:199], v[164:167], v[76:79]
    v_rcp_f32 v15, v15
    v_mfma_f32_16x16x32_bf16 v[80:83], v[200:203], v[160:163], v[80:83]
    v_rcp_f32 v252, v252
    v_mfma_f32_16x16x32_bf16 v[84:87], v[200:203], v[164:167], v[84:87]
    v_rcp_f32 v253, v253
    s_waitcnt lgkmcnt(0)
    s_barrier
    v_mfma_f32_16x16x32_bf16 v[16:19], v[212:215], v[204:207], v[16:19]
    ds_read_b128 v[160:163], v10 offset:36864
    v_mfma_f32_16x16x32_bf16 v[20:23], v[212:215], v[208:211], v[20:23]
    ds_read_b128 v[164:167], v10 offset:38912
    v_rcp_f32 v254, v254
    v_mfma_f32_16x16x32_bf16 v[24:27], v[216:219], v[204:207], v[24:27]
    ds_read_b128 v[168:171], v2 offset:36864
    v_rcp_f32 v255, v255
    v_mfma_f32_16x16x32_bf16 v[28:31], v[216:219], v[208:211], v[28:31]
    ds_read_b128 v[172:175], v2 offset:37888
    v_mul_f32 v136, v136, v12
    v_mfma_f32_16x16x32_bf16 v[32:35], v[220:223], v[204:207], v[32:35]
    ds_read_b128 v[176:179], v2 offset:38912
    v_mul_f32 v137, v137, v13
    v_mfma_f32_16x16x32_bf16 v[36:39], v[220:223], v[208:211], v[36:39]
    ds_read_b128 v[180:183], v2 offset:39936
    v_mul_f32 v138, v138, v14
    v_mfma_f32_16x16x32_bf16 v[40:43], v[224:227], v[204:207], v[40:43]
    ds_read_b128 v[184:187], v2 offset:40960
    v_mul_f32 v139, v139, v15
    v_mfma_f32_16x16x32_bf16 v[44:47], v[224:227], v[208:211], v[44:47]
    ds_read_b128 v[188:191], v2 offset:41984
    v_mfma_f32_16x16x32_bf16 v[48:51], v[228:231], v[204:207], v[48:51]
    ds_read_b128 v[192:195], v2 offset:43008
    v_mul_f32 v140, v140, v252
    v_mfma_f32_16x16x32_bf16 v[52:55], v[228:231], v[208:211], v[52:55]
    ds_read_b128 v[196:199], v2 offset:44032
    v_mul_f32 v141, v141, v253
    v_mfma_f32_16x16x32_bf16 v[56:59], v[232:235], v[204:207], v[56:59]
    ds_read_b128 v[200:203], v2 offset:45056
    v_mul_f32 v142, v142, v254
    v_mfma_f32_16x16x32_bf16 v[60:63], v[232:235], v[208:211], v[60:63]
    v_mul_f32 v143, v143, v255
    v_mul_f32 v12, v144, v144
    v_mfma_f32_16x16x32_bf16 v[64:67], v[236:239], v[204:207], v[64:67]
    v_mul_f32 v13, v145, v145
    v_mul_f32 v14, v146, v146
    v_mfma_f32_16x16x32_bf16 v[68:71], v[236:239], v[208:211], v[68:71]
    v_mul_f32 v15, v147, v147
    v_mul_f32 v252, v148, v148
    v_mfma_f32_16x16x32_bf16 v[72:75], v[240:243], v[204:207], v[72:75]
    v_mul_f32 v253, v149, v149
    v_mul_f32 v254, v150, v150
    v_mfma_f32_16x16x32_bf16 v[76:79], v[240:243], v[208:211], v[76:79]
    v_mul_f32 v255, v151, v151
    v_fma_f32 v12, v12, v5, v4
    v_mfma_f32_16x16x32_bf16 v[80:83], v[244:247], v[204:207], v[80:83]
    v_fma_f32 v13, v13, v5, v4
    v_fma_f32 v14, v14, v5, v4
    v_mfma_f32_16x16x32_bf16 v[84:87], v[244:247], v[208:211], v[84:87]
    v_fma_f32 v15, v15, v5, v4
    s_waitcnt lgkmcnt(5)
    v_mfma_f32_16x16x32_bf16 v[16:19], v[168:171], v[160:163], v[16:19]
    ds_read_b128 v[204:207], v11 offset:36864
    v_mfma_f32_16x16x32_bf16 v[20:23], v[168:171], v[164:167], v[20:23]
    ds_read_b128 v[208:211], v11 offset:38912
    v_fma_f32 v252, v252, v7, v6
    v_mfma_f32_16x16x32_bf16 v[24:27], v[172:175], v[160:163], v[24:27]
    ds_read_b128 v[212:215], v2 offset:46080
    v_fma_f32 v253, v253, v7, v6
    v_mfma_f32_16x16x32_bf16 v[28:31], v[172:175], v[164:167], v[28:31]
    ds_read_b128 v[216:219], v2 offset:47104
    v_fma_f32 v254, v254, v7, v6
    v_mfma_f32_16x16x32_bf16 v[32:35], v[176:179], v[160:163], v[32:35]
    ds_read_b128 v[220:223], v2 offset:48128
    v_fma_f32 v255, v255, v7, v6
    v_mfma_f32_16x16x32_bf16 v[36:39], v[176:179], v[164:167], v[36:39]
    ds_read_b128 v[224:227], v2 offset:49152
    v_mul_f32 v12, v12, v144
    v_mfma_f32_16x16x32_bf16 v[40:43], v[180:183], v[160:163], v[40:43]
    ds_read_b128 v[228:231], v2 offset:50176
    v_mul_f32 v13, v13, v145
    v_mfma_f32_16x16x32_bf16 v[44:47], v[180:183], v[164:167], v[44:47]
    ds_read_b128 v[232:235], v2 offset:51200
    s_waitcnt lgkmcnt(8)
    v_mfma_f32_16x16x32_bf16 v[48:51], v[184:187], v[160:163], v[48:51]
    ds_read_b128 v[236:239], v2 offset:52224
    v_mul_f32 v14, v14, v146
    v_mfma_f32_16x16x32_bf16 v[52:55], v[184:187], v[164:167], v[52:55]
    ds_read_b128 v[240:243], v2 offset:53248
    v_mul_f32 v15, v15, v147
    v_mfma_f32_16x16x32_bf16 v[56:59], v[188:191], v[160:163], v[56:59]
    ds_read_b128 v[244:247], v2 offset:54272
    v_mul_f32 v252, v252, v148
    v_mfma_f32_16x16x32_bf16 v[60:63], v[188:191], v[164:167], v[60:63]
    v_mul_f32 v253, v253, v149
    v_mul_f32 v254, v254, v150
    v_mfma_f32_16x16x32_bf16 v[64:67], v[192:195], v[160:163], v[64:67]
    v_mul_f32 v255, v255, v151
    v_exp_f32 v12, v12
    v_mfma_f32_16x16x32_bf16 v[68:71], v[192:195], v[164:167], v[68:71]
    v_exp_f32 v13, v13
    v_mfma_f32_16x16x32_bf16 v[72:75], v[196:199], v[160:163], v[72:75]
    v_exp_f32 v14, v14
    v_mfma_f32_16x16x32_bf16 v[76:79], v[196:199], v[164:167], v[76:79]
    v_exp_f32 v15, v15
    v_mfma_f32_16x16x32_bf16 v[80:83], v[200:203], v[160:163], v[80:83]
    v_exp_f32 v252, v252
    v_mfma_f32_16x16x32_bf16 v[84:87], v[200:203], v[164:167], v[84:87]
    v_exp_f32 v253, v253
    s_waitcnt lgkmcnt(0)
    s_barrier
    v_mfma_f32_16x16x32_bf16 v[16:19], v[212:215], v[204:207], v[16:19]
    ds_read_b128 v[160:163], v8 offset:0
    v_mfma_f32_16x16x32_bf16 v[20:23], v[212:215], v[208:211], v[20:23]
    ds_read_b128 v[164:167], v8 offset:2048
    v_exp_f32 v254, v254
    v_mfma_f32_16x16x32_bf16 v[24:27], v[216:219], v[204:207], v[24:27]
    ds_read_b128 v[168:171], v1 offset:0
    v_exp_f32 v255, v255
    v_mfma_f32_16x16x32_bf16 v[28:31], v[216:219], v[208:211], v[28:31]
    ds_read_b128 v[172:175], v1 offset:1024
    v_fma_f32 v12, v12, v249, v249
    v_mfma_f32_16x16x32_bf16 v[32:35], v[220:223], v[204:207], v[32:35]
    ds_read_b128 v[176:179], v1 offset:2048
    v_fma_f32 v13, v13, v249, v249
    v_mfma_f32_16x16x32_bf16 v[36:39], v[220:223], v[208:211], v[36:39]
    ds_read_b128 v[180:183], v1 offset:3072
    v_fma_f32 v14, v14, v249, v249
    v_mfma_f32_16x16x32_bf16 v[40:43], v[224:227], v[204:207], v[40:43]
    ds_read_b128 v[184:187], v1 offset:4096
    v_fma_f32 v15, v15, v249, v249
    v_mfma_f32_16x16x32_bf16 v[44:47], v[224:227], v[208:211], v[44:47]
    ds_read_b128 v[188:191], v1 offset:5120
    v_mfma_f32_16x16x32_bf16 v[48:51], v[228:231], v[204:207], v[48:51]
    ds_read_b128 v[192:195], v1 offset:6144
    v_fma_f32 v252, v252, v251, v251
    v_mfma_f32_16x16x32_bf16 v[52:55], v[228:231], v[208:211], v[52:55]
    ds_read_b128 v[196:199], v1 offset:7168
    v_fma_f32 v253, v253, v251, v251
    v_mfma_f32_16x16x32_bf16 v[56:59], v[232:235], v[204:207], v[56:59]
    ds_read_b128 v[200:203], v1 offset:8192
    v_fma_f32 v254, v254, v251, v251
    v_mfma_f32_16x16x32_bf16 v[60:63], v[232:235], v[208:211], v[60:63]
    v_fma_f32 v255, v255, v251, v251
    v_rcp_f32 v12, v12
    v_mfma_f32_16x16x32_bf16 v[64:67], v[236:239], v[204:207], v[64:67]
    v_rcp_f32 v13, v13
    v_mfma_f32_16x16x32_bf16 v[68:71], v[236:239], v[208:211], v[68:71]
    v_rcp_f32 v14, v14
    v_mfma_f32_16x16x32_bf16 v[72:75], v[240:243], v[204:207], v[72:75]
    v_rcp_f32 v15, v15
    v_mfma_f32_16x16x32_bf16 v[76:79], v[240:243], v[208:211], v[76:79]
    v_rcp_f32 v252, v252
    v_mfma_f32_16x16x32_bf16 v[80:83], v[244:247], v[204:207], v[80:83]
    v_rcp_f32 v253, v253
    v_mfma_f32_16x16x32_bf16 v[84:87], v[244:247], v[208:211], v[84:87]
    v_rcp_f32 v254, v254
    s_waitcnt lgkmcnt(5)
    v_mfma_f32_16x16x32_bf16 v[16:19], v[168:171], v[160:163], v[16:19]
    ds_read_b128 v[204:207], v9 offset:0
    v_mfma_f32_16x16x32_bf16 v[20:23], v[168:171], v[164:167], v[20:23]
    ds_read_b128 v[208:211], v9 offset:2048
    v_rcp_f32 v255, v255
    v_mfma_f32_16x16x32_bf16 v[24:27], v[172:175], v[160:163], v[24:27]
    ds_read_b128 v[212:215], v1 offset:9216
    v_mul_f32 v144, v144, v12
    v_mfma_f32_16x16x32_bf16 v[28:31], v[172:175], v[164:167], v[28:31]
    ds_read_b128 v[216:219], v1 offset:10240
    v_mul_f32 v145, v145, v13
    v_mfma_f32_16x16x32_bf16 v[32:35], v[176:179], v[160:163], v[32:35]
    ds_read_b128 v[220:223], v1 offset:11264
    v_mul_f32 v146, v146, v14
    v_mfma_f32_16x16x32_bf16 v[36:39], v[176:179], v[164:167], v[36:39]
    ds_read_b128 v[224:227], v1 offset:12288
    v_mul_f32 v147, v147, v15
    v_mfma_f32_16x16x32_bf16 v[40:43], v[180:183], v[160:163], v[40:43]
    ds_read_b128 v[228:231], v1 offset:13312
    v_mul_f32 v148, v148, v252
    v_mfma_f32_16x16x32_bf16 v[44:47], v[180:183], v[164:167], v[44:47]
    ds_read_b128 v[232:235], v1 offset:14336
    s_waitcnt lgkmcnt(8)
    v_mfma_f32_16x16x32_bf16 v[48:51], v[184:187], v[160:163], v[48:51]
    ds_read_b128 v[236:239], v1 offset:15360
    v_mul_f32 v149, v149, v253
    v_mfma_f32_16x16x32_bf16 v[52:55], v[184:187], v[164:167], v[52:55]
    ds_read_b128 v[240:243], v1 offset:16384
    v_mul_f32 v150, v150, v254
    v_mfma_f32_16x16x32_bf16 v[56:59], v[188:191], v[160:163], v[56:59]
    ds_read_b128 v[244:247], v1 offset:17408
    v_mul_f32 v151, v151, v255
    v_mfma_f32_16x16x32_bf16 v[60:63], v[188:191], v[164:167], v[60:63]
    v_mul_f32 v12, v152, v152
    v_mul_f32 v13, v153, v153
    v_mfma_f32_16x16x32_bf16 v[64:67], v[192:195], v[160:163], v[64:67]
    v_mul_f32 v14, v154, v154
    v_mul_f32 v15, v155, v155
    v_mfma_f32_16x16x32_bf16 v[68:71], v[192:195], v[164:167], v[68:71]
    v_mul_f32 v252, v156, v156
    v_mul_f32 v253, v157, v157
    v_mfma_f32_16x16x32_bf16 v[72:75], v[196:199], v[160:163], v[72:75]
    v_mul_f32 v254, v158, v158
    v_mul_f32 v255, v159, v159
    v_mfma_f32_16x16x32_bf16 v[76:79], v[196:199], v[164:167], v[76:79]
    v_fma_f32 v12, v12, v5, v4
    v_fma_f32 v13, v13, v5, v4
    v_mfma_f32_16x16x32_bf16 v[80:83], v[200:203], v[160:163], v[80:83]
    v_fma_f32 v14, v14, v5, v4
    v_fma_f32 v15, v15, v5, v4
    v_mfma_f32_16x16x32_bf16 v[84:87], v[200:203], v[164:167], v[84:87]
    v_fma_f32 v252, v252, v7, v6
    s_waitcnt lgkmcnt(0)
    s_barrier
    v_mfma_f32_16x16x32_bf16 v[16:19], v[212:215], v[204:207], v[16:19]
    ds_read_b128 v[160:163], v8 offset:36864
    v_mfma_f32_16x16x32_bf16 v[20:23], v[212:215], v[208:211], v[20:23]
    ds_read_b128 v[164:167], v8 offset:38912
    v_fma_f32 v253, v253, v7, v6
    v_mfma_f32_16x16x32_bf16 v[24:27], v[216:219], v[204:207], v[24:27]
    ds_read_b128 v[168:171], v1 offset:36864
    v_fma_f32 v254, v254, v7, v6
    v_mfma_f32_16x16x32_bf16 v[28:31], v[216:219], v[208:211], v[28:31]
    ds_read_b128 v[172:175], v1 offset:37888
    v_fma_f32 v255, v255, v7, v6
    v_mfma_f32_16x16x32_bf16 v[32:35], v[220:223], v[204:207], v[32:35]
    ds_read_b128 v[176:179], v1 offset:38912
    v_mul_f32 v12, v12, v152
    v_mfma_f32_16x16x32_bf16 v[36:39], v[220:223], v[208:211], v[36:39]
    ds_read_b128 v[180:183], v1 offset:39936
    v_mul_f32 v13, v13, v153
    v_mfma_f32_16x16x32_bf16 v[40:43], v[224:227], v[204:207], v[40:43]
    ds_read_b128 v[184:187], v1 offset:40960
    v_mul_f32 v14, v14, v154
    v_mfma_f32_16x16x32_bf16 v[44:47], v[224:227], v[208:211], v[44:47]
    ds_read_b128 v[188:191], v1 offset:41984
    v_mfma_f32_16x16x32_bf16 v[48:51], v[228:231], v[204:207], v[48:51]
    ds_read_b128 v[192:195], v1 offset:43008
    v_mul_f32 v15, v15, v155
    v_mfma_f32_16x16x32_bf16 v[52:55], v[228:231], v[208:211], v[52:55]
    ds_read_b128 v[196:199], v1 offset:44032
    v_mul_f32 v252, v252, v156
    v_mfma_f32_16x16x32_bf16 v[56:59], v[232:235], v[204:207], v[56:59]
    ds_read_b128 v[200:203], v1 offset:45056
    v_mul_f32 v253, v253, v157
    v_mfma_f32_16x16x32_bf16 v[60:63], v[232:235], v[208:211], v[60:63]
    v_mul_f32 v254, v254, v158
    v_mul_f32 v255, v255, v159
    v_mfma_f32_16x16x32_bf16 v[64:67], v[236:239], v[204:207], v[64:67]
    v_exp_f32 v12, v12
    v_mfma_f32_16x16x32_bf16 v[68:71], v[236:239], v[208:211], v[68:71]
    v_exp_f32 v13, v13
    v_mfma_f32_16x16x32_bf16 v[72:75], v[240:243], v[204:207], v[72:75]
    v_exp_f32 v14, v14
    v_mfma_f32_16x16x32_bf16 v[76:79], v[240:243], v[208:211], v[76:79]
    v_exp_f32 v15, v15
    v_mfma_f32_16x16x32_bf16 v[80:83], v[244:247], v[204:207], v[80:83]
    v_exp_f32 v252, v252
    v_mfma_f32_16x16x32_bf16 v[84:87], v[244:247], v[208:211], v[84:87]
    v_exp_f32 v253, v253
    s_waitcnt lgkmcnt(5)
    v_mfma_f32_16x16x32_bf16 v[16:19], v[168:171], v[160:163], v[16:19]
    ds_read_b128 v[204:207], v9 offset:36864
    v_mfma_f32_16x16x32_bf16 v[20:23], v[168:171], v[164:167], v[20:23]
    ds_read_b128 v[208:211], v9 offset:38912
    v_exp_f32 v254, v254
    v_mfma_f32_16x16x32_bf16 v[24:27], v[172:175], v[160:163], v[24:27]
    ds_read_b128 v[212:215], v1 offset:46080
    v_exp_f32 v255, v255
    v_mfma_f32_16x16x32_bf16 v[28:31], v[172:175], v[164:167], v[28:31]
    ds_read_b128 v[216:219], v1 offset:47104
    v_fma_f32 v12, v12, v249, v249
    v_mfma_f32_16x16x32_bf16 v[32:35], v[176:179], v[160:163], v[32:35]
    ds_read_b128 v[220:223], v1 offset:48128
    v_fma_f32 v13, v13, v249, v249
    v_mfma_f32_16x16x32_bf16 v[36:39], v[176:179], v[164:167], v[36:39]
    ds_read_b128 v[224:227], v1 offset:49152
    v_fma_f32 v14, v14, v249, v249
    v_mfma_f32_16x16x32_bf16 v[40:43], v[180:183], v[160:163], v[40:43]
    ds_read_b128 v[228:231], v1 offset:50176
    v_fma_f32 v15, v15, v249, v249
    v_mfma_f32_16x16x32_bf16 v[44:47], v[180:183], v[164:167], v[44:47]
    ds_read_b128 v[232:235], v1 offset:51200
    s_waitcnt lgkmcnt(8)
    v_mfma_f32_16x16x32_bf16 v[48:51], v[184:187], v[160:163], v[48:51]
    ds_read_b128 v[236:239], v1 offset:52224
    v_fma_f32 v252, v252, v251, v251
    v_mfma_f32_16x16x32_bf16 v[52:55], v[184:187], v[164:167], v[52:55]
    ds_read_b128 v[240:243], v1 offset:53248
    v_fma_f32 v253, v253, v251, v251
    v_mfma_f32_16x16x32_bf16 v[56:59], v[188:191], v[160:163], v[56:59]
    ds_read_b128 v[244:247], v1 offset:54272
    v_fma_f32 v254, v254, v251, v251
    v_mfma_f32_16x16x32_bf16 v[60:63], v[188:191], v[164:167], v[60:63]
    v_fma_f32 v255, v255, v251, v251
    v_rcp_f32 v12, v12
    v_mfma_f32_16x16x32_bf16 v[64:67], v[192:195], v[160:163], v[64:67]
    v_rcp_f32 v13, v13
    v_mfma_f32_16x16x32_bf16 v[68:71], v[192:195], v[164:167], v[68:71]
    v_rcp_f32 v14, v14
    v_mfma_f32_16x16x32_bf16 v[72:75], v[196:199], v[160:163], v[72:75]
    v_rcp_f32 v15, v15
    v_mfma_f32_16x16x32_bf16 v[76:79], v[196:199], v[164:167], v[76:79]
    v_rcp_f32 v252, v252
    v_mfma_f32_16x16x32_bf16 v[80:83], v[200:203], v[160:163], v[80:83]
    v_rcp_f32 v253, v253
    v_mfma_f32_16x16x32_bf16 v[84:87], v[200:203], v[164:167], v[84:87]
    v_rcp_f32 v254, v254
    s_waitcnt lgkmcnt(0)
    s_barrier
    v_mfma_f32_16x16x32_bf16 v[16:19], v[212:215], v[204:207], v[16:19]
    ds_read_b128 v[160:163], v10 offset:0
    v_mfma_f32_16x16x32_bf16 v[20:23], v[212:215], v[208:211], v[20:23]
    ds_read_b128 v[164:167], v10 offset:2048
    v_rcp_f32 v255, v255
    v_mfma_f32_16x16x32_bf16 v[24:27], v[216:219], v[204:207], v[24:27]
    ds_read_b128 v[168:171], v2 offset:0
    v_mul_f32 v152, v152, v12
    v_mfma_f32_16x16x32_bf16 v[28:31], v[216:219], v[208:211], v[28:31]
    ds_read_b128 v[172:175], v2 offset:1024
    v_mul_f32 v153, v153, v13
    v_mfma_f32_16x16x32_bf16 v[32:35], v[220:223], v[204:207], v[32:35]
    ds_read_b128 v[176:179], v2 offset:2048
    v_mul_f32 v154, v154, v14
    v_mfma_f32_16x16x32_bf16 v[36:39], v[220:223], v[208:211], v[36:39]
    ds_read_b128 v[180:183], v2 offset:3072
    v_mul_f32 v155, v155, v15
    v_mfma_f32_16x16x32_bf16 v[40:43], v[224:227], v[204:207], v[40:43]
    ds_read_b128 v[184:187], v2 offset:4096
    v_mul_f32 v156, v156, v252
    v_mfma_f32_16x16x32_bf16 v[44:47], v[224:227], v[208:211], v[44:47]
    ds_read_b128 v[188:191], v2 offset:5120
    v_mfma_f32_16x16x32_bf16 v[48:51], v[228:231], v[204:207], v[48:51]
    ds_read_b128 v[192:195], v2 offset:6144
    v_mul_f32 v157, v157, v253
    v_mfma_f32_16x16x32_bf16 v[52:55], v[228:231], v[208:211], v[52:55]
    ds_read_b128 v[196:199], v2 offset:7168
    v_mul_f32 v158, v158, v254
    v_mfma_f32_16x16x32_bf16 v[56:59], v[232:235], v[204:207], v[56:59]
    ds_read_b128 v[200:203], v2 offset:8192
    v_mul_f32 v159, v159, v255
    v_mfma_f32_16x16x32_bf16 v[60:63], v[232:235], v[208:211], v[60:63]
    s_mul_i32 s36, s31, 73728
    s_add_u32 s36, s36, s21
    v_mfma_f32_16x16x32_bf16 v[64:67], v[236:239], v[204:207], v[64:67]
    s_lshl_b32 s34, s24, 10
    s_lshr_b32 s35, s24, 1
    v_mfma_f32_16x16x32_bf16 v[68:71], v[236:239], v[208:211], v[68:71]
    s_lshl_b32 s35, s35, 10
    s_and_b32 s33, s24, 1
    v_mfma_f32_16x16x32_bf16 v[72:75], v[240:243], v[204:207], v[72:75]
    s_mul_i32 s33, s33, 73728
    s_add_u32 s35, s35, s33
    v_mfma_f32_16x16x32_bf16 v[76:79], v[240:243], v[208:211], v[76:79]
    s_add_u32 s35, s35, 65536
    v_add_u32 v14, s34, v1
    v_mfma_f32_16x16x32_bf16 v[80:83], v[244:247], v[204:207], v[80:83]
    v_add_u32 v15, s35, v1
    s_add_u32 s39, s36, 0x1200000
    v_mfma_f32_16x16x32_bf16 v[84:87], v[244:247], v[208:211], v[84:87]
    s_add_u32 s40, s36, 0x1212000
    s_mov_b32 s41, 5
    .p2align 6
L_g_loop:
    s_waitcnt lgkmcnt(5)
    v_mfma_f32_16x16x32_bf16 v[16:19], v[168:171], v[160:163], v[16:19]
    ds_read_b128 v[204:207], v11 offset:0
    v_mfma_f32_16x16x32_bf16 v[20:23], v[168:171], v[164:167], v[20:23]
    ds_read_b128 v[208:211], v11 offset:2048
    v_mfma_f32_16x16x32_bf16 v[24:27], v[172:175], v[160:163], v[24:27]
    ds_read_b128 v[212:215], v2 offset:9216
    v_mfma_f32_16x16x32_bf16 v[28:31], v[172:175], v[164:167], v[28:31]
    ds_read_b128 v[216:219], v2 offset:10240
    v_mfma_f32_16x16x32_bf16 v[32:35], v[176:179], v[160:163], v[32:35]
    ds_read_b128 v[220:223], v2 offset:11264
    v_mfma_f32_16x16x32_bf16 v[36:39], v[176:179], v[164:167], v[36:39]
    ds_read_b128 v[224:227], v2 offset:12288
    v_mfma_f32_16x16x32_bf16 v[40:43], v[180:183], v[160:163], v[40:43]
    ds_read_b128 v[228:231], v2 offset:13312
    v_mfma_f32_16x16x32_bf16 v[44:47], v[180:183], v[164:167], v[44:47]
    ds_read_b128 v[232:235], v2 offset:14336
    s_waitcnt lgkmcnt(8)
    v_mfma_f32_16x16x32_bf16 v[48:51], v[184:187], v[160:163], v[48:51]
    ds_read_b128 v[236:239], v2 offset:15360
    v_mfma_f32_16x16x32_bf16 v[52:55], v[184:187], v[164:167], v[52:55]
    ds_read_b128 v[240:243], v2 offset:16384
    v_mfma_f32_16x16x32_bf16 v[56:59], v[188:191], v[160:163], v[56:59]
    ds_read_b128 v[244:247], v2 offset:17408
    v_mfma_f32_16x16x32_bf16 v[60:63], v[188:191], v[164:167], v[60:63]
    v_mfma_f32_16x16x32_bf16 v[64:67], v[192:195], v[160:163], v[64:67]
    v_mfma_f32_16x16x32_bf16 v[68:71], v[192:195], v[164:167], v[68:71]
    v_mfma_f32_16x16x32_bf16 v[72:75], v[196:199], v[160:163], v[72:75]
    v_mfma_f32_16x16x32_bf16 v[76:79], v[196:199], v[164:167], v[76:79]
    v_mfma_f32_16x16x32_bf16 v[80:83], v[200:203], v[160:163], v[80:83]
    v_mfma_f32_16x16x32_bf16 v[84:87], v[200:203], v[164:167], v[84:87]
    s_waitcnt lgkmcnt(0)
    s_barrier
    v_mfma_f32_16x16x32_bf16 v[16:19], v[212:215], v[204:207], v[16:19]
    ds_read_b128 v[160:163], v10 offset:36864
    v_mfma_f32_16x16x32_bf16 v[20:23], v[212:215], v[208:211], v[20:23]
    ds_read_b128 v[164:167], v10 offset:38912
    v_mfma_f32_16x16x32_bf16 v[24:27], v[216:219], v[204:207], v[24:27]
    ds_read_b128 v[168:171], v2 offset:36864
    v_mfma_f32_16x16x32_bf16 v[28:31], v[216:219], v[208:211], v[28:31]
    ds_read_b128 v[172:175], v2 offset:37888
    v_mfma_f32_16x16x32_bf16 v[32:35], v[220:223], v[204:207], v[32:35]
    ds_read_b128 v[176:179], v2 offset:38912
    v_mfma_f32_16x16x32_bf16 v[36:39], v[220:223], v[208:211], v[36:39]
    ds_read_b128 v[180:183], v2 offset:39936
    v_mfma_f32_16x16x32_bf16 v[40:43], v[224:227], v[204:207], v[40:43]
    ds_read_b128 v[184:187], v2 offset:40960
    v_mfma_f32_16x16x32_bf16 v[44:47], v[224:227], v[208:211], v[44:47]
    ds_read_b128 v[188:191], v2 offset:41984
    v_mfma_f32_16x16x32_bf16 v[48:51], v[228:231], v[204:207], v[48:51]
    ds_read_b128 v[192:195], v2 offset:43008
    v_mfma_f32_16x16x32_bf16 v[52:55], v[228:231], v[208:211], v[52:55]
    ds_read_b128 v[196:199], v2 offset:44032
    v_mfma_f32_16x16x32_bf16 v[56:59], v[232:235], v[204:207], v[56:59]
    ds_read_b128 v[200:203], v2 offset:45056
    v_mfma_f32_16x16x32_bf16 v[60:63], v[232:235], v[208:211], v[60:63]
    v_mfma_f32_16x16x32_bf16 v[64:67], v[236:239], v[204:207], v[64:67]
    v_mfma_f32_16x16x32_bf16 v[68:71], v[236:239], v[208:211], v[68:71]
    v_mfma_f32_16x16x32_bf16 v[72:75], v[240:243], v[204:207], v[72:75]
    v_mfma_f32_16x16x32_bf16 v[76:79], v[240:243], v[208:211], v[76:79]
    v_mfma_f32_16x16x32_bf16 v[80:83], v[244:247], v[204:207], v[80:83]
    v_mfma_f32_16x16x32_bf16 v[84:87], v[244:247], v[208:211], v[84:87]
    s_waitcnt lgkmcnt(5)
    v_mfma_f32_16x16x32_bf16 v[16:19], v[168:171], v[160:163], v[16:19]
    ds_read_b128 v[204:207], v11 offset:36864
    v_mfma_f32_16x16x32_bf16 v[20:23], v[168:171], v[164:167], v[20:23]
    ds_read_b128 v[208:211], v11 offset:38912
    v_mfma_f32_16x16x32_bf16 v[24:27], v[172:175], v[160:163], v[24:27]
    ds_read_b128 v[212:215], v2 offset:46080
    v_mfma_f32_16x16x32_bf16 v[28:31], v[172:175], v[164:167], v[28:31]
    ds_read_b128 v[216:219], v2 offset:47104
    v_mfma_f32_16x16x32_bf16 v[32:35], v[176:179], v[160:163], v[32:35]
    ds_read_b128 v[220:223], v2 offset:48128
    v_mfma_f32_16x16x32_bf16 v[36:39], v[176:179], v[164:167], v[36:39]
    ds_read_b128 v[224:227], v2 offset:49152
    v_mfma_f32_16x16x32_bf16 v[40:43], v[180:183], v[160:163], v[40:43]
    ds_read_b128 v[228:231], v2 offset:50176
    v_mfma_f32_16x16x32_bf16 v[44:47], v[180:183], v[164:167], v[44:47]
    ds_read_b128 v[232:235], v2 offset:51200
    s_waitcnt lgkmcnt(8)
    v_mfma_f32_16x16x32_bf16 v[48:51], v[184:187], v[160:163], v[48:51]
    ds_read_b128 v[236:239], v2 offset:52224
    v_mfma_f32_16x16x32_bf16 v[52:55], v[184:187], v[164:167], v[52:55]
    ds_read_b128 v[240:243], v2 offset:53248
    v_mfma_f32_16x16x32_bf16 v[56:59], v[188:191], v[160:163], v[56:59]
    ds_read_b128 v[244:247], v2 offset:54272
    v_mfma_f32_16x16x32_bf16 v[60:63], v[188:191], v[164:167], v[60:63]
    v_mfma_f32_16x16x32_bf16 v[64:67], v[192:195], v[160:163], v[64:67]
    v_mfma_f32_16x16x32_bf16 v[68:71], v[192:195], v[164:167], v[68:71]
    v_mfma_f32_16x16x32_bf16 v[72:75], v[196:199], v[160:163], v[72:75]
    v_mfma_f32_16x16x32_bf16 v[76:79], v[196:199], v[164:167], v[76:79]
    v_mfma_f32_16x16x32_bf16 v[80:83], v[200:203], v[160:163], v[80:83]
    v_mfma_f32_16x16x32_bf16 v[84:87], v[200:203], v[164:167], v[84:87]
    s_waitcnt lgkmcnt(0)
    s_barrier
    v_mfma_f32_16x16x32_bf16 v[16:19], v[212:215], v[204:207], v[16:19]
    ds_read_b128 v[160:163], v8 offset:0
    v_mfma_f32_16x16x32_bf16 v[20:23], v[212:215], v[208:211], v[20:23]
    ds_read_b128 v[164:167], v8 offset:2048
    v_mfma_f32_16x16x32_bf16 v[24:27], v[216:219], v[204:207], v[24:27]
    ds_read_b128 v[168:171], v1 offset:0
    v_mfma_f32_16x16x32_bf16 v[28:31], v[216:219], v[208:211], v[28:31]
    ds_read_b128 v[172:175], v1 offset:1024
    v_mfma_f32_16x16x32_bf16 v[32:35], v[220:223], v[204:207], v[32:35]
    ds_read_b128 v[176:179], v1 offset:2048
    v_mfma_f32_16x16x32_bf16 v[36:39], v[220:223], v[208:211], v[36:39]
    ds_read_b128 v[180:183], v1 offset:3072
    v_mfma_f32_16x16x32_bf16 v[40:43], v[224:227], v[204:207], v[40:43]
    ds_read_b128 v[184:187], v1 offset:4096
    v_mfma_f32_16x16x32_bf16 v[44:47], v[224:227], v[208:211], v[44:47]
    ds_read_b128 v[188:191], v1 offset:5120
    v_mfma_f32_16x16x32_bf16 v[48:51], v[228:231], v[204:207], v[48:51]
    ds_read_b128 v[192:195], v1 offset:6144
    v_mfma_f32_16x16x32_bf16 v[52:55], v[228:231], v[208:211], v[52:55]
    ds_read_b128 v[196:199], v1 offset:7168
    v_mfma_f32_16x16x32_bf16 v[56:59], v[232:235], v[204:207], v[56:59]
    ds_read_b128 v[200:203], v1 offset:8192
    v_mfma_f32_16x16x32_bf16 v[60:63], v[232:235], v[208:211], v[60:63]
    v_mfma_f32_16x16x32_bf16 v[64:67], v[236:239], v[204:207], v[64:67]
    v_mfma_f32_16x16x32_bf16 v[68:71], v[236:239], v[208:211], v[68:71]
    v_mfma_f32_16x16x32_bf16 v[72:75], v[240:243], v[204:207], v[72:75]
    v_mfma_f32_16x16x32_bf16 v[76:79], v[240:243], v[208:211], v[76:79]
    v_mfma_f32_16x16x32_bf16 v[80:83], v[244:247], v[204:207], v[80:83]
    v_mfma_f32_16x16x32_bf16 v[84:87], v[244:247], v[208:211], v[84:87]
    s_waitcnt lgkmcnt(5)
    v_mfma_f32_16x16x32_bf16 v[16:19], v[168:171], v[160:163], v[16:19]
    ds_read_b128 v[204:207], v9 offset:0
    v_mfma_f32_16x16x32_bf16 v[20:23], v[168:171], v[164:167], v[20:23]
    ds_read_b128 v[208:211], v9 offset:2048
    v_mfma_f32_16x16x32_bf16 v[24:27], v[172:175], v[160:163], v[24:27]
    ds_read_b128 v[212:215], v1 offset:9216
    v_mfma_f32_16x16x32_bf16 v[28:31], v[172:175], v[164:167], v[28:31]
    ds_read_b128 v[216:219], v1 offset:10240
    v_mfma_f32_16x16x32_bf16 v[32:35], v[176:179], v[160:163], v[32:35]
    ds_read_b128 v[220:223], v1 offset:11264
    v_mfma_f32_16x16x32_bf16 v[36:39], v[176:179], v[164:167], v[36:39]
    ds_read_b128 v[224:227], v1 offset:12288
    v_mfma_f32_16x16x32_bf16 v[40:43], v[180:183], v[160:163], v[40:43]
    ds_read_b128 v[228:231], v1 offset:13312
    v_mfma_f32_16x16x32_bf16 v[44:47], v[180:183], v[164:167], v[44:47]
    ds_read_b128 v[232:235], v1 offset:14336
    s_waitcnt lgkmcnt(8)
    v_mfma_f32_16x16x32_bf16 v[48:51], v[184:187], v[160:163], v[48:51]
    ds_read_b128 v[236:239], v1 offset:15360
    v_mfma_f32_16x16x32_bf16 v[52:55], v[184:187], v[164:167], v[52:55]
    ds_read_b128 v[240:243], v1 offset:16384
    v_mfma_f32_16x16x32_bf16 v[56:59], v[188:191], v[160:163], v[56:59]
    ds_read_b128 v[244:247], v1 offset:17408
    v_mfma_f32_16x16x32_bf16 v[60:63], v[188:191], v[164:167], v[60:63]
    v_mfma_f32_16x16x32_bf16 v[64:67], v[192:195], v[160:163], v[64:67]
    v_mfma_f32_16x16x32_bf16 v[68:71], v[192:195], v[164:167], v[68:71]
    v_mfma_f32_16x16x32_bf16 v[72:75], v[196:199], v[160:163], v[72:75]
    v_mfma_f32_16x16x32_bf16 v[76:79], v[196:199], v[164:167], v[76:79]
    v_mfma_f32_16x16x32_bf16 v[80:83], v[200:203], v[160:163], v[80:83]
    v_mfma_f32_16x16x32_bf16 v[84:87], v[200:203], v[164:167], v[84:87]
    s_waitcnt lgkmcnt(0)
    s_barrier
    v_mfma_f32_16x16x32_bf16 v[16:19], v[212:215], v[204:207], v[16:19]
    ds_read_b128 v[160:163], v8 offset:36864
    v_mfma_f32_16x16x32_bf16 v[20:23], v[212:215], v[208:211], v[20:23]
    ds_read_b128 v[164:167], v8 offset:38912
    v_mfma_f32_16x16x32_bf16 v[24:27], v[216:219], v[204:207], v[24:27]
    ds_read_b128 v[168:171], v1 offset:36864
    v_mfma_f32_16x16x32_bf16 v[28:31], v[216:219], v[208:211], v[28:31]
    ds_read_b128 v[172:175], v1 offset:37888
    v_mfma_f32_16x16x32_bf16 v[32:35], v[220:223], v[204:207], v[32:35]
    ds_read_b128 v[176:179], v1 offset:38912
    v_mfma_f32_16x16x32_bf16 v[36:39], v[220:223], v[208:211], v[36:39]
    ds_read_b128 v[180:183], v1 offset:39936
    v_mfma_f32_16x16x32_bf16 v[40:43], v[224:227], v[204:207], v[40:43]
    ds_read_b128 v[184:187], v1 offset:40960
    v_mfma_f32_16x16x32_bf16 v[44:47], v[224:227], v[208:211], v[44:47]
    ds_read_b128 v[188:191], v1 offset:41984
    v_mfma_f32_16x16x32_bf16 v[48:51], v[228:231], v[204:207], v[48:51]
    ds_read_b128 v[192:195], v1 offset:43008
    v_mfma_f32_16x16x32_bf16 v[52:55], v[228:231], v[208:211], v[52:55]
    ds_read_b128 v[196:199], v1 offset:44032
    v_mfma_f32_16x16x32_bf16 v[56:59], v[232:235], v[204:207], v[56:59]
    ds_read_b128 v[200:203], v1 offset:45056
    v_mfma_f32_16x16x32_bf16 v[60:63], v[232:235], v[208:211], v[60:63]
    v_mfma_f32_16x16x32_bf16 v[64:67], v[236:239], v[204:207], v[64:67]
    v_mfma_f32_16x16x32_bf16 v[68:71], v[236:239], v[208:211], v[68:71]
    v_mfma_f32_16x16x32_bf16 v[72:75], v[240:243], v[204:207], v[72:75]
    v_mfma_f32_16x16x32_bf16 v[76:79], v[240:243], v[208:211], v[76:79]
    v_mfma_f32_16x16x32_bf16 v[80:83], v[244:247], v[204:207], v[80:83]
    v_mfma_f32_16x16x32_bf16 v[84:87], v[244:247], v[208:211], v[84:87]
    s_waitcnt lgkmcnt(5)
    v_mfma_f32_16x16x32_bf16 v[16:19], v[168:171], v[160:163], v[16:19]
    ds_read_b128 v[204:207], v9 offset:36864
    v_mfma_f32_16x16x32_bf16 v[20:23], v[168:171], v[164:167], v[20:23]
    ds_read_b128 v[208:211], v9 offset:38912
    v_mfma_f32_16x16x32_bf16 v[24:27], v[172:175], v[160:163], v[24:27]
    ds_read_b128 v[212:215], v1 offset:46080
    v_mfma_f32_16x16x32_bf16 v[28:31], v[172:175], v[164:167], v[28:31]
    ds_read_b128 v[216:219], v1 offset:47104
    v_mfma_f32_16x16x32_bf16 v[32:35], v[176:179], v[160:163], v[32:35]
    ds_read_b128 v[220:223], v1 offset:48128
    v_mfma_f32_16x16x32_bf16 v[36:39], v[176:179], v[164:167], v[36:39]
    ds_read_b128 v[224:227], v1 offset:49152
    v_mfma_f32_16x16x32_bf16 v[40:43], v[180:183], v[160:163], v[40:43]
    ds_read_b128 v[228:231], v1 offset:50176
    v_mfma_f32_16x16x32_bf16 v[44:47], v[180:183], v[164:167], v[44:47]
    ds_read_b128 v[232:235], v1 offset:51200
    s_waitcnt lgkmcnt(8)
    v_mfma_f32_16x16x32_bf16 v[48:51], v[184:187], v[160:163], v[48:51]
    ds_read_b128 v[236:239], v1 offset:52224
    v_mfma_f32_16x16x32_bf16 v[52:55], v[184:187], v[164:167], v[52:55]
    ds_read_b128 v[240:243], v1 offset:53248
    v_mfma_f32_16x16x32_bf16 v[56:59], v[188:191], v[160:163], v[56:59]
    ds_read_b128 v[244:247], v1 offset:54272
    v_mfma_f32_16x16x32_bf16 v[60:63], v[188:191], v[164:167], v[60:63]
    v_mfma_f32_16x16x32_bf16 v[64:67], v[192:195], v[160:163], v[64:67]
    v_mfma_f32_16x16x32_bf16 v[68:71], v[192:195], v[164:167], v[68:71]
    v_mfma_f32_16x16x32_bf16 v[72:75], v[196:199], v[160:163], v[72:75]
    v_mfma_f32_16x16x32_bf16 v[76:79], v[196:199], v[164:167], v[76:79]
    v_mfma_f32_16x16x32_bf16 v[80:83], v[200:203], v[160:163], v[80:83]
    v_mfma_f32_16x16x32_bf16 v[84:87], v[200:203], v[164:167], v[84:87]
    s_waitcnt lgkmcnt(0)
    s_barrier
    v_mfma_f32_16x16x32_bf16 v[16:19], v[212:215], v[204:207], v[16:19]
    ds_read_b128 v[160:163], v10 offset:0
    v_mfma_f32_16x16x32_bf16 v[20:23], v[212:215], v[208:211], v[20:23]
    ds_read_b128 v[164:167], v10 offset:2048
    v_mfma_f32_16x16x32_bf16 v[24:27], v[216:219], v[204:207], v[24:27]
    ds_read_b128 v[168:171], v2 offset:0
    v_mfma_f32_16x16x32_bf16 v[28:31], v[216:219], v[208:211], v[28:31]
    ds_read_b128 v[172:175], v2 offset:1024
    v_mfma_f32_16x16x32_bf16 v[32:35], v[220:223], v[204:207], v[32:35]
    ds_read_b128 v[176:179], v2 offset:2048
    v_mfma_f32_16x16x32_bf16 v[36:39], v[220:223], v[208:211], v[36:39]
    ds_read_b128 v[180:183], v2 offset:3072
    v_mfma_f32_16x16x32_bf16 v[40:43], v[224:227], v[204:207], v[40:43]
    ds_read_b128 v[184:187], v2 offset:4096
    v_mfma_f32_16x16x32_bf16 v[44:47], v[224:227], v[208:211], v[44:47]
    ds_read_b128 v[188:191], v2 offset:5120
    v_mfma_f32_16x16x32_bf16 v[48:51], v[228:231], v[204:207], v[48:51]
    ds_read_b128 v[192:195], v2 offset:6144
    v_mfma_f32_16x16x32_bf16 v[52:55], v[228:231], v[208:211], v[52:55]
    ds_read_b128 v[196:199], v2 offset:7168
    v_mfma_f32_16x16x32_bf16 v[56:59], v[232:235], v[204:207], v[56:59]
    ds_read_b128 v[200:203], v2 offset:8192
    v_mfma_f32_16x16x32_bf16 v[60:63], v[232:235], v[208:211], v[60:63]
    v_mfma_f32_16x16x32_bf16 v[64:67], v[236:239], v[204:207], v[64:67]
    v_mfma_f32_16x16x32_bf16 v[68:71], v[236:239], v[208:211], v[68:71]
    v_mfma_f32_16x16x32_bf16 v[72:75], v[240:243], v[204:207], v[72:75]
    v_mfma_f32_16x16x32_bf16 v[76:79], v[240:243], v[208:211], v[76:79]
    v_mfma_f32_16x16x32_bf16 v[80:83], v[244:247], v[204:207], v[80:83]
    s_sub_u32 s41, s41, 1
    v_mfma_f32_16x16x32_bf16 v[84:87], v[244:247], v[208:211], v[84:87]
    s_cmp_lg_u32 s41, 0
    s_cbranch_scc1 L_g_loop
    s_waitcnt lgkmcnt(5)
    v_mfma_f32_16x16x32_bf16 v[16:19], v[168:171], v[160:163], v[16:19]
    ds_read_b128 v[204:207], v11 offset:0
    v_mfma_f32_16x16x32_bf16 v[20:23], v[168:171], v[164:167], v[20:23]
    ds_read_b128 v[208:211], v11 offset:2048
    v_mfma_f32_16x16x32_bf16 v[24:27], v[172:175], v[160:163], v[24:27]
    ds_read_b128 v[212:215], v2 offset:9216
    v_mfma_f32_16x16x32_bf16 v[28:31], v[172:175], v[164:167], v[28:31]
    ds_read_b128 v[216:219], v2 offset:10240
    v_mfma_f32_16x16x32_bf16 v[32:35], v[176:179], v[160:163], v[32:35]
    ds_read_b128 v[220:223], v2 offset:11264
    v_mfma_f32_16x16x32_bf16 v[36:39], v[176:179], v[164:167], v[36:39]
    ds_read_b128 v[224:227], v2 offset:12288
    v_mfma_f32_16x16x32_bf16 v[40:43], v[180:183], v[160:163], v[40:43]
    ds_read_b128 v[228:231], v2 offset:13312
    v_mfma_f32_16x16x32_bf16 v[44:47], v[180:183], v[164:167], v[44:47]
    ds_read_b128 v[232:235], v2 offset:14336
    s_waitcnt lgkmcnt(8)
    v_mfma_f32_16x16x32_bf16 v[48:51], v[184:187], v[160:163], v[48:51]
    ds_read_b128 v[236:239], v2 offset:15360
    v_mfma_f32_16x16x32_bf16 v[52:55], v[184:187], v[164:167], v[52:55]
    ds_read_b128 v[240:243], v2 offset:16384
    v_mfma_f32_16x16x32_bf16 v[56:59], v[188:191], v[160:163], v[56:59]
    ds_read_b128 v[244:247], v2 offset:17408
    v_mfma_f32_16x16x32_bf16 v[60:63], v[188:191], v[164:167], v[60:63]
    v_mfma_f32_16x16x32_bf16 v[64:67], v[192:195], v[160:163], v[64:67]
    v_mfma_f32_16x16x32_bf16 v[68:71], v[192:195], v[164:167], v[68:71]
    v_mfma_f32_16x16x32_bf16 v[72:75], v[196:199], v[160:163], v[72:75]
    v_mfma_f32_16x16x32_bf16 v[76:79], v[196:199], v[164:167], v[76:79]
    v_mfma_f32_16x16x32_bf16 v[80:83], v[200:203], v[160:163], v[80:83]
    v_mfma_f32_16x16x32_bf16 v[84:87], v[200:203], v[164:167], v[84:87]
    s_waitcnt lgkmcnt(0)
    s_barrier
    v_mfma_f32_16x16x32_bf16 v[16:19], v[212:215], v[204:207], v[16:19]
    ds_read_b128 v[160:163], v10 offset:36864
    v_mfma_f32_16x16x32_bf16 v[20:23], v[212:215], v[208:211], v[20:23]
    ds_read_b128 v[164:167], v10 offset:38912
    v_mfma_f32_16x16x32_bf16 v[24:27], v[216:219], v[204:207], v[24:27]
    ds_read_b128 v[168:171], v2 offset:36864
    v_mfma_f32_16x16x32_bf16 v[28:31], v[216:219], v[208:211], v[28:31]
    ds_read_b128 v[172:175], v2 offset:37888
    v_mfma_f32_16x16x32_bf16 v[32:35], v[220:223], v[204:207], v[32:35]
    ds_read_b128 v[176:179], v2 offset:38912
    v_mfma_f32_16x16x32_bf16 v[36:39], v[220:223], v[208:211], v[36:39]
    ds_read_b128 v[180:183], v2 offset:39936
    v_mfma_f32_16x16x32_bf16 v[40:43], v[224:227], v[204:207], v[40:43]
    ds_read_b128 v[184:187], v2 offset:40960
    v_mfma_f32_16x16x32_bf16 v[44:47], v[224:227], v[208:211], v[44:47]
    ds_read_b128 v[188:191], v2 offset:41984
    v_mfma_f32_16x16x32_bf16 v[48:51], v[228:231], v[204:207], v[48:51]
    ds_read_b128 v[192:195], v2 offset:43008
    v_mfma_f32_16x16x32_bf16 v[52:55], v[228:231], v[208:211], v[52:55]
    ds_read_b128 v[196:199], v2 offset:44032
    v_mfma_f32_16x16x32_bf16 v[56:59], v[232:235], v[204:207], v[56:59]
    ds_read_b128 v[200:203], v2 offset:45056
    v_mfma_f32_16x16x32_bf16 v[60:63], v[232:235], v[208:211], v[60:63]
    v_mfma_f32_16x16x32_bf16 v[64:67], v[236:239], v[204:207], v[64:67]
    v_mfma_f32_16x16x32_bf16 v[68:71], v[236:239], v[208:211], v[68:71]
    v_mfma_f32_16x16x32_bf16 v[72:75], v[240:243], v[204:207], v[72:75]
    v_mfma_f32_16x16x32_bf16 v[76:79], v[240:243], v[208:211], v[76:79]
    v_mfma_f32_16x16x32_bf16 v[80:83], v[244:247], v[204:207], v[80:83]
    v_mfma_f32_16x16x32_bf16 v[84:87], v[244:247], v[208:211], v[84:87]
    s_waitcnt lgkmcnt(5)
    v_mfma_f32_16x16x32_bf16 v[16:19], v[168:171], v[160:163], v[16:19]
    ds_read_b128 v[204:207], v11 offset:36864
    v_mfma_f32_16x16x32_bf16 v[20:23], v[168:171], v[164:167], v[20:23]
    ds_read_b128 v[208:211], v11 offset:38912
    v_mfma_f32_16x16x32_bf16 v[24:27], v[172:175], v[160:163], v[24:27]
    ds_read_b128 v[212:215], v2 offset:46080
    v_mfma_f32_16x16x32_bf16 v[28:31], v[172:175], v[164:167], v[28:31]
    ds_read_b128 v[216:219], v2 offset:47104
    v_mfma_f32_16x16x32_bf16 v[32:35], v[176:179], v[160:163], v[32:35]
    ds_read_b128 v[220:223], v2 offset:48128
    v_mfma_f32_16x16x32_bf16 v[36:39], v[176:179], v[164:167], v[36:39]
    ds_read_b128 v[224:227], v2 offset:49152
    v_mfma_f32_16x16x32_bf16 v[40:43], v[180:183], v[160:163], v[40:43]
    ds_read_b128 v[228:231], v2 offset:50176
    v_mfma_f32_16x16x32_bf16 v[44:47], v[180:183], v[164:167], v[44:47]
    ds_read_b128 v[232:235], v2 offset:51200
    s_waitcnt lgkmcnt(8)
    v_mfma_f32_16x16x32_bf16 v[48:51], v[184:187], v[160:163], v[48:51]
    ds_read_b128 v[236:239], v2 offset:52224
    v_mfma_f32_16x16x32_bf16 v[52:55], v[184:187], v[164:167], v[52:55]
    ds_read_b128 v[240:243], v2 offset:53248
    v_mfma_f32_16x16x32_bf16 v[56:59], v[188:191], v[160:163], v[56:59]
    ds_read_b128 v[244:247], v2 offset:54272
    v_mfma_f32_16x16x32_bf16 v[60:63], v[188:191], v[164:167], v[60:63]
    v_mfma_f32_16x16x32_bf16 v[64:67], v[192:195], v[160:163], v[64:67]
    v_mfma_f32_16x16x32_bf16 v[68:71], v[192:195], v[164:167], v[68:71]
    v_mfma_f32_16x16x32_bf16 v[72:75], v[196:199], v[160:163], v[72:75]
    v_mfma_f32_16x16x32_bf16 v[76:79], v[196:199], v[164:167], v[76:79]
    v_mfma_f32_16x16x32_bf16 v[80:83], v[200:203], v[160:163], v[80:83]
    v_mfma_f32_16x16x32_bf16 v[84:87], v[200:203], v[164:167], v[84:87]
    s_waitcnt lgkmcnt(0)
    s_barrier
    v_mfma_f32_16x16x32_bf16 v[16:19], v[212:215], v[204:207], v[16:19]
    ds_read_b128 v[160:163], v8 offset:0
    v_mfma_f32_16x16x32_bf16 v[20:23], v[212:215], v[208:211], v[20:23]
    ds_read_b128 v[164:167], v8 offset:2048
    v_mfma_f32_16x16x32_bf16 v[24:27], v[216:219], v[204:207], v[24:27]
    ds_read_b128 v[192:195], v1 offset:0
    v_mfma_f32_16x16x32_bf16 v[28:31], v[216:219], v[208:211], v[28:31]
    ds_read_b128 v[168:171], v9 offset:0
    v_mfma_f32_16x16x32_bf16 v[32:35], v[220:223], v[204:207], v[32:35]
    ds_read_b128 v[172:175], v9 offset:2048
    v_mfma_f32_16x16x32_bf16 v[36:39], v[220:223], v[208:211], v[36:39]
    ds_read_b128 v[176:179], v8 offset:36864
    v_mfma_f32_16x16x32_bf16 v[40:43], v[224:227], v[204:207], v[40:43]
    ds_read_b128 v[180:183], v8 offset:38912
    v_mfma_f32_16x16x32_bf16 v[44:47], v[224:227], v[208:211], v[44:47]
    ds_read_b128 v[184:187], v9 offset:36864
    v_mfma_f32_16x16x32_bf16 v[48:51], v[228:231], v[204:207], v[48:51]
    ds_read_b128 v[188:191], v9 offset:38912
    v_mfma_f32_16x16x32_bf16 v[52:55], v[228:231], v[208:211], v[52:55]
    ds_read_b128 v[196:199], v1 offset:9216
    v_mfma_f32_16x16x32_bf16 v[56:59], v[232:235], v[204:207], v[56:59]
    ds_read_b128 v[200:203], v1 offset:36864
    v_mfma_f32_16x16x32_bf16 v[60:63], v[232:235], v[208:211], v[60:63]
    v_mfma_f32_16x16x32_bf16 v[64:67], v[236:239], v[204:207], v[64:67]
    v_mfma_f32_16x16x32_bf16 v[68:71], v[236:239], v[208:211], v[68:71]
    v_mfma_f32_16x16x32_bf16 v[72:75], v[240:243], v[204:207], v[72:75]
    v_mfma_f32_16x16x32_bf16 v[76:79], v[240:243], v[208:211], v[76:79]
    v_mfma_f32_16x16x32_bf16 v[80:83], v[244:247], v[204:207], v[80:83]
    v_mfma_f32_16x16x32_bf16 v[84:87], v[244:247], v[208:211], v[84:87]
    s_waitcnt lgkmcnt(0)
    v_mfma_f32_16x16x32_bf16 v[16:19], v[192:195], v[160:163], v[16:19]
    ds_read_b128 v[204:207], v1 offset:46080
    v_mfma_f32_16x16x32_bf16 v[20:23], v[192:195], v[164:167], v[20:23]
    ds_read_b128 v[208:211], v1 offset:1024
    s_waitcnt lgkmcnt(3)
    v_mfma_f32_16x16x32_bf16 v[16:19], v[196:199], v[168:171], v[16:19]
    ds_read_b128 v[212:215], v1 offset:10240
    v_mfma_f32_16x16x32_bf16 v[20:23], v[196:199], v[172:175], v[20:23]
    ds_read_b128 v[216:219], v1 offset:37888
    s_waitcnt lgkmcnt(4)
    v_mfma_f32_16x16x32_bf16 v[16:19], v[200:203], v[176:179], v[16:19]
    ds_read_b128 v[220:223], v1 offset:47104
    v_mfma_f32_16x16x32_bf16 v[20:23], v[200:203], v[180:183], v[20:23]
    ds_read_b128 v[224:227], v1 offset:2048
    s_waitcnt lgkmcnt(5)
    v_mfma_f32_16x16x32_bf16 v[16:19], v[204:207], v[184:187], v[16:19]
    ds_read_b128 v[228:231], v1 offset:11264
    v_mfma_f32_16x16x32_bf16 v[20:23], v[204:207], v[188:191], v[20:23]
    ds_read_b128 v[232:235], v1 offset:38912
    s_waitcnt lgkmcnt(6)
    v_mfma_f32_16x16x32_bf16 v[24:27], v[208:211], v[160:163], v[24:27]
    ds_read_b128 v[236:239], v1 offset:48128
    v_mfma_f32_16x16x32_bf16 v[28:31], v[208:211], v[164:167], v[28:31]
    ds_read_b128 v[240:243], v1 offset:3072
    s_waitcnt lgkmcnt(7)
    v_mfma_f32_16x16x32_bf16 v[24:27], v[212:215], v[168:171], v[24:27]
    ds_read_b128 v[244:247], v1 offset:12288
    v_mfma_f32_16x16x32_bf16 v[28:31], v[212:215], v[172:175], v[28:31]
    s_waitcnt lgkmcnt(7)
    v_mfma_f32_16x16x32_bf16 v[24:27], v[216:219], v[176:179], v[24:27]
    ds_read_b128 v[192:195], v1 offset:39936
    v_mul_f32 v16, v16, v88
    v_mfma_f32_16x16x32_bf16 v[28:31], v[216:219], v[180:183], v[28:31]
    v_mul_f32 v17, v17, v89
    v_mul_f32 v18, v18, v90
    s_waitcnt lgkmcnt(7)
    v_mfma_f32_16x16x32_bf16 v[24:27], v[220:223], v[184:187], v[24:27]
    ds_read_b128 v[196:199], v1 offset:49152
    v_mul_f32 v19, v19, v91
    v_mfma_f32_16x16x32_bf16 v[28:31], v[220:223], v[188:191], v[28:31]
    v_cvt_pk_bf16_f32 v88, v16, v17
    v_cvt_pk_bf16_f32 v89, v18, v19
    s_waitcnt lgkmcnt(7)
    v_mfma_f32_16x16x32_bf16 v[32:35], v[224:227], v[160:163], v[32:35]
    ds_read_b128 v[200:203], v1 offset:4096
    v_mul_f32 v20, v20, v92
    v_mfma_f32_16x16x32_bf16 v[36:39], v[224:227], v[164:167], v[36:39]
    v_mul_f32 v21, v21, v93
    v_mul_f32 v22, v22, v94
    s_waitcnt lgkmcnt(7)
    v_mfma_f32_16x16x32_bf16 v[32:35], v[228:231], v[168:171], v[32:35]
    ds_read_b128 v[204:207], v1 offset:13312
    v_mul_f32 v23, v23, v95
    v_mfma_f32_16x16x32_bf16 v[36:39], v[228:231], v[172:175], v[36:39]
    v_cvt_pk_bf16_f32 v92, v20, v21
    v_cvt_pk_bf16_f32 v93, v22, v23
    s_waitcnt lgkmcnt(7)
    v_mfma_f32_16x16x32_bf16 v[32:35], v[232:235], v[176:179], v[32:35]
    ds_read_b128 v[208:211], v1 offset:40960
    v_mul_f32 v24, v24, v96
    v_mfma_f32_16x16x32_bf16 v[36:39], v[232:235], v[180:183], v[36:39]
    v_mul_f32 v25, v25, v97
    v_mul_f32 v26, v26, v98
    v_mul_f32 v27, v27, v99
    s_waitcnt lgkmcnt(7)
    v_mfma_f32_16x16x32_bf16 v[32:35], v[236:239], v[184:187], v[32:35]
    ds_read_b128 v[212:215], v1 offset:50176
    v_cvt_pk_bf16_f32 v90, v24, v25
    v_mfma_f32_16x16x32_bf16 v[36:39], v[236:239], v[188:191], v[36:39]
    v_cvt_pk_bf16_f32 v91, v26, v27
    buffer_store_dwordx4 v[88:91], v14, s[4:7], s39 offen sc1
    s_waitcnt lgkmcnt(7)
    v_mfma_f32_16x16x32_bf16 v[40:43], v[240:243], v[160:163], v[40:43]
    ds_read_b128 v[216:219], v1 offset:5120
    v_mul_f32 v28, v28, v100
    v_mfma_f32_16x16x32_bf16 v[44:47], v[240:243], v[164:167], v[44:47]
    v_mul_f32 v29, v29, v101
    v_mul_f32 v30, v30, v102
    s_waitcnt lgkmcnt(7)
    v_mfma_f32_16x16x32_bf16 v[40:43], v[244:247], v[168:171], v[40:43]
    ds_read_b128 v[220:223], v1 offset:14336
    v_mul_f32 v31, v31, v103
    v_mfma_f32_16x16x32_bf16 v[44:47], v[244:247], v[172:175], v[44:47]
    v_cvt_pk_bf16_f32 v94, v28, v29
    v_cvt_pk_bf16_f32 v95, v30, v31
    s_waitcnt lgkmcnt(7)
    v_mfma_f32_16x16x32_bf16 v[40:43], v[192:195], v[176:179], v[40:43]
    ds_read_b128 v[224:227], v1 offset:41984
    buffer_store_dwordx4 v[92:95], v14, s[4:7], s40 offen sc1
    v_mfma_f32_16x16x32_bf16 v[44:47], v[192:195], v[180:183], v[44:47]
    v_add_u32 v14, 16384, v14
    v_mul_f32 v32, v32, v104
    v_mul_f32 v33, v33, v105
    s_waitcnt lgkmcnt(7)
    v_mfma_f32_16x16x32_bf16 v[40:43], v[196:199], v[184:187], v[40:43]
    ds_read_b128 v[228:231], v1 offset:51200
    v_mul_f32 v34, v34, v106
    v_mfma_f32_16x16x32_bf16 v[44:47], v[196:199], v[188:191], v[44:47]
    v_mul_f32 v35, v35, v107
    v_cvt_pk_bf16_f32 v104, v32, v33
    s_waitcnt lgkmcnt(7)
    v_mfma_f32_16x16x32_bf16 v[48:51], v[200:203], v[160:163], v[48:51]
    ds_read_b128 v[232:235], v1 offset:6144
    v_cvt_pk_bf16_f32 v105, v34, v35
    v_mfma_f32_16x16x32_bf16 v[52:55], v[200:203], v[164:167], v[52:55]
    v_mul_f32 v36, v36, v108
    v_mul_f32 v37, v37, v109
    s_waitcnt lgkmcnt(7)
    v_mfma_f32_16x16x32_bf16 v[48:51], v[204:207], v[168:171], v[48:51]
    ds_read_b128 v[236:239], v1 offset:15360
    v_mul_f32 v38, v38, v110
    v_mfma_f32_16x16x32_bf16 v[52:55], v[204:207], v[172:175], v[52:55]
    v_mul_f32 v39, v39, v111
    v_cvt_pk_bf16_f32 v108, v36, v37
    s_waitcnt lgkmcnt(7)
    v_mfma_f32_16x16x32_bf16 v[48:51], v[208:211], v[176:179], v[48:51]
    ds_read_b128 v[240:243], v1 offset:43008
    v_cvt_pk_bf16_f32 v109, v38, v39
    v_mfma_f32_16x16x32_bf16 v[52:55], v[208:211], v[180:183], v[52:55]
    v_mul_f32 v40, v40, v112
    v_mul_f32 v41, v41, v113
    v_mul_f32 v42, v42, v114
    s_waitcnt lgkmcnt(7)
    v_mfma_f32_16x16x32_bf16 v[48:51], v[212:215], v[184:187], v[48:51]
    ds_read_b128 v[244:247], v1 offset:52224
    v_mul_f32 v43, v43, v115
    v_mfma_f32_16x16x32_bf16 v[52:55], v[212:215], v[188:191], v[52:55]
    v_cvt_pk_bf16_f32 v106, v40, v41
    v_cvt_pk_bf16_f32 v107, v42, v43
    s_waitcnt lgkmcnt(7)
    v_mfma_f32_16x16x32_bf16 v[56:59], v[216:219], v[160:163], v[56:59]
    ds_read_b128 v[192:195], v1 offset:7168
    buffer_store_dwordx4 v[104:107], v14, s[4:7], s39 offen sc1
    v_mfma_f32_16x16x32_bf16 v[60:63], v[216:219], v[164:167], v[60:63]
    v_mul_f32 v44, v44, v116
    v_mul_f32 v45, v45, v117
    s_waitcnt lgkmcnt(7)
    v_mfma_f32_16x16x32_bf16 v[56:59], v[220:223], v[168:171], v[56:59]
    ds_read_b128 v[196:199], v1 offset:16384
    v_mul_f32 v46, v46, v118
    v_mfma_f32_16x16x32_bf16 v[60:63], v[220:223], v[172:175], v[60:63]
    v_mul_f32 v47, v47, v119
    v_cvt_pk_bf16_f32 v110, v44, v45
    s_waitcnt lgkmcnt(7)
    v_mfma_f32_16x16x32_bf16 v[56:59], v[224:227], v[176:179], v[56:59]
    ds_read_b128 v[200:203], v1 offset:44032
    v_cvt_pk_bf16_f32 v111, v46, v47
    v_mfma_f32_16x16x32_bf16 v[60:63], v[224:227], v[180:183], v[60:63]
    buffer_store_dwordx4 v[108:111], v14, s[4:7], s40 offen sc1
    v_add_u32 v14, 16384, v14
    v_mul_f32 v48, v48, v120
    s_waitcnt lgkmcnt(7)
    v_mfma_f32_16x16x32_bf16 v[56:59], v[228:231], v[184:187], v[56:59]
    ds_read_b128 v[204:207], v1 offset:53248
    v_mul_f32 v49, v49, v121
    v_mfma_f32_16x16x32_bf16 v[60:63], v[228:231], v[188:191], v[60:63]
    v_mul_f32 v50, v50, v122
    v_mul_f32 v51, v51, v123
    s_waitcnt lgkmcnt(7)
    v_mfma_f32_16x16x32_bf16 v[64:67], v[232:235], v[160:163], v[64:67]
    ds_read_b128 v[208:211], v1 offset:8192
    v_cvt_pk_bf16_f32 v120, v48, v49
    v_mfma_f32_16x16x32_bf16 v[68:71], v[232:235], v[164:167], v[68:71]
    v_cvt_pk_bf16_f32 v121, v50, v51
    v_mul_f32 v52, v52, v124
    s_waitcnt lgkmcnt(7)
    v_mfma_f32_16x16x32_bf16 v[64:67], v[236:239], v[168:171], v[64:67]
    ds_read_b128 v[212:215], v1 offset:17408
    v_mul_f32 v53, v53, v125
    v_mfma_f32_16x16x32_bf16 v[68:71], v[236:239], v[172:175], v[68:71]
    v_mul_f32 v54, v54, v126
    v_mul_f32 v55, v55, v127
    s_waitcnt lgkmcnt(7)
    v_mfma_f32_16x16x32_bf16 v[64:67], v[240:243], v[176:179], v[64:67]
    ds_read_b128 v[216:219], v1 offset:45056
    v_cvt_pk_bf16_f32 v124, v52, v53
    v_mfma_f32_16x16x32_bf16 v[68:71], v[240:243], v[180:183], v[68:71]
    v_cvt_pk_bf16_f32 v125, v54, v55
    v_mul_f32 v56, v56, v128
    v_mul_f32 v57, v57, v129
    s_waitcnt lgkmcnt(7)
    v_mfma_f32_16x16x32_bf16 v[64:67], v[244:247], v[184:187], v[64:67]
    ds_read_b128 v[220:223], v1 offset:54272
    v_mul_f32 v58, v58, v130
    v_mfma_f32_16x16x32_bf16 v[68:71], v[244:247], v[188:191], v[68:71]
    v_mul_f32 v59, v59, v131
    v_cvt_pk_bf16_f32 v122, v56, v57
    v_cvt_pk_bf16_f32 v123, v58, v59
    s_waitcnt lgkmcnt(7)
    v_mfma_f32_16x16x32_bf16 v[72:75], v[192:195], v[160:163], v[72:75]
    buffer_store_dwordx4 v[120:123], v14, s[4:7], s39 offen sc1
    v_mul_f32 v60, v60, v132
    v_mfma_f32_16x16x32_bf16 v[76:79], v[192:195], v[164:167], v[76:79]
    v_mul_f32 v61, v61, v133
    v_mul_f32 v62, v62, v134
    s_waitcnt lgkmcnt(6)
    v_mfma_f32_16x16x32_bf16 v[72:75], v[196:199], v[168:171], v[72:75]
    v_mul_f32 v63, v63, v135
    v_cvt_pk_bf16_f32 v126, v60, v61
    v_mfma_f32_16x16x32_bf16 v[76:79], v[196:199], v[172:175], v[76:79]
    v_cvt_pk_bf16_f32 v127, v62, v63
    buffer_store_dwordx4 v[124:127], v14, s[4:7], s40 offen sc1
    s_waitcnt lgkmcnt(5)
    v_mfma_f32_16x16x32_bf16 v[72:75], v[200:203], v[176:179], v[72:75]
    v_add_u32 v14, 16384, v14
    v_mul_f32 v64, v64, v136
    v_mfma_f32_16x16x32_bf16 v[76:79], v[200:203], v[180:183], v[76:79]
    v_mul_f32 v65, v65, v137
    v_mul_f32 v66, v66, v138
    v_mul_f32 v67, v67, v139
    s_waitcnt lgkmcnt(4)
    v_mfma_f32_16x16x32_bf16 v[72:75], v[204:207], v[184:187], v[72:75]
    v_cvt_pk_bf16_f32 v136, v64, v65
    v_cvt_pk_bf16_f32 v137, v66, v67
    v_mfma_f32_16x16x32_bf16 v[76:79], v[204:207], v[188:191], v[76:79]
    v_mul_f32 v68, v68, v140
    v_mul_f32 v69, v69, v141
    s_waitcnt lgkmcnt(3)
    v_mfma_f32_16x16x32_bf16 v[80:83], v[208:211], v[160:163], v[80:83]
    v_mul_f32 v70, v70, v142
    v_mul_f32 v71, v71, v143
    v_mfma_f32_16x16x32_bf16 v[84:87], v[208:211], v[164:167], v[84:87]
    v_cvt_pk_bf16_f32 v140, v68, v69
    v_cvt_pk_bf16_f32 v141, v70, v71
    s_waitcnt lgkmcnt(2)
    v_mfma_f32_16x16x32_bf16 v[80:83], v[212:215], v[168:171], v[80:83]
    v_mfma_f32_16x16x32_bf16 v[84:87], v[212:215], v[172:175], v[84:87]
    s_waitcnt lgkmcnt(1)
    v_mfma_f32_16x16x32_bf16 v[80:83], v[216:219], v[176:179], v[80:83]
    v_mul_f32 v72, v72, v144
    v_mul_f32 v73, v73, v145
    v_mfma_f32_16x16x32_bf16 v[84:87], v[216:219], v[180:183], v[84:87]
    v_mul_f32 v74, v74, v146
    v_mul_f32 v75, v75, v147
    v_cvt_pk_bf16_f32 v138, v72, v73
    s_waitcnt lgkmcnt(0)
    v_mfma_f32_16x16x32_bf16 v[80:83], v[220:223], v[184:187], v[80:83]
    v_cvt_pk_bf16_f32 v139, v74, v75
    buffer_store_dwordx4 v[136:139], v14, s[4:7], s39 offen sc1
    v_mfma_f32_16x16x32_bf16 v[84:87], v[220:223], v[188:191], v[84:87]
    v_mul_f32 v76, v76, v148
    v_mul_f32 v77, v77, v149
    v_mul_f32 v78, v78, v150
    v_mul_f32 v79, v79, v151
    v_cvt_pk_bf16_f32 v142, v76, v77
    v_cvt_pk_bf16_f32 v143, v78, v79
    buffer_store_dwordx4 v[140:143], v14, s[4:7], s40 offen sc1
    s_nop 1
    v_mul_f32 v80, v80, v152
    v_mul_f32 v81, v81, v153
    v_mul_f32 v82, v82, v154
    v_mul_f32 v83, v83, v155
    v_cvt_pk_bf16_f32 v152, v80, v81
    v_cvt_pk_bf16_f32 v153, v82, v83
    v_mul_f32 v84, v84, v156
    v_mul_f32 v85, v85, v157
    v_mul_f32 v86, v86, v158
    v_mul_f32 v87, v87, v159
    v_cvt_pk_bf16_f32 v154, v84, v85
    v_cvt_pk_bf16_f32 v155, v86, v87
    s_bitcmp0_b32 s24, 1
    s_cbranch_scc1 L_g_ns
    v_swap_b32 v152, v154
    v_swap_b32 v153, v155
L_g_ns:
    buffer_store_dwordx4 v[152:155], v15, s[4:7], s39 offen sc1
    s_barrier
    s_and_b32 s25, s2, 7
    s_lshr_b32 s26, s2, 3
    s_lshr_b32 s23, s25, 1
    s_lshl_b32 s23, s23, 3
    s_lshr_b32 s27, s26, 2
    s_add_u32 s23, s23, s27
    s_and_b32 s24, s25, 1
    s_lshl_b32 s24, s24, 2
    s_and_b32 s27, s26, 3
    s_add_u32 s24, s24, s27
    s_add_u32 s25, s23, s24
    s_and_b32 s25, s25, 3
    s_lshl_b32 s30, s23, 2
    s_add_u32 s30, s30, s20
    s_and_b32 s31, s20, 1
    s_mul_i32 s34, s30, 18432
    s_add_u32 s34, s34, s21
    s_add_u32 s34, s34, 0x300000
    s_lshl_b32 s35, s24, 11
    s_lshr_b32 s36, s24, 2
    s_lshl_b32 s36, s36, 10
    s_and_b32 s37, s24, 3
    s_lshl_b32 s37, s37, 8
    s_add_u32 s36, s36, s37
    s_add_u32 s36, s36, 16384
    v_bfe_u32 v2, v1, 4, 4
    v_lshrrev_b32 v3, 8, v1
    v_add_u32 v4, s35, v1
    v_lshrrev_b32 v0, 1, v3
    v_and_b32 v9, 1, v3
    v_cmp_eq_u32 s[40:41], s31, v0
    v_bfrev_b32 v6, 1
    v_lshlrev_b32 v5, 4, v2
    v_lshl_add_u32 v5, v9, 3, v5
    v_add_u32 v5, s36, v5
    v_cndmask_b32 v5, v6, v5, s[40:41]
    buffer_load_dwordx4 v[220:223], v4, s[4:7], s34 offen offset:0 sc1
    buffer_load_dwordx4 v[224:227], v4, s[4:7], s34 offen offset:1024 sc1
    buffer_load_dwordx2 v[228:229], v5, s[4:7], s34 offen sc1
    s_and_b32 s29, s30, 0xfffe
    s_mul_i32 s29, s29, 73728
    s_add_u32 s29, s29, s21
    s_lshl_b32 s37, s31, 10
    s_add_u32 s29, s29, s37
    s_add_u32 s29, s29, 0x1200000
    s_mul_i32 s37, s31, 73728
    s_sub_u32 s38, 73728, s37
    v_lshlrev_b32 v10, 3, v2
    v_add_u32 v16, s37, v1
    v_add_u32 v17, s38, v1
    v_mov_b32 v18, v1
    v_add_u32 v19, 73728, v1
    s_lshl_b32 s37, s31, 12
    v_add_u32 v20, 0, v1
    v_add_u32 v12, s37, v20
    v_add_u32 v21, 36864, v1
    v_add_u32 v13, s37, v21
    v_add_u32 v22, 73728, v1
    v_add_u32 v14, s37, v22
    v_add_u32 v23, 110592, v1
    v_add_u32 v15, s37, v23
    s_add_u32 s34, s34, 0x1900000
    s_lshl_b32 s39, s30, 10
    s_add_u32 s39, s39, s21
    s_lshl_b32 s42, s24, 7
    s_add_u32 s39, s39, s42
    s_add_u32 s39, s39, 0x3700000
    v_cmp_eq_u32 vcc, 0, v3
    v_mov_b32 v11, 0x3f803f80
    s_lshr_b32 s44, s23, 1
    v_cndmask_b32 v10, v6, v10, vcc
    s_cmp_eq_u32 s22, 0
    s_cbranch_scc1 L_p5_nf
    v_mul_u32_u24 v8, 1152, v2
    s_mul_i32 s34, s30, 18432
    s_mul_i32 s42, s24, 144
    s_add_u32 s34, s34, s42
    v_lshl_add_u32 v4, v3, 4, v8
    v_lshl_add_u32 v5, v9, 3, v8
    v_cndmask_b32 v5, v6, v5, s[40:41]
L_p5_nf:
    s_lshl_b32 s52, s22, 7
    s_add_u32 s52, s52, s44
    s_lshl_b32 s52, s52, 8
    s_add_u32 s52, s52, 0x450a000
    s_add_u32 s52, s52, s4
    s_addc_u32 s53, s5, 0
    s_waitcnt vmcnt(3)
    s_barrier
    s_cmp_lg_u32 s20, 0
    s_cbranch_scc1 L_ns_d5
    s_mov_b32 s56, 1
    s_atomic_add s56, s[50:51], 0
L_ns_d5:
    s_mul_i32 s37, s20, 4608
    s_add_u32 s37, s37, 131072
    s_xor_b32 s38, s20, 1
    s_mul_i32 s42, s38, 4608
    s_add_u32 s42, s42, 131072
    v_and_b32 v0, 0x1ff, v1
    v_add_u32 v2, s37, v1
    v_add_u32 v3, s37, v0
    v_add_u32 v7, s42, v1
    v_add_u32 v8, s42, v0
    s_lshl_b32 s37, s20, 2
    s_add_u32 s37, s37, 163808
    s_xor_b32 s38, s37, 4
    v_mov_b32 v0, s37
    v_mov_b32 v6, s38
    s_lshl_b32 s43, s22, 1
    s_add_u32 s43, s43, 2
    v_mov_b32 v9, s43
    s_cmp_lg_u32 s20, 0
    s_cbranch_scc1 L_pd_d5
    s_mov_b32 s60, 65536
L_poll_d5:
    s_mov_b32 s57, 0
    s_atomic_add s57, s[52:53], 0 glc
    s_waitcnt lgkmcnt(0)
    s_cmp_ge_u32 s57, 16
    s_cbranch_scc1 L_pd_d5
    s_sub_u32 s60, s60, 1
    s_cbranch_scc1 L_pd_d5
    s_sleep 2
    s_branch L_poll_d5
L_pd_d5:
    s_barrier
    s_mov_b32 s32, 0
    s_lshl_b32 s32, s32, 13
    s_add_u32 s32, s32, s29
    s_add_u32 s33, s32, 4096
    buffer_load_dwordx4 v[124:127], v16, s[4:7], s32 offen offset:0 sc1
    buffer_load_dwordx4 v[128:131], v17, s[4:7], s32 offen offset:0 sc1
    buffer_load_dwordx4 v[132:135], v16, s[4:7], s32 offen offset:2048 sc1
    buffer_load_dwordx4 v[136:139], v17, s[4:7], s32 offen offset:2048 sc1
    buffer_load_dwordx4 v[140:143], v16, s[4:7], s33 offen offset:0 sc1
    buffer_load_dwordx4 v[144:147], v17, s[4:7], s33 offen offset:0 sc1
    buffer_load_dwordx4 v[148:151], v16, s[4:7], s33 offen offset:2048 sc1
    buffer_load_dwordx4 v[152:155], v17, s[4:7], s33 offen offset:2048 sc1
    ds_read_b128 v[64:67], v14 offset:0
    ds_read_b128 v[68:71], v14 offset:1024
    ds_read_b128 v[72:75], v14 offset:2048
    ds_read_b128 v[76:79], v14 offset:3072
    ds_read_b128 v[80:83], v22 offset:8192
    ds_read_b128 v[84:87], v14 offset:9216
    ds_read_b128 v[88:91], v14 offset:10240
    ds_read_b128 v[92:95], v14 offset:11264
    ds_read_b128 v[96:99], v14 offset:12288
    ds_read_b128 v[100:103], v22 offset:17408
    s_add_u32 s45, s29, 8192
    s_add_u32 s46, s29, 12288
    buffer_load_dwordx4 v[156:159], v16, s[4:7], s45 offen offset:0 sc1
    buffer_load_dwordx4 v[160:163], v17, s[4:7], s45 offen offset:0 sc1
    s_lshl_b32 s50, s22, 7
    s_add_u32 s50, s50, s44
    s_lshl_b32 s50, s50, 8
    s_add_u32 s50, s50, 0x450b000
    s_add_u32 s50, s50, s4
    s_addc_u32 s51, s5, 0
    s_waitcnt vmcnt(10)
    v_lshlrev_b32 v24, 16, v220
    v_and_b32 v25, 0xffff0000, v220
    v_lshlrev_b32 v26, 16, v221
    v_and_b32 v27, 0xffff0000, v221
    v_lshlrev_b32 v28, 16, v222
    v_and_b32 v29, 0xffff0000, v222
    v_lshlrev_b32 v30, 16, v223
    v_and_b32 v31, 0xffff0000, v223
    v_lshlrev_b32 v32, 16, v224
    v_and_b32 v33, 0xffff0000, v224
    v_lshlrev_b32 v34, 16, v225
    v_and_b32 v35, 0xffff0000, v225
    v_lshlrev_b32 v36, 16, v226
    v_and_b32 v37, 0xffff0000, v226
    v_lshlrev_b32 v38, 16, v227
    v_and_b32 v39, 0xffff0000, v227
    v_lshlrev_b32 v40, 16, v228
    v_and_b32 v41, 0xffff0000, v228
    v_lshlrev_b32 v42, 16, v229
    v_and_b32 v43, 0xffff0000, v229
    s_waitcnt vmcnt(8) lgkmcnt(5)
    v_mfma_f32_16x16x32_bf16 v[44:47], v[64:67], v[128:131], 0
    ds_read_b128 v[104:107], v14 offset:18432
    s_mov_b32 s32, 2
    s_lshl_b32 s32, s32, 13
    s_add_u32 s32, s32, s29
    s_add_u32 s33, s32, 4096
    v_mfma_f32_16x16x32_bf16 v[24:27], v[64:67], v[124:127], v[24:27]
    ds_read_b128 v[108:111], v14 offset:19456
    buffer_load_dwordx4 v[164:167], v16, s[4:7], s45 offen offset:2048 sc1
    v_mfma_f32_16x16x32_bf16 v[48:51], v[68:71], v[128:131], 0
    ds_read_b128 v[112:115], v14 offset:20480
    v_mfma_f32_16x16x32_bf16 v[28:31], v[68:71], v[124:127], v[28:31]
    ds_read_b128 v[116:119], v14 offset:21504
    buffer_load_dwordx4 v[168:171], v17, s[4:7], s45 offen offset:2048 sc1
    v_mfma_f32_16x16x32_bf16 v[52:55], v[72:75], v[128:131], 0
    ds_read_b128 v[120:123], v22 offset:26624
    v_mfma_f32_16x16x32_bf16 v[32:35], v[72:75], v[124:127], v[32:35]
    buffer_load_dwordx4 v[188:191], v16, s[4:7], s32 offen offset:0 sc1
    v_mfma_f32_16x16x32_bf16 v[56:59], v[76:79], v[128:131], 0
    v_mfma_f32_16x16x32_bf16 v[36:39], v[76:79], v[124:127], v[36:39]
    buffer_load_dwordx4 v[192:195], v17, s[4:7], s32 offen offset:0 sc1
    v_mfma_f32_16x16x32_bf16 v[60:63], v[80:83], v[128:131], 0
    v_mfma_f32_16x16x32_bf16 v[40:43], v[80:83], v[124:127], v[40:43]
    s_waitcnt vmcnt(10) lgkmcnt(5)
    v_mfma_f32_16x16x32_bf16 v[44:47], v[84:87], v[136:139], v[44:47]
    ds_read_b128 v[64:67], v14 offset:27648
    v_mfma_f32_16x16x32_bf16 v[24:27], v[84:87], v[132:135], v[24:27]
    ds_read_b128 v[68:71], v14 offset:28672
    buffer_load_dwordx4 v[172:175], v16, s[4:7], s46 offen offset:0 sc1
    v_mfma_f32_16x16x32_bf16 v[48:51], v[88:91], v[136:139], v[48:51]
    ds_read_b128 v[72:75], v14 offset:29696
    v_mfma_f32_16x16x32_bf16 v[28:31], v[88:91], v[132:135], v[28:31]
    ds_read_b128 v[76:79], v14 offset:30720
    buffer_load_dwordx4 v[176:179], v17, s[4:7], s46 offen offset:0 sc1
    v_mfma_f32_16x16x32_bf16 v[52:55], v[92:95], v[136:139], v[52:55]
    ds_read_b128 v[80:83], v22 offset:35840
    v_mfma_f32_16x16x32_bf16 v[32:35], v[92:95], v[132:135], v[32:35]
    buffer_load_dwordx4 v[196:199], v16, s[4:7], s32 offen offset:2048 sc1
    v_mfma_f32_16x16x32_bf16 v[56:59], v[96:99], v[136:139], v[56:59]
    v_mfma_f32_16x16x32_bf16 v[36:39], v[96:99], v[132:135], v[36:39]
    buffer_load_dwordx4 v[200:203], v17, s[4:7], s32 offen offset:2048 sc1
    v_mfma_f32_16x16x32_bf16 v[60:63], v[100:103], v[136:139], v[60:63]
    v_mfma_f32_16x16x32_bf16 v[40:43], v[100:103], v[132:135], v[40:43]
    s_waitcnt vmcnt(12) lgkmcnt(0)
    s_barrier
    v_mfma_f32_16x16x32_bf16 v[44:47], v[104:107], v[144:147], v[44:47]
    ds_read_b128 v[84:87], v15 offset:0
    v_mfma_f32_16x16x32_bf16 v[24:27], v[104:107], v[140:143], v[24:27]
    ds_read_b128 v[88:91], v15 offset:1024
    buffer_load_dwordx4 v[180:183], v16, s[4:7], s46 offen offset:2048 sc1
    v_mfma_f32_16x16x32_bf16 v[48:51], v[108:111], v[144:147], v[48:51]
    ds_read_b128 v[92:95], v15 offset:2048
    v_mfma_f32_16x16x32_bf16 v[28:31], v[108:111], v[140:143], v[28:31]
    ds_read_b128 v[96:99], v15 offset:3072
    buffer_load_dwordx4 v[184:187], v17, s[4:7], s46 offen offset:2048 sc1
    v_mfma_f32_16x16x32_bf16 v[52:55], v[112:115], v[144:147], v[52:55]
    ds_read_b128 v[100:103], v23 offset:8192
    v_mfma_f32_16x16x32_bf16 v[32:35], v[112:115], v[140:143], v[32:35]
    buffer_load_dwordx4 v[204:207], v16, s[4:7], s33 offen offset:0 sc1
    v_mfma_f32_16x16x32_bf16 v[56:59], v[116:119], v[144:147], v[56:59]
    v_mfma_f32_16x16x32_bf16 v[36:39], v[116:119], v[140:143], v[36:39]
    buffer_load_dwordx4 v[208:211], v17, s[4:7], s33 offen offset:0 sc1
    v_mfma_f32_16x16x32_bf16 v[60:63], v[120:123], v[144:147], v[60:63]
    v_mfma_f32_16x16x32_bf16 v[40:43], v[120:123], v[140:143], v[40:43]
    s_waitcnt vmcnt(14) lgkmcnt(5)
    v_mfma_f32_16x16x32_bf16 v[44:47], v[64:67], v[152:155], v[44:47]
    ds_read_b128 v[104:107], v15 offset:9216
    v_mfma_f32_16x16x32_bf16 v[24:27], v[64:67], v[148:151], v[24:27]
    ds_read_b128 v[108:111], v15 offset:10240
    v_mfma_f32_16x16x32_bf16 v[48:51], v[68:71], v[152:155], v[48:51]
    ds_read_b128 v[112:115], v15 offset:11264
    v_mfma_f32_16x16x32_bf16 v[28:31], v[68:71], v[148:151], v[28:31]
    ds_read_b128 v[116:119], v15 offset:12288
    v_mfma_f32_16x16x32_bf16 v[52:55], v[72:75], v[152:155], v[52:55]
    ds_read_b128 v[120:123], v23 offset:17408
    v_mfma_f32_16x16x32_bf16 v[32:35], v[72:75], v[148:151], v[32:35]
    buffer_load_dwordx4 v[212:215], v16, s[4:7], s33 offen offset:2048 sc1
    v_mfma_f32_16x16x32_bf16 v[56:59], v[76:79], v[152:155], v[56:59]
    v_mfma_f32_16x16x32_bf16 v[36:39], v[76:79], v[148:151], v[36:39]
    buffer_load_dwordx4 v[216:219], v17, s[4:7], s33 offen offset:2048 sc1
    v_mfma_f32_16x16x32_bf16 v[60:63], v[80:83], v[152:155], v[60:63]
    v_mfma_f32_16x16x32_bf16 v[40:43], v[80:83], v[148:151], v[40:43]
    s_waitcnt vmcnt(14) lgkmcnt(5)
    v_mfma_f32_16x16x32_bf16 v[44:47], v[84:87], v[160:163], v[44:47]
    ds_read_b128 v[64:67], v15 offset:18432
    s_mov_b32 s32, 3
    s_lshl_b32 s32, s32, 13
    s_add_u32 s32, s32, s29
    s_add_u32 s33, s32, 4096
    v_mfma_f32_16x16x32_bf16 v[24:27], v[84:87], v[156:159], v[24:27]
    ds_read_b128 v[68:71], v15 offset:19456
    v_mfma_f32_16x16x32_bf16 v[48:51], v[88:91], v[160:163], v[48:51]
    ds_read_b128 v[72:75], v15 offset:20480
    v_mfma_f32_16x16x32_bf16 v[28:31], v[88:91], v[156:159], v[28:31]
    ds_read_b128 v[76:79], v15 offset:21504
    v_mfma_f32_16x16x32_bf16 v[52:55], v[92:95], v[160:163], v[52:55]
    ds_read_b128 v[80:83], v23 offset:26624
    v_mfma_f32_16x16x32_bf16 v[32:35], v[92:95], v[156:159], v[32:35]
    buffer_load_dwordx4 v[124:127], v16, s[4:7], s32 offen offset:0 sc1
    v_mfma_f32_16x16x32_bf16 v[56:59], v[96:99], v[160:163], v[56:59]
    v_mfma_f32_16x16x32_bf16 v[36:39], v[96:99], v[156:159], v[36:39]
    buffer_load_dwordx4 v[128:131], v17, s[4:7], s32 offen offset:0 sc1
    v_mfma_f32_16x16x32_bf16 v[60:63], v[100:103], v[160:163], v[60:63]
    v_mfma_f32_16x16x32_bf16 v[40:43], v[100:103], v[156:159], v[40:43]
    s_waitcnt vmcnt(14) lgkmcnt(5)
    v_mfma_f32_16x16x32_bf16 v[44:47], v[104:107], v[168:171], v[44:47]
    ds_read_b128 v[84:87], v15 offset:27648
    v_mfma_f32_16x16x32_bf16 v[24:27], v[104:107], v[164:167], v[24:27]
    ds_read_b128 v[88:91], v15 offset:28672
    v_mfma_f32_16x16x32_bf16 v[48:51], v[108:111], v[168:171], v[48:51]
    ds_read_b128 v[92:95], v15 offset:29696
    v_mfma_f32_16x16x32_bf16 v[28:31], v[108:111], v[164:167], v[28:31]
    ds_read_b128 v[96:99], v15 offset:30720
    v_mfma_f32_16x16x32_bf16 v[52:55], v[112:115], v[168:171], v[52:55]
    ds_read_b128 v[100:103], v23 offset:35840
    v_mfma_f32_16x16x32_bf16 v[32:35], v[112:115], v[164:167], v[32:35]
    buffer_load_dwordx4 v[132:135], v16, s[4:7], s32 offen offset:2048 sc1
    v_mfma_f32_16x16x32_bf16 v[56:59], v[116:119], v[168:171], v[56:59]
    v_mfma_f32_16x16x32_bf16 v[36:39], v[116:119], v[164:167], v[36:39]
    buffer_load_dwordx4 v[136:139], v17, s[4:7], s32 offen offset:2048 sc1
    v_mfma_f32_16x16x32_bf16 v[60:63], v[120:123], v[168:171], v[60:63]
    v_mfma_f32_16x16x32_bf16 v[40:43], v[120:123], v[164:167], v[40:43]
    s_waitcnt vmcnt(12) lgkmcnt(0)
    s_barrier
    v_mfma_f32_16x16x32_bf16 v[44:47], v[64:67], v[176:179], v[44:47]
    ds_read_b128 v[104:107], v12 offset:0
    v_mfma_f32_16x16x32_bf16 v[24:27], v[64:67], v[172:175], v[24:27]
    ds_read_b128 v[108:111], v12 offset:1024
    v_mfma_f32_16x16x32_bf16 v[48:51], v[68:71], v[176:179], v[48:51]
    ds_read_b128 v[112:115], v12 offset:2048
    v_mfma_f32_16x16x32_bf16 v[28:31], v[68:71], v[172:175], v[28:31]
    ds_read_b128 v[116:119], v12 offset:3072
    v_mfma_f32_16x16x32_bf16 v[52:55], v[72:75], v[176:179], v[52:55]
    ds_read_b128 v[120:123], v20 offset:8192
    v_mfma_f32_16x16x32_bf16 v[32:35], v[72:75], v[172:175], v[32:35]
    buffer_load_dwordx4 v[140:143], v16, s[4:7], s33 offen offset:0 sc1
    v_mfma_f32_16x16x32_bf16 v[56:59], v[76:79], v[176:179], v[56:59]
    v_mfma_f32_16x16x32_bf16 v[36:39], v[76:79], v[172:175], v[36:39]
    buffer_load_dwordx4 v[144:147], v17, s[4:7], s33 offen offset:0 sc1
    v_mfma_f32_16x16x32_bf16 v[60:63], v[80:83], v[176:179], v[60:63]
    v_mfma_f32_16x16x32_bf16 v[40:43], v[80:83], v[172:175], v[40:43]
    s_waitcnt vmcnt(10) lgkmcnt(5)
    v_mfma_f32_16x16x32_bf16 v[44:47], v[84:87], v[184:187], v[44:47]
    ds_read_b128 v[64:67], v12 offset:9216
    v_mfma_f32_16x16x32_bf16 v[24:27], v[84:87], v[180:183], v[24:27]
    ds_read_b128 v[68:71], v12 offset:10240
    v_mfma_f32_16x16x32_bf16 v[48:51], v[88:91], v[184:187], v[48:51]
    ds_read_b128 v[72:75], v12 offset:11264
    v_mfma_f32_16x16x32_bf16 v[28:31], v[88:91], v[180:183], v[28:31]
    ds_read_b128 v[76:79], v12 offset:12288
    v_mfma_f32_16x16x32_bf16 v[52:55], v[92:95], v[184:187], v[52:55]
    ds_read_b128 v[80:83], v20 offset:17408
    v_mfma_f32_16x16x32_bf16 v[32:35], v[92:95], v[180:183], v[32:35]
    buffer_load_dwordx4 v[148:151], v16, s[4:7], s33 offen offset:2048 sc1
    v_mfma_f32_16x16x32_bf16 v[56:59], v[96:99], v[184:187], v[56:59]
    v_mfma_f32_16x16x32_bf16 v[36:39], v[96:99], v[180:183], v[36:39]
    buffer_load_dwordx4 v[152:155], v17, s[4:7], s33 offen offset:2048 sc1
    v_mfma_f32_16x16x32_bf16 v[60:63], v[100:103], v[184:187], v[60:63]
    v_mfma_f32_16x16x32_bf16 v[40:43], v[100:103], v[180:183], v[40:43]
    s_waitcnt vmcnt(12) lgkmcnt(5)
    v_mfma_f32_16x16x32_bf16 v[44:47], v[104:107], v[192:195], v[44:47]
    ds_read_b128 v[84:87], v12 offset:18432
    s_mov_b32 s32, 4
    s_lshl_b32 s32, s32, 13
    s_add_u32 s32, s32, s29
    s_add_u32 s33, s32, 4096
    v_mfma_f32_16x16x32_bf16 v[24:27], v[104:107], v[188:191], v[24:27]
    ds_read_b128 v[88:91], v12 offset:19456
    v_mfma_f32_16x16x32_bf16 v[48:51], v[108:111], v[192:195], v[48:51]
    ds_read_b128 v[92:95], v12 offset:20480
    v_mfma_f32_16x16x32_bf16 v[28:31], v[108:111], v[188:191], v[28:31]
    ds_read_b128 v[96:99], v12 offset:21504
    v_mfma_f32_16x16x32_bf16 v[52:55], v[112:115], v[192:195], v[52:55]
    ds_read_b128 v[100:103], v20 offset:26624
    v_mfma_f32_16x16x32_bf16 v[32:35], v[112:115], v[188:191], v[32:35]
    buffer_load_dwordx4 v[156:159], v16, s[4:7], s32 offen offset:0 sc1
    v_mfma_f32_16x16x32_bf16 v[56:59], v[116:119], v[192:195], v[56:59]
    v_mfma_f32_16x16x32_bf16 v[36:39], v[116:119], v[188:191], v[36:39]
    buffer_load_dwordx4 v[160:163], v17, s[4:7], s32 offen offset:0 sc1
    v_mfma_f32_16x16x32_bf16 v[60:63], v[120:123], v[192:195], v[60:63]
    v_mfma_f32_16x16x32_bf16 v[40:43], v[120:123], v[188:191], v[40:43]
    s_waitcnt vmcnt(14) lgkmcnt(5)
    v_mfma_f32_16x16x32_bf16 v[44:47], v[64:67], v[200:203], v[44:47]
    ds_read_b128 v[104:107], v12 offset:27648
    v_mfma_f32_16x16x32_bf16 v[24:27], v[64:67], v[196:199], v[24:27]
    ds_read_b128 v[108:111], v12 offset:28672
    v_mfma_f32_16x16x32_bf16 v[48:51], v[68:71], v[200:203], v[48:51]
    ds_read_b128 v[112:115], v12 offset:29696
    v_mfma_f32_16x16x32_bf16 v[28:31], v[68:71], v[196:199], v[28:31]
    ds_read_b128 v[116:119], v12 offset:30720
    v_mfma_f32_16x16x32_bf16 v[52:55], v[72:75], v[200:203], v[52:55]
    ds_read_b128 v[120:123], v20 offset:35840
    v_mfma_f32_16x16x32_bf16 v[32:35], v[72:75], v[196:199], v[32:35]
    buffer_load_dwordx4 v[164:167], v16, s[4:7], s32 offen offset:2048 sc1
    v_mfma_f32_16x16x32_bf16 v[56:59], v[76:79], v[200:203], v[56:59]
    v_mfma_f32_16x16x32_bf16 v[36:39], v[76:79], v[196:199], v[36:39]
    buffer_load_dwordx4 v[168:171], v17, s[4:7], s32 offen offset:2048 sc1
    v_mfma_f32_16x16x32_bf16 v[60:63], v[80:83], v[200:203], v[60:63]
    v_mfma_f32_16x16x32_bf16 v[40:43], v[80:83], v[196:199], v[40:43]
    s_waitcnt vmcnt(14) lgkmcnt(0)
    s_barrier
    v_mfma_f32_16x16x32_bf16 v[44:47], v[84:87], v[208:211], v[44:47]
    ds_read_b128 v[64:67], v13 offset:0
    v_mfma_f32_16x16x32_bf16 v[24:27], v[84:87], v[204:207], v[24:27]
    ds_read_b128 v[68:71], v13 offset:1024
    v_mfma_f32_16x16x32_bf16 v[48:51], v[88:91], v[208:211], v[48:51]
    ds_read_b128 v[72:75], v13 offset:2048
    v_mfma_f32_16x16x32_bf16 v[28:31], v[88:91], v[204:207], v[28:31]
    ds_read_b128 v[76:79], v13 offset:3072
    v_mfma_f32_16x16x32_bf16 v[52:55], v[92:95], v[208:211], v[52:55]
    ds_read_b128 v[80:83], v21 offset:8192
    v_mfma_f32_16x16x32_bf16 v[32:35], v[92:95], v[204:207], v[32:35]
    buffer_load_dwordx4 v[172:175], v16, s[4:7], s33 offen offset:0 sc1
    v_mfma_f32_16x16x32_bf16 v[56:59], v[96:99], v[208:211], v[56:59]
    v_mfma_f32_16x16x32_bf16 v[36:39], v[96:99], v[204:207], v[36:39]
    buffer_load_dwordx4 v[176:179], v17, s[4:7], s33 offen offset:0 sc1
    v_mfma_f32_16x16x32_bf16 v[60:63], v[100:103], v[208:211], v[60:63]
    v_mfma_f32_16x16x32_bf16 v[40:43], v[100:103], v[204:207], v[40:43]
    s_waitcnt vmcnt(14) lgkmcnt(5)
    v_mfma_f32_16x16x32_bf16 v[44:47], v[104:107], v[216:219], v[44:47]
    ds_read_b128 v[84:87], v13 offset:9216
    v_mfma_f32_16x16x32_bf16 v[24:27], v[104:107], v[212:215], v[24:27]
    ds_read_b128 v[88:91], v13 offset:10240
    v_mfma_f32_16x16x32_bf16 v[48:51], v[108:111], v[216:219], v[48:51]
    ds_read_b128 v[92:95], v13 offset:11264
    v_mfma_f32_16x16x32_bf16 v[28:31], v[108:111], v[212:215], v[28:31]
    ds_read_b128 v[96:99], v13 offset:12288
    v_mfma_f32_16x16x32_bf16 v[52:55], v[112:115], v[216:219], v[52:55]
    ds_read_b128 v[100:103], v21 offset:17408
    v_mfma_f32_16x16x32_bf16 v[32:35], v[112:115], v[212:215], v[32:35]
    buffer_load_dwordx4 v[180:183], v16, s[4:7], s33 offen offset:2048 sc1
    v_mfma_f32_16x16x32_bf16 v[56:59], v[116:119], v[216:219], v[56:59]
    v_mfma_f32_16x16x32_bf16 v[36:39], v[116:119], v[212:215], v[36:39]
    buffer_load_dwordx4 v[184:187], v17, s[4:7], s33 offen offset:2048 sc1
    v_mfma_f32_16x16x32_bf16 v[60:63], v[120:123], v[216:219], v[60:63]
    v_mfma_f32_16x16x32_bf16 v[40:43], v[120:123], v[212:215], v[40:43]
    s_waitcnt vmcnt(14) lgkmcnt(5)
    v_mfma_f32_16x16x32_bf16 v[44:47], v[64:67], v[128:131], v[44:47]
    ds_read_b128 v[104:107], v13 offset:18432
    s_mov_b32 s32, 5
    s_lshl_b32 s32, s32, 13
    s_add_u32 s32, s32, s29
    s_add_u32 s33, s32, 4096
    v_mfma_f32_16x16x32_bf16 v[24:27], v[64:67], v[124:127], v[24:27]
    ds_read_b128 v[108:111], v13 offset:19456
    v_mfma_f32_16x16x32_bf16 v[48:51], v[68:71], v[128:131], v[48:51]
    ds_read_b128 v[112:115], v13 offset:20480
    v_mfma_f32_16x16x32_bf16 v[28:31], v[68:71], v[124:127], v[28:31]
    ds_read_b128 v[116:119], v13 offset:21504
    v_mfma_f32_16x16x32_bf16 v[52:55], v[72:75], v[128:131], v[52:55]
    ds_read_b128 v[120:123], v21 offset:26624
    v_mfma_f32_16x16x32_bf16 v[32:35], v[72:75], v[124:127], v[32:35]
    buffer_load_dwordx4 v[188:191], v16, s[4:7], s32 offen offset:0 sc1
    v_mfma_f32_16x16x32_bf16 v[56:59], v[76:79], v[128:131], v[56:59]
    v_mfma_f32_16x16x32_bf16 v[36:39], v[76:79], v[124:127], v[36:39]
    buffer_load_dwordx4 v[192:195], v17, s[4:7], s32 offen offset:0 sc1
    v_mfma_f32_16x16x32_bf16 v[60:63], v[80:83], v[128:131], v[60:63]
    v_mfma_f32_16x16x32_bf16 v[40:43], v[80:83], v[124:127], v[40:43]
    s_waitcnt vmcnt(14) lgkmcnt(5)
    v_mfma_f32_16x16x32_bf16 v[44:47], v[84:87], v[136:139], v[44:47]
    ds_read_b128 v[64:67], v13 offset:27648
    v_mfma_f32_16x16x32_bf16 v[24:27], v[84:87], v[132:135], v[24:27]
    ds_read_b128 v[68:71], v13 offset:28672
    v_mfma_f32_16x16x32_bf16 v[48:51], v[88:91], v[136:139], v[48:51]
    ds_read_b128 v[72:75], v13 offset:29696
    v_mfma_f32_16x16x32_bf16 v[28:31], v[88:91], v[132:135], v[28:31]
    ds_read_b128 v[76:79], v13 offset:30720
    v_mfma_f32_16x16x32_bf16 v[52:55], v[92:95], v[136:139], v[52:55]
    ds_read_b128 v[80:83], v21 offset:35840
    v_mfma_f32_16x16x32_bf16 v[32:35], v[92:95], v[132:135], v[32:35]
    buffer_load_dwordx4 v[196:199], v16, s[4:7], s32 offen offset:2048 sc1
    v_mfma_f32_16x16x32_bf16 v[56:59], v[96:99], v[136:139], v[56:59]
    v_mfma_f32_16x16x32_bf16 v[36:39], v[96:99], v[132:135], v[36:39]
    buffer_load_dwordx4 v[200:203], v17, s[4:7], s32 offen offset:2048 sc1
    v_mfma_f32_16x16x32_bf16 v[60:63], v[100:103], v[136:139], v[60:63]
    v_mfma_f32_16x16x32_bf16 v[40:43], v[100:103], v[132:135], v[40:43]
    s_waitcnt vmcnt(14) lgkmcnt(0)
    s_barrier
    v_mfma_f32_16x16x32_bf16 v[44:47], v[104:107], v[144:147], v[44:47]
    ds_read_b128 v[84:87], v14 offset:0
    v_mfma_f32_16x16x32_bf16 v[24:27], v[104:107], v[140:143], v[24:27]
    ds_read_b128 v[88:91], v14 offset:1024
    v_mfma_f32_16x16x32_bf16 v[48:51], v[108:111], v[144:147], v[48:51]
    ds_read_b128 v[92:95], v14 offset:2048
    v_mfma_f32_16x16x32_bf16 v[28:31], v[108:111], v[140:143], v[28:31]
    ds_read_b128 v[96:99], v14 offset:3072
    v_mfma_f32_16x16x32_bf16 v[52:55], v[112:115], v[144:147], v[52:55]
    ds_read_b128 v[100:103], v22 offset:8192
    v_mfma_f32_16x16x32_bf16 v[32:35], v[112:115], v[140:143], v[32:35]
    buffer_load_dwordx4 v[204:207], v16, s[4:7], s33 offen offset:0 sc1
    v_mfma_f32_16x16x32_bf16 v[56:59], v[116:119], v[144:147], v[56:59]
    v_mfma_f32_16x16x32_bf16 v[36:39], v[116:119], v[140:143], v[36:39]
    buffer_load_dwordx4 v[208:211], v17, s[4:7], s33 offen offset:0 sc1
    v_mfma_f32_16x16x32_bf16 v[60:63], v[120:123], v[144:147], v[60:63]
    v_mfma_f32_16x16x32_bf16 v[40:43], v[120:123], v[140:143], v[40:43]
    s_waitcnt vmcnt(14) lgkmcnt(5)
    v_mfma_f32_16x16x32_bf16 v[44:47], v[64:67], v[152:155], v[44:47]
    ds_read_b128 v[104:107], v14 offset:9216
    v_mfma_f32_16x16x32_bf16 v[24:27], v[64:67], v[148:151], v[24:27]
    ds_read_b128 v[108:111], v14 offset:10240
    v_mfma_f32_16x16x32_bf16 v[48:51], v[68:71], v[152:155], v[48:51]
    ds_read_b128 v[112:115], v14 offset:11264
    v_mfma_f32_16x16x32_bf16 v[28:31], v[68:71], v[148:151], v[28:31]
    ds_read_b128 v[116:119], v14 offset:12288
    v_mfma_f32_16x16x32_bf16 v[52:55], v[72:75], v[152:155], v[52:55]
    ds_read_b128 v[120:123], v22 offset:17408
    v_mfma_f32_16x16x32_bf16 v[32:35], v[72:75], v[148:151], v[32:35]
    buffer_load_dwordx4 v[212:215], v16, s[4:7], s33 offen offset:2048 sc1
    v_mfma_f32_16x16x32_bf16 v[56:59], v[76:79], v[152:155], v[56:59]
    v_mfma_f32_16x16x32_bf16 v[36:39], v[76:79], v[148:151], v[36:39]
    buffer_load_dwordx4 v[216:219], v17, s[4:7], s33 offen offset:2048 sc1
    v_mfma_f32_16x16x32_bf16 v[60:63], v[80:83], v[152:155], v[60:63]
    v_mfma_f32_16x16x32_bf16 v[40:43], v[80:83], v[148:151], v[40:43]
    s_waitcnt vmcnt(14) lgkmcnt(5)
    v_mfma_f32_16x16x32_bf16 v[44:47], v[84:87], v[160:163], v[44:47]
    ds_read_b128 v[64:67], v14 offset:18432
    s_mov_b32 s32, 6
    s_lshl_b32 s32, s32, 13
    s_add_u32 s32, s32, s29
    s_add_u32 s33, s32, 4096
    v_mfma_f32_16x16x32_bf16 v[24:27], v[84:87], v[156:159], v[24:27]
    ds_read_b128 v[68:71], v14 offset:19456
    v_mfma_f32_16x16x32_bf16 v[48:51], v[88:91], v[160:163], v[48:51]
    ds_read_b128 v[72:75], v14 offset:20480
    v_mfma_f32_16x16x32_bf16 v[28:31], v[88:91], v[156:159], v[28:31]
    ds_read_b128 v[76:79], v14 offset:21504
    v_mfma_f32_16x16x32_bf16 v[52:55], v[92:95], v[160:163], v[52:55]
    ds_read_b128 v[80:83], v22 offset:26624
    v_mfma_f32_16x16x32_bf16 v[32:35], v[92:95], v[156:159], v[32:35]
    buffer_load_dwordx4 v[124:127], v16, s[4:7], s32 offen offset:0 sc1
    v_mfma_f32_16x16x32_bf16 v[56:59], v[96:99], v[160:163], v[56:59]
    v_mfma_f32_16x16x32_bf16 v[36:39], v[96:99], v[156:159], v[36:39]
    buffer_load_dwordx4 v[128:131], v17, s[4:7], s32 offen offset:0 sc1
    v_mfma_f32_16x16x32_bf16 v[60:63], v[100:103], v[160:163], v[60:63]
    v_mfma_f32_16x16x32_bf16 v[40:43], v[100:103], v[156:159], v[40:43]
    s_waitcnt vmcnt(14) lgkmcnt(5)
    v_mfma_f32_16x16x32_bf16 v[44:47], v[104:107], v[168:171], v[44:47]
    ds_read_b128 v[84:87], v14 offset:27648
    v_mfma_f32_16x16x32_bf16 v[24:27], v[104:107], v[164:167], v[24:27]
    ds_read_b128 v[88:91], v14 offset:28672
    v_mfma_f32_16x16x32_bf16 v[48:51], v[108:111], v[168:171], v[48:51]
    ds_read_b128 v[92:95], v14 offset:29696
    v_mfma_f32_16x16x32_bf16 v[28:31], v[108:111], v[164:167], v[28:31]
    ds_read_b128 v[96:99], v14 offset:30720
    v_mfma_f32_16x16x32_bf16 v[52:55], v[112:115], v[168:171], v[52:55]
    ds_read_b128 v[100:103], v22 offset:35840
    v_mfma_f32_16x16x32_bf16 v[32:35], v[112:115], v[164:167], v[32:35]
    buffer_load_dwordx4 v[132:135], v16, s[4:7], s32 offen offset:2048 sc1
    v_mfma_f32_16x16x32_bf16 v[56:59], v[116:119], v[168:171], v[56:59]
    v_mfma_f32_16x16x32_bf16 v[36:39], v[116:119], v[164:167], v[36:39]
    buffer_load_dwordx4 v[136:139], v17, s[4:7], s32 offen offset:2048 sc1
    v_mfma_f32_16x16x32_bf16 v[60:63], v[120:123], v[168:171], v[60:63]
    v_mfma_f32_16x16x32_bf16 v[40:43], v[120:123], v[164:167], v[40:43]
    s_waitcnt vmcnt(14) lgkmcnt(0)
    s_barrier
    v_mfma_f32_16x16x32_bf16 v[44:47], v[64:67], v[176:179], v[44:47]
    ds_read_b128 v[104:107], v15 offset:0
    v_mfma_f32_16x16x32_bf16 v[24:27], v[64:67], v[172:175], v[24:27]
    ds_read_b128 v[108:111], v15 offset:1024
    v_mfma_f32_16x16x32_bf16 v[48:51], v[68:71], v[176:179], v[48:51]
    ds_read_b128 v[112:115], v15 offset:2048
    v_mfma_f32_16x16x32_bf16 v[28:31], v[68:71], v[172:175], v[28:31]
    ds_read_b128 v[116:119], v15 offset:3072
    v_mfma_f32_16x16x32_bf16 v[52:55], v[72:75], v[176:179], v[52:55]
    ds_read_b128 v[120:123], v23 offset:8192
    v_mfma_f32_16x16x32_bf16 v[32:35], v[72:75], v[172:175], v[32:35]
    buffer_load_dwordx4 v[140:143], v16, s[4:7], s33 offen offset:0 sc1
    v_mfma_f32_16x16x32_bf16 v[56:59], v[76:79], v[176:179], v[56:59]
    v_mfma_f32_16x16x32_bf16 v[36:39], v[76:79], v[172:175], v[36:39]
    buffer_load_dwordx4 v[144:147], v17, s[4:7], s33 offen offset:0 sc1
    v_mfma_f32_16x16x32_bf16 v[60:63], v[80:83], v[176:179], v[60:63]
    v_mfma_f32_16x16x32_bf16 v[40:43], v[80:83], v[172:175], v[40:43]
    s_waitcnt vmcnt(14) lgkmcnt(5)
    v_mfma_f32_16x16x32_bf16 v[44:47], v[84:87], v[184:187], v[44:47]
    ds_read_b128 v[64:67], v15 offset:9216
    v_mfma_f32_16x16x32_bf16 v[24:27], v[84:87], v[180:183], v[24:27]
    ds_read_b128 v[68:71], v15 offset:10240
    v_mfma_f32_16x16x32_bf16 v[48:51], v[88:91], v[184:187], v[48:51]
    ds_read_b128 v[72:75], v15 offset:11264
    v_mfma_f32_16x16x32_bf16 v[28:31], v[88:91], v[180:183], v[28:31]
    ds_read_b128 v[76:79], v15 offset:12288
    v_mfma_f32_16x16x32_bf16 v[52:55], v[92:95], v[184:187], v[52:55]
    ds_read_b128 v[80:83], v23 offset:17408
    v_mfma_f32_16x16x32_bf16 v[32:35], v[92:95], v[180:183], v[32:35]
    buffer_load_dwordx4 v[148:151], v16, s[4:7], s33 offen offset:2048 sc1
    v_mfma_f32_16x16x32_bf16 v[56:59], v[96:99], v[184:187], v[56:59]
    v_mfma_f32_16x16x32_bf16 v[36:39], v[96:99], v[180:183], v[36:39]
    buffer_load_dwordx4 v[152:155], v17, s[4:7], s33 offen offset:2048 sc1
    v_mfma_f32_16x16x32_bf16 v[60:63], v[100:103], v[184:187], v[60:63]
    v_mfma_f32_16x16x32_bf16 v[40:43], v[100:103], v[180:183], v[40:43]
    s_waitcnt vmcnt(14) lgkmcnt(5)
    v_mfma_f32_16x16x32_bf16 v[44:47], v[104:107], v[192:195], v[44:47]
    ds_read_b128 v[84:87], v15 offset:18432
    s_mov_b32 s32, 7
    s_lshl_b32 s32, s32, 13
    s_add_u32 s32, s32, s29
    s_add_u32 s33, s32, 4096
    v_mfma_f32_16x16x32_bf16 v[24:27], v[104:107], v[188:191], v[24:27]
    ds_read_b128 v[88:91], v15 offset:19456
    v_mfma_f32_16x16x32_bf16 v[48:51], v[108:111], v[192:195], v[48:51]
    ds_read_b128 v[92:95], v15 offset:20480
    v_mfma_f32_16x16x32_bf16 v[28:31], v[108:111], v[188:191], v[28:31]
    ds_read_b128 v[96:99], v15 offset:21504
    v_mfma_f32_16x16x32_bf16 v[52:55], v[112:115], v[192:195], v[52:55]
    ds_read_b128 v[100:103], v23 offset:26624
    v_mfma_f32_16x16x32_bf16 v[32:35], v[112:115], v[188:191], v[32:35]
    buffer_load_dwordx4 v[156:159], v16, s[4:7], s32 offen offset:0 sc1
    v_mfma_f32_16x16x32_bf16 v[56:59], v[116:119], v[192:195], v[56:59]
    v_mfma_f32_16x16x32_bf16 v[36:39], v[116:119], v[188:191], v[36:39]
    buffer_load_dwordx4 v[160:163], v17, s[4:7], s32 offen offset:0 sc1
    v_mfma_f32_16x16x32_bf16 v[60:63], v[120:123], v[192:195], v[60:63]
    v_mfma_f32_16x16x32_bf16 v[40:43], v[120:123], v[188:191], v[40:43]
    s_waitcnt vmcnt(14) lgkmcnt(5)
    v_mfma_f32_16x16x32_bf16 v[44:47], v[64:67], v[200:203], v[44:47]
    ds_read_b128 v[104:107], v15 offset:27648
    v_mfma_f32_16x16x32_bf16 v[24:27], v[64:67], v[196:199], v[24:27]
    ds_read_b128 v[108:111], v15 offset:28672
    v_mfma_f32_16x16x32_bf16 v[48:51], v[68:71], v[200:203], v[48:51]
    ds_read_b128 v[112:115], v15 offset:29696
    v_mfma_f32_16x16x32_bf16 v[28:31], v[68:71], v[196:199], v[28:31]
    ds_read_b128 v[116:119], v15 offset:30720
    v_mfma_f32_16x16x32_bf16 v[52:55], v[72:75], v[200:203], v[52:55]
    ds_read_b128 v[120:123], v23 offset:35840
    v_mfma_f32_16x16x32_bf16 v[32:35], v[72:75], v[196:199], v[32:35]
    buffer_load_dwordx4 v[164:167], v16, s[4:7], s32 offen offset:2048 sc1
    v_mfma_f32_16x16x32_bf16 v[56:59], v[76:79], v[200:203], v[56:59]
    v_mfma_f32_16x16x32_bf16 v[36:39], v[76:79], v[196:199], v[36:39]
    buffer_load_dwordx4 v[168:171], v17, s[4:7], s32 offen offset:2048 sc1
    v_mfma_f32_16x16x32_bf16 v[60:63], v[80:83], v[200:203], v[60:63]
    v_mfma_f32_16x16x32_bf16 v[40:43], v[80:83], v[196:199], v[40:43]
    s_waitcnt vmcnt(14) lgkmcnt(0)
    s_barrier
    v_mfma_f32_16x16x32_bf16 v[44:47], v[84:87], v[208:211], v[44:47]
    ds_read_b128 v[64:67], v12 offset:0
    v_mfma_f32_16x16x32_bf16 v[24:27], v[84:87], v[204:207], v[24:27]
    ds_read_b128 v[68:71], v12 offset:1024
    v_mfma_f32_16x16x32_bf16 v[48:51], v[88:91], v[208:211], v[48:51]
    ds_read_b128 v[72:75], v12 offset:2048
    v_mfma_f32_16x16x32_bf16 v[28:31], v[88:91], v[204:207], v[28:31]
    ds_read_b128 v[76:79], v12 offset:3072
    v_mfma_f32_16x16x32_bf16 v[52:55], v[92:95], v[208:211], v[52:55]
    ds_read_b128 v[80:83], v20 offset:8192
    v_mfma_f32_16x16x32_bf16 v[32:35], v[92:95], v[204:207], v[32:35]
    buffer_load_dwordx4 v[172:175], v16, s[4:7], s33 offen offset:0 sc1
    v_mfma_f32_16x16x32_bf16 v[56:59], v[96:99], v[208:211], v[56:59]
    v_mfma_f32_16x16x32_bf16 v[36:39], v[96:99], v[204:207], v[36:39]
    buffer_load_dwordx4 v[176:179], v17, s[4:7], s33 offen offset:0 sc1
    v_mfma_f32_16x16x32_bf16 v[60:63], v[100:103], v[208:211], v[60:63]
    v_mfma_f32_16x16x32_bf16 v[40:43], v[100:103], v[204:207], v[40:43]
    s_waitcnt vmcnt(14) lgkmcnt(5)
    v_mfma_f32_16x16x32_bf16 v[44:47], v[104:107], v[216:219], v[44:47]
    ds_read_b128 v[84:87], v12 offset:9216
    v_mfma_f32_16x16x32_bf16 v[24:27], v[104:107], v[212:215], v[24:27]
    ds_read_b128 v[88:91], v12 offset:10240
    v_mfma_f32_16x16x32_bf16 v[48:51], v[108:111], v[216:219], v[48:51]
    ds_read_b128 v[92:95], v12 offset:11264
    v_mfma_f32_16x16x32_bf16 v[28:31], v[108:111], v[212:215], v[28:31]
    ds_read_b128 v[96:99], v12 offset:12288
    v_mfma_f32_16x16x32_bf16 v[52:55], v[112:115], v[216:219], v[52:55]
    ds_read_b128 v[100:103], v20 offset:17408
    v_mfma_f32_16x16x32_bf16 v[32:35], v[112:115], v[212:215], v[32:35]
    buffer_load_dwordx4 v[180:183], v16, s[4:7], s33 offen offset:2048 sc1
    v_mfma_f32_16x16x32_bf16 v[56:59], v[116:119], v[216:219], v[56:59]
    v_mfma_f32_16x16x32_bf16 v[36:39], v[116:119], v[212:215], v[36:39]
    buffer_load_dwordx4 v[184:187], v17, s[4:7], s33 offen offset:2048 sc1
    v_mfma_f32_16x16x32_bf16 v[60:63], v[120:123], v[216:219], v[60:63]
    v_mfma_f32_16x16x32_bf16 v[40:43], v[120:123], v[212:215], v[40:43]
    s_waitcnt vmcnt(14) lgkmcnt(5)
    v_mfma_f32_16x16x32_bf16 v[44:47], v[64:67], v[128:131], v[44:47]
    ds_read_b128 v[104:107], v12 offset:18432
    s_mov_b32 s32, 8
    s_lshl_b32 s32, s32, 13
    s_add_u32 s32, s32, s29
    s_add_u32 s33, s32, 4096
    v_mfma_f32_16x16x32_bf16 v[24:27], v[64:67], v[124:127], v[24:27]
    ds_read_b128 v[108:111], v12 offset:19456
    v_mfma_f32_16x16x32_bf16 v[48:51], v[68:71], v[128:131], v[48:51]
    ds_read_b128 v[112:115], v12 offset:20480
    v_mfma_f32_16x16x32_bf16 v[28:31], v[68:71], v[124:127], v[28:31]
    ds_read_b128 v[116:119], v12 offset:21504
    v_mfma_f32_16x16x32_bf16 v[52:55], v[72:75], v[128:131], v[52:55]
    ds_read_b128 v[120:123], v20 offset:26624
    v_mfma_f32_16x16x32_bf16 v[32:35], v[72:75], v[124:127], v[32:35]
    buffer_load_dwordx4 v[188:191], v18, s[4:7], s32 offen offset:0 sc1
    v_mfma_f32_16x16x32_bf16 v[56:59], v[76:79], v[128:131], v[56:59]
    v_mfma_f32_16x16x32_bf16 v[36:39], v[76:79], v[124:127], v[36:39]
    buffer_load_dwordx4 v[192:195], v19, s[4:7], s32 offen offset:0 sc1
    v_mfma_f32_16x16x32_bf16 v[60:63], v[80:83], v[128:131], v[60:63]
    v_mfma_f32_16x16x32_bf16 v[40:43], v[80:83], v[124:127], v[40:43]
    s_waitcnt vmcnt(14) lgkmcnt(5)
    v_mfma_f32_16x16x32_bf16 v[44:47], v[84:87], v[136:139], v[44:47]
    ds_read_b128 v[64:67], v12 offset:27648
    v_mfma_f32_16x16x32_bf16 v[24:27], v[84:87], v[132:135], v[24:27]
    ds_read_b128 v[68:71], v12 offset:28672
    v_mfma_f32_16x16x32_bf16 v[48:51], v[88:91], v[136:139], v[48:51]
    ds_read_b128 v[72:75], v12 offset:29696
    v_mfma_f32_16x16x32_bf16 v[28:31], v[88:91], v[132:135], v[28:31]
    ds_read_b128 v[76:79], v12 offset:30720
    v_mfma_f32_16x16x32_bf16 v[52:55], v[92:95], v[136:139], v[52:55]
    ds_read_b128 v[80:83], v20 offset:35840
    v_mfma_f32_16x16x32_bf16 v[32:35], v[92:95], v[132:135], v[32:35]
    buffer_load_dwordx4 v[196:199], v18, s[4:7], s32 offen offset:2048 sc1
    v_mfma_f32_16x16x32_bf16 v[56:59], v[96:99], v[136:139], v[56:59]
    v_mfma_f32_16x16x32_bf16 v[36:39], v[96:99], v[132:135], v[36:39]
    buffer_load_dwordx4 v[200:203], v19, s[4:7], s32 offen offset:2048 sc1
    v_mfma_f32_16x16x32_bf16 v[60:63], v[100:103], v[136:139], v[60:63]
    v_mfma_f32_16x16x32_bf16 v[40:43], v[100:103], v[132:135], v[40:43]
    s_waitcnt vmcnt(14) lgkmcnt(0)
    s_barrier
    v_mfma_f32_16x16x32_bf16 v[44:47], v[104:107], v[144:147], v[44:47]
    ds_read_b128 v[84:87], v13 offset:0
    v_mfma_f32_16x16x32_bf16 v[24:27], v[104:107], v[140:143], v[24:27]
    ds_read_b128 v[88:91], v13 offset:1024
    v_mfma_f32_16x16x32_bf16 v[48:51], v[108:111], v[144:147], v[48:51]
    ds_read_b128 v[92:95], v13 offset:2048
    v_mfma_f32_16x16x32_bf16 v[28:31], v[108:111], v[140:143], v[28:31]
    ds_read_b128 v[96:99], v13 offset:3072
    v_mfma_f32_16x16x32_bf16 v[52:55], v[112:115], v[144:147], v[52:55]
    ds_read_b128 v[100:103], v21 offset:8192
    v_mfma_f32_16x16x32_bf16 v[32:35], v[112:115], v[140:143], v[32:35]
    buffer_load_dwordx4 v[204:207], v18, s[4:7], s33 offen offset:0 sc1
    v_mfma_f32_16x16x32_bf16 v[56:59], v[116:119], v[144:147], v[56:59]
    v_mfma_f32_16x16x32_bf16 v[36:39], v[116:119], v[140:143], v[36:39]
    buffer_load_dwordx4 v[208:211], v19, s[4:7], s33 offen offset:0 sc1
    v_mfma_f32_16x16x32_bf16 v[60:63], v[120:123], v[144:147], v[60:63]
    v_mfma_f32_16x16x32_bf16 v[40:43], v[120:123], v[140:143], v[40:43]
    s_waitcnt vmcnt(14) lgkmcnt(5)
    v_mfma_f32_16x16x32_bf16 v[44:47], v[64:67], v[152:155], v[44:47]
    ds_read_b128 v[104:107], v13 offset:9216
    v_mfma_f32_16x16x32_bf16 v[24:27], v[64:67], v[148:151], v[24:27]
    ds_read_b128 v[108:111], v13 offset:10240
    v_mfma_f32_16x16x32_bf16 v[48:51], v[68:71], v[152:155], v[48:51]
    ds_read_b128 v[112:115], v13 offset:11264
    v_mfma_f32_16x16x32_bf16 v[28:31], v[68:71], v[148:151], v[28:31]
    ds_read_b128 v[116:119], v13 offset:12288
    v_mfma_f32_16x16x32_bf16 v[52:55], v[72:75], v[152:155], v[52:55]
    ds_read_b128 v[120:123], v21 offset:17408
    v_mfma_f32_16x16x32_bf16 v[32:35], v[72:75], v[148:151], v[32:35]
    buffer_load_dwordx4 v[212:215], v18, s[4:7], s33 offen offset:2048 sc1
    v_mfma_f32_16x16x32_bf16 v[56:59], v[76:79], v[152:155], v[56:59]
    v_mfma_f32_16x16x32_bf16 v[36:39], v[76:79], v[148:151], v[36:39]
    buffer_load_dwordx4 v[216:219], v19, s[4:7], s33 offen offset:2048 sc1
    v_mfma_f32_16x16x32_bf16 v[60:63], v[80:83], v[152:155], v[60:63]
    v_mfma_f32_16x16x32_bf16 v[40:43], v[80:83], v[148:151], v[40:43]
    s_waitcnt vmcnt(14) lgkmcnt(5)
    v_mfma_f32_16x16x32_bf16 v[44:47], v[84:87], v[160:163], v[44:47]
    ds_read_b128 v[64:67], v13 offset:18432
    v_mfma_f32_16x16x32_bf16 v[24:27], v[84:87], v[156:159], v[24:27]
    ds_read_b128 v[68:71], v13 offset:19456
    v_mfma_f32_16x16x32_bf16 v[48:51], v[88:91], v[160:163], v[48:51]
    ds_read_b128 v[72:75], v13 offset:20480
    v_mfma_f32_16x16x32_bf16 v[28:31], v[88:91], v[156:159], v[28:31]
    ds_read_b128 v[76:79], v13 offset:21504
    v_mfma_f32_16x16x32_bf16 v[52:55], v[92:95], v[160:163], v[52:55]
    ds_read_b128 v[80:83], v21 offset:26624
    v_mfma_f32_16x16x32_bf16 v[32:35], v[92:95], v[156:159], v[32:35]
    v_mfma_f32_16x16x32_bf16 v[56:59], v[96:99], v[160:163], v[56:59]
    v_mfma_f32_16x16x32_bf16 v[36:39], v[96:99], v[156:159], v[36:39]
    v_mfma_f32_16x16x32_bf16 v[60:63], v[100:103], v[160:163], v[60:63]
    v_mfma_f32_16x16x32_bf16 v[40:43], v[100:103], v[156:159], v[40:43]
    s_waitcnt vmcnt(12) lgkmcnt(5)
    v_mfma_f32_16x16x32_bf16 v[44:47], v[104:107], v[168:171], v[44:47]
    ds_read_b128 v[84:87], v13 offset:27648
    v_mfma_f32_16x16x32_bf16 v[24:27], v[104:107], v[164:167], v[24:27]
    ds_read_b128 v[88:91], v13 offset:28672
    v_mfma_f32_16x16x32_bf16 v[48:51], v[108:111], v[168:171], v[48:51]
    ds_read_b128 v[92:95], v13 offset:29696
    v_mfma_f32_16x16x32_bf16 v[28:31], v[108:111], v[164:167], v[28:31]
    ds_read_b128 v[96:99], v13 offset:30720
    v_mfma_f32_16x16x32_bf16 v[52:55], v[112:115], v[168:171], v[52:55]
    ds_read_b128 v[100:103], v21 offset:35840
    v_mfma_f32_16x16x32_bf16 v[32:35], v[112:115], v[164:167], v[32:35]
    v_mfma_f32_16x16x32_bf16 v[56:59], v[116:119], v[168:171], v[56:59]
    v_mfma_f32_16x16x32_bf16 v[36:39], v[116:119], v[164:167], v[36:39]
    v_mfma_f32_16x16x32_bf16 v[60:63], v[120:123], v[168:171], v[60:63]
    v_mfma_f32_16x16x32_bf16 v[40:43], v[120:123], v[164:167], v[40:43]
    s_waitcnt vmcnt(10) lgkmcnt(0)
    s_barrier
    v_mfma_f32_16x16x32_bf16 v[44:47], v[64:67], v[176:179], v[44:47]
    ds_read_b128 v[104:107], v14 offset:0
    v_mfma_f32_16x16x32_bf16 v[24:27], v[64:67], v[172:175], v[24:27]
    ds_read_b128 v[108:111], v14 offset:1024
    v_mfma_f32_16x16x32_bf16 v[48:51], v[68:71], v[176:179], v[48:51]
    ds_read_b128 v[112:115], v14 offset:2048
    v_mfma_f32_16x16x32_bf16 v[28:31], v[68:71], v[172:175], v[28:31]
    ds_read_b128 v[116:119], v14 offset:3072
    v_mfma_f32_16x16x32_bf16 v[52:55], v[72:75], v[176:179], v[52:55]
    ds_read_b128 v[120:123], v22 offset:8192
    v_mfma_f32_16x16x32_bf16 v[32:35], v[72:75], v[172:175], v[32:35]
    v_mfma_f32_16x16x32_bf16 v[56:59], v[76:79], v[176:179], v[56:59]
    v_mfma_f32_16x16x32_bf16 v[36:39], v[76:79], v[172:175], v[36:39]
    v_mfma_f32_16x16x32_bf16 v[60:63], v[80:83], v[176:179], v[60:63]
    v_mfma_f32_16x16x32_bf16 v[40:43], v[80:83], v[172:175], v[40:43]
    s_waitcnt vmcnt(8) lgkmcnt(5)
    v_mfma_f32_16x16x32_bf16 v[44:47], v[84:87], v[184:187], v[44:47]
    ds_read_b128 v[64:67], v14 offset:9216
    v_mfma_f32_16x16x32_bf16 v[24:27], v[84:87], v[180:183], v[24:27]
    ds_read_b128 v[68:71], v14 offset:10240
    v_mfma_f32_16x16x32_bf16 v[48:51], v[88:91], v[184:187], v[48:51]
    ds_read_b128 v[72:75], v14 offset:11264
    v_mfma_f32_16x16x32_bf16 v[28:31], v[88:91], v[180:183], v[28:31]
    ds_read_b128 v[76:79], v14 offset:12288
    v_mfma_f32_16x16x32_bf16 v[52:55], v[92:95], v[184:187], v[52:55]
    ds_read_b128 v[80:83], v22 offset:17408
    v_mfma_f32_16x16x32_bf16 v[32:35], v[92:95], v[180:183], v[32:35]
    s_waitcnt vmcnt(6)
    v_mfma_f32_16x16x32_bf16 v[56:59], v[96:99], v[184:187], v[56:59]
    v_swap_b32 v190, v192
    v_mfma_f32_16x16x32_bf16 v[36:39], v[96:99], v[180:183], v[36:39]
    v_swap_b32 v191, v193
    v_mfma_f32_16x16x32_bf16 v[60:63], v[100:103], v[184:187], v[60:63]
    v_mfma_f32_16x16x32_bf16 v[40:43], v[100:103], v[180:183], v[40:43]
    s_waitcnt vmcnt(6) lgkmcnt(5)
    v_mfma_f32_16x16x32_bf16 v[44:47], v[104:107], v[192:195], v[44:47]
    ds_read_b128 v[84:87], v14 offset:18432
    v_mfma_f32_16x16x32_bf16 v[24:27], v[104:107], v[188:191], v[24:27]
    ds_read_b128 v[88:91], v14 offset:19456
    v_mfma_f32_16x16x32_bf16 v[48:51], v[108:111], v[192:195], v[48:51]
    ds_read_b128 v[92:95], v14 offset:20480
    v_mfma_f32_16x16x32_bf16 v[28:31], v[108:111], v[188:191], v[28:31]
    ds_read_b128 v[96:99], v14 offset:21504
    v_mfma_f32_16x16x32_bf16 v[52:55], v[112:115], v[192:195], v[52:55]
    ds_read_b128 v[100:103], v22 offset:26624
    v_mfma_f32_16x16x32_bf16 v[32:35], v[112:115], v[188:191], v[32:35]
    s_waitcnt vmcnt(4)
    v_mfma_f32_16x16x32_bf16 v[56:59], v[116:119], v[192:195], v[56:59]
    v_swap_b32 v198, v200
    v_mfma_f32_16x16x32_bf16 v[36:39], v[116:119], v[188:191], v[36:39]
    v_swap_b32 v199, v201
    v_mfma_f32_16x16x32_bf16 v[60:63], v[120:123], v[192:195], v[60:63]
    v_mfma_f32_16x16x32_bf16 v[40:43], v[120:123], v[188:191], v[40:43]
    s_waitcnt vmcnt(4) lgkmcnt(5)
    v_mfma_f32_16x16x32_bf16 v[44:47], v[64:67], v[200:203], v[44:47]
    ds_read_b128 v[104:107], v14 offset:27648
    v_mfma_f32_16x16x32_bf16 v[24:27], v[64:67], v[196:199], v[24:27]
    ds_read_b128 v[108:111], v14 offset:28672
    v_mfma_f32_16x16x32_bf16 v[48:51], v[68:71], v[200:203], v[48:51]
    ds_read_b128 v[112:115], v14 offset:29696
    v_mfma_f32_16x16x32_bf16 v[28:31], v[68:71], v[196:199], v[28:31]
    ds_read_b128 v[116:119], v14 offset:30720
    v_mfma_f32_16x16x32_bf16 v[52:55], v[72:75], v[200:203], v[52:55]
    ds_read_b128 v[120:123], v22 offset:35840
    v_mfma_f32_16x16x32_bf16 v[32:35], v[72:75], v[196:199], v[32:35]
    s_waitcnt vmcnt(2)
    v_mfma_f32_16x16x32_bf16 v[56:59], v[76:79], v[200:203], v[56:59]
    v_swap_b32 v206, v208
    v_mfma_f32_16x16x32_bf16 v[36:39], v[76:79], v[196:199], v[36:39]
    v_swap_b32 v207, v209
    v_mfma_f32_16x16x32_bf16 v[60:63], v[80:83], v[200:203], v[60:63]
    v_mfma_f32_16x16x32_bf16 v[40:43], v[80:83], v[196:199], v[40:43]
    s_waitcnt vmcnt(2) lgkmcnt(5)
    v_mfma_f32_16x16x32_bf16 v[44:47], v[84:87], v[208:211], v[44:47]
    v_mfma_f32_16x16x32_bf16 v[24:27], v[84:87], v[204:207], v[24:27]
    v_mfma_f32_16x16x32_bf16 v[48:51], v[88:91], v[208:211], v[48:51]
    v_mfma_f32_16x16x32_bf16 v[28:31], v[88:91], v[204:207], v[28:31]
    v_mfma_f32_16x16x32_bf16 v[52:55], v[92:95], v[208:211], v[52:55]
    v_mfma_f32_16x16x32_bf16 v[32:35], v[92:95], v[204:207], v[32:35]
    s_waitcnt vmcnt(0)
    v_mfma_f32_16x16x32_bf16 v[56:59], v[96:99], v[208:211], v[56:59]
    v_swap_b32 v214, v216
    v_mfma_f32_16x16x32_bf16 v[36:39], v[96:99], v[204:207], v[36:39]
    v_swap_b32 v215, v217
    v_mfma_f32_16x16x32_bf16 v[60:63], v[100:103], v[208:211], v[60:63]
    v_mfma_f32_16x16x32_bf16 v[40:43], v[100:103], v[204:207], v[40:43]
    s_waitcnt vmcnt(0) lgkmcnt(0)
    v_mfma_f32_16x16x32_bf16 v[44:47], v[104:107], v[216:219], v[44:47]
    v_mfma_f32_16x16x32_bf16 v[48:51], v[108:111], v[216:219], v[48:51]
    v_mfma_f32_16x16x32_bf16 v[52:55], v[112:115], v[216:219], v[52:55]
    v_mfma_f32_16x16x32_bf16 v[56:59], v[116:119], v[216:219], v[56:59]
    v_mfma_f32_16x16x32_bf16 v[60:63], v[120:123], v[216:219], v[60:63]
    v_mfma_f32_16x16x32_bf16 v[24:27], v[104:107], v[212:215], v[24:27]
    v_mfma_f32_16x16x32_bf16 v[28:31], v[108:111], v[212:215], v[28:31]
    v_mfma_f32_16x16x32_bf16 v[32:35], v[112:115], v[212:215], v[32:35]
    v_mfma_f32_16x16x32_bf16 v[36:39], v[116:119], v[212:215], v[36:39]
    v_mfma_f32_16x16x32_bf16 v[40:43], v[120:123], v[212:215], v[40:43]
    ds_write_b128 v2, v[44:47] offset:0
    ds_write_b128 v2, v[48:51] offset:1024
    ds_write_b128 v2, v[52:55] offset:2048
    ds_write_b128 v2, v[56:59] offset:3072
    s_mov_b64 exec, s[40:41]
    ds_write_b128 v3, v[60:63] offset:4096
    s_mov_b64 exec, -1
    ds_write_b32 v0, v9
    s_mov_b32 s60, 1048576
L_px_p5:
    ds_read_b32 v232, v6
    ds_read_b128 v[64:67], v7 offset:0
    ds_read_b128 v[68:71], v7 offset:1024
    ds_read_b128 v[72:75], v7 offset:2048
    ds_read_b128 v[76:79], v7 offset:3072
    ds_read_b128 v[80:83], v8 offset:4096
    s_waitcnt lgkmcnt(5)
    v_cmp_ne_u32 vcc, s43, v232
    s_sub_u32 s60, s60, 1
    s_cbranch_scc1 L_py_p5
    s_cbranch_vccnz L_px_p5
L_py_p5:
    s_waitcnt lgkmcnt(4)
    v_pk_add_f32 v[24:25], v[24:25], v[64:65]
    v_pk_add_f32 v[26:27], v[26:27], v[66:67]
    v_cvt_pk_bf16_f32 v220, v24, v25
    v_cvt_pk_bf16_f32 v221, v26, v27
    s_waitcnt lgkmcnt(3)
    v_pk_add_f32 v[28:29], v[28:29], v[68:69]
    v_pk_add_f32 v[30:31], v[30:31], v[70:71]
    v_cvt_pk_bf16_f32 v222, v28, v29
    v_cvt_pk_bf16_f32 v223, v30, v31
    s_waitcnt lgkmcnt(2)
    v_pk_add_f32 v[32:33], v[32:33], v[72:73]
    v_pk_add_f32 v[34:35], v[34:35], v[74:75]
    v_cvt_pk_bf16_f32 v224, v32, v33
    v_cvt_pk_bf16_f32 v225, v34, v35
    s_waitcnt lgkmcnt(1)
    v_pk_add_f32 v[36:37], v[36:37], v[76:77]
    v_pk_add_f32 v[38:39], v[38:39], v[78:79]
    v_cvt_pk_bf16_f32 v226, v36, v37
    v_cvt_pk_bf16_f32 v227, v38, v39
    s_waitcnt lgkmcnt(0)
    v_pk_add_f32 v[40:41], v[40:41], v[80:81]
    v_pk_add_f32 v[42:43], v[42:43], v[82:83]
    v_cvt_pk_bf16_f32 v228, v40, v41
    v_cvt_pk_bf16_f32 v229, v42, v43
    s_cmp_eq_u32 s22, 1
    s_cbranch_scc1 L_fin_p5
    buffer_store_dwordx4 v[220:223], v4, s[4:7], s34 offen offset:0 sc1
    buffer_store_dwordx4 v[224:227], v4, s[4:7], s34 offen offset:1024 sc1
    buffer_store_dwordx2 v[228:229], v5, s[4:7], s34 offen sc1
    v_cndmask_b32 v234, 0, v228, s[40:41]
    v_cndmask_b32 v235, 0, v229, s[40:41]
    v_dot2_f32_bf16 v232, v220, v11, 0
    v_dot2_f32_bf16 v233, v220, v220, 0
    v_dot2_f32_bf16 v232, v221, v11, v232
    v_dot2_f32_bf16 v233, v221, v221, v233
    v_dot2_f32_bf16 v232, v222, v11, v232
    v_dot2_f32_bf16 v233, v222, v222, v233
    v_dot2_f32_bf16 v232, v223, v11, v232
    v_dot2_f32_bf16 v233, v223, v223, v233
    v_dot2_f32_bf16 v232, v224, v11, v232
    v_dot2_f32_bf16 v233, v224, v224, v233
    v_dot2_f32_bf16 v232, v225, v11, v232
    v_dot2_f32_bf16 v233, v225, v225, v233
    v_dot2_f32_bf16 v232, v226, v11, v232
    v_dot2_f32_bf16 v233, v226, v226, v233
    v_dot2_f32_bf16 v232, v227, v11, v232
    v_dot2_f32_bf16 v233, v227, v227, v233
    v_dot2_f32_bf16 v232, v234, v11, v232
    v_dot2_f32_bf16 v233, v234, v234, v233
    v_dot2_f32_bf16 v232, v235, v11, v232
    v_dot2_f32_bf16 v233, v235, v235, v233
    s_nop 2
    v_mov_b32 v234, v232
    v_mov_b32 v235, v233
    s_nop 1
    v_permlane32_swap_b32 v232, v234
    v_permlane32_swap_b32 v233, v235
    v_add_f32 v232, v232, v234
    v_add_f32 v233, v233, v235
    v_mov_b32 v234, v232
    v_mov_b32 v235, v233
    s_nop 1
    v_permlane16_swap_b32 v232, v234
    v_permlane16_swap_b32 v233, v235
    v_add_f32 v232, v232, v234
    v_add_f32 v233, v233, v235
    buffer_store_dwordx2 v[232:233], v10, s[4:7], s39 offen sc1
    s_barrier
    s_mov_b32 s22, 1
    s_mov_b32 s21, 0x1c00000
    s_branch L_m_cl
L_fin_p5:
    buffer_store_dwordx4 v[220:223], v4, s[16:19], s34 offen offset:0
    buffer_store_dwordx4 v[224:227], v4, s[16:19], s34 offen offset:64
    buffer_store_dwordx2 v[228:229], v5, s[16:19], s34 offen offset:128
    s_endpgm
L_m_l1:
    s_and_b32 s25, s2, 7
    s_lshr_b32 s26, s2, 3
    s_lshr_b32 s23, s25, 1
    s_lshl_b32 s23, s23, 2
    s_lshr_b32 s27, s26, 3
    s_add_u32 s23, s23, s27
    s_and_b32 s24, s25, 1
    s_lshl_b32 s24, s24, 3
    s_and_b32 s27, s26, 7
    s_add_u32 s24, s24, s27
    s_mul_i32 s29, s24, 129024
    s_lshl_b32 s30, s20, 12
    s_add_u32 s29, s29, s30
    s_add_u32 s29, s29, 0x3800000
    s_lshl_b32 s31, s23, 3
    s_max_u32 s31, s31, 1
    s_sub_u32 s31, s31, 1
    s_mul_i32 s31, s31, 18432
    s_add_u32 s31, s31, 0x0
    s_lshl_b32 s35, s20, 10
    s_and_b32 s36, s35, 1024
    s_barrier
    s_add_u32 m0, s35, 131072
    s_add_u32 s34, s31, s35
    s_add_u32 s34, s34, 0
    buffer_load_dwordx4 v1, s[4:7], s34 offen sc1 lds
    s_add_u32 m0, s30, 0
    s_add_u32 s34, s29, 0
    buffer_load_dwordx4 v1, s[4:7], s34 offen offset:0 sc1 lds
    buffer_load_dwordx4 v1, s[4:7], s34 offen offset:1024 sc1 lds
    buffer_load_dwordx4 v1, s[4:7], s34 offen offset:2048 sc1 lds
    buffer_load_dwordx4 v1, s[4:7], s34 offen offset:3072 sc1 lds
    s_add_u32 m0, s30, 16384
    s_add_u32 s34, s29, 16384
    buffer_load_dwordx4 v1, s[4:7], s34 offen offset:0 sc1 lds
    buffer_load_dwordx4 v1, s[4:7], s34 offen offset:1024 sc1 lds
    buffer_load_dwordx4 v1, s[4:7], s34 offen offset:2048 sc1 lds
    buffer_load_dwordx4 v1, s[4:7], s34 offen offset:3072 sc1 lds
    s_waitcnt vmcnt(4) lgkmcnt(0)
    s_barrier
    s_add_u32 m0, s30, 32768
    s_add_u32 s34, s29, 32768
    buffer_load_dwordx4 v1, s[4:7], s34 offen offset:0 sc1 lds
    buffer_load_dwordx4 v1, s[4:7], s34 offen offset:1024 sc1 lds
    buffer_load_dwordx4 v1, s[4:7], s34 offen offset:2048 sc1 lds
    buffer_load_dwordx4 v1, s[4:7], s34 offen offset:3072 sc1 lds
    s_cmp_lt_u32 s2, 144
    s_cbranch_scc1 L_p0_t1
    s_cmp_ge_u32 s2, 216
    s_cbranch_scc1 L_p0_t2
    ds_read_b64_tr_b16 v[16:17], v4 offset:0
    ds_read_b64_tr_b16 v[18:19], v4 offset:2048
    ds_read_b64_tr_b16 v[20:21], v4 offset:18432
    ds_read_b64_tr_b16 v[22:23], v4 offset:20480
    ds_read_b64_tr_b16 v[24:25], v4 offset:4096
    ds_read_b64_tr_b16 v[26:27], v4 offset:6144
    ds_read_b64_tr_b16 v[28:29], v4 offset:22528
    ds_read_b64_tr_b16 v[30:31], v4 offset:24576
    ds_read_b64_tr_b16 v[32:33], v4 offset:8192
    ds_read_b64_tr_b16 v[34:35], v4 offset:10240
    ds_read_b64_tr_b16 v[36:37], v4 offset:26624
    ds_read_b64_tr_b16 v[38:39], v4 offset:28672
    ds_read_b64_tr_b16 v[40:41], v4 offset:12288
    ds_read_b64_tr_b16 v[42:43], v4 offset:14336
    ds_read_b64_tr_b16 v[44:45], v4 offset:30720
    ds_read_b64_tr_b16 v[46:47], v4 offset:32768
    ds_read_b64_tr_b16 v[48:49], v5 offset:16384
    ds_read_b64_tr_b16 v[50:51], v5 offset:34816
    s_branch L_p0_t2
L_p0_t1:
    ds_read_b64_tr_b16 v[16:17], v4 offset:0
    ds_read_b64_tr_b16 v[18:19], v4 offset:512
    ds_read_b64_tr_b16 v[20:21], v4 offset:4352
    ds_read_b64_tr_b16 v[22:23], v4 offset:4864
    ds_read_b64_tr_b16 v[24:25], v4 offset:9792
    ds_read_b64_tr_b16 v[26:27], v4 offset:10304
    ds_read_b64_tr_b16 v[28:29], v4 offset:14144
    ds_read_b64_tr_b16 v[30:31], v4 offset:14656
    ds_read_b64_tr_b16 v[32:33], v4 offset:19584
    ds_read_b64_tr_b16 v[34:35], v4 offset:20096
    ds_read_b64_tr_b16 v[36:37], v4 offset:23936
    ds_read_b64_tr_b16 v[38:39], v4 offset:24448
    ds_read_b64_tr_b16 v[40:41], v4 offset:29376
    ds_read_b64_tr_b16 v[42:43], v4 offset:29888
    ds_read_b64_tr_b16 v[44:45], v4 offset:33728
    ds_read_b64_tr_b16 v[46:47], v4 offset:34240
    ds_read_b64_tr_b16 v[48:49], v5 offset:8704
    ds_read_b64_tr_b16 v[50:51], v5 offset:9216
L_p0_t2:
    s_waitcnt lgkmcnt(0)
    s_waitcnt vmcnt(4) lgkmcnt(0)
    s_barrier
    s_add_u32 m0, s35, 135168
    s_add_u32 s34, s31, s35
    s_add_u32 s34, s34, 4096
    buffer_load_dwordx4 v1, s[4:7], s34 offen sc1 lds
    s_add_u32 m0, s30, 49152
    s_add_u32 s34, s29, 49152
    buffer_load_dwordx4 v1, s[4:7], s34 offen offset:0 sc1 lds
    buffer_load_dwordx4 v1, s[4:7], s34 offen offset:1024 sc1 lds
    buffer_load_dwordx4 v1, s[4:7], s34 offen offset:2048 sc1 lds
    buffer_load_dwordx4 v1, s[4:7], s34 offen offset:3072 sc1 lds
    s_waitcnt vmcnt(5) lgkmcnt(0)
    s_barrier
    s_add_u32 m0, s35, 139264
    s_add_u32 s34, s31, s35
    s_add_u32 s34, s34, 8192
    buffer_load_dwordx4 v1, s[4:7], s34 offen sc1 lds
    v_lshrrev_b32 v2, 8, v1
    v_bfe_u32 v3, v1, 7, 1
    v_bfe_u32 v4, v1, 4, 3
    v_cmp_gt_u32 vcc, 3, v2
    v_mul_u32_u24 v3, 80, v3
    v_lshl_add_u32 v3, v4, 3, v3
    v_lshrrev_b32 v5, 1, v4
    v_and_b32 v4, 1, v4
    v_lshl_add_u32 v4, v4, 3, 64
    v_cndmask_b32 v2, v5, v2, vcc
    v_cndmask_b32 v3, v4, v3, vcc
    v_mul_u32_u24 v2, 2304, v2
    v_add_u32 v0, v2, v3
    v_lshrrev_b32 v8, 1, v1
    s_mul_i32 s34, s24, 144
    s_add_u32 s34, s34, 0x4400000
    buffer_load_dwordx2 v[2:3], v0, s[4:7], s34 offen sc1
    s_mul_i32 s34, s24, 144
    s_add_u32 s34, s34, 0x4402000
    buffer_load_dwordx2 v[4:5], v0, s[4:7], s34 offen sc1
    s_mul_i32 s34, s24, 144
    s_add_u32 s34, s34, 0x4404000
    buffer_load_dwordx2 v[6:7], v0, s[4:7], s34 offen sc1
    s_mul_i32 s34, s24, 144
    s_add_u32 s34, s34, 0x4406000
    buffer_load_dwordx2 v[12:13], v0, s[4:7], s34 offen sc1
    s_add_u32 m0, s30, 65536
    s_add_u32 s34, s29, 65536
    buffer_load_dwordx4 v1, s[4:7], s34 offen offset:0 sc1 lds
    buffer_load_dwordx4 v1, s[4:7], s34 offen offset:1024 sc1 lds
    buffer_load_dwordx4 v1, s[4:7], s34 offen offset:2048 sc1 lds
    buffer_load_dwordx4 v1, s[4:7], s34 offen offset:3072 sc1 lds
    s_waitcnt vmcnt(9) lgkmcnt(0)
    s_barrier
    s_add_u32 m0, s30, 81920
    s_add_u32 s34, s29, 81920
    buffer_load_dwordx4 v1, s[4:7], s34 offen offset:0 sc1 lds
    buffer_load_dwordx4 v1, s[4:7], s34 offen offset:1024 sc1 lds
    buffer_load_dwordx4 v1, s[4:7], s34 offen offset:2048 sc1 lds
    buffer_load_dwordx4 v1, s[4:7], s34 offen offset:3072 sc1 lds
    s_waitcnt vmcnt(8)
    v_add_f32 v2, v2, v4
    v_add_f32 v3, v3, v5
    v_add_f32 v6, v6, v12
    v_add_f32 v7, v7, v13
    v_add_f32 v2, v2, v6
    v_add_f32 v3, v3, v7
    v_cmp_gt_u32 vcc, 864, v1
    v_add_u32 v8, 161792, v8
    s_nop 0
    v_cndmask_b32 v2, 0, v2, vcc
    v_cndmask_b32 v3, 0, v3, vcc
    ds_write_b64 v8, v[2:3]
    s_waitcnt vmcnt(4) lgkmcnt(0)
    s_barrier
    s_add_u32 m0, s35, 143360
    s_add_u32 s34, s31, s35
    s_add_u32 s34, s34, 12288
    buffer_load_dwordx4 v1, s[4:7], s34 offen sc1 lds
    s_add_u32 m0, s30, 98304
    s_add_u32 s34, s29, 98304
    buffer_load_dwordx4 v1, s[4:7], s34 offen offset:0 sc1 lds
    buffer_load_dwordx4 v1, s[4:7], s34 offen offset:1024 sc1 lds
    buffer_load_dwordx4 v1, s[4:7], s34 offen offset:2048 sc1 lds
    buffer_load_dwordx4 v1, s[4:7], s34 offen offset:3072 sc1 lds
    s_waitcnt vmcnt(5) lgkmcnt(0)
    s_barrier
    s_add_u32 m0, s36, 147456
    s_add_u32 s34, s31, s36
    s_add_u32 s34, s34, 16384
    buffer_load_dwordx4 v1, s[4:7], s34 offen sc1 lds
    s_add_u32 m0, s30, 114688
    s_add_u32 s34, s29, 114688
    buffer_load_dwordx4 v1, s[4:7], s34 offen offset:0 sc1 lds
    buffer_load_dwordx4 v1, s[4:7], s34 offen offset:1024 sc1 lds
    buffer_load_dwordx4 v1, s[4:7], s34 offen offset:2048 sc1 lds
    buffer_load_dwordx4 v1, s[4:7], s34 offen offset:3072 sc1 lds
    buffer_store_dwordx4 v[16:19], v9, s[4:7], s37 offen sc1
    buffer_store_dwordx4 v[20:23], v10, s[4:7], s38 offen sc1
    buffer_store_dwordx4 v[24:27], v9, s[4:7], s39 offen sc1
    buffer_store_dwordx4 v[28:31], v10, s[4:7], s40 offen sc1
    s_waitcnt vmcnt(9) lgkmcnt(0)
    s_barrier
    buffer_store_dwordx4 v[32:35], v9, s[4:7], s41 offen sc1
    buffer_store_dwordx4 v[36:39], v10, s[4:7], s42 offen sc1
    buffer_store_dwordx4 v[40:43], v9, s[4:7], s43 offen sc1
    s_waitcnt vmcnt(7) lgkmcnt(0)
    s_barrier
    s_mov_b32 s46, 0x4502000
    v_mov_b32 v4, 0
    s_mov_b32 s60, 65536
L_poll_wo:
    buffer_load_dword v5, v4, s[4:7], s46 offen sc1
    s_waitcnt vmcnt(0)
    v_cmp_gt_u32 vcc, 18, v5
    s_sub_u32 s60, s60, 1
    s_cbranch_scc1 L_pd_wo
    s_cbranch_vccz L_pd_wo
    s_sleep 4
    s_branch L_poll_wo
L_pd_wo:
    buffer_store_dwordx4 v[44:47], v10, s[4:7], s47 offen sc1
    buffer_store_dwordx4 v[48:51], v14, s[4:7], s48 offen sc1
    v_dot2_f32_bf16 v12, v16, v11, 0
    v_dot2_f32_bf16 v13, v17, v11, 0
    v_dot2_f32_bf16 v12, v18, v11, v12
    v_dot2_f32_bf16 v13, v19, v11, v13
    v_dot2_f32_bf16 v12, v20, v11, v12
    v_dot2_f32_bf16 v13, v21, v11, v13
    v_dot2_f32_bf16 v12, v22, v11, v12
    v_dot2_f32_bf16 v13, v23, v11, v13
    v_dot2_f32_bf16 v12, v24, v11, v12
    v_dot2_f32_bf16 v13, v25, v11, v13
    v_dot2_f32_bf16 v12, v26, v11, v12
    v_dot2_f32_bf16 v13, v27, v11, v13
    v_dot2_f32_bf16 v12, v28, v11, v12
    v_dot2_f32_bf16 v13, v29, v11, v13
    v_dot2_f32_bf16 v12, v30, v11, v12
    v_dot2_f32_bf16 v13, v31, v11, v13
    v_dot2_f32_bf16 v12, v32, v11, v12
    v_dot2_f32_bf16 v13, v33, v11, v13
    v_dot2_f32_bf16 v12, v34, v11, v12
    v_dot2_f32_bf16 v13, v35, v11, v13
    v_dot2_f32_bf16 v12, v36, v11, v12
    v_dot2_f32_bf16 v13, v37, v11, v13
    v_dot2_f32_bf16 v12, v38, v11, v12
    v_dot2_f32_bf16 v13, v39, v11, v13
    v_dot2_f32_bf16 v12, v40, v11, v12
    v_dot2_f32_bf16 v13, v41, v11, v13
    v_dot2_f32_bf16 v12, v42, v11, v12
    v_dot2_f32_bf16 v13, v43, v11, v13
    v_dot2_f32_bf16 v12, v44, v11, v12
    v_dot2_f32_bf16 v13, v45, v11, v13
    v_dot2_f32_bf16 v12, v46, v11, v12
    v_dot2_f32_bf16 v13, v47, v11, v13
    v_dot2_f32_bf16 v12, v48, v11, v12
    v_dot2_f32_bf16 v13, v49, v11, v13
    v_dot2_f32_bf16 v12, v50, v11, v12
    v_dot2_f32_bf16 v13, v51, v11, v13
    s_nop 2
    v_add_f32 v12, v12, v13
    v_mov_b32 v13, v12
    s_nop 1
    v_permlane32_swap_b32 v12, v13
    v_add_f32 v12, v12, v13
    v_mov_b32 v13, v12
    s_nop 1
    v_permlane16_swap_b32 v12, v13
    v_add_f32 v12, v12, v13
    buffer_store_dword v12, v15, s[4:7], s49 offen sc1
    s_barrier
L_m_ll:
    s_and_b32 s25, s2, 7
    s_lshr_b32 s26, s2, 3
    s_lshr_b32 s23, s25, 1
    s_lshl_b32 s23, s23, 3
    s_lshr_b32 s27, s26, 2
    s_add_u32 s23, s23, s27
    s_and_b32 s24, s25, 1
    s_lshl_b32 s24, s24, 2
    s_and_b32 s27, s26, 3
    s_add_u32 s24, s24, s27
    s_add_u32 s25, s23, s24
    s_and_b32 s25, s25, 3
    s_mul_i32 s29, s24, 82944
    s_add_u32 s29, s29, 0x3a00000
    s_mul_i32 s30, s20, 36864
    s_mul_i32 s31, s20, 18432
    s_add_u32 s31, s31, s29
    s_add_u32 m0, s30, 18432
    s_add_u32 s33, s31, 0
    buffer_load_dwordx4 v1, s[4:7], s33 offen offset:0  sc1 lds
    buffer_load_dwordx4 v1, s[4:7], s33 offen offset:1024  sc1 lds
    buffer_load_dwordx4 v1, s[4:7], s33 offen offset:2048  sc1 lds
    buffer_load_dwordx4 v1, s[4:7], s33 offen offset:3072  sc1 lds
    s_add_u32 m0, s30, 22528
    s_add_u32 s33, s31, 4096
    buffer_load_dwordx4 v1, s[4:7], s33 offen offset:0  sc1 lds
    buffer_load_dwordx4 v1, s[4:7], s33 offen offset:1024  sc1 lds
    buffer_load_dwordx4 v1, s[4:7], s33 offen offset:2048  sc1 lds
    buffer_load_dwordx4 v1, s[4:7], s33 offen offset:3072  sc1 lds
    s_add_u32 m0, s30, 26624
    s_add_u32 s33, s31, 8192
    buffer_load_dwordx4 v1, s[4:7], s33 offen offset:0  sc1 lds
    buffer_load_dwordx4 v1, s[4:7], s33 offen offset:1024  sc1 lds
    buffer_load_dwordx4 v1, s[4:7], s33 offen offset:2048  sc1 lds
    buffer_load_dwordx4 v1, s[4:7], s33 offen offset:3072  sc1 lds
    s_add_u32 m0, s30, 30720
    s_add_u32 s33, s31, 12288
    buffer_load_dwordx4 v1, s[4:7], s33 offen offset:0  sc1 lds
    buffer_load_dwordx4 v1, s[4:7], s33 offen offset:1024  sc1 lds
    buffer_load_dwordx4 v1, s[4:7], s33 offen offset:2048  sc1 lds
    buffer_load_dwordx4 v1, s[4:7], s33 offen offset:3072  sc1 lds
    s_add_u32 m0, s30, 34816
    s_add_u32 s33, s31, 16384
    buffer_load_dwordx4 v1, s[4:7], s33 offen offset:0  sc1 lds
    buffer_load_dwordx4 v1, s[4:7], s33 offen offset:1024  sc1 lds
    s_mul_i32 s30, s20, 3072
    s_add_u32 s31, s30, s29
    s_waitcnt vmcnt(18)
    s_barrier
    s_add_u32 m0, s30, 147456
    s_add_u32 s33, s31, 73728
    buffer_load_dwordx4 v1, s[4:7], s33 offen offset:0  sc1 lds
    buffer_load_dwordx4 v1, s[4:7], s33 offen offset:1024  sc1 lds
    buffer_load_dwordx4 v1, s[4:7], s33 offen offset:2048  sc1 lds
    s_or_b32 s44, s20, s22
    s_cbranch_scc1 L_p2_ns
    s_and_b32 s44, s2, 15
    s_lshl_b32 s44, s44, 8
    s_add_u32 s44, s44, 0x4501000
    s_add_u32 s44, s44, s4
    s_addc_u32 s45, s5, 0
    s_mov_b32 s56, 1
    s_atomic_add s56, s[44:45], 0
L_p2_ns:
    s_waitcnt vmcnt(0)
    s_barrier
    s_and_b32 s25, s2, 7
    s_lshr_b32 s26, s2, 3
    s_and_b32 s23, s25, 1
    s_lshl_b32 s23, s23, 3
    s_and_b32 s27, s26, 7
    s_add_u32 s23, s23, s27
    s_lshr_b32 s24, s25, 1
    s_lshl_b32 s24, s24, 2
    s_lshr_b32 s27, s26, 3
    s_add_u32 s24, s24, s27
    s_add_u32 s28, s23, s24
    s_and_b32 s28, s28, 3
    s_lshl_b32 s30, s20, 12
    s_lshr_b32 s33, s20, 1
    s_mul_i32 s31, s33, 36864
    s_and_b32 s33, s20, 1
    s_lshl_b32 s33, s33, 10
    s_add_u32 s33, s33, 16384
    s_add_u32 s31, s31, s33
    s_sub_u32 s49, s33, s30
    s_mul_i32 s34, s24, 331776
    s_add_u32 s34, s34, s30
    s_add_u32 s34, s34, 0x3b00000
    s_lshl_b32 s35, s23, 3
    s_lshl_b32 s33, s20, 1
    s_add_u32 s35, s35, s33
    s_mul_i32 s35, s35, 18432
    s_add_u32 s35, s35, s21
    s_add_u32 s35, s35, 0x300000
    s_mul_i32 s36, s24, 589824
    s_add_u32 s36, s36, s30
    s_add_u32 s36, s36, s21
    s_add_u32 s36, s36, 0x900000
    v_add_u32 v2, 16384, v1
    s_add_u32 s33, s30, 18432
    v_add_u32 v6, s33, v1
    v_add_u32 v7, 73728, v6
    s_lshl_b32 s29, s23, 2
    s_add_u32 s29, s29, s20
    s_lshl_b32 s29, s29, 12
    s_add_u32 s29, s29, s21
    s_add_u32 s29, s29, 0x1b40000
    v_and_b32 v3, 48, v1
    v_lshrrev_b32 v8, 8, v1
    v_lshl_add_u32 v3, v8, 6, v3
    v_bfe_u32 v8, v1, 6, 2
    v_lshl_add_u32 v3, v8, 8, v3
    s_lshl_b32 s33, s23, 7
    s_lshl_b32 s37, s20, 5
    s_add_u32 s33, s33, s37
    v_lshrrev_b32 v8, 7, v1
    v_add_u32 v8, s33, v8
    v_lshlrev_b32 v8, 12, v8
    v_lshrrev_b32 v9, 8, v1
    v_bfe_u32 v10, v1, 4, 3
    v_xor_b32 v9, v9, v10
    v_lshl_add_u32 v8, v9, 4, v8
    v_xor_b32 v9, 64, v8
    v_add_u32 v9, 31744, v9
    v_add_u32 v10, 63488, v8
    v_add_u32 v11, 63488, v9
    s_cmp_eq_u32 s28, 0
    s_cselect_b32 s44, 4, 0
    s_cmp_eq_u32 s28, 1
    s_cselect_b32 s45, 5, 1
    s_cmp_eq_u32 s28, 2
    s_cselect_b32 s46, 6, 2
    s_cmp_eq_u32 s28, 3
    s_cselect_b32 s47, 7, 3
    s_lshl_b32 s33, s20, 4
    s_add_u32 s33, s33, s24
    s_lshl_b32 s54, s22, 7
    s_add_u32 s54, s54, s33
    s_lshl_b32 s54, s54, 8
    s_add_u32 s54, s54, 0x450c000
    s_add_u32 s54, s54, s4
    s_addc_u32 s55, s5, 0
    s_mov_b32 s33, 0x4501000
    v_and_b32 v4, 0xf0, v1
    v_lshlrev_b32 v4, 4, v4
    s_mov_b32 s60, 65536
L_poll_wr:
    buffer_load_dword v5, v4, s[4:7], s33 offen sc1
    s_waitcnt vmcnt(0)
    v_cmp_gt_u32 vcc, 16, v5
    s_sub_u32 s60, s60, 1
    s_cbranch_scc1 L_pd_wr
    s_cbranch_vccz L_pd_wr
    s_sleep 4
    s_branch L_poll_wr
L_pd_wr:
    s_min_u32 s33, s20, 2
    s_lshl_b32 s33, s33, 9
    v_lshrrev_b32 v4, 1, v1
    v_add_u32 v4, s33, v4
    s_lshl_b32 s51, s24, 12
    s_add_u32 s51, s51, 0x4410000
    buffer_load_dwordx2 v[16:17], v4, s[4:7], s51 offen offset:0 sc1
    buffer_load_dwordx2 v[18:19], v4, s[4:7], s51 offen offset:1152 sc1
    s_mov_b32 s48, 0
    s_mul_i32 s50, s48, 18432
    s_add_u32 s50, s50, s34
    s_add_u32 m0, s30, 0
    s_mov_b32 s53, s50
    buffer_load_dwordx4 v1, s[4:7], s50 offen offset:0  sc1 lds
    buffer_load_dwordx4 v1, s[4:7], s50 offen offset:1024  sc1 lds
    buffer_load_dwordx4 v1, s[4:7], s50 offen offset:2048  sc1 lds
    buffer_load_dwordx4 v1, s[4:7], s50 offen offset:3072  sc1 lds
    s_mov_b32 s48, 1
    s_mul_i32 s50, s48, 18432
    s_add_u32 s50, s50, s34
    s_cmp_ge_u32 s20, 2
    s_cselect_b32 s52, s50, s53
    s_add_u32 m0, s31, 0
    s_add_u32 s52, s52, s49
    buffer_load_dwordx4 v1, s[4:7], s52 offen  sc1 lds
    s_add_u32 m0, s30, 36864
    s_mov_b32 s53, s50
    buffer_load_dwordx4 v1, s[4:7], s50 offen offset:0  sc1 lds
    buffer_load_dwordx4 v1, s[4:7], s50 offen offset:1024  sc1 lds
    buffer_load_dwordx4 v1, s[4:7], s50 offen offset:2048  sc1 lds
    buffer_load_dwordx4 v1, s[4:7], s50 offen offset:3072  sc1 lds
    s_mov_b32 m0, 161280
    v_lshrrev_b32 v5, 2, v1
    s_lshl_b32 s33, s23, 8
    buffer_load_dword v5, s[12:15], s33 offen lds
    s_waitcnt vmcnt(10)
    v_add_u32 v4, 159744, v4
    v_add_f32 v16, v16, v18
    v_add_f32 v17, v17, v19
    ds_write_b64 v4, v[16:17]
    s_waitcnt lgkmcnt(0)
    s_barrier
    s_mov_b32 s48, 2
    s_mul_i32 s50, s48, 18432
    s_add_u32 s50, s50, s34
    s_add_u32 m0, s30, 73728
    s_mov_b32 s53, s50
    buffer_load_dwordx4 v1, s[4:7], s50 offen offset:0  sc1 lds
    buffer_load_dwordx4 v1, s[4:7], s50 offen offset:1024  sc1 lds
    buffer_load_dwordx4 v1, s[4:7], s50 offen offset:2048  sc1 lds
    buffer_load_dwordx4 v1, s[4:7], s50 offen offset:3072  sc1 lds
    s_mov_b32 s48, 3
    s_mul_i32 s50, s48, 18432
    s_add_u32 s50, s50, s34
    s_cmp_ge_u32 s20, 2
    s_cselect_b32 s52, s50, s53
    s_add_u32 m0, s31, 73728
    s_add_u32 s52, s52, s49
    buffer_load_dwordx4 v1, s[4:7], s52 offen  sc1 lds
    s_add_u32 m0, s30, 110592
    s_mov_b32 s53, s50
    buffer_load_dwordx4 v1, s[4:7], s50 offen offset:0  sc1 lds
    buffer_load_dwordx4 v1, s[4:7], s50 offen offset:1024  sc1 lds
    buffer_load_dwordx4 v1, s[4:7], s50 offen offset:2048  sc1 lds
    buffer_load_dwordx4 v1, s[4:7], s50 offen offset:3072  sc1 lds
    s_barrier
    s_add_u32 m0, s30, 18432
    s_add_u32 s51, s35, 0
    buffer_load_dwordx4 v1, s[4:7], s51 offen offset:0 sc1 lds
    buffer_load_dwordx4 v1, s[4:7], s51 offen offset:1024 sc1 lds
    buffer_load_dwordx4 v2, s[4:7], s51 offen offset:2048 sc1 lds
    buffer_load_dwordx4 v2, s[4:7], s51 offen offset:3072 sc1 lds
    s_add_u32 m0, s30, 55296
    s_add_u32 s51, s35, 2048
    buffer_load_dwordx4 v1, s[4:7], s51 offen offset:0 sc1 lds
    buffer_load_dwordx4 v1, s[4:7], s51 offen offset:1024 sc1 lds
    buffer_load_dwordx4 v2, s[4:7], s51 offen offset:2048 sc1 lds
    buffer_load_dwordx4 v2, s[4:7], s51 offen offset:3072 sc1 lds
    s_add_u32 m0, s30, 92160
    s_add_u32 s51, s35, 4096
    buffer_load_dwordx4 v1, s[4:7], s51 offen offset:0 sc1 lds
    buffer_load_dwordx4 v1, s[4:7], s51 offen offset:1024 sc1 lds
    buffer_load_dwordx4 v2, s[4:7], s51 offen offset:2048 sc1 lds
    buffer_load_dwordx4 v2, s[4:7], s51 offen offset:3072 sc1 lds
    s_waitcnt vmcnt(8)
    s_barrier
    s_add_u32 m0, s30, 129024
    s_add_u32 s51, s35, 6144
    buffer_load_dwordx4 v1, s[4:7], s51 offen offset:0 sc1 lds
    buffer_load_dwordx4 v1, s[4:7], s51 offen offset:1024 sc1 lds
    buffer_load_dwordx4 v2, s[4:7], s51 offen offset:2048 sc1 lds
    buffer_load_dwordx4 v2, s[4:7], s51 offen offset:3072 sc1 lds
    s_and_b32 s40, s2, 7
    s_lshr_b32 s26, s2, 3
    s_lshr_b32 s38, s40, 1
    s_lshl_b32 s38, s38, 3
    s_lshr_b32 s27, s26, 2
    s_add_u32 s38, s38, s27
    s_and_b32 s39, s40, 1
    s_lshl_b32 s39, s39, 2
    s_and_b32 s27, s26, 3
    s_add_u32 s39, s39, s27
    s_add_u32 s40, s38, s39
    s_and_b32 s40, s40, 3
    s_mul_i32 s42, s20, 9216
    s_mul_i32 s43, s39, 331776
    s_add_u32 s43, s43, s42
    s_add_u32 s43, s43, 0x4100000
    s_waitcnt vmcnt(8) lgkmcnt(0)
    s_barrier
    s_mov_b32 s48, 4
    s_mul_i32 s50, s48, 18432
    s_add_u32 s50, s50, s34
    s_add_u32 m0, s30, 0
    s_mov_b32 s53, s50
    buffer_load_dwordx4 v1, s[4:7], s50 offen offset:0  sc1 lds
    buffer_load_dwordx4 v1, s[4:7], s50 offen offset:1024  sc1 lds
    buffer_load_dwordx4 v1, s[4:7], s50 offen offset:2048  sc1 lds
    buffer_load_dwordx4 v1, s[4:7], s50 offen offset:3072  sc1 lds
    s_add_u32 m0, s30, 18432
    s_add_u32 s51, s35, 8192
    buffer_load_dwordx4 v1, s[4:7], s51 offen offset:0 sc1 lds
    buffer_load_dwordx4 v1, s[4:7], s51 offen offset:1024 sc1 lds
    buffer_load_dwordx4 v2, s[4:7], s51 offen offset:2048 sc1 lds
    buffer_load_dwordx4 v2, s[4:7], s51 offen offset:3072 sc1 lds
    s_waitcnt vmcnt(12) lgkmcnt(0)
    s_barrier
    s_mov_b32 s48, 5
    s_mul_i32 s50, s48, 18432
    s_add_u32 s50, s50, s34
    s_cmp_ge_u32 s20, 2
    s_cselect_b32 s52, s50, s53
    s_add_u32 m0, s31, 0
    s_add_u32 s52, s52, s49
    buffer_load_dwordx4 v1, s[4:7], s52 offen  sc1 lds
    s_add_u32 m0, s30, 36864
    s_mov_b32 s53, s50
    buffer_load_dwordx4 v1, s[4:7], s50 offen offset:0  sc1 lds
    buffer_load_dwordx4 v1, s[4:7], s50 offen offset:1024  sc1 lds
    buffer_load_dwordx4 v1, s[4:7], s50 offen offset:2048  sc1 lds
    buffer_load_dwordx4 v1, s[4:7], s50 offen offset:3072  sc1 lds
    s_add_u32 m0, s30, 55296
    s_add_u32 s51, s35, 10240
    buffer_load_dwordx4 v1, s[4:7], s51 offen offset:0 sc1 lds
    buffer_load_dwordx4 v1, s[4:7], s51 offen offset:1024 sc1 lds
    buffer_load_dwordx4 v2, s[4:7], s51 offen offset:2048 sc1 lds
    buffer_load_dwordx4 v2, s[4:7], s51 offen offset:3072 sc1 lds
    s_waitcnt vmcnt(17) lgkmcnt(0)
    s_barrier
    s_mov_b32 s48, 6
    s_mul_i32 s50, s48, 18432
    s_add_u32 s50, s50, s34
    s_add_u32 m0, s30, 73728
    s_mov_b32 s53, s50
    buffer_load_dwordx4 v1, s[4:7], s50 offen offset:0  sc1 lds
    buffer_load_dwordx4 v1, s[4:7], s50 offen offset:1024  sc1 lds
    buffer_load_dwordx4 v1, s[4:7], s50 offen offset:2048  sc1 lds
    buffer_load_dwordx4 v1, s[4:7], s50 offen offset:3072  sc1 lds
    s_add_u32 m0, s30, 92160
    s_add_u32 s51, s35, 12288
    buffer_load_dwordx4 v1, s[4:7], s51 offen offset:0 sc1 lds
    buffer_load_dwordx4 v1, s[4:7], s51 offen offset:1024 sc1 lds
    buffer_load_dwordx4 v2, s[4:7], s51 offen offset:2048 sc1 lds
    buffer_load_dwordx4 v2, s[4:7], s51 offen offset:3072 sc1 lds
    s_waitcnt vmcnt(16) lgkmcnt(0)
    s_barrier
    s_mov_b32 s48, 7
    s_mul_i32 s50, s48, 18432
    s_add_u32 s50, s50, s34
    s_cmp_ge_u32 s20, 2
    s_cselect_b32 s52, s50, s53
    s_add_u32 m0, s31, 73728
    s_add_u32 s52, s52, s49
    buffer_load_dwordx4 v1, s[4:7], s52 offen  sc1 lds
    s_add_u32 m0, s30, 110592
    s_mov_b32 s53, s50
    buffer_load_dwordx4 v1, s[4:7], s50 offen offset:0  sc1 lds
    buffer_load_dwordx4 v1, s[4:7], s50 offen offset:1024  sc1 lds
    buffer_load_dwordx4 v1, s[4:7], s50 offen offset:2048  sc1 lds
    buffer_load_dwordx4 v1, s[4:7], s50 offen offset:3072  sc1 lds
    s_add_u32 m0, s30, 129024
    s_add_u32 s51, s35, 14336
    buffer_load_dwordx4 v1, s[4:7], s51 offen offset:0 sc1 lds
    buffer_load_dwordx4 v1, s[4:7], s51 offen offset:1024 sc1 lds
    buffer_load_dwordx4 v2, s[4:7], s51 offen offset:2048 sc1 lds
    buffer_load_dwordx4 v2, s[4:7], s51 offen offset:3072 sc1 lds
    s_waitcnt vmcnt(17) lgkmcnt(0)
    s_barrier
    s_mov_b32 s48, 8
    s_mul_i32 s50, s48, 18432
    s_add_u32 s50, s50, s34
    s_add_u32 m0, s30, 0
    s_mov_b32 s53, s50
    buffer_load_dwordx4 v1, s[4:7], s50 offen offset:0  sc1 lds
    buffer_load_dwordx4 v1, s[4:7], s50 offen offset:1024  sc1 lds
    buffer_load_dwordx4 v1, s[4:7], s50 offen offset:2048  sc1 lds
    buffer_load_dwordx4 v1, s[4:7], s50 offen offset:3072  sc1 lds
    s_add_u32 m0, s30, 18432
    s_add_u32 s51, s35, 16384
    buffer_load_dwordx4 v1, s[4:7], s51 offen offset:0 sc1 lds
    buffer_load_dwordx4 v1, s[4:7], s51 offen offset:1024 sc1 lds
    buffer_load_dwordx4 v2, s[4:7], s51 offen offset:2048 sc1 lds
    buffer_load_dwordx4 v2, s[4:7], s51 offen offset:3072 sc1 lds
    s_waitcnt vmcnt(16) lgkmcnt(0)
    s_barrier
    s_mov_b32 s48, 5
    s_mul_i32 s50, s48, 18432
    s_add_u32 s50, s50, s34
    s_add_u32 s50, s50, 165888
    s_cmp_ge_u32 s20, 2
    s_cselect_b32 s52, s50, s53
    s_add_u32 m0, s31, 0
    s_add_u32 s52, s52, s49
    buffer_load_dwordx4 v1, s[4:7], s52 offen  sc1 lds
    s_add_u32 m0, s30, 36864
    s_mov_b32 s53, s50
    buffer_load_dwordx4 v1, s[4:7], s50 offen offset:0  sc1 lds
    buffer_load_dwordx4 v1, s[4:7], s50 offen offset:1024  sc1 lds
    buffer_load_dwordx4 v1, s[4:7], s50 offen offset:2048  sc1 lds
    buffer_load_dwordx4 v1, s[4:7], s50 offen offset:3072  sc1 lds
    s_cmp_lg_u32 s22, 0
    s_cbranch_scc1 L_p5_k6
    s_add_u32 s32, s43, 294912
    buffer_load_dwordx4 v[220:223], v1, s[4:7], s32 offen offset:0 sc1
    buffer_load_dwordx4 v[224:227], v1, s[4:7], s32 offen offset:1024 sc1
    buffer_load_dwordx4 v[228:231], v1, s[4:7], s32 offen offset:2048 sc1
    buffer_load_dwordx4 v[232:235], v1, s[4:7], s32 offen offset:3072 sc1
    s_add_u32 s32, s43, 299008
    buffer_load_dwordx4 v[236:239], v1, s[4:7], s32 offen offset:0 sc1
L_p5_k6:
    s_waitcnt vmcnt(18) lgkmcnt(0)
    s_cmp_eq_u32 s22, 0
    s_cbranch_scc1 L_wv_926
    s_waitcnt vmcnt(13)
L_wv_926:
    s_barrier
    s_mov_b32 s48, 6
    s_mul_i32 s50, s48, 18432
    s_add_u32 s50, s50, s34
    s_add_u32 s50, s50, 165888
    s_add_u32 m0, s30, 73728
    s_mov_b32 s53, s50
    buffer_load_dwordx4 v1, s[4:7], s50 offen offset:0  sc1 lds
    buffer_load_dwordx4 v1, s[4:7], s50 offen offset:1024  sc1 lds
    buffer_load_dwordx4 v1, s[4:7], s50 offen offset:2048  sc1 lds
    buffer_load_dwordx4 v1, s[4:7], s50 offen offset:3072  sc1 lds
    s_cmp_lg_u32 s22, 0
    s_cbranch_scc1 L_p5_k7
    s_add_u32 s32, s43, 299008
    buffer_load_dwordx4 v[240:243], v1, s[4:7], s32 offen offset:1024 sc1
    buffer_load_dwordx4 v[244:247], v1, s[4:7], s32 offen offset:2048 sc1
    buffer_load_dwordx4 v[248:251], v1, s[4:7], s32 offen offset:3072 sc1
    s_add_u32 s32, s43, 303104
    buffer_load_dwordx4 v[252:255], v1, s[4:7], s32 offen offset:0 sc1
    s_add_u32 s32, s43, 258048
    buffer_load_dwordx4 v[184:187], v1, s[4:7], s32 offen offset:0 sc1
L_p5_k7:
    s_waitcnt vmcnt(18) lgkmcnt(0)
    s_cmp_eq_u32 s22, 0
    s_cbranch_scc1 L_wv_953
    s_waitcnt vmcnt(8)
L_wv_953:
    s_barrier
    s_mov_b32 s48, 7
    s_mul_i32 s50, s48, 18432
    s_add_u32 s50, s50, s34
    s_add_u32 s50, s50, 165888
    s_cmp_ge_u32 s20, 2
    s_cselect_b32 s52, s50, s53
    s_add_u32 m0, s31, 73728
    s_add_u32 s52, s52, s49
    buffer_load_dwordx4 v1, s[4:7], s52 offen  sc1 lds
    s_add_u32 m0, s30, 110592
    s_mov_b32 s53, s50
    buffer_load_dwordx4 v1, s[4:7], s50 offen offset:0  sc1 lds
    buffer_load_dwordx4 v1, s[4:7], s50 offen offset:1024  sc1 lds
    buffer_load_dwordx4 v1, s[4:7], s50 offen offset:2048  sc1 lds
    buffer_load_dwordx4 v1, s[4:7], s50 offen offset:3072  sc1 lds
    s_cmp_lg_u32 s22, 0
    s_cbranch_scc1 L_p5_k8
    s_add_u32 s32, s43, 258048
    buffer_load_dwordx4 v[188:191], v1, s[4:7], s32 offen offset:1024 sc1
    buffer_load_dwordx4 v[192:195], v1, s[4:7], s32 offen offset:2048 sc1
    buffer_load_dwordx4 v[196:199], v1, s[4:7], s32 offen offset:3072 sc1
    s_add_u32 s32, s43, 262144
    buffer_load_dwordx4 v[200:203], v1, s[4:7], s32 offen offset:0 sc1
    buffer_load_dwordx4 v[204:207], v1, s[4:7], s32 offen offset:1024 sc1
L_p5_k8:
    s_waitcnt vmcnt(24) lgkmcnt(0)
    s_cmp_eq_u32 s22, 0
    s_cbranch_scc1 L_wv_984
    s_waitcnt vmcnt(9)
L_wv_984:
    s_barrier
    s_mov_b32 s48, 8
    s_mul_i32 s50, s48, 18432
    s_add_u32 s50, s50, s34
    s_add_u32 s50, s50, 165888
    s_add_u32 m0, s30, 0
    s_mov_b32 s53, s50
    buffer_load_dwordx4 v1, s[4:7], s50 offen offset:0  sc1 lds
    buffer_load_dwordx4 v1, s[4:7], s50 offen offset:1024  sc1 lds
    buffer_load_dwordx4 v1, s[4:7], s50 offen offset:2048  sc1 lds
    buffer_load_dwordx4 v1, s[4:7], s50 offen offset:3072  sc1 lds
    s_cmp_lg_u32 s22, 0
    s_cbranch_scc1 L_p5_k9
    s_add_u32 s32, s43, 262144
    buffer_load_dwordx4 v[208:211], v1, s[4:7], s32 offen offset:2048 sc1
    buffer_load_dwordx4 v[212:215], v1, s[4:7], s32 offen offset:3072 sc1
    s_add_u32 s32, s43, 266240
    buffer_load_dwordx4 v[216:219], v1, s[4:7], s32 offen offset:0 sc1
    s_add_u32 s32, s43, 221184
    buffer_load_dwordx4 v[148:151], v1, s[4:7], s32 offen offset:0 sc1
    buffer_load_dwordx4 v[152:155], v1, s[4:7], s32 offen offset:1024 sc1
    buffer_load_dwordx4 v[156:159], v1, s[4:7], s32 offen offset:2048 sc1
    buffer_load_dwordx4 v[160:163], v1, s[4:7], s32 offen offset:3072 sc1
    s_add_u32 s32, s43, 225280
    buffer_load_dwordx4 v[164:167], v1, s[4:7], s32 offen offset:0 sc1
    buffer_load_dwordx4 v[168:171], v1, s[4:7], s32 offen offset:1024 sc1
    buffer_load_dwordx4 v[172:175], v1, s[4:7], s32 offen offset:2048 sc1
    buffer_load_dwordx4 v[176:179], v1, s[4:7], s32 offen offset:3072 sc1
    s_add_u32 s32, s43, 229376
    buffer_load_dwordx4 v[180:183], v1, s[4:7], s32 offen offset:0 sc1
    s_add_u32 s32, s43, 184320
    buffer_load_dwordx4 v[112:115], v1, s[4:7], s32 offen offset:0 sc1
    buffer_load_dwordx4 v[116:119], v1, s[4:7], s32 offen offset:1024 sc1
    buffer_load_dwordx4 v[120:123], v1, s[4:7], s32 offen offset:2048 sc1
    buffer_load_dwordx4 v[124:127], v1, s[4:7], s32 offen offset:3072 sc1
    s_add_u32 s32, s43, 188416
    buffer_load_dwordx4 v[128:131], v1, s[4:7], s32 offen offset:0 sc1
    buffer_load_dwordx4 v[132:135], v1, s[4:7], s32 offen offset:1024 sc1
    buffer_load_dwordx4 v[136:139], v1, s[4:7], s32 offen offset:2048 sc1
    buffer_load_dwordx4 v[140:143], v1, s[4:7], s32 offen offset:3072 sc1
    s_add_u32 s32, s43, 192512
    buffer_load_dwordx4 v[144:147], v1, s[4:7], s32 offen offset:0 sc1
    s_add_u32 s32, s43, 147456
    buffer_load_dwordx4 v[76:79], v1, s[4:7], s32 offen offset:0 sc1
    buffer_load_dwordx4 v[80:83], v1, s[4:7], s32 offen offset:1024 sc1
    buffer_load_dwordx4 v[84:87], v1, s[4:7], s32 offen offset:2048 sc1
    buffer_load_dwordx4 v[88:91], v1, s[4:7], s32 offen offset:3072 sc1
    s_add_u32 s32, s43, 151552
    buffer_load_dwordx4 v[92:95], v1, s[4:7], s32 offen offset:0 sc1
    buffer_load_dwordx4 v[96:99], v1, s[4:7], s32 offen offset:1024 sc1
    buffer_load_dwordx4 v[100:103], v1, s[4:7], s32 offen offset:2048 sc1
    buffer_load_dwordx4 v[104:107], v1, s[4:7], s32 offen offset:3072 sc1
    s_add_u32 s32, s43, 155648
    buffer_load_dwordx4 v[108:111], v1, s[4:7], s32 offen offset:0 sc1
L_p5_k9:
    s_waitcnt vmcnt(43) lgkmcnt(0)
    s_cmp_eq_u32 s22, 0
    s_cbranch_scc1 L_wv_1044
    s_waitcnt vmcnt(8)
L_wv_1044:
    s_barrier
    s_mov_b32 s48, 0
    s_mul_i32 s50, s48, 18432
    s_add_u32 s50, s50, s34
    s_add_u32 s50, s50, 165888
    s_cmp_ge_u32 s20, 2
    s_cselect_b32 s52, s50, s53
    s_add_u32 m0, s31, 0
    s_add_u32 s52, s52, s49
    buffer_load_dwordx4 v1, s[4:7], s52 offen  sc1 lds
    s_add_u32 m0, s30, 36864
    s_mov_b32 s53, s50
    buffer_load_dwordx4 v1, s[4:7], s50 offen offset:0  sc1 lds
    buffer_load_dwordx4 v1, s[4:7], s50 offen offset:1024  sc1 lds
    buffer_load_dwordx4 v1, s[4:7], s50 offen offset:2048  sc1 lds
    buffer_load_dwordx4 v1, s[4:7], s50 offen offset:3072  sc1 lds
    s_add_u32 m0, s30, 55296
    s_add_u32 s51, s35, 0
    buffer_load_dwordx4 v1, s[4:7], s51 offen offset:0 sc1 lds
    buffer_load_dwordx4 v1, s[4:7], s51 offen offset:1024 sc1 lds
    buffer_load_dwordx4 v2, s[4:7], s51 offen offset:2048 sc1 lds
    buffer_load_dwordx4 v2, s[4:7], s51 offen offset:3072 sc1 lds
    s_waitcnt vmcnt(48) lgkmcnt(0)
    s_cmp_eq_u32 s22, 0
    s_cbranch_scc1 L_wv_1071
    s_waitcnt vmcnt(13)
L_wv_1071:
    s_barrier
    buffer_load_dwordx4 v[16:19], v3, s[4:7], s29 offen offset:0 sc1
    buffer_load_dwordx4 v[20:23], v3, s[4:7], s29 offen offset:1024 sc1
    buffer_load_dwordx4 v[24:27], v3, s[4:7], s29 offen offset:2048 sc1
    buffer_load_dwordx4 v[28:31], v3, s[4:7], s29 offen offset:3072 sc1
    s_mov_b32 s48, 1
    s_mul_i32 s50, s48, 18432
    s_add_u32 s50, s50, s34
    s_add_u32 s50, s50, 165888
    s_add_u32 m0, s30, 73728
    s_mov_b32 s53, s50
    buffer_load_dwordx4 v1, s[4:7], s50 offen offset:0  sc1 lds
    buffer_load_dwordx4 v1, s[4:7], s50 offen offset:1024  sc1 lds
    buffer_load_dwordx4 v1, s[4:7], s50 offen offset:2048  sc1 lds
    buffer_load_dwordx4 v1, s[4:7], s50 offen offset:3072  sc1 lds
    s_add_u32 m0, s30, 92160
    s_add_u32 s51, s35, 2048
    buffer_load_dwordx4 v1, s[4:7], s51 offen offset:0 sc1 lds
    buffer_load_dwordx4 v1, s[4:7], s51 offen offset:1024 sc1 lds
    buffer_load_dwordx4 v2, s[4:7], s51 offen offset:2048 sc1 lds
    buffer_load_dwordx4 v2, s[4:7], s51 offen offset:3072 sc1 lds
    s_waitcnt vmcnt(20) lgkmcnt(0)
    s_barrier
    s_mov_b32 s48, 2
    s_mul_i32 s50, s48, 18432
    s_add_u32 s50, s50, s34
    s_add_u32 s50, s50, 165888
    s_cmp_ge_u32 s20, 2
    s_cselect_b32 s52, s50, s53
    s_add_u32 m0, s31, 73728
    s_add_u32 s52, s52, s49
    buffer_load_dwordx4 v1, s[4:7], s52 offen  sc1 lds
    s_add_u32 m0, s30, 110592
    s_mov_b32 s53, s50
    buffer_load_dwordx4 v1, s[4:7], s50 offen offset:0  sc1 lds
    buffer_load_dwordx4 v1, s[4:7], s50 offen offset:1024  sc1 lds
    buffer_load_dwordx4 v1, s[4:7], s50 offen offset:2048  sc1 lds
    buffer_load_dwordx4 v1, s[4:7], s50 offen offset:3072  sc1 lds
    s_add_u32 m0, s30, 129024
    s_add_u32 s51, s35, 4096
    buffer_load_dwordx4 v1, s[4:7], s51 offen offset:0 sc1 lds
    buffer_load_dwordx4 v1, s[4:7], s51 offen offset:1024 sc1 lds
    buffer_load_dwordx4 v2, s[4:7], s51 offen offset:2048 sc1 lds
    buffer_load_dwordx4 v2, s[4:7], s51 offen offset:3072 sc1 lds
    s_mov_b32 s60, 65536
    s_waitcnt vmcnt(17)
L_g_chk:
    v_or3_b32 v32, v17, v19, v21
    v_or3_b32 v33, v23, v25, v27
    v_or3_b32 v32, v29, v31, v32
    v_or_b32 v32, v32, v33
    v_cmp_gt_i32 vcc, 0, v32
    s_sub_u32 s60, s60, 1
    s_cbranch_scc1 L_g_ok
    s_cbranch_vccz L_g_ok
    buffer_load_dwordx4 v[16:19], v3, s[4:7], s29 offen offset:0 sc1
    buffer_load_dwordx4 v[20:23], v3, s[4:7], s29 offen offset:1024 sc1
    buffer_load_dwordx4 v[24:27], v3, s[4:7], s29 offen offset:2048 sc1
    buffer_load_dwordx4 v[28:31], v3, s[4:7], s29 offen offset:3072 sc1
    s_waitcnt vmcnt(0)
    s_branch L_g_chk
L_g_ok:
    v_add_f32 v16, v16, v20
    v_add_f32 v24, v24, v28
    v_add_f32 v17, v17, v21
    v_add_f32 v25, v25, v29
    v_add_f32 v18, v18, v22
    v_add_f32 v26, v26, v30
    v_add_f32 v19, v19, v23
    v_add_f32 v27, v27, v31
    v_add_f32 v16, v16, v24
    v_add_f32 v17, v17, v25
    v_add_f32 v18, v18, v26
    v_add_f32 v19, v19, v27
    v_add_f32_dpp v16, v16, v16 row_ror:4 row_mask:0xf bank_mask:0xf
    v_add_f32_dpp v17, v17, v17 row_ror:4 row_mask:0xf bank_mask:0xf
    v_add_f32_dpp v18, v18, v18 row_ror:4 row_mask:0xf bank_mask:0xf
    v_add_f32_dpp v19, v19, v19 row_ror:4 row_mask:0xf bank_mask:0xf
    v_add_f32_dpp v16, v16, v16 row_ror:8 row_mask:0xf bank_mask:0xf
    v_add_f32_dpp v17, v17, v17 row_ror:8 row_mask:0xf bank_mask:0xf
    v_add_f32_dpp v18, v18, v18 row_ror:8 row_mask:0xf bank_mask:0xf
    v_add_f32_dpp v19, v19, v19 row_ror:8 row_mask:0xf bank_mask:0xf
    v_mul_f32 v16, 0x39e38e39, v16
    v_mul_f32 v17, 0x39e38e39, v17
    v_mul_f32 v18, 0x39e38e39, v18
    v_mul_f32 v19, 0x39e38e39, v19
    v_fma_f32 v17, -v16, v16, v17
    v_fma_f32 v19, -v18, v18, v19
    v_max_f32 v17, 0, v17
    v_max_f32 v19, 0, v19
    v_add_f32 v17, 0x3727c5ac, v17
    v_add_f32 v19, 0x3727c5ac, v19
    v_rsq_f32 v20, v17
    v_rsq_f32 v21, v19
    v_and_b32 v32, 0xff, v3
    s_lshl_b32 s33, s20, 8
    s_add_u32 s33, s33, 148480
    v_add_u32 v32, s33, v32
    v_mul_f32 v22, v16, v20
    v_mul_f32 v23, v18, v21
    ds_write_b128 v32, v[20:23]
    s_waitcnt vmcnt(17) lgkmcnt(0)
    s_barrier
    s_mov_b32 s48, 3
    s_mul_i32 s50, s48, 18432
    s_add_u32 s50, s50, s34
    s_add_u32 s50, s50, 165888
    s_add_u32 m0, s30, 0
    s_mov_b32 s53, s50
    buffer_load_dwordx4 v1, s[4:7], s50 offen offset:0  sc1 lds
    buffer_load_dwordx4 v1, s[4:7], s50 offen offset:1024  sc1 lds
    buffer_load_dwordx4 v1, s[4:7], s50 offen offset:2048  sc1 lds
    buffer_load_dwordx4 v1, s[4:7], s50 offen offset:3072  sc1 lds
    s_add_u32 m0, s30, 18432
    s_add_u32 s51, s35, 6144
    buffer_load_dwordx4 v1, s[4:7], s51 offen offset:0 sc1 lds
    buffer_load_dwordx4 v1, s[4:7], s51 offen offset:1024 sc1 lds
    buffer_load_dwordx4 v2, s[4:7], s51 offen offset:2048 sc1 lds
    buffer_load_dwordx4 v2, s[4:7], s51 offen offset:3072 sc1 lds
    s_waitcnt vmcnt(16) lgkmcnt(0)
    s_barrier
    s_mov_b32 s48, 4
    s_mul_i32 s50, s48, 18432
    s_add_u32 s50, s50, s34
    s_add_u32 s50, s50, 165888
    s_cmp_ge_u32 s20, 2
    s_cselect_b32 s52, s50, s53
    s_add_u32 m0, s31, 0
    s_add_u32 s52, s52, s49
    buffer_load_dwordx4 v1, s[4:7], s52 offen  sc1 lds
    s_add_u32 m0, s30, 36864
    s_mov_b32 s53, s50
    buffer_load_dwordx4 v1, s[4:7], s50 offen offset:0  sc1 lds
    buffer_load_dwordx4 v1, s[4:7], s50 offen offset:1024  sc1 lds
    buffer_load_dwordx4 v1, s[4:7], s50 offen offset:2048  sc1 lds
    buffer_load_dwordx4 v1, s[4:7], s50 offen offset:3072  sc1 lds
    s_add_u32 m0, s30, 55296
    s_add_u32 s51, s35, 8192
    buffer_load_dwordx4 v1, s[4:7], s51 offen offset:0 sc1 lds
    buffer_load_dwordx4 v1, s[4:7], s51 offen offset:1024 sc1 lds
    buffer_load_dwordx4 v2, s[4:7], s51 offen offset:2048 sc1 lds
    buffer_load_dwordx4 v2, s[4:7], s51 offen offset:3072 sc1 lds
    s_waitcnt vmcnt(17) lgkmcnt(0)
    s_barrier
    s_waitcnt vmcnt(8) lgkmcnt(0)
    s_barrier
    s_waitcnt vmcnt(0) lgkmcnt(0)
    s_barrier
    s_barrier
    s_mov_b32 s56, 1
    s_atomic_add s56, s[54:55], 0
    s_mov_b32 s57, 0
    s_atomic_add s57, s[54:55], 0 glc
    s_lshl_b32 s48, s23, 1
    s_add_u32 s48, s48, 0
    s_add_u32 m0, s30, 92160
    s_lshl_b32 s51, s48, 7
    buffer_load_dwordx4 v8, s[8:11], s51 offen offset:0  lds
    buffer_load_dwordx4 v9, s[8:11], s51 offen offset:1024  lds
    buffer_load_dwordx4 v10, s[8:11], s51 offen offset:2048  lds
    buffer_load_dwordx4 v11, s[8:11], s51 offen offset:3072  lds
    s_lshl_b32 s48, s23, 1
    s_add_u32 s48, s48, 1
    s_add_u32 m0, s30, 129024
    s_lshl_b32 s51, s48, 7
    buffer_load_dwordx4 v8, s[8:11], s51 offen offset:0  lds
    buffer_load_dwordx4 v9, s[8:11], s51 offen offset:1024  lds
    buffer_load_dwordx4 v10, s[8:11], s51 offen offset:2048  lds
    buffer_load_dwordx4 v11, s[8:11], s51 offen offset:3072  lds
    s_lshr_b32 s48, s46, 1
    s_cmp_eq_u32 s48, s23
    s_cselect_b32 s48, 1, 31
    s_and_b32 s48, s48, s46
    s_add_u32 m0, s30, 18432
    s_lshl_b32 s51, s48, 7
    buffer_load_dwordx4 v8, s[8:11], s51 offen offset:0  lds
    buffer_load_dwordx4 v9, s[8:11], s51 offen offset:1024  lds
    buffer_load_dwordx4 v10, s[8:11], s51 offen offset:2048  lds
    buffer_load_dwordx4 v11, s[8:11], s51 offen offset:3072  lds
    s_waitcnt lgkmcnt(0)
    s_cmp_ge_u32 s57, 16
    s_cbranch_scc1 L_g_r0
    s_mov_b32 s57, 0
    s_atomic_add s57, s[54:55], 0 glc
    s_waitcnt vmcnt(8)
    s_barrier
    s_waitcnt lgkmcnt(0)
    s_cmp_ge_u32 s57, 16
    s_cbranch_scc1 L_g_r1
    s_waitcnt vmcnt(4)
    s_barrier
    s_mov_b32 s60, 65536
L_poll_z2:
    s_mov_b32 s57, 0
    s_atomic_add s57, s[54:55], 0 glc
    s_waitcnt lgkmcnt(0)
    s_cmp_ge_u32 s57, 16
    s_cbranch_scc1 L_pd_z2
    s_sub_u32 s60, s60, 1
    s_cbranch_scc1 L_pd_z2
    s_sleep 2
    s_branch L_poll_z2
L_pd_z2:
    s_lshr_b32 s48, s46, 1
    s_cmp_eq_u32 s48, s23
    s_cselect_b32 s48, 1, 31
    s_and_b32 s48, s48, s46
    s_mul_i32 s50, s48, 18432
    s_add_u32 s50, s50, s36
    s_add_u32 m0, s30, 0
    s_mov_b32 s53, s50
    buffer_load_dwordx4 v1, s[4:7], s50 offen offset:0 sc1 lds
    buffer_load_dwordx4 v1, s[4:7], s50 offen offset:1024 sc1 lds
    buffer_load_dwordx4 v1, s[4:7], s50 offen offset:2048 sc1 lds
    buffer_load_dwordx4 v1, s[4:7], s50 offen offset:3072 sc1 lds
    s_lshr_b32 s48, s47, 1
    s_cmp_eq_u32 s48, s23
    s_cselect_b32 s48, 1, 31
    s_and_b32 s48, s48, s47
    s_mul_i32 s50, s48, 18432
    s_add_u32 s50, s50, s36
    s_cmp_ge_u32 s20, 2
    s_cselect_b32 s52, s50, s53
    s_add_u32 m0, s31, 0
    s_add_u32 s52, s52, s49
    buffer_load_dwordx4 v1, s[4:7], s52 offen sc1 lds
    s_add_u32 m0, s30, 36864
    s_mov_b32 s53, s50
    buffer_load_dwordx4 v1, s[4:7], s50 offen offset:0 sc1 lds
    buffer_load_dwordx4 v1, s[4:7], s50 offen offset:1024 sc1 lds
    buffer_load_dwordx4 v1, s[4:7], s50 offen offset:2048 sc1 lds
    buffer_load_dwordx4 v1, s[4:7], s50 offen offset:3072 sc1 lds
    s_lshr_b32 s48, s47, 1
    s_cmp_eq_u32 s48, s23
    s_cselect_b32 s48, 1, 31
    s_and_b32 s48, s48, s47
    s_add_u32 m0, s30, 55296
    s_lshl_b32 s51, s48, 7
    buffer_load_dwordx4 v8, s[8:11], s51 offen offset:0  lds
    buffer_load_dwordx4 v9, s[8:11], s51 offen offset:1024  lds
    buffer_load_dwordx4 v10, s[8:11], s51 offen offset:2048  lds
    buffer_load_dwordx4 v11, s[8:11], s51 offen offset:3072  lds
    s_branch L_g_jn
L_g_r0:
    s_lshr_b32 s48, s46, 1
    s_cmp_eq_u32 s48, s23
    s_cselect_b32 s48, 1, 31
    s_and_b32 s48, s48, s46
    s_mul_i32 s50, s48, 18432
    s_add_u32 s50, s50, s36
    s_add_u32 m0, s30, 0
    s_mov_b32 s53, s50
    buffer_load_dwordx4 v1, s[4:7], s50 offen offset:0 sc1 lds
    buffer_load_dwordx4 v1, s[4:7], s50 offen offset:1024 sc1 lds
    buffer_load_dwordx4 v1, s[4:7], s50 offen offset:2048 sc1 lds
    buffer_load_dwordx4 v1, s[4:7], s50 offen offset:3072 sc1 lds
    s_lshr_b32 s48, s47, 1
    s_cmp_eq_u32 s48, s23
    s_cselect_b32 s48, 1, 31
    s_and_b32 s48, s48, s47
    s_mul_i32 s50, s48, 18432
    s_add_u32 s50, s50, s36
    s_cmp_ge_u32 s20, 2
    s_cselect_b32 s52, s50, s53
    s_add_u32 m0, s31, 0
    s_add_u32 s52, s52, s49
    buffer_load_dwordx4 v1, s[4:7], s52 offen sc1 lds
    s_add_u32 m0, s30, 36864
    s_mov_b32 s53, s50
    buffer_load_dwordx4 v1, s[4:7], s50 offen offset:0 sc1 lds
    buffer_load_dwordx4 v1, s[4:7], s50 offen offset:1024 sc1 lds
    buffer_load_dwordx4 v1, s[4:7], s50 offen offset:2048 sc1 lds
    buffer_load_dwordx4 v1, s[4:7], s50 offen offset:3072 sc1 lds
    s_lshr_b32 s48, s47, 1
    s_cmp_eq_u32 s48, s23
    s_cselect_b32 s48, 1, 31
    s_and_b32 s48, s48, s47
    s_add_u32 m0, s30, 55296
    s_lshl_b32 s51, s48, 7
    buffer_load_dwordx4 v8, s[8:11], s51 offen offset:0  lds
    buffer_load_dwordx4 v9, s[8:11], s51 offen offset:1024  lds
    buffer_load_dwordx4 v10, s[8:11], s51 offen offset:2048  lds
    buffer_load_dwordx4 v11, s[8:11], s51 offen offset:3072  lds
    s_waitcnt vmcnt(21)
    s_barrier
    s_waitcnt vmcnt(17)
    s_barrier
    s_branch L_g_jn
L_g_r1:
    s_lshr_b32 s48, s46, 1
    s_cmp_eq_u32 s48, s23
    s_cselect_b32 s48, 1, 31
    s_and_b32 s48, s48, s46
    s_mul_i32 s50, s48, 18432
    s_add_u32 s50, s50, s36
    s_add_u32 m0, s30, 0
    s_mov_b32 s53, s50
    buffer_load_dwordx4 v1, s[4:7], s50 offen offset:0 sc1 lds
    buffer_load_dwordx4 v1, s[4:7], s50 offen offset:1024 sc1 lds
    buffer_load_dwordx4 v1, s[4:7], s50 offen offset:2048 sc1 lds
    buffer_load_dwordx4 v1, s[4:7], s50 offen offset:3072 sc1 lds
    s_lshr_b32 s48, s47, 1
    s_cmp_eq_u32 s48, s23
    s_cselect_b32 s48, 1, 31
    s_and_b32 s48, s48, s47
    s_mul_i32 s50, s48, 18432
    s_add_u32 s50, s50, s36
    s_cmp_ge_u32 s20, 2
    s_cselect_b32 s52, s50, s53
    s_add_u32 m0, s31, 0
    s_add_u32 s52, s52, s49
    buffer_load_dwordx4 v1, s[4:7], s52 offen sc1 lds
    s_add_u32 m0, s30, 36864
    s_mov_b32 s53, s50
    buffer_load_dwordx4 v1, s[4:7], s50 offen offset:0 sc1 lds
    buffer_load_dwordx4 v1, s[4:7], s50 offen offset:1024 sc1 lds
    buffer_load_dwordx4 v1, s[4:7], s50 offen offset:2048 sc1 lds
    buffer_load_dwordx4 v1, s[4:7], s50 offen offset:3072 sc1 lds
    s_lshr_b32 s48, s47, 1
    s_cmp_eq_u32 s48, s23
    s_cselect_b32 s48, 1, 31
    s_and_b32 s48, s48, s47
    s_add_u32 m0, s30, 55296
    s_lshl_b32 s51, s48, 7
    buffer_load_dwordx4 v8, s[8:11], s51 offen offset:0  lds
    buffer_load_dwordx4 v9, s[8:11], s51 offen offset:1024  lds
    buffer_load_dwordx4 v10, s[8:11], s51 offen offset:2048  lds
    buffer_load_dwordx4 v11, s[8:11], s51 offen offset:3072  lds
    s_waitcnt vmcnt(17)
    s_barrier
L_g_jn:
    s_add_u32 s44, s44, 4
    s_cmp_ge_u32 s44, 32
    s_cselect_b32 s44, 4, s44
    s_add_u32 s45, s45, 4
    s_cmp_ge_u32 s45, 32
    s_cselect_b32 s45, 5, s45
    s_add_u32 s46, s46, 4
    s_and_b32 s46, s46, 31
    s_add_u32 s47, s47, 4
    s_and_b32 s47, s47, 31
    s_lshr_b32 s48, s44, 1
    s_cmp_eq_u32 s48, s23
    s_cselect_b32 s48, 1, 31
    s_and_b32 s48, s48, s44
    s_mul_i32 s50, s48, 18432
    s_add_u32 s50, s50, s36
    s_add_u32 m0, s30, 73728
    s_mov_b32 s53, s50
    buffer_load_dwordx4 v1, s[4:7], s50 offen offset:0 sc1 lds
    buffer_load_dwordx4 v1, s[4:7], s50 offen offset:1024 sc1 lds
    buffer_load_dwordx4 v1, s[4:7], s50 offen offset:2048 sc1 lds
    buffer_load_dwordx4 v1, s[4:7], s50 offen offset:3072 sc1 lds
    s_lshr_b32 s48, s44, 1
    s_cmp_eq_u32 s48, s23
    s_cselect_b32 s48, 1, 31
    s_and_b32 s48, s48, s44
    s_add_u32 m0, s30, 92160
    s_lshl_b32 s51, s48, 7
    buffer_load_dwordx4 v8, s[8:11], s51 offen offset:0  lds
    buffer_load_dwordx4 v9, s[8:11], s51 offen offset:1024  lds
    buffer_load_dwordx4 v10, s[8:11], s51 offen offset:2048  lds
    buffer_load_dwordx4 v11, s[8:11], s51 offen offset:3072  lds
    s_add_u32 s44, s44, 4
    s_cmp_ge_u32 s44, 32
    s_cselect_b32 s44, 4, s44
    s_waitcnt vmcnt(16)
    s_barrier
    s_lshr_b32 s48, s45, 1
    s_cmp_eq_u32 s48, s23
    s_cselect_b32 s48, 1, 31
    s_and_b32 s48, s48, s45
    s_mul_i32 s50, s48, 18432
    s_add_u32 s50, s50, s36
    s_cmp_ge_u32 s20, 2
    s_cselect_b32 s52, s50, s53
    s_add_u32 m0, s31, 73728
    s_add_u32 s52, s52, s49
    buffer_load_dwordx4 v1, s[4:7], s52 offen sc1 lds
    s_add_u32 m0, s30, 110592
    s_mov_b32 s53, s50
    buffer_load_dwordx4 v1, s[4:7], s50 offen offset:0 sc1 lds
    buffer_load_dwordx4 v1, s[4:7], s50 offen offset:1024 sc1 lds
    buffer_load_dwordx4 v1, s[4:7], s50 offen offset:2048 sc1 lds
    buffer_load_dwordx4 v1, s[4:7], s50 offen offset:3072 sc1 lds
    s_lshr_b32 s48, s45, 1
    s_cmp_eq_u32 s48, s23
    s_cselect_b32 s48, 1, 31
    s_and_b32 s48, s48, s45
    s_add_u32 m0, s30, 129024
    s_lshl_b32 s51, s48, 7
    buffer_load_dwordx4 v8, s[8:11], s51 offen offset:0  lds
    buffer_load_dwordx4 v9, s[8:11], s51 offen offset:1024  lds
    buffer_load_dwordx4 v10, s[8:11], s51 offen offset:2048  lds
    buffer_load_dwordx4 v11, s[8:11], s51 offen offset:3072  lds
    s_add_u32 s45, s45, 4
    s_cmp_ge_u32 s45, 32
    s_cselect_b32 s45, 5, s45
    s_waitcnt vmcnt(17)
    s_barrier
    s_lshr_b32 s48, s46, 1
    s_cmp_eq_u32 s48, s23
    s_cselect_b32 s48, 1, 31
    s_and_b32 s48, s48, s46
    s_mul_i32 s50, s48, 18432
    s_add_u32 s50, s50, s36
    s_add_u32 m0, s30, 0
    s_mov_b32 s53, s50
    buffer_load_dwordx4 v1, s[4:7], s50 offen offset:0 sc1 lds
    buffer_load_dwordx4 v1, s[4:7], s50 offen offset:1024 sc1 lds
    buffer_load_dwordx4 v1, s[4:7], s50 offen offset:2048 sc1 lds
    buffer_load_dwordx4 v1, s[4:7], s50 offen offset:3072 sc1 lds
    s_lshr_b32 s48, s46, 1
    s_cmp_eq_u32 s48, s23
    s_cselect_b32 s48, 1, 31
    s_and_b32 s48, s48, s46
    s_add_u32 m0, s30, 18432
    s_lshl_b32 s51, s48, 7
    buffer_load_dwordx4 v8, s[8:11], s51 offen offset:0  lds
    buffer_load_dwordx4 v9, s[8:11], s51 offen offset:1024  lds
    buffer_load_dwordx4 v10, s[8:11], s51 offen offset:2048  lds
    buffer_load_dwordx4 v11, s[8:11], s51 offen offset:3072  lds
    s_add_u32 s46, s46, 4
    s_and_b32 s46, s46, 31
    s_waitcnt vmcnt(16)
    s_barrier
    s_lshr_b32 s48, s47, 1
    s_cmp_eq_u32 s48, s23
    s_cselect_b32 s48, 1, 31
    s_and_b32 s48, s48, s47
    s_mul_i32 s50, s48, 18432
    s_add_u32 s50, s50, s36
    s_cmp_ge_u32 s20, 2
    s_cselect_b32 s52, s50, s53
    s_add_u32 m0, s31, 0
    s_add_u32 s52, s52, s49
    buffer_load_dwordx4 v1, s[4:7], s52 offen sc1 lds
    s_add_u32 m0, s30, 36864
    s_mov_b32 s53, s50
    buffer_load_dwordx4 v1, s[4:7], s50 offen offset:0 sc1 lds
    buffer_load_dwordx4 v1, s[4:7], s50 offen offset:1024 sc1 lds
    buffer_load_dwordx4 v1, s[4:7], s50 offen offset:2048 sc1 lds
    buffer_load_dwordx4 v1, s[4:7], s50 offen offset:3072 sc1 lds
    s_lshr_b32 s48, s47, 1
    s_cmp_eq_u32 s48, s23
    s_cselect_b32 s48, 1, 31
    s_and_b32 s48, s48, s47
    s_add_u32 m0, s30, 55296
    s_lshl_b32 s51, s48, 7
    buffer_load_dwordx4 v8, s[8:11], s51 offen offset:0  lds
    buffer_load_dwordx4 v9, s[8:11], s51 offen offset:1024  lds
    buffer_load_dwordx4 v10, s[8:11], s51 offen offset:2048  lds
    buffer_load_dwordx4 v11, s[8:11], s51 offen offset:3072  lds
    s_add_u32 s47, s47, 4
    s_and_b32 s47, s47, 31
    s_mov_b32 s41, 6
L_g_ll:
    s_waitcnt vmcnt(17)
    s_barrier
    s_lshr_b32 s48, s44, 1
    s_cmp_eq_u32 s48, s23
    s_cselect_b32 s48, 1, 31
    s_and_b32 s48, s48, s44
    s_mul_i32 s50, s48, 18432
    s_add_u32 s50, s50, s36
    s_add_u32 m0, s30, 73728
    s_mov_b32 s53, s50
    buffer_load_dwordx4 v1, s[4:7], s50 offen offset:0 sc1 lds
    buffer_load_dwordx4 v1, s[4:7], s50 offen offset:1024 sc1 lds
    buffer_load_dwordx4 v1, s[4:7], s50 offen offset:2048 sc1 lds
    buffer_load_dwordx4 v1, s[4:7], s50 offen offset:3072 sc1 lds
    s_lshr_b32 s48, s44, 1
    s_cmp_eq_u32 s48, s23
    s_cselect_b32 s48, 1, 31
    s_and_b32 s48, s48, s44
    s_add_u32 m0, s30, 92160
    s_lshl_b32 s51, s48, 7
    buffer_load_dwordx4 v8, s[8:11], s51 offen offset:0  lds
    buffer_load_dwordx4 v9, s[8:11], s51 offen offset:1024  lds
    buffer_load_dwordx4 v10, s[8:11], s51 offen offset:2048  lds
    buffer_load_dwordx4 v11, s[8:11], s51 offen offset:3072  lds
    s_add_u32 s44, s44, 4
    s_cmp_ge_u32 s44, 32
    s_cselect_b32 s44, 4, s44
    s_waitcnt vmcnt(16)
    s_barrier
    s_lshr_b32 s48, s45, 1
    s_cmp_eq_u32 s48, s23
    s_cselect_b32 s48, 1, 31
    s_and_b32 s48, s48, s45
    s_mul_i32 s50, s48, 18432
    s_add_u32 s50, s50, s36
    s_cmp_ge_u32 s20, 2
    s_cselect_b32 s52, s50, s53
    s_add_u32 m0, s31, 73728
    s_add_u32 s52, s52, s49
    buffer_load_dwordx4 v1, s[4:7], s52 offen sc1 lds
    s_add_u32 m0, s30, 110592
    s_mov_b32 s53, s50
    buffer_load_dwordx4 v1, s[4:7], s50 offen offset:0 sc1 lds
    buffer_load_dwordx4 v1, s[4:7], s50 offen offset:1024 sc1 lds
    buffer_load_dwordx4 v1, s[4:7], s50 offen offset:2048 sc1 lds
    buffer_load_dwordx4 v1, s[4:7], s50 offen offset:3072 sc1 lds
    s_lshr_b32 s48, s45, 1
    s_cmp_eq_u32 s48, s23
    s_cselect_b32 s48, 1, 31
    s_and_b32 s48, s48, s45
    s_add_u32 m0, s30, 129024
    s_lshl_b32 s51, s48, 7
    buffer_load_dwordx4 v8, s[8:11], s51 offen offset:0  lds
    buffer_load_dwordx4 v9, s[8:11], s51 offen offset:1024  lds
    buffer_load_dwordx4 v10, s[8:11], s51 offen offset:2048  lds
    buffer_load_dwordx4 v11, s[8:11], s51 offen offset:3072  lds
    s_add_u32 s45, s45, 4
    s_cmp_ge_u32 s45, 32
    s_cselect_b32 s45, 5, s45
    s_waitcnt vmcnt(17)
    s_barrier
    s_lshr_b32 s48, s46, 1
    s_cmp_eq_u32 s48, s23
    s_cselect_b32 s48, 1, 31
    s_and_b32 s48, s48, s46
    s_mul_i32 s50, s48, 18432
    s_add_u32 s50, s50, s36
    s_add_u32 m0, s30, 0
    s_mov_b32 s53, s50
    buffer_load_dwordx4 v1, s[4:7], s50 offen offset:0 sc1 lds
    buffer_load_dwordx4 v1, s[4:7], s50 offen offset:1024 sc1 lds
    buffer_load_dwordx4 v1, s[4:7], s50 offen offset:2048 sc1 lds
    buffer_load_dwordx4 v1, s[4:7], s50 offen offset:3072 sc1 lds
    s_lshr_b32 s48, s46, 1
    s_cmp_eq_u32 s48, s23
    s_cselect_b32 s48, 1, 31
    s_and_b32 s48, s48, s46
    s_add_u32 m0, s30, 18432
    s_lshl_b32 s51, s48, 7
    buffer_load_dwordx4 v8, s[8:11], s51 offen offset:0  lds
    buffer_load_dwordx4 v9, s[8:11], s51 offen offset:1024  lds
    buffer_load_dwordx4 v10, s[8:11], s51 offen offset:2048  lds
    buffer_load_dwordx4 v11, s[8:11], s51 offen offset:3072  lds
    s_add_u32 s46, s46, 4
    s_and_b32 s46, s46, 31
    s_waitcnt vmcnt(16)
    s_barrier
    s_lshr_b32 s48, s47, 1
    s_cmp_eq_u32 s48, s23
    s_cselect_b32 s48, 1, 31
    s_and_b32 s48, s48, s47
    s_mul_i32 s50, s48, 18432
    s_add_u32 s50, s50, s36
    s_cmp_ge_u32 s20, 2
    s_cselect_b32 s52, s50, s53
    s_add_u32 m0, s31, 0
    s_add_u32 s52, s52, s49
    buffer_load_dwordx4 v1, s[4:7], s52 offen sc1 lds
    s_add_u32 m0, s30, 36864
    s_mov_b32 s53, s50
    buffer_load_dwordx4 v1, s[4:7], s50 offen offset:0 sc1 lds
    buffer_load_dwordx4 v1, s[4:7], s50 offen offset:1024 sc1 lds
    buffer_load_dwordx4 v1, s[4:7], s50 offen offset:2048 sc1 lds
    buffer_load_dwordx4 v1, s[4:7], s50 offen offset:3072 sc1 lds
    s_lshr_b32 s48, s47, 1
    s_cmp_eq_u32 s48, s23
    s_cselect_b32 s48, 1, 31
    s_and_b32 s48, s48, s47
    s_add_u32 m0, s30, 55296
    s_lshl_b32 s51, s48, 7
    buffer_load_dwordx4 v8, s[8:11], s51 offen offset:0  lds
    buffer_load_dwordx4 v9, s[8:11], s51 offen offset:1024  lds
    buffer_load_dwordx4 v10, s[8:11], s51 offen offset:2048  lds
    buffer_load_dwordx4 v11, s[8:11], s51 offen offset:3072  lds
    s_add_u32 s47, s47, 4
    s_and_b32 s47, s47, 31
    s_sub_u32 s41, s41, 1
    s_cmp_lg_u32 s41, 0
    s_cbranch_scc1 L_g_ll
    s_waitcnt vmcnt(17)
    s_barrier
    s_mov_b32 s32, 0
    s_mul_i32 s32, s32, 36864
    s_add_u32 s32, s32, s43
    s_add_u32 m0, s42, 73728
    s_add_u32 s33, s32, 0
    buffer_load_dwordx4 v1, s[4:7], s33 offen offset:0  sc1 lds
    buffer_load_dwordx4 v1, s[4:7], s33 offen offset:1024  sc1 lds
    buffer_load_dwordx4 v1, s[4:7], s33 offen offset:2048  sc1 lds
    buffer_load_dwordx4 v1, s[4:7], s33 offen offset:3072  sc1 lds
    s_add_u32 m0, s42, 77824
    s_add_u32 s33, s32, 4096
    buffer_load_dwordx4 v1, s[4:7], s33 offen offset:0  sc1 lds
    buffer_load_dwordx4 v1, s[4:7], s33 offen offset:1024  sc1 lds
    buffer_load_dwordx4 v1, s[4:7], s33 offen offset:2048  sc1 lds
    buffer_load_dwordx4 v1, s[4:7], s33 offen offset:3072  sc1 lds
    s_add_u32 m0, s42, 81920
    s_add_u32 s33, s32, 8192
    buffer_load_dwordx4 v1, s[4:7], s33 offen offset:0  sc1 lds
    s_waitcnt vmcnt(9)
    s_barrier
    s_mov_b32 s32, 1
    s_mul_i32 s32, s32, 36864
    s_add_u32 s32, s32, s43
    s_add_u32 m0, s42, 110592
    s_add_u32 s33, s32, 0
    buffer_load_dwordx4 v1, s[4:7], s33 offen offset:0  sc1 lds
    buffer_load_dwordx4 v1, s[4:7], s33 offen offset:1024  sc1 lds
    buffer_load_dwordx4 v1, s[4:7], s33 offen offset:2048  sc1 lds
    buffer_load_dwordx4 v1, s[4:7], s33 offen offset:3072  sc1 lds
    s_add_u32 m0, s42, 114688
    s_add_u32 s33, s32, 4096
    buffer_load_dwordx4 v1, s[4:7], s33 offen offset:0  sc1 lds
    buffer_load_dwordx4 v1, s[4:7], s33 offen offset:1024  sc1 lds
    buffer_load_dwordx4 v1, s[4:7], s33 offen offset:2048  sc1 lds
    buffer_load_dwordx4 v1, s[4:7], s33 offen offset:3072  sc1 lds
    s_add_u32 m0, s42, 118784
    s_add_u32 s33, s32, 8192
    buffer_load_dwordx4 v1, s[4:7], s33 offen offset:0  sc1 lds
    s_barrier
    s_mov_b32 s32, 2
    s_mul_i32 s32, s32, 36864
    s_add_u32 s32, s32, s43
    s_add_u32 m0, s42, 0
    s_add_u32 s33, s32, 0
    buffer_load_dwordx4 v1, s[4:7], s33 offen offset:0  sc1 lds
    buffer_load_dwordx4 v1, s[4:7], s33 offen offset:1024  sc1 lds
    buffer_load_dwordx4 v1, s[4:7], s33 offen offset:2048  sc1 lds
    buffer_load_dwordx4 v1, s[4:7], s33 offen offset:3072  sc1 lds
    s_add_u32 m0, s42, 4096
    s_add_u32 s33, s32, 4096
    buffer_load_dwordx4 v1, s[4:7], s33 offen offset:0  sc1 lds
    buffer_load_dwordx4 v1, s[4:7], s33 offen offset:1024  sc1 lds
    buffer_load_dwordx4 v1, s[4:7], s33 offen offset:2048  sc1 lds
    buffer_load_dwordx4 v1, s[4:7], s33 offen offset:3072  sc1 lds
    s_add_u32 m0, s42, 8192
    s_add_u32 s33, s32, 8192
    buffer_load_dwordx4 v1, s[4:7], s33 offen offset:0  sc1 lds
    s_barrier
    s_mov_b32 s32, 3
    s_mul_i32 s32, s32, 36864
    s_add_u32 s32, s32, s43
    s_add_u32 m0, s42, 36864
    s_add_u32 s33, s32, 0
    buffer_load_dwordx4 v1, s[4:7], s33 offen offset:0  sc1 lds
    buffer_load_dwordx4 v1, s[4:7], s33 offen offset:1024  sc1 lds
    buffer_load_dwordx4 v1, s[4:7], s33 offen offset:2048  sc1 lds
    buffer_load_dwordx4 v1, s[4:7], s33 offen offset:3072  sc1 lds
    s_add_u32 m0, s42, 40960
    s_add_u32 s33, s32, 4096
    buffer_load_dwordx4 v1, s[4:7], s33 offen offset:0  sc1 lds
    buffer_load_dwordx4 v1, s[4:7], s33 offen offset:1024  sc1 lds
    buffer_load_dwordx4 v1, s[4:7], s33 offen offset:2048  sc1 lds
    buffer_load_dwordx4 v1, s[4:7], s33 offen offset:3072  sc1 lds
    s_add_u32 m0, s42, 45056
    s_add_u32 s33, s32, 8192
    buffer_load_dwordx4 v1, s[4:7], s33 offen offset:0  sc1 lds
    s_waitcnt vmcnt(27) lgkmcnt(0)
    s_barrier
    v_add_u32 v12, s42, v1
    v_add_u32 v13, 36864, v12
    v_add_u32 v14, 73728, v12
    v_add_u32 v15, 110592, v12
    s_waitcnt vmcnt(18) lgkmcnt(15)
    s_barrier
    ds_write_b128 v14, v[76:79] offset:0
    ds_write_b128 v14, v[80:83] offset:1024
    ds_write_b128 v14, v[84:87] offset:2048
    ds_write_b128 v14, v[88:91] offset:3072
    ds_write_b128 v14, v[92:95] offset:4096
    ds_write_b128 v14, v[96:99] offset:5120
    ds_write_b128 v14, v[100:103] offset:6144
    s_waitcnt vmcnt(9) lgkmcnt(15)
    s_barrier
    ds_write_b128 v14, v[104:107] offset:7168
    ds_write_b128 v14, v[108:111] offset:8192
    ds_write_b128 v15, v[112:115] offset:0
    ds_write_b128 v15, v[116:119] offset:1024
    ds_write_b128 v15, v[120:123] offset:2048
    ds_write_b128 v15, v[124:127] offset:3072
    ds_write_b128 v15, v[128:131] offset:4096
    s_waitcnt vmcnt(0) lgkmcnt(15)
    s_barrier
    ds_write_b128 v15, v[132:135] offset:5120
    ds_write_b128 v15, v[136:139] offset:6144
    ds_write_b128 v15, v[140:143] offset:7168
    ds_write_b128 v15, v[144:147] offset:8192
    ds_write_b128 v12, v[148:151] offset:0
    ds_write_b128 v12, v[152:155] offset:1024
    ds_write_b128 v12, v[156:159] offset:2048
    s_waitcnt vmcnt(63) lgkmcnt(12)
    s_barrier
    ds_write_b128 v12, v[160:163] offset:3072
    ds_write_b128 v12, v[164:167] offset:4096
    ds_write_b128 v12, v[168:171] offset:5120
    ds_write_b128 v12, v[172:175] offset:6144
    ds_write_b128 v12, v[176:179] offset:7168
    ds_write_b128 v12, v[180:183] offset:8192
    s_waitcnt vmcnt(63) lgkmcnt(9)
    s_barrier
    ds_write_b128 v13, v[184:187] offset:0
    ds_write_b128 v13, v[188:191] offset:1024
    ds_write_b128 v13, v[192:195] offset:2048
    ds_write_b128 v13, v[196:199] offset:3072
    ds_write_b128 v13, v[200:203] offset:4096
    ds_write_b128 v13, v[204:207] offset:5120
    s_waitcnt vmcnt(63) lgkmcnt(6)
    s_barrier
    s_and_b32 s25, s2, 7
    s_lshr_b32 s26, s2, 3
    s_lshr_b32 s23, s25, 1
    s_lshl_b32 s23, s23, 2
    s_lshr_b32 s27, s26, 3
    s_add_u32 s23, s23, s27
    s_and_b32 s24, s25, 1
    s_lshl_b32 s24, s24, 3
    s_and_b32 s27, s26, 7
    s_add_u32 s24, s24, s27
    s_mul_i32 s29, s24, 129024
    s_lshl_b32 s30, s20, 12
    s_add_u32 s29, s29, s30
    s_add_u32 s29, s29, 0x3800000
    s_lshl_b32 s31, s23, 3
    s_max_u32 s31, s31, 1
    s_sub_u32 s31, s31, 1
    s_mul_i32 s31, s31, 18432
    s_add_u32 s31, s31, 0x1c00000
    s_lshl_b32 s35, s20, 10
    s_and_b32 s36, s35, 1024
    ds_write_b128 v13, v[208:211] offset:6144
    ds_write_b128 v13, v[212:215] offset:7168
    ds_write_b128 v13, v[216:219] offset:8192
    ds_write_b128 v14, v[220:223] offset:0
    ds_write_b128 v14, v[224:227] offset:1024
    ds_write_b128 v14, v[228:231] offset:2048
    s_waitcnt vmcnt(63) lgkmcnt(3)
    s_barrier
    ds_write_b128 v14, v[232:235] offset:3072
    ds_write_b128 v14, v[236:239] offset:4096
    ds_write_b128 v14, v[240:243] offset:5120
    ds_write_b128 v14, v[244:247] offset:6144
    ds_write_b128 v14, v[248:251] offset:7168
    ds_write_b128 v14, v[252:255] offset:8192
    s_waitcnt vmcnt(63) lgkmcnt(0)
    s_barrier
    s_cmp_eq_u32 s22, 1
    s_cbranch_scc1 L_m_t8
    s_add_u32 m0, s30, 0
    s_add_u32 s34, s29, 0
    buffer_load_dwordx4 v1, s[4:7], s34 offen offset:0 sc1 lds
    buffer_load_dwordx4 v1, s[4:7], s34 offen offset:1024 sc1 lds
    buffer_load_dwordx4 v1, s[4:7], s34 offen offset:2048 sc1 lds
    buffer_load_dwordx4 v1, s[4:7], s34 offen offset:3072 sc1 lds
    s_add_u32 m0, s30, 16384
    s_add_u32 s34, s29, 16384
    buffer_load_dwordx4 v1, s[4:7], s34 offen offset:0 sc1 lds
    buffer_load_dwordx4 v1, s[4:7], s34 offen offset:1024 sc1 lds
    buffer_load_dwordx4 v1, s[4:7], s34 offen offset:2048 sc1 lds
    buffer_load_dwordx4 v1, s[4:7], s34 offen offset:3072 sc1 lds
L_m_t8:
    s_cmp_eq_u32 s22, 1
    s_cbranch_scc1 L_m_lfin
    s_barrier
    s_add_u32 m0, s30, 32768
    s_add_u32 s34, s29, 32768
    buffer_load_dwordx4 v1, s[4:7], s34 offen offset:0 sc1 lds
    buffer_load_dwordx4 v1, s[4:7], s34 offen offset:1024 sc1 lds
    buffer_load_dwordx4 v1, s[4:7], s34 offen offset:2048 sc1 lds
    buffer_load_dwordx4 v1, s[4:7], s34 offen offset:3072 sc1 lds
    s_add_u32 m0, s30, 114688
    s_add_u32 s34, s29, 114688
    buffer_load_dwordx4 v1, s[4:7], s34 offen offset:0 sc1 lds
    buffer_load_dwordx4 v1, s[4:7], s34 offen offset:1024 sc1 lds
    buffer_load_dwordx4 v1, s[4:7], s34 offen offset:2048 sc1 lds
    buffer_load_dwordx4 v1, s[4:7], s34 offen offset:3072 sc1 lds
    s_mov_b32 s22, 1
    s_mov_b32 s21, 0x1c00000
    s_barrier
    s_barrier
    s_add_u32 m0, s30, 49152
    s_add_u32 s34, s29, 49152
    buffer_load_dwordx4 v1, s[4:7], s34 offen offset:0 sc1 lds
    buffer_load_dwordx4 v1, s[4:7], s34 offen offset:1024 sc1 lds
    buffer_load_dwordx4 v1, s[4:7], s34 offen offset:2048 sc1 lds
    buffer_load_dwordx4 v1, s[4:7], s34 offen offset:3072 sc1 lds
    v_lshrrev_b32 v2, 8, v1
    v_bfe_u32 v3, v1, 7, 1
    v_bfe_u32 v4, v1, 4, 3
    v_cmp_gt_u32 vcc, 3, v2
    v_mul_u32_u24 v3, 80, v3
    v_lshl_add_u32 v3, v4, 3, v3
    v_lshrrev_b32 v5, 1, v4
    v_and_b32 v4, 1, v4
    v_lshl_add_u32 v4, v4, 3, 64
    v_cndmask_b32 v2, v5, v2, vcc
    v_cndmask_b32 v3, v4, v3, vcc
    v_mul_u32_u24 v2, 2304, v2
    v_add_u32 v0, v2, v3
    v_lshrrev_b32 v8, 1, v1
    s_mul_i32 s34, s24, 144
    s_add_u32 s34, s34, 0x4400000
    buffer_load_dwordx2 v[2:3], v0, s[4:7], s34 offen sc1
    s_mul_i32 s34, s24, 144
    s_add_u32 s34, s34, 0x4402000
    buffer_load_dwordx2 v[4:5], v0, s[4:7], s34 offen sc1
    s_mul_i32 s34, s24, 144
    s_add_u32 s34, s34, 0x4404000
    buffer_load_dwordx2 v[6:7], v0, s[4:7], s34 offen sc1
    s_mul_i32 s34, s24, 144
    s_add_u32 s34, s34, 0x4406000
    buffer_load_dwordx2 v[12:13], v0, s[4:7], s34 offen sc1
    s_add_u32 m0, s30, 65536
    s_add_u32 s34, s29, 65536
    buffer_load_dwordx4 v1, s[4:7], s34 offen offset:0 sc1 lds
    buffer_load_dwordx4 v1, s[4:7], s34 offen offset:1024 sc1 lds
    buffer_load_dwordx4 v1, s[4:7], s34 offen offset:2048 sc1 lds
    buffer_load_dwordx4 v1, s[4:7], s34 offen offset:3072 sc1 lds
    s_add_u32 m0, s30, 81920
    s_add_u32 s34, s29, 81920
    buffer_load_dwordx4 v1, s[4:7], s34 offen offset:0 sc1 lds
    buffer_load_dwordx4 v1, s[4:7], s34 offen offset:1024 sc1 lds
    buffer_load_dwordx4 v1, s[4:7], s34 offen offset:2048 sc1 lds
    buffer_load_dwordx4 v1, s[4:7], s34 offen offset:3072 sc1 lds
    s_barrier
    s_add_u32 m0, s35, 131072
    s_add_u32 s34, s31, s35
    s_add_u32 s34, s34, 0
    buffer_load_dwordx4 v1, s[4:7], s34 offen sc1 lds
    s_waitcnt vmcnt(29) lgkmcnt(0)
    s_barrier
    s_add_u32 m0, s35, 135168
    s_add_u32 s34, s31, s35
    s_add_u32 s34, s34, 4096
    buffer_load_dwordx4 v1, s[4:7], s34 offen sc1 lds
    s_waitcnt vmcnt(1) lgkmcnt(0)
    s_barrier
    s_add_u32 m0, s35, 139264
    s_add_u32 s34, s31, s35
    s_add_u32 s34, s34, 8192
    buffer_load_dwordx4 v1, s[4:7], s34 offen sc1 lds
    s_waitcnt vmcnt(2) lgkmcnt(0)
    s_barrier
    s_add_u32 m0, s35, 143360
    s_add_u32 s34, s31, s35
    s_add_u32 s34, s34, 12288
    buffer_load_dwordx4 v1, s[4:7], s34 offen sc1 lds
    s_add_u32 m0, s30, 98304
    s_add_u32 s34, s29, 98304
    buffer_load_dwordx4 v1, s[4:7], s34 offen offset:0 sc1 lds
    buffer_load_dwordx4 v1, s[4:7], s34 offen offset:1024 sc1 lds
    buffer_load_dwordx4 v1, s[4:7], s34 offen offset:2048 sc1 lds
    buffer_load_dwordx4 v1, s[4:7], s34 offen offset:3072 sc1 lds
    s_waitcnt vmcnt(6) lgkmcnt(0)
    s_barrier
    s_add_u32 m0, s36, 147456
    s_add_u32 s34, s31, s36
    s_add_u32 s34, s34, 16384
    buffer_load_dwordx4 v1, s[4:7], s34 offen sc1 lds
    v_add_f32 v2, v2, v4
    v_add_f32 v3, v3, v5
    v_add_f32 v6, v6, v12
    v_add_f32 v7, v7, v13
    v_add_f32 v2, v2, v6
    v_add_f32 v3, v3, v7
    v_cmp_gt_u32 vcc, 864, v1
    v_add_u32 v8, 161792, v8
    s_nop 0
    v_cndmask_b32 v2, 0, v2, vcc
    v_cndmask_b32 v3, 0, v3, vcc
    ds_write_b64 v8, v[2:3]
    s_waitcnt vmcnt(6) lgkmcnt(0)
    s_barrier
    s_waitcnt vmcnt(6) lgkmcnt(0)
    s_barrier
    s_waitcnt vmcnt(1) lgkmcnt(0)
    s_barrier
    s_waitcnt vmcnt(0) lgkmcnt(0)
    s_barrier
    s_barrier
    s_branch L_m_ll
L_m_lfin:
L_end_m:
    s_endpgm

.section .rodata,"a"
.p2align 6
.amdhsa_kernel interleave_layers__sliding_local_dilated__mixer_gmlp__prompt_kernel
  .amdhsa_next_free_vgpr 256
  .amdhsa_next_free_sgpr 102
  .amdhsa_accum_offset 256
  .amdhsa_group_segment_fixed_size 0
  .amdhsa_kernarg_size 88
  .amdhsa_user_sgpr_count 2
  .amdhsa_user_sgpr_kernarg_segment_ptr 1
  .amdhsa_system_sgpr_workgroup_id_x 1
  .amdhsa_float_denorm_mode_32 3
.end_amdhsa_kernel
```

```asm
; @launch grid=(256,1,1) block=(512,1,1) lds=163840
.amdgcn_target "amdgcn-amd-amdhsa--gfx950"
.text
.globl interleave_layers__sliding_local_dilated__mixer_gmlp__prompt_kernel
.p2align 8
.type interleave_layers__sliding_local_dilated__mixer_gmlp__prompt_kernel,@function
interleave_layers__sliding_local_dilated__mixer_gmlp__prompt_kernel:
    s_cmp_ge_u32 s2, 256
    s_cbranch_scc1 L_end_m
    s_load_dwordx16 s[36:51], s[0:1], 0
    s_load_dwordx4 s[56:59], s[0:1], 64
    s_load_dwordx2 s[24:25], s[0:1], 80
    s_getpc_b64 s[26:27]
L_m_pc:
    s_sub_u32 s26, s26, L_m_pc-interleave_layers__sliding_local_dilated__mixer_gmlp__prompt_kernel
    s_subb_u32 s27, s27, 0
    v_lshlrev_b32 v4, 4, v0
    v_mov_b32 v5, s27
    v_add_co_u32 v6, vcc, s26, v4
    s_lshr_b32 s28, s2, 3
    s_lshl_b32 s28, s28, 11
    v_addc_co_u32 v7, vcc, 0, v5, vcc
    global_load_dwordx4 v[60:63], v[6:7], off
    v_lshl_add_u32 v4, v0, 2, s28
    v_min_u32 v4, L_end_m-interleave_layers__sliding_local_dilated__mixer_gmlp__prompt_kernel-4, v4
    v_add_co_u32 v6, vcc, s26, v4
    s_nop 1
    v_addc_co_u32 v7, vcc, 0, v5, vcc
    global_load_dword v64, v[6:7], off
    v_lshrrev_b32 v2, 6, v0
    v_and_b32 v1, 63, v0
    v_lshlrev_b32 v1, 4, v1
    v_readfirstlane_b32 s23, v2
    s_mov_b32 s22, 0
    s_mov_b32 s21, 0
    s_and_b32 s20, s23, 3
    s_waitcnt lgkmcnt(0)
    s_mov_b32 s4, s24
    s_mov_b32 s5, s25
    s_mov_b32 s6, 0x10000000
    s_mov_b32 s7, 0x20000
    s_cmp_ge_u32 s23, 4
    s_cbranch_scc1 L_ld_m
    v_bfe_u32 v2, v1, 4, 4
    v_lshrrev_b32 v3, 8, v1
    v_bfrev_b32 v6, 1
    v_mov_b32 v11, 0x3f803f80
    s_lshl_b32 s30, s20, 12
    s_and_b32 s29, s20, 1
    s_cmp_lt_u32 s2, 128
    s_cbranch_scc1 L_p0_x
    s_cmp_lt_u32 s2, 236
    s_cbranch_scc1 L_p0_wq
    s_cmp_lt_u32 s2, 254
    s_cbranch_scc1 L_p0_wo
    s_mov_b32 s46, 0
    s_mov_b32 s27, 0x800000
    s_barrier
    s_branch L_p0_cd
L_p0_wo:
    s_mul_i32 s30, s20, 9216
    s_sub_u32 s26, s2, 236
    s_mul_i32 s28, s26, 57
    s_lshr_b32 s28, s28, 9
    s_mul_i32 s27, s28, 9
    s_sub_u32 s27, s26, s27
    s_mov_b32 s32, s40
    s_mov_b32 s33, s41
    s_mov_b32 s34, 0xa2000
    s_mov_b32 s35, 0x20000
    s_mul_i32 s29, s28, 331776
    s_lshl_b32 s31, s27, 7
    s_add_u32 s29, s29, s31
    s_mul_i32 s31, s20, 82944
    s_add_u32 s29, s29, s31
    s_mul_i32 s30, s20, 9216
    v_lshrrev_b32 v4, 7, v1
    v_mul_u32_u24 v4, 1152, v4
    v_and_b32 v5, 0x70, v1
    v_add_u32 v4, v4, v5
    s_add_u32 m0, s30, 0
    s_add_u32 s31, s29, 0
    buffer_load_dwordx4 v4, s[32:35], s31 offen  lds
    s_add_u32 m0, s30, 1024
    s_add_u32 s31, s29, 9216
    buffer_load_dwordx4 v4, s[32:35], s31 offen  lds
    s_add_u32 m0, s30, 2048
    s_add_u32 s31, s29, 18432
    buffer_load_dwordx4 v4, s[32:35], s31 offen  lds
    s_add_u32 m0, s30, 3072
    s_add_u32 s31, s29, 27648
    buffer_load_dwordx4 v4, s[32:35], s31 offen  lds
    s_add_u32 m0, s30, 4096
    s_add_u32 s31, s29, 36864
    buffer_load_dwordx4 v4, s[32:35], s31 offen  lds
    s_add_u32 m0, s30, 5120
    s_add_u32 s31, s29, 46080
    buffer_load_dwordx4 v4, s[32:35], s31 offen  lds
    s_add_u32 m0, s30, 6144
    s_add_u32 s31, s29, 55296
    buffer_load_dwordx4 v4, s[32:35], s31 offen  lds
    s_add_u32 m0, s30, 7168
    s_add_u32 s31, s29, 64512
    buffer_load_dwordx4 v4, s[32:35], s31 offen  lds
    s_add_u32 m0, s30, 8192
    s_add_u32 s31, s29, 73728
    buffer_load_dwordx4 v4, s[32:35], s31 offen  lds
    v_lshrrev_b32 v7, 2, v2
    v_and_b32 v8, 3, v2
    v_bfe_u32 v9, v1, 7, 0
    v_xor_b32 v9, s20, v9
    v_lshlrev_b32 v9, 5, v9
    v_lshl_add_u32 v9, v7, 7, v9
    v_lshl_add_u32 v9, v8, 3, v9
    v_add_u32 v9, 0, v9
    v_mul_u32_u24 v4, 512, v3
    v_add_u32 v4, v4, v9
    v_mul_u32_u24 v5, 9216, v3
    v_add_u32 v5, v5, v9
    s_lshl_b32 s31, s27, 2
    s_add_u32 s31, s31, s20
    v_lshl_add_u32 v7, s31, 2, v7
    v_lshlrev_b32 v8, 4, v8
    v_lshl_add_u32 v8, v3, 8, v8
    v_mul_u32_u24 v9, 57, v7
    v_lshrrev_b32 v9, 10, v9
    v_mul_u32_u24 v10, 18, v9
    v_sub_u32 v10, v7, v10
    v_lshrrev_b32 v12, 3, v10
    v_and_b32 v13, 1, v10
    v_lshl_add_u32 v12, v12, 1, v13
    v_bfe_u32 v14, v10, 1, 2
    v_cmp_gt_u32 vcc, 16, v10
    v_mul_u32_u24 v9, 82944, v9
    v_add_u32 v9, v9, v8
    v_cndmask_b32 v12, 8, v12, vcc
    v_cndmask_b32 v14, v13, v14, vcc
    v_mov_b32 v15, 0x1000
    v_mov_b32 v13, 0x80
    v_cndmask_b32 v15, v13, v15, vcc
    v_lshl_add_u32 v9, v12, 10, v9
    v_lshl_add_u32 v9, v14, 6, v9
    v_add_u32 v10, v9, v15
    s_and_b32 s31, s28, 1
    s_cmp_eq_u32 s31, 1
    s_cselect_b64 vcc, -1, 0
    v_cndmask_b32 v14, v9, v10, vcc
    s_mul_i32 s31, s28, 36864
    s_add_u32 s37, s31, 0x3a00000
    s_add_u32 s38, s31, 0x3a00000
    s_add_u32 s39, s31, 0x3a02400
    s_add_u32 s40, s31, 0x3a02400
    s_add_u32 s41, s31, 0x3a04800
    s_add_u32 s42, s31, 0x3a04800
    s_add_u32 s43, s31, 0x3a06c00
    s_add_u32 s47, s31, 0x3a06c00
    s_lshr_b32 s31, s28, 1
    s_mul_i32 s31, s31, 9216
    s_add_u32 s48, s31, 0x3a12000
    s_cmp_ge_u32 s26, 4
    s_cbranch_scc1 L_p0_n2
    s_lshl_b32 s31, s26, 2
    s_add_u32 s31, s31, s20
    s_lshl_b32 s31, s31, 12
    s_add_u32 s31, s31, 0x4508000
    v_and_b32 v56, 0x380, v1
    v_add_u32 v56, v56, v1
    v_mov_b32 v52, 0
    v_mov_b32 v53, 0
    v_mov_b32 v54, 0
    v_mov_b32 v55, 0
    buffer_store_dwordx4 v[52:55], v56, s[4:7], s31 offen offset:0 sc1
    buffer_store_dwordx4 v[52:55], v56, s[4:7], s31 offen offset:2048 sc1
L_p0_n2:
    s_waitcnt vmcnt(0)
    s_barrier
    ds_read_b64_tr_b16 v[16:17], v4 offset:0
    ds_read_b64_tr_b16 v[18:19], v4 offset:2560
    ds_read_b64_tr_b16 v[20:21], v4 offset:4608
    ds_read_b64_tr_b16 v[22:23], v4 offset:7168
    ds_read_b64_tr_b16 v[24:25], v4 offset:9216
    ds_read_b64_tr_b16 v[26:27], v4 offset:11776
    ds_read_b64_tr_b16 v[28:29], v4 offset:13824
    ds_read_b64_tr_b16 v[30:31], v4 offset:16384
    ds_read_b64_tr_b16 v[32:33], v4 offset:18432
    ds_read_b64_tr_b16 v[34:35], v4 offset:20992
    ds_read_b64_tr_b16 v[36:37], v4 offset:23040
    ds_read_b64_tr_b16 v[38:39], v4 offset:25600
    ds_read_b64_tr_b16 v[40:41], v4 offset:27648
    ds_read_b64_tr_b16 v[42:43], v4 offset:30208
    ds_read_b64_tr_b16 v[44:45], v4 offset:32256
    ds_read_b64_tr_b16 v[46:47], v4 offset:34816
    ds_read_b64_tr_b16 v[48:49], v5 offset:2048
    ds_read_b64_tr_b16 v[50:51], v5 offset:6656
    s_waitcnt lgkmcnt(15)
    s_mov_b32 s31, s37
    buffer_store_dwordx4 v[16:19], v9, s[4:7], s31 offen sc1
    s_waitcnt lgkmcnt(14)
    s_mov_b32 s31, s38
    buffer_store_dwordx4 v[20:23], v10, s[4:7], s31 offen sc1
    s_waitcnt lgkmcnt(12)
    s_mov_b32 s31, s39
    buffer_store_dwordx4 v[24:27], v9, s[4:7], s31 offen sc1
    s_waitcnt lgkmcnt(10)
    s_mov_b32 s31, s40
    buffer_store_dwordx4 v[28:31], v10, s[4:7], s31 offen sc1
    s_waitcnt lgkmcnt(8)
    s_mov_b32 s31, s41
    buffer_store_dwordx4 v[32:35], v9, s[4:7], s31 offen sc1
    s_waitcnt lgkmcnt(6)
    s_mov_b32 s31, s42
    buffer_store_dwordx4 v[36:39], v10, s[4:7], s31 offen sc1
    s_waitcnt lgkmcnt(4)
    s_mov_b32 s31, s43
    buffer_store_dwordx4 v[40:43], v9, s[4:7], s31 offen sc1
    s_waitcnt lgkmcnt(2)
    s_mov_b32 s31, s47
    buffer_store_dwordx4 v[44:47], v10, s[4:7], s31 offen sc1
    s_waitcnt lgkmcnt(0)
    s_mov_b32 s31, s48
    buffer_store_dwordx4 v[48:51], v14, s[4:7], s31 offen sc1
    s_mov_b32 s46, 1
    s_mov_b32 s27, 32
    s_branch L_p0_cd
L_p0_wq:
    s_mov_b32 s32, s38
    s_mov_b32 s33, s39
    s_mov_b32 s34, 0x1e6000
    s_mov_b32 s35, 0x20000
    s_sub_u32 s23, s2, 128
    s_mul_i32 s25, s23, 19
    s_lshr_b32 s25, s25, 9
    s_mul_i32 s24, s25, 27
    s_sub_u32 s24, s23, s24
    s_mul_i32 s26, s25, 497664
    s_lshl_b32 s31, s24, 7
    s_add_u32 s26, s26, s31
    v_lshrrev_b32 v4, 7, v1
    v_mul_u32_u24 v4, 3456, v4
    v_lshrrev_b32 v5, 4, v1
    v_and_b32 v5, 16, v5
    v_xor_b32 v5, v5, v1
    v_and_b32 v5, 0x70, v5
    v_add_u32 v4, v4, v5
    s_mul_i32 s31, s20, 110592
    s_add_u32 s27, s26, s31
    s_mul_i32 s30, s20, 4224
    s_add_u32 m0, s30, 0
    s_add_u32 s31, s27, 0
    buffer_load_dwordx4 v4, s[32:35], s31 offen  lds
    s_add_u32 m0, s30, 1056
    s_add_u32 s31, s27, 27648
    buffer_load_dwordx4 v4, s[32:35], s31 offen  lds
    s_add_u32 m0, s30, 2112
    s_add_u32 s31, s27, 55296
    buffer_load_dwordx4 v4, s[32:35], s31 offen  lds
    s_add_u32 m0, s30, 3168
    s_add_u32 s31, s27, 82944
    buffer_load_dwordx4 v4, s[32:35], s31 offen  lds
    s_cmp_ge_u32 s20, 2
    s_cbranch_scc1 L_p0_q5
    s_mul_i32 s31, s29, 1056
    s_add_u32 m0, s31, 16896
    s_mul_i32 s31, s29, 27648
    s_add_u32 s31, s31, s26
    s_add_u32 s31, s31, 442368
    buffer_load_dwordx4 v4, s[32:35], s31 offen  lds
L_p0_q5:
    v_lshrrev_b32 v7, 2, v2
    v_and_b32 v8, 3, v2
    s_lshl_b32 s31, s20, 5
    v_and_b32 v9, 2, v7
    v_xor_b32 v9, v9, v3
    v_lshlrev_b32 v9, 3, v9
    v_lshl_add_u32 v9, v7, 7, v9
    v_add_u32 v9, s31, v9
    v_mul_u32_u24 v4, 1056, v8
    v_add_u32 v4, v4, v9
    v_and_b32 v5, 1, v2
    v_mul_u32_u24 v5, 9504, v5
    v_add_u32 v5, v5, v9
    s_lshl_b32 s31, s24, 2
    s_add_u32 s31, s31, s20
    v_lshlrev_b32 v8, 4, v8
    v_lshl_add_u32 v8, v7, 8, v8
    v_lshl_add_u32 v7, s31, 2, v3
    v_mul_u32_u24 v9, 57, v7
    v_lshrrev_b32 v9, 13, v9
    v_mul_u32_u24 v10, 144, v9
    v_sub_u32 v10, v7, v10
    v_mul_u32_u24 v12, 57, v10
    v_lshrrev_b32 v12, 9, v12
    v_mul_u32_u24 v13, 9, v12
    v_sub_u32 v13, v10, v13
    v_cmp_lt_u32 s[36:37], 4, v13
    v_cmp_eq_u32 s[38:39], 4, v13
    v_cmp_eq_u32 s[40:41], 2, v9
    v_lshlrev_b32 v14, 1, v9
    v_add_u32 v15, 1, v14
    v_subrev_u32 v10, 5, v13
    v_cndmask_b32 v14, v14, v15, s[36:37]
    v_cndmask_b32 v13, v13, v10, s[36:37]
    v_cndmask_b32 v14, v14, 6, s[38:39]
    v_cndmask_b32 v13, v13, v9, s[38:39]
    s_and_b64 s[40:41], s[40:41], s[38:39]
    s_mov_b32 s31, 129024
    v_mul_lo_u32 v9, v12, s31
    v_add_u32 v9, v9, v8
    v_lshl_add_u32 v9, v14, 10, v9
    v_lshl_add_u32 v9, v13, 6, v9
    s_and_b32 s31, s25, 1
    v_lshrrev_b32 v8, 3, v2
    v_cmp_eq_u32 vcc, s31, v8
    v_add_u32 v15, 64, v9
    v_cndmask_b32 v15, v6, v15, s[40:41]
    v_cndmask_b32 v8, v6, v9, vcc
    v_lshlrev_b32 v10, 2, v2
    v_lshl_add_u32 v10, v7, 4, v10
    v_cmp_gt_u32 vcc, 4, v2
    s_lshl_b32 s45, s25, 13
    s_add_u32 s45, s45, 0x4400000
    v_cndmask_b32 v10, v6, v10, vcc
    s_mul_i32 s42, s25, 28672
    s_add_u32 s42, s42, 0x3800000
    s_lshr_b32 s44, s25, 1
    s_mul_i32 s44, s44, 7168
    s_add_u32 s44, s44, 0x381c000
    s_mul_i32 s26, s24, 29
    s_lshr_b32 s26, s26, 8
    s_mul_i32 s27, s26, 9
    s_sub_u32 s27, s24, s27
    s_lshl_b32 s27, s27, 4
    s_add_u32 s28, s27, 16
    v_lshrrev_b32 v254, 4, v1
    v_mul_u32_u24 v7, 9, v254
    v_add_u32 v255, 9, v7
    v_min_u32 v255, s28, v255
    v_max_u32 v7, s27, v7
    v_sub_u32 v255, v255, v7
    v_cmp_lt_i32 vcc, 0, v255
    v_lshlrev_b32 v254, 8, v254
    v_mov_b32 v14, 0x3f003f00
    v_cndmask_b32 v254, v6, v254, vcc
    s_cmp_eq_u64 s[40:41], 0
    s_cbranch_scc1 L_p0_np
    v_mov_b32 v52, 0
    v_mov_b32 v53, 0
    v_mov_b32 v54, 0
    v_mov_b32 v55, 0
    s_add_u32 s31, s42, 0
    buffer_store_dwordx4 v[52:55], v15, s[4:7], s31 offen sc1
    s_add_u32 s31, s42, 7168
    buffer_store_dwordx4 v[52:55], v15, s[4:7], s31 offen sc1
    s_add_u32 s31, s42, 14336
    buffer_store_dwordx4 v[52:55], v15, s[4:7], s31 offen sc1
    s_add_u32 s31, s42, 21504
    buffer_store_dwordx4 v[52:55], v15, s[4:7], s31 offen sc1
    s_mov_b32 s31, s44
    buffer_store_dwordx4 v[52:55], v15, s[4:7], s31 offen sc1
    s_waitcnt vmcnt(5)
    s_branch L_p0_n3
L_p0_np:
    s_waitcnt vmcnt(0)
L_p0_n3:
    s_barrier
    ds_read_b64_tr_b16 v[16:17], v4 offset:0
    ds_read_b64_tr_b16 v[18:19], v4 offset:512
    ds_read_b64_tr_b16 v[20:21], v4 offset:4224
    ds_read_b64_tr_b16 v[22:23], v4 offset:4736
    ds_read_b64_tr_b16 v[24:25], v4 offset:9504
    ds_read_b64_tr_b16 v[26:27], v4 offset:10016
    ds_read_b64_tr_b16 v[28:29], v4 offset:13728
    ds_read_b64_tr_b16 v[30:31], v4 offset:14240
    ds_read_b64_tr_b16 v[32:33], v5 offset:8448
    ds_read_b64_tr_b16 v[34:35], v5 offset:8960
    s_waitcnt lgkmcnt(8)
    s_add_u32 s31, s42, 0
    buffer_store_dwordx4 v[16:19], v9, s[4:7], s31 offen sc1
    s_waitcnt lgkmcnt(6)
    s_add_u32 s31, s42, 7168
    buffer_store_dwordx4 v[20:23], v9, s[4:7], s31 offen sc1
    s_waitcnt lgkmcnt(4)
    s_add_u32 s31, s42, 14336
    buffer_store_dwordx4 v[24:27], v9, s[4:7], s31 offen sc1
    s_waitcnt lgkmcnt(2)
    s_add_u32 s31, s42, 21504
    buffer_store_dwordx4 v[28:31], v9, s[4:7], s31 offen sc1
    s_waitcnt lgkmcnt(0)
    s_mov_b32 s31, s44
    buffer_store_dwordx4 v[32:35], v8, s[4:7], s31 offen sc1
    v_dot2_f32_bf16 v12, v16, v11, 0
    v_dot2_f32_bf16 v13, v17, v11, 0
    v_dot2_f32_bf16 v12, v18, v11, v12
    v_dot2_f32_bf16 v13, v19, v11, v13
    v_dot2_f32_bf16 v12, v20, v11, v12
    v_dot2_f32_bf16 v13, v21, v11, v13
    v_dot2_f32_bf16 v12, v22, v11, v12
    v_dot2_f32_bf16 v13, v23, v11, v13
    v_dot2_f32_bf16 v12, v24, v11, v12
    v_dot2_f32_bf16 v13, v25, v11, v13
    v_dot2_f32_bf16 v12, v26, v11, v12
    v_dot2_f32_bf16 v13, v27, v11, v13
    v_dot2_f32_bf16 v12, v28, v11, v12
    v_dot2_f32_bf16 v13, v29, v11, v13
    v_dot2_f32_bf16 v12, v30, v11, v12
    v_dot2_f32_bf16 v13, v31, v11, v13
    v_dot2_f32_bf16 v12, v32, v14, v12
    v_dot2_f32_bf16 v13, v33, v14, v13
    v_dot2_f32_bf16 v12, v34, v14, v12
    v_dot2_f32_bf16 v13, v35, v14, v13
    s_nop 2
    v_add_f32 v12, v12, v13
    s_nop 1
    v_add_f32_dpp v12, v12, v12 row_ror:4 row_mask:0xf bank_mask:0xf
    s_nop 1
    v_add_f32_dpp v12, v12, v12 row_ror:8 row_mask:0xf bank_mask:0xf
    buffer_store_dword v12, v10, s[4:7], s45 offen sc1
    s_branch L_p0_ce
L_p0_x:
    s_mov_b32 s32, s36
    s_mov_b32 s33, s37
    s_mov_b32 s34, 0x240000
    s_mov_b32 s35, 0x20000
    s_mul_i32 s26, s2, 18432
    s_mul_i32 s31, s20, 288
    s_add_u32 s28, s26, s31
    v_lshrrev_b32 v4, 6, v1
    v_mul_u32_u24 v4, 1152, v4
    v_and_b32 v5, 48, v1
    v_add_u32 v4, v4, v5
    s_add_u32 m0, s30, 0
    s_add_u32 s31, s28, 0
    buffer_load_dwordx4 v4, s[32:35], s31 offen  lds
    s_add_u32 m0, s30, 1024
    s_add_u32 s31, s28, 64
    buffer_load_dwordx4 v4, s[32:35], s31 offen  lds
    s_add_u32 m0, s30, 2048
    s_add_u32 s31, s28, 144
    buffer_load_dwordx4 v4, s[32:35], s31 offen  lds
    s_add_u32 m0, s30, 3072
    s_add_u32 s31, s28, 208
    buffer_load_dwordx4 v4, s[32:35], s31 offen  lds
    s_mul_i32 s31, s29, 576
    s_add_u32 s31, s31, s26
    v_mul_u32_u24 v7, 1152, v2
    v_mul_u32_u24 v5, 144, v3
    v_add_u32 v5, v5, v7
    buffer_load_dwordx4 v[32:35], v5, s[32:35], s31 offen offset:128
    s_lshl_b32 s27, s29, 10
    s_add_u32 s27, s27, 16384
    s_barrier
    v_lshlrev_b32 v4, 6, v2
    v_lshl_add_u32 v4, v3, 4, v4
    v_add_u32 v4, s30, v4
    s_add_u32 s26, s26, 0x0
    s_add_u32 s42, s26, s30
    s_add_u32 s44, s26, s27
    s_lshl_b32 s45, s2, 10
    s_lshl_b32 s31, s20, 8
    s_add_u32 s45, s45, s31
    s_add_u32 s45, s45, 0x1b00000
    v_cmp_gt_u32 vcc, 2, v3
    v_lshrrev_b32 v10, 1, v1
    s_mov_b32 s46, 2
    v_cndmask_b32 v10, v6, v10, vcc
    s_lshr_b32 s27, s2, 3
    s_add_u32 s27, s27, 48
    s_waitcnt vmcnt(0)
    ds_read_b128 v[16:19], v4 offset:0
    ds_read_b128 v[20:23], v4 offset:1024
    ds_read_b128 v[24:27], v4 offset:2048
    ds_read_b128 v[28:31], v4 offset:3072
    s_waitcnt lgkmcnt(3)
    buffer_store_dwordx4 v[16:19], v1, s[4:7], s42 offen offset:0 sc1
    s_waitcnt lgkmcnt(2)
    buffer_store_dwordx4 v[20:23], v1, s[4:7], s42 offen offset:1024 sc1
    s_waitcnt lgkmcnt(1)
    buffer_store_dwordx4 v[24:27], v1, s[4:7], s42 offen offset:2048 sc1
    s_waitcnt lgkmcnt(0)
    buffer_store_dwordx4 v[28:31], v1, s[4:7], s42 offen offset:3072 sc1
    v_dot2_f32_bf16 v12, v16, v11, 0
    v_dot2_f32_bf16 v13, v16, v16, 0
    v_dot2_f32_bf16 v12, v17, v11, v12
    v_dot2_f32_bf16 v13, v17, v17, v13
    v_dot2_f32_bf16 v12, v18, v11, v12
    v_dot2_f32_bf16 v13, v18, v18, v13
    v_dot2_f32_bf16 v12, v19, v11, v12
    v_dot2_f32_bf16 v13, v19, v19, v13
    v_dot2_f32_bf16 v12, v20, v11, v12
    v_dot2_f32_bf16 v13, v20, v20, v13
    v_dot2_f32_bf16 v12, v21, v11, v12
    v_dot2_f32_bf16 v13, v21, v21, v13
    v_dot2_f32_bf16 v12, v22, v11, v12
    v_dot2_f32_bf16 v13, v22, v22, v13
    v_dot2_f32_bf16 v12, v23, v11, v12
    v_dot2_f32_bf16 v13, v23, v23, v13
    v_dot2_f32_bf16 v12, v24, v11, v12
    v_dot2_f32_bf16 v13, v24, v24, v13
    v_dot2_f32_bf16 v12, v25, v11, v12
    v_dot2_f32_bf16 v13, v25, v25, v13
    v_dot2_f32_bf16 v12, v26, v11, v12
    v_dot2_f32_bf16 v13, v26, v26, v13
    v_dot2_f32_bf16 v12, v27, v11, v12
    v_dot2_f32_bf16 v13, v27, v27, v13
    v_dot2_f32_bf16 v12, v28, v11, v12
    v_dot2_f32_bf16 v13, v28, v28, v13
    v_dot2_f32_bf16 v12, v29, v11, v12
    v_dot2_f32_bf16 v13, v29, v29, v13
    v_dot2_f32_bf16 v12, v30, v11, v12
    v_dot2_f32_bf16 v13, v30, v30, v13
    v_dot2_f32_bf16 v12, v31, v11, v12
    v_dot2_f32_bf16 v13, v31, v31, v13
    s_waitcnt lgkmcnt(0)
    s_cmp_ge_u32 s20, 2
    s_cbranch_scc1 L_p0_xs
    buffer_store_dwordx4 v[32:35], v1, s[4:7], s44 offen sc1
    v_dot2_f32_bf16 v12, v32, v11, v12
    v_dot2_f32_bf16 v13, v32, v32, v13
    v_dot2_f32_bf16 v12, v33, v11, v12
    v_dot2_f32_bf16 v13, v33, v33, v13
    v_dot2_f32_bf16 v12, v34, v11, v12
    v_dot2_f32_bf16 v13, v34, v34, v13
    v_dot2_f32_bf16 v12, v35, v11, v12
    v_dot2_f32_bf16 v13, v35, v35, v13
L_p0_xs:
    s_nop 2
    v_mov_b32 v14, v12
    v_mov_b32 v15, v13
    s_nop 1
    v_permlane32_swap_b32 v12, v14
    v_permlane32_swap_b32 v13, v15
    v_add_f32 v12, v12, v14
    v_add_f32 v13, v13, v15
    buffer_store_dwordx2 v[12:13], v10, s[4:7], s45 offen sc1
L_p0_cd:
    v_cmp_eq_u32 vcc, 0, v1
    s_lshl_b32 s27, s27, 8
    v_mov_b32 v255, s46
    v_mov_b32 v254, s27
    v_cndmask_b32 v254, v6, v254, vcc
L_p0_ce:
    s_mov_b32 s48, s58
    s_mov_b32 s49, s59
    s_mov_b32 s50, 0x100
    s_mov_b32 s51, 0x20000
    v_mov_b32 v4, 0
    buffer_load_dword v246, v4, s[48:51], 0 offen sc1
    s_mov_b32 s16, s56
    s_mov_b32 s17, s57
    s_mov_b32 s18, 0x240000
    s_mov_b32 s19, 0x20000
    s_branch L_m_cl
L_d1_first:
    v_cmp_gt_u32 vcc, 4, v246
    v_mov_b32 v4, 0
    s_mov_b32 s46, 0x4500000
    s_cbranch_vccz L_pd_dbg
    s_mov_b32 s60, 65536
L_poll_dbg:
    buffer_load_dword v5, v4, s[48:51], 0 offen sc1
    s_waitcnt vmcnt(0)
    v_cmp_gt_u32 vcc, 4, v5
    s_sub_u32 s60, s60, 1
    s_cbranch_scc1 L_pd_dbg
    s_cbranch_vccz L_pd_dbg
    s_sleep 4
    s_branch L_poll_dbg
L_pd_dbg:
    buffer_atomic_add v255, v254, s[4:7], s46 offen sc1
    s_branch L_ns_d1
L_ld_m:
    s_cmp_lg_u32 s2, 254
    s_cbranch_scc1 L_p0_nz
    s_lshl_b32 s31, s20, 12
    s_add_u32 s31, s31, 0x4500000
    v_and_b32 v56, 0x380, v1
    v_add_u32 v56, v56, v1
    v_mov_b32 v52, 0
    v_mov_b32 v53, 0
    v_mov_b32 v54, 0
    v_mov_b32 v55, 0
    buffer_store_dwordx4 v[52:55], v56, s[4:7], s31 offen offset:0 sc1
    buffer_store_dwordx4 v[52:55], v56, s[4:7], s31 offen offset:2048 sc1
    s_waitcnt vmcnt(0)
    s_mov_b32 s53, 1
    s_atomic_add s53, s[58:59], 0
L_p0_nz:
    s_mov_b32 s8, s46
    s_mov_b32 s9, s47
    s_mov_b32 s10, 0x800000
    s_mov_b32 s11, 0x20000
    s_mov_b32 s12, s48
    s_mov_b32 s13, s49
    s_mov_b32 s14, 0x1000
    s_mov_b32 s15, 0x20000
    v_mov_b32 v2, 163808
    v_mov_b32 v4, 0
    v_mov_b32 v5, 0
    ds_write2_b64 v2, v[4:5], v[4:5] offset0:0 offset1:1
    s_waitcnt lgkmcnt(0)
    v_bfe_u32 v2, v1, 4, 4
    v_lshrrev_b32 v3, 8, v1
    v_bfrev_b32 v6, 1
    v_mov_b32 v11, 0x3f803f80
    s_mul_i32 s30, s20, 9216
    s_cmp_lt_u32 s2, 144
    s_cbranch_scc1 L_p0_wi
    s_cmp_lt_u32 s2, 216
    s_cbranch_scc1 L_p0_wu
    v_mov_b32 v9, v6
    v_mov_b32 v10, v6
    v_mov_b32 v14, v6
    v_mov_b32 v15, v6
    s_mov_b32 s37, 0
    s_mov_b32 s38, 0
    s_mov_b32 s39, 0
    s_mov_b32 s40, 0
    s_mov_b32 s41, 0
    s_mov_b32 s42, 0
    s_mov_b32 s43, 0
    s_mov_b32 s47, 0
    s_mov_b32 s48, 0
    s_mov_b32 s49, 0
    s_barrier
    s_barrier
    s_barrier
    s_branch L_p0_ld
L_p0_wu:
    s_sub_u32 s26, s2, 144
    s_mul_i32 s28, s26, 57
    s_lshr_b32 s28, s28, 9
    s_mul_i32 s27, s28, 9
    s_sub_u32 s27, s26, s27
    s_mov_b32 s32, s50
    s_mov_b32 s33, s51
    s_mov_b32 s34, 0x288000
    s_mov_b32 s35, 0x20000
    s_mul_i32 s29, s28, 331776
    s_lshl_b32 s31, s27, 7
    s_add_u32 s29, s29, s31
    s_mul_i32 s31, s20, 82944
    s_add_u32 s29, s29, s31
    s_mul_i32 s30, s20, 9216
    v_lshrrev_b32 v4, 7, v1
    v_mul_u32_u24 v4, 1152, v4
    v_and_b32 v5, 0x70, v1
    v_bfe_u32 v7, v1, 8, 2
    v_lshlrev_b32 v7, 5, v7
    v_xor_b32 v5, v5, v7
    v_add_u32 v4, v4, v5
    s_barrier
    s_barrier
    s_barrier
    s_add_u32 m0, s30, 91904
    s_add_u32 s31, s29, 0
    buffer_load_dwordx4 v4, s[32:35], s31 offen  lds
    s_add_u32 m0, s30, 92928
    s_add_u32 s31, s29, 9216
    buffer_load_dwordx4 v4, s[32:35], s31 offen  lds
    s_add_u32 m0, s30, 93952
    s_add_u32 s31, s29, 18432
    buffer_load_dwordx4 v4, s[32:35], s31 offen  lds
    s_add_u32 m0, s30, 94976
    s_add_u32 s31, s29, 27648
    buffer_load_dwordx4 v4, s[32:35], s31 offen  lds
    s_add_u32 m0, s30, 96000
    s_add_u32 s31, s29, 36864
    buffer_load_dwordx4 v4, s[32:35], s31 offen  lds
    s_add_u32 m0, s30, 97024
    s_add_u32 s31, s29, 46080
    buffer_load_dwordx4 v4, s[32:35], s31 offen  lds
    s_add_u32 m0, s30, 98048
    s_add_u32 s31, s29, 55296
    buffer_load_dwordx4 v4, s[32:35], s31 offen  lds
    s_add_u32 m0, s30, 99072
    s_add_u32 s31, s29, 64512
    buffer_load_dwordx4 v4, s[32:35], s31 offen  lds
    s_add_u32 m0, s30, 100096
    s_add_u32 s31, s29, 73728
    buffer_load_dwordx4 v4, s[32:35], s31 offen  lds
    v_lshrrev_b32 v7, 2, v2
    v_and_b32 v8, 3, v2
    v_bfe_u32 v9, v1, 7, 2
    v_xor_b32 v9, s20, v9
    v_lshlrev_b32 v9, 5, v9
    v_lshl_add_u32 v9, v7, 7, v9
    v_lshl_add_u32 v9, v8, 3, v9
    v_add_u32 v9, 91904, v9
    v_mul_u32_u24 v4, 512, v3
    v_add_u32 v4, v4, v9
    v_mul_u32_u24 v5, 512, v3
    v_add_u32 v5, v5, v9
    s_lshl_b32 s31, s27, 2
    s_add_u32 s31, s31, s20
    v_lshl_add_u32 v7, s31, 2, v7
    v_lshlrev_b32 v8, 4, v8
    v_lshl_add_u32 v8, v3, 8, v8
    v_mul_u32_u24 v9, 57, v7
    v_lshrrev_b32 v9, 10, v9
    v_mul_u32_u24 v10, 18, v9
    v_sub_u32 v10, v7, v10
    v_lshrrev_b32 v12, 3, v10
    v_and_b32 v13, 1, v10
    v_lshl_add_u32 v12, v12, 1, v13
    v_bfe_u32 v14, v10, 1, 2
    v_cmp_gt_u32 vcc, 16, v10
    v_mul_u32_u24 v9, 331776, v9
    v_add_u32 v9, v9, v8
    v_cndmask_b32 v12, 8, v12, vcc
    v_cndmask_b32 v14, v13, v14, vcc
    v_mov_b32 v15, 0x1000
    v_mov_b32 v13, 0x80
    v_cndmask_b32 v15, v13, v15, vcc
    v_lshl_add_u32 v9, v12, 10, v9
    v_lshl_add_u32 v9, v14, 6, v9
    v_add_u32 v10, v9, v15
    s_and_b32 s31, s28, 1
    s_cmp_eq_u32 s31, 1
    s_cselect_b64 vcc, -1, 0
    v_cndmask_b32 v14, v9, v10, vcc
    s_mul_i32 s31, s28, 9216
    s_add_u32 s37, s31, 0x4100000
    s_add_u32 s38, s31, 0x4100000
    s_add_u32 s39, s31, 0x4112000
    s_add_u32 s40, s31, 0x4112000
    s_add_u32 s41, s31, 0x4124000
    s_add_u32 s42, s31, 0x4124000
    s_add_u32 s43, s31, 0x4136000
    s_add_u32 s47, s31, 0x4136000
    s_lshr_b32 s31, s28, 1
    s_mul_i32 s31, s31, 9216
    s_add_u32 s48, s31, 0x4148000
    v_mov_b32 v15, v6
    s_mov_b32 s49, 0
    s_branch L_p0_ld
L_p0_wi:
    s_mov_b32 s26, s2
    s_mul_i32 s28, s26, 57
    s_lshr_b32 s28, s28, 12
    s_mul_i32 s27, s28, 72
    s_sub_u32 s27, s26, s27
    s_mov_b32 s32, s44
    s_mov_b32 s33, s45
    s_mov_b32 s34, 0x510000
    s_mov_b32 s35, 0x20000
    s_mul_i32 s29, s28, 2654208
    s_lshl_b32 s31, s27, 7
    s_add_u32 s29, s29, s31
    s_mul_i32 s31, s20, 663552
    s_add_u32 s29, s29, s31
    s_mul_i32 s30, s20, 9792
    v_lshrrev_b32 v4, 7, v1
    v_mul_u32_u24 v4, 9216, v4
    v_and_b32 v5, 0x70, v1
    v_bfe_u32 v7, v1, 8, 1
    v_lshlrev_b32 v7, 5, v7
    v_xor_b32 v5, v5, v7
    v_add_u32 v4, v4, v5
    s_barrier
    s_barrier
    s_barrier
    s_add_u32 m0, s30, 91904
    s_add_u32 s31, s29, 0
    buffer_load_dwordx4 v4, s[32:35], s31 offen  lds
    s_add_u32 m0, s30, 92992
    s_add_u32 s31, s29, 73728
    buffer_load_dwordx4 v4, s[32:35], s31 offen  lds
    s_add_u32 m0, s30, 94080
    s_add_u32 s31, s29, 147456
    buffer_load_dwordx4 v4, s[32:35], s31 offen  lds
    s_add_u32 m0, s30, 95168
    s_add_u32 s31, s29, 221184
    buffer_load_dwordx4 v4, s[32:35], s31 offen  lds
    s_add_u32 m0, s30, 96256
    s_add_u32 s31, s29, 294912
    buffer_load_dwordx4 v4, s[32:35], s31 offen  lds
    s_add_u32 m0, s30, 97344
    s_add_u32 s31, s29, 368640
    buffer_load_dwordx4 v4, s[32:35], s31 offen  lds
    s_add_u32 m0, s30, 98432
    s_add_u32 s31, s29, 442368
    buffer_load_dwordx4 v4, s[32:35], s31 offen  lds
    s_add_u32 m0, s30, 99520
    s_add_u32 s31, s29, 516096
    buffer_load_dwordx4 v4, s[32:35], s31 offen  lds
    s_add_u32 m0, s30, 100608
    s_add_u32 s31, s29, 589824
    buffer_load_dwordx4 v4, s[32:35], s31 offen  lds
    v_lshrrev_b32 v7, 2, v2
    v_and_b32 v8, 3, v2
    v_bfe_u32 v9, v1, 7, 1
    v_xor_b32 v9, s20, v9
    v_lshlrev_b32 v9, 5, v9
    v_lshl_add_u32 v9, v7, 7, v9
    v_lshl_add_u32 v9, v8, 3, v9
    v_add_u32 v9, 91904, v9
    v_mul_u32_u24 v4, 1088, v3
    v_add_u32 v4, v4, v9
    v_mul_u32_u24 v5, 9792, v3
    v_add_u32 v5, v5, v9
    s_lshl_b32 s31, s27, 2
    s_add_u32 s31, s31, s20
    v_lshl_add_u32 v7, s31, 2, v7
    v_lshlrev_b32 v8, 4, v8
    v_lshl_add_u32 v8, v3, 8, v8
    s_cmp_lt_u32 s31, 144
    s_cselect_b32 s23, 1, 0
    s_cselect_b32 s24, 0, 144
    s_sub_u32 s26, s31, s24
    s_mul_i32 s25, s26, 57
    s_lshr_b32 s25, s25, 9
    s_mul_i32 s24, s25, 9
    s_sub_u32 s24, s26, s24
    s_lshl_b32 s26, s25, 1
    s_add_u32 s26, s26, s23
    s_mul_i32 s26, s26, 165888
    s_lshl_b32 s31, s24, 10
    s_add_u32 s26, s26, s31
    s_add_u32 s26, s26, 0x3b00000
    s_mul_i32 s31, s28, 9216
    s_add_u32 s48, s26, s31
    s_add_u32 s48, s48, 147456
    s_lshl_b32 s31, s31, 3
    s_add_u32 s26, s26, s31
    s_add_u32 s37, s26, 0
    s_add_u32 s38, s26, 9216
    s_add_u32 s39, s26, 18432
    s_add_u32 s40, s26, 27648
    s_add_u32 s41, s26, 36864
    s_add_u32 s42, s26, 46080
    s_add_u32 s43, s26, 55296
    s_add_u32 s47, s26, 64512
    s_lshl_b32 s49, s25, 12
    s_mul_i32 s31, s28, 1152
    s_add_u32 s49, s49, s31
    s_mul_i32 s31, s23, 576
    s_add_u32 s49, s49, s31
    s_lshl_b32 s31, s24, 6
    s_add_u32 s49, s49, s31
    s_add_u32 s49, s49, 0x4410000
    v_cmp_eq_u32 vcc, 0, v3
    v_lshlrev_b32 v15, 2, v2
    v_mov_b32 v9, v1
    v_mov_b32 v10, v1
    v_mov_b32 v14, v1
    v_cndmask_b32 v15, v6, v15, vcc
L_p0_ld:
    s_waitcnt lgkmcnt(0)
    s_branch L_m_l1
L_m_cl:
    s_and_b32 s25, s2, 7
    s_lshr_b32 s26, s2, 3
    s_lshr_b32 s23, s25, 1
    s_lshl_b32 s23, s23, 2
    s_lshr_b32 s27, s26, 3
    s_add_u32 s23, s23, s27
    s_and_b32 s24, s25, 1
    s_lshl_b32 s24, s24, 3
    s_and_b32 s27, s26, 7
    s_add_u32 s24, s24, s27
    s_lshl_b32 s30, s23, 3
    s_lshl_b32 s31, s20, 1
    s_add_u32 s31, s30, s31
    s_mul_i32 s29, s31, 18432
    s_add_u32 s29, s29, s21
    s_add_u32 s35, s29, 0x600000
    s_add_u32 s29, s29, 0x0
    s_max_u32 s30, s30, 1
    s_sub_u32 s30, s30, 1
    s_lshl_b32 s30, s30, 10
    s_add_u32 s30, s30, s21
    s_add_u32 s30, s30, 0x1b00000
    s_lshl_b32 s32, s31, 10
    s_add_u32 s32, s32, s21
    s_add_u32 s32, s32, 0x1b00000
    v_bfe_u32 v2, v1, 4, 4
    v_lshrrev_b32 v3, 8, v1
    s_lshl_b32 s33, s20, 2
    s_lshr_b32 s33, 0x3362, s33
    s_and_b32 s33, s33, 15
    s_min_u32 s34, s20, 1
    s_add_u32 s34, s34, 4
    s_lshl_b32 s36, s33, 10
    s_lshl_b32 s37, s34, 10
    v_add_u32 v247, 64512, v1
    v_add_u32 v248, 131072, v1
    v_add_u32 v249, s36, v1
    v_add_u32 v250, s36, v247
    v_add_u32 v251, s37, v1
    v_add_u32 v252, s37, v247
    v_add_u32 v253, 18432, v1
    v_lshrrev_b32 v0, 1, v1
    s_add_u32 s38, s29, 0
    s_add_u32 s39, s29, 4096
    s_add_u32 s40, s29, 8192
    s_add_u32 s41, s29, 12288
    s_add_u32 s42, s29, 16384
    s_max_u32 s44, s23, 1
    s_sub_u32 s44, s44, 1
    s_lshl_b32 s52, s22, 7
    s_add_u32 s52, s52, s23
    s_lshl_b32 s52, s52, 8
    s_add_u32 s52, s52, 0x4503000
    s_add_u32 s52, s52, s4
    s_addc_u32 s53, s5, 0
    s_lshl_b32 s54, s22, 7
    s_add_u32 s54, s54, s44
    s_lshl_b32 s54, s54, 8
    s_add_u32 s54, s54, 0x4503000
    s_add_u32 s54, s54, s4
    s_addc_u32 s55, s5, 0
    s_lshl_b32 s44, s24, 8
    s_add_u32 s44, s44, 0x4500000
    s_add_u32 s44, s44, s4
    s_addc_u32 s45, s5, 0
    s_waitcnt vmcnt(0)
    s_barrier
    s_cmp_lg_u32 s20, 0
    s_cbranch_scc1 L_ns_d1
    s_cmp_eq_u32 s22, 0
    s_cbranch_scc1 L_d1_first
    s_mov_b32 s56, 1
    s_atomic_add s56, s[50:51], 0
L_ns_d1:
    s_barrier
    s_cmp_lg_u32 s20, 0
    s_cbranch_scc1 L_pd_d1
    s_mov_b32 s60, 65536
L_poll_d1:
    s_mov_b32 s57, 0
    s_atomic_add s57, s[52:53], 0 glc
    s_mov_b32 s58, 0
    s_atomic_add s58, s[54:55], 0 glc
    s_mov_b32 s59, 0
    s_atomic_add s59, s[44:45], 0 glc
    s_waitcnt lgkmcnt(0)
    s_cmp_ge_u32 s59, 108
    s_cselect_b32 s59, 16, 0
    s_min_u32 s57, s57, s58
    s_min_u32 s57, s57, s59
    s_cmp_ge_u32 s57, 16
    s_cbranch_scc1 L_pd_d1
    s_sub_u32 s60, s60, 1
    s_cbranch_scc1 L_pd_d1
    s_sleep 2
    s_branch L_poll_d1
L_pd_d1:
    s_barrier
    buffer_load_dwordx4 v[160:163], v1, s[4:7], s38 offen offset:0 sc1
    buffer_load_dwordx4 v[164:167], v253, s[4:7], s38 offen offset:0 sc1
    buffer_load_dwordx4 v[168:171], v1, s[4:7], s38 offen offset:1024 sc1
    buffer_load_dwordx4 v[172:175], v253, s[4:7], s38 offen offset:1024 sc1
    buffer_load_dwordx4 v[176:179], v1, s[4:7], s38 offen offset:2048 sc1
    buffer_load_dwordx4 v[180:183], v253, s[4:7], s38 offen offset:2048 sc1
    buffer_load_dwordx4 v[184:187], v1, s[4:7], s38 offen offset:3072 sc1
    buffer_load_dwordx4 v[188:191], v253, s[4:7], s38 offen offset:3072 sc1
    s_barrier
    ds_read_b128 v[80:83], v1 offset:0
    ds_read_b128 v[84:87], v1 offset:1024
    ds_read_b128 v[88:91], v1 offset:2048
    ds_read_b128 v[92:95], v1 offset:3072
    ds_read_b128 v[96:99], v1 offset:4096
    ds_read_b128 v[100:103], v1 offset:5120
    ds_read_b128 v[104:107], v1 offset:6144
    s_lshl_b32 s50, s22, 7
    s_add_u32 s50, s50, s23
    s_lshl_b32 s50, s50, 8
    s_add_u32 s50, s50, 0x4508000
    s_add_u32 s50, s50, s4
    s_addc_u32 s51, s5, 0
    s_waitcnt vmcnt(6) lgkmcnt(3)
    v_mfma_f32_16x16x32_bf16 v[16:19], v[80:83], v[160:163], 0
    ds_read_b128 v[120:123], v1 offset:7168
    v_mfma_f32_16x16x32_bf16 v[44:47], v[80:83], v[164:167], 0
    ds_read_b128 v[124:127], v1 offset:8192
    v_mfma_f32_16x16x32_bf16 v[20:23], v[84:87], v[160:163], 0
    ds_read_b128 v[128:131], v1 offset:9216
    v_mfma_f32_16x16x32_bf16 v[48:51], v[84:87], v[164:167], 0
    ds_read_b128 v[132:135], v1 offset:10240
    v_mfma_f32_16x16x32_bf16 v[24:27], v[88:91], v[160:163], 0
    ds_read_b128 v[136:139], v1 offset:11264
    buffer_load_dwordx2 v[4:5], v0, s[4:7], s30 offen offset:0 sc1
    v_mfma_f32_16x16x32_bf16 v[52:55], v[88:91], v[164:167], 0
    ds_read_b128 v[140:143], v1 offset:12288
    buffer_load_dwordx2 v[6:7], v0, s[4:7], s30 offen offset:512 sc1
    v_mfma_f32_16x16x32_bf16 v[28:31], v[92:95], v[160:163], 0
    ds_read_b128 v[144:147], v1 offset:13312
    buffer_load_dwordx2 v[8:9], v0, s[4:7], s32 offen offset:0 sc1
    v_mfma_f32_16x16x32_bf16 v[56:59], v[92:95], v[164:167], 0
    s_waitcnt lgkmcnt(7)
    buffer_load_dwordx2 v[10:11], v0, s[4:7], s32 offen offset:512 sc1
    v_mfma_f32_16x16x32_bf16 v[32:35], v[160:163], v[96:99], 0
    buffer_load_dwordx2 v[12:13], v0, s[4:7], s32 offen offset:1024 sc1
    v_mfma_f32_16x16x32_bf16 v[60:63], v[164:167], v[96:99], 0
    buffer_load_dwordx2 v[14:15], v0, s[4:7], s32 offen offset:1536 sc1
    v_mfma_f32_16x16x32_bf16 v[36:39], v[160:163], v[100:103], 0
    buffer_load_dwordx4 v[192:195], v1, s[4:7], s39 offen offset:0 sc1
    v_mfma_f32_16x16x32_bf16 v[64:67], v[164:167], v[100:103], 0
    buffer_load_dwordx4 v[196:199], v253, s[4:7], s39 offen offset:0 sc1
    v_mfma_f32_16x16x32_bf16 v[40:43], v[104:107], v[160:163], 0
    buffer_load_dwordx4 v[200:203], v1, s[4:7], s39 offen offset:1024 sc1
    v_mfma_f32_16x16x32_bf16 v[68:71], v[104:107], v[164:167], 0
    buffer_load_dwordx4 v[204:207], v253, s[4:7], s39 offen offset:1024 sc1
    s_waitcnt vmcnt(14) lgkmcnt(3)
    s_barrier
    v_mfma_f32_16x16x32_bf16 v[16:19], v[120:123], v[168:171], v[16:19]
    ds_read_b128 v[80:83], v1 offset:14336
    v_mfma_f32_16x16x32_bf16 v[44:47], v[120:123], v[172:175], v[44:47]
    ds_read_b128 v[84:87], v1 offset:15360
    v_mfma_f32_16x16x32_bf16 v[20:23], v[124:127], v[168:171], v[20:23]
    ds_read_b128 v[88:91], v1 offset:16384
    v_mfma_f32_16x16x32_bf16 v[48:51], v[124:127], v[172:175], v[48:51]
    ds_read_b128 v[92:95], v1 offset:17408
    v_mfma_f32_16x16x32_bf16 v[24:27], v[128:131], v[168:171], v[24:27]
    ds_read_b128 v[96:99], v1 offset:18432
    v_mfma_f32_16x16x32_bf16 v[52:55], v[128:131], v[172:175], v[52:55]
    ds_read_b128 v[100:103], v1 offset:19456
    v_mfma_f32_16x16x32_bf16 v[28:31], v[132:135], v[168:171], v[28:31]
    ds_read_b128 v[104:107], v1 offset:20480
    v_mfma_f32_16x16x32_bf16 v[56:59], v[132:135], v[172:175], v[56:59]
    ds_read_b128 v[108:111], v248 offset:0
    s_waitcnt lgkmcnt(8)
    v_mfma_f32_16x16x32_bf16 v[32:35], v[168:171], v[136:139], v[32:35]
    ds_read_b128 v[112:115], v249 offset:0
    v_mfma_f32_16x16x32_bf16 v[60:63], v[172:175], v[136:139], v[60:63]
    ds_read_b128 v[116:119], v251 offset:0
    v_mfma_f32_16x16x32_bf16 v[36:39], v[168:171], v[140:143], v[36:39]
    buffer_load_dwordx4 v[160:163], v1, s[4:7], s39 offen offset:2048 sc1
    v_mfma_f32_16x16x32_bf16 v[64:67], v[172:175], v[140:143], v[64:67]
    buffer_load_dwordx4 v[164:167], v253, s[4:7], s39 offen offset:2048 sc1
    v_mfma_f32_16x16x32_bf16 v[40:43], v[144:147], v[168:171], v[40:43]
    v_mfma_f32_16x16x32_bf16 v[68:71], v[144:147], v[172:175], v[68:71]
    s_waitcnt vmcnt(14) lgkmcnt(6)
    v_mfma_f32_16x16x32_bf16 v[16:19], v[80:83], v[176:179], v[16:19]
    ds_read_b128 v[120:123], v1 offset:21504
    v_mfma_f32_16x16x32_bf16 v[44:47], v[80:83], v[180:183], v[44:47]
    ds_read_b128 v[124:127], v1 offset:22528
    v_mfma_f32_16x16x32_bf16 v[20:23], v[84:87], v[176:179], v[20:23]
    ds_read_b128 v[128:131], v1 offset:23552
    v_mfma_f32_16x16x32_bf16 v[48:51], v[84:87], v[180:183], v[48:51]
    ds_read_b128 v[132:135], v1 offset:24576
    v_mfma_f32_16x16x32_bf16 v[24:27], v[88:91], v[176:179], v[24:27]
    ds_read_b128 v[136:139], v1 offset:25600
    v_mfma_f32_16x16x32_bf16 v[52:55], v[88:91], v[180:183], v[52:55]
    ds_read_b128 v[140:143], v1 offset:26624
    v_mfma_f32_16x16x32_bf16 v[28:31], v[92:95], v[176:179], v[28:31]
    ds_read_b128 v[144:147], v1 offset:27648
    v_mfma_f32_16x16x32_bf16 v[56:59], v[92:95], v[180:183], v[56:59]
    ds_read_b128 v[148:151], v248 offset:1024
    s_waitcnt lgkmcnt(8)
    v_mfma_f32_16x16x32_bf16 v[32:35], v[176:179], v[96:99], v[32:35]
    ds_read_b128 v[152:155], v249 offset:7168
    v_mfma_f32_16x16x32_bf16 v[60:63], v[180:183], v[96:99], v[60:63]
    ds_read_b128 v[156:159], v251 offset:7168
    v_mfma_f32_16x16x32_bf16 v[36:39], v[176:179], v[100:103], v[36:39]
    buffer_load_dwordx4 v[168:171], v1, s[4:7], s39 offen offset:3072 sc1
    v_mfma_f32_16x16x32_bf16 v[64:67], v[180:183], v[100:103], v[64:67]
    buffer_load_dwordx4 v[172:175], v253, s[4:7], s39 offen offset:3072 sc1
    v_mfma_f32_16x16x32_bf16 v[40:43], v[104:107], v[176:179], v[40:43]
    v_mfma_f32_16x16x32_bf16 v[68:71], v[104:107], v[180:183], v[68:71]
    v_mfma_f32_16x16x32_bf16 v[72:75], v[112:115], v[108:111], 0
    v_mfma_f32_16x16x32_bf16 v[76:79], v[108:111], v[116:119], 0
    s_waitcnt vmcnt(8) lgkmcnt(6)
    s_barrier
    v_mfma_f32_16x16x32_bf16 v[16:19], v[120:123], v[184:187], v[16:19]
    ds_read_b128 v[80:83], v1 offset:28672
    v_mfma_f32_16x16x32_bf16 v[44:47], v[120:123], v[188:191], v[44:47]
    ds_read_b128 v[84:87], v1 offset:29696
    v_add_f32 v240, v4, v6
    v_mfma_f32_16x16x32_bf16 v[20:23], v[124:127], v[184:187], v[20:23]
    ds_read_b128 v[88:91], v1 offset:30720
    v_add_f32 v241, v5, v7
    v_mfma_f32_16x16x32_bf16 v[48:51], v[124:127], v[188:191], v[48:51]
    ds_read_b128 v[92:95], v1 offset:31744
    v_add_f32 v242, v8, v10
    v_mfma_f32_16x16x32_bf16 v[24:27], v[128:131], v[184:187], v[24:27]
    ds_read_b128 v[96:99], v1 offset:32768
    v_add_f32 v243, v9, v11
    v_mfma_f32_16x16x32_bf16 v[52:55], v[128:131], v[188:191], v[52:55]
    ds_read_b128 v[100:103], v1 offset:33792
    v_add_f32 v244, v12, v14
    v_mfma_f32_16x16x32_bf16 v[28:31], v[132:135], v[184:187], v[28:31]
    ds_read_b128 v[104:107], v1 offset:34816
    v_add_f32 v245, v13, v15
    v_mfma_f32_16x16x32_bf16 v[56:59], v[132:135], v[188:191], v[56:59]
    ds_read_b128 v[108:111], v248 offset:2048
    s_waitcnt lgkmcnt(8)
    v_mfma_f32_16x16x32_bf16 v[32:35], v[184:187], v[136:139], v[32:35]
    ds_read_b128 v[112:115], v249 offset:14336
    v_mov_b32 v4, v240
    v_mfma_f32_16x16x32_bf16 v[60:63], v[188:191], v[136:139], v[60:63]
    ds_read_b128 v[116:119], v251 offset:14336
    v_mov_b32 v5, v241
    v_mfma_f32_16x16x32_bf16 v[36:39], v[184:187], v[140:143], v[36:39]
    buffer_load_dwordx4 v[176:179], v1, s[4:7], s40 offen offset:0 sc1
    v_mov_b32 v8, v242
    v_mfma_f32_16x16x32_bf16 v[64:67], v[188:191], v[140:143], v[64:67]
    buffer_load_dwordx4 v[180:183], v253, s[4:7], s40 offen offset:0 sc1
    v_mov_b32 v9, v243
    v_mfma_f32_16x16x32_bf16 v[40:43], v[144:147], v[184:187], v[40:43]
    v_mov_b32 v12, v244
    v_mov_b32 v13, v245
    v_mfma_f32_16x16x32_bf16 v[68:71], v[144:147], v[188:191], v[68:71]
    v_permlane32_swap_b32 v240, v4
    v_permlane32_swap_b32 v241, v5
    v_mfma_f32_16x16x32_bf16 v[72:75], v[152:155], v[148:151], v[72:75]
    v_permlane32_swap_b32 v242, v8
    v_mfma_f32_16x16x32_bf16 v[76:79], v[148:151], v[156:159], v[76:79]
    v_permlane32_swap_b32 v243, v9
    s_waitcnt vmcnt(8) lgkmcnt(6)
    v_mfma_f32_16x16x32_bf16 v[16:19], v[80:83], v[192:195], v[16:19]
    ds_read_b128 v[120:123], v1 offset:35840
    v_mfma_f32_16x16x32_bf16 v[44:47], v[80:83], v[196:199], v[44:47]
    ds_read_b128 v[124:127], v1 offset:36864
    v_permlane32_swap_b32 v244, v12
    v_mfma_f32_16x16x32_bf16 v[20:23], v[84:87], v[192:195], v[20:23]
    ds_read_b128 v[128:131], v1 offset:37888
    v_permlane32_swap_b32 v245, v13
    v_mfma_f32_16x16x32_bf16 v[48:51], v[84:87], v[196:199], v[48:51]
    ds_read_b128 v[132:135], v1 offset:38912
    v_add_f32 v240, v240, v4
    v_mfma_f32_16x16x32_bf16 v[24:27], v[88:91], v[192:195], v[24:27]
    ds_read_b128 v[136:139], v1 offset:39936
    v_add_f32 v241, v241, v5
    v_mfma_f32_16x16x32_bf16 v[52:55], v[88:91], v[196:199], v[52:55]
    ds_read_b128 v[140:143], v1 offset:40960
    v_add_f32 v242, v242, v8
    v_mfma_f32_16x16x32_bf16 v[28:31], v[92:95], v[192:195], v[28:31]
    ds_read_b128 v[144:147], v1 offset:41984
    v_add_f32 v243, v243, v9
    v_mfma_f32_16x16x32_bf16 v[56:59], v[92:95], v[196:199], v[56:59]
    ds_read_b128 v[148:151], v248 offset:3072
    s_waitcnt lgkmcnt(8)
    v_mfma_f32_16x16x32_bf16 v[32:35], v[192:195], v[96:99], v[32:35]
    ds_read_b128 v[152:155], v249 offset:21504
    v_add_f32 v244, v244, v12
    v_mfma_f32_16x16x32_bf16 v[60:63], v[196:199], v[96:99], v[60:63]
    ds_read_b128 v[156:159], v251 offset:21504
    v_add_f32 v245, v245, v13
    v_mfma_f32_16x16x32_bf16 v[36:39], v[192:195], v[100:103], v[36:39]
    buffer_load_dwordx4 v[184:187], v1, s[4:7], s40 offen offset:1024 sc1
    v_mov_b32 v4, v240
    v_mfma_f32_16x16x32_bf16 v[64:67], v[196:199], v[100:103], v[64:67]
    buffer_load_dwordx4 v[188:191], v253, s[4:7], s40 offen offset:1024 sc1
    v_mov_b32 v5, v241
    v_mfma_f32_16x16x32_bf16 v[40:43], v[104:107], v[192:195], v[40:43]
    v_mov_b32 v8, v242
    v_mov_b32 v9, v243
    v_mfma_f32_16x16x32_bf16 v[68:71], v[104:107], v[196:199], v[68:71]
    v_mov_b32 v12, v244
    v_mov_b32 v13, v245
    v_mfma_f32_16x16x32_bf16 v[72:75], v[112:115], v[108:111], v[72:75]
    v_permlane16_swap_b32 v240, v4
    v_mfma_f32_16x16x32_bf16 v[76:79], v[108:111], v[116:119], v[76:79]
    v_permlane16_swap_b32 v241, v5
    s_waitcnt vmcnt(8) lgkmcnt(6)
    s_barrier
    v_mfma_f32_16x16x32_bf16 v[16:19], v[120:123], v[200:203], v[16:19]
    ds_read_b128 v[80:83], v1 offset:43008
    v_mfma_f32_16x16x32_bf16 v[44:47], v[120:123], v[204:207], v[44:47]
    ds_read_b128 v[84:87], v1 offset:44032
    v_permlane16_swap_b32 v242, v8
    v_mfma_f32_16x16x32_bf16 v[20:23], v[124:127], v[200:203], v[20:23]
    ds_read_b128 v[88:91], v1 offset:45056
    v_permlane16_swap_b32 v243, v9
    v_mfma_f32_16x16x32_bf16 v[48:51], v[124:127], v[204:207], v[48:51]
    ds_read_b128 v[92:95], v1 offset:46080
    v_permlane16_swap_b32 v244, v12
    v_mfma_f32_16x16x32_bf16 v[24:27], v[128:131], v[200:203], v[24:27]
    ds_read_b128 v[96:99], v1 offset:47104
    v_permlane16_swap_b32 v245, v13
    v_mfma_f32_16x16x32_bf16 v[52:55], v[128:131], v[204:207], v[52:55]
    ds_read_b128 v[100:103], v1 offset:48128
    v_add_f32 v240, v240, v4
    v_mfma_f32_16x16x32_bf16 v[28:31], v[132:135], v[200:203], v[28:31]
    ds_read_b128 v[104:107], v1 offset:49152
    v_add_f32 v241, v241, v5
    v_mfma_f32_16x16x32_bf16 v[56:59], v[132:135], v[204:207], v[56:59]
    ds_read_b128 v[108:111], v248 offset:4096
    s_waitcnt lgkmcnt(8)
    v_mfma_f32_16x16x32_bf16 v[32:35], v[200:203], v[136:139], v[32:35]
    ds_read_b128 v[112:115], v249 offset:28672
    v_add_f32 v242, v242, v8
    v_mfma_f32_16x16x32_bf16 v[60:63], v[204:207], v[136:139], v[60:63]
    ds_read_b128 v[116:119], v251 offset:28672
    v_add_f32 v243, v243, v9
    v_mfma_f32_16x16x32_bf16 v[36:39], v[200:203], v[140:143], v[36:39]
    buffer_load_dwordx4 v[192:195], v1, s[4:7], s40 offen offset:2048 sc1
    v_add_f32 v244, v244, v12
    v_mfma_f32_16x16x32_bf16 v[64:67], v[204:207], v[140:143], v[64:67]
    buffer_load_dwordx4 v[196:199], v253, s[4:7], s40 offen offset:2048 sc1
    v_add_f32 v245, v245, v13
    v_mfma_f32_16x16x32_bf16 v[40:43], v[144:147], v[200:203], v[40:43]
    v_mul_f32 v240, 0x3ae38e39, v240
    v_mul_f32 v241, 0x3ae38e39, v241
    v_mfma_f32_16x16x32_bf16 v[68:71], v[144:147], v[204:207], v[68:71]
    v_mul_f32 v242, 0x3ae38e39, v242
    v_mul_f32 v243, 0x3ae38e39, v243
    v_mfma_f32_16x16x32_bf16 v[72:75], v[152:155], v[148:151], v[72:75]
    v_mul_f32 v244, 0x3ae38e39, v244
    v_mfma_f32_16x16x32_bf16 v[76:79], v[148:151], v[156:159], v[76:79]
    v_mul_f32 v245, 0x3ae38e39, v245
    s_waitcnt vmcnt(8) lgkmcnt(6)
    v_mfma_f32_16x16x32_bf16 v[16:19], v[80:83], v[160:163], v[16:19]
    ds_read_b128 v[120:123], v1 offset:50176
    v_mfma_f32_16x16x32_bf16 v[44:47], v[80:83], v[164:167], v[44:47]
    ds_read_b128 v[124:127], v1 offset:51200
    v_fma_f32 v241, -v240, v240, v241
    v_mfma_f32_16x16x32_bf16 v[20:23], v[84:87], v[160:163], v[20:23]
    ds_read_b128 v[128:131], v1 offset:52224
    v_fma_f32 v243, -v242, v242, v243
    v_mfma_f32_16x16x32_bf16 v[48:51], v[84:87], v[164:167], v[48:51]
    ds_read_b128 v[132:135], v1 offset:53248
    v_fma_f32 v245, -v244, v244, v245
    v_mfma_f32_16x16x32_bf16 v[24:27], v[88:91], v[160:163], v[24:27]
    ds_read_b128 v[136:139], v1 offset:54272
    v_max_f32 v241, 0, v241
    v_mfma_f32_16x16x32_bf16 v[52:55], v[88:91], v[164:167], v[52:55]
    ds_read_b128 v[140:143], v1 offset:55296
    v_max_f32 v243, 0, v243
    v_mfma_f32_16x16x32_bf16 v[28:31], v[92:95], v[160:163], v[28:31]
    ds_read_b128 v[144:147], v1 offset:56320
    v_max_f32 v245, 0, v245
    v_mfma_f32_16x16x32_bf16 v[56:59], v[92:95], v[164:167], v[56:59]
    ds_read_b128 v[148:151], v248 offset:5120
    s_waitcnt lgkmcnt(8)
    v_mfma_f32_16x16x32_bf16 v[32:35], v[160:163], v[96:99], v[32:35]
    ds_read_b128 v[152:155], v249 offset:35840
    v_add_f32 v241, 0x3727c5ac, v241
    v_mfma_f32_16x16x32_bf16 v[60:63], v[164:167], v[96:99], v[60:63]
    ds_read_b128 v[156:159], v251 offset:35840
    v_add_f32 v243, 0x3727c5ac, v243
    v_mfma_f32_16x16x32_bf16 v[36:39], v[160:163], v[100:103], v[36:39]
    buffer_load_dwordx4 v[200:203], v1, s[4:7], s40 offen offset:3072 sc1
    v_add_f32 v245, 0x3727c5ac, v245
    v_mfma_f32_16x16x32_bf16 v[64:67], v[164:167], v[100:103], v[64:67]
    buffer_load_dwordx4 v[204:207], v253, s[4:7], s40 offen offset:3072 sc1
    v_rsq_f32 v241, v241
    v_mfma_f32_16x16x32_bf16 v[40:43], v[104:107], v[160:163], v[40:43]
    v_rsq_f32 v243, v243
    v_rsq_f32 v245, v245
    v_mfma_f32_16x16x32_bf16 v[68:71], v[104:107], v[164:167], v[68:71]
    s_nop 0
    v_lshlrev_b32 v255, 4, v3
    v_mfma_f32_16x16x32_bf16 v[72:75], v[112:115], v[108:111], v[72:75]
    v_add_u32 v236, 161792, v255
    v_mfma_f32_16x16x32_bf16 v[76:79], v[108:111], v[116:119], v[76:79]
    s_lshl_b32 s36, s33, 6
    s_waitcnt vmcnt(8) lgkmcnt(6)
    v_mfma_f32_16x16x32_bf16 v[16:19], v[120:123], v[168:171], v[16:19]
    ds_read_b128 v[80:83], v1 offset:57344
    v_mfma_f32_16x16x32_bf16 v[44:47], v[120:123], v[172:175], v[44:47]
    ds_read_b128 v[84:87], v1 offset:58368
    v_add_u32 v237, s36, v236
    v_mfma_f32_16x16x32_bf16 v[20:23], v[124:127], v[168:171], v[20:23]
    ds_read_b128 v[88:91], v1 offset:59392
    v_lshlrev_b32 v254, 2, v2
    v_mfma_f32_16x16x32_bf16 v[48:51], v[124:127], v[172:175], v[48:51]
    ds_read_b128 v[92:95], v1 offset:60416
    v_add_u32 v238, 161792, v254
    v_mfma_f32_16x16x32_bf16 v[24:27], v[128:131], v[168:171], v[24:27]
    ds_read_b128 v[96:99], v1 offset:61440
    s_lshl_b32 s37, s34, 6
    v_mfma_f32_16x16x32_bf16 v[52:55], v[128:131], v[172:175], v[52:55]
    ds_read_b128 v[100:103], v1 offset:62464
    v_add_u32 v239, s37, v238
    v_mfma_f32_16x16x32_bf16 v[28:31], v[132:135], v[168:171], v[28:31]
    ds_read_b128 v[104:107], v1 offset:63488
    s_mul_i32 s36, s20, 3072
    v_mfma_f32_16x16x32_bf16 v[56:59], v[132:135], v[172:175], v[56:59]
    ds_read_b128 v[108:111], v248 offset:6144
    s_waitcnt lgkmcnt(8)
    v_mfma_f32_16x16x32_bf16 v[32:35], v[168:171], v[136:139], v[32:35]
    ds_read_b128 v[112:115], v249 offset:43008
    s_add_u32 s36, s36, 153600
    v_mfma_f32_16x16x32_bf16 v[60:63], v[172:175], v[136:139], v[60:63]
    ds_read_b128 v[116:119], v251 offset:43008
    v_add_u32 v254, s36, v254
    v_mfma_f32_16x16x32_bf16 v[36:39], v[168:171], v[140:143], v[36:39]
    buffer_load_dwordx4 v[160:163], v1, s[4:7], s41 offen offset:0 sc1
    v_add_u32 v255, s36, v255
    v_mfma_f32_16x16x32_bf16 v[64:67], v[172:175], v[140:143], v[64:67]
    buffer_load_dwordx4 v[164:167], v253, s[4:7], s41 offen offset:0 sc1
    v_mfma_f32_16x16x32_bf16 v[40:43], v[144:147], v[168:171], v[40:43]
    v_mfma_f32_16x16x32_bf16 v[68:71], v[144:147], v[172:175], v[68:71]
    ds_write2_b32 v254, v240, v241 offset0:0 offset1:16
    v_mfma_f32_16x16x32_bf16 v[72:75], v[152:155], v[148:151], v[72:75]
    ds_write2_b32 v254, v242, v243 offset0:32 offset1:48
    v_mfma_f32_16x16x32_bf16 v[76:79], v[148:151], v[156:159], v[76:79]
    ds_write2_b32 v254, v244, v245 offset0:64 offset1:80
    s_waitcnt vmcnt(8) lgkmcnt(9)
    s_barrier
    v_mfma_f32_16x16x32_bf16 v[16:19], v[80:83], v[176:179], v[16:19]
    ds_read_b128 v[120:123], v247 offset:0
    v_mfma_f32_16x16x32_bf16 v[44:47], v[80:83], v[180:183], v[44:47]
    ds_read_b128 v[124:127], v247 offset:1024
    v_mfma_f32_16x16x32_bf16 v[20:23], v[84:87], v[176:179], v[20:23]
    ds_read_b128 v[128:131], v247 offset:2048
    v_mfma_f32_16x16x32_bf16 v[48:51], v[84:87], v[180:183], v[48:51]
    ds_read_b128 v[132:135], v247 offset:3072
    v_mfma_f32_16x16x32_bf16 v[24:27], v[88:91], v[176:179], v[24:27]
    ds_read_b128 v[136:139], v247 offset:4096
    v_mfma_f32_16x16x32_bf16 v[52:55], v[88:91], v[180:183], v[52:55]
    ds_read_b128 v[140:143], v247 offset:5120
    v_mfma_f32_16x16x32_bf16 v[28:31], v[92:95], v[176:179], v[28:31]
    ds_read_b128 v[144:147], v247 offset:6144
    v_mfma_f32_16x16x32_bf16 v[56:59], v[92:95], v[180:183], v[56:59]
    ds_read_b128 v[148:151], v248 offset:7168
    s_waitcnt lgkmcnt(8)
    v_mfma_f32_16x16x32_bf16 v[32:35], v[176:179], v[96:99], v[32:35]
    ds_read_b128 v[152:155], v249 offset:50176
    v_mfma_f32_16x16x32_bf16 v[60:63], v[180:183], v[96:99], v[60:63]
    ds_read_b128 v[156:159], v251 offset:50176
    v_mfma_f32_16x16x32_bf16 v[36:39], v[176:179], v[100:103], v[36:39]
    buffer_load_dwordx4 v[168:171], v1, s[4:7], s41 offen offset:1024 sc1
    ds_read_b128 v[208:211], v236 offset:0
    v_mfma_f32_16x16x32_bf16 v[64:67], v[180:183], v[100:103], v[64:67]
    buffer_load_dwordx4 v[172:175], v253, s[4:7], s41 offen offset:1024 sc1
    ds_read_b128 v[212:215], v236 offset:64
    v_mfma_f32_16x16x32_bf16 v[40:43], v[104:107], v[176:179], v[40:43]
    ds_read_b128 v[216:219], v236 offset:128
    v_mfma_f32_16x16x32_bf16 v[68:71], v[104:107], v[180:183], v[68:71]
    ds_read_b128 v[220:223], v236 offset:192
    v_mfma_f32_16x16x32_bf16 v[72:75], v[112:115], v[108:111], v[72:75]
    ds_read_b128 v[224:227], v236 offset:384
    v_mfma_f32_16x16x32_bf16 v[76:79], v[108:111], v[116:119], v[76:79]
    ds_read_b128 v[228:231], v237
    s_waitcnt vmcnt(8) lgkmcnt(12)
    v_mfma_f32_16x16x32_bf16 v[16:19], v[120:123], v[184:187], v[16:19]
    ds_read_b128 v[80:83], v247 offset:7168
    v_mfma_f32_16x16x32_bf16 v[44:47], v[120:123], v[188:191], v[44:47]
    ds_read_b128 v[84:87], v247 offset:8192
    v_mfma_f32_16x16x32_bf16 v[20:23], v[124:127], v[184:187], v[20:23]
    ds_read_b128 v[88:91], v247 offset:9216
    v_mfma_f32_16x16x32_bf16 v[48:51], v[124:127], v[188:191], v[48:51]
    ds_read_b128 v[92:95], v247 offset:10240
    v_mfma_f32_16x16x32_bf16 v[24:27], v[128:131], v[184:187], v[24:27]
    ds_read_b128 v[96:99], v247 offset:11264
    v_mfma_f32_16x16x32_bf16 v[52:55], v[128:131], v[188:191], v[52:55]
    ds_read_b128 v[100:103], v247 offset:12288
    v_mfma_f32_16x16x32_bf16 v[28:31], v[132:135], v[184:187], v[28:31]
    ds_read_b128 v[104:107], v247 offset:13312
    v_mfma_f32_16x16x32_bf16 v[56:59], v[132:135], v[188:191], v[56:59]
    ds_read_b128 v[108:111], v248 offset:8192
    s_waitcnt lgkmcnt(8)
    v_mfma_f32_16x16x32_bf16 v[32:35], v[184:187], v[136:139], v[32:35]
    ds_read_b128 v[112:115], v249 offset:57344
    v_mfma_f32_16x16x32_bf16 v[60:63], v[188:191], v[136:139], v[60:63]
    ds_read_b128 v[116:119], v251 offset:57344
    v_mfma_f32_16x16x32_bf16 v[36:39], v[184:187], v[140:143], v[36:39]
    buffer_load_dwordx4 v[176:179], v1, s[4:7], s41 offen offset:2048 sc1
    v_mfma_f32_16x16x32_bf16 v[64:67], v[188:191], v[140:143], v[64:67]
    buffer_load_dwordx4 v[180:183], v253, s[4:7], s41 offen offset:2048 sc1
    ds_read2_b32 v[232:233], v238 offset0:64 offset1:80
    v_mfma_f32_16x16x32_bf16 v[40:43], v[144:147], v[184:187], v[40:43]
    ds_read_b32 v234, v239
    v_mfma_f32_16x16x32_bf16 v[68:71], v[144:147], v[188:191], v[68:71]
    ds_read_b128 v[4:7], v255 offset:0
    v_mfma_f32_16x16x32_bf16 v[72:75], v[152:155], v[148:151], v[72:75]
    ds_read_b128 v[8:11], v255 offset:128
    v_mfma_f32_16x16x32_bf16 v[76:79], v[148:151], v[156:159], v[76:79]
    ds_read_b128 v[12:15], v255 offset:256
    s_waitcnt vmcnt(8) lgkmcnt(11)
    s_barrier
    v_mfma_f32_16x16x32_bf16 v[16:19], v[80:83], v[192:195], v[16:19]
    ds_read_b128 v[120:123], v247 offset:14336
    v_mfma_f32_16x16x32_bf16 v[44:47], v[80:83], v[196:199], v[44:47]
    ds_read_b128 v[124:127], v247 offset:15360
    v_mfma_f32_16x16x32_bf16 v[20:23], v[84:87], v[192:195], v[20:23]
    ds_read_b128 v[128:131], v247 offset:16384
    v_mfma_f32_16x16x32_bf16 v[48:51], v[84:87], v[196:199], v[48:51]
    ds_read_b128 v[132:135], v247 offset:17408
    v_mfma_f32_16x16x32_bf16 v[24:27], v[88:91], v[192:195], v[24:27]
    ds_read_b128 v[136:139], v247 offset:18432
    v_mfma_f32_16x16x32_bf16 v[52:55], v[88:91], v[196:199], v[52:55]
    ds_read_b128 v[140:143], v247 offset:19456
    v_mfma_f32_16x16x32_bf16 v[28:31], v[92:95], v[192:195], v[28:31]
    ds_read_b128 v[144:147], v247 offset:20480
    v_mfma_f32_16x16x32_bf16 v[56:59], v[92:95], v[196:199], v[56:59]
    ds_read_b128 v[148:151], v248 offset:9216
    s_waitcnt lgkmcnt(8)
    v_mfma_f32_16x16x32_bf16 v[32:35], v[192:195], v[96:99], v[32:35]
    ds_read_b128 v[152:155], v250 offset:0
    v_mfma_f32_16x16x32_bf16 v[60:63], v[196:199], v[96:99], v[60:63]
    ds_read_b128 v[156:159], v252 offset:0
    v_mfma_f32_16x16x32_bf16 v[36:39], v[192:195], v[100:103], v[36:39]
    buffer_load_dwordx4 v[184:187], v1, s[4:7], s41 offen offset:3072 sc1
    v_mfma_f32_16x16x32_bf16 v[64:67], v[196:199], v[100:103], v[64:67]
    buffer_load_dwordx4 v[188:191], v253, s[4:7], s41 offen offset:3072 sc1
    v_mfma_f32_16x16x32_bf16 v[40:43], v[104:107], v[192:195], v[40:43]
    v_mfma_f32_16x16x32_bf16 v[68:71], v[104:107], v[196:199], v[68:71]
    v_mfma_f32_16x16x32_bf16 v[72:75], v[112:115], v[108:111], v[72:75]
    v_mfma_f32_16x16x32_bf16 v[76:79], v[108:111], v[116:119], v[76:79]
    s_waitcnt vmcnt(8) lgkmcnt(6)
    v_mfma_f32_16x16x32_bf16 v[16:19], v[120:123], v[200:203], v[16:19]
    ds_read_b128 v[80:83], v247 offset:21504
    v_fma_f32 v32, -v8, v232, v32
    v_mfma_f32_16x16x32_bf16 v[44:47], v[120:123], v[204:207], v[44:47]
    ds_read_b128 v[84:87], v247 offset:22528
    v_fma_f32 v60, -v12, v232, v60
    v_mfma_f32_16x16x32_bf16 v[20:23], v[124:127], v[200:203], v[20:23]
    ds_read_b128 v[88:91], v247 offset:23552
    v_fma_f32 v36, -v8, v233, v36
    v_mfma_f32_16x16x32_bf16 v[48:51], v[124:127], v[204:207], v[48:51]
    ds_read_b128 v[92:95], v247 offset:24576
    v_fma_f32 v64, -v12, v233, v64
    v_mfma_f32_16x16x32_bf16 v[24:27], v[128:131], v[200:203], v[24:27]
    ds_read_b128 v[96:99], v247 offset:25600
    v_fma_f32 v40, -v242, v224, v40
    v_mfma_f32_16x16x32_bf16 v[52:55], v[128:131], v[204:207], v[52:55]
    ds_read_b128 v[100:103], v247 offset:26624
    v_fma_f32 v68, -v244, v224, v68
    v_mfma_f32_16x16x32_bf16 v[28:31], v[132:135], v[200:203], v[28:31]
    ds_read_b128 v[104:107], v247 offset:27648
    v_fma_f32 v72, -v240, v228, v72
    v_mfma_f32_16x16x32_bf16 v[56:59], v[132:135], v[204:207], v[56:59]
    ds_read_b128 v[108:111], v248 offset:10240
    s_waitcnt lgkmcnt(8)
    v_fma_f32 v76, -v4, v234, v76
    v_mfma_f32_16x16x32_bf16 v[32:35], v[200:203], v[136:139], v[32:35]
    ds_read_b128 v[112:115], v250 offset:7168
    v_fma_f32 v16, -v242, v208, v16
    v_mfma_f32_16x16x32_bf16 v[60:63], v[204:207], v[136:139], v[60:63]
    ds_read_b128 v[116:119], v252 offset:7168
    v_fma_f32 v44, -v244, v208, v44
    v_mfma_f32_16x16x32_bf16 v[36:39], v[200:203], v[140:143], v[36:39]
    buffer_load_dwordx4 v[192:195], v1, s[4:7], s42 offen offset:0 sc1
    v_fma_f32 v20, -v242, v212, v20
    v_mfma_f32_16x16x32_bf16 v[64:67], v[204:207], v[140:143], v[64:67]
    buffer_load_dwordx4 v[196:199], v253, s[4:7], s42 offen offset:0 sc1
    v_fma_f32 v48, -v244, v212, v48
    v_mfma_f32_16x16x32_bf16 v[40:43], v[144:147], v[200:203], v[40:43]
    v_fma_f32 v24, -v242, v216, v24
    v_mfma_f32_16x16x32_bf16 v[68:71], v[144:147], v[204:207], v[68:71]
    v_fma_f32 v52, -v244, v216, v52
    v_mfma_f32_16x16x32_bf16 v[72:75], v[152:155], v[148:151], v[72:75]
    v_fma_f32 v28, -v242, v220, v28
    v_mfma_f32_16x16x32_bf16 v[76:79], v[148:151], v[156:159], v[76:79]
    v_fma_f32 v56, -v244, v220, v56
    s_waitcnt vmcnt(8) lgkmcnt(6)
    s_barrier
    v_mfma_f32_16x16x32_bf16 v[16:19], v[80:83], v[160:163], v[16:19]
    ds_read_b128 v[120:123], v247 offset:28672
    v_fma_f32 v33, -v9, v232, v33
    v_mfma_f32_16x16x32_bf16 v[44:47], v[80:83], v[164:167], v[44:47]
    ds_read_b128 v[124:127], v247 offset:29696
    v_fma_f32 v61, -v13, v232, v61
    v_mfma_f32_16x16x32_bf16 v[20:23], v[84:87], v[160:163], v[20:23]
    ds_read_b128 v[128:131], v247 offset:30720
    v_fma_f32 v37, -v9, v233, v37
    v_mfma_f32_16x16x32_bf16 v[48:51], v[84:87], v[164:167], v[48:51]
    ds_read_b128 v[132:135], v247 offset:31744
    v_fma_f32 v65, -v13, v233, v65
    v_mfma_f32_16x16x32_bf16 v[24:27], v[88:91], v[160:163], v[24:27]
    ds_read_b128 v[136:139], v247 offset:32768
    v_fma_f32 v41, -v242, v225, v41
    v_mfma_f32_16x16x32_bf16 v[52:55], v[88:91], v[164:167], v[52:55]
    ds_read_b128 v[140:143], v247 offset:33792
    v_fma_f32 v69, -v244, v225, v69
    v_mfma_f32_16x16x32_bf16 v[28:31], v[92:95], v[160:163], v[28:31]
    ds_read_b128 v[144:147], v247 offset:34816
    v_fma_f32 v73, -v240, v229, v73
    v_mfma_f32_16x16x32_bf16 v[56:59], v[92:95], v[164:167], v[56:59]
    ds_read_b128 v[148:151], v248 offset:11264
    s_waitcnt lgkmcnt(8)
    v_fma_f32 v77, -v5, v234, v77
    v_mfma_f32_16x16x32_bf16 v[32:35], v[160:163], v[96:99], v[32:35]
    ds_read_b128 v[152:155], v250 offset:14336
    v_fma_f32 v17, -v242, v209, v17
    v_mfma_f32_16x16x32_bf16 v[60:63], v[164:167], v[96:99], v[60:63]
    ds_read_b128 v[156:159], v252 offset:14336
    v_fma_f32 v45, -v244, v209, v45
    v_mfma_f32_16x16x32_bf16 v[36:39], v[160:163], v[100:103], v[36:39]
    buffer_load_dwordx4 v[200:203], v1, s[4:7], s42 offen offset:1024 sc1
    v_fma_f32 v21, -v242, v213, v21
    v_mfma_f32_16x16x32_bf16 v[64:67], v[164:167], v[100:103], v[64:67]
    buffer_load_dwordx4 v[204:207], v253, s[4:7], s42 offen offset:1024 sc1
    v_fma_f32 v49, -v244, v213, v49
    v_mfma_f32_16x16x32_bf16 v[40:43], v[104:107], v[160:163], v[40:43]
    v_fma_f32 v25, -v242, v217, v25
    v_mfma_f32_16x16x32_bf16 v[68:71], v[104:107], v[164:167], v[68:71]
    v_fma_f32 v53, -v244, v217, v53
    v_mfma_f32_16x16x32_bf16 v[72:75], v[112:115], v[108:111], v[72:75]
    v_fma_f32 v29, -v242, v221, v29
    v_mfma_f32_16x16x32_bf16 v[76:79], v[108:111], v[116:119], v[76:79]
    v_fma_f32 v57, -v244, v221, v57
    s_waitcnt vmcnt(8) lgkmcnt(6)
    v_mfma_f32_16x16x32_bf16 v[16:19], v[120:123], v[168:171], v[16:19]
    ds_read_b128 v[80:83], v247 offset:35840
    v_fma_f32 v34, -v10, v232, v34
    v_mfma_f32_16x16x32_bf16 v[44:47], v[120:123], v[172:175], v[44:47]
    ds_read_b128 v[84:87], v247 offset:36864
    v_fma_f32 v62, -v14, v232, v62
    v_mfma_f32_16x16x32_bf16 v[20:23], v[124:127], v[168:171], v[20:23]
    ds_read_b128 v[88:91], v247 offset:37888
    v_fma_f32 v38, -v10, v233, v38
    v_mfma_f32_16x16x32_bf16 v[48:51], v[124:127], v[172:175], v[48:51]
    ds_read_b128 v[92:95], v247 offset:38912
    v_fma_f32 v66, -v14, v233, v66
    v_mfma_f32_16x16x32_bf16 v[24:27], v[128:131], v[168:171], v[24:27]
    ds_read_b128 v[96:99], v247 offset:39936
    v_fma_f32 v42, -v242, v226, v42
    v_mfma_f32_16x16x32_bf16 v[52:55], v[128:131], v[172:175], v[52:55]
    ds_read_b128 v[100:103], v247 offset:40960
    v_fma_f32 v70, -v244, v226, v70
    v_mfma_f32_16x16x32_bf16 v[28:31], v[132:135], v[168:171], v[28:31]
    ds_read_b128 v[104:107], v247 offset:41984
    v_fma_f32 v74, -v240, v230, v74
    v_mfma_f32_16x16x32_bf16 v[56:59], v[132:135], v[172:175], v[56:59]
    ds_read_b128 v[108:111], v248 offset:12288
    s_waitcnt lgkmcnt(8)
    v_fma_f32 v78, -v6, v234, v78
    v_mfma_f32_16x16x32_bf16 v[32:35], v[168:171], v[136:139], v[32:35]
    ds_read_b128 v[112:115], v250 offset:21504
    v_fma_f32 v18, -v242, v210, v18
    v_mfma_f32_16x16x32_bf16 v[60:63], v[172:175], v[136:139], v[60:63]
    ds_read_b128 v[116:119], v252 offset:21504
    v_fma_f32 v46, -v244, v210, v46
    v_mfma_f32_16x16x32_bf16 v[36:39], v[168:171], v[140:143], v[36:39]
    v_fma_f32 v22, -v242, v214, v22
    v_mfma_f32_16x16x32_bf16 v[64:67], v[172:175], v[140:143], v[64:67]
    v_fma_f32 v50, -v244, v214, v50
    v_mfma_f32_16x16x32_bf16 v[40:43], v[144:147], v[168:171], v[40:43]
    v_fma_f32 v26, -v242, v218, v26
    v_mfma_f32_16x16x32_bf16 v[68:71], v[144:147], v[172:175], v[68:71]
    v_fma_f32 v54, -v244, v218, v54
    v_mfma_f32_16x16x32_bf16 v[72:75], v[152:155], v[148:151], v[72:75]
    v_fma_f32 v30, -v242, v222, v30
    v_mfma_f32_16x16x32_bf16 v[76:79], v[148:151], v[156:159], v[76:79]
    v_fma_f32 v58, -v244, v222, v58
    s_waitcnt vmcnt(6) lgkmcnt(6)
    v_mfma_f32_16x16x32_bf16 v[16:19], v[80:83], v[176:179], v[16:19]
    ds_read_b128 v[120:123], v247 offset:43008
    v_fma_f32 v35, -v11, v232, v35
    v_mfma_f32_16x16x32_bf16 v[44:47], v[80:83], v[180:183], v[44:47]
    ds_read_b128 v[124:127], v247 offset:44032
    v_fma_f32 v63, -v15, v232, v63
    v_mfma_f32_16x16x32_bf16 v[20:23], v[84:87], v[176:179], v[20:23]
    ds_read_b128 v[128:131], v247 offset:45056
    v_fma_f32 v39, -v11, v233, v39
    v_mfma_f32_16x16x32_bf16 v[48:51], v[84:87], v[180:183], v[48:51]
    ds_read_b128 v[132:135], v247 offset:46080
    v_fma_f32 v67, -v15, v233, v67
    v_mfma_f32_16x16x32_bf16 v[24:27], v[88:91], v[176:179], v[24:27]
    ds_read_b128 v[136:139], v247 offset:47104
    v_fma_f32 v43, -v242, v227, v43
    v_mfma_f32_16x16x32_bf16 v[52:55], v[88:91], v[180:183], v[52:55]
    ds_read_b128 v[140:143], v247 offset:48128
    v_fma_f32 v71, -v244, v227, v71
    v_mfma_f32_16x16x32_bf16 v[28:31], v[92:95], v[176:179], v[28:31]
    ds_read_b128 v[144:147], v247 offset:49152
    v_fma_f32 v75, -v240, v231, v75
    v_mfma_f32_16x16x32_bf16 v[56:59], v[92:95], v[180:183], v[56:59]
    ds_read_b128 v[148:151], v248 offset:13312
    s_waitcnt lgkmcnt(8)
    v_fma_f32 v79, -v7, v234, v79
    v_mfma_f32_16x16x32_bf16 v[32:35], v[176:179], v[96:99], v[32:35]
    ds_read_b128 v[152:155], v250 offset:28672
    v_fma_f32 v19, -v242, v211, v19
    v_mfma_f32_16x16x32_bf16 v[60:63], v[180:183], v[96:99], v[60:63]
    ds_read_b128 v[156:159], v252 offset:28672
    v_fma_f32 v47, -v244, v211, v47
    v_mfma_f32_16x16x32_bf16 v[36:39], v[176:179], v[100:103], v[36:39]
    v_fma_f32 v23, -v242, v215, v23
    v_mfma_f32_16x16x32_bf16 v[64:67], v[180:183], v[100:103], v[64:67]
    v_fma_f32 v51, -v244, v215, v51
    v_mfma_f32_16x16x32_bf16 v[40:43], v[104:107], v[176:179], v[40:43]
    v_fma_f32 v27, -v242, v219, v27
    v_mfma_f32_16x16x32_bf16 v[68:71], v[104:107], v[180:183], v[68:71]
    v_fma_f32 v55, -v244, v219, v55
    v_mfma_f32_16x16x32_bf16 v[72:75], v[112:115], v[108:111], v[72:75]
    v_fma_f32 v31, -v242, v223, v31
    v_mfma_f32_16x16x32_bf16 v[76:79], v[108:111], v[116:119], v[76:79]
    v_fma_f32 v59, -v244, v223, v59
    s_waitcnt vmcnt(4) lgkmcnt(6)
    s_barrier
    v_mfma_f32_16x16x32_bf16 v[16:19], v[120:123], v[184:187], v[16:19]
    ds_read_b128 v[80:83], v247 offset:50176
    v_mfma_f32_16x16x32_bf16 v[44:47], v[120:123], v[188:191], v[44:47]
    ds_read_b128 v[84:87], v247 offset:51200
    v_and_b32 v4, 1, v2
    v_mfma_f32_16x16x32_bf16 v[20:23], v[124:127], v[184:187], v[20:23]
    ds_read_b128 v[88:91], v247 offset:52224
    v_lshl_add_u32 v5, v3, 2, v4
    v_mfma_f32_16x16x32_bf16 v[48:51], v[124:127], v[188:191], v[48:51]
    ds_read_b128 v[92:95], v247 offset:53248
    v_add_u32 v6, 2, v5
    v_mfma_f32_16x16x32_bf16 v[24:27], v[128:131], v[184:187], v[24:27]
    ds_read_b128 v[96:99], v247 offset:54272
    v_cmp_eq_u32 s[40:41], 1, v4
    v_mfma_f32_16x16x32_bf16 v[52:55], v[128:131], v[188:191], v[52:55]
    ds_read_b128 v[100:103], v247 offset:55296
    v_cmp_le_u32 s[42:43], v5, v2
    v_mfma_f32_16x16x32_bf16 v[28:31], v[132:135], v[184:187], v[28:31]
    ds_read_b128 v[104:107], v247 offset:56320
    v_cmp_le_u32 s[44:45], v6, v2
    v_mfma_f32_16x16x32_bf16 v[56:59], v[132:135], v[188:191], v[56:59]
    ds_read_b128 v[108:111], v248 offset:14336
    s_waitcnt lgkmcnt(8)
    v_mfma_f32_16x16x32_bf16 v[32:35], v[184:187], v[136:139], v[32:35]
    ds_read_b128 v[112:115], v250 offset:35840
    v_mov_b32 v4, 0x0c0c0100
    v_mfma_f32_16x16x32_bf16 v[60:63], v[188:191], v[136:139], v[60:63]
    ds_read_b128 v[116:119], v252 offset:35840
    v_mov_b32 v5, 0x01000c0c
    v_mfma_f32_16x16x32_bf16 v[36:39], v[184:187], v[140:143], v[36:39]
    v_mov_b32 v6, 0x0c0c0302
    v_mov_b32 v7, 0x03020c0c
    v_mfma_f32_16x16x32_bf16 v[64:67], v[188:191], v[140:143], v[64:67]
    v_mov_b32 v8, 0x0c0c0c0c
    v_cndmask_b32 v4, v4, v5, s[40:41]
    v_mfma_f32_16x16x32_bf16 v[40:43], v[144:147], v[184:187], v[40:43]
    v_cndmask_b32 v6, v6, v7, s[40:41]
    v_cndmask_b32 v12, v4, v8, s[42:43]
    v_mfma_f32_16x16x32_bf16 v[68:71], v[144:147], v[188:191], v[68:71]
    v_cndmask_b32 v13, v6, v8, s[44:45]
    v_cndmask_b32 v14, v8, v4, s[42:43]
    v_mfma_f32_16x16x32_bf16 v[72:75], v[152:155], v[148:151], v[72:75]
    v_cndmask_b32 v15, v8, v6, s[44:45]
    s_cmp_eq_u32 s31, 0
    v_mfma_f32_16x16x32_bf16 v[76:79], v[148:151], v[156:159], v[76:79]
    s_cselect_b64 s[48:49], s[42:43], -1
    s_cselect_b64 s[38:39], s[44:45], -1
    s_waitcnt vmcnt(2) lgkmcnt(6)
    v_mfma_f32_16x16x32_bf16 v[16:19], v[80:83], v[192:195], v[16:19]
    ds_read_b128 v[120:123], v247 offset:57344
    v_mfma_f32_16x16x32_bf16 v[44:47], v[80:83], v[196:199], v[44:47]
    ds_read_b128 v[124:127], v247 offset:58368
    s_mul_i32 s36, s20, 3072
    v_mfma_f32_16x16x32_bf16 v[20:23], v[84:87], v[192:195], v[20:23]
    ds_read_b128 v[128:131], v247 offset:59392
    s_add_u32 s36, s36, 149504
    v_mfma_f32_16x16x32_bf16 v[48:51], v[84:87], v[196:199], v[48:51]
    ds_read_b128 v[132:135], v247 offset:60416
    v_add_u32 v9, s36, v0
    v_mfma_f32_16x16x32_bf16 v[24:27], v[88:91], v[192:195], v[24:27]
    ds_read_b128 v[136:139], v247 offset:61440
    s_lshl_b32 s37, s20, 9
    v_mfma_f32_16x16x32_bf16 v[52:55], v[88:91], v[196:199], v[52:55]
    ds_read_b128 v[140:143], v247 offset:62464
    s_add_u32 s37, s37, 149504
    v_mfma_f32_16x16x32_bf16 v[28:31], v[92:95], v[192:195], v[28:31]
    ds_read_b128 v[144:147], v247 offset:63488
    v_add_u32 v10, s37, v0
    v_mfma_f32_16x16x32_bf16 v[56:59], v[92:95], v[196:199], v[56:59]
    ds_read_b128 v[148:151], v248 offset:15360
    s_waitcnt lgkmcnt(8)
    v_mfma_f32_16x16x32_bf16 v[32:35], v[192:195], v[96:99], v[32:35]
    ds_read_b128 v[152:155], v250 offset:43008
    v_lshlrev_b32 v4, 2, v3
    v_mfma_f32_16x16x32_bf16 v[60:63], v[196:199], v[96:99], v[60:63]
    ds_read_b128 v[156:159], v252 offset:43008
    v_sub_u32 v4, v2, v4
    v_mfma_f32_16x16x32_bf16 v[36:39], v[192:195], v[100:103], v[36:39]
    v_lshlrev_b32 v5, 4, v4
    v_lshrrev_b32 v4, 1, v4
    v_mfma_f32_16x16x32_bf16 v[64:67], v[196:199], v[100:103], v[64:67]
    v_mov_b32 v6, 0x3f80
    v_lshlrev_b32 v5, v5, v6
    v_mfma_f32_16x16x32_bf16 v[40:43], v[104:107], v[192:195], v[40:43]
    v_cmp_eq_u32 vcc, 0, v4
    v_cmp_eq_u32 s[46:47], 1, v4
    v_mfma_f32_16x16x32_bf16 v[68:71], v[104:107], v[196:199], v[68:71]
    ds_read_b128 v[208:211], v255 offset:64
    s_lshl_b32 s36, s24, 10
    v_add_u32 v4, s36, v1
    v_mfma_f32_16x16x32_bf16 v[72:75], v[112:115], v[108:111], v[72:75]
    ds_read_b128 v[212:215], v255 offset:192
    v_cndmask_b32 v234, 0, v5, vcc
    v_cndmask_b32 v235, 0, v5, s[46:47]
    v_mfma_f32_16x16x32_bf16 v[76:79], v[108:111], v[116:119], v[76:79]
    ds_read_b128 v[216:219], v255 offset:320
    v_add_u32 v5, 18432, v4
    s_lshl_b32 s36, s24, 7
    s_waitcnt vmcnt(0) lgkmcnt(9)
    v_mfma_f32_16x16x32_bf16 v[16:19], v[120:123], v[200:203], v[16:19]
    ds_read_b128 v[80:83], v248 offset:16384
    v_mfma_f32_16x16x32_bf16 v[44:47], v[120:123], v[204:207], v[44:47]
    ds_read_b128 v[84:87], v250 offset:50176
    s_add_u32 s36, s36, 16384
    v_mfma_f32_16x16x32_bf16 v[20:23], v[124:127], v[200:203], v[20:23]
    ds_read_b128 v[88:91], v252 offset:50176
    v_cmp_eq_u32 vcc, 2, v3
    v_mfma_f32_16x16x32_bf16 v[48:51], v[124:127], v[204:207], v[48:51]
    ds_read_b128 v[92:95], v248 offset:17408
    v_lshl_add_u32 v6, v2, 3, s36
    v_mfma_f32_16x16x32_bf16 v[24:27], v[128:131], v[200:203], v[24:27]
    ds_read_b128 v[96:99], v250 offset:57344
    v_bfrev_b32 v7, 1
    v_mfma_f32_16x16x32_bf16 v[52:55], v[128:131], v[204:207], v[52:55]
    ds_read_b128 v[100:103], v252 offset:57344
    v_cndmask_b32 v6, v7, v6, vcc
    v_mfma_f32_16x16x32_bf16 v[28:31], v[132:135], v[200:203], v[28:31]
    v_add_u32 v7, 18432, v6
    v_mov_b32 v106, 0
    v_mfma_f32_16x16x32_bf16 v[56:59], v[132:135], v[204:207], v[56:59]
    s_waitcnt lgkmcnt(6)
    v_mov_b32 v107, 0
    v_mfma_f32_16x16x32_bf16 v[32:35], v[200:203], v[136:139], v[32:35]
    v_mov_b32 v8, 0xf149f2ca
    v_mov_b32 v108, 0
    v_mfma_f32_16x16x32_bf16 v[60:63], v[204:207], v[136:139], v[60:63]
    s_mov_b32 s33, 0x3eae1a93
    v_mov_b32 v109, 0
    v_mfma_f32_16x16x32_bf16 v[36:39], v[200:203], v[140:143], v[36:39]
    v_mov_b32 v236, 0x3f803f80
    v_mov_b32 v237, 0x3f803f80
    v_mfma_f32_16x16x32_bf16 v[64:67], v[204:207], v[140:143], v[64:67]
    v_mov_b32 v238, 0x3f803f80
    v_mov_b32 v239, 0x3f803f80
    v_mfma_f32_16x16x32_bf16 v[40:43], v[144:147], v[200:203], v[40:43]
    v_mov_b32 v114, 0
    v_mfma_f32_16x16x32_bf16 v[68:71], v[144:147], v[204:207], v[68:71]
    v_mov_b32 v115, 0
    v_mfma_f32_16x16x32_bf16 v[72:75], v[152:155], v[148:151], v[72:75]
    v_mov_b32 v116, 0
    v_mfma_f32_16x16x32_bf16 v[76:79], v[148:151], v[156:159], v[76:79]
    v_mov_b32 v117, 0
    s_waitcnt lgkmcnt(0)
    v_mfma_f32_16x16x32_bf16 v[72:75], v[84:87], v[80:83], v[72:75]
    v_mfma_f32_16x16x32_bf16 v[76:79], v[80:83], v[88:91], v[76:79]
    v_mfma_f32_16x16x32_bf16 v[72:75], v[96:99], v[92:95], v[72:75]
    v_mfma_f32_16x16x32_bf16 v[76:79], v[92:95], v[100:103], v[76:79]
    v_pk_mul_f32 v[52:53], v[52:53], v[244:245] op_sel:[0,1] op_sel_hi:[1,1]
    v_pk_mul_f32 v[54:55], v[54:55], v[244:245] op_sel:[0,1] op_sel_hi:[1,1]
    v_pk_mul_f32 v[56:57], v[56:57], v[244:245] op_sel:[0,1] op_sel_hi:[1,1]
    v_pk_mul_f32 v[58:59], v[58:59], v[244:245] op_sel:[0,1] op_sel_hi:[1,1]
    v_pk_mul_f32 v[60:61], v[60:61], v[216:217]
    v_pk_mul_f32 v[62:63], v[62:63], v[218:219]
    v_pk_mul_f32 v[64:65], v[64:65], v[216:217]
    v_pk_mul_f32 v[66:67], v[66:67], v[218:219]
    v_pk_mul_f32 v[68:69], v[68:69], v[244:245] op_sel:[0,1] op_sel_hi:[1,1]
    v_pk_mul_f32 v[70:71], v[70:71], v[244:245] op_sel:[0,1] op_sel_hi:[1,1]
    v_pk_mul_f32 v[72:73], v[72:73], v[240:241] op_sel:[0,1] op_sel_hi:[1,1]
    v_pk_mul_f32 v[74:75], v[74:75], v[240:241] op_sel:[0,1] op_sel_hi:[1,1]
    v_pk_mul_f32 v[76:77], v[76:77], v[208:209]
    v_pk_mul_f32 v[78:79], v[78:79], v[210:211]
    v_cvt_pk_bf16_f32 v172, v52, v53
    v_cvt_pk_bf16_f32 v173, v54, v55
    v_cvt_pk_bf16_f32 v176, v56, v57
    v_cvt_pk_bf16_f32 v177, v58, v59
    v_cvt_pk_bf16_f32 v182, v60, v61
    v_cvt_pk_bf16_f32 v183, v62, v63
    v_cvt_pk_bf16_f32 v188, v64, v65
    v_cvt_pk_bf16_f32 v189, v66, v67
    v_cvt_pk_bf16_f32 v174, v68, v69
    v_cvt_pk_bf16_f32 v175, v70, v71
    v_cvt_pk_bf16_f32 v220, v72, v73
    v_cvt_pk_bf16_f32 v221, v74, v75
    v_cvt_pk_bf16_f32 v222, v76, v77
    v_cvt_pk_bf16_f32 v223, v78, v79
    s_cmp_eq_u32 s20, 3
    s_cbranch_scc1 L_a_nw
    ds_write2st64_b64 v9, v[172:173], v[174:175] offset0:6 offset1:7
    ds_write2st64_b64 v9, v[176:177], v[182:183] offset0:8 offset1:9
    ds_write_b64 v9, v[188:189] offset:5120
    ds_write2st64_b64 v10, v[220:221], v[222:223] offset0:0 offset1:3
L_a_nw:
    v_pk_mul_f32 v[24:25], v[24:25], v[242:243] op_sel:[0,1] op_sel_hi:[1,1]
    v_pk_mul_f32 v[26:27], v[26:27], v[242:243] op_sel:[0,1] op_sel_hi:[1,1]
    v_pk_mul_f32 v[28:29], v[28:29], v[242:243] op_sel:[0,1] op_sel_hi:[1,1]
    v_pk_mul_f32 v[30:31], v[30:31], v[242:243] op_sel:[0,1] op_sel_hi:[1,1]
    v_pk_mul_f32 v[32:33], v[32:33], v[212:213]
    v_pk_mul_f32 v[34:35], v[34:35], v[214:215]
    v_pk_mul_f32 v[36:37], v[36:37], v[212:213]
    v_pk_mul_f32 v[38:39], v[38:39], v[214:215]
    v_pk_mul_f32 v[40:41], v[40:41], v[242:243] op_sel:[0,1] op_sel_hi:[1,1]
    v_pk_mul_f32 v[42:43], v[42:43], v[242:243] op_sel:[0,1] op_sel_hi:[1,1]
    v_cvt_pk_bf16_f32 v166, v24, v25
    v_cvt_pk_bf16_f32 v167, v26, v27
    v_cvt_pk_bf16_f32 v170, v28, v29
    v_cvt_pk_bf16_f32 v171, v30, v31
    v_cvt_pk_bf16_f32 v180, v32, v33
    v_cvt_pk_bf16_f32 v181, v34, v35
    v_cvt_pk_bf16_f32 v186, v36, v37
    v_cvt_pk_bf16_f32 v187, v38, v39
    v_cvt_pk_bf16_f32 v168, v40, v41
    v_cvt_pk_bf16_f32 v169, v42, v43
    s_waitcnt lgkmcnt(0)
    s_barrier
    ds_read2st64_b64 v[160:163], v9 offset0:0 offset1:1
    ds_read_b64 v[164:165], v9 offset:1024
    ds_read_b64 v[178:179], v9 offset:1536
    ds_read_b64 v[184:185], v9 offset:2048
    v_mfma_f32_16x16x16_bf16 v[128:131], v[174:175], v[234:235], 0
    v_mfma_f32_16x16x16_bf16 v[124:127], v[168:169], v[234:235], 0
    v_pk_mul_f32 v[44:45], v[44:45], v[244:245] op_sel:[0,1] op_sel_hi:[1,1]
    v_pk_mul_f32 v[46:47], v[46:47], v[244:245] op_sel:[0,1] op_sel_hi:[1,1]
    v_pk_mul_f32 v[48:49], v[48:49], v[244:245] op_sel:[0,1] op_sel_hi:[1,1]
    v_pk_mul_f32 v[50:51], v[50:51], v[244:245] op_sel:[0,1] op_sel_hi:[1,1]
    v_pk_mul_f32 v[16:17], v[16:17], v[242:243] op_sel:[0,1] op_sel_hi:[1,1]
    v_pk_mul_f32 v[18:19], v[18:19], v[242:243] op_sel:[0,1] op_sel_hi:[1,1]
    v_pk_mul_f32 v[20:21], v[20:21], v[242:243] op_sel:[0,1] op_sel_hi:[1,1]
    v_pk_mul_f32 v[22:23], v[22:23], v[242:243] op_sel:[0,1] op_sel_hi:[1,1]
    v_cvt_pk_bf16_f32 v112, v44, v45
    v_cvt_pk_bf16_f32 v113, v46, v47
    v_cvt_pk_bf16_f32 v118, v48, v49
    v_cvt_pk_bf16_f32 v119, v50, v51
    v_cvt_pk_bf16_f32 v104, v16, v17
    v_cvt_pk_bf16_f32 v105, v18, v19
    v_cvt_pk_bf16_f32 v110, v20, v21
    v_cvt_pk_bf16_f32 v111, v22, v23
    v_permlane16_swap_b32 v114, v174
    v_permlane16_swap_b32 v117, v175
    v_permlane16_swap_b32 v106, v168
    v_permlane16_swap_b32 v109, v169
    s_waitcnt lgkmcnt(0)
    v_mfma_f32_16x16x16_bf16 v[120:123], v[162:163], v[234:235], 0
    v_mfma_f32_16x16x32_bf16 v[20:23], v[172:175], v[112:115], 0
    v_mfma_f32_16x16x32_bf16 v[16:19], v[166:169], v[112:115], 0
    v_mfma_f32_16x16x32_bf16 v[28:31], v[174:177], v[116:119], 0
    v_mfma_f32_16x16x32_bf16 v[24:27], v[168:171], v[116:119], 0
    v_mfma_f32_16x16x32_bf16 v[36:39], v[166:169], v[104:107], 0
    v_mfma_f32_16x16x32_bf16 v[32:35], v[160:163], v[104:107], 0
    v_mfma_f32_16x16x32_bf16 v[44:47], v[168:171], v[108:111], 0
    v_mfma_f32_16x16x32_bf16 v[40:43], v[162:165], v[108:111], 0
    v_cvt_pk_bf16_f32 v194, v128, v129
    v_cvt_pk_bf16_f32 v195, v130, v131
    v_cvt_pk_bf16_f32 v192, v124, v125
    v_cvt_pk_bf16_f32 v193, v126, v127
    v_cvt_pk_bf16_f32 v190, v120, v121
    v_cvt_pk_bf16_f32 v191, v122, v123
    v_cndmask_b32 v20, v20, v21, s[40:41]
    v_cndmask_b32 v16, v16, v17, s[40:41]
    v_cndmask_b32 v48, v16, v20, s[42:43]
    v_cndmask_b32 v22, v22, v23, s[40:41]
    v_cndmask_b32 v18, v18, v19, s[40:41]
    v_cndmask_b32 v49, v18, v22, s[44:45]
    v_max_f32 v56, v48, v49
    v_cndmask_b32 v28, v28, v29, s[40:41]
    v_cndmask_b32 v24, v24, v25, s[40:41]
    v_cndmask_b32 v50, v24, v28, s[42:43]
    v_cndmask_b32 v30, v30, v31, s[40:41]
    v_cndmask_b32 v26, v26, v27, s[40:41]
    v_cndmask_b32 v51, v26, v30, s[44:45]
    v_max_f32 v57, v50, v51
    v_cndmask_b32 v36, v36, v37, s[40:41]
    v_cndmask_b32 v32, v32, v33, s[40:41]
    v_cndmask_b32 v52, v32, v36, s[42:43]
    v_cndmask_b32 v52, v8, v52, s[48:49]
    v_cndmask_b32 v38, v38, v39, s[40:41]
    v_cndmask_b32 v34, v34, v35, s[40:41]
    v_cndmask_b32 v53, v34, v38, s[44:45]
    v_cndmask_b32 v53, v8, v53, s[38:39]
    v_max_f32 v58, v52, v53
    v_permlane32_swap_b32 v56, v57
    v_max_f32 v56, v56, v57
    v_cndmask_b32 v44, v44, v45, s[40:41]
    v_cndmask_b32 v40, v40, v41, s[40:41]
    v_cndmask_b32 v54, v40, v44, s[42:43]
    v_cndmask_b32 v54, v8, v54, s[48:49]
    v_cndmask_b32 v46, v46, v47, s[40:41]
    v_cndmask_b32 v42, v42, v43, s[40:41]
    v_cndmask_b32 v55, v42, v46, s[44:45]
    v_cndmask_b32 v55, v8, v55, s[38:39]
    v_max_f32 v59, v54, v55
    s_nop 1
    v_permlane32_swap_b32 v58, v59
    v_max_f32 v58, v58, v59
    s_nop 1
    v_permlane16_swap_b32 v56, v58
    v_max_f32 v57, v56, v58
    v_mul_f32 v56, s33, v57
    v_mul_f32 v58, s33, v57
    s_nop 1
    v_permlane16_swap_b32 v56, v58
    v_mov_b32 v57, v56
    v_mov_b32 v59, v58
    s_nop 0
    v_permlane32_swap_b32 v56, v57
    v_permlane32_swap_b32 v58, v59
    v_fma_f32 v48, v48, s33, -v56
    v_fma_f32 v49, v49, s33, -v56
    v_fma_f32 v50, v50, s33, -v57
    v_fma_f32 v51, v51, s33, -v57
    v_fma_f32 v52, v52, s33, -v58
    v_fma_f32 v53, v53, s33, -v58
    v_fma_f32 v54, v54, s33, -v59
    v_fma_f32 v55, v55, s33, -v59
    v_exp_f32 v48, v48
    v_exp_f32 v49, v49
    v_exp_f32 v50, v50
    v_exp_f32 v51, v51
    v_exp_f32 v52, v52
    v_exp_f32 v53, v53
    v_exp_f32 v54, v54
    v_exp_f32 v55, v55
    v_cvt_pk_bf16_f32 v56, v48, v49
    v_cvt_pk_bf16_f32 v57, v50, v51
    v_cvt_pk_bf16_f32 v58, v52, v53
    v_cvt_pk_bf16_f32 v59, v54, v55
    v_perm_b32 v64, v56, v56, v12
    v_perm_b32 v65, v56, v56, v13
    v_perm_b32 v66, v56, v56, v14
    v_perm_b32 v67, v56, v56, v15
    v_perm_b32 v68, v57, v57, v12
    v_perm_b32 v69, v57, v57, v13
    v_perm_b32 v70, v57, v57, v14
    v_perm_b32 v71, v57, v57, v15
    v_perm_b32 v72, v58, v58, v12
    v_perm_b32 v73, v58, v58, v13
    v_perm_b32 v74, v58, v58, v14
    v_perm_b32 v75, v58, v58, v15
    v_perm_b32 v76, v59, v59, v12
    v_perm_b32 v77, v59, v59, v13
    v_perm_b32 v78, v59, v59, v14
    v_perm_b32 v79, v59, v59, v15
    v_mfma_f32_16x16x32_bf16 v[80:83], v[236:239], v[64:67], 0
    v_mfma_f32_16x16x32_bf16 v[84:87], v[236:239], v[68:71], 0
    v_mfma_f32_16x16x32_bf16 v[88:91], v[236:239], v[72:75], 0
    v_mfma_f32_16x16x32_bf16 v[92:95], v[236:239], v[76:79], 0
    v_mfma_f32_16x16x32_bf16 v[16:19], v[180:183], v[64:67], 0
    v_mfma_f32_16x16x32_bf16 v[20:23], v[192:195], v[64:67], 0
    v_mfma_f32_16x16x32_bf16 v[24:27], v[186:189], v[68:71], 0
    v_mfma_f32_16x16x32_bf16 v[28:31], v[192:195], v[68:71], 0
    v_mfma_f32_16x16x32_bf16 v[32:35], v[178:181], v[72:75], 0
    v_mfma_f32_16x16x32_bf16 v[36:39], v[190:193], v[72:75], 0
    v_mfma_f32_16x16x32_bf16 v[40:43], v[184:187], v[76:79], 0
    v_mfma_f32_16x16x32_bf16 v[44:47], v[190:193], v[76:79], 0
    v_rcp_f32 v80, v80
    v_rcp_f32 v84, v84
    v_rcp_f32 v88, v88
    v_rcp_f32 v92, v92
    v_pk_mul_f32 v[16:17], v[16:17], v[80:81] op_sel_hi:[1,0]
    v_pk_mul_f32 v[18:19], v[18:19], v[80:81] op_sel_hi:[1,0]
    v_pk_mul_f32 v[20:21], v[20:21], v[80:81] op_sel_hi:[1,0]
    v_pk_mul_f32 v[24:25], v[24:25], v[84:85] op_sel_hi:[1,0]
    v_pk_mul_f32 v[26:27], v[26:27], v[84:85] op_sel_hi:[1,0]
    v_pk_mul_f32 v[30:31], v[30:31], v[84:85] op_sel_hi:[1,0]
    v_cvt_pk_bf16_f32 v220, v16, v17
    v_cvt_pk_bf16_f32 v221, v18, v19
    v_cvt_pk_bf16_f32 v224, v20, v21
    v_cvt_pk_bf16_f32 v222, v24, v25
    v_cvt_pk_bf16_f32 v223, v26, v27
    v_cvt_pk_bf16_f32 v225, v30, v31
    buffer_store_dwordx4 v[220:223], v5, s[4:7], s35 offen sc1
    buffer_store_dwordx2 v[224:225], v7, s[4:7], s35 offen sc1
    v_pk_mul_f32 v[32:33], v[32:33], v[88:89] op_sel_hi:[1,0]
    v_pk_mul_f32 v[34:35], v[34:35], v[88:89] op_sel_hi:[1,0]
    v_pk_mul_f32 v[36:37], v[36:37], v[88:89] op_sel_hi:[1,0]
    v_pk_mul_f32 v[40:41], v[40:41], v[92:93] op_sel_hi:[1,0]
    v_pk_mul_f32 v[42:43], v[42:43], v[92:93] op_sel_hi:[1,0]
    v_pk_mul_f32 v[46:47], v[46:47], v[92:93] op_sel_hi:[1,0]
    v_cvt_pk_bf16_f32 v228, v32, v33
    v_cvt_pk_bf16_f32 v229, v34, v35
    v_cvt_pk_bf16_f32 v232, v36, v37
    v_cvt_pk_bf16_f32 v230, v40, v41
    v_cvt_pk_bf16_f32 v231, v42, v43
    v_cvt_pk_bf16_f32 v233, v46, v47
    buffer_store_dwordx4 v[228:231], v4, s[4:7], s35 offen sc1
    buffer_store_dwordx2 v[232:233], v6, s[4:7], s35 offen sc1
    s_and_b32 s25, s2, 7
    s_lshr_b32 s26, s2, 3
    s_lshr_b32 s23, s25, 1
    s_lshl_b32 s23, s23, 3
    s_lshr_b32 s27, s26, 2
    s_add_u32 s23, s23, s27
    s_and_b32 s24, s25, 1
    s_lshl_b32 s24, s24, 2
    s_and_b32 s27, s26, 3
    s_add_u32 s24, s24, s27
    s_add_u32 s25, s23, s24
    s_and_b32 s25, s25, 3
    s_lshl_b32 s30, s23, 2
    s_add_u32 s30, s30, s20
    s_mul_i32 s29, s30, 18432
    s_add_u32 s29, s29, s21
    s_add_u32 s29, s29, 0x600000
    s_mul_i32 s34, s30, 18432
    s_add_u32 s34, s34, s21
    s_add_u32 s34, s34, 0x0
    s_lshl_b32 s35, s24, 11
    s_lshr_b32 s36, s24, 2
    s_lshl_b32 s36, s36, 10
    s_and_b32 s37, s24, 3
    s_lshl_b32 s37, s37, 8
    s_add_u32 s36, s36, s37
    s_add_u32 s36, s36, 16384
    v_bfe_u32 v2, v1, 4, 4
    v_lshrrev_b32 v3, 8, v1
    v_add_u32 v4, s35, v1
    v_lshlrev_b32 v5, 4, v2
    v_lshl_add_u32 v5, v3, 3, v5
    v_add_u32 v5, s36, v5
    v_cmp_gt_u32 s[40:41], 2, v3
    v_bfrev_b32 v6, 1
    v_add_u32 v12, 0, v1
    v_add_u32 v13, 36864, v1
    v_add_u32 v14, 73728, v1
    v_add_u32 v15, 110592, v1
    v_cndmask_b32 v5, v6, v5, s[40:41]
    buffer_load_dwordx4 v[208:211], v4, s[4:7], s34 offen offset:0 sc1
    buffer_load_dwordx4 v[212:215], v4, s[4:7], s34 offen offset:1024 sc1
    buffer_load_dwordx2 v[216:217], v5, s[4:7], s34 offen sc1
    s_add_u32 s34, s34, 0x300000
    s_lshl_b32 s39, s30, 10
    s_add_u32 s39, s39, s21
    s_lshl_b32 s42, s24, 7
    s_add_u32 s39, s39, s42
    s_add_u32 s39, s39, 0x1b20000
    v_cmp_eq_u32 vcc, 0, v3
    v_lshlrev_b32 v10, 3, v2
    v_mov_b32 v11, 0x3f803f80
    v_lshl_add_u32 v7, v3, 8, v10
    v_cndmask_b32 v10, v6, v10, vcc
    s_lshr_b32 s44, s23, 1
    s_lshl_b32 s52, s22, 7
    s_add_u32 s52, s52, s44
    s_lshl_b32 s52, s52, 8
    s_add_u32 s52, s52, 0x4508000
    s_add_u32 s52, s52, s4
    s_addc_u32 s53, s5, 0
    s_waitcnt vmcnt(3)
    s_barrier
    s_cmp_lg_u32 s20, 0
    s_cbranch_scc1 L_ns_d2
    s_mov_b32 s56, 1
    s_atomic_add s56, s[50:51], 0
L_ns_d2:
    s_cmp_lg_u32 s20, 0
    s_cbranch_scc1 L_pd_d2
    s_mov_b32 s60, 65536
L_poll_d2:
    s_mov_b32 s57, 0
    s_atomic_add s57, s[52:53], 0 glc
    s_waitcnt lgkmcnt(0)
    s_cmp_ge_u32 s57, 16
    s_cbranch_scc1 L_pd_d2
    s_sub_u32 s60, s60, 1
    s_cbranch_scc1 L_pd_d2
    s_sleep 2
    s_branch L_poll_d2
L_pd_d2:
    s_barrier
    s_mov_b32 s32, 0
    s_lshl_b32 s32, s32, 13
    s_add_u32 s32, s32, s29
    s_add_u32 s33, s32, 4096
    buffer_load_dwordx4 v[112:115], v1, s[4:7], s32 offen offset:0 sc1
    buffer_load_dwordx4 v[116:119], v1, s[4:7], s32 offen offset:1024 sc1
    buffer_load_dwordx4 v[120:123], v1, s[4:7], s32 offen offset:2048 sc1
    buffer_load_dwordx4 v[124:127], v1, s[4:7], s32 offen offset:3072 sc1
    buffer_load_dwordx4 v[128:131], v1, s[4:7], s33 offen offset:0 sc1
    buffer_load_dwordx4 v[132:135], v1, s[4:7], s33 offen offset:1024 sc1
    buffer_load_dwordx4 v[136:139], v1, s[4:7], s33 offen offset:2048 sc1
    buffer_load_dwordx4 v[140:143], v1, s[4:7], s33 offen offset:3072 sc1
    ds_read_b128 v[40:43], v12 offset:18432
    ds_read_b128 v[44:47], v12 offset:19456
    ds_read_b128 v[48:51], v12 offset:20480
    ds_read_b128 v[52:55], v12 offset:21504
    ds_read_b128 v[72:75], v12 offset:26624
    ds_read_b128 v[56:59], v12 offset:22528
    ds_read_b128 v[60:63], v12 offset:23552
    ds_read_b128 v[64:67], v12 offset:24576
    ds_read_b128 v[68:71], v12 offset:25600
    s_add_u32 s45, s29, 8192
    s_add_u32 s46, s29, 12288
    s_add_u32 s47, s29, 16384
    buffer_load_dwordx4 v[144:147], v1, s[4:7], s45 offen offset:0 sc1
    buffer_load_dwordx4 v[148:151], v1, s[4:7], s45 offen offset:1024 sc1
    s_lshl_b32 s42, s23, 3
    s_add_u32 s42, s42, s24
    s_lshl_b32 s42, s42, 2
    s_add_u32 s42, s42, s20
    s_lshl_b32 s42, s42, 8
    s_add_u32 s42, s42, s21
    s_add_u32 s42, s42, 0x1b40000
    v_mov_b32 v220, -1.0
    v_lshrrev_b32 v221, 2, v1
    buffer_store_dword v220, v221, s[4:7], s42 offen sc1
    s_lshl_b32 s50, s22, 7
    s_add_u32 s50, s50, s44
    s_lshl_b32 s50, s50, 8
    s_add_u32 s50, s50, 0x4509000
    s_add_u32 s50, s50, s4
    s_addc_u32 s51, s5, 0
    s_waitcnt vmcnt(11)
    v_lshlrev_b32 v16, 16, v208
    v_and_b32 v17, 0xffff0000, v208
    v_lshlrev_b32 v18, 16, v209
    v_and_b32 v19, 0xffff0000, v209
    v_lshlrev_b32 v20, 16, v210
    v_and_b32 v21, 0xffff0000, v210
    v_lshlrev_b32 v22, 16, v211
    v_and_b32 v23, 0xffff0000, v211
    v_lshlrev_b32 v24, 16, v212
    v_and_b32 v25, 0xffff0000, v212
    v_lshlrev_b32 v26, 16, v213
    v_and_b32 v27, 0xffff0000, v213
    v_lshlrev_b32 v28, 16, v214
    v_and_b32 v29, 0xffff0000, v214
    v_lshlrev_b32 v30, 16, v215
    v_and_b32 v31, 0xffff0000, v215
    v_lshlrev_b32 v32, 16, v216
    v_and_b32 v33, 0xffff0000, v216
    v_lshlrev_b32 v34, 16, v217
    v_and_b32 v35, 0xffff0000, v217
    s_waitcnt vmcnt(9) lgkmcnt(4)
    v_mfma_f32_16x16x32_bf16 v[16:19], v[40:43], v[112:115], v[16:19]
    ds_read_b128 v[76:79], v12 offset:27648
    v_mfma_f32_16x16x32_bf16 v[20:23], v[44:47], v[112:115], v[20:23]
    ds_read_b128 v[80:83], v12 offset:28672
    buffer_load_dwordx4 v[152:155], v1, s[4:7], s45 offen offset:2048 sc1
    v_mfma_f32_16x16x32_bf16 v[24:27], v[48:51], v[112:115], v[24:27]
    ds_read_b128 v[84:87], v12 offset:29696
    v_mfma_f32_16x16x32_bf16 v[28:31], v[52:55], v[112:115], v[28:31]
    ds_read_b128 v[88:91], v12 offset:30720
    v_mfma_f32_16x16x32_bf16 v[32:35], v[72:75], v[112:115], v[32:35]
    ds_read_b128 v[108:111], v12 offset:35840
    s_waitcnt lgkmcnt(5)
    buffer_load_dwordx4 v[156:159], v1, s[4:7], s45 offen offset:3072 sc1
    v_mfma_f32_16x16x32_bf16 v[16:19], v[56:59], v[116:119], v[16:19]
    ds_read_b128 v[92:95], v12 offset:31744
    v_mfma_f32_16x16x32_bf16 v[20:23], v[60:63], v[116:119], v[20:23]
    ds_read_b128 v[96:99], v12 offset:32768
    v_mfma_f32_16x16x32_bf16 v[24:27], v[64:67], v[116:119], v[24:27]
    ds_read_b128 v[100:103], v12 offset:33792
    buffer_load_dwordx4 v[160:163], v1, s[4:7], s46 offen offset:0 sc1
    v_mfma_f32_16x16x32_bf16 v[28:31], v[68:71], v[116:119], v[28:31]
    ds_read_b128 v[104:107], v12 offset:34816
    v_mfma_f32_16x16x32_bf16 v[36:39], v[72:75], v[116:119], 0
    s_waitcnt vmcnt(10) lgkmcnt(4)
    v_mfma_f32_16x16x32_bf16 v[16:19], v[76:79], v[120:123], v[16:19]
    ds_read_b128 v[40:43], v13 offset:18432
    v_mfma_f32_16x16x32_bf16 v[20:23], v[80:83], v[120:123], v[20:23]
    ds_read_b128 v[44:47], v13 offset:19456
    buffer_load_dwordx4 v[164:167], v1, s[4:7], s46 offen offset:1024 sc1
    v_mfma_f32_16x16x32_bf16 v[24:27], v[84:87], v[120:123], v[24:27]
    ds_read_b128 v[48:51], v13 offset:20480
    v_mfma_f32_16x16x32_bf16 v[28:31], v[88:91], v[120:123], v[28:31]
    ds_read_b128 v[52:55], v13 offset:21504
    v_mfma_f32_16x16x32_bf16 v[32:35], v[108:111], v[120:123], v[32:35]
    ds_read_b128 v[72:75], v13 offset:26624
    s_waitcnt lgkmcnt(5)
    buffer_load_dwordx4 v[168:171], v1, s[4:7], s46 offen offset:2048 sc1
    v_mfma_f32_16x16x32_bf16 v[16:19], v[92:95], v[124:127], v[16:19]
    ds_read_b128 v[56:59], v13 offset:22528
    v_mfma_f32_16x16x32_bf16 v[20:23], v[96:99], v[124:127], v[20:23]
    ds_read_b128 v[60:63], v13 offset:23552
    v_mfma_f32_16x16x32_bf16 v[24:27], v[100:103], v[124:127], v[24:27]
    ds_read_b128 v[64:67], v13 offset:24576
    buffer_load_dwordx4 v[172:175], v1, s[4:7], s46 offen offset:3072 sc1
    v_mfma_f32_16x16x32_bf16 v[28:31], v[104:107], v[124:127], v[28:31]
    ds_read_b128 v[68:71], v13 offset:25600
    v_mfma_f32_16x16x32_bf16 v[36:39], v[108:111], v[124:127], v[36:39]
    s_waitcnt vmcnt(11) lgkmcnt(4)
    v_mfma_f32_16x16x32_bf16 v[16:19], v[40:43], v[128:131], v[16:19]
    ds_read_b128 v[76:79], v13 offset:27648
    v_mfma_f32_16x16x32_bf16 v[20:23], v[44:47], v[128:131], v[20:23]
    ds_read_b128 v[80:83], v13 offset:28672
    buffer_load_dwordx2 v[176:177], v7, s[4:7], s47 offen offset:0 sc1
    v_mfma_f32_16x16x32_bf16 v[24:27], v[48:51], v[128:131], v[24:27]
    ds_read_b128 v[84:87], v13 offset:29696
    v_mfma_f32_16x16x32_bf16 v[28:31], v[52:55], v[128:131], v[28:31]
    ds_read_b128 v[88:91], v13 offset:30720
    v_mfma_f32_16x16x32_bf16 v[32:35], v[72:75], v[128:131], v[32:35]
    ds_read_b128 v[108:111], v13 offset:35840
    s_waitcnt lgkmcnt(5)
    buffer_load_dwordx2 v[178:179], v7, s[4:7], s47 offen offset:128 sc1
    v_mfma_f32_16x16x32_bf16 v[16:19], v[56:59], v[132:135], v[16:19]
    ds_read_b128 v[92:95], v13 offset:31744
    v_mfma_f32_16x16x32_bf16 v[20:23], v[60:63], v[132:135], v[20:23]
    ds_read_b128 v[96:99], v13 offset:32768
    v_mfma_f32_16x16x32_bf16 v[24:27], v[64:67], v[132:135], v[24:27]
    ds_read_b128 v[100:103], v13 offset:33792
    buffer_load_dwordx2 v[180:181], v7, s[4:7], s47 offen offset:1024 sc1
    v_mfma_f32_16x16x32_bf16 v[28:31], v[68:71], v[132:135], v[28:31]
    ds_read_b128 v[104:107], v13 offset:34816
    v_mfma_f32_16x16x32_bf16 v[36:39], v[72:75], v[132:135], v[36:39]
    s_waitcnt vmcnt(12) lgkmcnt(4)
    v_mfma_f32_16x16x32_bf16 v[16:19], v[76:79], v[136:139], v[16:19]
    ds_read_b128 v[40:43], v14 offset:18432
    v_mfma_f32_16x16x32_bf16 v[20:23], v[80:83], v[136:139], v[20:23]
    ds_read_b128 v[44:47], v14 offset:19456
    buffer_load_dwordx2 v[182:183], v7, s[4:7], s47 offen offset:1152 sc1
    v_mfma_f32_16x16x32_bf16 v[24:27], v[84:87], v[136:139], v[24:27]
    ds_read_b128 v[48:51], v14 offset:20480
    v_mfma_f32_16x16x32_bf16 v[28:31], v[88:91], v[136:139], v[28:31]
    ds_read_b128 v[52:55], v14 offset:21504
    v_mfma_f32_16x16x32_bf16 v[32:35], v[108:111], v[136:139], v[32:35]
    ds_read_b128 v[72:75], v14 offset:26624
    s_waitcnt lgkmcnt(5)
    v_mfma_f32_16x16x32_bf16 v[16:19], v[92:95], v[140:143], v[16:19]
    ds_read_b128 v[56:59], v14 offset:22528
    v_mfma_f32_16x16x32_bf16 v[20:23], v[96:99], v[140:143], v[20:23]
    ds_read_b128 v[60:63], v14 offset:23552
    v_mfma_f32_16x16x32_bf16 v[24:27], v[100:103], v[140:143], v[24:27]
    ds_read_b128 v[64:67], v14 offset:24576
    v_mfma_f32_16x16x32_bf16 v[28:31], v[104:107], v[140:143], v[28:31]
    ds_read_b128 v[68:71], v14 offset:25600
    v_mfma_f32_16x16x32_bf16 v[36:39], v[108:111], v[140:143], v[36:39]
    s_waitcnt vmcnt(11) lgkmcnt(4)
    v_mfma_f32_16x16x32_bf16 v[16:19], v[40:43], v[144:147], v[16:19]
    ds_read_b128 v[76:79], v14 offset:27648
    v_mfma_f32_16x16x32_bf16 v[20:23], v[44:47], v[144:147], v[20:23]
    ds_read_b128 v[80:83], v14 offset:28672
    v_mfma_f32_16x16x32_bf16 v[24:27], v[48:51], v[144:147], v[24:27]
    ds_read_b128 v[84:87], v14 offset:29696
    v_mfma_f32_16x16x32_bf16 v[28:31], v[52:55], v[144:147], v[28:31]
    ds_read_b128 v[88:91], v14 offset:30720
    v_mfma_f32_16x16x32_bf16 v[32:35], v[72:75], v[144:147], v[32:35]
    ds_read_b128 v[108:111], v14 offset:35840
    s_waitcnt lgkmcnt(5)
    v_mfma_f32_16x16x32_bf16 v[16:19], v[56:59], v[148:151], v[16:19]
    ds_read_b128 v[92:95], v14 offset:31744
    v_mfma_f32_16x16x32_bf16 v[20:23], v[60:63], v[148:151], v[20:23]
    ds_read_b128 v[96:99], v14 offset:32768
    v_mfma_f32_16x16x32_bf16 v[24:27], v[64:67], v[148:151], v[24:27]
    ds_read_b128 v[100:103], v14 offset:33792
    v_mfma_f32_16x16x32_bf16 v[28:31], v[68:71], v[148:151], v[28:31]
    ds_read_b128 v[104:107], v14 offset:34816
    v_mfma_f32_16x16x32_bf16 v[36:39], v[72:75], v[148:151], v[36:39]
    s_waitcnt vmcnt(8) lgkmcnt(4)
    v_mfma_f32_16x16x32_bf16 v[16:19], v[76:79], v[152:155], v[16:19]
    ds_read_b128 v[40:43], v15 offset:18432
    v_mfma_f32_16x16x32_bf16 v[20:23], v[80:83], v[152:155], v[20:23]
    ds_read_b128 v[44:47], v15 offset:19456
    v_mfma_f32_16x16x32_bf16 v[24:27], v[84:87], v[152:155], v[24:27]
    ds_read_b128 v[48:51], v15 offset:20480
    v_mfma_f32_16x16x32_bf16 v[28:31], v[88:91], v[152:155], v[28:31]
    ds_read_b128 v[52:55], v15 offset:21504
    v_mfma_f32_16x16x32_bf16 v[32:35], v[108:111], v[152:155], v[32:35]
    ds_read_b128 v[72:75], v15 offset:26624
    s_waitcnt lgkmcnt(5)
    v_mfma_f32_16x16x32_bf16 v[16:19], v[92:95], v[156:159], v[16:19]
    ds_read_b128 v[56:59], v15 offset:22528
    v_mfma_f32_16x16x32_bf16 v[20:23], v[96:99], v[156:159], v[20:23]
    ds_read_b128 v[60:63], v15 offset:23552
    v_mfma_f32_16x16x32_bf16 v[24:27], v[100:103], v[156:159], v[24:27]
    ds_read_b128 v[64:67], v15 offset:24576
    v_mfma_f32_16x16x32_bf16 v[28:31], v[104:107], v[156:159], v[28:31]
    ds_read_b128 v[68:71], v15 offset:25600
    v_mfma_f32_16x16x32_bf16 v[36:39], v[108:111], v[156:159], v[36:39]
    s_waitcnt vmcnt(6) lgkmcnt(4)
    v_mfma_f32_16x16x32_bf16 v[16:19], v[40:43], v[160:163], v[16:19]
    ds_read_b128 v[76:79], v15 offset:27648
    v_mfma_f32_16x16x32_bf16 v[20:23], v[44:47], v[160:163], v[20:23]
    ds_read_b128 v[80:83], v15 offset:28672
    v_mfma_f32_16x16x32_bf16 v[24:27], v[48:51], v[160:163], v[24:27]
    ds_read_b128 v[84:87], v15 offset:29696
    v_mfma_f32_16x16x32_bf16 v[28:31], v[52:55], v[160:163], v[28:31]
    ds_read_b128 v[88:91], v15 offset:30720
    v_mfma_f32_16x16x32_bf16 v[32:35], v[72:75], v[160:163], v[32:35]
    ds_read_b128 v[108:111], v15 offset:35840
    s_waitcnt lgkmcnt(5)
    v_mfma_f32_16x16x32_bf16 v[16:19], v[56:59], v[164:167], v[16:19]
    ds_read_b128 v[92:95], v15 offset:31744
    v_mfma_f32_16x16x32_bf16 v[20:23], v[60:63], v[164:167], v[20:23]
    ds_read_b128 v[96:99], v15 offset:32768
    v_mfma_f32_16x16x32_bf16 v[24:27], v[64:67], v[164:167], v[24:27]
    ds_read_b128 v[100:103], v15 offset:33792
    v_mfma_f32_16x16x32_bf16 v[28:31], v[68:71], v[164:167], v[28:31]
    ds_read_b128 v[104:107], v15 offset:34816
    v_mfma_f32_16x16x32_bf16 v[36:39], v[72:75], v[164:167], v[36:39]
    s_waitcnt vmcnt(4) lgkmcnt(4)
    v_mfma_f32_16x16x32_bf16 v[16:19], v[76:79], v[168:171], v[16:19]
    ds_read_b128 v[40:43], v15 offset:36864
    v_mfma_f32_16x16x32_bf16 v[20:23], v[80:83], v[168:171], v[20:23]
    ds_read_b128 v[44:47], v15 offset:37888
    v_mfma_f32_16x16x32_bf16 v[24:27], v[84:87], v[168:171], v[24:27]
    ds_read_b128 v[48:51], v15 offset:38912
    v_mfma_f32_16x16x32_bf16 v[28:31], v[88:91], v[168:171], v[28:31]
    ds_read_b128 v[52:55], v15 offset:39936
    v_mfma_f32_16x16x32_bf16 v[32:35], v[108:111], v[168:171], v[32:35]
    ds_read_b128 v[72:75], v15 offset:45056
    s_waitcnt lgkmcnt(5)
    v_mfma_f32_16x16x32_bf16 v[16:19], v[92:95], v[172:175], v[16:19]
    ds_read_b128 v[56:59], v15 offset:40960
    v_mfma_f32_16x16x32_bf16 v[20:23], v[96:99], v[172:175], v[20:23]
    ds_read_b128 v[60:63], v15 offset:41984
    v_mfma_f32_16x16x32_bf16 v[24:27], v[100:103], v[172:175], v[24:27]
    ds_read_b128 v[64:67], v15 offset:43008
    v_mfma_f32_16x16x32_bf16 v[28:31], v[104:107], v[172:175], v[28:31]
    ds_read_b128 v[68:71], v15 offset:44032
    v_mfma_f32_16x16x32_bf16 v[36:39], v[108:111], v[172:175], v[36:39]
    s_waitcnt vmcnt(0) lgkmcnt(4)
    v_mfma_f32_16x16x32_bf16 v[16:19], v[40:43], v[176:179], v[16:19]
    v_mfma_f32_16x16x32_bf16 v[20:23], v[44:47], v[176:179], v[20:23]
    v_mfma_f32_16x16x32_bf16 v[24:27], v[48:51], v[176:179], v[24:27]
    v_mfma_f32_16x16x32_bf16 v[28:31], v[52:55], v[176:179], v[28:31]
    v_mfma_f32_16x16x32_bf16 v[32:35], v[72:75], v[176:179], v[32:35]
    s_waitcnt lgkmcnt(0)
    v_mfma_f32_16x16x32_bf16 v[16:19], v[56:59], v[180:183], v[16:19]
    v_mfma_f32_16x16x32_bf16 v[20:23], v[60:63], v[180:183], v[20:23]
    v_mfma_f32_16x16x32_bf16 v[24:27], v[64:67], v[180:183], v[24:27]
    v_mfma_f32_16x16x32_bf16 v[28:31], v[68:71], v[180:183], v[28:31]
    v_mfma_f32_16x16x32_bf16 v[36:39], v[72:75], v[180:183], v[36:39]
    s_nop 3
    v_cvt_pk_bf16_f32 v208, v16, v17
    v_cvt_pk_bf16_f32 v209, v18, v19
    v_cvt_pk_bf16_f32 v210, v20, v21
    v_cvt_pk_bf16_f32 v211, v22, v23
    v_cvt_pk_bf16_f32 v212, v24, v25
    v_cvt_pk_bf16_f32 v213, v26, v27
    v_cvt_pk_bf16_f32 v214, v28, v29
    v_cvt_pk_bf16_f32 v215, v30, v31
    buffer_store_dwordx4 v[208:211], v4, s[4:7], s34 offen offset:0 sc1
    buffer_store_dwordx4 v[212:215], v4, s[4:7], s34 offen offset:1024 sc1
    v_permlane32_swap_b32 v36, v220
    v_permlane32_swap_b32 v37, v221
    v_permlane32_swap_b32 v38, v222
    v_permlane32_swap_b32 v39, v223
    v_pk_add_f32 v[32:33], v[32:33], v[220:221]
    v_pk_add_f32 v[34:35], v[34:35], v[222:223]
    v_cvt_pk_bf16_f32 v216, v32, v33
    v_cvt_pk_bf16_f32 v217, v34, v35
    buffer_store_dwordx2 v[216:217], v5, s[4:7], s34 offen sc1
    v_cndmask_b32 v222, 0, v216, s[40:41]
    v_cndmask_b32 v223, 0, v217, s[40:41]
    v_dot2_f32_bf16 v220, v208, v11, 0
    v_dot2_f32_bf16 v221, v208, v208, 0
    v_dot2_f32_bf16 v224, v209, v11, 0
    v_dot2_f32_bf16 v225, v209, v209, 0
    v_dot2_f32_bf16 v220, v210, v11, v220
    v_dot2_f32_bf16 v221, v210, v210, v221
    v_dot2_f32_bf16 v224, v211, v11, v224
    v_dot2_f32_bf16 v225, v211, v211, v225
    v_dot2_f32_bf16 v220, v212, v11, v220
    v_dot2_f32_bf16 v221, v212, v212, v221
    v_dot2_f32_bf16 v224, v213, v11, v224
    v_dot2_f32_bf16 v225, v213, v213, v225
    v_dot2_f32_bf16 v220, v214, v11, v220
    v_dot2_f32_bf16 v221, v214, v214, v221
    v_dot2_f32_bf16 v224, v215, v11, v224
    v_dot2_f32_bf16 v225, v215, v215, v225
    v_dot2_f32_bf16 v220, v222, v11, v220
    v_dot2_f32_bf16 v221, v222, v222, v221
    v_dot2_f32_bf16 v224, v223, v11, v224
    v_dot2_f32_bf16 v225, v223, v223, v225
    s_nop 2
    v_pk_add_f32 v[220:221], v[220:221], v[224:225]
    v_mov_b32 v222, v220
    v_mov_b32 v223, v221
    s_nop 1
    v_permlane32_swap_b32 v220, v222
    v_permlane32_swap_b32 v221, v223
    v_add_f32 v220, v220, v222
    v_add_f32 v221, v221, v223
    v_mov_b32 v222, v220
    v_mov_b32 v223, v221
    s_nop 1
    v_permlane16_swap_b32 v220, v222
    v_permlane16_swap_b32 v221, v223
    v_add_f32 v220, v220, v222
    v_add_f32 v221, v221, v223
    buffer_store_dwordx2 v[220:221], v10, s[4:7], s39 offen sc1
    s_and_b32 s25, s2, 7
    s_lshr_b32 s26, s2, 3
    s_and_b32 s23, s25, 1
    s_lshl_b32 s23, s23, 3
    s_and_b32 s27, s26, 7
    s_add_u32 s23, s23, s27
    s_lshr_b32 s24, s25, 1
    s_lshl_b32 s24, s24, 2
    s_lshr_b32 s27, s26, 3
    s_add_u32 s24, s24, s27
    s_add_u32 s28, s23, s24
    s_and_b32 s28, s28, 3
    s_lshl_b32 s30, s20, 12
    s_lshl_b32 s31, s23, 3
    s_lshl_b32 s33, s20, 1
    s_add_u32 s31, s31, s33
    s_lshl_b32 s32, s31, 10
    s_add_u32 s32, s32, s21
    s_add_u32 s32, s32, 0x1b20000
    v_add_u32 v2, 73728, v1
    s_add_u32 s33, s30, 18432
    v_add_u32 v3, s33, v1
    v_add_u32 v0, s33, v2
    s_lshr_b32 s34, s31, 1
    s_lshl_b32 s35, s34, 12
    s_add_u32 s35, s35, s21
    s_add_u32 s35, s35, 0x1b40000
    s_lshl_b32 s36, s24, 8
    s_add_u32 s36, s36, s35
    s_lshl_b32 s38, s24, 6
    s_add_u32 s38, s38, s34
    s_mul_i32 s38, s38, 9216
    s_add_u32 s38, s38, s21
    s_add_u32 s38, s38, 0x900000
    s_add_u32 s39, s38, 4096
    s_add_u32 s46, s38, 8192
    s_mov_b32 s40, 0xc0135761
    s_mov_b32 s42, 0x3d372713
    s_mov_b32 s44, 0x39e38e39
    s_mov_b32 s45, 0x3727c5ac
    v_lshrrev_b32 v4, 1, v1
    s_lshl_b32 s52, s22, 7
    s_add_u32 s52, s52, s23
    s_lshl_b32 s52, s52, 8
    s_add_u32 s52, s52, 0x4509000
    s_add_u32 s52, s52, s4
    s_addc_u32 s53, s5, 0
    s_waitcnt vmcnt(0)
    s_barrier
    s_cmp_lg_u32 s20, 0
    s_cbranch_scc1 L_ns_d3
    s_mov_b32 s56, 1
    s_atomic_add s56, s[50:51], 0
L_ns_d3:
    s_cmp_lg_u32 s20, 0
    s_cbranch_scc1 L_pd_d3
    s_mov_b32 s60, 65536
L_poll_d3:
    s_mov_b32 s57, 0
    s_atomic_add s57, s[52:53], 0 glc
    s_waitcnt lgkmcnt(0)
    s_cmp_ge_u32 s57, 16
    s_cbranch_scc1 L_pd_d3
    s_sub_u32 s60, s60, 1
    s_cbranch_scc1 L_pd_d3
    s_sleep 2
    s_branch L_poll_d3
L_pd_d3:
    s_barrier
    buffer_load_dwordx2 v[8:9], v4, s[4:7], s32 offen offset:0 sc1
    buffer_load_dwordx2 v[10:11], v4, s[4:7], s32 offen offset:512 sc1
    buffer_load_dwordx2 v[12:13], v4, s[4:7], s32 offen offset:1024 sc1
    buffer_load_dwordx2 v[14:15], v4, s[4:7], s32 offen offset:1536 sc1
    s_lshl_b32 s50, s22, 7
    s_add_u32 s50, s50, s23
    s_lshl_b32 s50, s50, 8
    s_add_u32 s50, s50, 0x450a000
    s_add_u32 s50, s50, s4
    s_addc_u32 s51, s5, 0
    s_barrier
    ds_read_b128 v[160:163], v3 offset:0
    ds_read_b128 v[164:167], v3 offset:2048
    ds_read_b128 v[168:171], v1 offset:0
    ds_read_b128 v[172:175], v1 offset:1024
    ds_read_b128 v[176:179], v1 offset:2048
    ds_read_b128 v[180:183], v1 offset:3072
    ds_read_b128 v[184:187], v1 offset:4096
    ds_read_b128 v[188:191], v1 offset:5120
    ds_read_b128 v[192:195], v1 offset:6144
    ds_read_b128 v[196:199], v1 offset:7168
    ds_read_b128 v[200:203], v1 offset:8192
    s_waitcnt lgkmcnt(5)
    v_mfma_f32_16x16x32_bf16 v[16:19], v[160:163], v[168:171], 0
    ds_read_b128 v[204:207], v3 offset:1024
    v_mfma_f32_16x16x32_bf16 v[20:23], v[164:167], v[168:171], 0
    ds_read_b128 v[208:211], v3 offset:3072
    v_mfma_f32_16x16x32_bf16 v[24:27], v[160:163], v[172:175], 0
    ds_read_b128 v[212:215], v1 offset:9216
    v_mfma_f32_16x16x32_bf16 v[28:31], v[164:167], v[172:175], 0
    ds_read_b128 v[216:219], v1 offset:10240
    v_mfma_f32_16x16x32_bf16 v[32:35], v[160:163], v[176:179], 0
    ds_read_b128 v[220:223], v1 offset:11264
    v_mfma_f32_16x16x32_bf16 v[36:39], v[164:167], v[176:179], 0
    ds_read_b128 v[224:227], v1 offset:12288
    v_mfma_f32_16x16x32_bf16 v[40:43], v[160:163], v[180:183], 0
    ds_read_b128 v[228:231], v1 offset:13312
    v_mfma_f32_16x16x32_bf16 v[44:47], v[164:167], v[180:183], 0
    ds_read_b128 v[232:235], v1 offset:14336
    s_waitcnt lgkmcnt(8)
    v_mfma_f32_16x16x32_bf16 v[48:51], v[160:163], v[184:187], 0
    ds_read_b128 v[236:239], v1 offset:15360
    v_mfma_f32_16x16x32_bf16 v[52:55], v[164:167], v[184:187], 0
    ds_read_b128 v[240:243], v1 offset:16384
    v_mfma_f32_16x16x32_bf16 v[56:59], v[160:163], v[188:191], 0
    ds_read_b128 v[244:247], v1 offset:17408
    v_mfma_f32_16x16x32_bf16 v[60:63], v[164:167], v[188:191], 0
    v_mfma_f32_16x16x32_bf16 v[64:67], v[160:163], v[192:195], 0
    v_mfma_f32_16x16x32_bf16 v[68:71], v[164:167], v[192:195], 0
    v_mfma_f32_16x16x32_bf16 v[72:75], v[160:163], v[196:199], 0
    v_mfma_f32_16x16x32_bf16 v[76:79], v[164:167], v[196:199], 0
    v_mfma_f32_16x16x32_bf16 v[80:83], v[160:163], v[200:203], 0
    v_mfma_f32_16x16x32_bf16 v[84:87], v[164:167], v[200:203], 0
    s_waitcnt lgkmcnt(0)
    s_barrier
    v_mfma_f32_16x16x32_bf16 v[16:19], v[204:207], v[212:215], v[16:19]
    ds_read_b128 v[160:163], v3 offset:36864
    v_mfma_f32_16x16x32_bf16 v[20:23], v[208:211], v[212:215], v[20:23]
    ds_read_b128 v[164:167], v3 offset:38912
    v_mfma_f32_16x16x32_bf16 v[24:27], v[204:207], v[216:219], v[24:27]
    ds_read_b128 v[168:171], v1 offset:36864
    v_mfma_f32_16x16x32_bf16 v[28:31], v[208:211], v[216:219], v[28:31]
    ds_read_b128 v[172:175], v1 offset:37888
    v_mfma_f32_16x16x32_bf16 v[32:35], v[204:207], v[220:223], v[32:35]
    ds_read_b128 v[176:179], v1 offset:38912
    v_mfma_f32_16x16x32_bf16 v[36:39], v[208:211], v[220:223], v[36:39]
    ds_read_b128 v[180:183], v1 offset:39936
    v_mfma_f32_16x16x32_bf16 v[40:43], v[204:207], v[224:227], v[40:43]
    ds_read_b128 v[184:187], v1 offset:40960
    v_mfma_f32_16x16x32_bf16 v[44:47], v[208:211], v[224:227], v[44:47]
    ds_read_b128 v[188:191], v1 offset:41984
    v_mfma_f32_16x16x32_bf16 v[48:51], v[204:207], v[228:231], v[48:51]
    ds_read_b128 v[192:195], v1 offset:43008
    v_mfma_f32_16x16x32_bf16 v[52:55], v[208:211], v[228:231], v[52:55]
    ds_read_b128 v[196:199], v1 offset:44032
    v_lshrrev_b32 v5, 8, v1
    v_mfma_f32_16x16x32_bf16 v[56:59], v[204:207], v[232:235], v[56:59]
    ds_read_b128 v[200:203], v1 offset:45056
    v_bfe_u32 v6, v1, 4, 4
    v_mfma_f32_16x16x32_bf16 v[60:63], v[208:211], v[232:235], v[60:63]
    v_lshlrev_b32 v7, 2, v6
    v_mfma_f32_16x16x32_bf16 v[64:67], v[204:207], v[236:239], v[64:67]
    s_lshl_b32 s33, s20, 8
    v_mfma_f32_16x16x32_bf16 v[68:71], v[208:211], v[236:239], v[68:71]
    s_add_u32 s33, s33, 147456
    v_mfma_f32_16x16x32_bf16 v[72:75], v[204:207], v[240:243], v[72:75]
    v_add_u32 v4, s33, v7
    v_mfma_f32_16x16x32_bf16 v[76:79], v[208:211], v[240:243], v[76:79]
    v_lshl_add_u32 v252, v5, 4, s33
    v_mfma_f32_16x16x32_bf16 v[80:83], v[204:207], v[244:247], v[80:83]
    v_add_u32 v7, 159744, v7
    v_mfma_f32_16x16x32_bf16 v[84:87], v[208:211], v[244:247], v[84:87]
    s_waitcnt vmcnt(0)
    v_add_f32 v248, v8, v10
    s_waitcnt lgkmcnt(5)
    v_mfma_f32_16x16x32_bf16 v[16:19], v[160:163], v[168:171], v[16:19]
    ds_read_b128 v[204:207], v3 offset:37888
    v_mfma_f32_16x16x32_bf16 v[20:23], v[164:167], v[168:171], v[20:23]
    ds_read_b128 v[208:211], v3 offset:39936
    v_mfma_f32_16x16x32_bf16 v[24:27], v[160:163], v[172:175], v[24:27]
    ds_read_b128 v[212:215], v1 offset:46080
    v_mfma_f32_16x16x32_bf16 v[28:31], v[164:167], v[172:175], v[28:31]
    ds_read_b128 v[216:219], v1 offset:47104
    v_mfma_f32_16x16x32_bf16 v[32:35], v[160:163], v[176:179], v[32:35]
    ds_read_b128 v[220:223], v1 offset:48128
    v_mfma_f32_16x16x32_bf16 v[36:39], v[164:167], v[176:179], v[36:39]
    ds_read_b128 v[224:227], v1 offset:49152
    v_mfma_f32_16x16x32_bf16 v[40:43], v[160:163], v[180:183], v[40:43]
    ds_read_b128 v[228:231], v1 offset:50176
    v_mfma_f32_16x16x32_bf16 v[44:47], v[164:167], v[180:183], v[44:47]
    ds_read_b128 v[232:235], v1 offset:51200
    s_waitcnt lgkmcnt(8)
    v_mfma_f32_16x16x32_bf16 v[48:51], v[160:163], v[184:187], v[48:51]
    ds_read_b128 v[236:239], v1 offset:52224
    v_mfma_f32_16x16x32_bf16 v[52:55], v[164:167], v[184:187], v[52:55]
    ds_read_b128 v[240:243], v1 offset:53248
    v_add_f32 v249, v9, v11
    v_mfma_f32_16x16x32_bf16 v[56:59], v[160:163], v[188:191], v[56:59]
    ds_read_b128 v[244:247], v1 offset:54272
    v_add_f32 v250, v12, v14
    v_mfma_f32_16x16x32_bf16 v[60:63], v[164:167], v[188:191], v[60:63]
    v_add_f32 v251, v13, v15
    v_mfma_f32_16x16x32_bf16 v[64:67], v[160:163], v[192:195], v[64:67]
    v_mov_b32 v8, v248
    v_mfma_f32_16x16x32_bf16 v[68:71], v[164:167], v[192:195], v[68:71]
    v_mov_b32 v9, v249
    v_mfma_f32_16x16x32_bf16 v[72:75], v[160:163], v[196:199], v[72:75]
    v_mov_b32 v12, v250
    v_mfma_f32_16x16x32_bf16 v[76:79], v[164:167], v[196:199], v[76:79]
    v_mov_b32 v13, v251
    v_mfma_f32_16x16x32_bf16 v[80:83], v[160:163], v[200:203], v[80:83]
    v_permlane32_swap_b32 v248, v8
    v_mfma_f32_16x16x32_bf16 v[84:87], v[164:167], v[200:203], v[84:87]
    v_permlane32_swap_b32 v249, v9
    v_permlane32_swap_b32 v250, v12
    s_waitcnt lgkmcnt(0)
    s_barrier
    v_mfma_f32_16x16x32_bf16 v[16:19], v[204:207], v[212:215], v[16:19]
    ds_read_b128 v[160:163], v0 offset:0
    v_mfma_f32_16x16x32_bf16 v[20:23], v[208:211], v[212:215], v[20:23]
    ds_read_b128 v[164:167], v0 offset:2048
    v_mfma_f32_16x16x32_bf16 v[24:27], v[204:207], v[216:219], v[24:27]
    ds_read_b128 v[168:171], v2 offset:0
    v_mfma_f32_16x16x32_bf16 v[28:31], v[208:211], v[216:219], v[28:31]
    ds_read_b128 v[172:175], v2 offset:1024
    v_mfma_f32_16x16x32_bf16 v[32:35], v[204:207], v[220:223], v[32:35]
    ds_read_b128 v[176:179], v2 offset:2048
    v_mfma_f32_16x16x32_bf16 v[36:39], v[208:211], v[220:223], v[36:39]
    ds_read_b128 v[180:183], v2 offset:3072
    v_mfma_f32_16x16x32_bf16 v[40:43], v[204:207], v[224:227], v[40:43]
    ds_read_b128 v[184:187], v2 offset:4096
    v_mfma_f32_16x16x32_bf16 v[44:47], v[208:211], v[224:227], v[44:47]
    ds_read_b128 v[188:191], v2 offset:5120
    v_mfma_f32_16x16x32_bf16 v[48:51], v[204:207], v[228:231], v[48:51]
    ds_read_b128 v[192:195], v2 offset:6144
    v_mfma_f32_16x16x32_bf16 v[52:55], v[208:211], v[228:231], v[52:55]
    ds_read_b128 v[196:199], v2 offset:7168
    v_permlane32_swap_b32 v251, v13
    v_mfma_f32_16x16x32_bf16 v[56:59], v[204:207], v[232:235], v[56:59]
    ds_read_b128 v[200:203], v2 offset:8192
    v_add_f32 v248, v248, v8
    v_mfma_f32_16x16x32_bf16 v[60:63], v[208:211], v[232:235], v[60:63]
    ds_read2_b32 v[128:129], v7 offset0:0 offset1:16
    v_add_f32 v249, v249, v9
    v_mfma_f32_16x16x32_bf16 v[64:67], v[204:207], v[236:239], v[64:67]
    ds_read2_b32 v[130:131], v7 offset0:32 offset1:48
    v_add_f32 v250, v250, v12
    v_mfma_f32_16x16x32_bf16 v[68:71], v[208:211], v[236:239], v[68:71]
    ds_read2_b32 v[132:133], v7 offset0:64 offset1:80
    v_add_f32 v251, v251, v13
    v_mfma_f32_16x16x32_bf16 v[72:75], v[204:207], v[240:243], v[72:75]
    ds_read2_b32 v[134:135], v7 offset0:96 offset1:112
    v_mov_b32 v8, v248
    v_mfma_f32_16x16x32_bf16 v[76:79], v[208:211], v[240:243], v[76:79]
    ds_read2_b32 v[136:137], v7 offset0:128 offset1:144
    v_mov_b32 v9, v249
    v_mfma_f32_16x16x32_bf16 v[80:83], v[204:207], v[244:247], v[80:83]
    v_mov_b32 v12, v250
    v_mfma_f32_16x16x32_bf16 v[84:87], v[208:211], v[244:247], v[84:87]
    v_mov_b32 v13, v251
    v_permlane16_swap_b32 v248, v8
    s_waitcnt lgkmcnt(10)
    v_mfma_f32_16x16x32_bf16 v[16:19], v[160:163], v[168:171], v[16:19]
    ds_read_b128 v[204:207], v0 offset:1024
    v_mfma_f32_16x16x32_bf16 v[20:23], v[164:167], v[168:171], v[20:23]
    ds_read_b128 v[208:211], v0 offset:3072
    v_mfma_f32_16x16x32_bf16 v[24:27], v[160:163], v[172:175], v[24:27]
    ds_read_b128 v[212:215], v2 offset:9216
    v_mfma_f32_16x16x32_bf16 v[28:31], v[164:167], v[172:175], v[28:31]
    ds_read_b128 v[216:219], v2 offset:10240
    v_mfma_f32_16x16x32_bf16 v[32:35], v[160:163], v[176:179], v[32:35]
    ds_read_b128 v[220:223], v2 offset:11264
    v_mfma_f32_16x16x32_bf16 v[36:39], v[164:167], v[176:179], v[36:39]
    ds_read_b128 v[224:227], v2 offset:12288
    v_mfma_f32_16x16x32_bf16 v[40:43], v[160:163], v[180:183], v[40:43]
    ds_read_b128 v[228:231], v2 offset:13312
    v_mfma_f32_16x16x32_bf16 v[44:47], v[164:167], v[180:183], v[44:47]
    ds_read_b128 v[232:235], v2 offset:14336
    s_waitcnt lgkmcnt(8)
    v_mfma_f32_16x16x32_bf16 v[48:51], v[160:163], v[184:187], v[48:51]
    ds_read_b128 v[236:239], v2 offset:15360
    v_mfma_f32_16x16x32_bf16 v[52:55], v[164:167], v[184:187], v[52:55]
    ds_read_b128 v[240:243], v2 offset:16384
    v_permlane16_swap_b32 v249, v9
    v_mfma_f32_16x16x32_bf16 v[56:59], v[160:163], v[188:191], v[56:59]
    ds_read_b128 v[244:247], v2 offset:17408
    v_permlane16_swap_b32 v250, v12
    v_mfma_f32_16x16x32_bf16 v[60:63], v[164:167], v[188:191], v[60:63]
    v_permlane16_swap_b32 v251, v13
    v_mfma_f32_16x16x32_bf16 v[64:67], v[160:163], v[192:195], v[64:67]
    v_add_f32 v248, v248, v8
    v_mfma_f32_16x16x32_bf16 v[68:71], v[164:167], v[192:195], v[68:71]
    v_add_f32 v249, v249, v9
    v_mfma_f32_16x16x32_bf16 v[72:75], v[160:163], v[196:199], v[72:75]
    v_add_f32 v250, v250, v12
    v_mfma_f32_16x16x32_bf16 v[76:79], v[164:167], v[196:199], v[76:79]
    v_add_f32 v251, v251, v13
    v_mfma_f32_16x16x32_bf16 v[80:83], v[160:163], v[200:203], v[80:83]
    v_mul_f32 v248, 0x3ae38e39, v248
    v_mfma_f32_16x16x32_bf16 v[84:87], v[164:167], v[200:203], v[84:87]
    v_mul_f32 v249, 0x3ae38e39, v249
    v_mul_f32 v250, 0x3ae38e39, v250
    s_waitcnt lgkmcnt(0)
    s_barrier
    v_mfma_f32_16x16x32_bf16 v[16:19], v[204:207], v[212:215], v[16:19]
    ds_read_b128 v[160:163], v0 offset:36864
    v_mfma_f32_16x16x32_bf16 v[20:23], v[208:211], v[212:215], v[20:23]
    ds_read_b128 v[164:167], v0 offset:38912
    v_mfma_f32_16x16x32_bf16 v[24:27], v[204:207], v[216:219], v[24:27]
    ds_read_b128 v[168:171], v2 offset:36864
    v_mfma_f32_16x16x32_bf16 v[28:31], v[208:211], v[216:219], v[28:31]
    ds_read_b128 v[172:175], v2 offset:37888
    v_mfma_f32_16x16x32_bf16 v[32:35], v[204:207], v[220:223], v[32:35]
    ds_read_b128 v[176:179], v2 offset:38912
    v_mfma_f32_16x16x32_bf16 v[36:39], v[208:211], v[220:223], v[36:39]
    ds_read_b128 v[180:183], v2 offset:39936
    v_mfma_f32_16x16x32_bf16 v[40:43], v[204:207], v[224:227], v[40:43]
    ds_read_b128 v[184:187], v2 offset:40960
    v_mfma_f32_16x16x32_bf16 v[44:47], v[208:211], v[224:227], v[44:47]
    ds_read_b128 v[188:191], v2 offset:41984
    v_mfma_f32_16x16x32_bf16 v[48:51], v[204:207], v[228:231], v[48:51]
    ds_read_b128 v[192:195], v2 offset:43008
    v_mfma_f32_16x16x32_bf16 v[52:55], v[208:211], v[228:231], v[52:55]
    ds_read_b128 v[196:199], v2 offset:44032
    v_mul_f32 v251, 0x3ae38e39, v251
    v_mfma_f32_16x16x32_bf16 v[56:59], v[204:207], v[232:235], v[56:59]
    ds_read_b128 v[200:203], v2 offset:45056
    v_fma_f32 v249, -v248, v248, v249
    v_mfma_f32_16x16x32_bf16 v[60:63], v[208:211], v[232:235], v[60:63]
    v_fma_f32 v251, -v250, v250, v251
    v_mfma_f32_16x16x32_bf16 v[64:67], v[204:207], v[236:239], v[64:67]
    v_max_f32 v249, 0, v249
    v_mfma_f32_16x16x32_bf16 v[68:71], v[208:211], v[236:239], v[68:71]
    v_max_f32 v251, 0, v251
    v_mfma_f32_16x16x32_bf16 v[72:75], v[204:207], v[240:243], v[72:75]
    v_add_f32 v249, 0x3727c5ac, v249
    v_mfma_f32_16x16x32_bf16 v[76:79], v[208:211], v[240:243], v[76:79]
    v_add_f32 v251, 0x3727c5ac, v251
    v_mfma_f32_16x16x32_bf16 v[80:83], v[204:207], v[244:247], v[80:83]
    v_rsq_f32 v249, v249
    v_mfma_f32_16x16x32_bf16 v[84:87], v[208:211], v[244:247], v[84:87]
    v_rsq_f32 v251, v251
    s_nop 0
    s_waitcnt lgkmcnt(5)
    v_mfma_f32_16x16x32_bf16 v[16:19], v[160:163], v[168:171], v[16:19]
    ds_read_b128 v[204:207], v0 offset:37888
    v_mfma_f32_16x16x32_bf16 v[20:23], v[164:167], v[168:171], v[20:23]
    ds_read_b128 v[208:211], v0 offset:39936
    v_mfma_f32_16x16x32_bf16 v[24:27], v[160:163], v[172:175], v[24:27]
    ds_read_b128 v[212:215], v2 offset:46080
    v_mfma_f32_16x16x32_bf16 v[28:31], v[164:167], v[172:175], v[28:31]
    ds_read_b128 v[216:219], v2 offset:47104
    v_mfma_f32_16x16x32_bf16 v[32:35], v[160:163], v[176:179], v[32:35]
    ds_read_b128 v[220:223], v2 offset:48128
    v_mfma_f32_16x16x32_bf16 v[36:39], v[164:167], v[176:179], v[36:39]
    ds_read_b128 v[224:227], v2 offset:49152
    v_mfma_f32_16x16x32_bf16 v[40:43], v[160:163], v[180:183], v[40:43]
    ds_read_b128 v[228:231], v2 offset:50176
    v_mfma_f32_16x16x32_bf16 v[44:47], v[164:167], v[180:183], v[44:47]
    ds_read_b128 v[232:235], v2 offset:51200
    s_waitcnt lgkmcnt(8)
    v_mfma_f32_16x16x32_bf16 v[48:51], v[160:163], v[184:187], v[48:51]
    ds_read_b128 v[236:239], v2 offset:52224
    v_mfma_f32_16x16x32_bf16 v[52:55], v[164:167], v[184:187], v[52:55]
    ds_read_b128 v[240:243], v2 offset:53248
    v_mfma_f32_16x16x32_bf16 v[56:59], v[160:163], v[188:191], v[56:59]
    ds_read_b128 v[244:247], v2 offset:54272
    v_mfma_f32_16x16x32_bf16 v[60:63], v[164:167], v[188:191], v[60:63]
    v_mfma_f32_16x16x32_bf16 v[64:67], v[160:163], v[192:195], v[64:67]
    v_mfma_f32_16x16x32_bf16 v[68:71], v[164:167], v[192:195], v[68:71]
    v_mfma_f32_16x16x32_bf16 v[72:75], v[160:163], v[196:199], v[72:75]
    v_mfma_f32_16x16x32_bf16 v[76:79], v[164:167], v[196:199], v[76:79]
    v_mfma_f32_16x16x32_bf16 v[80:83], v[160:163], v[200:203], v[80:83]
    v_mfma_f32_16x16x32_bf16 v[84:87], v[164:167], v[200:203], v[84:87]
    s_waitcnt lgkmcnt(0)
    s_barrier
    v_mfma_f32_16x16x32_bf16 v[16:19], v[204:207], v[212:215], v[16:19]
    ds_read_b128 v[160:163], v3 offset:0
    v_mfma_f32_16x16x32_bf16 v[20:23], v[208:211], v[212:215], v[20:23]
    ds_read_b128 v[164:167], v3 offset:2048
    v_mfma_f32_16x16x32_bf16 v[24:27], v[204:207], v[216:219], v[24:27]
    ds_read_b128 v[168:171], v1 offset:0
    v_mfma_f32_16x16x32_bf16 v[28:31], v[208:211], v[216:219], v[28:31]
    ds_read_b128 v[172:175], v1 offset:1024
    v_mfma_f32_16x16x32_bf16 v[32:35], v[204:207], v[220:223], v[32:35]
    ds_read_b128 v[176:179], v1 offset:2048
    v_mfma_f32_16x16x32_bf16 v[36:39], v[208:211], v[220:223], v[36:39]
    ds_read_b128 v[180:183], v1 offset:3072
    v_mfma_f32_16x16x32_bf16 v[40:43], v[204:207], v[224:227], v[40:43]
    ds_read_b128 v[184:187], v1 offset:4096
    v_mfma_f32_16x16x32_bf16 v[44:47], v[208:211], v[224:227], v[44:47]
    ds_read_b128 v[188:191], v1 offset:5120
    v_mfma_f32_16x16x32_bf16 v[48:51], v[204:207], v[228:231], v[48:51]
    ds_read_b128 v[192:195], v1 offset:6144
    v_mfma_f32_16x16x32_bf16 v[52:55], v[208:211], v[228:231], v[52:55]
    ds_read_b128 v[196:199], v1 offset:7168
    v_mfma_f32_16x16x32_bf16 v[56:59], v[204:207], v[232:235], v[56:59]
    ds_read_b128 v[200:203], v1 offset:8192
    v_mfma_f32_16x16x32_bf16 v[60:63], v[208:211], v[232:235], v[60:63]
    ds_write2_b32 v4, v248, v249 offset0:0 offset1:32
    v_mfma_f32_16x16x32_bf16 v[64:67], v[204:207], v[236:239], v[64:67]
    ds_write2_b32 v4, v250, v251 offset0:16 offset1:48
    v_mfma_f32_16x16x32_bf16 v[68:71], v[208:211], v[236:239], v[68:71]
    ds_read_b128 v[88:91], v252 offset:0
    v_mfma_f32_16x16x32_bf16 v[72:75], v[204:207], v[240:243], v[72:75]
    ds_read_b128 v[92:95], v252 offset:64
    v_mfma_f32_16x16x32_bf16 v[76:79], v[208:211], v[240:243], v[76:79]
    ds_read_b128 v[96:99], v252 offset:128
    v_mfma_f32_16x16x32_bf16 v[80:83], v[204:207], v[244:247], v[80:83]
    ds_read_b128 v[100:103], v252 offset:192
    v_mfma_f32_16x16x32_bf16 v[84:87], v[208:211], v[244:247], v[84:87]
    s_waitcnt lgkmcnt(11)
    v_mfma_f32_16x16x32_bf16 v[16:19], v[160:163], v[168:171], v[16:19]
    ds_read_b128 v[204:207], v3 offset:1024
    v_mfma_f32_16x16x32_bf16 v[20:23], v[164:167], v[168:171], v[20:23]
    ds_read_b128 v[208:211], v3 offset:3072
    v_mfma_f32_16x16x32_bf16 v[24:27], v[160:163], v[172:175], v[24:27]
    ds_read_b128 v[212:215], v1 offset:9216
    v_mfma_f32_16x16x32_bf16 v[28:31], v[164:167], v[172:175], v[28:31]
    ds_read_b128 v[216:219], v1 offset:10240
    v_mfma_f32_16x16x32_bf16 v[32:35], v[160:163], v[176:179], v[32:35]
    ds_read_b128 v[220:223], v1 offset:11264
    v_mfma_f32_16x16x32_bf16 v[36:39], v[164:167], v[176:179], v[36:39]
    ds_read_b128 v[224:227], v1 offset:12288
    v_mfma_f32_16x16x32_bf16 v[40:43], v[160:163], v[180:183], v[40:43]
    ds_read_b128 v[228:231], v1 offset:13312
    v_mfma_f32_16x16x32_bf16 v[44:47], v[164:167], v[180:183], v[44:47]
    ds_read_b128 v[232:235], v1 offset:14336
    s_waitcnt lgkmcnt(8)
    v_mfma_f32_16x16x32_bf16 v[48:51], v[160:163], v[184:187], v[48:51]
    ds_read_b128 v[236:239], v1 offset:15360
    v_mfma_f32_16x16x32_bf16 v[52:55], v[164:167], v[184:187], v[52:55]
    ds_read_b128 v[240:243], v1 offset:16384
    v_rcp_f32 v120, v96
    v_mfma_f32_16x16x32_bf16 v[56:59], v[160:163], v[188:191], v[56:59]
    ds_read_b128 v[244:247], v1 offset:17408
    v_mul_f32 v104, s40, v96
    v_mfma_f32_16x16x32_bf16 v[60:63], v[164:167], v[188:191], v[60:63]
    v_mul_f32 v112, v96, v96
    v_mfma_f32_16x16x32_bf16 v[64:67], v[160:163], v[192:195], v[64:67]
    v_rcp_f32 v121, v97
    v_mfma_f32_16x16x32_bf16 v[68:71], v[164:167], v[192:195], v[68:71]
    v_mul_f32 v105, s40, v97
    v_mfma_f32_16x16x32_bf16 v[72:75], v[160:163], v[196:199], v[72:75]
    v_mul_f32 v113, v97, v97
    v_mfma_f32_16x16x32_bf16 v[76:79], v[164:167], v[196:199], v[76:79]
    v_rcp_f32 v122, v98
    v_mfma_f32_16x16x32_bf16 v[80:83], v[160:163], v[200:203], v[80:83]
    v_mul_f32 v106, s40, v98
    v_mfma_f32_16x16x32_bf16 v[84:87], v[164:167], v[200:203], v[84:87]
    v_mul_f32 v114, v98, v98
    v_rcp_f32 v123, v99
    s_waitcnt lgkmcnt(0)
    s_barrier
    v_mfma_f32_16x16x32_bf16 v[16:19], v[204:207], v[212:215], v[16:19]
    ds_read_b128 v[160:163], v3 offset:36864
    v_mfma_f32_16x16x32_bf16 v[20:23], v[208:211], v[212:215], v[20:23]
    ds_read_b128 v[164:167], v3 offset:38912
    v_mfma_f32_16x16x32_bf16 v[24:27], v[204:207], v[216:219], v[24:27]
    ds_read_b128 v[168:171], v1 offset:36864
    v_mfma_f32_16x16x32_bf16 v[28:31], v[208:211], v[216:219], v[28:31]
    ds_read_b128 v[172:175], v1 offset:37888
    v_mfma_f32_16x16x32_bf16 v[32:35], v[204:207], v[220:223], v[32:35]
    ds_read_b128 v[176:179], v1 offset:38912
    v_mfma_f32_16x16x32_bf16 v[36:39], v[208:211], v[220:223], v[36:39]
    ds_read_b128 v[180:183], v1 offset:39936
    v_mfma_f32_16x16x32_bf16 v[40:43], v[204:207], v[224:227], v[40:43]
    ds_read_b128 v[184:187], v1 offset:40960
    v_mfma_f32_16x16x32_bf16 v[44:47], v[208:211], v[224:227], v[44:47]
    ds_read_b128 v[188:191], v1 offset:41984
    v_mfma_f32_16x16x32_bf16 v[48:51], v[204:207], v[228:231], v[48:51]
    ds_read_b128 v[192:195], v1 offset:43008
    v_mfma_f32_16x16x32_bf16 v[52:55], v[208:211], v[228:231], v[52:55]
    ds_read_b128 v[196:199], v1 offset:44032
    v_mul_f32 v107, s40, v99
    v_mfma_f32_16x16x32_bf16 v[56:59], v[204:207], v[232:235], v[56:59]
    ds_read_b128 v[200:203], v1 offset:45056
    v_mul_f32 v115, v99, v99
    v_mfma_f32_16x16x32_bf16 v[60:63], v[208:211], v[232:235], v[60:63]
    v_rcp_f32 v124, v100
    v_mfma_f32_16x16x32_bf16 v[64:67], v[204:207], v[236:239], v[64:67]
    v_mul_f32 v108, s40, v100
    v_mfma_f32_16x16x32_bf16 v[68:71], v[208:211], v[236:239], v[68:71]
    v_mul_f32 v116, v100, v100
    v_mfma_f32_16x16x32_bf16 v[72:75], v[204:207], v[240:243], v[72:75]
    v_rcp_f32 v125, v101
    v_mfma_f32_16x16x32_bf16 v[76:79], v[208:211], v[240:243], v[76:79]
    v_mul_f32 v109, s40, v101
    v_mfma_f32_16x16x32_bf16 v[80:83], v[204:207], v[244:247], v[80:83]
    v_mul_f32 v117, v101, v101
    v_mfma_f32_16x16x32_bf16 v[84:87], v[208:211], v[244:247], v[84:87]
    v_rcp_f32 v126, v102
    v_mul_f32 v110, s40, v102
    s_waitcnt lgkmcnt(5)
    v_mfma_f32_16x16x32_bf16 v[16:19], v[160:163], v[168:171], v[16:19]
    ds_read_b128 v[204:207], v3 offset:37888
    v_mfma_f32_16x16x32_bf16 v[20:23], v[164:167], v[168:171], v[20:23]
    ds_read_b128 v[208:211], v3 offset:39936
    v_mfma_f32_16x16x32_bf16 v[24:27], v[160:163], v[172:175], v[24:27]
    ds_read_b128 v[212:215], v1 offset:46080
    v_mfma_f32_16x16x32_bf16 v[28:31], v[164:167], v[172:175], v[28:31]
    ds_read_b128 v[216:219], v1 offset:47104
    v_mfma_f32_16x16x32_bf16 v[32:35], v[160:163], v[176:179], v[32:35]
    ds_read_b128 v[220:223], v1 offset:48128
    v_mfma_f32_16x16x32_bf16 v[36:39], v[164:167], v[176:179], v[36:39]
    ds_read_b128 v[224:227], v1 offset:49152
    v_mfma_f32_16x16x32_bf16 v[40:43], v[160:163], v[180:183], v[40:43]
    ds_read_b128 v[228:231], v1 offset:50176
    v_mfma_f32_16x16x32_bf16 v[44:47], v[164:167], v[180:183], v[44:47]
    ds_read_b128 v[232:235], v1 offset:51200
    s_waitcnt lgkmcnt(8)
    v_mfma_f32_16x16x32_bf16 v[48:51], v[160:163], v[184:187], v[48:51]
    ds_read_b128 v[236:239], v1 offset:52224
    v_mfma_f32_16x16x32_bf16 v[52:55], v[164:167], v[184:187], v[52:55]
    ds_read_b128 v[240:243], v1 offset:53248
    v_mul_f32 v118, v102, v102
    v_mfma_f32_16x16x32_bf16 v[56:59], v[160:163], v[188:191], v[56:59]
    ds_read_b128 v[244:247], v1 offset:54272
    v_rcp_f32 v127, v103
    v_mfma_f32_16x16x32_bf16 v[60:63], v[164:167], v[188:191], v[60:63]
    v_mul_f32 v111, s40, v103
    v_mfma_f32_16x16x32_bf16 v[64:67], v[160:163], v[192:195], v[64:67]
    v_mul_f32 v119, v103, v103
    v_mfma_f32_16x16x32_bf16 v[68:71], v[164:167], v[192:195], v[68:71]
    v_mul_f32 v112, s42, v112
    v_mfma_f32_16x16x32_bf16 v[72:75], v[160:163], v[196:199], v[72:75]
    v_mul_f32 v113, s42, v113
    v_mfma_f32_16x16x32_bf16 v[76:79], v[164:167], v[196:199], v[76:79]
    v_mul_f32 v114, s42, v114
    v_mfma_f32_16x16x32_bf16 v[80:83], v[160:163], v[200:203], v[80:83]
    v_mul_f32 v115, s42, v115
    v_mfma_f32_16x16x32_bf16 v[84:87], v[164:167], v[200:203], v[84:87]
    v_mul_f32 v116, s42, v116
    v_mul_f32 v117, s42, v117
    s_waitcnt lgkmcnt(0)
    s_barrier
    v_mfma_f32_16x16x32_bf16 v[16:19], v[204:207], v[212:215], v[16:19]
    ds_read_b128 v[160:163], v0 offset:0
    v_mfma_f32_16x16x32_bf16 v[20:23], v[208:211], v[212:215], v[20:23]
    ds_read_b128 v[164:167], v0 offset:2048
    v_mfma_f32_16x16x32_bf16 v[24:27], v[204:207], v[216:219], v[24:27]
    ds_read_b128 v[168:171], v2 offset:0
    v_mfma_f32_16x16x32_bf16 v[28:31], v[208:211], v[216:219], v[28:31]
    ds_read_b128 v[172:175], v2 offset:1024
    v_mfma_f32_16x16x32_bf16 v[32:35], v[204:207], v[220:223], v[32:35]
    ds_read_b128 v[176:179], v2 offset:2048
    v_mfma_f32_16x16x32_bf16 v[36:39], v[208:211], v[220:223], v[36:39]
    ds_read_b128 v[180:183], v2 offset:3072
    v_mfma_f32_16x16x32_bf16 v[40:43], v[204:207], v[224:227], v[40:43]
    ds_read_b128 v[184:187], v2 offset:4096
    v_mfma_f32_16x16x32_bf16 v[44:47], v[208:211], v[224:227], v[44:47]
    ds_read_b128 v[188:191], v2 offset:5120
    v_mfma_f32_16x16x32_bf16 v[48:51], v[204:207], v[228:231], v[48:51]
    ds_read_b128 v[192:195], v2 offset:6144
    v_mfma_f32_16x16x32_bf16 v[52:55], v[208:211], v[228:231], v[52:55]
    ds_read_b128 v[196:199], v2 offset:7168
    v_mul_f32 v118, s42, v118
    v_mfma_f32_16x16x32_bf16 v[56:59], v[204:207], v[232:235], v[56:59]
    ds_read_b128 v[200:203], v2 offset:8192
    v_mul_f32 v119, s42, v119
    v_mfma_f32_16x16x32_bf16 v[60:63], v[208:211], v[232:235], v[60:63]
    v_mul_f32 v112, v112, v104
    v_mfma_f32_16x16x32_bf16 v[64:67], v[204:207], v[236:239], v[64:67]
    v_mul_f32 v113, v113, v105
    v_mfma_f32_16x16x32_bf16 v[68:71], v[208:211], v[236:239], v[68:71]
    v_mul_f32 v114, v114, v106
    v_mfma_f32_16x16x32_bf16 v[72:75], v[204:207], v[240:243], v[72:75]
    v_mul_f32 v115, v115, v107
    v_mfma_f32_16x16x32_bf16 v[76:79], v[208:211], v[240:243], v[76:79]
    v_mul_f32 v116, v116, v108
    v_mfma_f32_16x16x32_bf16 v[80:83], v[204:207], v[244:247], v[80:83]
    v_mul_f32 v117, v117, v109
    v_mfma_f32_16x16x32_bf16 v[84:87], v[208:211], v[244:247], v[84:87]
    v_mul_f32 v118, v118, v110
    v_mul_f32 v119, v119, v111
    s_waitcnt lgkmcnt(5)
    v_mfma_f32_16x16x32_bf16 v[16:19], v[160:163], v[168:171], v[16:19]
    ds_read_b128 v[204:207], v0 offset:1024
    v_mfma_f32_16x16x32_bf16 v[20:23], v[164:167], v[168:171], v[20:23]
    ds_read_b128 v[208:211], v0 offset:3072
    v_mfma_f32_16x16x32_bf16 v[24:27], v[160:163], v[172:175], v[24:27]
    ds_read_b128 v[212:215], v2 offset:9216
    v_mfma_f32_16x16x32_bf16 v[28:31], v[164:167], v[172:175], v[28:31]
    ds_read_b128 v[216:219], v2 offset:10240
    v_mfma_f32_16x16x32_bf16 v[32:35], v[160:163], v[176:179], v[32:35]
    ds_read_b128 v[220:223], v2 offset:11264
    v_mfma_f32_16x16x32_bf16 v[36:39], v[164:167], v[176:179], v[36:39]
    ds_read_b128 v[224:227], v2 offset:12288
    v_mfma_f32_16x16x32_bf16 v[40:43], v[160:163], v[180:183], v[40:43]
    ds_read_b128 v[228:231], v2 offset:13312
    v_mfma_f32_16x16x32_bf16 v[44:47], v[164:167], v[180:183], v[44:47]
    ds_read_b128 v[232:235], v2 offset:14336
    s_waitcnt lgkmcnt(8)
    v_mfma_f32_16x16x32_bf16 v[48:51], v[160:163], v[184:187], v[48:51]
    ds_read_b128 v[236:239], v2 offset:15360
    v_mfma_f32_16x16x32_bf16 v[52:55], v[164:167], v[184:187], v[52:55]
    ds_read_b128 v[240:243], v2 offset:16384
    v_lshrrev_b32 v8, 2, v6
    v_mfma_f32_16x16x32_bf16 v[56:59], v[160:163], v[188:191], v[56:59]
    ds_read_b128 v[244:247], v2 offset:17408
    v_lshlrev_b32 v8, 4, v8
    v_mfma_f32_16x16x32_bf16 v[60:63], v[164:167], v[188:191], v[60:63]
    v_lshl_add_u32 v8, v5, 6, v8
    v_mfma_f32_16x16x32_bf16 v[64:67], v[160:163], v[192:195], v[64:67]
    v_and_b32 v9, 3, v6
    v_mfma_f32_16x16x32_bf16 v[68:71], v[164:167], v[192:195], v[68:71]
    v_cmp_eq_u32 vcc, 0, v9
    v_mfma_f32_16x16x32_bf16 v[72:75], v[160:163], v[196:199], v[72:75]
    v_bfrev_b32 v10, 1
    v_mfma_f32_16x16x32_bf16 v[76:79], v[164:167], v[196:199], v[76:79]
    v_lshlrev_b32 v9, 4, v9
    v_mfma_f32_16x16x32_bf16 v[80:83], v[160:163], v[200:203], v[80:83]
    v_cndmask_b32 v8, v10, v8, vcc
    v_mfma_f32_16x16x32_bf16 v[84:87], v[164:167], v[200:203], v[84:87]
    v_lshl_add_u32 v9, v5, 6, v9
    v_lshrrev_b32 v255, 2, v6
    s_waitcnt lgkmcnt(0)
    s_barrier
    v_mfma_f32_16x16x32_bf16 v[16:19], v[204:207], v[212:215], v[16:19]
    ds_read_b128 v[160:163], v0 offset:36864
    v_fma_f32 v52, -v92, v132, v52
    v_mfma_f32_16x16x32_bf16 v[20:23], v[208:211], v[212:215], v[20:23]
    ds_read_b128 v[164:167], v0 offset:38912
    v_fma_f32 v56, -v88, v133, v56
    v_mfma_f32_16x16x32_bf16 v[24:27], v[204:207], v[216:219], v[24:27]
    ds_read_b128 v[168:171], v2 offset:36864
    v_fma_f32 v60, -v92, v133, v60
    v_mfma_f32_16x16x32_bf16 v[28:31], v[208:211], v[216:219], v[28:31]
    ds_read_b128 v[172:175], v2 offset:37888
    v_fma_f32 v64, -v88, v134, v64
    v_mfma_f32_16x16x32_bf16 v[32:35], v[204:207], v[220:223], v[32:35]
    ds_read_b128 v[176:179], v2 offset:38912
    v_fma_f32 v68, -v92, v134, v68
    v_mfma_f32_16x16x32_bf16 v[36:39], v[208:211], v[220:223], v[36:39]
    ds_read_b128 v[180:183], v2 offset:39936
    v_fma_f32 v72, -v88, v135, v72
    v_mfma_f32_16x16x32_bf16 v[40:43], v[204:207], v[224:227], v[40:43]
    ds_read_b128 v[184:187], v2 offset:40960
    v_fma_f32 v76, -v92, v135, v76
    v_mfma_f32_16x16x32_bf16 v[44:47], v[208:211], v[224:227], v[44:47]
    ds_read_b128 v[188:191], v2 offset:41984
    v_fma_f32 v80, -v88, v136, v80
    v_mfma_f32_16x16x32_bf16 v[48:51], v[204:207], v[228:231], v[48:51]
    ds_read_b128 v[192:195], v2 offset:43008
    v_fma_f32 v84, -v92, v136, v84
    v_mfma_f32_16x16x32_bf16 v[52:55], v[208:211], v[228:231], v[52:55]
    ds_read_b128 v[196:199], v2 offset:44032
    v_lshl_add_u32 v255, v255, 8, v9
    v_fma_f32 v16, -v88, v128, v16
    v_mfma_f32_16x16x32_bf16 v[56:59], v[204:207], v[232:235], v[56:59]
    ds_read_b128 v[200:203], v2 offset:45056
    v_fma_f32 v20, -v92, v128, v20
    v_mfma_f32_16x16x32_bf16 v[60:63], v[208:211], v[232:235], v[60:63]
    v_fma_f32 v24, -v88, v129, v24
    v_mfma_f32_16x16x32_bf16 v[64:67], v[204:207], v[236:239], v[64:67]
    v_fma_f32 v28, -v92, v129, v28
    v_mfma_f32_16x16x32_bf16 v[68:71], v[208:211], v[236:239], v[68:71]
    v_fma_f32 v32, -v88, v130, v32
    v_mfma_f32_16x16x32_bf16 v[72:75], v[204:207], v[240:243], v[72:75]
    v_fma_f32 v36, -v92, v130, v36
    v_mfma_f32_16x16x32_bf16 v[76:79], v[208:211], v[240:243], v[76:79]
    v_fma_f32 v40, -v88, v131, v40
    v_mfma_f32_16x16x32_bf16 v[80:83], v[204:207], v[244:247], v[80:83]
    v_fma_f32 v44, -v92, v131, v44
    v_mfma_f32_16x16x32_bf16 v[84:87], v[208:211], v[244:247], v[84:87]
    v_fma_f32 v48, -v88, v132, v48
    s_waitcnt lgkmcnt(5)
    v_mfma_f32_16x16x32_bf16 v[16:19], v[160:163], v[168:171], v[16:19]
    ds_read_b128 v[204:207], v0 offset:37888
    v_fma_f32 v53, -v93, v132, v53
    v_mfma_f32_16x16x32_bf16 v[20:23], v[164:167], v[168:171], v[20:23]
    ds_read_b128 v[208:211], v0 offset:39936
    v_fma_f32 v57, -v89, v133, v57
    v_mfma_f32_16x16x32_bf16 v[24:27], v[160:163], v[172:175], v[24:27]
    ds_read_b128 v[212:215], v2 offset:46080
    v_fma_f32 v61, -v93, v133, v61
    v_mfma_f32_16x16x32_bf16 v[28:31], v[164:167], v[172:175], v[28:31]
    ds_read_b128 v[216:219], v2 offset:47104
    v_fma_f32 v65, -v89, v134, v65
    v_mfma_f32_16x16x32_bf16 v[32:35], v[160:163], v[176:179], v[32:35]
    ds_read_b128 v[220:223], v2 offset:48128
    v_fma_f32 v69, -v93, v134, v69
    v_mfma_f32_16x16x32_bf16 v[36:39], v[164:167], v[176:179], v[36:39]
    ds_read_b128 v[224:227], v2 offset:49152
    v_fma_f32 v73, -v89, v135, v73
    v_mfma_f32_16x16x32_bf16 v[40:43], v[160:163], v[180:183], v[40:43]
    ds_read_b128 v[228:231], v2 offset:50176
    v_fma_f32 v77, -v93, v135, v77
    v_mfma_f32_16x16x32_bf16 v[44:47], v[164:167], v[180:183], v[44:47]
    ds_read_b128 v[232:235], v2 offset:51200
    s_waitcnt lgkmcnt(8)
    v_fma_f32 v81, -v89, v136, v81
    v_mfma_f32_16x16x32_bf16 v[48:51], v[160:163], v[184:187], v[48:51]
    ds_read_b128 v[236:239], v2 offset:52224
    v_fma_f32 v85, -v93, v136, v85
    v_mfma_f32_16x16x32_bf16 v[52:55], v[164:167], v[184:187], v[52:55]
    ds_read_b128 v[240:243], v2 offset:53248
    v_fma_f32 v17, -v89, v128, v17
    v_mfma_f32_16x16x32_bf16 v[56:59], v[160:163], v[188:191], v[56:59]
    ds_read_b128 v[244:247], v2 offset:54272
    v_fma_f32 v21, -v93, v128, v21
    v_mfma_f32_16x16x32_bf16 v[60:63], v[164:167], v[188:191], v[60:63]
    v_fma_f32 v25, -v89, v129, v25
    v_mfma_f32_16x16x32_bf16 v[64:67], v[160:163], v[192:195], v[64:67]
    v_fma_f32 v29, -v93, v129, v29
    v_mfma_f32_16x16x32_bf16 v[68:71], v[164:167], v[192:195], v[68:71]
    v_fma_f32 v33, -v89, v130, v33
    v_mfma_f32_16x16x32_bf16 v[72:75], v[160:163], v[196:199], v[72:75]
    v_fma_f32 v37, -v93, v130, v37
    v_mfma_f32_16x16x32_bf16 v[76:79], v[164:167], v[196:199], v[76:79]
    v_fma_f32 v41, -v89, v131, v41
    v_mfma_f32_16x16x32_bf16 v[80:83], v[160:163], v[200:203], v[80:83]
    v_fma_f32 v45, -v93, v131, v45
    v_mfma_f32_16x16x32_bf16 v[84:87], v[164:167], v[200:203], v[84:87]
    v_fma_f32 v49, -v89, v132, v49
    s_waitcnt lgkmcnt(0)
    s_barrier
    v_mfma_f32_16x16x32_bf16 v[16:19], v[204:207], v[212:215], v[16:19]
    ds_read_b128 v[160:163], v3 offset:0
    v_fma_f32 v54, -v94, v132, v54
    v_mfma_f32_16x16x32_bf16 v[20:23], v[208:211], v[212:215], v[20:23]
    ds_read_b128 v[164:167], v3 offset:2048
    v_fma_f32 v58, -v90, v133, v58
    v_mfma_f32_16x16x32_bf16 v[24:27], v[204:207], v[216:219], v[24:27]
    ds_read_b128 v[168:171], v1 offset:0
    v_fma_f32 v62, -v94, v133, v62
    v_mfma_f32_16x16x32_bf16 v[28:31], v[208:211], v[216:219], v[28:31]
    ds_read_b128 v[172:175], v1 offset:1024
    v_fma_f32 v66, -v90, v134, v66
    v_mfma_f32_16x16x32_bf16 v[32:35], v[204:207], v[220:223], v[32:35]
    ds_read_b128 v[176:179], v1 offset:2048
    v_fma_f32 v70, -v94, v134, v70
    v_mfma_f32_16x16x32_bf16 v[36:39], v[208:211], v[220:223], v[36:39]
    ds_read_b128 v[180:183], v1 offset:3072
    v_fma_f32 v74, -v90, v135, v74
    v_mfma_f32_16x16x32_bf16 v[40:43], v[204:207], v[224:227], v[40:43]
    ds_read_b128 v[184:187], v1 offset:4096
    v_fma_f32 v78, -v94, v135, v78
    v_mfma_f32_16x16x32_bf16 v[44:47], v[208:211], v[224:227], v[44:47]
    ds_read_b128 v[188:191], v1 offset:5120
    v_fma_f32 v82, -v90, v136, v82
    v_mfma_f32_16x16x32_bf16 v[48:51], v[204:207], v[228:231], v[48:51]
    ds_read_b128 v[192:195], v1 offset:6144
    v_fma_f32 v86, -v94, v136, v86
    v_mfma_f32_16x16x32_bf16 v[52:55], v[208:211], v[228:231], v[52:55]
    ds_read_b128 v[196:199], v1 offset:7168
    v_fma_f32 v18, -v90, v128, v18
    v_mfma_f32_16x16x32_bf16 v[56:59], v[204:207], v[232:235], v[56:59]
    ds_read_b128 v[200:203], v1 offset:8192
    v_fma_f32 v22, -v94, v128, v22
    v_mfma_f32_16x16x32_bf16 v[60:63], v[208:211], v[232:235], v[60:63]
    v_fma_f32 v26, -v90, v129, v26
    v_mfma_f32_16x16x32_bf16 v[64:67], v[204:207], v[236:239], v[64:67]
    v_fma_f32 v30, -v94, v129, v30
    v_mfma_f32_16x16x32_bf16 v[68:71], v[208:211], v[236:239], v[68:71]
    v_fma_f32 v34, -v90, v130, v34
    v_mfma_f32_16x16x32_bf16 v[72:75], v[204:207], v[240:243], v[72:75]
    v_fma_f32 v38, -v94, v130, v38
    v_mfma_f32_16x16x32_bf16 v[76:79], v[208:211], v[240:243], v[76:79]
    v_fma_f32 v42, -v90, v131, v42
    v_mfma_f32_16x16x32_bf16 v[80:83], v[204:207], v[244:247], v[80:83]
    v_fma_f32 v46, -v94, v131, v46
    v_mfma_f32_16x16x32_bf16 v[84:87], v[208:211], v[244:247], v[84:87]
    v_fma_f32 v50, -v90, v132, v50
    s_waitcnt lgkmcnt(5)
    v_mfma_f32_16x16x32_bf16 v[16:19], v[160:163], v[168:171], v[16:19]
    ds_read_b128 v[204:207], v3 offset:1024
    v_fma_f32 v55, -v95, v132, v55
    v_mfma_f32_16x16x32_bf16 v[20:23], v[164:167], v[168:171], v[20:23]
    ds_read_b128 v[208:211], v3 offset:3072
    v_fma_f32 v59, -v91, v133, v59
    v_mfma_f32_16x16x32_bf16 v[24:27], v[160:163], v[172:175], v[24:27]
    ds_read_b128 v[212:215], v1 offset:9216
    v_fma_f32 v63, -v95, v133, v63
    v_mfma_f32_16x16x32_bf16 v[28:31], v[164:167], v[172:175], v[28:31]
    ds_read_b128 v[216:219], v1 offset:10240
    v_fma_f32 v67, -v91, v134, v67
    v_mfma_f32_16x16x32_bf16 v[32:35], v[160:163], v[176:179], v[32:35]
    ds_read_b128 v[220:223], v1 offset:11264
    v_fma_f32 v71, -v95, v134, v71
    v_mfma_f32_16x16x32_bf16 v[36:39], v[164:167], v[176:179], v[36:39]
    ds_read_b128 v[224:227], v1 offset:12288
    v_fma_f32 v75, -v91, v135, v75
    v_mfma_f32_16x16x32_bf16 v[40:43], v[160:163], v[180:183], v[40:43]
    ds_read_b128 v[228:231], v1 offset:13312
    v_fma_f32 v79, -v95, v135, v79
    v_mfma_f32_16x16x32_bf16 v[44:47], v[164:167], v[180:183], v[44:47]
    ds_read_b128 v[232:235], v1 offset:14336
    s_waitcnt lgkmcnt(8)
    v_fma_f32 v83, -v91, v136, v83
    v_mfma_f32_16x16x32_bf16 v[48:51], v[160:163], v[184:187], v[48:51]
    ds_read_b128 v[236:239], v1 offset:15360
    v_fma_f32 v87, -v95, v136, v87
    v_mfma_f32_16x16x32_bf16 v[52:55], v[164:167], v[184:187], v[52:55]
    ds_read_b128 v[240:243], v1 offset:16384
    v_fma_f32 v19, -v91, v128, v19
    v_mfma_f32_16x16x32_bf16 v[56:59], v[160:163], v[188:191], v[56:59]
    ds_read_b128 v[244:247], v1 offset:17408
    v_fma_f32 v23, -v95, v128, v23
    v_mfma_f32_16x16x32_bf16 v[60:63], v[164:167], v[188:191], v[60:63]
    v_fma_f32 v27, -v91, v129, v27
    v_mfma_f32_16x16x32_bf16 v[64:67], v[160:163], v[192:195], v[64:67]
    v_fma_f32 v31, -v95, v129, v31
    v_mfma_f32_16x16x32_bf16 v[68:71], v[164:167], v[192:195], v[68:71]
    v_fma_f32 v35, -v91, v130, v35
    v_mfma_f32_16x16x32_bf16 v[72:75], v[160:163], v[196:199], v[72:75]
    v_fma_f32 v39, -v95, v130, v39
    v_mfma_f32_16x16x32_bf16 v[76:79], v[164:167], v[196:199], v[76:79]
    v_fma_f32 v43, -v91, v131, v43
    v_mfma_f32_16x16x32_bf16 v[80:83], v[160:163], v[200:203], v[80:83]
    v_fma_f32 v47, -v95, v131, v47
    v_mfma_f32_16x16x32_bf16 v[84:87], v[164:167], v[200:203], v[84:87]
    v_fma_f32 v51, -v91, v132, v51
    s_waitcnt lgkmcnt(0)
    s_barrier
    v_mfma_f32_16x16x32_bf16 v[16:19], v[204:207], v[212:215], v[16:19]
    ds_read_b128 v[160:163], v3 offset:36864
    v_mfma_f32_16x16x32_bf16 v[20:23], v[208:211], v[212:215], v[20:23]
    ds_read_b128 v[164:167], v3 offset:38912
    v_mfma_f32_16x16x32_bf16 v[24:27], v[204:207], v[216:219], v[24:27]
    ds_read_b128 v[168:171], v1 offset:36864
    v_mfma_f32_16x16x32_bf16 v[28:31], v[208:211], v[216:219], v[28:31]
    ds_read_b128 v[172:175], v1 offset:37888
    v_mfma_f32_16x16x32_bf16 v[32:35], v[204:207], v[220:223], v[32:35]
    ds_read_b128 v[176:179], v1 offset:38912
    v_mfma_f32_16x16x32_bf16 v[36:39], v[208:211], v[220:223], v[36:39]
    ds_read_b128 v[180:183], v1 offset:39936
    v_mfma_f32_16x16x32_bf16 v[40:43], v[204:207], v[224:227], v[40:43]
    ds_read_b128 v[184:187], v1 offset:40960
    v_mfma_f32_16x16x32_bf16 v[44:47], v[208:211], v[224:227], v[44:47]
    ds_read_b128 v[188:191], v1 offset:41984
    v_mfma_f32_16x16x32_bf16 v[48:51], v[204:207], v[228:231], v[48:51]
    ds_read_b128 v[192:195], v1 offset:43008
    v_mfma_f32_16x16x32_bf16 v[52:55], v[208:211], v[228:231], v[52:55]
    ds_read_b128 v[196:199], v1 offset:44032
    v_mfma_f32_16x16x32_bf16 v[56:59], v[204:207], v[232:235], v[56:59]
    ds_read_b128 v[200:203], v1 offset:45056
    v_mfma_f32_16x16x32_bf16 v[60:63], v[208:211], v[232:235], v[60:63]
    v_mfma_f32_16x16x32_bf16 v[64:67], v[204:207], v[236:239], v[64:67]
    v_mfma_f32_16x16x32_bf16 v[68:71], v[208:211], v[236:239], v[68:71]
    v_mfma_f32_16x16x32_bf16 v[72:75], v[204:207], v[240:243], v[72:75]
    v_mfma_f32_16x16x32_bf16 v[76:79], v[208:211], v[240:243], v[76:79]
    v_mfma_f32_16x16x32_bf16 v[80:83], v[204:207], v[244:247], v[80:83]
    v_mfma_f32_16x16x32_bf16 v[84:87], v[208:211], v[244:247], v[84:87]
    v_pk_mul_f32 v[220:221], v[16:17], v[16:17]
    v_pk_mul_f32 v[222:223], v[18:19], v[18:19]
    v_pk_mul_f32 v[224:225], v[20:21], v[20:21]
    v_pk_mul_f32 v[226:227], v[22:23], v[22:23]
    v_pk_fma_f32 v[220:221], v[220:221], v[112:113], v[104:105]
    v_pk_fma_f32 v[222:223], v[222:223], v[114:115], v[106:107]
    v_pk_fma_f32 v[224:225], v[224:225], v[116:117], v[108:109]
    v_pk_fma_f32 v[226:227], v[226:227], v[118:119], v[110:111]
    v_pk_mul_f32 v[220:221], v[220:221], v[16:17]
    v_pk_mul_f32 v[222:223], v[222:223], v[18:19]
    v_pk_mul_f32 v[224:225], v[224:225], v[20:21]
    v_pk_mul_f32 v[226:227], v[226:227], v[22:23]
    v_exp_f32 v220, v220
    v_exp_f32 v221, v221
    v_exp_f32 v222, v222
    v_exp_f32 v223, v223
    v_exp_f32 v224, v224
    v_exp_f32 v225, v225
    v_exp_f32 v226, v226
    v_exp_f32 v227, v227
    v_pk_fma_f32 v[220:221], v[220:221], v[120:121], v[120:121]
    v_pk_fma_f32 v[222:223], v[222:223], v[122:123], v[122:123]
    v_pk_fma_f32 v[224:225], v[224:225], v[124:125], v[124:125]
    v_pk_fma_f32 v[226:227], v[226:227], v[126:127], v[126:127]
    v_rcp_f32 v220, v220
    v_rcp_f32 v221, v221
    v_rcp_f32 v222, v222
    v_rcp_f32 v223, v223
    v_rcp_f32 v224, v224
    v_rcp_f32 v225, v225
    v_rcp_f32 v226, v226
    v_rcp_f32 v227, v227
    v_pk_mul_f32 v[16:17], v[16:17], v[220:221]
    v_pk_mul_f32 v[18:19], v[18:19], v[222:223]
    v_pk_mul_f32 v[20:21], v[20:21], v[224:225]
    v_pk_mul_f32 v[22:23], v[22:23], v[226:227]
    v_pk_mul_f32 v[206:207], v[16:17], v[16:17]
    v_pk_mul_f32 v[210:211], v[18:19], v[18:19]
    v_pk_mul_f32 v[214:215], v[20:21], v[20:21]
    v_pk_mul_f32 v[218:219], v[22:23], v[22:23]
    v_pk_mul_f32 v[228:229], v[24:25], v[24:25]
    v_pk_mul_f32 v[230:231], v[26:27], v[26:27]
    v_pk_mul_f32 v[232:233], v[28:29], v[28:29]
    v_pk_mul_f32 v[234:235], v[30:31], v[30:31]
    v_pk_fma_f32 v[228:229], v[228:229], v[112:113], v[104:105]
    v_pk_fma_f32 v[230:231], v[230:231], v[114:115], v[106:107]
    v_pk_fma_f32 v[232:233], v[232:233], v[116:117], v[108:109]
    v_pk_fma_f32 v[234:235], v[234:235], v[118:119], v[110:111]
    v_pk_mul_f32 v[228:229], v[228:229], v[24:25]
    v_pk_mul_f32 v[230:231], v[230:231], v[26:27]
    v_pk_mul_f32 v[232:233], v[232:233], v[28:29]
    v_pk_mul_f32 v[234:235], v[234:235], v[30:31]
    v_exp_f32 v228, v228
    v_exp_f32 v229, v229
    v_exp_f32 v230, v230
    v_exp_f32 v231, v231
    v_exp_f32 v232, v232
    v_exp_f32 v233, v233
    v_exp_f32 v234, v234
    v_exp_f32 v235, v235
    v_pk_fma_f32 v[228:229], v[228:229], v[120:121], v[120:121]
    v_pk_fma_f32 v[230:231], v[230:231], v[122:123], v[122:123]
    v_pk_fma_f32 v[232:233], v[232:233], v[124:125], v[124:125]
    v_pk_fma_f32 v[234:235], v[234:235], v[126:127], v[126:127]
    v_rcp_f32 v228, v228
    v_rcp_f32 v229, v229
    v_rcp_f32 v230, v230
    v_rcp_f32 v231, v231
    v_rcp_f32 v232, v232
    v_rcp_f32 v233, v233
    v_rcp_f32 v234, v234
    v_rcp_f32 v235, v235
    v_pk_mul_f32 v[24:25], v[24:25], v[228:229]
    v_pk_mul_f32 v[26:27], v[26:27], v[230:231]
    v_pk_mul_f32 v[28:29], v[28:29], v[232:233]
    v_pk_mul_f32 v[30:31], v[30:31], v[234:235]
    v_pk_add_f32 v[204:205], v[16:17], v[24:25]
    v_pk_fma_f32 v[206:207], v[24:25], v[24:25], v[206:207]
    v_pk_add_f32 v[208:209], v[18:19], v[26:27]
    v_pk_fma_f32 v[210:211], v[26:27], v[26:27], v[210:211]
    v_pk_add_f32 v[212:213], v[20:21], v[28:29]
    v_pk_fma_f32 v[214:215], v[28:29], v[28:29], v[214:215]
    v_pk_add_f32 v[216:217], v[22:23], v[30:31]
    v_pk_fma_f32 v[218:219], v[30:31], v[30:31], v[218:219]
    v_pk_mul_f32 v[220:221], v[32:33], v[32:33]
    v_pk_mul_f32 v[222:223], v[34:35], v[34:35]
    v_pk_mul_f32 v[224:225], v[36:37], v[36:37]
    v_pk_mul_f32 v[226:227], v[38:39], v[38:39]
    v_pk_fma_f32 v[220:221], v[220:221], v[112:113], v[104:105]
    v_pk_fma_f32 v[222:223], v[222:223], v[114:115], v[106:107]
    v_pk_fma_f32 v[224:225], v[224:225], v[116:117], v[108:109]
    v_pk_fma_f32 v[226:227], v[226:227], v[118:119], v[110:111]
    v_pk_mul_f32 v[220:221], v[220:221], v[32:33]
    v_pk_mul_f32 v[222:223], v[222:223], v[34:35]
    v_pk_mul_f32 v[224:225], v[224:225], v[36:37]
    v_pk_mul_f32 v[226:227], v[226:227], v[38:39]
    v_exp_f32 v220, v220
    v_exp_f32 v221, v221
    v_exp_f32 v222, v222
    v_exp_f32 v223, v223
    v_exp_f32 v224, v224
    v_exp_f32 v225, v225
    v_exp_f32 v226, v226
    v_exp_f32 v227, v227
    v_pk_fma_f32 v[220:221], v[220:221], v[120:121], v[120:121]
    v_pk_fma_f32 v[222:223], v[222:223], v[122:123], v[122:123]
    v_pk_fma_f32 v[224:225], v[224:225], v[124:125], v[124:125]
    v_pk_fma_f32 v[226:227], v[226:227], v[126:127], v[126:127]
    v_rcp_f32 v220, v220
    v_rcp_f32 v221, v221
    v_rcp_f32 v222, v222
    v_rcp_f32 v223, v223
    v_rcp_f32 v224, v224
    v_rcp_f32 v225, v225
    v_rcp_f32 v226, v226
    v_rcp_f32 v227, v227
    v_pk_mul_f32 v[32:33], v[32:33], v[220:221]
    v_pk_mul_f32 v[34:35], v[34:35], v[222:223]
    v_pk_mul_f32 v[36:37], v[36:37], v[224:225]
    v_pk_mul_f32 v[38:39], v[38:39], v[226:227]
    v_pk_add_f32 v[204:205], v[204:205], v[32:33]
    v_pk_fma_f32 v[206:207], v[32:33], v[32:33], v[206:207]
    v_pk_add_f32 v[208:209], v[208:209], v[34:35]
    v_pk_fma_f32 v[210:211], v[34:35], v[34:35], v[210:211]
    v_pk_add_f32 v[212:213], v[212:213], v[36:37]
    v_pk_fma_f32 v[214:215], v[36:37], v[36:37], v[214:215]
    v_pk_add_f32 v[216:217], v[216:217], v[38:39]
    v_pk_fma_f32 v[218:219], v[38:39], v[38:39], v[218:219]
    v_pk_mul_f32 v[228:229], v[40:41], v[40:41]
    v_pk_mul_f32 v[230:231], v[42:43], v[42:43]
    v_pk_mul_f32 v[232:233], v[44:45], v[44:45]
    v_pk_mul_f32 v[234:235], v[46:47], v[46:47]
    v_pk_fma_f32 v[228:229], v[228:229], v[112:113], v[104:105]
    v_pk_fma_f32 v[230:231], v[230:231], v[114:115], v[106:107]
    v_pk_fma_f32 v[232:233], v[232:233], v[116:117], v[108:109]
    v_pk_fma_f32 v[234:235], v[234:235], v[118:119], v[110:111]
    v_pk_mul_f32 v[228:229], v[228:229], v[40:41]
    v_pk_mul_f32 v[230:231], v[230:231], v[42:43]
    v_pk_mul_f32 v[232:233], v[232:233], v[44:45]
    v_pk_mul_f32 v[234:235], v[234:235], v[46:47]
    v_exp_f32 v228, v228
    v_exp_f32 v229, v229
    v_exp_f32 v230, v230
    v_exp_f32 v231, v231
    v_exp_f32 v232, v232
    v_exp_f32 v233, v233
    v_exp_f32 v234, v234
    v_exp_f32 v235, v235
    v_pk_fma_f32 v[228:229], v[228:229], v[120:121], v[120:121]
    v_pk_fma_f32 v[230:231], v[230:231], v[122:123], v[122:123]
    v_pk_fma_f32 v[232:233], v[232:233], v[124:125], v[124:125]
    v_pk_fma_f32 v[234:235], v[234:235], v[126:127], v[126:127]
    v_rcp_f32 v228, v228
    v_rcp_f32 v229, v229
    v_rcp_f32 v230, v230
    v_rcp_f32 v231, v231
    v_rcp_f32 v232, v232
    v_rcp_f32 v233, v233
    v_rcp_f32 v234, v234
    v_rcp_f32 v235, v235
    v_pk_mul_f32 v[40:41], v[40:41], v[228:229]
    v_pk_mul_f32 v[42:43], v[42:43], v[230:231]
    v_pk_mul_f32 v[44:45], v[44:45], v[232:233]
    v_pk_mul_f32 v[46:47], v[46:47], v[234:235]
    v_pk_add_f32 v[204:205], v[204:205], v[40:41]
    v_pk_fma_f32 v[206:207], v[40:41], v[40:41], v[206:207]
    v_pk_add_f32 v[208:209], v[208:209], v[42:43]
    v_pk_fma_f32 v[210:211], v[42:43], v[42:43], v[210:211]
    v_pk_add_f32 v[212:213], v[212:213], v[44:45]
    v_pk_fma_f32 v[214:215], v[44:45], v[44:45], v[214:215]
    v_pk_add_f32 v[216:217], v[216:217], v[46:47]
    v_pk_fma_f32 v[218:219], v[46:47], v[46:47], v[218:219]
    v_pk_mul_f32 v[220:221], v[48:49], v[48:49]
    v_pk_mul_f32 v[222:223], v[50:51], v[50:51]
    v_pk_mul_f32 v[224:225], v[52:53], v[52:53]
    v_pk_mul_f32 v[226:227], v[54:55], v[54:55]
    v_pk_fma_f32 v[220:221], v[220:221], v[112:113], v[104:105]
    v_pk_fma_f32 v[222:223], v[222:223], v[114:115], v[106:107]
    v_pk_fma_f32 v[224:225], v[224:225], v[116:117], v[108:109]
    v_pk_fma_f32 v[226:227], v[226:227], v[118:119], v[110:111]
    v_pk_mul_f32 v[220:221], v[220:221], v[48:49]
    v_pk_mul_f32 v[222:223], v[222:223], v[50:51]
    v_pk_mul_f32 v[224:225], v[224:225], v[52:53]
    v_pk_mul_f32 v[226:227], v[226:227], v[54:55]
    v_exp_f32 v220, v220
    v_exp_f32 v221, v221
    v_exp_f32 v222, v222
    v_exp_f32 v223, v223
    v_exp_f32 v224, v224
    v_exp_f32 v225, v225
    v_exp_f32 v226, v226
    v_exp_f32 v227, v227
    v_pk_fma_f32 v[220:221], v[220:221], v[120:121], v[120:121]
    v_pk_fma_f32 v[222:223], v[222:223], v[122:123], v[122:123]
    v_pk_fma_f32 v[224:225], v[224:225], v[124:125], v[124:125]
    v_pk_fma_f32 v[226:227], v[226:227], v[126:127], v[126:127]
    v_rcp_f32 v220, v220
    v_rcp_f32 v221, v221
    v_rcp_f32 v222, v222
    v_rcp_f32 v223, v223
    v_rcp_f32 v224, v224
    v_rcp_f32 v225, v225
    v_rcp_f32 v226, v226
    v_rcp_f32 v227, v227
    v_pk_mul_f32 v[48:49], v[48:49], v[220:221]
    v_pk_mul_f32 v[50:51], v[50:51], v[222:223]
    v_pk_mul_f32 v[52:53], v[52:53], v[224:225]
    v_pk_mul_f32 v[54:55], v[54:55], v[226:227]
    v_pk_add_f32 v[204:205], v[204:205], v[48:49]
    v_pk_fma_f32 v[206:207], v[48:49], v[48:49], v[206:207]
    v_pk_add_f32 v[208:209], v[208:209], v[50:51]
    v_pk_fma_f32 v[210:211], v[50:51], v[50:51], v[210:211]
    v_pk_add_f32 v[212:213], v[212:213], v[52:53]
    v_pk_fma_f32 v[214:215], v[52:53], v[52:53], v[214:215]
    v_pk_add_f32 v[216:217], v[216:217], v[54:55]
    v_pk_fma_f32 v[218:219], v[54:55], v[54:55], v[218:219]
    v_pk_mul_f32 v[228:229], v[56:57], v[56:57]
    v_pk_mul_f32 v[230:231], v[58:59], v[58:59]
    v_pk_mul_f32 v[232:233], v[60:61], v[60:61]
    v_pk_mul_f32 v[234:235], v[62:63], v[62:63]
    v_pk_fma_f32 v[228:229], v[228:229], v[112:113], v[104:105]
    v_pk_fma_f32 v[230:231], v[230:231], v[114:115], v[106:107]
    v_pk_fma_f32 v[232:233], v[232:233], v[116:117], v[108:109]
    v_pk_fma_f32 v[234:235], v[234:235], v[118:119], v[110:111]
    v_pk_mul_f32 v[228:229], v[228:229], v[56:57]
    v_pk_mul_f32 v[230:231], v[230:231], v[58:59]
    v_pk_mul_f32 v[232:233], v[232:233], v[60:61]
    v_pk_mul_f32 v[234:235], v[234:235], v[62:63]
    v_exp_f32 v228, v228
    v_exp_f32 v229, v229
    v_exp_f32 v230, v230
    v_exp_f32 v231, v231
    v_exp_f32 v232, v232
    v_exp_f32 v233, v233
    v_exp_f32 v234, v234
    v_exp_f32 v235, v235
    v_pk_fma_f32 v[228:229], v[228:229], v[120:121], v[120:121]
    v_pk_fma_f32 v[230:231], v[230:231], v[122:123], v[122:123]
    v_pk_fma_f32 v[232:233], v[232:233], v[124:125], v[124:125]
    v_pk_fma_f32 v[234:235], v[234:235], v[126:127], v[126:127]
    v_rcp_f32 v228, v228
    v_rcp_f32 v229, v229
    v_rcp_f32 v230, v230
    v_rcp_f32 v231, v231
    v_rcp_f32 v232, v232
    v_rcp_f32 v233, v233
    v_rcp_f32 v234, v234
    v_rcp_f32 v235, v235
    v_pk_mul_f32 v[56:57], v[56:57], v[228:229]
    v_pk_mul_f32 v[58:59], v[58:59], v[230:231]
    v_pk_mul_f32 v[60:61], v[60:61], v[232:233]
    v_pk_mul_f32 v[62:63], v[62:63], v[234:235]
    v_pk_add_f32 v[204:205], v[204:205], v[56:57]
    v_pk_fma_f32 v[206:207], v[56:57], v[56:57], v[206:207]
    v_pk_add_f32 v[208:209], v[208:209], v[58:59]
    v_pk_fma_f32 v[210:211], v[58:59], v[58:59], v[210:211]
    v_pk_add_f32 v[212:213], v[212:213], v[60:61]
    v_pk_fma_f32 v[214:215], v[60:61], v[60:61], v[214:215]
    v_pk_add_f32 v[216:217], v[216:217], v[62:63]
    v_pk_fma_f32 v[218:219], v[62:63], v[62:63], v[218:219]
    v_pk_mul_f32 v[220:221], v[64:65], v[64:65]
    v_pk_mul_f32 v[222:223], v[66:67], v[66:67]
    v_pk_mul_f32 v[224:225], v[68:69], v[68:69]
    v_pk_mul_f32 v[226:227], v[70:71], v[70:71]
    v_pk_fma_f32 v[220:221], v[220:221], v[112:113], v[104:105]
    v_pk_fma_f32 v[222:223], v[222:223], v[114:115], v[106:107]
    v_pk_fma_f32 v[224:225], v[224:225], v[116:117], v[108:109]
    v_pk_fma_f32 v[226:227], v[226:227], v[118:119], v[110:111]
    v_pk_mul_f32 v[220:221], v[220:221], v[64:65]
    v_pk_mul_f32 v[222:223], v[222:223], v[66:67]
    v_pk_mul_f32 v[224:225], v[224:225], v[68:69]
    v_pk_mul_f32 v[226:227], v[226:227], v[70:71]
    v_exp_f32 v220, v220
    v_exp_f32 v221, v221
    v_exp_f32 v222, v222
    v_exp_f32 v223, v223
    v_exp_f32 v224, v224
    v_exp_f32 v225, v225
    v_exp_f32 v226, v226
    v_exp_f32 v227, v227
    v_pk_fma_f32 v[220:221], v[220:221], v[120:121], v[120:121]
    v_pk_fma_f32 v[222:223], v[222:223], v[122:123], v[122:123]
    v_pk_fma_f32 v[224:225], v[224:225], v[124:125], v[124:125]
    v_pk_fma_f32 v[226:227], v[226:227], v[126:127], v[126:127]
    v_rcp_f32 v220, v220
    v_rcp_f32 v221, v221
    v_rcp_f32 v222, v222
    v_rcp_f32 v223, v223
    v_rcp_f32 v224, v224
    v_rcp_f32 v225, v225
    v_rcp_f32 v226, v226
    v_rcp_f32 v227, v227
    v_pk_mul_f32 v[64:65], v[64:65], v[220:221]
    v_pk_mul_f32 v[66:67], v[66:67], v[222:223]
    v_pk_mul_f32 v[68:69], v[68:69], v[224:225]
    v_pk_mul_f32 v[70:71], v[70:71], v[226:227]
    v_pk_add_f32 v[204:205], v[204:205], v[64:65]
    v_pk_fma_f32 v[206:207], v[64:65], v[64:65], v[206:207]
    v_pk_add_f32 v[208:209], v[208:209], v[66:67]
    v_pk_fma_f32 v[210:211], v[66:67], v[66:67], v[210:211]
    v_pk_add_f32 v[212:213], v[212:213], v[68:69]
    v_pk_fma_f32 v[214:215], v[68:69], v[68:69], v[214:215]
    v_pk_add_f32 v[216:217], v[216:217], v[70:71]
    v_pk_fma_f32 v[218:219], v[70:71], v[70:71], v[218:219]
    v_pk_mul_f32 v[228:229], v[72:73], v[72:73]
    v_pk_mul_f32 v[230:231], v[74:75], v[74:75]
    v_pk_mul_f32 v[232:233], v[76:77], v[76:77]
    v_pk_mul_f32 v[234:235], v[78:79], v[78:79]
    v_pk_fma_f32 v[228:229], v[228:229], v[112:113], v[104:105]
    v_pk_fma_f32 v[230:231], v[230:231], v[114:115], v[106:107]
    v_pk_fma_f32 v[232:233], v[232:233], v[116:117], v[108:109]
    v_pk_fma_f32 v[234:235], v[234:235], v[118:119], v[110:111]
    v_pk_mul_f32 v[228:229], v[228:229], v[72:73]
    v_pk_mul_f32 v[230:231], v[230:231], v[74:75]
    v_pk_mul_f32 v[232:233], v[232:233], v[76:77]
    v_pk_mul_f32 v[234:235], v[234:235], v[78:79]
    v_exp_f32 v228, v228
    v_exp_f32 v229, v229
    v_exp_f32 v230, v230
    v_exp_f32 v231, v231
    v_exp_f32 v232, v232
    v_exp_f32 v233, v233
    v_exp_f32 v234, v234
    v_exp_f32 v235, v235
    v_pk_fma_f32 v[228:229], v[228:229], v[120:121], v[120:121]
    v_pk_fma_f32 v[230:231], v[230:231], v[122:123], v[122:123]
    v_pk_fma_f32 v[232:233], v[232:233], v[124:125], v[124:125]
    v_pk_fma_f32 v[234:235], v[234:235], v[126:127], v[126:127]
    v_rcp_f32 v228, v228
    v_rcp_f32 v229, v229
    v_rcp_f32 v230, v230
    v_rcp_f32 v231, v231
    v_rcp_f32 v232, v232
    v_rcp_f32 v233, v233
    v_rcp_f32 v234, v234
    v_rcp_f32 v235, v235
    v_pk_mul_f32 v[72:73], v[72:73], v[228:229]
    v_pk_mul_f32 v[74:75], v[74:75], v[230:231]
    v_pk_mul_f32 v[76:77], v[76:77], v[232:233]
    v_pk_mul_f32 v[78:79], v[78:79], v[234:235]
    v_pk_add_f32 v[204:205], v[204:205], v[72:73]
    v_pk_fma_f32 v[206:207], v[72:73], v[72:73], v[206:207]
    v_pk_add_f32 v[208:209], v[208:209], v[74:75]
    v_pk_fma_f32 v[210:211], v[74:75], v[74:75], v[210:211]
    v_pk_add_f32 v[212:213], v[212:213], v[76:77]
    v_pk_fma_f32 v[214:215], v[76:77], v[76:77], v[214:215]
    v_pk_add_f32 v[216:217], v[216:217], v[78:79]
    v_pk_fma_f32 v[218:219], v[78:79], v[78:79], v[218:219]
    v_pk_mul_f32 v[220:221], v[80:81], v[80:81]
    v_pk_mul_f32 v[222:223], v[82:83], v[82:83]
    v_pk_mul_f32 v[224:225], v[84:85], v[84:85]
    v_pk_mul_f32 v[226:227], v[86:87], v[86:87]
    v_pk_fma_f32 v[220:221], v[220:221], v[112:113], v[104:105]
    v_pk_fma_f32 v[222:223], v[222:223], v[114:115], v[106:107]
    v_pk_fma_f32 v[224:225], v[224:225], v[116:117], v[108:109]
    v_pk_fma_f32 v[226:227], v[226:227], v[118:119], v[110:111]
    v_pk_mul_f32 v[220:221], v[220:221], v[80:81]
    v_pk_mul_f32 v[222:223], v[222:223], v[82:83]
    v_pk_mul_f32 v[224:225], v[224:225], v[84:85]
    v_pk_mul_f32 v[226:227], v[226:227], v[86:87]
    v_exp_f32 v220, v220
    v_exp_f32 v221, v221
    v_exp_f32 v222, v222
    v_exp_f32 v223, v223
    v_exp_f32 v224, v224
    v_exp_f32 v225, v225
    v_exp_f32 v226, v226
    v_exp_f32 v227, v227
    v_pk_fma_f32 v[220:221], v[220:221], v[120:121], v[120:121]
    v_pk_fma_f32 v[222:223], v[222:223], v[122:123], v[122:123]
    v_pk_fma_f32 v[224:225], v[224:225], v[124:125], v[124:125]
    v_pk_fma_f32 v[226:227], v[226:227], v[126:127], v[126:127]
    v_rcp_f32 v220, v220
    v_rcp_f32 v221, v221
    v_rcp_f32 v222, v222
    v_rcp_f32 v223, v223
    v_rcp_f32 v224, v224
    v_rcp_f32 v225, v225
    v_rcp_f32 v226, v226
    v_rcp_f32 v227, v227
    v_pk_mul_f32 v[80:81], v[80:81], v[220:221]
    v_pk_mul_f32 v[82:83], v[82:83], v[222:223]
    v_pk_mul_f32 v[84:85], v[84:85], v[224:225]
    v_pk_mul_f32 v[86:87], v[86:87], v[226:227]
    v_pk_add_f32 v[204:205], v[204:205], v[80:81]
    v_pk_fma_f32 v[206:207], v[80:81], v[80:81], v[206:207]
    v_pk_add_f32 v[208:209], v[208:209], v[82:83]
    v_pk_fma_f32 v[210:211], v[82:83], v[82:83], v[210:211]
    v_pk_add_f32 v[212:213], v[212:213], v[84:85]
    v_pk_fma_f32 v[214:215], v[84:85], v[84:85], v[214:215]
    v_pk_add_f32 v[216:217], v[216:217], v[86:87]
    v_pk_fma_f32 v[218:219], v[86:87], v[86:87], v[218:219]
    v_add_f32_dpp v204, v204, v204 row_mirror row_mask:0xf bank_mask:0x3
    v_add_f32_dpp v205, v205, v205 row_mirror row_mask:0xf bank_mask:0x3
    v_add_f32_dpp v206, v206, v206 row_mirror row_mask:0xf bank_mask:0x3
    v_add_f32_dpp v207, v207, v207 row_mirror row_mask:0xf bank_mask:0x3
    v_add_f32_dpp v208, v208, v208 row_mirror row_mask:0xf bank_mask:0x3
    v_add_f32_dpp v209, v209, v209 row_mirror row_mask:0xf bank_mask:0x3
    v_add_f32_dpp v210, v210, v210 row_mirror row_mask:0xf bank_mask:0x3
    v_add_f32_dpp v211, v211, v211 row_mirror row_mask:0xf bank_mask:0x3
    v_add_f32_dpp v204, v212, v212 row_mirror row_mask:0xf bank_mask:0xc
    v_add_f32_dpp v205, v213, v213 row_mirror row_mask:0xf bank_mask:0xc
    v_add_f32_dpp v206, v214, v214 row_mirror row_mask:0xf bank_mask:0xc
    v_add_f32_dpp v207, v215, v215 row_mirror row_mask:0xf bank_mask:0xc
    v_add_f32_dpp v208, v216, v216 row_mirror row_mask:0xf bank_mask:0xc
    v_add_f32_dpp v209, v217, v217 row_mirror row_mask:0xf bank_mask:0xc
    v_add_f32_dpp v210, v218, v218 row_mirror row_mask:0xf bank_mask:0xc
    v_add_f32_dpp v211, v219, v219 row_mirror row_mask:0xf bank_mask:0xc
    v_add_f32_dpp v204, v204, v204 row_half_mirror row_mask:0xf bank_mask:0x5
    v_add_f32_dpp v205, v205, v205 row_half_mirror row_mask:0xf bank_mask:0x5
    v_add_f32_dpp v206, v206, v206 row_half_mirror row_mask:0xf bank_mask:0x5
    v_add_f32_dpp v207, v207, v207 row_half_mirror row_mask:0xf bank_mask:0x5
    v_add_f32_dpp v204, v208, v208 row_half_mirror row_mask:0xf bank_mask:0xa
    v_add_f32_dpp v205, v209, v209 row_half_mirror row_mask:0xf bank_mask:0xa
    v_add_f32_dpp v206, v210, v210 row_half_mirror row_mask:0xf bank_mask:0xa
    v_add_f32_dpp v207, v211, v211 row_half_mirror row_mask:0xf bank_mask:0xa
    v_add_f32_dpp v204, v204, v204 quad_perm:[1,0,3,2] row_mask:0xf bank_mask:0xf
    v_add_f32_dpp v205, v205, v205 quad_perm:[1,0,3,2] row_mask:0xf bank_mask:0xf
    v_add_f32_dpp v206, v206, v206 quad_perm:[1,0,3,2] row_mask:0xf bank_mask:0xf
    v_add_f32_dpp v207, v207, v207 quad_perm:[1,0,3,2] row_mask:0xf bank_mask:0xf
    v_add_f32_dpp v12, v204, v204 quad_perm:[2,3,0,1] row_mask:0xf bank_mask:0xf
    v_add_f32_dpp v14, v205, v205 quad_perm:[2,3,0,1] row_mask:0xf bank_mask:0xf
    v_add_f32_dpp v13, v206, v206 quad_perm:[2,3,0,1] row_mask:0xf bank_mask:0xf
    v_add_f32_dpp v15, v207, v207 quad_perm:[2,3,0,1] row_mask:0xf bank_mask:0xf
    buffer_store_dwordx4 v[12:15], v8, s[4:7], s36 offen sc1
    s_waitcnt lgkmcnt(5)
    v_mfma_f32_16x16x32_bf16 v[88:91], v[168:171], v[160:163], 0
    ds_read_b128 v[204:207], v3 offset:37888
    v_mfma_f32_16x16x32_bf16 v[92:95], v[168:171], v[164:167], 0
    ds_read_b128 v[208:211], v3 offset:39936
    v_mfma_f32_16x16x32_bf16 v[96:99], v[172:175], v[160:163], 0
    ds_read_b128 v[212:215], v1 offset:46080
    v_mfma_f32_16x16x32_bf16 v[100:103], v[172:175], v[164:167], 0
    ds_read_b128 v[216:219], v1 offset:47104
    v_mfma_f32_16x16x32_bf16 v[104:107], v[176:179], v[160:163], 0
    ds_read_b128 v[220:223], v1 offset:48128
    v_mfma_f32_16x16x32_bf16 v[108:111], v[176:179], v[164:167], 0
    ds_read_b128 v[224:227], v1 offset:49152
    v_mfma_f32_16x16x32_bf16 v[112:115], v[180:183], v[160:163], 0
    ds_read_b128 v[228:231], v1 offset:50176
    v_mfma_f32_16x16x32_bf16 v[116:119], v[180:183], v[164:167], 0
    ds_read_b128 v[232:235], v1 offset:51200
    s_waitcnt lgkmcnt(8)
    v_mfma_f32_16x16x32_bf16 v[120:123], v[184:187], v[160:163], 0
    ds_read_b128 v[236:239], v1 offset:52224
    v_mfma_f32_16x16x32_bf16 v[124:127], v[184:187], v[164:167], 0
    ds_read_b128 v[240:243], v1 offset:53248
    v_mfma_f32_16x16x32_bf16 v[128:131], v[188:191], v[160:163], 0
    ds_read_b128 v[244:247], v1 offset:54272
    v_mfma_f32_16x16x32_bf16 v[132:135], v[188:191], v[164:167], 0
    v_mfma_f32_16x16x32_bf16 v[136:139], v[192:195], v[160:163], 0
    v_lshrrev_b32 v255, 8, v1
    v_mfma_f32_16x16x32_bf16 v[140:143], v[192:195], v[164:167], 0
    v_lshl_add_u32 v255, v255, 6, s33
    v_mfma_f32_16x16x32_bf16 v[144:147], v[196:199], v[160:163], 0
    v_mfma_f32_16x16x32_bf16 v[148:151], v[196:199], v[164:167], 0
    v_mfma_f32_16x16x32_bf16 v[152:155], v[200:203], v[160:163], 0
    v_mfma_f32_16x16x32_bf16 v[156:159], v[200:203], v[164:167], 0
    s_waitcnt lgkmcnt(0)
    s_barrier
    v_mfma_f32_16x16x32_bf16 v[88:91], v[212:215], v[204:207], v[88:91]
    ds_read_b128 v[160:163], v0 offset:0
    v_mfma_f32_16x16x32_bf16 v[92:95], v[212:215], v[208:211], v[92:95]
    ds_read_b128 v[164:167], v0 offset:2048
    v_mfma_f32_16x16x32_bf16 v[96:99], v[216:219], v[204:207], v[96:99]
    ds_read_b128 v[168:171], v2 offset:0
    v_mfma_f32_16x16x32_bf16 v[100:103], v[216:219], v[208:211], v[100:103]
    ds_read_b128 v[172:175], v2 offset:1024
    v_mfma_f32_16x16x32_bf16 v[104:107], v[220:223], v[204:207], v[104:107]
    ds_read_b128 v[176:179], v2 offset:2048
    v_mfma_f32_16x16x32_bf16 v[108:111], v[220:223], v[208:211], v[108:111]
    ds_read_b128 v[180:183], v2 offset:3072
    v_mfma_f32_16x16x32_bf16 v[112:115], v[224:227], v[204:207], v[112:115]
    ds_read_b128 v[184:187], v2 offset:4096
    v_mfma_f32_16x16x32_bf16 v[116:119], v[224:227], v[208:211], v[116:119]
    ds_read_b128 v[188:191], v2 offset:5120
    v_mfma_f32_16x16x32_bf16 v[120:123], v[228:231], v[204:207], v[120:123]
    ds_read_b128 v[192:195], v2 offset:6144
    v_mfma_f32_16x16x32_bf16 v[124:127], v[228:231], v[208:211], v[124:127]
    ds_read_b128 v[196:199], v2 offset:7168
    v_mfma_f32_16x16x32_bf16 v[128:131], v[232:235], v[204:207], v[128:131]
    ds_read_b128 v[200:203], v2 offset:8192
    v_mfma_f32_16x16x32_bf16 v[132:135], v[232:235], v[208:211], v[132:135]
    v_mfma_f32_16x16x32_bf16 v[136:139], v[236:239], v[204:207], v[136:139]
    v_mfma_f32_16x16x32_bf16 v[140:143], v[236:239], v[208:211], v[140:143]
    v_mfma_f32_16x16x32_bf16 v[144:147], v[240:243], v[204:207], v[144:147]
    v_mfma_f32_16x16x32_bf16 v[148:151], v[240:243], v[208:211], v[148:151]
    v_mfma_f32_16x16x32_bf16 v[152:155], v[244:247], v[204:207], v[152:155]
    v_mfma_f32_16x16x32_bf16 v[156:159], v[244:247], v[208:211], v[156:159]
    s_waitcnt lgkmcnt(5)
    v_mfma_f32_16x16x32_bf16 v[88:91], v[168:171], v[160:163], v[88:91]
    ds_read_b128 v[204:207], v0 offset:1024
    v_mfma_f32_16x16x32_bf16 v[92:95], v[168:171], v[164:167], v[92:95]
    ds_read_b128 v[208:211], v0 offset:3072
    v_mfma_f32_16x16x32_bf16 v[96:99], v[172:175], v[160:163], v[96:99]
    ds_read_b128 v[212:215], v2 offset:9216
    v_mfma_f32_16x16x32_bf16 v[100:103], v[172:175], v[164:167], v[100:103]
    ds_read_b128 v[216:219], v2 offset:10240
    v_mfma_f32_16x16x32_bf16 v[104:107], v[176:179], v[160:163], v[104:107]
    ds_read_b128 v[220:223], v2 offset:11264
    v_mfma_f32_16x16x32_bf16 v[108:111], v[176:179], v[164:167], v[108:111]
    ds_read_b128 v[224:227], v2 offset:12288
    v_mfma_f32_16x16x32_bf16 v[112:115], v[180:183], v[160:163], v[112:115]
    ds_read_b128 v[228:231], v2 offset:13312
    v_mfma_f32_16x16x32_bf16 v[116:119], v[180:183], v[164:167], v[116:119]
    ds_read_b128 v[232:235], v2 offset:14336
    s_waitcnt lgkmcnt(8)
    v_mfma_f32_16x16x32_bf16 v[120:123], v[184:187], v[160:163], v[120:123]
    ds_read_b128 v[236:239], v2 offset:15360
    v_mfma_f32_16x16x32_bf16 v[124:127], v[184:187], v[164:167], v[124:127]
    ds_read_b128 v[240:243], v2 offset:16384
    v_mfma_f32_16x16x32_bf16 v[128:131], v[188:191], v[160:163], v[128:131]
    ds_read_b128 v[244:247], v2 offset:17408
    v_mfma_f32_16x16x32_bf16 v[132:135], v[188:191], v[164:167], v[132:135]
    v_mfma_f32_16x16x32_bf16 v[136:139], v[192:195], v[160:163], v[136:139]
    v_mfma_f32_16x16x32_bf16 v[140:143], v[192:195], v[164:167], v[140:143]
    v_mfma_f32_16x16x32_bf16 v[144:147], v[196:199], v[160:163], v[144:147]
    v_mfma_f32_16x16x32_bf16 v[148:151], v[196:199], v[164:167], v[148:151]
    v_mfma_f32_16x16x32_bf16 v[152:155], v[200:203], v[160:163], v[152:155]
    v_mfma_f32_16x16x32_bf16 v[156:159], v[200:203], v[164:167], v[156:159]
    s_waitcnt lgkmcnt(0)
    s_barrier
    v_mfma_f32_16x16x32_bf16 v[88:91], v[212:215], v[204:207], v[88:91]
    ds_read_b128 v[160:163], v0 offset:36864
    v_mfma_f32_16x16x32_bf16 v[92:95], v[212:215], v[208:211], v[92:95]
    ds_read_b128 v[164:167], v0 offset:38912
    v_mfma_f32_16x16x32_bf16 v[96:99], v[216:219], v[204:207], v[96:99]
    ds_read_b128 v[168:171], v2 offset:36864
    v_mfma_f32_16x16x32_bf16 v[100:103], v[216:219], v[208:211], v[100:103]
    ds_read_b128 v[172:175], v2 offset:37888
    v_mfma_f32_16x16x32_bf16 v[104:107], v[220:223], v[204:207], v[104:107]
    ds_read_b128 v[176:179], v2 offset:38912
    v_mfma_f32_16x16x32_bf16 v[108:111], v[220:223], v[208:211], v[108:111]
    ds_read_b128 v[180:183], v2 offset:39936
    v_mfma_f32_16x16x32_bf16 v[112:115], v[224:227], v[204:207], v[112:115]
    ds_read_b128 v[184:187], v2 offset:40960
    v_mfma_f32_16x16x32_bf16 v[116:119], v[224:227], v[208:211], v[116:119]
    ds_read_b128 v[188:191], v2 offset:41984
    v_mfma_f32_16x16x32_bf16 v[120:123], v[228:231], v[204:207], v[120:123]
    ds_read_b128 v[192:195], v2 offset:43008
    v_mfma_f32_16x16x32_bf16 v[124:127], v[228:231], v[208:211], v[124:127]
    ds_read_b128 v[196:199], v2 offset:44032
    v_mfma_f32_16x16x32_bf16 v[128:131], v[232:235], v[204:207], v[128:131]
    ds_read_b128 v[200:203], v2 offset:45056
    v_mfma_f32_16x16x32_bf16 v[132:135], v[232:235], v[208:211], v[132:135]
    v_mfma_f32_16x16x32_bf16 v[136:139], v[236:239], v[204:207], v[136:139]
    v_mfma_f32_16x16x32_bf16 v[140:143], v[236:239], v[208:211], v[140:143]
    v_mfma_f32_16x16x32_bf16 v[144:147], v[240:243], v[204:207], v[144:147]
    v_mfma_f32_16x16x32_bf16 v[148:151], v[240:243], v[208:211], v[148:151]
    v_mfma_f32_16x16x32_bf16 v[152:155], v[244:247], v[204:207], v[152:155]
    v_mfma_f32_16x16x32_bf16 v[156:159], v[244:247], v[208:211], v[156:159]
    s_waitcnt lgkmcnt(5)
    v_mfma_f32_16x16x32_bf16 v[88:91], v[168:171], v[160:163], v[88:91]
    ds_read_b128 v[204:207], v0 offset:37888
    v_mfma_f32_16x16x32_bf16 v[92:95], v[168:171], v[164:167], v[92:95]
    ds_read_b128 v[208:211], v0 offset:39936
    v_mfma_f32_16x16x32_bf16 v[96:99], v[172:175], v[160:163], v[96:99]
    ds_read_b128 v[212:215], v2 offset:46080
    v_mfma_f32_16x16x32_bf16 v[100:103], v[172:175], v[164:167], v[100:103]
    ds_read_b128 v[216:219], v2 offset:47104
    v_mfma_f32_16x16x32_bf16 v[104:107], v[176:179], v[160:163], v[104:107]
    ds_read_b128 v[220:223], v2 offset:48128
    v_mfma_f32_16x16x32_bf16 v[108:111], v[176:179], v[164:167], v[108:111]
    ds_read_b128 v[224:227], v2 offset:49152
    v_mfma_f32_16x16x32_bf16 v[112:115], v[180:183], v[160:163], v[112:115]
    ds_read_b128 v[228:231], v2 offset:50176
    v_mfma_f32_16x16x32_bf16 v[116:119], v[180:183], v[164:167], v[116:119]
    ds_read_b128 v[232:235], v2 offset:51200
    s_waitcnt lgkmcnt(8)
    v_mfma_f32_16x16x32_bf16 v[120:123], v[184:187], v[160:163], v[120:123]
    ds_read_b128 v[236:239], v2 offset:52224
    v_mfma_f32_16x16x32_bf16 v[124:127], v[184:187], v[164:167], v[124:127]
    ds_read_b128 v[240:243], v2 offset:53248
    v_mfma_f32_16x16x32_bf16 v[128:131], v[188:191], v[160:163], v[128:131]
    ds_read_b128 v[244:247], v2 offset:54272
    v_mfma_f32_16x16x32_bf16 v[132:135], v[188:191], v[164:167], v[132:135]
    v_mfma_f32_16x16x32_bf16 v[136:139], v[192:195], v[160:163], v[136:139]
    v_mfma_f32_16x16x32_bf16 v[140:143], v[192:195], v[164:167], v[140:143]
    v_mfma_f32_16x16x32_bf16 v[144:147], v[196:199], v[160:163], v[144:147]
    v_mfma_f32_16x16x32_bf16 v[148:151], v[196:199], v[164:167], v[148:151]
    v_mfma_f32_16x16x32_bf16 v[152:155], v[200:203], v[160:163], v[152:155]
    v_mfma_f32_16x16x32_bf16 v[156:159], v[200:203], v[164:167], v[156:159]
    s_waitcnt lgkmcnt(0)
    s_barrier
    v_mfma_f32_16x16x32_bf16 v[88:91], v[212:215], v[204:207], v[88:91]
    ds_read_b128 v[160:163], v3 offset:0
    v_mfma_f32_16x16x32_bf16 v[92:95], v[212:215], v[208:211], v[92:95]
    ds_read_b128 v[164:167], v3 offset:2048
    v_mfma_f32_16x16x32_bf16 v[96:99], v[216:219], v[204:207], v[96:99]
    ds_read_b128 v[168:171], v1 offset:0
    v_mfma_f32_16x16x32_bf16 v[100:103], v[216:219], v[208:211], v[100:103]
    ds_read_b128 v[172:175], v1 offset:1024
    v_mfma_f32_16x16x32_bf16 v[104:107], v[220:223], v[204:207], v[104:107]
    ds_read_b128 v[176:179], v1 offset:2048
    v_mfma_f32_16x16x32_bf16 v[108:111], v[220:223], v[208:211], v[108:111]
    ds_read_b128 v[180:183], v1 offset:3072
    v_mfma_f32_16x16x32_bf16 v[112:115], v[224:227], v[204:207], v[112:115]
    ds_read_b128 v[184:187], v1 offset:4096
    v_mfma_f32_16x16x32_bf16 v[116:119], v[224:227], v[208:211], v[116:119]
    ds_read_b128 v[188:191], v1 offset:5120
    v_mfma_f32_16x16x32_bf16 v[120:123], v[228:231], v[204:207], v[120:123]
    ds_read_b128 v[192:195], v1 offset:6144
    v_mfma_f32_16x16x32_bf16 v[124:127], v[228:231], v[208:211], v[124:127]
    ds_read_b128 v[196:199], v1 offset:7168
    v_mfma_f32_16x16x32_bf16 v[128:131], v[232:235], v[204:207], v[128:131]
    ds_read_b128 v[200:203], v1 offset:8192
    v_mfma_f32_16x16x32_bf16 v[132:135], v[232:235], v[208:211], v[132:135]
    v_mfma_f32_16x16x32_bf16 v[136:139], v[236:239], v[204:207], v[136:139]
    v_mfma_f32_16x16x32_bf16 v[140:143], v[236:239], v[208:211], v[140:143]
    v_mfma_f32_16x16x32_bf16 v[144:147], v[240:243], v[204:207], v[144:147]
    v_mfma_f32_16x16x32_bf16 v[148:151], v[240:243], v[208:211], v[148:151]
    v_mfma_f32_16x16x32_bf16 v[152:155], v[244:247], v[204:207], v[152:155]
    v_mfma_f32_16x16x32_bf16 v[156:159], v[244:247], v[208:211], v[156:159]
    s_waitcnt lgkmcnt(5)
    v_mfma_f32_16x16x32_bf16 v[88:91], v[168:171], v[160:163], v[88:91]
    ds_read_b128 v[204:207], v3 offset:1024
    v_mfma_f32_16x16x32_bf16 v[92:95], v[168:171], v[164:167], v[92:95]
    ds_read_b128 v[208:211], v3 offset:3072
    v_mfma_f32_16x16x32_bf16 v[96:99], v[172:175], v[160:163], v[96:99]
    ds_read_b128 v[212:215], v1 offset:9216
    v_mfma_f32_16x16x32_bf16 v[100:103], v[172:175], v[164:167], v[100:103]
    ds_read_b128 v[216:219], v1 offset:10240
    v_mfma_f32_16x16x32_bf16 v[104:107], v[176:179], v[160:163], v[104:107]
    ds_read_b128 v[220:223], v1 offset:11264
    v_mfma_f32_16x16x32_bf16 v[108:111], v[176:179], v[164:167], v[108:111]
    ds_read_b128 v[224:227], v1 offset:12288
    v_mfma_f32_16x16x32_bf16 v[112:115], v[180:183], v[160:163], v[112:115]
    ds_read_b128 v[228:231], v1 offset:13312
    v_mfma_f32_16x16x32_bf16 v[116:119], v[180:183], v[164:167], v[116:119]
    ds_read_b128 v[232:235], v1 offset:14336
    s_waitcnt lgkmcnt(8)
    v_mfma_f32_16x16x32_bf16 v[120:123], v[184:187], v[160:163], v[120:123]
    ds_read_b128 v[236:239], v1 offset:15360
    v_mfma_f32_16x16x32_bf16 v[124:127], v[184:187], v[164:167], v[124:127]
    ds_read_b128 v[240:243], v1 offset:16384
    v_mfma_f32_16x16x32_bf16 v[128:131], v[188:191], v[160:163], v[128:131]
    ds_read_b128 v[244:247], v1 offset:17408
    v_mfma_f32_16x16x32_bf16 v[132:135], v[188:191], v[164:167], v[132:135]
    v_mfma_f32_16x16x32_bf16 v[136:139], v[192:195], v[160:163], v[136:139]
    v_mfma_f32_16x16x32_bf16 v[140:143], v[192:195], v[164:167], v[140:143]
    v_mfma_f32_16x16x32_bf16 v[144:147], v[196:199], v[160:163], v[144:147]
    v_mfma_f32_16x16x32_bf16 v[148:151], v[196:199], v[164:167], v[148:151]
    v_mfma_f32_16x16x32_bf16 v[152:155], v[200:203], v[160:163], v[152:155]
    v_mfma_f32_16x16x32_bf16 v[156:159], v[200:203], v[164:167], v[156:159]
    s_waitcnt lgkmcnt(0)
    s_barrier
    v_mfma_f32_16x16x32_bf16 v[88:91], v[212:215], v[204:207], v[88:91]
    ds_read_b128 v[160:163], v3 offset:36864
    v_mfma_f32_16x16x32_bf16 v[92:95], v[212:215], v[208:211], v[92:95]
    ds_read_b128 v[164:167], v3 offset:38912
    v_mfma_f32_16x16x32_bf16 v[96:99], v[216:219], v[204:207], v[96:99]
    ds_read_b128 v[168:171], v1 offset:36864
    v_mfma_f32_16x16x32_bf16 v[100:103], v[216:219], v[208:211], v[100:103]
    ds_read_b128 v[172:175], v1 offset:37888
    v_mfma_f32_16x16x32_bf16 v[104:107], v[220:223], v[204:207], v[104:107]
    ds_read_b128 v[176:179], v1 offset:38912
    v_mfma_f32_16x16x32_bf16 v[108:111], v[220:223], v[208:211], v[108:111]
    ds_read_b128 v[180:183], v1 offset:39936
    v_mfma_f32_16x16x32_bf16 v[112:115], v[224:227], v[204:207], v[112:115]
    ds_read_b128 v[184:187], v1 offset:40960
    v_mfma_f32_16x16x32_bf16 v[116:119], v[224:227], v[208:211], v[116:119]
    ds_read_b128 v[188:191], v1 offset:41984
    v_mfma_f32_16x16x32_bf16 v[120:123], v[228:231], v[204:207], v[120:123]
    ds_read_b128 v[192:195], v1 offset:43008
    v_mfma_f32_16x16x32_bf16 v[124:127], v[228:231], v[208:211], v[124:127]
    ds_read_b128 v[196:199], v1 offset:44032
    v_mfma_f32_16x16x32_bf16 v[128:131], v[232:235], v[204:207], v[128:131]
    ds_read_b128 v[200:203], v1 offset:45056
    v_mfma_f32_16x16x32_bf16 v[132:135], v[232:235], v[208:211], v[132:135]
    ds_read_b128 v[4:7], v255 offset:1024
    v_mfma_f32_16x16x32_bf16 v[136:139], v[236:239], v[204:207], v[136:139]
    ds_read_b128 v[8:11], v255 offset:1040
    v_mfma_f32_16x16x32_bf16 v[140:143], v[236:239], v[208:211], v[140:143]
    ds_read_b128 v[12:15], v255 offset:1056
    v_mfma_f32_16x16x32_bf16 v[144:147], v[240:243], v[204:207], v[144:147]
    ds_read_b128 v[252:255], v255 offset:1072
    v_mfma_f32_16x16x32_bf16 v[148:151], v[240:243], v[208:211], v[148:151]
    v_mfma_f32_16x16x32_bf16 v[152:155], v[244:247], v[204:207], v[152:155]
    v_mfma_f32_16x16x32_bf16 v[156:159], v[244:247], v[208:211], v[156:159]
    s_waitcnt lgkmcnt(9)
    v_mfma_f32_16x16x32_bf16 v[88:91], v[168:171], v[160:163], v[88:91]
    ds_read_b128 v[204:207], v3 offset:37888
    v_mfma_f32_16x16x32_bf16 v[92:95], v[168:171], v[164:167], v[92:95]
    ds_read_b128 v[208:211], v3 offset:39936
    v_mfma_f32_16x16x32_bf16 v[96:99], v[172:175], v[160:163], v[96:99]
    ds_read_b128 v[212:215], v1 offset:46080
    v_mfma_f32_16x16x32_bf16 v[100:103], v[172:175], v[164:167], v[100:103]
    ds_read_b128 v[216:219], v1 offset:47104
    v_mfma_f32_16x16x32_bf16 v[104:107], v[176:179], v[160:163], v[104:107]
    ds_read_b128 v[220:223], v1 offset:48128
    v_mfma_f32_16x16x32_bf16 v[108:111], v[176:179], v[164:167], v[108:111]
    ds_read_b128 v[224:227], v1 offset:49152
    v_mfma_f32_16x16x32_bf16 v[112:115], v[180:183], v[160:163], v[112:115]
    ds_read_b128 v[228:231], v1 offset:50176
    v_mfma_f32_16x16x32_bf16 v[116:119], v[180:183], v[164:167], v[116:119]
    ds_read_b128 v[232:235], v1 offset:51200
    s_waitcnt lgkmcnt(8)
    v_mfma_f32_16x16x32_bf16 v[120:123], v[184:187], v[160:163], v[120:123]
    ds_read_b128 v[236:239], v1 offset:52224
    v_fma_f32 v16, v16, v4, -v6
    v_mfma_f32_16x16x32_bf16 v[124:127], v[184:187], v[164:167], v[124:127]
    ds_read_b128 v[240:243], v1 offset:53248
    v_fma_f32 v17, v17, v5, -v7
    v_mfma_f32_16x16x32_bf16 v[128:131], v[188:191], v[160:163], v[128:131]
    ds_read_b128 v[244:247], v1 offset:54272
    v_fma_f32 v18, v18, v8, -v10
    v_mfma_f32_16x16x32_bf16 v[132:135], v[188:191], v[164:167], v[132:135]
    v_fma_f32 v19, v19, v9, -v11
    v_fma_f32 v20, v20, v12, -v14
    v_mfma_f32_16x16x32_bf16 v[136:139], v[192:195], v[160:163], v[136:139]
    v_fma_f32 v21, v21, v13, -v15
    v_fma_f32 v22, v22, v252, -v254
    v_mfma_f32_16x16x32_bf16 v[140:143], v[192:195], v[164:167], v[140:143]
    v_fma_f32 v23, v23, v253, -v255
    v_cvt_pk_bf16_f32 v16, v16, v17
    v_mfma_f32_16x16x32_bf16 v[144:147], v[196:199], v[160:163], v[144:147]
    v_cvt_pk_bf16_f32 v17, v18, v19
    v_cvt_pk_bf16_f32 v18, v20, v21
    v_mfma_f32_16x16x32_bf16 v[148:151], v[196:199], v[164:167], v[148:151]
    v_cvt_pk_bf16_f32 v19, v22, v23
    v_fma_f32 v24, v24, v4, -v6
    v_mfma_f32_16x16x32_bf16 v[152:155], v[200:203], v[160:163], v[152:155]
    v_fma_f32 v25, v25, v5, -v7
    v_fma_f32 v26, v26, v8, -v10
    v_mfma_f32_16x16x32_bf16 v[156:159], v[200:203], v[164:167], v[156:159]
    v_fma_f32 v27, v27, v9, -v11
    s_waitcnt lgkmcnt(0)
    s_barrier
    v_mfma_f32_16x16x32_bf16 v[88:91], v[212:215], v[204:207], v[88:91]
    ds_read_b128 v[160:163], v0 offset:0
    v_mfma_f32_16x16x32_bf16 v[92:95], v[212:215], v[208:211], v[92:95]
    ds_read_b128 v[164:167], v0 offset:2048
    v_fma_f32 v28, v28, v12, -v14
    v_mfma_f32_16x16x32_bf16 v[96:99], v[216:219], v[204:207], v[96:99]
    ds_read_b128 v[168:171], v2 offset:0
    v_fma_f32 v29, v29, v13, -v15
    v_mfma_f32_16x16x32_bf16 v[100:103], v[216:219], v[208:211], v[100:103]
    ds_read_b128 v[172:175], v2 offset:1024
    v_fma_f32 v30, v30, v252, -v254
    v_mfma_f32_16x16x32_bf16 v[104:107], v[220:223], v[204:207], v[104:107]
    ds_read_b128 v[176:179], v2 offset:2048
    v_fma_f32 v31, v31, v253, -v255
    v_mfma_f32_16x16x32_bf16 v[108:111], v[220:223], v[208:211], v[108:111]
    ds_read_b128 v[180:183], v2 offset:3072
    v_permlane32_swap_b32 v16, v18
    v_mfma_f32_16x16x32_bf16 v[112:115], v[224:227], v[204:207], v[112:115]
    ds_read_b128 v[184:187], v2 offset:4096
    v_permlane32_swap_b32 v17, v19
    v_mfma_f32_16x16x32_bf16 v[116:119], v[224:227], v[208:211], v[116:119]
    ds_read_b128 v[188:191], v2 offset:5120
    v_mfma_f32_16x16x32_bf16 v[120:123], v[228:231], v[204:207], v[120:123]
    ds_read_b128 v[192:195], v2 offset:6144
    v_cvt_pk_bf16_f32 v24, v24, v25
    v_mfma_f32_16x16x32_bf16 v[124:127], v[228:231], v[208:211], v[124:127]
    ds_read_b128 v[196:199], v2 offset:7168
    v_cvt_pk_bf16_f32 v25, v26, v27
    v_mfma_f32_16x16x32_bf16 v[128:131], v[232:235], v[204:207], v[128:131]
    ds_read_b128 v[200:203], v2 offset:8192
    v_cvt_pk_bf16_f32 v26, v28, v29
    v_mfma_f32_16x16x32_bf16 v[132:135], v[232:235], v[208:211], v[132:135]
    v_cvt_pk_bf16_f32 v27, v30, v31
    v_permlane16_swap_b32 v16, v18
    v_mfma_f32_16x16x32_bf16 v[136:139], v[236:239], v[204:207], v[136:139]
    v_permlane16_swap_b32 v17, v19
    v_fma_f32 v32, v32, v4, -v6
    v_mfma_f32_16x16x32_bf16 v[140:143], v[236:239], v[208:211], v[140:143]
    v_fma_f32 v33, v33, v5, -v7
    v_fma_f32 v34, v34, v8, -v10
    v_mfma_f32_16x16x32_bf16 v[144:147], v[240:243], v[204:207], v[144:147]
    v_fma_f32 v35, v35, v9, -v11
    v_fma_f32 v36, v36, v12, -v14
    v_mfma_f32_16x16x32_bf16 v[148:151], v[240:243], v[208:211], v[148:151]
    v_fma_f32 v37, v37, v13, -v15
    v_fma_f32 v38, v38, v252, -v254
    v_mfma_f32_16x16x32_bf16 v[152:155], v[244:247], v[204:207], v[152:155]
    v_fma_f32 v39, v39, v253, -v255
    v_permlane32_swap_b32 v24, v26
    v_mfma_f32_16x16x32_bf16 v[156:159], v[244:247], v[208:211], v[156:159]
    v_permlane32_swap_b32 v25, v27
    s_waitcnt lgkmcnt(5)
    v_mfma_f32_16x16x32_bf16 v[88:91], v[168:171], v[160:163], v[88:91]
    ds_read_b128 v[204:207], v0 offset:1024
    v_mfma_f32_16x16x32_bf16 v[92:95], v[168:171], v[164:167], v[92:95]
    ds_read_b128 v[208:211], v0 offset:3072
    v_cvt_pk_bf16_f32 v32, v32, v33
    v_mfma_f32_16x16x32_bf16 v[96:99], v[172:175], v[160:163], v[96:99]
    ds_read_b128 v[212:215], v2 offset:9216
    v_cvt_pk_bf16_f32 v33, v34, v35
    v_mfma_f32_16x16x32_bf16 v[100:103], v[172:175], v[164:167], v[100:103]
    ds_read_b128 v[216:219], v2 offset:10240
    v_cvt_pk_bf16_f32 v34, v36, v37
    v_mfma_f32_16x16x32_bf16 v[104:107], v[176:179], v[160:163], v[104:107]
    ds_read_b128 v[220:223], v2 offset:11264
    v_cvt_pk_bf16_f32 v35, v38, v39
    v_mfma_f32_16x16x32_bf16 v[108:111], v[176:179], v[164:167], v[108:111]
    ds_read_b128 v[224:227], v2 offset:12288
    v_permlane16_swap_b32 v24, v26
    v_mfma_f32_16x16x32_bf16 v[112:115], v[180:183], v[160:163], v[112:115]
    ds_read_b128 v[228:231], v2 offset:13312
    v_permlane16_swap_b32 v25, v27
    v_mfma_f32_16x16x32_bf16 v[116:119], v[180:183], v[164:167], v[116:119]
    ds_read_b128 v[232:235], v2 offset:14336
    s_waitcnt lgkmcnt(8)
    v_mfma_f32_16x16x32_bf16 v[120:123], v[184:187], v[160:163], v[120:123]
    ds_read_b128 v[236:239], v2 offset:15360
    v_fma_f32 v40, v40, v4, -v6
    v_mfma_f32_16x16x32_bf16 v[124:127], v[184:187], v[164:167], v[124:127]
    ds_read_b128 v[240:243], v2 offset:16384
    v_fma_f32 v41, v41, v5, -v7
    v_mfma_f32_16x16x32_bf16 v[128:131], v[188:191], v[160:163], v[128:131]
    ds_read_b128 v[244:247], v2 offset:17408
    v_fma_f32 v42, v42, v8, -v10
    v_mfma_f32_16x16x32_bf16 v[132:135], v[188:191], v[164:167], v[132:135]
    v_fma_f32 v43, v43, v9, -v11
    v_fma_f32 v44, v44, v12, -v14
    v_mfma_f32_16x16x32_bf16 v[136:139], v[192:195], v[160:163], v[136:139]
    v_fma_f32 v45, v45, v13, -v15
    v_fma_f32 v46, v46, v252, -v254
    v_mfma_f32_16x16x32_bf16 v[140:143], v[192:195], v[164:167], v[140:143]
    v_fma_f32 v47, v47, v253, -v255
    v_permlane32_swap_b32 v32, v34
    v_mfma_f32_16x16x32_bf16 v[144:147], v[196:199], v[160:163], v[144:147]
    v_permlane32_swap_b32 v33, v35
    v_cvt_pk_bf16_f32 v40, v40, v41
    v_mfma_f32_16x16x32_bf16 v[148:151], v[196:199], v[164:167], v[148:151]
    v_cvt_pk_bf16_f32 v41, v42, v43
    v_cvt_pk_bf16_f32 v42, v44, v45
    v_mfma_f32_16x16x32_bf16 v[152:155], v[200:203], v[160:163], v[152:155]
    v_cvt_pk_bf16_f32 v43, v46, v47
    v_permlane16_swap_b32 v32, v34
    v_mfma_f32_16x16x32_bf16 v[156:159], v[200:203], v[164:167], v[156:159]
    v_permlane16_swap_b32 v33, v35
    s_waitcnt lgkmcnt(0)
    s_barrier
    v_mfma_f32_16x16x32_bf16 v[88:91], v[212:215], v[204:207], v[88:91]
    ds_read_b128 v[160:163], v0 offset:36864
    v_mfma_f32_16x16x32_bf16 v[92:95], v[212:215], v[208:211], v[92:95]
    ds_read_b128 v[164:167], v0 offset:38912
    v_fma_f32 v48, v48, v4, -v6
    v_mfma_f32_16x16x32_bf16 v[96:99], v[216:219], v[204:207], v[96:99]
    ds_read_b128 v[168:171], v2 offset:36864
    v_fma_f32 v49, v49, v5, -v7
    v_mfma_f32_16x16x32_bf16 v[100:103], v[216:219], v[208:211], v[100:103]
    ds_read_b128 v[172:175], v2 offset:37888
    v_fma_f32 v50, v50, v8, -v10
    v_mfma_f32_16x16x32_bf16 v[104:107], v[220:223], v[204:207], v[104:107]
    ds_read_b128 v[176:179], v2 offset:38912
    v_fma_f32 v51, v51, v9, -v11
    v_mfma_f32_16x16x32_bf16 v[108:111], v[220:223], v[208:211], v[108:111]
    ds_read_b128 v[180:183], v2 offset:39936
    v_fma_f32 v52, v52, v12, -v14
    v_mfma_f32_16x16x32_bf16 v[112:115], v[224:227], v[204:207], v[112:115]
    ds_read_b128 v[184:187], v2 offset:40960
    v_fma_f32 v53, v53, v13, -v15
    v_mfma_f32_16x16x32_bf16 v[116:119], v[224:227], v[208:211], v[116:119]
    ds_read_b128 v[188:191], v2 offset:41984
    v_mfma_f32_16x16x32_bf16 v[120:123], v[228:231], v[204:207], v[120:123]
    ds_read_b128 v[192:195], v2 offset:43008
    v_fma_f32 v54, v54, v252, -v254
    v_mfma_f32_16x16x32_bf16 v[124:127], v[228:231], v[208:211], v[124:127]
    ds_read_b128 v[196:199], v2 offset:44032
    v_fma_f32 v55, v55, v253, -v255
    v_mfma_f32_16x16x32_bf16 v[128:131], v[232:235], v[204:207], v[128:131]
    ds_read_b128 v[200:203], v2 offset:45056
    v_permlane32_swap_b32 v40, v42
    v_mfma_f32_16x16x32_bf16 v[132:135], v[232:235], v[208:211], v[132:135]
    v_permlane32_swap_b32 v41, v43
    v_cvt_pk_bf16_f32 v48, v48, v49
    v_mfma_f32_16x16x32_bf16 v[136:139], v[236:239], v[204:207], v[136:139]
    v_cvt_pk_bf16_f32 v49, v50, v51
    v_cvt_pk_bf16_f32 v50, v52, v53
    v_mfma_f32_16x16x32_bf16 v[140:143], v[236:239], v[208:211], v[140:143]
    v_cvt_pk_bf16_f32 v51, v54, v55
    v_permlane16_swap_b32 v40, v42
    v_mfma_f32_16x16x32_bf16 v[144:147], v[240:243], v[204:207], v[144:147]
    v_permlane16_swap_b32 v41, v43
    v_fma_f32 v56, v56, v4, -v6
    v_mfma_f32_16x16x32_bf16 v[148:151], v[240:243], v[208:211], v[148:151]
    v_fma_f32 v57, v57, v5, -v7
    v_fma_f32 v58, v58, v8, -v10
    v_mfma_f32_16x16x32_bf16 v[152:155], v[244:247], v[204:207], v[152:155]
    v_fma_f32 v59, v59, v9, -v11
    v_fma_f32 v60, v60, v12, -v14
    v_mfma_f32_16x16x32_bf16 v[156:159], v[244:247], v[208:211], v[156:159]
    v_fma_f32 v61, v61, v13, -v15
    s_waitcnt lgkmcnt(5)
    v_mfma_f32_16x16x32_bf16 v[88:91], v[168:171], v[160:163], v[88:91]
    ds_read_b128 v[204:207], v0 offset:37888
    v_mfma_f32_16x16x32_bf16 v[92:95], v[168:171], v[164:167], v[92:95]
    ds_read_b128 v[208:211], v0 offset:39936
    v_fma_f32 v62, v62, v252, -v254
    v_mfma_f32_16x16x32_bf16 v[96:99], v[172:175], v[160:163], v[96:99]
    ds_read_b128 v[212:215], v2 offset:46080
    buffer_store_dwordx4 v[16:19], v1, s[4:7], s38 offen offset:0 sc1
    v_fma_f32 v63, v63, v253, -v255
    v_mfma_f32_16x16x32_bf16 v[100:103], v[172:175], v[164:167], v[100:103]
    ds_read_b128 v[216:219], v2 offset:47104
    v_permlane32_swap_b32 v48, v50
    v_mfma_f32_16x16x32_bf16 v[104:107], v[176:179], v[160:163], v[104:107]
    ds_read_b128 v[220:223], v2 offset:48128
    v_permlane32_swap_b32 v49, v51
    v_mfma_f32_16x16x32_bf16 v[108:111], v[176:179], v[164:167], v[108:111]
    ds_read_b128 v[224:227], v2 offset:49152
    v_cvt_pk_bf16_f32 v56, v56, v57
    v_mfma_f32_16x16x32_bf16 v[112:115], v[180:183], v[160:163], v[112:115]
    ds_read_b128 v[228:231], v2 offset:50176
    v_cvt_pk_bf16_f32 v57, v58, v59
    v_mfma_f32_16x16x32_bf16 v[116:119], v[180:183], v[164:167], v[116:119]
    ds_read_b128 v[232:235], v2 offset:51200
    s_waitcnt lgkmcnt(8)
    buffer_store_dwordx4 v[24:27], v1, s[4:7], s38 offen offset:1024 sc1
    v_mfma_f32_16x16x32_bf16 v[120:123], v[184:187], v[160:163], v[120:123]
    ds_read_b128 v[236:239], v2 offset:52224
    v_cvt_pk_bf16_f32 v58, v60, v61
    v_mfma_f32_16x16x32_bf16 v[124:127], v[184:187], v[164:167], v[124:127]
    ds_read_b128 v[240:243], v2 offset:53248
    v_cvt_pk_bf16_f32 v59, v62, v63
    v_mfma_f32_16x16x32_bf16 v[128:131], v[188:191], v[160:163], v[128:131]
    ds_read_b128 v[244:247], v2 offset:54272
    v_permlane16_swap_b32 v48, v50
    v_mfma_f32_16x16x32_bf16 v[132:135], v[188:191], v[164:167], v[132:135]
    v_permlane16_swap_b32 v49, v51
    v_fma_f32 v64, v64, v4, -v6
    v_mfma_f32_16x16x32_bf16 v[136:139], v[192:195], v[160:163], v[136:139]
    buffer_store_dwordx4 v[32:35], v1, s[4:7], s38 offen offset:2048 sc1
    v_fma_f32 v65, v65, v5, -v7
    v_fma_f32 v66, v66, v8, -v10
    v_mfma_f32_16x16x32_bf16 v[140:143], v[192:195], v[164:167], v[140:143]
    v_fma_f32 v67, v67, v9, -v11
    v_fma_f32 v68, v68, v12, -v14
    v_mfma_f32_16x16x32_bf16 v[144:147], v[196:199], v[160:163], v[144:147]
    v_fma_f32 v69, v69, v13, -v15
    v_fma_f32 v70, v70, v252, -v254
    v_mfma_f32_16x16x32_bf16 v[148:151], v[196:199], v[164:167], v[148:151]
    v_fma_f32 v71, v71, v253, -v255
    v_permlane32_swap_b32 v56, v58
    v_mfma_f32_16x16x32_bf16 v[152:155], v[200:203], v[160:163], v[152:155]
    v_permlane32_swap_b32 v57, v59
    v_cvt_pk_bf16_f32 v64, v64, v65
    v_mfma_f32_16x16x32_bf16 v[156:159], v[200:203], v[164:167], v[156:159]
    v_cvt_pk_bf16_f32 v65, v66, v67
    s_waitcnt lgkmcnt(0)
    s_barrier
    v_mfma_f32_16x16x32_bf16 v[88:91], v[212:215], v[204:207], v[88:91]
    ds_read_b128 v[160:163], v3 offset:0
    v_mfma_f32_16x16x32_bf16 v[92:95], v[212:215], v[208:211], v[92:95]
    ds_read_b128 v[164:167], v3 offset:2048
    v_cvt_pk_bf16_f32 v66, v68, v69
    v_mfma_f32_16x16x32_bf16 v[96:99], v[216:219], v[204:207], v[96:99]
    ds_read_b128 v[168:171], v1 offset:0
    buffer_store_dwordx4 v[40:43], v1, s[4:7], s38 offen offset:3072 sc1
    v_cvt_pk_bf16_f32 v67, v70, v71
    v_mfma_f32_16x16x32_bf16 v[100:103], v[216:219], v[208:211], v[100:103]
    ds_read_b128 v[172:175], v1 offset:1024
    v_permlane16_swap_b32 v56, v58
    v_mfma_f32_16x16x32_bf16 v[104:107], v[220:223], v[204:207], v[104:107]
    ds_read_b128 v[176:179], v1 offset:2048
    v_permlane16_swap_b32 v57, v59
    v_mfma_f32_16x16x32_bf16 v[108:111], v[220:223], v[208:211], v[108:111]
    ds_read_b128 v[180:183], v1 offset:3072
    v_fma_f32 v72, v72, v4, -v6
    v_mfma_f32_16x16x32_bf16 v[112:115], v[224:227], v[204:207], v[112:115]
    ds_read_b128 v[184:187], v1 offset:4096
    v_fma_f32 v73, v73, v5, -v7
    v_mfma_f32_16x16x32_bf16 v[116:119], v[224:227], v[208:211], v[116:119]
    ds_read_b128 v[188:191], v1 offset:5120
    buffer_store_dwordx4 v[48:51], v1, s[4:7], s39 offen offset:0 sc1
    v_mfma_f32_16x16x32_bf16 v[120:123], v[228:231], v[204:207], v[120:123]
    ds_read_b128 v[192:195], v1 offset:6144
    v_fma_f32 v74, v74, v8, -v10
    v_mfma_f32_16x16x32_bf16 v[124:127], v[228:231], v[208:211], v[124:127]
    ds_read_b128 v[196:199], v1 offset:7168
    v_fma_f32 v75, v75, v9, -v11
    v_mfma_f32_16x16x32_bf16 v[128:131], v[232:235], v[204:207], v[128:131]
    ds_read_b128 v[200:203], v1 offset:8192
    v_fma_f32 v76, v76, v12, -v14
    v_mfma_f32_16x16x32_bf16 v[132:135], v[232:235], v[208:211], v[132:135]
    v_fma_f32 v77, v77, v13, -v15
    v_fma_f32 v78, v78, v252, -v254
    v_mfma_f32_16x16x32_bf16 v[136:139], v[236:239], v[204:207], v[136:139]
    v_fma_f32 v79, v79, v253, -v255
    v_permlane32_swap_b32 v64, v66
    v_mfma_f32_16x16x32_bf16 v[140:143], v[236:239], v[208:211], v[140:143]
    v_permlane32_swap_b32 v65, v67
    v_cvt_pk_bf16_f32 v72, v72, v73
    v_mfma_f32_16x16x32_bf16 v[144:147], v[240:243], v[204:207], v[144:147]
    v_cvt_pk_bf16_f32 v73, v74, v75
    v_cvt_pk_bf16_f32 v74, v76, v77
    v_mfma_f32_16x16x32_bf16 v[148:151], v[240:243], v[208:211], v[148:151]
    v_cvt_pk_bf16_f32 v75, v78, v79
    v_permlane16_swap_b32 v64, v66
    v_mfma_f32_16x16x32_bf16 v[152:155], v[244:247], v[204:207], v[152:155]
    v_permlane16_swap_b32 v65, v67
    v_fma_f32 v80, v80, v4, -v6
    v_mfma_f32_16x16x32_bf16 v[156:159], v[244:247], v[208:211], v[156:159]
    v_fma_f32 v81, v81, v5, -v7
    s_waitcnt lgkmcnt(5)
    v_mfma_f32_16x16x32_bf16 v[88:91], v[168:171], v[160:163], v[88:91]
    ds_read_b128 v[204:207], v3 offset:1024
    v_mfma_f32_16x16x32_bf16 v[92:95], v[168:171], v[164:167], v[92:95]
    ds_read_b128 v[208:211], v3 offset:3072
    v_fma_f32 v82, v82, v8, -v10
    v_mfma_f32_16x16x32_bf16 v[96:99], v[172:175], v[160:163], v[96:99]
    ds_read_b128 v[212:215], v1 offset:9216
    buffer_store_dwordx4 v[56:59], v1, s[4:7], s39 offen offset:1024 sc1
    v_fma_f32 v83, v83, v9, -v11
    v_mfma_f32_16x16x32_bf16 v[100:103], v[172:175], v[164:167], v[100:103]
    ds_read_b128 v[216:219], v1 offset:10240
    v_fma_f32 v84, v84, v12, -v14
    v_mfma_f32_16x16x32_bf16 v[104:107], v[176:179], v[160:163], v[104:107]
    ds_read_b128 v[220:223], v1 offset:11264
    v_fma_f32 v85, v85, v13, -v15
    v_mfma_f32_16x16x32_bf16 v[108:111], v[176:179], v[164:167], v[108:111]
    ds_read_b128 v[224:227], v1 offset:12288
    v_fma_f32 v86, v86, v252, -v254
    v_mfma_f32_16x16x32_bf16 v[112:115], v[180:183], v[160:163], v[112:115]
    ds_read_b128 v[228:231], v1 offset:13312
    v_fma_f32 v87, v87, v253, -v255
    v_mfma_f32_16x16x32_bf16 v[116:119], v[180:183], v[164:167], v[116:119]
    ds_read_b128 v[232:235], v1 offset:14336
    s_waitcnt lgkmcnt(8)
    buffer_store_dwordx4 v[64:67], v1, s[4:7], s39 offen offset:2048 sc1
    v_mfma_f32_16x16x32_bf16 v[120:123], v[184:187], v[160:163], v[120:123]
    ds_read_b128 v[236:239], v1 offset:15360
    v_permlane32_swap_b32 v72, v74
    v_mfma_f32_16x16x32_bf16 v[124:127], v[184:187], v[164:167], v[124:127]
    ds_read_b128 v[240:243], v1 offset:16384
    v_permlane32_swap_b32 v73, v75
    v_mfma_f32_16x16x32_bf16 v[128:131], v[188:191], v[160:163], v[128:131]
    ds_read_b128 v[244:247], v1 offset:17408
    v_cvt_pk_bf16_f32 v80, v80, v81
    v_mfma_f32_16x16x32_bf16 v[132:135], v[188:191], v[164:167], v[132:135]
    v_cvt_pk_bf16_f32 v81, v82, v83
    v_cvt_pk_bf16_f32 v82, v84, v85
    v_mfma_f32_16x16x32_bf16 v[136:139], v[192:195], v[160:163], v[136:139]
    v_cvt_pk_bf16_f32 v83, v86, v87
    v_permlane16_swap_b32 v72, v74
    v_mfma_f32_16x16x32_bf16 v[140:143], v[192:195], v[164:167], v[140:143]
    v_permlane16_swap_b32 v73, v75
    s_nop 0
    v_mfma_f32_16x16x32_bf16 v[144:147], v[196:199], v[160:163], v[144:147]
    v_permlane32_swap_b32 v80, v82
    v_permlane32_swap_b32 v81, v83
    v_mfma_f32_16x16x32_bf16 v[148:151], v[196:199], v[164:167], v[148:151]
    s_nop 0
    v_permlane16_swap_b32 v80, v82
    v_mfma_f32_16x16x32_bf16 v[152:155], v[200:203], v[160:163], v[152:155]
    v_permlane16_swap_b32 v81, v83
    v_mul_f32 v4, s40, v249
    v_mfma_f32_16x16x32_bf16 v[156:159], v[200:203], v[164:167], v[156:159]
    v_mul_f32 v6, s40, v251
    s_waitcnt lgkmcnt(0)
    s_barrier
    v_mfma_f32_16x16x32_bf16 v[88:91], v[212:215], v[204:207], v[88:91]
    ds_read_b128 v[160:163], v3 offset:36864
    v_mfma_f32_16x16x32_bf16 v[92:95], v[212:215], v[208:211], v[92:95]
    ds_read_b128 v[164:167], v3 offset:38912
    v_mul_f32 v5, v249, v249
    v_mfma_f32_16x16x32_bf16 v[96:99], v[216:219], v[204:207], v[96:99]
    ds_read_b128 v[168:171], v1 offset:36864
    buffer_store_dwordx4 v[72:75], v1, s[4:7], s39 offen offset:3072 sc1
    v_mul_f32 v7, v251, v251
    v_mfma_f32_16x16x32_bf16 v[100:103], v[216:219], v[208:211], v[100:103]
    ds_read_b128 v[172:175], v1 offset:37888
    v_rcp_f32 v249, v249
    v_mfma_f32_16x16x32_bf16 v[104:107], v[220:223], v[204:207], v[104:107]
    ds_read_b128 v[176:179], v1 offset:38912
    v_rcp_f32 v251, v251
    v_mfma_f32_16x16x32_bf16 v[108:111], v[220:223], v[208:211], v[108:111]
    ds_read_b128 v[180:183], v1 offset:39936
    v_mul_f32 v5, s42, v5
    v_mfma_f32_16x16x32_bf16 v[112:115], v[224:227], v[204:207], v[112:115]
    ds_read_b128 v[184:187], v1 offset:40960
    v_mul_f32 v7, s42, v7
    v_mfma_f32_16x16x32_bf16 v[116:119], v[224:227], v[208:211], v[116:119]
    ds_read_b128 v[188:191], v1 offset:41984
    buffer_store_dwordx4 v[80:83], v1, s[4:7], s46 offen offset:0 sc1
    v_mfma_f32_16x16x32_bf16 v[120:123], v[228:231], v[204:207], v[120:123]
    ds_read_b128 v[192:195], v1 offset:43008
    v_mul_f32 v5, v5, v4
    v_mfma_f32_16x16x32_bf16 v[124:127], v[228:231], v[208:211], v[124:127]
    ds_read_b128 v[196:199], v1 offset:44032
    v_mul_f32 v7, v7, v6
    v_mfma_f32_16x16x32_bf16 v[128:131], v[232:235], v[204:207], v[128:131]
    ds_read_b128 v[200:203], v1 offset:45056
    v_bfe_u32 v13, v1, 4, 4
    v_mfma_f32_16x16x32_bf16 v[132:135], v[232:235], v[208:211], v[132:135]
    v_lshrrev_b32 v8, 1, v13
    v_lshrrev_b32 v9, 8, v1
    v_mfma_f32_16x16x32_bf16 v[136:139], v[236:239], v[204:207], v[136:139]
    v_xor_b32 v8, v8, v9
    v_lshlrev_b32 v8, 4, v8
    v_mfma_f32_16x16x32_bf16 v[140:143], v[236:239], v[208:211], v[140:143]
    v_lshl_add_u32 v8, v13, 7, v8
    s_add_u32 s33, s30, 18432
    v_mfma_f32_16x16x32_bf16 v[144:147], v[240:243], v[204:207], v[144:147]
    v_add_u32 v8, s33, v8
    v_xor_b32 v9, 64, v8
    v_mfma_f32_16x16x32_bf16 v[148:151], v[240:243], v[208:211], v[148:151]
    v_add_u32 v10, 73728, v8
    v_add_u32 v11, 73728, v9
    v_mfma_f32_16x16x32_bf16 v[152:155], v[244:247], v[204:207], v[152:155]
    s_lshl_b32 s33, s20, 6
    s_add_u32 s33, s33, 161280
    v_mfma_f32_16x16x32_bf16 v[156:159], v[244:247], v[208:211], v[156:159]
    v_lshl_add_u32 v13, v13, 1, s33
    s_waitcnt lgkmcnt(5)
    v_mfma_f32_16x16x32_bf16 v[88:91], v[168:171], v[160:163], v[88:91]
    ds_read_b128 v[204:207], v3 offset:37888
    v_mfma_f32_16x16x32_bf16 v[92:95], v[168:171], v[164:167], v[92:95]
    ds_read_b128 v[208:211], v3 offset:39936
    v_mfma_f32_16x16x32_bf16 v[96:99], v[172:175], v[160:163], v[96:99]
    ds_read_b128 v[212:215], v1 offset:46080
    v_mfma_f32_16x16x32_bf16 v[100:103], v[172:175], v[164:167], v[100:103]
    ds_read_b128 v[216:219], v1 offset:47104
    v_mfma_f32_16x16x32_bf16 v[104:107], v[176:179], v[160:163], v[104:107]
    ds_read_b128 v[220:223], v1 offset:48128
    v_mfma_f32_16x16x32_bf16 v[108:111], v[176:179], v[164:167], v[108:111]
    ds_read_b128 v[224:227], v1 offset:49152
    v_mfma_f32_16x16x32_bf16 v[112:115], v[180:183], v[160:163], v[112:115]
    ds_read_b128 v[228:231], v1 offset:50176
    v_mfma_f32_16x16x32_bf16 v[116:119], v[180:183], v[164:167], v[116:119]
    ds_read_b128 v[232:235], v1 offset:51200
    s_waitcnt lgkmcnt(8)
    v_mfma_f32_16x16x32_bf16 v[120:123], v[184:187], v[160:163], v[120:123]
    ds_read_b128 v[236:239], v1 offset:52224
    v_mfma_f32_16x16x32_bf16 v[124:127], v[184:187], v[164:167], v[124:127]
    ds_read_b128 v[240:243], v1 offset:53248
    v_mfma_f32_16x16x32_bf16 v[128:131], v[188:191], v[160:163], v[128:131]
    ds_read_b128 v[244:247], v1 offset:54272
    v_mfma_f32_16x16x32_bf16 v[132:135], v[188:191], v[164:167], v[132:135]
    v_mfma_f32_16x16x32_bf16 v[136:139], v[192:195], v[160:163], v[136:139]
    v_lshrrev_b32 v0, 4, v1
    v_mfma_f32_16x16x32_bf16 v[140:143], v[192:195], v[164:167], v[140:143]
    v_and_b32 v0, 48, v0
    v_mfma_f32_16x16x32_bf16 v[144:147], v[196:199], v[160:163], v[144:147]
    v_add_u32 v0, 160320, v0
    v_mfma_f32_16x16x32_bf16 v[148:151], v[196:199], v[164:167], v[148:151]
    v_mfma_f32_16x16x32_bf16 v[152:155], v[200:203], v[160:163], v[152:155]
    v_mfma_f32_16x16x32_bf16 v[156:159], v[200:203], v[164:167], v[156:159]
    s_waitcnt lgkmcnt(0)
    v_mfma_f32_16x16x32_bf16 v[88:91], v[212:215], v[204:207], v[88:91]
    ds_read_b128 v[168:171], v0 offset:0
    v_mfma_f32_16x16x32_bf16 v[92:95], v[212:215], v[208:211], v[92:95]
    ds_read_b128 v[172:175], v0 offset:64
    v_mfma_f32_16x16x32_bf16 v[96:99], v[216:219], v[204:207], v[96:99]
    ds_read_b128 v[176:179], v0 offset:128
    v_mfma_f32_16x16x32_bf16 v[100:103], v[216:219], v[208:211], v[100:103]
    ds_read_b128 v[180:183], v0 offset:192
    v_mfma_f32_16x16x32_bf16 v[104:107], v[220:223], v[204:207], v[104:107]
    ds_read_b128 v[184:187], v0 offset:256
    v_mfma_f32_16x16x32_bf16 v[108:111], v[220:223], v[208:211], v[108:111]
    ds_read_b128 v[188:191], v0 offset:320
    v_mfma_f32_16x16x32_bf16 v[112:115], v[224:227], v[204:207], v[112:115]
    ds_read_b128 v[192:195], v0 offset:384
    v_mfma_f32_16x16x32_bf16 v[116:119], v[224:227], v[208:211], v[116:119]
    ds_read_b128 v[196:199], v0 offset:448
    v_mfma_f32_16x16x32_bf16 v[120:123], v[228:231], v[204:207], v[120:123]
    ds_read_b128 v[200:203], v0 offset:512
    v_mfma_f32_16x16x32_bf16 v[124:127], v[228:231], v[208:211], v[124:127]
    ds_read_u16 v12, v13
    v_mfma_f32_16x16x32_bf16 v[128:131], v[232:235], v[204:207], v[128:131]
    ds_read_u16 v252, v13 offset:32
    v_mfma_f32_16x16x32_bf16 v[132:135], v[232:235], v[208:211], v[132:135]
    v_mfma_f32_16x16x32_bf16 v[136:139], v[236:239], v[204:207], v[136:139]
    s_lshr_b32 s35, s20, 1
    s_mul_i32 s35, s35, 36864
    v_mfma_f32_16x16x32_bf16 v[140:143], v[236:239], v[208:211], v[140:143]
    s_and_b32 s34, s20, 1
    s_mul_i32 s34, s34, 9216
    v_mfma_f32_16x16x32_bf16 v[144:147], v[240:243], v[204:207], v[144:147]
    s_add_u32 s35, s35, s34
    v_mfma_f32_16x16x32_bf16 v[148:151], v[240:243], v[208:211], v[148:151]
    v_add_u32 v3, s35, v2
    v_mfma_f32_16x16x32_bf16 v[152:155], v[244:247], v[204:207], v[152:155]
    v_mfma_f32_16x16x32_bf16 v[156:159], v[244:247], v[208:211], v[156:159]
    s_waitcnt vmcnt(0)
    s_barrier
    s_waitcnt lgkmcnt(0)
    v_lshlrev_b32 v15, 16, v12
    v_lshlrev_b32 v255, 16, v252
    v_lshlrev_b32 v14, 16, v12
    v_lshlrev_b32 v254, 16, v252
    v_lshlrev_b32 v13, 16, v12
    v_lshlrev_b32 v253, 16, v252
    v_lshlrev_b32 v12, 16, v12
    v_lshlrev_b32 v252, 16, v252
    ds_write_b128 v3, v[16:19] offset:0
    v_pk_fma_f32 v[88:89], v[248:249], v[168:169], v[88:89] op_sel_hi:[0,1,1] neg_lo:[1,0,0] neg_hi:[1,0,0]
    v_pk_fma_f32 v[90:91], v[248:249], v[170:171], v[90:91] op_sel_hi:[0,1,1] neg_lo:[1,0,0] neg_hi:[1,0,0]
    v_pk_fma_f32 v[92:93], v[250:251], v[168:169], v[92:93] op_sel_hi:[0,1,1] neg_lo:[1,0,0] neg_hi:[1,0,0]
    v_pk_fma_f32 v[94:95], v[250:251], v[170:171], v[94:95] op_sel_hi:[0,1,1] neg_lo:[1,0,0] neg_hi:[1,0,0]
    ds_write_b128 v3, v[24:27] offset:1024
    v_pk_fma_f32 v[96:97], v[248:249], v[172:173], v[96:97] op_sel_hi:[0,1,1] neg_lo:[1,0,0] neg_hi:[1,0,0]
    v_pk_fma_f32 v[98:99], v[248:249], v[174:175], v[98:99] op_sel_hi:[0,1,1] neg_lo:[1,0,0] neg_hi:[1,0,0]
    v_pk_fma_f32 v[100:101], v[250:251], v[172:173], v[100:101] op_sel_hi:[0,1,1] neg_lo:[1,0,0] neg_hi:[1,0,0]
    v_pk_fma_f32 v[102:103], v[250:251], v[174:175], v[102:103] op_sel_hi:[0,1,1] neg_lo:[1,0,0] neg_hi:[1,0,0]
    ds_write_b128 v3, v[32:35] offset:2048
    v_pk_fma_f32 v[104:105], v[248:249], v[176:177], v[104:105] op_sel_hi:[0,1,1] neg_lo:[1,0,0] neg_hi:[1,0,0]
    v_pk_fma_f32 v[106:107], v[248:249], v[178:179], v[106:107] op_sel_hi:[0,1,1] neg_lo:[1,0,0] neg_hi:[1,0,0]
    v_pk_fma_f32 v[108:109], v[250:251], v[176:177], v[108:109] op_sel_hi:[0,1,1] neg_lo:[1,0,0] neg_hi:[1,0,0]
    v_pk_fma_f32 v[110:111], v[250:251], v[178:179], v[110:111] op_sel_hi:[0,1,1] neg_lo:[1,0,0] neg_hi:[1,0,0]
    ds_write_b128 v3, v[40:43] offset:3072
    v_pk_fma_f32 v[112:113], v[248:249], v[180:181], v[112:113] op_sel_hi:[0,1,1] neg_lo:[1,0,0] neg_hi:[1,0,0]
    v_pk_fma_f32 v[114:115], v[248:249], v[182:183], v[114:115] op_sel_hi:[0,1,1] neg_lo:[1,0,0] neg_hi:[1,0,0]
    v_pk_fma_f32 v[116:117], v[250:251], v[180:181], v[116:117] op_sel_hi:[0,1,1] neg_lo:[1,0,0] neg_hi:[1,0,0]
    v_pk_fma_f32 v[118:119], v[250:251], v[182:183], v[118:119] op_sel_hi:[0,1,1] neg_lo:[1,0,0] neg_hi:[1,0,0]
    ds_write_b128 v3, v[48:51] offset:4096
    v_pk_fma_f32 v[120:121], v[248:249], v[184:185], v[120:121] op_sel_hi:[0,1,1] neg_lo:[1,0,0] neg_hi:[1,0,0]
    v_pk_fma_f32 v[122:123], v[248:249], v[186:187], v[122:123] op_sel_hi:[0,1,1] neg_lo:[1,0,0] neg_hi:[1,0,0]
    v_pk_fma_f32 v[124:125], v[250:251], v[184:185], v[124:125] op_sel_hi:[0,1,1] neg_lo:[1,0,0] neg_hi:[1,0,0]
    v_pk_fma_f32 v[126:127], v[250:251], v[186:187], v[126:127] op_sel_hi:[0,1,1] neg_lo:[1,0,0] neg_hi:[1,0,0]
    ds_write_b128 v3, v[56:59] offset:5120
    v_pk_fma_f32 v[128:129], v[248:249], v[188:189], v[128:129] op_sel_hi:[0,1,1] neg_lo:[1,0,0] neg_hi:[1,0,0]
    v_pk_fma_f32 v[130:131], v[248:249], v[190:191], v[130:131] op_sel_hi:[0,1,1] neg_lo:[1,0,0] neg_hi:[1,0,0]
    v_pk_fma_f32 v[132:133], v[250:251], v[188:189], v[132:133] op_sel_hi:[0,1,1] neg_lo:[1,0,0] neg_hi:[1,0,0]
    v_pk_fma_f32 v[134:135], v[250:251], v[190:191], v[134:135] op_sel_hi:[0,1,1] neg_lo:[1,0,0] neg_hi:[1,0,0]
    ds_write_b128 v3, v[64:67] offset:6144
    v_pk_fma_f32 v[136:137], v[248:249], v[192:193], v[136:137] op_sel_hi:[0,1,1] neg_lo:[1,0,0] neg_hi:[1,0,0]
    v_pk_fma_f32 v[138:139], v[248:249], v[194:195], v[138:139] op_sel_hi:[0,1,1] neg_lo:[1,0,0] neg_hi:[1,0,0]
    v_pk_fma_f32 v[140:141], v[250:251], v[192:193], v[140:141] op_sel_hi:[0,1,1] neg_lo:[1,0,0] neg_hi:[1,0,0]
    v_pk_fma_f32 v[142:143], v[250:251], v[194:195], v[142:143] op_sel_hi:[0,1,1] neg_lo:[1,0,0] neg_hi:[1,0,0]
    ds_write_b128 v3, v[72:75] offset:7168
    v_pk_fma_f32 v[144:145], v[248:249], v[196:197], v[144:145] op_sel_hi:[0,1,1] neg_lo:[1,0,0] neg_hi:[1,0,0]
    v_pk_fma_f32 v[146:147], v[248:249], v[198:199], v[146:147] op_sel_hi:[0,1,1] neg_lo:[1,0,0] neg_hi:[1,0,0]
    v_pk_fma_f32 v[148:149], v[250:251], v[196:197], v[148:149] op_sel_hi:[0,1,1] neg_lo:[1,0,0] neg_hi:[1,0,0]
    v_pk_fma_f32 v[150:151], v[250:251], v[198:199], v[150:151] op_sel_hi:[0,1,1] neg_lo:[1,0,0] neg_hi:[1,0,0]
    ds_write_b128 v3, v[80:83] offset:8192
    v_pk_fma_f32 v[152:153], v[248:249], v[200:201], v[152:153] op_sel_hi:[0,1,1] neg_lo:[1,0,0] neg_hi:[1,0,0]
    v_pk_fma_f32 v[154:155], v[248:249], v[202:203], v[154:155] op_sel_hi:[0,1,1] neg_lo:[1,0,0] neg_hi:[1,0,0]
    v_pk_fma_f32 v[156:157], v[250:251], v[200:201], v[156:157] op_sel_hi:[0,1,1] neg_lo:[1,0,0] neg_hi:[1,0,0]
    v_pk_fma_f32 v[158:159], v[250:251], v[202:203], v[158:159] op_sel_hi:[0,1,1] neg_lo:[1,0,0] neg_hi:[1,0,0]
    v_pk_mul_f32 v[204:205], v[88:89], v[88:89]
    v_pk_mul_f32 v[206:207], v[90:91], v[90:91]
    v_pk_mul_f32 v[208:209], v[92:93], v[92:93]
    v_pk_mul_f32 v[210:211], v[94:95], v[94:95]
    v_pk_fma_f32 v[204:205], v[204:205], v[4:5], v[4:5] op_sel:[0,1,0] op_sel_hi:[1,1,0]
    v_pk_fma_f32 v[206:207], v[206:207], v[4:5], v[4:5] op_sel:[0,1,0] op_sel_hi:[1,1,0]
    v_pk_fma_f32 v[208:209], v[208:209], v[6:7], v[6:7] op_sel:[0,1,0] op_sel_hi:[1,1,0]
    v_pk_fma_f32 v[210:211], v[210:211], v[6:7], v[6:7] op_sel:[0,1,0] op_sel_hi:[1,1,0]
    v_pk_mul_f32 v[204:205], v[204:205], v[88:89]
    v_pk_mul_f32 v[206:207], v[206:207], v[90:91]
    v_pk_mul_f32 v[208:209], v[208:209], v[92:93]
    v_pk_mul_f32 v[210:211], v[210:211], v[94:95]
    v_exp_f32 v204, v204
    v_exp_f32 v205, v205
    v_exp_f32 v206, v206
    v_exp_f32 v207, v207
    v_exp_f32 v208, v208
    v_exp_f32 v209, v209
    v_exp_f32 v210, v210
    v_exp_f32 v211, v211
    v_pk_fma_f32 v[204:205], v[204:205], v[248:249], v[248:249] op_sel:[0,1,1] op_sel_hi:[1,1,1]
    v_pk_fma_f32 v[206:207], v[206:207], v[248:249], v[248:249] op_sel:[0,1,1] op_sel_hi:[1,1,1]
    v_pk_fma_f32 v[208:209], v[208:209], v[250:251], v[250:251] op_sel:[0,1,1] op_sel_hi:[1,1,1]
    v_pk_fma_f32 v[210:211], v[210:211], v[250:251], v[250:251] op_sel:[0,1,1] op_sel_hi:[1,1,1]
    v_rcp_f32 v204, v204
    v_rcp_f32 v205, v205
    v_rcp_f32 v206, v206
    v_rcp_f32 v207, v207
    v_rcp_f32 v208, v208
    v_rcp_f32 v209, v209
    v_rcp_f32 v210, v210
    v_rcp_f32 v211, v211
    v_pk_mul_f32 v[88:89], v[88:89], v[204:205]
    v_pk_mul_f32 v[90:91], v[90:91], v[206:207]
    v_pk_mul_f32 v[92:93], v[92:93], v[208:209]
    v_pk_mul_f32 v[94:95], v[94:95], v[210:211]
    v_pk_mul_f32 v[212:213], v[96:97], v[96:97]
    v_pk_mul_f32 v[214:215], v[98:99], v[98:99]
    v_pk_mul_f32 v[216:217], v[100:101], v[100:101]
    v_pk_mul_f32 v[218:219], v[102:103], v[102:103]
    v_pk_fma_f32 v[212:213], v[212:213], v[4:5], v[4:5] op_sel:[0,1,0] op_sel_hi:[1,1,0]
    v_pk_fma_f32 v[214:215], v[214:215], v[4:5], v[4:5] op_sel:[0,1,0] op_sel_hi:[1,1,0]
    v_pk_fma_f32 v[216:217], v[216:217], v[6:7], v[6:7] op_sel:[0,1,0] op_sel_hi:[1,1,0]
    v_pk_fma_f32 v[218:219], v[218:219], v[6:7], v[6:7] op_sel:[0,1,0] op_sel_hi:[1,1,0]
    v_pk_mul_f32 v[212:213], v[212:213], v[96:97]
    v_pk_mul_f32 v[214:215], v[214:215], v[98:99]
    v_pk_mul_f32 v[216:217], v[216:217], v[100:101]
    v_pk_mul_f32 v[218:219], v[218:219], v[102:103]
    v_exp_f32 v212, v212
    v_exp_f32 v213, v213
    v_exp_f32 v214, v214
    v_exp_f32 v215, v215
    v_exp_f32 v216, v216
    v_exp_f32 v217, v217
    v_exp_f32 v218, v218
    v_exp_f32 v219, v219
    v_pk_fma_f32 v[212:213], v[212:213], v[248:249], v[248:249] op_sel:[0,1,1] op_sel_hi:[1,1,1]
    v_pk_fma_f32 v[214:215], v[214:215], v[248:249], v[248:249] op_sel:[0,1,1] op_sel_hi:[1,1,1]
    v_pk_fma_f32 v[216:217], v[216:217], v[250:251], v[250:251] op_sel:[0,1,1] op_sel_hi:[1,1,1]
    v_pk_fma_f32 v[218:219], v[218:219], v[250:251], v[250:251] op_sel:[0,1,1] op_sel_hi:[1,1,1]
    v_rcp_f32 v212, v212
    v_rcp_f32 v213, v213
    v_rcp_f32 v214, v214
    v_rcp_f32 v215, v215
    v_rcp_f32 v216, v216
    v_rcp_f32 v217, v217
    v_rcp_f32 v218, v218
    v_rcp_f32 v219, v219
    v_pk_mul_f32 v[96:97], v[96:97], v[212:213]
    v_pk_mul_f32 v[98:99], v[98:99], v[214:215]
    v_pk_mul_f32 v[100:101], v[100:101], v[216:217]
    v_pk_mul_f32 v[102:103], v[102:103], v[218:219]
    v_pk_mul_f32 v[204:205], v[104:105], v[104:105]
    v_pk_mul_f32 v[206:207], v[106:107], v[106:107]
    v_pk_mul_f32 v[208:209], v[108:109], v[108:109]
    v_pk_mul_f32 v[210:211], v[110:111], v[110:111]
    v_pk_fma_f32 v[204:205], v[204:205], v[4:5], v[4:5] op_sel:[0,1,0] op_sel_hi:[1,1,0]
    v_pk_fma_f32 v[206:207], v[206:207], v[4:5], v[4:5] op_sel:[0,1,0] op_sel_hi:[1,1,0]
    v_pk_fma_f32 v[208:209], v[208:209], v[6:7], v[6:7] op_sel:[0,1,0] op_sel_hi:[1,1,0]
    v_pk_fma_f32 v[210:211], v[210:211], v[6:7], v[6:7] op_sel:[0,1,0] op_sel_hi:[1,1,0]
    v_pk_mul_f32 v[204:205], v[204:205], v[104:105]
    v_pk_mul_f32 v[206:207], v[206:207], v[106:107]
    v_pk_mul_f32 v[208:209], v[208:209], v[108:109]
    v_pk_mul_f32 v[210:211], v[210:211], v[110:111]
    v_exp_f32 v204, v204
    v_exp_f32 v205, v205
    v_exp_f32 v206, v206
    v_exp_f32 v207, v207
    v_exp_f32 v208, v208
    v_exp_f32 v209, v209
    v_exp_f32 v210, v210
    v_exp_f32 v211, v211
    v_pk_fma_f32 v[204:205], v[204:205], v[248:249], v[248:249] op_sel:[0,1,1] op_sel_hi:[1,1,1]
    v_pk_fma_f32 v[206:207], v[206:207], v[248:249], v[248:249] op_sel:[0,1,1] op_sel_hi:[1,1,1]
    v_pk_fma_f32 v[208:209], v[208:209], v[250:251], v[250:251] op_sel:[0,1,1] op_sel_hi:[1,1,1]
    v_pk_fma_f32 v[210:211], v[210:211], v[250:251], v[250:251] op_sel:[0,1,1] op_sel_hi:[1,1,1]
    v_rcp_f32 v204, v204
    v_rcp_f32 v205, v205
    v_rcp_f32 v206, v206
    v_rcp_f32 v207, v207
    v_rcp_f32 v208, v208
    v_rcp_f32 v209, v209
    v_rcp_f32 v210, v210
    v_rcp_f32 v211, v211
    v_pk_mul_f32 v[104:105], v[104:105], v[204:205]
    v_pk_mul_f32 v[106:107], v[106:107], v[206:207]
    v_pk_mul_f32 v[108:109], v[108:109], v[208:209]
    v_pk_mul_f32 v[110:111], v[110:111], v[210:211]
    s_waitcnt lgkmcnt(0)
    s_barrier
    ds_read_b128 v[160:163], v10 offset:0
    ds_read_b128 v[164:167], v10 offset:2048
    ds_read_b128 v[168:171], v2 offset:0
    ds_read_b128 v[172:175], v2 offset:1024
    ds_read_b128 v[176:179], v2 offset:2048
    ds_read_b128 v[180:183], v2 offset:3072
    ds_read_b128 v[184:187], v2 offset:4096
    ds_read_b128 v[188:191], v2 offset:5120
    ds_read_b128 v[192:195], v2 offset:6144
    ds_read_b128 v[196:199], v2 offset:7168
    ds_read_b128 v[200:203], v2 offset:8192
    v_pk_mul_f32 v[212:213], v[112:113], v[112:113]
    v_pk_mul_f32 v[214:215], v[114:115], v[114:115]
    v_pk_mul_f32 v[216:217], v[116:117], v[116:117]
    v_pk_mul_f32 v[218:219], v[118:119], v[118:119]
    v_pk_fma_f32 v[212:213], v[212:213], v[4:5], v[4:5] op_sel:[0,1,0] op_sel_hi:[1,1,0]
    v_pk_fma_f32 v[214:215], v[214:215], v[4:5], v[4:5] op_sel:[0,1,0] op_sel_hi:[1,1,0]
    v_pk_fma_f32 v[216:217], v[216:217], v[6:7], v[6:7] op_sel:[0,1,0] op_sel_hi:[1,1,0]
    v_pk_fma_f32 v[218:219], v[218:219], v[6:7], v[6:7] op_sel:[0,1,0] op_sel_hi:[1,1,0]
    v_pk_mul_f32 v[212:213], v[212:213], v[112:113]
    v_pk_mul_f32 v[214:215], v[214:215], v[114:115]
    v_pk_mul_f32 v[216:217], v[216:217], v[116:117]
    v_pk_mul_f32 v[218:219], v[218:219], v[118:119]
    v_exp_f32 v212, v212
    v_exp_f32 v213, v213
    v_exp_f32 v214, v214
    v_exp_f32 v215, v215
    v_exp_f32 v216, v216
    v_exp_f32 v217, v217
    v_exp_f32 v218, v218
    v_exp_f32 v219, v219
    v_pk_fma_f32 v[212:213], v[212:213], v[248:249], v[248:249] op_sel:[0,1,1] op_sel_hi:[1,1,1]
    v_pk_fma_f32 v[214:215], v[214:215], v[248:249], v[248:249] op_sel:[0,1,1] op_sel_hi:[1,1,1]
    v_pk_fma_f32 v[216:217], v[216:217], v[250:251], v[250:251] op_sel:[0,1,1] op_sel_hi:[1,1,1]
    v_pk_fma_f32 v[218:219], v[218:219], v[250:251], v[250:251] op_sel:[0,1,1] op_sel_hi:[1,1,1]
    v_rcp_f32 v212, v212
    v_rcp_f32 v213, v213
    v_rcp_f32 v214, v214
    v_rcp_f32 v215, v215
    v_rcp_f32 v216, v216
    v_rcp_f32 v217, v217
    v_rcp_f32 v218, v218
    v_rcp_f32 v219, v219
    v_pk_mul_f32 v[112:113], v[112:113], v[212:213]
    v_pk_mul_f32 v[114:115], v[114:115], v[214:215]
    v_pk_mul_f32 v[116:117], v[116:117], v[216:217]
    v_pk_mul_f32 v[118:119], v[118:119], v[218:219]
    s_waitcnt lgkmcnt(5)
    v_mfma_f32_16x16x32_bf16 v[16:19], v[168:171], v[160:163], v[12:15]
    ds_read_b128 v[204:207], v11 offset:0
    v_mfma_f32_16x16x32_bf16 v[20:23], v[168:171], v[164:167], v[252:255]
    ds_read_b128 v[208:211], v11 offset:2048
    v_mfma_f32_16x16x32_bf16 v[24:27], v[172:175], v[160:163], v[12:15]
    ds_read_b128 v[212:215], v2 offset:9216
    v_mfma_f32_16x16x32_bf16 v[28:31], v[172:175], v[164:167], v[252:255]
    ds_read_b128 v[216:219], v2 offset:10240
    v_mfma_f32_16x16x32_bf16 v[32:35], v[176:179], v[160:163], v[12:15]
    ds_read_b128 v[220:223], v2 offset:11264
    v_mfma_f32_16x16x32_bf16 v[36:39], v[176:179], v[164:167], v[252:255]
    ds_read_b128 v[224:227], v2 offset:12288
    v_mfma_f32_16x16x32_bf16 v[40:43], v[180:183], v[160:163], v[12:15]
    ds_read_b128 v[228:231], v2 offset:13312
    v_mfma_f32_16x16x32_bf16 v[44:47], v[180:183], v[164:167], v[252:255]
    ds_read_b128 v[232:235], v2 offset:14336
    s_waitcnt lgkmcnt(8)
    v_mfma_f32_16x16x32_bf16 v[48:51], v[184:187], v[160:163], v[12:15]
    ds_read_b128 v[236:239], v2 offset:15360
    v_mfma_f32_16x16x32_bf16 v[52:55], v[184:187], v[164:167], v[252:255]
    ds_read_b128 v[240:243], v2 offset:16384
    v_mfma_f32_16x16x32_bf16 v[56:59], v[188:191], v[160:163], v[12:15]
    ds_read_b128 v[244:247], v2 offset:17408
    v_mfma_f32_16x16x32_bf16 v[60:63], v[188:191], v[164:167], v[252:255]
    v_mfma_f32_16x16x32_bf16 v[64:67], v[192:195], v[160:163], v[12:15]
    v_mfma_f32_16x16x32_bf16 v[68:71], v[192:195], v[164:167], v[252:255]
    v_mfma_f32_16x16x32_bf16 v[72:75], v[196:199], v[160:163], v[12:15]
    v_mfma_f32_16x16x32_bf16 v[76:79], v[196:199], v[164:167], v[252:255]
    v_mfma_f32_16x16x32_bf16 v[80:83], v[200:203], v[160:163], v[12:15]
    v_mfma_f32_16x16x32_bf16 v[84:87], v[200:203], v[164:167], v[252:255]
    s_waitcnt lgkmcnt(0)
    s_barrier
    v_mfma_f32_16x16x32_bf16 v[16:19], v[212:215], v[204:207], v[16:19]
    ds_read_b128 v[160:163], v10 offset:36864
    v_mfma_f32_16x16x32_bf16 v[20:23], v[212:215], v[208:211], v[20:23]
    ds_read_b128 v[164:167], v10 offset:38912
    v_mfma_f32_16x16x32_bf16 v[24:27], v[216:219], v[204:207], v[24:27]
    ds_read_b128 v[168:171], v2 offset:36864
    v_mfma_f32_16x16x32_bf16 v[28:31], v[216:219], v[208:211], v[28:31]
    ds_read_b128 v[172:175], v2 offset:37888
    v_mul_f32 v12, v120, v120
    v_mfma_f32_16x16x32_bf16 v[32:35], v[220:223], v[204:207], v[32:35]
    ds_read_b128 v[176:179], v2 offset:38912
    v_mul_f32 v13, v121, v121
    v_mfma_f32_16x16x32_bf16 v[36:39], v[220:223], v[208:211], v[36:39]
    ds_read_b128 v[180:183], v2 offset:39936
    v_mul_f32 v14, v122, v122
    v_mfma_f32_16x16x32_bf16 v[40:43], v[224:227], v[204:207], v[40:43]
    ds_read_b128 v[184:187], v2 offset:40960
    v_mul_f32 v15, v123, v123
    v_mfma_f32_16x16x32_bf16 v[44:47], v[224:227], v[208:211], v[44:47]
    ds_read_b128 v[188:191], v2 offset:41984
    v_mfma_f32_16x16x32_bf16 v[48:51], v[228:231], v[204:207], v[48:51]
    ds_read_b128 v[192:195], v2 offset:43008
    v_mul_f32 v252, v124, v124
    v_mfma_f32_16x16x32_bf16 v[52:55], v[228:231], v[208:211], v[52:55]
    ds_read_b128 v[196:199], v2 offset:44032
    v_mul_f32 v253, v125, v125
    v_mfma_f32_16x16x32_bf16 v[56:59], v[232:235], v[204:207], v[56:59]
    ds_read_b128 v[200:203], v2 offset:45056
    v_mul_f32 v254, v126, v126
    v_mfma_f32_16x16x32_bf16 v[60:63], v[232:235], v[208:211], v[60:63]
    v_mul_f32 v255, v127, v127
    v_fma_f32 v12, v12, v5, v4
    v_mfma_f32_16x16x32_bf16 v[64:67], v[236:239], v[204:207], v[64:67]
    v_fma_f32 v13, v13, v5, v4
    v_fma_f32 v14, v14, v5, v4
    v_mfma_f32_16x16x32_bf16 v[68:71], v[236:239], v[208:211], v[68:71]
    v_fma_f32 v15, v15, v5, v4
    v_fma_f32 v252, v252, v7, v6
    v_mfma_f32_16x16x32_bf16 v[72:75], v[240:243], v[204:207], v[72:75]
    v_fma_f32 v253, v253, v7, v6
    v_fma_f32 v254, v254, v7, v6
    v_mfma_f32_16x16x32_bf16 v[76:79], v[240:243], v[208:211], v[76:79]
    v_fma_f32 v255, v255, v7, v6
    v_mul_f32 v12, v12, v120
    v_mfma_f32_16x16x32_bf16 v[80:83], v[244:247], v[204:207], v[80:83]
    v_mul_f32 v13, v13, v121
    v_mul_f32 v14, v14, v122
    v_mfma_f32_16x16x32_bf16 v[84:87], v[244:247], v[208:211], v[84:87]
    v_mul_f32 v15, v15, v123
    s_waitcnt lgkmcnt(5)
    v_mfma_f32_16x16x32_bf16 v[16:19], v[168:171], v[160:163], v[16:19]
    ds_read_b128 v[204:207], v11 offset:36864
    v_mfma_f32_16x16x32_bf16 v[20:23], v[168:171], v[164:167], v[20:23]
    ds_read_b128 v[208:211], v11 offset:38912
    v_mul_f32 v252, v252, v124
    v_mfma_f32_16x16x32_bf16 v[24:27], v[172:175], v[160:163], v[24:27]
    ds_read_b128 v[212:215], v2 offset:46080
    v_mul_f32 v253, v253, v125
    v_mfma_f32_16x16x32_bf16 v[28:31], v[172:175], v[164:167], v[28:31]
    ds_read_b128 v[216:219], v2 offset:47104
    v_mul_f32 v254, v254, v126
    v_mfma_f32_16x16x32_bf16 v[32:35], v[176:179], v[160:163], v[32:35]
    ds_read_b128 v[220:223], v2 offset:48128
    v_mul_f32 v255, v255, v127
    v_mfma_f32_16x16x32_bf16 v[36:39], v[176:179], v[164:167], v[36:39]
    ds_read_b128 v[224:227], v2 offset:49152
    v_exp_f32 v12, v12
    v_mfma_f32_16x16x32_bf16 v[40:43], v[180:183], v[160:163], v[40:43]
    ds_read_b128 v[228:231], v2 offset:50176
    v_exp_f32 v13, v13
    v_mfma_f32_16x16x32_bf16 v[44:47], v[180:183], v[164:167], v[44:47]
    ds_read_b128 v[232:235], v2 offset:51200
    s_waitcnt lgkmcnt(8)
    v_mfma_f32_16x16x32_bf16 v[48:51], v[184:187], v[160:163], v[48:51]
    ds_read_b128 v[236:239], v2 offset:52224
    v_exp_f32 v14, v14
    v_mfma_f32_16x16x32_bf16 v[52:55], v[184:187], v[164:167], v[52:55]
    ds_read_b128 v[240:243], v2 offset:53248
    v_exp_f32 v15, v15
    v_mfma_f32_16x16x32_bf16 v[56:59], v[188:191], v[160:163], v[56:59]
    ds_read_b128 v[244:247], v2 offset:54272
    v_exp_f32 v252, v252
    v_mfma_f32_16x16x32_bf16 v[60:63], v[188:191], v[164:167], v[60:63]
    v_exp_f32 v253, v253
    v_mfma_f32_16x16x32_bf16 v[64:67], v[192:195], v[160:163], v[64:67]
    v_exp_f32 v254, v254
    v_mfma_f32_16x16x32_bf16 v[68:71], v[192:195], v[164:167], v[68:71]
    v_exp_f32 v255, v255
    v_mfma_f32_16x16x32_bf16 v[72:75], v[196:199], v[160:163], v[72:75]
    v_fma_f32 v12, v12, v249, v249
    v_fma_f32 v13, v13, v249, v249
    v_mfma_f32_16x16x32_bf16 v[76:79], v[196:199], v[164:167], v[76:79]
    v_fma_f32 v14, v14, v249, v249
    v_fma_f32 v15, v15, v249, v249
    v_mfma_f32_16x16x32_bf16 v[80:83], v[200:203], v[160:163], v[80:83]
    v_fma_f32 v252, v252, v251, v251
    v_fma_f32 v253, v253, v251, v251
    v_mfma_f32_16x16x32_bf16 v[84:87], v[200:203], v[164:167], v[84:87]
    v_fma_f32 v254, v254, v251, v251
    s_waitcnt lgkmcnt(0)
    s_barrier
    v_mfma_f32_16x16x32_bf16 v[16:19], v[212:215], v[204:207], v[16:19]
    ds_read_b128 v[160:163], v8 offset:0
    v_mfma_f32_16x16x32_bf16 v[20:23], v[212:215], v[208:211], v[20:23]
    ds_read_b128 v[164:167], v8 offset:2048
    v_fma_f32 v255, v255, v251, v251
    v_mfma_f32_16x16x32_bf16 v[24:27], v[216:219], v[204:207], v[24:27]
    ds_read_b128 v[168:171], v1 offset:0
    v_rcp_f32 v12, v12
    v_mfma_f32_16x16x32_bf16 v[28:31], v[216:219], v[208:211], v[28:31]
    ds_read_b128 v[172:175], v1 offset:1024
    v_rcp_f32 v13, v13
    v_mfma_f32_16x16x32_bf16 v[32:35], v[220:223], v[204:207], v[32:35]
    ds_read_b128 v[176:179], v1 offset:2048
    v_rcp_f32 v14, v14
    v_mfma_f32_16x16x32_bf16 v[36:39], v[220:223], v[208:211], v[36:39]
    ds_read_b128 v[180:183], v1 offset:3072
    v_rcp_f32 v15, v15
    v_mfma_f32_16x16x32_bf16 v[40:43], v[224:227], v[204:207], v[40:43]
    ds_read_b128 v[184:187], v1 offset:4096
    v_rcp_f32 v252, v252
    v_mfma_f32_16x16x32_bf16 v[44:47], v[224:227], v[208:211], v[44:47]
    ds_read_b128 v[188:191], v1 offset:5120
    v_mfma_f32_16x16x32_bf16 v[48:51], v[228:231], v[204:207], v[48:51]
    ds_read_b128 v[192:195], v1 offset:6144
    v_rcp_f32 v253, v253
    v_mfma_f32_16x16x32_bf16 v[52:55], v[228:231], v[208:211], v[52:55]
    ds_read_b128 v[196:199], v1 offset:7168
    v_rcp_f32 v254, v254
    v_mfma_f32_16x16x32_bf16 v[56:59], v[232:235], v[204:207], v[56:59]
    ds_read_b128 v[200:203], v1 offset:8192
    v_rcp_f32 v255, v255
    v_mfma_f32_16x16x32_bf16 v[60:63], v[232:235], v[208:211], v[60:63]
    v_mul_f32 v120, v120, v12
    v_mul_f32 v121, v121, v13
    v_mfma_f32_16x16x32_bf16 v[64:67], v[236:239], v[204:207], v[64:67]
    v_mul_f32 v122, v122, v14
    v_mul_f32 v123, v123, v15
    v_mfma_f32_16x16x32_bf16 v[68:71], v[236:239], v[208:211], v[68:71]
    v_mul_f32 v124, v124, v252
    v_mul_f32 v125, v125, v253
    v_mfma_f32_16x16x32_bf16 v[72:75], v[240:243], v[204:207], v[72:75]
    v_mul_f32 v126, v126, v254
    v_mul_f32 v127, v127, v255
    v_mfma_f32_16x16x32_bf16 v[76:79], v[240:243], v[208:211], v[76:79]
    v_mul_f32 v12, v128, v128
    v_mul_f32 v13, v129, v129
    v_mfma_f32_16x16x32_bf16 v[80:83], v[244:247], v[204:207], v[80:83]
    v_mul_f32 v14, v130, v130
    v_mul_f32 v15, v131, v131
    v_mfma_f32_16x16x32_bf16 v[84:87], v[244:247], v[208:211], v[84:87]
    v_mul_f32 v252, v132, v132
    s_waitcnt lgkmcnt(5)
    v_mfma_f32_16x16x32_bf16 v[16:19], v[168:171], v[160:163], v[16:19]
    ds_read_b128 v[204:207], v9 offset:0
    v_mfma_f32_16x16x32_bf16 v[20:23], v[168:171], v[164:167], v[20:23]
    ds_read_b128 v[208:211], v9 offset:2048
    v_mul_f32 v253, v133, v133
    v_mfma_f32_16x16x32_bf16 v[24:27], v[172:175], v[160:163], v[24:27]
    ds_read_b128 v[212:215], v1 offset:9216
    v_mul_f32 v254, v134, v134
    v_mfma_f32_16x16x32_bf16 v[28:31], v[172:175], v[164:167], v[28:31]
    ds_read_b128 v[216:219], v1 offset:10240
    v_mul_f32 v255, v135, v135
    v_mfma_f32_16x16x32_bf16 v[32:35], v[176:179], v[160:163], v[32:35]
    ds_read_b128 v[220:223], v1 offset:11264
    v_fma_f32 v12, v12, v5, v4
    v_mfma_f32_16x16x32_bf16 v[36:39], v[176:179], v[164:167], v[36:39]
    ds_read_b128 v[224:227], v1 offset:12288
    v_fma_f32 v13, v13, v5, v4
    v_mfma_f32_16x16x32_bf16 v[40:43], v[180:183], v[160:163], v[40:43]
    ds_read_b128 v[228:231], v1 offset:13312
    v_fma_f32 v14, v14, v5, v4
    v_mfma_f32_16x16x32_bf16 v[44:47], v[180:183], v[164:167], v[44:47]
    ds_read_b128 v[232:235], v1 offset:14336
    s_waitcnt lgkmcnt(8)
    v_mfma_f32_16x16x32_bf16 v[48:51], v[184:187], v[160:163], v[48:51]
    ds_read_b128 v[236:239], v1 offset:15360
    v_fma_f32 v15, v15, v5, v4
    v_mfma_f32_16x16x32_bf16 v[52:55], v[184:187], v[164:167], v[52:55]
    ds_read_b128 v[240:243], v1 offset:16384
    v_fma_f32 v252, v252, v7, v6
    v_mfma_f32_16x16x32_bf16 v[56:59], v[188:191], v[160:163], v[56:59]
    ds_read_b128 v[244:247], v1 offset:17408
    v_fma_f32 v253, v253, v7, v6
    v_mfma_f32_16x16x32_bf16 v[60:63], v[188:191], v[164:167], v[60:63]
    v_fma_f32 v254, v254, v7, v6
    v_fma_f32 v255, v255, v7, v6
    v_mfma_f32_16x16x32_bf16 v[64:67], v[192:195], v[160:163], v[64:67]
    v_mul_f32 v12, v12, v128
    v_mul_f32 v13, v13, v129
    v_mfma_f32_16x16x32_bf16 v[68:71], v[192:195], v[164:167], v[68:71]
    v_mul_f32 v14, v14, v130
    v_mul_f32 v15, v15, v131
    v_mfma_f32_16x16x32_bf16 v[72:75], v[196:199], v[160:163], v[72:75]
    v_mul_f32 v252, v252, v132
    v_mul_f32 v253, v253, v133
    v_mfma_f32_16x16x32_bf16 v[76:79], v[196:199], v[164:167], v[76:79]
    v_mul_f32 v254, v254, v134
    v_mul_f32 v255, v255, v135
    v_mfma_f32_16x16x32_bf16 v[80:83], v[200:203], v[160:163], v[80:83]
    v_exp_f32 v12, v12
    v_mfma_f32_16x16x32_bf16 v[84:87], v[200:203], v[164:167], v[84:87]
    v_exp_f32 v13, v13
    s_waitcnt lgkmcnt(0)
    s_barrier
    v_mfma_f32_16x16x32_bf16 v[16:19], v[212:215], v[204:207], v[16:19]
    ds_read_b128 v[160:163], v8 offset:36864
    v_mfma_f32_16x16x32_bf16 v[20:23], v[212:215], v[208:211], v[20:23]
    ds_read_b128 v[164:167], v8 offset:38912
    v_exp_f32 v14, v14
    v_mfma_f32_16x16x32_bf16 v[24:27], v[216:219], v[204:207], v[24:27]
    ds_read_b128 v[168:171], v1 offset:36864
    v_exp_f32 v15, v15
    v_mfma_f32_16x16x32_bf16 v[28:31], v[216:219], v[208:211], v[28:31]
    ds_read_b128 v[172:175], v1 offset:37888
    v_exp_f32 v252, v252
    v_mfma_f32_16x16x32_bf16 v[32:35], v[220:223], v[204:207], v[32:35]
    ds_read_b128 v[176:179], v1 offset:38912
    v_exp_f32 v253, v253
    v_mfma_f32_16x16x32_bf16 v[36:39], v[220:223], v[208:211], v[36:39]
    ds_read_b128 v[180:183], v1 offset:39936
    v_exp_f32 v254, v254
    v_mfma_f32_16x16x32_bf16 v[40:43], v[224:227], v[204:207], v[40:43]
    ds_read_b128 v[184:187], v1 offset:40960
    v_exp_f32 v255, v255
    v_mfma_f32_16x16x32_bf16 v[44:47], v[224:227], v[208:211], v[44:47]
    ds_read_b128 v[188:191], v1 offset:41984
    v_mfma_f32_16x16x32_bf16 v[48:51], v[228:231], v[204:207], v[48:51]
    ds_read_b128 v[192:195], v1 offset:43008
    v_fma_f32 v12, v12, v249, v249
    v_mfma_f32_16x16x32_bf16 v[52:55], v[228:231], v[208:211], v[52:55]
    ds_read_b128 v[196:199], v1 offset:44032
    v_fma_f32 v13, v13, v249, v249
    v_mfma_f32_16x16x32_bf16 v[56:59], v[232:235], v[204:207], v[56:59]
    ds_read_b128 v[200:203], v1 offset:45056
    v_fma_f32 v14, v14, v249, v249
    v_mfma_f32_16x16x32_bf16 v[60:63], v[232:235], v[208:211], v[60:63]
    v_fma_f32 v15, v15, v249, v249
    v_fma_f32 v252, v252, v251, v251
    v_mfma_f32_16x16x32_bf16 v[64:67], v[236:239], v[204:207], v[64:67]
    v_fma_f32 v253, v253, v251, v251
    v_fma_f32 v254, v254, v251, v251
    v_mfma_f32_16x16x32_bf16 v[68:71], v[236:239], v[208:211], v[68:71]
    v_fma_f32 v255, v255, v251, v251
    v_rcp_f32 v12, v12
    v_mfma_f32_16x16x32_bf16 v[72:75], v[240:243], v[204:207], v[72:75]
    v_rcp_f32 v13, v13
    v_mfma_f32_16x16x32_bf16 v[76:79], v[240:243], v[208:211], v[76:79]
    v_rcp_f32 v14, v14
    v_mfma_f32_16x16x32_bf16 v[80:83], v[244:247], v[204:207], v[80:83]
    v_rcp_f32 v15, v15
    v_mfma_f32_16x16x32_bf16 v[84:87], v[244:247], v[208:211], v[84:87]
    v_rcp_f32 v252, v252
    s_waitcnt lgkmcnt(5)
    v_mfma_f32_16x16x32_bf16 v[16:19], v[168:171], v[160:163], v[16:19]
    ds_read_b128 v[204:207], v9 offset:36864
    v_mfma_f32_16x16x32_bf16 v[20:23], v[168:171], v[164:167], v[20:23]
    ds_read_b128 v[208:211], v9 offset:38912
    v_rcp_f32 v253, v253
    v_mfma_f32_16x16x32_bf16 v[24:27], v[172:175], v[160:163], v[24:27]
    ds_read_b128 v[212:215], v1 offset:46080
    v_rcp_f32 v254, v254
    v_mfma_f32_16x16x32_bf16 v[28:31], v[172:175], v[164:167], v[28:31]
    ds_read_b128 v[216:219], v1 offset:47104
    v_rcp_f32 v255, v255
    v_mfma_f32_16x16x32_bf16 v[32:35], v[176:179], v[160:163], v[32:35]
    ds_read_b128 v[220:223], v1 offset:48128
    v_mul_f32 v128, v128, v12
    v_mfma_f32_16x16x32_bf16 v[36:39], v[176:179], v[164:167], v[36:39]
    ds_read_b128 v[224:227], v1 offset:49152
    v_mul_f32 v129, v129, v13
    v_mfma_f32_16x16x32_bf16 v[40:43], v[180:183], v[160:163], v[40:43]
    ds_read_b128 v[228:231], v1 offset:50176
    v_mul_f32 v130, v130, v14
    v_mfma_f32_16x16x32_bf16 v[44:47], v[180:183], v[164:167], v[44:47]
    ds_read_b128 v[232:235], v1 offset:51200
    s_waitcnt lgkmcnt(8)
    v_mfma_f32_16x16x32_bf16 v[48:51], v[184:187], v[160:163], v[48:51]
    ds_read_b128 v[236:239], v1 offset:52224
    v_mul_f32 v131, v131, v15
    v_mfma_f32_16x16x32_bf16 v[52:55], v[184:187], v[164:167], v[52:55]
    ds_read_b128 v[240:243], v1 offset:53248
    v_mul_f32 v132, v132, v252
    v_mfma_f32_16x16x32_bf16 v[56:59], v[188:191], v[160:163], v[56:59]
    ds_read_b128 v[244:247], v1 offset:54272
    v_mul_f32 v133, v133, v253
    v_mfma_f32_16x16x32_bf16 v[60:63], v[188:191], v[164:167], v[60:63]
    v_mul_f32 v134, v134, v254
    v_mul_f32 v135, v135, v255
    v_mfma_f32_16x16x32_bf16 v[64:67], v[192:195], v[160:163], v[64:67]
    v_mul_f32 v12, v136, v136
    v_mul_f32 v13, v137, v137
    v_mfma_f32_16x16x32_bf16 v[68:71], v[192:195], v[164:167], v[68:71]
    v_mul_f32 v14, v138, v138
    v_mul_f32 v15, v139, v139
    v_mfma_f32_16x16x32_bf16 v[72:75], v[196:199], v[160:163], v[72:75]
    v_mul_f32 v252, v140, v140
    v_mul_f32 v253, v141, v141
    v_mfma_f32_16x16x32_bf16 v[76:79], v[196:199], v[164:167], v[76:79]
    v_mul_f32 v254, v142, v142
    v_mul_f32 v255, v143, v143
    v_mfma_f32_16x16x32_bf16 v[80:83], v[200:203], v[160:163], v[80:83]
    v_fma_f32 v12, v12, v5, v4
    v_fma_f32 v13, v13, v5, v4
    v_mfma_f32_16x16x32_bf16 v[84:87], v[200:203], v[164:167], v[84:87]
    v_fma_f32 v14, v14, v5, v4
    s_waitcnt lgkmcnt(0)
    s_barrier
    v_mfma_f32_16x16x32_bf16 v[16:19], v[212:215], v[204:207], v[16:19]
    ds_read_b128 v[160:163], v10 offset:0
    v_mfma_f32_16x16x32_bf16 v[20:23], v[212:215], v[208:211], v[20:23]
    ds_read_b128 v[164:167], v10 offset:2048
    v_fma_f32 v15, v15, v5, v4
    v_mfma_f32_16x16x32_bf16 v[24:27], v[216:219], v[204:207], v[24:27]
    ds_read_b128 v[168:171], v2 offset:0
    v_fma_f32 v252, v252, v7, v6
    v_mfma_f32_16x16x32_bf16 v[28:31], v[216:219], v[208:211], v[28:31]
    ds_read_b128 v[172:175], v2 offset:1024
    v_fma_f32 v253, v253, v7, v6
    v_mfma_f32_16x16x32_bf16 v[32:35], v[220:223], v[204:207], v[32:35]
    ds_read_b128 v[176:179], v2 offset:2048
    v_fma_f32 v254, v254, v7, v6
    v_mfma_f32_16x16x32_bf16 v[36:39], v[220:223], v[208:211], v[36:39]
    ds_read_b128 v[180:183], v2 offset:3072
    v_fma_f32 v255, v255, v7, v6
    v_mfma_f32_16x16x32_bf16 v[40:43], v[224:227], v[204:207], v[40:43]
    ds_read_b128 v[184:187], v2 offset:4096
    v_mul_f32 v12, v12, v136
    v_mfma_f32_16x16x32_bf16 v[44:47], v[224:227], v[208:211], v[44:47]
    ds_read_b128 v[188:191], v2 offset:5120
    v_mfma_f32_16x16x32_bf16 v[48:51], v[228:231], v[204:207], v[48:51]
    ds_read_b128 v[192:195], v2 offset:6144
    v_mul_f32 v13, v13, v137
    v_mfma_f32_16x16x32_bf16 v[52:55], v[228:231], v[208:211], v[52:55]
    ds_read_b128 v[196:199], v2 offset:7168
    v_mul_f32 v14, v14, v138
    v_mfma_f32_16x16x32_bf16 v[56:59], v[232:235], v[204:207], v[56:59]
    ds_read_b128 v[200:203], v2 offset:8192
    v_mul_f32 v15, v15, v139
    v_mfma_f32_16x16x32_bf16 v[60:63], v[232:235], v[208:211], v[60:63]
    v_mul_f32 v252, v252, v140
    v_mul_f32 v253, v253, v141
    v_mfma_f32_16x16x32_bf16 v[64:67], v[236:239], v[204:207], v[64:67]
    v_mul_f32 v254, v254, v142
    v_mul_f32 v255, v255, v143
    v_mfma_f32_16x16x32_bf16 v[68:71], v[236:239], v[208:211], v[68:71]
    v_exp_f32 v12, v12
    v_mfma_f32_16x16x32_bf16 v[72:75], v[240:243], v[204:207], v[72:75]
    v_exp_f32 v13, v13
    v_mfma_f32_16x16x32_bf16 v[76:79], v[240:243], v[208:211], v[76:79]
    v_exp_f32 v14, v14
    v_mfma_f32_16x16x32_bf16 v[80:83], v[244:247], v[204:207], v[80:83]
    v_exp_f32 v15, v15
    v_mfma_f32_16x16x32_bf16 v[84:87], v[244:247], v[208:211], v[84:87]
    v_exp_f32 v252, v252
    s_waitcnt lgkmcnt(5)
    v_mfma_f32_16x16x32_bf16 v[16:19], v[168:171], v[160:163], v[16:19]
    ds_read_b128 v[204:207], v11 offset:0
    v_mfma_f32_16x16x32_bf16 v[20:23], v[168:171], v[164:167], v[20:23]
    ds_read_b128 v[208:211], v11 offset:2048
    v_exp_f32 v253, v253
    v_mfma_f32_16x16x32_bf16 v[24:27], v[172:175], v[160:163], v[24:27]
    ds_read_b128 v[212:215], v2 offset:9216
    v_exp_f32 v254, v254
    v_mfma_f32_16x16x32_bf16 v[28:31], v[172:175], v[164:167], v[28:31]
    ds_read_b128 v[216:219], v2 offset:10240
    v_exp_f32 v255, v255
    v_mfma_f32_16x16x32_bf16 v[32:35], v[176:179], v[160:163], v[32:35]
    ds_read_b128 v[220:223], v2 offset:11264
    v_fma_f32 v12, v12, v249, v249
    v_mfma_f32_16x16x32_bf16 v[36:39], v[176:179], v[164:167], v[36:39]
    ds_read_b128 v[224:227], v2 offset:12288
    v_fma_f32 v13, v13, v249, v249
    v_mfma_f32_16x16x32_bf16 v[40:43], v[180:183], v[160:163], v[40:43]
    ds_read_b128 v[228:231], v2 offset:13312
    v_fma_f32 v14, v14, v249, v249
    v_mfma_f32_16x16x32_bf16 v[44:47], v[180:183], v[164:167], v[44:47]
    ds_read_b128 v[232:235], v2 offset:14336
    s_waitcnt lgkmcnt(8)
    v_mfma_f32_16x16x32_bf16 v[48:51], v[184:187], v[160:163], v[48:51]
    ds_read_b128 v[236:239], v2 offset:15360
    v_fma_f32 v15, v15, v249, v249
    v_mfma_f32_16x16x32_bf16 v[52:55], v[184:187], v[164:167], v[52:55]
    ds_read_b128 v[240:243], v2 offset:16384
    v_fma_f32 v252, v252, v251, v251
    v_mfma_f32_16x16x32_bf16 v[56:59], v[188:191], v[160:163], v[56:59]
    ds_read_b128 v[244:247], v2 offset:17408
    v_fma_f32 v253, v253, v251, v251
    v_mfma_f32_16x16x32_bf16 v[60:63], v[188:191], v[164:167], v[60:63]
    v_fma_f32 v254, v254, v251, v251
    v_fma_f32 v255, v255, v251, v251
    v_mfma_f32_16x16x32_bf16 v[64:67], v[192:195], v[160:163], v[64:67]
    v_rcp_f32 v12, v12
    v_mfma_f32_16x16x32_bf16 v[68:71], v[192:195], v[164:167], v[68:71]
    v_rcp_f32 v13, v13
    v_mfma_f32_16x16x32_bf16 v[72:75], v[196:199], v[160:163], v[72:75]
    v_rcp_f32 v14, v14
    v_mfma_f32_16x16x32_bf16 v[76:79], v[196:199], v[164:167], v[76:79]
    v_rcp_f32 v15, v15
    v_mfma_f32_16x16x32_bf16 v[80:83], v[200:203], v[160:163], v[80:83]
    v_rcp_f32 v252, v252
    v_mfma_f32_16x16x32_bf16 v[84:87], v[200:203], v[164:167], v[84:87]
    v_rcp_f32 v253, v253
    s_waitcnt lgkmcnt(0)
    s_barrier
    v_mfma_f32_16x16x32_bf16 v[16:19], v[212:215], v[204:207], v[16:19]
    ds_read_b128 v[160:163], v10 offset:36864
    v_mfma_f32_16x16x32_bf16 v[20:23], v[212:215], v[208:211], v[20:23]
    ds_read_b128 v[164:167], v10 offset:38912
    v_rcp_f32 v254, v254
    v_mfma_f32_16x16x32_bf16 v[24:27], v[216:219], v[204:207], v[24:27]
    ds_read_b128 v[168:171], v2 offset:36864
    v_rcp_f32 v255, v255
    v_mfma_f32_16x16x32_bf16 v[28:31], v[216:219], v[208:211], v[28:31]
    ds_read_b128 v[172:175], v2 offset:37888
    v_mul_f32 v136, v136, v12
    v_mfma_f32_16x16x32_bf16 v[32:35], v[220:223], v[204:207], v[32:35]
    ds_read_b128 v[176:179], v2 offset:38912
    v_mul_f32 v137, v137, v13
    v_mfma_f32_16x16x32_bf16 v[36:39], v[220:223], v[208:211], v[36:39]
    ds_read_b128 v[180:183], v2 offset:39936
    v_mul_f32 v138, v138, v14
    v_mfma_f32_16x16x32_bf16 v[40:43], v[224:227], v[204:207], v[40:43]
    ds_read_b128 v[184:187], v2 offset:40960
    v_mul_f32 v139, v139, v15
    v_mfma_f32_16x16x32_bf16 v[44:47], v[224:227], v[208:211], v[44:47]
    ds_read_b128 v[188:191], v2 offset:41984
    v_mfma_f32_16x16x32_bf16 v[48:51], v[228:231], v[204:207], v[48:51]
    ds_read_b128 v[192:195], v2 offset:43008
    v_mul_f32 v140, v140, v252
    v_mfma_f32_16x16x32_bf16 v[52:55], v[228:231], v[208:211], v[52:55]
    ds_read_b128 v[196:199], v2 offset:44032
    v_mul_f32 v141, v141, v253
    v_mfma_f32_16x16x32_bf16 v[56:59], v[232:235], v[204:207], v[56:59]
    ds_read_b128 v[200:203], v2 offset:45056
    v_mul_f32 v142, v142, v254
    v_mfma_f32_16x16x32_bf16 v[60:63], v[232:235], v[208:211], v[60:63]
    v_mul_f32 v143, v143, v255
    v_mul_f32 v12, v144, v144
    v_mfma_f32_16x16x32_bf16 v[64:67], v[236:239], v[204:207], v[64:67]
    v_mul_f32 v13, v145, v145
    v_mul_f32 v14, v146, v146
    v_mfma_f32_16x16x32_bf16 v[68:71], v[236:239], v[208:211], v[68:71]
    v_mul_f32 v15, v147, v147
    v_mul_f32 v252, v148, v148
    v_mfma_f32_16x16x32_bf16 v[72:75], v[240:243], v[204:207], v[72:75]
    v_mul_f32 v253, v149, v149
    v_mul_f32 v254, v150, v150
    v_mfma_f32_16x16x32_bf16 v[76:79], v[240:243], v[208:211], v[76:79]
    v_mul_f32 v255, v151, v151
    v_fma_f32 v12, v12, v5, v4
    v_mfma_f32_16x16x32_bf16 v[80:83], v[244:247], v[204:207], v[80:83]
    v_fma_f32 v13, v13, v5, v4
    v_fma_f32 v14, v14, v5, v4
    v_mfma_f32_16x16x32_bf16 v[84:87], v[244:247], v[208:211], v[84:87]
    v_fma_f32 v15, v15, v5, v4
    s_waitcnt lgkmcnt(5)
    v_mfma_f32_16x16x32_bf16 v[16:19], v[168:171], v[160:163], v[16:19]
    ds_read_b128 v[204:207], v11 offset:36864
    v_mfma_f32_16x16x32_bf16 v[20:23], v[168:171], v[164:167], v[20:23]
    ds_read_b128 v[208:211], v11 offset:38912
    v_fma_f32 v252, v252, v7, v6
    v_mfma_f32_16x16x32_bf16 v[24:27], v[172:175], v[160:163], v[24:27]
    ds_read_b128 v[212:215], v2 offset:46080
    v_fma_f32 v253, v253, v7, v6
    v_mfma_f32_16x16x32_bf16 v[28:31], v[172:175], v[164:167], v[28:31]
    ds_read_b128 v[216:219], v2 offset:47104
    v_fma_f32 v254, v254, v7, v6
    v_mfma_f32_16x16x32_bf16 v[32:35], v[176:179], v[160:163], v[32:35]
    ds_read_b128 v[220:223], v2 offset:48128
    v_fma_f32 v255, v255, v7, v6
    v_mfma_f32_16x16x32_bf16 v[36:39], v[176:179], v[164:167], v[36:39]
    ds_read_b128 v[224:227], v2 offset:49152
    v_mul_f32 v12, v12, v144
    v_mfma_f32_16x16x32_bf16 v[40:43], v[180:183], v[160:163], v[40:43]
    ds_read_b128 v[228:231], v2 offset:50176
    v_mul_f32 v13, v13, v145
    v_mfma_f32_16x16x32_bf16 v[44:47], v[180:183], v[164:167], v[44:47]
    ds_read_b128 v[232:235], v2 offset:51200
    s_waitcnt lgkmcnt(8)
    v_mfma_f32_16x16x32_bf16 v[48:51], v[184:187], v[160:163], v[48:51]
    ds_read_b128 v[236:239], v2 offset:52224
    v_mul_f32 v14, v14, v146
    v_mfma_f32_16x16x32_bf16 v[52:55], v[184:187], v[164:167], v[52:55]
    ds_read_b128 v[240:243], v2 offset:53248
    v_mul_f32 v15, v15, v147
    v_mfma_f32_16x16x32_bf16 v[56:59], v[188:191], v[160:163], v[56:59]
    ds_read_b128 v[244:247], v2 offset:54272
    v_mul_f32 v252, v252, v148
    v_mfma_f32_16x16x32_bf16 v[60:63], v[188:191], v[164:167], v[60:63]
    v_mul_f32 v253, v253, v149
    v_mul_f32 v254, v254, v150
    v_mfma_f32_16x16x32_bf16 v[64:67], v[192:195], v[160:163], v[64:67]
    v_mul_f32 v255, v255, v151
    v_exp_f32 v12, v12
    v_mfma_f32_16x16x32_bf16 v[68:71], v[192:195], v[164:167], v[68:71]
    v_exp_f32 v13, v13
    v_mfma_f32_16x16x32_bf16 v[72:75], v[196:199], v[160:163], v[72:75]
    v_exp_f32 v14, v14
    v_mfma_f32_16x16x32_bf16 v[76:79], v[196:199], v[164:167], v[76:79]
    v_exp_f32 v15, v15
    v_mfma_f32_16x16x32_bf16 v[80:83], v[200:203], v[160:163], v[80:83]
    v_exp_f32 v252, v252
    v_mfma_f32_16x16x32_bf16 v[84:87], v[200:203], v[164:167], v[84:87]
    v_exp_f32 v253, v253
    s_waitcnt lgkmcnt(0)
    s_barrier
    v_mfma_f32_16x16x32_bf16 v[16:19], v[212:215], v[204:207], v[16:19]
    ds_read_b128 v[160:163], v8 offset:0
    v_mfma_f32_16x16x32_bf16 v[20:23], v[212:215], v[208:211], v[20:23]
    ds_read_b128 v[164:167], v8 offset:2048
    v_exp_f32 v254, v254
    v_mfma_f32_16x16x32_bf16 v[24:27], v[216:219], v[204:207], v[24:27]
    ds_read_b128 v[168:171], v1 offset:0
    v_exp_f32 v255, v255
    v_mfma_f32_16x16x32_bf16 v[28:31], v[216:219], v[208:211], v[28:31]
    ds_read_b128 v[172:175], v1 offset:1024
    v_fma_f32 v12, v12, v249, v249
    v_mfma_f32_16x16x32_bf16 v[32:35], v[220:223], v[204:207], v[32:35]
    ds_read_b128 v[176:179], v1 offset:2048
    v_fma_f32 v13, v13, v249, v249
    v_mfma_f32_16x16x32_bf16 v[36:39], v[220:223], v[208:211], v[36:39]
    ds_read_b128 v[180:183], v1 offset:3072
    v_fma_f32 v14, v14, v249, v249
    v_mfma_f32_16x16x32_bf16 v[40:43], v[224:227], v[204:207], v[40:43]
    ds_read_b128 v[184:187], v1 offset:4096
    v_fma_f32 v15, v15, v249, v249
    v_mfma_f32_16x16x32_bf16 v[44:47], v[224:227], v[208:211], v[44:47]
    ds_read_b128 v[188:191], v1 offset:5120
    v_mfma_f32_16x16x32_bf16 v[48:51], v[228:231], v[204:207], v[48:51]
    ds_read_b128 v[192:195], v1 offset:6144
    v_fma_f32 v252, v252, v251, v251
    v_mfma_f32_16x16x32_bf16 v[52:55], v[228:231], v[208:211], v[52:55]
    ds_read_b128 v[196:199], v1 offset:7168
    v_fma_f32 v253, v253, v251, v251
    v_mfma_f32_16x16x32_bf16 v[56:59], v[232:235], v[204:207], v[56:59]
    ds_read_b128 v[200:203], v1 offset:8192
    v_fma_f32 v254, v254, v251, v251
    v_mfma_f32_16x16x32_bf16 v[60:63], v[232:235], v[208:211], v[60:63]
    v_fma_f32 v255, v255, v251, v251
    v_rcp_f32 v12, v12
    v_mfma_f32_16x16x32_bf16 v[64:67], v[236:239], v[204:207], v[64:67]
    v_rcp_f32 v13, v13
    v_mfma_f32_16x16x32_bf16 v[68:71], v[236:239], v[208:211], v[68:71]
    v_rcp_f32 v14, v14
    v_mfma_f32_16x16x32_bf16 v[72:75], v[240:243], v[204:207], v[72:75]
    v_rcp_f32 v15, v15
    v_mfma_f32_16x16x32_bf16 v[76:79], v[240:243], v[208:211], v[76:79]
    v_rcp_f32 v252, v252
    v_mfma_f32_16x16x32_bf16 v[80:83], v[244:247], v[204:207], v[80:83]
    v_rcp_f32 v253, v253
    v_mfma_f32_16x16x32_bf16 v[84:87], v[244:247], v[208:211], v[84:87]
    v_rcp_f32 v254, v254
    s_waitcnt lgkmcnt(5)
    v_mfma_f32_16x16x32_bf16 v[16:19], v[168:171], v[160:163], v[16:19]
    ds_read_b128 v[204:207], v9 offset:0
    v_mfma_f32_16x16x32_bf16 v[20:23], v[168:171], v[164:167], v[20:23]
    ds_read_b128 v[208:211], v9 offset:2048
    v_rcp_f32 v255, v255
    v_mfma_f32_16x16x32_bf16 v[24:27], v[172:175], v[160:163], v[24:27]
    ds_read_b128 v[212:215], v1 offset:9216
    v_mul_f32 v144, v144, v12
    v_mfma_f32_16x16x32_bf16 v[28:31], v[172:175], v[164:167], v[28:31]
    ds_read_b128 v[216:219], v1 offset:10240
    v_mul_f32 v145, v145, v13
    v_mfma_f32_16x16x32_bf16 v[32:35], v[176:179], v[160:163], v[32:35]
    ds_read_b128 v[220:223], v1 offset:11264
    v_mul_f32 v146, v146, v14
    v_mfma_f32_16x16x32_bf16 v[36:39], v[176:179], v[164:167], v[36:39]
    ds_read_b128 v[224:227], v1 offset:12288
    v_mul_f32 v147, v147, v15
    v_mfma_f32_16x16x32_bf16 v[40:43], v[180:183], v[160:163], v[40:43]
    ds_read_b128 v[228:231], v1 offset:13312
    v_mul_f32 v148, v148, v252
    v_mfma_f32_16x16x32_bf16 v[44:47], v[180:183], v[164:167], v[44:47]
    ds_read_b128 v[232:235], v1 offset:14336
    s_waitcnt lgkmcnt(8)
    v_mfma_f32_16x16x32_bf16 v[48:51], v[184:187], v[160:163], v[48:51]
    ds_read_b128 v[236:239], v1 offset:15360
    v_mul_f32 v149, v149, v253
    v_mfma_f32_16x16x32_bf16 v[52:55], v[184:187], v[164:167], v[52:55]
    ds_read_b128 v[240:243], v1 offset:16384
    v_mul_f32 v150, v150, v254
    v_mfma_f32_16x16x32_bf16 v[56:59], v[188:191], v[160:163], v[56:59]
    ds_read_b128 v[244:247], v1 offset:17408
    v_mul_f32 v151, v151, v255
    v_mfma_f32_16x16x32_bf16 v[60:63], v[188:191], v[164:167], v[60:63]
    v_mul_f32 v12, v152, v152
    v_mul_f32 v13, v153, v153
    v_mfma_f32_16x16x32_bf16 v[64:67], v[192:195], v[160:163], v[64:67]
    v_mul_f32 v14, v154, v154
    v_mul_f32 v15, v155, v155
    v_mfma_f32_16x16x32_bf16 v[68:71], v[192:195], v[164:167], v[68:71]
    v_mul_f32 v252, v156, v156
    v_mul_f32 v253, v157, v157
    v_mfma_f32_16x16x32_bf16 v[72:75], v[196:199], v[160:163], v[72:75]
    v_mul_f32 v254, v158, v158
    v_mul_f32 v255, v159, v159
    v_mfma_f32_16x16x32_bf16 v[76:79], v[196:199], v[164:167], v[76:79]
    v_fma_f32 v12, v12, v5, v4
    v_fma_f32 v13, v13, v5, v4
    v_mfma_f32_16x16x32_bf16 v[80:83], v[200:203], v[160:163], v[80:83]
    v_fma_f32 v14, v14, v5, v4
    v_fma_f32 v15, v15, v5, v4
    v_mfma_f32_16x16x32_bf16 v[84:87], v[200:203], v[164:167], v[84:87]
    v_fma_f32 v252, v252, v7, v6
    s_waitcnt lgkmcnt(0)
    s_barrier
    v_mfma_f32_16x16x32_bf16 v[16:19], v[212:215], v[204:207], v[16:19]
    ds_read_b128 v[160:163], v8 offset:36864
    v_mfma_f32_16x16x32_bf16 v[20:23], v[212:215], v[208:211], v[20:23]
    ds_read_b128 v[164:167], v8 offset:38912
    v_fma_f32 v253, v253, v7, v6
    v_mfma_f32_16x16x32_bf16 v[24:27], v[216:219], v[204:207], v[24:27]
    ds_read_b128 v[168:171], v1 offset:36864
    v_fma_f32 v254, v254, v7, v6
    v_mfma_f32_16x16x32_bf16 v[28:31], v[216:219], v[208:211], v[28:31]
    ds_read_b128 v[172:175], v1 offset:37888
    v_fma_f32 v255, v255, v7, v6
    v_mfma_f32_16x16x32_bf16 v[32:35], v[220:223], v[204:207], v[32:35]
    ds_read_b128 v[176:179], v1 offset:38912
    v_mul_f32 v12, v12, v152
    v_mfma_f32_16x16x32_bf16 v[36:39], v[220:223], v[208:211], v[36:39]
    ds_read_b128 v[180:183], v1 offset:39936
    v_mul_f32 v13, v13, v153
    v_mfma_f32_16x16x32_bf16 v[40:43], v[224:227], v[204:207], v[40:43]
    ds_read_b128 v[184:187], v1 offset:40960
    v_mul_f32 v14, v14, v154
    v_mfma_f32_16x16x32_bf16 v[44:47], v[224:227], v[208:211], v[44:47]
    ds_read_b128 v[188:191], v1 offset:41984
    v_mfma_f32_16x16x32_bf16 v[48:51], v[228:231], v[204:207], v[48:51]
    ds_read_b128 v[192:195], v1 offset:43008
    v_mul_f32 v15, v15, v155
    v_mfma_f32_16x16x32_bf16 v[52:55], v[228:231], v[208:211], v[52:55]
    ds_read_b128 v[196:199], v1 offset:44032
    v_mul_f32 v252, v252, v156
    v_mfma_f32_16x16x32_bf16 v[56:59], v[232:235], v[204:207], v[56:59]
    ds_read_b128 v[200:203], v1 offset:45056
    v_mul_f32 v253, v253, v157
    v_mfma_f32_16x16x32_bf16 v[60:63], v[232:235], v[208:211], v[60:63]
    v_mul_f32 v254, v254, v158
    v_mul_f32 v255, v255, v159
    v_mfma_f32_16x16x32_bf16 v[64:67], v[236:239], v[204:207], v[64:67]
    v_exp_f32 v12, v12
    v_mfma_f32_16x16x32_bf16 v[68:71], v[236:239], v[208:211], v[68:71]
    v_exp_f32 v13, v13
    v_mfma_f32_16x16x32_bf16 v[72:75], v[240:243], v[204:207], v[72:75]
    v_exp_f32 v14, v14
    v_mfma_f32_16x16x32_bf16 v[76:79], v[240:243], v[208:211], v[76:79]
    v_exp_f32 v15, v15
    v_mfma_f32_16x16x32_bf16 v[80:83], v[244:247], v[204:207], v[80:83]
    v_exp_f32 v252, v252
    v_mfma_f32_16x16x32_bf16 v[84:87], v[244:247], v[208:211], v[84:87]
    v_exp_f32 v253, v253
    s_waitcnt lgkmcnt(5)
    v_mfma_f32_16x16x32_bf16 v[16:19], v[168:171], v[160:163], v[16:19]
    ds_read_b128 v[204:207], v9 offset:36864
    v_mfma_f32_16x16x32_bf16 v[20:23], v[168:171], v[164:167], v[20:23]
    ds_read_b128 v[208:211], v9 offset:38912
    v_exp_f32 v254, v254
    v_mfma_f32_16x16x32_bf16 v[24:27], v[172:175], v[160:163], v[24:27]
    ds_read_b128 v[212:215], v1 offset:46080
    v_exp_f32 v255, v255
    v_mfma_f32_16x16x32_bf16 v[28:31], v[172:175], v[164:167], v[28:31]
    ds_read_b128 v[216:219], v1 offset:47104
    v_fma_f32 v12, v12, v249, v249
    v_mfma_f32_16x16x32_bf16 v[32:35], v[176:179], v[160:163], v[32:35]
    ds_read_b128 v[220:223], v1 offset:48128
    v_fma_f32 v13, v13, v249, v249
    v_mfma_f32_16x16x32_bf16 v[36:39], v[176:179], v[164:167], v[36:39]
    ds_read_b128 v[224:227], v1 offset:49152
    v_fma_f32 v14, v14, v249, v249
    v_mfma_f32_16x16x32_bf16 v[40:43], v[180:183], v[160:163], v[40:43]
    ds_read_b128 v[228:231], v1 offset:50176
    v_fma_f32 v15, v15, v249, v249
    v_mfma_f32_16x16x32_bf16 v[44:47], v[180:183], v[164:167], v[44:47]
    ds_read_b128 v[232:235], v1 offset:51200
    s_waitcnt lgkmcnt(8)
    v_mfma_f32_16x16x32_bf16 v[48:51], v[184:187], v[160:163], v[48:51]
    ds_read_b128 v[236:239], v1 offset:52224
    v_fma_f32 v252, v252, v251, v251
    v_mfma_f32_16x16x32_bf16 v[52:55], v[184:187], v[164:167], v[52:55]
    ds_read_b128 v[240:243], v1 offset:53248
    v_fma_f32 v253, v253, v251, v251
    v_mfma_f32_16x16x32_bf16 v[56:59], v[188:191], v[160:163], v[56:59]
    ds_read_b128 v[244:247], v1 offset:54272
    v_fma_f32 v254, v254, v251, v251
    v_mfma_f32_16x16x32_bf16 v[60:63], v[188:191], v[164:167], v[60:63]
    v_fma_f32 v255, v255, v251, v251
    v_rcp_f32 v12, v12
    v_mfma_f32_16x16x32_bf16 v[64:67], v[192:195], v[160:163], v[64:67]
    v_rcp_f32 v13, v13
    v_mfma_f32_16x16x32_bf16 v[68:71], v[192:195], v[164:167], v[68:71]
    v_rcp_f32 v14, v14
    v_mfma_f32_16x16x32_bf16 v[72:75], v[196:199], v[160:163], v[72:75]
    v_rcp_f32 v15, v15
    v_mfma_f32_16x16x32_bf16 v[76:79], v[196:199], v[164:167], v[76:79]
    v_rcp_f32 v252, v252
    v_mfma_f32_16x16x32_bf16 v[80:83], v[200:203], v[160:163], v[80:83]
    v_rcp_f32 v253, v253
    v_mfma_f32_16x16x32_bf16 v[84:87], v[200:203], v[164:167], v[84:87]
    v_rcp_f32 v254, v254
    s_waitcnt lgkmcnt(0)
    s_barrier
    v_mfma_f32_16x16x32_bf16 v[16:19], v[212:215], v[204:207], v[16:19]
    ds_read_b128 v[160:163], v10 offset:0
    v_mfma_f32_16x16x32_bf16 v[20:23], v[212:215], v[208:211], v[20:23]
    ds_read_b128 v[164:167], v10 offset:2048
    v_rcp_f32 v255, v255
    v_mfma_f32_16x16x32_bf16 v[24:27], v[216:219], v[204:207], v[24:27]
    ds_read_b128 v[168:171], v2 offset:0
    v_mul_f32 v152, v152, v12
    v_mfma_f32_16x16x32_bf16 v[28:31], v[216:219], v[208:211], v[28:31]
    ds_read_b128 v[172:175], v2 offset:1024
    v_mul_f32 v153, v153, v13
    v_mfma_f32_16x16x32_bf16 v[32:35], v[220:223], v[204:207], v[32:35]
    ds_read_b128 v[176:179], v2 offset:2048
    v_mul_f32 v154, v154, v14
    v_mfma_f32_16x16x32_bf16 v[36:39], v[220:223], v[208:211], v[36:39]
    ds_read_b128 v[180:183], v2 offset:3072
    v_mul_f32 v155, v155, v15
    v_mfma_f32_16x16x32_bf16 v[40:43], v[224:227], v[204:207], v[40:43]
    ds_read_b128 v[184:187], v2 offset:4096
    v_mul_f32 v156, v156, v252
    v_mfma_f32_16x16x32_bf16 v[44:47], v[224:227], v[208:211], v[44:47]
    ds_read_b128 v[188:191], v2 offset:5120
    v_mfma_f32_16x16x32_bf16 v[48:51], v[228:231], v[204:207], v[48:51]
    ds_read_b128 v[192:195], v2 offset:6144
    v_mul_f32 v157, v157, v253
    v_mfma_f32_16x16x32_bf16 v[52:55], v[228:231], v[208:211], v[52:55]
    ds_read_b128 v[196:199], v2 offset:7168
    v_mul_f32 v158, v158, v254
    v_mfma_f32_16x16x32_bf16 v[56:59], v[232:235], v[204:207], v[56:59]
    ds_read_b128 v[200:203], v2 offset:8192
    v_mul_f32 v159, v159, v255
    v_mfma_f32_16x16x32_bf16 v[60:63], v[232:235], v[208:211], v[60:63]
    s_mul_i32 s36, s31, 73728
    s_add_u32 s36, s36, s21
    v_mfma_f32_16x16x32_bf16 v[64:67], v[236:239], v[204:207], v[64:67]
    s_lshl_b32 s34, s24, 10
    s_lshr_b32 s35, s24, 1
    v_mfma_f32_16x16x32_bf16 v[68:71], v[236:239], v[208:211], v[68:71]
    s_lshl_b32 s35, s35, 10
    s_and_b32 s33, s24, 1
    v_mfma_f32_16x16x32_bf16 v[72:75], v[240:243], v[204:207], v[72:75]
    s_mul_i32 s33, s33, 73728
    s_add_u32 s35, s35, s33
    v_mfma_f32_16x16x32_bf16 v[76:79], v[240:243], v[208:211], v[76:79]
    s_add_u32 s35, s35, 65536
    v_add_u32 v14, s34, v1
    v_mfma_f32_16x16x32_bf16 v[80:83], v[244:247], v[204:207], v[80:83]
    v_add_u32 v15, s35, v1
    s_add_u32 s39, s36, 0x1200000
    v_mfma_f32_16x16x32_bf16 v[84:87], v[244:247], v[208:211], v[84:87]
    s_add_u32 s40, s36, 0x1212000
    s_mov_b32 s41, 5
    .p2align 6
L_g_loop:
    s_waitcnt lgkmcnt(5)
    v_mfma_f32_16x16x32_bf16 v[16:19], v[168:171], v[160:163], v[16:19]
    ds_read_b128 v[204:207], v11 offset:0
    v_mfma_f32_16x16x32_bf16 v[20:23], v[168:171], v[164:167], v[20:23]
    ds_read_b128 v[208:211], v11 offset:2048
    v_mfma_f32_16x16x32_bf16 v[24:27], v[172:175], v[160:163], v[24:27]
    ds_read_b128 v[212:215], v2 offset:9216
    v_mfma_f32_16x16x32_bf16 v[28:31], v[172:175], v[164:167], v[28:31]
    ds_read_b128 v[216:219], v2 offset:10240
    v_mfma_f32_16x16x32_bf16 v[32:35], v[176:179], v[160:163], v[32:35]
    ds_read_b128 v[220:223], v2 offset:11264
    v_mfma_f32_16x16x32_bf16 v[36:39], v[176:179], v[164:167], v[36:39]
    ds_read_b128 v[224:227], v2 offset:12288
    v_mfma_f32_16x16x32_bf16 v[40:43], v[180:183], v[160:163], v[40:43]
    ds_read_b128 v[228:231], v2 offset:13312
    v_mfma_f32_16x16x32_bf16 v[44:47], v[180:183], v[164:167], v[44:47]
    ds_read_b128 v[232:235], v2 offset:14336
    s_waitcnt lgkmcnt(8)
    v_mfma_f32_16x16x32_bf16 v[48:51], v[184:187], v[160:163], v[48:51]
    ds_read_b128 v[236:239], v2 offset:15360
    v_mfma_f32_16x16x32_bf16 v[52:55], v[184:187], v[164:167], v[52:55]
    ds_read_b128 v[240:243], v2 offset:16384
    v_mfma_f32_16x16x32_bf16 v[56:59], v[188:191], v[160:163], v[56:59]
    ds_read_b128 v[244:247], v2 offset:17408
    v_mfma_f32_16x16x32_bf16 v[60:63], v[188:191], v[164:167], v[60:63]
    v_mfma_f32_16x16x32_bf16 v[64:67], v[192:195], v[160:163], v[64:67]
    v_mfma_f32_16x16x32_bf16 v[68:71], v[192:195], v[164:167], v[68:71]
    v_mfma_f32_16x16x32_bf16 v[72:75], v[196:199], v[160:163], v[72:75]
    v_mfma_f32_16x16x32_bf16 v[76:79], v[196:199], v[164:167], v[76:79]
    v_mfma_f32_16x16x32_bf16 v[80:83], v[200:203], v[160:163], v[80:83]
    v_mfma_f32_16x16x32_bf16 v[84:87], v[200:203], v[164:167], v[84:87]
    s_waitcnt lgkmcnt(0)
    s_barrier
    v_mfma_f32_16x16x32_bf16 v[16:19], v[212:215], v[204:207], v[16:19]
    ds_read_b128 v[160:163], v10 offset:36864
    v_mfma_f32_16x16x32_bf16 v[20:23], v[212:215], v[208:211], v[20:23]
    ds_read_b128 v[164:167], v10 offset:38912
    v_mfma_f32_16x16x32_bf16 v[24:27], v[216:219], v[204:207], v[24:27]
    ds_read_b128 v[168:171], v2 offset:36864
    v_mfma_f32_16x16x32_bf16 v[28:31], v[216:219], v[208:211], v[28:31]
    ds_read_b128 v[172:175], v2 offset:37888
    v_mfma_f32_16x16x32_bf16 v[32:35], v[220:223], v[204:207], v[32:35]
    ds_read_b128 v[176:179], v2 offset:38912
    v_mfma_f32_16x16x32_bf16 v[36:39], v[220:223], v[208:211], v[36:39]
    ds_read_b128 v[180:183], v2 offset:39936
    v_mfma_f32_16x16x32_bf16 v[40:43], v[224:227], v[204:207], v[40:43]
    ds_read_b128 v[184:187], v2 offset:40960
    v_mfma_f32_16x16x32_bf16 v[44:47], v[224:227], v[208:211], v[44:47]
    ds_read_b128 v[188:191], v2 offset:41984
    v_mfma_f32_16x16x32_bf16 v[48:51], v[228:231], v[204:207], v[48:51]
    ds_read_b128 v[192:195], v2 offset:43008
    v_mfma_f32_16x16x32_bf16 v[52:55], v[228:231], v[208:211], v[52:55]
    ds_read_b128 v[196:199], v2 offset:44032
    v_mfma_f32_16x16x32_bf16 v[56:59], v[232:235], v[204:207], v[56:59]
    ds_read_b128 v[200:203], v2 offset:45056
    v_mfma_f32_16x16x32_bf16 v[60:63], v[232:235], v[208:211], v[60:63]
    v_mfma_f32_16x16x32_bf16 v[64:67], v[236:239], v[204:207], v[64:67]
    v_mfma_f32_16x16x32_bf16 v[68:71], v[236:239], v[208:211], v[68:71]
    v_mfma_f32_16x16x32_bf16 v[72:75], v[240:243], v[204:207], v[72:75]
    v_mfma_f32_16x16x32_bf16 v[76:79], v[240:243], v[208:211], v[76:79]
    v_mfma_f32_16x16x32_bf16 v[80:83], v[244:247], v[204:207], v[80:83]
    v_mfma_f32_16x16x32_bf16 v[84:87], v[244:247], v[208:211], v[84:87]
    s_waitcnt lgkmcnt(5)
    v_mfma_f32_16x16x32_bf16 v[16:19], v[168:171], v[160:163], v[16:19]
    ds_read_b128 v[204:207], v11 offset:36864
    v_mfma_f32_16x16x32_bf16 v[20:23], v[168:171], v[164:167], v[20:23]
    ds_read_b128 v[208:211], v11 offset:38912
    v_mfma_f32_16x16x32_bf16 v[24:27], v[172:175], v[160:163], v[24:27]
    ds_read_b128 v[212:215], v2 offset:46080
    v_mfma_f32_16x16x32_bf16 v[28:31], v[172:175], v[164:167], v[28:31]
    ds_read_b128 v[216:219], v2 offset:47104
    v_mfma_f32_16x16x32_bf16 v[32:35], v[176:179], v[160:163], v[32:35]
    ds_read_b128 v[220:223], v2 offset:48128
    v_mfma_f32_16x16x32_bf16 v[36:39], v[176:179], v[164:167], v[36:39]
    ds_read_b128 v[224:227], v2 offset:49152
    v_mfma_f32_16x16x32_bf16 v[40:43], v[180:183], v[160:163], v[40:43]
    ds_read_b128 v[228:231], v2 offset:50176
    v_mfma_f32_16x16x32_bf16 v[44:47], v[180:183], v[164:167], v[44:47]
    ds_read_b128 v[232:235], v2 offset:51200
    s_waitcnt lgkmcnt(8)
    v_mfma_f32_16x16x32_bf16 v[48:51], v[184:187], v[160:163], v[48:51]
    ds_read_b128 v[236:239], v2 offset:52224
    v_mfma_f32_16x16x32_bf16 v[52:55], v[184:187], v[164:167], v[52:55]
    ds_read_b128 v[240:243], v2 offset:53248
    v_mfma_f32_16x16x32_bf16 v[56:59], v[188:191], v[160:163], v[56:59]
    ds_read_b128 v[244:247], v2 offset:54272
    v_mfma_f32_16x16x32_bf16 v[60:63], v[188:191], v[164:167], v[60:63]
    v_mfma_f32_16x16x32_bf16 v[64:67], v[192:195], v[160:163], v[64:67]
    v_mfma_f32_16x16x32_bf16 v[68:71], v[192:195], v[164:167], v[68:71]
    v_mfma_f32_16x16x32_bf16 v[72:75], v[196:199], v[160:163], v[72:75]
    v_mfma_f32_16x16x32_bf16 v[76:79], v[196:199], v[164:167], v[76:79]
    v_mfma_f32_16x16x32_bf16 v[80:83], v[200:203], v[160:163], v[80:83]
    v_mfma_f32_16x16x32_bf16 v[84:87], v[200:203], v[164:167], v[84:87]
    s_waitcnt lgkmcnt(0)
    s_barrier
    v_mfma_f32_16x16x32_bf16 v[16:19], v[212:215], v[204:207], v[16:19]
    ds_read_b128 v[160:163], v8 offset:0
    v_mfma_f32_16x16x32_bf16 v[20:23], v[212:215], v[208:211], v[20:23]
    ds_read_b128 v[164:167], v8 offset:2048
    v_mfma_f32_16x16x32_bf16 v[24:27], v[216:219], v[204:207], v[24:27]
    ds_read_b128 v[168:171], v1 offset:0
    v_mfma_f32_16x16x32_bf16 v[28:31], v[216:219], v[208:211], v[28:31]
    ds_read_b128 v[172:175], v1 offset:1024
    v_mfma_f32_16x16x32_bf16 v[32:35], v[220:223], v[204:207], v[32:35]
    ds_read_b128 v[176:179], v1 offset:2048
    v_mfma_f32_16x16x32_bf16 v[36:39], v[220:223], v[208:211], v[36:39]
    ds_read_b128 v[180:183], v1 offset:3072
    v_mfma_f32_16x16x32_bf16 v[40:43], v[224:227], v[204:207], v[40:43]
    ds_read_b128 v[184:187], v1 offset:4096
    v_mfma_f32_16x16x32_bf16 v[44:47], v[224:227], v[208:211], v[44:47]
    ds_read_b128 v[188:191], v1 offset:5120
    v_mfma_f32_16x16x32_bf16 v[48:51], v[228:231], v[204:207], v[48:51]
    ds_read_b128 v[192:195], v1 offset:6144
    v_mfma_f32_16x16x32_bf16 v[52:55], v[228:231], v[208:211], v[52:55]
    ds_read_b128 v[196:199], v1 offset:7168
    v_mfma_f32_16x16x32_bf16 v[56:59], v[232:235], v[204:207], v[56:59]
    ds_read_b128 v[200:203], v1 offset:8192
    v_mfma_f32_16x16x32_bf16 v[60:63], v[232:235], v[208:211], v[60:63]
    v_mfma_f32_16x16x32_bf16 v[64:67], v[236:239], v[204:207], v[64:67]
    v_mfma_f32_16x16x32_bf16 v[68:71], v[236:239], v[208:211], v[68:71]
    v_mfma_f32_16x16x32_bf16 v[72:75], v[240:243], v[204:207], v[72:75]
    v_mfma_f32_16x16x32_bf16 v[76:79], v[240:243], v[208:211], v[76:79]
    v_mfma_f32_16x16x32_bf16 v[80:83], v[244:247], v[204:207], v[80:83]
    v_mfma_f32_16x16x32_bf16 v[84:87], v[244:247], v[208:211], v[84:87]
    s_waitcnt lgkmcnt(5)
    v_mfma_f32_16x16x32_bf16 v[16:19], v[168:171], v[160:163], v[16:19]
    ds_read_b128 v[204:207], v9 offset:0
    v_mfma_f32_16x16x32_bf16 v[20:23], v[168:171], v[164:167], v[20:23]
    ds_read_b128 v[208:211], v9 offset:2048
    v_mfma_f32_16x16x32_bf16 v[24:27], v[172:175], v[160:163], v[24:27]
    ds_read_b128 v[212:215], v1 offset:9216
    v_mfma_f32_16x16x32_bf16 v[28:31], v[172:175], v[164:167], v[28:31]
    ds_read_b128 v[216:219], v1 offset:10240
    v_mfma_f32_16x16x32_bf16 v[32:35], v[176:179], v[160:163], v[32:35]
    ds_read_b128 v[220:223], v1 offset:11264
    v_mfma_f32_16x16x32_bf16 v[36:39], v[176:179], v[164:167], v[36:39]
    ds_read_b128 v[224:227], v1 offset:12288
    v_mfma_f32_16x16x32_bf16 v[40:43], v[180:183], v[160:163], v[40:43]
    ds_read_b128 v[228:231], v1 offset:13312
    v_mfma_f32_16x16x32_bf16 v[44:47], v[180:183], v[164:167], v[44:47]
    ds_read_b128 v[232:235], v1 offset:14336
    s_waitcnt lgkmcnt(8)
    v_mfma_f32_16x16x32_bf16 v[48:51], v[184:187], v[160:163], v[48:51]
    ds_read_b128 v[236:239], v1 offset:15360
    v_mfma_f32_16x16x32_bf16 v[52:55], v[184:187], v[164:167], v[52:55]
    ds_read_b128 v[240:243], v1 offset:16384
    v_mfma_f32_16x16x32_bf16 v[56:59], v[188:191], v[160:163], v[56:59]
    ds_read_b128 v[244:247], v1 offset:17408
    v_mfma_f32_16x16x32_bf16 v[60:63], v[188:191], v[164:167], v[60:63]
    v_mfma_f32_16x16x32_bf16 v[64:67], v[192:195], v[160:163], v[64:67]
    v_mfma_f32_16x16x32_bf16 v[68:71], v[192:195], v[164:167], v[68:71]
    v_mfma_f32_16x16x32_bf16 v[72:75], v[196:199], v[160:163], v[72:75]
    v_mfma_f32_16x16x32_bf16 v[76:79], v[196:199], v[164:167], v[76:79]
    v_mfma_f32_16x16x32_bf16 v[80:83], v[200:203], v[160:163], v[80:83]
    v_mfma_f32_16x16x32_bf16 v[84:87], v[200:203], v[164:167], v[84:87]
    s_waitcnt lgkmcnt(0)
    s_barrier
    v_mfma_f32_16x16x32_bf16 v[16:19], v[212:215], v[204:207], v[16:19]
    ds_read_b128 v[160:163], v8 offset:36864
    v_mfma_f32_16x16x32_bf16 v[20:23], v[212:215], v[208:211], v[20:23]
    ds_read_b128 v[164:167], v8 offset:38912
    v_mfma_f32_16x16x32_bf16 v[24:27], v[216:219], v[204:207], v[24:27]
    ds_read_b128 v[168:171], v1 offset:36864
    v_mfma_f32_16x16x32_bf16 v[28:31], v[216:219], v[208:211], v[28:31]
    ds_read_b128 v[172:175], v1 offset:37888
    v_mfma_f32_16x16x32_bf16 v[32:35], v[220:223], v[204:207], v[32:35]
    ds_read_b128 v[176:179], v1 offset:38912
    v_mfma_f32_16x16x32_bf16 v[36:39], v[220:223], v[208:211], v[36:39]
    ds_read_b128 v[180:183], v1 offset:39936
    v_mfma_f32_16x16x32_bf16 v[40:43], v[224:227], v[204:207], v[40:43]
    ds_read_b128 v[184:187], v1 offset:40960
    v_mfma_f32_16x16x32_bf16 v[44:47], v[224:227], v[208:211], v[44:47]
    ds_read_b128 v[188:191], v1 offset:41984
    v_mfma_f32_16x16x32_bf16 v[48:51], v[228:231], v[204:207], v[48:51]
    ds_read_b128 v[192:195], v1 offset:43008
    v_mfma_f32_16x16x32_bf16 v[52:55], v[228:231], v[208:211], v[52:55]
    ds_read_b128 v[196:199], v1 offset:44032
    v_mfma_f32_16x16x32_bf16 v[56:59], v[232:235], v[204:207], v[56:59]
    ds_read_b128 v[200:203], v1 offset:45056
    v_mfma_f32_16x16x32_bf16 v[60:63], v[232:235], v[208:211], v[60:63]
    v_mfma_f32_16x16x32_bf16 v[64:67], v[236:239], v[204:207], v[64:67]
    v_mfma_f32_16x16x32_bf16 v[68:71], v[236:239], v[208:211], v[68:71]
    v_mfma_f32_16x16x32_bf16 v[72:75], v[240:243], v[204:207], v[72:75]
    v_mfma_f32_16x16x32_bf16 v[76:79], v[240:243], v[208:211], v[76:79]
    v_mfma_f32_16x16x32_bf16 v[80:83], v[244:247], v[204:207], v[80:83]
    v_mfma_f32_16x16x32_bf16 v[84:87], v[244:247], v[208:211], v[84:87]
    s_waitcnt lgkmcnt(5)
    v_mfma_f32_16x16x32_bf16 v[16:19], v[168:171], v[160:163], v[16:19]
    ds_read_b128 v[204:207], v9 offset:36864
    v_mfma_f32_16x16x32_bf16 v[20:23], v[168:171], v[164:167], v[20:23]
    ds_read_b128 v[208:211], v9 offset:38912
    v_mfma_f32_16x16x32_bf16 v[24:27], v[172:175], v[160:163], v[24:27]
    ds_read_b128 v[212:215], v1 offset:46080
    v_mfma_f32_16x16x32_bf16 v[28:31], v[172:175], v[164:167], v[28:31]
    ds_read_b128 v[216:219], v1 offset:47104
    v_mfma_f32_16x16x32_bf16 v[32:35], v[176:179], v[160:163], v[32:35]
    ds_read_b128 v[220:223], v1 offset:48128
    v_mfma_f32_16x16x32_bf16 v[36:39], v[176:179], v[164:167], v[36:39]
    ds_read_b128 v[224:227], v1 offset:49152
    v_mfma_f32_16x16x32_bf16 v[40:43], v[180:183], v[160:163], v[40:43]
    ds_read_b128 v[228:231], v1 offset:50176
    v_mfma_f32_16x16x32_bf16 v[44:47], v[180:183], v[164:167], v[44:47]
    ds_read_b128 v[232:235], v1 offset:51200
    s_waitcnt lgkmcnt(8)
    v_mfma_f32_16x16x32_bf16 v[48:51], v[184:187], v[160:163], v[48:51]
    ds_read_b128 v[236:239], v1 offset:52224
    v_mfma_f32_16x16x32_bf16 v[52:55], v[184:187], v[164:167], v[52:55]
    ds_read_b128 v[240:243], v1 offset:53248
    v_mfma_f32_16x16x32_bf16 v[56:59], v[188:191], v[160:163], v[56:59]
    ds_read_b128 v[244:247], v1 offset:54272
    v_mfma_f32_16x16x32_bf16 v[60:63], v[188:191], v[164:167], v[60:63]
    v_mfma_f32_16x16x32_bf16 v[64:67], v[192:195], v[160:163], v[64:67]
    v_mfma_f32_16x16x32_bf16 v[68:71], v[192:195], v[164:167], v[68:71]
    v_mfma_f32_16x16x32_bf16 v[72:75], v[196:199], v[160:163], v[72:75]
    v_mfma_f32_16x16x32_bf16 v[76:79], v[196:199], v[164:167], v[76:79]
    v_mfma_f32_16x16x32_bf16 v[80:83], v[200:203], v[160:163], v[80:83]
    v_mfma_f32_16x16x32_bf16 v[84:87], v[200:203], v[164:167], v[84:87]
    s_waitcnt lgkmcnt(0)
    s_barrier
    v_mfma_f32_16x16x32_bf16 v[16:19], v[212:215], v[204:207], v[16:19]
    ds_read_b128 v[160:163], v10 offset:0
    v_mfma_f32_16x16x32_bf16 v[20:23], v[212:215], v[208:211], v[20:23]
    ds_read_b128 v[164:167], v10 offset:2048
    v_mfma_f32_16x16x32_bf16 v[24:27], v[216:219], v[204:207], v[24:27]
    ds_read_b128 v[168:171], v2 offset:0
    v_mfma_f32_16x16x32_bf16 v[28:31], v[216:219], v[208:211], v[28:31]
    ds_read_b128 v[172:175], v2 offset:1024
    v_mfma_f32_16x16x32_bf16 v[32:35], v[220:223], v[204:207], v[32:35]
    ds_read_b128 v[176:179], v2 offset:2048
    v_mfma_f32_16x16x32_bf16 v[36:39], v[220:223], v[208:211], v[36:39]
    ds_read_b128 v[180:183], v2 offset:3072
    v_mfma_f32_16x16x32_bf16 v[40:43], v[224:227], v[204:207], v[40:43]
    ds_read_b128 v[184:187], v2 offset:4096
    v_mfma_f32_16x16x32_bf16 v[44:47], v[224:227], v[208:211], v[44:47]
    ds_read_b128 v[188:191], v2 offset:5120
    v_mfma_f32_16x16x32_bf16 v[48:51], v[228:231], v[204:207], v[48:51]
    ds_read_b128 v[192:195], v2 offset:6144
    v_mfma_f32_16x16x32_bf16 v[52:55], v[228:231], v[208:211], v[52:55]
    ds_read_b128 v[196:199], v2 offset:7168
    v_mfma_f32_16x16x32_bf16 v[56:59], v[232:235], v[204:207], v[56:59]
    ds_read_b128 v[200:203], v2 offset:8192
    v_mfma_f32_16x16x32_bf16 v[60:63], v[232:235], v[208:211], v[60:63]
    v_mfma_f32_16x16x32_bf16 v[64:67], v[236:239], v[204:207], v[64:67]
    v_mfma_f32_16x16x32_bf16 v[68:71], v[236:239], v[208:211], v[68:71]
    v_mfma_f32_16x16x32_bf16 v[72:75], v[240:243], v[204:207], v[72:75]
    v_mfma_f32_16x16x32_bf16 v[76:79], v[240:243], v[208:211], v[76:79]
    v_mfma_f32_16x16x32_bf16 v[80:83], v[244:247], v[204:207], v[80:83]
    s_sub_u32 s41, s41, 1
    v_mfma_f32_16x16x32_bf16 v[84:87], v[244:247], v[208:211], v[84:87]
    s_cmp_lg_u32 s41, 0
    s_cbranch_scc1 L_g_loop
    s_waitcnt lgkmcnt(5)
    v_mfma_f32_16x16x32_bf16 v[16:19], v[168:171], v[160:163], v[16:19]
    ds_read_b128 v[204:207], v11 offset:0
    v_mfma_f32_16x16x32_bf16 v[20:23], v[168:171], v[164:167], v[20:23]
    ds_read_b128 v[208:211], v11 offset:2048
    v_mfma_f32_16x16x32_bf16 v[24:27], v[172:175], v[160:163], v[24:27]
    ds_read_b128 v[212:215], v2 offset:9216
    v_mfma_f32_16x16x32_bf16 v[28:31], v[172:175], v[164:167], v[28:31]
    ds_read_b128 v[216:219], v2 offset:10240
    v_mfma_f32_16x16x32_bf16 v[32:35], v[176:179], v[160:163], v[32:35]
    ds_read_b128 v[220:223], v2 offset:11264
    v_mfma_f32_16x16x32_bf16 v[36:39], v[176:179], v[164:167], v[36:39]
    ds_read_b128 v[224:227], v2 offset:12288
    v_mfma_f32_16x16x32_bf16 v[40:43], v[180:183], v[160:163], v[40:43]
    ds_read_b128 v[228:231], v2 offset:13312
    v_mfma_f32_16x16x32_bf16 v[44:47], v[180:183], v[164:167], v[44:47]
    ds_read_b128 v[232:235], v2 offset:14336
    s_waitcnt lgkmcnt(8)
    v_mfma_f32_16x16x32_bf16 v[48:51], v[184:187], v[160:163], v[48:51]
    ds_read_b128 v[236:239], v2 offset:15360
    v_mfma_f32_16x16x32_bf16 v[52:55], v[184:187], v[164:167], v[52:55]
    ds_read_b128 v[240:243], v2 offset:16384
    v_mfma_f32_16x16x32_bf16 v[56:59], v[188:191], v[160:163], v[56:59]
    ds_read_b128 v[244:247], v2 offset:17408
    v_mfma_f32_16x16x32_bf16 v[60:63], v[188:191], v[164:167], v[60:63]
    v_mfma_f32_16x16x32_bf16 v[64:67], v[192:195], v[160:163], v[64:67]
    v_mfma_f32_16x16x32_bf16 v[68:71], v[192:195], v[164:167], v[68:71]
    v_mfma_f32_16x16x32_bf16 v[72:75], v[196:199], v[160:163], v[72:75]
    v_mfma_f32_16x16x32_bf16 v[76:79], v[196:199], v[164:167], v[76:79]
    v_mfma_f32_16x16x32_bf16 v[80:83], v[200:203], v[160:163], v[80:83]
    v_mfma_f32_16x16x32_bf16 v[84:87], v[200:203], v[164:167], v[84:87]
    s_waitcnt lgkmcnt(0)
    s_barrier
    v_mfma_f32_16x16x32_bf16 v[16:19], v[212:215], v[204:207], v[16:19]
    ds_read_b128 v[160:163], v10 offset:36864
    v_mfma_f32_16x16x32_bf16 v[20:23], v[212:215], v[208:211], v[20:23]
    ds_read_b128 v[164:167], v10 offset:38912
    v_mfma_f32_16x16x32_bf16 v[24:27], v[216:219], v[204:207], v[24:27]
    ds_read_b128 v[168:171], v2 offset:36864
    v_mfma_f32_16x16x32_bf16 v[28:31], v[216:219], v[208:211], v[28:31]
    ds_read_b128 v[172:175], v2 offset:37888
    v_mfma_f32_16x16x32_bf16 v[32:35], v[220:223], v[204:207], v[32:35]
    ds_read_b128 v[176:179], v2 offset:38912
    v_mfma_f32_16x16x32_bf16 v[36:39], v[220:223], v[208:211], v[36:39]
    ds_read_b128 v[180:183], v2 offset:39936
    v_mfma_f32_16x16x32_bf16 v[40:43], v[224:227], v[204:207], v[40:43]
    ds_read_b128 v[184:187], v2 offset:40960
    v_mfma_f32_16x16x32_bf16 v[44:47], v[224:227], v[208:211], v[44:47]
    ds_read_b128 v[188:191], v2 offset:41984
    v_mfma_f32_16x16x32_bf16 v[48:51], v[228:231], v[204:207], v[48:51]
    ds_read_b128 v[192:195], v2 offset:43008
    v_mfma_f32_16x16x32_bf16 v[52:55], v[228:231], v[208:211], v[52:55]
    ds_read_b128 v[196:199], v2 offset:44032
    v_mfma_f32_16x16x32_bf16 v[56:59], v[232:235], v[204:207], v[56:59]
    ds_read_b128 v[200:203], v2 offset:45056
    v_mfma_f32_16x16x32_bf16 v[60:63], v[232:235], v[208:211], v[60:63]
    v_mfma_f32_16x16x32_bf16 v[64:67], v[236:239], v[204:207], v[64:67]
    v_mfma_f32_16x16x32_bf16 v[68:71], v[236:239], v[208:211], v[68:71]
    v_mfma_f32_16x16x32_bf16 v[72:75], v[240:243], v[204:207], v[72:75]
    v_mfma_f32_16x16x32_bf16 v[76:79], v[240:243], v[208:211], v[76:79]
    v_mfma_f32_16x16x32_bf16 v[80:83], v[244:247], v[204:207], v[80:83]
    v_mfma_f32_16x16x32_bf16 v[84:87], v[244:247], v[208:211], v[84:87]
    s_waitcnt lgkmcnt(5)
    v_mfma_f32_16x16x32_bf16 v[16:19], v[168:171], v[160:163], v[16:19]
    ds_read_b128 v[204:207], v11 offset:36864
    v_mfma_f32_16x16x32_bf16 v[20:23], v[168:171], v[164:167], v[20:23]
    ds_read_b128 v[208:211], v11 offset:38912
    v_mfma_f32_16x16x32_bf16 v[24:27], v[172:175], v[160:163], v[24:27]
    ds_read_b128 v[212:215], v2 offset:46080
    v_mfma_f32_16x16x32_bf16 v[28:31], v[172:175], v[164:167], v[28:31]
    ds_read_b128 v[216:219], v2 offset:47104
    v_mfma_f32_16x16x32_bf16 v[32:35], v[176:179], v[160:163], v[32:35]
    ds_read_b128 v[220:223], v2 offset:48128
    v_mfma_f32_16x16x32_bf16 v[36:39], v[176:179], v[164:167], v[36:39]
    ds_read_b128 v[224:227], v2 offset:49152
    v_mfma_f32_16x16x32_bf16 v[40:43], v[180:183], v[160:163], v[40:43]
    ds_read_b128 v[228:231], v2 offset:50176
    v_mfma_f32_16x16x32_bf16 v[44:47], v[180:183], v[164:167], v[44:47]
    ds_read_b128 v[232:235], v2 offset:51200
    s_waitcnt lgkmcnt(8)
    v_mfma_f32_16x16x32_bf16 v[48:51], v[184:187], v[160:163], v[48:51]
    ds_read_b128 v[236:239], v2 offset:52224
    v_mfma_f32_16x16x32_bf16 v[52:55], v[184:187], v[164:167], v[52:55]
    ds_read_b128 v[240:243], v2 offset:53248
    v_mfma_f32_16x16x32_bf16 v[56:59], v[188:191], v[160:163], v[56:59]
    ds_read_b128 v[244:247], v2 offset:54272
    v_mfma_f32_16x16x32_bf16 v[60:63], v[188:191], v[164:167], v[60:63]
    v_mfma_f32_16x16x32_bf16 v[64:67], v[192:195], v[160:163], v[64:67]
    v_mfma_f32_16x16x32_bf16 v[68:71], v[192:195], v[164:167], v[68:71]
    v_mfma_f32_16x16x32_bf16 v[72:75], v[196:199], v[160:163], v[72:75]
    v_mfma_f32_16x16x32_bf16 v[76:79], v[196:199], v[164:167], v[76:79]
    v_mfma_f32_16x16x32_bf16 v[80:83], v[200:203], v[160:163], v[80:83]
    v_mfma_f32_16x16x32_bf16 v[84:87], v[200:203], v[164:167], v[84:87]
    s_waitcnt lgkmcnt(0)
    s_barrier
    v_mfma_f32_16x16x32_bf16 v[16:19], v[212:215], v[204:207], v[16:19]
    ds_read_b128 v[160:163], v8 offset:0
    v_mfma_f32_16x16x32_bf16 v[20:23], v[212:215], v[208:211], v[20:23]
    ds_read_b128 v[164:167], v8 offset:2048
    v_mfma_f32_16x16x32_bf16 v[24:27], v[216:219], v[204:207], v[24:27]
    ds_read_b128 v[192:195], v1 offset:0
    v_mfma_f32_16x16x32_bf16 v[28:31], v[216:219], v[208:211], v[28:31]
    ds_read_b128 v[168:171], v9 offset:0
    v_mfma_f32_16x16x32_bf16 v[32:35], v[220:223], v[204:207], v[32:35]
    ds_read_b128 v[172:175], v9 offset:2048
    v_mfma_f32_16x16x32_bf16 v[36:39], v[220:223], v[208:211], v[36:39]
    ds_read_b128 v[176:179], v8 offset:36864
    v_mfma_f32_16x16x32_bf16 v[40:43], v[224:227], v[204:207], v[40:43]
    ds_read_b128 v[180:183], v8 offset:38912
    v_mfma_f32_16x16x32_bf16 v[44:47], v[224:227], v[208:211], v[44:47]
    ds_read_b128 v[184:187], v9 offset:36864
    v_mfma_f32_16x16x32_bf16 v[48:51], v[228:231], v[204:207], v[48:51]
    ds_read_b128 v[188:191], v9 offset:38912
    v_mfma_f32_16x16x32_bf16 v[52:55], v[228:231], v[208:211], v[52:55]
    ds_read_b128 v[196:199], v1 offset:9216
    v_mfma_f32_16x16x32_bf16 v[56:59], v[232:235], v[204:207], v[56:59]
    ds_read_b128 v[200:203], v1 offset:36864
    v_mfma_f32_16x16x32_bf16 v[60:63], v[232:235], v[208:211], v[60:63]
    v_mfma_f32_16x16x32_bf16 v[64:67], v[236:239], v[204:207], v[64:67]
    v_mfma_f32_16x16x32_bf16 v[68:71], v[236:239], v[208:211], v[68:71]
    v_mfma_f32_16x16x32_bf16 v[72:75], v[240:243], v[204:207], v[72:75]
    v_mfma_f32_16x16x32_bf16 v[76:79], v[240:243], v[208:211], v[76:79]
    v_mfma_f32_16x16x32_bf16 v[80:83], v[244:247], v[204:207], v[80:83]
    v_mfma_f32_16x16x32_bf16 v[84:87], v[244:247], v[208:211], v[84:87]
    s_waitcnt lgkmcnt(0)
    v_mfma_f32_16x16x32_bf16 v[16:19], v[192:195], v[160:163], v[16:19]
    ds_read_b128 v[204:207], v1 offset:46080
    v_mfma_f32_16x16x32_bf16 v[20:23], v[192:195], v[164:167], v[20:23]
    ds_read_b128 v[208:211], v1 offset:1024
    s_waitcnt lgkmcnt(3)
    v_mfma_f32_16x16x32_bf16 v[16:19], v[196:199], v[168:171], v[16:19]
    ds_read_b128 v[212:215], v1 offset:10240
    v_mfma_f32_16x16x32_bf16 v[20:23], v[196:199], v[172:175], v[20:23]
    ds_read_b128 v[216:219], v1 offset:37888
    s_waitcnt lgkmcnt(4)
    v_mfma_f32_16x16x32_bf16 v[16:19], v[200:203], v[176:179], v[16:19]
    ds_read_b128 v[220:223], v1 offset:47104
    v_mfma_f32_16x16x32_bf16 v[20:23], v[200:203], v[180:183], v[20:23]
    ds_read_b128 v[224:227], v1 offset:2048
    s_waitcnt lgkmcnt(5)
    v_mfma_f32_16x16x32_bf16 v[16:19], v[204:207], v[184:187], v[16:19]
    ds_read_b128 v[228:231], v1 offset:11264
    v_mfma_f32_16x16x32_bf16 v[20:23], v[204:207], v[188:191], v[20:23]
    ds_read_b128 v[232:235], v1 offset:38912
    s_waitcnt lgkmcnt(6)
    v_mfma_f32_16x16x32_bf16 v[24:27], v[208:211], v[160:163], v[24:27]
    ds_read_b128 v[236:239], v1 offset:48128
    v_mfma_f32_16x16x32_bf16 v[28:31], v[208:211], v[164:167], v[28:31]
    ds_read_b128 v[240:243], v1 offset:3072
    s_waitcnt lgkmcnt(7)
    v_mfma_f32_16x16x32_bf16 v[24:27], v[212:215], v[168:171], v[24:27]
    ds_read_b128 v[244:247], v1 offset:12288
    v_mfma_f32_16x16x32_bf16 v[28:31], v[212:215], v[172:175], v[28:31]
    s_waitcnt lgkmcnt(7)
    v_mfma_f32_16x16x32_bf16 v[24:27], v[216:219], v[176:179], v[24:27]
    ds_read_b128 v[192:195], v1 offset:39936
    v_mul_f32 v16, v16, v88
    v_mfma_f32_16x16x32_bf16 v[28:31], v[216:219], v[180:183], v[28:31]
    v_mul_f32 v17, v17, v89
    v_mul_f32 v18, v18, v90
    s_waitcnt lgkmcnt(7)
    v_mfma_f32_16x16x32_bf16 v[24:27], v[220:223], v[184:187], v[24:27]
    ds_read_b128 v[196:199], v1 offset:49152
    v_mul_f32 v19, v19, v91
    v_mfma_f32_16x16x32_bf16 v[28:31], v[220:223], v[188:191], v[28:31]
    v_cvt_pk_bf16_f32 v88, v16, v17
    v_cvt_pk_bf16_f32 v89, v18, v19
    s_waitcnt lgkmcnt(7)
    v_mfma_f32_16x16x32_bf16 v[32:35], v[224:227], v[160:163], v[32:35]
    ds_read_b128 v[200:203], v1 offset:4096
    v_mul_f32 v20, v20, v92
    v_mfma_f32_16x16x32_bf16 v[36:39], v[224:227], v[164:167], v[36:39]
    v_mul_f32 v21, v21, v93
    v_mul_f32 v22, v22, v94
    s_waitcnt lgkmcnt(7)
    v_mfma_f32_16x16x32_bf16 v[32:35], v[228:231], v[168:171], v[32:35]
    ds_read_b128 v[204:207], v1 offset:13312
    v_mul_f32 v23, v23, v95
    v_mfma_f32_16x16x32_bf16 v[36:39], v[228:231], v[172:175], v[36:39]
    v_cvt_pk_bf16_f32 v92, v20, v21
    v_cvt_pk_bf16_f32 v93, v22, v23
    s_waitcnt lgkmcnt(7)
    v_mfma_f32_16x16x32_bf16 v[32:35], v[232:235], v[176:179], v[32:35]
    ds_read_b128 v[208:211], v1 offset:40960
    v_mul_f32 v24, v24, v96
    v_mfma_f32_16x16x32_bf16 v[36:39], v[232:235], v[180:183], v[36:39]
    v_mul_f32 v25, v25, v97
    v_mul_f32 v26, v26, v98
    v_mul_f32 v27, v27, v99
    s_waitcnt lgkmcnt(7)
    v_mfma_f32_16x16x32_bf16 v[32:35], v[236:239], v[184:187], v[32:35]
    ds_read_b128 v[212:215], v1 offset:50176
    v_cvt_pk_bf16_f32 v90, v24, v25
    v_mfma_f32_16x16x32_bf16 v[36:39], v[236:239], v[188:191], v[36:39]
    v_cvt_pk_bf16_f32 v91, v26, v27
    buffer_store_dwordx4 v[88:91], v14, s[4:7], s39 offen sc1
    s_waitcnt lgkmcnt(7)
    v_mfma_f32_16x16x32_bf16 v[40:43], v[240:243], v[160:163], v[40:43]
    ds_read_b128 v[216:219], v1 offset:5120
    v_mul_f32 v28, v28, v100
    v_mfma_f32_16x16x32_bf16 v[44:47], v[240:243], v[164:167], v[44:47]
    v_mul_f32 v29, v29, v101
    v_mul_f32 v30, v30, v102
    s_waitcnt lgkmcnt(7)
    v_mfma_f32_16x16x32_bf16 v[40:43], v[244:247], v[168:171], v[40:43]
    ds_read_b128 v[220:223], v1 offset:14336
    v_mul_f32 v31, v31, v103
    v_mfma_f32_16x16x32_bf16 v[44:47], v[244:247], v[172:175], v[44:47]
    v_cvt_pk_bf16_f32 v94, v28, v29
    v_cvt_pk_bf16_f32 v95, v30, v31
    s_waitcnt lgkmcnt(7)
    v_mfma_f32_16x16x32_bf16 v[40:43], v[192:195], v[176:179], v[40:43]
    ds_read_b128 v[224:227], v1 offset:41984
    buffer_store_dwordx4 v[92:95], v14, s[4:7], s40 offen sc1
    v_mfma_f32_16x16x32_bf16 v[44:47], v[192:195], v[180:183], v[44:47]
    v_add_u32 v14, 16384, v14
    v_mul_f32 v32, v32, v104
    v_mul_f32 v33, v33, v105
    s_waitcnt lgkmcnt(7)
    v_mfma_f32_16x16x32_bf16 v[40:43], v[196:199], v[184:187], v[40:43]
    ds_read_b128 v[228:231], v1 offset:51200
    v_mul_f32 v34, v34, v106
    v_mfma_f32_16x16x32_bf16 v[44:47], v[196:199], v[188:191], v[44:47]
    v_mul_f32 v35, v35, v107
    v_cvt_pk_bf16_f32 v104, v32, v33
    s_waitcnt lgkmcnt(7)
    v_mfma_f32_16x16x32_bf16 v[48:51], v[200:203], v[160:163], v[48:51]
    ds_read_b128 v[232:235], v1 offset:6144
    v_cvt_pk_bf16_f32 v105, v34, v35
    v_mfma_f32_16x16x32_bf16 v[52:55], v[200:203], v[164:167], v[52:55]
    v_mul_f32 v36, v36, v108
    v_mul_f32 v37, v37, v109
    s_waitcnt lgkmcnt(7)
    v_mfma_f32_16x16x32_bf16 v[48:51], v[204:207], v[168:171], v[48:51]
    ds_read_b128 v[236:239], v1 offset:15360
    v_mul_f32 v38, v38, v110
    v_mfma_f32_16x16x32_bf16 v[52:55], v[204:207], v[172:175], v[52:55]
    v_mul_f32 v39, v39, v111
    v_cvt_pk_bf16_f32 v108, v36, v37
    s_waitcnt lgkmcnt(7)
    v_mfma_f32_16x16x32_bf16 v[48:51], v[208:211], v[176:179], v[48:51]
    ds_read_b128 v[240:243], v1 offset:43008
    v_cvt_pk_bf16_f32 v109, v38, v39
    v_mfma_f32_16x16x32_bf16 v[52:55], v[208:211], v[180:183], v[52:55]
    v_mul_f32 v40, v40, v112
    v_mul_f32 v41, v41, v113
    v_mul_f32 v42, v42, v114
    s_waitcnt lgkmcnt(7)
    v_mfma_f32_16x16x32_bf16 v[48:51], v[212:215], v[184:187], v[48:51]
    ds_read_b128 v[244:247], v1 offset:52224
    v_mul_f32 v43, v43, v115
    v_mfma_f32_16x16x32_bf16 v[52:55], v[212:215], v[188:191], v[52:55]
    v_cvt_pk_bf16_f32 v106, v40, v41
    v_cvt_pk_bf16_f32 v107, v42, v43
    s_waitcnt lgkmcnt(7)
    v_mfma_f32_16x16x32_bf16 v[56:59], v[216:219], v[160:163], v[56:59]
    ds_read_b128 v[192:195], v1 offset:7168
    buffer_store_dwordx4 v[104:107], v14, s[4:7], s39 offen sc1
    v_mfma_f32_16x16x32_bf16 v[60:63], v[216:219], v[164:167], v[60:63]
    v_mul_f32 v44, v44, v116
    v_mul_f32 v45, v45, v117
    s_waitcnt lgkmcnt(7)
    v_mfma_f32_16x16x32_bf16 v[56:59], v[220:223], v[168:171], v[56:59]
    ds_read_b128 v[196:199], v1 offset:16384
    v_mul_f32 v46, v46, v118
    v_mfma_f32_16x16x32_bf16 v[60:63], v[220:223], v[172:175], v[60:63]
    v_mul_f32 v47, v47, v119
    v_cvt_pk_bf16_f32 v110, v44, v45
    s_waitcnt lgkmcnt(7)
    v_mfma_f32_16x16x32_bf16 v[56:59], v[224:227], v[176:179], v[56:59]
    ds_read_b128 v[200:203], v1 offset:44032
    v_cvt_pk_bf16_f32 v111, v46, v47
    v_mfma_f32_16x16x32_bf16 v[60:63], v[224:227], v[180:183], v[60:63]
    buffer_store_dwordx4 v[108:111], v14, s[4:7], s40 offen sc1
    v_add_u32 v14, 16384, v14
    v_mul_f32 v48, v48, v120
    s_waitcnt lgkmcnt(7)
    v_mfma_f32_16x16x32_bf16 v[56:59], v[228:231], v[184:187], v[56:59]
    ds_read_b128 v[204:207], v1 offset:53248
    v_mul_f32 v49, v49, v121
    v_mfma_f32_16x16x32_bf16 v[60:63], v[228:231], v[188:191], v[60:63]
    v_mul_f32 v50, v50, v122
    v_mul_f32 v51, v51, v123
    s_waitcnt lgkmcnt(7)
    v_mfma_f32_16x16x32_bf16 v[64:67], v[232:235], v[160:163], v[64:67]
    ds_read_b128 v[208:211], v1 offset:8192
    v_cvt_pk_bf16_f32 v120, v48, v49
    v_mfma_f32_16x16x32_bf16 v[68:71], v[232:235], v[164:167], v[68:71]
    v_cvt_pk_bf16_f32 v121, v50, v51
    v_mul_f32 v52, v52, v124
    s_waitcnt lgkmcnt(7)
    v_mfma_f32_16x16x32_bf16 v[64:67], v[236:239], v[168:171], v[64:67]
    ds_read_b128 v[212:215], v1 offset:17408
    v_mul_f32 v53, v53, v125
    v_mfma_f32_16x16x32_bf16 v[68:71], v[236:239], v[172:175], v[68:71]
    v_mul_f32 v54, v54, v126
    v_mul_f32 v55, v55, v127
    s_waitcnt lgkmcnt(7)
    v_mfma_f32_16x16x32_bf16 v[64:67], v[240:243], v[176:179], v[64:67]
    ds_read_b128 v[216:219], v1 offset:45056
    v_cvt_pk_bf16_f32 v124, v52, v53
    v_mfma_f32_16x16x32_bf16 v[68:71], v[240:243], v[180:183], v[68:71]
    v_cvt_pk_bf16_f32 v125, v54, v55
    v_mul_f32 v56, v56, v128
    v_mul_f32 v57, v57, v129
    s_waitcnt lgkmcnt(7)
    v_mfma_f32_16x16x32_bf16 v[64:67], v[244:247], v[184:187], v[64:67]
    ds_read_b128 v[220:223], v1 offset:54272
    v_mul_f32 v58, v58, v130
    v_mfma_f32_16x16x32_bf16 v[68:71], v[244:247], v[188:191], v[68:71]
    v_mul_f32 v59, v59, v131
    v_cvt_pk_bf16_f32 v122, v56, v57
    v_cvt_pk_bf16_f32 v123, v58, v59
    s_waitcnt lgkmcnt(7)
    v_mfma_f32_16x16x32_bf16 v[72:75], v[192:195], v[160:163], v[72:75]
    buffer_store_dwordx4 v[120:123], v14, s[4:7], s39 offen sc1
    v_mul_f32 v60, v60, v132
    v_mfma_f32_16x16x32_bf16 v[76:79], v[192:195], v[164:167], v[76:79]
    v_mul_f32 v61, v61, v133
    v_mul_f32 v62, v62, v134
    s_waitcnt lgkmcnt(6)
    v_mfma_f32_16x16x32_bf16 v[72:75], v[196:199], v[168:171], v[72:75]
    v_mul_f32 v63, v63, v135
    v_cvt_pk_bf16_f32 v126, v60, v61
    v_mfma_f32_16x16x32_bf16 v[76:79], v[196:199], v[172:175], v[76:79]
    v_cvt_pk_bf16_f32 v127, v62, v63
    buffer_store_dwordx4 v[124:127], v14, s[4:7], s40 offen sc1
    s_waitcnt lgkmcnt(5)
    v_mfma_f32_16x16x32_bf16 v[72:75], v[200:203], v[176:179], v[72:75]
    v_add_u32 v14, 16384, v14
    v_mul_f32 v64, v64, v136
    v_mfma_f32_16x16x32_bf16 v[76:79], v[200:203], v[180:183], v[76:79]
    v_mul_f32 v65, v65, v137
    v_mul_f32 v66, v66, v138
    v_mul_f32 v67, v67, v139
    s_waitcnt lgkmcnt(4)
    v_mfma_f32_16x16x32_bf16 v[72:75], v[204:207], v[184:187], v[72:75]
    v_cvt_pk_bf16_f32 v136, v64, v65
    v_cvt_pk_bf16_f32 v137, v66, v67
    v_mfma_f32_16x16x32_bf16 v[76:79], v[204:207], v[188:191], v[76:79]
    v_mul_f32 v68, v68, v140
    v_mul_f32 v69, v69, v141
    s_waitcnt lgkmcnt(3)
    v_mfma_f32_16x16x32_bf16 v[80:83], v[208:211], v[160:163], v[80:83]
    v_mul_f32 v70, v70, v142
    v_mul_f32 v71, v71, v143
    v_mfma_f32_16x16x32_bf16 v[84:87], v[208:211], v[164:167], v[84:87]
    v_cvt_pk_bf16_f32 v140, v68, v69
    v_cvt_pk_bf16_f32 v141, v70, v71
    s_waitcnt lgkmcnt(2)
    v_mfma_f32_16x16x32_bf16 v[80:83], v[212:215], v[168:171], v[80:83]
    v_mfma_f32_16x16x32_bf16 v[84:87], v[212:215], v[172:175], v[84:87]
    s_waitcnt lgkmcnt(1)
    v_mfma_f32_16x16x32_bf16 v[80:83], v[216:219], v[176:179], v[80:83]
    v_mul_f32 v72, v72, v144
    v_mul_f32 v73, v73, v145
    v_mfma_f32_16x16x32_bf16 v[84:87], v[216:219], v[180:183], v[84:87]
    v_mul_f32 v74, v74, v146
    v_mul_f32 v75, v75, v147
    v_cvt_pk_bf16_f32 v138, v72, v73
    s_waitcnt lgkmcnt(0)
    v_mfma_f32_16x16x32_bf16 v[80:83], v[220:223], v[184:187], v[80:83]
    v_cvt_pk_bf16_f32 v139, v74, v75
    buffer_store_dwordx4 v[136:139], v14, s[4:7], s39 offen sc1
    v_mfma_f32_16x16x32_bf16 v[84:87], v[220:223], v[188:191], v[84:87]
    v_mul_f32 v76, v76, v148
    v_mul_f32 v77, v77, v149
    v_mul_f32 v78, v78, v150
    v_mul_f32 v79, v79, v151
    v_cvt_pk_bf16_f32 v142, v76, v77
    v_cvt_pk_bf16_f32 v143, v78, v79
    buffer_store_dwordx4 v[140:143], v14, s[4:7], s40 offen sc1
    s_nop 1
    v_mul_f32 v80, v80, v152
    v_mul_f32 v81, v81, v153
    v_mul_f32 v82, v82, v154
    v_mul_f32 v83, v83, v155
    v_cvt_pk_bf16_f32 v152, v80, v81
    v_cvt_pk_bf16_f32 v153, v82, v83
    v_mul_f32 v84, v84, v156
    v_mul_f32 v85, v85, v157
    v_mul_f32 v86, v86, v158
    v_mul_f32 v87, v87, v159
    v_cvt_pk_bf16_f32 v154, v84, v85
    v_cvt_pk_bf16_f32 v155, v86, v87
    s_bitcmp0_b32 s24, 1
    s_cbranch_scc1 L_g_ns
    v_swap_b32 v152, v154
    v_swap_b32 v153, v155
L_g_ns:
    buffer_store_dwordx4 v[152:155], v15, s[4:7], s39 offen sc1
    s_barrier
    s_and_b32 s25, s2, 7
    s_lshr_b32 s26, s2, 3
    s_lshr_b32 s23, s25, 1
    s_lshl_b32 s23, s23, 3
    s_lshr_b32 s27, s26, 2
    s_add_u32 s23, s23, s27
    s_and_b32 s24, s25, 1
    s_lshl_b32 s24, s24, 2
    s_and_b32 s27, s26, 3
    s_add_u32 s24, s24, s27
    s_add_u32 s25, s23, s24
    s_and_b32 s25, s25, 3
    s_lshl_b32 s30, s23, 2
    s_add_u32 s30, s30, s20
    s_and_b32 s31, s20, 1
    s_mul_i32 s34, s30, 18432
    s_add_u32 s34, s34, s21
    s_add_u32 s34, s34, 0x300000
    s_lshl_b32 s35, s24, 11
    s_lshr_b32 s36, s24, 2
    s_lshl_b32 s36, s36, 10
    s_and_b32 s37, s24, 3
    s_lshl_b32 s37, s37, 8
    s_add_u32 s36, s36, s37
    s_add_u32 s36, s36, 16384
    v_bfe_u32 v2, v1, 4, 4
    v_lshrrev_b32 v3, 8, v1
    v_add_u32 v4, s35, v1
    v_lshrrev_b32 v0, 1, v3
    v_and_b32 v9, 1, v3
    v_cmp_eq_u32 s[40:41], s31, v0
    v_bfrev_b32 v6, 1
    v_lshlrev_b32 v5, 4, v2
    v_lshl_add_u32 v5, v9, 3, v5
    v_add_u32 v5, s36, v5
    v_cndmask_b32 v5, v6, v5, s[40:41]
    buffer_load_dwordx4 v[220:223], v4, s[4:7], s34 offen offset:0 sc1
    buffer_load_dwordx4 v[224:227], v4, s[4:7], s34 offen offset:1024 sc1
    buffer_load_dwordx2 v[228:229], v5, s[4:7], s34 offen sc1
    s_and_b32 s29, s30, 0xfffe
    s_mul_i32 s29, s29, 73728
    s_add_u32 s29, s29, s21
    s_lshl_b32 s37, s31, 10
    s_add_u32 s29, s29, s37
    s_add_u32 s29, s29, 0x1200000
    s_mul_i32 s37, s31, 73728
    s_sub_u32 s38, 73728, s37
    v_lshlrev_b32 v10, 3, v2
    v_add_u32 v16, s37, v1
    v_add_u32 v17, s38, v1
    v_mov_b32 v18, v1
    v_add_u32 v19, 73728, v1
    s_lshl_b32 s37, s31, 12
    v_add_u32 v20, 0, v1
    v_add_u32 v12, s37, v20
    v_add_u32 v21, 36864, v1
    v_add_u32 v13, s37, v21
    v_add_u32 v22, 73728, v1
    v_add_u32 v14, s37, v22
    v_add_u32 v23, 110592, v1
    v_add_u32 v15, s37, v23
    s_add_u32 s34, s34, 0x1900000
    s_lshl_b32 s39, s30, 10
    s_add_u32 s39, s39, s21
    s_lshl_b32 s42, s24, 7
    s_add_u32 s39, s39, s42
    s_add_u32 s39, s39, 0x3700000
    v_cmp_eq_u32 vcc, 0, v3
    v_mov_b32 v11, 0x3f803f80
    s_lshr_b32 s44, s23, 1
    v_cndmask_b32 v10, v6, v10, vcc
    s_cmp_eq_u32 s22, 0
    s_cbranch_scc1 L_p5_nf
    v_mul_u32_u24 v8, 1152, v2
    s_mul_i32 s34, s30, 18432
    s_mul_i32 s42, s24, 144
    s_add_u32 s34, s34, s42
    v_lshrrev_b32 v4, 6, v1
    v_bfe_u32 v5, v1, 4, 2
    v_lshlrev_b32 v10, 2, v4
    v_lshl_add_u32 v10, v5, 6, v10
    v_mul_u32_u24 v8, 1152, v4
    v_lshrrev_b32 v11, 1, v5
    v_cmp_eq_u32 vcc, s31, v11
    v_lshl_add_u32 v4, v5, 4, v8
    v_and_b32 v5, 1, v5
    v_lshl_add_u32 v5, v5, 3, v8
    v_cndmask_b32 v5, v6, v5, vcc
L_p5_nf:
    s_lshl_b32 s52, s22, 7
    s_add_u32 s52, s52, s44
    s_lshl_b32 s52, s52, 8
    s_add_u32 s52, s52, 0x450a000
    s_add_u32 s52, s52, s4
    s_addc_u32 s53, s5, 0
    s_waitcnt vmcnt(3)
    s_barrier
    s_cmp_lg_u32 s20, 0
    s_cbranch_scc1 L_ns_d5
    s_mov_b32 s56, 1
    s_atomic_add s56, s[50:51], 0
L_ns_d5:
    s_mul_i32 s37, s20, 4608
    s_add_u32 s37, s37, 131072
    s_xor_b32 s38, s20, 1
    s_mul_i32 s42, s38, 4608
    s_add_u32 s42, s42, 131072
    v_and_b32 v0, 0x1ff, v1
    v_add_u32 v2, s37, v1
    v_add_u32 v3, s37, v0
    v_add_u32 v7, s42, v1
    v_add_u32 v8, s42, v0
    s_lshl_b32 s37, s20, 2
    s_add_u32 s37, s37, 163808
    s_xor_b32 s38, s37, 4
    v_mov_b32 v0, s37
    v_mov_b32 v6, s38
    s_lshl_b32 s43, s22, 1
    s_add_u32 s43, s43, 2
    v_mov_b32 v9, s43
    s_cmp_lg_u32 s20, 0
    s_cbranch_scc1 L_pd_d5
    s_mov_b32 s60, 65536
L_poll_d5:
    s_mov_b32 s57, 0
    s_atomic_add s57, s[52:53], 0 glc
    s_waitcnt lgkmcnt(0)
    s_cmp_ge_u32 s57, 16
    s_cbranch_scc1 L_pd_d5
    s_sub_u32 s60, s60, 1
    s_cbranch_scc1 L_pd_d5
    s_sleep 2
    s_branch L_poll_d5
L_pd_d5:
    s_barrier
    s_mov_b32 s32, 0
    s_lshl_b32 s32, s32, 13
    s_add_u32 s32, s32, s29
    s_add_u32 s33, s32, 4096
    buffer_load_dwordx4 v[124:127], v16, s[4:7], s32 offen offset:0 sc1
    buffer_load_dwordx4 v[128:131], v17, s[4:7], s32 offen offset:0 sc1
    buffer_load_dwordx4 v[132:135], v16, s[4:7], s32 offen offset:2048 sc1
    buffer_load_dwordx4 v[136:139], v17, s[4:7], s32 offen offset:2048 sc1
    buffer_load_dwordx4 v[140:143], v16, s[4:7], s33 offen offset:0 sc1
    buffer_load_dwordx4 v[144:147], v17, s[4:7], s33 offen offset:0 sc1
    buffer_load_dwordx4 v[148:151], v16, s[4:7], s33 offen offset:2048 sc1
    buffer_load_dwordx4 v[152:155], v17, s[4:7], s33 offen offset:2048 sc1
    ds_read_b128 v[64:67], v14 offset:0
    ds_read_b128 v[68:71], v14 offset:1024
    ds_read_b128 v[72:75], v14 offset:2048
    ds_read_b128 v[76:79], v14 offset:3072
    ds_read_b128 v[80:83], v22 offset:8192
    ds_read_b128 v[84:87], v14 offset:9216
    ds_read_b128 v[88:91], v14 offset:10240
    ds_read_b128 v[92:95], v14 offset:11264
    ds_read_b128 v[96:99], v14 offset:12288
    ds_read_b128 v[100:103], v22 offset:17408
    s_add_u32 s45, s29, 8192
    s_add_u32 s46, s29, 12288
    buffer_load_dwordx4 v[156:159], v16, s[4:7], s45 offen offset:0 sc1
    buffer_load_dwordx4 v[160:163], v17, s[4:7], s45 offen offset:0 sc1
    s_lshl_b32 s50, s22, 7
    s_add_u32 s50, s50, s44
    s_lshl_b32 s50, s50, 8
    s_add_u32 s50, s50, 0x450b000
    s_add_u32 s50, s50, s4
    s_addc_u32 s51, s5, 0
    s_waitcnt vmcnt(10)
    v_lshlrev_b32 v24, 16, v220
    v_and_b32 v25, 0xffff0000, v220
    v_lshlrev_b32 v26, 16, v221
    v_and_b32 v27, 0xffff0000, v221
    v_lshlrev_b32 v28, 16, v222
    v_and_b32 v29, 0xffff0000, v222
    v_lshlrev_b32 v30, 16, v223
    v_and_b32 v31, 0xffff0000, v223
    v_lshlrev_b32 v32, 16, v224
    v_and_b32 v33, 0xffff0000, v224
    v_lshlrev_b32 v34, 16, v225
    v_and_b32 v35, 0xffff0000, v225
    v_lshlrev_b32 v36, 16, v226
    v_and_b32 v37, 0xffff0000, v226
    v_lshlrev_b32 v38, 16, v227
    v_and_b32 v39, 0xffff0000, v227
    v_lshlrev_b32 v40, 16, v228
    v_and_b32 v41, 0xffff0000, v228
    v_lshlrev_b32 v42, 16, v229
    v_and_b32 v43, 0xffff0000, v229
    s_waitcnt vmcnt(8) lgkmcnt(5)
    v_mfma_f32_16x16x32_bf16 v[44:47], v[64:67], v[128:131], 0
    ds_read_b128 v[104:107], v14 offset:18432
    s_mov_b32 s32, 2
    s_lshl_b32 s32, s32, 13
    s_add_u32 s32, s32, s29
    s_add_u32 s33, s32, 4096
    v_mfma_f32_16x16x32_bf16 v[24:27], v[64:67], v[124:127], v[24:27]
    ds_read_b128 v[108:111], v14 offset:19456
    buffer_load_dwordx4 v[164:167], v16, s[4:7], s45 offen offset:2048 sc1
    v_mfma_f32_16x16x32_bf16 v[48:51], v[68:71], v[128:131], 0
    ds_read_b128 v[112:115], v14 offset:20480
    v_mfma_f32_16x16x32_bf16 v[28:31], v[68:71], v[124:127], v[28:31]
    ds_read_b128 v[116:119], v14 offset:21504
    buffer_load_dwordx4 v[168:171], v17, s[4:7], s45 offen offset:2048 sc1
    v_mfma_f32_16x16x32_bf16 v[52:55], v[72:75], v[128:131], 0
    ds_read_b128 v[120:123], v22 offset:26624
    v_mfma_f32_16x16x32_bf16 v[32:35], v[72:75], v[124:127], v[32:35]
    buffer_load_dwordx4 v[188:191], v16, s[4:7], s32 offen offset:0 sc1
    v_mfma_f32_16x16x32_bf16 v[56:59], v[76:79], v[128:131], 0
    v_mfma_f32_16x16x32_bf16 v[36:39], v[76:79], v[124:127], v[36:39]
    buffer_load_dwordx4 v[192:195], v17, s[4:7], s32 offen offset:0 sc1
    v_mfma_f32_16x16x32_bf16 v[60:63], v[80:83], v[128:131], 0
    v_mfma_f32_16x16x32_bf16 v[40:43], v[80:83], v[124:127], v[40:43]
    s_waitcnt vmcnt(10) lgkmcnt(5)
    v_mfma_f32_16x16x32_bf16 v[44:47], v[84:87], v[136:139], v[44:47]
    ds_read_b128 v[64:67], v14 offset:27648
    v_mfma_f32_16x16x32_bf16 v[24:27], v[84:87], v[132:135], v[24:27]
    ds_read_b128 v[68:71], v14 offset:28672
    buffer_load_dwordx4 v[172:175], v16, s[4:7], s46 offen offset:0 sc1
    v_mfma_f32_16x16x32_bf16 v[48:51], v[88:91], v[136:139], v[48:51]
    ds_read_b128 v[72:75], v14 offset:29696
    v_mfma_f32_16x16x32_bf16 v[28:31], v[88:91], v[132:135], v[28:31]
    ds_read_b128 v[76:79], v14 offset:30720
    buffer_load_dwordx4 v[176:179], v17, s[4:7], s46 offen offset:0 sc1
    v_mfma_f32_16x16x32_bf16 v[52:55], v[92:95], v[136:139], v[52:55]
    ds_read_b128 v[80:83], v22 offset:35840
    v_mfma_f32_16x16x32_bf16 v[32:35], v[92:95], v[132:135], v[32:35]
    buffer_load_dwordx4 v[196:199], v16, s[4:7], s32 offen offset:2048 sc1
    v_mfma_f32_16x16x32_bf16 v[56:59], v[96:99], v[136:139], v[56:59]
    v_mfma_f32_16x16x32_bf16 v[36:39], v[96:99], v[132:135], v[36:39]
    buffer_load_dwordx4 v[200:203], v17, s[4:7], s32 offen offset:2048 sc1
    v_mfma_f32_16x16x32_bf16 v[60:63], v[100:103], v[136:139], v[60:63]
    v_mfma_f32_16x16x32_bf16 v[40:43], v[100:103], v[132:135], v[40:43]
    s_waitcnt vmcnt(12) lgkmcnt(0)
    s_barrier
    v_mfma_f32_16x16x32_bf16 v[44:47], v[104:107], v[144:147], v[44:47]
    ds_read_b128 v[84:87], v15 offset:0
    v_mfma_f32_16x16x32_bf16 v[24:27], v[104:107], v[140:143], v[24:27]
    ds_read_b128 v[88:91], v15 offset:1024
    buffer_load_dwordx4 v[180:183], v16, s[4:7], s46 offen offset:2048 sc1
    v_mfma_f32_16x16x32_bf16 v[48:51], v[108:111], v[144:147], v[48:51]
    ds_read_b128 v[92:95], v15 offset:2048
    v_mfma_f32_16x16x32_bf16 v[28:31], v[108:111], v[140:143], v[28:31]
    ds_read_b128 v[96:99], v15 offset:3072
    buffer_load_dwordx4 v[184:187], v17, s[4:7], s46 offen offset:2048 sc1
    v_mfma_f32_16x16x32_bf16 v[52:55], v[112:115], v[144:147], v[52:55]
    ds_read_b128 v[100:103], v23 offset:8192
    v_mfma_f32_16x16x32_bf16 v[32:35], v[112:115], v[140:143], v[32:35]
    buffer_load_dwordx4 v[204:207], v16, s[4:7], s33 offen offset:0 sc1
    v_mfma_f32_16x16x32_bf16 v[56:59], v[116:119], v[144:147], v[56:59]
    v_mfma_f32_16x16x32_bf16 v[36:39], v[116:119], v[140:143], v[36:39]
    buffer_load_dwordx4 v[208:211], v17, s[4:7], s33 offen offset:0 sc1
    v_mfma_f32_16x16x32_bf16 v[60:63], v[120:123], v[144:147], v[60:63]
    v_mfma_f32_16x16x32_bf16 v[40:43], v[120:123], v[140:143], v[40:43]
    s_waitcnt vmcnt(14) lgkmcnt(5)
    v_mfma_f32_16x16x32_bf16 v[44:47], v[64:67], v[152:155], v[44:47]
    ds_read_b128 v[104:107], v15 offset:9216
    v_mfma_f32_16x16x32_bf16 v[24:27], v[64:67], v[148:151], v[24:27]
    ds_read_b128 v[108:111], v15 offset:10240
    v_mfma_f32_16x16x32_bf16 v[48:51], v[68:71], v[152:155], v[48:51]
    ds_read_b128 v[112:115], v15 offset:11264
    v_mfma_f32_16x16x32_bf16 v[28:31], v[68:71], v[148:151], v[28:31]
    ds_read_b128 v[116:119], v15 offset:12288
    v_mfma_f32_16x16x32_bf16 v[52:55], v[72:75], v[152:155], v[52:55]
    ds_read_b128 v[120:123], v23 offset:17408
    v_mfma_f32_16x16x32_bf16 v[32:35], v[72:75], v[148:151], v[32:35]
    buffer_load_dwordx4 v[212:215], v16, s[4:7], s33 offen offset:2048 sc1
    v_mfma_f32_16x16x32_bf16 v[56:59], v[76:79], v[152:155], v[56:59]
    v_mfma_f32_16x16x32_bf16 v[36:39], v[76:79], v[148:151], v[36:39]
    buffer_load_dwordx4 v[216:219], v17, s[4:7], s33 offen offset:2048 sc1
    v_mfma_f32_16x16x32_bf16 v[60:63], v[80:83], v[152:155], v[60:63]
    v_mfma_f32_16x16x32_bf16 v[40:43], v[80:83], v[148:151], v[40:43]
    s_waitcnt vmcnt(14) lgkmcnt(5)
    v_mfma_f32_16x16x32_bf16 v[44:47], v[84:87], v[160:163], v[44:47]
    ds_read_b128 v[64:67], v15 offset:18432
    s_mov_b32 s32, 3
    s_lshl_b32 s32, s32, 13
    s_add_u32 s32, s32, s29
    s_add_u32 s33, s32, 4096
    v_mfma_f32_16x16x32_bf16 v[24:27], v[84:87], v[156:159], v[24:27]
    ds_read_b128 v[68:71], v15 offset:19456
    v_mfma_f32_16x16x32_bf16 v[48:51], v[88:91], v[160:163], v[48:51]
    ds_read_b128 v[72:75], v15 offset:20480
    v_mfma_f32_16x16x32_bf16 v[28:31], v[88:91], v[156:159], v[28:31]
    ds_read_b128 v[76:79], v15 offset:21504
    v_mfma_f32_16x16x32_bf16 v[52:55], v[92:95], v[160:163], v[52:55]
    ds_read_b128 v[80:83], v23 offset:26624
    v_mfma_f32_16x16x32_bf16 v[32:35], v[92:95], v[156:159], v[32:35]
    buffer_load_dwordx4 v[124:127], v16, s[4:7], s32 offen offset:0 sc1
    v_mfma_f32_16x16x32_bf16 v[56:59], v[96:99], v[160:163], v[56:59]
    v_mfma_f32_16x16x32_bf16 v[36:39], v[96:99], v[156:159], v[36:39]
    buffer_load_dwordx4 v[128:131], v17, s[4:7], s32 offen offset:0 sc1
    v_mfma_f32_16x16x32_bf16 v[60:63], v[100:103], v[160:163], v[60:63]
    v_mfma_f32_16x16x32_bf16 v[40:43], v[100:103], v[156:159], v[40:43]
    s_waitcnt vmcnt(14) lgkmcnt(5)
    v_mfma_f32_16x16x32_bf16 v[44:47], v[104:107], v[168:171], v[44:47]
    ds_read_b128 v[84:87], v15 offset:27648
    v_mfma_f32_16x16x32_bf16 v[24:27], v[104:107], v[164:167], v[24:27]
    ds_read_b128 v[88:91], v15 offset:28672
    v_mfma_f32_16x16x32_bf16 v[48:51], v[108:111], v[168:171], v[48:51]
    ds_read_b128 v[92:95], v15 offset:29696
    v_mfma_f32_16x16x32_bf16 v[28:31], v[108:111], v[164:167], v[28:31]
    ds_read_b128 v[96:99], v15 offset:30720
    v_mfma_f32_16x16x32_bf16 v[52:55], v[112:115], v[168:171], v[52:55]
    ds_read_b128 v[100:103], v23 offset:35840
    v_mfma_f32_16x16x32_bf16 v[32:35], v[112:115], v[164:167], v[32:35]
    buffer_load_dwordx4 v[132:135], v16, s[4:7], s32 offen offset:2048 sc1
    v_mfma_f32_16x16x32_bf16 v[56:59], v[116:119], v[168:171], v[56:59]
    v_mfma_f32_16x16x32_bf16 v[36:39], v[116:119], v[164:167], v[36:39]
    buffer_load_dwordx4 v[136:139], v17, s[4:7], s32 offen offset:2048 sc1
    v_mfma_f32_16x16x32_bf16 v[60:63], v[120:123], v[168:171], v[60:63]
    v_mfma_f32_16x16x32_bf16 v[40:43], v[120:123], v[164:167], v[40:43]
    s_waitcnt vmcnt(12) lgkmcnt(0)
    s_barrier
    v_mfma_f32_16x16x32_bf16 v[44:47], v[64:67], v[176:179], v[44:47]
    ds_read_b128 v[104:107], v12 offset:0
    v_mfma_f32_16x16x32_bf16 v[24:27], v[64:67], v[172:175], v[24:27]
    ds_read_b128 v[108:111], v12 offset:1024
    v_mfma_f32_16x16x32_bf16 v[48:51], v[68:71], v[176:179], v[48:51]
    ds_read_b128 v[112:115], v12 offset:2048
    v_mfma_f32_16x16x32_bf16 v[28:31], v[68:71], v[172:175], v[28:31]
    ds_read_b128 v[116:119], v12 offset:3072
    v_mfma_f32_16x16x32_bf16 v[52:55], v[72:75], v[176:179], v[52:55]
    ds_read_b128 v[120:123], v20 offset:8192
    v_mfma_f32_16x16x32_bf16 v[32:35], v[72:75], v[172:175], v[32:35]
    buffer_load_dwordx4 v[140:143], v16, s[4:7], s33 offen offset:0 sc1
    v_mfma_f32_16x16x32_bf16 v[56:59], v[76:79], v[176:179], v[56:59]
    v_mfma_f32_16x16x32_bf16 v[36:39], v[76:79], v[172:175], v[36:39]
    buffer_load_dwordx4 v[144:147], v17, s[4:7], s33 offen offset:0 sc1
    v_mfma_f32_16x16x32_bf16 v[60:63], v[80:83], v[176:179], v[60:63]
    v_mfma_f32_16x16x32_bf16 v[40:43], v[80:83], v[172:175], v[40:43]
    s_waitcnt vmcnt(10) lgkmcnt(5)
    v_mfma_f32_16x16x32_bf16 v[44:47], v[84:87], v[184:187], v[44:47]
    ds_read_b128 v[64:67], v12 offset:9216
    v_mfma_f32_16x16x32_bf16 v[24:27], v[84:87], v[180:183], v[24:27]
    ds_read_b128 v[68:71], v12 offset:10240
    v_mfma_f32_16x16x32_bf16 v[48:51], v[88:91], v[184:187], v[48:51]
    ds_read_b128 v[72:75], v12 offset:11264
    v_mfma_f32_16x16x32_bf16 v[28:31], v[88:91], v[180:183], v[28:31]
    ds_read_b128 v[76:79], v12 offset:12288
    v_mfma_f32_16x16x32_bf16 v[52:55], v[92:95], v[184:187], v[52:55]
    ds_read_b128 v[80:83], v20 offset:17408
    v_mfma_f32_16x16x32_bf16 v[32:35], v[92:95], v[180:183], v[32:35]
    buffer_load_dwordx4 v[148:151], v16, s[4:7], s33 offen offset:2048 sc1
    v_mfma_f32_16x16x32_bf16 v[56:59], v[96:99], v[184:187], v[56:59]
    v_mfma_f32_16x16x32_bf16 v[36:39], v[96:99], v[180:183], v[36:39]
    buffer_load_dwordx4 v[152:155], v17, s[4:7], s33 offen offset:2048 sc1
    v_mfma_f32_16x16x32_bf16 v[60:63], v[100:103], v[184:187], v[60:63]
    v_mfma_f32_16x16x32_bf16 v[40:43], v[100:103], v[180:183], v[40:43]
    s_waitcnt vmcnt(12) lgkmcnt(5)
    v_mfma_f32_16x16x32_bf16 v[44:47], v[104:107], v[192:195], v[44:47]
    ds_read_b128 v[84:87], v12 offset:18432
    s_mov_b32 s32, 4
    s_lshl_b32 s32, s32, 13
    s_add_u32 s32, s32, s29
    s_add_u32 s33, s32, 4096
    v_mfma_f32_16x16x32_bf16 v[24:27], v[104:107], v[188:191], v[24:27]
    ds_read_b128 v[88:91], v12 offset:19456
    v_mfma_f32_16x16x32_bf16 v[48:51], v[108:111], v[192:195], v[48:51]
    ds_read_b128 v[92:95], v12 offset:20480
    v_mfma_f32_16x16x32_bf16 v[28:31], v[108:111], v[188:191], v[28:31]
    ds_read_b128 v[96:99], v12 offset:21504
    v_mfma_f32_16x16x32_bf16 v[52:55], v[112:115], v[192:195], v[52:55]
    ds_read_b128 v[100:103], v20 offset:26624
    v_mfma_f32_16x16x32_bf16 v[32:35], v[112:115], v[188:191], v[32:35]
    buffer_load_dwordx4 v[156:159], v16, s[4:7], s32 offen offset:0 sc1
    v_mfma_f32_16x16x32_bf16 v[56:59], v[116:119], v[192:195], v[56:59]
    v_mfma_f32_16x16x32_bf16 v[36:39], v[116:119], v[188:191], v[36:39]
    buffer_load_dwordx4 v[160:163], v17, s[4:7], s32 offen offset:0 sc1
    v_mfma_f32_16x16x32_bf16 v[60:63], v[120:123], v[192:195], v[60:63]
    v_mfma_f32_16x16x32_bf16 v[40:43], v[120:123], v[188:191], v[40:43]
    s_waitcnt vmcnt(14) lgkmcnt(5)
    v_mfma_f32_16x16x32_bf16 v[44:47], v[64:67], v[200:203], v[44:47]
    ds_read_b128 v[104:107], v12 offset:27648
    v_mfma_f32_16x16x32_bf16 v[24:27], v[64:67], v[196:199], v[24:27]
    ds_read_b128 v[108:111], v12 offset:28672
    v_mfma_f32_16x16x32_bf16 v[48:51], v[68:71], v[200:203], v[48:51]
    ds_read_b128 v[112:115], v12 offset:29696
    v_mfma_f32_16x16x32_bf16 v[28:31], v[68:71], v[196:199], v[28:31]
    ds_read_b128 v[116:119], v12 offset:30720
    v_mfma_f32_16x16x32_bf16 v[52:55], v[72:75], v[200:203], v[52:55]
    ds_read_b128 v[120:123], v20 offset:35840
    v_mfma_f32_16x16x32_bf16 v[32:35], v[72:75], v[196:199], v[32:35]
    buffer_load_dwordx4 v[164:167], v16, s[4:7], s32 offen offset:2048 sc1
    v_mfma_f32_16x16x32_bf16 v[56:59], v[76:79], v[200:203], v[56:59]
    v_mfma_f32_16x16x32_bf16 v[36:39], v[76:79], v[196:199], v[36:39]
    buffer_load_dwordx4 v[168:171], v17, s[4:7], s32 offen offset:2048 sc1
    v_mfma_f32_16x16x32_bf16 v[60:63], v[80:83], v[200:203], v[60:63]
    v_mfma_f32_16x16x32_bf16 v[40:43], v[80:83], v[196:199], v[40:43]
    s_waitcnt vmcnt(14) lgkmcnt(0)
    s_barrier
    v_mfma_f32_16x16x32_bf16 v[44:47], v[84:87], v[208:211], v[44:47]
    ds_read_b128 v[64:67], v13 offset:0
    v_mfma_f32_16x16x32_bf16 v[24:27], v[84:87], v[204:207], v[24:27]
    ds_read_b128 v[68:71], v13 offset:1024
    v_mfma_f32_16x16x32_bf16 v[48:51], v[88:91], v[208:211], v[48:51]
    ds_read_b128 v[72:75], v13 offset:2048
    v_mfma_f32_16x16x32_bf16 v[28:31], v[88:91], v[204:207], v[28:31]
    ds_read_b128 v[76:79], v13 offset:3072
    v_mfma_f32_16x16x32_bf16 v[52:55], v[92:95], v[208:211], v[52:55]
    ds_read_b128 v[80:83], v21 offset:8192
    v_mfma_f32_16x16x32_bf16 v[32:35], v[92:95], v[204:207], v[32:35]
    buffer_load_dwordx4 v[172:175], v16, s[4:7], s33 offen offset:0 sc1
    v_mfma_f32_16x16x32_bf16 v[56:59], v[96:99], v[208:211], v[56:59]
    v_mfma_f32_16x16x32_bf16 v[36:39], v[96:99], v[204:207], v[36:39]
    buffer_load_dwordx4 v[176:179], v17, s[4:7], s33 offen offset:0 sc1
    v_mfma_f32_16x16x32_bf16 v[60:63], v[100:103], v[208:211], v[60:63]
    v_mfma_f32_16x16x32_bf16 v[40:43], v[100:103], v[204:207], v[40:43]
    s_waitcnt vmcnt(14) lgkmcnt(5)
    v_mfma_f32_16x16x32_bf16 v[44:47], v[104:107], v[216:219], v[44:47]
    ds_read_b128 v[84:87], v13 offset:9216
    v_mfma_f32_16x16x32_bf16 v[24:27], v[104:107], v[212:215], v[24:27]
    ds_read_b128 v[88:91], v13 offset:10240
    v_mfma_f32_16x16x32_bf16 v[48:51], v[108:111], v[216:219], v[48:51]
    ds_read_b128 v[92:95], v13 offset:11264
    v_mfma_f32_16x16x32_bf16 v[28:31], v[108:111], v[212:215], v[28:31]
    ds_read_b128 v[96:99], v13 offset:12288
    v_mfma_f32_16x16x32_bf16 v[52:55], v[112:115], v[216:219], v[52:55]
    ds_read_b128 v[100:103], v21 offset:17408
    v_mfma_f32_16x16x32_bf16 v[32:35], v[112:115], v[212:215], v[32:35]
    buffer_load_dwordx4 v[180:183], v16, s[4:7], s33 offen offset:2048 sc1
    v_mfma_f32_16x16x32_bf16 v[56:59], v[116:119], v[216:219], v[56:59]
    v_mfma_f32_16x16x32_bf16 v[36:39], v[116:119], v[212:215], v[36:39]
    buffer_load_dwordx4 v[184:187], v17, s[4:7], s33 offen offset:2048 sc1
    v_mfma_f32_16x16x32_bf16 v[60:63], v[120:123], v[216:219], v[60:63]
    v_mfma_f32_16x16x32_bf16 v[40:43], v[120:123], v[212:215], v[40:43]
    s_waitcnt vmcnt(14) lgkmcnt(5)
    v_mfma_f32_16x16x32_bf16 v[44:47], v[64:67], v[128:131], v[44:47]
    ds_read_b128 v[104:107], v13 offset:18432
    s_mov_b32 s32, 5
    s_lshl_b32 s32, s32, 13
    s_add_u32 s32, s32, s29
    s_add_u32 s33, s32, 4096
    v_mfma_f32_16x16x32_bf16 v[24:27], v[64:67], v[124:127], v[24:27]
    ds_read_b128 v[108:111], v13 offset:19456
    v_mfma_f32_16x16x32_bf16 v[48:51], v[68:71], v[128:131], v[48:51]
    ds_read_b128 v[112:115], v13 offset:20480
    v_mfma_f32_16x16x32_bf16 v[28:31], v[68:71], v[124:127], v[28:31]
    ds_read_b128 v[116:119], v13 offset:21504
    v_mfma_f32_16x16x32_bf16 v[52:55], v[72:75], v[128:131], v[52:55]
    ds_read_b128 v[120:123], v21 offset:26624
    v_mfma_f32_16x16x32_bf16 v[32:35], v[72:75], v[124:127], v[32:35]
    buffer_load_dwordx4 v[188:191], v16, s[4:7], s32 offen offset:0 sc1
    v_mfma_f32_16x16x32_bf16 v[56:59], v[76:79], v[128:131], v[56:59]
    v_mfma_f32_16x16x32_bf16 v[36:39], v[76:79], v[124:127], v[36:39]
    buffer_load_dwordx4 v[192:195], v17, s[4:7], s32 offen offset:0 sc1
    v_mfma_f32_16x16x32_bf16 v[60:63], v[80:83], v[128:131], v[60:63]
    v_mfma_f32_16x16x32_bf16 v[40:43], v[80:83], v[124:127], v[40:43]
    s_waitcnt vmcnt(14) lgkmcnt(5)
    v_mfma_f32_16x16x32_bf16 v[44:47], v[84:87], v[136:139], v[44:47]
    ds_read_b128 v[64:67], v13 offset:27648
    v_mfma_f32_16x16x32_bf16 v[24:27], v[84:87], v[132:135], v[24:27]
    ds_read_b128 v[68:71], v13 offset:28672
    v_mfma_f32_16x16x32_bf16 v[48:51], v[88:91], v[136:139], v[48:51]
    ds_read_b128 v[72:75], v13 offset:29696
    v_mfma_f32_16x16x32_bf16 v[28:31], v[88:91], v[132:135], v[28:31]
    ds_read_b128 v[76:79], v13 offset:30720
    v_mfma_f32_16x16x32_bf16 v[52:55], v[92:95], v[136:139], v[52:55]
    ds_read_b128 v[80:83], v21 offset:35840
    v_mfma_f32_16x16x32_bf16 v[32:35], v[92:95], v[132:135], v[32:35]
    buffer_load_dwordx4 v[196:199], v16, s[4:7], s32 offen offset:2048 sc1
    v_mfma_f32_16x16x32_bf16 v[56:59], v[96:99], v[136:139], v[56:59]
    v_mfma_f32_16x16x32_bf16 v[36:39], v[96:99], v[132:135], v[36:39]
    buffer_load_dwordx4 v[200:203], v17, s[4:7], s32 offen offset:2048 sc1
    v_mfma_f32_16x16x32_bf16 v[60:63], v[100:103], v[136:139], v[60:63]
    v_mfma_f32_16x16x32_bf16 v[40:43], v[100:103], v[132:135], v[40:43]
    s_waitcnt vmcnt(14) lgkmcnt(0)
    s_barrier
    v_mfma_f32_16x16x32_bf16 v[44:47], v[104:107], v[144:147], v[44:47]
    ds_read_b128 v[84:87], v14 offset:0
    v_mfma_f32_16x16x32_bf16 v[24:27], v[104:107], v[140:143], v[24:27]
    ds_read_b128 v[88:91], v14 offset:1024
    v_mfma_f32_16x16x32_bf16 v[48:51], v[108:111], v[144:147], v[48:51]
    ds_read_b128 v[92:95], v14 offset:2048
    v_mfma_f32_16x16x32_bf16 v[28:31], v[108:111], v[140:143], v[28:31]
    ds_read_b128 v[96:99], v14 offset:3072
    v_mfma_f32_16x16x32_bf16 v[52:55], v[112:115], v[144:147], v[52:55]
    ds_read_b128 v[100:103], v22 offset:8192
    v_mfma_f32_16x16x32_bf16 v[32:35], v[112:115], v[140:143], v[32:35]
    buffer_load_dwordx4 v[204:207], v16, s[4:7], s33 offen offset:0 sc1
    v_mfma_f32_16x16x32_bf16 v[56:59], v[116:119], v[144:147], v[56:59]
    v_mfma_f32_16x16x32_bf16 v[36:39], v[116:119], v[140:143], v[36:39]
    buffer_load_dwordx4 v[208:211], v17, s[4:7], s33 offen offset:0 sc1
    v_mfma_f32_16x16x32_bf16 v[60:63], v[120:123], v[144:147], v[60:63]
    v_mfma_f32_16x16x32_bf16 v[40:43], v[120:123], v[140:143], v[40:43]
    s_waitcnt vmcnt(14) lgkmcnt(5)
    v_mfma_f32_16x16x32_bf16 v[44:47], v[64:67], v[152:155], v[44:47]
    ds_read_b128 v[104:107], v14 offset:9216
    v_mfma_f32_16x16x32_bf16 v[24:27], v[64:67], v[148:151], v[24:27]
    ds_read_b128 v[108:111], v14 offset:10240
    v_mfma_f32_16x16x32_bf16 v[48:51], v[68:71], v[152:155], v[48:51]
    ds_read_b128 v[112:115], v14 offset:11264
    v_mfma_f32_16x16x32_bf16 v[28:31], v[68:71], v[148:151], v[28:31]
    ds_read_b128 v[116:119], v14 offset:12288
    v_mfma_f32_16x16x32_bf16 v[52:55], v[72:75], v[152:155], v[52:55]
    ds_read_b128 v[120:123], v22 offset:17408
    v_mfma_f32_16x16x32_bf16 v[32:35], v[72:75], v[148:151], v[32:35]
    buffer_load_dwordx4 v[212:215], v16, s[4:7], s33 offen offset:2048 sc1
    v_mfma_f32_16x16x32_bf16 v[56:59], v[76:79], v[152:155], v[56:59]
    v_mfma_f32_16x16x32_bf16 v[36:39], v[76:79], v[148:151], v[36:39]
    buffer_load_dwordx4 v[216:219], v17, s[4:7], s33 offen offset:2048 sc1
    v_mfma_f32_16x16x32_bf16 v[60:63], v[80:83], v[152:155], v[60:63]
    v_mfma_f32_16x16x32_bf16 v[40:43], v[80:83], v[148:151], v[40:43]
    s_waitcnt vmcnt(14) lgkmcnt(5)
    v_mfma_f32_16x16x32_bf16 v[44:47], v[84:87], v[160:163], v[44:47]
    ds_read_b128 v[64:67], v14 offset:18432
    s_mov_b32 s32, 6
    s_lshl_b32 s32, s32, 13
    s_add_u32 s32, s32, s29
    s_add_u32 s33, s32, 4096
    v_mfma_f32_16x16x32_bf16 v[24:27], v[84:87], v[156:159], v[24:27]
    ds_read_b128 v[68:71], v14 offset:19456
    v_mfma_f32_16x16x32_bf16 v[48:51], v[88:91], v[160:163], v[48:51]
    ds_read_b128 v[72:75], v14 offset:20480
    v_mfma_f32_16x16x32_bf16 v[28:31], v[88:91], v[156:159], v[28:31]
    ds_read_b128 v[76:79], v14 offset:21504
    v_mfma_f32_16x16x32_bf16 v[52:55], v[92:95], v[160:163], v[52:55]
    ds_read_b128 v[80:83], v22 offset:26624
    v_mfma_f32_16x16x32_bf16 v[32:35], v[92:95], v[156:159], v[32:35]
    buffer_load_dwordx4 v[124:127], v16, s[4:7], s32 offen offset:0 sc1
    v_mfma_f32_16x16x32_bf16 v[56:59], v[96:99], v[160:163], v[56:59]
    v_mfma_f32_16x16x32_bf16 v[36:39], v[96:99], v[156:159], v[36:39]
    buffer_load_dwordx4 v[128:131], v17, s[4:7], s32 offen offset:0 sc1
    v_mfma_f32_16x16x32_bf16 v[60:63], v[100:103], v[160:163], v[60:63]
    v_mfma_f32_16x16x32_bf16 v[40:43], v[100:103], v[156:159], v[40:43]
    s_waitcnt vmcnt(14) lgkmcnt(5)
    v_mfma_f32_16x16x32_bf16 v[44:47], v[104:107], v[168:171], v[44:47]
    ds_read_b128 v[84:87], v14 offset:27648
    v_mfma_f32_16x16x32_bf16 v[24:27], v[104:107], v[164:167], v[24:27]
    ds_read_b128 v[88:91], v14 offset:28672
    v_mfma_f32_16x16x32_bf16 v[48:51], v[108:111], v[168:171], v[48:51]
    ds_read_b128 v[92:95], v14 offset:29696
    v_mfma_f32_16x16x32_bf16 v[28:31], v[108:111], v[164:167], v[28:31]
    ds_read_b128 v[96:99], v14 offset:30720
    v_mfma_f32_16x16x32_bf16 v[52:55], v[112:115], v[168:171], v[52:55]
    ds_read_b128 v[100:103], v22 offset:35840
    v_mfma_f32_16x16x32_bf16 v[32:35], v[112:115], v[164:167], v[32:35]
    buffer_load_dwordx4 v[132:135], v16, s[4:7], s32 offen offset:2048 sc1
    v_mfma_f32_16x16x32_bf16 v[56:59], v[116:119], v[168:171], v[56:59]
    v_mfma_f32_16x16x32_bf16 v[36:39], v[116:119], v[164:167], v[36:39]
    buffer_load_dwordx4 v[136:139], v17, s[4:7], s32 offen offset:2048 sc1
    v_mfma_f32_16x16x32_bf16 v[60:63], v[120:123], v[168:171], v[60:63]
    v_mfma_f32_16x16x32_bf16 v[40:43], v[120:123], v[164:167], v[40:43]
    s_waitcnt vmcnt(14) lgkmcnt(0)
    s_barrier
    v_mfma_f32_16x16x32_bf16 v[44:47], v[64:67], v[176:179], v[44:47]
    ds_read_b128 v[104:107], v15 offset:0
    v_mfma_f32_16x16x32_bf16 v[24:27], v[64:67], v[172:175], v[24:27]
    ds_read_b128 v[108:111], v15 offset:1024
    v_mfma_f32_16x16x32_bf16 v[48:51], v[68:71], v[176:179], v[48:51]
    ds_read_b128 v[112:115], v15 offset:2048
    v_mfma_f32_16x16x32_bf16 v[28:31], v[68:71], v[172:175], v[28:31]
    ds_read_b128 v[116:119], v15 offset:3072
    v_mfma_f32_16x16x32_bf16 v[52:55], v[72:75], v[176:179], v[52:55]
    ds_read_b128 v[120:123], v23 offset:8192
    v_mfma_f32_16x16x32_bf16 v[32:35], v[72:75], v[172:175], v[32:35]
    buffer_load_dwordx4 v[140:143], v16, s[4:7], s33 offen offset:0 sc1
    v_mfma_f32_16x16x32_bf16 v[56:59], v[76:79], v[176:179], v[56:59]
    v_mfma_f32_16x16x32_bf16 v[36:39], v[76:79], v[172:175], v[36:39]
    buffer_load_dwordx4 v[144:147], v17, s[4:7], s33 offen offset:0 sc1
    v_mfma_f32_16x16x32_bf16 v[60:63], v[80:83], v[176:179], v[60:63]
    v_mfma_f32_16x16x32_bf16 v[40:43], v[80:83], v[172:175], v[40:43]
    s_waitcnt vmcnt(14) lgkmcnt(5)
    v_mfma_f32_16x16x32_bf16 v[44:47], v[84:87], v[184:187], v[44:47]
    ds_read_b128 v[64:67], v15 offset:9216
    v_mfma_f32_16x16x32_bf16 v[24:27], v[84:87], v[180:183], v[24:27]
    ds_read_b128 v[68:71], v15 offset:10240
    v_mfma_f32_16x16x32_bf16 v[48:51], v[88:91], v[184:187], v[48:51]
    ds_read_b128 v[72:75], v15 offset:11264
    v_mfma_f32_16x16x32_bf16 v[28:31], v[88:91], v[180:183], v[28:31]
    ds_read_b128 v[76:79], v15 offset:12288
    v_mfma_f32_16x16x32_bf16 v[52:55], v[92:95], v[184:187], v[52:55]
    ds_read_b128 v[80:83], v23 offset:17408
    v_mfma_f32_16x16x32_bf16 v[32:35], v[92:95], v[180:183], v[32:35]
    buffer_load_dwordx4 v[148:151], v16, s[4:7], s33 offen offset:2048 sc1
    v_mfma_f32_16x16x32_bf16 v[56:59], v[96:99], v[184:187], v[56:59]
    v_mfma_f32_16x16x32_bf16 v[36:39], v[96:99], v[180:183], v[36:39]
    buffer_load_dwordx4 v[152:155], v17, s[4:7], s33 offen offset:2048 sc1
    v_mfma_f32_16x16x32_bf16 v[60:63], v[100:103], v[184:187], v[60:63]
    v_mfma_f32_16x16x32_bf16 v[40:43], v[100:103], v[180:183], v[40:43]
    s_waitcnt vmcnt(14) lgkmcnt(5)
    v_mfma_f32_16x16x32_bf16 v[44:47], v[104:107], v[192:195], v[44:47]
    ds_read_b128 v[84:87], v15 offset:18432
    s_mov_b32 s32, 7
    s_lshl_b32 s32, s32, 13
    s_add_u32 s32, s32, s29
    s_add_u32 s33, s32, 4096
    v_mfma_f32_16x16x32_bf16 v[24:27], v[104:107], v[188:191], v[24:27]
    ds_read_b128 v[88:91], v15 offset:19456
    v_mfma_f32_16x16x32_bf16 v[48:51], v[108:111], v[192:195], v[48:51]
    ds_read_b128 v[92:95], v15 offset:20480
    v_mfma_f32_16x16x32_bf16 v[28:31], v[108:111], v[188:191], v[28:31]
    ds_read_b128 v[96:99], v15 offset:21504
    v_mfma_f32_16x16x32_bf16 v[52:55], v[112:115], v[192:195], v[52:55]
    ds_read_b128 v[100:103], v23 offset:26624
    v_mfma_f32_16x16x32_bf16 v[32:35], v[112:115], v[188:191], v[32:35]
    buffer_load_dwordx4 v[156:159], v16, s[4:7], s32 offen offset:0 sc1
    v_mfma_f32_16x16x32_bf16 v[56:59], v[116:119], v[192:195], v[56:59]
    v_mfma_f32_16x16x32_bf16 v[36:39], v[116:119], v[188:191], v[36:39]
    buffer_load_dwordx4 v[160:163], v17, s[4:7], s32 offen offset:0 sc1
    v_mfma_f32_16x16x32_bf16 v[60:63], v[120:123], v[192:195], v[60:63]
    v_mfma_f32_16x16x32_bf16 v[40:43], v[120:123], v[188:191], v[40:43]
    s_waitcnt vmcnt(14) lgkmcnt(5)
    v_mfma_f32_16x16x32_bf16 v[44:47], v[64:67], v[200:203], v[44:47]
    ds_read_b128 v[104:107], v15 offset:27648
    v_mfma_f32_16x16x32_bf16 v[24:27], v[64:67], v[196:199], v[24:27]
    ds_read_b128 v[108:111], v15 offset:28672
    v_mfma_f32_16x16x32_bf16 v[48:51], v[68:71], v[200:203], v[48:51]
    ds_read_b128 v[112:115], v15 offset:29696
    v_mfma_f32_16x16x32_bf16 v[28:31], v[68:71], v[196:199], v[28:31]
    ds_read_b128 v[116:119], v15 offset:30720
    v_mfma_f32_16x16x32_bf16 v[52:55], v[72:75], v[200:203], v[52:55]
    ds_read_b128 v[120:123], v23 offset:35840
    v_mfma_f32_16x16x32_bf16 v[32:35], v[72:75], v[196:199], v[32:35]
    buffer_load_dwordx4 v[164:167], v16, s[4:7], s32 offen offset:2048 sc1
    v_mfma_f32_16x16x32_bf16 v[56:59], v[76:79], v[200:203], v[56:59]
    v_mfma_f32_16x16x32_bf16 v[36:39], v[76:79], v[196:199], v[36:39]
    buffer_load_dwordx4 v[168:171], v17, s[4:7], s32 offen offset:2048 sc1
    v_mfma_f32_16x16x32_bf16 v[60:63], v[80:83], v[200:203], v[60:63]
    v_mfma_f32_16x16x32_bf16 v[40:43], v[80:83], v[196:199], v[40:43]
    s_waitcnt vmcnt(14) lgkmcnt(0)
    s_barrier
    v_mfma_f32_16x16x32_bf16 v[44:47], v[84:87], v[208:211], v[44:47]
    ds_read_b128 v[64:67], v12 offset:0
    v_mfma_f32_16x16x32_bf16 v[24:27], v[84:87], v[204:207], v[24:27]
    ds_read_b128 v[68:71], v12 offset:1024
    v_mfma_f32_16x16x32_bf16 v[48:51], v[88:91], v[208:211], v[48:51]
    ds_read_b128 v[72:75], v12 offset:2048
    v_mfma_f32_16x16x32_bf16 v[28:31], v[88:91], v[204:207], v[28:31]
    ds_read_b128 v[76:79], v12 offset:3072
    v_mfma_f32_16x16x32_bf16 v[52:55], v[92:95], v[208:211], v[52:55]
    ds_read_b128 v[80:83], v20 offset:8192
    v_mfma_f32_16x16x32_bf16 v[32:35], v[92:95], v[204:207], v[32:35]
    buffer_load_dwordx4 v[172:175], v16, s[4:7], s33 offen offset:0 sc1
    v_mfma_f32_16x16x32_bf16 v[56:59], v[96:99], v[208:211], v[56:59]
    v_mfma_f32_16x16x32_bf16 v[36:39], v[96:99], v[204:207], v[36:39]
    buffer_load_dwordx4 v[176:179], v17, s[4:7], s33 offen offset:0 sc1
    v_mfma_f32_16x16x32_bf16 v[60:63], v[100:103], v[208:211], v[60:63]
    v_mfma_f32_16x16x32_bf16 v[40:43], v[100:103], v[204:207], v[40:43]
    s_waitcnt vmcnt(14) lgkmcnt(5)
    v_mfma_f32_16x16x32_bf16 v[44:47], v[104:107], v[216:219], v[44:47]
    ds_read_b128 v[84:87], v12 offset:9216
    v_mfma_f32_16x16x32_bf16 v[24:27], v[104:107], v[212:215], v[24:27]
    ds_read_b128 v[88:91], v12 offset:10240
    v_mfma_f32_16x16x32_bf16 v[48:51], v[108:111], v[216:219], v[48:51]
    ds_read_b128 v[92:95], v12 offset:11264
    v_mfma_f32_16x16x32_bf16 v[28:31], v[108:111], v[212:215], v[28:31]
    ds_read_b128 v[96:99], v12 offset:12288
    v_mfma_f32_16x16x32_bf16 v[52:55], v[112:115], v[216:219], v[52:55]
    ds_read_b128 v[100:103], v20 offset:17408
    v_mfma_f32_16x16x32_bf16 v[32:35], v[112:115], v[212:215], v[32:35]
    buffer_load_dwordx4 v[180:183], v16, s[4:7], s33 offen offset:2048 sc1
    v_mfma_f32_16x16x32_bf16 v[56:59], v[116:119], v[216:219], v[56:59]
    v_mfma_f32_16x16x32_bf16 v[36:39], v[116:119], v[212:215], v[36:39]
    buffer_load_dwordx4 v[184:187], v17, s[4:7], s33 offen offset:2048 sc1
    v_mfma_f32_16x16x32_bf16 v[60:63], v[120:123], v[216:219], v[60:63]
    v_mfma_f32_16x16x32_bf16 v[40:43], v[120:123], v[212:215], v[40:43]
    s_waitcnt vmcnt(14) lgkmcnt(5)
    v_mfma_f32_16x16x32_bf16 v[44:47], v[64:67], v[128:131], v[44:47]
    ds_read_b128 v[104:107], v12 offset:18432
    s_mov_b32 s32, 8
    s_lshl_b32 s32, s32, 13
    s_add_u32 s32, s32, s29
    s_add_u32 s33, s32, 4096
    v_mfma_f32_16x16x32_bf16 v[24:27], v[64:67], v[124:127], v[24:27]
    ds_read_b128 v[108:111], v12 offset:19456
    v_mfma_f32_16x16x32_bf16 v[48:51], v[68:71], v[128:131], v[48:51]
    ds_read_b128 v[112:115], v12 offset:20480
    v_mfma_f32_16x16x32_bf16 v[28:31], v[68:71], v[124:127], v[28:31]
    ds_read_b128 v[116:119], v12 offset:21504
    v_mfma_f32_16x16x32_bf16 v[52:55], v[72:75], v[128:131], v[52:55]
    ds_read_b128 v[120:123], v20 offset:26624
    v_mfma_f32_16x16x32_bf16 v[32:35], v[72:75], v[124:127], v[32:35]
    buffer_load_dwordx4 v[188:191], v18, s[4:7], s32 offen offset:0 sc1
    v_mfma_f32_16x16x32_bf16 v[56:59], v[76:79], v[128:131], v[56:59]
    v_mfma_f32_16x16x32_bf16 v[36:39], v[76:79], v[124:127], v[36:39]
    buffer_load_dwordx4 v[192:195], v19, s[4:7], s32 offen offset:0 sc1
    v_mfma_f32_16x16x32_bf16 v[60:63], v[80:83], v[128:131], v[60:63]
    v_mfma_f32_16x16x32_bf16 v[40:43], v[80:83], v[124:127], v[40:43]
    s_waitcnt vmcnt(14) lgkmcnt(5)
    v_mfma_f32_16x16x32_bf16 v[44:47], v[84:87], v[136:139], v[44:47]
    ds_read_b128 v[64:67], v12 offset:27648
    v_mfma_f32_16x16x32_bf16 v[24:27], v[84:87], v[132:135], v[24:27]
    ds_read_b128 v[68:71], v12 offset:28672
    v_mfma_f32_16x16x32_bf16 v[48:51], v[88:91], v[136:139], v[48:51]
    ds_read_b128 v[72:75], v12 offset:29696
    v_mfma_f32_16x16x32_bf16 v[28:31], v[88:91], v[132:135], v[28:31]
    ds_read_b128 v[76:79], v12 offset:30720
    v_mfma_f32_16x16x32_bf16 v[52:55], v[92:95], v[136:139], v[52:55]
    ds_read_b128 v[80:83], v20 offset:35840
    v_mfma_f32_16x16x32_bf16 v[32:35], v[92:95], v[132:135], v[32:35]
    buffer_load_dwordx4 v[196:199], v18, s[4:7], s32 offen offset:2048 sc1
    v_mfma_f32_16x16x32_bf16 v[56:59], v[96:99], v[136:139], v[56:59]
    v_mfma_f32_16x16x32_bf16 v[36:39], v[96:99], v[132:135], v[36:39]
    buffer_load_dwordx4 v[200:203], v19, s[4:7], s32 offen offset:2048 sc1
    v_mfma_f32_16x16x32_bf16 v[60:63], v[100:103], v[136:139], v[60:63]
    v_mfma_f32_16x16x32_bf16 v[40:43], v[100:103], v[132:135], v[40:43]
    s_waitcnt vmcnt(14) lgkmcnt(0)
    s_barrier
    v_mfma_f32_16x16x32_bf16 v[44:47], v[104:107], v[144:147], v[44:47]
    ds_read_b128 v[84:87], v13 offset:0
    v_mfma_f32_16x16x32_bf16 v[24:27], v[104:107], v[140:143], v[24:27]
    ds_read_b128 v[88:91], v13 offset:1024
    v_mfma_f32_16x16x32_bf16 v[48:51], v[108:111], v[144:147], v[48:51]
    ds_read_b128 v[92:95], v13 offset:2048
    v_mfma_f32_16x16x32_bf16 v[28:31], v[108:111], v[140:143], v[28:31]
    ds_read_b128 v[96:99], v13 offset:3072
    v_mfma_f32_16x16x32_bf16 v[52:55], v[112:115], v[144:147], v[52:55]
    ds_read_b128 v[100:103], v21 offset:8192
    v_mfma_f32_16x16x32_bf16 v[32:35], v[112:115], v[140:143], v[32:35]
    buffer_load_dwordx4 v[204:207], v18, s[4:7], s33 offen offset:0 sc1
    v_mfma_f32_16x16x32_bf16 v[56:59], v[116:119], v[144:147], v[56:59]
    v_mfma_f32_16x16x32_bf16 v[36:39], v[116:119], v[140:143], v[36:39]
    buffer_load_dwordx4 v[208:211], v19, s[4:7], s33 offen offset:0 sc1
    v_mfma_f32_16x16x32_bf16 v[60:63], v[120:123], v[144:147], v[60:63]
    v_mfma_f32_16x16x32_bf16 v[40:43], v[120:123], v[140:143], v[40:43]
    s_waitcnt vmcnt(14) lgkmcnt(5)
    v_mfma_f32_16x16x32_bf16 v[44:47], v[64:67], v[152:155], v[44:47]
    ds_read_b128 v[104:107], v13 offset:9216
    v_mfma_f32_16x16x32_bf16 v[24:27], v[64:67], v[148:151], v[24:27]
    ds_read_b128 v[108:111], v13 offset:10240
    v_mfma_f32_16x16x32_bf16 v[48:51], v[68:71], v[152:155], v[48:51]
    ds_read_b128 v[112:115], v13 offset:11264
    v_mfma_f32_16x16x32_bf16 v[28:31], v[68:71], v[148:151], v[28:31]
    ds_read_b128 v[116:119], v13 offset:12288
    v_mfma_f32_16x16x32_bf16 v[52:55], v[72:75], v[152:155], v[52:55]
    ds_read_b128 v[120:123], v21 offset:17408
    v_mfma_f32_16x16x32_bf16 v[32:35], v[72:75], v[148:151], v[32:35]
    buffer_load_dwordx4 v[212:215], v18, s[4:7], s33 offen offset:2048 sc1
    v_mfma_f32_16x16x32_bf16 v[56:59], v[76:79], v[152:155], v[56:59]
    v_mfma_f32_16x16x32_bf16 v[36:39], v[76:79], v[148:151], v[36:39]
    buffer_load_dwordx4 v[216:219], v19, s[4:7], s33 offen offset:2048 sc1
    v_mfma_f32_16x16x32_bf16 v[60:63], v[80:83], v[152:155], v[60:63]
    v_mfma_f32_16x16x32_bf16 v[40:43], v[80:83], v[148:151], v[40:43]
    s_waitcnt vmcnt(14) lgkmcnt(5)
    v_mfma_f32_16x16x32_bf16 v[44:47], v[84:87], v[160:163], v[44:47]
    ds_read_b128 v[64:67], v13 offset:18432
    v_mfma_f32_16x16x32_bf16 v[24:27], v[84:87], v[156:159], v[24:27]
    ds_read_b128 v[68:71], v13 offset:19456
    v_mfma_f32_16x16x32_bf16 v[48:51], v[88:91], v[160:163], v[48:51]
    ds_read_b128 v[72:75], v13 offset:20480
    v_mfma_f32_16x16x32_bf16 v[28:31], v[88:91], v[156:159], v[28:31]
    ds_read_b128 v[76:79], v13 offset:21504
    v_mfma_f32_16x16x32_bf16 v[52:55], v[92:95], v[160:163], v[52:55]
    ds_read_b128 v[80:83], v21 offset:26624
    v_mfma_f32_16x16x32_bf16 v[32:35], v[92:95], v[156:159], v[32:35]
    v_mfma_f32_16x16x32_bf16 v[56:59], v[96:99], v[160:163], v[56:59]
    v_mfma_f32_16x16x32_bf16 v[36:39], v[96:99], v[156:159], v[36:39]
    v_mfma_f32_16x16x32_bf16 v[60:63], v[100:103], v[160:163], v[60:63]
    v_mfma_f32_16x16x32_bf16 v[40:43], v[100:103], v[156:159], v[40:43]
    s_waitcnt vmcnt(12) lgkmcnt(5)
    v_mfma_f32_16x16x32_bf16 v[44:47], v[104:107], v[168:171], v[44:47]
    ds_read_b128 v[84:87], v13 offset:27648
    v_mfma_f32_16x16x32_bf16 v[24:27], v[104:107], v[164:167], v[24:27]
    ds_read_b128 v[88:91], v13 offset:28672
    v_mfma_f32_16x16x32_bf16 v[48:51], v[108:111], v[168:171], v[48:51]
    ds_read_b128 v[92:95], v13 offset:29696
    v_mfma_f32_16x16x32_bf16 v[28:31], v[108:111], v[164:167], v[28:31]
    ds_read_b128 v[96:99], v13 offset:30720
    v_mfma_f32_16x16x32_bf16 v[52:55], v[112:115], v[168:171], v[52:55]
    ds_read_b128 v[100:103], v21 offset:35840
    v_mfma_f32_16x16x32_bf16 v[32:35], v[112:115], v[164:167], v[32:35]
    v_mfma_f32_16x16x32_bf16 v[56:59], v[116:119], v[168:171], v[56:59]
    v_mfma_f32_16x16x32_bf16 v[36:39], v[116:119], v[164:167], v[36:39]
    v_mfma_f32_16x16x32_bf16 v[60:63], v[120:123], v[168:171], v[60:63]
    v_mfma_f32_16x16x32_bf16 v[40:43], v[120:123], v[164:167], v[40:43]
    s_waitcnt vmcnt(10) lgkmcnt(0)
    s_barrier
    v_mfma_f32_16x16x32_bf16 v[44:47], v[64:67], v[176:179], v[44:47]
    ds_read_b128 v[104:107], v14 offset:0
    v_mfma_f32_16x16x32_bf16 v[24:27], v[64:67], v[172:175], v[24:27]
    ds_read_b128 v[108:111], v14 offset:1024
    v_mfma_f32_16x16x32_bf16 v[48:51], v[68:71], v[176:179], v[48:51]
    ds_read_b128 v[112:115], v14 offset:2048
    v_mfma_f32_16x16x32_bf16 v[28:31], v[68:71], v[172:175], v[28:31]
    ds_read_b128 v[116:119], v14 offset:3072
    v_mfma_f32_16x16x32_bf16 v[52:55], v[72:75], v[176:179], v[52:55]
    ds_read_b128 v[120:123], v22 offset:8192
    v_mfma_f32_16x16x32_bf16 v[32:35], v[72:75], v[172:175], v[32:35]
    v_mfma_f32_16x16x32_bf16 v[56:59], v[76:79], v[176:179], v[56:59]
    v_mfma_f32_16x16x32_bf16 v[36:39], v[76:79], v[172:175], v[36:39]
    v_mfma_f32_16x16x32_bf16 v[60:63], v[80:83], v[176:179], v[60:63]
    v_mfma_f32_16x16x32_bf16 v[40:43], v[80:83], v[172:175], v[40:43]
    s_waitcnt vmcnt(8) lgkmcnt(5)
    v_mfma_f32_16x16x32_bf16 v[44:47], v[84:87], v[184:187], v[44:47]
    ds_read_b128 v[64:67], v14 offset:9216
    v_mfma_f32_16x16x32_bf16 v[24:27], v[84:87], v[180:183], v[24:27]
    ds_read_b128 v[68:71], v14 offset:10240
    v_mfma_f32_16x16x32_bf16 v[48:51], v[88:91], v[184:187], v[48:51]
    ds_read_b128 v[72:75], v14 offset:11264
    v_mfma_f32_16x16x32_bf16 v[28:31], v[88:91], v[180:183], v[28:31]
    ds_read_b128 v[76:79], v14 offset:12288
    v_mfma_f32_16x16x32_bf16 v[52:55], v[92:95], v[184:187], v[52:55]
    ds_read_b128 v[80:83], v22 offset:17408
    v_mfma_f32_16x16x32_bf16 v[32:35], v[92:95], v[180:183], v[32:35]
    s_waitcnt vmcnt(6)
    v_mfma_f32_16x16x32_bf16 v[56:59], v[96:99], v[184:187], v[56:59]
    v_swap_b32 v190, v192
    v_mfma_f32_16x16x32_bf16 v[36:39], v[96:99], v[180:183], v[36:39]
    v_swap_b32 v191, v193
    v_mfma_f32_16x16x32_bf16 v[60:63], v[100:103], v[184:187], v[60:63]
    v_mfma_f32_16x16x32_bf16 v[40:43], v[100:103], v[180:183], v[40:43]
    s_waitcnt vmcnt(6) lgkmcnt(5)
    v_mfma_f32_16x16x32_bf16 v[44:47], v[104:107], v[192:195], v[44:47]
    ds_read_b128 v[84:87], v14 offset:18432
    v_mfma_f32_16x16x32_bf16 v[24:27], v[104:107], v[188:191], v[24:27]
    ds_read_b128 v[88:91], v14 offset:19456
    v_mfma_f32_16x16x32_bf16 v[48:51], v[108:111], v[192:195], v[48:51]
    ds_read_b128 v[92:95], v14 offset:20480
    v_mfma_f32_16x16x32_bf16 v[28:31], v[108:111], v[188:191], v[28:31]
    ds_read_b128 v[96:99], v14 offset:21504
    v_mfma_f32_16x16x32_bf16 v[52:55], v[112:115], v[192:195], v[52:55]
    ds_read_b128 v[100:103], v22 offset:26624
    v_mfma_f32_16x16x32_bf16 v[32:35], v[112:115], v[188:191], v[32:35]
    s_waitcnt vmcnt(4)
    v_mfma_f32_16x16x32_bf16 v[56:59], v[116:119], v[192:195], v[56:59]
    v_swap_b32 v198, v200
    v_mfma_f32_16x16x32_bf16 v[36:39], v[116:119], v[188:191], v[36:39]
    v_swap_b32 v199, v201
    v_mfma_f32_16x16x32_bf16 v[60:63], v[120:123], v[192:195], v[60:63]
    v_mfma_f32_16x16x32_bf16 v[40:43], v[120:123], v[188:191], v[40:43]
    s_waitcnt vmcnt(4) lgkmcnt(5)
    v_mfma_f32_16x16x32_bf16 v[44:47], v[64:67], v[200:203], v[44:47]
    ds_read_b128 v[104:107], v14 offset:27648
    v_mfma_f32_16x16x32_bf16 v[24:27], v[64:67], v[196:199], v[24:27]
    ds_read_b128 v[108:111], v14 offset:28672
    v_mfma_f32_16x16x32_bf16 v[48:51], v[68:71], v[200:203], v[48:51]
    ds_read_b128 v[112:115], v14 offset:29696
    v_mfma_f32_16x16x32_bf16 v[28:31], v[68:71], v[196:199], v[28:31]
    ds_read_b128 v[116:119], v14 offset:30720
    v_mfma_f32_16x16x32_bf16 v[52:55], v[72:75], v[200:203], v[52:55]
    ds_read_b128 v[120:123], v22 offset:35840
    v_mfma_f32_16x16x32_bf16 v[32:35], v[72:75], v[196:199], v[32:35]
    s_waitcnt vmcnt(2)
    v_mfma_f32_16x16x32_bf16 v[56:59], v[76:79], v[200:203], v[56:59]
    v_swap_b32 v206, v208
    v_mfma_f32_16x16x32_bf16 v[36:39], v[76:79], v[196:199], v[36:39]
    v_swap_b32 v207, v209
    v_mfma_f32_16x16x32_bf16 v[60:63], v[80:83], v[200:203], v[60:63]
    v_mfma_f32_16x16x32_bf16 v[40:43], v[80:83], v[196:199], v[40:43]
    s_waitcnt vmcnt(2) lgkmcnt(5)
    v_mfma_f32_16x16x32_bf16 v[44:47], v[84:87], v[208:211], v[44:47]
    v_mfma_f32_16x16x32_bf16 v[24:27], v[84:87], v[204:207], v[24:27]
    v_mfma_f32_16x16x32_bf16 v[48:51], v[88:91], v[208:211], v[48:51]
    v_mfma_f32_16x16x32_bf16 v[28:31], v[88:91], v[204:207], v[28:31]
    v_mfma_f32_16x16x32_bf16 v[52:55], v[92:95], v[208:211], v[52:55]
    v_mfma_f32_16x16x32_bf16 v[32:35], v[92:95], v[204:207], v[32:35]
    s_waitcnt vmcnt(0)
    v_mfma_f32_16x16x32_bf16 v[56:59], v[96:99], v[208:211], v[56:59]
    v_swap_b32 v214, v216
    v_mfma_f32_16x16x32_bf16 v[36:39], v[96:99], v[204:207], v[36:39]
    v_swap_b32 v215, v217
    v_mfma_f32_16x16x32_bf16 v[60:63], v[100:103], v[208:211], v[60:63]
    v_mfma_f32_16x16x32_bf16 v[40:43], v[100:103], v[204:207], v[40:43]
    s_waitcnt vmcnt(0) lgkmcnt(0)
    v_mfma_f32_16x16x32_bf16 v[44:47], v[104:107], v[216:219], v[44:47]
    v_mfma_f32_16x16x32_bf16 v[48:51], v[108:111], v[216:219], v[48:51]
    v_mfma_f32_16x16x32_bf16 v[52:55], v[112:115], v[216:219], v[52:55]
    v_mfma_f32_16x16x32_bf16 v[56:59], v[116:119], v[216:219], v[56:59]
    v_mfma_f32_16x16x32_bf16 v[60:63], v[120:123], v[216:219], v[60:63]
    v_mfma_f32_16x16x32_bf16 v[24:27], v[104:107], v[212:215], v[24:27]
    v_mfma_f32_16x16x32_bf16 v[28:31], v[108:111], v[212:215], v[28:31]
    v_mfma_f32_16x16x32_bf16 v[32:35], v[112:115], v[212:215], v[32:35]
    v_mfma_f32_16x16x32_bf16 v[36:39], v[116:119], v[212:215], v[36:39]
    v_mfma_f32_16x16x32_bf16 v[40:43], v[120:123], v[212:215], v[40:43]
    ds_write_b128 v2, v[44:47] offset:0
    ds_write_b128 v2, v[48:51] offset:1024
    ds_write_b128 v2, v[52:55] offset:2048
    ds_write_b128 v2, v[56:59] offset:3072
    s_mov_b64 exec, s[40:41]
    ds_write_b128 v3, v[60:63] offset:4096
    s_mov_b64 exec, -1
    ds_write_b32 v0, v9
    s_mov_b32 s60, 1048576
L_px_p5:
    ds_read_b32 v232, v6
    ds_read_b128 v[64:67], v7 offset:0
    ds_read_b128 v[68:71], v7 offset:1024
    ds_read_b128 v[72:75], v7 offset:2048
    ds_read_b128 v[76:79], v7 offset:3072
    ds_read_b128 v[80:83], v8 offset:4096
    s_waitcnt lgkmcnt(5)
    v_cmp_ne_u32 vcc, s43, v232
    s_sub_u32 s60, s60, 1
    s_cbranch_scc1 L_py_p5
    s_cbranch_vccnz L_px_p5
L_py_p5:
    s_waitcnt lgkmcnt(4)
    v_pk_add_f32 v[24:25], v[24:25], v[64:65]
    v_pk_add_f32 v[26:27], v[26:27], v[66:67]
    v_cvt_pk_bf16_f32 v220, v24, v25
    v_cvt_pk_bf16_f32 v221, v26, v27
    s_waitcnt lgkmcnt(3)
    v_pk_add_f32 v[28:29], v[28:29], v[68:69]
    v_pk_add_f32 v[30:31], v[30:31], v[70:71]
    v_cvt_pk_bf16_f32 v222, v28, v29
    v_cvt_pk_bf16_f32 v223, v30, v31
    s_waitcnt lgkmcnt(2)
    v_pk_add_f32 v[32:33], v[32:33], v[72:73]
    v_pk_add_f32 v[34:35], v[34:35], v[74:75]
    v_cvt_pk_bf16_f32 v224, v32, v33
    v_cvt_pk_bf16_f32 v225, v34, v35
    s_waitcnt lgkmcnt(1)
    v_pk_add_f32 v[36:37], v[36:37], v[76:77]
    v_pk_add_f32 v[38:39], v[38:39], v[78:79]
    v_cvt_pk_bf16_f32 v226, v36, v37
    v_cvt_pk_bf16_f32 v227, v38, v39
    s_waitcnt lgkmcnt(0)
    v_pk_add_f32 v[40:41], v[40:41], v[80:81]
    v_pk_add_f32 v[42:43], v[42:43], v[82:83]
    v_cvt_pk_bf16_f32 v228, v40, v41
    v_cvt_pk_bf16_f32 v229, v42, v43
    s_cmp_eq_u32 s22, 1
    s_cbranch_scc1 L_fin_p5
    buffer_store_dwordx4 v[220:223], v4, s[4:7], s34 offen offset:0 sc1
    buffer_store_dwordx4 v[224:227], v4, s[4:7], s34 offen offset:1024 sc1
    buffer_store_dwordx2 v[228:229], v5, s[4:7], s34 offen sc1
    v_cndmask_b32 v234, 0, v228, s[40:41]
    v_cndmask_b32 v235, 0, v229, s[40:41]
    v_dot2_f32_bf16 v232, v220, v11, 0
    v_dot2_f32_bf16 v233, v220, v220, 0
    v_dot2_f32_bf16 v232, v221, v11, v232
    v_dot2_f32_bf16 v233, v221, v221, v233
    v_dot2_f32_bf16 v232, v222, v11, v232
    v_dot2_f32_bf16 v233, v222, v222, v233
    v_dot2_f32_bf16 v232, v223, v11, v232
    v_dot2_f32_bf16 v233, v223, v223, v233
    v_dot2_f32_bf16 v232, v224, v11, v232
    v_dot2_f32_bf16 v233, v224, v224, v233
    v_dot2_f32_bf16 v232, v225, v11, v232
    v_dot2_f32_bf16 v233, v225, v225, v233
    v_dot2_f32_bf16 v232, v226, v11, v232
    v_dot2_f32_bf16 v233, v226, v226, v233
    v_dot2_f32_bf16 v232, v227, v11, v232
    v_dot2_f32_bf16 v233, v227, v227, v233
    v_dot2_f32_bf16 v232, v234, v11, v232
    v_dot2_f32_bf16 v233, v234, v234, v233
    v_dot2_f32_bf16 v232, v235, v11, v232
    v_dot2_f32_bf16 v233, v235, v235, v233
    s_nop 2
    v_mov_b32 v234, v232
    v_mov_b32 v235, v233
    s_nop 1
    v_permlane32_swap_b32 v232, v234
    v_permlane32_swap_b32 v233, v235
    v_add_f32 v232, v232, v234
    v_add_f32 v233, v233, v235
    v_mov_b32 v234, v232
    v_mov_b32 v235, v233
    s_nop 1
    v_permlane16_swap_b32 v232, v234
    v_permlane16_swap_b32 v233, v235
    v_add_f32 v232, v232, v234
    v_add_f32 v233, v233, v235
    buffer_store_dwordx2 v[232:233], v10, s[4:7], s39 offen sc1
    s_barrier
    s_mov_b32 s22, 1
    s_mov_b32 s21, 0x1c00000
    s_branch L_m_cl
L_fin_p5:
    ds_bpermute_b32 v220, v10, v220
    ds_bpermute_b32 v221, v10, v221
    ds_bpermute_b32 v222, v10, v222
    ds_bpermute_b32 v223, v10, v223
    ds_bpermute_b32 v224, v10, v224
    ds_bpermute_b32 v225, v10, v225
    ds_bpermute_b32 v226, v10, v226
    ds_bpermute_b32 v227, v10, v227
    ds_bpermute_b32 v228, v10, v228
    ds_bpermute_b32 v229, v10, v229
    s_waitcnt lgkmcnt(6)
    buffer_store_dwordx4 v[220:223], v4, s[16:19], s34 offen offset:0
    s_waitcnt lgkmcnt(2)
    buffer_store_dwordx4 v[224:227], v4, s[16:19], s34 offen offset:64
    s_waitcnt lgkmcnt(0)
    buffer_store_dwordx2 v[228:229], v5, s[16:19], s34 offen offset:128
    s_endpgm
L_m_l1:
    s_and_b32 s25, s2, 7
    s_lshr_b32 s26, s2, 3
    s_lshr_b32 s23, s25, 1
    s_lshl_b32 s23, s23, 2
    s_lshr_b32 s27, s26, 3
    s_add_u32 s23, s23, s27
    s_and_b32 s24, s25, 1
    s_lshl_b32 s24, s24, 3
    s_and_b32 s27, s26, 7
    s_add_u32 s24, s24, s27
    s_mul_i32 s29, s24, 129024
    s_lshl_b32 s30, s20, 12
    s_add_u32 s29, s29, s30
    s_add_u32 s29, s29, 0x3800000
    s_lshl_b32 s31, s23, 3
    s_max_u32 s31, s31, 1
    s_sub_u32 s31, s31, 1
    s_mul_i32 s31, s31, 18432
    s_add_u32 s31, s31, 0x0
    s_lshl_b32 s35, s20, 10
    s_and_b32 s36, s35, 1024
    s_barrier
    s_add_u32 m0, s35, 131072
    s_add_u32 s34, s31, s35
    s_add_u32 s34, s34, 0
    buffer_load_dwordx4 v1, s[4:7], s34 offen sc1 lds
    s_add_u32 m0, s30, 0
    s_add_u32 s34, s29, 0
    buffer_load_dwordx4 v1, s[4:7], s34 offen offset:0 sc1 lds
    buffer_load_dwordx4 v1, s[4:7], s34 offen offset:1024 sc1 lds
    buffer_load_dwordx4 v1, s[4:7], s34 offen offset:2048 sc1 lds
    buffer_load_dwordx4 v1, s[4:7], s34 offen offset:3072 sc1 lds
    s_add_u32 m0, s30, 16384
    s_add_u32 s34, s29, 16384
    buffer_load_dwordx4 v1, s[4:7], s34 offen offset:0 sc1 lds
    buffer_load_dwordx4 v1, s[4:7], s34 offen offset:1024 sc1 lds
    buffer_load_dwordx4 v1, s[4:7], s34 offen offset:2048 sc1 lds
    buffer_load_dwordx4 v1, s[4:7], s34 offen offset:3072 sc1 lds
    s_waitcnt vmcnt(4) lgkmcnt(0)
    s_barrier
    s_add_u32 m0, s30, 32768
    s_add_u32 s34, s29, 32768
    buffer_load_dwordx4 v1, s[4:7], s34 offen offset:0 sc1 lds
    buffer_load_dwordx4 v1, s[4:7], s34 offen offset:1024 sc1 lds
    buffer_load_dwordx4 v1, s[4:7], s34 offen offset:2048 sc1 lds
    buffer_load_dwordx4 v1, s[4:7], s34 offen offset:3072 sc1 lds
    s_cmp_lt_u32 s2, 144
    s_cbranch_scc1 L_p0_t1
    s_cmp_ge_u32 s2, 216
    s_cbranch_scc1 L_p0_t2
    ds_read_b64_tr_b16 v[16:17], v4 offset:0
    ds_read_b64_tr_b16 v[18:19], v4 offset:2048
    ds_read_b64_tr_b16 v[20:21], v4 offset:18432
    ds_read_b64_tr_b16 v[22:23], v4 offset:20480
    ds_read_b64_tr_b16 v[24:25], v4 offset:4096
    ds_read_b64_tr_b16 v[26:27], v4 offset:6144
    ds_read_b64_tr_b16 v[28:29], v4 offset:22528
    ds_read_b64_tr_b16 v[30:31], v4 offset:24576
    ds_read_b64_tr_b16 v[32:33], v4 offset:8192
    ds_read_b64_tr_b16 v[34:35], v4 offset:10240
    ds_read_b64_tr_b16 v[36:37], v4 offset:26624
    ds_read_b64_tr_b16 v[38:39], v4 offset:28672
    ds_read_b64_tr_b16 v[40:41], v4 offset:12288
    ds_read_b64_tr_b16 v[42:43], v4 offset:14336
    ds_read_b64_tr_b16 v[44:45], v4 offset:30720
    ds_read_b64_tr_b16 v[46:47], v4 offset:32768
    ds_read_b64_tr_b16 v[48:49], v5 offset:16384
    ds_read_b64_tr_b16 v[50:51], v5 offset:34816
    s_branch L_p0_t2
L_p0_t1:
    ds_read_b64_tr_b16 v[16:17], v4 offset:0
    ds_read_b64_tr_b16 v[18:19], v4 offset:512
    ds_read_b64_tr_b16 v[20:21], v4 offset:4352
    ds_read_b64_tr_b16 v[22:23], v4 offset:4864
    ds_read_b64_tr_b16 v[24:25], v4 offset:9792
    ds_read_b64_tr_b16 v[26:27], v4 offset:10304
    ds_read_b64_tr_b16 v[28:29], v4 offset:14144
    ds_read_b64_tr_b16 v[30:31], v4 offset:14656
    ds_read_b64_tr_b16 v[32:33], v4 offset:19584
    ds_read_b64_tr_b16 v[34:35], v4 offset:20096
    ds_read_b64_tr_b16 v[36:37], v4 offset:23936
    ds_read_b64_tr_b16 v[38:39], v4 offset:24448
    ds_read_b64_tr_b16 v[40:41], v4 offset:29376
    ds_read_b64_tr_b16 v[42:43], v4 offset:29888
    ds_read_b64_tr_b16 v[44:45], v4 offset:33728
    ds_read_b64_tr_b16 v[46:47], v4 offset:34240
    ds_read_b64_tr_b16 v[48:49], v5 offset:8704
    ds_read_b64_tr_b16 v[50:51], v5 offset:9216
L_p0_t2:
    s_waitcnt lgkmcnt(0)
    s_waitcnt vmcnt(4) lgkmcnt(0)
    s_barrier
    s_add_u32 m0, s35, 135168
    s_add_u32 s34, s31, s35
    s_add_u32 s34, s34, 4096
    buffer_load_dwordx4 v1, s[4:7], s34 offen sc1 lds
    s_add_u32 m0, s30, 49152
    s_add_u32 s34, s29, 49152
    buffer_load_dwordx4 v1, s[4:7], s34 offen offset:0 sc1 lds
    buffer_load_dwordx4 v1, s[4:7], s34 offen offset:1024 sc1 lds
    buffer_load_dwordx4 v1, s[4:7], s34 offen offset:2048 sc1 lds
    buffer_load_dwordx4 v1, s[4:7], s34 offen offset:3072 sc1 lds
    s_waitcnt vmcnt(5) lgkmcnt(0)
    s_barrier
    s_add_u32 m0, s35, 139264
    s_add_u32 s34, s31, s35
    s_add_u32 s34, s34, 8192
    buffer_load_dwordx4 v1, s[4:7], s34 offen sc1 lds
    v_lshrrev_b32 v2, 8, v1
    v_bfe_u32 v3, v1, 7, 1
    v_bfe_u32 v4, v1, 4, 3
    v_cmp_gt_u32 vcc, 3, v2
    v_mul_u32_u24 v3, 80, v3
    v_lshl_add_u32 v3, v4, 3, v3
    v_lshrrev_b32 v5, 1, v4
    v_and_b32 v4, 1, v4
    v_lshl_add_u32 v4, v4, 3, 64
    v_cndmask_b32 v2, v5, v2, vcc
    v_cndmask_b32 v3, v4, v3, vcc
    v_mul_u32_u24 v2, 2304, v2
    v_add_u32 v0, v2, v3
    v_lshrrev_b32 v8, 1, v1
    s_mul_i32 s34, s24, 144
    s_add_u32 s34, s34, 0x4400000
    buffer_load_dwordx2 v[2:3], v0, s[4:7], s34 offen sc1
    s_mul_i32 s34, s24, 144
    s_add_u32 s34, s34, 0x4402000
    buffer_load_dwordx2 v[4:5], v0, s[4:7], s34 offen sc1
    s_mul_i32 s34, s24, 144
    s_add_u32 s34, s34, 0x4404000
    buffer_load_dwordx2 v[6:7], v0, s[4:7], s34 offen sc1
    s_mul_i32 s34, s24, 144
    s_add_u32 s34, s34, 0x4406000
    buffer_load_dwordx2 v[12:13], v0, s[4:7], s34 offen sc1
    s_add_u32 m0, s30, 65536
    s_add_u32 s34, s29, 65536
    buffer_load_dwordx4 v1, s[4:7], s34 offen offset:0 sc1 lds
    buffer_load_dwordx4 v1, s[4:7], s34 offen offset:1024 sc1 lds
    buffer_load_dwordx4 v1, s[4:7], s34 offen offset:2048 sc1 lds
    buffer_load_dwordx4 v1, s[4:7], s34 offen offset:3072 sc1 lds
    s_waitcnt vmcnt(9) lgkmcnt(0)
    s_barrier
    s_add_u32 m0, s30, 81920
    s_add_u32 s34, s29, 81920
    buffer_load_dwordx4 v1, s[4:7], s34 offen offset:0 sc1 lds
    buffer_load_dwordx4 v1, s[4:7], s34 offen offset:1024 sc1 lds
    buffer_load_dwordx4 v1, s[4:7], s34 offen offset:2048 sc1 lds
    buffer_load_dwordx4 v1, s[4:7], s34 offen offset:3072 sc1 lds
    s_waitcnt vmcnt(8)
    v_add_f32 v2, v2, v4
    v_add_f32 v3, v3, v5
    v_add_f32 v6, v6, v12
    v_add_f32 v7, v7, v13
    v_add_f32 v2, v2, v6
    v_add_f32 v3, v3, v7
    v_cmp_gt_u32 vcc, 864, v1
    v_add_u32 v8, 161792, v8
    s_nop 0
    v_cndmask_b32 v2, 0, v2, vcc
    v_cndmask_b32 v3, 0, v3, vcc
    ds_write_b64 v8, v[2:3]
    s_waitcnt vmcnt(4) lgkmcnt(0)
    s_barrier
    s_add_u32 m0, s35, 143360
    s_add_u32 s34, s31, s35
    s_add_u32 s34, s34, 12288
    buffer_load_dwordx4 v1, s[4:7], s34 offen sc1 lds
    s_add_u32 m0, s30, 98304
    s_add_u32 s34, s29, 98304
    buffer_load_dwordx4 v1, s[4:7], s34 offen offset:0 sc1 lds
    buffer_load_dwordx4 v1, s[4:7], s34 offen offset:1024 sc1 lds
    buffer_load_dwordx4 v1, s[4:7], s34 offen offset:2048 sc1 lds
    buffer_load_dwordx4 v1, s[4:7], s34 offen offset:3072 sc1 lds
    s_waitcnt vmcnt(5) lgkmcnt(0)
    s_barrier
    s_add_u32 m0, s36, 147456
    s_add_u32 s34, s31, s36
    s_add_u32 s34, s34, 16384
    buffer_load_dwordx4 v1, s[4:7], s34 offen sc1 lds
    s_add_u32 m0, s30, 114688
    s_add_u32 s34, s29, 114688
    buffer_load_dwordx4 v1, s[4:7], s34 offen offset:0 sc1 lds
    buffer_load_dwordx4 v1, s[4:7], s34 offen offset:1024 sc1 lds
    buffer_load_dwordx4 v1, s[4:7], s34 offen offset:2048 sc1 lds
    buffer_load_dwordx4 v1, s[4:7], s34 offen offset:3072 sc1 lds
    buffer_store_dwordx4 v[16:19], v9, s[4:7], s37 offen sc1
    buffer_store_dwordx4 v[20:23], v10, s[4:7], s38 offen sc1
    buffer_store_dwordx4 v[24:27], v9, s[4:7], s39 offen sc1
    buffer_store_dwordx4 v[28:31], v10, s[4:7], s40 offen sc1
    s_waitcnt vmcnt(9) lgkmcnt(0)
    s_barrier
    buffer_store_dwordx4 v[32:35], v9, s[4:7], s41 offen sc1
    buffer_store_dwordx4 v[36:39], v10, s[4:7], s42 offen sc1
    buffer_store_dwordx4 v[40:43], v9, s[4:7], s43 offen sc1
    s_waitcnt vmcnt(7) lgkmcnt(0)
    s_barrier
    s_mov_b32 s46, 0x4502000
    v_mov_b32 v4, 0
    s_mov_b32 s60, 65536
L_poll_wo:
    buffer_load_dword v5, v4, s[4:7], s46 offen sc1
    s_waitcnt vmcnt(0)
    v_cmp_gt_u32 vcc, 18, v5
    s_sub_u32 s60, s60, 1
    s_cbranch_scc1 L_pd_wo
    s_cbranch_vccz L_pd_wo
    s_sleep 4
    s_branch L_poll_wo
L_pd_wo:
    buffer_store_dwordx4 v[44:47], v10, s[4:7], s47 offen sc1
    buffer_store_dwordx4 v[48:51], v14, s[4:7], s48 offen sc1
    v_dot2_f32_bf16 v12, v16, v11, 0
    v_dot2_f32_bf16 v13, v17, v11, 0
    v_dot2_f32_bf16 v12, v18, v11, v12
    v_dot2_f32_bf16 v13, v19, v11, v13
    v_dot2_f32_bf16 v12, v20, v11, v12
    v_dot2_f32_bf16 v13, v21, v11, v13
    v_dot2_f32_bf16 v12, v22, v11, v12
    v_dot2_f32_bf16 v13, v23, v11, v13
    v_dot2_f32_bf16 v12, v24, v11, v12
    v_dot2_f32_bf16 v13, v25, v11, v13
    v_dot2_f32_bf16 v12, v26, v11, v12
    v_dot2_f32_bf16 v13, v27, v11, v13
    v_dot2_f32_bf16 v12, v28, v11, v12
    v_dot2_f32_bf16 v13, v29, v11, v13
    v_dot2_f32_bf16 v12, v30, v11, v12
    v_dot2_f32_bf16 v13, v31, v11, v13
    v_dot2_f32_bf16 v12, v32, v11, v12
    v_dot2_f32_bf16 v13, v33, v11, v13
    v_dot2_f32_bf16 v12, v34, v11, v12
    v_dot2_f32_bf16 v13, v35, v11, v13
    v_dot2_f32_bf16 v12, v36, v11, v12
    v_dot2_f32_bf16 v13, v37, v11, v13
    v_dot2_f32_bf16 v12, v38, v11, v12
    v_dot2_f32_bf16 v13, v39, v11, v13
    v_dot2_f32_bf16 v12, v40, v11, v12
    v_dot2_f32_bf16 v13, v41, v11, v13
    v_dot2_f32_bf16 v12, v42, v11, v12
    v_dot2_f32_bf16 v13, v43, v11, v13
    v_dot2_f32_bf16 v12, v44, v11, v12
    v_dot2_f32_bf16 v13, v45, v11, v13
    v_dot2_f32_bf16 v12, v46, v11, v12
    v_dot2_f32_bf16 v13, v47, v11, v13
    v_dot2_f32_bf16 v12, v48, v11, v12
    v_dot2_f32_bf16 v13, v49, v11, v13
    v_dot2_f32_bf16 v12, v50, v11, v12
    v_dot2_f32_bf16 v13, v51, v11, v13
    s_nop 2
    v_add_f32 v12, v12, v13
    v_mov_b32 v13, v12
    s_nop 1
    v_permlane32_swap_b32 v12, v13
    v_add_f32 v12, v12, v13
    v_mov_b32 v13, v12
    s_nop 1
    v_permlane16_swap_b32 v12, v13
    v_add_f32 v12, v12, v13
    buffer_store_dword v12, v15, s[4:7], s49 offen sc1
    s_barrier
L_m_ll:
    s_and_b32 s25, s2, 7
    s_lshr_b32 s26, s2, 3
    s_lshr_b32 s23, s25, 1
    s_lshl_b32 s23, s23, 3
    s_lshr_b32 s27, s26, 2
    s_add_u32 s23, s23, s27
    s_and_b32 s24, s25, 1
    s_lshl_b32 s24, s24, 2
    s_and_b32 s27, s26, 3
    s_add_u32 s24, s24, s27
    s_add_u32 s25, s23, s24
    s_and_b32 s25, s25, 3
    s_mul_i32 s29, s24, 82944
    s_add_u32 s29, s29, 0x3a00000
    s_mul_i32 s30, s20, 36864
    s_mul_i32 s31, s20, 18432
    s_add_u32 s31, s31, s29
    s_add_u32 m0, s30, 18432
    s_add_u32 s33, s31, 0
    buffer_load_dwordx4 v1, s[4:7], s33 offen offset:0  sc1 lds
    buffer_load_dwordx4 v1, s[4:7], s33 offen offset:1024  sc1 lds
    buffer_load_dwordx4 v1, s[4:7], s33 offen offset:2048  sc1 lds
    buffer_load_dwordx4 v1, s[4:7], s33 offen offset:3072  sc1 lds
    s_add_u32 m0, s30, 22528
    s_add_u32 s33, s31, 4096
    buffer_load_dwordx4 v1, s[4:7], s33 offen offset:0  sc1 lds
    buffer_load_dwordx4 v1, s[4:7], s33 offen offset:1024  sc1 lds
    buffer_load_dwordx4 v1, s[4:7], s33 offen offset:2048  sc1 lds
    buffer_load_dwordx4 v1, s[4:7], s33 offen offset:3072  sc1 lds
    s_add_u32 m0, s30, 26624
    s_add_u32 s33, s31, 8192
    buffer_load_dwordx4 v1, s[4:7], s33 offen offset:0  sc1 lds
    buffer_load_dwordx4 v1, s[4:7], s33 offen offset:1024  sc1 lds
    buffer_load_dwordx4 v1, s[4:7], s33 offen offset:2048  sc1 lds
    buffer_load_dwordx4 v1, s[4:7], s33 offen offset:3072  sc1 lds
    s_waitcnt vmcnt(12)
    s_barrier
    s_add_u32 m0, s30, 30720
    s_add_u32 s33, s31, 12288
    buffer_load_dwordx4 v1, s[4:7], s33 offen offset:0  sc1 lds
    buffer_load_dwordx4 v1, s[4:7], s33 offen offset:1024  sc1 lds
    buffer_load_dwordx4 v1, s[4:7], s33 offen offset:2048  sc1 lds
    buffer_load_dwordx4 v1, s[4:7], s33 offen offset:3072  sc1 lds
    s_add_u32 m0, s30, 34816
    s_add_u32 s33, s31, 16384
    buffer_load_dwordx4 v1, s[4:7], s33 offen offset:0  sc1 lds
    buffer_load_dwordx4 v1, s[4:7], s33 offen offset:1024  sc1 lds
    s_mul_i32 s30, s20, 3072
    s_add_u32 s31, s30, s29
    s_add_u32 m0, s30, 147456
    s_add_u32 s33, s31, 73728
    buffer_load_dwordx4 v1, s[4:7], s33 offen offset:0  sc1 lds
    buffer_load_dwordx4 v1, s[4:7], s33 offen offset:1024  sc1 lds
    buffer_load_dwordx4 v1, s[4:7], s33 offen offset:2048  sc1 lds
    s_or_b32 s44, s20, s22
    s_cbranch_scc1 L_p2_ns
    s_and_b32 s44, s2, 15
    s_lshl_b32 s44, s44, 8
    s_add_u32 s44, s44, 0x4501000
    s_add_u32 s44, s44, s4
    s_addc_u32 s45, s5, 0
    s_mov_b32 s56, 1
    s_atomic_add s56, s[44:45], 0
L_p2_ns:
    s_waitcnt vmcnt(0)
    s_barrier
    s_and_b32 s25, s2, 7
    s_lshr_b32 s26, s2, 3
    s_and_b32 s23, s25, 1
    s_lshl_b32 s23, s23, 3
    s_and_b32 s27, s26, 7
    s_add_u32 s23, s23, s27
    s_lshr_b32 s24, s25, 1
    s_lshl_b32 s24, s24, 2
    s_lshr_b32 s27, s26, 3
    s_add_u32 s24, s24, s27
    s_add_u32 s28, s23, s24
    s_and_b32 s28, s28, 3
    s_lshl_b32 s30, s20, 12
    s_lshr_b32 s33, s20, 1
    s_mul_i32 s31, s33, 36864
    s_and_b32 s33, s20, 1
    s_lshl_b32 s33, s33, 10
    s_add_u32 s33, s33, 16384
    s_add_u32 s31, s31, s33
    s_sub_u32 s49, s33, s30
    s_mul_i32 s34, s24, 331776
    s_add_u32 s34, s34, s30
    s_add_u32 s34, s34, 0x3b00000
    s_lshl_b32 s35, s23, 3
    s_lshl_b32 s33, s20, 1
    s_add_u32 s35, s35, s33
    s_mul_i32 s35, s35, 18432
    s_add_u32 s35, s35, s21
    s_add_u32 s35, s35, 0x300000
    s_mul_i32 s36, s24, 589824
    s_add_u32 s36, s36, s30
    s_add_u32 s36, s36, s21
    s_add_u32 s36, s36, 0x900000
    v_add_u32 v2, 16384, v1
    s_add_u32 s33, s30, 18432
    v_add_u32 v6, s33, v1
    v_add_u32 v7, 73728, v6
    s_lshl_b32 s29, s23, 2
    s_add_u32 s29, s29, s20
    s_lshl_b32 s29, s29, 12
    s_add_u32 s29, s29, s21
    s_add_u32 s29, s29, 0x1b40000
    v_and_b32 v3, 48, v1
    v_lshrrev_b32 v8, 8, v1
    v_lshl_add_u32 v3, v8, 6, v3
    v_bfe_u32 v8, v1, 6, 2
    v_lshl_add_u32 v3, v8, 8, v3
    s_lshl_b32 s33, s23, 7
    s_lshl_b32 s37, s20, 5
    s_add_u32 s33, s33, s37
    v_lshrrev_b32 v8, 7, v1
    v_add_u32 v8, s33, v8
    v_lshlrev_b32 v8, 12, v8
    v_lshrrev_b32 v9, 8, v1
    v_bfe_u32 v10, v1, 4, 3
    v_xor_b32 v9, v9, v10
    v_lshl_add_u32 v8, v9, 4, v8
    v_xor_b32 v9, 64, v8
    v_add_u32 v9, 31744, v9
    v_add_u32 v10, 63488, v8
    v_add_u32 v11, 63488, v9
    s_cmp_eq_u32 s28, 0
    s_cselect_b32 s44, 4, 0
    s_cmp_eq_u32 s28, 1
    s_cselect_b32 s45, 5, 1
    s_cmp_eq_u32 s28, 2
    s_cselect_b32 s46, 6, 2
    s_cmp_eq_u32 s28, 3
    s_cselect_b32 s47, 7, 3
    s_lshl_b32 s33, s20, 4
    s_add_u32 s33, s33, s24
    s_lshl_b32 s54, s22, 7
    s_add_u32 s54, s54, s33
    s_lshl_b32 s54, s54, 8
    s_add_u32 s54, s54, 0x450c000
    s_add_u32 s54, s54, s4
    s_addc_u32 s55, s5, 0
    s_mov_b32 s33, 0x4501000
    v_and_b32 v4, 0xf0, v1
    v_lshlrev_b32 v4, 4, v4
    s_mov_b32 s60, 65536
L_poll_wr:
    buffer_load_dword v5, v4, s[4:7], s33 offen sc1
    s_waitcnt vmcnt(0)
    v_cmp_gt_u32 vcc, 16, v5
    s_sub_u32 s60, s60, 1
    s_cbranch_scc1 L_pd_wr
    s_cbranch_vccz L_pd_wr
    s_sleep 4
    s_branch L_poll_wr
L_pd_wr:
    s_min_u32 s33, s20, 2
    s_lshl_b32 s33, s33, 9
    v_lshrrev_b32 v4, 1, v1
    v_add_u32 v4, s33, v4
    s_lshl_b32 s51, s24, 12
    s_add_u32 s51, s51, 0x4410000
    buffer_load_dwordx2 v[16:17], v4, s[4:7], s51 offen offset:0 sc1
    buffer_load_dwordx2 v[18:19], v4, s[4:7], s51 offen offset:1152 sc1
    s_mov_b32 s48, 0
    s_mul_i32 s50, s48, 18432
    s_add_u32 s50, s50, s34
    s_add_u32 m0, s30, 0
    s_mov_b32 s53, s50
    buffer_load_dwordx4 v1, s[4:7], s50 offen offset:0  sc1 lds
    buffer_load_dwordx4 v1, s[4:7], s50 offen offset:1024  sc1 lds
    buffer_load_dwordx4 v1, s[4:7], s50 offen offset:2048  sc1 lds
    buffer_load_dwordx4 v1, s[4:7], s50 offen offset:3072  sc1 lds
    s_mov_b32 s48, 1
    s_mul_i32 s50, s48, 18432
    s_add_u32 s50, s50, s34
    s_cmp_ge_u32 s20, 2
    s_cselect_b32 s52, s50, s53
    s_add_u32 m0, s31, 0
    s_add_u32 s52, s52, s49
    buffer_load_dwordx4 v1, s[4:7], s52 offen  sc1 lds
    s_add_u32 m0, s30, 36864
    s_mov_b32 s53, s50
    buffer_load_dwordx4 v1, s[4:7], s50 offen offset:0  sc1 lds
    buffer_load_dwordx4 v1, s[4:7], s50 offen offset:1024  sc1 lds
    buffer_load_dwordx4 v1, s[4:7], s50 offen offset:2048  sc1 lds
    buffer_load_dwordx4 v1, s[4:7], s50 offen offset:3072  sc1 lds
    s_mov_b32 m0, 161280
    v_lshrrev_b32 v5, 2, v1
    s_lshl_b32 s33, s23, 8
    buffer_load_dword v5, s[12:15], s33 offen lds
    s_waitcnt vmcnt(10)
    v_add_u32 v4, 159744, v4
    v_add_f32 v16, v16, v18
    v_add_f32 v17, v17, v19
    ds_write_b64 v4, v[16:17]
    s_waitcnt lgkmcnt(0)
    s_barrier
    s_mov_b32 s48, 2
    s_mul_i32 s50, s48, 18432
    s_add_u32 s50, s50, s34
    s_add_u32 m0, s30, 73728
    s_mov_b32 s53, s50
    buffer_load_dwordx4 v1, s[4:7], s50 offen offset:0  sc1 lds
    buffer_load_dwordx4 v1, s[4:7], s50 offen offset:1024  sc1 lds
    buffer_load_dwordx4 v1, s[4:7], s50 offen offset:2048  sc1 lds
    buffer_load_dwordx4 v1, s[4:7], s50 offen offset:3072  sc1 lds
    s_mov_b32 s48, 3
    s_mul_i32 s50, s48, 18432
    s_add_u32 s50, s50, s34
    s_cmp_ge_u32 s20, 2
    s_cselect_b32 s52, s50, s53
    s_add_u32 m0, s31, 73728
    s_add_u32 s52, s52, s49
    buffer_load_dwordx4 v1, s[4:7], s52 offen  sc1 lds
    s_add_u32 m0, s30, 110592
    s_mov_b32 s53, s50
    buffer_load_dwordx4 v1, s[4:7], s50 offen offset:0  sc1 lds
    buffer_load_dwordx4 v1, s[4:7], s50 offen offset:1024  sc1 lds
    buffer_load_dwordx4 v1, s[4:7], s50 offen offset:2048  sc1 lds
    buffer_load_dwordx4 v1, s[4:7], s50 offen offset:3072  sc1 lds
    s_barrier
    s_add_u32 m0, s30, 18432
    s_add_u32 s51, s35, 0
    buffer_load_dwordx4 v1, s[4:7], s51 offen offset:0 sc1 lds
    buffer_load_dwordx4 v1, s[4:7], s51 offen offset:1024 sc1 lds
    buffer_load_dwordx4 v2, s[4:7], s51 offen offset:2048 sc1 lds
    buffer_load_dwordx4 v2, s[4:7], s51 offen offset:3072 sc1 lds
    s_add_u32 m0, s30, 55296
    s_add_u32 s51, s35, 2048
    buffer_load_dwordx4 v1, s[4:7], s51 offen offset:0 sc1 lds
    buffer_load_dwordx4 v1, s[4:7], s51 offen offset:1024 sc1 lds
    buffer_load_dwordx4 v2, s[4:7], s51 offen offset:2048 sc1 lds
    buffer_load_dwordx4 v2, s[4:7], s51 offen offset:3072 sc1 lds
    s_add_u32 m0, s30, 92160
    s_add_u32 s51, s35, 4096
    buffer_load_dwordx4 v1, s[4:7], s51 offen offset:0 sc1 lds
    buffer_load_dwordx4 v1, s[4:7], s51 offen offset:1024 sc1 lds
    buffer_load_dwordx4 v2, s[4:7], s51 offen offset:2048 sc1 lds
    buffer_load_dwordx4 v2, s[4:7], s51 offen offset:3072 sc1 lds
    s_waitcnt vmcnt(8)
    s_barrier
    s_add_u32 m0, s30, 129024
    s_add_u32 s51, s35, 6144
    buffer_load_dwordx4 v1, s[4:7], s51 offen offset:0 sc1 lds
    buffer_load_dwordx4 v1, s[4:7], s51 offen offset:1024 sc1 lds
    buffer_load_dwordx4 v2, s[4:7], s51 offen offset:2048 sc1 lds
    buffer_load_dwordx4 v2, s[4:7], s51 offen offset:3072 sc1 lds
    s_and_b32 s40, s2, 7
    s_lshr_b32 s26, s2, 3
    s_lshr_b32 s38, s40, 1
    s_lshl_b32 s38, s38, 3
    s_lshr_b32 s27, s26, 2
    s_add_u32 s38, s38, s27
    s_and_b32 s39, s40, 1
    s_lshl_b32 s39, s39, 2
    s_and_b32 s27, s26, 3
    s_add_u32 s39, s39, s27
    s_add_u32 s40, s38, s39
    s_and_b32 s40, s40, 3
    s_mul_i32 s42, s20, 9216
    s_mul_i32 s43, s39, 331776
    s_add_u32 s43, s43, s42
    s_add_u32 s43, s43, 0x4100000
    s_waitcnt vmcnt(8) lgkmcnt(0)
    s_barrier
    s_mov_b32 s48, 4
    s_mul_i32 s50, s48, 18432
    s_add_u32 s50, s50, s34
    s_add_u32 m0, s30, 0
    s_mov_b32 s53, s50
    buffer_load_dwordx4 v1, s[4:7], s50 offen offset:0  sc1 lds
    buffer_load_dwordx4 v1, s[4:7], s50 offen offset:1024  sc1 lds
    buffer_load_dwordx4 v1, s[4:7], s50 offen offset:2048  sc1 lds
    buffer_load_dwordx4 v1, s[4:7], s50 offen offset:3072  sc1 lds
    s_add_u32 m0, s30, 18432
    s_add_u32 s51, s35, 8192
    buffer_load_dwordx4 v1, s[4:7], s51 offen offset:0 sc1 lds
    buffer_load_dwordx4 v1, s[4:7], s51 offen offset:1024 sc1 lds
    buffer_load_dwordx4 v2, s[4:7], s51 offen offset:2048 sc1 lds
    buffer_load_dwordx4 v2, s[4:7], s51 offen offset:3072 sc1 lds
    s_waitcnt vmcnt(12) lgkmcnt(0)
    s_barrier
    s_mov_b32 s48, 5
    s_mul_i32 s50, s48, 18432
    s_add_u32 s50, s50, s34
    s_cmp_ge_u32 s20, 2
    s_cselect_b32 s52, s50, s53
    s_add_u32 m0, s31, 0
    s_add_u32 s52, s52, s49
    buffer_load_dwordx4 v1, s[4:7], s52 offen  sc1 lds
    s_add_u32 m0, s30, 36864
    s_mov_b32 s53, s50
    buffer_load_dwordx4 v1, s[4:7], s50 offen offset:0  sc1 lds
    buffer_load_dwordx4 v1, s[4:7], s50 offen offset:1024  sc1 lds
    buffer_load_dwordx4 v1, s[4:7], s50 offen offset:2048  sc1 lds
    buffer_load_dwordx4 v1, s[4:7], s50 offen offset:3072  sc1 lds
    s_add_u32 m0, s30, 55296
    s_add_u32 s51, s35, 10240
    buffer_load_dwordx4 v1, s[4:7], s51 offen offset:0 sc1 lds
    buffer_load_dwordx4 v1, s[4:7], s51 offen offset:1024 sc1 lds
    buffer_load_dwordx4 v2, s[4:7], s51 offen offset:2048 sc1 lds
    buffer_load_dwordx4 v2, s[4:7], s51 offen offset:3072 sc1 lds
    s_waitcnt vmcnt(17) lgkmcnt(0)
    s_barrier
    s_mov_b32 s48, 6
    s_mul_i32 s50, s48, 18432
    s_add_u32 s50, s50, s34
    s_add_u32 m0, s30, 73728
    s_mov_b32 s53, s50
    buffer_load_dwordx4 v1, s[4:7], s50 offen offset:0  sc1 lds
    buffer_load_dwordx4 v1, s[4:7], s50 offen offset:1024  sc1 lds
    buffer_load_dwordx4 v1, s[4:7], s50 offen offset:2048  sc1 lds
    buffer_load_dwordx4 v1, s[4:7], s50 offen offset:3072  sc1 lds
    s_add_u32 m0, s30, 92160
    s_add_u32 s51, s35, 12288
    buffer_load_dwordx4 v1, s[4:7], s51 offen offset:0 sc1 lds
    buffer_load_dwordx4 v1, s[4:7], s51 offen offset:1024 sc1 lds
    buffer_load_dwordx4 v2, s[4:7], s51 offen offset:2048 sc1 lds
    buffer_load_dwordx4 v2, s[4:7], s51 offen offset:3072 sc1 lds
    s_waitcnt vmcnt(16) lgkmcnt(0)
    s_barrier
    s_mov_b32 s48, 7
    s_mul_i32 s50, s48, 18432
    s_add_u32 s50, s50, s34
    s_cmp_ge_u32 s20, 2
    s_cselect_b32 s52, s50, s53
    s_add_u32 m0, s31, 73728
    s_add_u32 s52, s52, s49
    buffer_load_dwordx4 v1, s[4:7], s52 offen  sc1 lds
    s_add_u32 m0, s30, 110592
    s_mov_b32 s53, s50
    buffer_load_dwordx4 v1, s[4:7], s50 offen offset:0  sc1 lds
    buffer_load_dwordx4 v1, s[4:7], s50 offen offset:1024  sc1 lds
    buffer_load_dwordx4 v1, s[4:7], s50 offen offset:2048  sc1 lds
    buffer_load_dwordx4 v1, s[4:7], s50 offen offset:3072  sc1 lds
    s_add_u32 m0, s30, 129024
    s_add_u32 s51, s35, 14336
    buffer_load_dwordx4 v1, s[4:7], s51 offen offset:0 sc1 lds
    buffer_load_dwordx4 v1, s[4:7], s51 offen offset:1024 sc1 lds
    buffer_load_dwordx4 v2, s[4:7], s51 offen offset:2048 sc1 lds
    buffer_load_dwordx4 v2, s[4:7], s51 offen offset:3072 sc1 lds
    s_waitcnt vmcnt(17) lgkmcnt(0)
    s_barrier
    s_mov_b32 s48, 8
    s_mul_i32 s50, s48, 18432
    s_add_u32 s50, s50, s34
    s_add_u32 m0, s30, 0
    s_mov_b32 s53, s50
    buffer_load_dwordx4 v1, s[4:7], s50 offen offset:0  sc1 lds
    buffer_load_dwordx4 v1, s[4:7], s50 offen offset:1024  sc1 lds
    buffer_load_dwordx4 v1, s[4:7], s50 offen offset:2048  sc1 lds
    buffer_load_dwordx4 v1, s[4:7], s50 offen offset:3072  sc1 lds
    s_add_u32 m0, s30, 18432
    s_add_u32 s51, s35, 16384
    buffer_load_dwordx4 v1, s[4:7], s51 offen offset:0 sc1 lds
    buffer_load_dwordx4 v1, s[4:7], s51 offen offset:1024 sc1 lds
    buffer_load_dwordx4 v2, s[4:7], s51 offen offset:2048 sc1 lds
    buffer_load_dwordx4 v2, s[4:7], s51 offen offset:3072 sc1 lds
    s_waitcnt vmcnt(16) lgkmcnt(0)
    s_barrier
    s_mov_b32 s48, 5
    s_mul_i32 s50, s48, 18432
    s_add_u32 s50, s50, s34
    s_add_u32 s50, s50, 165888
    s_cmp_ge_u32 s20, 2
    s_cselect_b32 s52, s50, s53
    s_add_u32 m0, s31, 0
    s_add_u32 s52, s52, s49
    buffer_load_dwordx4 v1, s[4:7], s52 offen  sc1 lds
    s_add_u32 m0, s30, 36864
    s_mov_b32 s53, s50
    buffer_load_dwordx4 v1, s[4:7], s50 offen offset:0  sc1 lds
    buffer_load_dwordx4 v1, s[4:7], s50 offen offset:1024  sc1 lds
    buffer_load_dwordx4 v1, s[4:7], s50 offen offset:2048  sc1 lds
    buffer_load_dwordx4 v1, s[4:7], s50 offen offset:3072  sc1 lds
    s_cmp_lg_u32 s22, 0
    s_cbranch_scc1 L_p5_k6
    s_add_u32 s32, s43, 294912
    buffer_load_dwordx4 v[220:223], v1, s[4:7], s32 offen offset:0 sc1
    buffer_load_dwordx4 v[224:227], v1, s[4:7], s32 offen offset:1024 sc1
    buffer_load_dwordx4 v[228:231], v1, s[4:7], s32 offen offset:2048 sc1
    buffer_load_dwordx4 v[232:235], v1, s[4:7], s32 offen offset:3072 sc1
    s_add_u32 s32, s43, 299008
    buffer_load_dwordx4 v[236:239], v1, s[4:7], s32 offen offset:0 sc1
L_p5_k6:
    s_waitcnt vmcnt(18) lgkmcnt(0)
    s_cmp_eq_u32 s22, 0
    s_cbranch_scc1 L_wv_926
    s_waitcnt vmcnt(13)
L_wv_926:
    s_barrier
    s_mov_b32 s48, 6
    s_mul_i32 s50, s48, 18432
    s_add_u32 s50, s50, s34
    s_add_u32 s50, s50, 165888
    s_add_u32 m0, s30, 73728
    s_mov_b32 s53, s50
    buffer_load_dwordx4 v1, s[4:7], s50 offen offset:0  sc1 lds
    buffer_load_dwordx4 v1, s[4:7], s50 offen offset:1024  sc1 lds
    buffer_load_dwordx4 v1, s[4:7], s50 offen offset:2048  sc1 lds
    buffer_load_dwordx4 v1, s[4:7], s50 offen offset:3072  sc1 lds
    s_cmp_lg_u32 s22, 0
    s_cbranch_scc1 L_p5_k7
    s_add_u32 s32, s43, 299008
    buffer_load_dwordx4 v[240:243], v1, s[4:7], s32 offen offset:1024 sc1
    buffer_load_dwordx4 v[244:247], v1, s[4:7], s32 offen offset:2048 sc1
    buffer_load_dwordx4 v[248:251], v1, s[4:7], s32 offen offset:3072 sc1
    s_add_u32 s32, s43, 303104
    buffer_load_dwordx4 v[252:255], v1, s[4:7], s32 offen offset:0 sc1
    s_add_u32 s32, s43, 258048
    buffer_load_dwordx4 v[184:187], v1, s[4:7], s32 offen offset:0 sc1
L_p5_k7:
    s_waitcnt vmcnt(18) lgkmcnt(0)
    s_cmp_eq_u32 s22, 0
    s_cbranch_scc1 L_wv_953
    s_waitcnt vmcnt(8)
L_wv_953:
    s_barrier
    s_mov_b32 s48, 7
    s_mul_i32 s50, s48, 18432
    s_add_u32 s50, s50, s34
    s_add_u32 s50, s50, 165888
    s_cmp_ge_u32 s20, 2
    s_cselect_b32 s52, s50, s53
    s_add_u32 m0, s31, 73728
    s_add_u32 s52, s52, s49
    buffer_load_dwordx4 v1, s[4:7], s52 offen  sc1 lds
    s_add_u32 m0, s30, 110592
    s_mov_b32 s53, s50
    buffer_load_dwordx4 v1, s[4:7], s50 offen offset:0  sc1 lds
    buffer_load_dwordx4 v1, s[4:7], s50 offen offset:1024  sc1 lds
    buffer_load_dwordx4 v1, s[4:7], s50 offen offset:2048  sc1 lds
    buffer_load_dwordx4 v1, s[4:7], s50 offen offset:3072  sc1 lds
    s_cmp_lg_u32 s22, 0
    s_cbranch_scc1 L_p5_k8
    s_add_u32 s32, s43, 258048
    buffer_load_dwordx4 v[188:191], v1, s[4:7], s32 offen offset:1024 sc1
    buffer_load_dwordx4 v[192:195], v1, s[4:7], s32 offen offset:2048 sc1
    buffer_load_dwordx4 v[196:199], v1, s[4:7], s32 offen offset:3072 sc1
    s_add_u32 s32, s43, 262144
    buffer_load_dwordx4 v[200:203], v1, s[4:7], s32 offen offset:0 sc1
    buffer_load_dwordx4 v[204:207], v1, s[4:7], s32 offen offset:1024 sc1
L_p5_k8:
    s_waitcnt vmcnt(24) lgkmcnt(0)
    s_cmp_eq_u32 s22, 0
    s_cbranch_scc1 L_wv_984
    s_waitcnt vmcnt(9)
L_wv_984:
    s_barrier
    s_mov_b32 s48, 8
    s_mul_i32 s50, s48, 18432
    s_add_u32 s50, s50, s34
    s_add_u32 s50, s50, 165888
    s_add_u32 m0, s30, 0
    s_mov_b32 s53, s50
    buffer_load_dwordx4 v1, s[4:7], s50 offen offset:0  sc1 lds
    buffer_load_dwordx4 v1, s[4:7], s50 offen offset:1024  sc1 lds
    buffer_load_dwordx4 v1, s[4:7], s50 offen offset:2048  sc1 lds
    buffer_load_dwordx4 v1, s[4:7], s50 offen offset:3072  sc1 lds
    s_cmp_lg_u32 s22, 0
    s_cbranch_scc1 L_p5_k9
    s_add_u32 s32, s43, 262144
    buffer_load_dwordx4 v[208:211], v1, s[4:7], s32 offen offset:2048 sc1
    buffer_load_dwordx4 v[212:215], v1, s[4:7], s32 offen offset:3072 sc1
    s_add_u32 s32, s43, 266240
    buffer_load_dwordx4 v[216:219], v1, s[4:7], s32 offen offset:0 sc1
    s_add_u32 s32, s43, 221184
    buffer_load_dwordx4 v[148:151], v1, s[4:7], s32 offen offset:0 sc1
    buffer_load_dwordx4 v[152:155], v1, s[4:7], s32 offen offset:1024 sc1
    buffer_load_dwordx4 v[156:159], v1, s[4:7], s32 offen offset:2048 sc1
    buffer_load_dwordx4 v[160:163], v1, s[4:7], s32 offen offset:3072 sc1
    s_add_u32 s32, s43, 225280
    buffer_load_dwordx4 v[164:167], v1, s[4:7], s32 offen offset:0 sc1
    buffer_load_dwordx4 v[168:171], v1, s[4:7], s32 offen offset:1024 sc1
    buffer_load_dwordx4 v[172:175], v1, s[4:7], s32 offen offset:2048 sc1
    buffer_load_dwordx4 v[176:179], v1, s[4:7], s32 offen offset:3072 sc1
    s_add_u32 s32, s43, 229376
    buffer_load_dwordx4 v[180:183], v1, s[4:7], s32 offen offset:0 sc1
    s_add_u32 s32, s43, 184320
    buffer_load_dwordx4 v[112:115], v1, s[4:7], s32 offen offset:0 sc1
    buffer_load_dwordx4 v[116:119], v1, s[4:7], s32 offen offset:1024 sc1
    buffer_load_dwordx4 v[120:123], v1, s[4:7], s32 offen offset:2048 sc1
    buffer_load_dwordx4 v[124:127], v1, s[4:7], s32 offen offset:3072 sc1
    s_add_u32 s32, s43, 188416
    buffer_load_dwordx4 v[128:131], v1, s[4:7], s32 offen offset:0 sc1
    buffer_load_dwordx4 v[132:135], v1, s[4:7], s32 offen offset:1024 sc1
    buffer_load_dwordx4 v[136:139], v1, s[4:7], s32 offen offset:2048 sc1
    buffer_load_dwordx4 v[140:143], v1, s[4:7], s32 offen offset:3072 sc1
    s_add_u32 s32, s43, 192512
    buffer_load_dwordx4 v[144:147], v1, s[4:7], s32 offen offset:0 sc1
    s_add_u32 s32, s43, 147456
    buffer_load_dwordx4 v[76:79], v1, s[4:7], s32 offen offset:0 sc1
    buffer_load_dwordx4 v[80:83], v1, s[4:7], s32 offen offset:1024 sc1
    buffer_load_dwordx4 v[84:87], v1, s[4:7], s32 offen offset:2048 sc1
    buffer_load_dwordx4 v[88:91], v1, s[4:7], s32 offen offset:3072 sc1
    s_add_u32 s32, s43, 151552
    buffer_load_dwordx4 v[92:95], v1, s[4:7], s32 offen offset:0 sc1
    buffer_load_dwordx4 v[96:99], v1, s[4:7], s32 offen offset:1024 sc1
    buffer_load_dwordx4 v[100:103], v1, s[4:7], s32 offen offset:2048 sc1
    buffer_load_dwordx4 v[104:107], v1, s[4:7], s32 offen offset:3072 sc1
    s_add_u32 s32, s43, 155648
    buffer_load_dwordx4 v[108:111], v1, s[4:7], s32 offen offset:0 sc1
L_p5_k9:
    s_waitcnt vmcnt(43) lgkmcnt(0)
    s_cmp_eq_u32 s22, 0
    s_cbranch_scc1 L_wv_1044
    s_waitcnt vmcnt(8)
L_wv_1044:
    s_barrier
    s_mov_b32 s48, 0
    s_mul_i32 s50, s48, 18432
    s_add_u32 s50, s50, s34
    s_add_u32 s50, s50, 165888
    s_cmp_ge_u32 s20, 2
    s_cselect_b32 s52, s50, s53
    s_add_u32 m0, s31, 0
    s_add_u32 s52, s52, s49
    buffer_load_dwordx4 v1, s[4:7], s52 offen  sc1 lds
    s_add_u32 m0, s30, 36864
    s_mov_b32 s53, s50
    buffer_load_dwordx4 v1, s[4:7], s50 offen offset:0  sc1 lds
    buffer_load_dwordx4 v1, s[4:7], s50 offen offset:1024  sc1 lds
    buffer_load_dwordx4 v1, s[4:7], s50 offen offset:2048  sc1 lds
    buffer_load_dwordx4 v1, s[4:7], s50 offen offset:3072  sc1 lds
    s_add_u32 m0, s30, 55296
    s_add_u32 s51, s35, 0
    buffer_load_dwordx4 v1, s[4:7], s51 offen offset:0 sc1 lds
    buffer_load_dwordx4 v1, s[4:7], s51 offen offset:1024 sc1 lds
    buffer_load_dwordx4 v2, s[4:7], s51 offen offset:2048 sc1 lds
    buffer_load_dwordx4 v2, s[4:7], s51 offen offset:3072 sc1 lds
    s_waitcnt vmcnt(48) lgkmcnt(0)
    s_cmp_eq_u32 s22, 0
    s_cbranch_scc1 L_wv_1071
    s_waitcnt vmcnt(13)
L_wv_1071:
    s_barrier
    buffer_load_dwordx4 v[16:19], v3, s[4:7], s29 offen offset:0 sc1
    buffer_load_dwordx4 v[20:23], v3, s[4:7], s29 offen offset:1024 sc1
    buffer_load_dwordx4 v[24:27], v3, s[4:7], s29 offen offset:2048 sc1
    buffer_load_dwordx4 v[28:31], v3, s[4:7], s29 offen offset:3072 sc1
    s_mov_b32 s48, 1
    s_mul_i32 s50, s48, 18432
    s_add_u32 s50, s50, s34
    s_add_u32 s50, s50, 165888
    s_add_u32 m0, s30, 73728
    s_mov_b32 s53, s50
    buffer_load_dwordx4 v1, s[4:7], s50 offen offset:0  sc1 lds
    buffer_load_dwordx4 v1, s[4:7], s50 offen offset:1024  sc1 lds
    buffer_load_dwordx4 v1, s[4:7], s50 offen offset:2048  sc1 lds
    buffer_load_dwordx4 v1, s[4:7], s50 offen offset:3072  sc1 lds
    s_add_u32 m0, s30, 92160
    s_add_u32 s51, s35, 2048
    buffer_load_dwordx4 v1, s[4:7], s51 offen offset:0 sc1 lds
    buffer_load_dwordx4 v1, s[4:7], s51 offen offset:1024 sc1 lds
    buffer_load_dwordx4 v2, s[4:7], s51 offen offset:2048 sc1 lds
    buffer_load_dwordx4 v2, s[4:7], s51 offen offset:3072 sc1 lds
    s_waitcnt vmcnt(20) lgkmcnt(0)
    s_barrier
    s_mov_b32 s48, 2
    s_mul_i32 s50, s48, 18432
    s_add_u32 s50, s50, s34
    s_add_u32 s50, s50, 165888
    s_cmp_ge_u32 s20, 2
    s_cselect_b32 s52, s50, s53
    s_add_u32 m0, s31, 73728
    s_add_u32 s52, s52, s49
    buffer_load_dwordx4 v1, s[4:7], s52 offen  sc1 lds
    s_add_u32 m0, s30, 110592
    s_mov_b32 s53, s50
    buffer_load_dwordx4 v1, s[4:7], s50 offen offset:0  sc1 lds
    buffer_load_dwordx4 v1, s[4:7], s50 offen offset:1024  sc1 lds
    buffer_load_dwordx4 v1, s[4:7], s50 offen offset:2048  sc1 lds
    buffer_load_dwordx4 v1, s[4:7], s50 offen offset:3072  sc1 lds
    s_add_u32 m0, s30, 129024
    s_add_u32 s51, s35, 4096
    buffer_load_dwordx4 v1, s[4:7], s51 offen offset:0 sc1 lds
    buffer_load_dwordx4 v1, s[4:7], s51 offen offset:1024 sc1 lds
    buffer_load_dwordx4 v2, s[4:7], s51 offen offset:2048 sc1 lds
    buffer_load_dwordx4 v2, s[4:7], s51 offen offset:3072 sc1 lds
    s_setprio 2
    s_mov_b32 s60, 65536
    s_waitcnt vmcnt(17)
L_g_chk:
    v_or3_b32 v32, v17, v19, v21
    v_or3_b32 v33, v23, v25, v27
    v_or3_b32 v32, v29, v31, v32
    v_or_b32 v32, v32, v33
    v_cmp_gt_i32 vcc, 0, v32
    s_sub_u32 s60, s60, 1
    s_cbranch_scc1 L_g_ok
    s_cbranch_vccz L_g_ok
    buffer_load_dwordx4 v[16:19], v3, s[4:7], s29 offen offset:0 sc1
    buffer_load_dwordx4 v[20:23], v3, s[4:7], s29 offen offset:1024 sc1
    buffer_load_dwordx4 v[24:27], v3, s[4:7], s29 offen offset:2048 sc1
    buffer_load_dwordx4 v[28:31], v3, s[4:7], s29 offen offset:3072 sc1
    s_waitcnt vmcnt(0)
    s_branch L_g_chk
L_g_ok:
    v_add_f32 v16, v16, v20
    v_add_f32 v24, v24, v28
    v_add_f32 v17, v17, v21
    v_add_f32 v25, v25, v29
    v_add_f32 v18, v18, v22
    v_add_f32 v26, v26, v30
    v_add_f32 v19, v19, v23
    v_add_f32 v27, v27, v31
    v_add_f32 v16, v16, v24
    v_add_f32 v17, v17, v25
    v_add_f32 v18, v18, v26
    v_add_f32 v19, v19, v27
    v_add_f32_dpp v16, v16, v16 row_ror:4 row_mask:0xf bank_mask:0xf
    v_add_f32_dpp v17, v17, v17 row_ror:4 row_mask:0xf bank_mask:0xf
    v_add_f32_dpp v18, v18, v18 row_ror:4 row_mask:0xf bank_mask:0xf
    v_add_f32_dpp v19, v19, v19 row_ror:4 row_mask:0xf bank_mask:0xf
    v_add_f32_dpp v16, v16, v16 row_ror:8 row_mask:0xf bank_mask:0xf
    v_add_f32_dpp v17, v17, v17 row_ror:8 row_mask:0xf bank_mask:0xf
    v_add_f32_dpp v18, v18, v18 row_ror:8 row_mask:0xf bank_mask:0xf
    v_add_f32_dpp v19, v19, v19 row_ror:8 row_mask:0xf bank_mask:0xf
    v_mul_f32 v16, 0x39e38e39, v16
    v_mul_f32 v17, 0x39e38e39, v17
    v_mul_f32 v18, 0x39e38e39, v18
    v_mul_f32 v19, 0x39e38e39, v19
    v_fma_f32 v17, -v16, v16, v17
    v_fma_f32 v19, -v18, v18, v19
    v_max_f32 v17, 0, v17
    v_max_f32 v19, 0, v19
    v_add_f32 v17, 0x3727c5ac, v17
    v_add_f32 v19, 0x3727c5ac, v19
    v_rsq_f32 v20, v17
    v_rsq_f32 v21, v19
    v_and_b32 v32, 0xff, v3
    s_lshl_b32 s33, s20, 8
    s_add_u32 s33, s33, 148480
    v_add_u32 v32, s33, v32
    v_mul_f32 v22, v16, v20
    v_mul_f32 v23, v18, v21
    ds_write_b128 v32, v[20:23]
    s_setprio 0
    s_waitcnt vmcnt(17) lgkmcnt(0)
    s_barrier
    s_mov_b32 s48, 3
    s_mul_i32 s50, s48, 18432
    s_add_u32 s50, s50, s34
    s_add_u32 s50, s50, 165888
    s_add_u32 m0, s30, 0
    s_mov_b32 s53, s50
    buffer_load_dwordx4 v1, s[4:7], s50 offen offset:0  sc1 lds
    buffer_load_dwordx4 v1, s[4:7], s50 offen offset:1024  sc1 lds
    buffer_load_dwordx4 v1, s[4:7], s50 offen offset:2048  sc1 lds
    buffer_load_dwordx4 v1, s[4:7], s50 offen offset:3072  sc1 lds
    s_add_u32 m0, s30, 18432
    s_add_u32 s51, s35, 6144
    buffer_load_dwordx4 v1, s[4:7], s51 offen offset:0 sc1 lds
    buffer_load_dwordx4 v1, s[4:7], s51 offen offset:1024 sc1 lds
    buffer_load_dwordx4 v2, s[4:7], s51 offen offset:2048 sc1 lds
    buffer_load_dwordx4 v2, s[4:7], s51 offen offset:3072 sc1 lds
    s_waitcnt vmcnt(16) lgkmcnt(0)
    s_barrier
    s_mov_b32 s48, 4
    s_mul_i32 s50, s48, 18432
    s_add_u32 s50, s50, s34
    s_add_u32 s50, s50, 165888
    s_cmp_ge_u32 s20, 2
    s_cselect_b32 s52, s50, s53
    s_add_u32 m0, s31, 0
    s_add_u32 s52, s52, s49
    buffer_load_dwordx4 v1, s[4:7], s52 offen  sc1 lds
    s_add_u32 m0, s30, 36864
    s_mov_b32 s53, s50
    buffer_load_dwordx4 v1, s[4:7], s50 offen offset:0  sc1 lds
    buffer_load_dwordx4 v1, s[4:7], s50 offen offset:1024  sc1 lds
    buffer_load_dwordx4 v1, s[4:7], s50 offen offset:2048  sc1 lds
    buffer_load_dwordx4 v1, s[4:7], s50 offen offset:3072  sc1 lds
    s_add_u32 m0, s30, 55296
    s_add_u32 s51, s35, 8192
    buffer_load_dwordx4 v1, s[4:7], s51 offen offset:0 sc1 lds
    buffer_load_dwordx4 v1, s[4:7], s51 offen offset:1024 sc1 lds
    buffer_load_dwordx4 v2, s[4:7], s51 offen offset:2048 sc1 lds
    buffer_load_dwordx4 v2, s[4:7], s51 offen offset:3072 sc1 lds
    s_waitcnt vmcnt(17) lgkmcnt(0)
    s_barrier
    s_waitcnt vmcnt(8) lgkmcnt(0)
    s_barrier
    s_waitcnt vmcnt(0) lgkmcnt(0)
    s_barrier
    s_barrier
    s_mov_b32 s56, 1
    s_atomic_add s56, s[54:55], 0
    s_mov_b32 s57, 0
    s_atomic_add s57, s[54:55], 0 glc
    s_lshl_b32 s48, s23, 1
    s_add_u32 s48, s48, 0
    s_add_u32 m0, s30, 92160
    s_lshl_b32 s51, s48, 7
    buffer_load_dwordx4 v8, s[8:11], s51 offen offset:0  lds
    buffer_load_dwordx4 v9, s[8:11], s51 offen offset:1024  lds
    buffer_load_dwordx4 v10, s[8:11], s51 offen offset:2048  lds
    buffer_load_dwordx4 v11, s[8:11], s51 offen offset:3072  lds
    s_lshl_b32 s48, s23, 1
    s_add_u32 s48, s48, 1
    s_add_u32 m0, s30, 129024
    s_lshl_b32 s51, s48, 7
    buffer_load_dwordx4 v8, s[8:11], s51 offen offset:0  lds
    buffer_load_dwordx4 v9, s[8:11], s51 offen offset:1024  lds
    buffer_load_dwordx4 v10, s[8:11], s51 offen offset:2048  lds
    buffer_load_dwordx4 v11, s[8:11], s51 offen offset:3072  lds
    s_lshr_b32 s48, s46, 1
    s_cmp_eq_u32 s48, s23
    s_cselect_b32 s48, 1, 31
    s_and_b32 s48, s48, s46
    s_add_u32 m0, s30, 18432
    s_lshl_b32 s51, s48, 7
    buffer_load_dwordx4 v8, s[8:11], s51 offen offset:0  lds
    buffer_load_dwordx4 v9, s[8:11], s51 offen offset:1024  lds
    buffer_load_dwordx4 v10, s[8:11], s51 offen offset:2048  lds
    buffer_load_dwordx4 v11, s[8:11], s51 offen offset:3072  lds
    s_waitcnt lgkmcnt(0)
    s_cmp_ge_u32 s57, 16
    s_cbranch_scc1 L_g_r0
    s_mov_b32 s57, 0
    s_atomic_add s57, s[54:55], 0 glc
    s_waitcnt vmcnt(8)
    s_barrier
    s_waitcnt lgkmcnt(0)
    s_cmp_ge_u32 s57, 16
    s_cbranch_scc1 L_g_r1
    s_waitcnt vmcnt(4)
    s_barrier
    s_mov_b32 s60, 65536
L_poll_z2:
    s_mov_b32 s57, 0
    s_atomic_add s57, s[54:55], 0 glc
    s_waitcnt lgkmcnt(0)
    s_cmp_ge_u32 s57, 16
    s_cbranch_scc1 L_pd_z2
    s_sub_u32 s60, s60, 1
    s_cbranch_scc1 L_pd_z2
    s_sleep 2
    s_branch L_poll_z2
L_pd_z2:
    s_lshr_b32 s48, s46, 1
    s_cmp_eq_u32 s48, s23
    s_cselect_b32 s48, 1, 31
    s_and_b32 s48, s48, s46
    s_mul_i32 s50, s48, 18432
    s_add_u32 s50, s50, s36
    s_add_u32 m0, s30, 0
    s_mov_b32 s53, s50
    buffer_load_dwordx4 v1, s[4:7], s50 offen offset:0 sc1 lds
    buffer_load_dwordx4 v1, s[4:7], s50 offen offset:1024 sc1 lds
    buffer_load_dwordx4 v1, s[4:7], s50 offen offset:2048 sc1 lds
    buffer_load_dwordx4 v1, s[4:7], s50 offen offset:3072 sc1 lds
    s_lshr_b32 s48, s47, 1
    s_cmp_eq_u32 s48, s23
    s_cselect_b32 s48, 1, 31
    s_and_b32 s48, s48, s47
    s_mul_i32 s50, s48, 18432
    s_add_u32 s50, s50, s36
    s_cmp_ge_u32 s20, 2
    s_cselect_b32 s52, s50, s53
    s_add_u32 m0, s31, 0
    s_add_u32 s52, s52, s49
    buffer_load_dwordx4 v1, s[4:7], s52 offen sc1 lds
    s_add_u32 m0, s30, 36864
    s_mov_b32 s53, s50
    buffer_load_dwordx4 v1, s[4:7], s50 offen offset:0 sc1 lds
    buffer_load_dwordx4 v1, s[4:7], s50 offen offset:1024 sc1 lds
    buffer_load_dwordx4 v1, s[4:7], s50 offen offset:2048 sc1 lds
    buffer_load_dwordx4 v1, s[4:7], s50 offen offset:3072 sc1 lds
    s_lshr_b32 s48, s47, 1
    s_cmp_eq_u32 s48, s23
    s_cselect_b32 s48, 1, 31
    s_and_b32 s48, s48, s47
    s_add_u32 m0, s30, 55296
    s_lshl_b32 s51, s48, 7
    buffer_load_dwordx4 v8, s[8:11], s51 offen offset:0  lds
    buffer_load_dwordx4 v9, s[8:11], s51 offen offset:1024  lds
    buffer_load_dwordx4 v10, s[8:11], s51 offen offset:2048  lds
    buffer_load_dwordx4 v11, s[8:11], s51 offen offset:3072  lds
    s_branch L_g_jn
L_g_r0:
    s_lshr_b32 s48, s46, 1
    s_cmp_eq_u32 s48, s23
    s_cselect_b32 s48, 1, 31
    s_and_b32 s48, s48, s46
    s_mul_i32 s50, s48, 18432
    s_add_u32 s50, s50, s36
    s_add_u32 m0, s30, 0
    s_mov_b32 s53, s50
    buffer_load_dwordx4 v1, s[4:7], s50 offen offset:0 sc1 lds
    buffer_load_dwordx4 v1, s[4:7], s50 offen offset:1024 sc1 lds
    buffer_load_dwordx4 v1, s[4:7], s50 offen offset:2048 sc1 lds
    buffer_load_dwordx4 v1, s[4:7], s50 offen offset:3072 sc1 lds
    s_lshr_b32 s48, s47, 1
    s_cmp_eq_u32 s48, s23
    s_cselect_b32 s48, 1, 31
    s_and_b32 s48, s48, s47
    s_mul_i32 s50, s48, 18432
    s_add_u32 s50, s50, s36
    s_cmp_ge_u32 s20, 2
    s_cselect_b32 s52, s50, s53
    s_add_u32 m0, s31, 0
    s_add_u32 s52, s52, s49
    buffer_load_dwordx4 v1, s[4:7], s52 offen sc1 lds
    s_add_u32 m0, s30, 36864
    s_mov_b32 s53, s50
    buffer_load_dwordx4 v1, s[4:7], s50 offen offset:0 sc1 lds
    buffer_load_dwordx4 v1, s[4:7], s50 offen offset:1024 sc1 lds
    buffer_load_dwordx4 v1, s[4:7], s50 offen offset:2048 sc1 lds
    buffer_load_dwordx4 v1, s[4:7], s50 offen offset:3072 sc1 lds
    s_lshr_b32 s48, s47, 1
    s_cmp_eq_u32 s48, s23
    s_cselect_b32 s48, 1, 31
    s_and_b32 s48, s48, s47
    s_add_u32 m0, s30, 55296
    s_lshl_b32 s51, s48, 7
    buffer_load_dwordx4 v8, s[8:11], s51 offen offset:0  lds
    buffer_load_dwordx4 v9, s[8:11], s51 offen offset:1024  lds
    buffer_load_dwordx4 v10, s[8:11], s51 offen offset:2048  lds
    buffer_load_dwordx4 v11, s[8:11], s51 offen offset:3072  lds
    s_waitcnt vmcnt(21)
    s_barrier
    s_waitcnt vmcnt(17)
    s_barrier
    s_branch L_g_jn
L_g_r1:
    s_lshr_b32 s48, s46, 1
    s_cmp_eq_u32 s48, s23
    s_cselect_b32 s48, 1, 31
    s_and_b32 s48, s48, s46
    s_mul_i32 s50, s48, 18432
    s_add_u32 s50, s50, s36
    s_add_u32 m0, s30, 0
    s_mov_b32 s53, s50
    buffer_load_dwordx4 v1, s[4:7], s50 offen offset:0 sc1 lds
    buffer_load_dwordx4 v1, s[4:7], s50 offen offset:1024 sc1 lds
    buffer_load_dwordx4 v1, s[4:7], s50 offen offset:2048 sc1 lds
    buffer_load_dwordx4 v1, s[4:7], s50 offen offset:3072 sc1 lds
    s_lshr_b32 s48, s47, 1
    s_cmp_eq_u32 s48, s23
    s_cselect_b32 s48, 1, 31
    s_and_b32 s48, s48, s47
    s_mul_i32 s50, s48, 18432
    s_add_u32 s50, s50, s36
    s_cmp_ge_u32 s20, 2
    s_cselect_b32 s52, s50, s53
    s_add_u32 m0, s31, 0
    s_add_u32 s52, s52, s49
    buffer_load_dwordx4 v1, s[4:7], s52 offen sc1 lds
    s_add_u32 m0, s30, 36864
    s_mov_b32 s53, s50
    buffer_load_dwordx4 v1, s[4:7], s50 offen offset:0 sc1 lds
    buffer_load_dwordx4 v1, s[4:7], s50 offen offset:1024 sc1 lds
    buffer_load_dwordx4 v1, s[4:7], s50 offen offset:2048 sc1 lds
    buffer_load_dwordx4 v1, s[4:7], s50 offen offset:3072 sc1 lds
    s_lshr_b32 s48, s47, 1
    s_cmp_eq_u32 s48, s23
    s_cselect_b32 s48, 1, 31
    s_and_b32 s48, s48, s47
    s_add_u32 m0, s30, 55296
    s_lshl_b32 s51, s48, 7
    buffer_load_dwordx4 v8, s[8:11], s51 offen offset:0  lds
    buffer_load_dwordx4 v9, s[8:11], s51 offen offset:1024  lds
    buffer_load_dwordx4 v10, s[8:11], s51 offen offset:2048  lds
    buffer_load_dwordx4 v11, s[8:11], s51 offen offset:3072  lds
    s_waitcnt vmcnt(17)
    s_barrier
L_g_jn:
    s_add_u32 s44, s44, 4
    s_cmp_ge_u32 s44, 32
    s_cselect_b32 s44, 4, s44
    s_add_u32 s45, s45, 4
    s_cmp_ge_u32 s45, 32
    s_cselect_b32 s45, 5, s45
    s_add_u32 s46, s46, 4
    s_and_b32 s46, s46, 31
    s_add_u32 s47, s47, 4
    s_and_b32 s47, s47, 31
    s_lshr_b32 s48, s44, 1
    s_cmp_eq_u32 s48, s23
    s_cselect_b32 s48, 1, 31
    s_and_b32 s48, s48, s44
    s_mul_i32 s50, s48, 18432
    s_add_u32 s50, s50, s36
    s_add_u32 m0, s30, 73728
    s_mov_b32 s53, s50
    buffer_load_dwordx4 v1, s[4:7], s50 offen offset:0 sc1 lds
    buffer_load_dwordx4 v1, s[4:7], s50 offen offset:1024 sc1 lds
    buffer_load_dwordx4 v1, s[4:7], s50 offen offset:2048 sc1 lds
    buffer_load_dwordx4 v1, s[4:7], s50 offen offset:3072 sc1 lds
    s_lshr_b32 s48, s44, 1
    s_cmp_eq_u32 s48, s23
    s_cselect_b32 s48, 1, 31
    s_and_b32 s48, s48, s44
    s_add_u32 m0, s30, 92160
    s_lshl_b32 s51, s48, 7
    buffer_load_dwordx4 v8, s[8:11], s51 offen offset:0  lds
    buffer_load_dwordx4 v9, s[8:11], s51 offen offset:1024  lds
    buffer_load_dwordx4 v10, s[8:11], s51 offen offset:2048  lds
    buffer_load_dwordx4 v11, s[8:11], s51 offen offset:3072  lds
    s_add_u32 s44, s44, 4
    s_cmp_ge_u32 s44, 32
    s_cselect_b32 s44, 4, s44
    s_waitcnt vmcnt(16)
    s_barrier
    s_lshr_b32 s48, s45, 1
    s_cmp_eq_u32 s48, s23
    s_cselect_b32 s48, 1, 31
    s_and_b32 s48, s48, s45
    s_mul_i32 s50, s48, 18432
    s_add_u32 s50, s50, s36
    s_cmp_ge_u32 s20, 2
    s_cselect_b32 s52, s50, s53
    s_add_u32 m0, s31, 73728
    s_add_u32 s52, s52, s49
    buffer_load_dwordx4 v1, s[4:7], s52 offen sc1 lds
    s_add_u32 m0, s30, 110592
    s_mov_b32 s53, s50
    buffer_load_dwordx4 v1, s[4:7], s50 offen offset:0 sc1 lds
    buffer_load_dwordx4 v1, s[4:7], s50 offen offset:1024 sc1 lds
    buffer_load_dwordx4 v1, s[4:7], s50 offen offset:2048 sc1 lds
    buffer_load_dwordx4 v1, s[4:7], s50 offen offset:3072 sc1 lds
    s_lshr_b32 s48, s45, 1
    s_cmp_eq_u32 s48, s23
    s_cselect_b32 s48, 1, 31
    s_and_b32 s48, s48, s45
    s_add_u32 m0, s30, 129024
    s_lshl_b32 s51, s48, 7
    buffer_load_dwordx4 v8, s[8:11], s51 offen offset:0  lds
    buffer_load_dwordx4 v9, s[8:11], s51 offen offset:1024  lds
    buffer_load_dwordx4 v10, s[8:11], s51 offen offset:2048  lds
    buffer_load_dwordx4 v11, s[8:11], s51 offen offset:3072  lds
    s_add_u32 s45, s45, 4
    s_cmp_ge_u32 s45, 32
    s_cselect_b32 s45, 5, s45
    s_waitcnt vmcnt(17)
    s_barrier
    s_lshr_b32 s48, s46, 1
    s_cmp_eq_u32 s48, s23
    s_cselect_b32 s48, 1, 31
    s_and_b32 s48, s48, s46
    s_mul_i32 s50, s48, 18432
    s_add_u32 s50, s50, s36
    s_add_u32 m0, s30, 0
    s_mov_b32 s53, s50
    buffer_load_dwordx4 v1, s[4:7], s50 offen offset:0 sc1 lds
    buffer_load_dwordx4 v1, s[4:7], s50 offen offset:1024 sc1 lds
    buffer_load_dwordx4 v1, s[4:7], s50 offen offset:2048 sc1 lds
    buffer_load_dwordx4 v1, s[4:7], s50 offen offset:3072 sc1 lds
    s_lshr_b32 s48, s46, 1
    s_cmp_eq_u32 s48, s23
    s_cselect_b32 s48, 1, 31
    s_and_b32 s48, s48, s46
    s_add_u32 m0, s30, 18432
    s_lshl_b32 s51, s48, 7
    buffer_load_dwordx4 v8, s[8:11], s51 offen offset:0  lds
    buffer_load_dwordx4 v9, s[8:11], s51 offen offset:1024  lds
    buffer_load_dwordx4 v10, s[8:11], s51 offen offset:2048  lds
    buffer_load_dwordx4 v11, s[8:11], s51 offen offset:3072  lds
    s_add_u32 s46, s46, 4
    s_and_b32 s46, s46, 31
    s_waitcnt vmcnt(16)
    s_barrier
    s_lshr_b32 s48, s47, 1
    s_cmp_eq_u32 s48, s23
    s_cselect_b32 s48, 1, 31
    s_and_b32 s48, s48, s47
    s_mul_i32 s50, s48, 18432
    s_add_u32 s50, s50, s36
    s_cmp_ge_u32 s20, 2
    s_cselect_b32 s52, s50, s53
    s_add_u32 m0, s31, 0
    s_add_u32 s52, s52, s49
    buffer_load_dwordx4 v1, s[4:7], s52 offen sc1 lds
    s_add_u32 m0, s30, 36864
    s_mov_b32 s53, s50
    buffer_load_dwordx4 v1, s[4:7], s50 offen offset:0 sc1 lds
    buffer_load_dwordx4 v1, s[4:7], s50 offen offset:1024 sc1 lds
    buffer_load_dwordx4 v1, s[4:7], s50 offen offset:2048 sc1 lds
    buffer_load_dwordx4 v1, s[4:7], s50 offen offset:3072 sc1 lds
    s_lshr_b32 s48, s47, 1
    s_cmp_eq_u32 s48, s23
    s_cselect_b32 s48, 1, 31
    s_and_b32 s48, s48, s47
    s_add_u32 m0, s30, 55296
    s_lshl_b32 s51, s48, 7
    buffer_load_dwordx4 v8, s[8:11], s51 offen offset:0  lds
    buffer_load_dwordx4 v9, s[8:11], s51 offen offset:1024  lds
    buffer_load_dwordx4 v10, s[8:11], s51 offen offset:2048  lds
    buffer_load_dwordx4 v11, s[8:11], s51 offen offset:3072  lds
    s_add_u32 s47, s47, 4
    s_and_b32 s47, s47, 31
    s_mov_b32 s41, 6
L_g_ll:
    s_waitcnt vmcnt(17)
    s_barrier
    s_lshr_b32 s48, s44, 1
    s_cmp_eq_u32 s48, s23
    s_cselect_b32 s48, 1, 31
    s_and_b32 s48, s48, s44
    s_mul_i32 s50, s48, 18432
    s_add_u32 s50, s50, s36
    s_add_u32 m0, s30, 73728
    s_mov_b32 s53, s50
    buffer_load_dwordx4 v1, s[4:7], s50 offen offset:0 sc1 lds
    buffer_load_dwordx4 v1, s[4:7], s50 offen offset:1024 sc1 lds
    buffer_load_dwordx4 v1, s[4:7], s50 offen offset:2048 sc1 lds
    buffer_load_dwordx4 v1, s[4:7], s50 offen offset:3072 sc1 lds
    s_lshr_b32 s48, s44, 1
    s_cmp_eq_u32 s48, s23
    s_cselect_b32 s48, 1, 31
    s_and_b32 s48, s48, s44
    s_add_u32 m0, s30, 92160
    s_lshl_b32 s51, s48, 7
    buffer_load_dwordx4 v8, s[8:11], s51 offen offset:0  lds
    buffer_load_dwordx4 v9, s[8:11], s51 offen offset:1024  lds
    buffer_load_dwordx4 v10, s[8:11], s51 offen offset:2048  lds
    buffer_load_dwordx4 v11, s[8:11], s51 offen offset:3072  lds
    s_add_u32 s44, s44, 4
    s_cmp_ge_u32 s44, 32
    s_cselect_b32 s44, 4, s44
    s_waitcnt vmcnt(16)
    s_barrier
    s_lshr_b32 s48, s45, 1
    s_cmp_eq_u32 s48, s23
    s_cselect_b32 s48, 1, 31
    s_and_b32 s48, s48, s45
    s_mul_i32 s50, s48, 18432
    s_add_u32 s50, s50, s36
    s_cmp_ge_u32 s20, 2
    s_cselect_b32 s52, s50, s53
    s_add_u32 m0, s31, 73728
    s_add_u32 s52, s52, s49
    buffer_load_dwordx4 v1, s[4:7], s52 offen sc1 lds
    s_add_u32 m0, s30, 110592
    s_mov_b32 s53, s50
    buffer_load_dwordx4 v1, s[4:7], s50 offen offset:0 sc1 lds
    buffer_load_dwordx4 v1, s[4:7], s50 offen offset:1024 sc1 lds
    buffer_load_dwordx4 v1, s[4:7], s50 offen offset:2048 sc1 lds
    buffer_load_dwordx4 v1, s[4:7], s50 offen offset:3072 sc1 lds
    s_lshr_b32 s48, s45, 1
    s_cmp_eq_u32 s48, s23
    s_cselect_b32 s48, 1, 31
    s_and_b32 s48, s48, s45
    s_add_u32 m0, s30, 129024
    s_lshl_b32 s51, s48, 7
    buffer_load_dwordx4 v8, s[8:11], s51 offen offset:0  lds
    buffer_load_dwordx4 v9, s[8:11], s51 offen offset:1024  lds
    buffer_load_dwordx4 v10, s[8:11], s51 offen offset:2048  lds
    buffer_load_dwordx4 v11, s[8:11], s51 offen offset:3072  lds
    s_add_u32 s45, s45, 4
    s_cmp_ge_u32 s45, 32
    s_cselect_b32 s45, 5, s45
    s_waitcnt vmcnt(17)
    s_barrier
    s_lshr_b32 s48, s46, 1
    s_cmp_eq_u32 s48, s23
    s_cselect_b32 s48, 1, 31
    s_and_b32 s48, s48, s46
    s_mul_i32 s50, s48, 18432
    s_add_u32 s50, s50, s36
    s_add_u32 m0, s30, 0
    s_mov_b32 s53, s50
    buffer_load_dwordx4 v1, s[4:7], s50 offen offset:0 sc1 lds
    buffer_load_dwordx4 v1, s[4:7], s50 offen offset:1024 sc1 lds
    buffer_load_dwordx4 v1, s[4:7], s50 offen offset:2048 sc1 lds
    buffer_load_dwordx4 v1, s[4:7], s50 offen offset:3072 sc1 lds
    s_lshr_b32 s48, s46, 1
    s_cmp_eq_u32 s48, s23
    s_cselect_b32 s48, 1, 31
    s_and_b32 s48, s48, s46
    s_add_u32 m0, s30, 18432
    s_lshl_b32 s51, s48, 7
    buffer_load_dwordx4 v8, s[8:11], s51 offen offset:0  lds
    buffer_load_dwordx4 v9, s[8:11], s51 offen offset:1024  lds
    buffer_load_dwordx4 v10, s[8:11], s51 offen offset:2048  lds
    buffer_load_dwordx4 v11, s[8:11], s51 offen offset:3072  lds
    s_add_u32 s46, s46, 4
    s_and_b32 s46, s46, 31
    s_waitcnt vmcnt(16)
    s_barrier
    s_lshr_b32 s48, s47, 1
    s_cmp_eq_u32 s48, s23
    s_cselect_b32 s48, 1, 31
    s_and_b32 s48, s48, s47
    s_mul_i32 s50, s48, 18432
    s_add_u32 s50, s50, s36
    s_cmp_ge_u32 s20, 2
    s_cselect_b32 s52, s50, s53
    s_add_u32 m0, s31, 0
    s_add_u32 s52, s52, s49
    buffer_load_dwordx4 v1, s[4:7], s52 offen sc1 lds
    s_add_u32 m0, s30, 36864
    s_mov_b32 s53, s50
    buffer_load_dwordx4 v1, s[4:7], s50 offen offset:0 sc1 lds
    buffer_load_dwordx4 v1, s[4:7], s50 offen offset:1024 sc1 lds
    buffer_load_dwordx4 v1, s[4:7], s50 offen offset:2048 sc1 lds
    buffer_load_dwordx4 v1, s[4:7], s50 offen offset:3072 sc1 lds
    s_lshr_b32 s48, s47, 1
    s_cmp_eq_u32 s48, s23
    s_cselect_b32 s48, 1, 31
    s_and_b32 s48, s48, s47
    s_add_u32 m0, s30, 55296
    s_lshl_b32 s51, s48, 7
    buffer_load_dwordx4 v8, s[8:11], s51 offen offset:0  lds
    buffer_load_dwordx4 v9, s[8:11], s51 offen offset:1024  lds
    buffer_load_dwordx4 v10, s[8:11], s51 offen offset:2048  lds
    buffer_load_dwordx4 v11, s[8:11], s51 offen offset:3072  lds
    s_add_u32 s47, s47, 4
    s_and_b32 s47, s47, 31
    s_sub_u32 s41, s41, 1
    s_cmp_lg_u32 s41, 0
    s_cbranch_scc1 L_g_ll
    s_waitcnt vmcnt(17)
    s_barrier
    s_mov_b32 s32, 0
    s_mul_i32 s32, s32, 36864
    s_add_u32 s32, s32, s43
    s_add_u32 m0, s42, 73728
    s_add_u32 s33, s32, 0
    buffer_load_dwordx4 v1, s[4:7], s33 offen offset:0  sc1 lds
    buffer_load_dwordx4 v1, s[4:7], s33 offen offset:1024  sc1 lds
    buffer_load_dwordx4 v1, s[4:7], s33 offen offset:2048  sc1 lds
    buffer_load_dwordx4 v1, s[4:7], s33 offen offset:3072  sc1 lds
    s_add_u32 m0, s42, 77824
    s_add_u32 s33, s32, 4096
    buffer_load_dwordx4 v1, s[4:7], s33 offen offset:0  sc1 lds
    buffer_load_dwordx4 v1, s[4:7], s33 offen offset:1024  sc1 lds
    buffer_load_dwordx4 v1, s[4:7], s33 offen offset:2048  sc1 lds
    buffer_load_dwordx4 v1, s[4:7], s33 offen offset:3072  sc1 lds
    s_add_u32 m0, s42, 81920
    s_add_u32 s33, s32, 8192
    buffer_load_dwordx4 v1, s[4:7], s33 offen offset:0  sc1 lds
    s_waitcnt vmcnt(9)
    s_barrier
    s_cmp_lg_u32 s22, 0
    s_cbranch_scc1 L_p5_k48
    s_add_u32 s32, s43, 110592
    buffer_load_dwordx4 v[40:43], v1, s[4:7], s32 offen offset:0 sc1
    buffer_load_dwordx4 v[44:47], v1, s[4:7], s32 offen offset:1024 sc1
    buffer_load_dwordx4 v[48:51], v1, s[4:7], s32 offen offset:2048 sc1
    buffer_load_dwordx4 v[52:55], v1, s[4:7], s32 offen offset:3072 sc1
    s_add_u32 s32, s43, 114688
    buffer_load_dwordx4 v[56:59], v1, s[4:7], s32 offen offset:0 sc1
    buffer_load_dwordx4 v[60:63], v1, s[4:7], s32 offen offset:1024 sc1
    buffer_load_dwordx4 v[64:67], v1, s[4:7], s32 offen offset:2048 sc1
    buffer_load_dwordx4 v[68:71], v1, s[4:7], s32 offen offset:3072 sc1
    s_add_u32 s32, s43, 118784
    buffer_load_dwordx4 v[72:75], v1, s[4:7], s32 offen offset:0 sc1
L_p5_k48:
    s_mov_b32 s32, 1
    s_mul_i32 s32, s32, 36864
    s_add_u32 s32, s32, s43
    s_add_u32 m0, s42, 110592
    s_add_u32 s33, s32, 0
    buffer_load_dwordx4 v1, s[4:7], s33 offen offset:0  sc1 lds
    buffer_load_dwordx4 v1, s[4:7], s33 offen offset:1024  sc1 lds
    buffer_load_dwordx4 v1, s[4:7], s33 offen offset:2048  sc1 lds
    buffer_load_dwordx4 v1, s[4:7], s33 offen offset:3072  sc1 lds
    s_add_u32 m0, s42, 114688
    s_add_u32 s33, s32, 4096
    buffer_load_dwordx4 v1, s[4:7], s33 offen offset:0  sc1 lds
    buffer_load_dwordx4 v1, s[4:7], s33 offen offset:1024  sc1 lds
    buffer_load_dwordx4 v1, s[4:7], s33 offen offset:2048  sc1 lds
    buffer_load_dwordx4 v1, s[4:7], s33 offen offset:3072  sc1 lds
    s_add_u32 m0, s42, 118784
    s_add_u32 s33, s32, 8192
    buffer_load_dwordx4 v1, s[4:7], s33 offen offset:0  sc1 lds
    s_barrier
    v_add_u32 v12, s42, v1
    v_add_u32 v13, 36864, v12
    v_add_u32 v14, 73728, v12
    v_add_u32 v15, 110592, v12
    s_waitcnt vmcnt(9)
    ds_write_b128 v13, v[40:43] offset:0
    ds_write_b128 v13, v[44:47] offset:1024
    ds_write_b128 v13, v[48:51] offset:2048
    ds_write_b128 v13, v[52:55] offset:3072
    ds_write_b128 v13, v[56:59] offset:4096
    ds_write_b128 v13, v[60:63] offset:5120
    ds_write_b128 v13, v[64:67] offset:6144
    ds_write_b128 v13, v[68:71] offset:7168
    ds_write_b128 v13, v[72:75] offset:8192
    s_barrier
    s_mov_b32 s32, 2
    s_mul_i32 s32, s32, 36864
    s_add_u32 s32, s32, s43
    s_add_u32 m0, s42, 0
    s_add_u32 s33, s32, 0
    buffer_load_dwordx4 v1, s[4:7], s33 offen offset:0  sc1 lds
    buffer_load_dwordx4 v1, s[4:7], s33 offen offset:1024  sc1 lds
    buffer_load_dwordx4 v1, s[4:7], s33 offen offset:2048  sc1 lds
    buffer_load_dwordx4 v1, s[4:7], s33 offen offset:3072  sc1 lds
    s_add_u32 m0, s42, 4096
    s_add_u32 s33, s32, 4096
    buffer_load_dwordx4 v1, s[4:7], s33 offen offset:0  sc1 lds
    buffer_load_dwordx4 v1, s[4:7], s33 offen offset:1024  sc1 lds
    buffer_load_dwordx4 v1, s[4:7], s33 offen offset:2048  sc1 lds
    buffer_load_dwordx4 v1, s[4:7], s33 offen offset:3072  sc1 lds
    s_add_u32 m0, s42, 8192
    s_add_u32 s33, s32, 8192
    buffer_load_dwordx4 v1, s[4:7], s33 offen offset:0  sc1 lds
    s_waitcnt vmcnt(18) lgkmcnt(0)
    s_barrier
    s_waitcnt vmcnt(9) lgkmcnt(15)
    s_barrier
    ds_write_b128 v14, v[76:79] offset:0
    ds_write_b128 v14, v[80:83] offset:1024
    ds_write_b128 v14, v[84:87] offset:2048
    ds_write_b128 v14, v[88:91] offset:3072
    ds_write_b128 v14, v[92:95] offset:4096
    ds_write_b128 v14, v[96:99] offset:5120
    ds_write_b128 v14, v[100:103] offset:6144
    s_waitcnt vmcnt(0) lgkmcnt(15)
    s_barrier
    ds_write_b128 v14, v[104:107] offset:7168
    ds_write_b128 v14, v[108:111] offset:8192
    ds_write_b128 v15, v[112:115] offset:0
    ds_write_b128 v15, v[116:119] offset:1024
    ds_write_b128 v15, v[120:123] offset:2048
    ds_write_b128 v15, v[124:127] offset:3072
    ds_write_b128 v15, v[128:131] offset:4096
    s_waitcnt vmcnt(63) lgkmcnt(15)
    s_barrier
    ds_write_b128 v15, v[132:135] offset:5120
    ds_write_b128 v15, v[136:139] offset:6144
    ds_write_b128 v15, v[140:143] offset:7168
    ds_write_b128 v15, v[144:147] offset:8192
    ds_write_b128 v12, v[148:151] offset:0
    ds_write_b128 v12, v[152:155] offset:1024
    ds_write_b128 v12, v[156:159] offset:2048
    s_waitcnt vmcnt(63) lgkmcnt(12)
    s_barrier
    ds_write_b128 v12, v[160:163] offset:3072
    ds_write_b128 v12, v[164:167] offset:4096
    ds_write_b128 v12, v[168:171] offset:5120
    ds_write_b128 v12, v[172:175] offset:6144
    ds_write_b128 v12, v[176:179] offset:7168
    ds_write_b128 v12, v[180:183] offset:8192
    s_waitcnt vmcnt(63) lgkmcnt(9)
    s_barrier
    ds_write_b128 v13, v[184:187] offset:0
    ds_write_b128 v13, v[188:191] offset:1024
    ds_write_b128 v13, v[192:195] offset:2048
    ds_write_b128 v13, v[196:199] offset:3072
    ds_write_b128 v13, v[200:203] offset:4096
    ds_write_b128 v13, v[204:207] offset:5120
    s_waitcnt vmcnt(63) lgkmcnt(6)
    s_barrier
    s_and_b32 s25, s2, 7
    s_lshr_b32 s26, s2, 3
    s_lshr_b32 s23, s25, 1
    s_lshl_b32 s23, s23, 2
    s_lshr_b32 s27, s26, 3
    s_add_u32 s23, s23, s27
    s_and_b32 s24, s25, 1
    s_lshl_b32 s24, s24, 3
    s_and_b32 s27, s26, 7
    s_add_u32 s24, s24, s27
    s_mul_i32 s29, s24, 129024
    s_lshl_b32 s30, s20, 12
    s_add_u32 s29, s29, s30
    s_add_u32 s29, s29, 0x3800000
    s_lshl_b32 s31, s23, 3
    s_max_u32 s31, s31, 1
    s_sub_u32 s31, s31, 1
    s_mul_i32 s31, s31, 18432
    s_add_u32 s31, s31, 0x1c00000
    s_lshl_b32 s35, s20, 10
    s_and_b32 s36, s35, 1024
    ds_write_b128 v13, v[208:211] offset:6144
    ds_write_b128 v13, v[212:215] offset:7168
    ds_write_b128 v13, v[216:219] offset:8192
    ds_write_b128 v14, v[220:223] offset:0
    ds_write_b128 v14, v[224:227] offset:1024
    ds_write_b128 v14, v[228:231] offset:2048
    s_waitcnt vmcnt(63) lgkmcnt(3)
    s_barrier
    ds_write_b128 v14, v[232:235] offset:3072
    ds_write_b128 v14, v[236:239] offset:4096
    ds_write_b128 v14, v[240:243] offset:5120
    ds_write_b128 v14, v[244:247] offset:6144
    ds_write_b128 v14, v[248:251] offset:7168
    ds_write_b128 v14, v[252:255] offset:8192
    s_waitcnt vmcnt(63) lgkmcnt(0)
    s_barrier
    s_cmp_eq_u32 s22, 1
    s_cbranch_scc1 L_m_t8
    s_add_u32 m0, s30, 0
    s_add_u32 s34, s29, 0
    buffer_load_dwordx4 v1, s[4:7], s34 offen offset:0 sc1 lds
    buffer_load_dwordx4 v1, s[4:7], s34 offen offset:1024 sc1 lds
    buffer_load_dwordx4 v1, s[4:7], s34 offen offset:2048 sc1 lds
    buffer_load_dwordx4 v1, s[4:7], s34 offen offset:3072 sc1 lds
    s_add_u32 m0, s30, 16384
    s_add_u32 s34, s29, 16384
    buffer_load_dwordx4 v1, s[4:7], s34 offen offset:0 sc1 lds
    buffer_load_dwordx4 v1, s[4:7], s34 offen offset:1024 sc1 lds
    buffer_load_dwordx4 v1, s[4:7], s34 offen offset:2048 sc1 lds
    buffer_load_dwordx4 v1, s[4:7], s34 offen offset:3072 sc1 lds
L_m_t8:
    s_cmp_eq_u32 s22, 1
    s_cbranch_scc1 L_m_lfin
    s_barrier
    s_add_u32 m0, s30, 32768
    s_add_u32 s34, s29, 32768
    buffer_load_dwordx4 v1, s[4:7], s34 offen offset:0 sc1 lds
    buffer_load_dwordx4 v1, s[4:7], s34 offen offset:1024 sc1 lds
    buffer_load_dwordx4 v1, s[4:7], s34 offen offset:2048 sc1 lds
    buffer_load_dwordx4 v1, s[4:7], s34 offen offset:3072 sc1 lds
    s_add_u32 m0, s30, 114688
    s_add_u32 s34, s29, 114688
    buffer_load_dwordx4 v1, s[4:7], s34 offen offset:0 sc1 lds
    buffer_load_dwordx4 v1, s[4:7], s34 offen offset:1024 sc1 lds
    buffer_load_dwordx4 v1, s[4:7], s34 offen offset:2048 sc1 lds
    buffer_load_dwordx4 v1, s[4:7], s34 offen offset:3072 sc1 lds
    s_mov_b32 s22, 1
    s_mov_b32 s21, 0x1c00000
    s_barrier
    s_barrier
    s_add_u32 m0, s30, 49152
    s_add_u32 s34, s29, 49152
    buffer_load_dwordx4 v1, s[4:7], s34 offen offset:0 sc1 lds
    buffer_load_dwordx4 v1, s[4:7], s34 offen offset:1024 sc1 lds
    buffer_load_dwordx4 v1, s[4:7], s34 offen offset:2048 sc1 lds
    buffer_load_dwordx4 v1, s[4:7], s34 offen offset:3072 sc1 lds
    v_lshrrev_b32 v2, 8, v1
    v_bfe_u32 v3, v1, 7, 1
    v_bfe_u32 v4, v1, 4, 3
    v_cmp_gt_u32 vcc, 3, v2
    v_mul_u32_u24 v3, 80, v3
    v_lshl_add_u32 v3, v4, 3, v3
    v_lshrrev_b32 v5, 1, v4
    v_and_b32 v4, 1, v4
    v_lshl_add_u32 v4, v4, 3, 64
    v_cndmask_b32 v2, v5, v2, vcc
    v_cndmask_b32 v3, v4, v3, vcc
    v_mul_u32_u24 v2, 2304, v2
    v_add_u32 v0, v2, v3
    v_lshrrev_b32 v8, 1, v1
    s_mul_i32 s34, s24, 144
    s_add_u32 s34, s34, 0x4400000
    buffer_load_dwordx2 v[2:3], v0, s[4:7], s34 offen sc1
    s_mul_i32 s34, s24, 144
    s_add_u32 s34, s34, 0x4402000
    buffer_load_dwordx2 v[4:5], v0, s[4:7], s34 offen sc1
    s_mul_i32 s34, s24, 144
    s_add_u32 s34, s34, 0x4404000
    buffer_load_dwordx2 v[6:7], v0, s[4:7], s34 offen sc1
    s_mul_i32 s34, s24, 144
    s_add_u32 s34, s34, 0x4406000
    buffer_load_dwordx2 v[12:13], v0, s[4:7], s34 offen sc1
    s_add_u32 m0, s30, 65536
    s_add_u32 s34, s29, 65536
    buffer_load_dwordx4 v1, s[4:7], s34 offen offset:0 sc1 lds
    buffer_load_dwordx4 v1, s[4:7], s34 offen offset:1024 sc1 lds
    buffer_load_dwordx4 v1, s[4:7], s34 offen offset:2048 sc1 lds
    buffer_load_dwordx4 v1, s[4:7], s34 offen offset:3072 sc1 lds
    s_add_u32 m0, s30, 81920
    s_add_u32 s34, s29, 81920
    buffer_load_dwordx4 v1, s[4:7], s34 offen offset:0 sc1 lds
    buffer_load_dwordx4 v1, s[4:7], s34 offen offset:1024 sc1 lds
    buffer_load_dwordx4 v1, s[4:7], s34 offen offset:2048 sc1 lds
    buffer_load_dwordx4 v1, s[4:7], s34 offen offset:3072 sc1 lds
    s_barrier
    s_add_u32 m0, s35, 131072
    s_add_u32 s34, s31, s35
    s_add_u32 s34, s34, 0
    buffer_load_dwordx4 v1, s[4:7], s34 offen sc1 lds
    s_waitcnt vmcnt(29) lgkmcnt(0)
    s_barrier
    s_add_u32 m0, s35, 135168
    s_add_u32 s34, s31, s35
    s_add_u32 s34, s34, 4096
    buffer_load_dwordx4 v1, s[4:7], s34 offen sc1 lds
    s_waitcnt vmcnt(1) lgkmcnt(0)
    s_barrier
    s_add_u32 m0, s35, 139264
    s_add_u32 s34, s31, s35
    s_add_u32 s34, s34, 8192
    buffer_load_dwordx4 v1, s[4:7], s34 offen sc1 lds
    s_waitcnt vmcnt(2) lgkmcnt(0)
    s_barrier
    s_add_u32 m0, s35, 143360
    s_add_u32 s34, s31, s35
    s_add_u32 s34, s34, 12288
    buffer_load_dwordx4 v1, s[4:7], s34 offen sc1 lds
    s_add_u32 m0, s30, 98304
    s_add_u32 s34, s29, 98304
    buffer_load_dwordx4 v1, s[4:7], s34 offen offset:0 sc1 lds
    buffer_load_dwordx4 v1, s[4:7], s34 offen offset:1024 sc1 lds
    buffer_load_dwordx4 v1, s[4:7], s34 offen offset:2048 sc1 lds
    buffer_load_dwordx4 v1, s[4:7], s34 offen offset:3072 sc1 lds
    s_waitcnt vmcnt(6) lgkmcnt(0)
    s_barrier
    s_add_u32 m0, s36, 147456
    s_add_u32 s34, s31, s36
    s_add_u32 s34, s34, 16384
    buffer_load_dwordx4 v1, s[4:7], s34 offen sc1 lds
    v_add_f32 v2, v2, v4
    v_add_f32 v3, v3, v5
    v_add_f32 v6, v6, v12
    v_add_f32 v7, v7, v13
    v_add_f32 v2, v2, v6
    v_add_f32 v3, v3, v7
    v_cmp_gt_u32 vcc, 864, v1
    v_add_u32 v8, 161792, v8
    s_nop 0
    v_cndmask_b32 v2, 0, v2, vcc
    v_cndmask_b32 v3, 0, v3, vcc
    ds_write_b64 v8, v[2:3]
    s_waitcnt vmcnt(6) lgkmcnt(0)
    s_barrier
    s_waitcnt vmcnt(6) lgkmcnt(0)
    s_barrier
    s_waitcnt vmcnt(1) lgkmcnt(0)
    s_barrier
    s_waitcnt vmcnt(0) lgkmcnt(0)
    s_barrier
    s_barrier
    s_branch L_m_ll
L_m_lfin:
L_end_m:
    s_endpgm

.section .rodata,"a"
.p2align 6
.amdhsa_kernel interleave_layers__sliding_local_dilated__mixer_gmlp__prompt_kernel
  .amdhsa_next_free_vgpr 256
  .amdhsa_next_free_sgpr 102
  .amdhsa_accum_offset 256
  .amdhsa_group_segment_fixed_size 0
  .amdhsa_kernarg_size 88
  .amdhsa_user_sgpr_count 2
  .amdhsa_user_sgpr_kernarg_segment_ptr 1
  .amdhsa_system_sgpr_workgroup_id_x 1
  .amdhsa_float_denorm_mode_32 3
.end_amdhsa_kernel
```

```asm
; @launch grid=(256,1,1) block=(512,1,1) lds=163840
.amdgcn_target "amdgcn-amd-amdhsa--gfx950"
.text
.globl interleave_layers__sliding_local_dilated__mixer_gmlp__prompt_kernel
.p2align 8
.type interleave_layers__sliding_local_dilated__mixer_gmlp__prompt_kernel,@function
interleave_layers__sliding_local_dilated__mixer_gmlp__prompt_kernel:
    s_cmp_ge_u32 s2, 256
    s_cbranch_scc1 L_end_m
    s_load_dwordx16 s[36:51], s[0:1], 0
    s_load_dwordx4 s[56:59], s[0:1], 64
    s_load_dwordx2 s[24:25], s[0:1], 80
    s_getpc_b64 s[26:27]
L_m_pc:
    s_sub_u32 s26, s26, L_m_pc-interleave_layers__sliding_local_dilated__mixer_gmlp__prompt_kernel
    s_subb_u32 s27, s27, 0
    v_lshlrev_b32 v4, 4, v0
    v_mov_b32 v5, s27
    v_add_co_u32 v6, vcc, s26, v4
    s_lshr_b32 s28, s2, 3
    s_lshl_b32 s28, s28, 11
    v_addc_co_u32 v7, vcc, 0, v5, vcc
    global_load_dwordx4 v[60:63], v[6:7], off
    v_lshl_add_u32 v4, v0, 2, s28
    v_min_u32 v4, L_end_m-interleave_layers__sliding_local_dilated__mixer_gmlp__prompt_kernel-4, v4
    v_add_co_u32 v6, vcc, s26, v4
    s_nop 1
    v_addc_co_u32 v7, vcc, 0, v5, vcc
    global_load_dword v64, v[6:7], off
    v_lshrrev_b32 v2, 6, v0
    v_and_b32 v1, 63, v0
    v_lshlrev_b32 v1, 4, v1
    v_readfirstlane_b32 s23, v2
    s_mov_b32 s22, 0
    s_mov_b32 s21, 0
    s_and_b32 s20, s23, 3
    s_waitcnt lgkmcnt(0)
    s_mov_b32 s4, s24
    s_mov_b32 s5, s25
    s_mov_b32 s6, 0x10000000
    s_mov_b32 s7, 0x20000
    s_cmp_ge_u32 s23, 4
    s_cbranch_scc1 L_ld_m
    v_bfe_u32 v2, v1, 4, 4
    v_lshrrev_b32 v3, 8, v1
    v_bfrev_b32 v6, 1
    v_mov_b32 v11, 0x3f803f80
    s_lshl_b32 s30, s20, 12
    s_and_b32 s29, s20, 1
    s_cmp_lt_u32 s2, 128
    s_cbranch_scc1 L_p0_x
    s_cmp_lt_u32 s2, 236
    s_cbranch_scc1 L_p0_wq
    s_cmp_lt_u32 s2, 254
    s_cbranch_scc1 L_p0_wo
    s_mov_b32 s46, 0
    s_mov_b32 s27, 0x800000
    s_barrier
    s_branch L_p0_cd
L_p0_wo:
    s_mul_i32 s30, s20, 9216
    s_sub_u32 s26, s2, 236
    s_mul_i32 s28, s26, 57
    s_lshr_b32 s28, s28, 9
    s_mul_i32 s27, s28, 9
    s_sub_u32 s27, s26, s27
    s_mov_b32 s32, s40
    s_mov_b32 s33, s41
    s_mov_b32 s34, 0xa2000
    s_mov_b32 s35, 0x20000
    s_mul_i32 s29, s28, 331776
    s_lshl_b32 s31, s27, 7
    s_add_u32 s29, s29, s31
    s_mul_i32 s31, s20, 82944
    s_add_u32 s29, s29, s31
    s_mul_i32 s30, s20, 9216
    v_lshrrev_b32 v4, 7, v1
    v_mul_u32_u24 v4, 1152, v4
    v_and_b32 v5, 0x70, v1
    v_add_u32 v4, v4, v5
    s_add_u32 m0, s30, 0
    s_add_u32 s31, s29, 0
    buffer_load_dwordx4 v4, s[32:35], s31 offen  lds
    s_add_u32 m0, s30, 1024
    s_add_u32 s31, s29, 9216
    buffer_load_dwordx4 v4, s[32:35], s31 offen  lds
    s_add_u32 m0, s30, 2048
    s_add_u32 s31, s29, 18432
    buffer_load_dwordx4 v4, s[32:35], s31 offen  lds
    s_add_u32 m0, s30, 3072
    s_add_u32 s31, s29, 27648
    buffer_load_dwordx4 v4, s[32:35], s31 offen  lds
    s_add_u32 m0, s30, 4096
    s_add_u32 s31, s29, 36864
    buffer_load_dwordx4 v4, s[32:35], s31 offen  lds
    s_add_u32 m0, s30, 5120
    s_add_u32 s31, s29, 46080
    buffer_load_dwordx4 v4, s[32:35], s31 offen  lds
    s_add_u32 m0, s30, 6144
    s_add_u32 s31, s29, 55296
    buffer_load_dwordx4 v4, s[32:35], s31 offen  lds
    s_add_u32 m0, s30, 7168
    s_add_u32 s31, s29, 64512
    buffer_load_dwordx4 v4, s[32:35], s31 offen  lds
    s_add_u32 m0, s30, 8192
    s_add_u32 s31, s29, 73728
    buffer_load_dwordx4 v4, s[32:35], s31 offen  lds
    v_lshrrev_b32 v7, 2, v2
    v_and_b32 v8, 3, v2
    v_bfe_u32 v9, v1, 7, 0
    v_xor_b32 v9, s20, v9
    v_lshlrev_b32 v9, 5, v9
    v_lshl_add_u32 v9, v7, 7, v9
    v_lshl_add_u32 v9, v8, 3, v9
    v_add_u32 v9, 0, v9
    v_mul_u32_u24 v4, 512, v3
    v_add_u32 v4, v4, v9
    v_mul_u32_u24 v5, 9216, v3
    v_add_u32 v5, v5, v9
    s_lshl_b32 s31, s27, 2
    s_add_u32 s31, s31, s20
    v_lshl_add_u32 v7, s31, 2, v7
    v_lshlrev_b32 v8, 4, v8
    v_lshl_add_u32 v8, v3, 8, v8
    v_mul_u32_u24 v9, 57, v7
    v_lshrrev_b32 v9, 10, v9
    v_mul_u32_u24 v10, 18, v9
    v_sub_u32 v10, v7, v10
    v_lshrrev_b32 v12, 3, v10
    v_and_b32 v13, 1, v10
    v_lshl_add_u32 v12, v12, 1, v13
    v_bfe_u32 v14, v10, 1, 2
    v_cmp_gt_u32 vcc, 16, v10
    v_mul_u32_u24 v9, 82944, v9
    v_add_u32 v9, v9, v8
    v_cndmask_b32 v12, 8, v12, vcc
    v_cndmask_b32 v14, v13, v14, vcc
    v_mov_b32 v15, 0x1000
    v_mov_b32 v13, 0x80
    v_cndmask_b32 v15, v13, v15, vcc
    v_lshl_add_u32 v9, v12, 10, v9
    v_lshl_add_u32 v9, v14, 6, v9
    v_add_u32 v10, v9, v15
    s_and_b32 s31, s28, 1
    s_cmp_eq_u32 s31, 1
    s_cselect_b64 vcc, -1, 0
    v_cndmask_b32 v14, v9, v10, vcc
    s_mul_i32 s31, s28, 36864
    s_add_u32 s37, s31, 0x3a00000
    s_add_u32 s38, s31, 0x3a00000
    s_add_u32 s39, s31, 0x3a02400
    s_add_u32 s40, s31, 0x3a02400
    s_add_u32 s41, s31, 0x3a04800
    s_add_u32 s42, s31, 0x3a04800
    s_add_u32 s43, s31, 0x3a06c00
    s_add_u32 s47, s31, 0x3a06c00
    s_lshr_b32 s31, s28, 1
    s_mul_i32 s31, s31, 9216
    s_add_u32 s48, s31, 0x3a12000
    s_cmp_ge_u32 s26, 4
    s_cbranch_scc1 L_p0_n2
    s_lshl_b32 s31, s26, 2
    s_add_u32 s31, s31, s20
    s_lshl_b32 s31, s31, 12
    s_add_u32 s31, s31, 0x4508000
    v_and_b32 v56, 0x380, v1
    v_add_u32 v56, v56, v1
    v_mov_b32 v52, 0
    v_mov_b32 v53, 0
    v_mov_b32 v54, 0
    v_mov_b32 v55, 0
    buffer_store_dwordx4 v[52:55], v56, s[4:7], s31 offen offset:0 sc1
    buffer_store_dwordx4 v[52:55], v56, s[4:7], s31 offen offset:2048 sc1
L_p0_n2:
    s_waitcnt vmcnt(0)
    s_barrier
    ds_read_b64_tr_b16 v[16:17], v4 offset:0
    ds_read_b64_tr_b16 v[18:19], v4 offset:2560
    ds_read_b64_tr_b16 v[20:21], v4 offset:4608
    ds_read_b64_tr_b16 v[22:23], v4 offset:7168
    ds_read_b64_tr_b16 v[24:25], v4 offset:9216
    ds_read_b64_tr_b16 v[26:27], v4 offset:11776
    ds_read_b64_tr_b16 v[28:29], v4 offset:13824
    ds_read_b64_tr_b16 v[30:31], v4 offset:16384
    ds_read_b64_tr_b16 v[32:33], v4 offset:18432
    ds_read_b64_tr_b16 v[34:35], v4 offset:20992
    ds_read_b64_tr_b16 v[36:37], v4 offset:23040
    ds_read_b64_tr_b16 v[38:39], v4 offset:25600
    ds_read_b64_tr_b16 v[40:41], v4 offset:27648
    ds_read_b64_tr_b16 v[42:43], v4 offset:30208
    ds_read_b64_tr_b16 v[44:45], v4 offset:32256
    ds_read_b64_tr_b16 v[46:47], v4 offset:34816
    ds_read_b64_tr_b16 v[48:49], v5 offset:2048
    ds_read_b64_tr_b16 v[50:51], v5 offset:6656
    s_waitcnt lgkmcnt(15)
    s_mov_b32 s31, s37
    buffer_store_dwordx4 v[16:19], v9, s[4:7], s31 offen sc1
    s_waitcnt lgkmcnt(14)
    s_mov_b32 s31, s38
    buffer_store_dwordx4 v[20:23], v10, s[4:7], s31 offen sc1
    s_waitcnt lgkmcnt(12)
    s_mov_b32 s31, s39
    buffer_store_dwordx4 v[24:27], v9, s[4:7], s31 offen sc1
    s_waitcnt lgkmcnt(10)
    s_mov_b32 s31, s40
    buffer_store_dwordx4 v[28:31], v10, s[4:7], s31 offen sc1
    s_waitcnt lgkmcnt(8)
    s_mov_b32 s31, s41
    buffer_store_dwordx4 v[32:35], v9, s[4:7], s31 offen sc1
    s_waitcnt lgkmcnt(6)
    s_mov_b32 s31, s42
    buffer_store_dwordx4 v[36:39], v10, s[4:7], s31 offen sc1
    s_waitcnt lgkmcnt(4)
    s_mov_b32 s31, s43
    buffer_store_dwordx4 v[40:43], v9, s[4:7], s31 offen sc1
    s_waitcnt lgkmcnt(2)
    s_mov_b32 s31, s47
    buffer_store_dwordx4 v[44:47], v10, s[4:7], s31 offen sc1
    s_waitcnt lgkmcnt(0)
    s_mov_b32 s31, s48
    buffer_store_dwordx4 v[48:51], v14, s[4:7], s31 offen sc1
    s_mov_b32 s46, 1
    s_mov_b32 s27, 32
    s_branch L_p0_cd
L_p0_wq:
    s_mov_b32 s32, s38
    s_mov_b32 s33, s39
    s_mov_b32 s34, 0x1e6000
    s_mov_b32 s35, 0x20000
    s_sub_u32 s23, s2, 128
    s_mul_i32 s25, s23, 19
    s_lshr_b32 s25, s25, 9
    s_mul_i32 s24, s25, 27
    s_sub_u32 s24, s23, s24
    s_mul_i32 s26, s25, 497664
    s_lshl_b32 s31, s24, 7
    s_add_u32 s26, s26, s31
    v_lshrrev_b32 v4, 7, v1
    v_mul_u32_u24 v4, 3456, v4
    v_lshrrev_b32 v5, 4, v1
    v_and_b32 v5, 16, v5
    v_xor_b32 v5, v5, v1
    v_and_b32 v5, 0x70, v5
    v_add_u32 v4, v4, v5
    s_mul_i32 s31, s20, 110592
    s_add_u32 s27, s26, s31
    s_mul_i32 s30, s20, 4224
    s_add_u32 m0, s30, 0
    s_add_u32 s31, s27, 0
    buffer_load_dwordx4 v4, s[32:35], s31 offen  lds
    s_add_u32 m0, s30, 1056
    s_add_u32 s31, s27, 27648
    buffer_load_dwordx4 v4, s[32:35], s31 offen  lds
    s_add_u32 m0, s30, 2112
    s_add_u32 s31, s27, 55296
    buffer_load_dwordx4 v4, s[32:35], s31 offen  lds
    s_add_u32 m0, s30, 3168
    s_add_u32 s31, s27, 82944
    buffer_load_dwordx4 v4, s[32:35], s31 offen  lds
    s_cmp_ge_u32 s20, 2
    s_cbranch_scc1 L_p0_q5
    s_mul_i32 s31, s29, 1056
    s_add_u32 m0, s31, 16896
    s_mul_i32 s31, s29, 27648
    s_add_u32 s31, s31, s26
    s_add_u32 s31, s31, 442368
    buffer_load_dwordx4 v4, s[32:35], s31 offen  lds
L_p0_q5:
    v_lshrrev_b32 v7, 2, v2
    v_and_b32 v8, 3, v2
    s_lshl_b32 s31, s20, 5
    v_and_b32 v9, 2, v7
    v_xor_b32 v9, v9, v3
    v_lshlrev_b32 v9, 3, v9
    v_lshl_add_u32 v9, v7, 7, v9
    v_add_u32 v9, s31, v9
    v_mul_u32_u24 v4, 1056, v8
    v_add_u32 v4, v4, v9
    v_and_b32 v5, 1, v2
    v_mul_u32_u24 v5, 9504, v5
    v_add_u32 v5, v5, v9
    s_lshl_b32 s31, s24, 2
    s_add_u32 s31, s31, s20
    v_lshlrev_b32 v8, 4, v8
    v_lshl_add_u32 v8, v7, 8, v8
    v_lshl_add_u32 v7, s31, 2, v3
    v_mul_u32_u24 v9, 57, v7
    v_lshrrev_b32 v9, 13, v9
    v_mul_u32_u24 v10, 144, v9
    v_sub_u32 v10, v7, v10
    v_mul_u32_u24 v12, 57, v10
    v_lshrrev_b32 v12, 9, v12
    v_mul_u32_u24 v13, 9, v12
    v_sub_u32 v13, v10, v13
    v_cmp_lt_u32 s[36:37], 4, v13
    v_cmp_eq_u32 s[38:39], 4, v13
    v_cmp_eq_u32 s[40:41], 2, v9
    v_lshlrev_b32 v14, 1, v9
    v_add_u32 v15, 1, v14
    v_subrev_u32 v10, 5, v13
    v_cndmask_b32 v14, v14, v15, s[36:37]
    v_cndmask_b32 v13, v13, v10, s[36:37]
    v_cndmask_b32 v14, v14, 6, s[38:39]
    v_cndmask_b32 v13, v13, v9, s[38:39]
    s_and_b64 s[40:41], s[40:41], s[38:39]
    s_mov_b32 s31, 129024
    v_mul_lo_u32 v9, v12, s31
    v_add_u32 v9, v9, v8
    v_lshl_add_u32 v9, v14, 10, v9
    v_lshl_add_u32 v9, v13, 6, v9
    s_and_b32 s31, s25, 1
    v_lshrrev_b32 v8, 3, v2
    v_cmp_eq_u32 vcc, s31, v8
    v_add_u32 v15, 64, v9
    v_cndmask_b32 v15, v6, v15, s[40:41]
    v_cndmask_b32 v8, v6, v9, vcc
    v_lshlrev_b32 v10, 2, v2
    v_lshl_add_u32 v10, v7, 4, v10
    v_cmp_gt_u32 vcc, 4, v2
    s_lshl_b32 s45, s25, 13
    s_add_u32 s45, s45, 0x4400000
    v_cndmask_b32 v10, v6, v10, vcc
    s_mul_i32 s42, s25, 28672
    s_add_u32 s42, s42, 0x3800000
    s_lshr_b32 s44, s25, 1
    s_mul_i32 s44, s44, 7168
    s_add_u32 s44, s44, 0x381c000
    s_mul_i32 s26, s24, 29
    s_lshr_b32 s26, s26, 8
    s_mul_i32 s27, s26, 9
    s_sub_u32 s27, s24, s27
    s_lshl_b32 s27, s27, 4
    s_add_u32 s28, s27, 16
    v_lshrrev_b32 v254, 4, v1
    v_mul_u32_u24 v7, 9, v254
    v_add_u32 v255, 9, v7
    v_min_u32 v255, s28, v255
    v_max_u32 v7, s27, v7
    v_sub_u32 v255, v255, v7
    v_cmp_lt_i32 vcc, 0, v255
    v_lshlrev_b32 v254, 8, v254
    v_mov_b32 v14, 0x3f003f00
    v_cndmask_b32 v254, v6, v254, vcc
    s_cmp_eq_u64 s[40:41], 0
    s_cbranch_scc1 L_p0_np
    v_mov_b32 v52, 0
    v_mov_b32 v53, 0
    v_mov_b32 v54, 0
    v_mov_b32 v55, 0
    s_add_u32 s31, s42, 0
    buffer_store_dwordx4 v[52:55], v15, s[4:7], s31 offen sc1
    s_add_u32 s31, s42, 7168
    buffer_store_dwordx4 v[52:55], v15, s[4:7], s31 offen sc1
    s_add_u32 s31, s42, 14336
    buffer_store_dwordx4 v[52:55], v15, s[4:7], s31 offen sc1
    s_add_u32 s31, s42, 21504
    buffer_store_dwordx4 v[52:55], v15, s[4:7], s31 offen sc1
    s_mov_b32 s31, s44
    buffer_store_dwordx4 v[52:55], v15, s[4:7], s31 offen sc1
    s_waitcnt vmcnt(5)
    s_branch L_p0_n3
L_p0_np:
    s_waitcnt vmcnt(0)
L_p0_n3:
    s_barrier
    ds_read_b64_tr_b16 v[16:17], v4 offset:0
    ds_read_b64_tr_b16 v[18:19], v4 offset:512
    ds_read_b64_tr_b16 v[20:21], v4 offset:4224
    ds_read_b64_tr_b16 v[22:23], v4 offset:4736
    ds_read_b64_tr_b16 v[24:25], v4 offset:9504
    ds_read_b64_tr_b16 v[26:27], v4 offset:10016
    ds_read_b64_tr_b16 v[28:29], v4 offset:13728
    ds_read_b64_tr_b16 v[30:31], v4 offset:14240
    ds_read_b64_tr_b16 v[32:33], v5 offset:8448
    ds_read_b64_tr_b16 v[34:35], v5 offset:8960
    s_waitcnt lgkmcnt(8)
    s_add_u32 s31, s42, 0
    buffer_store_dwordx4 v[16:19], v9, s[4:7], s31 offen sc1
    s_waitcnt lgkmcnt(6)
    s_add_u32 s31, s42, 7168
    buffer_store_dwordx4 v[20:23], v9, s[4:7], s31 offen sc1
    s_waitcnt lgkmcnt(4)
    s_add_u32 s31, s42, 14336
    buffer_store_dwordx4 v[24:27], v9, s[4:7], s31 offen sc1
    s_waitcnt lgkmcnt(2)
    s_add_u32 s31, s42, 21504
    buffer_store_dwordx4 v[28:31], v9, s[4:7], s31 offen sc1
    s_waitcnt lgkmcnt(0)
    s_mov_b32 s31, s44
    buffer_store_dwordx4 v[32:35], v8, s[4:7], s31 offen sc1
    v_dot2_f32_bf16 v12, v16, v11, 0
    v_dot2_f32_bf16 v13, v17, v11, 0
    v_dot2_f32_bf16 v12, v18, v11, v12
    v_dot2_f32_bf16 v13, v19, v11, v13
    v_dot2_f32_bf16 v12, v20, v11, v12
    v_dot2_f32_bf16 v13, v21, v11, v13
    v_dot2_f32_bf16 v12, v22, v11, v12
    v_dot2_f32_bf16 v13, v23, v11, v13
    v_dot2_f32_bf16 v12, v24, v11, v12
    v_dot2_f32_bf16 v13, v25, v11, v13
    v_dot2_f32_bf16 v12, v26, v11, v12
    v_dot2_f32_bf16 v13, v27, v11, v13
    v_dot2_f32_bf16 v12, v28, v11, v12
    v_dot2_f32_bf16 v13, v29, v11, v13
    v_dot2_f32_bf16 v12, v30, v11, v12
    v_dot2_f32_bf16 v13, v31, v11, v13
    v_dot2_f32_bf16 v12, v32, v14, v12
    v_dot2_f32_bf16 v13, v33, v14, v13
    v_dot2_f32_bf16 v12, v34, v14, v12
    v_dot2_f32_bf16 v13, v35, v14, v13
    s_nop 2
    v_add_f32 v12, v12, v13
    s_nop 1
    v_add_f32_dpp v12, v12, v12 row_ror:4 row_mask:0xf bank_mask:0xf
    s_nop 1
    v_add_f32_dpp v12, v12, v12 row_ror:8 row_mask:0xf bank_mask:0xf
    buffer_store_dword v12, v10, s[4:7], s45 offen sc1
    s_branch L_p0_ce
L_p0_x:
    s_mov_b32 s32, s36
    s_mov_b32 s33, s37
    s_mov_b32 s34, 0x240000
    s_mov_b32 s35, 0x20000
    s_mul_i32 s26, s2, 18432
    s_mul_i32 s31, s20, 288
    s_add_u32 s28, s26, s31
    v_lshrrev_b32 v4, 6, v1
    v_mul_u32_u24 v4, 1152, v4
    v_and_b32 v5, 48, v1
    v_add_u32 v4, v4, v5
    s_add_u32 m0, s30, 0
    s_add_u32 s31, s28, 0
    buffer_load_dwordx4 v4, s[32:35], s31 offen  lds
    s_add_u32 m0, s30, 1024
    s_add_u32 s31, s28, 64
    buffer_load_dwordx4 v4, s[32:35], s31 offen  lds
    s_add_u32 m0, s30, 2048
    s_add_u32 s31, s28, 144
    buffer_load_dwordx4 v4, s[32:35], s31 offen  lds
    s_add_u32 m0, s30, 3072
    s_add_u32 s31, s28, 208
    buffer_load_dwordx4 v4, s[32:35], s31 offen  lds
    s_mul_i32 s31, s29, 576
    s_add_u32 s31, s31, s26
    v_mul_u32_u24 v7, 1152, v2
    v_mul_u32_u24 v5, 144, v3
    v_add_u32 v5, v5, v7
    buffer_load_dwordx4 v[32:35], v5, s[32:35], s31 offen offset:128
    s_lshl_b32 s27, s29, 10
    s_add_u32 s27, s27, 16384
    s_barrier
    v_lshlrev_b32 v4, 6, v2
    v_lshl_add_u32 v4, v3, 4, v4
    v_add_u32 v4, s30, v4
    s_add_u32 s26, s26, 0x0
    s_add_u32 s42, s26, s30
    s_add_u32 s44, s26, s27
    s_lshl_b32 s45, s2, 10
    s_lshl_b32 s31, s20, 8
    s_add_u32 s45, s45, s31
    s_add_u32 s45, s45, 0x1b00000
    v_cmp_gt_u32 vcc, 2, v3
    v_lshrrev_b32 v10, 1, v1
    s_mov_b32 s46, 2
    v_cndmask_b32 v10, v6, v10, vcc
    s_lshr_b32 s27, s2, 3
    s_add_u32 s27, s27, 48
    s_waitcnt vmcnt(0)
    ds_read_b128 v[16:19], v4 offset:0
    ds_read_b128 v[20:23], v4 offset:1024
    ds_read_b128 v[24:27], v4 offset:2048
    ds_read_b128 v[28:31], v4 offset:3072
    s_waitcnt lgkmcnt(3)
    buffer_store_dwordx4 v[16:19], v1, s[4:7], s42 offen offset:0 sc1
    s_waitcnt lgkmcnt(2)
    buffer_store_dwordx4 v[20:23], v1, s[4:7], s42 offen offset:1024 sc1
    s_waitcnt lgkmcnt(1)
    buffer_store_dwordx4 v[24:27], v1, s[4:7], s42 offen offset:2048 sc1
    s_waitcnt lgkmcnt(0)
    buffer_store_dwordx4 v[28:31], v1, s[4:7], s42 offen offset:3072 sc1
    v_dot2_f32_bf16 v12, v16, v11, 0
    v_dot2_f32_bf16 v13, v16, v16, 0
    v_dot2_f32_bf16 v12, v17, v11, v12
    v_dot2_f32_bf16 v13, v17, v17, v13
    v_dot2_f32_bf16 v12, v18, v11, v12
    v_dot2_f32_bf16 v13, v18, v18, v13
    v_dot2_f32_bf16 v12, v19, v11, v12
    v_dot2_f32_bf16 v13, v19, v19, v13
    v_dot2_f32_bf16 v12, v20, v11, v12
    v_dot2_f32_bf16 v13, v20, v20, v13
    v_dot2_f32_bf16 v12, v21, v11, v12
    v_dot2_f32_bf16 v13, v21, v21, v13
    v_dot2_f32_bf16 v12, v22, v11, v12
    v_dot2_f32_bf16 v13, v22, v22, v13
    v_dot2_f32_bf16 v12, v23, v11, v12
    v_dot2_f32_bf16 v13, v23, v23, v13
    v_dot2_f32_bf16 v12, v24, v11, v12
    v_dot2_f32_bf16 v13, v24, v24, v13
    v_dot2_f32_bf16 v12, v25, v11, v12
    v_dot2_f32_bf16 v13, v25, v25, v13
    v_dot2_f32_bf16 v12, v26, v11, v12
    v_dot2_f32_bf16 v13, v26, v26, v13
    v_dot2_f32_bf16 v12, v27, v11, v12
    v_dot2_f32_bf16 v13, v27, v27, v13
    v_dot2_f32_bf16 v12, v28, v11, v12
    v_dot2_f32_bf16 v13, v28, v28, v13
    v_dot2_f32_bf16 v12, v29, v11, v12
    v_dot2_f32_bf16 v13, v29, v29, v13
    v_dot2_f32_bf16 v12, v30, v11, v12
    v_dot2_f32_bf16 v13, v30, v30, v13
    v_dot2_f32_bf16 v12, v31, v11, v12
    v_dot2_f32_bf16 v13, v31, v31, v13
    s_waitcnt lgkmcnt(0)
    s_cmp_ge_u32 s20, 2
    s_cbranch_scc1 L_p0_xs
    buffer_store_dwordx4 v[32:35], v1, s[4:7], s44 offen sc1
    v_dot2_f32_bf16 v12, v32, v11, v12
    v_dot2_f32_bf16 v13, v32, v32, v13
    v_dot2_f32_bf16 v12, v33, v11, v12
    v_dot2_f32_bf16 v13, v33, v33, v13
    v_dot2_f32_bf16 v12, v34, v11, v12
    v_dot2_f32_bf16 v13, v34, v34, v13
    v_dot2_f32_bf16 v12, v35, v11, v12
    v_dot2_f32_bf16 v13, v35, v35, v13
L_p0_xs:
    s_nop 2
    v_mov_b32 v14, v12
    v_mov_b32 v15, v13
    s_nop 1
    v_permlane32_swap_b32 v12, v14
    v_permlane32_swap_b32 v13, v15
    v_add_f32 v12, v12, v14
    v_add_f32 v13, v13, v15
    buffer_store_dwordx2 v[12:13], v10, s[4:7], s45 offen sc1
L_p0_cd:
    v_cmp_eq_u32 vcc, 0, v1
    s_lshl_b32 s27, s27, 8
    v_mov_b32 v255, s46
    v_mov_b32 v254, s27
    v_cndmask_b32 v254, v6, v254, vcc
L_p0_ce:
    s_mov_b32 s48, s58
    s_mov_b32 s49, s59
    s_mov_b32 s50, 0x100
    s_mov_b32 s51, 0x20000
    v_mov_b32 v4, 0
    buffer_load_dword v246, v4, s[48:51], 0 offen sc1
    s_mov_b32 s16, s56
    s_mov_b32 s17, s57
    s_mov_b32 s18, 0x240000
    s_mov_b32 s19, 0x20000
    s_branch L_m_cl
L_d1_first:
    v_cmp_gt_u32 vcc, 4, v246
    v_mov_b32 v4, 0
    s_mov_b32 s46, 0x4500000
    s_cbranch_vccz L_pd_dbg
    s_mov_b32 s60, 65536
L_poll_dbg:
    buffer_load_dword v5, v4, s[48:51], 0 offen sc1
    s_waitcnt vmcnt(0)
    v_cmp_gt_u32 vcc, 4, v5
    s_sub_u32 s60, s60, 1
    s_cbranch_scc1 L_pd_dbg
    s_cbranch_vccz L_pd_dbg
    s_sleep 4
    s_branch L_poll_dbg
L_pd_dbg:
    buffer_atomic_add v255, v254, s[4:7], s46 offen sc1
    s_branch L_ns_d1
L_ld_m:
    s_cmp_lg_u32 s2, 254
    s_cbranch_scc1 L_p0_nz
    s_lshl_b32 s31, s20, 12
    s_add_u32 s31, s31, 0x4500000
    v_and_b32 v56, 0x380, v1
    v_add_u32 v56, v56, v1
    v_mov_b32 v52, 0
    v_mov_b32 v53, 0
    v_mov_b32 v54, 0
    v_mov_b32 v55, 0
    buffer_store_dwordx4 v[52:55], v56, s[4:7], s31 offen offset:0 sc1
    buffer_store_dwordx4 v[52:55], v56, s[4:7], s31 offen offset:2048 sc1
    s_waitcnt vmcnt(0)
    s_mov_b32 s53, 1
    s_atomic_add s53, s[58:59], 0
L_p0_nz:
    s_mov_b32 s8, s46
    s_mov_b32 s9, s47
    s_mov_b32 s10, 0x800000
    s_mov_b32 s11, 0x20000
    s_mov_b32 s12, s48
    s_mov_b32 s13, s49
    s_mov_b32 s14, 0x1000
    s_mov_b32 s15, 0x20000
    v_mov_b32 v2, 163808
    v_mov_b32 v4, 0
    v_mov_b32 v5, 0
    ds_write2_b64 v2, v[4:5], v[4:5] offset0:0 offset1:1
    s_waitcnt lgkmcnt(0)
    v_bfe_u32 v2, v1, 4, 4
    v_lshrrev_b32 v3, 8, v1
    v_bfrev_b32 v6, 1
    v_mov_b32 v11, 0x3f803f80
    s_mul_i32 s30, s20, 9216
    s_cmp_lt_u32 s2, 144
    s_cbranch_scc1 L_p0_wi
    s_cmp_lt_u32 s2, 216
    s_cbranch_scc1 L_p0_wu
    v_mov_b32 v9, v6
    v_mov_b32 v10, v6
    v_mov_b32 v14, v6
    v_mov_b32 v15, v6
    s_mov_b32 s37, 0
    s_mov_b32 s38, 0
    s_mov_b32 s39, 0
    s_mov_b32 s40, 0
    s_mov_b32 s41, 0
    s_mov_b32 s42, 0
    s_mov_b32 s43, 0
    s_mov_b32 s47, 0
    s_mov_b32 s48, 0
    s_mov_b32 s49, 0
    s_barrier
    s_barrier
    s_barrier
    s_branch L_p0_ld
L_p0_wu:
    s_sub_u32 s26, s2, 144
    s_mul_i32 s28, s26, 57
    s_lshr_b32 s28, s28, 9
    s_mul_i32 s27, s28, 9
    s_sub_u32 s27, s26, s27
    s_mov_b32 s32, s50
    s_mov_b32 s33, s51
    s_mov_b32 s34, 0x288000
    s_mov_b32 s35, 0x20000
    s_mul_i32 s29, s28, 331776
    s_lshl_b32 s31, s27, 7
    s_add_u32 s29, s29, s31
    s_mul_i32 s31, s20, 82944
    s_add_u32 s29, s29, s31
    s_mul_i32 s30, s20, 9216
    v_lshrrev_b32 v4, 7, v1
    v_mul_u32_u24 v4, 1152, v4
    v_and_b32 v5, 0x70, v1
    v_bfe_u32 v7, v1, 8, 2
    v_lshlrev_b32 v7, 5, v7
    v_xor_b32 v5, v5, v7
    v_add_u32 v4, v4, v5
    s_barrier
    s_barrier
    s_barrier
    s_add_u32 m0, s30, 91904
    s_add_u32 s31, s29, 0
    buffer_load_dwordx4 v4, s[32:35], s31 offen  lds
    s_add_u32 m0, s30, 92928
    s_add_u32 s31, s29, 9216
    buffer_load_dwordx4 v4, s[32:35], s31 offen  lds
    s_add_u32 m0, s30, 93952
    s_add_u32 s31, s29, 18432
    buffer_load_dwordx4 v4, s[32:35], s31 offen  lds
    s_add_u32 m0, s30, 94976
    s_add_u32 s31, s29, 27648
    buffer_load_dwordx4 v4, s[32:35], s31 offen  lds
    s_add_u32 m0, s30, 96000
    s_add_u32 s31, s29, 36864
    buffer_load_dwordx4 v4, s[32:35], s31 offen  lds
    s_add_u32 m0, s30, 97024
    s_add_u32 s31, s29, 46080
    buffer_load_dwordx4 v4, s[32:35], s31 offen  lds
    s_add_u32 m0, s30, 98048
    s_add_u32 s31, s29, 55296
    buffer_load_dwordx4 v4, s[32:35], s31 offen  lds
    s_add_u32 m0, s30, 99072
    s_add_u32 s31, s29, 64512
    buffer_load_dwordx4 v4, s[32:35], s31 offen  lds
    s_add_u32 m0, s30, 100096
    s_add_u32 s31, s29, 73728
    buffer_load_dwordx4 v4, s[32:35], s31 offen  lds
    v_lshrrev_b32 v7, 2, v2
    v_and_b32 v8, 3, v2
    v_bfe_u32 v9, v1, 7, 2
    v_xor_b32 v9, s20, v9
    v_lshlrev_b32 v9, 5, v9
    v_lshl_add_u32 v9, v7, 7, v9
    v_lshl_add_u32 v9, v8, 3, v9
    v_add_u32 v9, 91904, v9
    v_mul_u32_u24 v4, 512, v3
    v_add_u32 v4, v4, v9
    v_mul_u32_u24 v5, 512, v3
    v_add_u32 v5, v5, v9
    s_lshl_b32 s31, s27, 2
    s_add_u32 s31, s31, s20
    v_lshl_add_u32 v7, s31, 2, v7
    v_lshlrev_b32 v8, 4, v8
    v_lshl_add_u32 v8, v3, 8, v8
    v_mul_u32_u24 v9, 57, v7
    v_lshrrev_b32 v9, 10, v9
    v_mul_u32_u24 v10, 18, v9
    v_sub_u32 v10, v7, v10
    v_lshrrev_b32 v12, 3, v10
    v_and_b32 v13, 1, v10
    v_lshl_add_u32 v12, v12, 1, v13
    v_bfe_u32 v14, v10, 1, 2
    v_cmp_gt_u32 vcc, 16, v10
    v_mul_u32_u24 v9, 331776, v9
    v_add_u32 v9, v9, v8
    v_cndmask_b32 v12, 8, v12, vcc
    v_cndmask_b32 v14, v13, v14, vcc
    v_mov_b32 v15, 0x1000
    v_mov_b32 v13, 0x80
    v_cndmask_b32 v15, v13, v15, vcc
    v_lshl_add_u32 v9, v12, 10, v9
    v_lshl_add_u32 v9, v14, 6, v9
    v_add_u32 v10, v9, v15
    s_and_b32 s31, s28, 1
    s_cmp_eq_u32 s31, 1
    s_cselect_b64 vcc, -1, 0
    v_cndmask_b32 v14, v9, v10, vcc
    s_mul_i32 s31, s28, 9216
    s_add_u32 s37, s31, 0x4100000
    s_add_u32 s38, s31, 0x4100000
    s_add_u32 s39, s31, 0x4112000
    s_add_u32 s40, s31, 0x4112000
    s_add_u32 s41, s31, 0x4124000
    s_add_u32 s42, s31, 0x4124000
    s_add_u32 s43, s31, 0x4136000
    s_add_u32 s47, s31, 0x4136000
    s_lshr_b32 s31, s28, 1
    s_mul_i32 s31, s31, 9216
    s_add_u32 s48, s31, 0x4148000
    v_mov_b32 v15, v6
    s_mov_b32 s49, 0
    s_branch L_p0_ld
L_p0_wi:
    s_mov_b32 s26, s2
    s_mul_i32 s28, s26, 57
    s_lshr_b32 s28, s28, 12
    s_mul_i32 s27, s28, 72
    s_sub_u32 s27, s26, s27
    s_mov_b32 s32, s44
    s_mov_b32 s33, s45
    s_mov_b32 s34, 0x510000
    s_mov_b32 s35, 0x20000
    s_mul_i32 s29, s28, 2654208
    s_lshl_b32 s31, s27, 7
    s_add_u32 s29, s29, s31
    s_mul_i32 s31, s20, 663552
    s_add_u32 s29, s29, s31
    s_mul_i32 s30, s20, 9792
    v_lshrrev_b32 v4, 7, v1
    v_mul_u32_u24 v4, 9216, v4
    v_and_b32 v5, 0x70, v1
    v_bfe_u32 v7, v1, 8, 1
    v_lshlrev_b32 v7, 5, v7
    v_xor_b32 v5, v5, v7
    v_add_u32 v4, v4, v5
    s_barrier
    s_barrier
    s_barrier
    s_add_u32 m0, s30, 91904
    s_add_u32 s31, s29, 0
    buffer_load_dwordx4 v4, s[32:35], s31 offen  lds
    s_add_u32 m0, s30, 92992
    s_add_u32 s31, s29, 73728
    buffer_load_dwordx4 v4, s[32:35], s31 offen  lds
    s_add_u32 m0, s30, 94080
    s_add_u32 s31, s29, 147456
    buffer_load_dwordx4 v4, s[32:35], s31 offen  lds
    s_add_u32 m0, s30, 95168
    s_add_u32 s31, s29, 221184
    buffer_load_dwordx4 v4, s[32:35], s31 offen  lds
    s_add_u32 m0, s30, 96256
    s_add_u32 s31, s29, 294912
    buffer_load_dwordx4 v4, s[32:35], s31 offen  lds
    s_add_u32 m0, s30, 97344
    s_add_u32 s31, s29, 368640
    buffer_load_dwordx4 v4, s[32:35], s31 offen  lds
    s_add_u32 m0, s30, 98432
    s_add_u32 s31, s29, 442368
    buffer_load_dwordx4 v4, s[32:35], s31 offen  lds
    s_add_u32 m0, s30, 99520
    s_add_u32 s31, s29, 516096
    buffer_load_dwordx4 v4, s[32:35], s31 offen  lds
    s_add_u32 m0, s30, 100608
    s_add_u32 s31, s29, 589824
    buffer_load_dwordx4 v4, s[32:35], s31 offen  lds
    v_lshrrev_b32 v7, 2, v2
    v_and_b32 v8, 3, v2
    v_bfe_u32 v9, v1, 7, 1
    v_xor_b32 v9, s20, v9
    v_lshlrev_b32 v9, 5, v9
    v_lshl_add_u32 v9, v7, 7, v9
    v_lshl_add_u32 v9, v8, 3, v9
    v_add_u32 v9, 91904, v9
    v_mul_u32_u24 v4, 1088, v3
    v_add_u32 v4, v4, v9
    v_mul_u32_u24 v5, 9792, v3
    v_add_u32 v5, v5, v9
    s_lshl_b32 s31, s27, 2
    s_add_u32 s31, s31, s20
    v_lshl_add_u32 v7, s31, 2, v7
    v_lshlrev_b32 v8, 4, v8
    v_lshl_add_u32 v8, v3, 8, v8
    s_cmp_lt_u32 s31, 144
    s_cselect_b32 s23, 1, 0
    s_cselect_b32 s24, 0, 144
    s_sub_u32 s26, s31, s24
    s_mul_i32 s25, s26, 57
    s_lshr_b32 s25, s25, 9
    s_mul_i32 s24, s25, 9
    s_sub_u32 s24, s26, s24
    s_lshl_b32 s26, s25, 1
    s_add_u32 s26, s26, s23
    s_mul_i32 s26, s26, 165888
    s_lshl_b32 s31, s24, 10
    s_add_u32 s26, s26, s31
    s_add_u32 s26, s26, 0x3b00000
    s_mul_i32 s31, s28, 9216
    s_add_u32 s48, s26, s31
    s_add_u32 s48, s48, 147456
    s_lshl_b32 s31, s31, 3
    s_add_u32 s26, s26, s31
    s_add_u32 s37, s26, 0
    s_add_u32 s38, s26, 9216
    s_add_u32 s39, s26, 18432
    s_add_u32 s40, s26, 27648
    s_add_u32 s41, s26, 36864
    s_add_u32 s42, s26, 46080
    s_add_u32 s43, s26, 55296
    s_add_u32 s47, s26, 64512
    s_lshl_b32 s49, s25, 12
    s_mul_i32 s31, s28, 1152
    s_add_u32 s49, s49, s31
    s_mul_i32 s31, s23, 576
    s_add_u32 s49, s49, s31
    s_lshl_b32 s31, s24, 6
    s_add_u32 s49, s49, s31
    s_add_u32 s49, s49, 0x4410000
    v_cmp_eq_u32 vcc, 0, v3
    v_lshlrev_b32 v15, 2, v2
    v_mov_b32 v9, v1
    v_mov_b32 v10, v1
    v_mov_b32 v14, v1
    v_cndmask_b32 v15, v6, v15, vcc
L_p0_ld:
    s_waitcnt lgkmcnt(0)
    s_branch L_m_l1
L_m_cl:
    s_and_b32 s25, s2, 7
    s_lshr_b32 s26, s2, 3
    s_lshr_b32 s23, s25, 1
    s_lshl_b32 s23, s23, 2
    s_lshr_b32 s27, s26, 3
    s_add_u32 s23, s23, s27
    s_and_b32 s24, s25, 1
    s_lshl_b32 s24, s24, 3
    s_and_b32 s27, s26, 7
    s_add_u32 s24, s24, s27
    s_lshl_b32 s30, s23, 3
    s_lshl_b32 s31, s20, 1
    s_add_u32 s31, s30, s31
    s_mul_i32 s29, s31, 18432
    s_add_u32 s29, s29, s21
    s_add_u32 s35, s29, 0x600000
    s_add_u32 s29, s29, 0x0
    s_max_u32 s30, s30, 1
    s_sub_u32 s30, s30, 1
    s_lshl_b32 s30, s30, 10
    s_add_u32 s30, s30, s21
    s_add_u32 s30, s30, 0x1b00000
    s_lshl_b32 s32, s31, 10
    s_add_u32 s32, s32, s21
    s_add_u32 s32, s32, 0x1b00000
    v_bfe_u32 v2, v1, 4, 4
    v_lshrrev_b32 v3, 8, v1
    s_lshl_b32 s33, s20, 2
    s_lshr_b32 s33, 0x3362, s33
    s_and_b32 s33, s33, 15
    s_min_u32 s34, s20, 1
    s_add_u32 s34, s34, 4
    s_lshl_b32 s36, s33, 10
    s_lshl_b32 s37, s34, 10
    v_add_u32 v247, 64512, v1
    v_add_u32 v248, 131072, v1
    v_add_u32 v249, s36, v1
    v_add_u32 v250, s36, v247
    v_add_u32 v251, s37, v1
    v_add_u32 v252, s37, v247
    v_add_u32 v253, 18432, v1
    v_lshrrev_b32 v0, 1, v1
    s_add_u32 s38, s29, 0
    s_add_u32 s39, s29, 4096
    s_add_u32 s40, s29, 8192
    s_add_u32 s41, s29, 12288
    s_add_u32 s42, s29, 16384
    s_max_u32 s44, s23, 1
    s_sub_u32 s44, s44, 1
    s_lshl_b32 s52, s22, 7
    s_add_u32 s52, s52, s23
    s_lshl_b32 s52, s52, 8
    s_add_u32 s52, s52, 0x4503000
    s_add_u32 s52, s52, s4
    s_addc_u32 s53, s5, 0
    s_lshl_b32 s54, s22, 7
    s_add_u32 s54, s54, s44
    s_lshl_b32 s54, s54, 8
    s_add_u32 s54, s54, 0x4503000
    s_add_u32 s54, s54, s4
    s_addc_u32 s55, s5, 0
    s_lshl_b32 s44, s24, 8
    s_add_u32 s44, s44, 0x4500000
    s_add_u32 s44, s44, s4
    s_addc_u32 s45, s5, 0
    s_waitcnt vmcnt(0)
    s_barrier
    s_cmp_lg_u32 s20, 0
    s_cbranch_scc1 L_ns_d1
    s_cmp_eq_u32 s22, 0
    s_cbranch_scc1 L_d1_first
    s_mov_b32 s56, 1
    s_atomic_add s56, s[50:51], 0
L_ns_d1:
    s_barrier
    s_cmp_lg_u32 s20, 0
    s_cbranch_scc1 L_pd_d1
    s_mov_b32 s60, 65536
L_poll_d1:
    s_mov_b32 s57, 0
    s_atomic_add s57, s[52:53], 0 glc
    s_mov_b32 s58, 0
    s_atomic_add s58, s[54:55], 0 glc
    s_mov_b32 s59, 0
    s_atomic_add s59, s[44:45], 0 glc
    s_waitcnt lgkmcnt(0)
    s_cmp_ge_u32 s59, 108
    s_cselect_b32 s59, 16, 0
    s_min_u32 s57, s57, s58
    s_min_u32 s57, s57, s59
    s_cmp_ge_u32 s57, 16
    s_cbranch_scc1 L_pd_d1
    s_sub_u32 s60, s60, 1
    s_cbranch_scc1 L_pd_d1
    s_sleep 2
    s_branch L_poll_d1
L_pd_d1:
    s_barrier
    buffer_load_dwordx4 v[160:163], v1, s[4:7], s38 offen offset:0 sc1
    buffer_load_dwordx4 v[164:167], v253, s[4:7], s38 offen offset:0 sc1
    buffer_load_dwordx4 v[168:171], v1, s[4:7], s38 offen offset:1024 sc1
    buffer_load_dwordx4 v[172:175], v253, s[4:7], s38 offen offset:1024 sc1
    buffer_load_dwordx4 v[176:179], v1, s[4:7], s38 offen offset:2048 sc1
    buffer_load_dwordx4 v[180:183], v253, s[4:7], s38 offen offset:2048 sc1
    buffer_load_dwordx4 v[184:187], v1, s[4:7], s38 offen offset:3072 sc1
    buffer_load_dwordx4 v[188:191], v253, s[4:7], s38 offen offset:3072 sc1
    s_barrier
    ds_read_b128 v[80:83], v1 offset:0
    ds_read_b128 v[84:87], v1 offset:1024
    ds_read_b128 v[88:91], v1 offset:2048
    ds_read_b128 v[92:95], v1 offset:3072
    ds_read_b128 v[96:99], v1 offset:4096
    ds_read_b128 v[100:103], v1 offset:5120
    ds_read_b128 v[104:107], v1 offset:6144
    s_lshl_b32 s50, s22, 7
    s_add_u32 s50, s50, s23
    s_lshl_b32 s50, s50, 8
    s_add_u32 s50, s50, 0x4508000
    s_add_u32 s50, s50, s4
    s_addc_u32 s51, s5, 0
    s_waitcnt vmcnt(6) lgkmcnt(3)
    v_mfma_f32_16x16x32_bf16 v[16:19], v[80:83], v[160:163], 0
    ds_read_b128 v[120:123], v1 offset:7168
    v_mfma_f32_16x16x32_bf16 v[44:47], v[80:83], v[164:167], 0
    ds_read_b128 v[124:127], v1 offset:8192
    v_mfma_f32_16x16x32_bf16 v[20:23], v[84:87], v[160:163], 0
    ds_read_b128 v[128:131], v1 offset:9216
    v_mfma_f32_16x16x32_bf16 v[48:51], v[84:87], v[164:167], 0
    ds_read_b128 v[132:135], v1 offset:10240
    v_mfma_f32_16x16x32_bf16 v[24:27], v[88:91], v[160:163], 0
    ds_read_b128 v[136:139], v1 offset:11264
    buffer_load_dwordx2 v[4:5], v0, s[4:7], s30 offen offset:0 sc1
    v_mfma_f32_16x16x32_bf16 v[52:55], v[88:91], v[164:167], 0
    ds_read_b128 v[140:143], v1 offset:12288
    buffer_load_dwordx2 v[6:7], v0, s[4:7], s30 offen offset:512 sc1
    v_mfma_f32_16x16x32_bf16 v[28:31], v[92:95], v[160:163], 0
    ds_read_b128 v[144:147], v1 offset:13312
    buffer_load_dwordx2 v[8:9], v0, s[4:7], s32 offen offset:0 sc1
    v_mfma_f32_16x16x32_bf16 v[56:59], v[92:95], v[164:167], 0
    s_waitcnt lgkmcnt(7)
    buffer_load_dwordx2 v[10:11], v0, s[4:7], s32 offen offset:512 sc1
    v_mfma_f32_16x16x32_bf16 v[32:35], v[160:163], v[96:99], 0
    buffer_load_dwordx2 v[12:13], v0, s[4:7], s32 offen offset:1024 sc1
    v_mfma_f32_16x16x32_bf16 v[60:63], v[164:167], v[96:99], 0
    buffer_load_dwordx2 v[14:15], v0, s[4:7], s32 offen offset:1536 sc1
    v_mfma_f32_16x16x32_bf16 v[36:39], v[160:163], v[100:103], 0
    buffer_load_dwordx4 v[192:195], v1, s[4:7], s39 offen offset:0 sc1
    v_mfma_f32_16x16x32_bf16 v[64:67], v[164:167], v[100:103], 0
    buffer_load_dwordx4 v[196:199], v253, s[4:7], s39 offen offset:0 sc1
    v_mfma_f32_16x16x32_bf16 v[40:43], v[104:107], v[160:163], 0
    buffer_load_dwordx4 v[200:203], v1, s[4:7], s39 offen offset:1024 sc1
    v_mfma_f32_16x16x32_bf16 v[68:71], v[104:107], v[164:167], 0
    buffer_load_dwordx4 v[204:207], v253, s[4:7], s39 offen offset:1024 sc1
    s_waitcnt vmcnt(14) lgkmcnt(3)
    s_barrier
    v_mfma_f32_16x16x32_bf16 v[16:19], v[120:123], v[168:171], v[16:19]
    ds_read_b128 v[80:83], v1 offset:14336
    v_mfma_f32_16x16x32_bf16 v[44:47], v[120:123], v[172:175], v[44:47]
    ds_read_b128 v[84:87], v1 offset:15360
    v_mfma_f32_16x16x32_bf16 v[20:23], v[124:127], v[168:171], v[20:23]
    ds_read_b128 v[88:91], v1 offset:16384
    v_mfma_f32_16x16x32_bf16 v[48:51], v[124:127], v[172:175], v[48:51]
    ds_read_b128 v[92:95], v1 offset:17408
    v_mfma_f32_16x16x32_bf16 v[24:27], v[128:131], v[168:171], v[24:27]
    ds_read_b128 v[96:99], v1 offset:18432
    v_mfma_f32_16x16x32_bf16 v[52:55], v[128:131], v[172:175], v[52:55]
    ds_read_b128 v[100:103], v1 offset:19456
    v_mfma_f32_16x16x32_bf16 v[28:31], v[132:135], v[168:171], v[28:31]
    ds_read_b128 v[104:107], v1 offset:20480
    v_mfma_f32_16x16x32_bf16 v[56:59], v[132:135], v[172:175], v[56:59]
    ds_read_b128 v[108:111], v248 offset:0
    s_waitcnt lgkmcnt(8)
    v_mfma_f32_16x16x32_bf16 v[32:35], v[168:171], v[136:139], v[32:35]
    ds_read_b128 v[112:115], v249 offset:0
    v_mfma_f32_16x16x32_bf16 v[60:63], v[172:175], v[136:139], v[60:63]
    ds_read_b128 v[116:119], v251 offset:0
    v_mfma_f32_16x16x32_bf16 v[36:39], v[168:171], v[140:143], v[36:39]
    buffer_load_dwordx4 v[160:163], v1, s[4:7], s39 offen offset:2048 sc1
    v_mfma_f32_16x16x32_bf16 v[64:67], v[172:175], v[140:143], v[64:67]
    buffer_load_dwordx4 v[164:167], v253, s[4:7], s39 offen offset:2048 sc1
    v_mfma_f32_16x16x32_bf16 v[40:43], v[144:147], v[168:171], v[40:43]
    v_mfma_f32_16x16x32_bf16 v[68:71], v[144:147], v[172:175], v[68:71]
    s_waitcnt vmcnt(14) lgkmcnt(6)
    v_mfma_f32_16x16x32_bf16 v[16:19], v[80:83], v[176:179], v[16:19]
    ds_read_b128 v[120:123], v1 offset:21504
    v_mfma_f32_16x16x32_bf16 v[44:47], v[80:83], v[180:183], v[44:47]
    ds_read_b128 v[124:127], v1 offset:22528
    v_mfma_f32_16x16x32_bf16 v[20:23], v[84:87], v[176:179], v[20:23]
    ds_read_b128 v[128:131], v1 offset:23552
    v_mfma_f32_16x16x32_bf16 v[48:51], v[84:87], v[180:183], v[48:51]
    ds_read_b128 v[132:135], v1 offset:24576
    v_mfma_f32_16x16x32_bf16 v[24:27], v[88:91], v[176:179], v[24:27]
    ds_read_b128 v[136:139], v1 offset:25600
    v_mfma_f32_16x16x32_bf16 v[52:55], v[88:91], v[180:183], v[52:55]
    ds_read_b128 v[140:143], v1 offset:26624
    v_mfma_f32_16x16x32_bf16 v[28:31], v[92:95], v[176:179], v[28:31]
    ds_read_b128 v[144:147], v1 offset:27648
    v_mfma_f32_16x16x32_bf16 v[56:59], v[92:95], v[180:183], v[56:59]
    ds_read_b128 v[148:151], v248 offset:1024
    s_waitcnt lgkmcnt(8)
    v_mfma_f32_16x16x32_bf16 v[32:35], v[176:179], v[96:99], v[32:35]
    ds_read_b128 v[152:155], v249 offset:7168
    v_mfma_f32_16x16x32_bf16 v[60:63], v[180:183], v[96:99], v[60:63]
    ds_read_b128 v[156:159], v251 offset:7168
    v_mfma_f32_16x16x32_bf16 v[36:39], v[176:179], v[100:103], v[36:39]
    buffer_load_dwordx4 v[168:171], v1, s[4:7], s39 offen offset:3072 sc1
    v_mfma_f32_16x16x32_bf16 v[64:67], v[180:183], v[100:103], v[64:67]
    buffer_load_dwordx4 v[172:175], v253, s[4:7], s39 offen offset:3072 sc1
    v_mfma_f32_16x16x32_bf16 v[40:43], v[104:107], v[176:179], v[40:43]
    v_mfma_f32_16x16x32_bf16 v[68:71], v[104:107], v[180:183], v[68:71]
    v_mfma_f32_16x16x32_bf16 v[72:75], v[112:115], v[108:111], 0
    v_mfma_f32_16x16x32_bf16 v[76:79], v[108:111], v[116:119], 0
    s_waitcnt vmcnt(8) lgkmcnt(6)
    s_barrier
    v_mfma_f32_16x16x32_bf16 v[16:19], v[120:123], v[184:187], v[16:19]
    ds_read_b128 v[80:83], v1 offset:28672
    v_mfma_f32_16x16x32_bf16 v[44:47], v[120:123], v[188:191], v[44:47]
    ds_read_b128 v[84:87], v1 offset:29696
    v_add_f32 v240, v4, v6
    v_mfma_f32_16x16x32_bf16 v[20:23], v[124:127], v[184:187], v[20:23]
    ds_read_b128 v[88:91], v1 offset:30720
    v_add_f32 v241, v5, v7
    v_mfma_f32_16x16x32_bf16 v[48:51], v[124:127], v[188:191], v[48:51]
    ds_read_b128 v[92:95], v1 offset:31744
    v_add_f32 v242, v8, v10
    v_mfma_f32_16x16x32_bf16 v[24:27], v[128:131], v[184:187], v[24:27]
    ds_read_b128 v[96:99], v1 offset:32768
    v_add_f32 v243, v9, v11
    v_mfma_f32_16x16x32_bf16 v[52:55], v[128:131], v[188:191], v[52:55]
    ds_read_b128 v[100:103], v1 offset:33792
    v_add_f32 v244, v12, v14
    v_mfma_f32_16x16x32_bf16 v[28:31], v[132:135], v[184:187], v[28:31]
    ds_read_b128 v[104:107], v1 offset:34816
    v_add_f32 v245, v13, v15
    v_mfma_f32_16x16x32_bf16 v[56:59], v[132:135], v[188:191], v[56:59]
    ds_read_b128 v[108:111], v248 offset:2048
    s_waitcnt lgkmcnt(8)
    v_mfma_f32_16x16x32_bf16 v[32:35], v[184:187], v[136:139], v[32:35]
    ds_read_b128 v[112:115], v249 offset:14336
    v_mov_b32 v4, v240
    v_mfma_f32_16x16x32_bf16 v[60:63], v[188:191], v[136:139], v[60:63]
    ds_read_b128 v[116:119], v251 offset:14336
    v_mov_b32 v5, v241
    v_mfma_f32_16x16x32_bf16 v[36:39], v[184:187], v[140:143], v[36:39]
    buffer_load_dwordx4 v[176:179], v1, s[4:7], s40 offen offset:0 sc1
    v_mov_b32 v8, v242
    v_mfma_f32_16x16x32_bf16 v[64:67], v[188:191], v[140:143], v[64:67]
    buffer_load_dwordx4 v[180:183], v253, s[4:7], s40 offen offset:0 sc1
    v_mov_b32 v9, v243
    v_mfma_f32_16x16x32_bf16 v[40:43], v[144:147], v[184:187], v[40:43]
    v_mov_b32 v12, v244
    v_mov_b32 v13, v245
    v_mfma_f32_16x16x32_bf16 v[68:71], v[144:147], v[188:191], v[68:71]
    v_permlane32_swap_b32 v240, v4
    v_permlane32_swap_b32 v241, v5
    v_mfma_f32_16x16x32_bf16 v[72:75], v[152:155], v[148:151], v[72:75]
    v_permlane32_swap_b32 v242, v8
    v_mfma_f32_16x16x32_bf16 v[76:79], v[148:151], v[156:159], v[76:79]
    v_permlane32_swap_b32 v243, v9
    s_waitcnt vmcnt(8) lgkmcnt(6)
    v_mfma_f32_16x16x32_bf16 v[16:19], v[80:83], v[192:195], v[16:19]
    ds_read_b128 v[120:123], v1 offset:35840
    v_mfma_f32_16x16x32_bf16 v[44:47], v[80:83], v[196:199], v[44:47]
    ds_read_b128 v[124:127], v1 offset:36864
    v_permlane32_swap_b32 v244, v12
    v_mfma_f32_16x16x32_bf16 v[20:23], v[84:87], v[192:195], v[20:23]
    ds_read_b128 v[128:131], v1 offset:37888
    v_permlane32_swap_b32 v245, v13
    v_mfma_f32_16x16x32_bf16 v[48:51], v[84:87], v[196:199], v[48:51]
    ds_read_b128 v[132:135], v1 offset:38912
    v_add_f32 v240, v240, v4
    v_mfma_f32_16x16x32_bf16 v[24:27], v[88:91], v[192:195], v[24:27]
    ds_read_b128 v[136:139], v1 offset:39936
    v_add_f32 v241, v241, v5
    v_mfma_f32_16x16x32_bf16 v[52:55], v[88:91], v[196:199], v[52:55]
    ds_read_b128 v[140:143], v1 offset:40960
    v_add_f32 v242, v242, v8
    v_mfma_f32_16x16x32_bf16 v[28:31], v[92:95], v[192:195], v[28:31]
    ds_read_b128 v[144:147], v1 offset:41984
    v_add_f32 v243, v243, v9
    v_mfma_f32_16x16x32_bf16 v[56:59], v[92:95], v[196:199], v[56:59]
    ds_read_b128 v[148:151], v248 offset:3072
    s_waitcnt lgkmcnt(8)
    v_mfma_f32_16x16x32_bf16 v[32:35], v[192:195], v[96:99], v[32:35]
    ds_read_b128 v[152:155], v249 offset:21504
    v_add_f32 v244, v244, v12
    v_mfma_f32_16x16x32_bf16 v[60:63], v[196:199], v[96:99], v[60:63]
    ds_read_b128 v[156:159], v251 offset:21504
    v_add_f32 v245, v245, v13
    v_mfma_f32_16x16x32_bf16 v[36:39], v[192:195], v[100:103], v[36:39]
    buffer_load_dwordx4 v[184:187], v1, s[4:7], s40 offen offset:1024 sc1
    v_mov_b32 v4, v240
    v_mfma_f32_16x16x32_bf16 v[64:67], v[196:199], v[100:103], v[64:67]
    buffer_load_dwordx4 v[188:191], v253, s[4:7], s40 offen offset:1024 sc1
    v_mov_b32 v5, v241
    v_mfma_f32_16x16x32_bf16 v[40:43], v[104:107], v[192:195], v[40:43]
    v_mov_b32 v8, v242
    v_mov_b32 v9, v243
    v_mfma_f32_16x16x32_bf16 v[68:71], v[104:107], v[196:199], v[68:71]
    v_mov_b32 v12, v244
    v_mov_b32 v13, v245
    v_mfma_f32_16x16x32_bf16 v[72:75], v[112:115], v[108:111], v[72:75]
    v_permlane16_swap_b32 v240, v4
    v_mfma_f32_16x16x32_bf16 v[76:79], v[108:111], v[116:119], v[76:79]
    v_permlane16_swap_b32 v241, v5
    s_waitcnt vmcnt(8) lgkmcnt(6)
    s_barrier
    v_mfma_f32_16x16x32_bf16 v[16:19], v[120:123], v[200:203], v[16:19]
    ds_read_b128 v[80:83], v1 offset:43008
    v_mfma_f32_16x16x32_bf16 v[44:47], v[120:123], v[204:207], v[44:47]
    ds_read_b128 v[84:87], v1 offset:44032
    v_permlane16_swap_b32 v242, v8
    v_mfma_f32_16x16x32_bf16 v[20:23], v[124:127], v[200:203], v[20:23]
    ds_read_b128 v[88:91], v1 offset:45056
    v_permlane16_swap_b32 v243, v9
    v_mfma_f32_16x16x32_bf16 v[48:51], v[124:127], v[204:207], v[48:51]
    ds_read_b128 v[92:95], v1 offset:46080
    v_permlane16_swap_b32 v244, v12
    v_mfma_f32_16x16x32_bf16 v[24:27], v[128:131], v[200:203], v[24:27]
    ds_read_b128 v[96:99], v1 offset:47104
    v_permlane16_swap_b32 v245, v13
    v_mfma_f32_16x16x32_bf16 v[52:55], v[128:131], v[204:207], v[52:55]
    ds_read_b128 v[100:103], v1 offset:48128
    v_add_f32 v240, v240, v4
    v_mfma_f32_16x16x32_bf16 v[28:31], v[132:135], v[200:203], v[28:31]
    ds_read_b128 v[104:107], v1 offset:49152
    v_add_f32 v241, v241, v5
    v_mfma_f32_16x16x32_bf16 v[56:59], v[132:135], v[204:207], v[56:59]
    ds_read_b128 v[108:111], v248 offset:4096
    s_waitcnt lgkmcnt(8)
    v_mfma_f32_16x16x32_bf16 v[32:35], v[200:203], v[136:139], v[32:35]
    ds_read_b128 v[112:115], v249 offset:28672
    v_add_f32 v242, v242, v8
    v_mfma_f32_16x16x32_bf16 v[60:63], v[204:207], v[136:139], v[60:63]
    ds_read_b128 v[116:119], v251 offset:28672
    v_add_f32 v243, v243, v9
    v_mfma_f32_16x16x32_bf16 v[36:39], v[200:203], v[140:143], v[36:39]
    buffer_load_dwordx4 v[192:195], v1, s[4:7], s40 offen offset:2048 sc1
    v_add_f32 v244, v244, v12
    v_mfma_f32_16x16x32_bf16 v[64:67], v[204:207], v[140:143], v[64:67]
    buffer_load_dwordx4 v[196:199], v253, s[4:7], s40 offen offset:2048 sc1
    v_add_f32 v245, v245, v13
    v_mfma_f32_16x16x32_bf16 v[40:43], v[144:147], v[200:203], v[40:43]
    v_mul_f32 v240, 0x3ae38e39, v240
    v_mul_f32 v241, 0x3ae38e39, v241
    v_mfma_f32_16x16x32_bf16 v[68:71], v[144:147], v[204:207], v[68:71]
    v_mul_f32 v242, 0x3ae38e39, v242
    v_mul_f32 v243, 0x3ae38e39, v243
    v_mfma_f32_16x16x32_bf16 v[72:75], v[152:155], v[148:151], v[72:75]
    v_mul_f32 v244, 0x3ae38e39, v244
    v_mfma_f32_16x16x32_bf16 v[76:79], v[148:151], v[156:159], v[76:79]
    v_mul_f32 v245, 0x3ae38e39, v245
    s_waitcnt vmcnt(8) lgkmcnt(6)
    v_mfma_f32_16x16x32_bf16 v[16:19], v[80:83], v[160:163], v[16:19]
    ds_read_b128 v[120:123], v1 offset:50176
    v_mfma_f32_16x16x32_bf16 v[44:47], v[80:83], v[164:167], v[44:47]
    ds_read_b128 v[124:127], v1 offset:51200
    v_fma_f32 v241, -v240, v240, v241
    v_mfma_f32_16x16x32_bf16 v[20:23], v[84:87], v[160:163], v[20:23]
    ds_read_b128 v[128:131], v1 offset:52224
    v_fma_f32 v243, -v242, v242, v243
    v_mfma_f32_16x16x32_bf16 v[48:51], v[84:87], v[164:167], v[48:51]
    ds_read_b128 v[132:135], v1 offset:53248
    v_fma_f32 v245, -v244, v244, v245
    v_mfma_f32_16x16x32_bf16 v[24:27], v[88:91], v[160:163], v[24:27]
    ds_read_b128 v[136:139], v1 offset:54272
    v_max_f32 v241, 0, v241
    v_mfma_f32_16x16x32_bf16 v[52:55], v[88:91], v[164:167], v[52:55]
    ds_read_b128 v[140:143], v1 offset:55296
    v_max_f32 v243, 0, v243
    v_mfma_f32_16x16x32_bf16 v[28:31], v[92:95], v[160:163], v[28:31]
    ds_read_b128 v[144:147], v1 offset:56320
    v_max_f32 v245, 0, v245
    v_mfma_f32_16x16x32_bf16 v[56:59], v[92:95], v[164:167], v[56:59]
    ds_read_b128 v[148:151], v248 offset:5120
    s_waitcnt lgkmcnt(8)
    v_mfma_f32_16x16x32_bf16 v[32:35], v[160:163], v[96:99], v[32:35]
    ds_read_b128 v[152:155], v249 offset:35840
    v_add_f32 v241, 0x3727c5ac, v241
    v_mfma_f32_16x16x32_bf16 v[60:63], v[164:167], v[96:99], v[60:63]
    ds_read_b128 v[156:159], v251 offset:35840
    v_add_f32 v243, 0x3727c5ac, v243
    v_mfma_f32_16x16x32_bf16 v[36:39], v[160:163], v[100:103], v[36:39]
    buffer_load_dwordx4 v[200:203], v1, s[4:7], s40 offen offset:3072 sc1
    v_add_f32 v245, 0x3727c5ac, v245
    v_mfma_f32_16x16x32_bf16 v[64:67], v[164:167], v[100:103], v[64:67]
    buffer_load_dwordx4 v[204:207], v253, s[4:7], s40 offen offset:3072 sc1
    v_rsq_f32 v241, v241
    v_mfma_f32_16x16x32_bf16 v[40:43], v[104:107], v[160:163], v[40:43]
    v_rsq_f32 v243, v243
    v_rsq_f32 v245, v245
    v_mfma_f32_16x16x32_bf16 v[68:71], v[104:107], v[164:167], v[68:71]
    s_nop 0
    v_lshlrev_b32 v255, 4, v3
    v_mfma_f32_16x16x32_bf16 v[72:75], v[112:115], v[108:111], v[72:75]
    v_add_u32 v236, 161792, v255
    v_mfma_f32_16x16x32_bf16 v[76:79], v[108:111], v[116:119], v[76:79]
    s_lshl_b32 s36, s33, 6
    s_waitcnt vmcnt(8) lgkmcnt(6)
    v_mfma_f32_16x16x32_bf16 v[16:19], v[120:123], v[168:171], v[16:19]
    ds_read_b128 v[80:83], v1 offset:57344
    v_mfma_f32_16x16x32_bf16 v[44:47], v[120:123], v[172:175], v[44:47]
    ds_read_b128 v[84:87], v1 offset:58368
    v_add_u32 v237, s36, v236
    v_mfma_f32_16x16x32_bf16 v[20:23], v[124:127], v[168:171], v[20:23]
    ds_read_b128 v[88:91], v1 offset:59392
    v_lshlrev_b32 v254, 2, v2
    v_mfma_f32_16x16x32_bf16 v[48:51], v[124:127], v[172:175], v[48:51]
    ds_read_b128 v[92:95], v1 offset:60416
    v_add_u32 v238, 161792, v254
    v_mfma_f32_16x16x32_bf16 v[24:27], v[128:131], v[168:171], v[24:27]
    ds_read_b128 v[96:99], v1 offset:61440
    s_lshl_b32 s37, s34, 6
    v_mfma_f32_16x16x32_bf16 v[52:55], v[128:131], v[172:175], v[52:55]
    ds_read_b128 v[100:103], v1 offset:62464
    v_add_u32 v239, s37, v238
    v_mfma_f32_16x16x32_bf16 v[28:31], v[132:135], v[168:171], v[28:31]
    ds_read_b128 v[104:107], v1 offset:63488
    s_mul_i32 s36, s20, 3072
    v_mfma_f32_16x16x32_bf16 v[56:59], v[132:135], v[172:175], v[56:59]
    ds_read_b128 v[108:111], v248 offset:6144
    s_waitcnt lgkmcnt(8)
    v_mfma_f32_16x16x32_bf16 v[32:35], v[168:171], v[136:139], v[32:35]
    ds_read_b128 v[112:115], v249 offset:43008
    s_add_u32 s36, s36, 153600
    v_mfma_f32_16x16x32_bf16 v[60:63], v[172:175], v[136:139], v[60:63]
    ds_read_b128 v[116:119], v251 offset:43008
    v_add_u32 v254, s36, v254
    v_mfma_f32_16x16x32_bf16 v[36:39], v[168:171], v[140:143], v[36:39]
    buffer_load_dwordx4 v[160:163], v1, s[4:7], s41 offen offset:0 sc1
    v_add_u32 v255, s36, v255
    v_mfma_f32_16x16x32_bf16 v[64:67], v[172:175], v[140:143], v[64:67]
    buffer_load_dwordx4 v[164:167], v253, s[4:7], s41 offen offset:0 sc1
    v_mfma_f32_16x16x32_bf16 v[40:43], v[144:147], v[168:171], v[40:43]
    v_mfma_f32_16x16x32_bf16 v[68:71], v[144:147], v[172:175], v[68:71]
    ds_write2_b32 v254, v240, v241 offset0:0 offset1:16
    v_mfma_f32_16x16x32_bf16 v[72:75], v[152:155], v[148:151], v[72:75]
    ds_write2_b32 v254, v242, v243 offset0:32 offset1:48
    v_mfma_f32_16x16x32_bf16 v[76:79], v[148:151], v[156:159], v[76:79]
    ds_write2_b32 v254, v244, v245 offset0:64 offset1:80
    s_waitcnt vmcnt(8) lgkmcnt(9)
    s_barrier
    v_mfma_f32_16x16x32_bf16 v[16:19], v[80:83], v[176:179], v[16:19]
    ds_read_b128 v[120:123], v247 offset:0
    v_mfma_f32_16x16x32_bf16 v[44:47], v[80:83], v[180:183], v[44:47]
    ds_read_b128 v[124:127], v247 offset:1024
    v_mfma_f32_16x16x32_bf16 v[20:23], v[84:87], v[176:179], v[20:23]
    ds_read_b128 v[128:131], v247 offset:2048
    v_mfma_f32_16x16x32_bf16 v[48:51], v[84:87], v[180:183], v[48:51]
    ds_read_b128 v[132:135], v247 offset:3072
    v_mfma_f32_16x16x32_bf16 v[24:27], v[88:91], v[176:179], v[24:27]
    ds_read_b128 v[136:139], v247 offset:4096
    v_mfma_f32_16x16x32_bf16 v[52:55], v[88:91], v[180:183], v[52:55]
    ds_read_b128 v[140:143], v247 offset:5120
    v_mfma_f32_16x16x32_bf16 v[28:31], v[92:95], v[176:179], v[28:31]
    ds_read_b128 v[144:147], v247 offset:6144
    v_mfma_f32_16x16x32_bf16 v[56:59], v[92:95], v[180:183], v[56:59]
    ds_read_b128 v[148:151], v248 offset:7168
    s_waitcnt lgkmcnt(8)
    v_mfma_f32_16x16x32_bf16 v[32:35], v[176:179], v[96:99], v[32:35]
    ds_read_b128 v[152:155], v249 offset:50176
    v_mfma_f32_16x16x32_bf16 v[60:63], v[180:183], v[96:99], v[60:63]
    ds_read_b128 v[156:159], v251 offset:50176
    v_mfma_f32_16x16x32_bf16 v[36:39], v[176:179], v[100:103], v[36:39]
    buffer_load_dwordx4 v[168:171], v1, s[4:7], s41 offen offset:1024 sc1
    ds_read_b128 v[208:211], v236 offset:0
    v_mfma_f32_16x16x32_bf16 v[64:67], v[180:183], v[100:103], v[64:67]
    buffer_load_dwordx4 v[172:175], v253, s[4:7], s41 offen offset:1024 sc1
    ds_read_b128 v[212:215], v236 offset:64
    v_mfma_f32_16x16x32_bf16 v[40:43], v[104:107], v[176:179], v[40:43]
    ds_read_b128 v[216:219], v236 offset:128
    v_mfma_f32_16x16x32_bf16 v[68:71], v[104:107], v[180:183], v[68:71]
    ds_read_b128 v[220:223], v236 offset:192
    v_mfma_f32_16x16x32_bf16 v[72:75], v[112:115], v[108:111], v[72:75]
    ds_read_b128 v[224:227], v236 offset:384
    v_mfma_f32_16x16x32_bf16 v[76:79], v[108:111], v[116:119], v[76:79]
    ds_read_b128 v[228:231], v237
    s_waitcnt vmcnt(8) lgkmcnt(12)
    v_mfma_f32_16x16x32_bf16 v[16:19], v[120:123], v[184:187], v[16:19]
    ds_read_b128 v[80:83], v247 offset:7168
    v_mfma_f32_16x16x32_bf16 v[44:47], v[120:123], v[188:191], v[44:47]
    ds_read_b128 v[84:87], v247 offset:8192
    v_mfma_f32_16x16x32_bf16 v[20:23], v[124:127], v[184:187], v[20:23]
    ds_read_b128 v[88:91], v247 offset:9216
    v_mfma_f32_16x16x32_bf16 v[48:51], v[124:127], v[188:191], v[48:51]
    ds_read_b128 v[92:95], v247 offset:10240
    v_mfma_f32_16x16x32_bf16 v[24:27], v[128:131], v[184:187], v[24:27]
    ds_read_b128 v[96:99], v247 offset:11264
    v_mfma_f32_16x16x32_bf16 v[52:55], v[128:131], v[188:191], v[52:55]
    ds_read_b128 v[100:103], v247 offset:12288
    v_mfma_f32_16x16x32_bf16 v[28:31], v[132:135], v[184:187], v[28:31]
    ds_read_b128 v[104:107], v247 offset:13312
    v_mfma_f32_16x16x32_bf16 v[56:59], v[132:135], v[188:191], v[56:59]
    ds_read_b128 v[108:111], v248 offset:8192
    s_waitcnt lgkmcnt(8)
    v_mfma_f32_16x16x32_bf16 v[32:35], v[184:187], v[136:139], v[32:35]
    ds_read_b128 v[112:115], v249 offset:57344
    v_mfma_f32_16x16x32_bf16 v[60:63], v[188:191], v[136:139], v[60:63]
    ds_read_b128 v[116:119], v251 offset:57344
    v_mfma_f32_16x16x32_bf16 v[36:39], v[184:187], v[140:143], v[36:39]
    buffer_load_dwordx4 v[176:179], v1, s[4:7], s41 offen offset:2048 sc1
    v_mfma_f32_16x16x32_bf16 v[64:67], v[188:191], v[140:143], v[64:67]
    buffer_load_dwordx4 v[180:183], v253, s[4:7], s41 offen offset:2048 sc1
    ds_read2_b32 v[232:233], v238 offset0:64 offset1:80
    v_mfma_f32_16x16x32_bf16 v[40:43], v[144:147], v[184:187], v[40:43]
    ds_read_b32 v234, v239
    v_mfma_f32_16x16x32_bf16 v[68:71], v[144:147], v[188:191], v[68:71]
    ds_read_b128 v[4:7], v255 offset:0
    v_mfma_f32_16x16x32_bf16 v[72:75], v[152:155], v[148:151], v[72:75]
    ds_read_b128 v[8:11], v255 offset:128
    v_mfma_f32_16x16x32_bf16 v[76:79], v[148:151], v[156:159], v[76:79]
    ds_read_b128 v[12:15], v255 offset:256
    s_waitcnt vmcnt(8) lgkmcnt(11)
    s_barrier
    v_mfma_f32_16x16x32_bf16 v[16:19], v[80:83], v[192:195], v[16:19]
    ds_read_b128 v[120:123], v247 offset:14336
    v_mfma_f32_16x16x32_bf16 v[44:47], v[80:83], v[196:199], v[44:47]
    ds_read_b128 v[124:127], v247 offset:15360
    v_mfma_f32_16x16x32_bf16 v[20:23], v[84:87], v[192:195], v[20:23]
    ds_read_b128 v[128:131], v247 offset:16384
    v_mfma_f32_16x16x32_bf16 v[48:51], v[84:87], v[196:199], v[48:51]
    ds_read_b128 v[132:135], v247 offset:17408
    v_mfma_f32_16x16x32_bf16 v[24:27], v[88:91], v[192:195], v[24:27]
    ds_read_b128 v[136:139], v247 offset:18432
    v_mfma_f32_16x16x32_bf16 v[52:55], v[88:91], v[196:199], v[52:55]
    ds_read_b128 v[140:143], v247 offset:19456
    v_mfma_f32_16x16x32_bf16 v[28:31], v[92:95], v[192:195], v[28:31]
    ds_read_b128 v[144:147], v247 offset:20480
    v_mfma_f32_16x16x32_bf16 v[56:59], v[92:95], v[196:199], v[56:59]
    ds_read_b128 v[148:151], v248 offset:9216
    s_waitcnt lgkmcnt(8)
    v_mfma_f32_16x16x32_bf16 v[32:35], v[192:195], v[96:99], v[32:35]
    ds_read_b128 v[152:155], v250 offset:0
    v_mfma_f32_16x16x32_bf16 v[60:63], v[196:199], v[96:99], v[60:63]
    ds_read_b128 v[156:159], v252 offset:0
    v_mfma_f32_16x16x32_bf16 v[36:39], v[192:195], v[100:103], v[36:39]
    buffer_load_dwordx4 v[184:187], v1, s[4:7], s41 offen offset:3072 sc1
    v_mfma_f32_16x16x32_bf16 v[64:67], v[196:199], v[100:103], v[64:67]
    buffer_load_dwordx4 v[188:191], v253, s[4:7], s41 offen offset:3072 sc1
    v_mfma_f32_16x16x32_bf16 v[40:43], v[104:107], v[192:195], v[40:43]
    v_mfma_f32_16x16x32_bf16 v[68:71], v[104:107], v[196:199], v[68:71]
    v_mfma_f32_16x16x32_bf16 v[72:75], v[112:115], v[108:111], v[72:75]
    v_mfma_f32_16x16x32_bf16 v[76:79], v[108:111], v[116:119], v[76:79]
    s_waitcnt vmcnt(8) lgkmcnt(6)
    v_mfma_f32_16x16x32_bf16 v[16:19], v[120:123], v[200:203], v[16:19]
    ds_read_b128 v[80:83], v247 offset:21504
    v_fma_f32 v32, -v8, v232, v32
    v_mfma_f32_16x16x32_bf16 v[44:47], v[120:123], v[204:207], v[44:47]
    ds_read_b128 v[84:87], v247 offset:22528
    v_fma_f32 v60, -v12, v232, v60
    v_mfma_f32_16x16x32_bf16 v[20:23], v[124:127], v[200:203], v[20:23]
    ds_read_b128 v[88:91], v247 offset:23552
    v_fma_f32 v36, -v8, v233, v36
    v_mfma_f32_16x16x32_bf16 v[48:51], v[124:127], v[204:207], v[48:51]
    ds_read_b128 v[92:95], v247 offset:24576
    v_fma_f32 v64, -v12, v233, v64
    v_mfma_f32_16x16x32_bf16 v[24:27], v[128:131], v[200:203], v[24:27]
    ds_read_b128 v[96:99], v247 offset:25600
    v_fma_f32 v40, -v242, v224, v40
    v_mfma_f32_16x16x32_bf16 v[52:55], v[128:131], v[204:207], v[52:55]
    ds_read_b128 v[100:103], v247 offset:26624
    v_fma_f32 v68, -v244, v224, v68
    v_mfma_f32_16x16x32_bf16 v[28:31], v[132:135], v[200:203], v[28:31]
    ds_read_b128 v[104:107], v247 offset:27648
    v_fma_f32 v72, -v240, v228, v72
    v_mfma_f32_16x16x32_bf16 v[56:59], v[132:135], v[204:207], v[56:59]
    ds_read_b128 v[108:111], v248 offset:10240
    s_waitcnt lgkmcnt(8)
    v_fma_f32 v76, -v4, v234, v76
    v_mfma_f32_16x16x32_bf16 v[32:35], v[200:203], v[136:139], v[32:35]
    ds_read_b128 v[112:115], v250 offset:7168
    v_fma_f32 v16, -v242, v208, v16
    v_mfma_f32_16x16x32_bf16 v[60:63], v[204:207], v[136:139], v[60:63]
    ds_read_b128 v[116:119], v252 offset:7168
    v_fma_f32 v44, -v244, v208, v44
    v_mfma_f32_16x16x32_bf16 v[36:39], v[200:203], v[140:143], v[36:39]
    buffer_load_dwordx4 v[192:195], v1, s[4:7], s42 offen offset:0 sc1
    v_fma_f32 v20, -v242, v212, v20
    v_mfma_f32_16x16x32_bf16 v[64:67], v[204:207], v[140:143], v[64:67]
    buffer_load_dwordx4 v[196:199], v253, s[4:7], s42 offen offset:0 sc1
    v_fma_f32 v48, -v244, v212, v48
    v_mfma_f32_16x16x32_bf16 v[40:43], v[144:147], v[200:203], v[40:43]
    v_fma_f32 v24, -v242, v216, v24
    v_mfma_f32_16x16x32_bf16 v[68:71], v[144:147], v[204:207], v[68:71]
    v_fma_f32 v52, -v244, v216, v52
    v_mfma_f32_16x16x32_bf16 v[72:75], v[152:155], v[148:151], v[72:75]
    v_fma_f32 v28, -v242, v220, v28
    v_mfma_f32_16x16x32_bf16 v[76:79], v[148:151], v[156:159], v[76:79]
    v_fma_f32 v56, -v244, v220, v56
    s_waitcnt vmcnt(8) lgkmcnt(6)
    s_barrier
    v_mfma_f32_16x16x32_bf16 v[16:19], v[80:83], v[160:163], v[16:19]
    ds_read_b128 v[120:123], v247 offset:28672
    v_fma_f32 v33, -v9, v232, v33
    v_mfma_f32_16x16x32_bf16 v[44:47], v[80:83], v[164:167], v[44:47]
    ds_read_b128 v[124:127], v247 offset:29696
    v_fma_f32 v61, -v13, v232, v61
    v_mfma_f32_16x16x32_bf16 v[20:23], v[84:87], v[160:163], v[20:23]
    ds_read_b128 v[128:131], v247 offset:30720
    v_fma_f32 v37, -v9, v233, v37
    v_mfma_f32_16x16x32_bf16 v[48:51], v[84:87], v[164:167], v[48:51]
    ds_read_b128 v[132:135], v247 offset:31744
    v_fma_f32 v65, -v13, v233, v65
    v_mfma_f32_16x16x32_bf16 v[24:27], v[88:91], v[160:163], v[24:27]
    ds_read_b128 v[136:139], v247 offset:32768
    v_fma_f32 v41, -v242, v225, v41
    v_mfma_f32_16x16x32_bf16 v[52:55], v[88:91], v[164:167], v[52:55]
    ds_read_b128 v[140:143], v247 offset:33792
    v_fma_f32 v69, -v244, v225, v69
    v_mfma_f32_16x16x32_bf16 v[28:31], v[92:95], v[160:163], v[28:31]
    ds_read_b128 v[144:147], v247 offset:34816
    v_fma_f32 v73, -v240, v229, v73
    v_mfma_f32_16x16x32_bf16 v[56:59], v[92:95], v[164:167], v[56:59]
    ds_read_b128 v[148:151], v248 offset:11264
    s_waitcnt lgkmcnt(8)
    v_fma_f32 v77, -v5, v234, v77
    v_mfma_f32_16x16x32_bf16 v[32:35], v[160:163], v[96:99], v[32:35]
    ds_read_b128 v[152:155], v250 offset:14336
    v_fma_f32 v17, -v242, v209, v17
    v_mfma_f32_16x16x32_bf16 v[60:63], v[164:167], v[96:99], v[60:63]
    ds_read_b128 v[156:159], v252 offset:14336
    v_fma_f32 v45, -v244, v209, v45
    v_mfma_f32_16x16x32_bf16 v[36:39], v[160:163], v[100:103], v[36:39]
    buffer_load_dwordx4 v[200:203], v1, s[4:7], s42 offen offset:1024 sc1
    v_fma_f32 v21, -v242, v213, v21
    v_mfma_f32_16x16x32_bf16 v[64:67], v[164:167], v[100:103], v[64:67]
    buffer_load_dwordx4 v[204:207], v253, s[4:7], s42 offen offset:1024 sc1
    v_fma_f32 v49, -v244, v213, v49
    v_mfma_f32_16x16x32_bf16 v[40:43], v[104:107], v[160:163], v[40:43]
    v_fma_f32 v25, -v242, v217, v25
    v_mfma_f32_16x16x32_bf16 v[68:71], v[104:107], v[164:167], v[68:71]
    v_fma_f32 v53, -v244, v217, v53
    v_mfma_f32_16x16x32_bf16 v[72:75], v[112:115], v[108:111], v[72:75]
    v_fma_f32 v29, -v242, v221, v29
    v_mfma_f32_16x16x32_bf16 v[76:79], v[108:111], v[116:119], v[76:79]
    v_fma_f32 v57, -v244, v221, v57
    s_waitcnt vmcnt(8) lgkmcnt(6)
    v_mfma_f32_16x16x32_bf16 v[16:19], v[120:123], v[168:171], v[16:19]
    ds_read_b128 v[80:83], v247 offset:35840
    v_fma_f32 v34, -v10, v232, v34
    v_mfma_f32_16x16x32_bf16 v[44:47], v[120:123], v[172:175], v[44:47]
    ds_read_b128 v[84:87], v247 offset:36864
    v_fma_f32 v62, -v14, v232, v62
    v_mfma_f32_16x16x32_bf16 v[20:23], v[124:127], v[168:171], v[20:23]
    ds_read_b128 v[88:91], v247 offset:37888
    v_fma_f32 v38, -v10, v233, v38
    v_mfma_f32_16x16x32_bf16 v[48:51], v[124:127], v[172:175], v[48:51]
    ds_read_b128 v[92:95], v247 offset:38912
    v_fma_f32 v66, -v14, v233, v66
    v_mfma_f32_16x16x32_bf16 v[24:27], v[128:131], v[168:171], v[24:27]
    ds_read_b128 v[96:99], v247 offset:39936
    v_fma_f32 v42, -v242, v226, v42
    v_mfma_f32_16x16x32_bf16 v[52:55], v[128:131], v[172:175], v[52:55]
    ds_read_b128 v[100:103], v247 offset:40960
    v_fma_f32 v70, -v244, v226, v70
    v_mfma_f32_16x16x32_bf16 v[28:31], v[132:135], v[168:171], v[28:31]
    ds_read_b128 v[104:107], v247 offset:41984
    v_fma_f32 v74, -v240, v230, v74
    v_mfma_f32_16x16x32_bf16 v[56:59], v[132:135], v[172:175], v[56:59]
    ds_read_b128 v[108:111], v248 offset:12288
    s_waitcnt lgkmcnt(8)
    v_fma_f32 v78, -v6, v234, v78
    v_mfma_f32_16x16x32_bf16 v[32:35], v[168:171], v[136:139], v[32:35]
    ds_read_b128 v[112:115], v250 offset:21504
    v_fma_f32 v18, -v242, v210, v18
    v_mfma_f32_16x16x32_bf16 v[60:63], v[172:175], v[136:139], v[60:63]
    ds_read_b128 v[116:119], v252 offset:21504
    v_fma_f32 v46, -v244, v210, v46
    v_mfma_f32_16x16x32_bf16 v[36:39], v[168:171], v[140:143], v[36:39]
    v_fma_f32 v22, -v242, v214, v22
    v_mfma_f32_16x16x32_bf16 v[64:67], v[172:175], v[140:143], v[64:67]
    v_fma_f32 v50, -v244, v214, v50
    v_mfma_f32_16x16x32_bf16 v[40:43], v[144:147], v[168:171], v[40:43]
    v_fma_f32 v26, -v242, v218, v26
    v_mfma_f32_16x16x32_bf16 v[68:71], v[144:147], v[172:175], v[68:71]
    v_fma_f32 v54, -v244, v218, v54
    v_mfma_f32_16x16x32_bf16 v[72:75], v[152:155], v[148:151], v[72:75]
    v_fma_f32 v30, -v242, v222, v30
    v_mfma_f32_16x16x32_bf16 v[76:79], v[148:151], v[156:159], v[76:79]
    v_fma_f32 v58, -v244, v222, v58
    s_waitcnt vmcnt(6) lgkmcnt(6)
    v_mfma_f32_16x16x32_bf16 v[16:19], v[80:83], v[176:179], v[16:19]
    ds_read_b128 v[120:123], v247 offset:43008
    v_fma_f32 v35, -v11, v232, v35
    v_mfma_f32_16x16x32_bf16 v[44:47], v[80:83], v[180:183], v[44:47]
    ds_read_b128 v[124:127], v247 offset:44032
    v_fma_f32 v63, -v15, v232, v63
    v_mfma_f32_16x16x32_bf16 v[20:23], v[84:87], v[176:179], v[20:23]
    ds_read_b128 v[128:131], v247 offset:45056
    v_fma_f32 v39, -v11, v233, v39
    v_mfma_f32_16x16x32_bf16 v[48:51], v[84:87], v[180:183], v[48:51]
    ds_read_b128 v[132:135], v247 offset:46080
    v_fma_f32 v67, -v15, v233, v67
    v_mfma_f32_16x16x32_bf16 v[24:27], v[88:91], v[176:179], v[24:27]
    ds_read_b128 v[136:139], v247 offset:47104
    v_fma_f32 v43, -v242, v227, v43
    v_mfma_f32_16x16x32_bf16 v[52:55], v[88:91], v[180:183], v[52:55]
    ds_read_b128 v[140:143], v247 offset:48128
    v_fma_f32 v71, -v244, v227, v71
    v_mfma_f32_16x16x32_bf16 v[28:31], v[92:95], v[176:179], v[28:31]
    ds_read_b128 v[144:147], v247 offset:49152
    v_fma_f32 v75, -v240, v231, v75
    v_mfma_f32_16x16x32_bf16 v[56:59], v[92:95], v[180:183], v[56:59]
    ds_read_b128 v[148:151], v248 offset:13312
    s_waitcnt lgkmcnt(8)
    v_fma_f32 v79, -v7, v234, v79
    v_mfma_f32_16x16x32_bf16 v[32:35], v[176:179], v[96:99], v[32:35]
    ds_read_b128 v[152:155], v250 offset:28672
    v_fma_f32 v19, -v242, v211, v19
    v_mfma_f32_16x16x32_bf16 v[60:63], v[180:183], v[96:99], v[60:63]
    ds_read_b128 v[156:159], v252 offset:28672
    v_fma_f32 v47, -v244, v211, v47
    v_mfma_f32_16x16x32_bf16 v[36:39], v[176:179], v[100:103], v[36:39]
    v_fma_f32 v23, -v242, v215, v23
    v_mfma_f32_16x16x32_bf16 v[64:67], v[180:183], v[100:103], v[64:67]
    v_fma_f32 v51, -v244, v215, v51
    v_mfma_f32_16x16x32_bf16 v[40:43], v[104:107], v[176:179], v[40:43]
    v_fma_f32 v27, -v242, v219, v27
    v_mfma_f32_16x16x32_bf16 v[68:71], v[104:107], v[180:183], v[68:71]
    v_fma_f32 v55, -v244, v219, v55
    v_mfma_f32_16x16x32_bf16 v[72:75], v[112:115], v[108:111], v[72:75]
    v_fma_f32 v31, -v242, v223, v31
    v_mfma_f32_16x16x32_bf16 v[76:79], v[108:111], v[116:119], v[76:79]
    v_fma_f32 v59, -v244, v223, v59
    s_waitcnt vmcnt(4) lgkmcnt(6)
    s_barrier
    v_mfma_f32_16x16x32_bf16 v[16:19], v[120:123], v[184:187], v[16:19]
    ds_read_b128 v[80:83], v247 offset:50176
    v_mfma_f32_16x16x32_bf16 v[44:47], v[120:123], v[188:191], v[44:47]
    ds_read_b128 v[84:87], v247 offset:51200
    v_and_b32 v4, 1, v2
    v_mfma_f32_16x16x32_bf16 v[20:23], v[124:127], v[184:187], v[20:23]
    ds_read_b128 v[88:91], v247 offset:52224
    v_lshl_add_u32 v5, v3, 2, v4
    v_mfma_f32_16x16x32_bf16 v[48:51], v[124:127], v[188:191], v[48:51]
    ds_read_b128 v[92:95], v247 offset:53248
    v_add_u32 v6, 2, v5
    v_mfma_f32_16x16x32_bf16 v[24:27], v[128:131], v[184:187], v[24:27]
    ds_read_b128 v[96:99], v247 offset:54272
    v_cmp_eq_u32 s[40:41], 1, v4
    v_mfma_f32_16x16x32_bf16 v[52:55], v[128:131], v[188:191], v[52:55]
    ds_read_b128 v[100:103], v247 offset:55296
    v_cmp_le_u32 s[42:43], v5, v2
    v_mfma_f32_16x16x32_bf16 v[28:31], v[132:135], v[184:187], v[28:31]
    ds_read_b128 v[104:107], v247 offset:56320
    v_cmp_le_u32 s[44:45], v6, v2
    v_mfma_f32_16x16x32_bf16 v[56:59], v[132:135], v[188:191], v[56:59]
    ds_read_b128 v[108:111], v248 offset:14336
    s_waitcnt lgkmcnt(8)
    v_mfma_f32_16x16x32_bf16 v[32:35], v[184:187], v[136:139], v[32:35]
    ds_read_b128 v[112:115], v250 offset:35840
    v_mov_b32 v4, 0x0c0c0100
    v_mfma_f32_16x16x32_bf16 v[60:63], v[188:191], v[136:139], v[60:63]
    ds_read_b128 v[116:119], v252 offset:35840
    v_mov_b32 v5, 0x01000c0c
    v_mfma_f32_16x16x32_bf16 v[36:39], v[184:187], v[140:143], v[36:39]
    v_mov_b32 v6, 0x0c0c0302
    v_mov_b32 v7, 0x03020c0c
    v_mfma_f32_16x16x32_bf16 v[64:67], v[188:191], v[140:143], v[64:67]
    v_mov_b32 v8, 0x0c0c0c0c
    v_cndmask_b32 v4, v4, v5, s[40:41]
    v_mfma_f32_16x16x32_bf16 v[40:43], v[144:147], v[184:187], v[40:43]
    v_cndmask_b32 v6, v6, v7, s[40:41]
    v_cndmask_b32 v12, v4, v8, s[42:43]
    v_mfma_f32_16x16x32_bf16 v[68:71], v[144:147], v[188:191], v[68:71]
    v_cndmask_b32 v13, v6, v8, s[44:45]
    v_cndmask_b32 v14, v8, v4, s[42:43]
    v_mfma_f32_16x16x32_bf16 v[72:75], v[152:155], v[148:151], v[72:75]
    v_cndmask_b32 v15, v8, v6, s[44:45]
    s_cmp_eq_u32 s31, 0
    v_mfma_f32_16x16x32_bf16 v[76:79], v[148:151], v[156:159], v[76:79]
    s_cselect_b64 s[48:49], s[42:43], -1
    s_cselect_b64 s[38:39], s[44:45], -1
    s_waitcnt vmcnt(2) lgkmcnt(6)
    v_mfma_f32_16x16x32_bf16 v[16:19], v[80:83], v[192:195], v[16:19]
    ds_read_b128 v[120:123], v247 offset:57344
    v_mfma_f32_16x16x32_bf16 v[44:47], v[80:83], v[196:199], v[44:47]
    ds_read_b128 v[124:127], v247 offset:58368
    s_mul_i32 s36, s20, 3072
    v_mfma_f32_16x16x32_bf16 v[20:23], v[84:87], v[192:195], v[20:23]
    ds_read_b128 v[128:131], v247 offset:59392
    s_add_u32 s36, s36, 149504
    v_mfma_f32_16x16x32_bf16 v[48:51], v[84:87], v[196:199], v[48:51]
    ds_read_b128 v[132:135], v247 offset:60416
    v_add_u32 v9, s36, v0
    v_mfma_f32_16x16x32_bf16 v[24:27], v[88:91], v[192:195], v[24:27]
    ds_read_b128 v[136:139], v247 offset:61440
    s_lshl_b32 s37, s20, 9
    v_mfma_f32_16x16x32_bf16 v[52:55], v[88:91], v[196:199], v[52:55]
    ds_read_b128 v[140:143], v247 offset:62464
    s_add_u32 s37, s37, 149504
    v_mfma_f32_16x16x32_bf16 v[28:31], v[92:95], v[192:195], v[28:31]
    ds_read_b128 v[144:147], v247 offset:63488
    v_add_u32 v10, s37, v0
    v_mfma_f32_16x16x32_bf16 v[56:59], v[92:95], v[196:199], v[56:59]
    ds_read_b128 v[148:151], v248 offset:15360
    s_waitcnt lgkmcnt(8)
    v_mfma_f32_16x16x32_bf16 v[32:35], v[192:195], v[96:99], v[32:35]
    ds_read_b128 v[152:155], v250 offset:43008
    v_lshlrev_b32 v4, 2, v3
    v_mfma_f32_16x16x32_bf16 v[60:63], v[196:199], v[96:99], v[60:63]
    ds_read_b128 v[156:159], v252 offset:43008
    v_sub_u32 v4, v2, v4
    v_mfma_f32_16x16x32_bf16 v[36:39], v[192:195], v[100:103], v[36:39]
    v_lshlrev_b32 v5, 4, v4
    v_lshrrev_b32 v4, 1, v4
    v_mfma_f32_16x16x32_bf16 v[64:67], v[196:199], v[100:103], v[64:67]
    v_mov_b32 v6, 0x3f80
    v_lshlrev_b32 v5, v5, v6
    v_mfma_f32_16x16x32_bf16 v[40:43], v[104:107], v[192:195], v[40:43]
    v_cmp_eq_u32 vcc, 0, v4
    v_cmp_eq_u32 s[46:47], 1, v4
    v_mfma_f32_16x16x32_bf16 v[68:71], v[104:107], v[196:199], v[68:71]
    ds_read_b128 v[208:211], v255 offset:64
    s_lshl_b32 s36, s24, 10
    v_add_u32 v4, s36, v1
    v_mfma_f32_16x16x32_bf16 v[72:75], v[112:115], v[108:111], v[72:75]
    ds_read_b128 v[212:215], v255 offset:192
    v_cndmask_b32 v234, 0, v5, vcc
    v_cndmask_b32 v235, 0, v5, s[46:47]
    v_mfma_f32_16x16x32_bf16 v[76:79], v[108:111], v[116:119], v[76:79]
    ds_read_b128 v[216:219], v255 offset:320
    v_add_u32 v5, 18432, v4
    s_lshl_b32 s36, s24, 7
    s_waitcnt vmcnt(0) lgkmcnt(9)
    v_mfma_f32_16x16x32_bf16 v[16:19], v[120:123], v[200:203], v[16:19]
    ds_read_b128 v[80:83], v248 offset:16384
    v_mfma_f32_16x16x32_bf16 v[44:47], v[120:123], v[204:207], v[44:47]
    ds_read_b128 v[84:87], v250 offset:50176
    s_add_u32 s36, s36, 16384
    v_mfma_f32_16x16x32_bf16 v[20:23], v[124:127], v[200:203], v[20:23]
    ds_read_b128 v[88:91], v252 offset:50176
    v_cmp_eq_u32 vcc, 2, v3
    v_mfma_f32_16x16x32_bf16 v[48:51], v[124:127], v[204:207], v[48:51]
    ds_read_b128 v[92:95], v248 offset:17408
    v_lshl_add_u32 v6, v2, 3, s36
    v_mfma_f32_16x16x32_bf16 v[24:27], v[128:131], v[200:203], v[24:27]
    ds_read_b128 v[96:99], v250 offset:57344
    v_bfrev_b32 v7, 1
    v_mfma_f32_16x16x32_bf16 v[52:55], v[128:131], v[204:207], v[52:55]
    ds_read_b128 v[100:103], v252 offset:57344
    v_cndmask_b32 v6, v7, v6, vcc
    v_mfma_f32_16x16x32_bf16 v[28:31], v[132:135], v[200:203], v[28:31]
    v_add_u32 v7, 18432, v6
    v_mov_b32 v106, 0
    v_mfma_f32_16x16x32_bf16 v[56:59], v[132:135], v[204:207], v[56:59]
    s_waitcnt lgkmcnt(6)
    v_mov_b32 v107, 0
    v_mfma_f32_16x16x32_bf16 v[32:35], v[200:203], v[136:139], v[32:35]
    v_mov_b32 v8, 0xf149f2ca
    v_mov_b32 v108, 0
    v_mfma_f32_16x16x32_bf16 v[60:63], v[204:207], v[136:139], v[60:63]
    s_mov_b32 s33, 0x3eae1a93
    v_mov_b32 v109, 0
    v_mfma_f32_16x16x32_bf16 v[36:39], v[200:203], v[140:143], v[36:39]
    v_mov_b32 v236, 0x3f803f80
    v_mov_b32 v237, 0x3f803f80
    v_mfma_f32_16x16x32_bf16 v[64:67], v[204:207], v[140:143], v[64:67]
    v_mov_b32 v238, 0x3f803f80
    v_mov_b32 v239, 0x3f803f80
    v_mfma_f32_16x16x32_bf16 v[40:43], v[144:147], v[200:203], v[40:43]
    v_mov_b32 v114, 0
    v_mfma_f32_16x16x32_bf16 v[68:71], v[144:147], v[204:207], v[68:71]
    v_mov_b32 v115, 0
    v_mfma_f32_16x16x32_bf16 v[72:75], v[152:155], v[148:151], v[72:75]
    v_mov_b32 v116, 0
    v_mfma_f32_16x16x32_bf16 v[76:79], v[148:151], v[156:159], v[76:79]
    v_mov_b32 v117, 0
    s_waitcnt lgkmcnt(0)
    v_mfma_f32_16x16x32_bf16 v[72:75], v[84:87], v[80:83], v[72:75]
    v_mfma_f32_16x16x32_bf16 v[76:79], v[80:83], v[88:91], v[76:79]
    v_mfma_f32_16x16x32_bf16 v[72:75], v[96:99], v[92:95], v[72:75]
    v_mfma_f32_16x16x32_bf16 v[76:79], v[92:95], v[100:103], v[76:79]
    v_pk_mul_f32 v[52:53], v[52:53], v[244:245] op_sel:[0,1] op_sel_hi:[1,1]
    v_pk_mul_f32 v[54:55], v[54:55], v[244:245] op_sel:[0,1] op_sel_hi:[1,1]
    v_pk_mul_f32 v[56:57], v[56:57], v[244:245] op_sel:[0,1] op_sel_hi:[1,1]
    v_pk_mul_f32 v[58:59], v[58:59], v[244:245] op_sel:[0,1] op_sel_hi:[1,1]
    v_pk_mul_f32 v[60:61], v[60:61], v[216:217]
    v_pk_mul_f32 v[62:63], v[62:63], v[218:219]
    v_pk_mul_f32 v[64:65], v[64:65], v[216:217]
    v_pk_mul_f32 v[66:67], v[66:67], v[218:219]
    v_pk_mul_f32 v[68:69], v[68:69], v[244:245] op_sel:[0,1] op_sel_hi:[1,1]
    v_pk_mul_f32 v[70:71], v[70:71], v[244:245] op_sel:[0,1] op_sel_hi:[1,1]
    v_pk_mul_f32 v[72:73], v[72:73], v[240:241] op_sel:[0,1] op_sel_hi:[1,1]
    v_pk_mul_f32 v[74:75], v[74:75], v[240:241] op_sel:[0,1] op_sel_hi:[1,1]
    v_pk_mul_f32 v[76:77], v[76:77], v[208:209]
    v_pk_mul_f32 v[78:79], v[78:79], v[210:211]
    v_cvt_pk_bf16_f32 v172, v52, v53
    v_cvt_pk_bf16_f32 v173, v54, v55
    v_cvt_pk_bf16_f32 v176, v56, v57
    v_cvt_pk_bf16_f32 v177, v58, v59
    v_cvt_pk_bf16_f32 v182, v60, v61
    v_cvt_pk_bf16_f32 v183, v62, v63
    v_cvt_pk_bf16_f32 v188, v64, v65
    v_cvt_pk_bf16_f32 v189, v66, v67
    v_cvt_pk_bf16_f32 v174, v68, v69
    v_cvt_pk_bf16_f32 v175, v70, v71
    v_cvt_pk_bf16_f32 v220, v72, v73
    v_cvt_pk_bf16_f32 v221, v74, v75
    v_cvt_pk_bf16_f32 v222, v76, v77
    v_cvt_pk_bf16_f32 v223, v78, v79
    s_cmp_eq_u32 s20, 3
    s_cbranch_scc1 L_a_nw
    ds_write2st64_b64 v9, v[172:173], v[174:175] offset0:6 offset1:7
    ds_write2st64_b64 v9, v[176:177], v[182:183] offset0:8 offset1:9
    ds_write_b64 v9, v[188:189] offset:5120
    ds_write2st64_b64 v10, v[220:221], v[222:223] offset0:0 offset1:3
L_a_nw:
    v_pk_mul_f32 v[24:25], v[24:25], v[242:243] op_sel:[0,1] op_sel_hi:[1,1]
    v_pk_mul_f32 v[26:27], v[26:27], v[242:243] op_sel:[0,1] op_sel_hi:[1,1]
    v_pk_mul_f32 v[28:29], v[28:29], v[242:243] op_sel:[0,1] op_sel_hi:[1,1]
    v_pk_mul_f32 v[30:31], v[30:31], v[242:243] op_sel:[0,1] op_sel_hi:[1,1]
    v_pk_mul_f32 v[32:33], v[32:33], v[212:213]
    v_pk_mul_f32 v[34:35], v[34:35], v[214:215]
    v_pk_mul_f32 v[36:37], v[36:37], v[212:213]
    v_pk_mul_f32 v[38:39], v[38:39], v[214:215]
    v_pk_mul_f32 v[40:41], v[40:41], v[242:243] op_sel:[0,1] op_sel_hi:[1,1]
    v_pk_mul_f32 v[42:43], v[42:43], v[242:243] op_sel:[0,1] op_sel_hi:[1,1]
    v_cvt_pk_bf16_f32 v166, v24, v25
    v_cvt_pk_bf16_f32 v167, v26, v27
    v_cvt_pk_bf16_f32 v170, v28, v29
    v_cvt_pk_bf16_f32 v171, v30, v31
    v_cvt_pk_bf16_f32 v180, v32, v33
    v_cvt_pk_bf16_f32 v181, v34, v35
    v_cvt_pk_bf16_f32 v186, v36, v37
    v_cvt_pk_bf16_f32 v187, v38, v39
    v_cvt_pk_bf16_f32 v168, v40, v41
    v_cvt_pk_bf16_f32 v169, v42, v43
    s_waitcnt lgkmcnt(0)
    s_barrier
    ds_read2st64_b64 v[160:163], v9 offset0:0 offset1:1
    ds_read_b64 v[164:165], v9 offset:1024
    ds_read_b64 v[178:179], v9 offset:1536
    ds_read_b64 v[184:185], v9 offset:2048
    v_mfma_f32_16x16x16_bf16 v[128:131], v[174:175], v[234:235], 0
    v_mfma_f32_16x16x16_bf16 v[124:127], v[168:169], v[234:235], 0
    v_pk_mul_f32 v[44:45], v[44:45], v[244:245] op_sel:[0,1] op_sel_hi:[1,1]
    v_pk_mul_f32 v[46:47], v[46:47], v[244:245] op_sel:[0,1] op_sel_hi:[1,1]
    v_pk_mul_f32 v[48:49], v[48:49], v[244:245] op_sel:[0,1] op_sel_hi:[1,1]
    v_pk_mul_f32 v[50:51], v[50:51], v[244:245] op_sel:[0,1] op_sel_hi:[1,1]
    v_pk_mul_f32 v[16:17], v[16:17], v[242:243] op_sel:[0,1] op_sel_hi:[1,1]
    v_pk_mul_f32 v[18:19], v[18:19], v[242:243] op_sel:[0,1] op_sel_hi:[1,1]
    v_pk_mul_f32 v[20:21], v[20:21], v[242:243] op_sel:[0,1] op_sel_hi:[1,1]
    v_pk_mul_f32 v[22:23], v[22:23], v[242:243] op_sel:[0,1] op_sel_hi:[1,1]
    v_cvt_pk_bf16_f32 v112, v44, v45
    v_cvt_pk_bf16_f32 v113, v46, v47
    v_cvt_pk_bf16_f32 v118, v48, v49
    v_cvt_pk_bf16_f32 v119, v50, v51
    v_cvt_pk_bf16_f32 v104, v16, v17
    v_cvt_pk_bf16_f32 v105, v18, v19
    v_cvt_pk_bf16_f32 v110, v20, v21
    v_cvt_pk_bf16_f32 v111, v22, v23
    v_permlane16_swap_b32 v114, v174
    v_permlane16_swap_b32 v117, v175
    v_permlane16_swap_b32 v106, v168
    v_permlane16_swap_b32 v109, v169
    s_waitcnt lgkmcnt(0)
    v_mfma_f32_16x16x16_bf16 v[120:123], v[162:163], v[234:235], 0
    v_mfma_f32_16x16x32_bf16 v[20:23], v[172:175], v[112:115], 0
    v_mfma_f32_16x16x32_bf16 v[16:19], v[166:169], v[112:115], 0
    v_mfma_f32_16x16x32_bf16 v[28:31], v[174:177], v[116:119], 0
    v_mfma_f32_16x16x32_bf16 v[24:27], v[168:171], v[116:119], 0
    v_mfma_f32_16x16x32_bf16 v[36:39], v[166:169], v[104:107], 0
    v_mfma_f32_16x16x32_bf16 v[32:35], v[160:163], v[104:107], 0
    v_mfma_f32_16x16x32_bf16 v[44:47], v[168:171], v[108:111], 0
    v_mfma_f32_16x16x32_bf16 v[40:43], v[162:165], v[108:111], 0
    v_cvt_pk_bf16_f32 v194, v128, v129
    v_cvt_pk_bf16_f32 v195, v130, v131
    v_cvt_pk_bf16_f32 v192, v124, v125
    v_cvt_pk_bf16_f32 v193, v126, v127
    v_cvt_pk_bf16_f32 v190, v120, v121
    v_cvt_pk_bf16_f32 v191, v122, v123
    v_cndmask_b32 v20, v20, v21, s[40:41]
    v_cndmask_b32 v16, v16, v17, s[40:41]
    v_cndmask_b32 v48, v16, v20, s[42:43]
    v_cndmask_b32 v22, v22, v23, s[40:41]
    v_cndmask_b32 v18, v18, v19, s[40:41]
    v_cndmask_b32 v49, v18, v22, s[44:45]
    v_max_f32 v56, v48, v49
    v_cndmask_b32 v28, v28, v29, s[40:41]
    v_cndmask_b32 v24, v24, v25, s[40:41]
    v_cndmask_b32 v50, v24, v28, s[42:43]
    v_cndmask_b32 v30, v30, v31, s[40:41]
    v_cndmask_b32 v26, v26, v27, s[40:41]
    v_cndmask_b32 v51, v26, v30, s[44:45]
    v_max_f32 v57, v50, v51
    v_cndmask_b32 v36, v36, v37, s[40:41]
    v_cndmask_b32 v32, v32, v33, s[40:41]
    v_cndmask_b32 v52, v32, v36, s[42:43]
    v_cndmask_b32 v52, v8, v52, s[48:49]
    v_cndmask_b32 v38, v38, v39, s[40:41]
    v_cndmask_b32 v34, v34, v35, s[40:41]
    v_cndmask_b32 v53, v34, v38, s[44:45]
    v_cndmask_b32 v53, v8, v53, s[38:39]
    v_max_f32 v58, v52, v53
    v_permlane32_swap_b32 v56, v57
    v_max_f32 v56, v56, v57
    v_cndmask_b32 v44, v44, v45, s[40:41]
    v_cndmask_b32 v40, v40, v41, s[40:41]
    v_cndmask_b32 v54, v40, v44, s[42:43]
    v_cndmask_b32 v54, v8, v54, s[48:49]
    v_cndmask_b32 v46, v46, v47, s[40:41]
    v_cndmask_b32 v42, v42, v43, s[40:41]
    v_cndmask_b32 v55, v42, v46, s[44:45]
    v_cndmask_b32 v55, v8, v55, s[38:39]
    v_max_f32 v59, v54, v55
    s_nop 1
    v_permlane32_swap_b32 v58, v59
    v_max_f32 v58, v58, v59
    s_nop 1
    v_permlane16_swap_b32 v56, v58
    v_max_f32 v57, v56, v58
    v_mul_f32 v56, s33, v57
    v_mul_f32 v58, s33, v57
    s_nop 1
    v_permlane16_swap_b32 v56, v58
    v_mov_b32 v57, v56
    v_mov_b32 v59, v58
    s_nop 0
    v_permlane32_swap_b32 v56, v57
    v_permlane32_swap_b32 v58, v59
    v_fma_f32 v48, v48, s33, -v56
    v_fma_f32 v49, v49, s33, -v56
    v_fma_f32 v50, v50, s33, -v57
    v_fma_f32 v51, v51, s33, -v57
    v_fma_f32 v52, v52, s33, -v58
    v_fma_f32 v53, v53, s33, -v58
    v_fma_f32 v54, v54, s33, -v59
    v_fma_f32 v55, v55, s33, -v59
    v_exp_f32 v48, v48
    v_exp_f32 v49, v49
    v_exp_f32 v50, v50
    v_exp_f32 v51, v51
    v_exp_f32 v52, v52
    v_exp_f32 v53, v53
    v_exp_f32 v54, v54
    v_exp_f32 v55, v55
    v_cvt_pk_bf16_f32 v56, v48, v49
    v_cvt_pk_bf16_f32 v57, v50, v51
    v_cvt_pk_bf16_f32 v58, v52, v53
    v_cvt_pk_bf16_f32 v59, v54, v55
    v_perm_b32 v64, v56, v56, v12
    v_perm_b32 v65, v56, v56, v13
    v_perm_b32 v66, v56, v56, v14
    v_perm_b32 v67, v56, v56, v15
    v_perm_b32 v68, v57, v57, v12
    v_perm_b32 v69, v57, v57, v13
    v_perm_b32 v70, v57, v57, v14
    v_perm_b32 v71, v57, v57, v15
    v_perm_b32 v72, v58, v58, v12
    v_perm_b32 v73, v58, v58, v13
    v_perm_b32 v74, v58, v58, v14
    v_perm_b32 v75, v58, v58, v15
    v_perm_b32 v76, v59, v59, v12
    v_perm_b32 v77, v59, v59, v13
    v_perm_b32 v78, v59, v59, v14
    v_perm_b32 v79, v59, v59, v15
    v_mfma_f32_16x16x32_bf16 v[80:83], v[236:239], v[64:67], 0
    v_mfma_f32_16x16x32_bf16 v[84:87], v[236:239], v[68:71], 0
    v_mfma_f32_16x16x32_bf16 v[88:91], v[236:239], v[72:75], 0
    v_mfma_f32_16x16x32_bf16 v[92:95], v[236:239], v[76:79], 0
    v_mfma_f32_16x16x32_bf16 v[16:19], v[180:183], v[64:67], 0
    v_mfma_f32_16x16x32_bf16 v[20:23], v[192:195], v[64:67], 0
    v_mfma_f32_16x16x32_bf16 v[24:27], v[186:189], v[68:71], 0
    v_mfma_f32_16x16x32_bf16 v[28:31], v[192:195], v[68:71], 0
    v_mfma_f32_16x16x32_bf16 v[32:35], v[178:181], v[72:75], 0
    v_mfma_f32_16x16x32_bf16 v[36:39], v[190:193], v[72:75], 0
    v_mfma_f32_16x16x32_bf16 v[40:43], v[184:187], v[76:79], 0
    v_mfma_f32_16x16x32_bf16 v[44:47], v[190:193], v[76:79], 0
    v_rcp_f32 v80, v80
    v_rcp_f32 v84, v84
    v_rcp_f32 v88, v88
    v_rcp_f32 v92, v92
    v_pk_mul_f32 v[16:17], v[16:17], v[80:81] op_sel_hi:[1,0]
    v_pk_mul_f32 v[18:19], v[18:19], v[80:81] op_sel_hi:[1,0]
    v_pk_mul_f32 v[20:21], v[20:21], v[80:81] op_sel_hi:[1,0]
    v_pk_mul_f32 v[24:25], v[24:25], v[84:85] op_sel_hi:[1,0]
    v_pk_mul_f32 v[26:27], v[26:27], v[84:85] op_sel_hi:[1,0]
    v_pk_mul_f32 v[30:31], v[30:31], v[84:85] op_sel_hi:[1,0]
    v_cvt_pk_bf16_f32 v220, v16, v17
    v_cvt_pk_bf16_f32 v221, v18, v19
    v_cvt_pk_bf16_f32 v224, v20, v21
    v_cvt_pk_bf16_f32 v222, v24, v25
    v_cvt_pk_bf16_f32 v223, v26, v27
    v_cvt_pk_bf16_f32 v225, v30, v31
    buffer_store_dwordx4 v[220:223], v5, s[4:7], s35 offen sc1
    buffer_store_dwordx2 v[224:225], v7, s[4:7], s35 offen sc1
    v_pk_mul_f32 v[32:33], v[32:33], v[88:89] op_sel_hi:[1,0]
    v_pk_mul_f32 v[34:35], v[34:35], v[88:89] op_sel_hi:[1,0]
    v_pk_mul_f32 v[36:37], v[36:37], v[88:89] op_sel_hi:[1,0]
    v_pk_mul_f32 v[40:41], v[40:41], v[92:93] op_sel_hi:[1,0]
    v_pk_mul_f32 v[42:43], v[42:43], v[92:93] op_sel_hi:[1,0]
    v_pk_mul_f32 v[46:47], v[46:47], v[92:93] op_sel_hi:[1,0]
    v_cvt_pk_bf16_f32 v228, v32, v33
    v_cvt_pk_bf16_f32 v229, v34, v35
    v_cvt_pk_bf16_f32 v232, v36, v37
    v_cvt_pk_bf16_f32 v230, v40, v41
    v_cvt_pk_bf16_f32 v231, v42, v43
    v_cvt_pk_bf16_f32 v233, v46, v47
    buffer_store_dwordx4 v[228:231], v4, s[4:7], s35 offen sc1
    buffer_store_dwordx2 v[232:233], v6, s[4:7], s35 offen sc1
    s_and_b32 s25, s2, 7
    s_lshr_b32 s26, s2, 3
    s_lshr_b32 s23, s25, 1
    s_lshl_b32 s23, s23, 3
    s_lshr_b32 s27, s26, 2
    s_add_u32 s23, s23, s27
    s_and_b32 s24, s25, 1
    s_lshl_b32 s24, s24, 2
    s_and_b32 s27, s26, 3
    s_add_u32 s24, s24, s27
    s_add_u32 s25, s23, s24
    s_and_b32 s25, s25, 3
    s_lshl_b32 s30, s23, 2
    s_add_u32 s30, s30, s20
    s_mul_i32 s29, s30, 18432
    s_add_u32 s29, s29, s21
    s_add_u32 s29, s29, 0x600000
    s_mul_i32 s34, s30, 18432
    s_add_u32 s34, s34, s21
    s_add_u32 s34, s34, 0x0
    s_lshl_b32 s35, s24, 11
    s_lshr_b32 s36, s24, 2
    s_lshl_b32 s36, s36, 10
    s_and_b32 s37, s24, 3
    s_lshl_b32 s37, s37, 8
    s_add_u32 s36, s36, s37
    s_add_u32 s36, s36, 16384
    v_bfe_u32 v2, v1, 4, 4
    v_lshrrev_b32 v3, 8, v1
    v_add_u32 v4, s35, v1
    v_lshlrev_b32 v5, 4, v2
    v_lshl_add_u32 v5, v3, 3, v5
    v_add_u32 v5, s36, v5
    v_cmp_gt_u32 s[40:41], 2, v3
    v_bfrev_b32 v6, 1
    v_add_u32 v12, 0, v1
    v_add_u32 v13, 36864, v1
    v_add_u32 v14, 73728, v1
    v_add_u32 v15, 110592, v1
    v_cndmask_b32 v5, v6, v5, s[40:41]
    buffer_load_dwordx4 v[208:211], v4, s[4:7], s34 offen offset:0 sc1
    buffer_load_dwordx4 v[212:215], v4, s[4:7], s34 offen offset:1024 sc1
    buffer_load_dwordx2 v[216:217], v5, s[4:7], s34 offen sc1
    s_add_u32 s34, s34, 0x300000
    s_lshl_b32 s39, s30, 10
    s_add_u32 s39, s39, s21
    s_lshl_b32 s42, s24, 7
    s_add_u32 s39, s39, s42
    s_add_u32 s39, s39, 0x1b20000
    v_cmp_eq_u32 vcc, 0, v3
    v_lshlrev_b32 v10, 3, v2
    v_mov_b32 v11, 0x3f803f80
    v_lshl_add_u32 v7, v3, 8, v10
    v_cndmask_b32 v10, v6, v10, vcc
    s_lshr_b32 s44, s23, 1
    s_lshl_b32 s52, s22, 7
    s_add_u32 s52, s52, s44
    s_lshl_b32 s52, s52, 8
    s_add_u32 s52, s52, 0x4508000
    s_add_u32 s52, s52, s4
    s_addc_u32 s53, s5, 0
    s_waitcnt vmcnt(3)
    s_barrier
    s_cmp_lg_u32 s20, 0
    s_cbranch_scc1 L_ns_d2
    s_mov_b32 s56, 1
    s_atomic_add s56, s[50:51], 0
L_ns_d2:
    s_cmp_lg_u32 s20, 0
    s_cbranch_scc1 L_pd_d2
    s_mov_b32 s60, 65536
L_poll_d2:
    s_mov_b32 s57, 0
    s_atomic_add s57, s[52:53], 0 glc
    s_waitcnt lgkmcnt(0)
    s_cmp_ge_u32 s57, 16
    s_cbranch_scc1 L_pd_d2
    s_sub_u32 s60, s60, 1
    s_cbranch_scc1 L_pd_d2
    s_sleep 2
    s_branch L_poll_d2
L_pd_d2:
    s_barrier
    s_mov_b32 s32, 0
    s_lshl_b32 s32, s32, 13
    s_add_u32 s32, s32, s29
    s_add_u32 s33, s32, 4096
    buffer_load_dwordx4 v[112:115], v1, s[4:7], s32 offen offset:0 sc1
    buffer_load_dwordx4 v[116:119], v1, s[4:7], s32 offen offset:1024 sc1
    buffer_load_dwordx4 v[120:123], v1, s[4:7], s32 offen offset:2048 sc1
    buffer_load_dwordx4 v[124:127], v1, s[4:7], s32 offen offset:3072 sc1
    buffer_load_dwordx4 v[128:131], v1, s[4:7], s33 offen offset:0 sc1
    buffer_load_dwordx4 v[132:135], v1, s[4:7], s33 offen offset:1024 sc1
    buffer_load_dwordx4 v[136:139], v1, s[4:7], s33 offen offset:2048 sc1
    buffer_load_dwordx4 v[140:143], v1, s[4:7], s33 offen offset:3072 sc1
    ds_read_b128 v[40:43], v12 offset:18432
    ds_read_b128 v[44:47], v12 offset:19456
    ds_read_b128 v[48:51], v12 offset:20480
    ds_read_b128 v[52:55], v12 offset:21504
    ds_read_b128 v[72:75], v12 offset:26624
    ds_read_b128 v[56:59], v12 offset:22528
    ds_read_b128 v[60:63], v12 offset:23552
    ds_read_b128 v[64:67], v12 offset:24576
    ds_read_b128 v[68:71], v12 offset:25600
    s_add_u32 s45, s29, 8192
    s_add_u32 s46, s29, 12288
    s_add_u32 s47, s29, 16384
    buffer_load_dwordx4 v[144:147], v1, s[4:7], s45 offen offset:0 sc1
    buffer_load_dwordx4 v[148:151], v1, s[4:7], s45 offen offset:1024 sc1
    s_lshl_b32 s42, s23, 3
    s_add_u32 s42, s42, s24
    s_lshl_b32 s42, s42, 2
    s_add_u32 s42, s42, s20
    s_lshl_b32 s42, s42, 8
    s_add_u32 s42, s42, s21
    s_add_u32 s42, s42, 0x1b40000
    v_mov_b32 v220, -1.0
    v_lshrrev_b32 v221, 2, v1
    buffer_store_dword v220, v221, s[4:7], s42 offen sc1
    s_lshl_b32 s50, s22, 7
    s_add_u32 s50, s50, s44
    s_lshl_b32 s50, s50, 8
    s_add_u32 s50, s50, 0x4509000
    s_add_u32 s50, s50, s4
    s_addc_u32 s51, s5, 0
    s_waitcnt vmcnt(11)
    v_lshlrev_b32 v16, 16, v208
    v_and_b32 v17, 0xffff0000, v208
    v_lshlrev_b32 v18, 16, v209
    v_and_b32 v19, 0xffff0000, v209
    v_lshlrev_b32 v20, 16, v210
    v_and_b32 v21, 0xffff0000, v210
    v_lshlrev_b32 v22, 16, v211
    v_and_b32 v23, 0xffff0000, v211
    v_lshlrev_b32 v24, 16, v212
    v_and_b32 v25, 0xffff0000, v212
    v_lshlrev_b32 v26, 16, v213
    v_and_b32 v27, 0xffff0000, v213
    v_lshlrev_b32 v28, 16, v214
    v_and_b32 v29, 0xffff0000, v214
    v_lshlrev_b32 v30, 16, v215
    v_and_b32 v31, 0xffff0000, v215
    v_lshlrev_b32 v32, 16, v216
    v_and_b32 v33, 0xffff0000, v216
    v_lshlrev_b32 v34, 16, v217
    v_and_b32 v35, 0xffff0000, v217
    s_waitcnt vmcnt(9) lgkmcnt(4)
    v_mfma_f32_16x16x32_bf16 v[16:19], v[40:43], v[112:115], v[16:19]
    ds_read_b128 v[76:79], v12 offset:27648
    v_mfma_f32_16x16x32_bf16 v[20:23], v[44:47], v[112:115], v[20:23]
    ds_read_b128 v[80:83], v12 offset:28672
    buffer_load_dwordx4 v[152:155], v1, s[4:7], s45 offen offset:2048 sc1
    v_mfma_f32_16x16x32_bf16 v[24:27], v[48:51], v[112:115], v[24:27]
    ds_read_b128 v[84:87], v12 offset:29696
    v_mfma_f32_16x16x32_bf16 v[28:31], v[52:55], v[112:115], v[28:31]
    ds_read_b128 v[88:91], v12 offset:30720
    v_mfma_f32_16x16x32_bf16 v[32:35], v[72:75], v[112:115], v[32:35]
    ds_read_b128 v[108:111], v12 offset:35840
    s_waitcnt lgkmcnt(5)
    buffer_load_dwordx4 v[156:159], v1, s[4:7], s45 offen offset:3072 sc1
    v_mfma_f32_16x16x32_bf16 v[16:19], v[56:59], v[116:119], v[16:19]
    ds_read_b128 v[92:95], v12 offset:31744
    v_mfma_f32_16x16x32_bf16 v[20:23], v[60:63], v[116:119], v[20:23]
    ds_read_b128 v[96:99], v12 offset:32768
    v_mfma_f32_16x16x32_bf16 v[24:27], v[64:67], v[116:119], v[24:27]
    ds_read_b128 v[100:103], v12 offset:33792
    buffer_load_dwordx4 v[160:163], v1, s[4:7], s46 offen offset:0 sc1
    v_mfma_f32_16x16x32_bf16 v[28:31], v[68:71], v[116:119], v[28:31]
    ds_read_b128 v[104:107], v12 offset:34816
    v_mfma_f32_16x16x32_bf16 v[36:39], v[72:75], v[116:119], 0
    s_waitcnt vmcnt(10) lgkmcnt(4)
    v_mfma_f32_16x16x32_bf16 v[16:19], v[76:79], v[120:123], v[16:19]
    ds_read_b128 v[40:43], v13 offset:18432
    v_mfma_f32_16x16x32_bf16 v[20:23], v[80:83], v[120:123], v[20:23]
    ds_read_b128 v[44:47], v13 offset:19456
    buffer_load_dwordx4 v[164:167], v1, s[4:7], s46 offen offset:1024 sc1
    v_mfma_f32_16x16x32_bf16 v[24:27], v[84:87], v[120:123], v[24:27]
    ds_read_b128 v[48:51], v13 offset:20480
    v_mfma_f32_16x16x32_bf16 v[28:31], v[88:91], v[120:123], v[28:31]
    ds_read_b128 v[52:55], v13 offset:21504
    v_mfma_f32_16x16x32_bf16 v[32:35], v[108:111], v[120:123], v[32:35]
    ds_read_b128 v[72:75], v13 offset:26624
    s_waitcnt lgkmcnt(5)
    buffer_load_dwordx4 v[168:171], v1, s[4:7], s46 offen offset:2048 sc1
    v_mfma_f32_16x16x32_bf16 v[16:19], v[92:95], v[124:127], v[16:19]
    ds_read_b128 v[56:59], v13 offset:22528
    v_mfma_f32_16x16x32_bf16 v[20:23], v[96:99], v[124:127], v[20:23]
    ds_read_b128 v[60:63], v13 offset:23552
    v_mfma_f32_16x16x32_bf16 v[24:27], v[100:103], v[124:127], v[24:27]
    ds_read_b128 v[64:67], v13 offset:24576
    buffer_load_dwordx4 v[172:175], v1, s[4:7], s46 offen offset:3072 sc1
    v_mfma_f32_16x16x32_bf16 v[28:31], v[104:107], v[124:127], v[28:31]
    ds_read_b128 v[68:71], v13 offset:25600
    v_mfma_f32_16x16x32_bf16 v[36:39], v[108:111], v[124:127], v[36:39]
    s_waitcnt vmcnt(11) lgkmcnt(4)
    v_mfma_f32_16x16x32_bf16 v[16:19], v[40:43], v[128:131], v[16:19]
    ds_read_b128 v[76:79], v13 offset:27648
    v_mfma_f32_16x16x32_bf16 v[20:23], v[44:47], v[128:131], v[20:23]
    ds_read_b128 v[80:83], v13 offset:28672
    buffer_load_dwordx2 v[176:177], v7, s[4:7], s47 offen offset:0 sc1
    v_mfma_f32_16x16x32_bf16 v[24:27], v[48:51], v[128:131], v[24:27]
    ds_read_b128 v[84:87], v13 offset:29696
    v_mfma_f32_16x16x32_bf16 v[28:31], v[52:55], v[128:131], v[28:31]
    ds_read_b128 v[88:91], v13 offset:30720
    v_mfma_f32_16x16x32_bf16 v[32:35], v[72:75], v[128:131], v[32:35]
    ds_read_b128 v[108:111], v13 offset:35840
    s_waitcnt lgkmcnt(5)
    buffer_load_dwordx2 v[178:179], v7, s[4:7], s47 offen offset:128 sc1
    v_mfma_f32_16x16x32_bf16 v[16:19], v[56:59], v[132:135], v[16:19]
    ds_read_b128 v[92:95], v13 offset:31744
    v_mfma_f32_16x16x32_bf16 v[20:23], v[60:63], v[132:135], v[20:23]
    ds_read_b128 v[96:99], v13 offset:32768
    v_mfma_f32_16x16x32_bf16 v[24:27], v[64:67], v[132:135], v[24:27]
    ds_read_b128 v[100:103], v13 offset:33792
    buffer_load_dwordx2 v[180:181], v7, s[4:7], s47 offen offset:1024 sc1
    v_mfma_f32_16x16x32_bf16 v[28:31], v[68:71], v[132:135], v[28:31]
    ds_read_b128 v[104:107], v13 offset:34816
    v_mfma_f32_16x16x32_bf16 v[36:39], v[72:75], v[132:135], v[36:39]
    s_waitcnt vmcnt(12) lgkmcnt(4)
    v_mfma_f32_16x16x32_bf16 v[16:19], v[76:79], v[136:139], v[16:19]
    ds_read_b128 v[40:43], v14 offset:18432
    v_mfma_f32_16x16x32_bf16 v[20:23], v[80:83], v[136:139], v[20:23]
    ds_read_b128 v[44:47], v14 offset:19456
    buffer_load_dwordx2 v[182:183], v7, s[4:7], s47 offen offset:1152 sc1
    v_mfma_f32_16x16x32_bf16 v[24:27], v[84:87], v[136:139], v[24:27]
    ds_read_b128 v[48:51], v14 offset:20480
    v_mfma_f32_16x16x32_bf16 v[28:31], v[88:91], v[136:139], v[28:31]
    ds_read_b128 v[52:55], v14 offset:21504
    v_mfma_f32_16x16x32_bf16 v[32:35], v[108:111], v[136:139], v[32:35]
    ds_read_b128 v[72:75], v14 offset:26624
    s_waitcnt lgkmcnt(5)
    v_mfma_f32_16x16x32_bf16 v[16:19], v[92:95], v[140:143], v[16:19]
    ds_read_b128 v[56:59], v14 offset:22528
    v_mfma_f32_16x16x32_bf16 v[20:23], v[96:99], v[140:143], v[20:23]
    ds_read_b128 v[60:63], v14 offset:23552
    v_mfma_f32_16x16x32_bf16 v[24:27], v[100:103], v[140:143], v[24:27]
    ds_read_b128 v[64:67], v14 offset:24576
    v_mfma_f32_16x16x32_bf16 v[28:31], v[104:107], v[140:143], v[28:31]
    ds_read_b128 v[68:71], v14 offset:25600
    v_mfma_f32_16x16x32_bf16 v[36:39], v[108:111], v[140:143], v[36:39]
    s_waitcnt vmcnt(11) lgkmcnt(4)
    v_mfma_f32_16x16x32_bf16 v[16:19], v[40:43], v[144:147], v[16:19]
    ds_read_b128 v[76:79], v14 offset:27648
    v_mfma_f32_16x16x32_bf16 v[20:23], v[44:47], v[144:147], v[20:23]
    ds_read_b128 v[80:83], v14 offset:28672
    v_mfma_f32_16x16x32_bf16 v[24:27], v[48:51], v[144:147], v[24:27]
    ds_read_b128 v[84:87], v14 offset:29696
    v_mfma_f32_16x16x32_bf16 v[28:31], v[52:55], v[144:147], v[28:31]
    ds_read_b128 v[88:91], v14 offset:30720
    v_mfma_f32_16x16x32_bf16 v[32:35], v[72:75], v[144:147], v[32:35]
    ds_read_b128 v[108:111], v14 offset:35840
    s_waitcnt lgkmcnt(5)
    v_mfma_f32_16x16x32_bf16 v[16:19], v[56:59], v[148:151], v[16:19]
    ds_read_b128 v[92:95], v14 offset:31744
    v_mfma_f32_16x16x32_bf16 v[20:23], v[60:63], v[148:151], v[20:23]
    ds_read_b128 v[96:99], v14 offset:32768
    v_mfma_f32_16x16x32_bf16 v[24:27], v[64:67], v[148:151], v[24:27]
    ds_read_b128 v[100:103], v14 offset:33792
    v_mfma_f32_16x16x32_bf16 v[28:31], v[68:71], v[148:151], v[28:31]
    ds_read_b128 v[104:107], v14 offset:34816
    v_mfma_f32_16x16x32_bf16 v[36:39], v[72:75], v[148:151], v[36:39]
    s_waitcnt vmcnt(8) lgkmcnt(4)
    v_mfma_f32_16x16x32_bf16 v[16:19], v[76:79], v[152:155], v[16:19]
    ds_read_b128 v[40:43], v15 offset:18432
    v_mfma_f32_16x16x32_bf16 v[20:23], v[80:83], v[152:155], v[20:23]
    ds_read_b128 v[44:47], v15 offset:19456
    v_mfma_f32_16x16x32_bf16 v[24:27], v[84:87], v[152:155], v[24:27]
    ds_read_b128 v[48:51], v15 offset:20480
    v_mfma_f32_16x16x32_bf16 v[28:31], v[88:91], v[152:155], v[28:31]
    ds_read_b128 v[52:55], v15 offset:21504
    v_mfma_f32_16x16x32_bf16 v[32:35], v[108:111], v[152:155], v[32:35]
    ds_read_b128 v[72:75], v15 offset:26624
    s_waitcnt lgkmcnt(5)
    v_mfma_f32_16x16x32_bf16 v[16:19], v[92:95], v[156:159], v[16:19]
    ds_read_b128 v[56:59], v15 offset:22528
    v_mfma_f32_16x16x32_bf16 v[20:23], v[96:99], v[156:159], v[20:23]
    ds_read_b128 v[60:63], v15 offset:23552
    v_mfma_f32_16x16x32_bf16 v[24:27], v[100:103], v[156:159], v[24:27]
    ds_read_b128 v[64:67], v15 offset:24576
    v_mfma_f32_16x16x32_bf16 v[28:31], v[104:107], v[156:159], v[28:31]
    ds_read_b128 v[68:71], v15 offset:25600
    v_mfma_f32_16x16x32_bf16 v[36:39], v[108:111], v[156:159], v[36:39]
    s_waitcnt vmcnt(6) lgkmcnt(4)
    v_mfma_f32_16x16x32_bf16 v[16:19], v[40:43], v[160:163], v[16:19]
    ds_read_b128 v[76:79], v15 offset:27648
    v_mfma_f32_16x16x32_bf16 v[20:23], v[44:47], v[160:163], v[20:23]
    ds_read_b128 v[80:83], v15 offset:28672
    v_mfma_f32_16x16x32_bf16 v[24:27], v[48:51], v[160:163], v[24:27]
    ds_read_b128 v[84:87], v15 offset:29696
    v_mfma_f32_16x16x32_bf16 v[28:31], v[52:55], v[160:163], v[28:31]
    ds_read_b128 v[88:91], v15 offset:30720
    v_mfma_f32_16x16x32_bf16 v[32:35], v[72:75], v[160:163], v[32:35]
    ds_read_b128 v[108:111], v15 offset:35840
    s_waitcnt lgkmcnt(5)
    v_mfma_f32_16x16x32_bf16 v[16:19], v[56:59], v[164:167], v[16:19]
    ds_read_b128 v[92:95], v15 offset:31744
    v_mfma_f32_16x16x32_bf16 v[20:23], v[60:63], v[164:167], v[20:23]
    ds_read_b128 v[96:99], v15 offset:32768
    v_mfma_f32_16x16x32_bf16 v[24:27], v[64:67], v[164:167], v[24:27]
    ds_read_b128 v[100:103], v15 offset:33792
    v_mfma_f32_16x16x32_bf16 v[28:31], v[68:71], v[164:167], v[28:31]
    ds_read_b128 v[104:107], v15 offset:34816
    v_mfma_f32_16x16x32_bf16 v[36:39], v[72:75], v[164:167], v[36:39]
    s_waitcnt vmcnt(4) lgkmcnt(4)
    v_mfma_f32_16x16x32_bf16 v[16:19], v[76:79], v[168:171], v[16:19]
    ds_read_b128 v[40:43], v15 offset:36864
    v_mfma_f32_16x16x32_bf16 v[20:23], v[80:83], v[168:171], v[20:23]
    ds_read_b128 v[44:47], v15 offset:37888
    v_mfma_f32_16x16x32_bf16 v[24:27], v[84:87], v[168:171], v[24:27]
    ds_read_b128 v[48:51], v15 offset:38912
    v_mfma_f32_16x16x32_bf16 v[28:31], v[88:91], v[168:171], v[28:31]
    ds_read_b128 v[52:55], v15 offset:39936
    v_mfma_f32_16x16x32_bf16 v[32:35], v[108:111], v[168:171], v[32:35]
    ds_read_b128 v[72:75], v15 offset:45056
    s_waitcnt lgkmcnt(5)
    v_mfma_f32_16x16x32_bf16 v[16:19], v[92:95], v[172:175], v[16:19]
    ds_read_b128 v[56:59], v15 offset:40960
    v_mfma_f32_16x16x32_bf16 v[20:23], v[96:99], v[172:175], v[20:23]
    ds_read_b128 v[60:63], v15 offset:41984
    v_mfma_f32_16x16x32_bf16 v[24:27], v[100:103], v[172:175], v[24:27]
    ds_read_b128 v[64:67], v15 offset:43008
    v_mfma_f32_16x16x32_bf16 v[28:31], v[104:107], v[172:175], v[28:31]
    ds_read_b128 v[68:71], v15 offset:44032
    v_mfma_f32_16x16x32_bf16 v[36:39], v[108:111], v[172:175], v[36:39]
    s_waitcnt vmcnt(0) lgkmcnt(4)
    v_mfma_f32_16x16x32_bf16 v[16:19], v[40:43], v[176:179], v[16:19]
    v_mfma_f32_16x16x32_bf16 v[20:23], v[44:47], v[176:179], v[20:23]
    v_mfma_f32_16x16x32_bf16 v[24:27], v[48:51], v[176:179], v[24:27]
    v_mfma_f32_16x16x32_bf16 v[28:31], v[52:55], v[176:179], v[28:31]
    v_mfma_f32_16x16x32_bf16 v[32:35], v[72:75], v[176:179], v[32:35]
    s_waitcnt lgkmcnt(0)
    v_mfma_f32_16x16x32_bf16 v[16:19], v[56:59], v[180:183], v[16:19]
    v_mfma_f32_16x16x32_bf16 v[20:23], v[60:63], v[180:183], v[20:23]
    v_mfma_f32_16x16x32_bf16 v[24:27], v[64:67], v[180:183], v[24:27]
    v_mfma_f32_16x16x32_bf16 v[28:31], v[68:71], v[180:183], v[28:31]
    v_mfma_f32_16x16x32_bf16 v[36:39], v[72:75], v[180:183], v[36:39]
    s_nop 3
    v_cvt_pk_bf16_f32 v208, v16, v17
    v_cvt_pk_bf16_f32 v209, v18, v19
    v_cvt_pk_bf16_f32 v210, v20, v21
    v_cvt_pk_bf16_f32 v211, v22, v23
    v_cvt_pk_bf16_f32 v212, v24, v25
    v_cvt_pk_bf16_f32 v213, v26, v27
    v_cvt_pk_bf16_f32 v214, v28, v29
    v_cvt_pk_bf16_f32 v215, v30, v31
    buffer_store_dwordx4 v[208:211], v4, s[4:7], s34 offen offset:0 sc1
    buffer_store_dwordx4 v[212:215], v4, s[4:7], s34 offen offset:1024 sc1
    v_permlane32_swap_b32 v36, v220
    v_permlane32_swap_b32 v37, v221
    v_permlane32_swap_b32 v38, v222
    v_permlane32_swap_b32 v39, v223
    v_pk_add_f32 v[32:33], v[32:33], v[220:221]
    v_pk_add_f32 v[34:35], v[34:35], v[222:223]
    v_cvt_pk_bf16_f32 v216, v32, v33
    v_cvt_pk_bf16_f32 v217, v34, v35
    buffer_store_dwordx2 v[216:217], v5, s[4:7], s34 offen sc1
    v_cndmask_b32 v222, 0, v216, s[40:41]
    v_cndmask_b32 v223, 0, v217, s[40:41]
    v_dot2_f32_bf16 v220, v208, v11, 0
    v_dot2_f32_bf16 v221, v208, v208, 0
    v_dot2_f32_bf16 v224, v209, v11, 0
    v_dot2_f32_bf16 v225, v209, v209, 0
    v_dot2_f32_bf16 v220, v210, v11, v220
    v_dot2_f32_bf16 v221, v210, v210, v221
    v_dot2_f32_bf16 v224, v211, v11, v224
    v_dot2_f32_bf16 v225, v211, v211, v225
    v_dot2_f32_bf16 v220, v212, v11, v220
    v_dot2_f32_bf16 v221, v212, v212, v221
    v_dot2_f32_bf16 v224, v213, v11, v224
    v_dot2_f32_bf16 v225, v213, v213, v225
    v_dot2_f32_bf16 v220, v214, v11, v220
    v_dot2_f32_bf16 v221, v214, v214, v221
    v_dot2_f32_bf16 v224, v215, v11, v224
    v_dot2_f32_bf16 v225, v215, v215, v225
    v_dot2_f32_bf16 v220, v222, v11, v220
    v_dot2_f32_bf16 v221, v222, v222, v221
    v_dot2_f32_bf16 v224, v223, v11, v224
    v_dot2_f32_bf16 v225, v223, v223, v225
    s_nop 2
    v_pk_add_f32 v[220:221], v[220:221], v[224:225]
    v_mov_b32 v222, v220
    v_mov_b32 v223, v221
    s_nop 1
    v_permlane32_swap_b32 v220, v222
    v_permlane32_swap_b32 v221, v223
    v_add_f32 v220, v220, v222
    v_add_f32 v221, v221, v223
    v_mov_b32 v222, v220
    v_mov_b32 v223, v221
    s_nop 1
    v_permlane16_swap_b32 v220, v222
    v_permlane16_swap_b32 v221, v223
    v_add_f32 v220, v220, v222
    v_add_f32 v221, v221, v223
    buffer_store_dwordx2 v[220:221], v10, s[4:7], s39 offen sc1
    s_and_b32 s25, s2, 7
    s_lshr_b32 s26, s2, 3
    s_and_b32 s23, s25, 1
    s_lshl_b32 s23, s23, 3
    s_and_b32 s27, s26, 7
    s_add_u32 s23, s23, s27
    s_lshr_b32 s24, s25, 1
    s_lshl_b32 s24, s24, 2
    s_lshr_b32 s27, s26, 3
    s_add_u32 s24, s24, s27
    s_add_u32 s28, s23, s24
    s_and_b32 s28, s28, 3
    s_lshl_b32 s30, s20, 12
    s_lshl_b32 s31, s23, 3
    s_lshl_b32 s33, s20, 1
    s_add_u32 s31, s31, s33
    s_lshl_b32 s32, s31, 10
    s_add_u32 s32, s32, s21
    s_add_u32 s32, s32, 0x1b20000
    v_add_u32 v2, 73728, v1
    s_add_u32 s33, s30, 18432
    v_add_u32 v3, s33, v1
    v_add_u32 v0, s33, v2
    s_lshr_b32 s34, s31, 1
    s_lshl_b32 s35, s34, 12
    s_add_u32 s35, s35, s21
    s_add_u32 s35, s35, 0x1b40000
    s_lshl_b32 s36, s24, 8
    s_add_u32 s36, s36, s35
    s_lshl_b32 s38, s24, 6
    s_add_u32 s38, s38, s34
    s_mul_i32 s38, s38, 9216
    s_add_u32 s38, s38, s21
    s_add_u32 s38, s38, 0x900000
    s_add_u32 s39, s38, 4096
    s_add_u32 s46, s38, 8192
    s_mov_b32 s40, 0xc0135761
    s_mov_b32 s42, 0x3d372713
    s_mov_b32 s44, 0x39e38e39
    s_mov_b32 s45, 0x3727c5ac
    v_lshrrev_b32 v4, 1, v1
    s_lshl_b32 s52, s22, 7
    s_add_u32 s52, s52, s23
    s_lshl_b32 s52, s52, 8
    s_add_u32 s52, s52, 0x4509000
    s_add_u32 s52, s52, s4
    s_addc_u32 s53, s5, 0
    s_waitcnt vmcnt(0)
    s_barrier
    s_cmp_lg_u32 s20, 0
    s_cbranch_scc1 L_ns_d3
    s_mov_b32 s56, 1
    s_atomic_add s56, s[50:51], 0
L_ns_d3:
    s_cmp_lg_u32 s20, 0
    s_cbranch_scc1 L_pd_d3
    s_mov_b32 s60, 65536
L_poll_d3:
    s_mov_b32 s57, 0
    s_atomic_add s57, s[52:53], 0 glc
    s_waitcnt lgkmcnt(0)
    s_cmp_ge_u32 s57, 16
    s_cbranch_scc1 L_pd_d3
    s_sub_u32 s60, s60, 1
    s_cbranch_scc1 L_pd_d3
    s_sleep 2
    s_branch L_poll_d3
L_pd_d3:
    s_barrier
    buffer_load_dwordx2 v[8:9], v4, s[4:7], s32 offen offset:0 sc1
    buffer_load_dwordx2 v[10:11], v4, s[4:7], s32 offen offset:512 sc1
    buffer_load_dwordx2 v[12:13], v4, s[4:7], s32 offen offset:1024 sc1
    buffer_load_dwordx2 v[14:15], v4, s[4:7], s32 offen offset:1536 sc1
    s_lshl_b32 s50, s22, 7
    s_add_u32 s50, s50, s23
    s_lshl_b32 s50, s50, 8
    s_add_u32 s50, s50, 0x450a000
    s_add_u32 s50, s50, s4
    s_addc_u32 s51, s5, 0
    s_barrier
    ds_read_b128 v[160:163], v3 offset:0
    ds_read_b128 v[164:167], v3 offset:2048
    ds_read_b128 v[168:171], v1 offset:0
    ds_read_b128 v[172:175], v1 offset:1024
    ds_read_b128 v[176:179], v1 offset:2048
    ds_read_b128 v[180:183], v1 offset:3072
    ds_read_b128 v[184:187], v1 offset:4096
    ds_read_b128 v[188:191], v1 offset:5120
    ds_read_b128 v[192:195], v1 offset:6144
    ds_read_b128 v[196:199], v1 offset:7168
    ds_read_b128 v[200:203], v1 offset:8192
    s_waitcnt lgkmcnt(5)
    v_mfma_f32_16x16x32_bf16 v[16:19], v[160:163], v[168:171], 0
    ds_read_b128 v[204:207], v3 offset:1024
    v_mfma_f32_16x16x32_bf16 v[20:23], v[164:167], v[168:171], 0
    ds_read_b128 v[208:211], v3 offset:3072
    v_mfma_f32_16x16x32_bf16 v[24:27], v[160:163], v[172:175], 0
    ds_read_b128 v[212:215], v1 offset:9216
    v_mfma_f32_16x16x32_bf16 v[28:31], v[164:167], v[172:175], 0
    ds_read_b128 v[216:219], v1 offset:10240
    v_mfma_f32_16x16x32_bf16 v[32:35], v[160:163], v[176:179], 0
    ds_read_b128 v[220:223], v1 offset:11264
    v_mfma_f32_16x16x32_bf16 v[36:39], v[164:167], v[176:179], 0
    ds_read_b128 v[224:227], v1 offset:12288
    v_mfma_f32_16x16x32_bf16 v[40:43], v[160:163], v[180:183], 0
    ds_read_b128 v[228:231], v1 offset:13312
    v_mfma_f32_16x16x32_bf16 v[44:47], v[164:167], v[180:183], 0
    ds_read_b128 v[232:235], v1 offset:14336
    s_waitcnt lgkmcnt(8)
    v_mfma_f32_16x16x32_bf16 v[48:51], v[160:163], v[184:187], 0
    ds_read_b128 v[236:239], v1 offset:15360
    v_mfma_f32_16x16x32_bf16 v[52:55], v[164:167], v[184:187], 0
    ds_read_b128 v[240:243], v1 offset:16384
    v_mfma_f32_16x16x32_bf16 v[56:59], v[160:163], v[188:191], 0
    ds_read_b128 v[244:247], v1 offset:17408
    v_mfma_f32_16x16x32_bf16 v[60:63], v[164:167], v[188:191], 0
    v_mfma_f32_16x16x32_bf16 v[64:67], v[160:163], v[192:195], 0
    v_mfma_f32_16x16x32_bf16 v[68:71], v[164:167], v[192:195], 0
    v_mfma_f32_16x16x32_bf16 v[72:75], v[160:163], v[196:199], 0
    v_mfma_f32_16x16x32_bf16 v[76:79], v[164:167], v[196:199], 0
    v_mfma_f32_16x16x32_bf16 v[80:83], v[160:163], v[200:203], 0
    v_mfma_f32_16x16x32_bf16 v[84:87], v[164:167], v[200:203], 0
    s_waitcnt lgkmcnt(0)
    s_barrier
    v_mfma_f32_16x16x32_bf16 v[16:19], v[204:207], v[212:215], v[16:19]
    ds_read_b128 v[160:163], v3 offset:36864
    v_mfma_f32_16x16x32_bf16 v[20:23], v[208:211], v[212:215], v[20:23]
    ds_read_b128 v[164:167], v3 offset:38912
    v_mfma_f32_16x16x32_bf16 v[24:27], v[204:207], v[216:219], v[24:27]
    ds_read_b128 v[168:171], v1 offset:36864
    v_mfma_f32_16x16x32_bf16 v[28:31], v[208:211], v[216:219], v[28:31]
    ds_read_b128 v[172:175], v1 offset:37888
    v_mfma_f32_16x16x32_bf16 v[32:35], v[204:207], v[220:223], v[32:35]
    ds_read_b128 v[176:179], v1 offset:38912
    v_mfma_f32_16x16x32_bf16 v[36:39], v[208:211], v[220:223], v[36:39]
    ds_read_b128 v[180:183], v1 offset:39936
    v_mfma_f32_16x16x32_bf16 v[40:43], v[204:207], v[224:227], v[40:43]
    ds_read_b128 v[184:187], v1 offset:40960
    v_mfma_f32_16x16x32_bf16 v[44:47], v[208:211], v[224:227], v[44:47]
    ds_read_b128 v[188:191], v1 offset:41984
    v_mfma_f32_16x16x32_bf16 v[48:51], v[204:207], v[228:231], v[48:51]
    ds_read_b128 v[192:195], v1 offset:43008
    v_mfma_f32_16x16x32_bf16 v[52:55], v[208:211], v[228:231], v[52:55]
    ds_read_b128 v[196:199], v1 offset:44032
    v_lshrrev_b32 v5, 8, v1
    v_mfma_f32_16x16x32_bf16 v[56:59], v[204:207], v[232:235], v[56:59]
    ds_read_b128 v[200:203], v1 offset:45056
    v_bfe_u32 v6, v1, 4, 4
    v_mfma_f32_16x16x32_bf16 v[60:63], v[208:211], v[232:235], v[60:63]
    v_lshlrev_b32 v7, 2, v6
    v_mfma_f32_16x16x32_bf16 v[64:67], v[204:207], v[236:239], v[64:67]
    s_lshl_b32 s33, s20, 8
    v_mfma_f32_16x16x32_bf16 v[68:71], v[208:211], v[236:239], v[68:71]
    s_add_u32 s33, s33, 147456
    v_mfma_f32_16x16x32_bf16 v[72:75], v[204:207], v[240:243], v[72:75]
    v_add_u32 v4, s33, v7
    v_mfma_f32_16x16x32_bf16 v[76:79], v[208:211], v[240:243], v[76:79]
    v_lshl_add_u32 v252, v5, 4, s33
    v_mfma_f32_16x16x32_bf16 v[80:83], v[204:207], v[244:247], v[80:83]
    v_add_u32 v7, 159744, v7
    v_mfma_f32_16x16x32_bf16 v[84:87], v[208:211], v[244:247], v[84:87]
    s_waitcnt vmcnt(0)
    v_add_f32 v248, v8, v10
    s_waitcnt lgkmcnt(5)
    v_mfma_f32_16x16x32_bf16 v[16:19], v[160:163], v[168:171], v[16:19]
    ds_read_b128 v[204:207], v3 offset:37888
    v_mfma_f32_16x16x32_bf16 v[20:23], v[164:167], v[168:171], v[20:23]
    ds_read_b128 v[208:211], v3 offset:39936
    v_mfma_f32_16x16x32_bf16 v[24:27], v[160:163], v[172:175], v[24:27]
    ds_read_b128 v[212:215], v1 offset:46080
    v_mfma_f32_16x16x32_bf16 v[28:31], v[164:167], v[172:175], v[28:31]
    ds_read_b128 v[216:219], v1 offset:47104
    v_mfma_f32_16x16x32_bf16 v[32:35], v[160:163], v[176:179], v[32:35]
    ds_read_b128 v[220:223], v1 offset:48128
    v_mfma_f32_16x16x32_bf16 v[36:39], v[164:167], v[176:179], v[36:39]
    ds_read_b128 v[224:227], v1 offset:49152
    v_mfma_f32_16x16x32_bf16 v[40:43], v[160:163], v[180:183], v[40:43]
    ds_read_b128 v[228:231], v1 offset:50176
    v_mfma_f32_16x16x32_bf16 v[44:47], v[164:167], v[180:183], v[44:47]
    ds_read_b128 v[232:235], v1 offset:51200
    s_waitcnt lgkmcnt(8)
    v_mfma_f32_16x16x32_bf16 v[48:51], v[160:163], v[184:187], v[48:51]
    ds_read_b128 v[236:239], v1 offset:52224
    v_mfma_f32_16x16x32_bf16 v[52:55], v[164:167], v[184:187], v[52:55]
    ds_read_b128 v[240:243], v1 offset:53248
    v_add_f32 v249, v9, v11
    v_mfma_f32_16x16x32_bf16 v[56:59], v[160:163], v[188:191], v[56:59]
    ds_read_b128 v[244:247], v1 offset:54272
    v_add_f32 v250, v12, v14
    v_mfma_f32_16x16x32_bf16 v[60:63], v[164:167], v[188:191], v[60:63]
    v_add_f32 v251, v13, v15
    v_mfma_f32_16x16x32_bf16 v[64:67], v[160:163], v[192:195], v[64:67]
    v_mov_b32 v8, v248
    v_mfma_f32_16x16x32_bf16 v[68:71], v[164:167], v[192:195], v[68:71]
    v_mov_b32 v9, v249
    v_mfma_f32_16x16x32_bf16 v[72:75], v[160:163], v[196:199], v[72:75]
    v_mov_b32 v12, v250
    v_mfma_f32_16x16x32_bf16 v[76:79], v[164:167], v[196:199], v[76:79]
    v_mov_b32 v13, v251
    v_mfma_f32_16x16x32_bf16 v[80:83], v[160:163], v[200:203], v[80:83]
    v_permlane32_swap_b32 v248, v8
    v_mfma_f32_16x16x32_bf16 v[84:87], v[164:167], v[200:203], v[84:87]
    v_permlane32_swap_b32 v249, v9
    v_permlane32_swap_b32 v250, v12
    s_waitcnt lgkmcnt(0)
    s_barrier
    v_mfma_f32_16x16x32_bf16 v[16:19], v[204:207], v[212:215], v[16:19]
    ds_read_b128 v[160:163], v0 offset:0
    v_mfma_f32_16x16x32_bf16 v[20:23], v[208:211], v[212:215], v[20:23]
    ds_read_b128 v[164:167], v0 offset:2048
    v_mfma_f32_16x16x32_bf16 v[24:27], v[204:207], v[216:219], v[24:27]
    ds_read_b128 v[168:171], v2 offset:0
    v_mfma_f32_16x16x32_bf16 v[28:31], v[208:211], v[216:219], v[28:31]
    ds_read_b128 v[172:175], v2 offset:1024
    v_mfma_f32_16x16x32_bf16 v[32:35], v[204:207], v[220:223], v[32:35]
    ds_read_b128 v[176:179], v2 offset:2048
    v_mfma_f32_16x16x32_bf16 v[36:39], v[208:211], v[220:223], v[36:39]
    ds_read_b128 v[180:183], v2 offset:3072
    v_mfma_f32_16x16x32_bf16 v[40:43], v[204:207], v[224:227], v[40:43]
    ds_read_b128 v[184:187], v2 offset:4096
    v_mfma_f32_16x16x32_bf16 v[44:47], v[208:211], v[224:227], v[44:47]
    ds_read_b128 v[188:191], v2 offset:5120
    v_mfma_f32_16x16x32_bf16 v[48:51], v[204:207], v[228:231], v[48:51]
    ds_read_b128 v[192:195], v2 offset:6144
    v_mfma_f32_16x16x32_bf16 v[52:55], v[208:211], v[228:231], v[52:55]
    ds_read_b128 v[196:199], v2 offset:7168
    v_permlane32_swap_b32 v251, v13
    v_mfma_f32_16x16x32_bf16 v[56:59], v[204:207], v[232:235], v[56:59]
    ds_read_b128 v[200:203], v2 offset:8192
    v_add_f32 v248, v248, v8
    v_mfma_f32_16x16x32_bf16 v[60:63], v[208:211], v[232:235], v[60:63]
    ds_read2_b32 v[128:129], v7 offset0:0 offset1:16
    v_add_f32 v249, v249, v9
    v_mfma_f32_16x16x32_bf16 v[64:67], v[204:207], v[236:239], v[64:67]
    ds_read2_b32 v[130:131], v7 offset0:32 offset1:48
    v_add_f32 v250, v250, v12
    v_mfma_f32_16x16x32_bf16 v[68:71], v[208:211], v[236:239], v[68:71]
    ds_read2_b32 v[132:133], v7 offset0:64 offset1:80
    v_add_f32 v251, v251, v13
    v_mfma_f32_16x16x32_bf16 v[72:75], v[204:207], v[240:243], v[72:75]
    ds_read2_b32 v[134:135], v7 offset0:96 offset1:112
    v_mov_b32 v8, v248
    v_mfma_f32_16x16x32_bf16 v[76:79], v[208:211], v[240:243], v[76:79]
    ds_read2_b32 v[136:137], v7 offset0:128 offset1:144
    v_mov_b32 v9, v249
    v_mfma_f32_16x16x32_bf16 v[80:83], v[204:207], v[244:247], v[80:83]
    v_mov_b32 v12, v250
    v_mfma_f32_16x16x32_bf16 v[84:87], v[208:211], v[244:247], v[84:87]
    v_mov_b32 v13, v251
    v_permlane16_swap_b32 v248, v8
    s_waitcnt lgkmcnt(10)
    v_mfma_f32_16x16x32_bf16 v[16:19], v[160:163], v[168:171], v[16:19]
    ds_read_b128 v[204:207], v0 offset:1024
    v_mfma_f32_16x16x32_bf16 v[20:23], v[164:167], v[168:171], v[20:23]
    ds_read_b128 v[208:211], v0 offset:3072
    v_mfma_f32_16x16x32_bf16 v[24:27], v[160:163], v[172:175], v[24:27]
    ds_read_b128 v[212:215], v2 offset:9216
    v_mfma_f32_16x16x32_bf16 v[28:31], v[164:167], v[172:175], v[28:31]
    ds_read_b128 v[216:219], v2 offset:10240
    v_mfma_f32_16x16x32_bf16 v[32:35], v[160:163], v[176:179], v[32:35]
    ds_read_b128 v[220:223], v2 offset:11264
    v_mfma_f32_16x16x32_bf16 v[36:39], v[164:167], v[176:179], v[36:39]
    ds_read_b128 v[224:227], v2 offset:12288
    v_mfma_f32_16x16x32_bf16 v[40:43], v[160:163], v[180:183], v[40:43]
    ds_read_b128 v[228:231], v2 offset:13312
    v_mfma_f32_16x16x32_bf16 v[44:47], v[164:167], v[180:183], v[44:47]
    ds_read_b128 v[232:235], v2 offset:14336
    s_waitcnt lgkmcnt(8)
    v_mfma_f32_16x16x32_bf16 v[48:51], v[160:163], v[184:187], v[48:51]
    ds_read_b128 v[236:239], v2 offset:15360
    v_mfma_f32_16x16x32_bf16 v[52:55], v[164:167], v[184:187], v[52:55]
    ds_read_b128 v[240:243], v2 offset:16384
    v_permlane16_swap_b32 v249, v9
    v_mfma_f32_16x16x32_bf16 v[56:59], v[160:163], v[188:191], v[56:59]
    ds_read_b128 v[244:247], v2 offset:17408
    v_permlane16_swap_b32 v250, v12
    v_mfma_f32_16x16x32_bf16 v[60:63], v[164:167], v[188:191], v[60:63]
    v_permlane16_swap_b32 v251, v13
    v_mfma_f32_16x16x32_bf16 v[64:67], v[160:163], v[192:195], v[64:67]
    v_add_f32 v248, v248, v8
    v_mfma_f32_16x16x32_bf16 v[68:71], v[164:167], v[192:195], v[68:71]
    v_add_f32 v249, v249, v9
    v_mfma_f32_16x16x32_bf16 v[72:75], v[160:163], v[196:199], v[72:75]
    v_add_f32 v250, v250, v12
    v_mfma_f32_16x16x32_bf16 v[76:79], v[164:167], v[196:199], v[76:79]
    v_add_f32 v251, v251, v13
    v_mfma_f32_16x16x32_bf16 v[80:83], v[160:163], v[200:203], v[80:83]
    v_mul_f32 v248, 0x3ae38e39, v248
    v_mfma_f32_16x16x32_bf16 v[84:87], v[164:167], v[200:203], v[84:87]
    v_mul_f32 v249, 0x3ae38e39, v249
    v_mul_f32 v250, 0x3ae38e39, v250
    s_waitcnt lgkmcnt(0)
    s_barrier
    v_mfma_f32_16x16x32_bf16 v[16:19], v[204:207], v[212:215], v[16:19]
    ds_read_b128 v[160:163], v0 offset:36864
    v_mfma_f32_16x16x32_bf16 v[20:23], v[208:211], v[212:215], v[20:23]
    ds_read_b128 v[164:167], v0 offset:38912
    v_mfma_f32_16x16x32_bf16 v[24:27], v[204:207], v[216:219], v[24:27]
    ds_read_b128 v[168:171], v2 offset:36864
    v_mfma_f32_16x16x32_bf16 v[28:31], v[208:211], v[216:219], v[28:31]
    ds_read_b128 v[172:175], v2 offset:37888
    v_mfma_f32_16x16x32_bf16 v[32:35], v[204:207], v[220:223], v[32:35]
    ds_read_b128 v[176:179], v2 offset:38912
    v_mfma_f32_16x16x32_bf16 v[36:39], v[208:211], v[220:223], v[36:39]
    ds_read_b128 v[180:183], v2 offset:39936
    v_mfma_f32_16x16x32_bf16 v[40:43], v[204:207], v[224:227], v[40:43]
    ds_read_b128 v[184:187], v2 offset:40960
    v_mfma_f32_16x16x32_bf16 v[44:47], v[208:211], v[224:227], v[44:47]
    ds_read_b128 v[188:191], v2 offset:41984
    v_mfma_f32_16x16x32_bf16 v[48:51], v[204:207], v[228:231], v[48:51]
    ds_read_b128 v[192:195], v2 offset:43008
    v_mfma_f32_16x16x32_bf16 v[52:55], v[208:211], v[228:231], v[52:55]
    ds_read_b128 v[196:199], v2 offset:44032
    v_mul_f32 v251, 0x3ae38e39, v251
    v_mfma_f32_16x16x32_bf16 v[56:59], v[204:207], v[232:235], v[56:59]
    ds_read_b128 v[200:203], v2 offset:45056
    v_fma_f32 v249, -v248, v248, v249
    v_mfma_f32_16x16x32_bf16 v[60:63], v[208:211], v[232:235], v[60:63]
    v_fma_f32 v251, -v250, v250, v251
    v_mfma_f32_16x16x32_bf16 v[64:67], v[204:207], v[236:239], v[64:67]
    v_max_f32 v249, 0, v249
    v_mfma_f32_16x16x32_bf16 v[68:71], v[208:211], v[236:239], v[68:71]
    v_max_f32 v251, 0, v251
    v_mfma_f32_16x16x32_bf16 v[72:75], v[204:207], v[240:243], v[72:75]
    v_add_f32 v249, 0x3727c5ac, v249
    v_mfma_f32_16x16x32_bf16 v[76:79], v[208:211], v[240:243], v[76:79]
    v_add_f32 v251, 0x3727c5ac, v251
    v_mfma_f32_16x16x32_bf16 v[80:83], v[204:207], v[244:247], v[80:83]
    v_rsq_f32 v249, v249
    v_mfma_f32_16x16x32_bf16 v[84:87], v[208:211], v[244:247], v[84:87]
    v_rsq_f32 v251, v251
    s_nop 0
    s_waitcnt lgkmcnt(5)
    v_mfma_f32_16x16x32_bf16 v[16:19], v[160:163], v[168:171], v[16:19]
    ds_read_b128 v[204:207], v0 offset:37888
    v_mfma_f32_16x16x32_bf16 v[20:23], v[164:167], v[168:171], v[20:23]
    ds_read_b128 v[208:211], v0 offset:39936
    v_mfma_f32_16x16x32_bf16 v[24:27], v[160:163], v[172:175], v[24:27]
    ds_read_b128 v[212:215], v2 offset:46080
    v_mfma_f32_16x16x32_bf16 v[28:31], v[164:167], v[172:175], v[28:31]
    ds_read_b128 v[216:219], v2 offset:47104
    v_mfma_f32_16x16x32_bf16 v[32:35], v[160:163], v[176:179], v[32:35]
    ds_read_b128 v[220:223], v2 offset:48128
    v_mfma_f32_16x16x32_bf16 v[36:39], v[164:167], v[176:179], v[36:39]
    ds_read_b128 v[224:227], v2 offset:49152
    v_mfma_f32_16x16x32_bf16 v[40:43], v[160:163], v[180:183], v[40:43]
    ds_read_b128 v[228:231], v2 offset:50176
    v_mfma_f32_16x16x32_bf16 v[44:47], v[164:167], v[180:183], v[44:47]
    ds_read_b128 v[232:235], v2 offset:51200
    s_waitcnt lgkmcnt(8)
    v_mfma_f32_16x16x32_bf16 v[48:51], v[160:163], v[184:187], v[48:51]
    ds_read_b128 v[236:239], v2 offset:52224
    v_mfma_f32_16x16x32_bf16 v[52:55], v[164:167], v[184:187], v[52:55]
    ds_read_b128 v[240:243], v2 offset:53248
    v_mfma_f32_16x16x32_bf16 v[56:59], v[160:163], v[188:191], v[56:59]
    ds_read_b128 v[244:247], v2 offset:54272
    v_mfma_f32_16x16x32_bf16 v[60:63], v[164:167], v[188:191], v[60:63]
    v_mfma_f32_16x16x32_bf16 v[64:67], v[160:163], v[192:195], v[64:67]
    v_mfma_f32_16x16x32_bf16 v[68:71], v[164:167], v[192:195], v[68:71]
    v_mfma_f32_16x16x32_bf16 v[72:75], v[160:163], v[196:199], v[72:75]
    v_mfma_f32_16x16x32_bf16 v[76:79], v[164:167], v[196:199], v[76:79]
    v_mfma_f32_16x16x32_bf16 v[80:83], v[160:163], v[200:203], v[80:83]
    v_mfma_f32_16x16x32_bf16 v[84:87], v[164:167], v[200:203], v[84:87]
    s_waitcnt lgkmcnt(0)
    s_barrier
    v_mfma_f32_16x16x32_bf16 v[16:19], v[204:207], v[212:215], v[16:19]
    ds_read_b128 v[160:163], v3 offset:0
    v_mfma_f32_16x16x32_bf16 v[20:23], v[208:211], v[212:215], v[20:23]
    ds_read_b128 v[164:167], v3 offset:2048
    v_mfma_f32_16x16x32_bf16 v[24:27], v[204:207], v[216:219], v[24:27]
    ds_read_b128 v[168:171], v1 offset:0
    v_mfma_f32_16x16x32_bf16 v[28:31], v[208:211], v[216:219], v[28:31]
    ds_read_b128 v[172:175], v1 offset:1024
    v_mfma_f32_16x16x32_bf16 v[32:35], v[204:207], v[220:223], v[32:35]
    ds_read_b128 v[176:179], v1 offset:2048
    v_mfma_f32_16x16x32_bf16 v[36:39], v[208:211], v[220:223], v[36:39]
    ds_read_b128 v[180:183], v1 offset:3072
    v_mfma_f32_16x16x32_bf16 v[40:43], v[204:207], v[224:227], v[40:43]
    ds_read_b128 v[184:187], v1 offset:4096
    v_mfma_f32_16x16x32_bf16 v[44:47], v[208:211], v[224:227], v[44:47]
    ds_read_b128 v[188:191], v1 offset:5120
    v_mfma_f32_16x16x32_bf16 v[48:51], v[204:207], v[228:231], v[48:51]
    ds_read_b128 v[192:195], v1 offset:6144
    v_mfma_f32_16x16x32_bf16 v[52:55], v[208:211], v[228:231], v[52:55]
    ds_read_b128 v[196:199], v1 offset:7168
    v_mfma_f32_16x16x32_bf16 v[56:59], v[204:207], v[232:235], v[56:59]
    ds_read_b128 v[200:203], v1 offset:8192
    v_mfma_f32_16x16x32_bf16 v[60:63], v[208:211], v[232:235], v[60:63]
    ds_write2_b32 v4, v248, v249 offset0:0 offset1:32
    v_mfma_f32_16x16x32_bf16 v[64:67], v[204:207], v[236:239], v[64:67]
    ds_write2_b32 v4, v250, v251 offset0:16 offset1:48
    v_mfma_f32_16x16x32_bf16 v[68:71], v[208:211], v[236:239], v[68:71]
    ds_read_b128 v[88:91], v252 offset:0
    v_mfma_f32_16x16x32_bf16 v[72:75], v[204:207], v[240:243], v[72:75]
    ds_read_b128 v[92:95], v252 offset:64
    v_mfma_f32_16x16x32_bf16 v[76:79], v[208:211], v[240:243], v[76:79]
    ds_read_b128 v[96:99], v252 offset:128
    v_mfma_f32_16x16x32_bf16 v[80:83], v[204:207], v[244:247], v[80:83]
    ds_read_b128 v[100:103], v252 offset:192
    v_mfma_f32_16x16x32_bf16 v[84:87], v[208:211], v[244:247], v[84:87]
    s_waitcnt lgkmcnt(11)
    v_mfma_f32_16x16x32_bf16 v[16:19], v[160:163], v[168:171], v[16:19]
    ds_read_b128 v[204:207], v3 offset:1024
    v_mfma_f32_16x16x32_bf16 v[20:23], v[164:167], v[168:171], v[20:23]
    ds_read_b128 v[208:211], v3 offset:3072
    v_mfma_f32_16x16x32_bf16 v[24:27], v[160:163], v[172:175], v[24:27]
    ds_read_b128 v[212:215], v1 offset:9216
    v_mfma_f32_16x16x32_bf16 v[28:31], v[164:167], v[172:175], v[28:31]
    ds_read_b128 v[216:219], v1 offset:10240
    v_mfma_f32_16x16x32_bf16 v[32:35], v[160:163], v[176:179], v[32:35]
    ds_read_b128 v[220:223], v1 offset:11264
    v_mfma_f32_16x16x32_bf16 v[36:39], v[164:167], v[176:179], v[36:39]
    ds_read_b128 v[224:227], v1 offset:12288
    v_mfma_f32_16x16x32_bf16 v[40:43], v[160:163], v[180:183], v[40:43]
    ds_read_b128 v[228:231], v1 offset:13312
    v_mfma_f32_16x16x32_bf16 v[44:47], v[164:167], v[180:183], v[44:47]
    ds_read_b128 v[232:235], v1 offset:14336
    s_waitcnt lgkmcnt(8)
    v_mfma_f32_16x16x32_bf16 v[48:51], v[160:163], v[184:187], v[48:51]
    ds_read_b128 v[236:239], v1 offset:15360
    v_mfma_f32_16x16x32_bf16 v[52:55], v[164:167], v[184:187], v[52:55]
    ds_read_b128 v[240:243], v1 offset:16384
    v_rcp_f32 v120, v96
    v_mfma_f32_16x16x32_bf16 v[56:59], v[160:163], v[188:191], v[56:59]
    ds_read_b128 v[244:247], v1 offset:17408
    v_mul_f32 v104, s40, v96
    v_mfma_f32_16x16x32_bf16 v[60:63], v[164:167], v[188:191], v[60:63]
    v_mul_f32 v112, v96, v96
    v_mfma_f32_16x16x32_bf16 v[64:67], v[160:163], v[192:195], v[64:67]
    v_rcp_f32 v121, v97
    v_mfma_f32_16x16x32_bf16 v[68:71], v[164:167], v[192:195], v[68:71]
    v_mul_f32 v105, s40, v97
    v_mfma_f32_16x16x32_bf16 v[72:75], v[160:163], v[196:199], v[72:75]
    v_mul_f32 v113, v97, v97
    v_mfma_f32_16x16x32_bf16 v[76:79], v[164:167], v[196:199], v[76:79]
    v_rcp_f32 v122, v98
    v_mfma_f32_16x16x32_bf16 v[80:83], v[160:163], v[200:203], v[80:83]
    v_mul_f32 v106, s40, v98
    v_mfma_f32_16x16x32_bf16 v[84:87], v[164:167], v[200:203], v[84:87]
    v_mul_f32 v114, v98, v98
    v_rcp_f32 v123, v99
    s_waitcnt lgkmcnt(0)
    s_barrier
    v_mfma_f32_16x16x32_bf16 v[16:19], v[204:207], v[212:215], v[16:19]
    ds_read_b128 v[160:163], v3 offset:36864
    v_mfma_f32_16x16x32_bf16 v[20:23], v[208:211], v[212:215], v[20:23]
    ds_read_b128 v[164:167], v3 offset:38912
    v_mfma_f32_16x16x32_bf16 v[24:27], v[204:207], v[216:219], v[24:27]
    ds_read_b128 v[168:171], v1 offset:36864
    v_mfma_f32_16x16x32_bf16 v[28:31], v[208:211], v[216:219], v[28:31]
    ds_read_b128 v[172:175], v1 offset:37888
    v_mfma_f32_16x16x32_bf16 v[32:35], v[204:207], v[220:223], v[32:35]
    ds_read_b128 v[176:179], v1 offset:38912
    v_mfma_f32_16x16x32_bf16 v[36:39], v[208:211], v[220:223], v[36:39]
    ds_read_b128 v[180:183], v1 offset:39936
    v_mfma_f32_16x16x32_bf16 v[40:43], v[204:207], v[224:227], v[40:43]
    ds_read_b128 v[184:187], v1 offset:40960
    v_mfma_f32_16x16x32_bf16 v[44:47], v[208:211], v[224:227], v[44:47]
    ds_read_b128 v[188:191], v1 offset:41984
    v_mfma_f32_16x16x32_bf16 v[48:51], v[204:207], v[228:231], v[48:51]
    ds_read_b128 v[192:195], v1 offset:43008
    v_mfma_f32_16x16x32_bf16 v[52:55], v[208:211], v[228:231], v[52:55]
    ds_read_b128 v[196:199], v1 offset:44032
    v_mul_f32 v107, s40, v99
    v_mfma_f32_16x16x32_bf16 v[56:59], v[204:207], v[232:235], v[56:59]
    ds_read_b128 v[200:203], v1 offset:45056
    v_mul_f32 v115, v99, v99
    v_mfma_f32_16x16x32_bf16 v[60:63], v[208:211], v[232:235], v[60:63]
    v_rcp_f32 v124, v100
    v_mfma_f32_16x16x32_bf16 v[64:67], v[204:207], v[236:239], v[64:67]
    v_mul_f32 v108, s40, v100
    v_mfma_f32_16x16x32_bf16 v[68:71], v[208:211], v[236:239], v[68:71]
    v_mul_f32 v116, v100, v100
    v_mfma_f32_16x16x32_bf16 v[72:75], v[204:207], v[240:243], v[72:75]
    v_rcp_f32 v125, v101
    v_mfma_f32_16x16x32_bf16 v[76:79], v[208:211], v[240:243], v[76:79]
    v_mul_f32 v109, s40, v101
    v_mfma_f32_16x16x32_bf16 v[80:83], v[204:207], v[244:247], v[80:83]
    v_mul_f32 v117, v101, v101
    v_mfma_f32_16x16x32_bf16 v[84:87], v[208:211], v[244:247], v[84:87]
    v_rcp_f32 v126, v102
    v_mul_f32 v110, s40, v102
    s_waitcnt lgkmcnt(5)
    v_mfma_f32_16x16x32_bf16 v[16:19], v[160:163], v[168:171], v[16:19]
    ds_read_b128 v[204:207], v3 offset:37888
    v_mfma_f32_16x16x32_bf16 v[20:23], v[164:167], v[168:171], v[20:23]
    ds_read_b128 v[208:211], v3 offset:39936
    v_mfma_f32_16x16x32_bf16 v[24:27], v[160:163], v[172:175], v[24:27]
    ds_read_b128 v[212:215], v1 offset:46080
    v_mfma_f32_16x16x32_bf16 v[28:31], v[164:167], v[172:175], v[28:31]
    ds_read_b128 v[216:219], v1 offset:47104
    v_mfma_f32_16x16x32_bf16 v[32:35], v[160:163], v[176:179], v[32:35]
    ds_read_b128 v[220:223], v1 offset:48128
    v_mfma_f32_16x16x32_bf16 v[36:39], v[164:167], v[176:179], v[36:39]
    ds_read_b128 v[224:227], v1 offset:49152
    v_mfma_f32_16x16x32_bf16 v[40:43], v[160:163], v[180:183], v[40:43]
    ds_read_b128 v[228:231], v1 offset:50176
    v_mfma_f32_16x16x32_bf16 v[44:47], v[164:167], v[180:183], v[44:47]
    ds_read_b128 v[232:235], v1 offset:51200
    s_waitcnt lgkmcnt(8)
    v_mfma_f32_16x16x32_bf16 v[48:51], v[160:163], v[184:187], v[48:51]
    ds_read_b128 v[236:239], v1 offset:52224
    v_mfma_f32_16x16x32_bf16 v[52:55], v[164:167], v[184:187], v[52:55]
    ds_read_b128 v[240:243], v1 offset:53248
    v_mul_f32 v118, v102, v102
    v_mfma_f32_16x16x32_bf16 v[56:59], v[160:163], v[188:191], v[56:59]
    ds_read_b128 v[244:247], v1 offset:54272
    v_rcp_f32 v127, v103
    v_mfma_f32_16x16x32_bf16 v[60:63], v[164:167], v[188:191], v[60:63]
    v_mul_f32 v111, s40, v103
    v_mfma_f32_16x16x32_bf16 v[64:67], v[160:163], v[192:195], v[64:67]
    v_mul_f32 v119, v103, v103
    v_mfma_f32_16x16x32_bf16 v[68:71], v[164:167], v[192:195], v[68:71]
    v_mul_f32 v112, s42, v112
    v_mfma_f32_16x16x32_bf16 v[72:75], v[160:163], v[196:199], v[72:75]
    v_mul_f32 v113, s42, v113
    v_mfma_f32_16x16x32_bf16 v[76:79], v[164:167], v[196:199], v[76:79]
    v_mul_f32 v114, s42, v114
    v_mfma_f32_16x16x32_bf16 v[80:83], v[160:163], v[200:203], v[80:83]
    v_mul_f32 v115, s42, v115
    v_mfma_f32_16x16x32_bf16 v[84:87], v[164:167], v[200:203], v[84:87]
    v_mul_f32 v116, s42, v116
    v_mul_f32 v117, s42, v117
    s_waitcnt lgkmcnt(0)
    s_barrier
    v_mfma_f32_16x16x32_bf16 v[16:19], v[204:207], v[212:215], v[16:19]
    ds_read_b128 v[160:163], v0 offset:0
    v_mfma_f32_16x16x32_bf16 v[20:23], v[208:211], v[212:215], v[20:23]
    ds_read_b128 v[164:167], v0 offset:2048
    v_mfma_f32_16x16x32_bf16 v[24:27], v[204:207], v[216:219], v[24:27]
    ds_read_b128 v[168:171], v2 offset:0
    v_mfma_f32_16x16x32_bf16 v[28:31], v[208:211], v[216:219], v[28:31]
    ds_read_b128 v[172:175], v2 offset:1024
    v_mfma_f32_16x16x32_bf16 v[32:35], v[204:207], v[220:223], v[32:35]
    ds_read_b128 v[176:179], v2 offset:2048
    v_mfma_f32_16x16x32_bf16 v[36:39], v[208:211], v[220:223], v[36:39]
    ds_read_b128 v[180:183], v2 offset:3072
    v_mfma_f32_16x16x32_bf16 v[40:43], v[204:207], v[224:227], v[40:43]
    ds_read_b128 v[184:187], v2 offset:4096
    v_mfma_f32_16x16x32_bf16 v[44:47], v[208:211], v[224:227], v[44:47]
    ds_read_b128 v[188:191], v2 offset:5120
    v_mfma_f32_16x16x32_bf16 v[48:51], v[204:207], v[228:231], v[48:51]
    ds_read_b128 v[192:195], v2 offset:6144
    v_mfma_f32_16x16x32_bf16 v[52:55], v[208:211], v[228:231], v[52:55]
    ds_read_b128 v[196:199], v2 offset:7168
    v_mul_f32 v118, s42, v118
    v_mfma_f32_16x16x32_bf16 v[56:59], v[204:207], v[232:235], v[56:59]
    ds_read_b128 v[200:203], v2 offset:8192
    v_mul_f32 v119, s42, v119
    v_mfma_f32_16x16x32_bf16 v[60:63], v[208:211], v[232:235], v[60:63]
    v_mul_f32 v112, v112, v104
    v_mfma_f32_16x16x32_bf16 v[64:67], v[204:207], v[236:239], v[64:67]
    v_mul_f32 v113, v113, v105
    v_mfma_f32_16x16x32_bf16 v[68:71], v[208:211], v[236:239], v[68:71]
    v_mul_f32 v114, v114, v106
    v_mfma_f32_16x16x32_bf16 v[72:75], v[204:207], v[240:243], v[72:75]
    v_mul_f32 v115, v115, v107
    v_mfma_f32_16x16x32_bf16 v[76:79], v[208:211], v[240:243], v[76:79]
    v_mul_f32 v116, v116, v108
    v_mfma_f32_16x16x32_bf16 v[80:83], v[204:207], v[244:247], v[80:83]
    v_mul_f32 v117, v117, v109
    v_mfma_f32_16x16x32_bf16 v[84:87], v[208:211], v[244:247], v[84:87]
    v_mul_f32 v118, v118, v110
    v_mul_f32 v119, v119, v111
    s_waitcnt lgkmcnt(5)
    v_mfma_f32_16x16x32_bf16 v[16:19], v[160:163], v[168:171], v[16:19]
    ds_read_b128 v[204:207], v0 offset:1024
    v_mfma_f32_16x16x32_bf16 v[20:23], v[164:167], v[168:171], v[20:23]
    ds_read_b128 v[208:211], v0 offset:3072
    v_mfma_f32_16x16x32_bf16 v[24:27], v[160:163], v[172:175], v[24:27]
    ds_read_b128 v[212:215], v2 offset:9216
    v_mfma_f32_16x16x32_bf16 v[28:31], v[164:167], v[172:175], v[28:31]
    ds_read_b128 v[216:219], v2 offset:10240
    v_mfma_f32_16x16x32_bf16 v[32:35], v[160:163], v[176:179], v[32:35]
    ds_read_b128 v[220:223], v2 offset:11264
    v_mfma_f32_16x16x32_bf16 v[36:39], v[164:167], v[176:179], v[36:39]
    ds_read_b128 v[224:227], v2 offset:12288
    v_mfma_f32_16x16x32_bf16 v[40:43], v[160:163], v[180:183], v[40:43]
    ds_read_b128 v[228:231], v2 offset:13312
    v_mfma_f32_16x16x32_bf16 v[44:47], v[164:167], v[180:183], v[44:47]
    ds_read_b128 v[232:235], v2 offset:14336
    s_waitcnt lgkmcnt(8)
    v_mfma_f32_16x16x32_bf16 v[48:51], v[160:163], v[184:187], v[48:51]
    ds_read_b128 v[236:239], v2 offset:15360
    v_mfma_f32_16x16x32_bf16 v[52:55], v[164:167], v[184:187], v[52:55]
    ds_read_b128 v[240:243], v2 offset:16384
    v_lshrrev_b32 v8, 2, v6
    v_mfma_f32_16x16x32_bf16 v[56:59], v[160:163], v[188:191], v[56:59]
    ds_read_b128 v[244:247], v2 offset:17408
    v_lshlrev_b32 v8, 4, v8
    v_mfma_f32_16x16x32_bf16 v[60:63], v[164:167], v[188:191], v[60:63]
    v_lshl_add_u32 v8, v5, 6, v8
    v_mfma_f32_16x16x32_bf16 v[64:67], v[160:163], v[192:195], v[64:67]
    v_and_b32 v9, 3, v6
    v_mfma_f32_16x16x32_bf16 v[68:71], v[164:167], v[192:195], v[68:71]
    v_cmp_eq_u32 vcc, 0, v9
    v_mfma_f32_16x16x32_bf16 v[72:75], v[160:163], v[196:199], v[72:75]
    v_bfrev_b32 v10, 1
    v_mfma_f32_16x16x32_bf16 v[76:79], v[164:167], v[196:199], v[76:79]
    v_lshlrev_b32 v9, 4, v9
    v_mfma_f32_16x16x32_bf16 v[80:83], v[160:163], v[200:203], v[80:83]
    v_cndmask_b32 v8, v10, v8, vcc
    v_mfma_f32_16x16x32_bf16 v[84:87], v[164:167], v[200:203], v[84:87]
    v_lshl_add_u32 v9, v5, 6, v9
    v_lshrrev_b32 v255, 2, v6
    s_waitcnt lgkmcnt(0)
    s_barrier
    v_mfma_f32_16x16x32_bf16 v[16:19], v[204:207], v[212:215], v[16:19]
    ds_read_b128 v[160:163], v0 offset:36864
    v_fma_f32 v52, -v92, v132, v52
    v_mfma_f32_16x16x32_bf16 v[20:23], v[208:211], v[212:215], v[20:23]
    ds_read_b128 v[164:167], v0 offset:38912
    v_fma_f32 v56, -v88, v133, v56
    v_mfma_f32_16x16x32_bf16 v[24:27], v[204:207], v[216:219], v[24:27]
    ds_read_b128 v[168:171], v2 offset:36864
    v_fma_f32 v60, -v92, v133, v60
    v_mfma_f32_16x16x32_bf16 v[28:31], v[208:211], v[216:219], v[28:31]
    ds_read_b128 v[172:175], v2 offset:37888
    v_fma_f32 v64, -v88, v134, v64
    v_mfma_f32_16x16x32_bf16 v[32:35], v[204:207], v[220:223], v[32:35]
    ds_read_b128 v[176:179], v2 offset:38912
    v_fma_f32 v68, -v92, v134, v68
    v_mfma_f32_16x16x32_bf16 v[36:39], v[208:211], v[220:223], v[36:39]
    ds_read_b128 v[180:183], v2 offset:39936
    v_fma_f32 v72, -v88, v135, v72
    v_mfma_f32_16x16x32_bf16 v[40:43], v[204:207], v[224:227], v[40:43]
    ds_read_b128 v[184:187], v2 offset:40960
    v_fma_f32 v76, -v92, v135, v76
    v_mfma_f32_16x16x32_bf16 v[44:47], v[208:211], v[224:227], v[44:47]
    ds_read_b128 v[188:191], v2 offset:41984
    v_fma_f32 v80, -v88, v136, v80
    v_mfma_f32_16x16x32_bf16 v[48:51], v[204:207], v[228:231], v[48:51]
    ds_read_b128 v[192:195], v2 offset:43008
    v_fma_f32 v84, -v92, v136, v84
    v_mfma_f32_16x16x32_bf16 v[52:55], v[208:211], v[228:231], v[52:55]
    ds_read_b128 v[196:199], v2 offset:44032
    v_lshl_add_u32 v255, v255, 8, v9
    v_fma_f32 v16, -v88, v128, v16
    v_mfma_f32_16x16x32_bf16 v[56:59], v[204:207], v[232:235], v[56:59]
    ds_read_b128 v[200:203], v2 offset:45056
    v_fma_f32 v20, -v92, v128, v20
    v_mfma_f32_16x16x32_bf16 v[60:63], v[208:211], v[232:235], v[60:63]
    v_fma_f32 v24, -v88, v129, v24
    v_mfma_f32_16x16x32_bf16 v[64:67], v[204:207], v[236:239], v[64:67]
    v_fma_f32 v28, -v92, v129, v28
    v_mfma_f32_16x16x32_bf16 v[68:71], v[208:211], v[236:239], v[68:71]
    v_fma_f32 v32, -v88, v130, v32
    v_mfma_f32_16x16x32_bf16 v[72:75], v[204:207], v[240:243], v[72:75]
    v_fma_f32 v36, -v92, v130, v36
    v_mfma_f32_16x16x32_bf16 v[76:79], v[208:211], v[240:243], v[76:79]
    v_fma_f32 v40, -v88, v131, v40
    v_mfma_f32_16x16x32_bf16 v[80:83], v[204:207], v[244:247], v[80:83]
    v_fma_f32 v44, -v92, v131, v44
    v_mfma_f32_16x16x32_bf16 v[84:87], v[208:211], v[244:247], v[84:87]
    v_fma_f32 v48, -v88, v132, v48
    s_waitcnt lgkmcnt(5)
    v_mfma_f32_16x16x32_bf16 v[16:19], v[160:163], v[168:171], v[16:19]
    ds_read_b128 v[204:207], v0 offset:37888
    v_fma_f32 v53, -v93, v132, v53
    v_mfma_f32_16x16x32_bf16 v[20:23], v[164:167], v[168:171], v[20:23]
    ds_read_b128 v[208:211], v0 offset:39936
    v_fma_f32 v57, -v89, v133, v57
    v_mfma_f32_16x16x32_bf16 v[24:27], v[160:163], v[172:175], v[24:27]
    ds_read_b128 v[212:215], v2 offset:46080
    v_fma_f32 v61, -v93, v133, v61
    v_mfma_f32_16x16x32_bf16 v[28:31], v[164:167], v[172:175], v[28:31]
    ds_read_b128 v[216:219], v2 offset:47104
    v_fma_f32 v65, -v89, v134, v65
    v_mfma_f32_16x16x32_bf16 v[32:35], v[160:163], v[176:179], v[32:35]
    ds_read_b128 v[220:223], v2 offset:48128
    v_fma_f32 v69, -v93, v134, v69
    v_mfma_f32_16x16x32_bf16 v[36:39], v[164:167], v[176:179], v[36:39]
    ds_read_b128 v[224:227], v2 offset:49152
    v_fma_f32 v73, -v89, v135, v73
    v_mfma_f32_16x16x32_bf16 v[40:43], v[160:163], v[180:183], v[40:43]
    ds_read_b128 v[228:231], v2 offset:50176
    v_fma_f32 v77, -v93, v135, v77
    v_mfma_f32_16x16x32_bf16 v[44:47], v[164:167], v[180:183], v[44:47]
    ds_read_b128 v[232:235], v2 offset:51200
    s_waitcnt lgkmcnt(8)
    v_fma_f32 v81, -v89, v136, v81
    v_mfma_f32_16x16x32_bf16 v[48:51], v[160:163], v[184:187], v[48:51]
    ds_read_b128 v[236:239], v2 offset:52224
    v_fma_f32 v85, -v93, v136, v85
    v_mfma_f32_16x16x32_bf16 v[52:55], v[164:167], v[184:187], v[52:55]
    ds_read_b128 v[240:243], v2 offset:53248
    v_fma_f32 v17, -v89, v128, v17
    v_mfma_f32_16x16x32_bf16 v[56:59], v[160:163], v[188:191], v[56:59]
    ds_read_b128 v[244:247], v2 offset:54272
    v_fma_f32 v21, -v93, v128, v21
    v_mfma_f32_16x16x32_bf16 v[60:63], v[164:167], v[188:191], v[60:63]
    v_fma_f32 v25, -v89, v129, v25
    v_mfma_f32_16x16x32_bf16 v[64:67], v[160:163], v[192:195], v[64:67]
    v_fma_f32 v29, -v93, v129, v29
    v_mfma_f32_16x16x32_bf16 v[68:71], v[164:167], v[192:195], v[68:71]
    v_fma_f32 v33, -v89, v130, v33
    v_mfma_f32_16x16x32_bf16 v[72:75], v[160:163], v[196:199], v[72:75]
    v_fma_f32 v37, -v93, v130, v37
    v_mfma_f32_16x16x32_bf16 v[76:79], v[164:167], v[196:199], v[76:79]
    v_fma_f32 v41, -v89, v131, v41
    v_mfma_f32_16x16x32_bf16 v[80:83], v[160:163], v[200:203], v[80:83]
    v_fma_f32 v45, -v93, v131, v45
    v_mfma_f32_16x16x32_bf16 v[84:87], v[164:167], v[200:203], v[84:87]
    v_fma_f32 v49, -v89, v132, v49
    s_waitcnt lgkmcnt(0)
    s_barrier
    v_mfma_f32_16x16x32_bf16 v[16:19], v[204:207], v[212:215], v[16:19]
    ds_read_b128 v[160:163], v3 offset:0
    v_fma_f32 v54, -v94, v132, v54
    v_mfma_f32_16x16x32_bf16 v[20:23], v[208:211], v[212:215], v[20:23]
    ds_read_b128 v[164:167], v3 offset:2048
    v_fma_f32 v58, -v90, v133, v58
    v_mfma_f32_16x16x32_bf16 v[24:27], v[204:207], v[216:219], v[24:27]
    ds_read_b128 v[168:171], v1 offset:0
    v_fma_f32 v62, -v94, v133, v62
    v_mfma_f32_16x16x32_bf16 v[28:31], v[208:211], v[216:219], v[28:31]
    ds_read_b128 v[172:175], v1 offset:1024
    v_fma_f32 v66, -v90, v134, v66
    v_mfma_f32_16x16x32_bf16 v[32:35], v[204:207], v[220:223], v[32:35]
    ds_read_b128 v[176:179], v1 offset:2048
    v_fma_f32 v70, -v94, v134, v70
    v_mfma_f32_16x16x32_bf16 v[36:39], v[208:211], v[220:223], v[36:39]
    ds_read_b128 v[180:183], v1 offset:3072
    v_fma_f32 v74, -v90, v135, v74
    v_mfma_f32_16x16x32_bf16 v[40:43], v[204:207], v[224:227], v[40:43]
    ds_read_b128 v[184:187], v1 offset:4096
    v_fma_f32 v78, -v94, v135, v78
    v_mfma_f32_16x16x32_bf16 v[44:47], v[208:211], v[224:227], v[44:47]
    ds_read_b128 v[188:191], v1 offset:5120
    v_fma_f32 v82, -v90, v136, v82
    v_mfma_f32_16x16x32_bf16 v[48:51], v[204:207], v[228:231], v[48:51]
    ds_read_b128 v[192:195], v1 offset:6144
    v_fma_f32 v86, -v94, v136, v86
    v_mfma_f32_16x16x32_bf16 v[52:55], v[208:211], v[228:231], v[52:55]
    ds_read_b128 v[196:199], v1 offset:7168
    v_fma_f32 v18, -v90, v128, v18
    v_mfma_f32_16x16x32_bf16 v[56:59], v[204:207], v[232:235], v[56:59]
    ds_read_b128 v[200:203], v1 offset:8192
    v_fma_f32 v22, -v94, v128, v22
    v_mfma_f32_16x16x32_bf16 v[60:63], v[208:211], v[232:235], v[60:63]
    v_fma_f32 v26, -v90, v129, v26
    v_mfma_f32_16x16x32_bf16 v[64:67], v[204:207], v[236:239], v[64:67]
    v_fma_f32 v30, -v94, v129, v30
    v_mfma_f32_16x16x32_bf16 v[68:71], v[208:211], v[236:239], v[68:71]
    v_fma_f32 v34, -v90, v130, v34
    v_mfma_f32_16x16x32_bf16 v[72:75], v[204:207], v[240:243], v[72:75]
    v_fma_f32 v38, -v94, v130, v38
    v_mfma_f32_16x16x32_bf16 v[76:79], v[208:211], v[240:243], v[76:79]
    v_fma_f32 v42, -v90, v131, v42
    v_mfma_f32_16x16x32_bf16 v[80:83], v[204:207], v[244:247], v[80:83]
    v_fma_f32 v46, -v94, v131, v46
    v_mfma_f32_16x16x32_bf16 v[84:87], v[208:211], v[244:247], v[84:87]
    v_fma_f32 v50, -v90, v132, v50
    s_waitcnt lgkmcnt(5)
    v_mfma_f32_16x16x32_bf16 v[16:19], v[160:163], v[168:171], v[16:19]
    ds_read_b128 v[204:207], v3 offset:1024
    v_fma_f32 v55, -v95, v132, v55
    v_mfma_f32_16x16x32_bf16 v[20:23], v[164:167], v[168:171], v[20:23]
    ds_read_b128 v[208:211], v3 offset:3072
    v_fma_f32 v59, -v91, v133, v59
    v_mfma_f32_16x16x32_bf16 v[24:27], v[160:163], v[172:175], v[24:27]
    ds_read_b128 v[212:215], v1 offset:9216
    v_fma_f32 v63, -v95, v133, v63
    v_mfma_f32_16x16x32_bf16 v[28:31], v[164:167], v[172:175], v[28:31]
    ds_read_b128 v[216:219], v1 offset:10240
    v_fma_f32 v67, -v91, v134, v67
    v_mfma_f32_16x16x32_bf16 v[32:35], v[160:163], v[176:179], v[32:35]
    ds_read_b128 v[220:223], v1 offset:11264
    v_fma_f32 v71, -v95, v134, v71
    v_mfma_f32_16x16x32_bf16 v[36:39], v[164:167], v[176:179], v[36:39]
    ds_read_b128 v[224:227], v1 offset:12288
    v_fma_f32 v75, -v91, v135, v75
    v_mfma_f32_16x16x32_bf16 v[40:43], v[160:163], v[180:183], v[40:43]
    ds_read_b128 v[228:231], v1 offset:13312
    v_fma_f32 v79, -v95, v135, v79
    v_mfma_f32_16x16x32_bf16 v[44:47], v[164:167], v[180:183], v[44:47]
    ds_read_b128 v[232:235], v1 offset:14336
    s_waitcnt lgkmcnt(8)
    v_fma_f32 v83, -v91, v136, v83
    v_mfma_f32_16x16x32_bf16 v[48:51], v[160:163], v[184:187], v[48:51]
    ds_read_b128 v[236:239], v1 offset:15360
    v_fma_f32 v87, -v95, v136, v87
    v_mfma_f32_16x16x32_bf16 v[52:55], v[164:167], v[184:187], v[52:55]
    ds_read_b128 v[240:243], v1 offset:16384
    v_fma_f32 v19, -v91, v128, v19
    v_mfma_f32_16x16x32_bf16 v[56:59], v[160:163], v[188:191], v[56:59]
    ds_read_b128 v[244:247], v1 offset:17408
    v_fma_f32 v23, -v95, v128, v23
    v_mfma_f32_16x16x32_bf16 v[60:63], v[164:167], v[188:191], v[60:63]
    v_fma_f32 v27, -v91, v129, v27
    v_mfma_f32_16x16x32_bf16 v[64:67], v[160:163], v[192:195], v[64:67]
    v_fma_f32 v31, -v95, v129, v31
    v_mfma_f32_16x16x32_bf16 v[68:71], v[164:167], v[192:195], v[68:71]
    v_fma_f32 v35, -v91, v130, v35
    v_mfma_f32_16x16x32_bf16 v[72:75], v[160:163], v[196:199], v[72:75]
    v_fma_f32 v39, -v95, v130, v39
    v_mfma_f32_16x16x32_bf16 v[76:79], v[164:167], v[196:199], v[76:79]
    v_fma_f32 v43, -v91, v131, v43
    v_mfma_f32_16x16x32_bf16 v[80:83], v[160:163], v[200:203], v[80:83]
    v_fma_f32 v47, -v95, v131, v47
    v_mfma_f32_16x16x32_bf16 v[84:87], v[164:167], v[200:203], v[84:87]
    v_fma_f32 v51, -v91, v132, v51
    s_waitcnt lgkmcnt(0)
    s_barrier
    v_mfma_f32_16x16x32_bf16 v[16:19], v[204:207], v[212:215], v[16:19]
    ds_read_b128 v[160:163], v3 offset:36864
    v_mfma_f32_16x16x32_bf16 v[20:23], v[208:211], v[212:215], v[20:23]
    ds_read_b128 v[164:167], v3 offset:38912
    v_mfma_f32_16x16x32_bf16 v[24:27], v[204:207], v[216:219], v[24:27]
    ds_read_b128 v[168:171], v1 offset:36864
    v_mfma_f32_16x16x32_bf16 v[28:31], v[208:211], v[216:219], v[28:31]
    ds_read_b128 v[172:175], v1 offset:37888
    v_mfma_f32_16x16x32_bf16 v[32:35], v[204:207], v[220:223], v[32:35]
    ds_read_b128 v[176:179], v1 offset:38912
    v_mfma_f32_16x16x32_bf16 v[36:39], v[208:211], v[220:223], v[36:39]
    ds_read_b128 v[180:183], v1 offset:39936
    v_mfma_f32_16x16x32_bf16 v[40:43], v[204:207], v[224:227], v[40:43]
    ds_read_b128 v[184:187], v1 offset:40960
    v_mfma_f32_16x16x32_bf16 v[44:47], v[208:211], v[224:227], v[44:47]
    ds_read_b128 v[188:191], v1 offset:41984
    v_mfma_f32_16x16x32_bf16 v[48:51], v[204:207], v[228:231], v[48:51]
    ds_read_b128 v[192:195], v1 offset:43008
    v_mfma_f32_16x16x32_bf16 v[52:55], v[208:211], v[228:231], v[52:55]
    ds_read_b128 v[196:199], v1 offset:44032
    v_mfma_f32_16x16x32_bf16 v[56:59], v[204:207], v[232:235], v[56:59]
    ds_read_b128 v[200:203], v1 offset:45056
    v_mfma_f32_16x16x32_bf16 v[60:63], v[208:211], v[232:235], v[60:63]
    v_mfma_f32_16x16x32_bf16 v[64:67], v[204:207], v[236:239], v[64:67]
    v_mfma_f32_16x16x32_bf16 v[68:71], v[208:211], v[236:239], v[68:71]
    v_mfma_f32_16x16x32_bf16 v[72:75], v[204:207], v[240:243], v[72:75]
    v_mfma_f32_16x16x32_bf16 v[76:79], v[208:211], v[240:243], v[76:79]
    v_mfma_f32_16x16x32_bf16 v[80:83], v[204:207], v[244:247], v[80:83]
    v_mfma_f32_16x16x32_bf16 v[84:87], v[208:211], v[244:247], v[84:87]
    v_pk_mul_f32 v[220:221], v[16:17], v[16:17]
    v_pk_mul_f32 v[222:223], v[18:19], v[18:19]
    v_pk_mul_f32 v[224:225], v[20:21], v[20:21]
    v_pk_mul_f32 v[226:227], v[22:23], v[22:23]
    v_pk_fma_f32 v[220:221], v[220:221], v[112:113], v[104:105]
    v_pk_fma_f32 v[222:223], v[222:223], v[114:115], v[106:107]
    v_pk_fma_f32 v[224:225], v[224:225], v[116:117], v[108:109]
    v_pk_fma_f32 v[226:227], v[226:227], v[118:119], v[110:111]
    v_pk_mul_f32 v[220:221], v[220:221], v[16:17]
    v_pk_mul_f32 v[222:223], v[222:223], v[18:19]
    v_pk_mul_f32 v[224:225], v[224:225], v[20:21]
    v_pk_mul_f32 v[226:227], v[226:227], v[22:23]
    v_exp_f32 v220, v220
    v_exp_f32 v221, v221
    v_exp_f32 v222, v222
    v_exp_f32 v223, v223
    v_exp_f32 v224, v224
    v_exp_f32 v225, v225
    v_exp_f32 v226, v226
    v_exp_f32 v227, v227
    v_pk_fma_f32 v[220:221], v[220:221], v[120:121], v[120:121]
    v_pk_fma_f32 v[222:223], v[222:223], v[122:123], v[122:123]
    v_pk_fma_f32 v[224:225], v[224:225], v[124:125], v[124:125]
    v_pk_fma_f32 v[226:227], v[226:227], v[126:127], v[126:127]
    v_rcp_f32 v220, v220
    v_rcp_f32 v221, v221
    v_rcp_f32 v222, v222
    v_rcp_f32 v223, v223
    v_rcp_f32 v224, v224
    v_rcp_f32 v225, v225
    v_rcp_f32 v226, v226
    v_rcp_f32 v227, v227
    v_pk_mul_f32 v[16:17], v[16:17], v[220:221]
    v_pk_mul_f32 v[18:19], v[18:19], v[222:223]
    v_pk_mul_f32 v[20:21], v[20:21], v[224:225]
    v_pk_mul_f32 v[22:23], v[22:23], v[226:227]
    v_pk_mul_f32 v[206:207], v[16:17], v[16:17]
    v_pk_mul_f32 v[210:211], v[18:19], v[18:19]
    v_pk_mul_f32 v[214:215], v[20:21], v[20:21]
    v_pk_mul_f32 v[218:219], v[22:23], v[22:23]
    v_pk_mul_f32 v[228:229], v[24:25], v[24:25]
    v_pk_mul_f32 v[230:231], v[26:27], v[26:27]
    v_pk_mul_f32 v[232:233], v[28:29], v[28:29]
    v_pk_mul_f32 v[234:235], v[30:31], v[30:31]
    v_pk_fma_f32 v[228:229], v[228:229], v[112:113], v[104:105]
    v_pk_fma_f32 v[230:231], v[230:231], v[114:115], v[106:107]
    v_pk_fma_f32 v[232:233], v[232:233], v[116:117], v[108:109]
    v_pk_fma_f32 v[234:235], v[234:235], v[118:119], v[110:111]
    v_pk_mul_f32 v[228:229], v[228:229], v[24:25]
    v_pk_mul_f32 v[230:231], v[230:231], v[26:27]
    v_pk_mul_f32 v[232:233], v[232:233], v[28:29]
    v_pk_mul_f32 v[234:235], v[234:235], v[30:31]
    v_exp_f32 v228, v228
    v_exp_f32 v229, v229
    v_exp_f32 v230, v230
    v_exp_f32 v231, v231
    v_exp_f32 v232, v232
    v_exp_f32 v233, v233
    v_exp_f32 v234, v234
    v_exp_f32 v235, v235
    v_pk_fma_f32 v[228:229], v[228:229], v[120:121], v[120:121]
    v_pk_fma_f32 v[230:231], v[230:231], v[122:123], v[122:123]
    v_pk_fma_f32 v[232:233], v[232:233], v[124:125], v[124:125]
    v_pk_fma_f32 v[234:235], v[234:235], v[126:127], v[126:127]
    v_rcp_f32 v228, v228
    v_rcp_f32 v229, v229
    v_rcp_f32 v230, v230
    v_rcp_f32 v231, v231
    v_rcp_f32 v232, v232
    v_rcp_f32 v233, v233
    v_rcp_f32 v234, v234
    v_rcp_f32 v235, v235
    v_pk_mul_f32 v[24:25], v[24:25], v[228:229]
    v_pk_mul_f32 v[26:27], v[26:27], v[230:231]
    v_pk_mul_f32 v[28:29], v[28:29], v[232:233]
    v_pk_mul_f32 v[30:31], v[30:31], v[234:235]
    v_pk_add_f32 v[204:205], v[16:17], v[24:25]
    v_pk_fma_f32 v[206:207], v[24:25], v[24:25], v[206:207]
    v_pk_add_f32 v[208:209], v[18:19], v[26:27]
    v_pk_fma_f32 v[210:211], v[26:27], v[26:27], v[210:211]
    v_pk_add_f32 v[212:213], v[20:21], v[28:29]
    v_pk_fma_f32 v[214:215], v[28:29], v[28:29], v[214:215]
    v_pk_add_f32 v[216:217], v[22:23], v[30:31]
    v_pk_fma_f32 v[218:219], v[30:31], v[30:31], v[218:219]
    v_pk_mul_f32 v[220:221], v[32:33], v[32:33]
    v_pk_mul_f32 v[222:223], v[34:35], v[34:35]
    v_pk_mul_f32 v[224:225], v[36:37], v[36:37]
    v_pk_mul_f32 v[226:227], v[38:39], v[38:39]
    v_pk_fma_f32 v[220:221], v[220:221], v[112:113], v[104:105]
    v_pk_fma_f32 v[222:223], v[222:223], v[114:115], v[106:107]
    v_pk_fma_f32 v[224:225], v[224:225], v[116:117], v[108:109]
    v_pk_fma_f32 v[226:227], v[226:227], v[118:119], v[110:111]
    v_pk_mul_f32 v[220:221], v[220:221], v[32:33]
    v_pk_mul_f32 v[222:223], v[222:223], v[34:35]
    v_pk_mul_f32 v[224:225], v[224:225], v[36:37]
    v_pk_mul_f32 v[226:227], v[226:227], v[38:39]
    v_exp_f32 v220, v220
    v_exp_f32 v221, v221
    v_exp_f32 v222, v222
    v_exp_f32 v223, v223
    v_exp_f32 v224, v224
    v_exp_f32 v225, v225
    v_exp_f32 v226, v226
    v_exp_f32 v227, v227
    v_pk_fma_f32 v[220:221], v[220:221], v[120:121], v[120:121]
    v_pk_fma_f32 v[222:223], v[222:223], v[122:123], v[122:123]
    v_pk_fma_f32 v[224:225], v[224:225], v[124:125], v[124:125]
    v_pk_fma_f32 v[226:227], v[226:227], v[126:127], v[126:127]
    v_rcp_f32 v220, v220
    v_rcp_f32 v221, v221
    v_rcp_f32 v222, v222
    v_rcp_f32 v223, v223
    v_rcp_f32 v224, v224
    v_rcp_f32 v225, v225
    v_rcp_f32 v226, v226
    v_rcp_f32 v227, v227
    v_pk_mul_f32 v[32:33], v[32:33], v[220:221]
    v_pk_mul_f32 v[34:35], v[34:35], v[222:223]
    v_pk_mul_f32 v[36:37], v[36:37], v[224:225]
    v_pk_mul_f32 v[38:39], v[38:39], v[226:227]
    v_pk_add_f32 v[204:205], v[204:205], v[32:33]
    v_pk_fma_f32 v[206:207], v[32:33], v[32:33], v[206:207]
    v_pk_add_f32 v[208:209], v[208:209], v[34:35]
    v_pk_fma_f32 v[210:211], v[34:35], v[34:35], v[210:211]
    v_pk_add_f32 v[212:213], v[212:213], v[36:37]
    v_pk_fma_f32 v[214:215], v[36:37], v[36:37], v[214:215]
    v_pk_add_f32 v[216:217], v[216:217], v[38:39]
    v_pk_fma_f32 v[218:219], v[38:39], v[38:39], v[218:219]
    v_pk_mul_f32 v[228:229], v[40:41], v[40:41]
    v_pk_mul_f32 v[230:231], v[42:43], v[42:43]
    v_pk_mul_f32 v[232:233], v[44:45], v[44:45]
    v_pk_mul_f32 v[234:235], v[46:47], v[46:47]
    v_pk_fma_f32 v[228:229], v[228:229], v[112:113], v[104:105]
    v_pk_fma_f32 v[230:231], v[230:231], v[114:115], v[106:107]
    v_pk_fma_f32 v[232:233], v[232:233], v[116:117], v[108:109]
    v_pk_fma_f32 v[234:235], v[234:235], v[118:119], v[110:111]
    v_pk_mul_f32 v[228:229], v[228:229], v[40:41]
    v_pk_mul_f32 v[230:231], v[230:231], v[42:43]
    v_pk_mul_f32 v[232:233], v[232:233], v[44:45]
    v_pk_mul_f32 v[234:235], v[234:235], v[46:47]
    v_exp_f32 v228, v228
    v_exp_f32 v229, v229
    v_exp_f32 v230, v230
    v_exp_f32 v231, v231
    v_exp_f32 v232, v232
    v_exp_f32 v233, v233
    v_exp_f32 v234, v234
    v_exp_f32 v235, v235
    v_pk_fma_f32 v[228:229], v[228:229], v[120:121], v[120:121]
    v_pk_fma_f32 v[230:231], v[230:231], v[122:123], v[122:123]
    v_pk_fma_f32 v[232:233], v[232:233], v[124:125], v[124:125]
    v_pk_fma_f32 v[234:235], v[234:235], v[126:127], v[126:127]
    v_rcp_f32 v228, v228
    v_rcp_f32 v229, v229
    v_rcp_f32 v230, v230
    v_rcp_f32 v231, v231
    v_rcp_f32 v232, v232
    v_rcp_f32 v233, v233
    v_rcp_f32 v234, v234
    v_rcp_f32 v235, v235
    v_pk_mul_f32 v[40:41], v[40:41], v[228:229]
    v_pk_mul_f32 v[42:43], v[42:43], v[230:231]
    v_pk_mul_f32 v[44:45], v[44:45], v[232:233]
    v_pk_mul_f32 v[46:47], v[46:47], v[234:235]
    v_pk_add_f32 v[204:205], v[204:205], v[40:41]
    v_pk_fma_f32 v[206:207], v[40:41], v[40:41], v[206:207]
    v_pk_add_f32 v[208:209], v[208:209], v[42:43]
    v_pk_fma_f32 v[210:211], v[42:43], v[42:43], v[210:211]
    v_pk_add_f32 v[212:213], v[212:213], v[44:45]
    v_pk_fma_f32 v[214:215], v[44:45], v[44:45], v[214:215]
    v_pk_add_f32 v[216:217], v[216:217], v[46:47]
    v_pk_fma_f32 v[218:219], v[46:47], v[46:47], v[218:219]
    v_pk_mul_f32 v[220:221], v[48:49], v[48:49]
    v_pk_mul_f32 v[222:223], v[50:51], v[50:51]
    v_pk_mul_f32 v[224:225], v[52:53], v[52:53]
    v_pk_mul_f32 v[226:227], v[54:55], v[54:55]
    v_pk_fma_f32 v[220:221], v[220:221], v[112:113], v[104:105]
    v_pk_fma_f32 v[222:223], v[222:223], v[114:115], v[106:107]
    v_pk_fma_f32 v[224:225], v[224:225], v[116:117], v[108:109]
    v_pk_fma_f32 v[226:227], v[226:227], v[118:119], v[110:111]
    v_pk_mul_f32 v[220:221], v[220:221], v[48:49]
    v_pk_mul_f32 v[222:223], v[222:223], v[50:51]
    v_pk_mul_f32 v[224:225], v[224:225], v[52:53]
    v_pk_mul_f32 v[226:227], v[226:227], v[54:55]
    v_exp_f32 v220, v220
    v_exp_f32 v221, v221
    v_exp_f32 v222, v222
    v_exp_f32 v223, v223
    v_exp_f32 v224, v224
    v_exp_f32 v225, v225
    v_exp_f32 v226, v226
    v_exp_f32 v227, v227
    v_pk_fma_f32 v[220:221], v[220:221], v[120:121], v[120:121]
    v_pk_fma_f32 v[222:223], v[222:223], v[122:123], v[122:123]
    v_pk_fma_f32 v[224:225], v[224:225], v[124:125], v[124:125]
    v_pk_fma_f32 v[226:227], v[226:227], v[126:127], v[126:127]
    v_rcp_f32 v220, v220
    v_rcp_f32 v221, v221
    v_rcp_f32 v222, v222
    v_rcp_f32 v223, v223
    v_rcp_f32 v224, v224
    v_rcp_f32 v225, v225
    v_rcp_f32 v226, v226
    v_rcp_f32 v227, v227
    v_pk_mul_f32 v[48:49], v[48:49], v[220:221]
    v_pk_mul_f32 v[50:51], v[50:51], v[222:223]
    v_pk_mul_f32 v[52:53], v[52:53], v[224:225]
    v_pk_mul_f32 v[54:55], v[54:55], v[226:227]
    v_pk_add_f32 v[204:205], v[204:205], v[48:49]
    v_pk_fma_f32 v[206:207], v[48:49], v[48:49], v[206:207]
    v_pk_add_f32 v[208:209], v[208:209], v[50:51]
    v_pk_fma_f32 v[210:211], v[50:51], v[50:51], v[210:211]
    v_pk_add_f32 v[212:213], v[212:213], v[52:53]
    v_pk_fma_f32 v[214:215], v[52:53], v[52:53], v[214:215]
    v_pk_add_f32 v[216:217], v[216:217], v[54:55]
    v_pk_fma_f32 v[218:219], v[54:55], v[54:55], v[218:219]
    v_pk_mul_f32 v[228:229], v[56:57], v[56:57]
    v_pk_mul_f32 v[230:231], v[58:59], v[58:59]
    v_pk_mul_f32 v[232:233], v[60:61], v[60:61]
    v_pk_mul_f32 v[234:235], v[62:63], v[62:63]
    v_pk_fma_f32 v[228:229], v[228:229], v[112:113], v[104:105]
    v_pk_fma_f32 v[230:231], v[230:231], v[114:115], v[106:107]
    v_pk_fma_f32 v[232:233], v[232:233], v[116:117], v[108:109]
    v_pk_fma_f32 v[234:235], v[234:235], v[118:119], v[110:111]
    v_pk_mul_f32 v[228:229], v[228:229], v[56:57]
    v_pk_mul_f32 v[230:231], v[230:231], v[58:59]
    v_pk_mul_f32 v[232:233], v[232:233], v[60:61]
    v_pk_mul_f32 v[234:235], v[234:235], v[62:63]
    v_exp_f32 v228, v228
    v_exp_f32 v229, v229
    v_exp_f32 v230, v230
    v_exp_f32 v231, v231
    v_exp_f32 v232, v232
    v_exp_f32 v233, v233
    v_exp_f32 v234, v234
    v_exp_f32 v235, v235
    v_pk_fma_f32 v[228:229], v[228:229], v[120:121], v[120:121]
    v_pk_fma_f32 v[230:231], v[230:231], v[122:123], v[122:123]
    v_pk_fma_f32 v[232:233], v[232:233], v[124:125], v[124:125]
    v_pk_fma_f32 v[234:235], v[234:235], v[126:127], v[126:127]
    v_rcp_f32 v228, v228
    v_rcp_f32 v229, v229
    v_rcp_f32 v230, v230
    v_rcp_f32 v231, v231
    v_rcp_f32 v232, v232
    v_rcp_f32 v233, v233
    v_rcp_f32 v234, v234
    v_rcp_f32 v235, v235
    v_pk_mul_f32 v[56:57], v[56:57], v[228:229]
    v_pk_mul_f32 v[58:59], v[58:59], v[230:231]
    v_pk_mul_f32 v[60:61], v[60:61], v[232:233]
    v_pk_mul_f32 v[62:63], v[62:63], v[234:235]
    v_pk_add_f32 v[204:205], v[204:205], v[56:57]
    v_pk_fma_f32 v[206:207], v[56:57], v[56:57], v[206:207]
    v_pk_add_f32 v[208:209], v[208:209], v[58:59]
    v_pk_fma_f32 v[210:211], v[58:59], v[58:59], v[210:211]
    v_pk_add_f32 v[212:213], v[212:213], v[60:61]
    v_pk_fma_f32 v[214:215], v[60:61], v[60:61], v[214:215]
    v_pk_add_f32 v[216:217], v[216:217], v[62:63]
    v_pk_fma_f32 v[218:219], v[62:63], v[62:63], v[218:219]
    v_pk_mul_f32 v[220:221], v[64:65], v[64:65]
    v_pk_mul_f32 v[222:223], v[66:67], v[66:67]
    v_pk_mul_f32 v[224:225], v[68:69], v[68:69]
    v_pk_mul_f32 v[226:227], v[70:71], v[70:71]
    v_pk_fma_f32 v[220:221], v[220:221], v[112:113], v[104:105]
    v_pk_fma_f32 v[222:223], v[222:223], v[114:115], v[106:107]
    v_pk_fma_f32 v[224:225], v[224:225], v[116:117], v[108:109]
    v_pk_fma_f32 v[226:227], v[226:227], v[118:119], v[110:111]
    v_pk_mul_f32 v[220:221], v[220:221], v[64:65]
    v_pk_mul_f32 v[222:223], v[222:223], v[66:67]
    v_pk_mul_f32 v[224:225], v[224:225], v[68:69]
    v_pk_mul_f32 v[226:227], v[226:227], v[70:71]
    v_exp_f32 v220, v220
    v_exp_f32 v221, v221
    v_exp_f32 v222, v222
    v_exp_f32 v223, v223
    v_exp_f32 v224, v224
    v_exp_f32 v225, v225
    v_exp_f32 v226, v226
    v_exp_f32 v227, v227
    v_pk_fma_f32 v[220:221], v[220:221], v[120:121], v[120:121]
    v_pk_fma_f32 v[222:223], v[222:223], v[122:123], v[122:123]
    v_pk_fma_f32 v[224:225], v[224:225], v[124:125], v[124:125]
    v_pk_fma_f32 v[226:227], v[226:227], v[126:127], v[126:127]
    v_rcp_f32 v220, v220
    v_rcp_f32 v221, v221
    v_rcp_f32 v222, v222
    v_rcp_f32 v223, v223
    v_rcp_f32 v224, v224
    v_rcp_f32 v225, v225
    v_rcp_f32 v226, v226
    v_rcp_f32 v227, v227
    v_pk_mul_f32 v[64:65], v[64:65], v[220:221]
    v_pk_mul_f32 v[66:67], v[66:67], v[222:223]
    v_pk_mul_f32 v[68:69], v[68:69], v[224:225]
    v_pk_mul_f32 v[70:71], v[70:71], v[226:227]
    v_pk_add_f32 v[204:205], v[204:205], v[64:65]
    v_pk_fma_f32 v[206:207], v[64:65], v[64:65], v[206:207]
    v_pk_add_f32 v[208:209], v[208:209], v[66:67]
    v_pk_fma_f32 v[210:211], v[66:67], v[66:67], v[210:211]
    v_pk_add_f32 v[212:213], v[212:213], v[68:69]
    v_pk_fma_f32 v[214:215], v[68:69], v[68:69], v[214:215]
    v_pk_add_f32 v[216:217], v[216:217], v[70:71]
    v_pk_fma_f32 v[218:219], v[70:71], v[70:71], v[218:219]
    v_pk_mul_f32 v[228:229], v[72:73], v[72:73]
    v_pk_mul_f32 v[230:231], v[74:75], v[74:75]
    v_pk_mul_f32 v[232:233], v[76:77], v[76:77]
    v_pk_mul_f32 v[234:235], v[78:79], v[78:79]
    v_pk_fma_f32 v[228:229], v[228:229], v[112:113], v[104:105]
    v_pk_fma_f32 v[230:231], v[230:231], v[114:115], v[106:107]
    v_pk_fma_f32 v[232:233], v[232:233], v[116:117], v[108:109]
    v_pk_fma_f32 v[234:235], v[234:235], v[118:119], v[110:111]
    v_pk_mul_f32 v[228:229], v[228:229], v[72:73]
    v_pk_mul_f32 v[230:231], v[230:231], v[74:75]
    v_pk_mul_f32 v[232:233], v[232:233], v[76:77]
    v_pk_mul_f32 v[234:235], v[234:235], v[78:79]
    v_exp_f32 v228, v228
    v_exp_f32 v229, v229
    v_exp_f32 v230, v230
    v_exp_f32 v231, v231
    v_exp_f32 v232, v232
    v_exp_f32 v233, v233
    v_exp_f32 v234, v234
    v_exp_f32 v235, v235
    v_pk_fma_f32 v[228:229], v[228:229], v[120:121], v[120:121]
    v_pk_fma_f32 v[230:231], v[230:231], v[122:123], v[122:123]
    v_pk_fma_f32 v[232:233], v[232:233], v[124:125], v[124:125]
    v_pk_fma_f32 v[234:235], v[234:235], v[126:127], v[126:127]
    v_rcp_f32 v228, v228
    v_rcp_f32 v229, v229
    v_rcp_f32 v230, v230
    v_rcp_f32 v231, v231
    v_rcp_f32 v232, v232
    v_rcp_f32 v233, v233
    v_rcp_f32 v234, v234
    v_rcp_f32 v235, v235
    v_pk_mul_f32 v[72:73], v[72:73], v[228:229]
    v_pk_mul_f32 v[74:75], v[74:75], v[230:231]
    v_pk_mul_f32 v[76:77], v[76:77], v[232:233]
    v_pk_mul_f32 v[78:79], v[78:79], v[234:235]
    v_pk_add_f32 v[204:205], v[204:205], v[72:73]
    v_pk_fma_f32 v[206:207], v[72:73], v[72:73], v[206:207]
    v_pk_add_f32 v[208:209], v[208:209], v[74:75]
    v_pk_fma_f32 v[210:211], v[74:75], v[74:75], v[210:211]
    v_pk_add_f32 v[212:213], v[212:213], v[76:77]
    v_pk_fma_f32 v[214:215], v[76:77], v[76:77], v[214:215]
    v_pk_add_f32 v[216:217], v[216:217], v[78:79]
    v_pk_fma_f32 v[218:219], v[78:79], v[78:79], v[218:219]
    v_pk_mul_f32 v[220:221], v[80:81], v[80:81]
    v_pk_mul_f32 v[222:223], v[82:83], v[82:83]
    v_pk_mul_f32 v[224:225], v[84:85], v[84:85]
    v_pk_mul_f32 v[226:227], v[86:87], v[86:87]
    v_pk_fma_f32 v[220:221], v[220:221], v[112:113], v[104:105]
    v_pk_fma_f32 v[222:223], v[222:223], v[114:115], v[106:107]
    v_pk_fma_f32 v[224:225], v[224:225], v[116:117], v[108:109]
    v_pk_fma_f32 v[226:227], v[226:227], v[118:119], v[110:111]
    v_pk_mul_f32 v[220:221], v[220:221], v[80:81]
    v_pk_mul_f32 v[222:223], v[222:223], v[82:83]
    v_pk_mul_f32 v[224:225], v[224:225], v[84:85]
    v_pk_mul_f32 v[226:227], v[226:227], v[86:87]
    v_exp_f32 v220, v220
    v_exp_f32 v221, v221
    v_exp_f32 v222, v222
    v_exp_f32 v223, v223
    v_exp_f32 v224, v224
    v_exp_f32 v225, v225
    v_exp_f32 v226, v226
    v_exp_f32 v227, v227
    v_pk_fma_f32 v[220:221], v[220:221], v[120:121], v[120:121]
    v_pk_fma_f32 v[222:223], v[222:223], v[122:123], v[122:123]
    v_pk_fma_f32 v[224:225], v[224:225], v[124:125], v[124:125]
    v_pk_fma_f32 v[226:227], v[226:227], v[126:127], v[126:127]
    v_rcp_f32 v220, v220
    v_rcp_f32 v221, v221
    v_rcp_f32 v222, v222
    v_rcp_f32 v223, v223
    v_rcp_f32 v224, v224
    v_rcp_f32 v225, v225
    v_rcp_f32 v226, v226
    v_rcp_f32 v227, v227
    v_pk_mul_f32 v[80:81], v[80:81], v[220:221]
    v_pk_mul_f32 v[82:83], v[82:83], v[222:223]
    v_pk_mul_f32 v[84:85], v[84:85], v[224:225]
    v_pk_mul_f32 v[86:87], v[86:87], v[226:227]
    v_pk_add_f32 v[204:205], v[204:205], v[80:81]
    v_pk_fma_f32 v[206:207], v[80:81], v[80:81], v[206:207]
    v_pk_add_f32 v[208:209], v[208:209], v[82:83]
    v_pk_fma_f32 v[210:211], v[82:83], v[82:83], v[210:211]
    v_pk_add_f32 v[212:213], v[212:213], v[84:85]
    v_pk_fma_f32 v[214:215], v[84:85], v[84:85], v[214:215]
    v_pk_add_f32 v[216:217], v[216:217], v[86:87]
    v_pk_fma_f32 v[218:219], v[86:87], v[86:87], v[218:219]
    v_add_f32_dpp v204, v204, v204 row_mirror row_mask:0xf bank_mask:0x3
    v_add_f32_dpp v205, v205, v205 row_mirror row_mask:0xf bank_mask:0x3
    v_add_f32_dpp v206, v206, v206 row_mirror row_mask:0xf bank_mask:0x3
    v_add_f32_dpp v207, v207, v207 row_mirror row_mask:0xf bank_mask:0x3
    v_add_f32_dpp v208, v208, v208 row_mirror row_mask:0xf bank_mask:0x3
    v_add_f32_dpp v209, v209, v209 row_mirror row_mask:0xf bank_mask:0x3
    v_add_f32_dpp v210, v210, v210 row_mirror row_mask:0xf bank_mask:0x3
    v_add_f32_dpp v211, v211, v211 row_mirror row_mask:0xf bank_mask:0x3
    v_add_f32_dpp v204, v212, v212 row_mirror row_mask:0xf bank_mask:0xc
    v_add_f32_dpp v205, v213, v213 row_mirror row_mask:0xf bank_mask:0xc
    v_add_f32_dpp v206, v214, v214 row_mirror row_mask:0xf bank_mask:0xc
    v_add_f32_dpp v207, v215, v215 row_mirror row_mask:0xf bank_mask:0xc
    v_add_f32_dpp v208, v216, v216 row_mirror row_mask:0xf bank_mask:0xc
    v_add_f32_dpp v209, v217, v217 row_mirror row_mask:0xf bank_mask:0xc
    v_add_f32_dpp v210, v218, v218 row_mirror row_mask:0xf bank_mask:0xc
    v_add_f32_dpp v211, v219, v219 row_mirror row_mask:0xf bank_mask:0xc
    v_add_f32_dpp v204, v204, v204 row_half_mirror row_mask:0xf bank_mask:0x5
    v_add_f32_dpp v205, v205, v205 row_half_mirror row_mask:0xf bank_mask:0x5
    v_add_f32_dpp v206, v206, v206 row_half_mirror row_mask:0xf bank_mask:0x5
    v_add_f32_dpp v207, v207, v207 row_half_mirror row_mask:0xf bank_mask:0x5
    v_add_f32_dpp v204, v208, v208 row_half_mirror row_mask:0xf bank_mask:0xa
    v_add_f32_dpp v205, v209, v209 row_half_mirror row_mask:0xf bank_mask:0xa
    v_add_f32_dpp v206, v210, v210 row_half_mirror row_mask:0xf bank_mask:0xa
    v_add_f32_dpp v207, v211, v211 row_half_mirror row_mask:0xf bank_mask:0xa
    v_add_f32_dpp v204, v204, v204 quad_perm:[1,0,3,2] row_mask:0xf bank_mask:0xf
    v_add_f32_dpp v205, v205, v205 quad_perm:[1,0,3,2] row_mask:0xf bank_mask:0xf
    v_add_f32_dpp v206, v206, v206 quad_perm:[1,0,3,2] row_mask:0xf bank_mask:0xf
    v_add_f32_dpp v207, v207, v207 quad_perm:[1,0,3,2] row_mask:0xf bank_mask:0xf
    v_add_f32_dpp v12, v204, v204 quad_perm:[2,3,0,1] row_mask:0xf bank_mask:0xf
    v_add_f32_dpp v14, v205, v205 quad_perm:[2,3,0,1] row_mask:0xf bank_mask:0xf
    v_add_f32_dpp v13, v206, v206 quad_perm:[2,3,0,1] row_mask:0xf bank_mask:0xf
    v_add_f32_dpp v15, v207, v207 quad_perm:[2,3,0,1] row_mask:0xf bank_mask:0xf
    buffer_store_dwordx4 v[12:15], v8, s[4:7], s36 offen sc1
    s_waitcnt lgkmcnt(5)
    v_mfma_f32_16x16x32_bf16 v[88:91], v[168:171], v[160:163], 0
    ds_read_b128 v[204:207], v3 offset:37888
    v_mfma_f32_16x16x32_bf16 v[92:95], v[168:171], v[164:167], 0
    ds_read_b128 v[208:211], v3 offset:39936
    v_mfma_f32_16x16x32_bf16 v[96:99], v[172:175], v[160:163], 0
    ds_read_b128 v[212:215], v1 offset:46080
    v_mfma_f32_16x16x32_bf16 v[100:103], v[172:175], v[164:167], 0
    ds_read_b128 v[216:219], v1 offset:47104
    v_mfma_f32_16x16x32_bf16 v[104:107], v[176:179], v[160:163], 0
    ds_read_b128 v[220:223], v1 offset:48128
    v_mfma_f32_16x16x32_bf16 v[108:111], v[176:179], v[164:167], 0
    ds_read_b128 v[224:227], v1 offset:49152
    v_mfma_f32_16x16x32_bf16 v[112:115], v[180:183], v[160:163], 0
    ds_read_b128 v[228:231], v1 offset:50176
    v_mfma_f32_16x16x32_bf16 v[116:119], v[180:183], v[164:167], 0
    ds_read_b128 v[232:235], v1 offset:51200
    s_waitcnt lgkmcnt(8)
    v_mfma_f32_16x16x32_bf16 v[120:123], v[184:187], v[160:163], 0
    ds_read_b128 v[236:239], v1 offset:52224
    v_mfma_f32_16x16x32_bf16 v[124:127], v[184:187], v[164:167], 0
    ds_read_b128 v[240:243], v1 offset:53248
    v_mfma_f32_16x16x32_bf16 v[128:131], v[188:191], v[160:163], 0
    ds_read_b128 v[244:247], v1 offset:54272
    v_mfma_f32_16x16x32_bf16 v[132:135], v[188:191], v[164:167], 0
    v_mfma_f32_16x16x32_bf16 v[136:139], v[192:195], v[160:163], 0
    v_lshrrev_b32 v255, 8, v1
    v_mfma_f32_16x16x32_bf16 v[140:143], v[192:195], v[164:167], 0
    v_lshl_add_u32 v255, v255, 6, s33
    v_mfma_f32_16x16x32_bf16 v[144:147], v[196:199], v[160:163], 0
    v_mfma_f32_16x16x32_bf16 v[148:151], v[196:199], v[164:167], 0
    v_mfma_f32_16x16x32_bf16 v[152:155], v[200:203], v[160:163], 0
    v_mfma_f32_16x16x32_bf16 v[156:159], v[200:203], v[164:167], 0
    s_waitcnt lgkmcnt(0)
    s_barrier
    v_mfma_f32_16x16x32_bf16 v[88:91], v[212:215], v[204:207], v[88:91]
    ds_read_b128 v[160:163], v0 offset:0
    v_mfma_f32_16x16x32_bf16 v[92:95], v[212:215], v[208:211], v[92:95]
    ds_read_b128 v[164:167], v0 offset:2048
    v_mfma_f32_16x16x32_bf16 v[96:99], v[216:219], v[204:207], v[96:99]
    ds_read_b128 v[168:171], v2 offset:0
    v_mfma_f32_16x16x32_bf16 v[100:103], v[216:219], v[208:211], v[100:103]
    ds_read_b128 v[172:175], v2 offset:1024
    v_mfma_f32_16x16x32_bf16 v[104:107], v[220:223], v[204:207], v[104:107]
    ds_read_b128 v[176:179], v2 offset:2048
    v_mfma_f32_16x16x32_bf16 v[108:111], v[220:223], v[208:211], v[108:111]
    ds_read_b128 v[180:183], v2 offset:3072
    v_mfma_f32_16x16x32_bf16 v[112:115], v[224:227], v[204:207], v[112:115]
    ds_read_b128 v[184:187], v2 offset:4096
    v_mfma_f32_16x16x32_bf16 v[116:119], v[224:227], v[208:211], v[116:119]
    ds_read_b128 v[188:191], v2 offset:5120
    v_mfma_f32_16x16x32_bf16 v[120:123], v[228:231], v[204:207], v[120:123]
    ds_read_b128 v[192:195], v2 offset:6144
    v_mfma_f32_16x16x32_bf16 v[124:127], v[228:231], v[208:211], v[124:127]
    ds_read_b128 v[196:199], v2 offset:7168
    v_mfma_f32_16x16x32_bf16 v[128:131], v[232:235], v[204:207], v[128:131]
    ds_read_b128 v[200:203], v2 offset:8192
    v_mfma_f32_16x16x32_bf16 v[132:135], v[232:235], v[208:211], v[132:135]
    v_mfma_f32_16x16x32_bf16 v[136:139], v[236:239], v[204:207], v[136:139]
    v_mfma_f32_16x16x32_bf16 v[140:143], v[236:239], v[208:211], v[140:143]
    v_mfma_f32_16x16x32_bf16 v[144:147], v[240:243], v[204:207], v[144:147]
    v_mfma_f32_16x16x32_bf16 v[148:151], v[240:243], v[208:211], v[148:151]
    v_mfma_f32_16x16x32_bf16 v[152:155], v[244:247], v[204:207], v[152:155]
    v_mfma_f32_16x16x32_bf16 v[156:159], v[244:247], v[208:211], v[156:159]
    s_waitcnt lgkmcnt(5)
    v_mfma_f32_16x16x32_bf16 v[88:91], v[168:171], v[160:163], v[88:91]
    ds_read_b128 v[204:207], v0 offset:1024
    v_mfma_f32_16x16x32_bf16 v[92:95], v[168:171], v[164:167], v[92:95]
    ds_read_b128 v[208:211], v0 offset:3072
    v_mfma_f32_16x16x32_bf16 v[96:99], v[172:175], v[160:163], v[96:99]
    ds_read_b128 v[212:215], v2 offset:9216
    v_mfma_f32_16x16x32_bf16 v[100:103], v[172:175], v[164:167], v[100:103]
    ds_read_b128 v[216:219], v2 offset:10240
    v_mfma_f32_16x16x32_bf16 v[104:107], v[176:179], v[160:163], v[104:107]
    ds_read_b128 v[220:223], v2 offset:11264
    v_mfma_f32_16x16x32_bf16 v[108:111], v[176:179], v[164:167], v[108:111]
    ds_read_b128 v[224:227], v2 offset:12288
    v_mfma_f32_16x16x32_bf16 v[112:115], v[180:183], v[160:163], v[112:115]
    ds_read_b128 v[228:231], v2 offset:13312
    v_mfma_f32_16x16x32_bf16 v[116:119], v[180:183], v[164:167], v[116:119]
    ds_read_b128 v[232:235], v2 offset:14336
    s_waitcnt lgkmcnt(8)
    v_mfma_f32_16x16x32_bf16 v[120:123], v[184:187], v[160:163], v[120:123]
    ds_read_b128 v[236:239], v2 offset:15360
    v_mfma_f32_16x16x32_bf16 v[124:127], v[184:187], v[164:167], v[124:127]
    ds_read_b128 v[240:243], v2 offset:16384
    v_mfma_f32_16x16x32_bf16 v[128:131], v[188:191], v[160:163], v[128:131]
    ds_read_b128 v[244:247], v2 offset:17408
    v_mfma_f32_16x16x32_bf16 v[132:135], v[188:191], v[164:167], v[132:135]
    v_mfma_f32_16x16x32_bf16 v[136:139], v[192:195], v[160:163], v[136:139]
    v_mfma_f32_16x16x32_bf16 v[140:143], v[192:195], v[164:167], v[140:143]
    v_mfma_f32_16x16x32_bf16 v[144:147], v[196:199], v[160:163], v[144:147]
    v_mfma_f32_16x16x32_bf16 v[148:151], v[196:199], v[164:167], v[148:151]
    v_mfma_f32_16x16x32_bf16 v[152:155], v[200:203], v[160:163], v[152:155]
    v_mfma_f32_16x16x32_bf16 v[156:159], v[200:203], v[164:167], v[156:159]
    s_waitcnt lgkmcnt(0)
    s_barrier
    v_mfma_f32_16x16x32_bf16 v[88:91], v[212:215], v[204:207], v[88:91]
    ds_read_b128 v[160:163], v0 offset:36864
    v_mfma_f32_16x16x32_bf16 v[92:95], v[212:215], v[208:211], v[92:95]
    ds_read_b128 v[164:167], v0 offset:38912
    v_mfma_f32_16x16x32_bf16 v[96:99], v[216:219], v[204:207], v[96:99]
    ds_read_b128 v[168:171], v2 offset:36864
    v_mfma_f32_16x16x32_bf16 v[100:103], v[216:219], v[208:211], v[100:103]
    ds_read_b128 v[172:175], v2 offset:37888
    v_mfma_f32_16x16x32_bf16 v[104:107], v[220:223], v[204:207], v[104:107]
    ds_read_b128 v[176:179], v2 offset:38912
    v_mfma_f32_16x16x32_bf16 v[108:111], v[220:223], v[208:211], v[108:111]
    ds_read_b128 v[180:183], v2 offset:39936
    v_mfma_f32_16x16x32_bf16 v[112:115], v[224:227], v[204:207], v[112:115]
    ds_read_b128 v[184:187], v2 offset:40960
    v_mfma_f32_16x16x32_bf16 v[116:119], v[224:227], v[208:211], v[116:119]
    ds_read_b128 v[188:191], v2 offset:41984
    v_mfma_f32_16x16x32_bf16 v[120:123], v[228:231], v[204:207], v[120:123]
    ds_read_b128 v[192:195], v2 offset:43008
    v_mfma_f32_16x16x32_bf16 v[124:127], v[228:231], v[208:211], v[124:127]
    ds_read_b128 v[196:199], v2 offset:44032
    v_mfma_f32_16x16x32_bf16 v[128:131], v[232:235], v[204:207], v[128:131]
    ds_read_b128 v[200:203], v2 offset:45056
    v_mfma_f32_16x16x32_bf16 v[132:135], v[232:235], v[208:211], v[132:135]
    v_mfma_f32_16x16x32_bf16 v[136:139], v[236:239], v[204:207], v[136:139]
    v_mfma_f32_16x16x32_bf16 v[140:143], v[236:239], v[208:211], v[140:143]
    v_mfma_f32_16x16x32_bf16 v[144:147], v[240:243], v[204:207], v[144:147]
    v_mfma_f32_16x16x32_bf16 v[148:151], v[240:243], v[208:211], v[148:151]
    v_mfma_f32_16x16x32_bf16 v[152:155], v[244:247], v[204:207], v[152:155]
    v_mfma_f32_16x16x32_bf16 v[156:159], v[244:247], v[208:211], v[156:159]
    s_waitcnt lgkmcnt(5)
    v_mfma_f32_16x16x32_bf16 v[88:91], v[168:171], v[160:163], v[88:91]
    ds_read_b128 v[204:207], v0 offset:37888
    v_mfma_f32_16x16x32_bf16 v[92:95], v[168:171], v[164:167], v[92:95]
    ds_read_b128 v[208:211], v0 offset:39936
    v_mfma_f32_16x16x32_bf16 v[96:99], v[172:175], v[160:163], v[96:99]
    ds_read_b128 v[212:215], v2 offset:46080
    v_mfma_f32_16x16x32_bf16 v[100:103], v[172:175], v[164:167], v[100:103]
    ds_read_b128 v[216:219], v2 offset:47104
    v_mfma_f32_16x16x32_bf16 v[104:107], v[176:179], v[160:163], v[104:107]
    ds_read_b128 v[220:223], v2 offset:48128
    v_mfma_f32_16x16x32_bf16 v[108:111], v[176:179], v[164:167], v[108:111]
    ds_read_b128 v[224:227], v2 offset:49152
    v_mfma_f32_16x16x32_bf16 v[112:115], v[180:183], v[160:163], v[112:115]
    ds_read_b128 v[228:231], v2 offset:50176
    v_mfma_f32_16x16x32_bf16 v[116:119], v[180:183], v[164:167], v[116:119]
    ds_read_b128 v[232:235], v2 offset:51200
    s_waitcnt lgkmcnt(8)
    v_mfma_f32_16x16x32_bf16 v[120:123], v[184:187], v[160:163], v[120:123]
    ds_read_b128 v[236:239], v2 offset:52224
    v_mfma_f32_16x16x32_bf16 v[124:127], v[184:187], v[164:167], v[124:127]
    ds_read_b128 v[240:243], v2 offset:53248
    v_mfma_f32_16x16x32_bf16 v[128:131], v[188:191], v[160:163], v[128:131]
    ds_read_b128 v[244:247], v2 offset:54272
    v_mfma_f32_16x16x32_bf16 v[132:135], v[188:191], v[164:167], v[132:135]
    v_mfma_f32_16x16x32_bf16 v[136:139], v[192:195], v[160:163], v[136:139]
    v_mfma_f32_16x16x32_bf16 v[140:143], v[192:195], v[164:167], v[140:143]
    v_mfma_f32_16x16x32_bf16 v[144:147], v[196:199], v[160:163], v[144:147]
    v_mfma_f32_16x16x32_bf16 v[148:151], v[196:199], v[164:167], v[148:151]
    v_mfma_f32_16x16x32_bf16 v[152:155], v[200:203], v[160:163], v[152:155]
    v_mfma_f32_16x16x32_bf16 v[156:159], v[200:203], v[164:167], v[156:159]
    s_waitcnt lgkmcnt(0)
    s_barrier
    v_mfma_f32_16x16x32_bf16 v[88:91], v[212:215], v[204:207], v[88:91]
    ds_read_b128 v[160:163], v3 offset:0
    v_mfma_f32_16x16x32_bf16 v[92:95], v[212:215], v[208:211], v[92:95]
    ds_read_b128 v[164:167], v3 offset:2048
    v_mfma_f32_16x16x32_bf16 v[96:99], v[216:219], v[204:207], v[96:99]
    ds_read_b128 v[168:171], v1 offset:0
    v_mfma_f32_16x16x32_bf16 v[100:103], v[216:219], v[208:211], v[100:103]
    ds_read_b128 v[172:175], v1 offset:1024
    v_mfma_f32_16x16x32_bf16 v[104:107], v[220:223], v[204:207], v[104:107]
    ds_read_b128 v[176:179], v1 offset:2048
    v_mfma_f32_16x16x32_bf16 v[108:111], v[220:223], v[208:211], v[108:111]
    ds_read_b128 v[180:183], v1 offset:3072
    v_mfma_f32_16x16x32_bf16 v[112:115], v[224:227], v[204:207], v[112:115]
    ds_read_b128 v[184:187], v1 offset:4096
    v_mfma_f32_16x16x32_bf16 v[116:119], v[224:227], v[208:211], v[116:119]
    ds_read_b128 v[188:191], v1 offset:5120
    v_mfma_f32_16x16x32_bf16 v[120:123], v[228:231], v[204:207], v[120:123]
    ds_read_b128 v[192:195], v1 offset:6144
    v_mfma_f32_16x16x32_bf16 v[124:127], v[228:231], v[208:211], v[124:127]
    ds_read_b128 v[196:199], v1 offset:7168
    v_mfma_f32_16x16x32_bf16 v[128:131], v[232:235], v[204:207], v[128:131]
    ds_read_b128 v[200:203], v1 offset:8192
    v_mfma_f32_16x16x32_bf16 v[132:135], v[232:235], v[208:211], v[132:135]
    v_mfma_f32_16x16x32_bf16 v[136:139], v[236:239], v[204:207], v[136:139]
    v_mfma_f32_16x16x32_bf16 v[140:143], v[236:239], v[208:211], v[140:143]
    v_mfma_f32_16x16x32_bf16 v[144:147], v[240:243], v[204:207], v[144:147]
    v_mfma_f32_16x16x32_bf16 v[148:151], v[240:243], v[208:211], v[148:151]
    v_mfma_f32_16x16x32_bf16 v[152:155], v[244:247], v[204:207], v[152:155]
    v_mfma_f32_16x16x32_bf16 v[156:159], v[244:247], v[208:211], v[156:159]
    s_waitcnt lgkmcnt(5)
    v_mfma_f32_16x16x32_bf16 v[88:91], v[168:171], v[160:163], v[88:91]
    ds_read_b128 v[204:207], v3 offset:1024
    v_mfma_f32_16x16x32_bf16 v[92:95], v[168:171], v[164:167], v[92:95]
    ds_read_b128 v[208:211], v3 offset:3072
    v_mfma_f32_16x16x32_bf16 v[96:99], v[172:175], v[160:163], v[96:99]
    ds_read_b128 v[212:215], v1 offset:9216
    v_mfma_f32_16x16x32_bf16 v[100:103], v[172:175], v[164:167], v[100:103]
    ds_read_b128 v[216:219], v1 offset:10240
    v_mfma_f32_16x16x32_bf16 v[104:107], v[176:179], v[160:163], v[104:107]
    ds_read_b128 v[220:223], v1 offset:11264
    v_mfma_f32_16x16x32_bf16 v[108:111], v[176:179], v[164:167], v[108:111]
    ds_read_b128 v[224:227], v1 offset:12288
    v_mfma_f32_16x16x32_bf16 v[112:115], v[180:183], v[160:163], v[112:115]
    ds_read_b128 v[228:231], v1 offset:13312
    v_mfma_f32_16x16x32_bf16 v[116:119], v[180:183], v[164:167], v[116:119]
    ds_read_b128 v[232:235], v1 offset:14336
    s_waitcnt lgkmcnt(8)
    v_mfma_f32_16x16x32_bf16 v[120:123], v[184:187], v[160:163], v[120:123]
    ds_read_b128 v[236:239], v1 offset:15360
    v_mfma_f32_16x16x32_bf16 v[124:127], v[184:187], v[164:167], v[124:127]
    ds_read_b128 v[240:243], v1 offset:16384
    v_mfma_f32_16x16x32_bf16 v[128:131], v[188:191], v[160:163], v[128:131]
    ds_read_b128 v[244:247], v1 offset:17408
    v_mfma_f32_16x16x32_bf16 v[132:135], v[188:191], v[164:167], v[132:135]
    v_mfma_f32_16x16x32_bf16 v[136:139], v[192:195], v[160:163], v[136:139]
    v_mfma_f32_16x16x32_bf16 v[140:143], v[192:195], v[164:167], v[140:143]
    v_mfma_f32_16x16x32_bf16 v[144:147], v[196:199], v[160:163], v[144:147]
    v_mfma_f32_16x16x32_bf16 v[148:151], v[196:199], v[164:167], v[148:151]
    v_mfma_f32_16x16x32_bf16 v[152:155], v[200:203], v[160:163], v[152:155]
    v_mfma_f32_16x16x32_bf16 v[156:159], v[200:203], v[164:167], v[156:159]
    s_waitcnt lgkmcnt(0)
    s_barrier
    v_mfma_f32_16x16x32_bf16 v[88:91], v[212:215], v[204:207], v[88:91]
    ds_read_b128 v[160:163], v3 offset:36864
    v_mfma_f32_16x16x32_bf16 v[92:95], v[212:215], v[208:211], v[92:95]
    ds_read_b128 v[164:167], v3 offset:38912
    v_mfma_f32_16x16x32_bf16 v[96:99], v[216:219], v[204:207], v[96:99]
    ds_read_b128 v[168:171], v1 offset:36864
    v_mfma_f32_16x16x32_bf16 v[100:103], v[216:219], v[208:211], v[100:103]
    ds_read_b128 v[172:175], v1 offset:37888
    v_mfma_f32_16x16x32_bf16 v[104:107], v[220:223], v[204:207], v[104:107]
    ds_read_b128 v[176:179], v1 offset:38912
    v_mfma_f32_16x16x32_bf16 v[108:111], v[220:223], v[208:211], v[108:111]
    ds_read_b128 v[180:183], v1 offset:39936
    v_mfma_f32_16x16x32_bf16 v[112:115], v[224:227], v[204:207], v[112:115]
    ds_read_b128 v[184:187], v1 offset:40960
    v_mfma_f32_16x16x32_bf16 v[116:119], v[224:227], v[208:211], v[116:119]
    ds_read_b128 v[188:191], v1 offset:41984
    v_mfma_f32_16x16x32_bf16 v[120:123], v[228:231], v[204:207], v[120:123]
    ds_read_b128 v[192:195], v1 offset:43008
    v_mfma_f32_16x16x32_bf16 v[124:127], v[228:231], v[208:211], v[124:127]
    ds_read_b128 v[196:199], v1 offset:44032
    v_mfma_f32_16x16x32_bf16 v[128:131], v[232:235], v[204:207], v[128:131]
    ds_read_b128 v[200:203], v1 offset:45056
    v_mfma_f32_16x16x32_bf16 v[132:135], v[232:235], v[208:211], v[132:135]
    ds_read_b128 v[4:7], v255 offset:1024
    v_mfma_f32_16x16x32_bf16 v[136:139], v[236:239], v[204:207], v[136:139]
    ds_read_b128 v[8:11], v255 offset:1040
    v_mfma_f32_16x16x32_bf16 v[140:143], v[236:239], v[208:211], v[140:143]
    ds_read_b128 v[12:15], v255 offset:1056
    v_mfma_f32_16x16x32_bf16 v[144:147], v[240:243], v[204:207], v[144:147]
    ds_read_b128 v[252:255], v255 offset:1072
    v_mfma_f32_16x16x32_bf16 v[148:151], v[240:243], v[208:211], v[148:151]
    v_mfma_f32_16x16x32_bf16 v[152:155], v[244:247], v[204:207], v[152:155]
    v_mfma_f32_16x16x32_bf16 v[156:159], v[244:247], v[208:211], v[156:159]
    s_waitcnt lgkmcnt(9)
    v_mfma_f32_16x16x32_bf16 v[88:91], v[168:171], v[160:163], v[88:91]
    ds_read_b128 v[204:207], v3 offset:37888
    v_mfma_f32_16x16x32_bf16 v[92:95], v[168:171], v[164:167], v[92:95]
    ds_read_b128 v[208:211], v3 offset:39936
    v_mfma_f32_16x16x32_bf16 v[96:99], v[172:175], v[160:163], v[96:99]
    ds_read_b128 v[212:215], v1 offset:46080
    v_mfma_f32_16x16x32_bf16 v[100:103], v[172:175], v[164:167], v[100:103]
    ds_read_b128 v[216:219], v1 offset:47104
    v_mfma_f32_16x16x32_bf16 v[104:107], v[176:179], v[160:163], v[104:107]
    ds_read_b128 v[220:223], v1 offset:48128
    v_mfma_f32_16x16x32_bf16 v[108:111], v[176:179], v[164:167], v[108:111]
    ds_read_b128 v[224:227], v1 offset:49152
    v_mfma_f32_16x16x32_bf16 v[112:115], v[180:183], v[160:163], v[112:115]
    ds_read_b128 v[228:231], v1 offset:50176
    v_mfma_f32_16x16x32_bf16 v[116:119], v[180:183], v[164:167], v[116:119]
    ds_read_b128 v[232:235], v1 offset:51200
    s_waitcnt lgkmcnt(8)
    v_mfma_f32_16x16x32_bf16 v[120:123], v[184:187], v[160:163], v[120:123]
    ds_read_b128 v[236:239], v1 offset:52224
    v_fma_f32 v16, v16, v4, -v6
    v_mfma_f32_16x16x32_bf16 v[124:127], v[184:187], v[164:167], v[124:127]
    ds_read_b128 v[240:243], v1 offset:53248
    v_fma_f32 v17, v17, v5, -v7
    v_mfma_f32_16x16x32_bf16 v[128:131], v[188:191], v[160:163], v[128:131]
    ds_read_b128 v[244:247], v1 offset:54272
    v_fma_f32 v18, v18, v8, -v10
    v_mfma_f32_16x16x32_bf16 v[132:135], v[188:191], v[164:167], v[132:135]
    v_fma_f32 v19, v19, v9, -v11
    v_fma_f32 v20, v20, v12, -v14
    v_mfma_f32_16x16x32_bf16 v[136:139], v[192:195], v[160:163], v[136:139]
    v_fma_f32 v21, v21, v13, -v15
    v_fma_f32 v22, v22, v252, -v254
    v_mfma_f32_16x16x32_bf16 v[140:143], v[192:195], v[164:167], v[140:143]
    v_fma_f32 v23, v23, v253, -v255
    v_cvt_pk_bf16_f32 v16, v16, v17
    v_mfma_f32_16x16x32_bf16 v[144:147], v[196:199], v[160:163], v[144:147]
    v_cvt_pk_bf16_f32 v17, v18, v19
    v_cvt_pk_bf16_f32 v18, v20, v21
    v_mfma_f32_16x16x32_bf16 v[148:151], v[196:199], v[164:167], v[148:151]
    v_cvt_pk_bf16_f32 v19, v22, v23
    v_fma_f32 v24, v24, v4, -v6
    v_mfma_f32_16x16x32_bf16 v[152:155], v[200:203], v[160:163], v[152:155]
    v_fma_f32 v25, v25, v5, -v7
    v_fma_f32 v26, v26, v8, -v10
    v_mfma_f32_16x16x32_bf16 v[156:159], v[200:203], v[164:167], v[156:159]
    v_fma_f32 v27, v27, v9, -v11
    s_waitcnt lgkmcnt(0)
    s_barrier
    v_mfma_f32_16x16x32_bf16 v[88:91], v[212:215], v[204:207], v[88:91]
    ds_read_b128 v[160:163], v0 offset:0
    v_mfma_f32_16x16x32_bf16 v[92:95], v[212:215], v[208:211], v[92:95]
    ds_read_b128 v[164:167], v0 offset:2048
    v_fma_f32 v28, v28, v12, -v14
    v_mfma_f32_16x16x32_bf16 v[96:99], v[216:219], v[204:207], v[96:99]
    ds_read_b128 v[168:171], v2 offset:0
    v_fma_f32 v29, v29, v13, -v15
    v_mfma_f32_16x16x32_bf16 v[100:103], v[216:219], v[208:211], v[100:103]
    ds_read_b128 v[172:175], v2 offset:1024
    v_fma_f32 v30, v30, v252, -v254
    v_mfma_f32_16x16x32_bf16 v[104:107], v[220:223], v[204:207], v[104:107]
    ds_read_b128 v[176:179], v2 offset:2048
    v_fma_f32 v31, v31, v253, -v255
    v_mfma_f32_16x16x32_bf16 v[108:111], v[220:223], v[208:211], v[108:111]
    ds_read_b128 v[180:183], v2 offset:3072
    v_permlane32_swap_b32 v16, v18
    v_mfma_f32_16x16x32_bf16 v[112:115], v[224:227], v[204:207], v[112:115]
    ds_read_b128 v[184:187], v2 offset:4096
    v_permlane32_swap_b32 v17, v19
    v_mfma_f32_16x16x32_bf16 v[116:119], v[224:227], v[208:211], v[116:119]
    ds_read_b128 v[188:191], v2 offset:5120
    v_mfma_f32_16x16x32_bf16 v[120:123], v[228:231], v[204:207], v[120:123]
    ds_read_b128 v[192:195], v2 offset:6144
    v_cvt_pk_bf16_f32 v24, v24, v25
    v_mfma_f32_16x16x32_bf16 v[124:127], v[228:231], v[208:211], v[124:127]
    ds_read_b128 v[196:199], v2 offset:7168
    v_cvt_pk_bf16_f32 v25, v26, v27
    v_mfma_f32_16x16x32_bf16 v[128:131], v[232:235], v[204:207], v[128:131]
    ds_read_b128 v[200:203], v2 offset:8192
    v_cvt_pk_bf16_f32 v26, v28, v29
    v_mfma_f32_16x16x32_bf16 v[132:135], v[232:235], v[208:211], v[132:135]
    v_cvt_pk_bf16_f32 v27, v30, v31
    v_permlane16_swap_b32 v16, v18
    v_mfma_f32_16x16x32_bf16 v[136:139], v[236:239], v[204:207], v[136:139]
    v_permlane16_swap_b32 v17, v19
    v_fma_f32 v32, v32, v4, -v6
    v_mfma_f32_16x16x32_bf16 v[140:143], v[236:239], v[208:211], v[140:143]
    v_fma_f32 v33, v33, v5, -v7
    v_fma_f32 v34, v34, v8, -v10
    v_mfma_f32_16x16x32_bf16 v[144:147], v[240:243], v[204:207], v[144:147]
    v_fma_f32 v35, v35, v9, -v11
    v_fma_f32 v36, v36, v12, -v14
    v_mfma_f32_16x16x32_bf16 v[148:151], v[240:243], v[208:211], v[148:151]
    v_fma_f32 v37, v37, v13, -v15
    v_fma_f32 v38, v38, v252, -v254
    v_mfma_f32_16x16x32_bf16 v[152:155], v[244:247], v[204:207], v[152:155]
    v_fma_f32 v39, v39, v253, -v255
    v_permlane32_swap_b32 v24, v26
    v_mfma_f32_16x16x32_bf16 v[156:159], v[244:247], v[208:211], v[156:159]
    v_permlane32_swap_b32 v25, v27
    s_waitcnt lgkmcnt(5)
    v_mfma_f32_16x16x32_bf16 v[88:91], v[168:171], v[160:163], v[88:91]
    ds_read_b128 v[204:207], v0 offset:1024
    v_mfma_f32_16x16x32_bf16 v[92:95], v[168:171], v[164:167], v[92:95]
    ds_read_b128 v[208:211], v0 offset:3072
    v_cvt_pk_bf16_f32 v32, v32, v33
    v_mfma_f32_16x16x32_bf16 v[96:99], v[172:175], v[160:163], v[96:99]
    ds_read_b128 v[212:215], v2 offset:9216
    v_cvt_pk_bf16_f32 v33, v34, v35
    v_mfma_f32_16x16x32_bf16 v[100:103], v[172:175], v[164:167], v[100:103]
    ds_read_b128 v[216:219], v2 offset:10240
    v_cvt_pk_bf16_f32 v34, v36, v37
    v_mfma_f32_16x16x32_bf16 v[104:107], v[176:179], v[160:163], v[104:107]
    ds_read_b128 v[220:223], v2 offset:11264
    v_cvt_pk_bf16_f32 v35, v38, v39
    v_mfma_f32_16x16x32_bf16 v[108:111], v[176:179], v[164:167], v[108:111]
    ds_read_b128 v[224:227], v2 offset:12288
    v_permlane16_swap_b32 v24, v26
    v_mfma_f32_16x16x32_bf16 v[112:115], v[180:183], v[160:163], v[112:115]
    ds_read_b128 v[228:231], v2 offset:13312
    v_permlane16_swap_b32 v25, v27
    v_mfma_f32_16x16x32_bf16 v[116:119], v[180:183], v[164:167], v[116:119]
    ds_read_b128 v[232:235], v2 offset:14336
    s_waitcnt lgkmcnt(8)
    v_mfma_f32_16x16x32_bf16 v[120:123], v[184:187], v[160:163], v[120:123]
    ds_read_b128 v[236:239], v2 offset:15360
    v_fma_f32 v40, v40, v4, -v6
    v_mfma_f32_16x16x32_bf16 v[124:127], v[184:187], v[164:167], v[124:127]
    ds_read_b128 v[240:243], v2 offset:16384
    v_fma_f32 v41, v41, v5, -v7
    v_mfma_f32_16x16x32_bf16 v[128:131], v[188:191], v[160:163], v[128:131]
    ds_read_b128 v[244:247], v2 offset:17408
    v_fma_f32 v42, v42, v8, -v10
    v_mfma_f32_16x16x32_bf16 v[132:135], v[188:191], v[164:167], v[132:135]
    v_fma_f32 v43, v43, v9, -v11
    v_fma_f32 v44, v44, v12, -v14
    v_mfma_f32_16x16x32_bf16 v[136:139], v[192:195], v[160:163], v[136:139]
    v_fma_f32 v45, v45, v13, -v15
    v_fma_f32 v46, v46, v252, -v254
    v_mfma_f32_16x16x32_bf16 v[140:143], v[192:195], v[164:167], v[140:143]
    v_fma_f32 v47, v47, v253, -v255
    v_permlane32_swap_b32 v32, v34
    v_mfma_f32_16x16x32_bf16 v[144:147], v[196:199], v[160:163], v[144:147]
    v_permlane32_swap_b32 v33, v35
    v_cvt_pk_bf16_f32 v40, v40, v41
    v_mfma_f32_16x16x32_bf16 v[148:151], v[196:199], v[164:167], v[148:151]
    v_cvt_pk_bf16_f32 v41, v42, v43
    v_cvt_pk_bf16_f32 v42, v44, v45
    v_mfma_f32_16x16x32_bf16 v[152:155], v[200:203], v[160:163], v[152:155]
    v_cvt_pk_bf16_f32 v43, v46, v47
    v_permlane16_swap_b32 v32, v34
    v_mfma_f32_16x16x32_bf16 v[156:159], v[200:203], v[164:167], v[156:159]
    v_permlane16_swap_b32 v33, v35
    s_waitcnt lgkmcnt(0)
    s_barrier
    v_mfma_f32_16x16x32_bf16 v[88:91], v[212:215], v[204:207], v[88:91]
    ds_read_b128 v[160:163], v0 offset:36864
    v_mfma_f32_16x16x32_bf16 v[92:95], v[212:215], v[208:211], v[92:95]
    ds_read_b128 v[164:167], v0 offset:38912
    v_fma_f32 v48, v48, v4, -v6
    v_mfma_f32_16x16x32_bf16 v[96:99], v[216:219], v[204:207], v[96:99]
    ds_read_b128 v[168:171], v2 offset:36864
    v_fma_f32 v49, v49, v5, -v7
    v_mfma_f32_16x16x32_bf16 v[100:103], v[216:219], v[208:211], v[100:103]
    ds_read_b128 v[172:175], v2 offset:37888
    v_fma_f32 v50, v50, v8, -v10
    v_mfma_f32_16x16x32_bf16 v[104:107], v[220:223], v[204:207], v[104:107]
    ds_read_b128 v[176:179], v2 offset:38912
    v_fma_f32 v51, v51, v9, -v11
    v_mfma_f32_16x16x32_bf16 v[108:111], v[220:223], v[208:211], v[108:111]
    ds_read_b128 v[180:183], v2 offset:39936
    v_fma_f32 v52, v52, v12, -v14
    v_mfma_f32_16x16x32_bf16 v[112:115], v[224:227], v[204:207], v[112:115]
    ds_read_b128 v[184:187], v2 offset:40960
    v_fma_f32 v53, v53, v13, -v15
    v_mfma_f32_16x16x32_bf16 v[116:119], v[224:227], v[208:211], v[116:119]
    ds_read_b128 v[188:191], v2 offset:41984
    v_mfma_f32_16x16x32_bf16 v[120:123], v[228:231], v[204:207], v[120:123]
    ds_read_b128 v[192:195], v2 offset:43008
    v_fma_f32 v54, v54, v252, -v254
    v_mfma_f32_16x16x32_bf16 v[124:127], v[228:231], v[208:211], v[124:127]
    ds_read_b128 v[196:199], v2 offset:44032
    v_fma_f32 v55, v55, v253, -v255
    v_mfma_f32_16x16x32_bf16 v[128:131], v[232:235], v[204:207], v[128:131]
    ds_read_b128 v[200:203], v2 offset:45056
    v_permlane32_swap_b32 v40, v42
    v_mfma_f32_16x16x32_bf16 v[132:135], v[232:235], v[208:211], v[132:135]
    v_permlane32_swap_b32 v41, v43
    v_cvt_pk_bf16_f32 v48, v48, v49
    v_mfma_f32_16x16x32_bf16 v[136:139], v[236:239], v[204:207], v[136:139]
    v_cvt_pk_bf16_f32 v49, v50, v51
    v_cvt_pk_bf16_f32 v50, v52, v53
    v_mfma_f32_16x16x32_bf16 v[140:143], v[236:239], v[208:211], v[140:143]
    v_cvt_pk_bf16_f32 v51, v54, v55
    v_permlane16_swap_b32 v40, v42
    v_mfma_f32_16x16x32_bf16 v[144:147], v[240:243], v[204:207], v[144:147]
    v_permlane16_swap_b32 v41, v43
    v_fma_f32 v56, v56, v4, -v6
    v_mfma_f32_16x16x32_bf16 v[148:151], v[240:243], v[208:211], v[148:151]
    v_fma_f32 v57, v57, v5, -v7
    v_fma_f32 v58, v58, v8, -v10
    v_mfma_f32_16x16x32_bf16 v[152:155], v[244:247], v[204:207], v[152:155]
    v_fma_f32 v59, v59, v9, -v11
    v_fma_f32 v60, v60, v12, -v14
    v_mfma_f32_16x16x32_bf16 v[156:159], v[244:247], v[208:211], v[156:159]
    v_fma_f32 v61, v61, v13, -v15
    s_waitcnt lgkmcnt(5)
    v_mfma_f32_16x16x32_bf16 v[88:91], v[168:171], v[160:163], v[88:91]
    ds_read_b128 v[204:207], v0 offset:37888
    v_mfma_f32_16x16x32_bf16 v[92:95], v[168:171], v[164:167], v[92:95]
    ds_read_b128 v[208:211], v0 offset:39936
    v_fma_f32 v62, v62, v252, -v254
    v_mfma_f32_16x16x32_bf16 v[96:99], v[172:175], v[160:163], v[96:99]
    ds_read_b128 v[212:215], v2 offset:46080
    buffer_store_dwordx4 v[16:19], v1, s[4:7], s38 offen offset:0 sc1
    v_fma_f32 v63, v63, v253, -v255
    v_mfma_f32_16x16x32_bf16 v[100:103], v[172:175], v[164:167], v[100:103]
    ds_read_b128 v[216:219], v2 offset:47104
    v_permlane32_swap_b32 v48, v50
    v_mfma_f32_16x16x32_bf16 v[104:107], v[176:179], v[160:163], v[104:107]
    ds_read_b128 v[220:223], v2 offset:48128
    v_permlane32_swap_b32 v49, v51
    v_mfma_f32_16x16x32_bf16 v[108:111], v[176:179], v[164:167], v[108:111]
    ds_read_b128 v[224:227], v2 offset:49152
    v_cvt_pk_bf16_f32 v56, v56, v57
    v_mfma_f32_16x16x32_bf16 v[112:115], v[180:183], v[160:163], v[112:115]
    ds_read_b128 v[228:231], v2 offset:50176
    v_cvt_pk_bf16_f32 v57, v58, v59
    v_mfma_f32_16x16x32_bf16 v[116:119], v[180:183], v[164:167], v[116:119]
    ds_read_b128 v[232:235], v2 offset:51200
    s_waitcnt lgkmcnt(8)
    buffer_store_dwordx4 v[24:27], v1, s[4:7], s38 offen offset:1024 sc1
    v_mfma_f32_16x16x32_bf16 v[120:123], v[184:187], v[160:163], v[120:123]
    ds_read_b128 v[236:239], v2 offset:52224
    v_cvt_pk_bf16_f32 v58, v60, v61
    v_mfma_f32_16x16x32_bf16 v[124:127], v[184:187], v[164:167], v[124:127]
    ds_read_b128 v[240:243], v2 offset:53248
    v_cvt_pk_bf16_f32 v59, v62, v63
    v_mfma_f32_16x16x32_bf16 v[128:131], v[188:191], v[160:163], v[128:131]
    ds_read_b128 v[244:247], v2 offset:54272
    v_permlane16_swap_b32 v48, v50
    v_mfma_f32_16x16x32_bf16 v[132:135], v[188:191], v[164:167], v[132:135]
    v_permlane16_swap_b32 v49, v51
    v_fma_f32 v64, v64, v4, -v6
    v_mfma_f32_16x16x32_bf16 v[136:139], v[192:195], v[160:163], v[136:139]
    buffer_store_dwordx4 v[32:35], v1, s[4:7], s38 offen offset:2048 sc1
    v_fma_f32 v65, v65, v5, -v7
    v_fma_f32 v66, v66, v8, -v10
    v_mfma_f32_16x16x32_bf16 v[140:143], v[192:195], v[164:167], v[140:143]
    v_fma_f32 v67, v67, v9, -v11
    v_fma_f32 v68, v68, v12, -v14
    v_mfma_f32_16x16x32_bf16 v[144:147], v[196:199], v[160:163], v[144:147]
    v_fma_f32 v69, v69, v13, -v15
    v_fma_f32 v70, v70, v252, -v254
    v_mfma_f32_16x16x32_bf16 v[148:151], v[196:199], v[164:167], v[148:151]
    v_fma_f32 v71, v71, v253, -v255
    v_permlane32_swap_b32 v56, v58
    v_mfma_f32_16x16x32_bf16 v[152:155], v[200:203], v[160:163], v[152:155]
    v_permlane32_swap_b32 v57, v59
    v_cvt_pk_bf16_f32 v64, v64, v65
    v_mfma_f32_16x16x32_bf16 v[156:159], v[200:203], v[164:167], v[156:159]
    v_cvt_pk_bf16_f32 v65, v66, v67
    s_waitcnt lgkmcnt(0)
    s_barrier
    v_mfma_f32_16x16x32_bf16 v[88:91], v[212:215], v[204:207], v[88:91]
    ds_read_b128 v[160:163], v3 offset:0
    v_mfma_f32_16x16x32_bf16 v[92:95], v[212:215], v[208:211], v[92:95]
    ds_read_b128 v[164:167], v3 offset:2048
    v_cvt_pk_bf16_f32 v66, v68, v69
    v_mfma_f32_16x16x32_bf16 v[96:99], v[216:219], v[204:207], v[96:99]
    ds_read_b128 v[168:171], v1 offset:0
    buffer_store_dwordx4 v[40:43], v1, s[4:7], s38 offen offset:3072 sc1
    v_cvt_pk_bf16_f32 v67, v70, v71
    v_mfma_f32_16x16x32_bf16 v[100:103], v[216:219], v[208:211], v[100:103]
    ds_read_b128 v[172:175], v1 offset:1024
    v_permlane16_swap_b32 v56, v58
    v_mfma_f32_16x16x32_bf16 v[104:107], v[220:223], v[204:207], v[104:107]
    ds_read_b128 v[176:179], v1 offset:2048
    v_permlane16_swap_b32 v57, v59
    v_mfma_f32_16x16x32_bf16 v[108:111], v[220:223], v[208:211], v[108:111]
    ds_read_b128 v[180:183], v1 offset:3072
    v_fma_f32 v72, v72, v4, -v6
    v_mfma_f32_16x16x32_bf16 v[112:115], v[224:227], v[204:207], v[112:115]
    ds_read_b128 v[184:187], v1 offset:4096
    v_fma_f32 v73, v73, v5, -v7
    v_mfma_f32_16x16x32_bf16 v[116:119], v[224:227], v[208:211], v[116:119]
    ds_read_b128 v[188:191], v1 offset:5120
    buffer_store_dwordx4 v[48:51], v1, s[4:7], s39 offen offset:0 sc1
    v_mfma_f32_16x16x32_bf16 v[120:123], v[228:231], v[204:207], v[120:123]
    ds_read_b128 v[192:195], v1 offset:6144
    v_fma_f32 v74, v74, v8, -v10
    v_mfma_f32_16x16x32_bf16 v[124:127], v[228:231], v[208:211], v[124:127]
    ds_read_b128 v[196:199], v1 offset:7168
    v_fma_f32 v75, v75, v9, -v11
    v_mfma_f32_16x16x32_bf16 v[128:131], v[232:235], v[204:207], v[128:131]
    ds_read_b128 v[200:203], v1 offset:8192
    v_fma_f32 v76, v76, v12, -v14
    v_mfma_f32_16x16x32_bf16 v[132:135], v[232:235], v[208:211], v[132:135]
    v_fma_f32 v77, v77, v13, -v15
    v_fma_f32 v78, v78, v252, -v254
    v_mfma_f32_16x16x32_bf16 v[136:139], v[236:239], v[204:207], v[136:139]
    v_fma_f32 v79, v79, v253, -v255
    v_permlane32_swap_b32 v64, v66
    v_mfma_f32_16x16x32_bf16 v[140:143], v[236:239], v[208:211], v[140:143]
    v_permlane32_swap_b32 v65, v67
    v_cvt_pk_bf16_f32 v72, v72, v73
    v_mfma_f32_16x16x32_bf16 v[144:147], v[240:243], v[204:207], v[144:147]
    v_cvt_pk_bf16_f32 v73, v74, v75
    v_cvt_pk_bf16_f32 v74, v76, v77
    v_mfma_f32_16x16x32_bf16 v[148:151], v[240:243], v[208:211], v[148:151]
    v_cvt_pk_bf16_f32 v75, v78, v79
    v_permlane16_swap_b32 v64, v66
    v_mfma_f32_16x16x32_bf16 v[152:155], v[244:247], v[204:207], v[152:155]
    v_permlane16_swap_b32 v65, v67
    v_fma_f32 v80, v80, v4, -v6
    v_mfma_f32_16x16x32_bf16 v[156:159], v[244:247], v[208:211], v[156:159]
    v_fma_f32 v81, v81, v5, -v7
    s_waitcnt lgkmcnt(5)
    v_mfma_f32_16x16x32_bf16 v[88:91], v[168:171], v[160:163], v[88:91]
    ds_read_b128 v[204:207], v3 offset:1024
    v_mfma_f32_16x16x32_bf16 v[92:95], v[168:171], v[164:167], v[92:95]
    ds_read_b128 v[208:211], v3 offset:3072
    v_fma_f32 v82, v82, v8, -v10
    v_mfma_f32_16x16x32_bf16 v[96:99], v[172:175], v[160:163], v[96:99]
    ds_read_b128 v[212:215], v1 offset:9216
    buffer_store_dwordx4 v[56:59], v1, s[4:7], s39 offen offset:1024 sc1
    v_fma_f32 v83, v83, v9, -v11
    v_mfma_f32_16x16x32_bf16 v[100:103], v[172:175], v[164:167], v[100:103]
    ds_read_b128 v[216:219], v1 offset:10240
    v_fma_f32 v84, v84, v12, -v14
    v_mfma_f32_16x16x32_bf16 v[104:107], v[176:179], v[160:163], v[104:107]
    ds_read_b128 v[220:223], v1 offset:11264
    v_fma_f32 v85, v85, v13, -v15
    v_mfma_f32_16x16x32_bf16 v[108:111], v[176:179], v[164:167], v[108:111]
    ds_read_b128 v[224:227], v1 offset:12288
    v_fma_f32 v86, v86, v252, -v254
    v_mfma_f32_16x16x32_bf16 v[112:115], v[180:183], v[160:163], v[112:115]
    ds_read_b128 v[228:231], v1 offset:13312
    v_fma_f32 v87, v87, v253, -v255
    v_mfma_f32_16x16x32_bf16 v[116:119], v[180:183], v[164:167], v[116:119]
    ds_read_b128 v[232:235], v1 offset:14336
    s_waitcnt lgkmcnt(8)
    buffer_store_dwordx4 v[64:67], v1, s[4:7], s39 offen offset:2048 sc1
    v_mfma_f32_16x16x32_bf16 v[120:123], v[184:187], v[160:163], v[120:123]
    ds_read_b128 v[236:239], v1 offset:15360
    v_permlane32_swap_b32 v72, v74
    v_mfma_f32_16x16x32_bf16 v[124:127], v[184:187], v[164:167], v[124:127]
    ds_read_b128 v[240:243], v1 offset:16384
    v_permlane32_swap_b32 v73, v75
    v_mfma_f32_16x16x32_bf16 v[128:131], v[188:191], v[160:163], v[128:131]
    ds_read_b128 v[244:247], v1 offset:17408
    v_cvt_pk_bf16_f32 v80, v80, v81
    v_mfma_f32_16x16x32_bf16 v[132:135], v[188:191], v[164:167], v[132:135]
    v_cvt_pk_bf16_f32 v81, v82, v83
    v_cvt_pk_bf16_f32 v82, v84, v85
    v_mfma_f32_16x16x32_bf16 v[136:139], v[192:195], v[160:163], v[136:139]
    v_cvt_pk_bf16_f32 v83, v86, v87
    v_permlane16_swap_b32 v72, v74
    v_mfma_f32_16x16x32_bf16 v[140:143], v[192:195], v[164:167], v[140:143]
    v_permlane16_swap_b32 v73, v75
    s_nop 0
    v_mfma_f32_16x16x32_bf16 v[144:147], v[196:199], v[160:163], v[144:147]
    v_permlane32_swap_b32 v80, v82
    v_permlane32_swap_b32 v81, v83
    v_mfma_f32_16x16x32_bf16 v[148:151], v[196:199], v[164:167], v[148:151]
    s_nop 0
    v_permlane16_swap_b32 v80, v82
    v_mfma_f32_16x16x32_bf16 v[152:155], v[200:203], v[160:163], v[152:155]
    v_permlane16_swap_b32 v81, v83
    v_mul_f32 v4, s40, v249
    v_mfma_f32_16x16x32_bf16 v[156:159], v[200:203], v[164:167], v[156:159]
    v_mul_f32 v6, s40, v251
    s_waitcnt lgkmcnt(0)
    s_barrier
    v_mfma_f32_16x16x32_bf16 v[88:91], v[212:215], v[204:207], v[88:91]
    ds_read_b128 v[160:163], v3 offset:36864
    v_mfma_f32_16x16x32_bf16 v[92:95], v[212:215], v[208:211], v[92:95]
    ds_read_b128 v[164:167], v3 offset:38912
    v_mul_f32 v5, v249, v249
    v_mfma_f32_16x16x32_bf16 v[96:99], v[216:219], v[204:207], v[96:99]
    ds_read_b128 v[168:171], v1 offset:36864
    buffer_store_dwordx4 v[72:75], v1, s[4:7], s39 offen offset:3072 sc1
    v_mul_f32 v7, v251, v251
    v_mfma_f32_16x16x32_bf16 v[100:103], v[216:219], v[208:211], v[100:103]
    ds_read_b128 v[172:175], v1 offset:37888
    v_rcp_f32 v249, v249
    v_mfma_f32_16x16x32_bf16 v[104:107], v[220:223], v[204:207], v[104:107]
    ds_read_b128 v[176:179], v1 offset:38912
    v_rcp_f32 v251, v251
    v_mfma_f32_16x16x32_bf16 v[108:111], v[220:223], v[208:211], v[108:111]
    ds_read_b128 v[180:183], v1 offset:39936
    v_mul_f32 v5, s42, v5
    v_mfma_f32_16x16x32_bf16 v[112:115], v[224:227], v[204:207], v[112:115]
    ds_read_b128 v[184:187], v1 offset:40960
    v_mul_f32 v7, s42, v7
    v_mfma_f32_16x16x32_bf16 v[116:119], v[224:227], v[208:211], v[116:119]
    ds_read_b128 v[188:191], v1 offset:41984
    buffer_store_dwordx4 v[80:83], v1, s[4:7], s46 offen offset:0 sc1
    v_mfma_f32_16x16x32_bf16 v[120:123], v[228:231], v[204:207], v[120:123]
    ds_read_b128 v[192:195], v1 offset:43008
    v_mul_f32 v5, v5, v4
    v_mfma_f32_16x16x32_bf16 v[124:127], v[228:231], v[208:211], v[124:127]
    ds_read_b128 v[196:199], v1 offset:44032
    v_mul_f32 v7, v7, v6
    v_mfma_f32_16x16x32_bf16 v[128:131], v[232:235], v[204:207], v[128:131]
    ds_read_b128 v[200:203], v1 offset:45056
    v_bfe_u32 v13, v1, 4, 4
    v_mfma_f32_16x16x32_bf16 v[132:135], v[232:235], v[208:211], v[132:135]
    v_lshrrev_b32 v8, 1, v13
    v_lshrrev_b32 v9, 8, v1
    v_mfma_f32_16x16x32_bf16 v[136:139], v[236:239], v[204:207], v[136:139]
    v_xor_b32 v8, v8, v9
    v_lshlrev_b32 v8, 4, v8
    v_mfma_f32_16x16x32_bf16 v[140:143], v[236:239], v[208:211], v[140:143]
    v_lshl_add_u32 v8, v13, 7, v8
    s_add_u32 s33, s30, 18432
    v_mfma_f32_16x16x32_bf16 v[144:147], v[240:243], v[204:207], v[144:147]
    v_add_u32 v8, s33, v8
    v_xor_b32 v9, 64, v8
    v_mfma_f32_16x16x32_bf16 v[148:151], v[240:243], v[208:211], v[148:151]
    v_add_u32 v10, 73728, v8
    v_add_u32 v11, 73728, v9
    v_mfma_f32_16x16x32_bf16 v[152:155], v[244:247], v[204:207], v[152:155]
    s_lshl_b32 s33, s20, 6
    s_add_u32 s33, s33, 161280
    v_mfma_f32_16x16x32_bf16 v[156:159], v[244:247], v[208:211], v[156:159]
    v_lshl_add_u32 v13, v13, 1, s33
    s_waitcnt lgkmcnt(5)
    v_mfma_f32_16x16x32_bf16 v[88:91], v[168:171], v[160:163], v[88:91]
    ds_read_b128 v[204:207], v3 offset:37888
    v_mfma_f32_16x16x32_bf16 v[92:95], v[168:171], v[164:167], v[92:95]
    ds_read_b128 v[208:211], v3 offset:39936
    v_mfma_f32_16x16x32_bf16 v[96:99], v[172:175], v[160:163], v[96:99]
    ds_read_b128 v[212:215], v1 offset:46080
    v_mfma_f32_16x16x32_bf16 v[100:103], v[172:175], v[164:167], v[100:103]
    ds_read_b128 v[216:219], v1 offset:47104
    v_mfma_f32_16x16x32_bf16 v[104:107], v[176:179], v[160:163], v[104:107]
    ds_read_b128 v[220:223], v1 offset:48128
    v_mfma_f32_16x16x32_bf16 v[108:111], v[176:179], v[164:167], v[108:111]
    ds_read_b128 v[224:227], v1 offset:49152
    v_mfma_f32_16x16x32_bf16 v[112:115], v[180:183], v[160:163], v[112:115]
    ds_read_b128 v[228:231], v1 offset:50176
    v_mfma_f32_16x16x32_bf16 v[116:119], v[180:183], v[164:167], v[116:119]
    ds_read_b128 v[232:235], v1 offset:51200
    s_waitcnt lgkmcnt(8)
    v_mfma_f32_16x16x32_bf16 v[120:123], v[184:187], v[160:163], v[120:123]
    ds_read_b128 v[236:239], v1 offset:52224
    v_mfma_f32_16x16x32_bf16 v[124:127], v[184:187], v[164:167], v[124:127]
    ds_read_b128 v[240:243], v1 offset:53248
    v_mfma_f32_16x16x32_bf16 v[128:131], v[188:191], v[160:163], v[128:131]
    ds_read_b128 v[244:247], v1 offset:54272
    v_mfma_f32_16x16x32_bf16 v[132:135], v[188:191], v[164:167], v[132:135]
    v_mfma_f32_16x16x32_bf16 v[136:139], v[192:195], v[160:163], v[136:139]
    v_lshrrev_b32 v0, 4, v1
    v_mfma_f32_16x16x32_bf16 v[140:143], v[192:195], v[164:167], v[140:143]
    v_and_b32 v0, 48, v0
    v_mfma_f32_16x16x32_bf16 v[144:147], v[196:199], v[160:163], v[144:147]
    v_add_u32 v0, 160320, v0
    v_mfma_f32_16x16x32_bf16 v[148:151], v[196:199], v[164:167], v[148:151]
    v_mfma_f32_16x16x32_bf16 v[152:155], v[200:203], v[160:163], v[152:155]
    v_mfma_f32_16x16x32_bf16 v[156:159], v[200:203], v[164:167], v[156:159]
    s_waitcnt lgkmcnt(0)
    v_mfma_f32_16x16x32_bf16 v[88:91], v[212:215], v[204:207], v[88:91]
    ds_read_b128 v[168:171], v0 offset:0
    v_mfma_f32_16x16x32_bf16 v[92:95], v[212:215], v[208:211], v[92:95]
    ds_read_b128 v[172:175], v0 offset:64
    v_mfma_f32_16x16x32_bf16 v[96:99], v[216:219], v[204:207], v[96:99]
    ds_read_b128 v[176:179], v0 offset:128
    v_mfma_f32_16x16x32_bf16 v[100:103], v[216:219], v[208:211], v[100:103]
    ds_read_b128 v[180:183], v0 offset:192
    v_mfma_f32_16x16x32_bf16 v[104:107], v[220:223], v[204:207], v[104:107]
    ds_read_b128 v[184:187], v0 offset:256
    v_mfma_f32_16x16x32_bf16 v[108:111], v[220:223], v[208:211], v[108:111]
    ds_read_b128 v[188:191], v0 offset:320
    v_mfma_f32_16x16x32_bf16 v[112:115], v[224:227], v[204:207], v[112:115]
    ds_read_b128 v[192:195], v0 offset:384
    v_mfma_f32_16x16x32_bf16 v[116:119], v[224:227], v[208:211], v[116:119]
    ds_read_b128 v[196:199], v0 offset:448
    v_mfma_f32_16x16x32_bf16 v[120:123], v[228:231], v[204:207], v[120:123]
    ds_read_b128 v[200:203], v0 offset:512
    v_mfma_f32_16x16x32_bf16 v[124:127], v[228:231], v[208:211], v[124:127]
    ds_read_u16 v12, v13
    v_mfma_f32_16x16x32_bf16 v[128:131], v[232:235], v[204:207], v[128:131]
    ds_read_u16 v252, v13 offset:32
    v_mfma_f32_16x16x32_bf16 v[132:135], v[232:235], v[208:211], v[132:135]
    v_mfma_f32_16x16x32_bf16 v[136:139], v[236:239], v[204:207], v[136:139]
    s_lshr_b32 s35, s20, 1
    s_mul_i32 s35, s35, 36864
    v_mfma_f32_16x16x32_bf16 v[140:143], v[236:239], v[208:211], v[140:143]
    s_and_b32 s34, s20, 1
    s_mul_i32 s34, s34, 9216
    v_mfma_f32_16x16x32_bf16 v[144:147], v[240:243], v[204:207], v[144:147]
    s_add_u32 s35, s35, s34
    v_mfma_f32_16x16x32_bf16 v[148:151], v[240:243], v[208:211], v[148:151]
    v_add_u32 v3, s35, v2
    v_mfma_f32_16x16x32_bf16 v[152:155], v[244:247], v[204:207], v[152:155]
    v_mfma_f32_16x16x32_bf16 v[156:159], v[244:247], v[208:211], v[156:159]
    s_waitcnt vmcnt(0)
    s_barrier
    s_waitcnt lgkmcnt(0)
    v_lshlrev_b32 v15, 16, v12
    v_lshlrev_b32 v255, 16, v252
    v_lshlrev_b32 v14, 16, v12
    v_lshlrev_b32 v254, 16, v252
    v_lshlrev_b32 v13, 16, v12
    v_lshlrev_b32 v253, 16, v252
    v_lshlrev_b32 v12, 16, v12
    v_lshlrev_b32 v252, 16, v252
    ds_write_b128 v3, v[16:19] offset:0
    v_pk_fma_f32 v[88:89], v[248:249], v[168:169], v[88:89] op_sel_hi:[0,1,1] neg_lo:[1,0,0] neg_hi:[1,0,0]
    v_pk_fma_f32 v[90:91], v[248:249], v[170:171], v[90:91] op_sel_hi:[0,1,1] neg_lo:[1,0,0] neg_hi:[1,0,0]
    v_pk_fma_f32 v[92:93], v[250:251], v[168:169], v[92:93] op_sel_hi:[0,1,1] neg_lo:[1,0,0] neg_hi:[1,0,0]
    v_pk_fma_f32 v[94:95], v[250:251], v[170:171], v[94:95] op_sel_hi:[0,1,1] neg_lo:[1,0,0] neg_hi:[1,0,0]
    ds_write_b128 v3, v[24:27] offset:1024
    v_pk_fma_f32 v[96:97], v[248:249], v[172:173], v[96:97] op_sel_hi:[0,1,1] neg_lo:[1,0,0] neg_hi:[1,0,0]
    v_pk_fma_f32 v[98:99], v[248:249], v[174:175], v[98:99] op_sel_hi:[0,1,1] neg_lo:[1,0,0] neg_hi:[1,0,0]
    v_pk_fma_f32 v[100:101], v[250:251], v[172:173], v[100:101] op_sel_hi:[0,1,1] neg_lo:[1,0,0] neg_hi:[1,0,0]
    v_pk_fma_f32 v[102:103], v[250:251], v[174:175], v[102:103] op_sel_hi:[0,1,1] neg_lo:[1,0,0] neg_hi:[1,0,0]
    ds_write_b128 v3, v[32:35] offset:2048
    v_pk_fma_f32 v[104:105], v[248:249], v[176:177], v[104:105] op_sel_hi:[0,1,1] neg_lo:[1,0,0] neg_hi:[1,0,0]
    v_pk_fma_f32 v[106:107], v[248:249], v[178:179], v[106:107] op_sel_hi:[0,1,1] neg_lo:[1,0,0] neg_hi:[1,0,0]
    v_pk_fma_f32 v[108:109], v[250:251], v[176:177], v[108:109] op_sel_hi:[0,1,1] neg_lo:[1,0,0] neg_hi:[1,0,0]
    v_pk_fma_f32 v[110:111], v[250:251], v[178:179], v[110:111] op_sel_hi:[0,1,1] neg_lo:[1,0,0] neg_hi:[1,0,0]
    ds_write_b128 v3, v[40:43] offset:3072
    v_pk_fma_f32 v[112:113], v[248:249], v[180:181], v[112:113] op_sel_hi:[0,1,1] neg_lo:[1,0,0] neg_hi:[1,0,0]
    v_pk_fma_f32 v[114:115], v[248:249], v[182:183], v[114:115] op_sel_hi:[0,1,1] neg_lo:[1,0,0] neg_hi:[1,0,0]
    v_pk_fma_f32 v[116:117], v[250:251], v[180:181], v[116:117] op_sel_hi:[0,1,1] neg_lo:[1,0,0] neg_hi:[1,0,0]
    v_pk_fma_f32 v[118:119], v[250:251], v[182:183], v[118:119] op_sel_hi:[0,1,1] neg_lo:[1,0,0] neg_hi:[1,0,0]
    ds_write_b128 v3, v[48:51] offset:4096
    v_pk_fma_f32 v[120:121], v[248:249], v[184:185], v[120:121] op_sel_hi:[0,1,1] neg_lo:[1,0,0] neg_hi:[1,0,0]
    v_pk_fma_f32 v[122:123], v[248:249], v[186:187], v[122:123] op_sel_hi:[0,1,1] neg_lo:[1,0,0] neg_hi:[1,0,0]
    v_pk_fma_f32 v[124:125], v[250:251], v[184:185], v[124:125] op_sel_hi:[0,1,1] neg_lo:[1,0,0] neg_hi:[1,0,0]
    v_pk_fma_f32 v[126:127], v[250:251], v[186:187], v[126:127] op_sel_hi:[0,1,1] neg_lo:[1,0,0] neg_hi:[1,0,0]
    ds_write_b128 v3, v[56:59] offset:5120
    v_pk_fma_f32 v[128:129], v[248:249], v[188:189], v[128:129] op_sel_hi:[0,1,1] neg_lo:[1,0,0] neg_hi:[1,0,0]
    v_pk_fma_f32 v[130:131], v[248:249], v[190:191], v[130:131] op_sel_hi:[0,1,1] neg_lo:[1,0,0] neg_hi:[1,0,0]
    v_pk_fma_f32 v[132:133], v[250:251], v[188:189], v[132:133] op_sel_hi:[0,1,1] neg_lo:[1,0,0] neg_hi:[1,0,0]
    v_pk_fma_f32 v[134:135], v[250:251], v[190:191], v[134:135] op_sel_hi:[0,1,1] neg_lo:[1,0,0] neg_hi:[1,0,0]
    ds_write_b128 v3, v[64:67] offset:6144
    v_pk_fma_f32 v[136:137], v[248:249], v[192:193], v[136:137] op_sel_hi:[0,1,1] neg_lo:[1,0,0] neg_hi:[1,0,0]
    v_pk_fma_f32 v[138:139], v[248:249], v[194:195], v[138:139] op_sel_hi:[0,1,1] neg_lo:[1,0,0] neg_hi:[1,0,0]
    v_pk_fma_f32 v[140:141], v[250:251], v[192:193], v[140:141] op_sel_hi:[0,1,1] neg_lo:[1,0,0] neg_hi:[1,0,0]
    v_pk_fma_f32 v[142:143], v[250:251], v[194:195], v[142:143] op_sel_hi:[0,1,1] neg_lo:[1,0,0] neg_hi:[1,0,0]
    ds_write_b128 v3, v[72:75] offset:7168
    v_pk_fma_f32 v[144:145], v[248:249], v[196:197], v[144:145] op_sel_hi:[0,1,1] neg_lo:[1,0,0] neg_hi:[1,0,0]
    v_pk_fma_f32 v[146:147], v[248:249], v[198:199], v[146:147] op_sel_hi:[0,1,1] neg_lo:[1,0,0] neg_hi:[1,0,0]
    v_pk_fma_f32 v[148:149], v[250:251], v[196:197], v[148:149] op_sel_hi:[0,1,1] neg_lo:[1,0,0] neg_hi:[1,0,0]
    v_pk_fma_f32 v[150:151], v[250:251], v[198:199], v[150:151] op_sel_hi:[0,1,1] neg_lo:[1,0,0] neg_hi:[1,0,0]
    ds_write_b128 v3, v[80:83] offset:8192
    v_pk_fma_f32 v[152:153], v[248:249], v[200:201], v[152:153] op_sel_hi:[0,1,1] neg_lo:[1,0,0] neg_hi:[1,0,0]
    v_pk_fma_f32 v[154:155], v[248:249], v[202:203], v[154:155] op_sel_hi:[0,1,1] neg_lo:[1,0,0] neg_hi:[1,0,0]
    v_pk_fma_f32 v[156:157], v[250:251], v[200:201], v[156:157] op_sel_hi:[0,1,1] neg_lo:[1,0,0] neg_hi:[1,0,0]
    v_pk_fma_f32 v[158:159], v[250:251], v[202:203], v[158:159] op_sel_hi:[0,1,1] neg_lo:[1,0,0] neg_hi:[1,0,0]
    v_pk_mul_f32 v[204:205], v[88:89], v[88:89]
    v_pk_mul_f32 v[206:207], v[90:91], v[90:91]
    v_pk_mul_f32 v[208:209], v[92:93], v[92:93]
    v_pk_mul_f32 v[210:211], v[94:95], v[94:95]
    v_pk_fma_f32 v[204:205], v[204:205], v[4:5], v[4:5] op_sel:[0,1,0] op_sel_hi:[1,1,0]
    v_pk_fma_f32 v[206:207], v[206:207], v[4:5], v[4:5] op_sel:[0,1,0] op_sel_hi:[1,1,0]
    v_pk_fma_f32 v[208:209], v[208:209], v[6:7], v[6:7] op_sel:[0,1,0] op_sel_hi:[1,1,0]
    v_pk_fma_f32 v[210:211], v[210:211], v[6:7], v[6:7] op_sel:[0,1,0] op_sel_hi:[1,1,0]
    v_pk_mul_f32 v[204:205], v[204:205], v[88:89]
    v_pk_mul_f32 v[206:207], v[206:207], v[90:91]
    v_pk_mul_f32 v[208:209], v[208:209], v[92:93]
    v_pk_mul_f32 v[210:211], v[210:211], v[94:95]
    v_exp_f32 v204, v204
    v_exp_f32 v205, v205
    v_exp_f32 v206, v206
    v_exp_f32 v207, v207
    v_exp_f32 v208, v208
    v_exp_f32 v209, v209
    v_exp_f32 v210, v210
    v_exp_f32 v211, v211
    v_pk_fma_f32 v[204:205], v[204:205], v[248:249], v[248:249] op_sel:[0,1,1] op_sel_hi:[1,1,1]
    v_pk_fma_f32 v[206:207], v[206:207], v[248:249], v[248:249] op_sel:[0,1,1] op_sel_hi:[1,1,1]
    v_pk_fma_f32 v[208:209], v[208:209], v[250:251], v[250:251] op_sel:[0,1,1] op_sel_hi:[1,1,1]
    v_pk_fma_f32 v[210:211], v[210:211], v[250:251], v[250:251] op_sel:[0,1,1] op_sel_hi:[1,1,1]
    v_rcp_f32 v204, v204
    v_rcp_f32 v205, v205
    v_rcp_f32 v206, v206
    v_rcp_f32 v207, v207
    v_rcp_f32 v208, v208
    v_rcp_f32 v209, v209
    v_rcp_f32 v210, v210
    v_rcp_f32 v211, v211
    v_pk_mul_f32 v[88:89], v[88:89], v[204:205]
    v_pk_mul_f32 v[90:91], v[90:91], v[206:207]
    v_pk_mul_f32 v[92:93], v[92:93], v[208:209]
    v_pk_mul_f32 v[94:95], v[94:95], v[210:211]
    v_pk_mul_f32 v[212:213], v[96:97], v[96:97]
    v_pk_mul_f32 v[214:215], v[98:99], v[98:99]
    v_pk_mul_f32 v[216:217], v[100:101], v[100:101]
    v_pk_mul_f32 v[218:219], v[102:103], v[102:103]
    v_pk_fma_f32 v[212:213], v[212:213], v[4:5], v[4:5] op_sel:[0,1,0] op_sel_hi:[1,1,0]
    v_pk_fma_f32 v[214:215], v[214:215], v[4:5], v[4:5] op_sel:[0,1,0] op_sel_hi:[1,1,0]
    v_pk_fma_f32 v[216:217], v[216:217], v[6:7], v[6:7] op_sel:[0,1,0] op_sel_hi:[1,1,0]
    v_pk_fma_f32 v[218:219], v[218:219], v[6:7], v[6:7] op_sel:[0,1,0] op_sel_hi:[1,1,0]
    v_pk_mul_f32 v[212:213], v[212:213], v[96:97]
    v_pk_mul_f32 v[214:215], v[214:215], v[98:99]
    v_pk_mul_f32 v[216:217], v[216:217], v[100:101]
    v_pk_mul_f32 v[218:219], v[218:219], v[102:103]
    v_exp_f32 v212, v212
    v_exp_f32 v213, v213
    v_exp_f32 v214, v214
    v_exp_f32 v215, v215
    v_exp_f32 v216, v216
    v_exp_f32 v217, v217
    v_exp_f32 v218, v218
    v_exp_f32 v219, v219
    v_pk_fma_f32 v[212:213], v[212:213], v[248:249], v[248:249] op_sel:[0,1,1] op_sel_hi:[1,1,1]
    v_pk_fma_f32 v[214:215], v[214:215], v[248:249], v[248:249] op_sel:[0,1,1] op_sel_hi:[1,1,1]
    v_pk_fma_f32 v[216:217], v[216:217], v[250:251], v[250:251] op_sel:[0,1,1] op_sel_hi:[1,1,1]
    v_pk_fma_f32 v[218:219], v[218:219], v[250:251], v[250:251] op_sel:[0,1,1] op_sel_hi:[1,1,1]
    v_rcp_f32 v212, v212
    v_rcp_f32 v213, v213
    v_rcp_f32 v214, v214
    v_rcp_f32 v215, v215
    v_rcp_f32 v216, v216
    v_rcp_f32 v217, v217
    v_rcp_f32 v218, v218
    v_rcp_f32 v219, v219
    v_pk_mul_f32 v[96:97], v[96:97], v[212:213]
    v_pk_mul_f32 v[98:99], v[98:99], v[214:215]
    v_pk_mul_f32 v[100:101], v[100:101], v[216:217]
    v_pk_mul_f32 v[102:103], v[102:103], v[218:219]
    v_pk_mul_f32 v[204:205], v[104:105], v[104:105]
    v_pk_mul_f32 v[206:207], v[106:107], v[106:107]
    v_pk_mul_f32 v[208:209], v[108:109], v[108:109]
    v_pk_mul_f32 v[210:211], v[110:111], v[110:111]
    v_pk_fma_f32 v[204:205], v[204:205], v[4:5], v[4:5] op_sel:[0,1,0] op_sel_hi:[1,1,0]
    v_pk_fma_f32 v[206:207], v[206:207], v[4:5], v[4:5] op_sel:[0,1,0] op_sel_hi:[1,1,0]
    v_pk_fma_f32 v[208:209], v[208:209], v[6:7], v[6:7] op_sel:[0,1,0] op_sel_hi:[1,1,0]
    v_pk_fma_f32 v[210:211], v[210:211], v[6:7], v[6:7] op_sel:[0,1,0] op_sel_hi:[1,1,0]
    v_pk_mul_f32 v[204:205], v[204:205], v[104:105]
    v_pk_mul_f32 v[206:207], v[206:207], v[106:107]
    v_pk_mul_f32 v[208:209], v[208:209], v[108:109]
    v_pk_mul_f32 v[210:211], v[210:211], v[110:111]
    v_exp_f32 v204, v204
    v_exp_f32 v205, v205
    v_exp_f32 v206, v206
    v_exp_f32 v207, v207
    v_exp_f32 v208, v208
    v_exp_f32 v209, v209
    v_exp_f32 v210, v210
    v_exp_f32 v211, v211
    v_pk_fma_f32 v[204:205], v[204:205], v[248:249], v[248:249] op_sel:[0,1,1] op_sel_hi:[1,1,1]
    v_pk_fma_f32 v[206:207], v[206:207], v[248:249], v[248:249] op_sel:[0,1,1] op_sel_hi:[1,1,1]
    v_pk_fma_f32 v[208:209], v[208:209], v[250:251], v[250:251] op_sel:[0,1,1] op_sel_hi:[1,1,1]
    v_pk_fma_f32 v[210:211], v[210:211], v[250:251], v[250:251] op_sel:[0,1,1] op_sel_hi:[1,1,1]
    v_rcp_f32 v204, v204
    v_rcp_f32 v205, v205
    v_rcp_f32 v206, v206
    v_rcp_f32 v207, v207
    v_rcp_f32 v208, v208
    v_rcp_f32 v209, v209
    v_rcp_f32 v210, v210
    v_rcp_f32 v211, v211
    v_pk_mul_f32 v[104:105], v[104:105], v[204:205]
    v_pk_mul_f32 v[106:107], v[106:107], v[206:207]
    v_pk_mul_f32 v[108:109], v[108:109], v[208:209]
    v_pk_mul_f32 v[110:111], v[110:111], v[210:211]
    s_waitcnt lgkmcnt(0)
    s_barrier
    ds_read_b128 v[160:163], v10 offset:0
    ds_read_b128 v[164:167], v10 offset:2048
    ds_read_b128 v[168:171], v2 offset:0
    ds_read_b128 v[172:175], v2 offset:1024
    ds_read_b128 v[176:179], v2 offset:2048
    ds_read_b128 v[180:183], v2 offset:3072
    ds_read_b128 v[184:187], v2 offset:4096
    ds_read_b128 v[188:191], v2 offset:5120
    ds_read_b128 v[192:195], v2 offset:6144
    ds_read_b128 v[196:199], v2 offset:7168
    ds_read_b128 v[200:203], v2 offset:8192
    v_pk_mul_f32 v[212:213], v[112:113], v[112:113]
    v_pk_mul_f32 v[214:215], v[114:115], v[114:115]
    v_pk_mul_f32 v[216:217], v[116:117], v[116:117]
    v_pk_mul_f32 v[218:219], v[118:119], v[118:119]
    v_pk_fma_f32 v[212:213], v[212:213], v[4:5], v[4:5] op_sel:[0,1,0] op_sel_hi:[1,1,0]
    v_pk_fma_f32 v[214:215], v[214:215], v[4:5], v[4:5] op_sel:[0,1,0] op_sel_hi:[1,1,0]
    v_pk_fma_f32 v[216:217], v[216:217], v[6:7], v[6:7] op_sel:[0,1,0] op_sel_hi:[1,1,0]
    v_pk_fma_f32 v[218:219], v[218:219], v[6:7], v[6:7] op_sel:[0,1,0] op_sel_hi:[1,1,0]
    v_pk_mul_f32 v[212:213], v[212:213], v[112:113]
    v_pk_mul_f32 v[214:215], v[214:215], v[114:115]
    v_pk_mul_f32 v[216:217], v[216:217], v[116:117]
    v_pk_mul_f32 v[218:219], v[218:219], v[118:119]
    v_exp_f32 v212, v212
    v_exp_f32 v213, v213
    v_exp_f32 v214, v214
    v_exp_f32 v215, v215
    v_exp_f32 v216, v216
    v_exp_f32 v217, v217
    v_exp_f32 v218, v218
    v_exp_f32 v219, v219
    v_pk_fma_f32 v[212:213], v[212:213], v[248:249], v[248:249] op_sel:[0,1,1] op_sel_hi:[1,1,1]
    v_pk_fma_f32 v[214:215], v[214:215], v[248:249], v[248:249] op_sel:[0,1,1] op_sel_hi:[1,1,1]
    v_pk_fma_f32 v[216:217], v[216:217], v[250:251], v[250:251] op_sel:[0,1,1] op_sel_hi:[1,1,1]
    v_pk_fma_f32 v[218:219], v[218:219], v[250:251], v[250:251] op_sel:[0,1,1] op_sel_hi:[1,1,1]
    v_rcp_f32 v212, v212
    v_rcp_f32 v213, v213
    v_rcp_f32 v214, v214
    v_rcp_f32 v215, v215
    v_rcp_f32 v216, v216
    v_rcp_f32 v217, v217
    v_rcp_f32 v218, v218
    v_rcp_f32 v219, v219
    v_pk_mul_f32 v[112:113], v[112:113], v[212:213]
    v_pk_mul_f32 v[114:115], v[114:115], v[214:215]
    v_pk_mul_f32 v[116:117], v[116:117], v[216:217]
    v_pk_mul_f32 v[118:119], v[118:119], v[218:219]
    s_waitcnt lgkmcnt(5)
    v_mfma_f32_16x16x32_bf16 v[16:19], v[168:171], v[160:163], v[12:15]
    ds_read_b128 v[204:207], v11 offset:0
    v_mfma_f32_16x16x32_bf16 v[20:23], v[168:171], v[164:167], v[252:255]
    ds_read_b128 v[208:211], v11 offset:2048
    v_mfma_f32_16x16x32_bf16 v[24:27], v[172:175], v[160:163], v[12:15]
    ds_read_b128 v[212:215], v2 offset:9216
    v_mfma_f32_16x16x32_bf16 v[28:31], v[172:175], v[164:167], v[252:255]
    ds_read_b128 v[216:219], v2 offset:10240
    v_mfma_f32_16x16x32_bf16 v[32:35], v[176:179], v[160:163], v[12:15]
    ds_read_b128 v[220:223], v2 offset:11264
    v_mfma_f32_16x16x32_bf16 v[36:39], v[176:179], v[164:167], v[252:255]
    ds_read_b128 v[224:227], v2 offset:12288
    v_mfma_f32_16x16x32_bf16 v[40:43], v[180:183], v[160:163], v[12:15]
    ds_read_b128 v[228:231], v2 offset:13312
    v_mfma_f32_16x16x32_bf16 v[44:47], v[180:183], v[164:167], v[252:255]
    ds_read_b128 v[232:235], v2 offset:14336
    s_waitcnt lgkmcnt(8)
    v_mfma_f32_16x16x32_bf16 v[48:51], v[184:187], v[160:163], v[12:15]
    ds_read_b128 v[236:239], v2 offset:15360
    v_mfma_f32_16x16x32_bf16 v[52:55], v[184:187], v[164:167], v[252:255]
    ds_read_b128 v[240:243], v2 offset:16384
    v_mfma_f32_16x16x32_bf16 v[56:59], v[188:191], v[160:163], v[12:15]
    ds_read_b128 v[244:247], v2 offset:17408
    v_mfma_f32_16x16x32_bf16 v[60:63], v[188:191], v[164:167], v[252:255]
    v_mfma_f32_16x16x32_bf16 v[64:67], v[192:195], v[160:163], v[12:15]
    v_mfma_f32_16x16x32_bf16 v[68:71], v[192:195], v[164:167], v[252:255]
    v_mfma_f32_16x16x32_bf16 v[72:75], v[196:199], v[160:163], v[12:15]
    v_mfma_f32_16x16x32_bf16 v[76:79], v[196:199], v[164:167], v[252:255]
    v_mfma_f32_16x16x32_bf16 v[80:83], v[200:203], v[160:163], v[12:15]
    v_mfma_f32_16x16x32_bf16 v[84:87], v[200:203], v[164:167], v[252:255]
    s_waitcnt lgkmcnt(0)
    s_barrier
    v_mfma_f32_16x16x32_bf16 v[16:19], v[212:215], v[204:207], v[16:19]
    ds_read_b128 v[160:163], v10 offset:36864
    v_mfma_f32_16x16x32_bf16 v[20:23], v[212:215], v[208:211], v[20:23]
    ds_read_b128 v[164:167], v10 offset:38912
    v_mfma_f32_16x16x32_bf16 v[24:27], v[216:219], v[204:207], v[24:27]
    ds_read_b128 v[168:171], v2 offset:36864
    v_mfma_f32_16x16x32_bf16 v[28:31], v[216:219], v[208:211], v[28:31]
    ds_read_b128 v[172:175], v2 offset:37888
    v_mul_f32 v12, v120, v120
    v_mfma_f32_16x16x32_bf16 v[32:35], v[220:223], v[204:207], v[32:35]
    ds_read_b128 v[176:179], v2 offset:38912
    v_mul_f32 v13, v121, v121
    v_mfma_f32_16x16x32_bf16 v[36:39], v[220:223], v[208:211], v[36:39]
    ds_read_b128 v[180:183], v2 offset:39936
    v_mul_f32 v14, v122, v122
    v_mfma_f32_16x16x32_bf16 v[40:43], v[224:227], v[204:207], v[40:43]
    ds_read_b128 v[184:187], v2 offset:40960
    v_mul_f32 v15, v123, v123
    v_mfma_f32_16x16x32_bf16 v[44:47], v[224:227], v[208:211], v[44:47]
    ds_read_b128 v[188:191], v2 offset:41984
    v_mfma_f32_16x16x32_bf16 v[48:51], v[228:231], v[204:207], v[48:51]
    ds_read_b128 v[192:195], v2 offset:43008
    v_mul_f32 v252, v124, v124
    v_mfma_f32_16x16x32_bf16 v[52:55], v[228:231], v[208:211], v[52:55]
    ds_read_b128 v[196:199], v2 offset:44032
    v_mul_f32 v253, v125, v125
    v_mfma_f32_16x16x32_bf16 v[56:59], v[232:235], v[204:207], v[56:59]
    ds_read_b128 v[200:203], v2 offset:45056
    v_mul_f32 v254, v126, v126
    v_mfma_f32_16x16x32_bf16 v[60:63], v[232:235], v[208:211], v[60:63]
    v_mul_f32 v255, v127, v127
    v_fma_f32 v12, v12, v5, v4
    v_mfma_f32_16x16x32_bf16 v[64:67], v[236:239], v[204:207], v[64:67]
    v_fma_f32 v13, v13, v5, v4
    v_fma_f32 v14, v14, v5, v4
    v_mfma_f32_16x16x32_bf16 v[68:71], v[236:239], v[208:211], v[68:71]
    v_fma_f32 v15, v15, v5, v4
    v_fma_f32 v252, v252, v7, v6
    v_mfma_f32_16x16x32_bf16 v[72:75], v[240:243], v[204:207], v[72:75]
    v_fma_f32 v253, v253, v7, v6
    v_fma_f32 v254, v254, v7, v6
    v_mfma_f32_16x16x32_bf16 v[76:79], v[240:243], v[208:211], v[76:79]
    v_fma_f32 v255, v255, v7, v6
    v_mul_f32 v12, v12, v120
    v_mfma_f32_16x16x32_bf16 v[80:83], v[244:247], v[204:207], v[80:83]
    v_mul_f32 v13, v13, v121
    v_mul_f32 v14, v14, v122
    v_mfma_f32_16x16x32_bf16 v[84:87], v[244:247], v[208:211], v[84:87]
    v_mul_f32 v15, v15, v123
    s_waitcnt lgkmcnt(5)
    v_mfma_f32_16x16x32_bf16 v[16:19], v[168:171], v[160:163], v[16:19]
    ds_read_b128 v[204:207], v11 offset:36864
    v_mfma_f32_16x16x32_bf16 v[20:23], v[168:171], v[164:167], v[20:23]
    ds_read_b128 v[208:211], v11 offset:38912
    v_mul_f32 v252, v252, v124
    v_mfma_f32_16x16x32_bf16 v[24:27], v[172:175], v[160:163], v[24:27]
    ds_read_b128 v[212:215], v2 offset:46080
    v_mul_f32 v253, v253, v125
    v_mfma_f32_16x16x32_bf16 v[28:31], v[172:175], v[164:167], v[28:31]
    ds_read_b128 v[216:219], v2 offset:47104
    v_mul_f32 v254, v254, v126
    v_mfma_f32_16x16x32_bf16 v[32:35], v[176:179], v[160:163], v[32:35]
    ds_read_b128 v[220:223], v2 offset:48128
    v_mul_f32 v255, v255, v127
    v_mfma_f32_16x16x32_bf16 v[36:39], v[176:179], v[164:167], v[36:39]
    ds_read_b128 v[224:227], v2 offset:49152
    v_exp_f32 v12, v12
    v_mfma_f32_16x16x32_bf16 v[40:43], v[180:183], v[160:163], v[40:43]
    ds_read_b128 v[228:231], v2 offset:50176
    v_exp_f32 v13, v13
    v_mfma_f32_16x16x32_bf16 v[44:47], v[180:183], v[164:167], v[44:47]
    ds_read_b128 v[232:235], v2 offset:51200
    s_waitcnt lgkmcnt(8)
    v_mfma_f32_16x16x32_bf16 v[48:51], v[184:187], v[160:163], v[48:51]
    ds_read_b128 v[236:239], v2 offset:52224
    v_exp_f32 v14, v14
    v_mfma_f32_16x16x32_bf16 v[52:55], v[184:187], v[164:167], v[52:55]
    ds_read_b128 v[240:243], v2 offset:53248
    v_exp_f32 v15, v15
    v_mfma_f32_16x16x32_bf16 v[56:59], v[188:191], v[160:163], v[56:59]
    ds_read_b128 v[244:247], v2 offset:54272
    v_exp_f32 v252, v252
    v_mfma_f32_16x16x32_bf16 v[60:63], v[188:191], v[164:167], v[60:63]
    v_exp_f32 v253, v253
    v_mfma_f32_16x16x32_bf16 v[64:67], v[192:195], v[160:163], v[64:67]
    v_exp_f32 v254, v254
    v_mfma_f32_16x16x32_bf16 v[68:71], v[192:195], v[164:167], v[68:71]
    v_exp_f32 v255, v255
    v_mfma_f32_16x16x32_bf16 v[72:75], v[196:199], v[160:163], v[72:75]
    v_fma_f32 v12, v12, v249, v249
    v_fma_f32 v13, v13, v249, v249
    v_mfma_f32_16x16x32_bf16 v[76:79], v[196:199], v[164:167], v[76:79]
    v_fma_f32 v14, v14, v249, v249
    v_fma_f32 v15, v15, v249, v249
    v_mfma_f32_16x16x32_bf16 v[80:83], v[200:203], v[160:163], v[80:83]
    v_fma_f32 v252, v252, v251, v251
    v_fma_f32 v253, v253, v251, v251
    v_mfma_f32_16x16x32_bf16 v[84:87], v[200:203], v[164:167], v[84:87]
    v_fma_f32 v254, v254, v251, v251
    s_waitcnt lgkmcnt(0)
    s_barrier
    v_mfma_f32_16x16x32_bf16 v[16:19], v[212:215], v[204:207], v[16:19]
    ds_read_b128 v[160:163], v8 offset:0
    v_mfma_f32_16x16x32_bf16 v[20:23], v[212:215], v[208:211], v[20:23]
    ds_read_b128 v[164:167], v8 offset:2048
    v_fma_f32 v255, v255, v251, v251
    v_mfma_f32_16x16x32_bf16 v[24:27], v[216:219], v[204:207], v[24:27]
    ds_read_b128 v[168:171], v1 offset:0
    v_rcp_f32 v12, v12
    v_mfma_f32_16x16x32_bf16 v[28:31], v[216:219], v[208:211], v[28:31]
    ds_read_b128 v[172:175], v1 offset:1024
    v_rcp_f32 v13, v13
    v_mfma_f32_16x16x32_bf16 v[32:35], v[220:223], v[204:207], v[32:35]
    ds_read_b128 v[176:179], v1 offset:2048
    v_rcp_f32 v14, v14
    v_mfma_f32_16x16x32_bf16 v[36:39], v[220:223], v[208:211], v[36:39]
    ds_read_b128 v[180:183], v1 offset:3072
    v_rcp_f32 v15, v15
    v_mfma_f32_16x16x32_bf16 v[40:43], v[224:227], v[204:207], v[40:43]
    ds_read_b128 v[184:187], v1 offset:4096
    v_rcp_f32 v252, v252
    v_mfma_f32_16x16x32_bf16 v[44:47], v[224:227], v[208:211], v[44:47]
    ds_read_b128 v[188:191], v1 offset:5120
    v_mfma_f32_16x16x32_bf16 v[48:51], v[228:231], v[204:207], v[48:51]
    ds_read_b128 v[192:195], v1 offset:6144
    v_rcp_f32 v253, v253
    v_mfma_f32_16x16x32_bf16 v[52:55], v[228:231], v[208:211], v[52:55]
    ds_read_b128 v[196:199], v1 offset:7168
    v_rcp_f32 v254, v254
    v_mfma_f32_16x16x32_bf16 v[56:59], v[232:235], v[204:207], v[56:59]
    ds_read_b128 v[200:203], v1 offset:8192
    v_rcp_f32 v255, v255
    v_mfma_f32_16x16x32_bf16 v[60:63], v[232:235], v[208:211], v[60:63]
    v_mul_f32 v120, v120, v12
    v_mul_f32 v121, v121, v13
    v_mfma_f32_16x16x32_bf16 v[64:67], v[236:239], v[204:207], v[64:67]
    v_mul_f32 v122, v122, v14
    v_mul_f32 v123, v123, v15
    v_mfma_f32_16x16x32_bf16 v[68:71], v[236:239], v[208:211], v[68:71]
    v_mul_f32 v124, v124, v252
    v_mul_f32 v125, v125, v253
    v_mfma_f32_16x16x32_bf16 v[72:75], v[240:243], v[204:207], v[72:75]
    v_mul_f32 v126, v126, v254
    v_mul_f32 v127, v127, v255
    v_mfma_f32_16x16x32_bf16 v[76:79], v[240:243], v[208:211], v[76:79]
    v_mul_f32 v12, v128, v128
    v_mul_f32 v13, v129, v129
    v_mfma_f32_16x16x32_bf16 v[80:83], v[244:247], v[204:207], v[80:83]
    v_mul_f32 v14, v130, v130
    v_mul_f32 v15, v131, v131
    v_mfma_f32_16x16x32_bf16 v[84:87], v[244:247], v[208:211], v[84:87]
    v_mul_f32 v252, v132, v132
    s_waitcnt lgkmcnt(5)
    v_mfma_f32_16x16x32_bf16 v[16:19], v[168:171], v[160:163], v[16:19]
    ds_read_b128 v[204:207], v9 offset:0
    v_mfma_f32_16x16x32_bf16 v[20:23], v[168:171], v[164:167], v[20:23]
    ds_read_b128 v[208:211], v9 offset:2048
    v_mul_f32 v253, v133, v133
    v_mfma_f32_16x16x32_bf16 v[24:27], v[172:175], v[160:163], v[24:27]
    ds_read_b128 v[212:215], v1 offset:9216
    v_mul_f32 v254, v134, v134
    v_mfma_f32_16x16x32_bf16 v[28:31], v[172:175], v[164:167], v[28:31]
    ds_read_b128 v[216:219], v1 offset:10240
    v_mul_f32 v255, v135, v135
    v_mfma_f32_16x16x32_bf16 v[32:35], v[176:179], v[160:163], v[32:35]
    ds_read_b128 v[220:223], v1 offset:11264
    v_fma_f32 v12, v12, v5, v4
    v_mfma_f32_16x16x32_bf16 v[36:39], v[176:179], v[164:167], v[36:39]
    ds_read_b128 v[224:227], v1 offset:12288
    v_fma_f32 v13, v13, v5, v4
    v_mfma_f32_16x16x32_bf16 v[40:43], v[180:183], v[160:163], v[40:43]
    ds_read_b128 v[228:231], v1 offset:13312
    v_fma_f32 v14, v14, v5, v4
    v_mfma_f32_16x16x32_bf16 v[44:47], v[180:183], v[164:167], v[44:47]
    ds_read_b128 v[232:235], v1 offset:14336
    s_waitcnt lgkmcnt(8)
    v_mfma_f32_16x16x32_bf16 v[48:51], v[184:187], v[160:163], v[48:51]
    ds_read_b128 v[236:239], v1 offset:15360
    v_fma_f32 v15, v15, v5, v4
    v_mfma_f32_16x16x32_bf16 v[52:55], v[184:187], v[164:167], v[52:55]
    ds_read_b128 v[240:243], v1 offset:16384
    v_fma_f32 v252, v252, v7, v6
    v_mfma_f32_16x16x32_bf16 v[56:59], v[188:191], v[160:163], v[56:59]
    ds_read_b128 v[244:247], v1 offset:17408
    v_fma_f32 v253, v253, v7, v6
    v_mfma_f32_16x16x32_bf16 v[60:63], v[188:191], v[164:167], v[60:63]
    v_fma_f32 v254, v254, v7, v6
    v_fma_f32 v255, v255, v7, v6
    v_mfma_f32_16x16x32_bf16 v[64:67], v[192:195], v[160:163], v[64:67]
    v_mul_f32 v12, v12, v128
    v_mul_f32 v13, v13, v129
    v_mfma_f32_16x16x32_bf16 v[68:71], v[192:195], v[164:167], v[68:71]
    v_mul_f32 v14, v14, v130
    v_mul_f32 v15, v15, v131
    v_mfma_f32_16x16x32_bf16 v[72:75], v[196:199], v[160:163], v[72:75]
    v_mul_f32 v252, v252, v132
    v_mul_f32 v253, v253, v133
    v_mfma_f32_16x16x32_bf16 v[76:79], v[196:199], v[164:167], v[76:79]
    v_mul_f32 v254, v254, v134
    v_mul_f32 v255, v255, v135
    v_mfma_f32_16x16x32_bf16 v[80:83], v[200:203], v[160:163], v[80:83]
    v_exp_f32 v12, v12
    v_mfma_f32_16x16x32_bf16 v[84:87], v[200:203], v[164:167], v[84:87]
    v_exp_f32 v13, v13
    s_waitcnt lgkmcnt(0)
    s_barrier
    v_mfma_f32_16x16x32_bf16 v[16:19], v[212:215], v[204:207], v[16:19]
    ds_read_b128 v[160:163], v8 offset:36864
    v_mfma_f32_16x16x32_bf16 v[20:23], v[212:215], v[208:211], v[20:23]
    ds_read_b128 v[164:167], v8 offset:38912
    v_exp_f32 v14, v14
    v_mfma_f32_16x16x32_bf16 v[24:27], v[216:219], v[204:207], v[24:27]
    ds_read_b128 v[168:171], v1 offset:36864
    v_exp_f32 v15, v15
    v_mfma_f32_16x16x32_bf16 v[28:31], v[216:219], v[208:211], v[28:31]
    ds_read_b128 v[172:175], v1 offset:37888
    v_exp_f32 v252, v252
    v_mfma_f32_16x16x32_bf16 v[32:35], v[220:223], v[204:207], v[32:35]
    ds_read_b128 v[176:179], v1 offset:38912
    v_exp_f32 v253, v253
    v_mfma_f32_16x16x32_bf16 v[36:39], v[220:223], v[208:211], v[36:39]
    ds_read_b128 v[180:183], v1 offset:39936
    v_exp_f32 v254, v254
    v_mfma_f32_16x16x32_bf16 v[40:43], v[224:227], v[204:207], v[40:43]
    ds_read_b128 v[184:187], v1 offset:40960
    v_exp_f32 v255, v255
    v_mfma_f32_16x16x32_bf16 v[44:47], v[224:227], v[208:211], v[44:47]
    ds_read_b128 v[188:191], v1 offset:41984
    v_mfma_f32_16x16x32_bf16 v[48:51], v[228:231], v[204:207], v[48:51]
    ds_read_b128 v[192:195], v1 offset:43008
    v_fma_f32 v12, v12, v249, v249
    v_mfma_f32_16x16x32_bf16 v[52:55], v[228:231], v[208:211], v[52:55]
    ds_read_b128 v[196:199], v1 offset:44032
    v_fma_f32 v13, v13, v249, v249
    v_mfma_f32_16x16x32_bf16 v[56:59], v[232:235], v[204:207], v[56:59]
    ds_read_b128 v[200:203], v1 offset:45056
    v_fma_f32 v14, v14, v249, v249
    v_mfma_f32_16x16x32_bf16 v[60:63], v[232:235], v[208:211], v[60:63]
    v_fma_f32 v15, v15, v249, v249
    v_fma_f32 v252, v252, v251, v251
    v_mfma_f32_16x16x32_bf16 v[64:67], v[236:239], v[204:207], v[64:67]
    v_fma_f32 v253, v253, v251, v251
    v_fma_f32 v254, v254, v251, v251
    v_mfma_f32_16x16x32_bf16 v[68:71], v[236:239], v[208:211], v[68:71]
    v_fma_f32 v255, v255, v251, v251
    v_rcp_f32 v12, v12
    v_mfma_f32_16x16x32_bf16 v[72:75], v[240:243], v[204:207], v[72:75]
    v_rcp_f32 v13, v13
    v_mfma_f32_16x16x32_bf16 v[76:79], v[240:243], v[208:211], v[76:79]
    v_rcp_f32 v14, v14
    v_mfma_f32_16x16x32_bf16 v[80:83], v[244:247], v[204:207], v[80:83]
    v_rcp_f32 v15, v15
    v_mfma_f32_16x16x32_bf16 v[84:87], v[244:247], v[208:211], v[84:87]
    v_rcp_f32 v252, v252
    s_waitcnt lgkmcnt(5)
    v_mfma_f32_16x16x32_bf16 v[16:19], v[168:171], v[160:163], v[16:19]
    ds_read_b128 v[204:207], v9 offset:36864
    v_mfma_f32_16x16x32_bf16 v[20:23], v[168:171], v[164:167], v[20:23]
    ds_read_b128 v[208:211], v9 offset:38912
    v_rcp_f32 v253, v253
    v_mfma_f32_16x16x32_bf16 v[24:27], v[172:175], v[160:163], v[24:27]
    ds_read_b128 v[212:215], v1 offset:46080
    v_rcp_f32 v254, v254
    v_mfma_f32_16x16x32_bf16 v[28:31], v[172:175], v[164:167], v[28:31]
    ds_read_b128 v[216:219], v1 offset:47104
    v_rcp_f32 v255, v255
    v_mfma_f32_16x16x32_bf16 v[32:35], v[176:179], v[160:163], v[32:35]
    ds_read_b128 v[220:223], v1 offset:48128
    v_mul_f32 v128, v128, v12
    v_mfma_f32_16x16x32_bf16 v[36:39], v[176:179], v[164:167], v[36:39]
    ds_read_b128 v[224:227], v1 offset:49152
    v_mul_f32 v129, v129, v13
    v_mfma_f32_16x16x32_bf16 v[40:43], v[180:183], v[160:163], v[40:43]
    ds_read_b128 v[228:231], v1 offset:50176
    v_mul_f32 v130, v130, v14
    v_mfma_f32_16x16x32_bf16 v[44:47], v[180:183], v[164:167], v[44:47]
    ds_read_b128 v[232:235], v1 offset:51200
    s_waitcnt lgkmcnt(8)
    v_mfma_f32_16x16x32_bf16 v[48:51], v[184:187], v[160:163], v[48:51]
    ds_read_b128 v[236:239], v1 offset:52224
    v_mul_f32 v131, v131, v15
    v_mfma_f32_16x16x32_bf16 v[52:55], v[184:187], v[164:167], v[52:55]
    ds_read_b128 v[240:243], v1 offset:53248
    v_mul_f32 v132, v132, v252
    v_mfma_f32_16x16x32_bf16 v[56:59], v[188:191], v[160:163], v[56:59]
    ds_read_b128 v[244:247], v1 offset:54272
    v_mul_f32 v133, v133, v253
    v_mfma_f32_16x16x32_bf16 v[60:63], v[188:191], v[164:167], v[60:63]
    v_mul_f32 v134, v134, v254
    v_mul_f32 v135, v135, v255
    v_mfma_f32_16x16x32_bf16 v[64:67], v[192:195], v[160:163], v[64:67]
    v_mul_f32 v12, v136, v136
    v_mul_f32 v13, v137, v137
    v_mfma_f32_16x16x32_bf16 v[68:71], v[192:195], v[164:167], v[68:71]
    v_mul_f32 v14, v138, v138
    v_mul_f32 v15, v139, v139
    v_mfma_f32_16x16x32_bf16 v[72:75], v[196:199], v[160:163], v[72:75]
    v_mul_f32 v252, v140, v140
    v_mul_f32 v253, v141, v141
    v_mfma_f32_16x16x32_bf16 v[76:79], v[196:199], v[164:167], v[76:79]
    v_mul_f32 v254, v142, v142
    v_mul_f32 v255, v143, v143
    v_mfma_f32_16x16x32_bf16 v[80:83], v[200:203], v[160:163], v[80:83]
    v_fma_f32 v12, v12, v5, v4
    v_fma_f32 v13, v13, v5, v4
    v_mfma_f32_16x16x32_bf16 v[84:87], v[200:203], v[164:167], v[84:87]
    v_fma_f32 v14, v14, v5, v4
    s_waitcnt lgkmcnt(0)
    s_barrier
    v_mfma_f32_16x16x32_bf16 v[16:19], v[212:215], v[204:207], v[16:19]
    ds_read_b128 v[160:163], v10 offset:0
    v_mfma_f32_16x16x32_bf16 v[20:23], v[212:215], v[208:211], v[20:23]
    ds_read_b128 v[164:167], v10 offset:2048
    v_fma_f32 v15, v15, v5, v4
    v_mfma_f32_16x16x32_bf16 v[24:27], v[216:219], v[204:207], v[24:27]
    ds_read_b128 v[168:171], v2 offset:0
    v_fma_f32 v252, v252, v7, v6
    v_mfma_f32_16x16x32_bf16 v[28:31], v[216:219], v[208:211], v[28:31]
    ds_read_b128 v[172:175], v2 offset:1024
    v_fma_f32 v253, v253, v7, v6
    v_mfma_f32_16x16x32_bf16 v[32:35], v[220:223], v[204:207], v[32:35]
    ds_read_b128 v[176:179], v2 offset:2048
    v_fma_f32 v254, v254, v7, v6
    v_mfma_f32_16x16x32_bf16 v[36:39], v[220:223], v[208:211], v[36:39]
    ds_read_b128 v[180:183], v2 offset:3072
    v_fma_f32 v255, v255, v7, v6
    v_mfma_f32_16x16x32_bf16 v[40:43], v[224:227], v[204:207], v[40:43]
    ds_read_b128 v[184:187], v2 offset:4096
    v_mul_f32 v12, v12, v136
    v_mfma_f32_16x16x32_bf16 v[44:47], v[224:227], v[208:211], v[44:47]
    ds_read_b128 v[188:191], v2 offset:5120
    v_mfma_f32_16x16x32_bf16 v[48:51], v[228:231], v[204:207], v[48:51]
    ds_read_b128 v[192:195], v2 offset:6144
    v_mul_f32 v13, v13, v137
    v_mfma_f32_16x16x32_bf16 v[52:55], v[228:231], v[208:211], v[52:55]
    ds_read_b128 v[196:199], v2 offset:7168
    v_mul_f32 v14, v14, v138
    v_mfma_f32_16x16x32_bf16 v[56:59], v[232:235], v[204:207], v[56:59]
    ds_read_b128 v[200:203], v2 offset:8192
    v_mul_f32 v15, v15, v139
    v_mfma_f32_16x16x32_bf16 v[60:63], v[232:235], v[208:211], v[60:63]
    v_mul_f32 v252, v252, v140
    v_mul_f32 v253, v253, v141
    v_mfma_f32_16x16x32_bf16 v[64:67], v[236:239], v[204:207], v[64:67]
    v_mul_f32 v254, v254, v142
    v_mul_f32 v255, v255, v143
    v_mfma_f32_16x16x32_bf16 v[68:71], v[236:239], v[208:211], v[68:71]
    v_exp_f32 v12, v12
    v_mfma_f32_16x16x32_bf16 v[72:75], v[240:243], v[204:207], v[72:75]
    v_exp_f32 v13, v13
    v_mfma_f32_16x16x32_bf16 v[76:79], v[240:243], v[208:211], v[76:79]
    v_exp_f32 v14, v14
    v_mfma_f32_16x16x32_bf16 v[80:83], v[244:247], v[204:207], v[80:83]
    v_exp_f32 v15, v15
    v_mfma_f32_16x16x32_bf16 v[84:87], v[244:247], v[208:211], v[84:87]
    v_exp_f32 v252, v252
    s_waitcnt lgkmcnt(5)
    v_mfma_f32_16x16x32_bf16 v[16:19], v[168:171], v[160:163], v[16:19]
    ds_read_b128 v[204:207], v11 offset:0
    v_mfma_f32_16x16x32_bf16 v[20:23], v[168:171], v[164:167], v[20:23]
    ds_read_b128 v[208:211], v11 offset:2048
    v_exp_f32 v253, v253
    v_mfma_f32_16x16x32_bf16 v[24:27], v[172:175], v[160:163], v[24:27]
    ds_read_b128 v[212:215], v2 offset:9216
    v_exp_f32 v254, v254
    v_mfma_f32_16x16x32_bf16 v[28:31], v[172:175], v[164:167], v[28:31]
    ds_read_b128 v[216:219], v2 offset:10240
    v_exp_f32 v255, v255
    v_mfma_f32_16x16x32_bf16 v[32:35], v[176:179], v[160:163], v[32:35]
    ds_read_b128 v[220:223], v2 offset:11264
    v_fma_f32 v12, v12, v249, v249
    v_mfma_f32_16x16x32_bf16 v[36:39], v[176:179], v[164:167], v[36:39]
    ds_read_b128 v[224:227], v2 offset:12288
    v_fma_f32 v13, v13, v249, v249
    v_mfma_f32_16x16x32_bf16 v[40:43], v[180:183], v[160:163], v[40:43]
    ds_read_b128 v[228:231], v2 offset:13312
    v_fma_f32 v14, v14, v249, v249
    v_mfma_f32_16x16x32_bf16 v[44:47], v[180:183], v[164:167], v[44:47]
    ds_read_b128 v[232:235], v2 offset:14336
    s_waitcnt lgkmcnt(8)
    v_mfma_f32_16x16x32_bf16 v[48:51], v[184:187], v[160:163], v[48:51]
    ds_read_b128 v[236:239], v2 offset:15360
    v_fma_f32 v15, v15, v249, v249
    v_mfma_f32_16x16x32_bf16 v[52:55], v[184:187], v[164:167], v[52:55]
    ds_read_b128 v[240:243], v2 offset:16384
    v_fma_f32 v252, v252, v251, v251
    v_mfma_f32_16x16x32_bf16 v[56:59], v[188:191], v[160:163], v[56:59]
    ds_read_b128 v[244:247], v2 offset:17408
    v_fma_f32 v253, v253, v251, v251
    v_mfma_f32_16x16x32_bf16 v[60:63], v[188:191], v[164:167], v[60:63]
    v_fma_f32 v254, v254, v251, v251
    v_fma_f32 v255, v255, v251, v251
    v_mfma_f32_16x16x32_bf16 v[64:67], v[192:195], v[160:163], v[64:67]
    v_rcp_f32 v12, v12
    v_mfma_f32_16x16x32_bf16 v[68:71], v[192:195], v[164:167], v[68:71]
    v_rcp_f32 v13, v13
    v_mfma_f32_16x16x32_bf16 v[72:75], v[196:199], v[160:163], v[72:75]
    v_rcp_f32 v14, v14
    v_mfma_f32_16x16x32_bf16 v[76:79], v[196:199], v[164:167], v[76:79]
    v_rcp_f32 v15, v15
    v_mfma_f32_16x16x32_bf16 v[80:83], v[200:203], v[160:163], v[80:83]
    v_rcp_f32 v252, v252
    v_mfma_f32_16x16x32_bf16 v[84:87], v[200:203], v[164:167], v[84:87]
    v_rcp_f32 v253, v253
    s_waitcnt lgkmcnt(0)
    s_barrier
    v_mfma_f32_16x16x32_bf16 v[16:19], v[212:215], v[204:207], v[16:19]
    ds_read_b128 v[160:163], v10 offset:36864
    v_mfma_f32_16x16x32_bf16 v[20:23], v[212:215], v[208:211], v[20:23]
    ds_read_b128 v[164:167], v10 offset:38912
    v_rcp_f32 v254, v254
    v_mfma_f32_16x16x32_bf16 v[24:27], v[216:219], v[204:207], v[24:27]
    ds_read_b128 v[168:171], v2 offset:36864
    v_rcp_f32 v255, v255
    v_mfma_f32_16x16x32_bf16 v[28:31], v[216:219], v[208:211], v[28:31]
    ds_read_b128 v[172:175], v2 offset:37888
    v_mul_f32 v136, v136, v12
    v_mfma_f32_16x16x32_bf16 v[32:35], v[220:223], v[204:207], v[32:35]
    ds_read_b128 v[176:179], v2 offset:38912
    v_mul_f32 v137, v137, v13
    v_mfma_f32_16x16x32_bf16 v[36:39], v[220:223], v[208:211], v[36:39]
    ds_read_b128 v[180:183], v2 offset:39936
    v_mul_f32 v138, v138, v14
    v_mfma_f32_16x16x32_bf16 v[40:43], v[224:227], v[204:207], v[40:43]
    ds_read_b128 v[184:187], v2 offset:40960
    v_mul_f32 v139, v139, v15
    v_mfma_f32_16x16x32_bf16 v[44:47], v[224:227], v[208:211], v[44:47]
    ds_read_b128 v[188:191], v2 offset:41984
    v_mfma_f32_16x16x32_bf16 v[48:51], v[228:231], v[204:207], v[48:51]
    ds_read_b128 v[192:195], v2 offset:43008
    v_mul_f32 v140, v140, v252
    v_mfma_f32_16x16x32_bf16 v[52:55], v[228:231], v[208:211], v[52:55]
    ds_read_b128 v[196:199], v2 offset:44032
    v_mul_f32 v141, v141, v253
    v_mfma_f32_16x16x32_bf16 v[56:59], v[232:235], v[204:207], v[56:59]
    ds_read_b128 v[200:203], v2 offset:45056
    v_mul_f32 v142, v142, v254
    v_mfma_f32_16x16x32_bf16 v[60:63], v[232:235], v[208:211], v[60:63]
    v_mul_f32 v143, v143, v255
    v_mul_f32 v12, v144, v144
    v_mfma_f32_16x16x32_bf16 v[64:67], v[236:239], v[204:207], v[64:67]
    v_mul_f32 v13, v145, v145
    v_mul_f32 v14, v146, v146
    v_mfma_f32_16x16x32_bf16 v[68:71], v[236:239], v[208:211], v[68:71]
    v_mul_f32 v15, v147, v147
    v_mul_f32 v252, v148, v148
    v_mfma_f32_16x16x32_bf16 v[72:75], v[240:243], v[204:207], v[72:75]
    v_mul_f32 v253, v149, v149
    v_mul_f32 v254, v150, v150
    v_mfma_f32_16x16x32_bf16 v[76:79], v[240:243], v[208:211], v[76:79]
    v_mul_f32 v255, v151, v151
    v_fma_f32 v12, v12, v5, v4
    v_mfma_f32_16x16x32_bf16 v[80:83], v[244:247], v[204:207], v[80:83]
    v_fma_f32 v13, v13, v5, v4
    v_fma_f32 v14, v14, v5, v4
    v_mfma_f32_16x16x32_bf16 v[84:87], v[244:247], v[208:211], v[84:87]
    v_fma_f32 v15, v15, v5, v4
    s_waitcnt lgkmcnt(5)
    v_mfma_f32_16x16x32_bf16 v[16:19], v[168:171], v[160:163], v[16:19]
    ds_read_b128 v[204:207], v11 offset:36864
    v_mfma_f32_16x16x32_bf16 v[20:23], v[168:171], v[164:167], v[20:23]
    ds_read_b128 v[208:211], v11 offset:38912
    v_fma_f32 v252, v252, v7, v6
    v_mfma_f32_16x16x32_bf16 v[24:27], v[172:175], v[160:163], v[24:27]
    ds_read_b128 v[212:215], v2 offset:46080
    v_fma_f32 v253, v253, v7, v6
    v_mfma_f32_16x16x32_bf16 v[28:31], v[172:175], v[164:167], v[28:31]
    ds_read_b128 v[216:219], v2 offset:47104
    v_fma_f32 v254, v254, v7, v6
    v_mfma_f32_16x16x32_bf16 v[32:35], v[176:179], v[160:163], v[32:35]
    ds_read_b128 v[220:223], v2 offset:48128
    v_fma_f32 v255, v255, v7, v6
    v_mfma_f32_16x16x32_bf16 v[36:39], v[176:179], v[164:167], v[36:39]
    ds_read_b128 v[224:227], v2 offset:49152
    v_mul_f32 v12, v12, v144
    v_mfma_f32_16x16x32_bf16 v[40:43], v[180:183], v[160:163], v[40:43]
    ds_read_b128 v[228:231], v2 offset:50176
    v_mul_f32 v13, v13, v145
    v_mfma_f32_16x16x32_bf16 v[44:47], v[180:183], v[164:167], v[44:47]
    ds_read_b128 v[232:235], v2 offset:51200
    s_waitcnt lgkmcnt(8)
    v_mfma_f32_16x16x32_bf16 v[48:51], v[184:187], v[160:163], v[48:51]
    ds_read_b128 v[236:239], v2 offset:52224
    v_mul_f32 v14, v14, v146
    v_mfma_f32_16x16x32_bf16 v[52:55], v[184:187], v[164:167], v[52:55]
    ds_read_b128 v[240:243], v2 offset:53248
    v_mul_f32 v15, v15, v147
    v_mfma_f32_16x16x32_bf16 v[56:59], v[188:191], v[160:163], v[56:59]
    ds_read_b128 v[244:247], v2 offset:54272
    v_mul_f32 v252, v252, v148
    v_mfma_f32_16x16x32_bf16 v[60:63], v[188:191], v[164:167], v[60:63]
    v_mul_f32 v253, v253, v149
    v_mul_f32 v254, v254, v150
    v_mfma_f32_16x16x32_bf16 v[64:67], v[192:195], v[160:163], v[64:67]
    v_mul_f32 v255, v255, v151
    v_exp_f32 v12, v12
    v_mfma_f32_16x16x32_bf16 v[68:71], v[192:195], v[164:167], v[68:71]
    v_exp_f32 v13, v13
    v_mfma_f32_16x16x32_bf16 v[72:75], v[196:199], v[160:163], v[72:75]
    v_exp_f32 v14, v14
    v_mfma_f32_16x16x32_bf16 v[76:79], v[196:199], v[164:167], v[76:79]
    v_exp_f32 v15, v15
    v_mfma_f32_16x16x32_bf16 v[80:83], v[200:203], v[160:163], v[80:83]
    v_exp_f32 v252, v252
    v_mfma_f32_16x16x32_bf16 v[84:87], v[200:203], v[164:167], v[84:87]
    v_exp_f32 v253, v253
    s_waitcnt lgkmcnt(0)
    s_barrier
    v_mfma_f32_16x16x32_bf16 v[16:19], v[212:215], v[204:207], v[16:19]
    ds_read_b128 v[160:163], v8 offset:0
    v_mfma_f32_16x16x32_bf16 v[20:23], v[212:215], v[208:211], v[20:23]
    ds_read_b128 v[164:167], v8 offset:2048
    v_exp_f32 v254, v254
    v_mfma_f32_16x16x32_bf16 v[24:27], v[216:219], v[204:207], v[24:27]
    ds_read_b128 v[168:171], v1 offset:0
    v_exp_f32 v255, v255
    v_mfma_f32_16x16x32_bf16 v[28:31], v[216:219], v[208:211], v[28:31]
    ds_read_b128 v[172:175], v1 offset:1024
    v_fma_f32 v12, v12, v249, v249
    v_mfma_f32_16x16x32_bf16 v[32:35], v[220:223], v[204:207], v[32:35]
    ds_read_b128 v[176:179], v1 offset:2048
    v_fma_f32 v13, v13, v249, v249
    v_mfma_f32_16x16x32_bf16 v[36:39], v[220:223], v[208:211], v[36:39]
    ds_read_b128 v[180:183], v1 offset:3072
    v_fma_f32 v14, v14, v249, v249
    v_mfma_f32_16x16x32_bf16 v[40:43], v[224:227], v[204:207], v[40:43]
    ds_read_b128 v[184:187], v1 offset:4096
    v_fma_f32 v15, v15, v249, v249
    v_mfma_f32_16x16x32_bf16 v[44:47], v[224:227], v[208:211], v[44:47]
    ds_read_b128 v[188:191], v1 offset:5120
    v_mfma_f32_16x16x32_bf16 v[48:51], v[228:231], v[204:207], v[48:51]
    ds_read_b128 v[192:195], v1 offset:6144
    v_fma_f32 v252, v252, v251, v251
    v_mfma_f32_16x16x32_bf16 v[52:55], v[228:231], v[208:211], v[52:55]
    ds_read_b128 v[196:199], v1 offset:7168
    v_fma_f32 v253, v253, v251, v251
    v_mfma_f32_16x16x32_bf16 v[56:59], v[232:235], v[204:207], v[56:59]
    ds_read_b128 v[200:203], v1 offset:8192
    v_fma_f32 v254, v254, v251, v251
    v_mfma_f32_16x16x32_bf16 v[60:63], v[232:235], v[208:211], v[60:63]
    v_fma_f32 v255, v255, v251, v251
    v_rcp_f32 v12, v12
    v_mfma_f32_16x16x32_bf16 v[64:67], v[236:239], v[204:207], v[64:67]
    v_rcp_f32 v13, v13
    v_mfma_f32_16x16x32_bf16 v[68:71], v[236:239], v[208:211], v[68:71]
    v_rcp_f32 v14, v14
    v_mfma_f32_16x16x32_bf16 v[72:75], v[240:243], v[204:207], v[72:75]
    v_rcp_f32 v15, v15
    v_mfma_f32_16x16x32_bf16 v[76:79], v[240:243], v[208:211], v[76:79]
    v_rcp_f32 v252, v252
    v_mfma_f32_16x16x32_bf16 v[80:83], v[244:247], v[204:207], v[80:83]
    v_rcp_f32 v253, v253
    v_mfma_f32_16x16x32_bf16 v[84:87], v[244:247], v[208:211], v[84:87]
    v_rcp_f32 v254, v254
    s_waitcnt lgkmcnt(5)
    v_mfma_f32_16x16x32_bf16 v[16:19], v[168:171], v[160:163], v[16:19]
    ds_read_b128 v[204:207], v9 offset:0
    v_mfma_f32_16x16x32_bf16 v[20:23], v[168:171], v[164:167], v[20:23]
    ds_read_b128 v[208:211], v9 offset:2048
    v_rcp_f32 v255, v255
    v_mfma_f32_16x16x32_bf16 v[24:27], v[172:175], v[160:163], v[24:27]
    ds_read_b128 v[212:215], v1 offset:9216
    v_mul_f32 v144, v144, v12
    v_mfma_f32_16x16x32_bf16 v[28:31], v[172:175], v[164:167], v[28:31]
    ds_read_b128 v[216:219], v1 offset:10240
    v_mul_f32 v145, v145, v13
    v_mfma_f32_16x16x32_bf16 v[32:35], v[176:179], v[160:163], v[32:35]
    ds_read_b128 v[220:223], v1 offset:11264
    v_mul_f32 v146, v146, v14
    v_mfma_f32_16x16x32_bf16 v[36:39], v[176:179], v[164:167], v[36:39]
    ds_read_b128 v[224:227], v1 offset:12288
    v_mul_f32 v147, v147, v15
    v_mfma_f32_16x16x32_bf16 v[40:43], v[180:183], v[160:163], v[40:43]
    ds_read_b128 v[228:231], v1 offset:13312
    v_mul_f32 v148, v148, v252
    v_mfma_f32_16x16x32_bf16 v[44:47], v[180:183], v[164:167], v[44:47]
    ds_read_b128 v[232:235], v1 offset:14336
    s_waitcnt lgkmcnt(8)
    v_mfma_f32_16x16x32_bf16 v[48:51], v[184:187], v[160:163], v[48:51]
    ds_read_b128 v[236:239], v1 offset:15360
    v_mul_f32 v149, v149, v253
    v_mfma_f32_16x16x32_bf16 v[52:55], v[184:187], v[164:167], v[52:55]
    ds_read_b128 v[240:243], v1 offset:16384
    v_mul_f32 v150, v150, v254
    v_mfma_f32_16x16x32_bf16 v[56:59], v[188:191], v[160:163], v[56:59]
    ds_read_b128 v[244:247], v1 offset:17408
    v_mul_f32 v151, v151, v255
    v_mfma_f32_16x16x32_bf16 v[60:63], v[188:191], v[164:167], v[60:63]
    v_mul_f32 v12, v152, v152
    v_mul_f32 v13, v153, v153
    v_mfma_f32_16x16x32_bf16 v[64:67], v[192:195], v[160:163], v[64:67]
    v_mul_f32 v14, v154, v154
    v_mul_f32 v15, v155, v155
    v_mfma_f32_16x16x32_bf16 v[68:71], v[192:195], v[164:167], v[68:71]
    v_mul_f32 v252, v156, v156
    v_mul_f32 v253, v157, v157
    v_mfma_f32_16x16x32_bf16 v[72:75], v[196:199], v[160:163], v[72:75]
    v_mul_f32 v254, v158, v158
    v_mul_f32 v255, v159, v159
    v_mfma_f32_16x16x32_bf16 v[76:79], v[196:199], v[164:167], v[76:79]
    v_fma_f32 v12, v12, v5, v4
    v_fma_f32 v13, v13, v5, v4
    v_mfma_f32_16x16x32_bf16 v[80:83], v[200:203], v[160:163], v[80:83]
    v_fma_f32 v14, v14, v5, v4
    v_fma_f32 v15, v15, v5, v4
    v_mfma_f32_16x16x32_bf16 v[84:87], v[200:203], v[164:167], v[84:87]
    v_fma_f32 v252, v252, v7, v6
    s_waitcnt lgkmcnt(0)
    s_barrier
    v_mfma_f32_16x16x32_bf16 v[16:19], v[212:215], v[204:207], v[16:19]
    ds_read_b128 v[160:163], v8 offset:36864
    v_mfma_f32_16x16x32_bf16 v[20:23], v[212:215], v[208:211], v[20:23]
    ds_read_b128 v[164:167], v8 offset:38912
    v_fma_f32 v253, v253, v7, v6
    v_mfma_f32_16x16x32_bf16 v[24:27], v[216:219], v[204:207], v[24:27]
    ds_read_b128 v[168:171], v1 offset:36864
    v_fma_f32 v254, v254, v7, v6
    v_mfma_f32_16x16x32_bf16 v[28:31], v[216:219], v[208:211], v[28:31]
    ds_read_b128 v[172:175], v1 offset:37888
    v_fma_f32 v255, v255, v7, v6
    v_mfma_f32_16x16x32_bf16 v[32:35], v[220:223], v[204:207], v[32:35]
    ds_read_b128 v[176:179], v1 offset:38912
    v_mul_f32 v12, v12, v152
    v_mfma_f32_16x16x32_bf16 v[36:39], v[220:223], v[208:211], v[36:39]
    ds_read_b128 v[180:183], v1 offset:39936
    v_mul_f32 v13, v13, v153
    v_mfma_f32_16x16x32_bf16 v[40:43], v[224:227], v[204:207], v[40:43]
    ds_read_b128 v[184:187], v1 offset:40960
    v_mul_f32 v14, v14, v154
    v_mfma_f32_16x16x32_bf16 v[44:47], v[224:227], v[208:211], v[44:47]
    ds_read_b128 v[188:191], v1 offset:41984
    v_mfma_f32_16x16x32_bf16 v[48:51], v[228:231], v[204:207], v[48:51]
    ds_read_b128 v[192:195], v1 offset:43008
    v_mul_f32 v15, v15, v155
    v_mfma_f32_16x16x32_bf16 v[52:55], v[228:231], v[208:211], v[52:55]
    ds_read_b128 v[196:199], v1 offset:44032
    v_mul_f32 v252, v252, v156
    v_mfma_f32_16x16x32_bf16 v[56:59], v[232:235], v[204:207], v[56:59]
    ds_read_b128 v[200:203], v1 offset:45056
    v_mul_f32 v253, v253, v157
    v_mfma_f32_16x16x32_bf16 v[60:63], v[232:235], v[208:211], v[60:63]
    v_mul_f32 v254, v254, v158
    v_mul_f32 v255, v255, v159
    v_mfma_f32_16x16x32_bf16 v[64:67], v[236:239], v[204:207], v[64:67]
    v_exp_f32 v12, v12
    v_mfma_f32_16x16x32_bf16 v[68:71], v[236:239], v[208:211], v[68:71]
    v_exp_f32 v13, v13
    v_mfma_f32_16x16x32_bf16 v[72:75], v[240:243], v[204:207], v[72:75]
    v_exp_f32 v14, v14
    v_mfma_f32_16x16x32_bf16 v[76:79], v[240:243], v[208:211], v[76:79]
    v_exp_f32 v15, v15
    v_mfma_f32_16x16x32_bf16 v[80:83], v[244:247], v[204:207], v[80:83]
    v_exp_f32 v252, v252
    v_mfma_f32_16x16x32_bf16 v[84:87], v[244:247], v[208:211], v[84:87]
    v_exp_f32 v253, v253
    s_waitcnt lgkmcnt(5)
    v_mfma_f32_16x16x32_bf16 v[16:19], v[168:171], v[160:163], v[16:19]
    ds_read_b128 v[204:207], v9 offset:36864
    v_mfma_f32_16x16x32_bf16 v[20:23], v[168:171], v[164:167], v[20:23]
    ds_read_b128 v[208:211], v9 offset:38912
    v_exp_f32 v254, v254
    v_mfma_f32_16x16x32_bf16 v[24:27], v[172:175], v[160:163], v[24:27]
    ds_read_b128 v[212:215], v1 offset:46080
    v_exp_f32 v255, v255
    v_mfma_f32_16x16x32_bf16 v[28:31], v[172:175], v[164:167], v[28:31]
    ds_read_b128 v[216:219], v1 offset:47104
    v_fma_f32 v12, v12, v249, v249
    v_mfma_f32_16x16x32_bf16 v[32:35], v[176:179], v[160:163], v[32:35]
    ds_read_b128 v[220:223], v1 offset:48128
    v_fma_f32 v13, v13, v249, v249
    v_mfma_f32_16x16x32_bf16 v[36:39], v[176:179], v[164:167], v[36:39]
    ds_read_b128 v[224:227], v1 offset:49152
    v_fma_f32 v14, v14, v249, v249
    v_mfma_f32_16x16x32_bf16 v[40:43], v[180:183], v[160:163], v[40:43]
    ds_read_b128 v[228:231], v1 offset:50176
    v_fma_f32 v15, v15, v249, v249
    v_mfma_f32_16x16x32_bf16 v[44:47], v[180:183], v[164:167], v[44:47]
    ds_read_b128 v[232:235], v1 offset:51200
    s_waitcnt lgkmcnt(8)
    v_mfma_f32_16x16x32_bf16 v[48:51], v[184:187], v[160:163], v[48:51]
    ds_read_b128 v[236:239], v1 offset:52224
    v_fma_f32 v252, v252, v251, v251
    v_mfma_f32_16x16x32_bf16 v[52:55], v[184:187], v[164:167], v[52:55]
    ds_read_b128 v[240:243], v1 offset:53248
    v_fma_f32 v253, v253, v251, v251
    v_mfma_f32_16x16x32_bf16 v[56:59], v[188:191], v[160:163], v[56:59]
    ds_read_b128 v[244:247], v1 offset:54272
    v_fma_f32 v254, v254, v251, v251
    v_mfma_f32_16x16x32_bf16 v[60:63], v[188:191], v[164:167], v[60:63]
    v_fma_f32 v255, v255, v251, v251
    v_rcp_f32 v12, v12
    v_mfma_f32_16x16x32_bf16 v[64:67], v[192:195], v[160:163], v[64:67]
    v_rcp_f32 v13, v13
    v_mfma_f32_16x16x32_bf16 v[68:71], v[192:195], v[164:167], v[68:71]
    v_rcp_f32 v14, v14
    v_mfma_f32_16x16x32_bf16 v[72:75], v[196:199], v[160:163], v[72:75]
    v_rcp_f32 v15, v15
    v_mfma_f32_16x16x32_bf16 v[76:79], v[196:199], v[164:167], v[76:79]
    v_rcp_f32 v252, v252
    v_mfma_f32_16x16x32_bf16 v[80:83], v[200:203], v[160:163], v[80:83]
    v_rcp_f32 v253, v253
    v_mfma_f32_16x16x32_bf16 v[84:87], v[200:203], v[164:167], v[84:87]
    v_rcp_f32 v254, v254
    s_waitcnt lgkmcnt(0)
    s_barrier
    v_mfma_f32_16x16x32_bf16 v[16:19], v[212:215], v[204:207], v[16:19]
    ds_read_b128 v[160:163], v10 offset:0
    v_mfma_f32_16x16x32_bf16 v[20:23], v[212:215], v[208:211], v[20:23]
    ds_read_b128 v[164:167], v10 offset:2048
    v_rcp_f32 v255, v255
    v_mfma_f32_16x16x32_bf16 v[24:27], v[216:219], v[204:207], v[24:27]
    ds_read_b128 v[168:171], v2 offset:0
    v_mul_f32 v152, v152, v12
    v_mfma_f32_16x16x32_bf16 v[28:31], v[216:219], v[208:211], v[28:31]
    ds_read_b128 v[172:175], v2 offset:1024
    v_mul_f32 v153, v153, v13
    v_mfma_f32_16x16x32_bf16 v[32:35], v[220:223], v[204:207], v[32:35]
    ds_read_b128 v[176:179], v2 offset:2048
    v_mul_f32 v154, v154, v14
    v_mfma_f32_16x16x32_bf16 v[36:39], v[220:223], v[208:211], v[36:39]
    ds_read_b128 v[180:183], v2 offset:3072
    v_mul_f32 v155, v155, v15
    v_mfma_f32_16x16x32_bf16 v[40:43], v[224:227], v[204:207], v[40:43]
    ds_read_b128 v[184:187], v2 offset:4096
    v_mul_f32 v156, v156, v252
    v_mfma_f32_16x16x32_bf16 v[44:47], v[224:227], v[208:211], v[44:47]
    ds_read_b128 v[188:191], v2 offset:5120
    v_mfma_f32_16x16x32_bf16 v[48:51], v[228:231], v[204:207], v[48:51]
    ds_read_b128 v[192:195], v2 offset:6144
    v_mul_f32 v157, v157, v253
    v_mfma_f32_16x16x32_bf16 v[52:55], v[228:231], v[208:211], v[52:55]
    ds_read_b128 v[196:199], v2 offset:7168
    v_mul_f32 v158, v158, v254
    v_mfma_f32_16x16x32_bf16 v[56:59], v[232:235], v[204:207], v[56:59]
    ds_read_b128 v[200:203], v2 offset:8192
    v_mul_f32 v159, v159, v255
    v_mfma_f32_16x16x32_bf16 v[60:63], v[232:235], v[208:211], v[60:63]
    s_mul_i32 s36, s31, 73728
    s_add_u32 s36, s36, s21
    v_mfma_f32_16x16x32_bf16 v[64:67], v[236:239], v[204:207], v[64:67]
    s_lshl_b32 s34, s24, 10
    s_lshr_b32 s35, s24, 1
    v_mfma_f32_16x16x32_bf16 v[68:71], v[236:239], v[208:211], v[68:71]
    s_lshl_b32 s35, s35, 10
    s_and_b32 s33, s24, 1
    v_mfma_f32_16x16x32_bf16 v[72:75], v[240:243], v[204:207], v[72:75]
    s_mul_i32 s33, s33, 73728
    s_add_u32 s35, s35, s33
    v_mfma_f32_16x16x32_bf16 v[76:79], v[240:243], v[208:211], v[76:79]
    s_add_u32 s35, s35, 65536
    v_add_u32 v14, s34, v1
    v_mfma_f32_16x16x32_bf16 v[80:83], v[244:247], v[204:207], v[80:83]
    v_add_u32 v15, s35, v1
    s_add_u32 s39, s36, 0x1200000
    v_mfma_f32_16x16x32_bf16 v[84:87], v[244:247], v[208:211], v[84:87]
    s_add_u32 s40, s36, 0x1212000
    s_mov_b32 s41, 5
    .p2align 6
L_g_loop:
    s_waitcnt lgkmcnt(5)
    v_mfma_f32_16x16x32_bf16 v[16:19], v[168:171], v[160:163], v[16:19]
    ds_read_b128 v[204:207], v11 offset:0
    v_mfma_f32_16x16x32_bf16 v[20:23], v[168:171], v[164:167], v[20:23]
    ds_read_b128 v[208:211], v11 offset:2048
    v_mfma_f32_16x16x32_bf16 v[24:27], v[172:175], v[160:163], v[24:27]
    ds_read_b128 v[212:215], v2 offset:9216
    v_mfma_f32_16x16x32_bf16 v[28:31], v[172:175], v[164:167], v[28:31]
    ds_read_b128 v[216:219], v2 offset:10240
    v_mfma_f32_16x16x32_bf16 v[32:35], v[176:179], v[160:163], v[32:35]
    ds_read_b128 v[220:223], v2 offset:11264
    v_mfma_f32_16x16x32_bf16 v[36:39], v[176:179], v[164:167], v[36:39]
    ds_read_b128 v[224:227], v2 offset:12288
    v_mfma_f32_16x16x32_bf16 v[40:43], v[180:183], v[160:163], v[40:43]
    ds_read_b128 v[228:231], v2 offset:13312
    v_mfma_f32_16x16x32_bf16 v[44:47], v[180:183], v[164:167], v[44:47]
    ds_read_b128 v[232:235], v2 offset:14336
    s_waitcnt lgkmcnt(8)
    v_mfma_f32_16x16x32_bf16 v[48:51], v[184:187], v[160:163], v[48:51]
    ds_read_b128 v[236:239], v2 offset:15360
    v_mfma_f32_16x16x32_bf16 v[52:55], v[184:187], v[164:167], v[52:55]
    ds_read_b128 v[240:243], v2 offset:16384
    v_mfma_f32_16x16x32_bf16 v[56:59], v[188:191], v[160:163], v[56:59]
    ds_read_b128 v[244:247], v2 offset:17408
    v_mfma_f32_16x16x32_bf16 v[60:63], v[188:191], v[164:167], v[60:63]
    v_mfma_f32_16x16x32_bf16 v[64:67], v[192:195], v[160:163], v[64:67]
    v_mfma_f32_16x16x32_bf16 v[68:71], v[192:195], v[164:167], v[68:71]
    v_mfma_f32_16x16x32_bf16 v[72:75], v[196:199], v[160:163], v[72:75]
    v_mfma_f32_16x16x32_bf16 v[76:79], v[196:199], v[164:167], v[76:79]
    v_mfma_f32_16x16x32_bf16 v[80:83], v[200:203], v[160:163], v[80:83]
    v_mfma_f32_16x16x32_bf16 v[84:87], v[200:203], v[164:167], v[84:87]
    s_waitcnt lgkmcnt(0)
    s_barrier
    v_mfma_f32_16x16x32_bf16 v[16:19], v[212:215], v[204:207], v[16:19]
    ds_read_b128 v[160:163], v10 offset:36864
    v_mfma_f32_16x16x32_bf16 v[20:23], v[212:215], v[208:211], v[20:23]
    ds_read_b128 v[164:167], v10 offset:38912
    v_mfma_f32_16x16x32_bf16 v[24:27], v[216:219], v[204:207], v[24:27]
    ds_read_b128 v[168:171], v2 offset:36864
    v_mfma_f32_16x16x32_bf16 v[28:31], v[216:219], v[208:211], v[28:31]
    ds_read_b128 v[172:175], v2 offset:37888
    v_mfma_f32_16x16x32_bf16 v[32:35], v[220:223], v[204:207], v[32:35]
    ds_read_b128 v[176:179], v2 offset:38912
    v_mfma_f32_16x16x32_bf16 v[36:39], v[220:223], v[208:211], v[36:39]
    ds_read_b128 v[180:183], v2 offset:39936
    v_mfma_f32_16x16x32_bf16 v[40:43], v[224:227], v[204:207], v[40:43]
    ds_read_b128 v[184:187], v2 offset:40960
    v_mfma_f32_16x16x32_bf16 v[44:47], v[224:227], v[208:211], v[44:47]
    ds_read_b128 v[188:191], v2 offset:41984
    v_mfma_f32_16x16x32_bf16 v[48:51], v[228:231], v[204:207], v[48:51]
    ds_read_b128 v[192:195], v2 offset:43008
    v_mfma_f32_16x16x32_bf16 v[52:55], v[228:231], v[208:211], v[52:55]
    ds_read_b128 v[196:199], v2 offset:44032
    v_mfma_f32_16x16x32_bf16 v[56:59], v[232:235], v[204:207], v[56:59]
    ds_read_b128 v[200:203], v2 offset:45056
    v_mfma_f32_16x16x32_bf16 v[60:63], v[232:235], v[208:211], v[60:63]
    v_mfma_f32_16x16x32_bf16 v[64:67], v[236:239], v[204:207], v[64:67]
    v_mfma_f32_16x16x32_bf16 v[68:71], v[236:239], v[208:211], v[68:71]
    v_mfma_f32_16x16x32_bf16 v[72:75], v[240:243], v[204:207], v[72:75]
    v_mfma_f32_16x16x32_bf16 v[76:79], v[240:243], v[208:211], v[76:79]
    v_mfma_f32_16x16x32_bf16 v[80:83], v[244:247], v[204:207], v[80:83]
    v_mfma_f32_16x16x32_bf16 v[84:87], v[244:247], v[208:211], v[84:87]
    s_waitcnt lgkmcnt(5)
    v_mfma_f32_16x16x32_bf16 v[16:19], v[168:171], v[160:163], v[16:19]
    ds_read_b128 v[204:207], v11 offset:36864
    v_mfma_f32_16x16x32_bf16 v[20:23], v[168:171], v[164:167], v[20:23]
    ds_read_b128 v[208:211], v11 offset:38912
    v_mfma_f32_16x16x32_bf16 v[24:27], v[172:175], v[160:163], v[24:27]
    ds_read_b128 v[212:215], v2 offset:46080
    v_mfma_f32_16x16x32_bf16 v[28:31], v[172:175], v[164:167], v[28:31]
    ds_read_b128 v[216:219], v2 offset:47104
    v_mfma_f32_16x16x32_bf16 v[32:35], v[176:179], v[160:163], v[32:35]
    ds_read_b128 v[220:223], v2 offset:48128
    v_mfma_f32_16x16x32_bf16 v[36:39], v[176:179], v[164:167], v[36:39]
    ds_read_b128 v[224:227], v2 offset:49152
    v_mfma_f32_16x16x32_bf16 v[40:43], v[180:183], v[160:163], v[40:43]
    ds_read_b128 v[228:231], v2 offset:50176
    v_mfma_f32_16x16x32_bf16 v[44:47], v[180:183], v[164:167], v[44:47]
    ds_read_b128 v[232:235], v2 offset:51200
    s_waitcnt lgkmcnt(8)
    v_mfma_f32_16x16x32_bf16 v[48:51], v[184:187], v[160:163], v[48:51]
    ds_read_b128 v[236:239], v2 offset:52224
    v_mfma_f32_16x16x32_bf16 v[52:55], v[184:187], v[164:167], v[52:55]
    ds_read_b128 v[240:243], v2 offset:53248
    v_mfma_f32_16x16x32_bf16 v[56:59], v[188:191], v[160:163], v[56:59]
    ds_read_b128 v[244:247], v2 offset:54272
    v_mfma_f32_16x16x32_bf16 v[60:63], v[188:191], v[164:167], v[60:63]
    v_mfma_f32_16x16x32_bf16 v[64:67], v[192:195], v[160:163], v[64:67]
    v_mfma_f32_16x16x32_bf16 v[68:71], v[192:195], v[164:167], v[68:71]
    v_mfma_f32_16x16x32_bf16 v[72:75], v[196:199], v[160:163], v[72:75]
    v_mfma_f32_16x16x32_bf16 v[76:79], v[196:199], v[164:167], v[76:79]
    v_mfma_f32_16x16x32_bf16 v[80:83], v[200:203], v[160:163], v[80:83]
    v_mfma_f32_16x16x32_bf16 v[84:87], v[200:203], v[164:167], v[84:87]
    s_waitcnt lgkmcnt(0)
    s_barrier
    v_mfma_f32_16x16x32_bf16 v[16:19], v[212:215], v[204:207], v[16:19]
    ds_read_b128 v[160:163], v8 offset:0
    v_mfma_f32_16x16x32_bf16 v[20:23], v[212:215], v[208:211], v[20:23]
    ds_read_b128 v[164:167], v8 offset:2048
    v_mfma_f32_16x16x32_bf16 v[24:27], v[216:219], v[204:207], v[24:27]
    ds_read_b128 v[168:171], v1 offset:0
    v_mfma_f32_16x16x32_bf16 v[28:31], v[216:219], v[208:211], v[28:31]
    ds_read_b128 v[172:175], v1 offset:1024
    v_mfma_f32_16x16x32_bf16 v[32:35], v[220:223], v[204:207], v[32:35]
    ds_read_b128 v[176:179], v1 offset:2048
    v_mfma_f32_16x16x32_bf16 v[36:39], v[220:223], v[208:211], v[36:39]
    ds_read_b128 v[180:183], v1 offset:3072
    v_mfma_f32_16x16x32_bf16 v[40:43], v[224:227], v[204:207], v[40:43]
    ds_read_b128 v[184:187], v1 offset:4096
    v_mfma_f32_16x16x32_bf16 v[44:47], v[224:227], v[208:211], v[44:47]
    ds_read_b128 v[188:191], v1 offset:5120
    v_mfma_f32_16x16x32_bf16 v[48:51], v[228:231], v[204:207], v[48:51]
    ds_read_b128 v[192:195], v1 offset:6144
    v_mfma_f32_16x16x32_bf16 v[52:55], v[228:231], v[208:211], v[52:55]
    ds_read_b128 v[196:199], v1 offset:7168
    v_mfma_f32_16x16x32_bf16 v[56:59], v[232:235], v[204:207], v[56:59]
    ds_read_b128 v[200:203], v1 offset:8192
    v_mfma_f32_16x16x32_bf16 v[60:63], v[232:235], v[208:211], v[60:63]
    v_mfma_f32_16x16x32_bf16 v[64:67], v[236:239], v[204:207], v[64:67]
    v_mfma_f32_16x16x32_bf16 v[68:71], v[236:239], v[208:211], v[68:71]
    v_mfma_f32_16x16x32_bf16 v[72:75], v[240:243], v[204:207], v[72:75]
    v_mfma_f32_16x16x32_bf16 v[76:79], v[240:243], v[208:211], v[76:79]
    v_mfma_f32_16x16x32_bf16 v[80:83], v[244:247], v[204:207], v[80:83]
    v_mfma_f32_16x16x32_bf16 v[84:87], v[244:247], v[208:211], v[84:87]
    s_waitcnt lgkmcnt(5)
    v_mfma_f32_16x16x32_bf16 v[16:19], v[168:171], v[160:163], v[16:19]
    ds_read_b128 v[204:207], v9 offset:0
    v_mfma_f32_16x16x32_bf16 v[20:23], v[168:171], v[164:167], v[20:23]
    ds_read_b128 v[208:211], v9 offset:2048
    v_mfma_f32_16x16x32_bf16 v[24:27], v[172:175], v[160:163], v[24:27]
    ds_read_b128 v[212:215], v1 offset:9216
    v_mfma_f32_16x16x32_bf16 v[28:31], v[172:175], v[164:167], v[28:31]
    ds_read_b128 v[216:219], v1 offset:10240
    v_mfma_f32_16x16x32_bf16 v[32:35], v[176:179], v[160:163], v[32:35]
    ds_read_b128 v[220:223], v1 offset:11264
    v_mfma_f32_16x16x32_bf16 v[36:39], v[176:179], v[164:167], v[36:39]
    ds_read_b128 v[224:227], v1 offset:12288
    v_mfma_f32_16x16x32_bf16 v[40:43], v[180:183], v[160:163], v[40:43]
    ds_read_b128 v[228:231], v1 offset:13312
    v_mfma_f32_16x16x32_bf16 v[44:47], v[180:183], v[164:167], v[44:47]
    ds_read_b128 v[232:235], v1 offset:14336
    s_waitcnt lgkmcnt(8)
    v_mfma_f32_16x16x32_bf16 v[48:51], v[184:187], v[160:163], v[48:51]
    ds_read_b128 v[236:239], v1 offset:15360
    v_mfma_f32_16x16x32_bf16 v[52:55], v[184:187], v[164:167], v[52:55]
    ds_read_b128 v[240:243], v1 offset:16384
    v_mfma_f32_16x16x32_bf16 v[56:59], v[188:191], v[160:163], v[56:59]
    ds_read_b128 v[244:247], v1 offset:17408
    v_mfma_f32_16x16x32_bf16 v[60:63], v[188:191], v[164:167], v[60:63]
    v_mfma_f32_16x16x32_bf16 v[64:67], v[192:195], v[160:163], v[64:67]
    v_mfma_f32_16x16x32_bf16 v[68:71], v[192:195], v[164:167], v[68:71]
    v_mfma_f32_16x16x32_bf16 v[72:75], v[196:199], v[160:163], v[72:75]
    v_mfma_f32_16x16x32_bf16 v[76:79], v[196:199], v[164:167], v[76:79]
    v_mfma_f32_16x16x32_bf16 v[80:83], v[200:203], v[160:163], v[80:83]
    v_mfma_f32_16x16x32_bf16 v[84:87], v[200:203], v[164:167], v[84:87]
    s_waitcnt lgkmcnt(0)
    s_barrier
    v_mfma_f32_16x16x32_bf16 v[16:19], v[212:215], v[204:207], v[16:19]
    ds_read_b128 v[160:163], v8 offset:36864
    v_mfma_f32_16x16x32_bf16 v[20:23], v[212:215], v[208:211], v[20:23]
    ds_read_b128 v[164:167], v8 offset:38912
    v_mfma_f32_16x16x32_bf16 v[24:27], v[216:219], v[204:207], v[24:27]
    ds_read_b128 v[168:171], v1 offset:36864
    v_mfma_f32_16x16x32_bf16 v[28:31], v[216:219], v[208:211], v[28:31]
    ds_read_b128 v[172:175], v1 offset:37888
    v_mfma_f32_16x16x32_bf16 v[32:35], v[220:223], v[204:207], v[32:35]
    ds_read_b128 v[176:179], v1 offset:38912
    v_mfma_f32_16x16x32_bf16 v[36:39], v[220:223], v[208:211], v[36:39]
    ds_read_b128 v[180:183], v1 offset:39936
    v_mfma_f32_16x16x32_bf16 v[40:43], v[224:227], v[204:207], v[40:43]
    ds_read_b128 v[184:187], v1 offset:40960
    v_mfma_f32_16x16x32_bf16 v[44:47], v[224:227], v[208:211], v[44:47]
    ds_read_b128 v[188:191], v1 offset:41984
    v_mfma_f32_16x16x32_bf16 v[48:51], v[228:231], v[204:207], v[48:51]
    ds_read_b128 v[192:195], v1 offset:43008
    v_mfma_f32_16x16x32_bf16 v[52:55], v[228:231], v[208:211], v[52:55]
    ds_read_b128 v[196:199], v1 offset:44032
    v_mfma_f32_16x16x32_bf16 v[56:59], v[232:235], v[204:207], v[56:59]
    ds_read_b128 v[200:203], v1 offset:45056
    v_mfma_f32_16x16x32_bf16 v[60:63], v[232:235], v[208:211], v[60:63]
    v_mfma_f32_16x16x32_bf16 v[64:67], v[236:239], v[204:207], v[64:67]
    v_mfma_f32_16x16x32_bf16 v[68:71], v[236:239], v[208:211], v[68:71]
    v_mfma_f32_16x16x32_bf16 v[72:75], v[240:243], v[204:207], v[72:75]
    v_mfma_f32_16x16x32_bf16 v[76:79], v[240:243], v[208:211], v[76:79]
    v_mfma_f32_16x16x32_bf16 v[80:83], v[244:247], v[204:207], v[80:83]
    v_mfma_f32_16x16x32_bf16 v[84:87], v[244:247], v[208:211], v[84:87]
    s_waitcnt lgkmcnt(5)
    v_mfma_f32_16x16x32_bf16 v[16:19], v[168:171], v[160:163], v[16:19]
    ds_read_b128 v[204:207], v9 offset:36864
    v_mfma_f32_16x16x32_bf16 v[20:23], v[168:171], v[164:167], v[20:23]
    ds_read_b128 v[208:211], v9 offset:38912
    v_mfma_f32_16x16x32_bf16 v[24:27], v[172:175], v[160:163], v[24:27]
    ds_read_b128 v[212:215], v1 offset:46080
    v_mfma_f32_16x16x32_bf16 v[28:31], v[172:175], v[164:167], v[28:31]
    ds_read_b128 v[216:219], v1 offset:47104
    v_mfma_f32_16x16x32_bf16 v[32:35], v[176:179], v[160:163], v[32:35]
    ds_read_b128 v[220:223], v1 offset:48128
    v_mfma_f32_16x16x32_bf16 v[36:39], v[176:179], v[164:167], v[36:39]
    ds_read_b128 v[224:227], v1 offset:49152
    v_mfma_f32_16x16x32_bf16 v[40:43], v[180:183], v[160:163], v[40:43]
    ds_read_b128 v[228:231], v1 offset:50176
    v_mfma_f32_16x16x32_bf16 v[44:47], v[180:183], v[164:167], v[44:47]
    ds_read_b128 v[232:235], v1 offset:51200
    s_waitcnt lgkmcnt(8)
    v_mfma_f32_16x16x32_bf16 v[48:51], v[184:187], v[160:163], v[48:51]
    ds_read_b128 v[236:239], v1 offset:52224
    v_mfma_f32_16x16x32_bf16 v[52:55], v[184:187], v[164:167], v[52:55]
    ds_read_b128 v[240:243], v1 offset:53248
    v_mfma_f32_16x16x32_bf16 v[56:59], v[188:191], v[160:163], v[56:59]
    ds_read_b128 v[244:247], v1 offset:54272
    v_mfma_f32_16x16x32_bf16 v[60:63], v[188:191], v[164:167], v[60:63]
    v_mfma_f32_16x16x32_bf16 v[64:67], v[192:195], v[160:163], v[64:67]
    v_mfma_f32_16x16x32_bf16 v[68:71], v[192:195], v[164:167], v[68:71]
    v_mfma_f32_16x16x32_bf16 v[72:75], v[196:199], v[160:163], v[72:75]
    v_mfma_f32_16x16x32_bf16 v[76:79], v[196:199], v[164:167], v[76:79]
    v_mfma_f32_16x16x32_bf16 v[80:83], v[200:203], v[160:163], v[80:83]
    v_mfma_f32_16x16x32_bf16 v[84:87], v[200:203], v[164:167], v[84:87]
    s_waitcnt lgkmcnt(0)
    s_barrier
    v_mfma_f32_16x16x32_bf16 v[16:19], v[212:215], v[204:207], v[16:19]
    ds_read_b128 v[160:163], v10 offset:0
    v_mfma_f32_16x16x32_bf16 v[20:23], v[212:215], v[208:211], v[20:23]
    ds_read_b128 v[164:167], v10 offset:2048
    v_mfma_f32_16x16x32_bf16 v[24:27], v[216:219], v[204:207], v[24:27]
    ds_read_b128 v[168:171], v2 offset:0
    v_mfma_f32_16x16x32_bf16 v[28:31], v[216:219], v[208:211], v[28:31]
    ds_read_b128 v[172:175], v2 offset:1024
    v_mfma_f32_16x16x32_bf16 v[32:35], v[220:223], v[204:207], v[32:35]
    ds_read_b128 v[176:179], v2 offset:2048
    v_mfma_f32_16x16x32_bf16 v[36:39], v[220:223], v[208:211], v[36:39]
    ds_read_b128 v[180:183], v2 offset:3072
    v_mfma_f32_16x16x32_bf16 v[40:43], v[224:227], v[204:207], v[40:43]
    ds_read_b128 v[184:187], v2 offset:4096
    v_mfma_f32_16x16x32_bf16 v[44:47], v[224:227], v[208:211], v[44:47]
    ds_read_b128 v[188:191], v2 offset:5120
    v_mfma_f32_16x16x32_bf16 v[48:51], v[228:231], v[204:207], v[48:51]
    ds_read_b128 v[192:195], v2 offset:6144
    v_mfma_f32_16x16x32_bf16 v[52:55], v[228:231], v[208:211], v[52:55]
    ds_read_b128 v[196:199], v2 offset:7168
    v_mfma_f32_16x16x32_bf16 v[56:59], v[232:235], v[204:207], v[56:59]
    ds_read_b128 v[200:203], v2 offset:8192
    v_mfma_f32_16x16x32_bf16 v[60:63], v[232:235], v[208:211], v[60:63]
    v_mfma_f32_16x16x32_bf16 v[64:67], v[236:239], v[204:207], v[64:67]
    v_mfma_f32_16x16x32_bf16 v[68:71], v[236:239], v[208:211], v[68:71]
    v_mfma_f32_16x16x32_bf16 v[72:75], v[240:243], v[204:207], v[72:75]
    v_mfma_f32_16x16x32_bf16 v[76:79], v[240:243], v[208:211], v[76:79]
    v_mfma_f32_16x16x32_bf16 v[80:83], v[244:247], v[204:207], v[80:83]
    s_sub_u32 s41, s41, 1
    v_mfma_f32_16x16x32_bf16 v[84:87], v[244:247], v[208:211], v[84:87]
    s_cmp_lg_u32 s41, 0
    s_cbranch_scc1 L_g_loop
    s_waitcnt lgkmcnt(5)
    v_mfma_f32_16x16x32_bf16 v[16:19], v[168:171], v[160:163], v[16:19]
    ds_read_b128 v[204:207], v11 offset:0
    v_mfma_f32_16x16x32_bf16 v[20:23], v[168:171], v[164:167], v[20:23]
    ds_read_b128 v[208:211], v11 offset:2048
    v_mfma_f32_16x16x32_bf16 v[24:27], v[172:175], v[160:163], v[24:27]
    ds_read_b128 v[212:215], v2 offset:9216
    v_mfma_f32_16x16x32_bf16 v[28:31], v[172:175], v[164:167], v[28:31]
    ds_read_b128 v[216:219], v2 offset:10240
    v_mfma_f32_16x16x32_bf16 v[32:35], v[176:179], v[160:163], v[32:35]
    ds_read_b128 v[220:223], v2 offset:11264
    v_mfma_f32_16x16x32_bf16 v[36:39], v[176:179], v[164:167], v[36:39]
    ds_read_b128 v[224:227], v2 offset:12288
    v_mfma_f32_16x16x32_bf16 v[40:43], v[180:183], v[160:163], v[40:43]
    ds_read_b128 v[228:231], v2 offset:13312
    v_mfma_f32_16x16x32_bf16 v[44:47], v[180:183], v[164:167], v[44:47]
    ds_read_b128 v[232:235], v2 offset:14336
    s_waitcnt lgkmcnt(8)
    v_mfma_f32_16x16x32_bf16 v[48:51], v[184:187], v[160:163], v[48:51]
    ds_read_b128 v[236:239], v2 offset:15360
    v_mfma_f32_16x16x32_bf16 v[52:55], v[184:187], v[164:167], v[52:55]
    ds_read_b128 v[240:243], v2 offset:16384
    v_mfma_f32_16x16x32_bf16 v[56:59], v[188:191], v[160:163], v[56:59]
    ds_read_b128 v[244:247], v2 offset:17408
    v_mfma_f32_16x16x32_bf16 v[60:63], v[188:191], v[164:167], v[60:63]
    v_mfma_f32_16x16x32_bf16 v[64:67], v[192:195], v[160:163], v[64:67]
    v_mfma_f32_16x16x32_bf16 v[68:71], v[192:195], v[164:167], v[68:71]
    v_mfma_f32_16x16x32_bf16 v[72:75], v[196:199], v[160:163], v[72:75]
    v_mfma_f32_16x16x32_bf16 v[76:79], v[196:199], v[164:167], v[76:79]
    v_mfma_f32_16x16x32_bf16 v[80:83], v[200:203], v[160:163], v[80:83]
    v_mfma_f32_16x16x32_bf16 v[84:87], v[200:203], v[164:167], v[84:87]
    s_waitcnt lgkmcnt(0)
    s_barrier
    v_mfma_f32_16x16x32_bf16 v[16:19], v[212:215], v[204:207], v[16:19]
    ds_read_b128 v[160:163], v10 offset:36864
    v_mfma_f32_16x16x32_bf16 v[20:23], v[212:215], v[208:211], v[20:23]
    ds_read_b128 v[164:167], v10 offset:38912
    v_mfma_f32_16x16x32_bf16 v[24:27], v[216:219], v[204:207], v[24:27]
    ds_read_b128 v[168:171], v2 offset:36864
    v_mfma_f32_16x16x32_bf16 v[28:31], v[216:219], v[208:211], v[28:31]
    ds_read_b128 v[172:175], v2 offset:37888
    v_mfma_f32_16x16x32_bf16 v[32:35], v[220:223], v[204:207], v[32:35]
    ds_read_b128 v[176:179], v2 offset:38912
    v_mfma_f32_16x16x32_bf16 v[36:39], v[220:223], v[208:211], v[36:39]
    ds_read_b128 v[180:183], v2 offset:39936
    v_mfma_f32_16x16x32_bf16 v[40:43], v[224:227], v[204:207], v[40:43]
    ds_read_b128 v[184:187], v2 offset:40960
    v_mfma_f32_16x16x32_bf16 v[44:47], v[224:227], v[208:211], v[44:47]
    ds_read_b128 v[188:191], v2 offset:41984
    v_mfma_f32_16x16x32_bf16 v[48:51], v[228:231], v[204:207], v[48:51]
    ds_read_b128 v[192:195], v2 offset:43008
    v_mfma_f32_16x16x32_bf16 v[52:55], v[228:231], v[208:211], v[52:55]
    ds_read_b128 v[196:199], v2 offset:44032
    v_mfma_f32_16x16x32_bf16 v[56:59], v[232:235], v[204:207], v[56:59]
    ds_read_b128 v[200:203], v2 offset:45056
    v_mfma_f32_16x16x32_bf16 v[60:63], v[232:235], v[208:211], v[60:63]
    v_mfma_f32_16x16x32_bf16 v[64:67], v[236:239], v[204:207], v[64:67]
    v_mfma_f32_16x16x32_bf16 v[68:71], v[236:239], v[208:211], v[68:71]
    v_mfma_f32_16x16x32_bf16 v[72:75], v[240:243], v[204:207], v[72:75]
    v_mfma_f32_16x16x32_bf16 v[76:79], v[240:243], v[208:211], v[76:79]
    v_mfma_f32_16x16x32_bf16 v[80:83], v[244:247], v[204:207], v[80:83]
    v_mfma_f32_16x16x32_bf16 v[84:87], v[244:247], v[208:211], v[84:87]
    s_waitcnt lgkmcnt(5)
    v_mfma_f32_16x16x32_bf16 v[16:19], v[168:171], v[160:163], v[16:19]
    ds_read_b128 v[204:207], v11 offset:36864
    v_mfma_f32_16x16x32_bf16 v[20:23], v[168:171], v[164:167], v[20:23]
    ds_read_b128 v[208:211], v11 offset:38912
    v_mfma_f32_16x16x32_bf16 v[24:27], v[172:175], v[160:163], v[24:27]
    ds_read_b128 v[212:215], v2 offset:46080
    v_mfma_f32_16x16x32_bf16 v[28:31], v[172:175], v[164:167], v[28:31]
    ds_read_b128 v[216:219], v2 offset:47104
    v_mfma_f32_16x16x32_bf16 v[32:35], v[176:179], v[160:163], v[32:35]
    ds_read_b128 v[220:223], v2 offset:48128
    v_mfma_f32_16x16x32_bf16 v[36:39], v[176:179], v[164:167], v[36:39]
    ds_read_b128 v[224:227], v2 offset:49152
    v_mfma_f32_16x16x32_bf16 v[40:43], v[180:183], v[160:163], v[40:43]
    ds_read_b128 v[228:231], v2 offset:50176
    v_mfma_f32_16x16x32_bf16 v[44:47], v[180:183], v[164:167], v[44:47]
    ds_read_b128 v[232:235], v2 offset:51200
    s_waitcnt lgkmcnt(8)
    v_mfma_f32_16x16x32_bf16 v[48:51], v[184:187], v[160:163], v[48:51]
    ds_read_b128 v[236:239], v2 offset:52224
    v_mfma_f32_16x16x32_bf16 v[52:55], v[184:187], v[164:167], v[52:55]
    ds_read_b128 v[240:243], v2 offset:53248
    v_mfma_f32_16x16x32_bf16 v[56:59], v[188:191], v[160:163], v[56:59]
    ds_read_b128 v[244:247], v2 offset:54272
    v_mfma_f32_16x16x32_bf16 v[60:63], v[188:191], v[164:167], v[60:63]
    v_mfma_f32_16x16x32_bf16 v[64:67], v[192:195], v[160:163], v[64:67]
    v_mfma_f32_16x16x32_bf16 v[68:71], v[192:195], v[164:167], v[68:71]
    v_mfma_f32_16x16x32_bf16 v[72:75], v[196:199], v[160:163], v[72:75]
    v_mfma_f32_16x16x32_bf16 v[76:79], v[196:199], v[164:167], v[76:79]
    v_mfma_f32_16x16x32_bf16 v[80:83], v[200:203], v[160:163], v[80:83]
    v_mfma_f32_16x16x32_bf16 v[84:87], v[200:203], v[164:167], v[84:87]
    s_waitcnt lgkmcnt(0)
    s_barrier
    v_mfma_f32_16x16x32_bf16 v[16:19], v[212:215], v[204:207], v[16:19]
    ds_read_b128 v[160:163], v8 offset:0
    v_mfma_f32_16x16x32_bf16 v[20:23], v[212:215], v[208:211], v[20:23]
    ds_read_b128 v[164:167], v8 offset:2048
    v_mfma_f32_16x16x32_bf16 v[24:27], v[216:219], v[204:207], v[24:27]
    ds_read_b128 v[192:195], v1 offset:0
    v_mfma_f32_16x16x32_bf16 v[28:31], v[216:219], v[208:211], v[28:31]
    ds_read_b128 v[168:171], v9 offset:0
    v_mfma_f32_16x16x32_bf16 v[32:35], v[220:223], v[204:207], v[32:35]
    ds_read_b128 v[172:175], v9 offset:2048
    v_mfma_f32_16x16x32_bf16 v[36:39], v[220:223], v[208:211], v[36:39]
    ds_read_b128 v[176:179], v8 offset:36864
    v_mfma_f32_16x16x32_bf16 v[40:43], v[224:227], v[204:207], v[40:43]
    ds_read_b128 v[180:183], v8 offset:38912
    v_mfma_f32_16x16x32_bf16 v[44:47], v[224:227], v[208:211], v[44:47]
    ds_read_b128 v[184:187], v9 offset:36864
    v_mfma_f32_16x16x32_bf16 v[48:51], v[228:231], v[204:207], v[48:51]
    ds_read_b128 v[188:191], v9 offset:38912
    v_mfma_f32_16x16x32_bf16 v[52:55], v[228:231], v[208:211], v[52:55]
    ds_read_b128 v[196:199], v1 offset:9216
    v_mfma_f32_16x16x32_bf16 v[56:59], v[232:235], v[204:207], v[56:59]
    ds_read_b128 v[200:203], v1 offset:36864
    v_mfma_f32_16x16x32_bf16 v[60:63], v[232:235], v[208:211], v[60:63]
    v_mfma_f32_16x16x32_bf16 v[64:67], v[236:239], v[204:207], v[64:67]
    v_mfma_f32_16x16x32_bf16 v[68:71], v[236:239], v[208:211], v[68:71]
    v_mfma_f32_16x16x32_bf16 v[72:75], v[240:243], v[204:207], v[72:75]
    v_mfma_f32_16x16x32_bf16 v[76:79], v[240:243], v[208:211], v[76:79]
    v_mfma_f32_16x16x32_bf16 v[80:83], v[244:247], v[204:207], v[80:83]
    v_mfma_f32_16x16x32_bf16 v[84:87], v[244:247], v[208:211], v[84:87]
    s_waitcnt lgkmcnt(0)
    v_mfma_f32_16x16x32_bf16 v[16:19], v[192:195], v[160:163], v[16:19]
    ds_read_b128 v[204:207], v1 offset:46080
    v_mfma_f32_16x16x32_bf16 v[20:23], v[192:195], v[164:167], v[20:23]
    ds_read_b128 v[208:211], v1 offset:1024
    s_waitcnt lgkmcnt(3)
    v_mfma_f32_16x16x32_bf16 v[16:19], v[196:199], v[168:171], v[16:19]
    ds_read_b128 v[212:215], v1 offset:10240
    v_mfma_f32_16x16x32_bf16 v[20:23], v[196:199], v[172:175], v[20:23]
    ds_read_b128 v[216:219], v1 offset:37888
    s_waitcnt lgkmcnt(4)
    v_mfma_f32_16x16x32_bf16 v[16:19], v[200:203], v[176:179], v[16:19]
    ds_read_b128 v[220:223], v1 offset:47104
    v_mfma_f32_16x16x32_bf16 v[20:23], v[200:203], v[180:183], v[20:23]
    ds_read_b128 v[224:227], v1 offset:2048
    s_waitcnt lgkmcnt(5)
    v_mfma_f32_16x16x32_bf16 v[16:19], v[204:207], v[184:187], v[16:19]
    ds_read_b128 v[228:231], v1 offset:11264
    v_mfma_f32_16x16x32_bf16 v[20:23], v[204:207], v[188:191], v[20:23]
    ds_read_b128 v[232:235], v1 offset:38912
    s_waitcnt lgkmcnt(6)
    v_mfma_f32_16x16x32_bf16 v[24:27], v[208:211], v[160:163], v[24:27]
    ds_read_b128 v[236:239], v1 offset:48128
    v_mfma_f32_16x16x32_bf16 v[28:31], v[208:211], v[164:167], v[28:31]
    ds_read_b128 v[240:243], v1 offset:3072
    s_waitcnt lgkmcnt(7)
    v_mfma_f32_16x16x32_bf16 v[24:27], v[212:215], v[168:171], v[24:27]
    ds_read_b128 v[244:247], v1 offset:12288
    v_mfma_f32_16x16x32_bf16 v[28:31], v[212:215], v[172:175], v[28:31]
    s_waitcnt lgkmcnt(7)
    v_mfma_f32_16x16x32_bf16 v[24:27], v[216:219], v[176:179], v[24:27]
    ds_read_b128 v[192:195], v1 offset:39936
    v_mul_f32 v16, v16, v88
    v_mfma_f32_16x16x32_bf16 v[28:31], v[216:219], v[180:183], v[28:31]
    v_mul_f32 v17, v17, v89
    v_mul_f32 v18, v18, v90
    s_waitcnt lgkmcnt(7)
    v_mfma_f32_16x16x32_bf16 v[24:27], v[220:223], v[184:187], v[24:27]
    ds_read_b128 v[196:199], v1 offset:49152
    v_mul_f32 v19, v19, v91
    v_mfma_f32_16x16x32_bf16 v[28:31], v[220:223], v[188:191], v[28:31]
    v_cvt_pk_bf16_f32 v88, v16, v17
    v_cvt_pk_bf16_f32 v89, v18, v19
    s_waitcnt lgkmcnt(7)
    v_mfma_f32_16x16x32_bf16 v[32:35], v[224:227], v[160:163], v[32:35]
    ds_read_b128 v[200:203], v1 offset:4096
    v_mul_f32 v20, v20, v92
    v_mfma_f32_16x16x32_bf16 v[36:39], v[224:227], v[164:167], v[36:39]
    v_mul_f32 v21, v21, v93
    v_mul_f32 v22, v22, v94
    s_waitcnt lgkmcnt(7)
    v_mfma_f32_16x16x32_bf16 v[32:35], v[228:231], v[168:171], v[32:35]
    ds_read_b128 v[204:207], v1 offset:13312
    v_mul_f32 v23, v23, v95
    v_mfma_f32_16x16x32_bf16 v[36:39], v[228:231], v[172:175], v[36:39]
    v_cvt_pk_bf16_f32 v92, v20, v21
    v_cvt_pk_bf16_f32 v93, v22, v23
    s_waitcnt lgkmcnt(7)
    v_mfma_f32_16x16x32_bf16 v[32:35], v[232:235], v[176:179], v[32:35]
    ds_read_b128 v[208:211], v1 offset:40960
    v_mul_f32 v24, v24, v96
    v_mfma_f32_16x16x32_bf16 v[36:39], v[232:235], v[180:183], v[36:39]
    v_mul_f32 v25, v25, v97
    v_mul_f32 v26, v26, v98
    v_mul_f32 v27, v27, v99
    s_waitcnt lgkmcnt(7)
    v_mfma_f32_16x16x32_bf16 v[32:35], v[236:239], v[184:187], v[32:35]
    ds_read_b128 v[212:215], v1 offset:50176
    v_cvt_pk_bf16_f32 v90, v24, v25
    v_mfma_f32_16x16x32_bf16 v[36:39], v[236:239], v[188:191], v[36:39]
    v_cvt_pk_bf16_f32 v91, v26, v27
    buffer_store_dwordx4 v[88:91], v14, s[4:7], s39 offen sc1
    s_waitcnt lgkmcnt(7)
    v_mfma_f32_16x16x32_bf16 v[40:43], v[240:243], v[160:163], v[40:43]
    ds_read_b128 v[216:219], v1 offset:5120
    v_mul_f32 v28, v28, v100
    v_mfma_f32_16x16x32_bf16 v[44:47], v[240:243], v[164:167], v[44:47]
    v_mul_f32 v29, v29, v101
    v_mul_f32 v30, v30, v102
    s_waitcnt lgkmcnt(7)
    v_mfma_f32_16x16x32_bf16 v[40:43], v[244:247], v[168:171], v[40:43]
    ds_read_b128 v[220:223], v1 offset:14336
    v_mul_f32 v31, v31, v103
    v_mfma_f32_16x16x32_bf16 v[44:47], v[244:247], v[172:175], v[44:47]
    v_cvt_pk_bf16_f32 v94, v28, v29
    v_cvt_pk_bf16_f32 v95, v30, v31
    s_waitcnt lgkmcnt(7)
    v_mfma_f32_16x16x32_bf16 v[40:43], v[192:195], v[176:179], v[40:43]
    ds_read_b128 v[224:227], v1 offset:41984
    buffer_store_dwordx4 v[92:95], v14, s[4:7], s40 offen sc1
    v_mfma_f32_16x16x32_bf16 v[44:47], v[192:195], v[180:183], v[44:47]
    v_add_u32 v14, 16384, v14
    v_mul_f32 v32, v32, v104
    v_mul_f32 v33, v33, v105
    s_waitcnt lgkmcnt(7)
    v_mfma_f32_16x16x32_bf16 v[40:43], v[196:199], v[184:187], v[40:43]
    ds_read_b128 v[228:231], v1 offset:51200
    v_mul_f32 v34, v34, v106
    v_mfma_f32_16x16x32_bf16 v[44:47], v[196:199], v[188:191], v[44:47]
    v_mul_f32 v35, v35, v107
    v_cvt_pk_bf16_f32 v104, v32, v33
    s_waitcnt lgkmcnt(7)
    v_mfma_f32_16x16x32_bf16 v[48:51], v[200:203], v[160:163], v[48:51]
    ds_read_b128 v[232:235], v1 offset:6144
    v_cvt_pk_bf16_f32 v105, v34, v35
    v_mfma_f32_16x16x32_bf16 v[52:55], v[200:203], v[164:167], v[52:55]
    v_mul_f32 v36, v36, v108
    v_mul_f32 v37, v37, v109
    s_waitcnt lgkmcnt(7)
    v_mfma_f32_16x16x32_bf16 v[48:51], v[204:207], v[168:171], v[48:51]
    ds_read_b128 v[236:239], v1 offset:15360
    v_mul_f32 v38, v38, v110
    v_mfma_f32_16x16x32_bf16 v[52:55], v[204:207], v[172:175], v[52:55]
    v_mul_f32 v39, v39, v111
    v_cvt_pk_bf16_f32 v108, v36, v37
    s_waitcnt lgkmcnt(7)
    v_mfma_f32_16x16x32_bf16 v[48:51], v[208:211], v[176:179], v[48:51]
    ds_read_b128 v[240:243], v1 offset:43008
    v_cvt_pk_bf16_f32 v109, v38, v39
    v_mfma_f32_16x16x32_bf16 v[52:55], v[208:211], v[180:183], v[52:55]
    v_mul_f32 v40, v40, v112
    v_mul_f32 v41, v41, v113
    v_mul_f32 v42, v42, v114
    s_waitcnt lgkmcnt(7)
    v_mfma_f32_16x16x32_bf16 v[48:51], v[212:215], v[184:187], v[48:51]
    ds_read_b128 v[244:247], v1 offset:52224
    v_mul_f32 v43, v43, v115
    v_mfma_f32_16x16x32_bf16 v[52:55], v[212:215], v[188:191], v[52:55]
    v_cvt_pk_bf16_f32 v106, v40, v41
    v_cvt_pk_bf16_f32 v107, v42, v43
    s_waitcnt lgkmcnt(7)
    v_mfma_f32_16x16x32_bf16 v[56:59], v[216:219], v[160:163], v[56:59]
    ds_read_b128 v[192:195], v1 offset:7168
    buffer_store_dwordx4 v[104:107], v14, s[4:7], s39 offen sc1
    v_mfma_f32_16x16x32_bf16 v[60:63], v[216:219], v[164:167], v[60:63]
    v_mul_f32 v44, v44, v116
    v_mul_f32 v45, v45, v117
    s_waitcnt lgkmcnt(7)
    v_mfma_f32_16x16x32_bf16 v[56:59], v[220:223], v[168:171], v[56:59]
    ds_read_b128 v[196:199], v1 offset:16384
    v_mul_f32 v46, v46, v118
    v_mfma_f32_16x16x32_bf16 v[60:63], v[220:223], v[172:175], v[60:63]
    v_mul_f32 v47, v47, v119
    v_cvt_pk_bf16_f32 v110, v44, v45
    s_waitcnt lgkmcnt(7)
    v_mfma_f32_16x16x32_bf16 v[56:59], v[224:227], v[176:179], v[56:59]
    ds_read_b128 v[200:203], v1 offset:44032
    v_cvt_pk_bf16_f32 v111, v46, v47
    v_mfma_f32_16x16x32_bf16 v[60:63], v[224:227], v[180:183], v[60:63]
    buffer_store_dwordx4 v[108:111], v14, s[4:7], s40 offen sc1
    v_add_u32 v14, 16384, v14
    v_mul_f32 v48, v48, v120
    s_waitcnt lgkmcnt(7)
    v_mfma_f32_16x16x32_bf16 v[56:59], v[228:231], v[184:187], v[56:59]
    ds_read_b128 v[204:207], v1 offset:53248
    v_mul_f32 v49, v49, v121
    v_mfma_f32_16x16x32_bf16 v[60:63], v[228:231], v[188:191], v[60:63]
    v_mul_f32 v50, v50, v122
    v_mul_f32 v51, v51, v123
    s_waitcnt lgkmcnt(7)
    v_mfma_f32_16x16x32_bf16 v[64:67], v[232:235], v[160:163], v[64:67]
    ds_read_b128 v[208:211], v1 offset:8192
    v_cvt_pk_bf16_f32 v120, v48, v49
    v_mfma_f32_16x16x32_bf16 v[68:71], v[232:235], v[164:167], v[68:71]
    v_cvt_pk_bf16_f32 v121, v50, v51
    v_mul_f32 v52, v52, v124
    s_waitcnt lgkmcnt(7)
    v_mfma_f32_16x16x32_bf16 v[64:67], v[236:239], v[168:171], v[64:67]
    ds_read_b128 v[212:215], v1 offset:17408
    v_mul_f32 v53, v53, v125
    v_mfma_f32_16x16x32_bf16 v[68:71], v[236:239], v[172:175], v[68:71]
    v_mul_f32 v54, v54, v126
    v_mul_f32 v55, v55, v127
    s_waitcnt lgkmcnt(7)
    v_mfma_f32_16x16x32_bf16 v[64:67], v[240:243], v[176:179], v[64:67]
    ds_read_b128 v[216:219], v1 offset:45056
    v_cvt_pk_bf16_f32 v124, v52, v53
    v_mfma_f32_16x16x32_bf16 v[68:71], v[240:243], v[180:183], v[68:71]
    v_cvt_pk_bf16_f32 v125, v54, v55
    v_mul_f32 v56, v56, v128
    v_mul_f32 v57, v57, v129
    s_waitcnt lgkmcnt(7)
    v_mfma_f32_16x16x32_bf16 v[64:67], v[244:247], v[184:187], v[64:67]
    ds_read_b128 v[220:223], v1 offset:54272
    v_mul_f32 v58, v58, v130
    v_mfma_f32_16x16x32_bf16 v[68:71], v[244:247], v[188:191], v[68:71]
    v_mul_f32 v59, v59, v131
    v_cvt_pk_bf16_f32 v122, v56, v57
    v_cvt_pk_bf16_f32 v123, v58, v59
    s_waitcnt lgkmcnt(7)
    v_mfma_f32_16x16x32_bf16 v[72:75], v[192:195], v[160:163], v[72:75]
    buffer_store_dwordx4 v[120:123], v14, s[4:7], s39 offen sc1
    v_mul_f32 v60, v60, v132
    v_mfma_f32_16x16x32_bf16 v[76:79], v[192:195], v[164:167], v[76:79]
    v_mul_f32 v61, v61, v133
    v_mul_f32 v62, v62, v134
    s_waitcnt lgkmcnt(6)
    v_mfma_f32_16x16x32_bf16 v[72:75], v[196:199], v[168:171], v[72:75]
    v_mul_f32 v63, v63, v135
    v_cvt_pk_bf16_f32 v126, v60, v61
    v_mfma_f32_16x16x32_bf16 v[76:79], v[196:199], v[172:175], v[76:79]
    v_cvt_pk_bf16_f32 v127, v62, v63
    buffer_store_dwordx4 v[124:127], v14, s[4:7], s40 offen sc1
    s_waitcnt lgkmcnt(5)
    v_mfma_f32_16x16x32_bf16 v[72:75], v[200:203], v[176:179], v[72:75]
    v_add_u32 v14, 16384, v14
    v_mul_f32 v64, v64, v136
    v_mfma_f32_16x16x32_bf16 v[76:79], v[200:203], v[180:183], v[76:79]
    v_mul_f32 v65, v65, v137
    v_mul_f32 v66, v66, v138
    v_mul_f32 v67, v67, v139
    s_waitcnt lgkmcnt(4)
    v_mfma_f32_16x16x32_bf16 v[72:75], v[204:207], v[184:187], v[72:75]
    v_cvt_pk_bf16_f32 v136, v64, v65
    v_cvt_pk_bf16_f32 v137, v66, v67
    v_mfma_f32_16x16x32_bf16 v[76:79], v[204:207], v[188:191], v[76:79]
    v_mul_f32 v68, v68, v140
    v_mul_f32 v69, v69, v141
    s_waitcnt lgkmcnt(3)
    v_mfma_f32_16x16x32_bf16 v[80:83], v[208:211], v[160:163], v[80:83]
    v_mul_f32 v70, v70, v142
    v_mul_f32 v71, v71, v143
    v_mfma_f32_16x16x32_bf16 v[84:87], v[208:211], v[164:167], v[84:87]
    v_cvt_pk_bf16_f32 v140, v68, v69
    v_cvt_pk_bf16_f32 v141, v70, v71
    s_waitcnt lgkmcnt(2)
    v_mfma_f32_16x16x32_bf16 v[80:83], v[212:215], v[168:171], v[80:83]
    v_mfma_f32_16x16x32_bf16 v[84:87], v[212:215], v[172:175], v[84:87]
    s_waitcnt lgkmcnt(1)
    v_mfma_f32_16x16x32_bf16 v[80:83], v[216:219], v[176:179], v[80:83]
    v_mul_f32 v72, v72, v144
    v_mul_f32 v73, v73, v145
    v_mfma_f32_16x16x32_bf16 v[84:87], v[216:219], v[180:183], v[84:87]
    v_mul_f32 v74, v74, v146
    v_mul_f32 v75, v75, v147
    v_cvt_pk_bf16_f32 v138, v72, v73
    s_waitcnt lgkmcnt(0)
    v_mfma_f32_16x16x32_bf16 v[80:83], v[220:223], v[184:187], v[80:83]
    v_cvt_pk_bf16_f32 v139, v74, v75
    buffer_store_dwordx4 v[136:139], v14, s[4:7], s39 offen sc1
    v_mfma_f32_16x16x32_bf16 v[84:87], v[220:223], v[188:191], v[84:87]
    v_mul_f32 v76, v76, v148
    v_mul_f32 v77, v77, v149
    v_mul_f32 v78, v78, v150
    v_mul_f32 v79, v79, v151
    v_cvt_pk_bf16_f32 v142, v76, v77
    v_cvt_pk_bf16_f32 v143, v78, v79
    buffer_store_dwordx4 v[140:143], v14, s[4:7], s40 offen sc1
    s_nop 1
    v_mul_f32 v80, v80, v152
    v_mul_f32 v81, v81, v153
    v_mul_f32 v82, v82, v154
    v_mul_f32 v83, v83, v155
    v_cvt_pk_bf16_f32 v152, v80, v81
    v_cvt_pk_bf16_f32 v153, v82, v83
    v_mul_f32 v84, v84, v156
    v_mul_f32 v85, v85, v157
    v_mul_f32 v86, v86, v158
    v_mul_f32 v87, v87, v159
    v_cvt_pk_bf16_f32 v154, v84, v85
    v_cvt_pk_bf16_f32 v155, v86, v87
    s_bitcmp0_b32 s24, 1
    s_cbranch_scc1 L_g_ns
    v_swap_b32 v152, v154
    v_swap_b32 v153, v155
L_g_ns:
    buffer_store_dwordx4 v[152:155], v15, s[4:7], s39 offen sc1
    s_barrier
    s_and_b32 s25, s2, 7
    s_lshr_b32 s26, s2, 3
    s_lshr_b32 s23, s25, 1
    s_lshl_b32 s23, s23, 3
    s_lshr_b32 s27, s26, 2
    s_add_u32 s23, s23, s27
    s_and_b32 s24, s25, 1
    s_lshl_b32 s24, s24, 2
    s_and_b32 s27, s26, 3
    s_add_u32 s24, s24, s27
    s_add_u32 s25, s23, s24
    s_and_b32 s25, s25, 3
    s_lshl_b32 s30, s23, 2
    s_add_u32 s30, s30, s20
    s_and_b32 s31, s20, 1
    s_mul_i32 s34, s30, 18432
    s_add_u32 s34, s34, s21
    s_add_u32 s34, s34, 0x300000
    s_lshl_b32 s35, s24, 11
    s_lshr_b32 s36, s24, 2
    s_lshl_b32 s36, s36, 10
    s_and_b32 s37, s24, 3
    s_lshl_b32 s37, s37, 8
    s_add_u32 s36, s36, s37
    s_add_u32 s36, s36, 16384
    v_bfe_u32 v2, v1, 4, 4
    v_lshrrev_b32 v3, 8, v1
    v_add_u32 v4, s35, v1
    v_lshrrev_b32 v0, 1, v3
    v_and_b32 v9, 1, v3
    v_cmp_eq_u32 s[40:41], s31, v0
    v_bfrev_b32 v6, 1
    v_lshlrev_b32 v5, 4, v2
    v_lshl_add_u32 v5, v9, 3, v5
    v_add_u32 v5, s36, v5
    v_cndmask_b32 v5, v6, v5, s[40:41]
    buffer_load_dwordx4 v[220:223], v4, s[4:7], s34 offen offset:0 sc1
    buffer_load_dwordx4 v[224:227], v4, s[4:7], s34 offen offset:1024 sc1
    buffer_load_dwordx2 v[228:229], v5, s[4:7], s34 offen sc1
    s_and_b32 s29, s30, 0xfffe
    s_mul_i32 s29, s29, 73728
    s_add_u32 s29, s29, s21
    s_lshl_b32 s37, s31, 10
    s_add_u32 s29, s29, s37
    s_add_u32 s29, s29, 0x1200000
    s_mul_i32 s37, s31, 73728
    s_sub_u32 s38, 73728, s37
    v_lshlrev_b32 v10, 3, v2
    v_add_u32 v16, s37, v1
    v_add_u32 v17, s38, v1
    v_mov_b32 v18, v1
    v_add_u32 v19, 73728, v1
    s_lshl_b32 s37, s31, 12
    v_add_u32 v20, 0, v1
    v_add_u32 v12, s37, v20
    v_add_u32 v21, 36864, v1
    v_add_u32 v13, s37, v21
    v_add_u32 v22, 73728, v1
    v_add_u32 v14, s37, v22
    v_add_u32 v23, 110592, v1
    v_add_u32 v15, s37, v23
    s_add_u32 s34, s34, 0x1900000
    s_lshl_b32 s39, s30, 10
    s_add_u32 s39, s39, s21
    s_lshl_b32 s42, s24, 7
    s_add_u32 s39, s39, s42
    s_add_u32 s39, s39, 0x3700000
    v_cmp_eq_u32 vcc, 0, v3
    v_mov_b32 v11, 0x3f803f80
    s_lshr_b32 s44, s23, 1
    v_cndmask_b32 v10, v6, v10, vcc
    s_cmp_eq_u32 s22, 0
    s_cbranch_scc1 L_p5_nf
    v_mul_u32_u24 v8, 1152, v2
    s_mul_i32 s34, s30, 18432
    s_mul_i32 s42, s24, 144
    s_add_u32 s34, s34, s42
    v_lshrrev_b32 v4, 6, v1
    v_bfe_u32 v5, v1, 4, 2
    v_lshlrev_b32 v10, 2, v4
    v_lshl_add_u32 v10, v5, 6, v10
    v_mul_u32_u24 v8, 1152, v4
    v_lshrrev_b32 v11, 1, v5
    v_cmp_eq_u32 vcc, s31, v11
    v_lshl_add_u32 v4, v5, 4, v8
    v_and_b32 v5, 1, v5
    v_lshl_add_u32 v5, v5, 3, v8
    v_cndmask_b32 v5, v6, v5, vcc
L_p5_nf:
    s_lshl_b32 s52, s22, 7
    s_add_u32 s52, s52, s44
    s_lshl_b32 s52, s52, 8
    s_add_u32 s52, s52, 0x450a000
    s_add_u32 s52, s52, s4
    s_addc_u32 s53, s5, 0
    s_waitcnt vmcnt(3)
    s_barrier
    s_cmp_lg_u32 s20, 0
    s_cbranch_scc1 L_ns_d5
    s_mov_b32 s56, 1
    s_atomic_add s56, s[50:51], 0
L_ns_d5:
    s_mul_i32 s37, s20, 4608
    s_add_u32 s37, s37, 131072
    s_xor_b32 s38, s20, 1
    s_mul_i32 s42, s38, 4608
    s_add_u32 s42, s42, 131072
    v_and_b32 v0, 0x1ff, v1
    v_add_u32 v2, s37, v1
    v_add_u32 v3, s37, v0
    v_add_u32 v7, s42, v1
    v_add_u32 v8, s42, v0
    s_lshl_b32 s37, s20, 2
    s_add_u32 s37, s37, 163808
    s_xor_b32 s38, s37, 4
    v_mov_b32 v0, s37
    v_mov_b32 v6, s38
    s_lshl_b32 s43, s22, 1
    s_add_u32 s43, s43, 2
    v_mov_b32 v9, s43
    s_cmp_lg_u32 s20, 0
    s_cbranch_scc1 L_pd_d5
    s_mov_b32 s60, 65536
L_poll_d5:
    s_mov_b32 s57, 0
    s_atomic_add s57, s[52:53], 0 glc
    s_waitcnt lgkmcnt(0)
    s_cmp_ge_u32 s57, 16
    s_cbranch_scc1 L_pd_d5
    s_sub_u32 s60, s60, 1
    s_cbranch_scc1 L_pd_d5
    s_sleep 2
    s_branch L_poll_d5
L_pd_d5:
    s_barrier
    s_mov_b32 s32, 0
    s_lshl_b32 s32, s32, 13
    s_add_u32 s32, s32, s29
    s_add_u32 s33, s32, 4096
    buffer_load_dwordx4 v[124:127], v16, s[4:7], s32 offen offset:0 sc1
    buffer_load_dwordx4 v[128:131], v17, s[4:7], s32 offen offset:0 sc1
    buffer_load_dwordx4 v[132:135], v16, s[4:7], s32 offen offset:2048 sc1
    buffer_load_dwordx4 v[136:139], v17, s[4:7], s32 offen offset:2048 sc1
    buffer_load_dwordx4 v[140:143], v16, s[4:7], s33 offen offset:0 sc1
    buffer_load_dwordx4 v[144:147], v17, s[4:7], s33 offen offset:0 sc1
    buffer_load_dwordx4 v[148:151], v16, s[4:7], s33 offen offset:2048 sc1
    buffer_load_dwordx4 v[152:155], v17, s[4:7], s33 offen offset:2048 sc1
    ds_read_b128 v[64:67], v14 offset:0
    ds_read_b128 v[68:71], v14 offset:1024
    ds_read_b128 v[72:75], v14 offset:2048
    ds_read_b128 v[76:79], v14 offset:3072
    ds_read_b128 v[80:83], v22 offset:8192
    ds_read_b128 v[84:87], v14 offset:9216
    ds_read_b128 v[88:91], v14 offset:10240
    ds_read_b128 v[92:95], v14 offset:11264
    ds_read_b128 v[96:99], v14 offset:12288
    ds_read_b128 v[100:103], v22 offset:17408
    s_add_u32 s45, s29, 8192
    s_add_u32 s46, s29, 12288
    buffer_load_dwordx4 v[156:159], v16, s[4:7], s45 offen offset:0 sc1
    buffer_load_dwordx4 v[160:163], v17, s[4:7], s45 offen offset:0 sc1
    s_lshl_b32 s50, s22, 7
    s_add_u32 s50, s50, s44
    s_lshl_b32 s50, s50, 8
    s_add_u32 s50, s50, 0x450b000
    s_add_u32 s50, s50, s4
    s_addc_u32 s51, s5, 0
    s_waitcnt vmcnt(10)
    v_lshlrev_b32 v24, 16, v220
    v_and_b32 v25, 0xffff0000, v220
    v_lshlrev_b32 v26, 16, v221
    v_and_b32 v27, 0xffff0000, v221
    v_lshlrev_b32 v28, 16, v222
    v_and_b32 v29, 0xffff0000, v222
    v_lshlrev_b32 v30, 16, v223
    v_and_b32 v31, 0xffff0000, v223
    v_lshlrev_b32 v32, 16, v224
    v_and_b32 v33, 0xffff0000, v224
    v_lshlrev_b32 v34, 16, v225
    v_and_b32 v35, 0xffff0000, v225
    v_lshlrev_b32 v36, 16, v226
    v_and_b32 v37, 0xffff0000, v226
    v_lshlrev_b32 v38, 16, v227
    v_and_b32 v39, 0xffff0000, v227
    v_lshlrev_b32 v40, 16, v228
    v_and_b32 v41, 0xffff0000, v228
    v_lshlrev_b32 v42, 16, v229
    v_and_b32 v43, 0xffff0000, v229
    s_waitcnt vmcnt(8) lgkmcnt(5)
    v_mfma_f32_16x16x32_bf16 v[44:47], v[64:67], v[128:131], 0
    ds_read_b128 v[104:107], v14 offset:18432
    s_mov_b32 s32, 2
    s_lshl_b32 s32, s32, 13
    s_add_u32 s32, s32, s29
    s_add_u32 s33, s32, 4096
    v_mfma_f32_16x16x32_bf16 v[24:27], v[64:67], v[124:127], v[24:27]
    ds_read_b128 v[108:111], v14 offset:19456
    buffer_load_dwordx4 v[164:167], v16, s[4:7], s45 offen offset:2048 sc1
    v_mfma_f32_16x16x32_bf16 v[48:51], v[68:71], v[128:131], 0
    ds_read_b128 v[112:115], v14 offset:20480
    v_mfma_f32_16x16x32_bf16 v[28:31], v[68:71], v[124:127], v[28:31]
    ds_read_b128 v[116:119], v14 offset:21504
    buffer_load_dwordx4 v[168:171], v17, s[4:7], s45 offen offset:2048 sc1
    v_mfma_f32_16x16x32_bf16 v[52:55], v[72:75], v[128:131], 0
    ds_read_b128 v[120:123], v22 offset:26624
    v_mfma_f32_16x16x32_bf16 v[32:35], v[72:75], v[124:127], v[32:35]
    buffer_load_dwordx4 v[188:191], v16, s[4:7], s32 offen offset:0 sc1
    v_mfma_f32_16x16x32_bf16 v[56:59], v[76:79], v[128:131], 0
    v_mfma_f32_16x16x32_bf16 v[36:39], v[76:79], v[124:127], v[36:39]
    buffer_load_dwordx4 v[192:195], v17, s[4:7], s32 offen offset:0 sc1
    v_mfma_f32_16x16x32_bf16 v[60:63], v[80:83], v[128:131], 0
    v_mfma_f32_16x16x32_bf16 v[40:43], v[80:83], v[124:127], v[40:43]
    s_waitcnt vmcnt(10) lgkmcnt(5)
    v_mfma_f32_16x16x32_bf16 v[44:47], v[84:87], v[136:139], v[44:47]
    ds_read_b128 v[64:67], v14 offset:27648
    v_mfma_f32_16x16x32_bf16 v[24:27], v[84:87], v[132:135], v[24:27]
    ds_read_b128 v[68:71], v14 offset:28672
    buffer_load_dwordx4 v[172:175], v16, s[4:7], s46 offen offset:0 sc1
    v_mfma_f32_16x16x32_bf16 v[48:51], v[88:91], v[136:139], v[48:51]
    ds_read_b128 v[72:75], v14 offset:29696
    v_mfma_f32_16x16x32_bf16 v[28:31], v[88:91], v[132:135], v[28:31]
    ds_read_b128 v[76:79], v14 offset:30720
    buffer_load_dwordx4 v[176:179], v17, s[4:7], s46 offen offset:0 sc1
    v_mfma_f32_16x16x32_bf16 v[52:55], v[92:95], v[136:139], v[52:55]
    ds_read_b128 v[80:83], v22 offset:35840
    v_mfma_f32_16x16x32_bf16 v[32:35], v[92:95], v[132:135], v[32:35]
    buffer_load_dwordx4 v[196:199], v16, s[4:7], s32 offen offset:2048 sc1
    v_mfma_f32_16x16x32_bf16 v[56:59], v[96:99], v[136:139], v[56:59]
    v_mfma_f32_16x16x32_bf16 v[36:39], v[96:99], v[132:135], v[36:39]
    buffer_load_dwordx4 v[200:203], v17, s[4:7], s32 offen offset:2048 sc1
    v_mfma_f32_16x16x32_bf16 v[60:63], v[100:103], v[136:139], v[60:63]
    v_mfma_f32_16x16x32_bf16 v[40:43], v[100:103], v[132:135], v[40:43]
    s_waitcnt vmcnt(12) lgkmcnt(0)
    s_barrier
    v_mfma_f32_16x16x32_bf16 v[44:47], v[104:107], v[144:147], v[44:47]
    ds_read_b128 v[84:87], v15 offset:0
    v_mfma_f32_16x16x32_bf16 v[24:27], v[104:107], v[140:143], v[24:27]
    ds_read_b128 v[88:91], v15 offset:1024
    buffer_load_dwordx4 v[180:183], v16, s[4:7], s46 offen offset:2048 sc1
    v_mfma_f32_16x16x32_bf16 v[48:51], v[108:111], v[144:147], v[48:51]
    ds_read_b128 v[92:95], v15 offset:2048
    v_mfma_f32_16x16x32_bf16 v[28:31], v[108:111], v[140:143], v[28:31]
    ds_read_b128 v[96:99], v15 offset:3072
    buffer_load_dwordx4 v[184:187], v17, s[4:7], s46 offen offset:2048 sc1
    v_mfma_f32_16x16x32_bf16 v[52:55], v[112:115], v[144:147], v[52:55]
    ds_read_b128 v[100:103], v23 offset:8192
    v_mfma_f32_16x16x32_bf16 v[32:35], v[112:115], v[140:143], v[32:35]
    buffer_load_dwordx4 v[204:207], v16, s[4:7], s33 offen offset:0 sc1
    v_mfma_f32_16x16x32_bf16 v[56:59], v[116:119], v[144:147], v[56:59]
    v_mfma_f32_16x16x32_bf16 v[36:39], v[116:119], v[140:143], v[36:39]
    buffer_load_dwordx4 v[208:211], v17, s[4:7], s33 offen offset:0 sc1
    v_mfma_f32_16x16x32_bf16 v[60:63], v[120:123], v[144:147], v[60:63]
    v_mfma_f32_16x16x32_bf16 v[40:43], v[120:123], v[140:143], v[40:43]
    s_waitcnt vmcnt(14) lgkmcnt(5)
    v_mfma_f32_16x16x32_bf16 v[44:47], v[64:67], v[152:155], v[44:47]
    ds_read_b128 v[104:107], v15 offset:9216
    v_mfma_f32_16x16x32_bf16 v[24:27], v[64:67], v[148:151], v[24:27]
    ds_read_b128 v[108:111], v15 offset:10240
    v_mfma_f32_16x16x32_bf16 v[48:51], v[68:71], v[152:155], v[48:51]
    ds_read_b128 v[112:115], v15 offset:11264
    v_mfma_f32_16x16x32_bf16 v[28:31], v[68:71], v[148:151], v[28:31]
    ds_read_b128 v[116:119], v15 offset:12288
    v_mfma_f32_16x16x32_bf16 v[52:55], v[72:75], v[152:155], v[52:55]
    ds_read_b128 v[120:123], v23 offset:17408
    v_mfma_f32_16x16x32_bf16 v[32:35], v[72:75], v[148:151], v[32:35]
    buffer_load_dwordx4 v[212:215], v16, s[4:7], s33 offen offset:2048 sc1
    v_mfma_f32_16x16x32_bf16 v[56:59], v[76:79], v[152:155], v[56:59]
    v_mfma_f32_16x16x32_bf16 v[36:39], v[76:79], v[148:151], v[36:39]
    buffer_load_dwordx4 v[216:219], v17, s[4:7], s33 offen offset:2048 sc1
    v_mfma_f32_16x16x32_bf16 v[60:63], v[80:83], v[152:155], v[60:63]
    v_mfma_f32_16x16x32_bf16 v[40:43], v[80:83], v[148:151], v[40:43]
    s_waitcnt vmcnt(14) lgkmcnt(5)
    v_mfma_f32_16x16x32_bf16 v[44:47], v[84:87], v[160:163], v[44:47]
    ds_read_b128 v[64:67], v15 offset:18432
    s_mov_b32 s32, 3
    s_lshl_b32 s32, s32, 13
    s_add_u32 s32, s32, s29
    s_add_u32 s33, s32, 4096
    v_mfma_f32_16x16x32_bf16 v[24:27], v[84:87], v[156:159], v[24:27]
    ds_read_b128 v[68:71], v15 offset:19456
    v_mfma_f32_16x16x32_bf16 v[48:51], v[88:91], v[160:163], v[48:51]
    ds_read_b128 v[72:75], v15 offset:20480
    v_mfma_f32_16x16x32_bf16 v[28:31], v[88:91], v[156:159], v[28:31]
    ds_read_b128 v[76:79], v15 offset:21504
    v_mfma_f32_16x16x32_bf16 v[52:55], v[92:95], v[160:163], v[52:55]
    ds_read_b128 v[80:83], v23 offset:26624
    v_mfma_f32_16x16x32_bf16 v[32:35], v[92:95], v[156:159], v[32:35]
    buffer_load_dwordx4 v[124:127], v16, s[4:7], s32 offen offset:0 sc1
    v_mfma_f32_16x16x32_bf16 v[56:59], v[96:99], v[160:163], v[56:59]
    v_mfma_f32_16x16x32_bf16 v[36:39], v[96:99], v[156:159], v[36:39]
    buffer_load_dwordx4 v[128:131], v17, s[4:7], s32 offen offset:0 sc1
    v_mfma_f32_16x16x32_bf16 v[60:63], v[100:103], v[160:163], v[60:63]
    v_mfma_f32_16x16x32_bf16 v[40:43], v[100:103], v[156:159], v[40:43]
    s_waitcnt vmcnt(14) lgkmcnt(5)
    v_mfma_f32_16x16x32_bf16 v[44:47], v[104:107], v[168:171], v[44:47]
    ds_read_b128 v[84:87], v15 offset:27648
    v_mfma_f32_16x16x32_bf16 v[24:27], v[104:107], v[164:167], v[24:27]
    ds_read_b128 v[88:91], v15 offset:28672
    v_mfma_f32_16x16x32_bf16 v[48:51], v[108:111], v[168:171], v[48:51]
    ds_read_b128 v[92:95], v15 offset:29696
    v_mfma_f32_16x16x32_bf16 v[28:31], v[108:111], v[164:167], v[28:31]
    ds_read_b128 v[96:99], v15 offset:30720
    v_mfma_f32_16x16x32_bf16 v[52:55], v[112:115], v[168:171], v[52:55]
    ds_read_b128 v[100:103], v23 offset:35840
    v_mfma_f32_16x16x32_bf16 v[32:35], v[112:115], v[164:167], v[32:35]
    buffer_load_dwordx4 v[132:135], v16, s[4:7], s32 offen offset:2048 sc1
    v_mfma_f32_16x16x32_bf16 v[56:59], v[116:119], v[168:171], v[56:59]
    v_mfma_f32_16x16x32_bf16 v[36:39], v[116:119], v[164:167], v[36:39]
    buffer_load_dwordx4 v[136:139], v17, s[4:7], s32 offen offset:2048 sc1
    v_mfma_f32_16x16x32_bf16 v[60:63], v[120:123], v[168:171], v[60:63]
    v_mfma_f32_16x16x32_bf16 v[40:43], v[120:123], v[164:167], v[40:43]
    s_waitcnt vmcnt(12) lgkmcnt(0)
    s_barrier
    v_mfma_f32_16x16x32_bf16 v[44:47], v[64:67], v[176:179], v[44:47]
    ds_read_b128 v[104:107], v12 offset:0
    v_mfma_f32_16x16x32_bf16 v[24:27], v[64:67], v[172:175], v[24:27]
    ds_read_b128 v[108:111], v12 offset:1024
    v_mfma_f32_16x16x32_bf16 v[48:51], v[68:71], v[176:179], v[48:51]
    ds_read_b128 v[112:115], v12 offset:2048
    v_mfma_f32_16x16x32_bf16 v[28:31], v[68:71], v[172:175], v[28:31]
    ds_read_b128 v[116:119], v12 offset:3072
    v_mfma_f32_16x16x32_bf16 v[52:55], v[72:75], v[176:179], v[52:55]
    ds_read_b128 v[120:123], v20 offset:8192
    v_mfma_f32_16x16x32_bf16 v[32:35], v[72:75], v[172:175], v[32:35]
    buffer_load_dwordx4 v[140:143], v16, s[4:7], s33 offen offset:0 sc1
    v_mfma_f32_16x16x32_bf16 v[56:59], v[76:79], v[176:179], v[56:59]
    v_mfma_f32_16x16x32_bf16 v[36:39], v[76:79], v[172:175], v[36:39]
    buffer_load_dwordx4 v[144:147], v17, s[4:7], s33 offen offset:0 sc1
    v_mfma_f32_16x16x32_bf16 v[60:63], v[80:83], v[176:179], v[60:63]
    v_mfma_f32_16x16x32_bf16 v[40:43], v[80:83], v[172:175], v[40:43]
    s_waitcnt vmcnt(10) lgkmcnt(5)
    v_mfma_f32_16x16x32_bf16 v[44:47], v[84:87], v[184:187], v[44:47]
    ds_read_b128 v[64:67], v12 offset:9216
    v_mfma_f32_16x16x32_bf16 v[24:27], v[84:87], v[180:183], v[24:27]
    ds_read_b128 v[68:71], v12 offset:10240
    v_mfma_f32_16x16x32_bf16 v[48:51], v[88:91], v[184:187], v[48:51]
    ds_read_b128 v[72:75], v12 offset:11264
    v_mfma_f32_16x16x32_bf16 v[28:31], v[88:91], v[180:183], v[28:31]
    ds_read_b128 v[76:79], v12 offset:12288
    v_mfma_f32_16x16x32_bf16 v[52:55], v[92:95], v[184:187], v[52:55]
    ds_read_b128 v[80:83], v20 offset:17408
    v_mfma_f32_16x16x32_bf16 v[32:35], v[92:95], v[180:183], v[32:35]
    buffer_load_dwordx4 v[148:151], v16, s[4:7], s33 offen offset:2048 sc1
    v_mfma_f32_16x16x32_bf16 v[56:59], v[96:99], v[184:187], v[56:59]
    v_mfma_f32_16x16x32_bf16 v[36:39], v[96:99], v[180:183], v[36:39]
    buffer_load_dwordx4 v[152:155], v17, s[4:7], s33 offen offset:2048 sc1
    v_mfma_f32_16x16x32_bf16 v[60:63], v[100:103], v[184:187], v[60:63]
    v_mfma_f32_16x16x32_bf16 v[40:43], v[100:103], v[180:183], v[40:43]
    s_waitcnt vmcnt(12) lgkmcnt(5)
    v_mfma_f32_16x16x32_bf16 v[44:47], v[104:107], v[192:195], v[44:47]
    ds_read_b128 v[84:87], v12 offset:18432
    s_mov_b32 s32, 4
    s_lshl_b32 s32, s32, 13
    s_add_u32 s32, s32, s29
    s_add_u32 s33, s32, 4096
    v_mfma_f32_16x16x32_bf16 v[24:27], v[104:107], v[188:191], v[24:27]
    ds_read_b128 v[88:91], v12 offset:19456
    v_mfma_f32_16x16x32_bf16 v[48:51], v[108:111], v[192:195], v[48:51]
    ds_read_b128 v[92:95], v12 offset:20480
    v_mfma_f32_16x16x32_bf16 v[28:31], v[108:111], v[188:191], v[28:31]
    ds_read_b128 v[96:99], v12 offset:21504
    v_mfma_f32_16x16x32_bf16 v[52:55], v[112:115], v[192:195], v[52:55]
    ds_read_b128 v[100:103], v20 offset:26624
    v_mfma_f32_16x16x32_bf16 v[32:35], v[112:115], v[188:191], v[32:35]
    buffer_load_dwordx4 v[156:159], v16, s[4:7], s32 offen offset:0 sc1
    v_mfma_f32_16x16x32_bf16 v[56:59], v[116:119], v[192:195], v[56:59]
    v_mfma_f32_16x16x32_bf16 v[36:39], v[116:119], v[188:191], v[36:39]
    buffer_load_dwordx4 v[160:163], v17, s[4:7], s32 offen offset:0 sc1
    v_mfma_f32_16x16x32_bf16 v[60:63], v[120:123], v[192:195], v[60:63]
    v_mfma_f32_16x16x32_bf16 v[40:43], v[120:123], v[188:191], v[40:43]
    s_waitcnt vmcnt(14) lgkmcnt(5)
    v_mfma_f32_16x16x32_bf16 v[44:47], v[64:67], v[200:203], v[44:47]
    ds_read_b128 v[104:107], v12 offset:27648
    v_mfma_f32_16x16x32_bf16 v[24:27], v[64:67], v[196:199], v[24:27]
    ds_read_b128 v[108:111], v12 offset:28672
    v_mfma_f32_16x16x32_bf16 v[48:51], v[68:71], v[200:203], v[48:51]
    ds_read_b128 v[112:115], v12 offset:29696
    v_mfma_f32_16x16x32_bf16 v[28:31], v[68:71], v[196:199], v[28:31]
    ds_read_b128 v[116:119], v12 offset:30720
    v_mfma_f32_16x16x32_bf16 v[52:55], v[72:75], v[200:203], v[52:55]
    ds_read_b128 v[120:123], v20 offset:35840
    v_mfma_f32_16x16x32_bf16 v[32:35], v[72:75], v[196:199], v[32:35]
    buffer_load_dwordx4 v[164:167], v16, s[4:7], s32 offen offset:2048 sc1
    v_mfma_f32_16x16x32_bf16 v[56:59], v[76:79], v[200:203], v[56:59]
    v_mfma_f32_16x16x32_bf16 v[36:39], v[76:79], v[196:199], v[36:39]
    buffer_load_dwordx4 v[168:171], v17, s[4:7], s32 offen offset:2048 sc1
    v_mfma_f32_16x16x32_bf16 v[60:63], v[80:83], v[200:203], v[60:63]
    v_mfma_f32_16x16x32_bf16 v[40:43], v[80:83], v[196:199], v[40:43]
    s_waitcnt vmcnt(14) lgkmcnt(0)
    s_barrier
    v_mfma_f32_16x16x32_bf16 v[44:47], v[84:87], v[208:211], v[44:47]
    ds_read_b128 v[64:67], v13 offset:0
    v_mfma_f32_16x16x32_bf16 v[24:27], v[84:87], v[204:207], v[24:27]
    ds_read_b128 v[68:71], v13 offset:1024
    v_mfma_f32_16x16x32_bf16 v[48:51], v[88:91], v[208:211], v[48:51]
    ds_read_b128 v[72:75], v13 offset:2048
    v_mfma_f32_16x16x32_bf16 v[28:31], v[88:91], v[204:207], v[28:31]
    ds_read_b128 v[76:79], v13 offset:3072
    v_mfma_f32_16x16x32_bf16 v[52:55], v[92:95], v[208:211], v[52:55]
    ds_read_b128 v[80:83], v21 offset:8192
    v_mfma_f32_16x16x32_bf16 v[32:35], v[92:95], v[204:207], v[32:35]
    buffer_load_dwordx4 v[172:175], v16, s[4:7], s33 offen offset:0 sc1
    v_mfma_f32_16x16x32_bf16 v[56:59], v[96:99], v[208:211], v[56:59]
    v_mfma_f32_16x16x32_bf16 v[36:39], v[96:99], v[204:207], v[36:39]
    buffer_load_dwordx4 v[176:179], v17, s[4:7], s33 offen offset:0 sc1
    v_mfma_f32_16x16x32_bf16 v[60:63], v[100:103], v[208:211], v[60:63]
    v_mfma_f32_16x16x32_bf16 v[40:43], v[100:103], v[204:207], v[40:43]
    s_waitcnt vmcnt(14) lgkmcnt(5)
    v_mfma_f32_16x16x32_bf16 v[44:47], v[104:107], v[216:219], v[44:47]
    ds_read_b128 v[84:87], v13 offset:9216
    v_mfma_f32_16x16x32_bf16 v[24:27], v[104:107], v[212:215], v[24:27]
    ds_read_b128 v[88:91], v13 offset:10240
    v_mfma_f32_16x16x32_bf16 v[48:51], v[108:111], v[216:219], v[48:51]
    ds_read_b128 v[92:95], v13 offset:11264
    v_mfma_f32_16x16x32_bf16 v[28:31], v[108:111], v[212:215], v[28:31]
    ds_read_b128 v[96:99], v13 offset:12288
    v_mfma_f32_16x16x32_bf16 v[52:55], v[112:115], v[216:219], v[52:55]
    ds_read_b128 v[100:103], v21 offset:17408
    v_mfma_f32_16x16x32_bf16 v[32:35], v[112:115], v[212:215], v[32:35]
    buffer_load_dwordx4 v[180:183], v16, s[4:7], s33 offen offset:2048 sc1
    v_mfma_f32_16x16x32_bf16 v[56:59], v[116:119], v[216:219], v[56:59]
    v_mfma_f32_16x16x32_bf16 v[36:39], v[116:119], v[212:215], v[36:39]
    buffer_load_dwordx4 v[184:187], v17, s[4:7], s33 offen offset:2048 sc1
    v_mfma_f32_16x16x32_bf16 v[60:63], v[120:123], v[216:219], v[60:63]
    v_mfma_f32_16x16x32_bf16 v[40:43], v[120:123], v[212:215], v[40:43]
    s_waitcnt vmcnt(14) lgkmcnt(5)
    v_mfma_f32_16x16x32_bf16 v[44:47], v[64:67], v[128:131], v[44:47]
    ds_read_b128 v[104:107], v13 offset:18432
    s_mov_b32 s32, 5
    s_lshl_b32 s32, s32, 13
    s_add_u32 s32, s32, s29
    s_add_u32 s33, s32, 4096
    v_mfma_f32_16x16x32_bf16 v[24:27], v[64:67], v[124:127], v[24:27]
    ds_read_b128 v[108:111], v13 offset:19456
    v_mfma_f32_16x16x32_bf16 v[48:51], v[68:71], v[128:131], v[48:51]
    ds_read_b128 v[112:115], v13 offset:20480
    v_mfma_f32_16x16x32_bf16 v[28:31], v[68:71], v[124:127], v[28:31]
    ds_read_b128 v[116:119], v13 offset:21504
    v_mfma_f32_16x16x32_bf16 v[52:55], v[72:75], v[128:131], v[52:55]
    ds_read_b128 v[120:123], v21 offset:26624
    v_mfma_f32_16x16x32_bf16 v[32:35], v[72:75], v[124:127], v[32:35]
    buffer_load_dwordx4 v[188:191], v16, s[4:7], s32 offen offset:0 sc1
    v_mfma_f32_16x16x32_bf16 v[56:59], v[76:79], v[128:131], v[56:59]
    v_mfma_f32_16x16x32_bf16 v[36:39], v[76:79], v[124:127], v[36:39]
    buffer_load_dwordx4 v[192:195], v17, s[4:7], s32 offen offset:0 sc1
    v_mfma_f32_16x16x32_bf16 v[60:63], v[80:83], v[128:131], v[60:63]
    v_mfma_f32_16x16x32_bf16 v[40:43], v[80:83], v[124:127], v[40:43]
    s_waitcnt vmcnt(14) lgkmcnt(5)
    v_mfma_f32_16x16x32_bf16 v[44:47], v[84:87], v[136:139], v[44:47]
    ds_read_b128 v[64:67], v13 offset:27648
    v_mfma_f32_16x16x32_bf16 v[24:27], v[84:87], v[132:135], v[24:27]
    ds_read_b128 v[68:71], v13 offset:28672
    v_mfma_f32_16x16x32_bf16 v[48:51], v[88:91], v[136:139], v[48:51]
    ds_read_b128 v[72:75], v13 offset:29696
    v_mfma_f32_16x16x32_bf16 v[28:31], v[88:91], v[132:135], v[28:31]
    ds_read_b128 v[76:79], v13 offset:30720
    v_mfma_f32_16x16x32_bf16 v[52:55], v[92:95], v[136:139], v[52:55]
    ds_read_b128 v[80:83], v21 offset:35840
    v_mfma_f32_16x16x32_bf16 v[32:35], v[92:95], v[132:135], v[32:35]
    buffer_load_dwordx4 v[196:199], v16, s[4:7], s32 offen offset:2048 sc1
    v_mfma_f32_16x16x32_bf16 v[56:59], v[96:99], v[136:139], v[56:59]
    v_mfma_f32_16x16x32_bf16 v[36:39], v[96:99], v[132:135], v[36:39]
    buffer_load_dwordx4 v[200:203], v17, s[4:7], s32 offen offset:2048 sc1
    v_mfma_f32_16x16x32_bf16 v[60:63], v[100:103], v[136:139], v[60:63]
    v_mfma_f32_16x16x32_bf16 v[40:43], v[100:103], v[132:135], v[40:43]
    s_waitcnt vmcnt(14) lgkmcnt(0)
    s_barrier
    v_mfma_f32_16x16x32_bf16 v[44:47], v[104:107], v[144:147], v[44:47]
    ds_read_b128 v[84:87], v14 offset:0
    v_mfma_f32_16x16x32_bf16 v[24:27], v[104:107], v[140:143], v[24:27]
    ds_read_b128 v[88:91], v14 offset:1024
    v_mfma_f32_16x16x32_bf16 v[48:51], v[108:111], v[144:147], v[48:51]
    ds_read_b128 v[92:95], v14 offset:2048
    v_mfma_f32_16x16x32_bf16 v[28:31], v[108:111], v[140:143], v[28:31]
    ds_read_b128 v[96:99], v14 offset:3072
    v_mfma_f32_16x16x32_bf16 v[52:55], v[112:115], v[144:147], v[52:55]
    ds_read_b128 v[100:103], v22 offset:8192
    v_mfma_f32_16x16x32_bf16 v[32:35], v[112:115], v[140:143], v[32:35]
    buffer_load_dwordx4 v[204:207], v16, s[4:7], s33 offen offset:0 sc1
    v_mfma_f32_16x16x32_bf16 v[56:59], v[116:119], v[144:147], v[56:59]
    v_mfma_f32_16x16x32_bf16 v[36:39], v[116:119], v[140:143], v[36:39]
    buffer_load_dwordx4 v[208:211], v17, s[4:7], s33 offen offset:0 sc1
    v_mfma_f32_16x16x32_bf16 v[60:63], v[120:123], v[144:147], v[60:63]
    v_mfma_f32_16x16x32_bf16 v[40:43], v[120:123], v[140:143], v[40:43]
    s_waitcnt vmcnt(14) lgkmcnt(5)
    v_mfma_f32_16x16x32_bf16 v[44:47], v[64:67], v[152:155], v[44:47]
    ds_read_b128 v[104:107], v14 offset:9216
    v_mfma_f32_16x16x32_bf16 v[24:27], v[64:67], v[148:151], v[24:27]
    ds_read_b128 v[108:111], v14 offset:10240
    v_mfma_f32_16x16x32_bf16 v[48:51], v[68:71], v[152:155], v[48:51]
    ds_read_b128 v[112:115], v14 offset:11264
    v_mfma_f32_16x16x32_bf16 v[28:31], v[68:71], v[148:151], v[28:31]
    ds_read_b128 v[116:119], v14 offset:12288
    v_mfma_f32_16x16x32_bf16 v[52:55], v[72:75], v[152:155], v[52:55]
    ds_read_b128 v[120:123], v22 offset:17408
    v_mfma_f32_16x16x32_bf16 v[32:35], v[72:75], v[148:151], v[32:35]
    buffer_load_dwordx4 v[212:215], v16, s[4:7], s33 offen offset:2048 sc1
    v_mfma_f32_16x16x32_bf16 v[56:59], v[76:79], v[152:155], v[56:59]
    v_mfma_f32_16x16x32_bf16 v[36:39], v[76:79], v[148:151], v[36:39]
    buffer_load_dwordx4 v[216:219], v17, s[4:7], s33 offen offset:2048 sc1
    v_mfma_f32_16x16x32_bf16 v[60:63], v[80:83], v[152:155], v[60:63]
    v_mfma_f32_16x16x32_bf16 v[40:43], v[80:83], v[148:151], v[40:43]
    s_waitcnt vmcnt(14) lgkmcnt(5)
    v_mfma_f32_16x16x32_bf16 v[44:47], v[84:87], v[160:163], v[44:47]
    ds_read_b128 v[64:67], v14 offset:18432
    s_mov_b32 s32, 6
    s_lshl_b32 s32, s32, 13
    s_add_u32 s32, s32, s29
    s_add_u32 s33, s32, 4096
    v_mfma_f32_16x16x32_bf16 v[24:27], v[84:87], v[156:159], v[24:27]
    ds_read_b128 v[68:71], v14 offset:19456
    v_mfma_f32_16x16x32_bf16 v[48:51], v[88:91], v[160:163], v[48:51]
    ds_read_b128 v[72:75], v14 offset:20480
    v_mfma_f32_16x16x32_bf16 v[28:31], v[88:91], v[156:159], v[28:31]
    ds_read_b128 v[76:79], v14 offset:21504
    v_mfma_f32_16x16x32_bf16 v[52:55], v[92:95], v[160:163], v[52:55]
    ds_read_b128 v[80:83], v22 offset:26624
    v_mfma_f32_16x16x32_bf16 v[32:35], v[92:95], v[156:159], v[32:35]
    buffer_load_dwordx4 v[124:127], v16, s[4:7], s32 offen offset:0 sc1
    v_mfma_f32_16x16x32_bf16 v[56:59], v[96:99], v[160:163], v[56:59]
    v_mfma_f32_16x16x32_bf16 v[36:39], v[96:99], v[156:159], v[36:39]
    buffer_load_dwordx4 v[128:131], v17, s[4:7], s32 offen offset:0 sc1
    v_mfma_f32_16x16x32_bf16 v[60:63], v[100:103], v[160:163], v[60:63]
    v_mfma_f32_16x16x32_bf16 v[40:43], v[100:103], v[156:159], v[40:43]
    s_waitcnt vmcnt(14) lgkmcnt(5)
    v_mfma_f32_16x16x32_bf16 v[44:47], v[104:107], v[168:171], v[44:47]
    ds_read_b128 v[84:87], v14 offset:27648
    v_mfma_f32_16x16x32_bf16 v[24:27], v[104:107], v[164:167], v[24:27]
    ds_read_b128 v[88:91], v14 offset:28672
    v_mfma_f32_16x16x32_bf16 v[48:51], v[108:111], v[168:171], v[48:51]
    ds_read_b128 v[92:95], v14 offset:29696
    v_mfma_f32_16x16x32_bf16 v[28:31], v[108:111], v[164:167], v[28:31]
    ds_read_b128 v[96:99], v14 offset:30720
    v_mfma_f32_16x16x32_bf16 v[52:55], v[112:115], v[168:171], v[52:55]
    ds_read_b128 v[100:103], v22 offset:35840
    v_mfma_f32_16x16x32_bf16 v[32:35], v[112:115], v[164:167], v[32:35]
    buffer_load_dwordx4 v[132:135], v16, s[4:7], s32 offen offset:2048 sc1
    v_mfma_f32_16x16x32_bf16 v[56:59], v[116:119], v[168:171], v[56:59]
    v_mfma_f32_16x16x32_bf16 v[36:39], v[116:119], v[164:167], v[36:39]
    buffer_load_dwordx4 v[136:139], v17, s[4:7], s32 offen offset:2048 sc1
    v_mfma_f32_16x16x32_bf16 v[60:63], v[120:123], v[168:171], v[60:63]
    v_mfma_f32_16x16x32_bf16 v[40:43], v[120:123], v[164:167], v[40:43]
    s_waitcnt vmcnt(14) lgkmcnt(0)
    s_barrier
    v_mfma_f32_16x16x32_bf16 v[44:47], v[64:67], v[176:179], v[44:47]
    ds_read_b128 v[104:107], v15 offset:0
    v_mfma_f32_16x16x32_bf16 v[24:27], v[64:67], v[172:175], v[24:27]
    ds_read_b128 v[108:111], v15 offset:1024
    v_mfma_f32_16x16x32_bf16 v[48:51], v[68:71], v[176:179], v[48:51]
    ds_read_b128 v[112:115], v15 offset:2048
    v_mfma_f32_16x16x32_bf16 v[28:31], v[68:71], v[172:175], v[28:31]
    ds_read_b128 v[116:119], v15 offset:3072
    v_mfma_f32_16x16x32_bf16 v[52:55], v[72:75], v[176:179], v[52:55]
    ds_read_b128 v[120:123], v23 offset:8192
    v_mfma_f32_16x16x32_bf16 v[32:35], v[72:75], v[172:175], v[32:35]
    buffer_load_dwordx4 v[140:143], v16, s[4:7], s33 offen offset:0 sc1
    v_mfma_f32_16x16x32_bf16 v[56:59], v[76:79], v[176:179], v[56:59]
    v_mfma_f32_16x16x32_bf16 v[36:39], v[76:79], v[172:175], v[36:39]
    buffer_load_dwordx4 v[144:147], v17, s[4:7], s33 offen offset:0 sc1
    v_mfma_f32_16x16x32_bf16 v[60:63], v[80:83], v[176:179], v[60:63]
    v_mfma_f32_16x16x32_bf16 v[40:43], v[80:83], v[172:175], v[40:43]
    s_waitcnt vmcnt(14) lgkmcnt(5)
    v_mfma_f32_16x16x32_bf16 v[44:47], v[84:87], v[184:187], v[44:47]
    ds_read_b128 v[64:67], v15 offset:9216
    v_mfma_f32_16x16x32_bf16 v[24:27], v[84:87], v[180:183], v[24:27]
    ds_read_b128 v[68:71], v15 offset:10240
    v_mfma_f32_16x16x32_bf16 v[48:51], v[88:91], v[184:187], v[48:51]
    ds_read_b128 v[72:75], v15 offset:11264
    v_mfma_f32_16x16x32_bf16 v[28:31], v[88:91], v[180:183], v[28:31]
    ds_read_b128 v[76:79], v15 offset:12288
    v_mfma_f32_16x16x32_bf16 v[52:55], v[92:95], v[184:187], v[52:55]
    ds_read_b128 v[80:83], v23 offset:17408
    v_mfma_f32_16x16x32_bf16 v[32:35], v[92:95], v[180:183], v[32:35]
    buffer_load_dwordx4 v[148:151], v16, s[4:7], s33 offen offset:2048 sc1
    v_mfma_f32_16x16x32_bf16 v[56:59], v[96:99], v[184:187], v[56:59]
    v_mfma_f32_16x16x32_bf16 v[36:39], v[96:99], v[180:183], v[36:39]
    buffer_load_dwordx4 v[152:155], v17, s[4:7], s33 offen offset:2048 sc1
    v_mfma_f32_16x16x32_bf16 v[60:63], v[100:103], v[184:187], v[60:63]
    v_mfma_f32_16x16x32_bf16 v[40:43], v[100:103], v[180:183], v[40:43]
    s_waitcnt vmcnt(14) lgkmcnt(5)
    v_mfma_f32_16x16x32_bf16 v[44:47], v[104:107], v[192:195], v[44:47]
    ds_read_b128 v[84:87], v15 offset:18432
    s_mov_b32 s32, 7
    s_lshl_b32 s32, s32, 13
    s_add_u32 s32, s32, s29
    s_add_u32 s33, s32, 4096
    v_mfma_f32_16x16x32_bf16 v[24:27], v[104:107], v[188:191], v[24:27]
    ds_read_b128 v[88:91], v15 offset:19456
    v_mfma_f32_16x16x32_bf16 v[48:51], v[108:111], v[192:195], v[48:51]
    ds_read_b128 v[92:95], v15 offset:20480
    v_mfma_f32_16x16x32_bf16 v[28:31], v[108:111], v[188:191], v[28:31]
    ds_read_b128 v[96:99], v15 offset:21504
    v_mfma_f32_16x16x32_bf16 v[52:55], v[112:115], v[192:195], v[52:55]
    ds_read_b128 v[100:103], v23 offset:26624
    v_mfma_f32_16x16x32_bf16 v[32:35], v[112:115], v[188:191], v[32:35]
    buffer_load_dwordx4 v[156:159], v16, s[4:7], s32 offen offset:0 sc1
    v_mfma_f32_16x16x32_bf16 v[56:59], v[116:119], v[192:195], v[56:59]
    v_mfma_f32_16x16x32_bf16 v[36:39], v[116:119], v[188:191], v[36:39]
    buffer_load_dwordx4 v[160:163], v17, s[4:7], s32 offen offset:0 sc1
    v_mfma_f32_16x16x32_bf16 v[60:63], v[120:123], v[192:195], v[60:63]
    v_mfma_f32_16x16x32_bf16 v[40:43], v[120:123], v[188:191], v[40:43]
    s_waitcnt vmcnt(14) lgkmcnt(5)
    v_mfma_f32_16x16x32_bf16 v[44:47], v[64:67], v[200:203], v[44:47]
    ds_read_b128 v[104:107], v15 offset:27648
    v_mfma_f32_16x16x32_bf16 v[24:27], v[64:67], v[196:199], v[24:27]
    ds_read_b128 v[108:111], v15 offset:28672
    v_mfma_f32_16x16x32_bf16 v[48:51], v[68:71], v[200:203], v[48:51]
    ds_read_b128 v[112:115], v15 offset:29696
    v_mfma_f32_16x16x32_bf16 v[28:31], v[68:71], v[196:199], v[28:31]
    ds_read_b128 v[116:119], v15 offset:30720
    v_mfma_f32_16x16x32_bf16 v[52:55], v[72:75], v[200:203], v[52:55]
    ds_read_b128 v[120:123], v23 offset:35840
    v_mfma_f32_16x16x32_bf16 v[32:35], v[72:75], v[196:199], v[32:35]
    buffer_load_dwordx4 v[164:167], v16, s[4:7], s32 offen offset:2048 sc1
    v_mfma_f32_16x16x32_bf16 v[56:59], v[76:79], v[200:203], v[56:59]
    v_mfma_f32_16x16x32_bf16 v[36:39], v[76:79], v[196:199], v[36:39]
    buffer_load_dwordx4 v[168:171], v17, s[4:7], s32 offen offset:2048 sc1
    v_mfma_f32_16x16x32_bf16 v[60:63], v[80:83], v[200:203], v[60:63]
    v_mfma_f32_16x16x32_bf16 v[40:43], v[80:83], v[196:199], v[40:43]
    s_waitcnt vmcnt(14) lgkmcnt(0)
    s_barrier
    v_mfma_f32_16x16x32_bf16 v[44:47], v[84:87], v[208:211], v[44:47]
    ds_read_b128 v[64:67], v12 offset:0
    v_mfma_f32_16x16x32_bf16 v[24:27], v[84:87], v[204:207], v[24:27]
    ds_read_b128 v[68:71], v12 offset:1024
    v_mfma_f32_16x16x32_bf16 v[48:51], v[88:91], v[208:211], v[48:51]
    ds_read_b128 v[72:75], v12 offset:2048
    v_mfma_f32_16x16x32_bf16 v[28:31], v[88:91], v[204:207], v[28:31]
    ds_read_b128 v[76:79], v12 offset:3072
    v_mfma_f32_16x16x32_bf16 v[52:55], v[92:95], v[208:211], v[52:55]
    ds_read_b128 v[80:83], v20 offset:8192
    v_mfma_f32_16x16x32_bf16 v[32:35], v[92:95], v[204:207], v[32:35]
    buffer_load_dwordx4 v[172:175], v16, s[4:7], s33 offen offset:0 sc1
    v_mfma_f32_16x16x32_bf16 v[56:59], v[96:99], v[208:211], v[56:59]
    v_mfma_f32_16x16x32_bf16 v[36:39], v[96:99], v[204:207], v[36:39]
    buffer_load_dwordx4 v[176:179], v17, s[4:7], s33 offen offset:0 sc1
    v_mfma_f32_16x16x32_bf16 v[60:63], v[100:103], v[208:211], v[60:63]
    v_mfma_f32_16x16x32_bf16 v[40:43], v[100:103], v[204:207], v[40:43]
    s_waitcnt vmcnt(14) lgkmcnt(5)
    v_mfma_f32_16x16x32_bf16 v[44:47], v[104:107], v[216:219], v[44:47]
    ds_read_b128 v[84:87], v12 offset:9216
    v_mfma_f32_16x16x32_bf16 v[24:27], v[104:107], v[212:215], v[24:27]
    ds_read_b128 v[88:91], v12 offset:10240
    v_mfma_f32_16x16x32_bf16 v[48:51], v[108:111], v[216:219], v[48:51]
    ds_read_b128 v[92:95], v12 offset:11264
    v_mfma_f32_16x16x32_bf16 v[28:31], v[108:111], v[212:215], v[28:31]
    ds_read_b128 v[96:99], v12 offset:12288
    v_mfma_f32_16x16x32_bf16 v[52:55], v[112:115], v[216:219], v[52:55]
    ds_read_b128 v[100:103], v20 offset:17408
    v_mfma_f32_16x16x32_bf16 v[32:35], v[112:115], v[212:215], v[32:35]
    buffer_load_dwordx4 v[180:183], v16, s[4:7], s33 offen offset:2048 sc1
    v_mfma_f32_16x16x32_bf16 v[56:59], v[116:119], v[216:219], v[56:59]
    v_mfma_f32_16x16x32_bf16 v[36:39], v[116:119], v[212:215], v[36:39]
    buffer_load_dwordx4 v[184:187], v17, s[4:7], s33 offen offset:2048 sc1
    v_mfma_f32_16x16x32_bf16 v[60:63], v[120:123], v[216:219], v[60:63]
    v_mfma_f32_16x16x32_bf16 v[40:43], v[120:123], v[212:215], v[40:43]
    s_waitcnt vmcnt(14) lgkmcnt(5)
    v_mfma_f32_16x16x32_bf16 v[44:47], v[64:67], v[128:131], v[44:47]
    ds_read_b128 v[104:107], v12 offset:18432
    s_mov_b32 s32, 8
    s_lshl_b32 s32, s32, 13
    s_add_u32 s32, s32, s29
    s_add_u32 s33, s32, 4096
    v_mfma_f32_16x16x32_bf16 v[24:27], v[64:67], v[124:127], v[24:27]
    ds_read_b128 v[108:111], v12 offset:19456
    v_mfma_f32_16x16x32_bf16 v[48:51], v[68:71], v[128:131], v[48:51]
    ds_read_b128 v[112:115], v12 offset:20480
    v_mfma_f32_16x16x32_bf16 v[28:31], v[68:71], v[124:127], v[28:31]
    ds_read_b128 v[116:119], v12 offset:21504
    v_mfma_f32_16x16x32_bf16 v[52:55], v[72:75], v[128:131], v[52:55]
    ds_read_b128 v[120:123], v20 offset:26624
    v_mfma_f32_16x16x32_bf16 v[32:35], v[72:75], v[124:127], v[32:35]
    buffer_load_dwordx4 v[188:191], v18, s[4:7], s32 offen offset:0 sc1
    v_mfma_f32_16x16x32_bf16 v[56:59], v[76:79], v[128:131], v[56:59]
    v_mfma_f32_16x16x32_bf16 v[36:39], v[76:79], v[124:127], v[36:39]
    buffer_load_dwordx4 v[192:195], v19, s[4:7], s32 offen offset:0 sc1
    v_mfma_f32_16x16x32_bf16 v[60:63], v[80:83], v[128:131], v[60:63]
    v_mfma_f32_16x16x32_bf16 v[40:43], v[80:83], v[124:127], v[40:43]
    s_waitcnt vmcnt(14) lgkmcnt(5)
    v_mfma_f32_16x16x32_bf16 v[44:47], v[84:87], v[136:139], v[44:47]
    ds_read_b128 v[64:67], v12 offset:27648
    v_mfma_f32_16x16x32_bf16 v[24:27], v[84:87], v[132:135], v[24:27]
    ds_read_b128 v[68:71], v12 offset:28672
    v_mfma_f32_16x16x32_bf16 v[48:51], v[88:91], v[136:139], v[48:51]
    ds_read_b128 v[72:75], v12 offset:29696
    v_mfma_f32_16x16x32_bf16 v[28:31], v[88:91], v[132:135], v[28:31]
    ds_read_b128 v[76:79], v12 offset:30720
    v_mfma_f32_16x16x32_bf16 v[52:55], v[92:95], v[136:139], v[52:55]
    ds_read_b128 v[80:83], v20 offset:35840
    v_mfma_f32_16x16x32_bf16 v[32:35], v[92:95], v[132:135], v[32:35]
    buffer_load_dwordx4 v[196:199], v18, s[4:7], s32 offen offset:2048 sc1
    v_mfma_f32_16x16x32_bf16 v[56:59], v[96:99], v[136:139], v[56:59]
    v_mfma_f32_16x16x32_bf16 v[36:39], v[96:99], v[132:135], v[36:39]
    buffer_load_dwordx4 v[200:203], v19, s[4:7], s32 offen offset:2048 sc1
    v_mfma_f32_16x16x32_bf16 v[60:63], v[100:103], v[136:139], v[60:63]
    v_mfma_f32_16x16x32_bf16 v[40:43], v[100:103], v[132:135], v[40:43]
    s_waitcnt vmcnt(14) lgkmcnt(0)
    s_barrier
    v_mfma_f32_16x16x32_bf16 v[44:47], v[104:107], v[144:147], v[44:47]
    ds_read_b128 v[84:87], v13 offset:0
    v_mfma_f32_16x16x32_bf16 v[24:27], v[104:107], v[140:143], v[24:27]
    ds_read_b128 v[88:91], v13 offset:1024
    v_mfma_f32_16x16x32_bf16 v[48:51], v[108:111], v[144:147], v[48:51]
    ds_read_b128 v[92:95], v13 offset:2048
    v_mfma_f32_16x16x32_bf16 v[28:31], v[108:111], v[140:143], v[28:31]
    ds_read_b128 v[96:99], v13 offset:3072
    v_mfma_f32_16x16x32_bf16 v[52:55], v[112:115], v[144:147], v[52:55]
    ds_read_b128 v[100:103], v21 offset:8192
    v_mfma_f32_16x16x32_bf16 v[32:35], v[112:115], v[140:143], v[32:35]
    buffer_load_dwordx4 v[204:207], v18, s[4:7], s33 offen offset:0 sc1
    v_mfma_f32_16x16x32_bf16 v[56:59], v[116:119], v[144:147], v[56:59]
    v_mfma_f32_16x16x32_bf16 v[36:39], v[116:119], v[140:143], v[36:39]
    buffer_load_dwordx4 v[208:211], v19, s[4:7], s33 offen offset:0 sc1
    v_mfma_f32_16x16x32_bf16 v[60:63], v[120:123], v[144:147], v[60:63]
    v_mfma_f32_16x16x32_bf16 v[40:43], v[120:123], v[140:143], v[40:43]
    s_waitcnt vmcnt(14) lgkmcnt(5)
    v_mfma_f32_16x16x32_bf16 v[44:47], v[64:67], v[152:155], v[44:47]
    ds_read_b128 v[104:107], v13 offset:9216
    v_mfma_f32_16x16x32_bf16 v[24:27], v[64:67], v[148:151], v[24:27]
    ds_read_b128 v[108:111], v13 offset:10240
    v_mfma_f32_16x16x32_bf16 v[48:51], v[68:71], v[152:155], v[48:51]
    ds_read_b128 v[112:115], v13 offset:11264
    v_mfma_f32_16x16x32_bf16 v[28:31], v[68:71], v[148:151], v[28:31]
    ds_read_b128 v[116:119], v13 offset:12288
    v_mfma_f32_16x16x32_bf16 v[52:55], v[72:75], v[152:155], v[52:55]
    ds_read_b128 v[120:123], v21 offset:17408
    v_mfma_f32_16x16x32_bf16 v[32:35], v[72:75], v[148:151], v[32:35]
    buffer_load_dwordx4 v[212:215], v18, s[4:7], s33 offen offset:2048 sc1
    v_mfma_f32_16x16x32_bf16 v[56:59], v[76:79], v[152:155], v[56:59]
    v_mfma_f32_16x16x32_bf16 v[36:39], v[76:79], v[148:151], v[36:39]
    buffer_load_dwordx4 v[216:219], v19, s[4:7], s33 offen offset:2048 sc1
    v_mfma_f32_16x16x32_bf16 v[60:63], v[80:83], v[152:155], v[60:63]
    v_mfma_f32_16x16x32_bf16 v[40:43], v[80:83], v[148:151], v[40:43]
    s_waitcnt vmcnt(14) lgkmcnt(5)
    v_mfma_f32_16x16x32_bf16 v[44:47], v[84:87], v[160:163], v[44:47]
    ds_read_b128 v[64:67], v13 offset:18432
    v_mfma_f32_16x16x32_bf16 v[24:27], v[84:87], v[156:159], v[24:27]
    ds_read_b128 v[68:71], v13 offset:19456
    v_mfma_f32_16x16x32_bf16 v[48:51], v[88:91], v[160:163], v[48:51]
    ds_read_b128 v[72:75], v13 offset:20480
    v_mfma_f32_16x16x32_bf16 v[28:31], v[88:91], v[156:159], v[28:31]
    ds_read_b128 v[76:79], v13 offset:21504
    v_mfma_f32_16x16x32_bf16 v[52:55], v[92:95], v[160:163], v[52:55]
    ds_read_b128 v[80:83], v21 offset:26624
    v_mfma_f32_16x16x32_bf16 v[32:35], v[92:95], v[156:159], v[32:35]
    v_mfma_f32_16x16x32_bf16 v[56:59], v[96:99], v[160:163], v[56:59]
    v_mfma_f32_16x16x32_bf16 v[36:39], v[96:99], v[156:159], v[36:39]
    v_mfma_f32_16x16x32_bf16 v[60:63], v[100:103], v[160:163], v[60:63]
    v_mfma_f32_16x16x32_bf16 v[40:43], v[100:103], v[156:159], v[40:43]
    s_waitcnt vmcnt(12) lgkmcnt(5)
    v_mfma_f32_16x16x32_bf16 v[44:47], v[104:107], v[168:171], v[44:47]
    ds_read_b128 v[84:87], v13 offset:27648
    v_mfma_f32_16x16x32_bf16 v[24:27], v[104:107], v[164:167], v[24:27]
    ds_read_b128 v[88:91], v13 offset:28672
    v_mfma_f32_16x16x32_bf16 v[48:51], v[108:111], v[168:171], v[48:51]
    ds_read_b128 v[92:95], v13 offset:29696
    v_mfma_f32_16x16x32_bf16 v[28:31], v[108:111], v[164:167], v[28:31]
    ds_read_b128 v[96:99], v13 offset:30720
    v_mfma_f32_16x16x32_bf16 v[52:55], v[112:115], v[168:171], v[52:55]
    ds_read_b128 v[100:103], v21 offset:35840
    v_mfma_f32_16x16x32_bf16 v[32:35], v[112:115], v[164:167], v[32:35]
    v_mfma_f32_16x16x32_bf16 v[56:59], v[116:119], v[168:171], v[56:59]
    v_mfma_f32_16x16x32_bf16 v[36:39], v[116:119], v[164:167], v[36:39]
    v_mfma_f32_16x16x32_bf16 v[60:63], v[120:123], v[168:171], v[60:63]
    v_mfma_f32_16x16x32_bf16 v[40:43], v[120:123], v[164:167], v[40:43]
    s_waitcnt vmcnt(10) lgkmcnt(0)
    s_barrier
    v_mfma_f32_16x16x32_bf16 v[44:47], v[64:67], v[176:179], v[44:47]
    ds_read_b128 v[104:107], v14 offset:0
    v_mfma_f32_16x16x32_bf16 v[24:27], v[64:67], v[172:175], v[24:27]
    ds_read_b128 v[108:111], v14 offset:1024
    v_mfma_f32_16x16x32_bf16 v[48:51], v[68:71], v[176:179], v[48:51]
    ds_read_b128 v[112:115], v14 offset:2048
    v_mfma_f32_16x16x32_bf16 v[28:31], v[68:71], v[172:175], v[28:31]
    ds_read_b128 v[116:119], v14 offset:3072
    v_mfma_f32_16x16x32_bf16 v[52:55], v[72:75], v[176:179], v[52:55]
    ds_read_b128 v[120:123], v22 offset:8192
    v_mfma_f32_16x16x32_bf16 v[32:35], v[72:75], v[172:175], v[32:35]
    v_mfma_f32_16x16x32_bf16 v[56:59], v[76:79], v[176:179], v[56:59]
    v_mfma_f32_16x16x32_bf16 v[36:39], v[76:79], v[172:175], v[36:39]
    v_mfma_f32_16x16x32_bf16 v[60:63], v[80:83], v[176:179], v[60:63]
    v_mfma_f32_16x16x32_bf16 v[40:43], v[80:83], v[172:175], v[40:43]
    s_waitcnt vmcnt(8) lgkmcnt(5)
    v_mfma_f32_16x16x32_bf16 v[44:47], v[84:87], v[184:187], v[44:47]
    ds_read_b128 v[64:67], v14 offset:9216
    v_mfma_f32_16x16x32_bf16 v[24:27], v[84:87], v[180:183], v[24:27]
    ds_read_b128 v[68:71], v14 offset:10240
    v_mfma_f32_16x16x32_bf16 v[48:51], v[88:91], v[184:187], v[48:51]
    ds_read_b128 v[72:75], v14 offset:11264
    v_mfma_f32_16x16x32_bf16 v[28:31], v[88:91], v[180:183], v[28:31]
    ds_read_b128 v[76:79], v14 offset:12288
    v_mfma_f32_16x16x32_bf16 v[52:55], v[92:95], v[184:187], v[52:55]
    ds_read_b128 v[80:83], v22 offset:17408
    v_mfma_f32_16x16x32_bf16 v[32:35], v[92:95], v[180:183], v[32:35]
    s_waitcnt vmcnt(6)
    v_mfma_f32_16x16x32_bf16 v[56:59], v[96:99], v[184:187], v[56:59]
    v_swap_b32 v190, v192
    v_mfma_f32_16x16x32_bf16 v[36:39], v[96:99], v[180:183], v[36:39]
    v_swap_b32 v191, v193
    v_mfma_f32_16x16x32_bf16 v[60:63], v[100:103], v[184:187], v[60:63]
    v_mfma_f32_16x16x32_bf16 v[40:43], v[100:103], v[180:183], v[40:43]
    s_waitcnt vmcnt(6) lgkmcnt(5)
    v_mfma_f32_16x16x32_bf16 v[44:47], v[104:107], v[192:195], v[44:47]
    ds_read_b128 v[84:87], v14 offset:18432
    v_mfma_f32_16x16x32_bf16 v[24:27], v[104:107], v[188:191], v[24:27]
    ds_read_b128 v[88:91], v14 offset:19456
    v_mfma_f32_16x16x32_bf16 v[48:51], v[108:111], v[192:195], v[48:51]
    ds_read_b128 v[92:95], v14 offset:20480
    v_mfma_f32_16x16x32_bf16 v[28:31], v[108:111], v[188:191], v[28:31]
    ds_read_b128 v[96:99], v14 offset:21504
    v_mfma_f32_16x16x32_bf16 v[52:55], v[112:115], v[192:195], v[52:55]
    ds_read_b128 v[100:103], v22 offset:26624
    v_mfma_f32_16x16x32_bf16 v[32:35], v[112:115], v[188:191], v[32:35]
    s_waitcnt vmcnt(4)
    v_mfma_f32_16x16x32_bf16 v[56:59], v[116:119], v[192:195], v[56:59]
    v_swap_b32 v198, v200
    v_mfma_f32_16x16x32_bf16 v[36:39], v[116:119], v[188:191], v[36:39]
    v_swap_b32 v199, v201
    v_mfma_f32_16x16x32_bf16 v[60:63], v[120:123], v[192:195], v[60:63]
    v_mfma_f32_16x16x32_bf16 v[40:43], v[120:123], v[188:191], v[40:43]
    s_waitcnt vmcnt(4) lgkmcnt(5)
    v_mfma_f32_16x16x32_bf16 v[44:47], v[64:67], v[200:203], v[44:47]
    ds_read_b128 v[104:107], v14 offset:27648
    v_mfma_f32_16x16x32_bf16 v[24:27], v[64:67], v[196:199], v[24:27]
    ds_read_b128 v[108:111], v14 offset:28672
    v_mfma_f32_16x16x32_bf16 v[48:51], v[68:71], v[200:203], v[48:51]
    ds_read_b128 v[112:115], v14 offset:29696
    v_mfma_f32_16x16x32_bf16 v[28:31], v[68:71], v[196:199], v[28:31]
    ds_read_b128 v[116:119], v14 offset:30720
    v_mfma_f32_16x16x32_bf16 v[52:55], v[72:75], v[200:203], v[52:55]
    ds_read_b128 v[120:123], v22 offset:35840
    v_mfma_f32_16x16x32_bf16 v[32:35], v[72:75], v[196:199], v[32:35]
    s_waitcnt vmcnt(2)
    v_mfma_f32_16x16x32_bf16 v[56:59], v[76:79], v[200:203], v[56:59]
    v_swap_b32 v206, v208
    v_mfma_f32_16x16x32_bf16 v[36:39], v[76:79], v[196:199], v[36:39]
    v_swap_b32 v207, v209
    v_mfma_f32_16x16x32_bf16 v[60:63], v[80:83], v[200:203], v[60:63]
    v_mfma_f32_16x16x32_bf16 v[40:43], v[80:83], v[196:199], v[40:43]
    s_waitcnt vmcnt(2) lgkmcnt(5)
    v_mfma_f32_16x16x32_bf16 v[44:47], v[84:87], v[208:211], v[44:47]
    v_mfma_f32_16x16x32_bf16 v[24:27], v[84:87], v[204:207], v[24:27]
    v_mfma_f32_16x16x32_bf16 v[48:51], v[88:91], v[208:211], v[48:51]
    v_mfma_f32_16x16x32_bf16 v[28:31], v[88:91], v[204:207], v[28:31]
    v_mfma_f32_16x16x32_bf16 v[52:55], v[92:95], v[208:211], v[52:55]
    v_mfma_f32_16x16x32_bf16 v[32:35], v[92:95], v[204:207], v[32:35]
    s_waitcnt vmcnt(0)
    v_mfma_f32_16x16x32_bf16 v[56:59], v[96:99], v[208:211], v[56:59]
    v_swap_b32 v214, v216
    v_mfma_f32_16x16x32_bf16 v[36:39], v[96:99], v[204:207], v[36:39]
    v_swap_b32 v215, v217
    v_mfma_f32_16x16x32_bf16 v[60:63], v[100:103], v[208:211], v[60:63]
    v_mfma_f32_16x16x32_bf16 v[40:43], v[100:103], v[204:207], v[40:43]
    s_waitcnt vmcnt(0) lgkmcnt(0)
    v_mfma_f32_16x16x32_bf16 v[44:47], v[104:107], v[216:219], v[44:47]
    v_mfma_f32_16x16x32_bf16 v[48:51], v[108:111], v[216:219], v[48:51]
    v_mfma_f32_16x16x32_bf16 v[52:55], v[112:115], v[216:219], v[52:55]
    v_mfma_f32_16x16x32_bf16 v[56:59], v[116:119], v[216:219], v[56:59]
    v_mfma_f32_16x16x32_bf16 v[60:63], v[120:123], v[216:219], v[60:63]
    v_mfma_f32_16x16x32_bf16 v[24:27], v[104:107], v[212:215], v[24:27]
    v_mfma_f32_16x16x32_bf16 v[28:31], v[108:111], v[212:215], v[28:31]
    v_mfma_f32_16x16x32_bf16 v[32:35], v[112:115], v[212:215], v[32:35]
    v_mfma_f32_16x16x32_bf16 v[36:39], v[116:119], v[212:215], v[36:39]
    v_mfma_f32_16x16x32_bf16 v[40:43], v[120:123], v[212:215], v[40:43]
    ds_write_b128 v2, v[44:47] offset:0
    ds_write_b128 v2, v[48:51] offset:1024
    ds_write_b128 v2, v[52:55] offset:2048
    ds_write_b128 v2, v[56:59] offset:3072
    s_mov_b64 exec, s[40:41]
    ds_write_b128 v3, v[60:63] offset:4096
    s_mov_b64 exec, -1
    ds_write_b32 v0, v9
    s_mov_b32 s60, 1048576
L_px_p5:
    ds_read_b32 v232, v6
    ds_read_b128 v[64:67], v7 offset:0
    ds_read_b128 v[68:71], v7 offset:1024
    ds_read_b128 v[72:75], v7 offset:2048
    ds_read_b128 v[76:79], v7 offset:3072
    ds_read_b128 v[80:83], v8 offset:4096
    s_waitcnt lgkmcnt(5)
    v_cmp_ne_u32 vcc, s43, v232
    s_sub_u32 s60, s60, 1
    s_cbranch_scc1 L_py_p5
    s_cbranch_vccnz L_px_p5
L_py_p5:
    s_waitcnt lgkmcnt(4)
    v_pk_add_f32 v[24:25], v[24:25], v[64:65]
    v_pk_add_f32 v[26:27], v[26:27], v[66:67]
    v_cvt_pk_bf16_f32 v220, v24, v25
    v_cvt_pk_bf16_f32 v221, v26, v27
    s_waitcnt lgkmcnt(3)
    v_pk_add_f32 v[28:29], v[28:29], v[68:69]
    v_pk_add_f32 v[30:31], v[30:31], v[70:71]
    v_cvt_pk_bf16_f32 v222, v28, v29
    v_cvt_pk_bf16_f32 v223, v30, v31
    s_waitcnt lgkmcnt(2)
    v_pk_add_f32 v[32:33], v[32:33], v[72:73]
    v_pk_add_f32 v[34:35], v[34:35], v[74:75]
    v_cvt_pk_bf16_f32 v224, v32, v33
    v_cvt_pk_bf16_f32 v225, v34, v35
    s_waitcnt lgkmcnt(1)
    v_pk_add_f32 v[36:37], v[36:37], v[76:77]
    v_pk_add_f32 v[38:39], v[38:39], v[78:79]
    v_cvt_pk_bf16_f32 v226, v36, v37
    v_cvt_pk_bf16_f32 v227, v38, v39
    s_waitcnt lgkmcnt(0)
    v_pk_add_f32 v[40:41], v[40:41], v[80:81]
    v_pk_add_f32 v[42:43], v[42:43], v[82:83]
    v_cvt_pk_bf16_f32 v228, v40, v41
    v_cvt_pk_bf16_f32 v229, v42, v43
    s_cmp_eq_u32 s22, 1
    s_cbranch_scc1 L_fin_p5
    buffer_store_dwordx4 v[220:223], v4, s[4:7], s34 offen offset:0 sc1
    buffer_store_dwordx4 v[224:227], v4, s[4:7], s34 offen offset:1024 sc1
    buffer_store_dwordx2 v[228:229], v5, s[4:7], s34 offen sc1
    v_cndmask_b32 v234, 0, v228, s[40:41]
    v_cndmask_b32 v235, 0, v229, s[40:41]
    v_dot2_f32_bf16 v232, v220, v11, 0
    v_dot2_f32_bf16 v233, v220, v220, 0
    v_dot2_f32_bf16 v232, v221, v11, v232
    v_dot2_f32_bf16 v233, v221, v221, v233
    v_dot2_f32_bf16 v232, v222, v11, v232
    v_dot2_f32_bf16 v233, v222, v222, v233
    v_dot2_f32_bf16 v232, v223, v11, v232
    v_dot2_f32_bf16 v233, v223, v223, v233
    v_dot2_f32_bf16 v232, v224, v11, v232
    v_dot2_f32_bf16 v233, v224, v224, v233
    v_dot2_f32_bf16 v232, v225, v11, v232
    v_dot2_f32_bf16 v233, v225, v225, v233
    v_dot2_f32_bf16 v232, v226, v11, v232
    v_dot2_f32_bf16 v233, v226, v226, v233
    v_dot2_f32_bf16 v232, v227, v11, v232
    v_dot2_f32_bf16 v233, v227, v227, v233
    v_dot2_f32_bf16 v232, v234, v11, v232
    v_dot2_f32_bf16 v233, v234, v234, v233
    v_dot2_f32_bf16 v232, v235, v11, v232
    v_dot2_f32_bf16 v233, v235, v235, v233
    s_nop 2
    v_mov_b32 v234, v232
    v_mov_b32 v235, v233
    s_nop 1
    v_permlane32_swap_b32 v232, v234
    v_permlane32_swap_b32 v233, v235
    v_add_f32 v232, v232, v234
    v_add_f32 v233, v233, v235
    v_mov_b32 v234, v232
    v_mov_b32 v235, v233
    s_nop 1
    v_permlane16_swap_b32 v232, v234
    v_permlane16_swap_b32 v233, v235
    v_add_f32 v232, v232, v234
    v_add_f32 v233, v233, v235
    buffer_store_dwordx2 v[232:233], v10, s[4:7], s39 offen sc1
    s_barrier
    s_mov_b32 s22, 1
    s_mov_b32 s21, 0x1c00000
    s_branch L_m_cl
L_fin_p5:
    ds_bpermute_b32 v220, v10, v220
    ds_bpermute_b32 v221, v10, v221
    ds_bpermute_b32 v222, v10, v222
    ds_bpermute_b32 v223, v10, v223
    ds_bpermute_b32 v224, v10, v224
    ds_bpermute_b32 v225, v10, v225
    ds_bpermute_b32 v226, v10, v226
    ds_bpermute_b32 v227, v10, v227
    ds_bpermute_b32 v228, v10, v228
    ds_bpermute_b32 v229, v10, v229
    s_waitcnt lgkmcnt(6)
    buffer_store_dwordx4 v[220:223], v4, s[16:19], s34 offen offset:0
    s_waitcnt lgkmcnt(2)
    buffer_store_dwordx4 v[224:227], v4, s[16:19], s34 offen offset:64
    s_waitcnt lgkmcnt(0)
    buffer_store_dwordx2 v[228:229], v5, s[16:19], s34 offen offset:128
    s_endpgm
L_m_l1:
    s_and_b32 s25, s2, 7
    s_lshr_b32 s26, s2, 3
    s_lshr_b32 s23, s25, 1
    s_lshl_b32 s23, s23, 2
    s_lshr_b32 s27, s26, 3
    s_add_u32 s23, s23, s27
    s_and_b32 s24, s25, 1
    s_lshl_b32 s24, s24, 3
    s_and_b32 s27, s26, 7
    s_add_u32 s24, s24, s27
    s_mul_i32 s29, s24, 129024
    s_lshl_b32 s30, s20, 12
    s_add_u32 s29, s29, s30
    s_add_u32 s29, s29, 0x3800000
    s_lshl_b32 s31, s23, 3
    s_max_u32 s31, s31, 1
    s_sub_u32 s31, s31, 1
    s_mul_i32 s31, s31, 18432
    s_add_u32 s31, s31, 0x0
    s_lshl_b32 s35, s20, 10
    s_and_b32 s36, s35, 1024
    s_barrier
    s_add_u32 m0, s35, 131072
    s_add_u32 s34, s31, s35
    s_add_u32 s34, s34, 0
    buffer_load_dwordx4 v1, s[4:7], s34 offen sc1 lds
    s_add_u32 m0, s30, 0
    s_add_u32 s34, s29, 0
    buffer_load_dwordx4 v1, s[4:7], s34 offen offset:0 sc1 lds
    buffer_load_dwordx4 v1, s[4:7], s34 offen offset:1024 sc1 lds
    buffer_load_dwordx4 v1, s[4:7], s34 offen offset:2048 sc1 lds
    buffer_load_dwordx4 v1, s[4:7], s34 offen offset:3072 sc1 lds
    s_add_u32 m0, s30, 16384
    s_add_u32 s34, s29, 16384
    buffer_load_dwordx4 v1, s[4:7], s34 offen offset:0 sc1 lds
    buffer_load_dwordx4 v1, s[4:7], s34 offen offset:1024 sc1 lds
    buffer_load_dwordx4 v1, s[4:7], s34 offen offset:2048 sc1 lds
    buffer_load_dwordx4 v1, s[4:7], s34 offen offset:3072 sc1 lds
    s_waitcnt vmcnt(4) lgkmcnt(0)
    s_barrier
    s_add_u32 m0, s30, 32768
    s_add_u32 s34, s29, 32768
    buffer_load_dwordx4 v1, s[4:7], s34 offen offset:0 sc1 lds
    buffer_load_dwordx4 v1, s[4:7], s34 offen offset:1024 sc1 lds
    buffer_load_dwordx4 v1, s[4:7], s34 offen offset:2048 sc1 lds
    buffer_load_dwordx4 v1, s[4:7], s34 offen offset:3072 sc1 lds
    s_cmp_lt_u32 s2, 144
    s_cbranch_scc1 L_p0_t1
    s_cmp_ge_u32 s2, 216
    s_cbranch_scc1 L_p0_t2
    ds_read_b64_tr_b16 v[16:17], v4 offset:0
    ds_read_b64_tr_b16 v[18:19], v4 offset:2048
    ds_read_b64_tr_b16 v[20:21], v4 offset:18432
    ds_read_b64_tr_b16 v[22:23], v4 offset:20480
    ds_read_b64_tr_b16 v[24:25], v4 offset:4096
    ds_read_b64_tr_b16 v[26:27], v4 offset:6144
    ds_read_b64_tr_b16 v[28:29], v4 offset:22528
    ds_read_b64_tr_b16 v[30:31], v4 offset:24576
    ds_read_b64_tr_b16 v[32:33], v4 offset:8192
    ds_read_b64_tr_b16 v[34:35], v4 offset:10240
    ds_read_b64_tr_b16 v[36:37], v4 offset:26624
    ds_read_b64_tr_b16 v[38:39], v4 offset:28672
    ds_read_b64_tr_b16 v[40:41], v4 offset:12288
    ds_read_b64_tr_b16 v[42:43], v4 offset:14336
    ds_read_b64_tr_b16 v[44:45], v4 offset:30720
    ds_read_b64_tr_b16 v[46:47], v4 offset:32768
    ds_read_b64_tr_b16 v[48:49], v5 offset:16384
    ds_read_b64_tr_b16 v[50:51], v5 offset:34816
    s_branch L_p0_t2
L_p0_t1:
    ds_read_b64_tr_b16 v[16:17], v4 offset:0
    ds_read_b64_tr_b16 v[18:19], v4 offset:512
    ds_read_b64_tr_b16 v[20:21], v4 offset:4352
    ds_read_b64_tr_b16 v[22:23], v4 offset:4864
    ds_read_b64_tr_b16 v[24:25], v4 offset:9792
    ds_read_b64_tr_b16 v[26:27], v4 offset:10304
    ds_read_b64_tr_b16 v[28:29], v4 offset:14144
    ds_read_b64_tr_b16 v[30:31], v4 offset:14656
    ds_read_b64_tr_b16 v[32:33], v4 offset:19584
    ds_read_b64_tr_b16 v[34:35], v4 offset:20096
    ds_read_b64_tr_b16 v[36:37], v4 offset:23936
    ds_read_b64_tr_b16 v[38:39], v4 offset:24448
    ds_read_b64_tr_b16 v[40:41], v4 offset:29376
    ds_read_b64_tr_b16 v[42:43], v4 offset:29888
    ds_read_b64_tr_b16 v[44:45], v4 offset:33728
    ds_read_b64_tr_b16 v[46:47], v4 offset:34240
    ds_read_b64_tr_b16 v[48:49], v5 offset:8704
    ds_read_b64_tr_b16 v[50:51], v5 offset:9216
L_p0_t2:
    s_waitcnt lgkmcnt(0)
    s_waitcnt vmcnt(4) lgkmcnt(0)
    s_barrier
    s_add_u32 m0, s35, 135168
    s_add_u32 s34, s31, s35
    s_add_u32 s34, s34, 4096
    buffer_load_dwordx4 v1, s[4:7], s34 offen sc1 lds
    s_add_u32 m0, s30, 49152
    s_add_u32 s34, s29, 49152
    buffer_load_dwordx4 v1, s[4:7], s34 offen offset:0 sc1 lds
    buffer_load_dwordx4 v1, s[4:7], s34 offen offset:1024 sc1 lds
    buffer_load_dwordx4 v1, s[4:7], s34 offen offset:2048 sc1 lds
    buffer_load_dwordx4 v1, s[4:7], s34 offen offset:3072 sc1 lds
    s_waitcnt vmcnt(5) lgkmcnt(0)
    s_barrier
    s_add_u32 m0, s35, 139264
    s_add_u32 s34, s31, s35
    s_add_u32 s34, s34, 8192
    buffer_load_dwordx4 v1, s[4:7], s34 offen sc1 lds
    v_lshrrev_b32 v2, 8, v1
    v_bfe_u32 v3, v1, 7, 1
    v_bfe_u32 v4, v1, 4, 3
    v_cmp_gt_u32 vcc, 3, v2
    v_mul_u32_u24 v3, 80, v3
    v_lshl_add_u32 v3, v4, 3, v3
    v_lshrrev_b32 v5, 1, v4
    v_and_b32 v4, 1, v4
    v_lshl_add_u32 v4, v4, 3, 64
    v_cndmask_b32 v2, v5, v2, vcc
    v_cndmask_b32 v3, v4, v3, vcc
    v_mul_u32_u24 v2, 2304, v2
    v_add_u32 v0, v2, v3
    v_lshrrev_b32 v8, 1, v1
    s_mul_i32 s34, s24, 144
    s_add_u32 s34, s34, 0x4400000
    buffer_load_dwordx2 v[2:3], v0, s[4:7], s34 offen sc1
    s_mul_i32 s34, s24, 144
    s_add_u32 s34, s34, 0x4402000
    buffer_load_dwordx2 v[4:5], v0, s[4:7], s34 offen sc1
    s_mul_i32 s34, s24, 144
    s_add_u32 s34, s34, 0x4404000
    buffer_load_dwordx2 v[6:7], v0, s[4:7], s34 offen sc1
    s_mul_i32 s34, s24, 144
    s_add_u32 s34, s34, 0x4406000
    buffer_load_dwordx2 v[12:13], v0, s[4:7], s34 offen sc1
    s_add_u32 m0, s30, 65536
    s_add_u32 s34, s29, 65536
    buffer_load_dwordx4 v1, s[4:7], s34 offen offset:0 sc1 lds
    buffer_load_dwordx4 v1, s[4:7], s34 offen offset:1024 sc1 lds
    buffer_load_dwordx4 v1, s[4:7], s34 offen offset:2048 sc1 lds
    buffer_load_dwordx4 v1, s[4:7], s34 offen offset:3072 sc1 lds
    s_waitcnt vmcnt(9) lgkmcnt(0)
    s_barrier
    s_add_u32 m0, s30, 81920
    s_add_u32 s34, s29, 81920
    buffer_load_dwordx4 v1, s[4:7], s34 offen offset:0 sc1 lds
    buffer_load_dwordx4 v1, s[4:7], s34 offen offset:1024 sc1 lds
    buffer_load_dwordx4 v1, s[4:7], s34 offen offset:2048 sc1 lds
    buffer_load_dwordx4 v1, s[4:7], s34 offen offset:3072 sc1 lds
    s_waitcnt vmcnt(8)
    v_add_f32 v2, v2, v4
    v_add_f32 v3, v3, v5
    v_add_f32 v6, v6, v12
    v_add_f32 v7, v7, v13
    v_add_f32 v2, v2, v6
    v_add_f32 v3, v3, v7
    v_cmp_gt_u32 vcc, 864, v1
    v_add_u32 v8, 161792, v8
    s_nop 0
    v_cndmask_b32 v2, 0, v2, vcc
    v_cndmask_b32 v3, 0, v3, vcc
    ds_write_b64 v8, v[2:3]
    s_waitcnt vmcnt(4) lgkmcnt(0)
    s_barrier
    s_add_u32 m0, s35, 143360
    s_add_u32 s34, s31, s35
    s_add_u32 s34, s34, 12288
    buffer_load_dwordx4 v1, s[4:7], s34 offen sc1 lds
    s_add_u32 m0, s30, 98304
    s_add_u32 s34, s29, 98304
    buffer_load_dwordx4 v1, s[4:7], s34 offen offset:0 sc1 lds
    buffer_load_dwordx4 v1, s[4:7], s34 offen offset:1024 sc1 lds
    buffer_load_dwordx4 v1, s[4:7], s34 offen offset:2048 sc1 lds
    buffer_load_dwordx4 v1, s[4:7], s34 offen offset:3072 sc1 lds
    s_waitcnt vmcnt(5) lgkmcnt(0)
    s_barrier
    s_add_u32 m0, s36, 147456
    s_add_u32 s34, s31, s36
    s_add_u32 s34, s34, 16384
    buffer_load_dwordx4 v1, s[4:7], s34 offen sc1 lds
    s_add_u32 m0, s30, 114688
    s_add_u32 s34, s29, 114688
    buffer_load_dwordx4 v1, s[4:7], s34 offen offset:0 sc1 lds
    buffer_load_dwordx4 v1, s[4:7], s34 offen offset:1024 sc1 lds
    buffer_load_dwordx4 v1, s[4:7], s34 offen offset:2048 sc1 lds
    buffer_load_dwordx4 v1, s[4:7], s34 offen offset:3072 sc1 lds
    s_waitcnt vmcnt(5) lgkmcnt(0)
    s_barrier
    buffer_store_dwordx4 v[16:19], v9, s[4:7], s37 offen sc1
    buffer_store_dwordx4 v[20:23], v10, s[4:7], s38 offen sc1
    buffer_store_dwordx4 v[24:27], v9, s[4:7], s39 offen sc1
    buffer_store_dwordx4 v[28:31], v10, s[4:7], s40 offen sc1
    buffer_store_dwordx4 v[32:35], v9, s[4:7], s41 offen sc1
    s_waitcnt vmcnt(5) lgkmcnt(0)
    s_barrier
    s_mov_b32 s46, 0x4502000
    v_mov_b32 v4, 0
    s_mov_b32 s60, 65536
L_poll_wo:
    buffer_load_dword v5, v4, s[4:7], s46 offen sc1
    s_waitcnt vmcnt(0)
    v_cmp_gt_u32 vcc, 18, v5
    s_sub_u32 s60, s60, 1
    s_cbranch_scc1 L_pd_wo
    s_cbranch_vccz L_pd_wo
    s_sleep 4
    s_branch L_poll_wo
L_pd_wo:
    buffer_store_dwordx4 v[36:39], v10, s[4:7], s42 offen sc1
    buffer_store_dwordx4 v[40:43], v9, s[4:7], s43 offen sc1
    buffer_store_dwordx4 v[44:47], v10, s[4:7], s47 offen sc1
    buffer_store_dwordx4 v[48:51], v14, s[4:7], s48 offen sc1
    v_dot2_f32_bf16 v12, v16, v11, 0
    v_dot2_f32_bf16 v13, v17, v11, 0
    v_dot2_f32_bf16 v12, v18, v11, v12
    v_dot2_f32_bf16 v13, v19, v11, v13
    v_dot2_f32_bf16 v12, v20, v11, v12
    v_dot2_f32_bf16 v13, v21, v11, v13
    v_dot2_f32_bf16 v12, v22, v11, v12
    v_dot2_f32_bf16 v13, v23, v11, v13
    v_dot2_f32_bf16 v12, v24, v11, v12
    v_dot2_f32_bf16 v13, v25, v11, v13
    v_dot2_f32_bf16 v12, v26, v11, v12
    v_dot2_f32_bf16 v13, v27, v11, v13
    v_dot2_f32_bf16 v12, v28, v11, v12
    v_dot2_f32_bf16 v13, v29, v11, v13
    v_dot2_f32_bf16 v12, v30, v11, v12
    v_dot2_f32_bf16 v13, v31, v11, v13
    v_dot2_f32_bf16 v12, v32, v11, v12
    v_dot2_f32_bf16 v13, v33, v11, v13
    v_dot2_f32_bf16 v12, v34, v11, v12
    v_dot2_f32_bf16 v13, v35, v11, v13
    v_dot2_f32_bf16 v12, v36, v11, v12
    v_dot2_f32_bf16 v13, v37, v11, v13
    v_dot2_f32_bf16 v12, v38, v11, v12
    v_dot2_f32_bf16 v13, v39, v11, v13
    v_dot2_f32_bf16 v12, v40, v11, v12
    v_dot2_f32_bf16 v13, v41, v11, v13
    v_dot2_f32_bf16 v12, v42, v11, v12
    v_dot2_f32_bf16 v13, v43, v11, v13
    v_dot2_f32_bf16 v12, v44, v11, v12
    v_dot2_f32_bf16 v13, v45, v11, v13
    v_dot2_f32_bf16 v12, v46, v11, v12
    v_dot2_f32_bf16 v13, v47, v11, v13
    v_dot2_f32_bf16 v12, v48, v11, v12
    v_dot2_f32_bf16 v13, v49, v11, v13
    v_dot2_f32_bf16 v12, v50, v11, v12
    v_dot2_f32_bf16 v13, v51, v11, v13
    s_nop 2
    v_add_f32 v12, v12, v13
    v_mov_b32 v13, v12
    s_nop 1
    v_permlane32_swap_b32 v12, v13
    v_add_f32 v12, v12, v13
    v_mov_b32 v13, v12
    s_nop 1
    v_permlane16_swap_b32 v12, v13
    v_add_f32 v12, v12, v13
    buffer_store_dword v12, v15, s[4:7], s49 offen sc1
    s_barrier
L_m_ll:
    s_and_b32 s25, s2, 7
    s_lshr_b32 s26, s2, 3
    s_lshr_b32 s23, s25, 1
    s_lshl_b32 s23, s23, 3
    s_lshr_b32 s27, s26, 2
    s_add_u32 s23, s23, s27
    s_and_b32 s24, s25, 1
    s_lshl_b32 s24, s24, 2
    s_and_b32 s27, s26, 3
    s_add_u32 s24, s24, s27
    s_add_u32 s25, s23, s24
    s_and_b32 s25, s25, 3
    s_mul_i32 s29, s24, 82944
    s_add_u32 s29, s29, 0x3a00000
    s_mul_i32 s30, s20, 36864
    s_mul_i32 s31, s20, 18432
    s_add_u32 s31, s31, s29
    s_add_u32 m0, s30, 18432
    s_add_u32 s33, s31, 0
    buffer_load_dwordx4 v1, s[4:7], s33 offen offset:0  sc1 lds
    buffer_load_dwordx4 v1, s[4:7], s33 offen offset:1024  sc1 lds
    buffer_load_dwordx4 v1, s[4:7], s33 offen offset:2048  sc1 lds
    buffer_load_dwordx4 v1, s[4:7], s33 offen offset:3072  sc1 lds
    s_add_u32 m0, s30, 22528
    s_add_u32 s33, s31, 4096
    buffer_load_dwordx4 v1, s[4:7], s33 offen offset:0  sc1 lds
    buffer_load_dwordx4 v1, s[4:7], s33 offen offset:1024  sc1 lds
    buffer_load_dwordx4 v1, s[4:7], s33 offen offset:2048  sc1 lds
    buffer_load_dwordx4 v1, s[4:7], s33 offen offset:3072  sc1 lds
    s_add_u32 m0, s30, 26624
    s_add_u32 s33, s31, 8192
    buffer_load_dwordx4 v1, s[4:7], s33 offen offset:0  sc1 lds
    buffer_load_dwordx4 v1, s[4:7], s33 offen offset:1024  sc1 lds
    buffer_load_dwordx4 v1, s[4:7], s33 offen offset:2048  sc1 lds
    buffer_load_dwordx4 v1, s[4:7], s33 offen offset:3072  sc1 lds
    s_waitcnt vmcnt(12)
    s_barrier
    s_add_u32 m0, s30, 30720
    s_add_u32 s33, s31, 12288
    buffer_load_dwordx4 v1, s[4:7], s33 offen offset:0  sc1 lds
    buffer_load_dwordx4 v1, s[4:7], s33 offen offset:1024  sc1 lds
    buffer_load_dwordx4 v1, s[4:7], s33 offen offset:2048  sc1 lds
    buffer_load_dwordx4 v1, s[4:7], s33 offen offset:3072  sc1 lds
    s_add_u32 m0, s30, 34816
    s_add_u32 s33, s31, 16384
    buffer_load_dwordx4 v1, s[4:7], s33 offen offset:0  sc1 lds
    buffer_load_dwordx4 v1, s[4:7], s33 offen offset:1024  sc1 lds
    s_mul_i32 s30, s20, 3072
    s_add_u32 s31, s30, s29
    s_add_u32 m0, s30, 147456
    s_add_u32 s33, s31, 73728
    buffer_load_dwordx4 v1, s[4:7], s33 offen offset:0  sc1 lds
    buffer_load_dwordx4 v1, s[4:7], s33 offen offset:1024  sc1 lds
    buffer_load_dwordx4 v1, s[4:7], s33 offen offset:2048  sc1 lds
    s_or_b32 s44, s20, s22
    s_cbranch_scc1 L_p2_ns
    s_and_b32 s44, s2, 15
    s_lshl_b32 s44, s44, 8
    s_add_u32 s44, s44, 0x4501000
    s_add_u32 s44, s44, s4
    s_addc_u32 s45, s5, 0
    s_mov_b32 s56, 1
    s_atomic_add s56, s[44:45], 0
L_p2_ns:
    s_waitcnt vmcnt(0)
    s_barrier
    s_and_b32 s25, s2, 7
    s_lshr_b32 s26, s2, 3
    s_and_b32 s23, s25, 1
    s_lshl_b32 s23, s23, 3
    s_and_b32 s27, s26, 7
    s_add_u32 s23, s23, s27
    s_lshr_b32 s24, s25, 1
    s_lshl_b32 s24, s24, 2
    s_lshr_b32 s27, s26, 3
    s_add_u32 s24, s24, s27
    s_add_u32 s28, s23, s24
    s_and_b32 s28, s28, 3
    s_lshl_b32 s30, s20, 12
    s_lshr_b32 s33, s20, 1
    s_mul_i32 s31, s33, 36864
    s_and_b32 s33, s20, 1
    s_lshl_b32 s33, s33, 10
    s_add_u32 s33, s33, 16384
    s_add_u32 s31, s31, s33
    s_sub_u32 s49, s33, s30
    s_mul_i32 s34, s24, 331776
    s_add_u32 s34, s34, s30
    s_add_u32 s34, s34, 0x3b00000
    s_lshl_b32 s35, s23, 3
    s_lshl_b32 s33, s20, 1
    s_add_u32 s35, s35, s33
    s_mul_i32 s35, s35, 18432
    s_add_u32 s35, s35, s21
    s_add_u32 s35, s35, 0x300000
    s_mul_i32 s36, s24, 589824
    s_add_u32 s36, s36, s30
    s_add_u32 s36, s36, s21
    s_add_u32 s36, s36, 0x900000
    v_add_u32 v2, 16384, v1
    s_add_u32 s33, s30, 18432
    v_add_u32 v6, s33, v1
    v_add_u32 v7, 73728, v6
    s_lshl_b32 s29, s23, 2
    s_add_u32 s29, s29, s20
    s_lshl_b32 s29, s29, 12
    s_add_u32 s29, s29, s21
    s_add_u32 s29, s29, 0x1b40000
    v_and_b32 v3, 48, v1
    v_lshrrev_b32 v8, 8, v1
    v_lshl_add_u32 v3, v8, 6, v3
    v_bfe_u32 v8, v1, 6, 2
    v_lshl_add_u32 v3, v8, 8, v3
    s_lshl_b32 s33, s23, 7
    s_lshl_b32 s37, s20, 5
    s_add_u32 s33, s33, s37
    v_lshrrev_b32 v8, 7, v1
    v_add_u32 v8, s33, v8
    v_lshlrev_b32 v8, 12, v8
    v_lshrrev_b32 v9, 8, v1
    v_bfe_u32 v10, v1, 4, 3
    v_xor_b32 v9, v9, v10
    v_lshl_add_u32 v8, v9, 4, v8
    v_xor_b32 v9, 64, v8
    v_add_u32 v9, 31744, v9
    v_add_u32 v10, 63488, v8
    v_add_u32 v11, 63488, v9
    s_cmp_eq_u32 s28, 0
    s_cselect_b32 s44, 4, 0
    s_cmp_eq_u32 s28, 1
    s_cselect_b32 s45, 5, 1
    s_cmp_eq_u32 s28, 2
    s_cselect_b32 s46, 6, 2
    s_cmp_eq_u32 s28, 3
    s_cselect_b32 s47, 7, 3
    s_lshl_b32 s33, s20, 4
    s_add_u32 s33, s33, s24
    s_lshl_b32 s54, s22, 7
    s_add_u32 s54, s54, s33
    s_lshl_b32 s54, s54, 8
    s_add_u32 s54, s54, 0x450c000
    s_add_u32 s54, s54, s4
    s_addc_u32 s55, s5, 0
    s_mov_b32 s33, 0x4501000
    v_and_b32 v4, 0xf0, v1
    v_lshlrev_b32 v4, 4, v4
    s_mov_b32 s60, 65536
L_poll_wr:
    buffer_load_dword v5, v4, s[4:7], s33 offen sc1
    s_waitcnt vmcnt(0)
    v_cmp_gt_u32 vcc, 16, v5
    s_sub_u32 s60, s60, 1
    s_cbranch_scc1 L_pd_wr
    s_cbranch_vccz L_pd_wr
    s_sleep 4
    s_branch L_poll_wr
L_pd_wr:
    s_min_u32 s33, s20, 2
    s_lshl_b32 s33, s33, 9
    v_lshrrev_b32 v4, 1, v1
    v_add_u32 v4, s33, v4
    s_lshl_b32 s51, s24, 12
    s_add_u32 s51, s51, 0x4410000
    buffer_load_dwordx2 v[16:17], v4, s[4:7], s51 offen offset:0 sc1
    buffer_load_dwordx2 v[18:19], v4, s[4:7], s51 offen offset:1152 sc1
    s_mov_b32 s48, 0
    s_mul_i32 s50, s48, 18432
    s_add_u32 s50, s50, s34
    s_add_u32 m0, s30, 0
    s_mov_b32 s53, s50
    buffer_load_dwordx4 v1, s[4:7], s50 offen offset:0  sc1 lds
    buffer_load_dwordx4 v1, s[4:7], s50 offen offset:1024  sc1 lds
    buffer_load_dwordx4 v1, s[4:7], s50 offen offset:2048  sc1 lds
    buffer_load_dwordx4 v1, s[4:7], s50 offen offset:3072  sc1 lds
    s_mov_b32 s48, 1
    s_mul_i32 s50, s48, 18432
    s_add_u32 s50, s50, s34
    s_cmp_ge_u32 s20, 2
    s_cselect_b32 s52, s50, s53
    s_add_u32 m0, s31, 0
    s_add_u32 s52, s52, s49
    buffer_load_dwordx4 v1, s[4:7], s52 offen  sc1 lds
    s_add_u32 m0, s30, 36864
    s_mov_b32 s53, s50
    buffer_load_dwordx4 v1, s[4:7], s50 offen offset:0  sc1 lds
    buffer_load_dwordx4 v1, s[4:7], s50 offen offset:1024  sc1 lds
    buffer_load_dwordx4 v1, s[4:7], s50 offen offset:2048  sc1 lds
    buffer_load_dwordx4 v1, s[4:7], s50 offen offset:3072  sc1 lds
    s_mov_b32 m0, 161280
    v_lshrrev_b32 v5, 2, v1
    s_lshl_b32 s33, s23, 8
    buffer_load_dword v5, s[12:15], s33 offen lds
    s_waitcnt vmcnt(10)
    v_add_u32 v4, 159744, v4
    v_add_f32 v16, v16, v18
    v_add_f32 v17, v17, v19
    ds_write_b64 v4, v[16:17]
    s_waitcnt lgkmcnt(0)
    s_barrier
    s_mov_b32 s48, 2
    s_mul_i32 s50, s48, 18432
    s_add_u32 s50, s50, s34
    s_add_u32 m0, s30, 73728
    s_mov_b32 s53, s50
    buffer_load_dwordx4 v1, s[4:7], s50 offen offset:0  sc1 lds
    buffer_load_dwordx4 v1, s[4:7], s50 offen offset:1024  sc1 lds
    buffer_load_dwordx4 v1, s[4:7], s50 offen offset:2048  sc1 lds
    buffer_load_dwordx4 v1, s[4:7], s50 offen offset:3072  sc1 lds
    s_mov_b32 s48, 3
    s_mul_i32 s50, s48, 18432
    s_add_u32 s50, s50, s34
    s_cmp_ge_u32 s20, 2
    s_cselect_b32 s52, s50, s53
    s_add_u32 m0, s31, 73728
    s_add_u32 s52, s52, s49
    buffer_load_dwordx4 v1, s[4:7], s52 offen  sc1 lds
    s_add_u32 m0, s30, 110592
    s_mov_b32 s53, s50
    buffer_load_dwordx4 v1, s[4:7], s50 offen offset:0  sc1 lds
    buffer_load_dwordx4 v1, s[4:7], s50 offen offset:1024  sc1 lds
    buffer_load_dwordx4 v1, s[4:7], s50 offen offset:2048  sc1 lds
    buffer_load_dwordx4 v1, s[4:7], s50 offen offset:3072  sc1 lds
    s_barrier
    s_add_u32 m0, s30, 18432
    s_add_u32 s51, s35, 0
    buffer_load_dwordx4 v1, s[4:7], s51 offen offset:0 sc1 lds
    buffer_load_dwordx4 v1, s[4:7], s51 offen offset:1024 sc1 lds
    buffer_load_dwordx4 v2, s[4:7], s51 offen offset:2048 sc1 lds
    buffer_load_dwordx4 v2, s[4:7], s51 offen offset:3072 sc1 lds
    s_add_u32 m0, s30, 55296
    s_add_u32 s51, s35, 2048
    buffer_load_dwordx4 v1, s[4:7], s51 offen offset:0 sc1 lds
    buffer_load_dwordx4 v1, s[4:7], s51 offen offset:1024 sc1 lds
    buffer_load_dwordx4 v2, s[4:7], s51 offen offset:2048 sc1 lds
    buffer_load_dwordx4 v2, s[4:7], s51 offen offset:3072 sc1 lds
    s_add_u32 m0, s30, 92160
    s_add_u32 s51, s35, 4096
    buffer_load_dwordx4 v1, s[4:7], s51 offen offset:0 sc1 lds
    buffer_load_dwordx4 v1, s[4:7], s51 offen offset:1024 sc1 lds
    buffer_load_dwordx4 v2, s[4:7], s51 offen offset:2048 sc1 lds
    buffer_load_dwordx4 v2, s[4:7], s51 offen offset:3072 sc1 lds
    s_waitcnt vmcnt(8)
    s_barrier
    s_add_u32 m0, s30, 129024
    s_add_u32 s51, s35, 6144
    buffer_load_dwordx4 v1, s[4:7], s51 offen offset:0 sc1 lds
    buffer_load_dwordx4 v1, s[4:7], s51 offen offset:1024 sc1 lds
    buffer_load_dwordx4 v2, s[4:7], s51 offen offset:2048 sc1 lds
    buffer_load_dwordx4 v2, s[4:7], s51 offen offset:3072 sc1 lds
    s_and_b32 s40, s2, 7
    s_lshr_b32 s26, s2, 3
    s_lshr_b32 s38, s40, 1
    s_lshl_b32 s38, s38, 3
    s_lshr_b32 s27, s26, 2
    s_add_u32 s38, s38, s27
    s_and_b32 s39, s40, 1
    s_lshl_b32 s39, s39, 2
    s_and_b32 s27, s26, 3
    s_add_u32 s39, s39, s27
    s_add_u32 s40, s38, s39
    s_and_b32 s40, s40, 3
    s_mul_i32 s42, s20, 9216
    s_mul_i32 s43, s39, 331776
    s_add_u32 s43, s43, s42
    s_add_u32 s43, s43, 0x4100000
    s_waitcnt vmcnt(8) lgkmcnt(0)
    s_barrier
    s_mov_b32 s48, 4
    s_mul_i32 s50, s48, 18432
    s_add_u32 s50, s50, s34
    s_add_u32 m0, s30, 0
    s_mov_b32 s53, s50
    buffer_load_dwordx4 v1, s[4:7], s50 offen offset:0  sc1 lds
    buffer_load_dwordx4 v1, s[4:7], s50 offen offset:1024  sc1 lds
    buffer_load_dwordx4 v1, s[4:7], s50 offen offset:2048  sc1 lds
    buffer_load_dwordx4 v1, s[4:7], s50 offen offset:3072  sc1 lds
    s_add_u32 m0, s30, 18432
    s_add_u32 s51, s35, 8192
    buffer_load_dwordx4 v1, s[4:7], s51 offen offset:0 sc1 lds
    buffer_load_dwordx4 v1, s[4:7], s51 offen offset:1024 sc1 lds
    buffer_load_dwordx4 v2, s[4:7], s51 offen offset:2048 sc1 lds
    buffer_load_dwordx4 v2, s[4:7], s51 offen offset:3072 sc1 lds
    s_waitcnt vmcnt(12) lgkmcnt(0)
    s_barrier
    s_mov_b32 s48, 5
    s_mul_i32 s50, s48, 18432
    s_add_u32 s50, s50, s34
    s_cmp_ge_u32 s20, 2
    s_cselect_b32 s52, s50, s53
    s_add_u32 m0, s31, 0
    s_add_u32 s52, s52, s49
    buffer_load_dwordx4 v1, s[4:7], s52 offen  sc1 lds
    s_add_u32 m0, s30, 36864
    s_mov_b32 s53, s50
    buffer_load_dwordx4 v1, s[4:7], s50 offen offset:0  sc1 lds
    buffer_load_dwordx4 v1, s[4:7], s50 offen offset:1024  sc1 lds
    buffer_load_dwordx4 v1, s[4:7], s50 offen offset:2048  sc1 lds
    buffer_load_dwordx4 v1, s[4:7], s50 offen offset:3072  sc1 lds
    s_add_u32 m0, s30, 55296
    s_add_u32 s51, s35, 10240
    buffer_load_dwordx4 v1, s[4:7], s51 offen offset:0 sc1 lds
    buffer_load_dwordx4 v1, s[4:7], s51 offen offset:1024 sc1 lds
    buffer_load_dwordx4 v2, s[4:7], s51 offen offset:2048 sc1 lds
    buffer_load_dwordx4 v2, s[4:7], s51 offen offset:3072 sc1 lds
    s_waitcnt vmcnt(17) lgkmcnt(0)
    s_barrier
    s_mov_b32 s48, 6
    s_mul_i32 s50, s48, 18432
    s_add_u32 s50, s50, s34
    s_add_u32 m0, s30, 73728
    s_mov_b32 s53, s50
    buffer_load_dwordx4 v1, s[4:7], s50 offen offset:0  sc1 lds
    buffer_load_dwordx4 v1, s[4:7], s50 offen offset:1024  sc1 lds
    buffer_load_dwordx4 v1, s[4:7], s50 offen offset:2048  sc1 lds
    buffer_load_dwordx4 v1, s[4:7], s50 offen offset:3072  sc1 lds
    s_add_u32 m0, s30, 92160
    s_add_u32 s51, s35, 12288
    buffer_load_dwordx4 v1, s[4:7], s51 offen offset:0 sc1 lds
    buffer_load_dwordx4 v1, s[4:7], s51 offen offset:1024 sc1 lds
    buffer_load_dwordx4 v2, s[4:7], s51 offen offset:2048 sc1 lds
    buffer_load_dwordx4 v2, s[4:7], s51 offen offset:3072 sc1 lds
    s_waitcnt vmcnt(16) lgkmcnt(0)
    s_barrier
    s_mov_b32 s48, 7
    s_mul_i32 s50, s48, 18432
    s_add_u32 s50, s50, s34
    s_cmp_ge_u32 s20, 2
    s_cselect_b32 s52, s50, s53
    s_add_u32 m0, s31, 73728
    s_add_u32 s52, s52, s49
    buffer_load_dwordx4 v1, s[4:7], s52 offen  sc1 lds
    s_add_u32 m0, s30, 110592
    s_mov_b32 s53, s50
    buffer_load_dwordx4 v1, s[4:7], s50 offen offset:0  sc1 lds
    buffer_load_dwordx4 v1, s[4:7], s50 offen offset:1024  sc1 lds
    buffer_load_dwordx4 v1, s[4:7], s50 offen offset:2048  sc1 lds
    buffer_load_dwordx4 v1, s[4:7], s50 offen offset:3072  sc1 lds
    s_add_u32 m0, s30, 129024
    s_add_u32 s51, s35, 14336
    buffer_load_dwordx4 v1, s[4:7], s51 offen offset:0 sc1 lds
    buffer_load_dwordx4 v1, s[4:7], s51 offen offset:1024 sc1 lds
    buffer_load_dwordx4 v2, s[4:7], s51 offen offset:2048 sc1 lds
    buffer_load_dwordx4 v2, s[4:7], s51 offen offset:3072 sc1 lds
    s_waitcnt vmcnt(17) lgkmcnt(0)
    s_barrier
    s_mov_b32 s48, 8
    s_mul_i32 s50, s48, 18432
    s_add_u32 s50, s50, s34
    s_add_u32 m0, s30, 0
    s_mov_b32 s53, s50
    buffer_load_dwordx4 v1, s[4:7], s50 offen offset:0  sc1 lds
    buffer_load_dwordx4 v1, s[4:7], s50 offen offset:1024  sc1 lds
    buffer_load_dwordx4 v1, s[4:7], s50 offen offset:2048  sc1 lds
    buffer_load_dwordx4 v1, s[4:7], s50 offen offset:3072  sc1 lds
    s_add_u32 m0, s30, 18432
    s_add_u32 s51, s35, 16384
    buffer_load_dwordx4 v1, s[4:7], s51 offen offset:0 sc1 lds
    buffer_load_dwordx4 v1, s[4:7], s51 offen offset:1024 sc1 lds
    buffer_load_dwordx4 v2, s[4:7], s51 offen offset:2048 sc1 lds
    buffer_load_dwordx4 v2, s[4:7], s51 offen offset:3072 sc1 lds
    s_waitcnt vmcnt(16) lgkmcnt(0)
    s_barrier
    s_mov_b32 s48, 5
    s_mul_i32 s50, s48, 18432
    s_add_u32 s50, s50, s34
    s_add_u32 s50, s50, 165888
    s_cmp_ge_u32 s20, 2
    s_cselect_b32 s52, s50, s53
    s_add_u32 m0, s31, 0
    s_add_u32 s52, s52, s49
    buffer_load_dwordx4 v1, s[4:7], s52 offen  sc1 lds
    s_add_u32 m0, s30, 36864
    s_mov_b32 s53, s50
    buffer_load_dwordx4 v1, s[4:7], s50 offen offset:0  sc1 lds
    buffer_load_dwordx4 v1, s[4:7], s50 offen offset:1024  sc1 lds
    buffer_load_dwordx4 v1, s[4:7], s50 offen offset:2048  sc1 lds
    buffer_load_dwordx4 v1, s[4:7], s50 offen offset:3072  sc1 lds
    s_cmp_lg_u32 s22, 0
    s_cbranch_scc1 L_p5_k6
    s_add_u32 s32, s43, 294912
    buffer_load_dwordx4 v[220:223], v1, s[4:7], s32 offen offset:0 sc1
    buffer_load_dwordx4 v[224:227], v1, s[4:7], s32 offen offset:1024 sc1
    buffer_load_dwordx4 v[228:231], v1, s[4:7], s32 offen offset:2048 sc1
    buffer_load_dwordx4 v[232:235], v1, s[4:7], s32 offen offset:3072 sc1
    s_add_u32 s32, s43, 299008
    buffer_load_dwordx4 v[236:239], v1, s[4:7], s32 offen offset:0 sc1
L_p5_k6:
    s_waitcnt vmcnt(18) lgkmcnt(0)
    s_cmp_eq_u32 s22, 0
    s_cbranch_scc1 L_wv_926
    s_waitcnt vmcnt(13)
L_wv_926:
    s_barrier
    s_mov_b32 s48, 6
    s_mul_i32 s50, s48, 18432
    s_add_u32 s50, s50, s34
    s_add_u32 s50, s50, 165888
    s_add_u32 m0, s30, 73728
    s_mov_b32 s53, s50
    buffer_load_dwordx4 v1, s[4:7], s50 offen offset:0  sc1 lds
    buffer_load_dwordx4 v1, s[4:7], s50 offen offset:1024  sc1 lds
    buffer_load_dwordx4 v1, s[4:7], s50 offen offset:2048  sc1 lds
    buffer_load_dwordx4 v1, s[4:7], s50 offen offset:3072  sc1 lds
    s_cmp_lg_u32 s22, 0
    s_cbranch_scc1 L_p5_k7
    s_add_u32 s32, s43, 299008
    buffer_load_dwordx4 v[240:243], v1, s[4:7], s32 offen offset:1024 sc1
    buffer_load_dwordx4 v[244:247], v1, s[4:7], s32 offen offset:2048 sc1
    buffer_load_dwordx4 v[248:251], v1, s[4:7], s32 offen offset:3072 sc1
    s_add_u32 s32, s43, 303104
    buffer_load_dwordx4 v[252:255], v1, s[4:7], s32 offen offset:0 sc1
    s_add_u32 s32, s43, 258048
    buffer_load_dwordx4 v[184:187], v1, s[4:7], s32 offen offset:0 sc1
L_p5_k7:
    s_waitcnt vmcnt(18) lgkmcnt(0)
    s_cmp_eq_u32 s22, 0
    s_cbranch_scc1 L_wv_953
    s_waitcnt vmcnt(8)
L_wv_953:
    s_barrier
    s_mov_b32 s48, 7
    s_mul_i32 s50, s48, 18432
    s_add_u32 s50, s50, s34
    s_add_u32 s50, s50, 165888
    s_cmp_ge_u32 s20, 2
    s_cselect_b32 s52, s50, s53
    s_add_u32 m0, s31, 73728
    s_add_u32 s52, s52, s49
    buffer_load_dwordx4 v1, s[4:7], s52 offen  sc1 lds
    s_add_u32 m0, s30, 110592
    s_mov_b32 s53, s50
    buffer_load_dwordx4 v1, s[4:7], s50 offen offset:0  sc1 lds
    buffer_load_dwordx4 v1, s[4:7], s50 offen offset:1024  sc1 lds
    buffer_load_dwordx4 v1, s[4:7], s50 offen offset:2048  sc1 lds
    buffer_load_dwordx4 v1, s[4:7], s50 offen offset:3072  sc1 lds
    s_cmp_lg_u32 s22, 0
    s_cbranch_scc1 L_p5_k8
    s_add_u32 s32, s43, 258048
    buffer_load_dwordx4 v[188:191], v1, s[4:7], s32 offen offset:1024 sc1
    buffer_load_dwordx4 v[192:195], v1, s[4:7], s32 offen offset:2048 sc1
    buffer_load_dwordx4 v[196:199], v1, s[4:7], s32 offen offset:3072 sc1
    s_add_u32 s32, s43, 262144
    buffer_load_dwordx4 v[200:203], v1, s[4:7], s32 offen offset:0 sc1
    buffer_load_dwordx4 v[204:207], v1, s[4:7], s32 offen offset:1024 sc1
L_p5_k8:
    s_waitcnt vmcnt(24) lgkmcnt(0)
    s_cmp_eq_u32 s22, 0
    s_cbranch_scc1 L_wv_984
    s_waitcnt vmcnt(9)
L_wv_984:
    s_barrier
    s_mov_b32 s48, 8
    s_mul_i32 s50, s48, 18432
    s_add_u32 s50, s50, s34
    s_add_u32 s50, s50, 165888
    s_add_u32 m0, s30, 0
    s_mov_b32 s53, s50
    buffer_load_dwordx4 v1, s[4:7], s50 offen offset:0  sc1 lds
    buffer_load_dwordx4 v1, s[4:7], s50 offen offset:1024  sc1 lds
    buffer_load_dwordx4 v1, s[4:7], s50 offen offset:2048  sc1 lds
    buffer_load_dwordx4 v1, s[4:7], s50 offen offset:3072  sc1 lds
    s_cmp_lg_u32 s22, 0
    s_cbranch_scc1 L_p5_k9
    s_add_u32 s32, s43, 262144
    buffer_load_dwordx4 v[208:211], v1, s[4:7], s32 offen offset:2048 sc1
    buffer_load_dwordx4 v[212:215], v1, s[4:7], s32 offen offset:3072 sc1
    s_add_u32 s32, s43, 266240
    buffer_load_dwordx4 v[216:219], v1, s[4:7], s32 offen offset:0 sc1
    s_add_u32 s32, s43, 221184
    buffer_load_dwordx4 v[148:151], v1, s[4:7], s32 offen offset:0 sc1
    buffer_load_dwordx4 v[152:155], v1, s[4:7], s32 offen offset:1024 sc1
    buffer_load_dwordx4 v[156:159], v1, s[4:7], s32 offen offset:2048 sc1
    buffer_load_dwordx4 v[160:163], v1, s[4:7], s32 offen offset:3072 sc1
    s_add_u32 s32, s43, 225280
    buffer_load_dwordx4 v[164:167], v1, s[4:7], s32 offen offset:0 sc1
    buffer_load_dwordx4 v[168:171], v1, s[4:7], s32 offen offset:1024 sc1
    buffer_load_dwordx4 v[172:175], v1, s[4:7], s32 offen offset:2048 sc1
    buffer_load_dwordx4 v[176:179], v1, s[4:7], s32 offen offset:3072 sc1
    s_add_u32 s32, s43, 229376
    buffer_load_dwordx4 v[180:183], v1, s[4:7], s32 offen offset:0 sc1
    s_add_u32 s32, s43, 184320
    buffer_load_dwordx4 v[112:115], v1, s[4:7], s32 offen offset:0 sc1
    buffer_load_dwordx4 v[116:119], v1, s[4:7], s32 offen offset:1024 sc1
    buffer_load_dwordx4 v[120:123], v1, s[4:7], s32 offen offset:2048 sc1
    buffer_load_dwordx4 v[124:127], v1, s[4:7], s32 offen offset:3072 sc1
    s_add_u32 s32, s43, 188416
    buffer_load_dwordx4 v[128:131], v1, s[4:7], s32 offen offset:0 sc1
    buffer_load_dwordx4 v[132:135], v1, s[4:7], s32 offen offset:1024 sc1
    buffer_load_dwordx4 v[136:139], v1, s[4:7], s32 offen offset:2048 sc1
    buffer_load_dwordx4 v[140:143], v1, s[4:7], s32 offen offset:3072 sc1
    s_add_u32 s32, s43, 192512
    buffer_load_dwordx4 v[144:147], v1, s[4:7], s32 offen offset:0 sc1
    s_add_u32 s32, s43, 147456
    buffer_load_dwordx4 v[76:79], v1, s[4:7], s32 offen offset:0 sc1
    buffer_load_dwordx4 v[80:83], v1, s[4:7], s32 offen offset:1024 sc1
    buffer_load_dwordx4 v[84:87], v1, s[4:7], s32 offen offset:2048 sc1
    buffer_load_dwordx4 v[88:91], v1, s[4:7], s32 offen offset:3072 sc1
    s_add_u32 s32, s43, 151552
    buffer_load_dwordx4 v[92:95], v1, s[4:7], s32 offen offset:0 sc1
    buffer_load_dwordx4 v[96:99], v1, s[4:7], s32 offen offset:1024 sc1
    buffer_load_dwordx4 v[100:103], v1, s[4:7], s32 offen offset:2048 sc1
    buffer_load_dwordx4 v[104:107], v1, s[4:7], s32 offen offset:3072 sc1
    s_add_u32 s32, s43, 155648
    buffer_load_dwordx4 v[108:111], v1, s[4:7], s32 offen offset:0 sc1
L_p5_k9:
    s_waitcnt vmcnt(43) lgkmcnt(0)
    s_cmp_eq_u32 s22, 0
    s_cbranch_scc1 L_wv_1044
    s_waitcnt vmcnt(8)
L_wv_1044:
    s_barrier
    s_mov_b32 s48, 0
    s_mul_i32 s50, s48, 18432
    s_add_u32 s50, s50, s34
    s_add_u32 s50, s50, 165888
    s_cmp_ge_u32 s20, 2
    s_cselect_b32 s52, s50, s53
    s_add_u32 m0, s31, 0
    s_add_u32 s52, s52, s49
    buffer_load_dwordx4 v1, s[4:7], s52 offen  sc1 lds
    s_add_u32 m0, s30, 36864
    s_mov_b32 s53, s50
    buffer_load_dwordx4 v1, s[4:7], s50 offen offset:0  sc1 lds
    buffer_load_dwordx4 v1, s[4:7], s50 offen offset:1024  sc1 lds
    buffer_load_dwordx4 v1, s[4:7], s50 offen offset:2048  sc1 lds
    buffer_load_dwordx4 v1, s[4:7], s50 offen offset:3072  sc1 lds
    s_add_u32 m0, s30, 55296
    s_add_u32 s51, s35, 0
    buffer_load_dwordx4 v1, s[4:7], s51 offen offset:0 sc1 lds
    buffer_load_dwordx4 v1, s[4:7], s51 offen offset:1024 sc1 lds
    buffer_load_dwordx4 v2, s[4:7], s51 offen offset:2048 sc1 lds
    buffer_load_dwordx4 v2, s[4:7], s51 offen offset:3072 sc1 lds
    s_waitcnt vmcnt(48) lgkmcnt(0)
    s_cmp_eq_u32 s22, 0
    s_cbranch_scc1 L_wv_1071
    s_waitcnt vmcnt(13)
L_wv_1071:
    s_barrier
    buffer_load_dwordx4 v[16:19], v3, s[4:7], s29 offen offset:0 sc1
    buffer_load_dwordx4 v[20:23], v3, s[4:7], s29 offen offset:1024 sc1
    buffer_load_dwordx4 v[24:27], v3, s[4:7], s29 offen offset:2048 sc1
    buffer_load_dwordx4 v[28:31], v3, s[4:7], s29 offen offset:3072 sc1
    s_mov_b32 s48, 1
    s_mul_i32 s50, s48, 18432
    s_add_u32 s50, s50, s34
    s_add_u32 s50, s50, 165888
    s_add_u32 m0, s30, 73728
    s_mov_b32 s53, s50
    buffer_load_dwordx4 v1, s[4:7], s50 offen offset:0  sc1 lds
    buffer_load_dwordx4 v1, s[4:7], s50 offen offset:1024  sc1 lds
    buffer_load_dwordx4 v1, s[4:7], s50 offen offset:2048  sc1 lds
    buffer_load_dwordx4 v1, s[4:7], s50 offen offset:3072  sc1 lds
    s_add_u32 m0, s30, 92160
    s_add_u32 s51, s35, 2048
    buffer_load_dwordx4 v1, s[4:7], s51 offen offset:0 sc1 lds
    buffer_load_dwordx4 v1, s[4:7], s51 offen offset:1024 sc1 lds
    buffer_load_dwordx4 v2, s[4:7], s51 offen offset:2048 sc1 lds
    buffer_load_dwordx4 v2, s[4:7], s51 offen offset:3072 sc1 lds
    s_waitcnt vmcnt(20) lgkmcnt(0)
    s_barrier
    s_mov_b32 s48, 2
    s_mul_i32 s50, s48, 18432
    s_add_u32 s50, s50, s34
    s_add_u32 s50, s50, 165888
    s_cmp_ge_u32 s20, 2
    s_cselect_b32 s52, s50, s53
    s_add_u32 m0, s31, 73728
    s_add_u32 s52, s52, s49
    buffer_load_dwordx4 v1, s[4:7], s52 offen  sc1 lds
    s_add_u32 m0, s30, 110592
    s_mov_b32 s53, s50
    buffer_load_dwordx4 v1, s[4:7], s50 offen offset:0  sc1 lds
    buffer_load_dwordx4 v1, s[4:7], s50 offen offset:1024  sc1 lds
    buffer_load_dwordx4 v1, s[4:7], s50 offen offset:2048  sc1 lds
    buffer_load_dwordx4 v1, s[4:7], s50 offen offset:3072  sc1 lds
    s_add_u32 m0, s30, 129024
    s_add_u32 s51, s35, 4096
    buffer_load_dwordx4 v1, s[4:7], s51 offen offset:0 sc1 lds
    buffer_load_dwordx4 v1, s[4:7], s51 offen offset:1024 sc1 lds
    buffer_load_dwordx4 v2, s[4:7], s51 offen offset:2048 sc1 lds
    buffer_load_dwordx4 v2, s[4:7], s51 offen offset:3072 sc1 lds
    s_setprio 2
    s_mov_b32 s60, 65536
    s_waitcnt vmcnt(17)
L_g_chk:
    v_or3_b32 v32, v17, v19, v21
    v_or3_b32 v33, v23, v25, v27
    v_or3_b32 v32, v29, v31, v32
    v_or_b32 v32, v32, v33
    v_cmp_gt_i32 vcc, 0, v32
    s_sub_u32 s60, s60, 1
    s_cbranch_scc1 L_g_ok
    s_cbranch_vccz L_g_ok
    buffer_load_dwordx4 v[16:19], v3, s[4:7], s29 offen offset:0 sc1
    buffer_load_dwordx4 v[20:23], v3, s[4:7], s29 offen offset:1024 sc1
    buffer_load_dwordx4 v[24:27], v3, s[4:7], s29 offen offset:2048 sc1
    buffer_load_dwordx4 v[28:31], v3, s[4:7], s29 offen offset:3072 sc1
    s_waitcnt vmcnt(0)
    s_branch L_g_chk
L_g_ok:
    v_add_f32 v16, v16, v20
    v_add_f32 v24, v24, v28
    v_add_f32 v17, v17, v21
    v_add_f32 v25, v25, v29
    v_add_f32 v18, v18, v22
    v_add_f32 v26, v26, v30
    v_add_f32 v19, v19, v23
    v_add_f32 v27, v27, v31
    v_add_f32 v16, v16, v24
    v_add_f32 v17, v17, v25
    v_add_f32 v18, v18, v26
    v_add_f32 v19, v19, v27
    v_add_f32_dpp v16, v16, v16 row_ror:4 row_mask:0xf bank_mask:0xf
    v_add_f32_dpp v17, v17, v17 row_ror:4 row_mask:0xf bank_mask:0xf
    v_add_f32_dpp v18, v18, v18 row_ror:4 row_mask:0xf bank_mask:0xf
    v_add_f32_dpp v19, v19, v19 row_ror:4 row_mask:0xf bank_mask:0xf
    v_add_f32_dpp v16, v16, v16 row_ror:8 row_mask:0xf bank_mask:0xf
    v_add_f32_dpp v17, v17, v17 row_ror:8 row_mask:0xf bank_mask:0xf
    v_add_f32_dpp v18, v18, v18 row_ror:8 row_mask:0xf bank_mask:0xf
    v_add_f32_dpp v19, v19, v19 row_ror:8 row_mask:0xf bank_mask:0xf
    v_mul_f32 v16, 0x39e38e39, v16
    v_mul_f32 v17, 0x39e38e39, v17
    v_mul_f32 v18, 0x39e38e39, v18
    v_mul_f32 v19, 0x39e38e39, v19
    v_fma_f32 v17, -v16, v16, v17
    v_fma_f32 v19, -v18, v18, v19
    v_max_f32 v17, 0, v17
    v_max_f32 v19, 0, v19
    v_add_f32 v17, 0x3727c5ac, v17
    v_add_f32 v19, 0x3727c5ac, v19
    v_rsq_f32 v20, v17
    v_rsq_f32 v21, v19
    v_and_b32 v32, 0xff, v3
    s_lshl_b32 s33, s20, 8
    s_add_u32 s33, s33, 148480
    v_add_u32 v32, s33, v32
    v_mul_f32 v22, v16, v20
    v_mul_f32 v23, v18, v21
    ds_write_b128 v32, v[20:23]
    s_setprio 0
    s_waitcnt vmcnt(17) lgkmcnt(0)
    s_barrier
    s_mov_b32 s48, 3
    s_mul_i32 s50, s48, 18432
    s_add_u32 s50, s50, s34
    s_add_u32 s50, s50, 165888
    s_add_u32 m0, s30, 0
    s_mov_b32 s53, s50
    buffer_load_dwordx4 v1, s[4:7], s50 offen offset:0  sc1 lds
    buffer_load_dwordx4 v1, s[4:7], s50 offen offset:1024  sc1 lds
    buffer_load_dwordx4 v1, s[4:7], s50 offen offset:2048  sc1 lds
    buffer_load_dwordx4 v1, s[4:7], s50 offen offset:3072  sc1 lds
    s_add_u32 m0, s30, 18432
    s_add_u32 s51, s35, 6144
    buffer_load_dwordx4 v1, s[4:7], s51 offen offset:0 sc1 lds
    buffer_load_dwordx4 v1, s[4:7], s51 offen offset:1024 sc1 lds
    buffer_load_dwordx4 v2, s[4:7], s51 offen offset:2048 sc1 lds
    buffer_load_dwordx4 v2, s[4:7], s51 offen offset:3072 sc1 lds
    s_waitcnt vmcnt(16) lgkmcnt(0)
    s_barrier
    s_mov_b32 s48, 4
    s_mul_i32 s50, s48, 18432
    s_add_u32 s50, s50, s34
    s_add_u32 s50, s50, 165888
    s_cmp_ge_u32 s20, 2
    s_cselect_b32 s52, s50, s53
    s_add_u32 m0, s31, 0
    s_add_u32 s52, s52, s49
    buffer_load_dwordx4 v1, s[4:7], s52 offen  sc1 lds
    s_add_u32 m0, s30, 36864
    s_mov_b32 s53, s50
    buffer_load_dwordx4 v1, s[4:7], s50 offen offset:0  sc1 lds
    buffer_load_dwordx4 v1, s[4:7], s50 offen offset:1024  sc1 lds
    buffer_load_dwordx4 v1, s[4:7], s50 offen offset:2048  sc1 lds
    buffer_load_dwordx4 v1, s[4:7], s50 offen offset:3072  sc1 lds
    s_add_u32 m0, s30, 55296
    s_add_u32 s51, s35, 8192
    buffer_load_dwordx4 v1, s[4:7], s51 offen offset:0 sc1 lds
    buffer_load_dwordx4 v1, s[4:7], s51 offen offset:1024 sc1 lds
    buffer_load_dwordx4 v2, s[4:7], s51 offen offset:2048 sc1 lds
    buffer_load_dwordx4 v2, s[4:7], s51 offen offset:3072 sc1 lds
    s_waitcnt vmcnt(17) lgkmcnt(0)
    s_barrier
    s_waitcnt vmcnt(8) lgkmcnt(0)
    s_barrier
    s_waitcnt vmcnt(0) lgkmcnt(0)
    s_barrier
    s_barrier
    s_mov_b32 s56, 1
    s_atomic_add s56, s[54:55], 0
    s_mov_b32 s57, 0
    s_atomic_add s57, s[54:55], 0 glc
    s_lshl_b32 s48, s23, 1
    s_add_u32 s48, s48, 0
    s_add_u32 m0, s30, 92160
    s_lshl_b32 s51, s48, 7
    buffer_load_dwordx4 v8, s[8:11], s51 offen offset:0  lds
    buffer_load_dwordx4 v9, s[8:11], s51 offen offset:1024  lds
    buffer_load_dwordx4 v10, s[8:11], s51 offen offset:2048  lds
    buffer_load_dwordx4 v11, s[8:11], s51 offen offset:3072  lds
    s_lshl_b32 s48, s23, 1
    s_add_u32 s48, s48, 1
    s_add_u32 m0, s30, 129024
    s_lshl_b32 s51, s48, 7
    buffer_load_dwordx4 v8, s[8:11], s51 offen offset:0  lds
    buffer_load_dwordx4 v9, s[8:11], s51 offen offset:1024  lds
    buffer_load_dwordx4 v10, s[8:11], s51 offen offset:2048  lds
    buffer_load_dwordx4 v11, s[8:11], s51 offen offset:3072  lds
    s_lshr_b32 s48, s46, 1
    s_cmp_eq_u32 s48, s23
    s_cselect_b32 s48, 1, 31
    s_and_b32 s48, s48, s46
    s_add_u32 m0, s30, 18432
    s_lshl_b32 s51, s48, 7
    buffer_load_dwordx4 v8, s[8:11], s51 offen offset:0  lds
    buffer_load_dwordx4 v9, s[8:11], s51 offen offset:1024  lds
    buffer_load_dwordx4 v10, s[8:11], s51 offen offset:2048  lds
    buffer_load_dwordx4 v11, s[8:11], s51 offen offset:3072  lds
    s_waitcnt lgkmcnt(0)
    s_cmp_ge_u32 s57, 16
    s_cbranch_scc1 L_g_r0
    s_mov_b32 s57, 0
    s_atomic_add s57, s[54:55], 0 glc
    s_waitcnt vmcnt(8)
    s_barrier
    s_waitcnt lgkmcnt(0)
    s_cmp_ge_u32 s57, 16
    s_cbranch_scc1 L_g_r1
    s_waitcnt vmcnt(4)
    s_barrier
    s_mov_b32 s60, 65536
L_poll_z2:
    s_mov_b32 s57, 0
    s_atomic_add s57, s[54:55], 0 glc
    s_waitcnt lgkmcnt(0)
    s_cmp_ge_u32 s57, 16
    s_cbranch_scc1 L_pd_z2
    s_sub_u32 s60, s60, 1
    s_cbranch_scc1 L_pd_z2
    s_sleep 2
    s_branch L_poll_z2
L_pd_z2:
    s_lshr_b32 s48, s46, 1
    s_cmp_eq_u32 s48, s23
    s_cselect_b32 s48, 1, 31
    s_and_b32 s48, s48, s46
    s_mul_i32 s50, s48, 18432
    s_add_u32 s50, s50, s36
    s_add_u32 m0, s30, 0
    s_mov_b32 s53, s50
    buffer_load_dwordx4 v1, s[4:7], s50 offen offset:0 sc1 lds
    buffer_load_dwordx4 v1, s[4:7], s50 offen offset:1024 sc1 lds
    buffer_load_dwordx4 v1, s[4:7], s50 offen offset:2048 sc1 lds
    buffer_load_dwordx4 v1, s[4:7], s50 offen offset:3072 sc1 lds
    s_lshr_b32 s48, s47, 1
    s_cmp_eq_u32 s48, s23
    s_cselect_b32 s48, 1, 31
    s_and_b32 s48, s48, s47
    s_mul_i32 s50, s48, 18432
    s_add_u32 s50, s50, s36
    s_cmp_ge_u32 s20, 2
    s_cselect_b32 s52, s50, s53
    s_add_u32 m0, s31, 0
    s_add_u32 s52, s52, s49
    buffer_load_dwordx4 v1, s[4:7], s52 offen sc1 lds
    s_add_u32 m0, s30, 36864
    s_mov_b32 s53, s50
    buffer_load_dwordx4 v1, s[4:7], s50 offen offset:0 sc1 lds
    buffer_load_dwordx4 v1, s[4:7], s50 offen offset:1024 sc1 lds
    buffer_load_dwordx4 v1, s[4:7], s50 offen offset:2048 sc1 lds
    buffer_load_dwordx4 v1, s[4:7], s50 offen offset:3072 sc1 lds
    s_lshr_b32 s48, s47, 1
    s_cmp_eq_u32 s48, s23
    s_cselect_b32 s48, 1, 31
    s_and_b32 s48, s48, s47
    s_add_u32 m0, s30, 55296
    s_lshl_b32 s51, s48, 7
    buffer_load_dwordx4 v8, s[8:11], s51 offen offset:0  lds
    buffer_load_dwordx4 v9, s[8:11], s51 offen offset:1024  lds
    buffer_load_dwordx4 v10, s[8:11], s51 offen offset:2048  lds
    buffer_load_dwordx4 v11, s[8:11], s51 offen offset:3072  lds
    s_branch L_g_jn
L_g_r0:
    s_lshr_b32 s48, s46, 1
    s_cmp_eq_u32 s48, s23
    s_cselect_b32 s48, 1, 31
    s_and_b32 s48, s48, s46
    s_mul_i32 s50, s48, 18432
    s_add_u32 s50, s50, s36
    s_add_u32 m0, s30, 0
    s_mov_b32 s53, s50
    buffer_load_dwordx4 v1, s[4:7], s50 offen offset:0 sc1 lds
    buffer_load_dwordx4 v1, s[4:7], s50 offen offset:1024 sc1 lds
    buffer_load_dwordx4 v1, s[4:7], s50 offen offset:2048 sc1 lds
    buffer_load_dwordx4 v1, s[4:7], s50 offen offset:3072 sc1 lds
    s_lshr_b32 s48, s47, 1
    s_cmp_eq_u32 s48, s23
    s_cselect_b32 s48, 1, 31
    s_and_b32 s48, s48, s47
    s_mul_i32 s50, s48, 18432
    s_add_u32 s50, s50, s36
    s_cmp_ge_u32 s20, 2
    s_cselect_b32 s52, s50, s53
    s_add_u32 m0, s31, 0
    s_add_u32 s52, s52, s49
    buffer_load_dwordx4 v1, s[4:7], s52 offen sc1 lds
    s_add_u32 m0, s30, 36864
    s_mov_b32 s53, s50
    buffer_load_dwordx4 v1, s[4:7], s50 offen offset:0 sc1 lds
    buffer_load_dwordx4 v1, s[4:7], s50 offen offset:1024 sc1 lds
    buffer_load_dwordx4 v1, s[4:7], s50 offen offset:2048 sc1 lds
    buffer_load_dwordx4 v1, s[4:7], s50 offen offset:3072 sc1 lds
    s_lshr_b32 s48, s47, 1
    s_cmp_eq_u32 s48, s23
    s_cselect_b32 s48, 1, 31
    s_and_b32 s48, s48, s47
    s_add_u32 m0, s30, 55296
    s_lshl_b32 s51, s48, 7
    buffer_load_dwordx4 v8, s[8:11], s51 offen offset:0  lds
    buffer_load_dwordx4 v9, s[8:11], s51 offen offset:1024  lds
    buffer_load_dwordx4 v10, s[8:11], s51 offen offset:2048  lds
    buffer_load_dwordx4 v11, s[8:11], s51 offen offset:3072  lds
    s_waitcnt vmcnt(21)
    s_barrier
    s_waitcnt vmcnt(17)
    s_barrier
    s_branch L_g_jn
L_g_r1:
    s_lshr_b32 s48, s46, 1
    s_cmp_eq_u32 s48, s23
    s_cselect_b32 s48, 1, 31
    s_and_b32 s48, s48, s46
    s_mul_i32 s50, s48, 18432
    s_add_u32 s50, s50, s36
    s_add_u32 m0, s30, 0
    s_mov_b32 s53, s50
    buffer_load_dwordx4 v1, s[4:7], s50 offen offset:0 sc1 lds
    buffer_load_dwordx4 v1, s[4:7], s50 offen offset:1024 sc1 lds
    buffer_load_dwordx4 v1, s[4:7], s50 offen offset:2048 sc1 lds
    buffer_load_dwordx4 v1, s[4:7], s50 offen offset:3072 sc1 lds
    s_lshr_b32 s48, s47, 1
    s_cmp_eq_u32 s48, s23
    s_cselect_b32 s48, 1, 31
    s_and_b32 s48, s48, s47
    s_mul_i32 s50, s48, 18432
    s_add_u32 s50, s50, s36
    s_cmp_ge_u32 s20, 2
    s_cselect_b32 s52, s50, s53
    s_add_u32 m0, s31, 0
    s_add_u32 s52, s52, s49
    buffer_load_dwordx4 v1, s[4:7], s52 offen sc1 lds
    s_add_u32 m0, s30, 36864
    s_mov_b32 s53, s50
    buffer_load_dwordx4 v1, s[4:7], s50 offen offset:0 sc1 lds
    buffer_load_dwordx4 v1, s[4:7], s50 offen offset:1024 sc1 lds
    buffer_load_dwordx4 v1, s[4:7], s50 offen offset:2048 sc1 lds
    buffer_load_dwordx4 v1, s[4:7], s50 offen offset:3072 sc1 lds
    s_lshr_b32 s48, s47, 1
    s_cmp_eq_u32 s48, s23
    s_cselect_b32 s48, 1, 31
    s_and_b32 s48, s48, s47
    s_add_u32 m0, s30, 55296
    s_lshl_b32 s51, s48, 7
    buffer_load_dwordx4 v8, s[8:11], s51 offen offset:0  lds
    buffer_load_dwordx4 v9, s[8:11], s51 offen offset:1024  lds
    buffer_load_dwordx4 v10, s[8:11], s51 offen offset:2048  lds
    buffer_load_dwordx4 v11, s[8:11], s51 offen offset:3072  lds
    s_waitcnt vmcnt(17)
    s_barrier
L_g_jn:
    s_add_u32 s44, s44, 4
    s_cmp_ge_u32 s44, 32
    s_cselect_b32 s44, 4, s44
    s_add_u32 s45, s45, 4
    s_cmp_ge_u32 s45, 32
    s_cselect_b32 s45, 5, s45
    s_add_u32 s46, s46, 4
    s_and_b32 s46, s46, 31
    s_add_u32 s47, s47, 4
    s_and_b32 s47, s47, 31
    s_lshr_b32 s48, s44, 1
    s_cmp_eq_u32 s48, s23
    s_cselect_b32 s48, 1, 31
    s_and_b32 s48, s48, s44
    s_mul_i32 s50, s48, 18432
    s_add_u32 s50, s50, s36
    s_add_u32 m0, s30, 73728
    s_mov_b32 s53, s50
    buffer_load_dwordx4 v1, s[4:7], s50 offen offset:0 sc1 lds
    buffer_load_dwordx4 v1, s[4:7], s50 offen offset:1024 sc1 lds
    buffer_load_dwordx4 v1, s[4:7], s50 offen offset:2048 sc1 lds
    buffer_load_dwordx4 v1, s[4:7], s50 offen offset:3072 sc1 lds
    s_lshr_b32 s48, s44, 1
    s_cmp_eq_u32 s48, s23
    s_cselect_b32 s48, 1, 31
    s_and_b32 s48, s48, s44
    s_add_u32 m0, s30, 92160
    s_lshl_b32 s51, s48, 7
    buffer_load_dwordx4 v8, s[8:11], s51 offen offset:0  lds
    buffer_load_dwordx4 v9, s[8:11], s51 offen offset:1024  lds
    buffer_load_dwordx4 v10, s[8:11], s51 offen offset:2048  lds
    buffer_load_dwordx4 v11, s[8:11], s51 offen offset:3072  lds
    s_add_u32 s44, s44, 4
    s_cmp_ge_u32 s44, 32
    s_cselect_b32 s44, 4, s44
    s_waitcnt vmcnt(16)
    s_barrier
    s_lshr_b32 s48, s45, 1
    s_cmp_eq_u32 s48, s23
    s_cselect_b32 s48, 1, 31
    s_and_b32 s48, s48, s45
    s_mul_i32 s50, s48, 18432
    s_add_u32 s50, s50, s36
    s_cmp_ge_u32 s20, 2
    s_cselect_b32 s52, s50, s53
    s_add_u32 m0, s31, 73728
    s_add_u32 s52, s52, s49
    buffer_load_dwordx4 v1, s[4:7], s52 offen sc1 lds
    s_add_u32 m0, s30, 110592
    s_mov_b32 s53, s50
    buffer_load_dwordx4 v1, s[4:7], s50 offen offset:0 sc1 lds
    buffer_load_dwordx4 v1, s[4:7], s50 offen offset:1024 sc1 lds
    buffer_load_dwordx4 v1, s[4:7], s50 offen offset:2048 sc1 lds
    buffer_load_dwordx4 v1, s[4:7], s50 offen offset:3072 sc1 lds
    s_lshr_b32 s48, s45, 1
    s_cmp_eq_u32 s48, s23
    s_cselect_b32 s48, 1, 31
    s_and_b32 s48, s48, s45
    s_add_u32 m0, s30, 129024
    s_lshl_b32 s51, s48, 7
    buffer_load_dwordx4 v8, s[8:11], s51 offen offset:0  lds
    buffer_load_dwordx4 v9, s[8:11], s51 offen offset:1024  lds
    buffer_load_dwordx4 v10, s[8:11], s51 offen offset:2048  lds
    buffer_load_dwordx4 v11, s[8:11], s51 offen offset:3072  lds
    s_add_u32 s45, s45, 4
    s_cmp_ge_u32 s45, 32
    s_cselect_b32 s45, 5, s45
    s_waitcnt vmcnt(17)
    s_barrier
    s_lshr_b32 s48, s46, 1
    s_cmp_eq_u32 s48, s23
    s_cselect_b32 s48, 1, 31
    s_and_b32 s48, s48, s46
    s_mul_i32 s50, s48, 18432
    s_add_u32 s50, s50, s36
    s_add_u32 m0, s30, 0
    s_mov_b32 s53, s50
    buffer_load_dwordx4 v1, s[4:7], s50 offen offset:0 sc1 lds
    buffer_load_dwordx4 v1, s[4:7], s50 offen offset:1024 sc1 lds
    buffer_load_dwordx4 v1, s[4:7], s50 offen offset:2048 sc1 lds
    buffer_load_dwordx4 v1, s[4:7], s50 offen offset:3072 sc1 lds
    s_lshr_b32 s48, s46, 1
    s_cmp_eq_u32 s48, s23
    s_cselect_b32 s48, 1, 31
    s_and_b32 s48, s48, s46
    s_add_u32 m0, s30, 18432
    s_lshl_b32 s51, s48, 7
    buffer_load_dwordx4 v8, s[8:11], s51 offen offset:0  lds
    buffer_load_dwordx4 v9, s[8:11], s51 offen offset:1024  lds
    buffer_load_dwordx4 v10, s[8:11], s51 offen offset:2048  lds
    buffer_load_dwordx4 v11, s[8:11], s51 offen offset:3072  lds
    s_add_u32 s46, s46, 4
    s_and_b32 s46, s46, 31
    s_waitcnt vmcnt(16)
    s_barrier
    s_lshr_b32 s48, s47, 1
    s_cmp_eq_u32 s48, s23
    s_cselect_b32 s48, 1, 31
    s_and_b32 s48, s48, s47
    s_mul_i32 s50, s48, 18432
    s_add_u32 s50, s50, s36
    s_cmp_ge_u32 s20, 2
    s_cselect_b32 s52, s50, s53
    s_add_u32 m0, s31, 0
    s_add_u32 s52, s52, s49
    buffer_load_dwordx4 v1, s[4:7], s52 offen sc1 lds
    s_add_u32 m0, s30, 36864
    s_mov_b32 s53, s50
    buffer_load_dwordx4 v1, s[4:7], s50 offen offset:0 sc1 lds
    buffer_load_dwordx4 v1, s[4:7], s50 offen offset:1024 sc1 lds
    buffer_load_dwordx4 v1, s[4:7], s50 offen offset:2048 sc1 lds
    buffer_load_dwordx4 v1, s[4:7], s50 offen offset:3072 sc1 lds
    s_lshr_b32 s48, s47, 1
    s_cmp_eq_u32 s48, s23
    s_cselect_b32 s48, 1, 31
    s_and_b32 s48, s48, s47
    s_add_u32 m0, s30, 55296
    s_lshl_b32 s51, s48, 7
    buffer_load_dwordx4 v8, s[8:11], s51 offen offset:0  lds
    buffer_load_dwordx4 v9, s[8:11], s51 offen offset:1024  lds
    buffer_load_dwordx4 v10, s[8:11], s51 offen offset:2048  lds
    buffer_load_dwordx4 v11, s[8:11], s51 offen offset:3072  lds
    s_add_u32 s47, s47, 4
    s_and_b32 s47, s47, 31
    s_mov_b32 s41, 6
L_g_ll:
    s_waitcnt vmcnt(17)
    s_barrier
    s_lshr_b32 s48, s44, 1
    s_cmp_eq_u32 s48, s23
    s_cselect_b32 s48, 1, 31
    s_and_b32 s48, s48, s44
    s_mul_i32 s50, s48, 18432
    s_add_u32 s50, s50, s36
    s_add_u32 m0, s30, 73728
    s_mov_b32 s53, s50
    buffer_load_dwordx4 v1, s[4:7], s50 offen offset:0 sc1 lds
    buffer_load_dwordx4 v1, s[4:7], s50 offen offset:1024 sc1 lds
    buffer_load_dwordx4 v1, s[4:7], s50 offen offset:2048 sc1 lds
    buffer_load_dwordx4 v1, s[4:7], s50 offen offset:3072 sc1 lds
    s_lshr_b32 s48, s44, 1
    s_cmp_eq_u32 s48, s23
    s_cselect_b32 s48, 1, 31
    s_and_b32 s48, s48, s44
    s_add_u32 m0, s30, 92160
    s_lshl_b32 s51, s48, 7
    buffer_load_dwordx4 v8, s[8:11], s51 offen offset:0  lds
    buffer_load_dwordx4 v9, s[8:11], s51 offen offset:1024  lds
    buffer_load_dwordx4 v10, s[8:11], s51 offen offset:2048  lds
    buffer_load_dwordx4 v11, s[8:11], s51 offen offset:3072  lds
    s_add_u32 s44, s44, 4
    s_cmp_ge_u32 s44, 32
    s_cselect_b32 s44, 4, s44
    s_waitcnt vmcnt(16)
    s_barrier
    s_lshr_b32 s48, s45, 1
    s_cmp_eq_u32 s48, s23
    s_cselect_b32 s48, 1, 31
    s_and_b32 s48, s48, s45
    s_mul_i32 s50, s48, 18432
    s_add_u32 s50, s50, s36
    s_cmp_ge_u32 s20, 2
    s_cselect_b32 s52, s50, s53
    s_add_u32 m0, s31, 73728
    s_add_u32 s52, s52, s49
    buffer_load_dwordx4 v1, s[4:7], s52 offen sc1 lds
    s_add_u32 m0, s30, 110592
    s_mov_b32 s53, s50
    buffer_load_dwordx4 v1, s[4:7], s50 offen offset:0 sc1 lds
    buffer_load_dwordx4 v1, s[4:7], s50 offen offset:1024 sc1 lds
    buffer_load_dwordx4 v1, s[4:7], s50 offen offset:2048 sc1 lds
    buffer_load_dwordx4 v1, s[4:7], s50 offen offset:3072 sc1 lds
    s_lshr_b32 s48, s45, 1
    s_cmp_eq_u32 s48, s23
    s_cselect_b32 s48, 1, 31
    s_and_b32 s48, s48, s45
    s_add_u32 m0, s30, 129024
    s_lshl_b32 s51, s48, 7
    buffer_load_dwordx4 v8, s[8:11], s51 offen offset:0  lds
    buffer_load_dwordx4 v9, s[8:11], s51 offen offset:1024  lds
    buffer_load_dwordx4 v10, s[8:11], s51 offen offset:2048  lds
    buffer_load_dwordx4 v11, s[8:11], s51 offen offset:3072  lds
    s_add_u32 s45, s45, 4
    s_cmp_ge_u32 s45, 32
    s_cselect_b32 s45, 5, s45
    s_waitcnt vmcnt(17)
    s_barrier
    s_lshr_b32 s48, s46, 1
    s_cmp_eq_u32 s48, s23
    s_cselect_b32 s48, 1, 31
    s_and_b32 s48, s48, s46
    s_mul_i32 s50, s48, 18432
    s_add_u32 s50, s50, s36
    s_add_u32 m0, s30, 0
    s_mov_b32 s53, s50
    buffer_load_dwordx4 v1, s[4:7], s50 offen offset:0 sc1 lds
    buffer_load_dwordx4 v1, s[4:7], s50 offen offset:1024 sc1 lds
    buffer_load_dwordx4 v1, s[4:7], s50 offen offset:2048 sc1 lds
    buffer_load_dwordx4 v1, s[4:7], s50 offen offset:3072 sc1 lds
    s_lshr_b32 s48, s46, 1
    s_cmp_eq_u32 s48, s23
    s_cselect_b32 s48, 1, 31
    s_and_b32 s48, s48, s46
    s_add_u32 m0, s30, 18432
    s_lshl_b32 s51, s48, 7
    buffer_load_dwordx4 v8, s[8:11], s51 offen offset:0  lds
    buffer_load_dwordx4 v9, s[8:11], s51 offen offset:1024  lds
    buffer_load_dwordx4 v10, s[8:11], s51 offen offset:2048  lds
    buffer_load_dwordx4 v11, s[8:11], s51 offen offset:3072  lds
    s_add_u32 s46, s46, 4
    s_and_b32 s46, s46, 31
    s_waitcnt vmcnt(16)
    s_barrier
    s_lshr_b32 s48, s47, 1
    s_cmp_eq_u32 s48, s23
    s_cselect_b32 s48, 1, 31
    s_and_b32 s48, s48, s47
    s_mul_i32 s50, s48, 18432
    s_add_u32 s50, s50, s36
    s_cmp_ge_u32 s20, 2
    s_cselect_b32 s52, s50, s53
    s_add_u32 m0, s31, 0
    s_add_u32 s52, s52, s49
    buffer_load_dwordx4 v1, s[4:7], s52 offen sc1 lds
    s_add_u32 m0, s30, 36864
    s_mov_b32 s53, s50
    buffer_load_dwordx4 v1, s[4:7], s50 offen offset:0 sc1 lds
    buffer_load_dwordx4 v1, s[4:7], s50 offen offset:1024 sc1 lds
    buffer_load_dwordx4 v1, s[4:7], s50 offen offset:2048 sc1 lds
    buffer_load_dwordx4 v1, s[4:7], s50 offen offset:3072 sc1 lds
    s_lshr_b32 s48, s47, 1
    s_cmp_eq_u32 s48, s23
    s_cselect_b32 s48, 1, 31
    s_and_b32 s48, s48, s47
    s_add_u32 m0, s30, 55296
    s_lshl_b32 s51, s48, 7
    buffer_load_dwordx4 v8, s[8:11], s51 offen offset:0  lds
    buffer_load_dwordx4 v9, s[8:11], s51 offen offset:1024  lds
    buffer_load_dwordx4 v10, s[8:11], s51 offen offset:2048  lds
    buffer_load_dwordx4 v11, s[8:11], s51 offen offset:3072  lds
    s_add_u32 s47, s47, 4
    s_and_b32 s47, s47, 31
    s_sub_u32 s41, s41, 1
    s_cmp_lg_u32 s41, 0
    s_cbranch_scc1 L_g_ll
    s_waitcnt vmcnt(17)
    s_barrier
    s_mov_b32 s32, 0
    s_mul_i32 s32, s32, 36864
    s_add_u32 s32, s32, s43
    s_add_u32 m0, s42, 73728
    s_add_u32 s33, s32, 0
    buffer_load_dwordx4 v1, s[4:7], s33 offen offset:0  sc1 lds
    buffer_load_dwordx4 v1, s[4:7], s33 offen offset:1024  sc1 lds
    buffer_load_dwordx4 v1, s[4:7], s33 offen offset:2048  sc1 lds
    buffer_load_dwordx4 v1, s[4:7], s33 offen offset:3072  sc1 lds
    s_add_u32 m0, s42, 77824
    s_add_u32 s33, s32, 4096
    buffer_load_dwordx4 v1, s[4:7], s33 offen offset:0  sc1 lds
    buffer_load_dwordx4 v1, s[4:7], s33 offen offset:1024  sc1 lds
    buffer_load_dwordx4 v1, s[4:7], s33 offen offset:2048  sc1 lds
    buffer_load_dwordx4 v1, s[4:7], s33 offen offset:3072  sc1 lds
    s_add_u32 m0, s42, 81920
    s_add_u32 s33, s32, 8192
    buffer_load_dwordx4 v1, s[4:7], s33 offen offset:0  sc1 lds
    s_waitcnt vmcnt(9)
    s_barrier
    s_cmp_lg_u32 s22, 0
    s_cbranch_scc1 L_p5_k48
    s_add_u32 s32, s43, 110592
    buffer_load_dwordx4 v[40:43], v1, s[4:7], s32 offen offset:0 sc1
    buffer_load_dwordx4 v[44:47], v1, s[4:7], s32 offen offset:1024 sc1
    buffer_load_dwordx4 v[48:51], v1, s[4:7], s32 offen offset:2048 sc1
    buffer_load_dwordx4 v[52:55], v1, s[4:7], s32 offen offset:3072 sc1
    s_add_u32 s32, s43, 114688
    buffer_load_dwordx4 v[56:59], v1, s[4:7], s32 offen offset:0 sc1
    buffer_load_dwordx4 v[60:63], v1, s[4:7], s32 offen offset:1024 sc1
    buffer_load_dwordx4 v[64:67], v1, s[4:7], s32 offen offset:2048 sc1
    buffer_load_dwordx4 v[68:71], v1, s[4:7], s32 offen offset:3072 sc1
    s_add_u32 s32, s43, 118784
    buffer_load_dwordx4 v[72:75], v1, s[4:7], s32 offen offset:0 sc1
L_p5_k48:
    s_mov_b32 s32, 1
    s_mul_i32 s32, s32, 36864
    s_add_u32 s32, s32, s43
    s_add_u32 m0, s42, 110592
    s_add_u32 s33, s32, 0
    buffer_load_dwordx4 v1, s[4:7], s33 offen offset:0  sc1 lds
    buffer_load_dwordx4 v1, s[4:7], s33 offen offset:1024  sc1 lds
    buffer_load_dwordx4 v1, s[4:7], s33 offen offset:2048  sc1 lds
    buffer_load_dwordx4 v1, s[4:7], s33 offen offset:3072  sc1 lds
    s_add_u32 m0, s42, 114688
    s_add_u32 s33, s32, 4096
    buffer_load_dwordx4 v1, s[4:7], s33 offen offset:0  sc1 lds
    buffer_load_dwordx4 v1, s[4:7], s33 offen offset:1024  sc1 lds
    buffer_load_dwordx4 v1, s[4:7], s33 offen offset:2048  sc1 lds
    buffer_load_dwordx4 v1, s[4:7], s33 offen offset:3072  sc1 lds
    s_add_u32 m0, s42, 118784
    s_add_u32 s33, s32, 8192
    buffer_load_dwordx4 v1, s[4:7], s33 offen offset:0  sc1 lds
    s_barrier
    v_add_u32 v12, s42, v1
    v_add_u32 v13, 36864, v12
    v_add_u32 v14, 73728, v12
    v_add_u32 v15, 110592, v12
    s_waitcnt vmcnt(9)
    ds_write_b128 v13, v[40:43] offset:0
    ds_write_b128 v13, v[44:47] offset:1024
    ds_write_b128 v13, v[48:51] offset:2048
    ds_write_b128 v13, v[52:55] offset:3072
    ds_write_b128 v13, v[56:59] offset:4096
    ds_write_b128 v13, v[60:63] offset:5120
    ds_write_b128 v13, v[64:67] offset:6144
    ds_write_b128 v13, v[68:71] offset:7168
    ds_write_b128 v13, v[72:75] offset:8192
    s_barrier
    s_mov_b32 s32, 2
    s_mul_i32 s32, s32, 36864
    s_add_u32 s32, s32, s43
    s_add_u32 m0, s42, 0
    s_add_u32 s33, s32, 0
    buffer_load_dwordx4 v1, s[4:7], s33 offen offset:0  sc1 lds
    buffer_load_dwordx4 v1, s[4:7], s33 offen offset:1024  sc1 lds
    buffer_load_dwordx4 v1, s[4:7], s33 offen offset:2048  sc1 lds
    buffer_load_dwordx4 v1, s[4:7], s33 offen offset:3072  sc1 lds
    s_add_u32 m0, s42, 4096
    s_add_u32 s33, s32, 4096
    buffer_load_dwordx4 v1, s[4:7], s33 offen offset:0  sc1 lds
    buffer_load_dwordx4 v1, s[4:7], s33 offen offset:1024  sc1 lds
    buffer_load_dwordx4 v1, s[4:7], s33 offen offset:2048  sc1 lds
    buffer_load_dwordx4 v1, s[4:7], s33 offen offset:3072  sc1 lds
    s_add_u32 m0, s42, 8192
    s_add_u32 s33, s32, 8192
    buffer_load_dwordx4 v1, s[4:7], s33 offen offset:0  sc1 lds
    s_waitcnt vmcnt(18) lgkmcnt(0)
    s_barrier
    s_waitcnt vmcnt(9) lgkmcnt(15)
    s_barrier
    ds_write_b128 v14, v[76:79] offset:0
    ds_write_b128 v14, v[80:83] offset:1024
    ds_write_b128 v14, v[84:87] offset:2048
    ds_write_b128 v14, v[88:91] offset:3072
    ds_write_b128 v14, v[92:95] offset:4096
    ds_write_b128 v14, v[96:99] offset:5120
    ds_write_b128 v14, v[100:103] offset:6144
    s_waitcnt vmcnt(0) lgkmcnt(15)
    s_barrier
    ds_write_b128 v14, v[104:107] offset:7168
    ds_write_b128 v14, v[108:111] offset:8192
    ds_write_b128 v15, v[112:115] offset:0
    ds_write_b128 v15, v[116:119] offset:1024
    ds_write_b128 v15, v[120:123] offset:2048
    ds_write_b128 v15, v[124:127] offset:3072
    ds_write_b128 v15, v[128:131] offset:4096
    s_waitcnt vmcnt(63) lgkmcnt(15)
    s_barrier
    ds_write_b128 v15, v[132:135] offset:5120
    ds_write_b128 v15, v[136:139] offset:6144
    ds_write_b128 v15, v[140:143] offset:7168
    ds_write_b128 v15, v[144:147] offset:8192
    ds_write_b128 v12, v[148:151] offset:0
    ds_write_b128 v12, v[152:155] offset:1024
    ds_write_b128 v12, v[156:159] offset:2048
    s_waitcnt vmcnt(63) lgkmcnt(12)
    s_barrier
    ds_write_b128 v12, v[160:163] offset:3072
    ds_write_b128 v12, v[164:167] offset:4096
    ds_write_b128 v12, v[168:171] offset:5120
    ds_write_b128 v12, v[172:175] offset:6144
    ds_write_b128 v12, v[176:179] offset:7168
    ds_write_b128 v12, v[180:183] offset:8192
    s_waitcnt vmcnt(63) lgkmcnt(9)
    s_barrier
    ds_write_b128 v13, v[184:187] offset:0
    ds_write_b128 v13, v[188:191] offset:1024
    ds_write_b128 v13, v[192:195] offset:2048
    ds_write_b128 v13, v[196:199] offset:3072
    ds_write_b128 v13, v[200:203] offset:4096
    ds_write_b128 v13, v[204:207] offset:5120
    s_waitcnt vmcnt(63) lgkmcnt(6)
    s_barrier
    s_and_b32 s25, s2, 7
    s_lshr_b32 s26, s2, 3
    s_lshr_b32 s23, s25, 1
    s_lshl_b32 s23, s23, 2
    s_lshr_b32 s27, s26, 3
    s_add_u32 s23, s23, s27
    s_and_b32 s24, s25, 1
    s_lshl_b32 s24, s24, 3
    s_and_b32 s27, s26, 7
    s_add_u32 s24, s24, s27
    s_mul_i32 s29, s24, 129024
    s_lshl_b32 s30, s20, 12
    s_add_u32 s29, s29, s30
    s_add_u32 s29, s29, 0x3800000
    s_lshl_b32 s31, s23, 3
    s_max_u32 s31, s31, 1
    s_sub_u32 s31, s31, 1
    s_mul_i32 s31, s31, 18432
    s_add_u32 s31, s31, 0x1c00000
    s_lshl_b32 s35, s20, 10
    s_and_b32 s36, s35, 1024
    ds_write_b128 v13, v[208:211] offset:6144
    ds_write_b128 v13, v[212:215] offset:7168
    ds_write_b128 v13, v[216:219] offset:8192
    ds_write_b128 v14, v[220:223] offset:0
    ds_write_b128 v14, v[224:227] offset:1024
    ds_write_b128 v14, v[228:231] offset:2048
    s_waitcnt vmcnt(63) lgkmcnt(3)
    s_barrier
    ds_write_b128 v14, v[232:235] offset:3072
    ds_write_b128 v14, v[236:239] offset:4096
    ds_write_b128 v14, v[240:243] offset:5120
    ds_write_b128 v14, v[244:247] offset:6144
    ds_write_b128 v14, v[248:251] offset:7168
    ds_write_b128 v14, v[252:255] offset:8192
    s_waitcnt vmcnt(63) lgkmcnt(0)
    s_barrier
    s_cmp_eq_u32 s22, 1
    s_cbranch_scc1 L_m_t8
    s_add_u32 m0, s30, 0
    s_add_u32 s34, s29, 0
    buffer_load_dwordx4 v1, s[4:7], s34 offen offset:0 sc1 lds
    buffer_load_dwordx4 v1, s[4:7], s34 offen offset:1024 sc1 lds
    buffer_load_dwordx4 v1, s[4:7], s34 offen offset:2048 sc1 lds
    buffer_load_dwordx4 v1, s[4:7], s34 offen offset:3072 sc1 lds
    s_add_u32 m0, s30, 16384
    s_add_u32 s34, s29, 16384
    buffer_load_dwordx4 v1, s[4:7], s34 offen offset:0 sc1 lds
    buffer_load_dwordx4 v1, s[4:7], s34 offen offset:1024 sc1 lds
    buffer_load_dwordx4 v1, s[4:7], s34 offen offset:2048 sc1 lds
    buffer_load_dwordx4 v1, s[4:7], s34 offen offset:3072 sc1 lds
L_m_t8:
    s_cmp_eq_u32 s22, 1
    s_cbranch_scc1 L_m_lfin
    s_barrier
    s_add_u32 m0, s30, 32768
    s_add_u32 s34, s29, 32768
    buffer_load_dwordx4 v1, s[4:7], s34 offen offset:0 sc1 lds
    buffer_load_dwordx4 v1, s[4:7], s34 offen offset:1024 sc1 lds
    buffer_load_dwordx4 v1, s[4:7], s34 offen offset:2048 sc1 lds
    buffer_load_dwordx4 v1, s[4:7], s34 offen offset:3072 sc1 lds
    s_add_u32 m0, s30, 114688
    s_add_u32 s34, s29, 114688
    buffer_load_dwordx4 v1, s[4:7], s34 offen offset:0 sc1 lds
    buffer_load_dwordx4 v1, s[4:7], s34 offen offset:1024 sc1 lds
    buffer_load_dwordx4 v1, s[4:7], s34 offen offset:2048 sc1 lds
    buffer_load_dwordx4 v1, s[4:7], s34 offen offset:3072 sc1 lds
    s_mov_b32 s22, 1
    s_mov_b32 s21, 0x1c00000
    s_barrier
    s_barrier
    s_add_u32 m0, s30, 49152
    s_add_u32 s34, s29, 49152
    buffer_load_dwordx4 v1, s[4:7], s34 offen offset:0 sc1 lds
    buffer_load_dwordx4 v1, s[4:7], s34 offen offset:1024 sc1 lds
    buffer_load_dwordx4 v1, s[4:7], s34 offen offset:2048 sc1 lds
    buffer_load_dwordx4 v1, s[4:7], s34 offen offset:3072 sc1 lds
    v_lshrrev_b32 v2, 8, v1
    v_bfe_u32 v3, v1, 7, 1
    v_bfe_u32 v4, v1, 4, 3
    v_cmp_gt_u32 vcc, 3, v2
    v_mul_u32_u24 v3, 80, v3
    v_lshl_add_u32 v3, v4, 3, v3
    v_lshrrev_b32 v5, 1, v4
    v_and_b32 v4, 1, v4
    v_lshl_add_u32 v4, v4, 3, 64
    v_cndmask_b32 v2, v5, v2, vcc
    v_cndmask_b32 v3, v4, v3, vcc
    v_mul_u32_u24 v2, 2304, v2
    v_add_u32 v0, v2, v3
    v_lshrrev_b32 v8, 1, v1
    s_mul_i32 s34, s24, 144
    s_add_u32 s34, s34, 0x4400000
    buffer_load_dwordx2 v[2:3], v0, s[4:7], s34 offen sc1
    s_mul_i32 s34, s24, 144
    s_add_u32 s34, s34, 0x4402000
    buffer_load_dwordx2 v[4:5], v0, s[4:7], s34 offen sc1
    s_mul_i32 s34, s24, 144
    s_add_u32 s34, s34, 0x4404000
    buffer_load_dwordx2 v[6:7], v0, s[4:7], s34 offen sc1
    s_mul_i32 s34, s24, 144
    s_add_u32 s34, s34, 0x4406000
    buffer_load_dwordx2 v[12:13], v0, s[4:7], s34 offen sc1
    s_add_u32 m0, s30, 65536
    s_add_u32 s34, s29, 65536
    buffer_load_dwordx4 v1, s[4:7], s34 offen offset:0 sc1 lds
    buffer_load_dwordx4 v1, s[4:7], s34 offen offset:1024 sc1 lds
    buffer_load_dwordx4 v1, s[4:7], s34 offen offset:2048 sc1 lds
    buffer_load_dwordx4 v1, s[4:7], s34 offen offset:3072 sc1 lds
    s_add_u32 m0, s30, 81920
    s_add_u32 s34, s29, 81920
    buffer_load_dwordx4 v1, s[4:7], s34 offen offset:0 sc1 lds
    buffer_load_dwordx4 v1, s[4:7], s34 offen offset:1024 sc1 lds
    buffer_load_dwordx4 v1, s[4:7], s34 offen offset:2048 sc1 lds
    buffer_load_dwordx4 v1, s[4:7], s34 offen offset:3072 sc1 lds
    s_barrier
    s_add_u32 m0, s35, 131072
    s_add_u32 s34, s31, s35
    s_add_u32 s34, s34, 0
    buffer_load_dwordx4 v1, s[4:7], s34 offen sc1 lds
    s_waitcnt vmcnt(29) lgkmcnt(0)
    s_barrier
    s_add_u32 m0, s35, 135168
    s_add_u32 s34, s31, s35
    s_add_u32 s34, s34, 4096
    buffer_load_dwordx4 v1, s[4:7], s34 offen sc1 lds
    s_waitcnt vmcnt(1) lgkmcnt(0)
    s_barrier
    s_add_u32 m0, s35, 139264
    s_add_u32 s34, s31, s35
    s_add_u32 s34, s34, 8192
    buffer_load_dwordx4 v1, s[4:7], s34 offen sc1 lds
    s_waitcnt vmcnt(2) lgkmcnt(0)
    s_barrier
    s_add_u32 m0, s35, 143360
    s_add_u32 s34, s31, s35
    s_add_u32 s34, s34, 12288
    buffer_load_dwordx4 v1, s[4:7], s34 offen sc1 lds
    s_add_u32 m0, s30, 98304
    s_add_u32 s34, s29, 98304
    buffer_load_dwordx4 v1, s[4:7], s34 offen offset:0 sc1 lds
    buffer_load_dwordx4 v1, s[4:7], s34 offen offset:1024 sc1 lds
    buffer_load_dwordx4 v1, s[4:7], s34 offen offset:2048 sc1 lds
    buffer_load_dwordx4 v1, s[4:7], s34 offen offset:3072 sc1 lds
    s_waitcnt vmcnt(6) lgkmcnt(0)
    s_barrier
    s_add_u32 m0, s36, 147456
    s_add_u32 s34, s31, s36
    s_add_u32 s34, s34, 16384
    buffer_load_dwordx4 v1, s[4:7], s34 offen sc1 lds
    v_add_f32 v2, v2, v4
    v_add_f32 v3, v3, v5
    v_add_f32 v6, v6, v12
    v_add_f32 v7, v7, v13
    v_add_f32 v2, v2, v6
    v_add_f32 v3, v3, v7
    v_cmp_gt_u32 vcc, 864, v1
    v_add_u32 v8, 161792, v8
    s_nop 0
    v_cndmask_b32 v2, 0, v2, vcc
    v_cndmask_b32 v3, 0, v3, vcc
    ds_write_b64 v8, v[2:3]
    s_waitcnt vmcnt(6) lgkmcnt(0)
    s_barrier
    s_waitcnt vmcnt(6) lgkmcnt(0)
    s_barrier
    s_waitcnt vmcnt(1) lgkmcnt(0)
    s_barrier
    s_waitcnt vmcnt(0) lgkmcnt(0)
    s_barrier
    s_barrier
    s_branch L_m_ll
L_m_lfin:
L_end_m:
    s_endpgm

.section .rodata,"a"
.p2align 6
.amdhsa_kernel interleave_layers__sliding_local_dilated__mixer_gmlp__prompt_kernel
  .amdhsa_next_free_vgpr 256
  .amdhsa_next_free_sgpr 102
  .amdhsa_accum_offset 256
  .amdhsa_group_segment_fixed_size 0
  .amdhsa_kernarg_size 88
  .amdhsa_user_sgpr_count 2
  .amdhsa_user_sgpr_kernarg_segment_ptr 1
  .amdhsa_system_sgpr_workgroup_id_x 1
  .amdhsa_float_denorm_mode_32 3
.end_amdhsa_kernel
```

```asm
; @launch grid=(256,1,1) block=(512,1,1) lds=163840
.amdgcn_target "amdgcn-amd-amdhsa--gfx950"
.text
.globl interleave_layers__sliding_local_dilated__mixer_gmlp__prompt_kernel
.p2align 8
.type interleave_layers__sliding_local_dilated__mixer_gmlp__prompt_kernel,@function
interleave_layers__sliding_local_dilated__mixer_gmlp__prompt_kernel:
    s_cmp_ge_u32 s2, 256
    s_cbranch_scc1 L_end_m
    s_load_dwordx16 s[36:51], s[0:1], 0
    s_load_dwordx4 s[56:59], s[0:1], 64
    s_load_dwordx2 s[24:25], s[0:1], 80
    s_getpc_b64 s[26:27]
L_m_pc:
    s_sub_u32 s26, s26, L_m_pc-interleave_layers__sliding_local_dilated__mixer_gmlp__prompt_kernel
    s_subb_u32 s27, s27, 0
    v_lshlrev_b32 v4, 4, v0
    v_mov_b32 v5, s27
    v_add_co_u32 v6, vcc, s26, v4
    s_lshr_b32 s28, s2, 3
    s_lshl_b32 s28, s28, 11
    v_addc_co_u32_e64 v7, vcc, 0, v5, vcc
    global_load_dwordx4 v[60:63], v[6:7], off
    v_lshl_add_u32 v4, v0, 2, s28
    v_min_u32 v4, L_end_m-interleave_layers__sliding_local_dilated__mixer_gmlp__prompt_kernel-4, v4
    v_add_co_u32 v6, vcc, s26, v4
    s_nop 1
    v_addc_co_u32_e64 v7, vcc, 0, v5, vcc
    global_load_dword v64, v[6:7], off
    v_lshrrev_b32 v2, 6, v0
    v_and_b32 v1, 63, v0
    v_lshlrev_b32 v1, 4, v1
    v_readfirstlane_b32 s23, v2
    s_mov_b32 s22, 0
    s_mov_b32 s21, 0
    s_and_b32 s20, s23, 3
    s_waitcnt lgkmcnt(0)
    s_mov_b32 s4, s24
    s_mov_b32 s5, s25
    s_mov_b32 s6, 0x10000000
    s_mov_b32 s7, 0x20000
    s_cmp_ge_u32 s23, 4
    s_cbranch_scc1 L_ld_m
    v_bfe_u32 v2, v1, 4, 4
    v_lshrrev_b32 v3, 8, v1
    v_bfrev_b32 v6, 1
    v_mov_b32 v11, 0x3f803f80
    s_lshl_b32 s30, s20, 12
    s_and_b32 s29, s20, 1
    s_cmp_lt_u32 s2, 128
    s_cbranch_scc1 L_p0_x
    s_cmp_lt_u32 s2, 236
    s_cbranch_scc1 L_p0_wq
    s_cmp_lt_u32 s2, 254
    s_cbranch_scc1 L_p0_wo
    s_mov_b32 s46, 0
    s_mov_b32 s27, 0x800000
    s_barrier
    s_branch L_p0_cd
L_p0_wo:
    s_mul_i32 s30, s20, 9216
    s_sub_u32 s26, s2, 236
    s_mul_i32 s28, s26, 57
    s_lshr_b32 s28, s28, 9
    s_mul_i32 s27, s28, 9
    s_sub_u32 s27, s26, s27
    s_mov_b32 s32, s40
    s_mov_b32 s33, s41
    s_mov_b32 s34, 0xa2000
    s_mov_b32 s35, 0x20000
    s_mul_i32 s29, s28, 331776
    s_lshl_b32 s31, s27, 7
    s_add_u32 s29, s29, s31
    s_mul_i32 s31, s20, 82944
    s_add_u32 s29, s29, s31
    s_mul_i32 s30, s20, 9216
    v_lshrrev_b32 v4, 7, v1
    v_mul_u32_u24 v4, 1152, v4
    v_and_b32 v5, 0x70, v1
    v_add_u32_e64 v4, v4, v5
    s_add_u32 m0, s30, 0
    s_add_u32 s31, s29, 0
    buffer_load_dwordx4 v4, s[32:35], s31 offen  lds
    s_add_u32 m0, s30, 1024
    s_add_u32 s31, s29, 9216
    buffer_load_dwordx4 v4, s[32:35], s31 offen  lds
    s_add_u32 m0, s30, 2048
    s_add_u32 s31, s29, 18432
    buffer_load_dwordx4 v4, s[32:35], s31 offen  lds
    s_add_u32 m0, s30, 3072
    s_add_u32 s31, s29, 27648
    buffer_load_dwordx4 v4, s[32:35], s31 offen  lds
    s_add_u32 m0, s30, 4096
    s_add_u32 s31, s29, 36864
    buffer_load_dwordx4 v4, s[32:35], s31 offen  lds
    s_add_u32 m0, s30, 5120
    s_add_u32 s31, s29, 46080
    buffer_load_dwordx4 v4, s[32:35], s31 offen  lds
    s_add_u32 m0, s30, 6144
    s_add_u32 s31, s29, 55296
    buffer_load_dwordx4 v4, s[32:35], s31 offen  lds
    s_add_u32 m0, s30, 7168
    s_add_u32 s31, s29, 64512
    buffer_load_dwordx4 v4, s[32:35], s31 offen  lds
    s_add_u32 m0, s30, 8192
    s_add_u32 s31, s29, 73728
    buffer_load_dwordx4 v4, s[32:35], s31 offen  lds
    v_lshrrev_b32 v7, 2, v2
    v_and_b32 v8, 3, v2
    v_bfe_u32 v9, v1, 7, 0
    v_xor_b32 v9, s20, v9
    v_lshlrev_b32 v9, 5, v9
    v_lshl_add_u32 v9, v7, 7, v9
    v_lshl_add_u32 v9, v8, 3, v9
    v_add_u32_e64 v9, 0, v9
    v_mul_u32_u24 v4, 512, v3
    v_add_u32_e64 v4, v4, v9
    v_mul_u32_u24 v5, 9216, v3
    v_add_u32_e64 v5, v5, v9
    s_lshl_b32 s31, s27, 2
    s_add_u32 s31, s31, s20
    v_lshl_add_u32 v7, s31, 2, v7
    v_lshlrev_b32_e64 v8, 4, v8
    v_lshl_add_u32 v8, v3, 8, v8
    v_mul_u32_u24 v9, 57, v7
    v_lshrrev_b32 v9, 10, v9
    v_mul_u32_u24 v10, 18, v9
    v_sub_u32 v10, v7, v10
    v_lshrrev_b32 v12, 3, v10
    v_and_b32 v13, 1, v10
    v_lshl_add_u32 v12, v12, 1, v13
    v_bfe_u32 v14, v10, 1, 2
    v_cmp_gt_u32_e64 vcc, 16, v10
    v_mul_u32_u24 v9, 82944, v9
    v_add_u32 v9, v9, v8
    v_cndmask_b32 v12, 8, v12, vcc
    v_cndmask_b32_e64 v14, v13, v14, vcc
    v_mov_b32 v15, 0x1000
    v_mov_b32 v13, 0x80
    v_cndmask_b32_e64 v15, v13, v15, vcc
    v_lshl_add_u32 v9, v12, 10, v9
    v_lshl_add_u32 v9, v14, 6, v9
    v_add_u32 v10, v9, v15
    s_and_b32 s31, s28, 1
    s_cmp_eq_u32 s31, 1
    s_cselect_b64 vcc, -1, 0
    v_cndmask_b32_e64 v14, v9, v10, vcc
    s_mul_i32 s31, s28, 36864
    s_add_u32 s37, s31, 0x3a00000
    s_add_u32 s38, s31, 0x3a00000
    s_add_u32 s39, s31, 0x3a02400
    s_add_u32 s40, s31, 0x3a02400
    s_add_u32 s41, s31, 0x3a04800
    s_add_u32 s42, s31, 0x3a04800
    s_add_u32 s43, s31, 0x3a06c00
    s_add_u32 s47, s31, 0x3a06c00
    s_lshr_b32 s31, s28, 1
    s_mul_i32 s31, s31, 9216
    s_add_u32 s48, s31, 0x3a12000
    s_cmp_ge_u32 s26, 4
    s_cbranch_scc1 L_p0_n2
    s_lshl_b32 s31, s26, 2
    s_add_u32 s31, s31, s20
    s_lshl_b32 s31, s31, 12
    s_add_u32 s31, s31, 0x4508000
    v_and_b32 v56, 0x380, v1
    v_add_u32 v56, v56, v1
    v_mov_b32 v52, 0
    v_mov_b32 v53, 0
    v_mov_b32 v54, 0
    v_mov_b32_e64 v55, 0
    buffer_store_dwordx4 v[52:55], v56, s[4:7], s31 offen offset:0 sc1
    buffer_store_dwordx4 v[52:55], v56, s[4:7], s31 offen offset:2048 sc1
L_p0_n2:
    s_waitcnt vmcnt(0)
    s_barrier
    ds_read_b64_tr_b16 v[16:17], v4 offset:0
    ds_read_b64_tr_b16 v[18:19], v4 offset:2560
    ds_read_b64_tr_b16 v[20:21], v4 offset:4608
    ds_read_b64_tr_b16 v[22:23], v4 offset:7168
    ds_read_b64_tr_b16 v[24:25], v4 offset:9216
    ds_read_b64_tr_b16 v[26:27], v4 offset:11776
    ds_read_b64_tr_b16 v[28:29], v4 offset:13824
    ds_read_b64_tr_b16 v[30:31], v4 offset:16384
    ds_read_b64_tr_b16 v[32:33], v4 offset:18432
    ds_read_b64_tr_b16 v[34:35], v4 offset:20992
    ds_read_b64_tr_b16 v[36:37], v4 offset:23040
    ds_read_b64_tr_b16 v[38:39], v4 offset:25600
    ds_read_b64_tr_b16 v[40:41], v4 offset:27648
    ds_read_b64_tr_b16 v[42:43], v4 offset:30208
    ds_read_b64_tr_b16 v[44:45], v4 offset:32256
    ds_read_b64_tr_b16 v[46:47], v4 offset:34816
    ds_read_b64_tr_b16 v[48:49], v5 offset:2048
    ds_read_b64_tr_b16 v[50:51], v5 offset:6656
    s_waitcnt lgkmcnt(15)
    s_mov_b32 s31, s37
    buffer_store_dwordx4 v[16:19], v9, s[4:7], s31 offen sc1
    s_waitcnt lgkmcnt(14)
    s_mov_b32 s31, s38
    buffer_store_dwordx4 v[20:23], v10, s[4:7], s31 offen sc1
    s_waitcnt lgkmcnt(12)
    s_mov_b32 s31, s39
    buffer_store_dwordx4 v[24:27], v9, s[4:7], s31 offen sc1
    s_waitcnt lgkmcnt(10)
    s_mov_b32 s31, s40
    buffer_store_dwordx4 v[28:31], v10, s[4:7], s31 offen sc1
    s_waitcnt lgkmcnt(8)
    s_mov_b32 s31, s41
    buffer_store_dwordx4 v[32:35], v9, s[4:7], s31 offen sc1
    s_waitcnt lgkmcnt(6)
    s_mov_b32 s31, s42
    buffer_store_dwordx4 v[36:39], v10, s[4:7], s31 offen sc1
    s_waitcnt lgkmcnt(4)
    s_mov_b32 s31, s43
    buffer_store_dwordx4 v[40:43], v9, s[4:7], s31 offen sc1
    s_waitcnt lgkmcnt(2)
    s_mov_b32 s31, s47
    buffer_store_dwordx4 v[44:47], v10, s[4:7], s31 offen sc1
    s_waitcnt lgkmcnt(0)
    s_mov_b32 s31, s48
    buffer_store_dwordx4 v[48:51], v14, s[4:7], s31 offen sc1
    s_mov_b32 s46, 1
    s_mov_b32 s27, 32
    s_branch L_p0_cd
    s_nop 0
L_p0_wq:
    s_mov_b32 s32, s38
    s_mov_b32 s33, s39
    s_mov_b32 s34, 0x1e6000
    s_mov_b32 s35, 0x20000
    s_sub_u32 s23, s2, 128
    s_mul_i32 s25, s23, 19
    s_lshr_b32 s25, s25, 9
    s_mul_i32 s24, s25, 27
    s_sub_u32 s24, s23, s24
    s_mul_i32 s26, s25, 497664
    s_lshl_b32 s31, s24, 7
    s_add_u32 s26, s26, s31
    v_lshrrev_b32_e64 v4, 7, v1
    v_mul_u32_u24 v4, 3456, v4
    v_lshrrev_b32 v5, 4, v1
    v_and_b32 v5, 16, v5
    v_xor_b32_e64 v5, v5, v1
    v_and_b32 v5, 0x70, v5
    v_add_u32_e64 v4, v4, v5
    s_mul_i32 s31, s20, 110592
    s_add_u32 s27, s26, s31
    s_mul_i32 s30, s20, 4224
    s_add_u32 m0, s30, 0
    s_add_u32 s31, s27, 0
    buffer_load_dwordx4 v4, s[32:35], s31 offen  lds
    s_add_u32 m0, s30, 1056
    s_add_u32 s31, s27, 27648
    buffer_load_dwordx4 v4, s[32:35], s31 offen  lds
    s_add_u32 m0, s30, 2112
    s_add_u32 s31, s27, 55296
    buffer_load_dwordx4 v4, s[32:35], s31 offen  lds
    s_add_u32 m0, s30, 3168
    s_add_u32 s31, s27, 82944
    buffer_load_dwordx4 v4, s[32:35], s31 offen  lds
    s_cmp_ge_u32 s20, 2
    s_cbranch_scc1 L_p0_q5
    s_mul_i32 s31, s29, 1056
    s_add_u32 m0, s31, 16896
    s_mul_i32 s31, s29, 27648
    s_add_u32 s31, s31, s26
    s_add_u32 s31, s31, 442368
    buffer_load_dwordx4 v4, s[32:35], s31 offen  lds
L_p0_q5:
    v_lshrrev_b32 v7, 2, v2
    v_and_b32 v8, 3, v2
    s_lshl_b32 s31, s20, 5
    v_and_b32 v9, 2, v7
    v_xor_b32 v9, v9, v3
    v_lshlrev_b32 v9, 3, v9
    v_lshl_add_u32 v9, v7, 7, v9
    v_add_u32_e64 v9, s31, v9
    v_mul_u32_u24 v4, 1056, v8
    v_add_u32 v4, v4, v9
    v_and_b32 v5, 1, v2
    v_mul_u32_u24 v5, 9504, v5
    v_add_u32 v5, v5, v9
    s_lshl_b32 s31, s24, 2
    s_add_u32 s31, s31, s20
    v_lshlrev_b32 v8, 4, v8
    v_lshl_add_u32 v8, v7, 8, v8
    v_lshl_add_u32 v7, s31, 2, v3
    v_mul_u32_u24 v9, 57, v7
    v_lshrrev_b32 v9, 13, v9
    v_mul_u32_u24 v10, 144, v9
    v_sub_u32 v10, v7, v10
    v_mul_u32_u24 v12, 57, v10
    v_lshrrev_b32 v12, 9, v12
    v_mul_u32_u24 v13, 9, v12
    v_sub_u32_e64 v13, v10, v13
    v_cmp_lt_u32 s[36:37], 4, v13
    v_cmp_eq_u32 s[38:39], 4, v13
    v_cmp_eq_u32 s[40:41], 2, v9
    v_lshlrev_b32 v14, 1, v9
    v_add_u32 v15, 1, v14
    v_subrev_u32_e64 v10, 5, v13
    v_cndmask_b32 v14, v14, v15, s[36:37]
    v_cndmask_b32 v13, v13, v10, s[36:37]
    v_cndmask_b32 v14, v14, 6, s[38:39]
    v_cndmask_b32 v13, v13, v9, s[38:39]
    s_and_b64 s[40:41], s[40:41], s[38:39]
    s_mov_b32 s31, 129024
    v_mul_lo_u32 v9, v12, s31
    v_add_u32 v9, v9, v8
    v_lshl_add_u32 v9, v14, 10, v9
    v_lshl_add_u32 v9, v13, 6, v9
    s_and_b32 s31, s25, 1
    v_lshrrev_b32 v8, 3, v2
    v_cmp_eq_u32 vcc, s31, v8
    v_add_u32 v15, 64, v9
    v_cndmask_b32 v15, v6, v15, s[40:41]
    v_cndmask_b32 v8, v6, v9, vcc
    v_lshlrev_b32 v10, 2, v2
    v_lshl_add_u32 v10, v7, 4, v10
    v_cmp_gt_u32 vcc, 4, v2
    s_lshl_b32 s45, s25, 13
    s_add_u32 s45, s45, 0x4400000
    v_cndmask_b32_e64 v10, v6, v10, vcc
    s_mul_i32 s42, s25, 28672
    s_add_u32 s42, s42, 0x3800000
    s_lshr_b32 s44, s25, 1
    s_mul_i32 s44, s44, 7168
    s_add_u32 s44, s44, 0x381c000
    s_mul_i32 s26, s24, 29
    s_lshr_b32 s26, s26, 8
    s_mul_i32 s27, s26, 9
    s_sub_u32 s27, s24, s27
    s_lshl_b32 s27, s27, 4
    s_add_u32 s28, s27, 16
    v_lshrrev_b32 v254, 4, v1
    v_mul_u32_u24 v7, 9, v254
    v_add_u32 v255, 9, v7
    v_min_u32 v255, s28, v255
    v_max_u32 v7, s27, v7
    v_sub_u32 v255, v255, v7
    v_cmp_lt_i32 vcc, 0, v255
    v_lshlrev_b32_e64 v254, 8, v254
    v_mov_b32 v14, 0x3f003f00
    v_cndmask_b32 v254, v6, v254, vcc
    s_cmp_eq_u64 s[40:41], 0
    s_cbranch_scc1 L_p0_np
    v_mov_b32 v52, 0
    v_mov_b32 v53, 0
    v_mov_b32 v54, 0
    v_mov_b32 v55, 0
    s_add_u32 s31, s42, 0
    buffer_store_dwordx4 v[52:55], v15, s[4:7], s31 offen sc1
    s_add_u32 s31, s42, 7168
    buffer_store_dwordx4 v[52:55], v15, s[4:7], s31 offen sc1
    s_add_u32 s31, s42, 14336
    buffer_store_dwordx4 v[52:55], v15, s[4:7], s31 offen sc1
    s_add_u32 s31, s42, 21504
    buffer_store_dwordx4 v[52:55], v15, s[4:7], s31 offen sc1
    s_mov_b32 s31, s44
    buffer_store_dwordx4 v[52:55], v15, s[4:7], s31 offen sc1
    s_waitcnt vmcnt(5)
    s_branch L_p0_n3
    s_nop 0
L_p0_np:
    s_waitcnt vmcnt(0)
L_p0_n3:
    s_barrier
    ds_read_b64_tr_b16 v[16:17], v4 offset:0
    ds_read_b64_tr_b16 v[18:19], v4 offset:512
    ds_read_b64_tr_b16 v[20:21], v4 offset:4224
    ds_read_b64_tr_b16 v[22:23], v4 offset:4736
    ds_read_b64_tr_b16 v[24:25], v4 offset:9504
    ds_read_b64_tr_b16 v[26:27], v4 offset:10016
    ds_read_b64_tr_b16 v[28:29], v4 offset:13728
    ds_read_b64_tr_b16 v[30:31], v4 offset:14240
    ds_read_b64_tr_b16 v[32:33], v5 offset:8448
    ds_read_b64_tr_b16 v[34:35], v5 offset:8960
    s_waitcnt lgkmcnt(8)
    s_add_u32 s31, s42, 0
    buffer_store_dwordx4 v[16:19], v9, s[4:7], s31 offen sc1
    s_waitcnt lgkmcnt(6)
    s_add_u32 s31, s42, 7168
    buffer_store_dwordx4 v[20:23], v9, s[4:7], s31 offen sc1
    s_waitcnt lgkmcnt(4)
    s_add_u32 s31, s42, 14336
    buffer_store_dwordx4 v[24:27], v9, s[4:7], s31 offen sc1
    s_waitcnt lgkmcnt(2)
    s_add_u32 s31, s42, 21504
    buffer_store_dwordx4 v[28:31], v9, s[4:7], s31 offen sc1
    s_waitcnt lgkmcnt(0)
    s_mov_b32 s31, s44
    buffer_store_dwordx4 v[32:35], v8, s[4:7], s31 offen sc1
    v_dot2_f32_bf16 v12, v16, v11, 0
    v_dot2_f32_bf16 v13, v17, v11, 0
    v_dot2_f32_bf16 v12, v18, v11, v12
    v_dot2_f32_bf16 v13, v19, v11, v13
    v_dot2_f32_bf16 v12, v20, v11, v12
    v_dot2_f32_bf16 v13, v21, v11, v13
    v_dot2_f32_bf16 v12, v22, v11, v12
    v_dot2_f32_bf16 v13, v23, v11, v13
    v_dot2_f32_bf16 v12, v24, v11, v12
    v_dot2_f32_bf16 v13, v25, v11, v13
    v_dot2_f32_bf16 v12, v26, v11, v12
    v_dot2_f32_bf16 v13, v27, v11, v13
    v_dot2_f32_bf16 v12, v28, v11, v12
    v_dot2_f32_bf16 v13, v29, v11, v13
    v_dot2_f32_bf16 v12, v30, v11, v12
    v_dot2_f32_bf16 v13, v31, v11, v13
    v_dot2_f32_bf16 v12, v32, v14, v12
    v_dot2_f32_bf16 v13, v33, v14, v13
    v_dot2_f32_bf16 v12, v34, v14, v12
    v_dot2_f32_bf16 v13, v35, v14, v13
    s_nop 2
    v_add_f32 v12, v12, v13
    s_nop 1
    v_add_f32_dpp v12, v12, v12 row_ror:4 row_mask:0xf bank_mask:0xf
    s_nop 1
    v_add_f32_dpp v12, v12, v12 row_ror:8 row_mask:0xf bank_mask:0xf
    buffer_store_dword v12, v10, s[4:7], s45 offen sc1
    s_branch L_p0_ce
L_p0_x:
    s_mov_b32 s32, s36
    s_mov_b32 s33, s37
    s_mov_b32 s34, 0x240000
    s_mov_b32 s35, 0x20000
    s_mul_i32 s26, s2, 18432
    s_mul_i32 s31, s20, 288
    s_add_u32 s28, s26, s31
    v_lshrrev_b32 v4, 6, v1
    v_mul_u32_u24 v4, 1152, v4
    v_and_b32 v5, 48, v1
    v_add_u32 v4, v4, v5
    s_add_u32 m0, s30, 0
    s_add_u32 s31, s28, 0
    buffer_load_dwordx4 v4, s[32:35], s31 offen  lds
    s_add_u32 m0, s30, 1024
    s_add_u32 s31, s28, 64
    buffer_load_dwordx4 v4, s[32:35], s31 offen  lds
    s_add_u32 m0, s30, 2048
    s_add_u32 s31, s28, 144
    buffer_load_dwordx4 v4, s[32:35], s31 offen  lds
    s_add_u32 m0, s30, 3072
    s_add_u32 s31, s28, 208
    buffer_load_dwordx4 v4, s[32:35], s31 offen  lds
    s_mul_i32 s31, s29, 576
    s_add_u32 s31, s31, s26
    v_mul_u32_u24 v7, 1152, v2
    v_mul_u32_u24 v5, 144, v3
    v_add_u32_e64 v5, v5, v7
    buffer_load_dwordx4 v[32:35], v5, s[32:35], s31 offen offset:128
    s_lshl_b32 s27, s29, 10
    s_add_u32 s27, s27, 16384
    s_barrier
    v_lshlrev_b32_e64 v4, 6, v2
    v_lshl_add_u32 v4, v3, 4, v4
    v_add_u32_e64 v4, s30, v4
    s_add_u32 s26, s26, 0x0
    s_add_u32 s42, s26, s30
    s_add_u32 s44, s26, s27
    s_lshl_b32 s45, s2, 10
    s_lshl_b32 s31, s20, 8
    s_add_u32 s45, s45, s31
    s_add_u32 s45, s45, 0x1b00000
    v_cmp_gt_u32 vcc, 2, v3
    v_lshrrev_b32 v10, 1, v1
    s_mov_b32 s46, 2
    v_cndmask_b32_e64 v10, v6, v10, vcc
    s_lshr_b32 s27, s2, 3
    s_add_u32 s27, s27, 48
    s_waitcnt vmcnt(0)
    ds_read_b128 v[16:19], v4 offset:0
    ds_read_b128 v[20:23], v4 offset:1024
    ds_read_b128 v[24:27], v4 offset:2048
    ds_read_b128 v[28:31], v4 offset:3072
    s_waitcnt lgkmcnt(3)
    buffer_store_dwordx4 v[16:19], v1, s[4:7], s42 offen offset:0 sc1
    s_waitcnt lgkmcnt(2)
    buffer_store_dwordx4 v[20:23], v1, s[4:7], s42 offen offset:1024 sc1
    s_waitcnt lgkmcnt(1)
    buffer_store_dwordx4 v[24:27], v1, s[4:7], s42 offen offset:2048 sc1
    s_waitcnt lgkmcnt(0)
    buffer_store_dwordx4 v[28:31], v1, s[4:7], s42 offen offset:3072 sc1
    v_dot2_f32_bf16 v12, v16, v11, 0
    v_dot2_f32_bf16 v13, v16, v16, 0
    v_dot2_f32_bf16 v12, v17, v11, v12
    v_dot2_f32_bf16 v13, v17, v17, v13
    v_dot2_f32_bf16 v12, v18, v11, v12
    v_dot2_f32_bf16 v13, v18, v18, v13
    v_dot2_f32_bf16 v12, v19, v11, v12
    v_dot2_f32_bf16 v13, v19, v19, v13
    v_dot2_f32_bf16 v12, v20, v11, v12
    v_dot2_f32_bf16 v13, v20, v20, v13
    v_dot2_f32_bf16 v12, v21, v11, v12
    v_dot2_f32_bf16 v13, v21, v21, v13
    v_dot2_f32_bf16 v12, v22, v11, v12
    v_dot2_f32_bf16 v13, v22, v22, v13
    v_dot2_f32_bf16 v12, v23, v11, v12
    v_dot2_f32_bf16 v13, v23, v23, v13
    v_dot2_f32_bf16 v12, v24, v11, v12
    v_dot2_f32_bf16 v13, v24, v24, v13
    v_dot2_f32_bf16 v12, v25, v11, v12
    v_dot2_f32_bf16 v13, v25, v25, v13
    v_dot2_f32_bf16 v12, v26, v11, v12
    v_dot2_f32_bf16 v13, v26, v26, v13
    v_dot2_f32_bf16 v12, v27, v11, v12
    v_dot2_f32_bf16 v13, v27, v27, v13
    v_dot2_f32_bf16 v12, v28, v11, v12
    v_dot2_f32_bf16 v13, v28, v28, v13
    v_dot2_f32_bf16 v12, v29, v11, v12
    v_dot2_f32_bf16 v13, v29, v29, v13
    v_dot2_f32_bf16 v12, v30, v11, v12
    v_dot2_f32_bf16 v13, v30, v30, v13
    v_dot2_f32_bf16 v12, v31, v11, v12
    v_dot2_f32_bf16 v13, v31, v31, v13
    s_waitcnt lgkmcnt(0)
    s_cmp_ge_u32 s20, 2
    s_cbranch_scc1 L_p0_xs
    buffer_store_dwordx4 v[32:35], v1, s[4:7], s44 offen sc1
    v_dot2_f32_bf16 v12, v32, v11, v12
    v_dot2_f32_bf16 v13, v32, v32, v13
    v_dot2_f32_bf16 v12, v33, v11, v12
    v_dot2_f32_bf16 v13, v33, v33, v13
    v_dot2_f32_bf16 v12, v34, v11, v12
    v_dot2_f32_bf16 v13, v34, v34, v13
    v_dot2_f32_bf16 v12, v35, v11, v12
    v_dot2_f32_bf16 v13, v35, v35, v13
L_p0_xs:
    s_nop 2
    v_mov_b32 v14, v12
    v_mov_b32 v15, v13
    s_nop 1
    v_permlane32_swap_b32 v12, v14
    v_permlane32_swap_b32 v13, v15
    v_add_f32 v12, v12, v14
    v_add_f32_e64 v13, v13, v15
    buffer_store_dwordx2 v[12:13], v10, s[4:7], s45 offen sc1
L_p0_cd:
    v_cmp_eq_u32 vcc, 0, v1
    s_lshl_b32 s27, s27, 8
    v_mov_b32 v255, s46
    v_mov_b32 v254, s27
    v_cndmask_b32_e64 v254, v6, v254, vcc
L_p0_ce:
    s_mov_b32 s48, s58
    s_mov_b32 s49, s59
    s_mov_b32 s50, 0x100
    s_mov_b32 s51, 0x20000
    v_mov_b32_e64 v4, 0
    buffer_load_dword v246, v4, s[48:51], 0 offen sc1
    s_mov_b32 s16, s56
    s_mov_b32 s17, s57
    s_mov_b32 s18, 0x240000
    s_mov_b32 s19, 0x20000
    s_branch L_m_cl
L_d1_first:
    v_cmp_gt_u32 vcc, 4, v246
    v_mov_b32_e64 v4, 0
    s_mov_b32 s46, 0x4500000
    s_cbranch_vccz L_pd_dbg
    s_mov_b32 s60, 65536
L_poll_dbg:
    buffer_load_dword v5, v4, s[48:51], 0 offen sc1
    s_waitcnt vmcnt(0)
    v_cmp_gt_u32 vcc, 4, v5
    s_sub_u32 s60, s60, 1
    s_cbranch_scc1 L_pd_dbg
    s_cbranch_vccz L_pd_dbg
    s_sleep 4
    s_branch L_poll_dbg
L_pd_dbg:
    buffer_atomic_add v255, v254, s[4:7], s46 offen sc1
    s_branch L_ns_d1
    s_nop 0
L_ld_m:
    s_cmp_lg_u32 s2, 254
    s_cbranch_scc1 L_p0_nz
    s_lshl_b32 s31, s20, 12
    s_add_u32 s31, s31, 0x4500000
    v_and_b32 v56, 0x380, v1
    v_add_u32 v56, v56, v1
    v_mov_b32 v52, 0
    v_mov_b32 v53, 0
    v_mov_b32 v54, 0
    v_mov_b32_e64 v55, 0
    buffer_store_dwordx4 v[52:55], v56, s[4:7], s31 offen offset:0 sc1
    buffer_store_dwordx4 v[52:55], v56, s[4:7], s31 offen offset:2048 sc1
    s_waitcnt vmcnt(0)
    s_mov_b32 s53, 1
    s_atomic_add s53, s[58:59], 0
L_p0_nz:
    s_mov_b32 s8, s46
    s_mov_b32 s9, s47
    s_mov_b32 s10, 0x800000
    s_mov_b32 s11, 0x20000
    s_mov_b32 s12, s48
    s_mov_b32 s13, s49
    s_mov_b32 s14, 0x1000
    s_mov_b32 s15, 0x20000
    v_mov_b32 v2, 163808
    v_mov_b32 v4, 0
    v_mov_b32 v5, 0
    ds_write2_b64 v2, v[4:5], v[4:5] offset0:0 offset1:1
    s_waitcnt lgkmcnt(0)
    v_bfe_u32 v2, v1, 4, 4
    v_lshrrev_b32 v3, 8, v1
    v_bfrev_b32_e64 v6, 1
    v_mov_b32 v11, 0x3f803f80
    s_mul_i32 s30, s20, 9216
    s_cmp_lt_u32 s2, 144
    s_cbranch_scc1 L_p0_wi
    s_cmp_lt_u32 s2, 216
    s_cbranch_scc1 L_p0_wu
    v_mov_b32 v9, v6
    v_mov_b32 v10, v6
    v_mov_b32 v14, v6
    v_mov_b32 v15, v6
    s_mov_b32 s37, 0
    s_mov_b32 s38, 0
    s_mov_b32 s39, 0
    s_mov_b32 s40, 0
    s_mov_b32 s41, 0
    s_mov_b32 s42, 0
    s_mov_b32 s43, 0
    s_mov_b32 s47, 0
    s_mov_b32 s48, 0
    s_mov_b32 s49, 0
    s_barrier
    s_barrier
    s_barrier
    s_branch L_p0_ld
L_p0_wu:
    s_sub_u32 s26, s2, 144
    s_mul_i32 s28, s26, 57
    s_lshr_b32 s28, s28, 9
    s_mul_i32 s27, s28, 9
    s_sub_u32 s27, s26, s27
    s_mov_b32 s32, s50
    s_mov_b32 s33, s51
    s_mov_b32 s34, 0x288000
    s_mov_b32 s35, 0x20000
    s_mul_i32 s29, s28, 331776
    s_lshl_b32 s31, s27, 7
    s_add_u32 s29, s29, s31
    s_mul_i32 s31, s20, 82944
    s_add_u32 s29, s29, s31
    s_mul_i32 s30, s20, 9216
    v_lshrrev_b32 v4, 7, v1
    v_mul_u32_u24 v4, 1152, v4
    v_and_b32 v5, 0x70, v1
    v_bfe_u32 v7, v1, 8, 2
    v_lshlrev_b32 v7, 5, v7
    v_xor_b32 v5, v5, v7
    v_add_u32 v4, v4, v5
    s_barrier
    s_barrier
    s_barrier
    s_add_u32 m0, s30, 91904
    s_add_u32 s31, s29, 0
    buffer_load_dwordx4 v4, s[32:35], s31 offen  lds
    s_add_u32 m0, s30, 92928
    s_add_u32 s31, s29, 9216
    buffer_load_dwordx4 v4, s[32:35], s31 offen  lds
    s_add_u32 m0, s30, 93952
    s_add_u32 s31, s29, 18432
    buffer_load_dwordx4 v4, s[32:35], s31 offen  lds
    s_add_u32 m0, s30, 94976
    s_add_u32 s31, s29, 27648
    buffer_load_dwordx4 v4, s[32:35], s31 offen  lds
    s_add_u32 m0, s30, 96000
    s_add_u32 s31, s29, 36864
    buffer_load_dwordx4 v4, s[32:35], s31 offen  lds
    s_add_u32 m0, s30, 97024
    s_add_u32 s31, s29, 46080
    buffer_load_dwordx4 v4, s[32:35], s31 offen  lds
    s_add_u32 m0, s30, 98048
    s_add_u32 s31, s29, 55296
    buffer_load_dwordx4 v4, s[32:35], s31 offen  lds
    s_add_u32 m0, s30, 99072
    s_add_u32 s31, s29, 64512
    buffer_load_dwordx4 v4, s[32:35], s31 offen  lds
    s_add_u32 m0, s30, 100096
    s_add_u32 s31, s29, 73728
    buffer_load_dwordx4 v4, s[32:35], s31 offen  lds
    v_lshrrev_b32 v7, 2, v2
    v_and_b32_e64 v8, 3, v2
    v_bfe_u32 v9, v1, 7, 2
    v_xor_b32 v9, s20, v9
    v_lshlrev_b32 v9, 5, v9
    v_lshl_add_u32 v9, v7, 7, v9
    v_lshl_add_u32 v9, v8, 3, v9
    v_add_u32 v9, 91904, v9
    v_mul_u32_u24 v4, 512, v3
    v_add_u32_e64 v4, v4, v9
    v_mul_u32_u24 v5, 512, v3
    v_add_u32_e64 v5, v5, v9
    s_lshl_b32 s31, s27, 2
    s_add_u32 s31, s31, s20
    v_lshl_add_u32 v7, s31, 2, v7
    v_lshlrev_b32_e64 v8, 4, v8
    v_lshl_add_u32 v8, v3, 8, v8
    v_mul_u32_u24 v9, 57, v7
    v_lshrrev_b32 v9, 10, v9
    v_mul_u32_u24 v10, 18, v9
    v_sub_u32 v10, v7, v10
    v_lshrrev_b32 v12, 3, v10
    v_and_b32 v13, 1, v10
    v_lshl_add_u32 v12, v12, 1, v13
    v_bfe_u32 v14, v10, 1, 2
    v_cmp_gt_u32_e64 vcc, 16, v10
    v_mul_u32_u24 v9, 331776, v9
    v_add_u32 v9, v9, v8
    v_cndmask_b32 v12, 8, v12, vcc
    v_cndmask_b32_e64 v14, v13, v14, vcc
    v_mov_b32 v15, 0x1000
    v_mov_b32 v13, 0x80
    v_cndmask_b32_e64 v15, v13, v15, vcc
    v_lshl_add_u32 v9, v12, 10, v9
    v_lshl_add_u32 v9, v14, 6, v9
    v_add_u32 v10, v9, v15
    s_and_b32 s31, s28, 1
    s_cmp_eq_u32 s31, 1
    s_cselect_b64 vcc, -1, 0
    v_cndmask_b32_e64 v14, v9, v10, vcc
    s_mul_i32 s31, s28, 9216
    s_add_u32 s37, s31, 0x4100000
    s_add_u32 s38, s31, 0x4100000
    s_add_u32 s39, s31, 0x4112000
    s_add_u32 s40, s31, 0x4112000
    s_add_u32 s41, s31, 0x4124000
    s_add_u32 s42, s31, 0x4124000
    s_add_u32 s43, s31, 0x4136000
    s_add_u32 s47, s31, 0x4136000
    s_lshr_b32 s31, s28, 1
    s_mul_i32 s31, s31, 9216
    s_add_u32 s48, s31, 0x4148000
    v_mov_b32_e64 v15, v6
    s_mov_b32 s49, 0
    s_branch L_p0_ld
L_p0_wi:
    s_mov_b32 s26, s2
    s_mul_i32 s28, s26, 57
    s_lshr_b32 s28, s28, 12
    s_mul_i32 s27, s28, 72
    s_sub_u32 s27, s26, s27
    s_mov_b32 s32, s44
    s_mov_b32 s33, s45
    s_mov_b32 s34, 0x510000
    s_mov_b32 s35, 0x20000
    s_mul_i32 s29, s28, 2654208
    s_lshl_b32 s31, s27, 7
    s_add_u32 s29, s29, s31
    s_mul_i32 s31, s20, 663552
    s_add_u32 s29, s29, s31
    s_mul_i32 s30, s20, 9792
    v_lshrrev_b32_e64 v4, 7, v1
    v_mul_u32_u24 v4, 9216, v4
    v_and_b32 v5, 0x70, v1
    v_bfe_u32 v7, v1, 8, 1
    v_lshlrev_b32 v7, 5, v7
    v_xor_b32 v5, v5, v7
    v_add_u32 v4, v4, v5
    s_barrier
    s_barrier
    s_barrier
    s_add_u32 m0, s30, 91904
    s_add_u32 s31, s29, 0
    buffer_load_dwordx4 v4, s[32:35], s31 offen  lds
    s_add_u32 m0, s30, 92992
    s_add_u32 s31, s29, 73728
    buffer_load_dwordx4 v4, s[32:35], s31 offen  lds
    s_add_u32 m0, s30, 94080
    s_add_u32 s31, s29, 147456
    buffer_load_dwordx4 v4, s[32:35], s31 offen  lds
    s_add_u32 m0, s30, 95168
    s_add_u32 s31, s29, 221184
    buffer_load_dwordx4 v4, s[32:35], s31 offen  lds
    s_add_u32 m0, s30, 96256
    s_add_u32 s31, s29, 294912
    buffer_load_dwordx4 v4, s[32:35], s31 offen  lds
    s_add_u32 m0, s30, 97344
    s_add_u32 s31, s29, 368640
    buffer_load_dwordx4 v4, s[32:35], s31 offen  lds
    s_add_u32 m0, s30, 98432
    s_add_u32 s31, s29, 442368
    buffer_load_dwordx4 v4, s[32:35], s31 offen  lds
    s_add_u32 m0, s30, 99520
    s_add_u32 s31, s29, 516096
    buffer_load_dwordx4 v4, s[32:35], s31 offen  lds
    s_add_u32 m0, s30, 100608
    s_add_u32 s31, s29, 589824
    buffer_load_dwordx4 v4, s[32:35], s31 offen  lds
    v_lshrrev_b32 v7, 2, v2
    v_and_b32_e64 v8, 3, v2
    v_bfe_u32 v9, v1, 7, 1
    v_xor_b32 v9, s20, v9
    v_lshlrev_b32 v9, 5, v9
    v_lshl_add_u32 v9, v7, 7, v9
    v_lshl_add_u32 v9, v8, 3, v9
    v_add_u32 v9, 91904, v9
    v_mul_u32_u24 v4, 1088, v3
    v_add_u32_e64 v4, v4, v9
    v_mul_u32_u24 v5, 9792, v3
    v_add_u32_e64 v5, v5, v9
    s_lshl_b32 s31, s27, 2
    s_add_u32 s31, s31, s20
    v_lshl_add_u32 v7, s31, 2, v7
    v_lshlrev_b32_e64 v8, 4, v8
    v_lshl_add_u32 v8, v3, 8, v8
    s_cmp_lt_u32 s31, 144
    s_cselect_b32 s23, 1, 0
    s_cselect_b32 s24, 0, 144
    s_sub_u32 s26, s31, s24
    s_mul_i32 s25, s26, 57
    s_lshr_b32 s25, s25, 9
    s_mul_i32 s24, s25, 9
    s_sub_u32 s24, s26, s24
    s_lshl_b32 s26, s25, 1
    s_add_u32 s26, s26, s23
    s_mul_i32 s26, s26, 165888
    s_lshl_b32 s31, s24, 10
    s_add_u32 s26, s26, s31
    s_add_u32 s26, s26, 0x3b00000
    s_mul_i32 s31, s28, 9216
    s_add_u32 s48, s26, s31
    s_add_u32 s48, s48, 147456
    s_lshl_b32 s31, s31, 3
    s_add_u32 s26, s26, s31
    s_add_u32 s37, s26, 0
    s_add_u32 s38, s26, 9216
    s_add_u32 s39, s26, 18432
    s_add_u32 s40, s26, 27648
    s_add_u32 s41, s26, 36864
    s_add_u32 s42, s26, 46080
    s_add_u32 s43, s26, 55296
    s_add_u32 s47, s26, 64512
    s_lshl_b32 s49, s25, 12
    s_mul_i32 s31, s28, 1152
    s_add_u32 s49, s49, s31
    s_mul_i32 s31, s23, 576
    s_add_u32 s49, s49, s31
    s_lshl_b32 s31, s24, 6
    s_add_u32 s49, s49, s31
    s_add_u32 s49, s49, 0x4410000
    v_cmp_eq_u32 vcc, 0, v3
    v_lshlrev_b32 v15, 2, v2
    v_mov_b32 v9, v1
    v_mov_b32 v10, v1
    v_mov_b32 v14, v1
    v_cndmask_b32 v15, v6, v15, vcc
L_p0_ld:
    s_waitcnt lgkmcnt(0)
    s_branch L_m_l1
L_m_cl:
    s_and_b32 s25, s2, 7
    s_lshr_b32 s26, s2, 3
    s_lshr_b32 s23, s25, 1
    s_lshl_b32 s23, s23, 2
    s_lshr_b32 s27, s26, 3
    s_add_u32 s23, s23, s27
    s_and_b32 s24, s25, 1
    s_lshl_b32 s24, s24, 3
    s_and_b32 s27, s26, 7
    s_add_u32 s24, s24, s27
    s_lshl_b32 s30, s23, 3
    s_lshl_b32 s31, s20, 1
    s_add_u32 s31, s30, s31
    s_mul_i32 s29, s31, 18432
    s_add_u32 s29, s29, s21
    s_add_u32 s35, s29, 0x600000
    s_add_u32 s29, s29, 0x0
    s_max_u32 s30, s30, 1
    s_sub_u32 s30, s30, 1
    s_lshl_b32 s30, s30, 10
    s_add_u32 s30, s30, s21
    s_add_u32 s30, s30, 0x1b00000
    s_lshl_b32 s32, s31, 10
    s_add_u32 s32, s32, s21
    s_add_u32 s32, s32, 0x1b00000
    v_bfe_u32 v2, v1, 4, 4
    v_lshrrev_b32 v3, 8, v1
    s_lshl_b32 s33, s20, 2
    s_lshr_b32 s33, 0x3362, s33
    s_and_b32 s33, s33, 15
    s_min_u32 s34, s20, 1
    s_add_u32 s34, s34, 4
    s_lshl_b32 s36, s33, 10
    s_lshl_b32 s37, s34, 10
    v_add_u32 v247, 64512, v1
    v_add_u32 v248, 131072, v1
    v_add_u32 v249, s36, v1
    v_add_u32 v250, s36, v247
    v_add_u32 v251, s37, v1
    v_add_u32_e64 v252, s37, v247
    v_add_u32 v253, 18432, v1
    v_lshrrev_b32 v0, 1, v1
    s_add_u32 s38, s29, 0
    s_add_u32 s39, s29, 4096
    s_add_u32 s40, s29, 8192
    s_add_u32 s41, s29, 12288
    s_add_u32 s42, s29, 16384
    s_max_u32 s44, s23, 1
    s_sub_u32 s44, s44, 1
    s_lshl_b32 s52, s22, 7
    s_add_u32 s52, s52, s23
    s_lshl_b32 s52, s52, 8
    s_add_u32 s52, s52, 0x4503000
    s_add_u32 s52, s52, s4
    s_addc_u32 s53, s5, 0
    s_lshl_b32 s54, s22, 7
    s_add_u32 s54, s54, s44
    s_lshl_b32 s54, s54, 8
    s_add_u32 s54, s54, 0x4503000
    s_add_u32 s54, s54, s4
    s_addc_u32 s55, s5, 0
    s_lshl_b32 s44, s24, 8
    s_add_u32 s44, s44, 0x4500000
    s_add_u32 s44, s44, s4
    s_addc_u32 s45, s5, 0
    s_waitcnt vmcnt(0)
    s_barrier
    s_cmp_lg_u32 s20, 0
    s_cbranch_scc1 L_ns_d1
    s_cmp_eq_u32 s22, 0
    s_cbranch_scc1 L_d1_first
    s_mov_b32 s56, 1
    s_atomic_add s56, s[50:51], 0
L_ns_d1:
    s_barrier
    s_cmp_lg_u32 s20, 0
    s_cbranch_scc1 L_pd_d1
    s_mov_b32 s60, 65536
L_poll_d1:
    s_mov_b32 s57, 0
    s_atomic_add s57, s[52:53], 0 glc
    s_mov_b32 s58, 0
    s_atomic_add s58, s[54:55], 0 glc
    s_mov_b32 s59, 0
    s_atomic_add s59, s[44:45], 0 glc
    s_waitcnt lgkmcnt(0)
    s_cmp_ge_u32 s59, 108
    s_cselect_b32 s59, 16, 0
    s_min_u32 s57, s57, s58
    s_min_u32 s57, s57, s59
    s_cmp_ge_u32 s57, 16
    s_cbranch_scc1 L_pd_d1
    s_sub_u32 s60, s60, 1
    s_cbranch_scc1 L_pd_d1
    s_sleep 2
    s_branch L_poll_d1
    s_nop 0
L_pd_d1:
    s_barrier
    buffer_load_dwordx4 v[160:163], v1, s[4:7], s38 offen offset:0 sc1
    buffer_load_dwordx4 v[164:167], v253, s[4:7], s38 offen offset:0 sc1
    buffer_load_dwordx4 v[168:171], v1, s[4:7], s38 offen offset:1024 sc1
    buffer_load_dwordx4 v[172:175], v253, s[4:7], s38 offen offset:1024 sc1
    buffer_load_dwordx4 v[176:179], v1, s[4:7], s38 offen offset:2048 sc1
    buffer_load_dwordx4 v[180:183], v253, s[4:7], s38 offen offset:2048 sc1
    buffer_load_dwordx4 v[184:187], v1, s[4:7], s38 offen offset:3072 sc1
    buffer_load_dwordx4 v[188:191], v253, s[4:7], s38 offen offset:3072 sc1
    s_barrier
    ds_read_b128 v[80:83], v1 offset:0
    ds_read_b128 v[84:87], v1 offset:1024
    ds_read_b128 v[88:91], v1 offset:2048
    ds_read_b128 v[92:95], v1 offset:3072
    ds_read_b128 v[96:99], v1 offset:4096
    ds_read_b128 v[100:103], v1 offset:5120
    ds_read_b128 v[104:107], v1 offset:6144
    s_lshl_b32 s50, s22, 7
    s_add_u32 s50, s50, s23
    s_lshl_b32 s50, s50, 8
    s_add_u32 s50, s50, 0x4508000
    s_add_u32 s50, s50, s4
    s_addc_u32 s51, s5, 0
    s_waitcnt vmcnt(6) lgkmcnt(3)
    v_mfma_f32_16x16x32_bf16 v[16:19], v[80:83], v[160:163], 0
    ds_read_b128 v[120:123], v1 offset:7168
    v_mfma_f32_16x16x32_bf16 v[44:47], v[80:83], v[164:167], 0
    ds_read_b128 v[124:127], v1 offset:8192
    v_mfma_f32_16x16x32_bf16 v[20:23], v[84:87], v[160:163], 0
    ds_read_b128 v[128:131], v1 offset:9216
    v_mfma_f32_16x16x32_bf16 v[48:51], v[84:87], v[164:167], 0
    ds_read_b128 v[132:135], v1 offset:10240
    v_mfma_f32_16x16x32_bf16 v[24:27], v[88:91], v[160:163], 0
    ds_read_b128 v[136:139], v1 offset:11264
    buffer_load_dwordx2 v[4:5], v0, s[4:7], s30 offen offset:0 sc1
    v_mfma_f32_16x16x32_bf16 v[52:55], v[88:91], v[164:167], 0
    ds_read_b128 v[140:143], v1 offset:12288
    buffer_load_dwordx2 v[6:7], v0, s[4:7], s30 offen offset:512 sc1
    v_mfma_f32_16x16x32_bf16 v[28:31], v[92:95], v[160:163], 0
    ds_read_b128 v[144:147], v1 offset:13312
    buffer_load_dwordx2 v[8:9], v0, s[4:7], s32 offen offset:0 sc1
    v_mfma_f32_16x16x32_bf16 v[56:59], v[92:95], v[164:167], 0
    s_waitcnt lgkmcnt(7)
    buffer_load_dwordx2 v[10:11], v0, s[4:7], s32 offen offset:512 sc1
    v_mfma_f32_16x16x32_bf16 v[32:35], v[160:163], v[96:99], 0
    buffer_load_dwordx2 v[12:13], v0, s[4:7], s32 offen offset:1024 sc1
    v_mfma_f32_16x16x32_bf16 v[60:63], v[164:167], v[96:99], 0
    buffer_load_dwordx2 v[14:15], v0, s[4:7], s32 offen offset:1536 sc1
    v_mfma_f32_16x16x32_bf16 v[36:39], v[160:163], v[100:103], 0
    buffer_load_dwordx4 v[192:195], v1, s[4:7], s39 offen offset:0 sc1
    v_mfma_f32_16x16x32_bf16 v[64:67], v[164:167], v[100:103], 0
    buffer_load_dwordx4 v[196:199], v253, s[4:7], s39 offen offset:0 sc1
    v_mfma_f32_16x16x32_bf16 v[40:43], v[104:107], v[160:163], 0
    buffer_load_dwordx4 v[200:203], v1, s[4:7], s39 offen offset:1024 sc1
    v_mfma_f32_16x16x32_bf16 v[68:71], v[104:107], v[164:167], 0
    buffer_load_dwordx4 v[204:207], v253, s[4:7], s39 offen offset:1024 sc1
    s_waitcnt vmcnt(14) lgkmcnt(3)
    s_barrier
    v_mfma_f32_16x16x32_bf16 v[16:19], v[120:123], v[168:171], v[16:19]
    ds_read_b128 v[80:83], v1 offset:14336
    v_mfma_f32_16x16x32_bf16 v[44:47], v[120:123], v[172:175], v[44:47]
    ds_read_b128 v[84:87], v1 offset:15360
    v_mfma_f32_16x16x32_bf16 v[20:23], v[124:127], v[168:171], v[20:23]
    ds_read_b128 v[88:91], v1 offset:16384
    v_mfma_f32_16x16x32_bf16 v[48:51], v[124:127], v[172:175], v[48:51]
    ds_read_b128 v[92:95], v1 offset:17408
    v_mfma_f32_16x16x32_bf16 v[24:27], v[128:131], v[168:171], v[24:27]
    ds_read_b128 v[96:99], v1 offset:18432
    v_mfma_f32_16x16x32_bf16 v[52:55], v[128:131], v[172:175], v[52:55]
    ds_read_b128 v[100:103], v1 offset:19456
    v_mfma_f32_16x16x32_bf16 v[28:31], v[132:135], v[168:171], v[28:31]
    ds_read_b128 v[104:107], v1 offset:20480
    v_mfma_f32_16x16x32_bf16 v[56:59], v[132:135], v[172:175], v[56:59]
    ds_read_b128 v[108:111], v248 offset:0
    s_waitcnt lgkmcnt(8)
    v_mfma_f32_16x16x32_bf16 v[32:35], v[168:171], v[136:139], v[32:35]
    ds_read_b128 v[112:115], v249 offset:0
    v_mfma_f32_16x16x32_bf16 v[60:63], v[172:175], v[136:139], v[60:63]
    ds_read_b128 v[116:119], v251 offset:0
    v_mfma_f32_16x16x32_bf16 v[36:39], v[168:171], v[140:143], v[36:39]
    buffer_load_dwordx4 v[160:163], v1, s[4:7], s39 offen offset:2048 sc1
    v_mfma_f32_16x16x32_bf16 v[64:67], v[172:175], v[140:143], v[64:67]
    buffer_load_dwordx4 v[164:167], v253, s[4:7], s39 offen offset:2048 sc1
    v_mfma_f32_16x16x32_bf16 v[40:43], v[144:147], v[168:171], v[40:43]
    v_mfma_f32_16x16x32_bf16 v[68:71], v[144:147], v[172:175], v[68:71]
    s_waitcnt vmcnt(14) lgkmcnt(6)
    v_mfma_f32_16x16x32_bf16 v[16:19], v[80:83], v[176:179], v[16:19]
    ds_read_b128 v[120:123], v1 offset:21504
    v_mfma_f32_16x16x32_bf16 v[44:47], v[80:83], v[180:183], v[44:47]
    ds_read_b128 v[124:127], v1 offset:22528
    v_mfma_f32_16x16x32_bf16 v[20:23], v[84:87], v[176:179], v[20:23]
    ds_read_b128 v[128:131], v1 offset:23552
    v_mfma_f32_16x16x32_bf16 v[48:51], v[84:87], v[180:183], v[48:51]
    ds_read_b128 v[132:135], v1 offset:24576
    v_mfma_f32_16x16x32_bf16 v[24:27], v[88:91], v[176:179], v[24:27]
    ds_read_b128 v[136:139], v1 offset:25600
    v_mfma_f32_16x16x32_bf16 v[52:55], v[88:91], v[180:183], v[52:55]
    ds_read_b128 v[140:143], v1 offset:26624
    v_mfma_f32_16x16x32_bf16 v[28:31], v[92:95], v[176:179], v[28:31]
    ds_read_b128 v[144:147], v1 offset:27648
    v_mfma_f32_16x16x32_bf16 v[56:59], v[92:95], v[180:183], v[56:59]
    ds_read_b128 v[148:151], v248 offset:1024
    s_waitcnt lgkmcnt(8)
    v_mfma_f32_16x16x32_bf16 v[32:35], v[176:179], v[96:99], v[32:35]
    ds_read_b128 v[152:155], v249 offset:7168
    v_mfma_f32_16x16x32_bf16 v[60:63], v[180:183], v[96:99], v[60:63]
    ds_read_b128 v[156:159], v251 offset:7168
    v_mfma_f32_16x16x32_bf16 v[36:39], v[176:179], v[100:103], v[36:39]
    buffer_load_dwordx4 v[168:171], v1, s[4:7], s39 offen offset:3072 sc1
    v_mfma_f32_16x16x32_bf16 v[64:67], v[180:183], v[100:103], v[64:67]
    buffer_load_dwordx4 v[172:175], v253, s[4:7], s39 offen offset:3072 sc1
    v_mfma_f32_16x16x32_bf16 v[40:43], v[104:107], v[176:179], v[40:43]
    v_mfma_f32_16x16x32_bf16 v[68:71], v[104:107], v[180:183], v[68:71]
    v_mfma_f32_16x16x32_bf16 v[72:75], v[112:115], v[108:111], 0
    v_mfma_f32_16x16x32_bf16 v[76:79], v[108:111], v[116:119], 0
    s_waitcnt vmcnt(8) lgkmcnt(6)
    s_barrier
    v_mfma_f32_16x16x32_bf16 v[16:19], v[120:123], v[184:187], v[16:19]
    ds_read_b128 v[80:83], v1 offset:28672
    v_mfma_f32_16x16x32_bf16 v[44:47], v[120:123], v[188:191], v[44:47]
    ds_read_b128 v[84:87], v1 offset:29696
    v_add_f32 v240, v4, v6
    v_mfma_f32_16x16x32_bf16 v[20:23], v[124:127], v[184:187], v[20:23]
    ds_read_b128 v[88:91], v1 offset:30720
    v_add_f32_e64 v241, v5, v7
    v_mfma_f32_16x16x32_bf16 v[48:51], v[124:127], v[188:191], v[48:51]
    ds_read_b128 v[92:95], v1 offset:31744
    v_add_f32_e64 v242, v8, v10
    v_mfma_f32_16x16x32_bf16 v[24:27], v[128:131], v[184:187], v[24:27]
    ds_read_b128 v[96:99], v1 offset:32768
    v_add_f32_e64 v243, v9, v11
    v_mfma_f32_16x16x32_bf16 v[52:55], v[128:131], v[188:191], v[52:55]
    ds_read_b128 v[100:103], v1 offset:33792
    v_add_f32_e64 v244, v12, v14
    v_mfma_f32_16x16x32_bf16 v[28:31], v[132:135], v[184:187], v[28:31]
    ds_read_b128 v[104:107], v1 offset:34816
    v_add_f32_e64 v245, v13, v15
    v_mfma_f32_16x16x32_bf16 v[56:59], v[132:135], v[188:191], v[56:59]
    ds_read_b128 v[108:111], v248 offset:2048
    s_waitcnt lgkmcnt(8)
    v_mfma_f32_16x16x32_bf16 v[32:35], v[184:187], v[136:139], v[32:35]
    ds_read_b128 v[112:115], v249 offset:14336
    v_mov_b32 v4, v240
    v_mfma_f32_16x16x32_bf16 v[60:63], v[188:191], v[136:139], v[60:63]
    ds_read_b128 v[116:119], v251 offset:14336
    v_mov_b32_e64 v5, v241
    v_mfma_f32_16x16x32_bf16 v[36:39], v[184:187], v[140:143], v[36:39]
    buffer_load_dwordx4 v[176:179], v1, s[4:7], s40 offen offset:0 sc1
    v_mov_b32_e64 v8, v242
    v_mfma_f32_16x16x32_bf16 v[64:67], v[188:191], v[140:143], v[64:67]
    buffer_load_dwordx4 v[180:183], v253, s[4:7], s40 offen offset:0 sc1
    v_mov_b32_e64 v9, v243
    v_mfma_f32_16x16x32_bf16 v[40:43], v[144:147], v[184:187], v[40:43]
    v_mov_b32 v12, v244
    v_mov_b32 v13, v245
    v_mfma_f32_16x16x32_bf16 v[68:71], v[144:147], v[188:191], v[68:71]
    v_permlane32_swap_b32 v240, v4
    v_permlane32_swap_b32 v241, v5
    v_mfma_f32_16x16x32_bf16 v[72:75], v[152:155], v[148:151], v[72:75]
    v_permlane32_swap_b32 v242, v8
    v_mfma_f32_16x16x32_bf16 v[76:79], v[148:151], v[156:159], v[76:79]
    v_permlane32_swap_b32 v243, v9
    s_waitcnt vmcnt(8) lgkmcnt(6)
    v_mfma_f32_16x16x32_bf16 v[16:19], v[80:83], v[192:195], v[16:19]
    ds_read_b128 v[120:123], v1 offset:35840
    v_mfma_f32_16x16x32_bf16 v[44:47], v[80:83], v[196:199], v[44:47]
    ds_read_b128 v[124:127], v1 offset:36864
    v_permlane32_swap_b32 v244, v12
    v_mfma_f32_16x16x32_bf16 v[20:23], v[84:87], v[192:195], v[20:23]
    ds_read_b128 v[128:131], v1 offset:37888
    v_permlane32_swap_b32 v245, v13
    v_mfma_f32_16x16x32_bf16 v[48:51], v[84:87], v[196:199], v[48:51]
    ds_read_b128 v[132:135], v1 offset:38912
    v_add_f32 v240, v240, v4
    v_mfma_f32_16x16x32_bf16 v[24:27], v[88:91], v[192:195], v[24:27]
    ds_read_b128 v[136:139], v1 offset:39936
    v_add_f32_e64 v241, v241, v5
    v_mfma_f32_16x16x32_bf16 v[52:55], v[88:91], v[196:199], v[52:55]
    ds_read_b128 v[140:143], v1 offset:40960
    v_add_f32_e64 v242, v242, v8
    v_mfma_f32_16x16x32_bf16 v[28:31], v[92:95], v[192:195], v[28:31]
    ds_read_b128 v[144:147], v1 offset:41984
    v_add_f32_e64 v243, v243, v9
    v_mfma_f32_16x16x32_bf16 v[56:59], v[92:95], v[196:199], v[56:59]
    ds_read_b128 v[148:151], v248 offset:3072
    s_waitcnt lgkmcnt(8)
    v_mfma_f32_16x16x32_bf16 v[32:35], v[192:195], v[96:99], v[32:35]
    ds_read_b128 v[152:155], v249 offset:21504
    v_add_f32 v244, v244, v12
    v_mfma_f32_16x16x32_bf16 v[60:63], v[196:199], v[96:99], v[60:63]
    ds_read_b128 v[156:159], v251 offset:21504
    v_add_f32_e64 v245, v245, v13
    v_mfma_f32_16x16x32_bf16 v[36:39], v[192:195], v[100:103], v[36:39]
    buffer_load_dwordx4 v[184:187], v1, s[4:7], s40 offen offset:1024 sc1
    v_mov_b32_e64 v4, v240
    v_mfma_f32_16x16x32_bf16 v[64:67], v[196:199], v[100:103], v[64:67]
    buffer_load_dwordx4 v[188:191], v253, s[4:7], s40 offen offset:1024 sc1
    v_mov_b32_e64 v5, v241
    v_mfma_f32_16x16x32_bf16 v[40:43], v[104:107], v[192:195], v[40:43]
    v_mov_b32 v8, v242
    v_mov_b32 v9, v243
    v_mfma_f32_16x16x32_bf16 v[68:71], v[104:107], v[196:199], v[68:71]
    v_mov_b32 v12, v244
    v_mov_b32 v13, v245
    v_mfma_f32_16x16x32_bf16 v[72:75], v[112:115], v[108:111], v[72:75]
    v_permlane16_swap_b32 v240, v4
    v_mfma_f32_16x16x32_bf16 v[76:79], v[108:111], v[116:119], v[76:79]
    v_permlane16_swap_b32 v241, v5
    s_waitcnt vmcnt(8) lgkmcnt(6)
    s_barrier
    v_mfma_f32_16x16x32_bf16 v[16:19], v[120:123], v[200:203], v[16:19]
    ds_read_b128 v[80:83], v1 offset:43008
    v_mfma_f32_16x16x32_bf16 v[44:47], v[120:123], v[204:207], v[44:47]
    ds_read_b128 v[84:87], v1 offset:44032
    v_permlane16_swap_b32 v242, v8
    v_mfma_f32_16x16x32_bf16 v[20:23], v[124:127], v[200:203], v[20:23]
    ds_read_b128 v[88:91], v1 offset:45056
    v_permlane16_swap_b32 v243, v9
    v_mfma_f32_16x16x32_bf16 v[48:51], v[124:127], v[204:207], v[48:51]
    ds_read_b128 v[92:95], v1 offset:46080
    v_permlane16_swap_b32 v244, v12
    v_mfma_f32_16x16x32_bf16 v[24:27], v[128:131], v[200:203], v[24:27]
    ds_read_b128 v[96:99], v1 offset:47104
    v_permlane16_swap_b32 v245, v13
    v_mfma_f32_16x16x32_bf16 v[52:55], v[128:131], v[204:207], v[52:55]
    ds_read_b128 v[100:103], v1 offset:48128
    v_add_f32_e64 v240, v240, v4
    v_mfma_f32_16x16x32_bf16 v[28:31], v[132:135], v[200:203], v[28:31]
    ds_read_b128 v[104:107], v1 offset:49152
    v_add_f32_e64 v241, v241, v5
    v_mfma_f32_16x16x32_bf16 v[56:59], v[132:135], v[204:207], v[56:59]
    ds_read_b128 v[108:111], v248 offset:4096
    s_waitcnt lgkmcnt(8)
    v_mfma_f32_16x16x32_bf16 v[32:35], v[200:203], v[136:139], v[32:35]
    ds_read_b128 v[112:115], v249 offset:28672
    v_add_f32 v242, v242, v8
    v_mfma_f32_16x16x32_bf16 v[60:63], v[204:207], v[136:139], v[60:63]
    ds_read_b128 v[116:119], v251 offset:28672
    v_add_f32_e64 v243, v243, v9
    v_mfma_f32_16x16x32_bf16 v[36:39], v[200:203], v[140:143], v[36:39]
    buffer_load_dwordx4 v[192:195], v1, s[4:7], s40 offen offset:2048 sc1
    v_add_f32_e64 v244, v244, v12
    v_mfma_f32_16x16x32_bf16 v[64:67], v[204:207], v[140:143], v[64:67]
    buffer_load_dwordx4 v[196:199], v253, s[4:7], s40 offen offset:2048 sc1
    v_add_f32_e64 v245, v245, v13
    v_mfma_f32_16x16x32_bf16 v[40:43], v[144:147], v[200:203], v[40:43]
    v_mul_f32 v240, 0x3ae38e39, v240
    v_mul_f32 v241, 0x3ae38e39, v241
    v_mfma_f32_16x16x32_bf16 v[68:71], v[144:147], v[204:207], v[68:71]
    v_mul_f32 v242, 0x3ae38e39, v242
    v_mul_f32 v243, 0x3ae38e39, v243
    v_mfma_f32_16x16x32_bf16 v[72:75], v[152:155], v[148:151], v[72:75]
    v_mul_f32 v244, 0x3ae38e39, v244
    v_mfma_f32_16x16x32_bf16 v[76:79], v[148:151], v[156:159], v[76:79]
    v_mul_f32 v245, 0x3ae38e39, v245
    s_waitcnt vmcnt(8) lgkmcnt(6)
    v_mfma_f32_16x16x32_bf16 v[16:19], v[80:83], v[160:163], v[16:19]
    ds_read_b128 v[120:123], v1 offset:50176
    v_mfma_f32_16x16x32_bf16 v[44:47], v[80:83], v[164:167], v[44:47]
    ds_read_b128 v[124:127], v1 offset:51200
    v_fma_f32 v241, -v240, v240, v241
    v_mfma_f32_16x16x32_bf16 v[20:23], v[84:87], v[160:163], v[20:23]
    ds_read_b128 v[128:131], v1 offset:52224
    v_fma_f32 v243, -v242, v242, v243
    v_mfma_f32_16x16x32_bf16 v[48:51], v[84:87], v[164:167], v[48:51]
    ds_read_b128 v[132:135], v1 offset:53248
    v_fma_f32 v245, -v244, v244, v245
    v_mfma_f32_16x16x32_bf16 v[24:27], v[88:91], v[160:163], v[24:27]
    ds_read_b128 v[136:139], v1 offset:54272
    v_max_f32 v241, 0, v241
    v_mfma_f32_16x16x32_bf16 v[52:55], v[88:91], v[164:167], v[52:55]
    ds_read_b128 v[140:143], v1 offset:55296
    v_max_f32_e64 v243, 0, v243
    v_mfma_f32_16x16x32_bf16 v[28:31], v[92:95], v[160:163], v[28:31]
    ds_read_b128 v[144:147], v1 offset:56320
    v_max_f32_e64 v245, 0, v245
    v_mfma_f32_16x16x32_bf16 v[56:59], v[92:95], v[164:167], v[56:59]
    ds_read_b128 v[148:151], v248 offset:5120
    s_waitcnt lgkmcnt(8)
    v_mfma_f32_16x16x32_bf16 v[32:35], v[160:163], v[96:99], v[32:35]
    ds_read_b128 v[152:155], v249 offset:35840
    v_add_f32 v241, 0x3727c5ac, v241
    v_mfma_f32_16x16x32_bf16 v[60:63], v[164:167], v[96:99], v[60:63]
    ds_read_b128 v[156:159], v251 offset:35840
    v_add_f32 v243, 0x3727c5ac, v243
    v_mfma_f32_16x16x32_bf16 v[36:39], v[160:163], v[100:103], v[36:39]
    buffer_load_dwordx4 v[200:203], v1, s[4:7], s40 offen offset:3072 sc1
    v_add_f32 v245, 0x3727c5ac, v245
    v_mfma_f32_16x16x32_bf16 v[64:67], v[164:167], v[100:103], v[64:67]
    buffer_load_dwordx4 v[204:207], v253, s[4:7], s40 offen offset:3072 sc1
    v_rsq_f32 v241, v241
    v_mfma_f32_16x16x32_bf16 v[40:43], v[104:107], v[160:163], v[40:43]
    v_rsq_f32 v243, v243
    v_rsq_f32 v245, v245
    v_mfma_f32_16x16x32_bf16 v[68:71], v[104:107], v[164:167], v[68:71]
    s_nop 0
    v_lshlrev_b32 v255, 4, v3
    v_mfma_f32_16x16x32_bf16 v[72:75], v[112:115], v[108:111], v[72:75]
    v_add_u32 v236, 161792, v255
    v_mfma_f32_16x16x32_bf16 v[76:79], v[108:111], v[116:119], v[76:79]
    s_lshl_b32 s36, s33, 6
    s_waitcnt vmcnt(8) lgkmcnt(6)
    v_mfma_f32_16x16x32_bf16 v[16:19], v[120:123], v[168:171], v[16:19]
    ds_read_b128 v[80:83], v1 offset:57344
    v_mfma_f32_16x16x32_bf16 v[44:47], v[120:123], v[172:175], v[44:47]
    ds_read_b128 v[84:87], v1 offset:58368
    v_add_u32_e64 v237, s36, v236
    v_mfma_f32_16x16x32_bf16 v[20:23], v[124:127], v[168:171], v[20:23]
    ds_read_b128 v[88:91], v1 offset:59392
    v_lshlrev_b32_e64 v254, 2, v2
    v_mfma_f32_16x16x32_bf16 v[48:51], v[124:127], v[172:175], v[48:51]
    ds_read_b128 v[92:95], v1 offset:60416
    v_add_u32 v238, 161792, v254
    v_mfma_f32_16x16x32_bf16 v[24:27], v[128:131], v[168:171], v[24:27]
    ds_read_b128 v[96:99], v1 offset:61440
    s_lshl_b32 s37, s34, 6
    v_mfma_f32_16x16x32_bf16 v[52:55], v[128:131], v[172:175], v[52:55]
    ds_read_b128 v[100:103], v1 offset:62464
    v_add_u32 v239, s37, v238
    v_mfma_f32_16x16x32_bf16 v[28:31], v[132:135], v[168:171], v[28:31]
    ds_read_b128 v[104:107], v1 offset:63488
    s_mul_i32 s36, s20, 3072
    v_mfma_f32_16x16x32_bf16 v[56:59], v[132:135], v[172:175], v[56:59]
    ds_read_b128 v[108:111], v248 offset:6144
    s_waitcnt lgkmcnt(8)
    v_mfma_f32_16x16x32_bf16 v[32:35], v[168:171], v[136:139], v[32:35]
    ds_read_b128 v[112:115], v249 offset:43008
    s_add_u32 s36, s36, 153600
    v_mfma_f32_16x16x32_bf16 v[60:63], v[172:175], v[136:139], v[60:63]
    ds_read_b128 v[116:119], v251 offset:43008
    v_add_u32 v254, s36, v254
    v_mfma_f32_16x16x32_bf16 v[36:39], v[168:171], v[140:143], v[36:39]
    buffer_load_dwordx4 v[160:163], v1, s[4:7], s41 offen offset:0 sc1
    v_add_u32_e64 v255, s36, v255
    v_mfma_f32_16x16x32_bf16 v[64:67], v[172:175], v[140:143], v[64:67]
    buffer_load_dwordx4 v[164:167], v253, s[4:7], s41 offen offset:0 sc1
    v_mfma_f32_16x16x32_bf16 v[40:43], v[144:147], v[168:171], v[40:43]
    v_mfma_f32_16x16x32_bf16 v[68:71], v[144:147], v[172:175], v[68:71]
    ds_write2_b32 v254, v240, v241 offset0:0 offset1:16
    v_mfma_f32_16x16x32_bf16 v[72:75], v[152:155], v[148:151], v[72:75]
    ds_write2_b32 v254, v242, v243 offset0:32 offset1:48
    v_mfma_f32_16x16x32_bf16 v[76:79], v[148:151], v[156:159], v[76:79]
    ds_write2_b32 v254, v244, v245 offset0:64 offset1:80
    s_waitcnt vmcnt(8) lgkmcnt(9)
    s_barrier
    v_mfma_f32_16x16x32_bf16 v[16:19], v[80:83], v[176:179], v[16:19]
    ds_read_b128 v[120:123], v247 offset:0
    v_mfma_f32_16x16x32_bf16 v[44:47], v[80:83], v[180:183], v[44:47]
    ds_read_b128 v[124:127], v247 offset:1024
    v_mfma_f32_16x16x32_bf16 v[20:23], v[84:87], v[176:179], v[20:23]
    ds_read_b128 v[128:131], v247 offset:2048
    v_mfma_f32_16x16x32_bf16 v[48:51], v[84:87], v[180:183], v[48:51]
    ds_read_b128 v[132:135], v247 offset:3072
    v_mfma_f32_16x16x32_bf16 v[24:27], v[88:91], v[176:179], v[24:27]
    ds_read_b128 v[136:139], v247 offset:4096
    v_mfma_f32_16x16x32_bf16 v[52:55], v[88:91], v[180:183], v[52:55]
    ds_read_b128 v[140:143], v247 offset:5120
    v_mfma_f32_16x16x32_bf16 v[28:31], v[92:95], v[176:179], v[28:31]
    ds_read_b128 v[144:147], v247 offset:6144
    v_mfma_f32_16x16x32_bf16 v[56:59], v[92:95], v[180:183], v[56:59]
    ds_read_b128 v[148:151], v248 offset:7168
    s_waitcnt lgkmcnt(8)
    v_mfma_f32_16x16x32_bf16 v[32:35], v[176:179], v[96:99], v[32:35]
    ds_read_b128 v[152:155], v249 offset:50176
    v_mfma_f32_16x16x32_bf16 v[60:63], v[180:183], v[96:99], v[60:63]
    ds_read_b128 v[156:159], v251 offset:50176
    v_mfma_f32_16x16x32_bf16 v[36:39], v[176:179], v[100:103], v[36:39]
    buffer_load_dwordx4 v[168:171], v1, s[4:7], s41 offen offset:1024 sc1
    ds_read_b128 v[208:211], v236 offset:0
    v_mfma_f32_16x16x32_bf16 v[64:67], v[180:183], v[100:103], v[64:67]
    buffer_load_dwordx4 v[172:175], v253, s[4:7], s41 offen offset:1024 sc1
    ds_read_b128 v[212:215], v236 offset:64
    v_mfma_f32_16x16x32_bf16 v[40:43], v[104:107], v[176:179], v[40:43]
    ds_read_b128 v[216:219], v236 offset:128
    v_mfma_f32_16x16x32_bf16 v[68:71], v[104:107], v[180:183], v[68:71]
    ds_read_b128 v[220:223], v236 offset:192
    v_mfma_f32_16x16x32_bf16 v[72:75], v[112:115], v[108:111], v[72:75]
    ds_read_b128 v[224:227], v236 offset:384
    v_mfma_f32_16x16x32_bf16 v[76:79], v[108:111], v[116:119], v[76:79]
    ds_read_b128 v[228:231], v237
    s_waitcnt vmcnt(8) lgkmcnt(12)
    v_mfma_f32_16x16x32_bf16 v[16:19], v[120:123], v[184:187], v[16:19]
    ds_read_b128 v[80:83], v247 offset:7168
    v_mfma_f32_16x16x32_bf16 v[44:47], v[120:123], v[188:191], v[44:47]
    ds_read_b128 v[84:87], v247 offset:8192
    v_mfma_f32_16x16x32_bf16 v[20:23], v[124:127], v[184:187], v[20:23]
    ds_read_b128 v[88:91], v247 offset:9216
    v_mfma_f32_16x16x32_bf16 v[48:51], v[124:127], v[188:191], v[48:51]
    ds_read_b128 v[92:95], v247 offset:10240
    v_mfma_f32_16x16x32_bf16 v[24:27], v[128:131], v[184:187], v[24:27]
    ds_read_b128 v[96:99], v247 offset:11264
    v_mfma_f32_16x16x32_bf16 v[52:55], v[128:131], v[188:191], v[52:55]
    ds_read_b128 v[100:103], v247 offset:12288
    v_mfma_f32_16x16x32_bf16 v[28:31], v[132:135], v[184:187], v[28:31]
    ds_read_b128 v[104:107], v247 offset:13312
    v_mfma_f32_16x16x32_bf16 v[56:59], v[132:135], v[188:191], v[56:59]
    ds_read_b128 v[108:111], v248 offset:8192
    s_waitcnt lgkmcnt(8)
    v_mfma_f32_16x16x32_bf16 v[32:35], v[184:187], v[136:139], v[32:35]
    ds_read_b128 v[112:115], v249 offset:57344
    v_mfma_f32_16x16x32_bf16 v[60:63], v[188:191], v[136:139], v[60:63]
    ds_read_b128 v[116:119], v251 offset:57344
    v_mfma_f32_16x16x32_bf16 v[36:39], v[184:187], v[140:143], v[36:39]
    buffer_load_dwordx4 v[176:179], v1, s[4:7], s41 offen offset:2048 sc1
    v_mfma_f32_16x16x32_bf16 v[64:67], v[188:191], v[140:143], v[64:67]
    buffer_load_dwordx4 v[180:183], v253, s[4:7], s41 offen offset:2048 sc1
    ds_read2_b32 v[232:233], v238 offset0:64 offset1:80
    v_mfma_f32_16x16x32_bf16 v[40:43], v[144:147], v[184:187], v[40:43]
    ds_read_b32 v234, v239
    v_mfma_f32_16x16x32_bf16 v[68:71], v[144:147], v[188:191], v[68:71]
    ds_read_b128 v[4:7], v255 offset:0
    v_mfma_f32_16x16x32_bf16 v[72:75], v[152:155], v[148:151], v[72:75]
    ds_read_b128 v[8:11], v255 offset:128
    v_mfma_f32_16x16x32_bf16 v[76:79], v[148:151], v[156:159], v[76:79]
    ds_read_b128 v[12:15], v255 offset:256
    s_waitcnt vmcnt(8) lgkmcnt(11)
    s_barrier
    v_mfma_f32_16x16x32_bf16 v[16:19], v[80:83], v[192:195], v[16:19]
    ds_read_b128 v[120:123], v247 offset:14336
    v_mfma_f32_16x16x32_bf16 v[44:47], v[80:83], v[196:199], v[44:47]
    ds_read_b128 v[124:127], v247 offset:15360
    v_mfma_f32_16x16x32_bf16 v[20:23], v[84:87], v[192:195], v[20:23]
    ds_read_b128 v[128:131], v247 offset:16384
    v_mfma_f32_16x16x32_bf16 v[48:51], v[84:87], v[196:199], v[48:51]
    ds_read_b128 v[132:135], v247 offset:17408
    v_mfma_f32_16x16x32_bf16 v[24:27], v[88:91], v[192:195], v[24:27]
    ds_read_b128 v[136:139], v247 offset:18432
    v_mfma_f32_16x16x32_bf16 v[52:55], v[88:91], v[196:199], v[52:55]
    ds_read_b128 v[140:143], v247 offset:19456
    v_mfma_f32_16x16x32_bf16 v[28:31], v[92:95], v[192:195], v[28:31]
    ds_read_b128 v[144:147], v247 offset:20480
    v_mfma_f32_16x16x32_bf16 v[56:59], v[92:95], v[196:199], v[56:59]
    ds_read_b128 v[148:151], v248 offset:9216
    s_waitcnt lgkmcnt(8)
    v_mfma_f32_16x16x32_bf16 v[32:35], v[192:195], v[96:99], v[32:35]
    ds_read_b128 v[152:155], v250 offset:0
    v_mfma_f32_16x16x32_bf16 v[60:63], v[196:199], v[96:99], v[60:63]
    ds_read_b128 v[156:159], v252 offset:0
    v_mfma_f32_16x16x32_bf16 v[36:39], v[192:195], v[100:103], v[36:39]
    buffer_load_dwordx4 v[184:187], v1, s[4:7], s41 offen offset:3072 sc1
    v_mfma_f32_16x16x32_bf16 v[64:67], v[196:199], v[100:103], v[64:67]
    buffer_load_dwordx4 v[188:191], v253, s[4:7], s41 offen offset:3072 sc1
    v_mfma_f32_16x16x32_bf16 v[40:43], v[104:107], v[192:195], v[40:43]
    v_mfma_f32_16x16x32_bf16 v[68:71], v[104:107], v[196:199], v[68:71]
    v_mfma_f32_16x16x32_bf16 v[72:75], v[112:115], v[108:111], v[72:75]
    v_mfma_f32_16x16x32_bf16 v[76:79], v[108:111], v[116:119], v[76:79]
    s_waitcnt vmcnt(8) lgkmcnt(6)
    v_mfma_f32_16x16x32_bf16 v[16:19], v[120:123], v[200:203], v[16:19]
    ds_read_b128 v[80:83], v247 offset:21504
    v_fma_f32 v32, -v8, v232, v32
    v_mfma_f32_16x16x32_bf16 v[44:47], v[120:123], v[204:207], v[44:47]
    ds_read_b128 v[84:87], v247 offset:22528
    v_fma_f32 v60, -v12, v232, v60
    v_mfma_f32_16x16x32_bf16 v[20:23], v[124:127], v[200:203], v[20:23]
    ds_read_b128 v[88:91], v247 offset:23552
    v_fma_f32 v36, -v8, v233, v36
    v_mfma_f32_16x16x32_bf16 v[48:51], v[124:127], v[204:207], v[48:51]
    ds_read_b128 v[92:95], v247 offset:24576
    v_fma_f32 v64, -v12, v233, v64
    v_mfma_f32_16x16x32_bf16 v[24:27], v[128:131], v[200:203], v[24:27]
    ds_read_b128 v[96:99], v247 offset:25600
    v_fma_f32 v40, -v242, v224, v40
    v_mfma_f32_16x16x32_bf16 v[52:55], v[128:131], v[204:207], v[52:55]
    ds_read_b128 v[100:103], v247 offset:26624
    v_fma_f32 v68, -v244, v224, v68
    v_mfma_f32_16x16x32_bf16 v[28:31], v[132:135], v[200:203], v[28:31]
    ds_read_b128 v[104:107], v247 offset:27648
    v_fma_f32 v72, -v240, v228, v72
    v_mfma_f32_16x16x32_bf16 v[56:59], v[132:135], v[204:207], v[56:59]
    ds_read_b128 v[108:111], v248 offset:10240
    s_waitcnt lgkmcnt(8)
    v_fma_f32 v76, -v4, v234, v76
    v_mfma_f32_16x16x32_bf16 v[32:35], v[200:203], v[136:139], v[32:35]
    ds_read_b128 v[112:115], v250 offset:7168
    v_fma_f32 v16, -v242, v208, v16
    v_mfma_f32_16x16x32_bf16 v[60:63], v[204:207], v[136:139], v[60:63]
    ds_read_b128 v[116:119], v252 offset:7168
    v_fma_f32 v44, -v244, v208, v44
    v_mfma_f32_16x16x32_bf16 v[36:39], v[200:203], v[140:143], v[36:39]
    buffer_load_dwordx4 v[192:195], v1, s[4:7], s42 offen offset:0 sc1
    v_fma_f32 v20, -v242, v212, v20
    v_mfma_f32_16x16x32_bf16 v[64:67], v[204:207], v[140:143], v[64:67]
    buffer_load_dwordx4 v[196:199], v253, s[4:7], s42 offen offset:0 sc1
    v_fma_f32 v48, -v244, v212, v48
    v_mfma_f32_16x16x32_bf16 v[40:43], v[144:147], v[200:203], v[40:43]
    v_fma_f32 v24, -v242, v216, v24
    v_mfma_f32_16x16x32_bf16 v[68:71], v[144:147], v[204:207], v[68:71]
    v_fma_f32 v52, -v244, v216, v52
    v_mfma_f32_16x16x32_bf16 v[72:75], v[152:155], v[148:151], v[72:75]
    v_fma_f32 v28, -v242, v220, v28
    v_mfma_f32_16x16x32_bf16 v[76:79], v[148:151], v[156:159], v[76:79]
    v_fma_f32 v56, -v244, v220, v56
    s_waitcnt vmcnt(8) lgkmcnt(6)
    s_barrier
    v_mfma_f32_16x16x32_bf16 v[16:19], v[80:83], v[160:163], v[16:19]
    ds_read_b128 v[120:123], v247 offset:28672
    v_fma_f32 v33, -v9, v232, v33
    v_mfma_f32_16x16x32_bf16 v[44:47], v[80:83], v[164:167], v[44:47]
    ds_read_b128 v[124:127], v247 offset:29696
    v_fma_f32 v61, -v13, v232, v61
    v_mfma_f32_16x16x32_bf16 v[20:23], v[84:87], v[160:163], v[20:23]
    ds_read_b128 v[128:131], v247 offset:30720
    v_fma_f32 v37, -v9, v233, v37
    v_mfma_f32_16x16x32_bf16 v[48:51], v[84:87], v[164:167], v[48:51]
    ds_read_b128 v[132:135], v247 offset:31744
    v_fma_f32 v65, -v13, v233, v65
    v_mfma_f32_16x16x32_bf16 v[24:27], v[88:91], v[160:163], v[24:27]
    ds_read_b128 v[136:139], v247 offset:32768
    v_fma_f32 v41, -v242, v225, v41
    v_mfma_f32_16x16x32_bf16 v[52:55], v[88:91], v[164:167], v[52:55]
    ds_read_b128 v[140:143], v247 offset:33792
    v_fma_f32 v69, -v244, v225, v69
    v_mfma_f32_16x16x32_bf16 v[28:31], v[92:95], v[160:163], v[28:31]
    ds_read_b128 v[144:147], v247 offset:34816
    v_fma_f32 v73, -v240, v229, v73
    v_mfma_f32_16x16x32_bf16 v[56:59], v[92:95], v[164:167], v[56:59]
    ds_read_b128 v[148:151], v248 offset:11264
    s_waitcnt lgkmcnt(8)
    v_fma_f32 v77, -v5, v234, v77
    v_mfma_f32_16x16x32_bf16 v[32:35], v[160:163], v[96:99], v[32:35]
    ds_read_b128 v[152:155], v250 offset:14336
    v_fma_f32 v17, -v242, v209, v17
    v_mfma_f32_16x16x32_bf16 v[60:63], v[164:167], v[96:99], v[60:63]
    ds_read_b128 v[156:159], v252 offset:14336
    v_fma_f32 v45, -v244, v209, v45
    v_mfma_f32_16x16x32_bf16 v[36:39], v[160:163], v[100:103], v[36:39]
    buffer_load_dwordx4 v[200:203], v1, s[4:7], s42 offen offset:1024 sc1
    v_fma_f32 v21, -v242, v213, v21
    v_mfma_f32_16x16x32_bf16 v[64:67], v[164:167], v[100:103], v[64:67]
    buffer_load_dwordx4 v[204:207], v253, s[4:7], s42 offen offset:1024 sc1
    v_fma_f32 v49, -v244, v213, v49
    v_mfma_f32_16x16x32_bf16 v[40:43], v[104:107], v[160:163], v[40:43]
    v_fma_f32 v25, -v242, v217, v25
    v_mfma_f32_16x16x32_bf16 v[68:71], v[104:107], v[164:167], v[68:71]
    v_fma_f32 v53, -v244, v217, v53
    v_mfma_f32_16x16x32_bf16 v[72:75], v[112:115], v[108:111], v[72:75]
    v_fma_f32 v29, -v242, v221, v29
    v_mfma_f32_16x16x32_bf16 v[76:79], v[108:111], v[116:119], v[76:79]
    v_fma_f32 v57, -v244, v221, v57
    s_waitcnt vmcnt(8) lgkmcnt(6)
    v_mfma_f32_16x16x32_bf16 v[16:19], v[120:123], v[168:171], v[16:19]
    ds_read_b128 v[80:83], v247 offset:35840
    v_fma_f32 v34, -v10, v232, v34
    v_mfma_f32_16x16x32_bf16 v[44:47], v[120:123], v[172:175], v[44:47]
    ds_read_b128 v[84:87], v247 offset:36864
    v_fma_f32 v62, -v14, v232, v62
    v_mfma_f32_16x16x32_bf16 v[20:23], v[124:127], v[168:171], v[20:23]
    ds_read_b128 v[88:91], v247 offset:37888
    v_fma_f32 v38, -v10, v233, v38
    v_mfma_f32_16x16x32_bf16 v[48:51], v[124:127], v[172:175], v[48:51]
    ds_read_b128 v[92:95], v247 offset:38912
    v_fma_f32 v66, -v14, v233, v66
    v_mfma_f32_16x16x32_bf16 v[24:27], v[128:131], v[168:171], v[24:27]
    ds_read_b128 v[96:99], v247 offset:39936
    v_fma_f32 v42, -v242, v226, v42
    v_mfma_f32_16x16x32_bf16 v[52:55], v[128:131], v[172:175], v[52:55]
    ds_read_b128 v[100:103], v247 offset:40960
    v_fma_f32 v70, -v244, v226, v70
    v_mfma_f32_16x16x32_bf16 v[28:31], v[132:135], v[168:171], v[28:31]
    ds_read_b128 v[104:107], v247 offset:41984
    v_fma_f32 v74, -v240, v230, v74
    v_mfma_f32_16x16x32_bf16 v[56:59], v[132:135], v[172:175], v[56:59]
    ds_read_b128 v[108:111], v248 offset:12288
    s_waitcnt lgkmcnt(8)
    v_fma_f32 v78, -v6, v234, v78
    v_mfma_f32_16x16x32_bf16 v[32:35], v[168:171], v[136:139], v[32:35]
    ds_read_b128 v[112:115], v250 offset:21504
    v_fma_f32 v18, -v242, v210, v18
    v_mfma_f32_16x16x32_bf16 v[60:63], v[172:175], v[136:139], v[60:63]
    ds_read_b128 v[116:119], v252 offset:21504
    v_fma_f32 v46, -v244, v210, v46
    v_mfma_f32_16x16x32_bf16 v[36:39], v[168:171], v[140:143], v[36:39]
    v_fma_f32 v22, -v242, v214, v22
    v_mfma_f32_16x16x32_bf16 v[64:67], v[172:175], v[140:143], v[64:67]
    v_fma_f32 v50, -v244, v214, v50
    v_mfma_f32_16x16x32_bf16 v[40:43], v[144:147], v[168:171], v[40:43]
    v_fma_f32 v26, -v242, v218, v26
    v_mfma_f32_16x16x32_bf16 v[68:71], v[144:147], v[172:175], v[68:71]
    v_fma_f32 v54, -v244, v218, v54
    v_mfma_f32_16x16x32_bf16 v[72:75], v[152:155], v[148:151], v[72:75]
    v_fma_f32 v30, -v242, v222, v30
    v_mfma_f32_16x16x32_bf16 v[76:79], v[148:151], v[156:159], v[76:79]
    v_fma_f32 v58, -v244, v222, v58
    s_waitcnt vmcnt(6) lgkmcnt(6)
    v_mfma_f32_16x16x32_bf16 v[16:19], v[80:83], v[176:179], v[16:19]
    ds_read_b128 v[120:123], v247 offset:43008
    v_fma_f32 v35, -v11, v232, v35
    v_mfma_f32_16x16x32_bf16 v[44:47], v[80:83], v[180:183], v[44:47]
    ds_read_b128 v[124:127], v247 offset:44032
    v_fma_f32 v63, -v15, v232, v63
    v_mfma_f32_16x16x32_bf16 v[20:23], v[84:87], v[176:179], v[20:23]
    ds_read_b128 v[128:131], v247 offset:45056
    v_fma_f32 v39, -v11, v233, v39
    v_mfma_f32_16x16x32_bf16 v[48:51], v[84:87], v[180:183], v[48:51]
    ds_read_b128 v[132:135], v247 offset:46080
    v_fma_f32 v67, -v15, v233, v67
    v_mfma_f32_16x16x32_bf16 v[24:27], v[88:91], v[176:179], v[24:27]
    ds_read_b128 v[136:139], v247 offset:47104
    v_fma_f32 v43, -v242, v227, v43
    v_mfma_f32_16x16x32_bf16 v[52:55], v[88:91], v[180:183], v[52:55]
    ds_read_b128 v[140:143], v247 offset:48128
    v_fma_f32 v71, -v244, v227, v71
    v_mfma_f32_16x16x32_bf16 v[28:31], v[92:95], v[176:179], v[28:31]
    ds_read_b128 v[144:147], v247 offset:49152
    v_fma_f32 v75, -v240, v231, v75
    v_mfma_f32_16x16x32_bf16 v[56:59], v[92:95], v[180:183], v[56:59]
    ds_read_b128 v[148:151], v248 offset:13312
    s_waitcnt lgkmcnt(8)
    v_fma_f32 v79, -v7, v234, v79
    v_mfma_f32_16x16x32_bf16 v[32:35], v[176:179], v[96:99], v[32:35]
    ds_read_b128 v[152:155], v250 offset:28672
    v_fma_f32 v19, -v242, v211, v19
    v_mfma_f32_16x16x32_bf16 v[60:63], v[180:183], v[96:99], v[60:63]
    ds_read_b128 v[156:159], v252 offset:28672
    v_fma_f32 v47, -v244, v211, v47
    v_mfma_f32_16x16x32_bf16 v[36:39], v[176:179], v[100:103], v[36:39]
    v_fma_f32 v23, -v242, v215, v23
    v_mfma_f32_16x16x32_bf16 v[64:67], v[180:183], v[100:103], v[64:67]
    v_fma_f32 v51, -v244, v215, v51
    v_mfma_f32_16x16x32_bf16 v[40:43], v[104:107], v[176:179], v[40:43]
    v_fma_f32 v27, -v242, v219, v27
    v_mfma_f32_16x16x32_bf16 v[68:71], v[104:107], v[180:183], v[68:71]
    v_fma_f32 v55, -v244, v219, v55
    v_mfma_f32_16x16x32_bf16 v[72:75], v[112:115], v[108:111], v[72:75]
    v_fma_f32 v31, -v242, v223, v31
    v_mfma_f32_16x16x32_bf16 v[76:79], v[108:111], v[116:119], v[76:79]
    v_fma_f32 v59, -v244, v223, v59
    s_waitcnt vmcnt(4) lgkmcnt(6)
    s_barrier
    v_mfma_f32_16x16x32_bf16 v[16:19], v[120:123], v[184:187], v[16:19]
    ds_read_b128 v[80:83], v247 offset:50176
    v_mfma_f32_16x16x32_bf16 v[44:47], v[120:123], v[188:191], v[44:47]
    ds_read_b128 v[84:87], v247 offset:51200
    v_and_b32 v4, 1, v2
    v_mfma_f32_16x16x32_bf16 v[20:23], v[124:127], v[184:187], v[20:23]
    ds_read_b128 v[88:91], v247 offset:52224
    v_lshl_add_u32 v5, v3, 2, v4
    v_mfma_f32_16x16x32_bf16 v[48:51], v[124:127], v[188:191], v[48:51]
    ds_read_b128 v[92:95], v247 offset:53248
    v_add_u32_e64 v6, 2, v5
    v_mfma_f32_16x16x32_bf16 v[24:27], v[128:131], v[184:187], v[24:27]
    ds_read_b128 v[96:99], v247 offset:54272
    v_cmp_eq_u32 s[40:41], 1, v4
    v_mfma_f32_16x16x32_bf16 v[52:55], v[128:131], v[188:191], v[52:55]
    ds_read_b128 v[100:103], v247 offset:55296
    v_cmp_le_u32 s[42:43], v5, v2
    v_mfma_f32_16x16x32_bf16 v[28:31], v[132:135], v[184:187], v[28:31]
    ds_read_b128 v[104:107], v247 offset:56320
    v_cmp_le_u32 s[44:45], v6, v2
    v_mfma_f32_16x16x32_bf16 v[56:59], v[132:135], v[188:191], v[56:59]
    ds_read_b128 v[108:111], v248 offset:14336
    s_waitcnt lgkmcnt(8)
    v_mfma_f32_16x16x32_bf16 v[32:35], v[184:187], v[136:139], v[32:35]
    ds_read_b128 v[112:115], v250 offset:35840
    v_mov_b32 v4, 0x0c0c0100
    v_mfma_f32_16x16x32_bf16 v[60:63], v[188:191], v[136:139], v[60:63]
    ds_read_b128 v[116:119], v252 offset:35840
    v_mov_b32 v5, 0x01000c0c
    v_mfma_f32_16x16x32_bf16 v[36:39], v[184:187], v[140:143], v[36:39]
    v_mov_b32 v6, 0x0c0c0302
    v_mov_b32 v7, 0x03020c0c
    v_mfma_f32_16x16x32_bf16 v[64:67], v[188:191], v[140:143], v[64:67]
    v_mov_b32 v8, 0x0c0c0c0c
    v_cndmask_b32 v4, v4, v5, s[40:41]
    v_mfma_f32_16x16x32_bf16 v[40:43], v[144:147], v[184:187], v[40:43]
    v_cndmask_b32 v6, v6, v7, s[40:41]
    v_cndmask_b32 v12, v4, v8, s[42:43]
    v_mfma_f32_16x16x32_bf16 v[68:71], v[144:147], v[188:191], v[68:71]
    v_cndmask_b32 v13, v6, v8, s[44:45]
    v_cndmask_b32 v14, v8, v4, s[42:43]
    v_mfma_f32_16x16x32_bf16 v[72:75], v[152:155], v[148:151], v[72:75]
    v_cndmask_b32 v15, v8, v6, s[44:45]
    s_cmp_eq_u32 s31, 0
    v_mfma_f32_16x16x32_bf16 v[76:79], v[148:151], v[156:159], v[76:79]
    s_cselect_b64 s[48:49], s[42:43], -1
    s_cselect_b64 s[38:39], s[44:45], -1
    s_waitcnt vmcnt(2) lgkmcnt(6)
    v_mfma_f32_16x16x32_bf16 v[16:19], v[80:83], v[192:195], v[16:19]
    ds_read_b128 v[120:123], v247 offset:57344
    v_mfma_f32_16x16x32_bf16 v[44:47], v[80:83], v[196:199], v[44:47]
    ds_read_b128 v[124:127], v247 offset:58368
    s_mul_i32 s36, s20, 3072
    v_mfma_f32_16x16x32_bf16 v[20:23], v[84:87], v[192:195], v[20:23]
    ds_read_b128 v[128:131], v247 offset:59392
    s_add_u32 s36, s36, 149504
    v_mfma_f32_16x16x32_bf16 v[48:51], v[84:87], v[196:199], v[48:51]
    ds_read_b128 v[132:135], v247 offset:60416
    v_add_u32 v9, s36, v0
    v_mfma_f32_16x16x32_bf16 v[24:27], v[88:91], v[192:195], v[24:27]
    ds_read_b128 v[136:139], v247 offset:61440
    s_lshl_b32 s37, s20, 9
    v_mfma_f32_16x16x32_bf16 v[52:55], v[88:91], v[196:199], v[52:55]
    ds_read_b128 v[140:143], v247 offset:62464
    s_add_u32 s37, s37, 149504
    v_mfma_f32_16x16x32_bf16 v[28:31], v[92:95], v[192:195], v[28:31]
    ds_read_b128 v[144:147], v247 offset:63488
    v_add_u32 v10, s37, v0
    v_mfma_f32_16x16x32_bf16 v[56:59], v[92:95], v[196:199], v[56:59]
    ds_read_b128 v[148:151], v248 offset:15360
    s_waitcnt lgkmcnt(8)
    v_mfma_f32_16x16x32_bf16 v[32:35], v[192:195], v[96:99], v[32:35]
    ds_read_b128 v[152:155], v250 offset:43008
    v_lshlrev_b32 v4, 2, v3
    v_mfma_f32_16x16x32_bf16 v[60:63], v[196:199], v[96:99], v[60:63]
    ds_read_b128 v[156:159], v252 offset:43008
    v_sub_u32_e64 v4, v2, v4
    v_mfma_f32_16x16x32_bf16 v[36:39], v[192:195], v[100:103], v[36:39]
    v_lshlrev_b32 v5, 4, v4
    v_lshrrev_b32 v4, 1, v4
    v_mfma_f32_16x16x32_bf16 v[64:67], v[196:199], v[100:103], v[64:67]
    v_mov_b32 v6, 0x3f80
    v_lshlrev_b32_e64 v5, v5, v6
    v_mfma_f32_16x16x32_bf16 v[40:43], v[104:107], v[192:195], v[40:43]
    v_cmp_eq_u32_e64 vcc, 0, v4
    v_cmp_eq_u32 s[46:47], 1, v4
    v_mfma_f32_16x16x32_bf16 v[68:71], v[104:107], v[196:199], v[68:71]
    ds_read_b128 v[208:211], v255 offset:64
    s_lshl_b32 s36, s24, 10
    v_add_u32 v4, s36, v1
    v_mfma_f32_16x16x32_bf16 v[72:75], v[112:115], v[108:111], v[72:75]
    ds_read_b128 v[212:215], v255 offset:192
    v_cndmask_b32_e64 v234, 0, v5, vcc
    v_cndmask_b32 v235, 0, v5, s[46:47]
    v_mfma_f32_16x16x32_bf16 v[76:79], v[108:111], v[116:119], v[76:79]
    ds_read_b128 v[216:219], v255 offset:320
    v_add_u32 v5, 18432, v4
    s_lshl_b32 s36, s24, 7
    s_waitcnt vmcnt(0) lgkmcnt(9)
    v_mfma_f32_16x16x32_bf16 v[16:19], v[120:123], v[200:203], v[16:19]
    ds_read_b128 v[80:83], v248 offset:16384
    v_mfma_f32_16x16x32_bf16 v[44:47], v[120:123], v[204:207], v[44:47]
    ds_read_b128 v[84:87], v250 offset:50176
    s_add_u32 s36, s36, 16384
    v_mfma_f32_16x16x32_bf16 v[20:23], v[124:127], v[200:203], v[20:23]
    ds_read_b128 v[88:91], v252 offset:50176
    v_cmp_eq_u32_e64 vcc, 2, v3
    v_mfma_f32_16x16x32_bf16 v[48:51], v[124:127], v[204:207], v[48:51]
    ds_read_b128 v[92:95], v248 offset:17408
    v_lshl_add_u32 v6, v2, 3, s36
    v_mfma_f32_16x16x32_bf16 v[24:27], v[128:131], v[200:203], v[24:27]
    ds_read_b128 v[96:99], v250 offset:57344
    v_bfrev_b32_e64 v7, 1
    v_mfma_f32_16x16x32_bf16 v[52:55], v[128:131], v[204:207], v[52:55]
    ds_read_b128 v[100:103], v252 offset:57344
    v_cndmask_b32_e64 v6, v7, v6, vcc
    v_mfma_f32_16x16x32_bf16 v[28:31], v[132:135], v[200:203], v[28:31]
    v_add_u32 v7, 18432, v6
    v_mov_b32_e64 v106, 0
    v_mfma_f32_16x16x32_bf16 v[56:59], v[132:135], v[204:207], v[56:59]
    s_waitcnt lgkmcnt(6)
    v_mov_b32 v107, 0
    v_mfma_f32_16x16x32_bf16 v[32:35], v[200:203], v[136:139], v[32:35]
    v_mov_b32 v8, 0xf149f2ca
    v_mov_b32_e64 v108, 0
    v_mfma_f32_16x16x32_bf16 v[60:63], v[204:207], v[136:139], v[60:63]
    s_mov_b32 s33, 0x3eae1a93
    v_mov_b32_e64 v109, 0
    v_mfma_f32_16x16x32_bf16 v[36:39], v[200:203], v[140:143], v[36:39]
    v_mov_b32 v236, 0x3f803f80
    v_mov_b32 v237, 0x3f803f80
    v_mfma_f32_16x16x32_bf16 v[64:67], v[204:207], v[140:143], v[64:67]
    v_mov_b32 v238, 0x3f803f80
    v_mov_b32 v239, 0x3f803f80
    v_mfma_f32_16x16x32_bf16 v[40:43], v[144:147], v[200:203], v[40:43]
    v_mov_b32_e64 v114, 0
    v_mfma_f32_16x16x32_bf16 v[68:71], v[144:147], v[204:207], v[68:71]
    v_mov_b32_e64 v115, 0
    v_mfma_f32_16x16x32_bf16 v[72:75], v[152:155], v[148:151], v[72:75]
    v_mov_b32_e64 v116, 0
    v_mfma_f32_16x16x32_bf16 v[76:79], v[148:151], v[156:159], v[76:79]
    v_mov_b32 v117, 0
    s_waitcnt lgkmcnt(0)
    v_mfma_f32_16x16x32_bf16 v[72:75], v[84:87], v[80:83], v[72:75]
    v_mfma_f32_16x16x32_bf16 v[76:79], v[80:83], v[88:91], v[76:79]
    v_mfma_f32_16x16x32_bf16 v[72:75], v[96:99], v[92:95], v[72:75]
    v_mfma_f32_16x16x32_bf16 v[76:79], v[92:95], v[100:103], v[76:79]
L_a_e0:
    v_pk_mul_f32 v[52:53], v[52:53], v[244:245] op_sel:[0,1] op_sel_hi:[1,1]
    v_pk_mul_f32 v[54:55], v[54:55], v[244:245] op_sel:[0,1] op_sel_hi:[1,1]
    v_pk_mul_f32 v[56:57], v[56:57], v[244:245] op_sel:[0,1] op_sel_hi:[1,1]
    v_pk_mul_f32 v[58:59], v[58:59], v[244:245] op_sel:[0,1] op_sel_hi:[1,1]
    v_pk_mul_f32 v[60:61], v[60:61], v[216:217]
    v_pk_mul_f32 v[62:63], v[62:63], v[218:219]
    v_pk_mul_f32 v[64:65], v[64:65], v[216:217]
    v_pk_mul_f32 v[66:67], v[66:67], v[218:219]
    v_pk_mul_f32 v[68:69], v[68:69], v[244:245] op_sel:[0,1] op_sel_hi:[1,1]
    v_pk_mul_f32 v[70:71], v[70:71], v[244:245] op_sel:[0,1] op_sel_hi:[1,1]
    v_pk_mul_f32 v[72:73], v[72:73], v[240:241] op_sel:[0,1] op_sel_hi:[1,1]
    v_pk_mul_f32 v[74:75], v[74:75], v[240:241] op_sel:[0,1] op_sel_hi:[1,1]
    v_pk_mul_f32 v[76:77], v[76:77], v[208:209]
    v_pk_mul_f32 v[78:79], v[78:79], v[210:211]
    v_cvt_pk_bf16_f32 v172, v52, v53
    v_cvt_pk_bf16_f32 v173, v54, v55
    v_cvt_pk_bf16_f32 v176, v56, v57
    v_cvt_pk_bf16_f32 v177, v58, v59
    v_cvt_pk_bf16_f32 v182, v60, v61
    v_cvt_pk_bf16_f32 v183, v62, v63
    v_cvt_pk_bf16_f32 v188, v64, v65
    v_cvt_pk_bf16_f32 v189, v66, v67
    v_cvt_pk_bf16_f32 v174, v68, v69
    v_cvt_pk_bf16_f32 v175, v70, v71
    v_cvt_pk_bf16_f32 v220, v72, v73
    v_cvt_pk_bf16_f32 v221, v74, v75
    v_cvt_pk_bf16_f32 v222, v76, v77
    v_cvt_pk_bf16_f32 v223, v78, v79
    s_cmp_eq_u32 s20, 3
    s_cbranch_scc1 L_a_nw
    ds_write2st64_b64 v9, v[172:173], v[174:175] offset0:6 offset1:7
    ds_write2st64_b64 v9, v[176:177], v[182:183] offset0:8 offset1:9
    ds_write_b64 v9, v[188:189] offset:5120
    ds_write2st64_b64 v10, v[220:221], v[222:223] offset0:0 offset1:3
L_a_nw:
    v_pk_mul_f32 v[24:25], v[24:25], v[242:243] op_sel:[0,1] op_sel_hi:[1,1]
    v_pk_mul_f32 v[26:27], v[26:27], v[242:243] op_sel:[0,1] op_sel_hi:[1,1]
    v_pk_mul_f32 v[28:29], v[28:29], v[242:243] op_sel:[0,1] op_sel_hi:[1,1]
    v_pk_mul_f32 v[30:31], v[30:31], v[242:243] op_sel:[0,1] op_sel_hi:[1,1]
    v_pk_mul_f32 v[32:33], v[32:33], v[212:213]
    v_pk_mul_f32 v[34:35], v[34:35], v[214:215]
    v_pk_mul_f32 v[36:37], v[36:37], v[212:213]
    v_pk_mul_f32 v[38:39], v[38:39], v[214:215]
    v_pk_mul_f32 v[40:41], v[40:41], v[242:243] op_sel:[0,1] op_sel_hi:[1,1]
    v_pk_mul_f32 v[42:43], v[42:43], v[242:243] op_sel:[0,1] op_sel_hi:[1,1]
    v_cvt_pk_bf16_f32 v166, v24, v25
    v_cvt_pk_bf16_f32 v167, v26, v27
    v_cvt_pk_bf16_f32 v170, v28, v29
    v_cvt_pk_bf16_f32 v171, v30, v31
    v_cvt_pk_bf16_f32 v180, v32, v33
    v_cvt_pk_bf16_f32 v181, v34, v35
    v_cvt_pk_bf16_f32 v186, v36, v37
    v_cvt_pk_bf16_f32 v187, v38, v39
    v_cvt_pk_bf16_f32 v168, v40, v41
    v_cvt_pk_bf16_f32 v169, v42, v43
    s_waitcnt lgkmcnt(0)
    s_barrier
L_a_e1:
    ds_read2st64_b64 v[160:163], v9 offset0:0 offset1:1
    ds_read_b64 v[164:165], v9 offset:1024
    ds_read_b64 v[178:179], v9 offset:1536
    ds_read_b64 v[184:185], v9 offset:2048
    v_mfma_f32_16x16x16_bf16 v[128:131], v[174:175], v[234:235], 0
    v_mfma_f32_16x16x16_bf16 v[124:127], v[168:169], v[234:235], 0
    v_pk_mul_f32 v[44:45], v[44:45], v[244:245] op_sel:[0,1] op_sel_hi:[1,1]
    v_pk_mul_f32 v[46:47], v[46:47], v[244:245] op_sel:[0,1] op_sel_hi:[1,1]
    v_pk_mul_f32 v[48:49], v[48:49], v[244:245] op_sel:[0,1] op_sel_hi:[1,1]
    v_pk_mul_f32 v[50:51], v[50:51], v[244:245] op_sel:[0,1] op_sel_hi:[1,1]
    v_pk_mul_f32 v[16:17], v[16:17], v[242:243] op_sel:[0,1] op_sel_hi:[1,1]
    v_pk_mul_f32 v[18:19], v[18:19], v[242:243] op_sel:[0,1] op_sel_hi:[1,1]
    v_pk_mul_f32 v[20:21], v[20:21], v[242:243] op_sel:[0,1] op_sel_hi:[1,1]
    v_pk_mul_f32 v[22:23], v[22:23], v[242:243] op_sel:[0,1] op_sel_hi:[1,1]
    v_cvt_pk_bf16_f32 v112, v44, v45
    v_cvt_pk_bf16_f32 v113, v46, v47
    v_cvt_pk_bf16_f32 v118, v48, v49
    v_cvt_pk_bf16_f32 v119, v50, v51
    v_cvt_pk_bf16_f32 v104, v16, v17
    v_cvt_pk_bf16_f32 v105, v18, v19
    v_cvt_pk_bf16_f32 v110, v20, v21
    v_cvt_pk_bf16_f32 v111, v22, v23
    v_permlane16_swap_b32 v114, v174
    v_permlane16_swap_b32 v117, v175
    v_permlane16_swap_b32 v106, v168
    v_permlane16_swap_b32 v109, v169
    s_waitcnt lgkmcnt(0)
    v_mfma_f32_16x16x16_bf16 v[120:123], v[162:163], v[234:235], 0
    v_mfma_f32_16x16x32_bf16 v[20:23], v[172:175], v[112:115], 0
    v_mfma_f32_16x16x32_bf16 v[16:19], v[166:169], v[112:115], 0
    v_mfma_f32_16x16x32_bf16 v[28:31], v[174:177], v[116:119], 0
    v_mfma_f32_16x16x32_bf16 v[24:27], v[168:171], v[116:119], 0
    v_mfma_f32_16x16x32_bf16 v[36:39], v[166:169], v[104:107], 0
    v_mfma_f32_16x16x32_bf16 v[32:35], v[160:163], v[104:107], 0
    v_mfma_f32_16x16x32_bf16 v[44:47], v[168:171], v[108:111], 0
    v_mfma_f32_16x16x32_bf16 v[40:43], v[162:165], v[108:111], 0
    v_cvt_pk_bf16_f32 v194, v128, v129
    v_cvt_pk_bf16_f32 v195, v130, v131
    v_cvt_pk_bf16_f32 v192, v124, v125
    v_cvt_pk_bf16_f32 v193, v126, v127
    v_cvt_pk_bf16_f32 v190, v120, v121
    v_cvt_pk_bf16_f32 v191, v122, v123
    v_cndmask_b32 v20, v20, v21, s[40:41]
    v_cndmask_b32 v16, v16, v17, s[40:41]
    v_cndmask_b32 v48, v16, v20, s[42:43]
    v_cndmask_b32 v22, v22, v23, s[40:41]
    v_cndmask_b32 v18, v18, v19, s[40:41]
    v_cndmask_b32 v49, v18, v22, s[44:45]
    v_max_f32 v56, v48, v49
    v_cndmask_b32 v28, v28, v29, s[40:41]
    v_cndmask_b32 v24, v24, v25, s[40:41]
    v_cndmask_b32 v50, v24, v28, s[42:43]
    v_cndmask_b32 v30, v30, v31, s[40:41]
    v_cndmask_b32 v26, v26, v27, s[40:41]
    v_cndmask_b32 v51, v26, v30, s[44:45]
    v_max_f32_e64 v57, v50, v51
    v_cndmask_b32 v36, v36, v37, s[40:41]
    v_cndmask_b32 v32, v32, v33, s[40:41]
    v_cndmask_b32 v52, v32, v36, s[42:43]
    v_cndmask_b32 v52, v8, v52, s[48:49]
    v_cndmask_b32 v38, v38, v39, s[40:41]
    v_cndmask_b32 v34, v34, v35, s[40:41]
    v_cndmask_b32 v53, v34, v38, s[44:45]
    v_cndmask_b32 v53, v8, v53, s[38:39]
    v_max_f32 v58, v52, v53
    v_permlane32_swap_b32 v56, v57
    v_max_f32_e64 v56, v56, v57
    v_cndmask_b32 v44, v44, v45, s[40:41]
    v_cndmask_b32 v40, v40, v41, s[40:41]
    v_cndmask_b32 v54, v40, v44, s[42:43]
    v_cndmask_b32 v54, v8, v54, s[48:49]
    v_cndmask_b32 v46, v46, v47, s[40:41]
    v_cndmask_b32 v42, v42, v43, s[40:41]
    v_cndmask_b32 v55, v42, v46, s[44:45]
    v_cndmask_b32 v55, v8, v55, s[38:39]
    v_max_f32 v59, v54, v55
    s_nop 1
    v_permlane32_swap_b32 v58, v59
    v_max_f32 v58, v58, v59
    s_nop 1
    v_permlane16_swap_b32 v56, v58
    v_max_f32 v57, v56, v58
    v_mul_f32 v56, s33, v57
    v_mul_f32 v58, s33, v57
    s_nop 1
    v_permlane16_swap_b32 v56, v58
    v_mov_b32 v57, v56
    v_mov_b32 v59, v58
    s_nop 0
    v_permlane32_swap_b32 v56, v57
    v_permlane32_swap_b32 v58, v59
    v_fma_f32 v48, v48, s33, -v56
    v_fma_f32 v49, v49, s33, -v56
    v_fma_f32 v50, v50, s33, -v57
    v_fma_f32 v51, v51, s33, -v57
    v_fma_f32 v52, v52, s33, -v58
    v_fma_f32 v53, v53, s33, -v58
    v_fma_f32 v54, v54, s33, -v59
    v_fma_f32 v55, v55, s33, -v59
    v_exp_f32 v48, v48
    v_exp_f32 v49, v49
    v_exp_f32 v50, v50
    v_exp_f32 v51, v51
    v_exp_f32 v52, v52
    v_exp_f32 v53, v53
    v_exp_f32 v54, v54
    v_exp_f32 v55, v55
    v_cvt_pk_bf16_f32 v56, v48, v49
    v_cvt_pk_bf16_f32 v57, v50, v51
    v_cvt_pk_bf16_f32 v58, v52, v53
    v_cvt_pk_bf16_f32 v59, v54, v55
    v_perm_b32 v64, v56, v56, v12
    v_perm_b32 v65, v56, v56, v13
    v_perm_b32 v66, v56, v56, v14
    v_perm_b32 v67, v56, v56, v15
    v_perm_b32 v68, v57, v57, v12
    v_perm_b32 v69, v57, v57, v13
    v_perm_b32 v70, v57, v57, v14
    v_perm_b32 v71, v57, v57, v15
    v_perm_b32 v72, v58, v58, v12
    v_perm_b32 v73, v58, v58, v13
    v_perm_b32 v74, v58, v58, v14
    v_perm_b32 v75, v58, v58, v15
    v_perm_b32 v76, v59, v59, v12
    v_perm_b32 v77, v59, v59, v13
    v_perm_b32 v78, v59, v59, v14
    v_perm_b32 v79, v59, v59, v15
    v_mfma_f32_16x16x32_bf16 v[80:83], v[236:239], v[64:67], 0
    v_mfma_f32_16x16x32_bf16 v[84:87], v[236:239], v[68:71], 0
    v_mfma_f32_16x16x32_bf16 v[88:91], v[236:239], v[72:75], 0
    v_mfma_f32_16x16x32_bf16 v[92:95], v[236:239], v[76:79], 0
    v_mfma_f32_16x16x32_bf16 v[16:19], v[180:183], v[64:67], 0
    v_mfma_f32_16x16x32_bf16 v[20:23], v[192:195], v[64:67], 0
    v_mfma_f32_16x16x32_bf16 v[24:27], v[186:189], v[68:71], 0
    v_mfma_f32_16x16x32_bf16 v[28:31], v[192:195], v[68:71], 0
    v_mfma_f32_16x16x32_bf16 v[32:35], v[178:181], v[72:75], 0
    v_mfma_f32_16x16x32_bf16 v[36:39], v[190:193], v[72:75], 0
    v_mfma_f32_16x16x32_bf16 v[40:43], v[184:187], v[76:79], 0
    v_mfma_f32_16x16x32_bf16 v[44:47], v[190:193], v[76:79], 0
    v_rcp_f32 v80, v80
    v_rcp_f32 v84, v84
    v_rcp_f32 v88, v88
    v_rcp_f32 v92, v92
    v_pk_mul_f32 v[16:17], v[16:17], v[80:81] op_sel_hi:[1,0]
    v_pk_mul_f32 v[18:19], v[18:19], v[80:81] op_sel_hi:[1,0]
    v_pk_mul_f32 v[20:21], v[20:21], v[80:81] op_sel_hi:[1,0]
    v_pk_mul_f32 v[24:25], v[24:25], v[84:85] op_sel_hi:[1,0]
    v_pk_mul_f32 v[26:27], v[26:27], v[84:85] op_sel_hi:[1,0]
    v_pk_mul_f32 v[30:31], v[30:31], v[84:85] op_sel_hi:[1,0]
    v_cvt_pk_bf16_f32 v220, v16, v17
    v_cvt_pk_bf16_f32 v221, v18, v19
    v_cvt_pk_bf16_f32 v224, v20, v21
    v_cvt_pk_bf16_f32 v222, v24, v25
    v_cvt_pk_bf16_f32 v223, v26, v27
    v_cvt_pk_bf16_f32 v225, v30, v31
    buffer_store_dwordx4 v[220:223], v5, s[4:7], s35 offen sc1
    buffer_store_dwordx2 v[224:225], v7, s[4:7], s35 offen sc1
    v_pk_mul_f32 v[32:33], v[32:33], v[88:89] op_sel_hi:[1,0]
    v_pk_mul_f32 v[34:35], v[34:35], v[88:89] op_sel_hi:[1,0]
    v_pk_mul_f32 v[36:37], v[36:37], v[88:89] op_sel_hi:[1,0]
    v_pk_mul_f32 v[40:41], v[40:41], v[92:93] op_sel_hi:[1,0]
    v_pk_mul_f32 v[42:43], v[42:43], v[92:93] op_sel_hi:[1,0]
    v_pk_mul_f32 v[46:47], v[46:47], v[92:93] op_sel_hi:[1,0]
    v_cvt_pk_bf16_f32 v228, v32, v33
    v_cvt_pk_bf16_f32 v229, v34, v35
    v_cvt_pk_bf16_f32 v232, v36, v37
    v_cvt_pk_bf16_f32 v230, v40, v41
    v_cvt_pk_bf16_f32 v231, v42, v43
    v_cvt_pk_bf16_f32 v233, v46, v47
    buffer_store_dwordx4 v[228:231], v4, s[4:7], s35 offen sc1
    buffer_store_dwordx2 v[232:233], v6, s[4:7], s35 offen sc1
    s_and_b32 s25, s2, 7
    s_lshr_b32 s26, s2, 3
    s_lshr_b32 s23, s25, 1
    s_lshl_b32 s23, s23, 3
    s_lshr_b32 s27, s26, 2
    s_add_u32 s23, s23, s27
    s_and_b32 s24, s25, 1
    s_lshl_b32 s24, s24, 2
    s_and_b32 s27, s26, 3
    s_add_u32 s24, s24, s27
    s_add_u32 s25, s23, s24
    s_and_b32 s25, s25, 3
    s_lshl_b32 s30, s23, 2
    s_add_u32 s30, s30, s20
    s_mul_i32 s29, s30, 18432
    s_add_u32 s29, s29, s21
    s_add_u32 s29, s29, 0x600000
    s_mul_i32 s34, s30, 18432
    s_add_u32 s34, s34, s21
    s_add_u32 s34, s34, 0x0
    s_lshl_b32 s35, s24, 11
    s_lshr_b32 s36, s24, 2
    s_lshl_b32 s36, s36, 10
    s_and_b32 s37, s24, 3
    s_lshl_b32 s37, s37, 8
    s_add_u32 s36, s36, s37
    s_add_u32 s36, s36, 16384
    v_bfe_u32 v2, v1, 4, 4
    v_lshrrev_b32 v3, 8, v1
    v_add_u32 v4, s35, v1
    v_lshlrev_b32 v5, 4, v2
    v_lshl_add_u32 v5, v3, 3, v5
    v_add_u32_e64 v5, s36, v5
    v_cmp_gt_u32 s[40:41], 2, v3
    v_bfrev_b32 v6, 1
    v_add_u32 v12, 0, v1
    v_add_u32 v13, 36864, v1
    v_add_u32 v14, 73728, v1
    v_add_u32 v15, 110592, v1
    v_cndmask_b32 v5, v6, v5, s[40:41]
    buffer_load_dwordx4 v[208:211], v4, s[4:7], s34 offen offset:0 sc1
    buffer_load_dwordx4 v[212:215], v4, s[4:7], s34 offen offset:1024 sc1
    buffer_load_dwordx2 v[216:217], v5, s[4:7], s34 offen sc1
    s_add_u32 s34, s34, 0x300000
    s_lshl_b32 s39, s30, 10
    s_add_u32 s39, s39, s21
    s_lshl_b32 s42, s24, 7
    s_add_u32 s39, s39, s42
    s_add_u32 s39, s39, 0x1b20000
    v_cmp_eq_u32 vcc, 0, v3
    v_lshlrev_b32 v10, 3, v2
    v_mov_b32 v11, 0x3f803f80
    v_lshl_add_u32 v7, v3, 8, v10
    v_cndmask_b32_e64 v10, v6, v10, vcc
    s_lshr_b32 s44, s23, 1
    s_lshl_b32 s52, s22, 7
    s_add_u32 s52, s52, s44
    s_lshl_b32 s52, s52, 8
    s_add_u32 s52, s52, 0x4508000
    s_add_u32 s52, s52, s4
    s_addc_u32 s53, s5, 0
    s_waitcnt vmcnt(3)
    s_barrier
    s_cmp_lg_u32 s20, 0
    s_cbranch_scc1 L_ns_d2
    s_mov_b32 s56, 1
    s_atomic_add s56, s[50:51], 0
L_ns_d2:
    s_cmp_lg_u32 s20, 0
    s_cbranch_scc1 L_pd_d2
    s_mov_b32 s60, 65536
L_poll_d2:
    s_mov_b32 s57, 0
    s_atomic_add s57, s[52:53], 0 glc
    s_waitcnt lgkmcnt(0)
    s_cmp_ge_u32 s57, 16
    s_cbranch_scc1 L_pd_d2
    s_sub_u32 s60, s60, 1
    s_cbranch_scc1 L_pd_d2
    s_sleep 2
    s_branch L_poll_d2
    s_nop 0
L_pd_d2:
    s_barrier
    s_mov_b32 s32, 0
    s_lshl_b32 s32, s32, 13
    s_add_u32 s32, s32, s29
    s_add_u32 s33, s32, 4096
    buffer_load_dwordx4 v[112:115], v1, s[4:7], s32 offen offset:0 sc1
    buffer_load_dwordx4 v[116:119], v1, s[4:7], s32 offen offset:1024 sc1
    buffer_load_dwordx4 v[120:123], v1, s[4:7], s32 offen offset:2048 sc1
    buffer_load_dwordx4 v[124:127], v1, s[4:7], s32 offen offset:3072 sc1
    buffer_load_dwordx4 v[128:131], v1, s[4:7], s33 offen offset:0 sc1
    buffer_load_dwordx4 v[132:135], v1, s[4:7], s33 offen offset:1024 sc1
    buffer_load_dwordx4 v[136:139], v1, s[4:7], s33 offen offset:2048 sc1
    buffer_load_dwordx4 v[140:143], v1, s[4:7], s33 offen offset:3072 sc1
    ds_read_b128 v[40:43], v12 offset:18432
    ds_read_b128 v[44:47], v12 offset:19456
    ds_read_b128 v[48:51], v12 offset:20480
    ds_read_b128 v[52:55], v12 offset:21504
    ds_read_b128 v[72:75], v12 offset:26624
    ds_read_b128 v[56:59], v12 offset:22528
    ds_read_b128 v[60:63], v12 offset:23552
    ds_read_b128 v[64:67], v12 offset:24576
    ds_read_b128 v[68:71], v12 offset:25600
    s_add_u32 s45, s29, 8192
    s_add_u32 s46, s29, 12288
    s_add_u32 s47, s29, 16384
    buffer_load_dwordx4 v[144:147], v1, s[4:7], s45 offen offset:0 sc1
    buffer_load_dwordx4 v[148:151], v1, s[4:7], s45 offen offset:1024 sc1
    s_lshl_b32 s42, s23, 3
    s_add_u32 s42, s42, s24
    s_lshl_b32 s42, s42, 2
    s_add_u32 s42, s42, s20
    s_lshl_b32 s42, s42, 8
    s_add_u32 s42, s42, s21
    s_add_u32 s42, s42, 0x1b40000
    v_mov_b32 v220, -1.0
    v_lshrrev_b32 v221, 2, v1
    buffer_store_dword v220, v221, s[4:7], s42 offen sc1
    s_lshl_b32 s50, s22, 7
    s_add_u32 s50, s50, s44
    s_lshl_b32 s50, s50, 8
    s_add_u32 s50, s50, 0x4509000
    s_add_u32 s50, s50, s4
    s_addc_u32 s51, s5, 0
    s_waitcnt vmcnt(11)
    v_lshlrev_b32_e64 v16, 16, v208
    v_and_b32 v17, 0xffff0000, v208
    v_lshlrev_b32_e64 v18, 16, v209
    v_and_b32 v19, 0xffff0000, v209
    v_lshlrev_b32_e64 v20, 16, v210
    v_and_b32 v21, 0xffff0000, v210
    v_lshlrev_b32_e64 v22, 16, v211
    v_and_b32 v23, 0xffff0000, v211
    v_lshlrev_b32_e64 v24, 16, v212
    v_and_b32 v25, 0xffff0000, v212
    v_lshlrev_b32_e64 v26, 16, v213
    v_and_b32 v27, 0xffff0000, v213
    v_lshlrev_b32_e64 v28, 16, v214
    v_and_b32 v29, 0xffff0000, v214
    v_lshlrev_b32_e64 v30, 16, v215
    v_and_b32 v31, 0xffff0000, v215
    v_lshlrev_b32_e64 v32, 16, v216
    v_and_b32 v33, 0xffff0000, v216
    v_lshlrev_b32_e64 v34, 16, v217
    v_and_b32 v35, 0xffff0000, v217
    s_waitcnt vmcnt(9) lgkmcnt(4)
    v_mfma_f32_16x16x32_bf16 v[16:19], v[40:43], v[112:115], v[16:19]
    ds_read_b128 v[76:79], v12 offset:27648
    v_mfma_f32_16x16x32_bf16 v[20:23], v[44:47], v[112:115], v[20:23]
    ds_read_b128 v[80:83], v12 offset:28672
    buffer_load_dwordx4 v[152:155], v1, s[4:7], s45 offen offset:2048 sc1
    v_mfma_f32_16x16x32_bf16 v[24:27], v[48:51], v[112:115], v[24:27]
    ds_read_b128 v[84:87], v12 offset:29696
    v_mfma_f32_16x16x32_bf16 v[28:31], v[52:55], v[112:115], v[28:31]
    ds_read_b128 v[88:91], v12 offset:30720
    v_mfma_f32_16x16x32_bf16 v[32:35], v[72:75], v[112:115], v[32:35]
    ds_read_b128 v[108:111], v12 offset:35840
    s_waitcnt lgkmcnt(5)
    buffer_load_dwordx4 v[156:159], v1, s[4:7], s45 offen offset:3072 sc1
    v_mfma_f32_16x16x32_bf16 v[16:19], v[56:59], v[116:119], v[16:19]
    ds_read_b128 v[92:95], v12 offset:31744
    v_mfma_f32_16x16x32_bf16 v[20:23], v[60:63], v[116:119], v[20:23]
    ds_read_b128 v[96:99], v12 offset:32768
    v_mfma_f32_16x16x32_bf16 v[24:27], v[64:67], v[116:119], v[24:27]
    ds_read_b128 v[100:103], v12 offset:33792
    buffer_load_dwordx4 v[160:163], v1, s[4:7], s46 offen offset:0 sc1
    v_mfma_f32_16x16x32_bf16 v[28:31], v[68:71], v[116:119], v[28:31]
    ds_read_b128 v[104:107], v12 offset:34816
    v_mfma_f32_16x16x32_bf16 v[36:39], v[72:75], v[116:119], 0
    s_waitcnt vmcnt(10) lgkmcnt(4)
    v_mfma_f32_16x16x32_bf16 v[16:19], v[76:79], v[120:123], v[16:19]
    ds_read_b128 v[40:43], v13 offset:18432
    v_mfma_f32_16x16x32_bf16 v[20:23], v[80:83], v[120:123], v[20:23]
    ds_read_b128 v[44:47], v13 offset:19456
    buffer_load_dwordx4 v[164:167], v1, s[4:7], s46 offen offset:1024 sc1
    v_mfma_f32_16x16x32_bf16 v[24:27], v[84:87], v[120:123], v[24:27]
    ds_read_b128 v[48:51], v13 offset:20480
    v_mfma_f32_16x16x32_bf16 v[28:31], v[88:91], v[120:123], v[28:31]
    ds_read_b128 v[52:55], v13 offset:21504
    v_mfma_f32_16x16x32_bf16 v[32:35], v[108:111], v[120:123], v[32:35]
    ds_read_b128 v[72:75], v13 offset:26624
    s_waitcnt lgkmcnt(5)
    buffer_load_dwordx4 v[168:171], v1, s[4:7], s46 offen offset:2048 sc1
    v_mfma_f32_16x16x32_bf16 v[16:19], v[92:95], v[124:127], v[16:19]
    ds_read_b128 v[56:59], v13 offset:22528
    v_mfma_f32_16x16x32_bf16 v[20:23], v[96:99], v[124:127], v[20:23]
    ds_read_b128 v[60:63], v13 offset:23552
    v_mfma_f32_16x16x32_bf16 v[24:27], v[100:103], v[124:127], v[24:27]
    ds_read_b128 v[64:67], v13 offset:24576
    buffer_load_dwordx4 v[172:175], v1, s[4:7], s46 offen offset:3072 sc1
    v_mfma_f32_16x16x32_bf16 v[28:31], v[104:107], v[124:127], v[28:31]
    ds_read_b128 v[68:71], v13 offset:25600
    v_mfma_f32_16x16x32_bf16 v[36:39], v[108:111], v[124:127], v[36:39]
    s_waitcnt vmcnt(11) lgkmcnt(4)
    v_mfma_f32_16x16x32_bf16 v[16:19], v[40:43], v[128:131], v[16:19]
    ds_read_b128 v[76:79], v13 offset:27648
    v_mfma_f32_16x16x32_bf16 v[20:23], v[44:47], v[128:131], v[20:23]
    ds_read_b128 v[80:83], v13 offset:28672
    buffer_load_dwordx2 v[176:177], v7, s[4:7], s47 offen offset:0 sc1
    v_mfma_f32_16x16x32_bf16 v[24:27], v[48:51], v[128:131], v[24:27]
    ds_read_b128 v[84:87], v13 offset:29696
    v_mfma_f32_16x16x32_bf16 v[28:31], v[52:55], v[128:131], v[28:31]
    ds_read_b128 v[88:91], v13 offset:30720
    v_mfma_f32_16x16x32_bf16 v[32:35], v[72:75], v[128:131], v[32:35]
    ds_read_b128 v[108:111], v13 offset:35840
    s_waitcnt lgkmcnt(5)
    buffer_load_dwordx2 v[178:179], v7, s[4:7], s47 offen offset:128 sc1
    v_mfma_f32_16x16x32_bf16 v[16:19], v[56:59], v[132:135], v[16:19]
    ds_read_b128 v[92:95], v13 offset:31744
    v_mfma_f32_16x16x32_bf16 v[20:23], v[60:63], v[132:135], v[20:23]
    ds_read_b128 v[96:99], v13 offset:32768
    v_mfma_f32_16x16x32_bf16 v[24:27], v[64:67], v[132:135], v[24:27]
    ds_read_b128 v[100:103], v13 offset:33792
    buffer_load_dwordx2 v[180:181], v7, s[4:7], s47 offen offset:1024 sc1
    v_mfma_f32_16x16x32_bf16 v[28:31], v[68:71], v[132:135], v[28:31]
    ds_read_b128 v[104:107], v13 offset:34816
    v_mfma_f32_16x16x32_bf16 v[36:39], v[72:75], v[132:135], v[36:39]
    s_waitcnt vmcnt(12) lgkmcnt(4)
    v_mfma_f32_16x16x32_bf16 v[16:19], v[76:79], v[136:139], v[16:19]
    ds_read_b128 v[40:43], v14 offset:18432
    v_mfma_f32_16x16x32_bf16 v[20:23], v[80:83], v[136:139], v[20:23]
    ds_read_b128 v[44:47], v14 offset:19456
    buffer_load_dwordx2 v[182:183], v7, s[4:7], s47 offen offset:1152 sc1
    v_mfma_f32_16x16x32_bf16 v[24:27], v[84:87], v[136:139], v[24:27]
    ds_read_b128 v[48:51], v14 offset:20480
    v_mfma_f32_16x16x32_bf16 v[28:31], v[88:91], v[136:139], v[28:31]
    ds_read_b128 v[52:55], v14 offset:21504
    v_mfma_f32_16x16x32_bf16 v[32:35], v[108:111], v[136:139], v[32:35]
    ds_read_b128 v[72:75], v14 offset:26624
    s_waitcnt lgkmcnt(5)
    v_mfma_f32_16x16x32_bf16 v[16:19], v[92:95], v[140:143], v[16:19]
    ds_read_b128 v[56:59], v14 offset:22528
    v_mfma_f32_16x16x32_bf16 v[20:23], v[96:99], v[140:143], v[20:23]
    ds_read_b128 v[60:63], v14 offset:23552
    v_mfma_f32_16x16x32_bf16 v[24:27], v[100:103], v[140:143], v[24:27]
    ds_read_b128 v[64:67], v14 offset:24576
    v_mfma_f32_16x16x32_bf16 v[28:31], v[104:107], v[140:143], v[28:31]
    ds_read_b128 v[68:71], v14 offset:25600
    v_mfma_f32_16x16x32_bf16 v[36:39], v[108:111], v[140:143], v[36:39]
    s_waitcnt vmcnt(11) lgkmcnt(4)
    v_mfma_f32_16x16x32_bf16 v[16:19], v[40:43], v[144:147], v[16:19]
    ds_read_b128 v[76:79], v14 offset:27648
    v_mfma_f32_16x16x32_bf16 v[20:23], v[44:47], v[144:147], v[20:23]
    ds_read_b128 v[80:83], v14 offset:28672
    v_mfma_f32_16x16x32_bf16 v[24:27], v[48:51], v[144:147], v[24:27]
    ds_read_b128 v[84:87], v14 offset:29696
    v_mfma_f32_16x16x32_bf16 v[28:31], v[52:55], v[144:147], v[28:31]
    ds_read_b128 v[88:91], v14 offset:30720
    v_mfma_f32_16x16x32_bf16 v[32:35], v[72:75], v[144:147], v[32:35]
    ds_read_b128 v[108:111], v14 offset:35840
    s_waitcnt lgkmcnt(5)
    v_mfma_f32_16x16x32_bf16 v[16:19], v[56:59], v[148:151], v[16:19]
    ds_read_b128 v[92:95], v14 offset:31744
    v_mfma_f32_16x16x32_bf16 v[20:23], v[60:63], v[148:151], v[20:23]
    ds_read_b128 v[96:99], v14 offset:32768
    v_mfma_f32_16x16x32_bf16 v[24:27], v[64:67], v[148:151], v[24:27]
    ds_read_b128 v[100:103], v14 offset:33792
    v_mfma_f32_16x16x32_bf16 v[28:31], v[68:71], v[148:151], v[28:31]
    ds_read_b128 v[104:107], v14 offset:34816
    v_mfma_f32_16x16x32_bf16 v[36:39], v[72:75], v[148:151], v[36:39]
    s_waitcnt vmcnt(8) lgkmcnt(4)
    v_mfma_f32_16x16x32_bf16 v[16:19], v[76:79], v[152:155], v[16:19]
    ds_read_b128 v[40:43], v15 offset:18432
    v_mfma_f32_16x16x32_bf16 v[20:23], v[80:83], v[152:155], v[20:23]
    ds_read_b128 v[44:47], v15 offset:19456
    v_mfma_f32_16x16x32_bf16 v[24:27], v[84:87], v[152:155], v[24:27]
    ds_read_b128 v[48:51], v15 offset:20480
    v_mfma_f32_16x16x32_bf16 v[28:31], v[88:91], v[152:155], v[28:31]
    ds_read_b128 v[52:55], v15 offset:21504
    v_mfma_f32_16x16x32_bf16 v[32:35], v[108:111], v[152:155], v[32:35]
    ds_read_b128 v[72:75], v15 offset:26624
    s_waitcnt lgkmcnt(5)
    v_mfma_f32_16x16x32_bf16 v[16:19], v[92:95], v[156:159], v[16:19]
    ds_read_b128 v[56:59], v15 offset:22528
    v_mfma_f32_16x16x32_bf16 v[20:23], v[96:99], v[156:159], v[20:23]
    ds_read_b128 v[60:63], v15 offset:23552
    v_mfma_f32_16x16x32_bf16 v[24:27], v[100:103], v[156:159], v[24:27]
    ds_read_b128 v[64:67], v15 offset:24576
    v_mfma_f32_16x16x32_bf16 v[28:31], v[104:107], v[156:159], v[28:31]
    ds_read_b128 v[68:71], v15 offset:25600
    v_mfma_f32_16x16x32_bf16 v[36:39], v[108:111], v[156:159], v[36:39]
    s_waitcnt vmcnt(6) lgkmcnt(4)
    v_mfma_f32_16x16x32_bf16 v[16:19], v[40:43], v[160:163], v[16:19]
    ds_read_b128 v[76:79], v15 offset:27648
    v_mfma_f32_16x16x32_bf16 v[20:23], v[44:47], v[160:163], v[20:23]
    ds_read_b128 v[80:83], v15 offset:28672
    v_mfma_f32_16x16x32_bf16 v[24:27], v[48:51], v[160:163], v[24:27]
    ds_read_b128 v[84:87], v15 offset:29696
    v_mfma_f32_16x16x32_bf16 v[28:31], v[52:55], v[160:163], v[28:31]
    ds_read_b128 v[88:91], v15 offset:30720
    v_mfma_f32_16x16x32_bf16 v[32:35], v[72:75], v[160:163], v[32:35]
    ds_read_b128 v[108:111], v15 offset:35840
    s_waitcnt lgkmcnt(5)
    v_mfma_f32_16x16x32_bf16 v[16:19], v[56:59], v[164:167], v[16:19]
    ds_read_b128 v[92:95], v15 offset:31744
    v_mfma_f32_16x16x32_bf16 v[20:23], v[60:63], v[164:167], v[20:23]
    ds_read_b128 v[96:99], v15 offset:32768
    v_mfma_f32_16x16x32_bf16 v[24:27], v[64:67], v[164:167], v[24:27]
    ds_read_b128 v[100:103], v15 offset:33792
    v_mfma_f32_16x16x32_bf16 v[28:31], v[68:71], v[164:167], v[28:31]
    ds_read_b128 v[104:107], v15 offset:34816
    v_mfma_f32_16x16x32_bf16 v[36:39], v[72:75], v[164:167], v[36:39]
    s_waitcnt vmcnt(4) lgkmcnt(4)
    v_mfma_f32_16x16x32_bf16 v[16:19], v[76:79], v[168:171], v[16:19]
    ds_read_b128 v[40:43], v15 offset:36864
    v_mfma_f32_16x16x32_bf16 v[20:23], v[80:83], v[168:171], v[20:23]
    ds_read_b128 v[44:47], v15 offset:37888
    v_mfma_f32_16x16x32_bf16 v[24:27], v[84:87], v[168:171], v[24:27]
    ds_read_b128 v[48:51], v15 offset:38912
    v_mfma_f32_16x16x32_bf16 v[28:31], v[88:91], v[168:171], v[28:31]
    ds_read_b128 v[52:55], v15 offset:39936
    v_mfma_f32_16x16x32_bf16 v[32:35], v[108:111], v[168:171], v[32:35]
    ds_read_b128 v[72:75], v15 offset:45056
    s_waitcnt lgkmcnt(5)
    v_mfma_f32_16x16x32_bf16 v[16:19], v[92:95], v[172:175], v[16:19]
    ds_read_b128 v[56:59], v15 offset:40960
    v_mfma_f32_16x16x32_bf16 v[20:23], v[96:99], v[172:175], v[20:23]
    ds_read_b128 v[60:63], v15 offset:41984
    v_mfma_f32_16x16x32_bf16 v[24:27], v[100:103], v[172:175], v[24:27]
    ds_read_b128 v[64:67], v15 offset:43008
    v_mfma_f32_16x16x32_bf16 v[28:31], v[104:107], v[172:175], v[28:31]
    ds_read_b128 v[68:71], v15 offset:44032
    v_mfma_f32_16x16x32_bf16 v[36:39], v[108:111], v[172:175], v[36:39]
    s_waitcnt vmcnt(0) lgkmcnt(4)
    v_mfma_f32_16x16x32_bf16 v[16:19], v[40:43], v[176:179], v[16:19]
    v_mfma_f32_16x16x32_bf16 v[20:23], v[44:47], v[176:179], v[20:23]
    v_mfma_f32_16x16x32_bf16 v[24:27], v[48:51], v[176:179], v[24:27]
    v_mfma_f32_16x16x32_bf16 v[28:31], v[52:55], v[176:179], v[28:31]
    v_mfma_f32_16x16x32_bf16 v[32:35], v[72:75], v[176:179], v[32:35]
    s_waitcnt lgkmcnt(0)
    v_mfma_f32_16x16x32_bf16 v[16:19], v[56:59], v[180:183], v[16:19]
    v_mfma_f32_16x16x32_bf16 v[20:23], v[60:63], v[180:183], v[20:23]
    v_mfma_f32_16x16x32_bf16 v[24:27], v[64:67], v[180:183], v[24:27]
    v_mfma_f32_16x16x32_bf16 v[28:31], v[68:71], v[180:183], v[28:31]
    v_mfma_f32_16x16x32_bf16 v[36:39], v[72:75], v[180:183], v[36:39]
    s_nop 3
    v_cvt_pk_bf16_f32 v208, v16, v17
    v_cvt_pk_bf16_f32 v209, v18, v19
    v_cvt_pk_bf16_f32 v210, v20, v21
    v_cvt_pk_bf16_f32 v211, v22, v23
    v_cvt_pk_bf16_f32 v212, v24, v25
    v_cvt_pk_bf16_f32 v213, v26, v27
    v_cvt_pk_bf16_f32 v214, v28, v29
    v_cvt_pk_bf16_f32 v215, v30, v31
    buffer_store_dwordx4 v[208:211], v4, s[4:7], s34 offen offset:0 sc1
    buffer_store_dwordx4 v[212:215], v4, s[4:7], s34 offen offset:1024 sc1
    v_permlane32_swap_b32 v36, v220
    v_permlane32_swap_b32 v37, v221
    v_permlane32_swap_b32 v38, v222
    v_permlane32_swap_b32 v39, v223
    v_pk_add_f32 v[32:33], v[32:33], v[220:221]
    v_pk_add_f32 v[34:35], v[34:35], v[222:223]
    v_cvt_pk_bf16_f32 v216, v32, v33
    v_cvt_pk_bf16_f32 v217, v34, v35
    buffer_store_dwordx2 v[216:217], v5, s[4:7], s34 offen sc1
    v_cndmask_b32 v222, 0, v216, s[40:41]
    v_cndmask_b32 v223, 0, v217, s[40:41]
    v_dot2_f32_bf16 v220, v208, v11, 0
    v_dot2_f32_bf16 v221, v208, v208, 0
    v_dot2_f32_bf16 v224, v209, v11, 0
    v_dot2_f32_bf16 v225, v209, v209, 0
    v_dot2_f32_bf16 v220, v210, v11, v220
    v_dot2_f32_bf16 v221, v210, v210, v221
    v_dot2_f32_bf16 v224, v211, v11, v224
    v_dot2_f32_bf16 v225, v211, v211, v225
    v_dot2_f32_bf16 v220, v212, v11, v220
    v_dot2_f32_bf16 v221, v212, v212, v221
    v_dot2_f32_bf16 v224, v213, v11, v224
    v_dot2_f32_bf16 v225, v213, v213, v225
    v_dot2_f32_bf16 v220, v214, v11, v220
    v_dot2_f32_bf16 v221, v214, v214, v221
    v_dot2_f32_bf16 v224, v215, v11, v224
    v_dot2_f32_bf16 v225, v215, v215, v225
    v_dot2_f32_bf16 v220, v222, v11, v220
    v_dot2_f32_bf16 v221, v222, v222, v221
    v_dot2_f32_bf16 v224, v223, v11, v224
    v_dot2_f32_bf16 v225, v223, v223, v225
    s_nop 2
    v_pk_add_f32 v[220:221], v[220:221], v[224:225]
    v_mov_b32 v222, v220
    v_mov_b32 v223, v221
    s_nop 1
    v_permlane32_swap_b32 v220, v222
    v_permlane32_swap_b32 v221, v223
    v_add_f32 v220, v220, v222
    v_add_f32 v221, v221, v223
    v_mov_b32 v222, v220
    v_mov_b32 v223, v221
    s_nop 1
    v_permlane16_swap_b32 v220, v222
    v_permlane16_swap_b32 v221, v223
    v_add_f32 v220, v220, v222
    v_add_f32 v221, v221, v223
    buffer_store_dwordx2 v[220:221], v10, s[4:7], s39 offen sc1
    s_and_b32 s25, s2, 7
    s_lshr_b32 s26, s2, 3
    s_and_b32 s23, s25, 1
    s_lshl_b32 s23, s23, 3
    s_and_b32 s27, s26, 7
    s_add_u32 s23, s23, s27
    s_lshr_b32 s24, s25, 1
    s_lshl_b32 s24, s24, 2
    s_lshr_b32 s27, s26, 3
    s_add_u32 s24, s24, s27
    s_add_u32 s28, s23, s24
    s_and_b32 s28, s28, 3
    s_lshl_b32 s30, s20, 12
    s_lshl_b32 s31, s23, 3
    s_lshl_b32 s33, s20, 1
    s_add_u32 s31, s31, s33
    s_lshl_b32 s32, s31, 10
    s_add_u32 s32, s32, s21
    s_add_u32 s32, s32, 0x1b20000
    v_add_u32 v2, 73728, v1
    s_add_u32 s33, s30, 18432
    v_add_u32 v3, s33, v1
    v_add_u32_e64 v0, s33, v2
    s_lshr_b32 s34, s31, 1
    s_lshl_b32 s35, s34, 12
    s_add_u32 s35, s35, s21
    s_add_u32 s35, s35, 0x1b40000
    s_lshl_b32 s36, s24, 8
    s_add_u32 s36, s36, s35
    s_lshl_b32 s38, s24, 6
    s_add_u32 s38, s38, s34
    s_mul_i32 s38, s38, 9216
    s_add_u32 s38, s38, s21
    s_add_u32 s38, s38, 0x900000
    s_add_u32 s39, s38, 4096
    s_add_u32 s46, s38, 8192
    s_mov_b32 s40, 0xc0135761
    s_mov_b32 s42, 0x3d372713
    s_mov_b32 s44, 0x39e38e39
    s_mov_b32 s45, 0x3727c5ac
    v_lshrrev_b32_e64 v4, 1, v1
    s_lshl_b32 s52, s22, 7
    s_add_u32 s52, s52, s23
    s_lshl_b32 s52, s52, 8
    s_add_u32 s52, s52, 0x4509000
    s_add_u32 s52, s52, s4
    s_addc_u32 s53, s5, 0
    s_waitcnt vmcnt(0)
    s_barrier
    s_cmp_lg_u32 s20, 0
    s_cbranch_scc1 L_ns_d3
    s_mov_b32 s56, 1
    s_atomic_add s56, s[50:51], 0
L_ns_d3:
    s_cmp_lg_u32 s20, 0
    s_cbranch_scc1 L_pd_d3
    s_mov_b32 s60, 65536
L_poll_d3:
    s_mov_b32 s57, 0
    s_atomic_add s57, s[52:53], 0 glc
    s_waitcnt lgkmcnt(0)
    s_cmp_ge_u32 s57, 16
    s_cbranch_scc1 L_pd_d3
    s_sub_u32 s60, s60, 1
    s_cbranch_scc1 L_pd_d3
    s_sleep 2
    s_branch L_poll_d3
L_pd_d3:
    s_barrier
    buffer_load_dwordx2 v[8:9], v4, s[4:7], s32 offen offset:0 sc1
    buffer_load_dwordx2 v[10:11], v4, s[4:7], s32 offen offset:512 sc1
    buffer_load_dwordx2 v[12:13], v4, s[4:7], s32 offen offset:1024 sc1
    buffer_load_dwordx2 v[14:15], v4, s[4:7], s32 offen offset:1536 sc1
    s_lshl_b32 s50, s22, 7
    s_add_u32 s50, s50, s23
    s_lshl_b32 s50, s50, 8
    s_add_u32 s50, s50, 0x450a000
    s_add_u32 s50, s50, s4
    s_addc_u32 s51, s5, 0
    s_barrier
    ds_read_b128 v[160:163], v3 offset:0
    ds_read_b128 v[164:167], v3 offset:2048
    ds_read_b128 v[168:171], v1 offset:0
    ds_read_b128 v[172:175], v1 offset:1024
    ds_read_b128 v[176:179], v1 offset:2048
    ds_read_b128 v[180:183], v1 offset:3072
    ds_read_b128 v[184:187], v1 offset:4096
    ds_read_b128 v[188:191], v1 offset:5120
    ds_read_b128 v[192:195], v1 offset:6144
    ds_read_b128 v[196:199], v1 offset:7168
    ds_read_b128 v[200:203], v1 offset:8192
    s_waitcnt lgkmcnt(5)
    v_mfma_f32_16x16x32_bf16 v[16:19], v[160:163], v[168:171], 0
    ds_read_b128 v[204:207], v3 offset:1024
    v_mfma_f32_16x16x32_bf16 v[20:23], v[164:167], v[168:171], 0
    ds_read_b128 v[208:211], v3 offset:3072
    v_mfma_f32_16x16x32_bf16 v[24:27], v[160:163], v[172:175], 0
    ds_read_b128 v[212:215], v1 offset:9216
    v_mfma_f32_16x16x32_bf16 v[28:31], v[164:167], v[172:175], 0
    ds_read_b128 v[216:219], v1 offset:10240
    v_mfma_f32_16x16x32_bf16 v[32:35], v[160:163], v[176:179], 0
    ds_read_b128 v[220:223], v1 offset:11264
    v_mfma_f32_16x16x32_bf16 v[36:39], v[164:167], v[176:179], 0
    ds_read_b128 v[224:227], v1 offset:12288
    v_mfma_f32_16x16x32_bf16 v[40:43], v[160:163], v[180:183], 0
    ds_read_b128 v[228:231], v1 offset:13312
    v_mfma_f32_16x16x32_bf16 v[44:47], v[164:167], v[180:183], 0
    ds_read_b128 v[232:235], v1 offset:14336
    s_waitcnt lgkmcnt(8)
    v_mfma_f32_16x16x32_bf16 v[48:51], v[160:163], v[184:187], 0
    ds_read_b128 v[236:239], v1 offset:15360
    v_mfma_f32_16x16x32_bf16 v[52:55], v[164:167], v[184:187], 0
    ds_read_b128 v[240:243], v1 offset:16384
    v_mfma_f32_16x16x32_bf16 v[56:59], v[160:163], v[188:191], 0
    ds_read_b128 v[244:247], v1 offset:17408
    v_mfma_f32_16x16x32_bf16 v[60:63], v[164:167], v[188:191], 0
    v_mfma_f32_16x16x32_bf16 v[64:67], v[160:163], v[192:195], 0
    v_mfma_f32_16x16x32_bf16 v[68:71], v[164:167], v[192:195], 0
    v_mfma_f32_16x16x32_bf16 v[72:75], v[160:163], v[196:199], 0
    v_mfma_f32_16x16x32_bf16 v[76:79], v[164:167], v[196:199], 0
    v_mfma_f32_16x16x32_bf16 v[80:83], v[160:163], v[200:203], 0
    v_mfma_f32_16x16x32_bf16 v[84:87], v[164:167], v[200:203], 0
    s_waitcnt lgkmcnt(0)
    s_barrier
    v_mfma_f32_16x16x32_bf16 v[16:19], v[204:207], v[212:215], v[16:19]
    ds_read_b128 v[160:163], v3 offset:36864
    v_mfma_f32_16x16x32_bf16 v[20:23], v[208:211], v[212:215], v[20:23]
    ds_read_b128 v[164:167], v3 offset:38912
    v_mfma_f32_16x16x32_bf16 v[24:27], v[204:207], v[216:219], v[24:27]
    ds_read_b128 v[168:171], v1 offset:36864
    v_mfma_f32_16x16x32_bf16 v[28:31], v[208:211], v[216:219], v[28:31]
    ds_read_b128 v[172:175], v1 offset:37888
    v_mfma_f32_16x16x32_bf16 v[32:35], v[204:207], v[220:223], v[32:35]
    ds_read_b128 v[176:179], v1 offset:38912
    v_mfma_f32_16x16x32_bf16 v[36:39], v[208:211], v[220:223], v[36:39]
    ds_read_b128 v[180:183], v1 offset:39936
    v_mfma_f32_16x16x32_bf16 v[40:43], v[204:207], v[224:227], v[40:43]
    ds_read_b128 v[184:187], v1 offset:40960
    v_mfma_f32_16x16x32_bf16 v[44:47], v[208:211], v[224:227], v[44:47]
    ds_read_b128 v[188:191], v1 offset:41984
    v_mfma_f32_16x16x32_bf16 v[48:51], v[204:207], v[228:231], v[48:51]
    ds_read_b128 v[192:195], v1 offset:43008
    v_mfma_f32_16x16x32_bf16 v[52:55], v[208:211], v[228:231], v[52:55]
    ds_read_b128 v[196:199], v1 offset:44032
    v_lshrrev_b32_e64 v5, 8, v1
    v_mfma_f32_16x16x32_bf16 v[56:59], v[204:207], v[232:235], v[56:59]
    ds_read_b128 v[200:203], v1 offset:45056
    v_bfe_u32 v6, v1, 4, 4
    v_mfma_f32_16x16x32_bf16 v[60:63], v[208:211], v[232:235], v[60:63]
    v_lshlrev_b32_e64 v7, 2, v6
    v_mfma_f32_16x16x32_bf16 v[64:67], v[204:207], v[236:239], v[64:67]
    s_lshl_b32 s33, s20, 8
    v_mfma_f32_16x16x32_bf16 v[68:71], v[208:211], v[236:239], v[68:71]
    s_add_u32 s33, s33, 147456
    v_mfma_f32_16x16x32_bf16 v[72:75], v[204:207], v[240:243], v[72:75]
    v_add_u32 v4, s33, v7
    v_mfma_f32_16x16x32_bf16 v[76:79], v[208:211], v[240:243], v[76:79]
    v_lshl_add_u32 v252, v5, 4, s33
    v_mfma_f32_16x16x32_bf16 v[80:83], v[204:207], v[244:247], v[80:83]
    v_add_u32 v7, 159744, v7
    v_mfma_f32_16x16x32_bf16 v[84:87], v[208:211], v[244:247], v[84:87]
    s_waitcnt vmcnt(0)
    v_add_f32_e64 v248, v8, v10
    s_waitcnt lgkmcnt(5)
    v_mfma_f32_16x16x32_bf16 v[16:19], v[160:163], v[168:171], v[16:19]
    ds_read_b128 v[204:207], v3 offset:37888
    v_mfma_f32_16x16x32_bf16 v[20:23], v[164:167], v[168:171], v[20:23]
    ds_read_b128 v[208:211], v3 offset:39936
    v_mfma_f32_16x16x32_bf16 v[24:27], v[160:163], v[172:175], v[24:27]
    ds_read_b128 v[212:215], v1 offset:46080
    v_mfma_f32_16x16x32_bf16 v[28:31], v[164:167], v[172:175], v[28:31]
    ds_read_b128 v[216:219], v1 offset:47104
    v_mfma_f32_16x16x32_bf16 v[32:35], v[160:163], v[176:179], v[32:35]
    ds_read_b128 v[220:223], v1 offset:48128
    v_mfma_f32_16x16x32_bf16 v[36:39], v[164:167], v[176:179], v[36:39]
    ds_read_b128 v[224:227], v1 offset:49152
    v_mfma_f32_16x16x32_bf16 v[40:43], v[160:163], v[180:183], v[40:43]
    ds_read_b128 v[228:231], v1 offset:50176
    v_mfma_f32_16x16x32_bf16 v[44:47], v[164:167], v[180:183], v[44:47]
    ds_read_b128 v[232:235], v1 offset:51200
    s_waitcnt lgkmcnt(8)
    v_mfma_f32_16x16x32_bf16 v[48:51], v[160:163], v[184:187], v[48:51]
    ds_read_b128 v[236:239], v1 offset:52224
    v_mfma_f32_16x16x32_bf16 v[52:55], v[164:167], v[184:187], v[52:55]
    ds_read_b128 v[240:243], v1 offset:53248
    v_add_f32 v249, v9, v11
    v_mfma_f32_16x16x32_bf16 v[56:59], v[160:163], v[188:191], v[56:59]
    ds_read_b128 v[244:247], v1 offset:54272
    v_add_f32_e64 v250, v12, v14
    v_mfma_f32_16x16x32_bf16 v[60:63], v[164:167], v[188:191], v[60:63]
    v_add_f32_e64 v251, v13, v15
    v_mfma_f32_16x16x32_bf16 v[64:67], v[160:163], v[192:195], v[64:67]
    v_mov_b32_e64 v8, v248
    v_mfma_f32_16x16x32_bf16 v[68:71], v[164:167], v[192:195], v[68:71]
    v_mov_b32_e64 v9, v249
    v_mfma_f32_16x16x32_bf16 v[72:75], v[160:163], v[196:199], v[72:75]
    v_mov_b32_e64 v12, v250
    v_mfma_f32_16x16x32_bf16 v[76:79], v[164:167], v[196:199], v[76:79]
    v_mov_b32_e64 v13, v251
    v_mfma_f32_16x16x32_bf16 v[80:83], v[160:163], v[200:203], v[80:83]
    v_permlane32_swap_b32 v248, v8
    v_mfma_f32_16x16x32_bf16 v[84:87], v[164:167], v[200:203], v[84:87]
    v_permlane32_swap_b32 v249, v9
    v_permlane32_swap_b32 v250, v12
    s_waitcnt lgkmcnt(0)
    s_barrier
    v_mfma_f32_16x16x32_bf16 v[16:19], v[204:207], v[212:215], v[16:19]
    ds_read_b128 v[160:163], v0 offset:0
    v_mfma_f32_16x16x32_bf16 v[20:23], v[208:211], v[212:215], v[20:23]
    ds_read_b128 v[164:167], v0 offset:2048
    v_mfma_f32_16x16x32_bf16 v[24:27], v[204:207], v[216:219], v[24:27]
    ds_read_b128 v[168:171], v2 offset:0
    v_mfma_f32_16x16x32_bf16 v[28:31], v[208:211], v[216:219], v[28:31]
    ds_read_b128 v[172:175], v2 offset:1024
    v_mfma_f32_16x16x32_bf16 v[32:35], v[204:207], v[220:223], v[32:35]
    ds_read_b128 v[176:179], v2 offset:2048
    v_mfma_f32_16x16x32_bf16 v[36:39], v[208:211], v[220:223], v[36:39]
    ds_read_b128 v[180:183], v2 offset:3072
    v_mfma_f32_16x16x32_bf16 v[40:43], v[204:207], v[224:227], v[40:43]
    ds_read_b128 v[184:187], v2 offset:4096
    v_mfma_f32_16x16x32_bf16 v[44:47], v[208:211], v[224:227], v[44:47]
    ds_read_b128 v[188:191], v2 offset:5120
    v_mfma_f32_16x16x32_bf16 v[48:51], v[204:207], v[228:231], v[48:51]
    ds_read_b128 v[192:195], v2 offset:6144
    v_mfma_f32_16x16x32_bf16 v[52:55], v[208:211], v[228:231], v[52:55]
    ds_read_b128 v[196:199], v2 offset:7168
    v_permlane32_swap_b32 v251, v13
    v_mfma_f32_16x16x32_bf16 v[56:59], v[204:207], v[232:235], v[56:59]
    ds_read_b128 v[200:203], v2 offset:8192
    v_add_f32_e64 v248, v248, v8
    v_mfma_f32_16x16x32_bf16 v[60:63], v[208:211], v[232:235], v[60:63]
    ds_read2_b32 v[128:129], v7 offset0:0 offset1:16
    v_add_f32_e64 v249, v249, v9
    v_mfma_f32_16x16x32_bf16 v[64:67], v[204:207], v[236:239], v[64:67]
    ds_read2_b32 v[130:131], v7 offset0:32 offset1:48
    v_add_f32_e64 v250, v250, v12
    v_mfma_f32_16x16x32_bf16 v[68:71], v[208:211], v[236:239], v[68:71]
    ds_read2_b32 v[132:133], v7 offset0:64 offset1:80
    v_add_f32_e64 v251, v251, v13
    v_mfma_f32_16x16x32_bf16 v[72:75], v[204:207], v[240:243], v[72:75]
    ds_read2_b32 v[134:135], v7 offset0:96 offset1:112
    v_mov_b32_e64 v8, v248
    v_mfma_f32_16x16x32_bf16 v[76:79], v[208:211], v[240:243], v[76:79]
    ds_read2_b32 v[136:137], v7 offset0:128 offset1:144
    v_mov_b32_e64 v9, v249
    v_mfma_f32_16x16x32_bf16 v[80:83], v[204:207], v[244:247], v[80:83]
    v_mov_b32_e64 v12, v250
    v_mfma_f32_16x16x32_bf16 v[84:87], v[208:211], v[244:247], v[84:87]
    v_mov_b32_e64 v13, v251
    v_permlane16_swap_b32 v248, v8
    s_waitcnt lgkmcnt(10)
    v_mfma_f32_16x16x32_bf16 v[16:19], v[160:163], v[168:171], v[16:19]
    ds_read_b128 v[204:207], v0 offset:1024
    v_mfma_f32_16x16x32_bf16 v[20:23], v[164:167], v[168:171], v[20:23]
    ds_read_b128 v[208:211], v0 offset:3072
    v_mfma_f32_16x16x32_bf16 v[24:27], v[160:163], v[172:175], v[24:27]
    ds_read_b128 v[212:215], v2 offset:9216
    v_mfma_f32_16x16x32_bf16 v[28:31], v[164:167], v[172:175], v[28:31]
    ds_read_b128 v[216:219], v2 offset:10240
    v_mfma_f32_16x16x32_bf16 v[32:35], v[160:163], v[176:179], v[32:35]
    ds_read_b128 v[220:223], v2 offset:11264
    v_mfma_f32_16x16x32_bf16 v[36:39], v[164:167], v[176:179], v[36:39]
    ds_read_b128 v[224:227], v2 offset:12288
    v_mfma_f32_16x16x32_bf16 v[40:43], v[160:163], v[180:183], v[40:43]
    ds_read_b128 v[228:231], v2 offset:13312
    v_mfma_f32_16x16x32_bf16 v[44:47], v[164:167], v[180:183], v[44:47]
    ds_read_b128 v[232:235], v2 offset:14336
    s_waitcnt lgkmcnt(8)
    v_mfma_f32_16x16x32_bf16 v[48:51], v[160:163], v[184:187], v[48:51]
    ds_read_b128 v[236:239], v2 offset:15360
    v_mfma_f32_16x16x32_bf16 v[52:55], v[164:167], v[184:187], v[52:55]
    ds_read_b128 v[240:243], v2 offset:16384
    v_permlane16_swap_b32 v249, v9
    v_mfma_f32_16x16x32_bf16 v[56:59], v[160:163], v[188:191], v[56:59]
    ds_read_b128 v[244:247], v2 offset:17408
    v_permlane16_swap_b32 v250, v12
    v_mfma_f32_16x16x32_bf16 v[60:63], v[164:167], v[188:191], v[60:63]
    v_permlane16_swap_b32 v251, v13
    v_mfma_f32_16x16x32_bf16 v[64:67], v[160:163], v[192:195], v[64:67]
    v_add_f32_e64 v248, v248, v8
    v_mfma_f32_16x16x32_bf16 v[68:71], v[164:167], v[192:195], v[68:71]
    v_add_f32_e64 v249, v249, v9
    v_mfma_f32_16x16x32_bf16 v[72:75], v[160:163], v[196:199], v[72:75]
    v_add_f32_e64 v250, v250, v12
    v_mfma_f32_16x16x32_bf16 v[76:79], v[164:167], v[196:199], v[76:79]
    v_add_f32_e64 v251, v251, v13
    v_mfma_f32_16x16x32_bf16 v[80:83], v[160:163], v[200:203], v[80:83]
    v_mul_f32 v248, 0x3ae38e39, v248
    v_mfma_f32_16x16x32_bf16 v[84:87], v[164:167], v[200:203], v[84:87]
    v_mul_f32 v249, 0x3ae38e39, v249
    v_mul_f32 v250, 0x3ae38e39, v250
    s_waitcnt lgkmcnt(0)
    s_barrier
    v_mfma_f32_16x16x32_bf16 v[16:19], v[204:207], v[212:215], v[16:19]
    ds_read_b128 v[160:163], v0 offset:36864
    v_mfma_f32_16x16x32_bf16 v[20:23], v[208:211], v[212:215], v[20:23]
    ds_read_b128 v[164:167], v0 offset:38912
    v_mfma_f32_16x16x32_bf16 v[24:27], v[204:207], v[216:219], v[24:27]
    ds_read_b128 v[168:171], v2 offset:36864
    v_mfma_f32_16x16x32_bf16 v[28:31], v[208:211], v[216:219], v[28:31]
    ds_read_b128 v[172:175], v2 offset:37888
    v_mfma_f32_16x16x32_bf16 v[32:35], v[204:207], v[220:223], v[32:35]
    ds_read_b128 v[176:179], v2 offset:38912
    v_mfma_f32_16x16x32_bf16 v[36:39], v[208:211], v[220:223], v[36:39]
    ds_read_b128 v[180:183], v2 offset:39936
    v_mfma_f32_16x16x32_bf16 v[40:43], v[204:207], v[224:227], v[40:43]
    ds_read_b128 v[184:187], v2 offset:40960
    v_mfma_f32_16x16x32_bf16 v[44:47], v[208:211], v[224:227], v[44:47]
    ds_read_b128 v[188:191], v2 offset:41984
    v_mfma_f32_16x16x32_bf16 v[48:51], v[204:207], v[228:231], v[48:51]
    ds_read_b128 v[192:195], v2 offset:43008
    v_mfma_f32_16x16x32_bf16 v[52:55], v[208:211], v[228:231], v[52:55]
    ds_read_b128 v[196:199], v2 offset:44032
    v_mul_f32 v251, 0x3ae38e39, v251
    v_mfma_f32_16x16x32_bf16 v[56:59], v[204:207], v[232:235], v[56:59]
    ds_read_b128 v[200:203], v2 offset:45056
    v_fma_f32 v249, -v248, v248, v249
    v_mfma_f32_16x16x32_bf16 v[60:63], v[208:211], v[232:235], v[60:63]
    v_fma_f32 v251, -v250, v250, v251
    v_mfma_f32_16x16x32_bf16 v[64:67], v[204:207], v[236:239], v[64:67]
    v_max_f32_e64 v249, 0, v249
    v_mfma_f32_16x16x32_bf16 v[68:71], v[208:211], v[236:239], v[68:71]
    v_max_f32_e64 v251, 0, v251
    v_mfma_f32_16x16x32_bf16 v[72:75], v[204:207], v[240:243], v[72:75]
    v_add_f32 v249, 0x3727c5ac, v249
    v_mfma_f32_16x16x32_bf16 v[76:79], v[208:211], v[240:243], v[76:79]
    v_add_f32 v251, 0x3727c5ac, v251
    v_mfma_f32_16x16x32_bf16 v[80:83], v[204:207], v[244:247], v[80:83]
    v_rsq_f32_e64 v249, v249
    v_mfma_f32_16x16x32_bf16 v[84:87], v[208:211], v[244:247], v[84:87]
    v_rsq_f32_e64 v251, v251
    s_nop 0
    s_waitcnt lgkmcnt(5)
    v_mfma_f32_16x16x32_bf16 v[16:19], v[160:163], v[168:171], v[16:19]
    ds_read_b128 v[204:207], v0 offset:37888
    v_mfma_f32_16x16x32_bf16 v[20:23], v[164:167], v[168:171], v[20:23]
    ds_read_b128 v[208:211], v0 offset:39936
    v_mfma_f32_16x16x32_bf16 v[24:27], v[160:163], v[172:175], v[24:27]
    ds_read_b128 v[212:215], v2 offset:46080
    v_mfma_f32_16x16x32_bf16 v[28:31], v[164:167], v[172:175], v[28:31]
    ds_read_b128 v[216:219], v2 offset:47104
    v_mfma_f32_16x16x32_bf16 v[32:35], v[160:163], v[176:179], v[32:35]
    ds_read_b128 v[220:223], v2 offset:48128
    v_mfma_f32_16x16x32_bf16 v[36:39], v[164:167], v[176:179], v[36:39]
    ds_read_b128 v[224:227], v2 offset:49152
    v_mfma_f32_16x16x32_bf16 v[40:43], v[160:163], v[180:183], v[40:43]
    ds_read_b128 v[228:231], v2 offset:50176
    v_mfma_f32_16x16x32_bf16 v[44:47], v[164:167], v[180:183], v[44:47]
    ds_read_b128 v[232:235], v2 offset:51200
    s_waitcnt lgkmcnt(8)
    v_mfma_f32_16x16x32_bf16 v[48:51], v[160:163], v[184:187], v[48:51]
    ds_read_b128 v[236:239], v2 offset:52224
    v_mfma_f32_16x16x32_bf16 v[52:55], v[164:167], v[184:187], v[52:55]
    ds_read_b128 v[240:243], v2 offset:53248
    v_mfma_f32_16x16x32_bf16 v[56:59], v[160:163], v[188:191], v[56:59]
    ds_read_b128 v[244:247], v2 offset:54272
    v_mfma_f32_16x16x32_bf16 v[60:63], v[164:167], v[188:191], v[60:63]
    v_mfma_f32_16x16x32_bf16 v[64:67], v[160:163], v[192:195], v[64:67]
    v_mfma_f32_16x16x32_bf16 v[68:71], v[164:167], v[192:195], v[68:71]
    v_mfma_f32_16x16x32_bf16 v[72:75], v[160:163], v[196:199], v[72:75]
    v_mfma_f32_16x16x32_bf16 v[76:79], v[164:167], v[196:199], v[76:79]
    v_mfma_f32_16x16x32_bf16 v[80:83], v[160:163], v[200:203], v[80:83]
    v_mfma_f32_16x16x32_bf16 v[84:87], v[164:167], v[200:203], v[84:87]
    s_waitcnt lgkmcnt(0)
    s_barrier
    v_mfma_f32_16x16x32_bf16 v[16:19], v[204:207], v[212:215], v[16:19]
    ds_read_b128 v[160:163], v3 offset:0
    v_mfma_f32_16x16x32_bf16 v[20:23], v[208:211], v[212:215], v[20:23]
    ds_read_b128 v[164:167], v3 offset:2048
    v_mfma_f32_16x16x32_bf16 v[24:27], v[204:207], v[216:219], v[24:27]
    ds_read_b128 v[168:171], v1 offset:0
    v_mfma_f32_16x16x32_bf16 v[28:31], v[208:211], v[216:219], v[28:31]
    ds_read_b128 v[172:175], v1 offset:1024
    v_mfma_f32_16x16x32_bf16 v[32:35], v[204:207], v[220:223], v[32:35]
    ds_read_b128 v[176:179], v1 offset:2048
    v_mfma_f32_16x16x32_bf16 v[36:39], v[208:211], v[220:223], v[36:39]
    ds_read_b128 v[180:183], v1 offset:3072
    v_mfma_f32_16x16x32_bf16 v[40:43], v[204:207], v[224:227], v[40:43]
    ds_read_b128 v[184:187], v1 offset:4096
    v_mfma_f32_16x16x32_bf16 v[44:47], v[208:211], v[224:227], v[44:47]
    ds_read_b128 v[188:191], v1 offset:5120
    v_mfma_f32_16x16x32_bf16 v[48:51], v[204:207], v[228:231], v[48:51]
    ds_read_b128 v[192:195], v1 offset:6144
    v_mfma_f32_16x16x32_bf16 v[52:55], v[208:211], v[228:231], v[52:55]
    ds_read_b128 v[196:199], v1 offset:7168
    v_mfma_f32_16x16x32_bf16 v[56:59], v[204:207], v[232:235], v[56:59]
    ds_read_b128 v[200:203], v1 offset:8192
    v_mfma_f32_16x16x32_bf16 v[60:63], v[208:211], v[232:235], v[60:63]
    ds_write2_b32 v4, v248, v249 offset0:0 offset1:32
    v_mfma_f32_16x16x32_bf16 v[64:67], v[204:207], v[236:239], v[64:67]
    ds_write2_b32 v4, v250, v251 offset0:16 offset1:48
    v_mfma_f32_16x16x32_bf16 v[68:71], v[208:211], v[236:239], v[68:71]
    ds_read_b128 v[88:91], v252 offset:0
    v_mfma_f32_16x16x32_bf16 v[72:75], v[204:207], v[240:243], v[72:75]
    ds_read_b128 v[92:95], v252 offset:64
    v_mfma_f32_16x16x32_bf16 v[76:79], v[208:211], v[240:243], v[76:79]
    ds_read_b128 v[96:99], v252 offset:128
    v_mfma_f32_16x16x32_bf16 v[80:83], v[204:207], v[244:247], v[80:83]
    ds_read_b128 v[100:103], v252 offset:192
    v_mfma_f32_16x16x32_bf16 v[84:87], v[208:211], v[244:247], v[84:87]
    s_waitcnt lgkmcnt(11)
    v_mfma_f32_16x16x32_bf16 v[16:19], v[160:163], v[168:171], v[16:19]
    ds_read_b128 v[204:207], v3 offset:1024
    v_mfma_f32_16x16x32_bf16 v[20:23], v[164:167], v[168:171], v[20:23]
    ds_read_b128 v[208:211], v3 offset:3072
    v_mfma_f32_16x16x32_bf16 v[24:27], v[160:163], v[172:175], v[24:27]
    ds_read_b128 v[212:215], v1 offset:9216
    v_mfma_f32_16x16x32_bf16 v[28:31], v[164:167], v[172:175], v[28:31]
    ds_read_b128 v[216:219], v1 offset:10240
    v_mfma_f32_16x16x32_bf16 v[32:35], v[160:163], v[176:179], v[32:35]
    ds_read_b128 v[220:223], v1 offset:11264
    v_mfma_f32_16x16x32_bf16 v[36:39], v[164:167], v[176:179], v[36:39]
    ds_read_b128 v[224:227], v1 offset:12288
    v_mfma_f32_16x16x32_bf16 v[40:43], v[160:163], v[180:183], v[40:43]
    ds_read_b128 v[228:231], v1 offset:13312
    v_mfma_f32_16x16x32_bf16 v[44:47], v[164:167], v[180:183], v[44:47]
    ds_read_b128 v[232:235], v1 offset:14336
    s_waitcnt lgkmcnt(8)
    v_mfma_f32_16x16x32_bf16 v[48:51], v[160:163], v[184:187], v[48:51]
    ds_read_b128 v[236:239], v1 offset:15360
    v_mfma_f32_16x16x32_bf16 v[52:55], v[164:167], v[184:187], v[52:55]
    ds_read_b128 v[240:243], v1 offset:16384
    v_rcp_f32 v120, v96
    v_mfma_f32_16x16x32_bf16 v[56:59], v[160:163], v[188:191], v[56:59]
    ds_read_b128 v[244:247], v1 offset:17408
    v_mul_f32_e64 v104, s40, v96
    v_mfma_f32_16x16x32_bf16 v[60:63], v[164:167], v[188:191], v[60:63]
    v_mul_f32_e64 v112, v96, v96
    v_mfma_f32_16x16x32_bf16 v[64:67], v[160:163], v[192:195], v[64:67]
    v_rcp_f32_e64 v121, v97
    v_mfma_f32_16x16x32_bf16 v[68:71], v[164:167], v[192:195], v[68:71]
    v_mul_f32_e64 v105, s40, v97
    v_mfma_f32_16x16x32_bf16 v[72:75], v[160:163], v[196:199], v[72:75]
    v_mul_f32_e64 v113, v97, v97
    v_mfma_f32_16x16x32_bf16 v[76:79], v[164:167], v[196:199], v[76:79]
    v_rcp_f32_e64 v122, v98
    v_mfma_f32_16x16x32_bf16 v[80:83], v[160:163], v[200:203], v[80:83]
    v_mul_f32_e64 v106, s40, v98
    v_mfma_f32_16x16x32_bf16 v[84:87], v[164:167], v[200:203], v[84:87]
    v_mul_f32 v114, v98, v98
    v_rcp_f32 v123, v99
    s_waitcnt lgkmcnt(0)
    s_barrier
    v_mfma_f32_16x16x32_bf16 v[16:19], v[204:207], v[212:215], v[16:19]
    ds_read_b128 v[160:163], v3 offset:36864
    v_mfma_f32_16x16x32_bf16 v[20:23], v[208:211], v[212:215], v[20:23]
    ds_read_b128 v[164:167], v3 offset:38912
    v_mfma_f32_16x16x32_bf16 v[24:27], v[204:207], v[216:219], v[24:27]
    ds_read_b128 v[168:171], v1 offset:36864
    v_mfma_f32_16x16x32_bf16 v[28:31], v[208:211], v[216:219], v[28:31]
    ds_read_b128 v[172:175], v1 offset:37888
    v_mfma_f32_16x16x32_bf16 v[32:35], v[204:207], v[220:223], v[32:35]
    ds_read_b128 v[176:179], v1 offset:38912
    v_mfma_f32_16x16x32_bf16 v[36:39], v[208:211], v[220:223], v[36:39]
    ds_read_b128 v[180:183], v1 offset:39936
    v_mfma_f32_16x16x32_bf16 v[40:43], v[204:207], v[224:227], v[40:43]
    ds_read_b128 v[184:187], v1 offset:40960
    v_mfma_f32_16x16x32_bf16 v[44:47], v[208:211], v[224:227], v[44:47]
    ds_read_b128 v[188:191], v1 offset:41984
    v_mfma_f32_16x16x32_bf16 v[48:51], v[204:207], v[228:231], v[48:51]
    ds_read_b128 v[192:195], v1 offset:43008
    v_mfma_f32_16x16x32_bf16 v[52:55], v[208:211], v[228:231], v[52:55]
    ds_read_b128 v[196:199], v1 offset:44032
    v_mul_f32_e64 v107, s40, v99
    v_mfma_f32_16x16x32_bf16 v[56:59], v[204:207], v[232:235], v[56:59]
    ds_read_b128 v[200:203], v1 offset:45056
    v_mul_f32_e64 v115, v99, v99
    v_mfma_f32_16x16x32_bf16 v[60:63], v[208:211], v[232:235], v[60:63]
    v_rcp_f32_e64 v124, v100
    v_mfma_f32_16x16x32_bf16 v[64:67], v[204:207], v[236:239], v[64:67]
    v_mul_f32_e64 v108, s40, v100
    v_mfma_f32_16x16x32_bf16 v[68:71], v[208:211], v[236:239], v[68:71]
    v_mul_f32_e64 v116, v100, v100
    v_mfma_f32_16x16x32_bf16 v[72:75], v[204:207], v[240:243], v[72:75]
    v_rcp_f32_e64 v125, v101
    v_mfma_f32_16x16x32_bf16 v[76:79], v[208:211], v[240:243], v[76:79]
    v_mul_f32_e64 v109, s40, v101
    v_mfma_f32_16x16x32_bf16 v[80:83], v[204:207], v[244:247], v[80:83]
    v_mul_f32_e64 v117, v101, v101
    v_mfma_f32_16x16x32_bf16 v[84:87], v[208:211], v[244:247], v[84:87]
    v_rcp_f32 v126, v102
    v_mul_f32_e64 v110, s40, v102
    s_waitcnt lgkmcnt(5)
    v_mfma_f32_16x16x32_bf16 v[16:19], v[160:163], v[168:171], v[16:19]
    ds_read_b128 v[204:207], v3 offset:37888
    v_mfma_f32_16x16x32_bf16 v[20:23], v[164:167], v[168:171], v[20:23]
    ds_read_b128 v[208:211], v3 offset:39936
    v_mfma_f32_16x16x32_bf16 v[24:27], v[160:163], v[172:175], v[24:27]
    ds_read_b128 v[212:215], v1 offset:46080
    v_mfma_f32_16x16x32_bf16 v[28:31], v[164:167], v[172:175], v[28:31]
    ds_read_b128 v[216:219], v1 offset:47104
    v_mfma_f32_16x16x32_bf16 v[32:35], v[160:163], v[176:179], v[32:35]
    ds_read_b128 v[220:223], v1 offset:48128
    v_mfma_f32_16x16x32_bf16 v[36:39], v[164:167], v[176:179], v[36:39]
    ds_read_b128 v[224:227], v1 offset:49152
    v_mfma_f32_16x16x32_bf16 v[40:43], v[160:163], v[180:183], v[40:43]
    ds_read_b128 v[228:231], v1 offset:50176
    v_mfma_f32_16x16x32_bf16 v[44:47], v[164:167], v[180:183], v[44:47]
    ds_read_b128 v[232:235], v1 offset:51200
    s_waitcnt lgkmcnt(8)
    v_mfma_f32_16x16x32_bf16 v[48:51], v[160:163], v[184:187], v[48:51]
    ds_read_b128 v[236:239], v1 offset:52224
    v_mfma_f32_16x16x32_bf16 v[52:55], v[164:167], v[184:187], v[52:55]
    ds_read_b128 v[240:243], v1 offset:53248
    v_mul_f32 v118, v102, v102
    v_mfma_f32_16x16x32_bf16 v[56:59], v[160:163], v[188:191], v[56:59]
    ds_read_b128 v[244:247], v1 offset:54272
    v_rcp_f32_e64 v127, v103
    v_mfma_f32_16x16x32_bf16 v[60:63], v[164:167], v[188:191], v[60:63]
    v_mul_f32_e64 v111, s40, v103
    v_mfma_f32_16x16x32_bf16 v[64:67], v[160:163], v[192:195], v[64:67]
    v_mul_f32_e64 v119, v103, v103
    v_mfma_f32_16x16x32_bf16 v[68:71], v[164:167], v[192:195], v[68:71]
    v_mul_f32_e64 v112, s42, v112
    v_mfma_f32_16x16x32_bf16 v[72:75], v[160:163], v[196:199], v[72:75]
    v_mul_f32_e64 v113, s42, v113
    v_mfma_f32_16x16x32_bf16 v[76:79], v[164:167], v[196:199], v[76:79]
    v_mul_f32_e64 v114, s42, v114
    v_mfma_f32_16x16x32_bf16 v[80:83], v[160:163], v[200:203], v[80:83]
    v_mul_f32_e64 v115, s42, v115
    v_mfma_f32_16x16x32_bf16 v[84:87], v[164:167], v[200:203], v[84:87]
    v_mul_f32 v116, s42, v116
    v_mul_f32 v117, s42, v117
    s_waitcnt lgkmcnt(0)
    s_barrier
    v_mfma_f32_16x16x32_bf16 v[16:19], v[204:207], v[212:215], v[16:19]
    ds_read_b128 v[160:163], v0 offset:0
    v_mfma_f32_16x16x32_bf16 v[20:23], v[208:211], v[212:215], v[20:23]
    ds_read_b128 v[164:167], v0 offset:2048
    v_mfma_f32_16x16x32_bf16 v[24:27], v[204:207], v[216:219], v[24:27]
    ds_read_b128 v[168:171], v2 offset:0
    v_mfma_f32_16x16x32_bf16 v[28:31], v[208:211], v[216:219], v[28:31]
    ds_read_b128 v[172:175], v2 offset:1024
    v_mfma_f32_16x16x32_bf16 v[32:35], v[204:207], v[220:223], v[32:35]
    ds_read_b128 v[176:179], v2 offset:2048
    v_mfma_f32_16x16x32_bf16 v[36:39], v[208:211], v[220:223], v[36:39]
    ds_read_b128 v[180:183], v2 offset:3072
    v_mfma_f32_16x16x32_bf16 v[40:43], v[204:207], v[224:227], v[40:43]
    ds_read_b128 v[184:187], v2 offset:4096
    v_mfma_f32_16x16x32_bf16 v[44:47], v[208:211], v[224:227], v[44:47]
    ds_read_b128 v[188:191], v2 offset:5120
    v_mfma_f32_16x16x32_bf16 v[48:51], v[204:207], v[228:231], v[48:51]
    ds_read_b128 v[192:195], v2 offset:6144
    v_mfma_f32_16x16x32_bf16 v[52:55], v[208:211], v[228:231], v[52:55]
    ds_read_b128 v[196:199], v2 offset:7168
    v_mul_f32_e64 v118, s42, v118
    v_mfma_f32_16x16x32_bf16 v[56:59], v[204:207], v[232:235], v[56:59]
    ds_read_b128 v[200:203], v2 offset:8192
    v_mul_f32_e64 v119, s42, v119
    v_mfma_f32_16x16x32_bf16 v[60:63], v[208:211], v[232:235], v[60:63]
    v_mul_f32_e64 v112, v112, v104
    v_mfma_f32_16x16x32_bf16 v[64:67], v[204:207], v[236:239], v[64:67]
    v_mul_f32_e64 v113, v113, v105
    v_mfma_f32_16x16x32_bf16 v[68:71], v[208:211], v[236:239], v[68:71]
    v_mul_f32_e64 v114, v114, v106
    v_mfma_f32_16x16x32_bf16 v[72:75], v[204:207], v[240:243], v[72:75]
    v_mul_f32_e64 v115, v115, v107
    v_mfma_f32_16x16x32_bf16 v[76:79], v[208:211], v[240:243], v[76:79]
    v_mul_f32_e64 v116, v116, v108
    v_mfma_f32_16x16x32_bf16 v[80:83], v[204:207], v[244:247], v[80:83]
    v_mul_f32_e64 v117, v117, v109
    v_mfma_f32_16x16x32_bf16 v[84:87], v[208:211], v[244:247], v[84:87]
    v_mul_f32 v118, v118, v110
    v_mul_f32_e64 v119, v119, v111
    s_waitcnt lgkmcnt(5)
    v_mfma_f32_16x16x32_bf16 v[16:19], v[160:163], v[168:171], v[16:19]
    ds_read_b128 v[204:207], v0 offset:1024
    v_mfma_f32_16x16x32_bf16 v[20:23], v[164:167], v[168:171], v[20:23]
    ds_read_b128 v[208:211], v0 offset:3072
    v_mfma_f32_16x16x32_bf16 v[24:27], v[160:163], v[172:175], v[24:27]
    ds_read_b128 v[212:215], v2 offset:9216
    v_mfma_f32_16x16x32_bf16 v[28:31], v[164:167], v[172:175], v[28:31]
    ds_read_b128 v[216:219], v2 offset:10240
    v_mfma_f32_16x16x32_bf16 v[32:35], v[160:163], v[176:179], v[32:35]
    ds_read_b128 v[220:223], v2 offset:11264
    v_mfma_f32_16x16x32_bf16 v[36:39], v[164:167], v[176:179], v[36:39]
    ds_read_b128 v[224:227], v2 offset:12288
    v_mfma_f32_16x16x32_bf16 v[40:43], v[160:163], v[180:183], v[40:43]
    ds_read_b128 v[228:231], v2 offset:13312
    v_mfma_f32_16x16x32_bf16 v[44:47], v[164:167], v[180:183], v[44:47]
    ds_read_b128 v[232:235], v2 offset:14336
    s_waitcnt lgkmcnt(8)
    v_mfma_f32_16x16x32_bf16 v[48:51], v[160:163], v[184:187], v[48:51]
    ds_read_b128 v[236:239], v2 offset:15360
    v_mfma_f32_16x16x32_bf16 v[52:55], v[164:167], v[184:187], v[52:55]
    ds_read_b128 v[240:243], v2 offset:16384
    v_lshrrev_b32 v8, 2, v6
    v_mfma_f32_16x16x32_bf16 v[56:59], v[160:163], v[188:191], v[56:59]
    ds_read_b128 v[244:247], v2 offset:17408
    v_lshlrev_b32_e64 v8, 4, v8
    v_mfma_f32_16x16x32_bf16 v[60:63], v[164:167], v[188:191], v[60:63]
    v_lshl_add_u32 v8, v5, 6, v8
    v_mfma_f32_16x16x32_bf16 v[64:67], v[160:163], v[192:195], v[64:67]
    v_and_b32_e64 v9, 3, v6
    v_mfma_f32_16x16x32_bf16 v[68:71], v[164:167], v[192:195], v[68:71]
    v_cmp_eq_u32_e64 vcc, 0, v9
    v_mfma_f32_16x16x32_bf16 v[72:75], v[160:163], v[196:199], v[72:75]
    v_bfrev_b32_e64 v10, 1
    v_mfma_f32_16x16x32_bf16 v[76:79], v[164:167], v[196:199], v[76:79]
    v_xor_b32 v4, 256, v4
    v_mfma_f32_16x16x32_bf16 v[80:83], v[160:163], v[200:203], v[80:83]
    v_cndmask_b32_e64 v8, v10, v8, vcc
    v_mfma_f32_16x16x32_bf16 v[84:87], v[164:167], v[200:203], v[84:87]
    v_lshl_add_u32 v255, v5, 6, s33
    s_waitcnt lgkmcnt(0)
    s_barrier
    v_mfma_f32_16x16x32_bf16 v[16:19], v[204:207], v[212:215], v[16:19]
    ds_read_b128 v[160:163], v0 offset:36864
    v_fma_f32 v52, -v92, v132, v52
    v_mfma_f32_16x16x32_bf16 v[20:23], v[208:211], v[212:215], v[20:23]
    ds_read_b128 v[164:167], v0 offset:38912
    v_fma_f32 v56, -v88, v133, v56
    v_mfma_f32_16x16x32_bf16 v[24:27], v[204:207], v[216:219], v[24:27]
    ds_read_b128 v[168:171], v2 offset:36864
    v_fma_f32 v60, -v92, v133, v60
    v_mfma_f32_16x16x32_bf16 v[28:31], v[208:211], v[216:219], v[28:31]
    ds_read_b128 v[172:175], v2 offset:37888
    v_fma_f32 v64, -v88, v134, v64
    v_mfma_f32_16x16x32_bf16 v[32:35], v[204:207], v[220:223], v[32:35]
    ds_read_b128 v[176:179], v2 offset:38912
    v_fma_f32 v68, -v92, v134, v68
    v_mfma_f32_16x16x32_bf16 v[36:39], v[208:211], v[220:223], v[36:39]
    ds_read_b128 v[180:183], v2 offset:39936
    v_fma_f32 v72, -v88, v135, v72
    v_mfma_f32_16x16x32_bf16 v[40:43], v[204:207], v[224:227], v[40:43]
    ds_read_b128 v[184:187], v2 offset:40960
    v_fma_f32 v76, -v92, v135, v76
    v_mfma_f32_16x16x32_bf16 v[44:47], v[208:211], v[224:227], v[44:47]
    ds_read_b128 v[188:191], v2 offset:41984
    v_fma_f32 v80, -v88, v136, v80
    v_mfma_f32_16x16x32_bf16 v[48:51], v[204:207], v[228:231], v[48:51]
    ds_read_b128 v[192:195], v2 offset:43008
    v_fma_f32 v84, -v92, v136, v84
    v_mfma_f32_16x16x32_bf16 v[52:55], v[208:211], v[228:231], v[52:55]
    ds_read_b128 v[196:199], v2 offset:44032
    v_fma_f32 v16, -v88, v128, v16
    v_mfma_f32_16x16x32_bf16 v[56:59], v[204:207], v[232:235], v[56:59]
    ds_read_b128 v[200:203], v2 offset:45056
    v_fma_f32 v20, -v92, v128, v20
    v_mfma_f32_16x16x32_bf16 v[60:63], v[208:211], v[232:235], v[60:63]
    v_fma_f32 v24, -v88, v129, v24
    v_mfma_f32_16x16x32_bf16 v[64:67], v[204:207], v[236:239], v[64:67]
    v_fma_f32 v28, -v92, v129, v28
    v_mfma_f32_16x16x32_bf16 v[68:71], v[208:211], v[236:239], v[68:71]
    v_fma_f32 v32, -v88, v130, v32
    v_mfma_f32_16x16x32_bf16 v[72:75], v[204:207], v[240:243], v[72:75]
    v_fma_f32 v36, -v92, v130, v36
    v_mfma_f32_16x16x32_bf16 v[76:79], v[208:211], v[240:243], v[76:79]
    v_fma_f32 v40, -v88, v131, v40
    v_mfma_f32_16x16x32_bf16 v[80:83], v[204:207], v[244:247], v[80:83]
    v_fma_f32 v44, -v92, v131, v44
    v_mfma_f32_16x16x32_bf16 v[84:87], v[208:211], v[244:247], v[84:87]
    v_fma_f32 v48, -v88, v132, v48
    s_waitcnt lgkmcnt(5)
    v_mfma_f32_16x16x32_bf16 v[16:19], v[160:163], v[168:171], v[16:19]
    ds_read_b128 v[204:207], v0 offset:37888
    v_fma_f32 v53, -v93, v132, v53
    v_mfma_f32_16x16x32_bf16 v[20:23], v[164:167], v[168:171], v[20:23]
    ds_read_b128 v[208:211], v0 offset:39936
    v_fma_f32 v57, -v89, v133, v57
    v_mfma_f32_16x16x32_bf16 v[24:27], v[160:163], v[172:175], v[24:27]
    ds_read_b128 v[212:215], v2 offset:46080
    v_fma_f32 v61, -v93, v133, v61
    v_mfma_f32_16x16x32_bf16 v[28:31], v[164:167], v[172:175], v[28:31]
    ds_read_b128 v[216:219], v2 offset:47104
    v_fma_f32 v65, -v89, v134, v65
    v_mfma_f32_16x16x32_bf16 v[32:35], v[160:163], v[176:179], v[32:35]
    ds_read_b128 v[220:223], v2 offset:48128
    v_fma_f32 v69, -v93, v134, v69
    v_mfma_f32_16x16x32_bf16 v[36:39], v[164:167], v[176:179], v[36:39]
    ds_read_b128 v[224:227], v2 offset:49152
    v_fma_f32 v73, -v89, v135, v73
    v_mfma_f32_16x16x32_bf16 v[40:43], v[160:163], v[180:183], v[40:43]
    ds_read_b128 v[228:231], v2 offset:50176
    v_fma_f32 v77, -v93, v135, v77
    v_mfma_f32_16x16x32_bf16 v[44:47], v[164:167], v[180:183], v[44:47]
    ds_read_b128 v[232:235], v2 offset:51200
    s_waitcnt lgkmcnt(8)
    v_fma_f32 v81, -v89, v136, v81
    v_mfma_f32_16x16x32_bf16 v[48:51], v[160:163], v[184:187], v[48:51]
    ds_read_b128 v[236:239], v2 offset:52224
    v_fma_f32 v85, -v93, v136, v85
    v_mfma_f32_16x16x32_bf16 v[52:55], v[164:167], v[184:187], v[52:55]
    ds_read_b128 v[240:243], v2 offset:53248
    v_fma_f32 v17, -v89, v128, v17
    v_mfma_f32_16x16x32_bf16 v[56:59], v[160:163], v[188:191], v[56:59]
    ds_read_b128 v[244:247], v2 offset:54272
    v_fma_f32 v21, -v93, v128, v21
    v_mfma_f32_16x16x32_bf16 v[60:63], v[164:167], v[188:191], v[60:63]
    v_fma_f32 v25, -v89, v129, v25
    v_mfma_f32_16x16x32_bf16 v[64:67], v[160:163], v[192:195], v[64:67]
    v_fma_f32 v29, -v93, v129, v29
    v_mfma_f32_16x16x32_bf16 v[68:71], v[164:167], v[192:195], v[68:71]
    v_fma_f32 v33, -v89, v130, v33
    v_mfma_f32_16x16x32_bf16 v[72:75], v[160:163], v[196:199], v[72:75]
    v_fma_f32 v37, -v93, v130, v37
    v_mfma_f32_16x16x32_bf16 v[76:79], v[164:167], v[196:199], v[76:79]
    v_fma_f32 v41, -v89, v131, v41
    v_mfma_f32_16x16x32_bf16 v[80:83], v[160:163], v[200:203], v[80:83]
    v_fma_f32 v45, -v93, v131, v45
    v_mfma_f32_16x16x32_bf16 v[84:87], v[164:167], v[200:203], v[84:87]
    v_fma_f32 v49, -v89, v132, v49
    s_waitcnt lgkmcnt(0)
    s_barrier
    v_mfma_f32_16x16x32_bf16 v[16:19], v[204:207], v[212:215], v[16:19]
    ds_read_b128 v[160:163], v3 offset:0
    v_fma_f32 v54, -v94, v132, v54
    v_mfma_f32_16x16x32_bf16 v[20:23], v[208:211], v[212:215], v[20:23]
    ds_read_b128 v[164:167], v3 offset:2048
    v_fma_f32 v58, -v90, v133, v58
    v_mfma_f32_16x16x32_bf16 v[24:27], v[204:207], v[216:219], v[24:27]
    ds_read_b128 v[168:171], v1 offset:0
    v_fma_f32 v62, -v94, v133, v62
    v_mfma_f32_16x16x32_bf16 v[28:31], v[208:211], v[216:219], v[28:31]
    ds_read_b128 v[172:175], v1 offset:1024
    v_fma_f32 v66, -v90, v134, v66
    v_mfma_f32_16x16x32_bf16 v[32:35], v[204:207], v[220:223], v[32:35]
    ds_read_b128 v[176:179], v1 offset:2048
    v_fma_f32 v70, -v94, v134, v70
    v_mfma_f32_16x16x32_bf16 v[36:39], v[208:211], v[220:223], v[36:39]
    ds_read_b128 v[180:183], v1 offset:3072
    v_fma_f32 v74, -v90, v135, v74
    v_mfma_f32_16x16x32_bf16 v[40:43], v[204:207], v[224:227], v[40:43]
    ds_read_b128 v[184:187], v1 offset:4096
    v_fma_f32 v78, -v94, v135, v78
    v_mfma_f32_16x16x32_bf16 v[44:47], v[208:211], v[224:227], v[44:47]
    ds_read_b128 v[188:191], v1 offset:5120
    v_fma_f32 v82, -v90, v136, v82
    v_mfma_f32_16x16x32_bf16 v[48:51], v[204:207], v[228:231], v[48:51]
    ds_read_b128 v[192:195], v1 offset:6144
    v_fma_f32 v86, -v94, v136, v86
    v_mfma_f32_16x16x32_bf16 v[52:55], v[208:211], v[228:231], v[52:55]
    ds_read_b128 v[196:199], v1 offset:7168
    v_fma_f32 v18, -v90, v128, v18
    v_mfma_f32_16x16x32_bf16 v[56:59], v[204:207], v[232:235], v[56:59]
    ds_read_b128 v[200:203], v1 offset:8192
    v_fma_f32 v22, -v94, v128, v22
    v_mfma_f32_16x16x32_bf16 v[60:63], v[208:211], v[232:235], v[60:63]
    v_fma_f32 v26, -v90, v129, v26
    v_mfma_f32_16x16x32_bf16 v[64:67], v[204:207], v[236:239], v[64:67]
    v_fma_f32 v30, -v94, v129, v30
    v_mfma_f32_16x16x32_bf16 v[68:71], v[208:211], v[236:239], v[68:71]
    v_fma_f32 v34, -v90, v130, v34
    v_mfma_f32_16x16x32_bf16 v[72:75], v[204:207], v[240:243], v[72:75]
    v_fma_f32 v38, -v94, v130, v38
    v_mfma_f32_16x16x32_bf16 v[76:79], v[208:211], v[240:243], v[76:79]
    v_fma_f32 v42, -v90, v131, v42
    v_mfma_f32_16x16x32_bf16 v[80:83], v[204:207], v[244:247], v[80:83]
    v_fma_f32 v46, -v94, v131, v46
    v_mfma_f32_16x16x32_bf16 v[84:87], v[208:211], v[244:247], v[84:87]
    v_fma_f32 v50, -v90, v132, v50
    s_waitcnt lgkmcnt(5)
    v_mfma_f32_16x16x32_bf16 v[16:19], v[160:163], v[168:171], v[16:19]
    ds_read_b128 v[204:207], v3 offset:1024
    v_fma_f32 v55, -v95, v132, v55
    v_mfma_f32_16x16x32_bf16 v[20:23], v[164:167], v[168:171], v[20:23]
    ds_read_b128 v[208:211], v3 offset:3072
    v_fma_f32 v59, -v91, v133, v59
    v_mfma_f32_16x16x32_bf16 v[24:27], v[160:163], v[172:175], v[24:27]
    ds_read_b128 v[212:215], v1 offset:9216
    v_fma_f32 v63, -v95, v133, v63
    v_mfma_f32_16x16x32_bf16 v[28:31], v[164:167], v[172:175], v[28:31]
    ds_read_b128 v[216:219], v1 offset:10240
    v_fma_f32 v67, -v91, v134, v67
    v_mfma_f32_16x16x32_bf16 v[32:35], v[160:163], v[176:179], v[32:35]
    ds_read_b128 v[220:223], v1 offset:11264
    v_fma_f32 v71, -v95, v134, v71
    v_mfma_f32_16x16x32_bf16 v[36:39], v[164:167], v[176:179], v[36:39]
    ds_read_b128 v[224:227], v1 offset:12288
    v_fma_f32 v75, -v91, v135, v75
    v_mfma_f32_16x16x32_bf16 v[40:43], v[160:163], v[180:183], v[40:43]
    ds_read_b128 v[228:231], v1 offset:13312
    v_fma_f32 v79, -v95, v135, v79
    v_mfma_f32_16x16x32_bf16 v[44:47], v[164:167], v[180:183], v[44:47]
    ds_read_b128 v[232:235], v1 offset:14336
    s_waitcnt lgkmcnt(8)
    v_fma_f32 v83, -v91, v136, v83
    v_mfma_f32_16x16x32_bf16 v[48:51], v[160:163], v[184:187], v[48:51]
    ds_read_b128 v[236:239], v1 offset:15360
    v_fma_f32 v87, -v95, v136, v87
    v_mfma_f32_16x16x32_bf16 v[52:55], v[164:167], v[184:187], v[52:55]
    ds_read_b128 v[240:243], v1 offset:16384
    v_fma_f32 v19, -v91, v128, v19
    v_mfma_f32_16x16x32_bf16 v[56:59], v[160:163], v[188:191], v[56:59]
    ds_read_b128 v[244:247], v1 offset:17408
    v_fma_f32 v23, -v95, v128, v23
    v_mfma_f32_16x16x32_bf16 v[60:63], v[164:167], v[188:191], v[60:63]
    v_fma_f32 v27, -v91, v129, v27
    v_mfma_f32_16x16x32_bf16 v[64:67], v[160:163], v[192:195], v[64:67]
    v_fma_f32 v31, -v95, v129, v31
    v_mfma_f32_16x16x32_bf16 v[68:71], v[164:167], v[192:195], v[68:71]
    v_fma_f32 v35, -v91, v130, v35
    v_mfma_f32_16x16x32_bf16 v[72:75], v[160:163], v[196:199], v[72:75]
    v_fma_f32 v39, -v95, v130, v39
    v_mfma_f32_16x16x32_bf16 v[76:79], v[164:167], v[196:199], v[76:79]
    v_fma_f32 v43, -v91, v131, v43
    v_mfma_f32_16x16x32_bf16 v[80:83], v[160:163], v[200:203], v[80:83]
    v_fma_f32 v47, -v95, v131, v47
    v_mfma_f32_16x16x32_bf16 v[84:87], v[164:167], v[200:203], v[84:87]
    v_fma_f32 v51, -v91, v132, v51
    s_waitcnt lgkmcnt(0)
    s_barrier
    v_mfma_f32_16x16x32_bf16 v[16:19], v[204:207], v[212:215], v[16:19]
    s_xor_b32 s47, s30, 4096
    s_sub_u32 s47, s47, s30
    v_mfma_f32_16x16x32_bf16 v[20:23], v[208:211], v[212:215], v[20:23]
    s_and_b32 s48, s30, 4096
    v_add_u32 v196, s47, v3
    v_mfma_f32_16x16x32_bf16 v[24:27], v[204:207], v[216:219], v[24:27]
    v_add_u32 v197, s47, v0
    v_add_u32 v198, s48, v1
    v_mfma_f32_16x16x32_bf16 v[28:31], v[208:211], v[216:219], v[28:31]
    v_add_u32_e64 v199, s48, v2
    v_mfma_f32_16x16x32_bf16 v[32:35], v[204:207], v[220:223], v[32:35]
    ds_read_b128 v[160:163], v196 offset:36864
    v_mfma_f32_16x16x32_bf16 v[36:39], v[208:211], v[220:223], v[36:39]
    ds_read_b128 v[164:167], v196 offset:38912
    v_mfma_f32_16x16x32_bf16 v[40:43], v[204:207], v[224:227], v[40:43]
    ds_read_b128 v[168:171], v198 offset:36864
    v_mfma_f32_16x16x32_bf16 v[44:47], v[208:211], v[224:227], v[44:47]
    ds_read_b128 v[172:175], v198 offset:37888
    v_mfma_f32_16x16x32_bf16 v[48:51], v[204:207], v[228:231], v[48:51]
    ds_read_b128 v[176:179], v198 offset:38912
    v_mfma_f32_16x16x32_bf16 v[52:55], v[208:211], v[228:231], v[52:55]
    ds_read_b128 v[180:183], v198 offset:39936
    v_mfma_f32_16x16x32_bf16 v[56:59], v[204:207], v[232:235], v[56:59]
    ds_read_b128 v[184:187], v3 offset:36864
    v_mfma_f32_16x16x32_bf16 v[60:63], v[208:211], v[232:235], v[60:63]
    ds_read_b128 v[188:191], v3 offset:38912
    v_mfma_f32_16x16x32_bf16 v[64:67], v[204:207], v[236:239], v[64:67]
    ds_read_b128 v[192:195], v1 offset:45056
    v_mfma_f32_16x16x32_bf16 v[68:71], v[208:211], v[236:239], v[68:71]
    v_mfma_f32_16x16x32_bf16 v[72:75], v[204:207], v[240:243], v[72:75]
    v_mfma_f32_16x16x32_bf16 v[76:79], v[208:211], v[240:243], v[76:79]
    v_mfma_f32_16x16x32_bf16 v[80:83], v[204:207], v[244:247], v[80:83]
    v_mfma_f32_16x16x32_bf16 v[84:87], v[208:211], v[244:247], v[84:87]
L_g_z2:
    v_pk_mul_f32 v[220:221], v[16:17], v[16:17]
    v_pk_mul_f32 v[222:223], v[18:19], v[18:19]
    v_pk_mul_f32 v[224:225], v[20:21], v[20:21]
    v_pk_mul_f32 v[226:227], v[22:23], v[22:23]
    v_pk_fma_f32 v[220:221], v[220:221], v[112:113], v[104:105]
    v_pk_fma_f32 v[222:223], v[222:223], v[114:115], v[106:107]
    v_pk_fma_f32 v[224:225], v[224:225], v[116:117], v[108:109]
    v_pk_fma_f32 v[226:227], v[226:227], v[118:119], v[110:111]
    v_pk_mul_f32 v[220:221], v[220:221], v[16:17]
    v_pk_mul_f32 v[222:223], v[222:223], v[18:19]
    v_pk_mul_f32 v[224:225], v[224:225], v[20:21]
    v_pk_mul_f32 v[226:227], v[226:227], v[22:23]
    v_exp_f32 v220, v220
    v_exp_f32 v221, v221
    v_exp_f32 v222, v222
    v_exp_f32 v223, v223
    v_exp_f32 v224, v224
    v_exp_f32 v225, v225
    v_exp_f32 v226, v226
    v_exp_f32 v227, v227
    v_pk_fma_f32 v[220:221], v[220:221], v[120:121], v[120:121]
    v_pk_fma_f32 v[222:223], v[222:223], v[122:123], v[122:123]
    v_pk_fma_f32 v[224:225], v[224:225], v[124:125], v[124:125]
    v_pk_fma_f32 v[226:227], v[226:227], v[126:127], v[126:127]
    v_rcp_f32 v220, v220
    v_rcp_f32 v221, v221
    v_rcp_f32 v222, v222
    v_rcp_f32 v223, v223
    v_rcp_f32 v224, v224
    v_rcp_f32 v225, v225
    v_rcp_f32 v226, v226
    v_rcp_f32 v227, v227
    v_pk_mul_f32 v[16:17], v[16:17], v[220:221]
    v_pk_mul_f32 v[18:19], v[18:19], v[222:223]
    v_pk_mul_f32 v[20:21], v[20:21], v[224:225]
    v_pk_mul_f32 v[22:23], v[22:23], v[226:227]
    v_pk_mul_f32 v[206:207], v[16:17], v[16:17]
    v_pk_mul_f32 v[210:211], v[18:19], v[18:19]
    v_pk_mul_f32 v[214:215], v[20:21], v[20:21]
    v_pk_mul_f32 v[218:219], v[22:23], v[22:23]
    v_pk_mul_f32 v[228:229], v[24:25], v[24:25]
    v_pk_mul_f32 v[230:231], v[26:27], v[26:27]
    v_pk_mul_f32 v[232:233], v[28:29], v[28:29]
    v_pk_mul_f32 v[234:235], v[30:31], v[30:31]
    v_pk_fma_f32 v[228:229], v[228:229], v[112:113], v[104:105]
    v_pk_fma_f32 v[230:231], v[230:231], v[114:115], v[106:107]
    v_pk_fma_f32 v[232:233], v[232:233], v[116:117], v[108:109]
    v_pk_fma_f32 v[234:235], v[234:235], v[118:119], v[110:111]
    v_pk_mul_f32 v[228:229], v[228:229], v[24:25]
    v_pk_mul_f32 v[230:231], v[230:231], v[26:27]
    v_pk_mul_f32 v[232:233], v[232:233], v[28:29]
    v_pk_mul_f32 v[234:235], v[234:235], v[30:31]
    v_exp_f32 v228, v228
    v_exp_f32 v229, v229
    v_exp_f32 v230, v230
    v_exp_f32 v231, v231
    v_exp_f32 v232, v232
    v_exp_f32 v233, v233
    v_exp_f32 v234, v234
    v_exp_f32 v235, v235
    v_pk_fma_f32 v[228:229], v[228:229], v[120:121], v[120:121]
    v_pk_fma_f32 v[230:231], v[230:231], v[122:123], v[122:123]
    v_pk_fma_f32 v[232:233], v[232:233], v[124:125], v[124:125]
    v_pk_fma_f32 v[234:235], v[234:235], v[126:127], v[126:127]
    v_rcp_f32 v228, v228
    v_rcp_f32 v229, v229
    v_rcp_f32 v230, v230
    v_rcp_f32 v231, v231
    v_rcp_f32 v232, v232
    v_rcp_f32 v233, v233
    v_rcp_f32 v234, v234
    v_rcp_f32 v235, v235
    v_pk_mul_f32 v[24:25], v[24:25], v[228:229]
    v_pk_mul_f32 v[26:27], v[26:27], v[230:231]
    v_pk_mul_f32 v[28:29], v[28:29], v[232:233]
    v_pk_mul_f32 v[30:31], v[30:31], v[234:235]
    v_pk_add_f32 v[204:205], v[16:17], v[24:25]
    v_pk_fma_f32 v[206:207], v[24:25], v[24:25], v[206:207]
    v_pk_add_f32 v[208:209], v[18:19], v[26:27]
    v_pk_fma_f32 v[210:211], v[26:27], v[26:27], v[210:211]
    v_pk_add_f32 v[212:213], v[20:21], v[28:29]
    v_pk_fma_f32 v[214:215], v[28:29], v[28:29], v[214:215]
    v_pk_add_f32 v[216:217], v[22:23], v[30:31]
    v_pk_fma_f32 v[218:219], v[30:31], v[30:31], v[218:219]
    v_pk_mul_f32 v[220:221], v[32:33], v[32:33]
    v_pk_mul_f32 v[222:223], v[34:35], v[34:35]
    v_pk_mul_f32 v[224:225], v[36:37], v[36:37]
    v_pk_mul_f32 v[226:227], v[38:39], v[38:39]
    v_pk_fma_f32 v[220:221], v[220:221], v[112:113], v[104:105]
    v_pk_fma_f32 v[222:223], v[222:223], v[114:115], v[106:107]
    v_pk_fma_f32 v[224:225], v[224:225], v[116:117], v[108:109]
    v_pk_fma_f32 v[226:227], v[226:227], v[118:119], v[110:111]
    v_pk_mul_f32 v[220:221], v[220:221], v[32:33]
    v_pk_mul_f32 v[222:223], v[222:223], v[34:35]
    v_pk_mul_f32 v[224:225], v[224:225], v[36:37]
    v_pk_mul_f32 v[226:227], v[226:227], v[38:39]
    v_exp_f32 v220, v220
    v_exp_f32 v221, v221
    v_exp_f32 v222, v222
    v_exp_f32 v223, v223
    v_exp_f32 v224, v224
    v_exp_f32 v225, v225
    v_exp_f32 v226, v226
    v_exp_f32 v227, v227
    v_pk_fma_f32 v[220:221], v[220:221], v[120:121], v[120:121]
    v_pk_fma_f32 v[222:223], v[222:223], v[122:123], v[122:123]
    v_pk_fma_f32 v[224:225], v[224:225], v[124:125], v[124:125]
    v_pk_fma_f32 v[226:227], v[226:227], v[126:127], v[126:127]
    v_rcp_f32 v220, v220
    v_rcp_f32 v221, v221
    v_rcp_f32 v222, v222
    v_rcp_f32 v223, v223
    v_rcp_f32 v224, v224
    v_rcp_f32 v225, v225
    v_rcp_f32 v226, v226
    v_rcp_f32 v227, v227
    v_pk_mul_f32 v[32:33], v[32:33], v[220:221]
    v_pk_mul_f32 v[34:35], v[34:35], v[222:223]
    v_pk_mul_f32 v[36:37], v[36:37], v[224:225]
    v_pk_mul_f32 v[38:39], v[38:39], v[226:227]
    v_pk_add_f32 v[204:205], v[204:205], v[32:33]
    v_pk_fma_f32 v[206:207], v[32:33], v[32:33], v[206:207]
    v_pk_add_f32 v[208:209], v[208:209], v[34:35]
    v_pk_fma_f32 v[210:211], v[34:35], v[34:35], v[210:211]
    v_pk_add_f32 v[212:213], v[212:213], v[36:37]
    v_pk_fma_f32 v[214:215], v[36:37], v[36:37], v[214:215]
    v_pk_add_f32 v[216:217], v[216:217], v[38:39]
    v_pk_fma_f32 v[218:219], v[38:39], v[38:39], v[218:219]
    v_pk_mul_f32 v[228:229], v[40:41], v[40:41]
    v_pk_mul_f32 v[230:231], v[42:43], v[42:43]
    v_pk_mul_f32 v[232:233], v[44:45], v[44:45]
    v_pk_mul_f32 v[234:235], v[46:47], v[46:47]
    v_pk_fma_f32 v[228:229], v[228:229], v[112:113], v[104:105]
    v_pk_fma_f32 v[230:231], v[230:231], v[114:115], v[106:107]
    v_pk_fma_f32 v[232:233], v[232:233], v[116:117], v[108:109]
    v_pk_fma_f32 v[234:235], v[234:235], v[118:119], v[110:111]
    v_pk_mul_f32 v[228:229], v[228:229], v[40:41]
    v_pk_mul_f32 v[230:231], v[230:231], v[42:43]
    v_pk_mul_f32 v[232:233], v[232:233], v[44:45]
    v_pk_mul_f32 v[234:235], v[234:235], v[46:47]
    v_exp_f32 v228, v228
    v_exp_f32 v229, v229
    v_exp_f32 v230, v230
    v_exp_f32 v231, v231
    v_exp_f32 v232, v232
    v_exp_f32 v233, v233
    v_exp_f32 v234, v234
    v_exp_f32 v235, v235
    v_pk_fma_f32 v[228:229], v[228:229], v[120:121], v[120:121]
    v_pk_fma_f32 v[230:231], v[230:231], v[122:123], v[122:123]
    v_pk_fma_f32 v[232:233], v[232:233], v[124:125], v[124:125]
    v_pk_fma_f32 v[234:235], v[234:235], v[126:127], v[126:127]
    v_rcp_f32 v228, v228
    v_rcp_f32 v229, v229
    v_rcp_f32 v230, v230
    v_rcp_f32 v231, v231
    v_rcp_f32 v232, v232
    v_rcp_f32 v233, v233
    v_rcp_f32 v234, v234
    v_rcp_f32 v235, v235
    v_pk_mul_f32 v[40:41], v[40:41], v[228:229]
    v_pk_mul_f32 v[42:43], v[42:43], v[230:231]
    v_pk_mul_f32 v[44:45], v[44:45], v[232:233]
    v_pk_mul_f32 v[46:47], v[46:47], v[234:235]
    v_pk_add_f32 v[204:205], v[204:205], v[40:41]
    v_pk_fma_f32 v[206:207], v[40:41], v[40:41], v[206:207]
    v_pk_add_f32 v[208:209], v[208:209], v[42:43]
    v_pk_fma_f32 v[210:211], v[42:43], v[42:43], v[210:211]
    v_pk_add_f32 v[212:213], v[212:213], v[44:45]
    v_pk_fma_f32 v[214:215], v[44:45], v[44:45], v[214:215]
    v_pk_add_f32 v[216:217], v[216:217], v[46:47]
    v_pk_fma_f32 v[218:219], v[46:47], v[46:47], v[218:219]
    v_pk_mul_f32 v[220:221], v[48:49], v[48:49]
    v_pk_mul_f32 v[222:223], v[50:51], v[50:51]
    v_pk_mul_f32 v[224:225], v[52:53], v[52:53]
    v_pk_mul_f32 v[226:227], v[54:55], v[54:55]
    v_pk_fma_f32 v[220:221], v[220:221], v[112:113], v[104:105]
    v_pk_fma_f32 v[222:223], v[222:223], v[114:115], v[106:107]
    v_pk_fma_f32 v[224:225], v[224:225], v[116:117], v[108:109]
    v_pk_fma_f32 v[226:227], v[226:227], v[118:119], v[110:111]
    v_pk_mul_f32 v[220:221], v[220:221], v[48:49]
    v_pk_mul_f32 v[222:223], v[222:223], v[50:51]
    v_pk_mul_f32 v[224:225], v[224:225], v[52:53]
    v_pk_mul_f32 v[226:227], v[226:227], v[54:55]
    v_exp_f32 v220, v220
    v_exp_f32 v221, v221
    v_exp_f32 v222, v222
    v_exp_f32 v223, v223
    v_exp_f32 v224, v224
    v_exp_f32 v225, v225
    v_exp_f32 v226, v226
    v_exp_f32 v227, v227
    v_pk_fma_f32 v[220:221], v[220:221], v[120:121], v[120:121]
    v_pk_fma_f32 v[222:223], v[222:223], v[122:123], v[122:123]
    v_pk_fma_f32 v[224:225], v[224:225], v[124:125], v[124:125]
    v_pk_fma_f32 v[226:227], v[226:227], v[126:127], v[126:127]
    v_rcp_f32 v220, v220
    v_rcp_f32 v221, v221
    v_rcp_f32 v222, v222
    v_rcp_f32 v223, v223
    v_rcp_f32 v224, v224
    v_rcp_f32 v225, v225
    v_rcp_f32 v226, v226
    v_rcp_f32 v227, v227
    v_pk_mul_f32 v[48:49], v[48:49], v[220:221]
    v_pk_mul_f32 v[50:51], v[50:51], v[222:223]
    v_pk_mul_f32 v[52:53], v[52:53], v[224:225]
    v_pk_mul_f32 v[54:55], v[54:55], v[226:227]
    v_pk_add_f32 v[204:205], v[204:205], v[48:49]
    v_pk_fma_f32 v[206:207], v[48:49], v[48:49], v[206:207]
    v_pk_add_f32 v[208:209], v[208:209], v[50:51]
    v_pk_fma_f32 v[210:211], v[50:51], v[50:51], v[210:211]
    v_pk_add_f32 v[212:213], v[212:213], v[52:53]
    v_pk_fma_f32 v[214:215], v[52:53], v[52:53], v[214:215]
    v_pk_add_f32 v[216:217], v[216:217], v[54:55]
    v_pk_fma_f32 v[218:219], v[54:55], v[54:55], v[218:219]
    v_pk_mul_f32 v[228:229], v[56:57], v[56:57]
    v_pk_mul_f32 v[230:231], v[58:59], v[58:59]
    v_pk_mul_f32 v[232:233], v[60:61], v[60:61]
    v_pk_mul_f32 v[234:235], v[62:63], v[62:63]
    v_pk_fma_f32 v[228:229], v[228:229], v[112:113], v[104:105]
    v_pk_fma_f32 v[230:231], v[230:231], v[114:115], v[106:107]
    v_pk_fma_f32 v[232:233], v[232:233], v[116:117], v[108:109]
    v_pk_fma_f32 v[234:235], v[234:235], v[118:119], v[110:111]
    v_pk_mul_f32 v[228:229], v[228:229], v[56:57]
    v_pk_mul_f32 v[230:231], v[230:231], v[58:59]
    v_pk_mul_f32 v[232:233], v[232:233], v[60:61]
    v_pk_mul_f32 v[234:235], v[234:235], v[62:63]
    v_exp_f32 v228, v228
    v_exp_f32 v229, v229
    v_exp_f32 v230, v230
    v_exp_f32 v231, v231
    v_exp_f32 v232, v232
    v_exp_f32 v233, v233
    v_exp_f32 v234, v234
    v_exp_f32 v235, v235
    v_pk_fma_f32 v[228:229], v[228:229], v[120:121], v[120:121]
    v_pk_fma_f32 v[230:231], v[230:231], v[122:123], v[122:123]
    v_pk_fma_f32 v[232:233], v[232:233], v[124:125], v[124:125]
    v_pk_fma_f32 v[234:235], v[234:235], v[126:127], v[126:127]
    v_rcp_f32 v228, v228
    v_rcp_f32 v229, v229
    v_rcp_f32 v230, v230
    v_rcp_f32 v231, v231
    v_rcp_f32 v232, v232
    v_rcp_f32 v233, v233
    v_rcp_f32 v234, v234
    v_rcp_f32 v235, v235
    v_pk_mul_f32 v[56:57], v[56:57], v[228:229]
    v_pk_mul_f32 v[58:59], v[58:59], v[230:231]
    v_pk_mul_f32 v[60:61], v[60:61], v[232:233]
    v_pk_mul_f32 v[62:63], v[62:63], v[234:235]
    v_pk_add_f32 v[204:205], v[204:205], v[56:57]
    v_pk_fma_f32 v[206:207], v[56:57], v[56:57], v[206:207]
    v_pk_add_f32 v[208:209], v[208:209], v[58:59]
    v_pk_fma_f32 v[210:211], v[58:59], v[58:59], v[210:211]
    v_pk_add_f32 v[212:213], v[212:213], v[60:61]
    v_pk_fma_f32 v[214:215], v[60:61], v[60:61], v[214:215]
    v_pk_add_f32 v[216:217], v[216:217], v[62:63]
    v_pk_fma_f32 v[218:219], v[62:63], v[62:63], v[218:219]
    v_pk_mul_f32 v[220:221], v[64:65], v[64:65]
    v_pk_mul_f32 v[222:223], v[66:67], v[66:67]
    v_pk_mul_f32 v[224:225], v[68:69], v[68:69]
    v_pk_mul_f32 v[226:227], v[70:71], v[70:71]
    v_pk_fma_f32 v[220:221], v[220:221], v[112:113], v[104:105]
    v_pk_fma_f32 v[222:223], v[222:223], v[114:115], v[106:107]
    v_pk_fma_f32 v[224:225], v[224:225], v[116:117], v[108:109]
    v_pk_fma_f32 v[226:227], v[226:227], v[118:119], v[110:111]
    v_pk_mul_f32 v[220:221], v[220:221], v[64:65]
    v_pk_mul_f32 v[222:223], v[222:223], v[66:67]
    v_pk_mul_f32 v[224:225], v[224:225], v[68:69]
    v_pk_mul_f32 v[226:227], v[226:227], v[70:71]
    v_exp_f32 v220, v220
    v_exp_f32 v221, v221
    v_exp_f32 v222, v222
    v_exp_f32 v223, v223
    v_exp_f32 v224, v224
    v_exp_f32 v225, v225
    v_exp_f32 v226, v226
    v_exp_f32 v227, v227
    v_pk_fma_f32 v[220:221], v[220:221], v[120:121], v[120:121]
    v_pk_fma_f32 v[222:223], v[222:223], v[122:123], v[122:123]
    v_pk_fma_f32 v[224:225], v[224:225], v[124:125], v[124:125]
    v_pk_fma_f32 v[226:227], v[226:227], v[126:127], v[126:127]
    v_rcp_f32 v220, v220
    v_rcp_f32 v221, v221
    v_rcp_f32 v222, v222
    v_rcp_f32 v223, v223
    v_rcp_f32 v224, v224
    v_rcp_f32 v225, v225
    v_rcp_f32 v226, v226
    v_rcp_f32 v227, v227
    v_pk_mul_f32 v[64:65], v[64:65], v[220:221]
    v_pk_mul_f32 v[66:67], v[66:67], v[222:223]
    v_pk_mul_f32 v[68:69], v[68:69], v[224:225]
    v_pk_mul_f32 v[70:71], v[70:71], v[226:227]
    v_pk_add_f32 v[204:205], v[204:205], v[64:65]
    v_pk_fma_f32 v[206:207], v[64:65], v[64:65], v[206:207]
    v_pk_add_f32 v[208:209], v[208:209], v[66:67]
    v_pk_fma_f32 v[210:211], v[66:67], v[66:67], v[210:211]
    v_pk_add_f32 v[212:213], v[212:213], v[68:69]
    v_pk_fma_f32 v[214:215], v[68:69], v[68:69], v[214:215]
    v_pk_add_f32 v[216:217], v[216:217], v[70:71]
    v_pk_fma_f32 v[218:219], v[70:71], v[70:71], v[218:219]
    v_pk_mul_f32 v[228:229], v[72:73], v[72:73]
    v_pk_mul_f32 v[230:231], v[74:75], v[74:75]
    v_pk_mul_f32 v[232:233], v[76:77], v[76:77]
    v_pk_mul_f32 v[234:235], v[78:79], v[78:79]
    v_pk_fma_f32 v[228:229], v[228:229], v[112:113], v[104:105]
    v_pk_fma_f32 v[230:231], v[230:231], v[114:115], v[106:107]
    v_pk_fma_f32 v[232:233], v[232:233], v[116:117], v[108:109]
    v_pk_fma_f32 v[234:235], v[234:235], v[118:119], v[110:111]
    v_pk_mul_f32 v[228:229], v[228:229], v[72:73]
    v_pk_mul_f32 v[230:231], v[230:231], v[74:75]
    v_pk_mul_f32 v[232:233], v[232:233], v[76:77]
    v_pk_mul_f32 v[234:235], v[234:235], v[78:79]
    v_exp_f32 v228, v228
    v_exp_f32 v229, v229
    v_exp_f32 v230, v230
    v_exp_f32 v231, v231
    v_exp_f32 v232, v232
    v_exp_f32 v233, v233
    v_exp_f32 v234, v234
    v_exp_f32 v235, v235
    v_pk_fma_f32 v[228:229], v[228:229], v[120:121], v[120:121]
    v_pk_fma_f32 v[230:231], v[230:231], v[122:123], v[122:123]
    v_pk_fma_f32 v[232:233], v[232:233], v[124:125], v[124:125]
    v_pk_fma_f32 v[234:235], v[234:235], v[126:127], v[126:127]
    v_rcp_f32 v228, v228
    v_rcp_f32 v229, v229
    v_rcp_f32 v230, v230
    v_rcp_f32 v231, v231
    v_rcp_f32 v232, v232
    v_rcp_f32 v233, v233
    v_rcp_f32 v234, v234
    v_rcp_f32 v235, v235
    v_pk_mul_f32 v[72:73], v[72:73], v[228:229]
    v_pk_mul_f32 v[74:75], v[74:75], v[230:231]
    v_pk_mul_f32 v[76:77], v[76:77], v[232:233]
    v_pk_mul_f32 v[78:79], v[78:79], v[234:235]
    v_pk_add_f32 v[204:205], v[204:205], v[72:73]
    v_pk_fma_f32 v[206:207], v[72:73], v[72:73], v[206:207]
    v_pk_add_f32 v[208:209], v[208:209], v[74:75]
    v_pk_fma_f32 v[210:211], v[74:75], v[74:75], v[210:211]
    v_pk_add_f32 v[212:213], v[212:213], v[76:77]
    v_pk_fma_f32 v[214:215], v[76:77], v[76:77], v[214:215]
    v_pk_add_f32 v[216:217], v[216:217], v[78:79]
    v_pk_fma_f32 v[218:219], v[78:79], v[78:79], v[218:219]
    v_pk_mul_f32 v[220:221], v[80:81], v[80:81]
    v_pk_mul_f32 v[222:223], v[82:83], v[82:83]
    v_pk_mul_f32 v[224:225], v[84:85], v[84:85]
    v_pk_mul_f32 v[226:227], v[86:87], v[86:87]
    v_pk_fma_f32 v[220:221], v[220:221], v[112:113], v[104:105]
    v_pk_fma_f32 v[222:223], v[222:223], v[114:115], v[106:107]
    v_pk_fma_f32 v[224:225], v[224:225], v[116:117], v[108:109]
    v_pk_fma_f32 v[226:227], v[226:227], v[118:119], v[110:111]
    v_pk_mul_f32 v[220:221], v[220:221], v[80:81]
    v_pk_mul_f32 v[222:223], v[222:223], v[82:83]
    v_pk_mul_f32 v[224:225], v[224:225], v[84:85]
    v_pk_mul_f32 v[226:227], v[226:227], v[86:87]
    v_exp_f32 v220, v220
    v_exp_f32 v221, v221
    v_exp_f32 v222, v222
    v_exp_f32 v223, v223
    v_exp_f32 v224, v224
    v_exp_f32 v225, v225
    v_exp_f32 v226, v226
    v_exp_f32 v227, v227
    v_pk_fma_f32 v[220:221], v[220:221], v[120:121], v[120:121]
    v_pk_fma_f32 v[222:223], v[222:223], v[122:123], v[122:123]
    v_pk_fma_f32 v[224:225], v[224:225], v[124:125], v[124:125]
    v_pk_fma_f32 v[226:227], v[226:227], v[126:127], v[126:127]
    v_rcp_f32 v220, v220
    v_rcp_f32 v221, v221
    v_rcp_f32 v222, v222
    v_rcp_f32 v223, v223
    v_rcp_f32 v224, v224
    v_rcp_f32 v225, v225
    v_rcp_f32 v226, v226
    v_rcp_f32 v227, v227
    v_pk_mul_f32 v[80:81], v[80:81], v[220:221]
    v_pk_mul_f32 v[82:83], v[82:83], v[222:223]
    v_pk_mul_f32 v[84:85], v[84:85], v[224:225]
    v_pk_mul_f32 v[86:87], v[86:87], v[226:227]
    v_pk_add_f32 v[204:205], v[204:205], v[80:81]
    v_pk_fma_f32 v[206:207], v[80:81], v[80:81], v[206:207]
    v_pk_add_f32 v[208:209], v[208:209], v[82:83]
    v_pk_fma_f32 v[210:211], v[82:83], v[82:83], v[210:211]
    v_pk_add_f32 v[212:213], v[212:213], v[84:85]
    v_pk_fma_f32 v[214:215], v[84:85], v[84:85], v[214:215]
    v_pk_add_f32 v[216:217], v[216:217], v[86:87]
    v_pk_fma_f32 v[218:219], v[86:87], v[86:87], v[218:219]
    v_add_f32_dpp v204, v204, v204 row_mirror row_mask:0xf bank_mask:0x3
    v_add_f32_dpp v205, v205, v205 row_mirror row_mask:0xf bank_mask:0x3
    v_add_f32_dpp v206, v206, v206 row_mirror row_mask:0xf bank_mask:0x3
    v_add_f32_dpp v207, v207, v207 row_mirror row_mask:0xf bank_mask:0x3
    v_add_f32_dpp v208, v208, v208 row_mirror row_mask:0xf bank_mask:0x3
    v_add_f32_dpp v209, v209, v209 row_mirror row_mask:0xf bank_mask:0x3
    v_add_f32_dpp v210, v210, v210 row_mirror row_mask:0xf bank_mask:0x3
    v_add_f32_dpp v211, v211, v211 row_mirror row_mask:0xf bank_mask:0x3
    v_add_f32_dpp v204, v212, v212 row_mirror row_mask:0xf bank_mask:0xc
    v_add_f32_dpp v205, v213, v213 row_mirror row_mask:0xf bank_mask:0xc
    v_add_f32_dpp v206, v214, v214 row_mirror row_mask:0xf bank_mask:0xc
    v_add_f32_dpp v207, v215, v215 row_mirror row_mask:0xf bank_mask:0xc
    v_add_f32_dpp v208, v216, v216 row_mirror row_mask:0xf bank_mask:0xc
    v_add_f32_dpp v209, v217, v217 row_mirror row_mask:0xf bank_mask:0xc
    v_add_f32_dpp v210, v218, v218 row_mirror row_mask:0xf bank_mask:0xc
    v_add_f32_dpp v211, v219, v219 row_mirror row_mask:0xf bank_mask:0xc
    v_add_f32_dpp v204, v204, v204 row_half_mirror row_mask:0xf bank_mask:0x5
    v_add_f32_dpp v205, v205, v205 row_half_mirror row_mask:0xf bank_mask:0x5
    v_add_f32_dpp v206, v206, v206 row_half_mirror row_mask:0xf bank_mask:0x5
    v_add_f32_dpp v207, v207, v207 row_half_mirror row_mask:0xf bank_mask:0x5
    v_add_f32_dpp v204, v208, v208 row_half_mirror row_mask:0xf bank_mask:0xa
    v_add_f32_dpp v205, v209, v209 row_half_mirror row_mask:0xf bank_mask:0xa
    v_add_f32_dpp v206, v210, v210 row_half_mirror row_mask:0xf bank_mask:0xa
    v_add_f32_dpp v207, v211, v211 row_half_mirror row_mask:0xf bank_mask:0xa
    v_add_f32_dpp v204, v204, v204 quad_perm:[1,0,3,2] row_mask:0xf bank_mask:0xf
    v_add_f32_dpp v205, v205, v205 quad_perm:[1,0,3,2] row_mask:0xf bank_mask:0xf
    v_add_f32_dpp v206, v206, v206 quad_perm:[1,0,3,2] row_mask:0xf bank_mask:0xf
    v_add_f32_dpp v207, v207, v207 quad_perm:[1,0,3,2] row_mask:0xf bank_mask:0xf
    v_add_f32_dpp v12, v204, v204 quad_perm:[2,3,0,1] row_mask:0xf bank_mask:0xf
    v_add_f32_dpp v14, v205, v205 quad_perm:[2,3,0,1] row_mask:0xf bank_mask:0xf
    v_add_f32_dpp v13, v206, v206 quad_perm:[2,3,0,1] row_mask:0xf bank_mask:0xf
    v_add_f32_dpp v15, v207, v207 quad_perm:[2,3,0,1] row_mask:0xf bank_mask:0xf
    buffer_store_dwordx4 v[12:15], v8, s[4:7], s36 offen sc1
    s_waitcnt lgkmcnt(3)
    v_mfma_f32_16x16x32_bf16 v[88:91], v[168:171], v[160:163], 0
    ds_read_b128 v[204:207], v196 offset:37888
    v_mfma_f32_16x16x32_bf16 v[92:95], v[168:171], v[164:167], 0
    ds_read_b128 v[208:211], v196 offset:39936
    v_mfma_f32_16x16x32_bf16 v[96:99], v[172:175], v[160:163], 0
    ds_read_b128 v[212:215], v198 offset:46080
    v_mfma_f32_16x16x32_bf16 v[100:103], v[172:175], v[164:167], 0
    ds_read_b128 v[216:219], v198 offset:47104
    v_mfma_f32_16x16x32_bf16 v[104:107], v[176:179], v[160:163], 0
    ds_read_b128 v[220:223], v198 offset:48128
    v_mfma_f32_16x16x32_bf16 v[108:111], v[176:179], v[164:167], 0
    ds_read_b128 v[224:227], v198 offset:49152
    v_mfma_f32_16x16x32_bf16 v[112:115], v[180:183], v[160:163], 0
    ds_read_b128 v[228:231], v3 offset:37888
    v_mfma_f32_16x16x32_bf16 v[116:119], v[180:183], v[164:167], 0
    ds_read_b128 v[232:235], v3 offset:39936
    s_waitcnt lgkmcnt(8)
    v_mfma_f32_16x16x32_bf16 v[120:123], v[168:171], v[184:187], 0
    ds_read_b128 v[236:239], v1 offset:54272
    v_mfma_f32_16x16x32_bf16 v[124:127], v[168:171], v[188:191], 0
    v_mfma_f32_16x16x32_bf16 v[128:131], v[172:175], v[184:187], 0
    v_mfma_f32_16x16x32_bf16 v[132:135], v[172:175], v[188:191], 0
    v_mfma_f32_16x16x32_bf16 v[136:139], v[176:179], v[184:187], 0
    v_mfma_f32_16x16x32_bf16 v[140:143], v[176:179], v[188:191], 0
    v_mfma_f32_16x16x32_bf16 v[144:147], v[180:183], v[184:187], 0
    v_mfma_f32_16x16x32_bf16 v[148:151], v[180:183], v[188:191], 0
    v_mfma_f32_16x16x32_bf16 v[152:155], v[192:195], v[184:187], 0
    v_mfma_f32_16x16x32_bf16 v[156:159], v[192:195], v[188:191], 0
    s_waitcnt lgkmcnt(0)
    s_barrier
    v_mfma_f32_16x16x32_bf16 v[88:91], v[212:215], v[204:207], v[88:91]
    ds_read_b128 v[160:163], v197 offset:0
    v_mfma_f32_16x16x32_bf16 v[92:95], v[212:215], v[208:211], v[92:95]
    ds_read_b128 v[164:167], v197 offset:2048
    v_mfma_f32_16x16x32_bf16 v[96:99], v[216:219], v[204:207], v[96:99]
    ds_read_b128 v[168:171], v199 offset:0
    v_mfma_f32_16x16x32_bf16 v[100:103], v[216:219], v[208:211], v[100:103]
    ds_read_b128 v[172:175], v199 offset:1024
    v_mfma_f32_16x16x32_bf16 v[104:107], v[220:223], v[204:207], v[104:107]
    ds_read_b128 v[176:179], v199 offset:2048
    v_mfma_f32_16x16x32_bf16 v[108:111], v[220:223], v[208:211], v[108:111]
    ds_read_b128 v[180:183], v199 offset:3072
    v_mfma_f32_16x16x32_bf16 v[112:115], v[224:227], v[204:207], v[112:115]
    ds_read_b128 v[184:187], v0 offset:0
    v_mfma_f32_16x16x32_bf16 v[116:119], v[224:227], v[208:211], v[116:119]
    ds_read_b128 v[188:191], v0 offset:2048
    v_mfma_f32_16x16x32_bf16 v[120:123], v[212:215], v[228:231], v[120:123]
    ds_read_b128 v[192:195], v2 offset:8192
    v_mfma_f32_16x16x32_bf16 v[124:127], v[212:215], v[232:235], v[124:127]
    ds_read2_b32 v[240:241], v4 offset0:0 offset1:32
    v_mfma_f32_16x16x32_bf16 v[128:131], v[216:219], v[228:231], v[128:131]
    ds_read2_b32 v[242:243], v4 offset0:16 offset1:48
    v_mfma_f32_16x16x32_bf16 v[132:135], v[216:219], v[232:235], v[132:135]
    v_mfma_f32_16x16x32_bf16 v[136:139], v[220:223], v[228:231], v[136:139]
    v_mfma_f32_16x16x32_bf16 v[140:143], v[220:223], v[232:235], v[140:143]
    v_mfma_f32_16x16x32_bf16 v[144:147], v[224:227], v[228:231], v[144:147]
    v_mfma_f32_16x16x32_bf16 v[148:151], v[224:227], v[232:235], v[148:151]
    v_mfma_f32_16x16x32_bf16 v[152:155], v[236:239], v[228:231], v[152:155]
    v_mfma_f32_16x16x32_bf16 v[156:159], v[236:239], v[232:235], v[156:159]
    s_waitcnt lgkmcnt(5)
    v_mfma_f32_16x16x32_bf16 v[88:91], v[168:171], v[160:163], v[88:91]
    ds_read_b128 v[204:207], v197 offset:1024
    v_mfma_f32_16x16x32_bf16 v[92:95], v[168:171], v[164:167], v[92:95]
    ds_read_b128 v[208:211], v197 offset:3072
    v_mfma_f32_16x16x32_bf16 v[96:99], v[172:175], v[160:163], v[96:99]
    ds_read_b128 v[212:215], v199 offset:9216
    v_mfma_f32_16x16x32_bf16 v[100:103], v[172:175], v[164:167], v[100:103]
    ds_read_b128 v[216:219], v199 offset:10240
    v_mfma_f32_16x16x32_bf16 v[104:107], v[176:179], v[160:163], v[104:107]
    ds_read_b128 v[220:223], v199 offset:11264
    v_mfma_f32_16x16x32_bf16 v[108:111], v[176:179], v[164:167], v[108:111]
    ds_read_b128 v[224:227], v199 offset:12288
    v_mfma_f32_16x16x32_bf16 v[112:115], v[180:183], v[160:163], v[112:115]
    ds_read_b128 v[228:231], v0 offset:1024
    v_mfma_f32_16x16x32_bf16 v[116:119], v[180:183], v[164:167], v[116:119]
    ds_read_b128 v[232:235], v0 offset:3072
    s_waitcnt lgkmcnt(8)
    v_mfma_f32_16x16x32_bf16 v[120:123], v[168:171], v[184:187], v[120:123]
    ds_read_b128 v[236:239], v2 offset:17408
    v_mfma_f32_16x16x32_bf16 v[124:127], v[168:171], v[188:191], v[124:127]
    v_mfma_f32_16x16x32_bf16 v[128:131], v[172:175], v[184:187], v[128:131]
    v_mfma_f32_16x16x32_bf16 v[132:135], v[172:175], v[188:191], v[132:135]
    v_mfma_f32_16x16x32_bf16 v[136:139], v[176:179], v[184:187], v[136:139]
    v_mfma_f32_16x16x32_bf16 v[140:143], v[176:179], v[188:191], v[140:143]
    v_mfma_f32_16x16x32_bf16 v[144:147], v[180:183], v[184:187], v[144:147]
    v_mfma_f32_16x16x32_bf16 v[148:151], v[180:183], v[188:191], v[148:151]
    v_mfma_f32_16x16x32_bf16 v[152:155], v[192:195], v[184:187], v[152:155]
    v_mfma_f32_16x16x32_bf16 v[156:159], v[192:195], v[188:191], v[156:159]
    s_waitcnt lgkmcnt(0)
    s_barrier
    v_mfma_f32_16x16x32_bf16 v[88:91], v[212:215], v[204:207], v[88:91]
    ds_read_b128 v[160:163], v197 offset:36864
    v_mfma_f32_16x16x32_bf16 v[92:95], v[212:215], v[208:211], v[92:95]
    ds_read_b128 v[164:167], v197 offset:38912
    v_mfma_f32_16x16x32_bf16 v[96:99], v[216:219], v[204:207], v[96:99]
    ds_read_b128 v[168:171], v199 offset:36864
    v_mfma_f32_16x16x32_bf16 v[100:103], v[216:219], v[208:211], v[100:103]
    ds_read_b128 v[172:175], v199 offset:37888
    v_mfma_f32_16x16x32_bf16 v[104:107], v[220:223], v[204:207], v[104:107]
    ds_read_b128 v[176:179], v199 offset:38912
    v_mfma_f32_16x16x32_bf16 v[108:111], v[220:223], v[208:211], v[108:111]
    ds_read_b128 v[180:183], v199 offset:39936
    v_mfma_f32_16x16x32_bf16 v[112:115], v[224:227], v[204:207], v[112:115]
    ds_read_b128 v[184:187], v0 offset:36864
    v_mfma_f32_16x16x32_bf16 v[116:119], v[224:227], v[208:211], v[116:119]
    ds_read_b128 v[188:191], v0 offset:38912
    v_mfma_f32_16x16x32_bf16 v[120:123], v[212:215], v[228:231], v[120:123]
    ds_read_b128 v[192:195], v2 offset:45056
    v_mfma_f32_16x16x32_bf16 v[124:127], v[212:215], v[232:235], v[124:127]
    v_mul_f32_e64 v244, s40, v241
    v_mfma_f32_16x16x32_bf16 v[128:131], v[216:219], v[228:231], v[128:131]
    v_mul_f32_e64 v246, s40, v243
    v_mfma_f32_16x16x32_bf16 v[132:135], v[216:219], v[232:235], v[132:135]
    v_mul_f32_e64 v245, v241, v241
    v_mfma_f32_16x16x32_bf16 v[136:139], v[220:223], v[228:231], v[136:139]
    v_mul_f32_e64 v247, v243, v243
    v_mfma_f32_16x16x32_bf16 v[140:143], v[220:223], v[232:235], v[140:143]
    v_rcp_f32_e64 v241, v241
    v_mfma_f32_16x16x32_bf16 v[144:147], v[224:227], v[228:231], v[144:147]
    v_rcp_f32_e64 v243, v243
    v_mfma_f32_16x16x32_bf16 v[148:151], v[224:227], v[232:235], v[148:151]
    v_mul_f32_e64 v245, s42, v245
    v_mfma_f32_16x16x32_bf16 v[152:155], v[236:239], v[228:231], v[152:155]
    v_mul_f32_e64 v247, s42, v247
    v_mfma_f32_16x16x32_bf16 v[156:159], v[236:239], v[232:235], v[156:159]
    v_mul_f32 v245, v245, v244
    v_mul_f32_e64 v247, v247, v246
    s_waitcnt lgkmcnt(3)
    v_mfma_f32_16x16x32_bf16 v[88:91], v[168:171], v[160:163], v[88:91]
    ds_read_b128 v[204:207], v197 offset:37888
    v_mfma_f32_16x16x32_bf16 v[92:95], v[168:171], v[164:167], v[92:95]
    ds_read_b128 v[208:211], v197 offset:39936
    v_mfma_f32_16x16x32_bf16 v[96:99], v[172:175], v[160:163], v[96:99]
    ds_read_b128 v[212:215], v199 offset:46080
    v_mfma_f32_16x16x32_bf16 v[100:103], v[172:175], v[164:167], v[100:103]
    ds_read_b128 v[216:219], v199 offset:47104
    v_mfma_f32_16x16x32_bf16 v[104:107], v[176:179], v[160:163], v[104:107]
    ds_read_b128 v[220:223], v199 offset:48128
    v_mfma_f32_16x16x32_bf16 v[108:111], v[176:179], v[164:167], v[108:111]
    ds_read_b128 v[224:227], v199 offset:49152
    v_mfma_f32_16x16x32_bf16 v[112:115], v[180:183], v[160:163], v[112:115]
    ds_read_b128 v[228:231], v0 offset:37888
    v_mfma_f32_16x16x32_bf16 v[116:119], v[180:183], v[164:167], v[116:119]
    ds_read_b128 v[232:235], v0 offset:39936
    s_waitcnt lgkmcnt(8)
    v_mfma_f32_16x16x32_bf16 v[120:123], v[168:171], v[184:187], v[120:123]
    ds_read_b128 v[236:239], v2 offset:54272
    v_mfma_f32_16x16x32_bf16 v[124:127], v[168:171], v[188:191], v[124:127]
    v_bfe_u32 v202, v1, 4, 4
    v_mfma_f32_16x16x32_bf16 v[128:131], v[172:175], v[184:187], v[128:131]
    v_lshrrev_b32 v200, 1, v202
    v_mfma_f32_16x16x32_bf16 v[132:135], v[172:175], v[188:191], v[132:135]
    v_lshrrev_b32_e64 v201, 8, v1
    v_mfma_f32_16x16x32_bf16 v[136:139], v[176:179], v[184:187], v[136:139]
    v_xor_b32_e64 v200, v200, v201
    v_mfma_f32_16x16x32_bf16 v[140:143], v[176:179], v[188:191], v[140:143]
    v_lshlrev_b32_e64 v200, 4, v200
    v_mfma_f32_16x16x32_bf16 v[144:147], v[180:183], v[184:187], v[144:147]
    v_lshl_add_u32 v200, v202, 7, v200
    v_mfma_f32_16x16x32_bf16 v[148:151], v[180:183], v[188:191], v[148:151]
    s_xor_b32 s33, s30, 4096
    v_mfma_f32_16x16x32_bf16 v[152:155], v[192:195], v[184:187], v[152:155]
    s_add_u32 s33, s33, 18432
    v_mfma_f32_16x16x32_bf16 v[156:159], v[192:195], v[188:191], v[156:159]
    v_add_u32 v200, s33, v200
    v_xor_b32 v201, 64, v200
    s_waitcnt lgkmcnt(0)
    s_barrier
    v_mfma_f32_16x16x32_bf16 v[88:91], v[212:215], v[204:207], v[88:91]
    ds_read_b128 v[160:163], v196 offset:0
    v_mfma_f32_16x16x32_bf16 v[92:95], v[212:215], v[208:211], v[92:95]
    ds_read_b128 v[164:167], v196 offset:2048
    v_mfma_f32_16x16x32_bf16 v[96:99], v[216:219], v[204:207], v[96:99]
    ds_read_b128 v[168:171], v198 offset:0
    v_mfma_f32_16x16x32_bf16 v[100:103], v[216:219], v[208:211], v[100:103]
    ds_read_b128 v[172:175], v198 offset:1024
    v_mfma_f32_16x16x32_bf16 v[104:107], v[220:223], v[204:207], v[104:107]
    ds_read_b128 v[176:179], v198 offset:2048
    v_mfma_f32_16x16x32_bf16 v[108:111], v[220:223], v[208:211], v[108:111]
    ds_read_b128 v[180:183], v198 offset:3072
    v_mfma_f32_16x16x32_bf16 v[112:115], v[224:227], v[204:207], v[112:115]
    ds_read_b128 v[184:187], v3 offset:0
    v_mfma_f32_16x16x32_bf16 v[116:119], v[224:227], v[208:211], v[116:119]
    ds_read_b128 v[188:191], v3 offset:2048
    v_mfma_f32_16x16x32_bf16 v[120:123], v[212:215], v[228:231], v[120:123]
    ds_read_b128 v[192:195], v1 offset:8192
    v_mfma_f32_16x16x32_bf16 v[124:127], v[212:215], v[232:235], v[124:127]
    v_add_u32 v202, 73728, v200
    v_mfma_f32_16x16x32_bf16 v[128:131], v[216:219], v[228:231], v[128:131]
    v_add_u32 v203, 73728, v201
    v_mfma_f32_16x16x32_bf16 v[132:135], v[216:219], v[232:235], v[132:135]
    v_mfma_f32_16x16x32_bf16 v[136:139], v[220:223], v[228:231], v[136:139]
    v_mfma_f32_16x16x32_bf16 v[140:143], v[220:223], v[232:235], v[140:143]
    v_mfma_f32_16x16x32_bf16 v[144:147], v[224:227], v[228:231], v[144:147]
    v_mfma_f32_16x16x32_bf16 v[148:151], v[224:227], v[232:235], v[148:151]
    v_mfma_f32_16x16x32_bf16 v[152:155], v[236:239], v[228:231], v[152:155]
    v_mfma_f32_16x16x32_bf16 v[156:159], v[236:239], v[232:235], v[156:159]
    s_waitcnt lgkmcnt(3)
    v_mfma_f32_16x16x32_bf16 v[88:91], v[168:171], v[160:163], v[88:91]
    ds_read_b128 v[204:207], v196 offset:1024
    v_mfma_f32_16x16x32_bf16 v[92:95], v[168:171], v[164:167], v[92:95]
    ds_read_b128 v[208:211], v196 offset:3072
    v_mfma_f32_16x16x32_bf16 v[96:99], v[172:175], v[160:163], v[96:99]
    ds_read_b128 v[212:215], v198 offset:9216
    v_mfma_f32_16x16x32_bf16 v[100:103], v[172:175], v[164:167], v[100:103]
    ds_read_b128 v[216:219], v198 offset:10240
    v_mfma_f32_16x16x32_bf16 v[104:107], v[176:179], v[160:163], v[104:107]
    ds_read_b128 v[220:223], v198 offset:11264
    v_mfma_f32_16x16x32_bf16 v[108:111], v[176:179], v[164:167], v[108:111]
    ds_read_b128 v[224:227], v198 offset:12288
    v_mfma_f32_16x16x32_bf16 v[112:115], v[180:183], v[160:163], v[112:115]
    ds_read_b128 v[228:231], v3 offset:1024
    v_mfma_f32_16x16x32_bf16 v[116:119], v[180:183], v[164:167], v[116:119]
    ds_read_b128 v[232:235], v3 offset:3072
    s_waitcnt lgkmcnt(8)
    v_mfma_f32_16x16x32_bf16 v[120:123], v[168:171], v[184:187], v[120:123]
    ds_read_b128 v[236:239], v1 offset:17408
    v_mfma_f32_16x16x32_bf16 v[124:127], v[168:171], v[188:191], v[124:127]
    v_mfma_f32_16x16x32_bf16 v[128:131], v[172:175], v[184:187], v[128:131]
    v_mfma_f32_16x16x32_bf16 v[132:135], v[172:175], v[188:191], v[132:135]
    v_mfma_f32_16x16x32_bf16 v[136:139], v[176:179], v[184:187], v[136:139]
    v_mfma_f32_16x16x32_bf16 v[140:143], v[176:179], v[188:191], v[140:143]
    v_mfma_f32_16x16x32_bf16 v[144:147], v[180:183], v[184:187], v[144:147]
    v_mfma_f32_16x16x32_bf16 v[148:151], v[180:183], v[188:191], v[148:151]
    v_mfma_f32_16x16x32_bf16 v[152:155], v[192:195], v[184:187], v[152:155]
    v_mfma_f32_16x16x32_bf16 v[156:159], v[192:195], v[188:191], v[156:159]
    s_waitcnt lgkmcnt(0)
    s_barrier
    v_mfma_f32_16x16x32_bf16 v[88:91], v[212:215], v[204:207], v[88:91]
    ds_read_b128 v[160:163], v196 offset:36864
    v_mfma_f32_16x16x32_bf16 v[92:95], v[212:215], v[208:211], v[92:95]
    ds_read_b128 v[164:167], v196 offset:38912
    v_mfma_f32_16x16x32_bf16 v[96:99], v[216:219], v[204:207], v[96:99]
    ds_read_b128 v[168:171], v198 offset:36864
    v_mfma_f32_16x16x32_bf16 v[100:103], v[216:219], v[208:211], v[100:103]
    ds_read_b128 v[172:175], v198 offset:37888
    v_mfma_f32_16x16x32_bf16 v[104:107], v[220:223], v[204:207], v[104:107]
    ds_read_b128 v[176:179], v198 offset:38912
    v_mfma_f32_16x16x32_bf16 v[108:111], v[220:223], v[208:211], v[108:111]
    ds_read_b128 v[180:183], v198 offset:39936
    v_mfma_f32_16x16x32_bf16 v[112:115], v[224:227], v[204:207], v[112:115]
    ds_read_b128 v[184:187], v3 offset:36864
    v_mfma_f32_16x16x32_bf16 v[116:119], v[224:227], v[208:211], v[116:119]
    ds_read_b128 v[188:191], v3 offset:38912
    v_mfma_f32_16x16x32_bf16 v[120:123], v[212:215], v[228:231], v[120:123]
    ds_read_b128 v[192:195], v1 offset:45056
    v_mfma_f32_16x16x32_bf16 v[124:127], v[212:215], v[232:235], v[124:127]
    ds_read_b128 v[4:7], v255 offset:1024
    v_mfma_f32_16x16x32_bf16 v[128:131], v[216:219], v[228:231], v[128:131]
    ds_read_b128 v[8:11], v255 offset:1040
    v_mfma_f32_16x16x32_bf16 v[132:135], v[216:219], v[232:235], v[132:135]
    ds_read_b128 v[12:15], v255 offset:1056
    v_mfma_f32_16x16x32_bf16 v[136:139], v[220:223], v[228:231], v[136:139]
    ds_read_b128 v[252:255], v255 offset:1072
    v_mfma_f32_16x16x32_bf16 v[140:143], v[220:223], v[232:235], v[140:143]
    v_mfma_f32_16x16x32_bf16 v[144:147], v[224:227], v[228:231], v[144:147]
    v_mfma_f32_16x16x32_bf16 v[148:151], v[224:227], v[232:235], v[148:151]
    v_mfma_f32_16x16x32_bf16 v[152:155], v[236:239], v[228:231], v[152:155]
    v_mfma_f32_16x16x32_bf16 v[156:159], v[236:239], v[232:235], v[156:159]
    s_waitcnt lgkmcnt(7)
    v_mfma_f32_16x16x32_bf16 v[88:91], v[168:171], v[160:163], v[88:91]
    ds_read_b128 v[204:207], v196 offset:37888
    v_mfma_f32_16x16x32_bf16 v[92:95], v[168:171], v[164:167], v[92:95]
    ds_read_b128 v[208:211], v196 offset:39936
    v_mfma_f32_16x16x32_bf16 v[96:99], v[172:175], v[160:163], v[96:99]
    ds_read_b128 v[212:215], v198 offset:46080
    v_mfma_f32_16x16x32_bf16 v[100:103], v[172:175], v[164:167], v[100:103]
    ds_read_b128 v[216:219], v198 offset:47104
    v_mfma_f32_16x16x32_bf16 v[104:107], v[176:179], v[160:163], v[104:107]
    ds_read_b128 v[220:223], v198 offset:48128
    v_mfma_f32_16x16x32_bf16 v[108:111], v[176:179], v[164:167], v[108:111]
    ds_read_b128 v[224:227], v198 offset:49152
    v_mfma_f32_16x16x32_bf16 v[112:115], v[180:183], v[160:163], v[112:115]
    ds_read_b128 v[228:231], v3 offset:37888
    v_mfma_f32_16x16x32_bf16 v[116:119], v[180:183], v[164:167], v[116:119]
    ds_read_b128 v[232:235], v3 offset:39936
    s_waitcnt lgkmcnt(8)
    v_mfma_f32_16x16x32_bf16 v[120:123], v[168:171], v[184:187], v[120:123]
    ds_read_b128 v[236:239], v1 offset:54272
    v_fma_f32 v16, v16, v4, -v6
    v_mfma_f32_16x16x32_bf16 v[124:127], v[168:171], v[188:191], v[124:127]
    v_fma_f32 v17, v17, v5, -v7
    v_fma_f32 v18, v18, v8, -v10
    v_mfma_f32_16x16x32_bf16 v[128:131], v[172:175], v[184:187], v[128:131]
    v_fma_f32 v19, v19, v9, -v11
    v_fma_f32 v20, v20, v12, -v14
    v_mfma_f32_16x16x32_bf16 v[132:135], v[172:175], v[188:191], v[132:135]
    v_fma_f32 v21, v21, v13, -v15
    v_fma_f32 v22, v22, v252, -v254
    v_mfma_f32_16x16x32_bf16 v[136:139], v[176:179], v[184:187], v[136:139]
    v_fma_f32 v23, v23, v253, -v255
    v_cvt_pk_bf16_f32 v16, v16, v17
    v_mfma_f32_16x16x32_bf16 v[140:143], v[176:179], v[188:191], v[140:143]
    v_cvt_pk_bf16_f32 v17, v18, v19
    v_cvt_pk_bf16_f32 v18, v20, v21
    v_mfma_f32_16x16x32_bf16 v[144:147], v[180:183], v[184:187], v[144:147]
    v_cvt_pk_bf16_f32 v19, v22, v23
    v_fma_f32 v24, v24, v4, -v6
    v_mfma_f32_16x16x32_bf16 v[148:151], v[180:183], v[188:191], v[148:151]
    v_fma_f32 v25, v25, v5, -v7
    v_fma_f32 v26, v26, v8, -v10
    v_mfma_f32_16x16x32_bf16 v[152:155], v[192:195], v[184:187], v[152:155]
    v_fma_f32 v27, v27, v9, -v11
    v_fma_f32 v28, v28, v12, -v14
    v_mfma_f32_16x16x32_bf16 v[156:159], v[192:195], v[188:191], v[156:159]
    v_fma_f32 v29, v29, v13, -v15
    s_waitcnt lgkmcnt(0)
    s_barrier
    v_mfma_f32_16x16x32_bf16 v[88:91], v[212:215], v[204:207], v[88:91]
    ds_read_b128 v[160:163], v197 offset:0
    v_mfma_f32_16x16x32_bf16 v[92:95], v[212:215], v[208:211], v[92:95]
    ds_read_b128 v[164:167], v197 offset:2048
    v_fma_f32 v30, v30, v252, -v254
    v_mfma_f32_16x16x32_bf16 v[96:99], v[216:219], v[204:207], v[96:99]
    ds_read_b128 v[168:171], v199 offset:0
    v_fma_f32 v31, v31, v253, -v255
    v_mfma_f32_16x16x32_bf16 v[100:103], v[216:219], v[208:211], v[100:103]
    ds_read_b128 v[172:175], v199 offset:1024
    v_permlane32_swap_b32 v16, v18
    v_mfma_f32_16x16x32_bf16 v[104:107], v[220:223], v[204:207], v[104:107]
    ds_read_b128 v[176:179], v199 offset:2048
    v_permlane32_swap_b32 v17, v19
    v_mfma_f32_16x16x32_bf16 v[108:111], v[220:223], v[208:211], v[108:111]
    ds_read_b128 v[180:183], v199 offset:3072
    v_cvt_pk_bf16_f32 v24, v24, v25
    v_mfma_f32_16x16x32_bf16 v[112:115], v[224:227], v[204:207], v[112:115]
    ds_read_b128 v[184:187], v0 offset:0
    v_cvt_pk_bf16_f32 v25, v26, v27
    v_mfma_f32_16x16x32_bf16 v[116:119], v[224:227], v[208:211], v[116:119]
    ds_read_b128 v[188:191], v0 offset:2048
    v_mfma_f32_16x16x32_bf16 v[120:123], v[212:215], v[228:231], v[120:123]
    ds_read_b128 v[192:195], v2 offset:8192
    v_cvt_pk_bf16_f32 v26, v28, v29
    v_mfma_f32_16x16x32_bf16 v[124:127], v[212:215], v[232:235], v[124:127]
    v_cvt_pk_bf16_f32 v27, v30, v31
    v_permlane16_swap_b32 v16, v18
    v_mfma_f32_16x16x32_bf16 v[128:131], v[216:219], v[228:231], v[128:131]
    v_permlane16_swap_b32 v17, v19
    v_fma_f32 v32, v32, v4, -v6
    v_mfma_f32_16x16x32_bf16 v[132:135], v[216:219], v[232:235], v[132:135]
    v_fma_f32 v33, v33, v5, -v7
    v_fma_f32 v34, v34, v8, -v10
    v_mfma_f32_16x16x32_bf16 v[136:139], v[220:223], v[228:231], v[136:139]
    v_fma_f32 v35, v35, v9, -v11
    v_fma_f32 v36, v36, v12, -v14
    v_mfma_f32_16x16x32_bf16 v[140:143], v[220:223], v[232:235], v[140:143]
    v_fma_f32 v37, v37, v13, -v15
    v_fma_f32 v38, v38, v252, -v254
    v_mfma_f32_16x16x32_bf16 v[144:147], v[224:227], v[228:231], v[144:147]
    v_fma_f32 v39, v39, v253, -v255
    v_permlane32_swap_b32 v24, v26
    v_mfma_f32_16x16x32_bf16 v[148:151], v[224:227], v[232:235], v[148:151]
    v_permlane32_swap_b32 v25, v27
    v_cvt_pk_bf16_f32 v32, v32, v33
    v_mfma_f32_16x16x32_bf16 v[152:155], v[236:239], v[228:231], v[152:155]
    v_cvt_pk_bf16_f32 v33, v34, v35
    v_cvt_pk_bf16_f32 v34, v36, v37
    v_mfma_f32_16x16x32_bf16 v[156:159], v[236:239], v[232:235], v[156:159]
    v_cvt_pk_bf16_f32 v35, v38, v39
    s_waitcnt lgkmcnt(3)
    v_mfma_f32_16x16x32_bf16 v[88:91], v[168:171], v[160:163], v[88:91]
    ds_read_b128 v[204:207], v197 offset:1024
    v_mfma_f32_16x16x32_bf16 v[92:95], v[168:171], v[164:167], v[92:95]
    ds_read_b128 v[208:211], v197 offset:3072
    v_permlane16_swap_b32 v24, v26
    v_mfma_f32_16x16x32_bf16 v[96:99], v[172:175], v[160:163], v[96:99]
    ds_read_b128 v[212:215], v199 offset:9216
    v_permlane16_swap_b32 v25, v27
    v_mfma_f32_16x16x32_bf16 v[100:103], v[172:175], v[164:167], v[100:103]
    ds_read_b128 v[216:219], v199 offset:10240
    v_fma_f32 v40, v40, v4, -v6
    v_mfma_f32_16x16x32_bf16 v[104:107], v[176:179], v[160:163], v[104:107]
    ds_read_b128 v[220:223], v199 offset:11264
    v_fma_f32 v41, v41, v5, -v7
    v_mfma_f32_16x16x32_bf16 v[108:111], v[176:179], v[164:167], v[108:111]
    ds_read_b128 v[224:227], v199 offset:12288
    v_fma_f32 v42, v42, v8, -v10
    v_mfma_f32_16x16x32_bf16 v[112:115], v[180:183], v[160:163], v[112:115]
    ds_read_b128 v[228:231], v0 offset:1024
    v_fma_f32 v43, v43, v9, -v11
    v_mfma_f32_16x16x32_bf16 v[116:119], v[180:183], v[164:167], v[116:119]
    ds_read_b128 v[232:235], v0 offset:3072
    s_waitcnt lgkmcnt(8)
    v_mfma_f32_16x16x32_bf16 v[120:123], v[168:171], v[184:187], v[120:123]
    ds_read_b128 v[236:239], v2 offset:17408
    v_fma_f32 v44, v44, v12, -v14
    v_mfma_f32_16x16x32_bf16 v[124:127], v[168:171], v[188:191], v[124:127]
    v_fma_f32 v45, v45, v13, -v15
    v_fma_f32 v46, v46, v252, -v254
    v_mfma_f32_16x16x32_bf16 v[128:131], v[172:175], v[184:187], v[128:131]
    v_fma_f32 v47, v47, v253, -v255
    v_permlane32_swap_b32 v32, v34
    v_mfma_f32_16x16x32_bf16 v[132:135], v[172:175], v[188:191], v[132:135]
    v_permlane32_swap_b32 v33, v35
    v_cvt_pk_bf16_f32 v40, v40, v41
    v_mfma_f32_16x16x32_bf16 v[136:139], v[176:179], v[184:187], v[136:139]
    v_cvt_pk_bf16_f32 v41, v42, v43
    v_cvt_pk_bf16_f32 v42, v44, v45
    v_mfma_f32_16x16x32_bf16 v[140:143], v[176:179], v[188:191], v[140:143]
    v_cvt_pk_bf16_f32 v43, v46, v47
    v_permlane16_swap_b32 v32, v34
    v_mfma_f32_16x16x32_bf16 v[144:147], v[180:183], v[184:187], v[144:147]
    v_permlane16_swap_b32 v33, v35
    v_fma_f32 v48, v48, v4, -v6
    v_mfma_f32_16x16x32_bf16 v[148:151], v[180:183], v[188:191], v[148:151]
    v_fma_f32 v49, v49, v5, -v7
    v_fma_f32 v50, v50, v8, -v10
    v_mfma_f32_16x16x32_bf16 v[152:155], v[192:195], v[184:187], v[152:155]
    v_fma_f32 v51, v51, v9, -v11
    v_fma_f32 v52, v52, v12, -v14
    v_mfma_f32_16x16x32_bf16 v[156:159], v[192:195], v[188:191], v[156:159]
    v_fma_f32 v53, v53, v13, -v15
    s_waitcnt lgkmcnt(0)
    s_barrier
    v_mfma_f32_16x16x32_bf16 v[88:91], v[212:215], v[204:207], v[88:91]
    ds_read_b128 v[160:163], v197 offset:36864
    v_mfma_f32_16x16x32_bf16 v[92:95], v[212:215], v[208:211], v[92:95]
    ds_read_b128 v[164:167], v197 offset:38912
    v_fma_f32 v54, v54, v252, -v254
    v_mfma_f32_16x16x32_bf16 v[96:99], v[216:219], v[204:207], v[96:99]
    ds_read_b128 v[168:171], v199 offset:36864
    v_fma_f32 v55, v55, v253, -v255
    v_mfma_f32_16x16x32_bf16 v[100:103], v[216:219], v[208:211], v[100:103]
    ds_read_b128 v[172:175], v199 offset:37888
    v_permlane32_swap_b32 v40, v42
    v_mfma_f32_16x16x32_bf16 v[104:107], v[220:223], v[204:207], v[104:107]
    ds_read_b128 v[176:179], v199 offset:38912
    v_permlane32_swap_b32 v41, v43
    v_mfma_f32_16x16x32_bf16 v[108:111], v[220:223], v[208:211], v[108:111]
    ds_read_b128 v[180:183], v199 offset:39936
    v_cvt_pk_bf16_f32 v48, v48, v49
    v_mfma_f32_16x16x32_bf16 v[112:115], v[224:227], v[204:207], v[112:115]
    ds_read_b128 v[184:187], v0 offset:36864
    v_cvt_pk_bf16_f32 v49, v50, v51
    v_mfma_f32_16x16x32_bf16 v[116:119], v[224:227], v[208:211], v[116:119]
    ds_read_b128 v[188:191], v0 offset:38912
    v_mfma_f32_16x16x32_bf16 v[120:123], v[212:215], v[228:231], v[120:123]
    ds_read_b128 v[192:195], v2 offset:45056
    v_cvt_pk_bf16_f32 v50, v52, v53
    v_mfma_f32_16x16x32_bf16 v[124:127], v[212:215], v[232:235], v[124:127]
    v_cvt_pk_bf16_f32 v51, v54, v55
    v_permlane16_swap_b32 v40, v42
    v_mfma_f32_16x16x32_bf16 v[128:131], v[216:219], v[228:231], v[128:131]
    v_permlane16_swap_b32 v41, v43
    v_fma_f32 v56, v56, v4, -v6
    v_mfma_f32_16x16x32_bf16 v[132:135], v[216:219], v[232:235], v[132:135]
    v_fma_f32 v57, v57, v5, -v7
    v_fma_f32 v58, v58, v8, -v10
    v_mfma_f32_16x16x32_bf16 v[136:139], v[220:223], v[228:231], v[136:139]
    v_fma_f32 v59, v59, v9, -v11
    v_fma_f32 v60, v60, v12, -v14
    v_mfma_f32_16x16x32_bf16 v[140:143], v[220:223], v[232:235], v[140:143]
    v_fma_f32 v61, v61, v13, -v15
    v_fma_f32 v62, v62, v252, -v254
    v_mfma_f32_16x16x32_bf16 v[144:147], v[224:227], v[228:231], v[144:147]
    v_fma_f32 v63, v63, v253, -v255
    v_permlane32_swap_b32 v48, v50
    v_mfma_f32_16x16x32_bf16 v[148:151], v[224:227], v[232:235], v[148:151]
    v_permlane32_swap_b32 v49, v51
    v_cvt_pk_bf16_f32 v56, v56, v57
    v_mfma_f32_16x16x32_bf16 v[152:155], v[236:239], v[228:231], v[152:155]
    v_cvt_pk_bf16_f32 v57, v58, v59
    v_cvt_pk_bf16_f32 v58, v60, v61
    v_mfma_f32_16x16x32_bf16 v[156:159], v[236:239], v[232:235], v[156:159]
    v_cvt_pk_bf16_f32 v59, v62, v63
    s_waitcnt lgkmcnt(3)
    v_mfma_f32_16x16x32_bf16 v[88:91], v[168:171], v[160:163], v[88:91]
    ds_read_b128 v[204:207], v197 offset:37888
    v_mfma_f32_16x16x32_bf16 v[92:95], v[168:171], v[164:167], v[92:95]
    ds_read_b128 v[208:211], v197 offset:39936
    v_permlane16_swap_b32 v48, v50
    v_mfma_f32_16x16x32_bf16 v[96:99], v[172:175], v[160:163], v[96:99]
    ds_read_b128 v[212:215], v199 offset:46080
    buffer_store_dwordx4 v[16:19], v1, s[4:7], s38 offen offset:0 sc1
    v_permlane16_swap_b32 v49, v51
    v_mfma_f32_16x16x32_bf16 v[100:103], v[172:175], v[164:167], v[100:103]
    ds_read_b128 v[216:219], v199 offset:47104
    v_fma_f32 v64, v64, v4, -v6
    v_mfma_f32_16x16x32_bf16 v[104:107], v[176:179], v[160:163], v[104:107]
    ds_read_b128 v[220:223], v199 offset:48128
    v_fma_f32 v65, v65, v5, -v7
    v_mfma_f32_16x16x32_bf16 v[108:111], v[176:179], v[164:167], v[108:111]
    ds_read_b128 v[224:227], v199 offset:49152
    v_fma_f32 v66, v66, v8, -v10
    v_mfma_f32_16x16x32_bf16 v[112:115], v[180:183], v[160:163], v[112:115]
    ds_read_b128 v[228:231], v0 offset:37888
    v_fma_f32 v67, v67, v9, -v11
    v_mfma_f32_16x16x32_bf16 v[116:119], v[180:183], v[164:167], v[116:119]
    ds_read_b128 v[232:235], v0 offset:39936
    s_waitcnt lgkmcnt(8)
    buffer_store_dwordx4 v[24:27], v1, s[4:7], s38 offen offset:1024 sc1
    v_mfma_f32_16x16x32_bf16 v[120:123], v[168:171], v[184:187], v[120:123]
    ds_read_b128 v[236:239], v2 offset:54272
    v_fma_f32 v68, v68, v12, -v14
    v_mfma_f32_16x16x32_bf16 v[124:127], v[168:171], v[188:191], v[124:127]
    v_fma_f32 v69, v69, v13, -v15
    v_fma_f32 v70, v70, v252, -v254
    v_mfma_f32_16x16x32_bf16 v[128:131], v[172:175], v[184:187], v[128:131]
    v_fma_f32 v71, v71, v253, -v255
    v_permlane32_swap_b32 v56, v58
    v_mfma_f32_16x16x32_bf16 v[132:135], v[172:175], v[188:191], v[132:135]
    v_permlane32_swap_b32 v57, v59
    v_cvt_pk_bf16_f32 v64, v64, v65
    v_mfma_f32_16x16x32_bf16 v[136:139], v[176:179], v[184:187], v[136:139]
    buffer_store_dwordx4 v[32:35], v1, s[4:7], s38 offen offset:2048 sc1
    v_cvt_pk_bf16_f32 v65, v66, v67
    v_cvt_pk_bf16_f32 v66, v68, v69
    v_mfma_f32_16x16x32_bf16 v[140:143], v[176:179], v[188:191], v[140:143]
    v_cvt_pk_bf16_f32 v67, v70, v71
    v_permlane16_swap_b32 v56, v58
    v_mfma_f32_16x16x32_bf16 v[144:147], v[180:183], v[184:187], v[144:147]
    v_permlane16_swap_b32 v57, v59
    v_fma_f32 v72, v72, v4, -v6
    v_mfma_f32_16x16x32_bf16 v[148:151], v[180:183], v[188:191], v[148:151]
    v_fma_f32 v73, v73, v5, -v7
    v_fma_f32 v74, v74, v8, -v10
    v_mfma_f32_16x16x32_bf16 v[152:155], v[192:195], v[184:187], v[152:155]
    v_fma_f32 v75, v75, v9, -v11
    v_fma_f32 v76, v76, v12, -v14
    v_mfma_f32_16x16x32_bf16 v[156:159], v[192:195], v[188:191], v[156:159]
    v_fma_f32 v77, v77, v13, -v15
    s_waitcnt lgkmcnt(0)
    s_barrier
    v_mfma_f32_16x16x32_bf16 v[88:91], v[212:215], v[204:207], v[88:91]
    ds_read_b128 v[160:163], v196 offset:0
    v_mfma_f32_16x16x32_bf16 v[92:95], v[212:215], v[208:211], v[92:95]
    ds_read_b128 v[164:167], v196 offset:2048
    v_fma_f32 v78, v78, v252, -v254
    v_mfma_f32_16x16x32_bf16 v[96:99], v[216:219], v[204:207], v[96:99]
    ds_read_b128 v[168:171], v198 offset:0
    buffer_store_dwordx4 v[40:43], v1, s[4:7], s38 offen offset:3072 sc1
    v_fma_f32 v79, v79, v253, -v255
    v_mfma_f32_16x16x32_bf16 v[100:103], v[216:219], v[208:211], v[100:103]
    ds_read_b128 v[172:175], v198 offset:1024
    v_permlane32_swap_b32 v64, v66
    v_mfma_f32_16x16x32_bf16 v[104:107], v[220:223], v[204:207], v[104:107]
    ds_read_b128 v[176:179], v198 offset:2048
    v_permlane32_swap_b32 v65, v67
    v_mfma_f32_16x16x32_bf16 v[108:111], v[220:223], v[208:211], v[108:111]
    ds_read_b128 v[180:183], v198 offset:3072
    v_cvt_pk_bf16_f32 v72, v72, v73
    v_mfma_f32_16x16x32_bf16 v[112:115], v[224:227], v[204:207], v[112:115]
    ds_read_b128 v[184:187], v3 offset:0
    v_cvt_pk_bf16_f32 v73, v74, v75
    v_mfma_f32_16x16x32_bf16 v[116:119], v[224:227], v[208:211], v[116:119]
    ds_read_b128 v[188:191], v3 offset:2048
    buffer_store_dwordx4 v[48:51], v1, s[4:7], s39 offen offset:0 sc1
    v_mfma_f32_16x16x32_bf16 v[120:123], v[212:215], v[228:231], v[120:123]
    ds_read_b128 v[192:195], v1 offset:8192
    v_cvt_pk_bf16_f32 v74, v76, v77
    v_mfma_f32_16x16x32_bf16 v[124:127], v[212:215], v[232:235], v[124:127]
    v_cvt_pk_bf16_f32 v75, v78, v79
    v_permlane16_swap_b32 v64, v66
    v_mfma_f32_16x16x32_bf16 v[128:131], v[216:219], v[228:231], v[128:131]
    v_permlane16_swap_b32 v65, v67
    v_fma_f32 v80, v80, v4, -v6
    v_mfma_f32_16x16x32_bf16 v[132:135], v[216:219], v[232:235], v[132:135]
    v_fma_f32 v81, v81, v5, -v7
    v_fma_f32 v82, v82, v8, -v10
    v_mfma_f32_16x16x32_bf16 v[136:139], v[220:223], v[228:231], v[136:139]
    buffer_store_dwordx4 v[56:59], v1, s[4:7], s39 offen offset:1024 sc1
    v_fma_f32 v83, v83, v9, -v11
    v_fma_f32 v84, v84, v12, -v14
    v_mfma_f32_16x16x32_bf16 v[140:143], v[220:223], v[232:235], v[140:143]
    v_fma_f32 v85, v85, v13, -v15
    v_fma_f32 v86, v86, v252, -v254
    v_mfma_f32_16x16x32_bf16 v[144:147], v[224:227], v[228:231], v[144:147]
    v_fma_f32 v87, v87, v253, -v255
    v_permlane32_swap_b32 v72, v74
    v_mfma_f32_16x16x32_bf16 v[148:151], v[224:227], v[232:235], v[148:151]
    v_permlane32_swap_b32 v73, v75
    v_cvt_pk_bf16_f32 v80, v80, v81
    v_mfma_f32_16x16x32_bf16 v[152:155], v[236:239], v[228:231], v[152:155]
    v_cvt_pk_bf16_f32 v81, v82, v83
    v_cvt_pk_bf16_f32 v82, v84, v85
    v_mfma_f32_16x16x32_bf16 v[156:159], v[236:239], v[232:235], v[156:159]
    v_cvt_pk_bf16_f32 v83, v86, v87
    s_waitcnt lgkmcnt(3)
    v_mfma_f32_16x16x32_bf16 v[88:91], v[168:171], v[160:163], v[88:91]
    ds_read_b128 v[204:207], v196 offset:1024
    v_mfma_f32_16x16x32_bf16 v[92:95], v[168:171], v[164:167], v[92:95]
    ds_read_b128 v[208:211], v196 offset:3072
    v_permlane16_swap_b32 v72, v74
    v_mfma_f32_16x16x32_bf16 v[96:99], v[172:175], v[160:163], v[96:99]
    ds_read_b128 v[212:215], v198 offset:9216
    buffer_store_dwordx4 v[64:67], v1, s[4:7], s39 offen offset:2048 sc1
    v_permlane16_swap_b32 v73, v75
    v_mfma_f32_16x16x32_bf16 v[100:103], v[172:175], v[164:167], v[100:103]
    ds_read_b128 v[216:219], v198 offset:10240
    s_nop 0
    v_mfma_f32_16x16x32_bf16 v[104:107], v[176:179], v[160:163], v[104:107]
    ds_read_b128 v[220:223], v198 offset:11264
    v_permlane32_swap_b32 v80, v82
    v_mfma_f32_16x16x32_bf16 v[108:111], v[176:179], v[164:167], v[108:111]
    ds_read_b128 v[224:227], v198 offset:12288
    v_permlane32_swap_b32 v81, v83
    v_mfma_f32_16x16x32_bf16 v[112:115], v[180:183], v[160:163], v[112:115]
    ds_read_b128 v[228:231], v3 offset:1024
    s_nop 0
    v_mfma_f32_16x16x32_bf16 v[116:119], v[180:183], v[164:167], v[116:119]
    ds_read_b128 v[232:235], v3 offset:3072
    s_waitcnt lgkmcnt(8)
    v_mfma_f32_16x16x32_bf16 v[120:123], v[168:171], v[184:187], v[120:123]
    ds_read_b128 v[236:239], v1 offset:17408
    v_permlane16_swap_b32 v80, v82
    v_mfma_f32_16x16x32_bf16 v[124:127], v[168:171], v[188:191], v[124:127]
    v_permlane16_swap_b32 v81, v83
    v_mul_f32_e64 v4, s40, v249
    v_mfma_f32_16x16x32_bf16 v[128:131], v[172:175], v[184:187], v[128:131]
    v_mul_f32 v6, s40, v251
    v_mul_f32 v5, v249, v249
    v_mfma_f32_16x16x32_bf16 v[132:135], v[172:175], v[188:191], v[132:135]
    v_mul_f32 v7, v251, v251
    v_rcp_f32 v249, v249
    v_mfma_f32_16x16x32_bf16 v[136:139], v[176:179], v[184:187], v[136:139]
    v_rcp_f32 v251, v251
    v_mul_f32 v5, s42, v5
    v_mfma_f32_16x16x32_bf16 v[140:143], v[176:179], v[188:191], v[140:143]
    v_mul_f32 v7, s42, v7
    v_mul_f32 v5, v5, v4
    v_mfma_f32_16x16x32_bf16 v[144:147], v[180:183], v[184:187], v[144:147]
    v_mul_f32 v7, v7, v6
    v_subrev_u32 v8, s47, v200
    v_mfma_f32_16x16x32_bf16 v[148:151], v[180:183], v[188:191], v[148:151]
    v_subrev_u32 v9, s47, v201
    v_subrev_u32 v10, s47, v202
    v_mfma_f32_16x16x32_bf16 v[152:155], v[192:195], v[184:187], v[152:155]
    v_subrev_u32_e64 v11, s47, v203
    v_bfe_u32 v13, v1, 4, 4
    v_mfma_f32_16x16x32_bf16 v[156:159], v[192:195], v[188:191], v[156:159]
    s_lshl_b32 s33, s20, 6
    s_waitcnt lgkmcnt(0)
    s_barrier
    v_mfma_f32_16x16x32_bf16 v[88:91], v[212:215], v[204:207], v[88:91]
    ds_read_b128 v[160:163], v196 offset:36864
    v_mfma_f32_16x16x32_bf16 v[92:95], v[212:215], v[208:211], v[92:95]
    ds_read_b128 v[164:167], v196 offset:38912
    s_add_u32 s33, s33, 161280
    v_mfma_f32_16x16x32_bf16 v[96:99], v[216:219], v[204:207], v[96:99]
    ds_read_b128 v[168:171], v198 offset:36864
    buffer_store_dwordx4 v[72:75], v1, s[4:7], s39 offen offset:3072 sc1
    v_lshl_add_u32 v13, v13, 1, s33
    v_mfma_f32_16x16x32_bf16 v[100:103], v[216:219], v[208:211], v[100:103]
    ds_read_b128 v[172:175], v198 offset:37888
    v_xor_b32 v15, 64, v13
    v_mfma_f32_16x16x32_bf16 v[104:107], v[220:223], v[204:207], v[104:107]
    ds_read_b128 v[176:179], v198 offset:38912
    v_mfma_f32_16x16x32_bf16 v[108:111], v[220:223], v[208:211], v[108:111]
    ds_read_b128 v[180:183], v198 offset:39936
    v_mfma_f32_16x16x32_bf16 v[112:115], v[224:227], v[204:207], v[112:115]
    ds_read_b128 v[184:187], v3 offset:36864
    v_mfma_f32_16x16x32_bf16 v[116:119], v[224:227], v[208:211], v[116:119]
    ds_read_b128 v[188:191], v3 offset:38912
    buffer_store_dwordx4 v[80:83], v1, s[4:7], s46 offen offset:0 sc1
    v_mfma_f32_16x16x32_bf16 v[120:123], v[212:215], v[228:231], v[120:123]
    ds_read_b128 v[192:195], v1 offset:45056
    v_mfma_f32_16x16x32_bf16 v[124:127], v[212:215], v[232:235], v[124:127]
    v_mfma_f32_16x16x32_bf16 v[128:131], v[216:219], v[228:231], v[128:131]
    v_mfma_f32_16x16x32_bf16 v[132:135], v[216:219], v[232:235], v[132:135]
    v_mfma_f32_16x16x32_bf16 v[136:139], v[220:223], v[228:231], v[136:139]
    v_mfma_f32_16x16x32_bf16 v[140:143], v[220:223], v[232:235], v[140:143]
    v_mfma_f32_16x16x32_bf16 v[144:147], v[224:227], v[228:231], v[144:147]
    v_mfma_f32_16x16x32_bf16 v[148:151], v[224:227], v[232:235], v[148:151]
    v_mfma_f32_16x16x32_bf16 v[152:155], v[236:239], v[228:231], v[152:155]
    v_mfma_f32_16x16x32_bf16 v[156:159], v[236:239], v[232:235], v[156:159]
    s_waitcnt lgkmcnt(3)
    v_mfma_f32_16x16x32_bf16 v[88:91], v[168:171], v[160:163], v[88:91]
    ds_read_b128 v[204:207], v196 offset:37888
    v_mfma_f32_16x16x32_bf16 v[92:95], v[168:171], v[164:167], v[92:95]
    ds_read_b128 v[208:211], v196 offset:39936
    v_mfma_f32_16x16x32_bf16 v[96:99], v[172:175], v[160:163], v[96:99]
    ds_read_b128 v[212:215], v198 offset:46080
    v_mfma_f32_16x16x32_bf16 v[100:103], v[172:175], v[164:167], v[100:103]
    ds_read_b128 v[216:219], v198 offset:47104
    v_mfma_f32_16x16x32_bf16 v[104:107], v[176:179], v[160:163], v[104:107]
    ds_read_b128 v[220:223], v198 offset:48128
    v_mfma_f32_16x16x32_bf16 v[108:111], v[176:179], v[164:167], v[108:111]
    ds_read_b128 v[224:227], v198 offset:49152
    v_mfma_f32_16x16x32_bf16 v[112:115], v[180:183], v[160:163], v[112:115]
    ds_read_b128 v[228:231], v3 offset:37888
    v_mfma_f32_16x16x32_bf16 v[116:119], v[180:183], v[164:167], v[116:119]
    ds_read_b128 v[232:235], v3 offset:39936
    s_waitcnt lgkmcnt(8)
    v_mfma_f32_16x16x32_bf16 v[120:123], v[168:171], v[184:187], v[120:123]
    ds_read_b128 v[236:239], v1 offset:54272
    v_mfma_f32_16x16x32_bf16 v[124:127], v[168:171], v[188:191], v[124:127]
    v_mfma_f32_16x16x32_bf16 v[128:131], v[172:175], v[184:187], v[128:131]
    v_mfma_f32_16x16x32_bf16 v[132:135], v[172:175], v[188:191], v[132:135]
    s_lshr_b32 s35, s48, 4
    v_mfma_f32_16x16x32_bf16 v[136:139], v[176:179], v[184:187], v[136:139]
    v_lshrrev_b32 v0, 4, v1
    v_mfma_f32_16x16x32_bf16 v[140:143], v[176:179], v[188:191], v[140:143]
    v_and_b32_e64 v0, 48, v0
    v_mfma_f32_16x16x32_bf16 v[144:147], v[180:183], v[184:187], v[144:147]
    v_add_u32 v0, 160320, v0
    v_mfma_f32_16x16x32_bf16 v[148:151], v[180:183], v[188:191], v[148:151]
    v_add_u32_e64 v197, s35, v0
    v_mfma_f32_16x16x32_bf16 v[152:155], v[192:195], v[184:187], v[152:155]
    v_mfma_f32_16x16x32_bf16 v[156:159], v[192:195], v[188:191], v[156:159]
    s_waitcnt lgkmcnt(0)
    v_mfma_f32_16x16x32_bf16 v[88:91], v[212:215], v[204:207], v[88:91]
    ds_read_b128 v[168:171], v197 offset:0
    v_mfma_f32_16x16x32_bf16 v[92:95], v[212:215], v[208:211], v[92:95]
    ds_read_b128 v[172:175], v197 offset:64
    v_mfma_f32_16x16x32_bf16 v[96:99], v[216:219], v[204:207], v[96:99]
    ds_read_b128 v[176:179], v197 offset:128
    v_mfma_f32_16x16x32_bf16 v[100:103], v[216:219], v[208:211], v[100:103]
    ds_read_b128 v[180:183], v197 offset:192
    v_mfma_f32_16x16x32_bf16 v[104:107], v[220:223], v[204:207], v[104:107]
    ds_read_b128 v[184:187], v0 offset:512
    v_mfma_f32_16x16x32_bf16 v[108:111], v[220:223], v[208:211], v[108:111]
    ds_read_u16 v12, v13
    v_mfma_f32_16x16x32_bf16 v[112:115], v[224:227], v[204:207], v[112:115]
    ds_read_u16 v252, v13 offset:32
    v_mfma_f32_16x16x32_bf16 v[116:119], v[224:227], v[208:211], v[116:119]
    ds_read_u16 v160, v15
    v_mfma_f32_16x16x32_bf16 v[120:123], v[212:215], v[228:231], v[120:123]
    ds_read_u16 v161, v15 offset:32
    v_mfma_f32_16x16x32_bf16 v[124:127], v[212:215], v[232:235], v[124:127]
    v_mfma_f32_16x16x32_bf16 v[128:131], v[216:219], v[228:231], v[128:131]
    v_mfma_f32_16x16x32_bf16 v[132:135], v[216:219], v[232:235], v[132:135]
    v_mfma_f32_16x16x32_bf16 v[136:139], v[220:223], v[228:231], v[136:139]
    s_lshr_b32 s35, s20, 1
    s_mul_i32 s35, s35, 36864
    v_mfma_f32_16x16x32_bf16 v[140:143], v[220:223], v[232:235], v[140:143]
    s_and_b32 s34, s20, 1
    s_mul_i32 s34, s34, 9216
    v_mfma_f32_16x16x32_bf16 v[144:147], v[224:227], v[228:231], v[144:147]
    s_add_u32 s35, s35, s34
    v_mfma_f32_16x16x32_bf16 v[148:151], v[224:227], v[232:235], v[148:151]
    v_add_u32_e64 v3, s35, v2
    v_mfma_f32_16x16x32_bf16 v[152:155], v[236:239], v[228:231], v[152:155]
    v_mfma_f32_16x16x32_bf16 v[156:159], v[236:239], v[232:235], v[156:159]
    s_waitcnt vmcnt(0)
    s_barrier
    s_waitcnt lgkmcnt(0)
    v_lshlrev_b32 v15, 16, v12
    v_lshlrev_b32 v255, 16, v252
    v_lshlrev_b32 v235, 16, v160
    v_lshlrev_b32 v239, 16, v161
    v_lshlrev_b32 v14, 16, v12
    v_lshlrev_b32 v254, 16, v252
    v_lshlrev_b32 v234, 16, v160
    v_lshlrev_b32 v238, 16, v161
    v_lshlrev_b32 v13, 16, v12
    v_lshlrev_b32 v253, 16, v252
    v_lshlrev_b32 v233, 16, v160
    v_lshlrev_b32 v237, 16, v161
    v_lshlrev_b32 v12, 16, v12
    v_lshlrev_b32 v252, 16, v252
    v_lshlrev_b32 v232, 16, v160
    v_lshlrev_b32_e64 v236, 16, v161
L_g_z1:
    ds_write_b128 v3, v[16:19] offset:0
    v_pk_fma_f32 v[88:89], v[240:241], v[168:169], v[88:89] op_sel_hi:[0,1,1] neg_lo:[1,0,0] neg_hi:[1,0,0]
    v_pk_fma_f32 v[90:91], v[240:241], v[170:171], v[90:91] op_sel_hi:[0,1,1] neg_lo:[1,0,0] neg_hi:[1,0,0]
    v_pk_fma_f32 v[92:93], v[242:243], v[168:169], v[92:93] op_sel_hi:[0,1,1] neg_lo:[1,0,0] neg_hi:[1,0,0]
    v_pk_fma_f32 v[94:95], v[242:243], v[170:171], v[94:95] op_sel_hi:[0,1,1] neg_lo:[1,0,0] neg_hi:[1,0,0]
    ds_write_b128 v3, v[24:27] offset:1024
    v_pk_fma_f32 v[96:97], v[240:241], v[172:173], v[96:97] op_sel_hi:[0,1,1] neg_lo:[1,0,0] neg_hi:[1,0,0]
    v_pk_fma_f32 v[98:99], v[240:241], v[174:175], v[98:99] op_sel_hi:[0,1,1] neg_lo:[1,0,0] neg_hi:[1,0,0]
    v_pk_fma_f32 v[100:101], v[242:243], v[172:173], v[100:101] op_sel_hi:[0,1,1] neg_lo:[1,0,0] neg_hi:[1,0,0]
    v_pk_fma_f32 v[102:103], v[242:243], v[174:175], v[102:103] op_sel_hi:[0,1,1] neg_lo:[1,0,0] neg_hi:[1,0,0]
    ds_write_b128 v3, v[32:35] offset:2048
    v_pk_fma_f32 v[104:105], v[240:241], v[176:177], v[104:105] op_sel_hi:[0,1,1] neg_lo:[1,0,0] neg_hi:[1,0,0]
    v_pk_fma_f32 v[106:107], v[240:241], v[178:179], v[106:107] op_sel_hi:[0,1,1] neg_lo:[1,0,0] neg_hi:[1,0,0]
    v_pk_fma_f32 v[108:109], v[242:243], v[176:177], v[108:109] op_sel_hi:[0,1,1] neg_lo:[1,0,0] neg_hi:[1,0,0]
    v_pk_fma_f32 v[110:111], v[242:243], v[178:179], v[110:111] op_sel_hi:[0,1,1] neg_lo:[1,0,0] neg_hi:[1,0,0]
    ds_write_b128 v3, v[40:43] offset:3072
    v_pk_fma_f32 v[112:113], v[240:241], v[180:181], v[112:113] op_sel_hi:[0,1,1] neg_lo:[1,0,0] neg_hi:[1,0,0]
    v_pk_fma_f32 v[114:115], v[240:241], v[182:183], v[114:115] op_sel_hi:[0,1,1] neg_lo:[1,0,0] neg_hi:[1,0,0]
    v_pk_fma_f32 v[116:117], v[242:243], v[180:181], v[116:117] op_sel_hi:[0,1,1] neg_lo:[1,0,0] neg_hi:[1,0,0]
    v_pk_fma_f32 v[118:119], v[242:243], v[182:183], v[118:119] op_sel_hi:[0,1,1] neg_lo:[1,0,0] neg_hi:[1,0,0]
    ds_write_b128 v3, v[48:51] offset:4096
    v_pk_fma_f32 v[120:121], v[248:249], v[168:169], v[120:121] op_sel_hi:[0,1,1] neg_lo:[1,0,0] neg_hi:[1,0,0]
    v_pk_fma_f32 v[122:123], v[248:249], v[170:171], v[122:123] op_sel_hi:[0,1,1] neg_lo:[1,0,0] neg_hi:[1,0,0]
    v_pk_fma_f32 v[124:125], v[250:251], v[168:169], v[124:125] op_sel_hi:[0,1,1] neg_lo:[1,0,0] neg_hi:[1,0,0]
    v_pk_fma_f32 v[126:127], v[250:251], v[170:171], v[126:127] op_sel_hi:[0,1,1] neg_lo:[1,0,0] neg_hi:[1,0,0]
    ds_write_b128 v3, v[56:59] offset:5120
    v_pk_fma_f32 v[128:129], v[248:249], v[172:173], v[128:129] op_sel_hi:[0,1,1] neg_lo:[1,0,0] neg_hi:[1,0,0]
    v_pk_fma_f32 v[130:131], v[248:249], v[174:175], v[130:131] op_sel_hi:[0,1,1] neg_lo:[1,0,0] neg_hi:[1,0,0]
    v_pk_fma_f32 v[132:133], v[250:251], v[172:173], v[132:133] op_sel_hi:[0,1,1] neg_lo:[1,0,0] neg_hi:[1,0,0]
    v_pk_fma_f32 v[134:135], v[250:251], v[174:175], v[134:135] op_sel_hi:[0,1,1] neg_lo:[1,0,0] neg_hi:[1,0,0]
    ds_write_b128 v3, v[64:67] offset:6144
    v_pk_fma_f32 v[136:137], v[248:249], v[176:177], v[136:137] op_sel_hi:[0,1,1] neg_lo:[1,0,0] neg_hi:[1,0,0]
    v_pk_fma_f32 v[138:139], v[248:249], v[178:179], v[138:139] op_sel_hi:[0,1,1] neg_lo:[1,0,0] neg_hi:[1,0,0]
    v_pk_fma_f32 v[140:141], v[250:251], v[176:177], v[140:141] op_sel_hi:[0,1,1] neg_lo:[1,0,0] neg_hi:[1,0,0]
    v_pk_fma_f32 v[142:143], v[250:251], v[178:179], v[142:143] op_sel_hi:[0,1,1] neg_lo:[1,0,0] neg_hi:[1,0,0]
    ds_write_b128 v3, v[72:75] offset:7168
    v_pk_fma_f32 v[144:145], v[248:249], v[180:181], v[144:145] op_sel_hi:[0,1,1] neg_lo:[1,0,0] neg_hi:[1,0,0]
    v_pk_fma_f32 v[146:147], v[248:249], v[182:183], v[146:147] op_sel_hi:[0,1,1] neg_lo:[1,0,0] neg_hi:[1,0,0]
    v_pk_fma_f32 v[148:149], v[250:251], v[180:181], v[148:149] op_sel_hi:[0,1,1] neg_lo:[1,0,0] neg_hi:[1,0,0]
    v_pk_fma_f32 v[150:151], v[250:251], v[182:183], v[150:151] op_sel_hi:[0,1,1] neg_lo:[1,0,0] neg_hi:[1,0,0]
    ds_write_b128 v3, v[80:83] offset:8192
    v_pk_fma_f32 v[152:153], v[248:249], v[184:185], v[152:153] op_sel_hi:[0,1,1] neg_lo:[1,0,0] neg_hi:[1,0,0]
    v_pk_fma_f32 v[154:155], v[248:249], v[186:187], v[154:155] op_sel_hi:[0,1,1] neg_lo:[1,0,0] neg_hi:[1,0,0]
    v_pk_fma_f32 v[156:157], v[250:251], v[184:185], v[156:157] op_sel_hi:[0,1,1] neg_lo:[1,0,0] neg_hi:[1,0,0]
    v_pk_fma_f32 v[158:159], v[250:251], v[186:187], v[158:159] op_sel_hi:[0,1,1] neg_lo:[1,0,0] neg_hi:[1,0,0]
    v_pk_mul_f32 v[204:205], v[88:89], v[88:89]
    v_pk_mul_f32 v[206:207], v[90:91], v[90:91]
    v_pk_mul_f32 v[208:209], v[92:93], v[92:93]
    v_pk_mul_f32 v[210:211], v[94:95], v[94:95]
    v_pk_fma_f32 v[204:205], v[204:205], v[244:245], v[244:245] op_sel:[0,1,0] op_sel_hi:[1,1,0]
    v_pk_fma_f32 v[206:207], v[206:207], v[244:245], v[244:245] op_sel:[0,1,0] op_sel_hi:[1,1,0]
    v_pk_fma_f32 v[208:209], v[208:209], v[246:247], v[246:247] op_sel:[0,1,0] op_sel_hi:[1,1,0]
    v_pk_fma_f32 v[210:211], v[210:211], v[246:247], v[246:247] op_sel:[0,1,0] op_sel_hi:[1,1,0]
    v_pk_mul_f32 v[204:205], v[204:205], v[88:89]
    v_pk_mul_f32 v[206:207], v[206:207], v[90:91]
    v_pk_mul_f32 v[208:209], v[208:209], v[92:93]
    v_pk_mul_f32 v[210:211], v[210:211], v[94:95]
    v_exp_f32 v204, v204
    v_exp_f32 v205, v205
    v_exp_f32 v206, v206
    v_exp_f32 v207, v207
    v_exp_f32 v208, v208
    v_exp_f32 v209, v209
    v_exp_f32 v210, v210
    v_exp_f32 v211, v211
    v_pk_fma_f32 v[204:205], v[204:205], v[240:241], v[240:241] op_sel:[0,1,1] op_sel_hi:[1,1,1]
    v_pk_fma_f32 v[206:207], v[206:207], v[240:241], v[240:241] op_sel:[0,1,1] op_sel_hi:[1,1,1]
    v_pk_fma_f32 v[208:209], v[208:209], v[242:243], v[242:243] op_sel:[0,1,1] op_sel_hi:[1,1,1]
    v_pk_fma_f32 v[210:211], v[210:211], v[242:243], v[242:243] op_sel:[0,1,1] op_sel_hi:[1,1,1]
    v_rcp_f32 v204, v204
    v_rcp_f32 v205, v205
    v_rcp_f32 v206, v206
    v_rcp_f32 v207, v207
    v_rcp_f32 v208, v208
    v_rcp_f32 v209, v209
    v_rcp_f32 v210, v210
    v_rcp_f32 v211, v211
    v_pk_mul_f32 v[88:89], v[88:89], v[204:205]
    v_pk_mul_f32 v[90:91], v[90:91], v[206:207]
    v_pk_mul_f32 v[92:93], v[92:93], v[208:209]
    v_pk_mul_f32 v[94:95], v[94:95], v[210:211]
    v_pk_mul_f32 v[212:213], v[96:97], v[96:97]
    v_pk_mul_f32 v[214:215], v[98:99], v[98:99]
    v_pk_mul_f32 v[216:217], v[100:101], v[100:101]
    v_pk_mul_f32 v[218:219], v[102:103], v[102:103]
    v_pk_fma_f32 v[212:213], v[212:213], v[244:245], v[244:245] op_sel:[0,1,0] op_sel_hi:[1,1,0]
    v_pk_fma_f32 v[214:215], v[214:215], v[244:245], v[244:245] op_sel:[0,1,0] op_sel_hi:[1,1,0]
    v_pk_fma_f32 v[216:217], v[216:217], v[246:247], v[246:247] op_sel:[0,1,0] op_sel_hi:[1,1,0]
    v_pk_fma_f32 v[218:219], v[218:219], v[246:247], v[246:247] op_sel:[0,1,0] op_sel_hi:[1,1,0]
    v_pk_mul_f32 v[212:213], v[212:213], v[96:97]
    v_pk_mul_f32 v[214:215], v[214:215], v[98:99]
    v_pk_mul_f32 v[216:217], v[216:217], v[100:101]
    v_pk_mul_f32 v[218:219], v[218:219], v[102:103]
    v_exp_f32 v212, v212
    v_exp_f32 v213, v213
    v_exp_f32 v214, v214
    v_exp_f32 v215, v215
    v_exp_f32 v216, v216
    v_exp_f32 v217, v217
    v_exp_f32 v218, v218
    v_exp_f32 v219, v219
    v_pk_fma_f32 v[212:213], v[212:213], v[240:241], v[240:241] op_sel:[0,1,1] op_sel_hi:[1,1,1]
    v_pk_fma_f32 v[214:215], v[214:215], v[240:241], v[240:241] op_sel:[0,1,1] op_sel_hi:[1,1,1]
    v_pk_fma_f32 v[216:217], v[216:217], v[242:243], v[242:243] op_sel:[0,1,1] op_sel_hi:[1,1,1]
    v_pk_fma_f32 v[218:219], v[218:219], v[242:243], v[242:243] op_sel:[0,1,1] op_sel_hi:[1,1,1]
    v_rcp_f32 v212, v212
    v_rcp_f32 v213, v213
    v_rcp_f32 v214, v214
    v_rcp_f32 v215, v215
    v_rcp_f32 v216, v216
    v_rcp_f32 v217, v217
    v_rcp_f32 v218, v218
    v_rcp_f32 v219, v219
    v_pk_mul_f32 v[96:97], v[96:97], v[212:213]
    v_pk_mul_f32 v[98:99], v[98:99], v[214:215]
    v_pk_mul_f32 v[100:101], v[100:101], v[216:217]
    v_pk_mul_f32 v[102:103], v[102:103], v[218:219]
    v_pk_mul_f32 v[204:205], v[104:105], v[104:105]
    v_pk_mul_f32 v[206:207], v[106:107], v[106:107]
    v_pk_mul_f32 v[208:209], v[108:109], v[108:109]
    v_pk_mul_f32 v[210:211], v[110:111], v[110:111]
    v_pk_fma_f32 v[204:205], v[204:205], v[244:245], v[244:245] op_sel:[0,1,0] op_sel_hi:[1,1,0]
    v_pk_fma_f32 v[206:207], v[206:207], v[244:245], v[244:245] op_sel:[0,1,0] op_sel_hi:[1,1,0]
    v_pk_fma_f32 v[208:209], v[208:209], v[246:247], v[246:247] op_sel:[0,1,0] op_sel_hi:[1,1,0]
    v_pk_fma_f32 v[210:211], v[210:211], v[246:247], v[246:247] op_sel:[0,1,0] op_sel_hi:[1,1,0]
    v_pk_mul_f32 v[204:205], v[204:205], v[104:105]
    v_pk_mul_f32 v[206:207], v[206:207], v[106:107]
    v_pk_mul_f32 v[208:209], v[208:209], v[108:109]
    v_pk_mul_f32 v[210:211], v[210:211], v[110:111]
    v_exp_f32 v204, v204
    v_exp_f32 v205, v205
    v_exp_f32 v206, v206
    v_exp_f32 v207, v207
    v_exp_f32 v208, v208
    v_exp_f32 v209, v209
    v_exp_f32 v210, v210
    v_exp_f32 v211, v211
    v_pk_fma_f32 v[204:205], v[204:205], v[240:241], v[240:241] op_sel:[0,1,1] op_sel_hi:[1,1,1]
    v_pk_fma_f32 v[206:207], v[206:207], v[240:241], v[240:241] op_sel:[0,1,1] op_sel_hi:[1,1,1]
    v_pk_fma_f32 v[208:209], v[208:209], v[242:243], v[242:243] op_sel:[0,1,1] op_sel_hi:[1,1,1]
    v_pk_fma_f32 v[210:211], v[210:211], v[242:243], v[242:243] op_sel:[0,1,1] op_sel_hi:[1,1,1]
    v_rcp_f32 v204, v204
    v_rcp_f32 v205, v205
    v_rcp_f32 v206, v206
    v_rcp_f32 v207, v207
    v_rcp_f32 v208, v208
    v_rcp_f32 v209, v209
    v_rcp_f32 v210, v210
    v_rcp_f32 v211, v211
    v_pk_mul_f32 v[104:105], v[104:105], v[204:205]
    v_pk_mul_f32 v[106:107], v[106:107], v[206:207]
    v_pk_mul_f32 v[108:109], v[108:109], v[208:209]
    v_pk_mul_f32 v[110:111], v[110:111], v[210:211]
    s_waitcnt lgkmcnt(0)
    s_barrier
    ds_read_b128 v[160:163], v202 offset:0
    ds_read_b128 v[164:167], v202 offset:2048
    ds_read_b128 v[168:171], v199 offset:0
    ds_read_b128 v[172:175], v199 offset:1024
    ds_read_b128 v[176:179], v199 offset:2048
    ds_read_b128 v[180:183], v199 offset:3072
    ds_read_b128 v[184:187], v10 offset:0
    ds_read_b128 v[188:191], v10 offset:2048
    ds_read_b128 v[192:195], v2 offset:8192
    v_pk_mul_f32 v[212:213], v[112:113], v[112:113]
    v_pk_mul_f32 v[214:215], v[114:115], v[114:115]
    v_pk_mul_f32 v[216:217], v[116:117], v[116:117]
    v_pk_mul_f32 v[218:219], v[118:119], v[118:119]
    v_pk_fma_f32 v[212:213], v[212:213], v[244:245], v[244:245] op_sel:[0,1,0] op_sel_hi:[1,1,0]
    v_pk_fma_f32 v[214:215], v[214:215], v[244:245], v[244:245] op_sel:[0,1,0] op_sel_hi:[1,1,0]
    v_pk_fma_f32 v[216:217], v[216:217], v[246:247], v[246:247] op_sel:[0,1,0] op_sel_hi:[1,1,0]
    v_pk_fma_f32 v[218:219], v[218:219], v[246:247], v[246:247] op_sel:[0,1,0] op_sel_hi:[1,1,0]
    v_pk_mul_f32 v[212:213], v[212:213], v[112:113]
    v_pk_mul_f32 v[214:215], v[214:215], v[114:115]
    v_pk_mul_f32 v[216:217], v[216:217], v[116:117]
    v_pk_mul_f32 v[218:219], v[218:219], v[118:119]
    v_exp_f32 v212, v212
    v_exp_f32 v213, v213
    v_exp_f32 v214, v214
    v_exp_f32 v215, v215
    v_exp_f32 v216, v216
    v_exp_f32 v217, v217
    v_exp_f32 v218, v218
    v_exp_f32 v219, v219
    v_pk_fma_f32 v[212:213], v[212:213], v[240:241], v[240:241] op_sel:[0,1,1] op_sel_hi:[1,1,1]
    v_pk_fma_f32 v[214:215], v[214:215], v[240:241], v[240:241] op_sel:[0,1,1] op_sel_hi:[1,1,1]
    v_pk_fma_f32 v[216:217], v[216:217], v[242:243], v[242:243] op_sel:[0,1,1] op_sel_hi:[1,1,1]
    v_pk_fma_f32 v[218:219], v[218:219], v[242:243], v[242:243] op_sel:[0,1,1] op_sel_hi:[1,1,1]
    v_rcp_f32 v212, v212
    v_rcp_f32 v213, v213
    v_rcp_f32 v214, v214
    v_rcp_f32 v215, v215
    v_rcp_f32 v216, v216
    v_rcp_f32 v217, v217
    v_rcp_f32 v218, v218
    v_rcp_f32 v219, v219
    v_pk_mul_f32 v[112:113], v[112:113], v[212:213]
    v_pk_mul_f32 v[114:115], v[114:115], v[214:215]
    v_pk_mul_f32 v[116:117], v[116:117], v[216:217]
    v_pk_mul_f32 v[118:119], v[118:119], v[218:219]
    s_waitcnt lgkmcnt(3)
    v_mfma_f32_16x16x32_bf16 v[16:19], v[168:171], v[160:163], v[232:235]
    ds_read_b128 v[204:207], v203 offset:0
    v_mfma_f32_16x16x32_bf16 v[20:23], v[168:171], v[164:167], v[236:239]
    ds_read_b128 v[208:211], v203 offset:2048
    v_mfma_f32_16x16x32_bf16 v[24:27], v[172:175], v[160:163], v[232:235]
    ds_read_b128 v[212:215], v199 offset:9216
    v_mfma_f32_16x16x32_bf16 v[28:31], v[172:175], v[164:167], v[236:239]
    ds_read_b128 v[216:219], v199 offset:10240
    v_mfma_f32_16x16x32_bf16 v[32:35], v[176:179], v[160:163], v[232:235]
    ds_read_b128 v[220:223], v199 offset:11264
    v_mfma_f32_16x16x32_bf16 v[36:39], v[176:179], v[164:167], v[236:239]
    ds_read_b128 v[224:227], v199 offset:12288
    v_mfma_f32_16x16x32_bf16 v[40:43], v[180:183], v[160:163], v[232:235]
    ds_read_b128 v[228:231], v11 offset:0
    v_mfma_f32_16x16x32_bf16 v[44:47], v[180:183], v[164:167], v[236:239]
    ds_read_b128 v[232:235], v11 offset:2048
    s_waitcnt lgkmcnt(8)
    v_mfma_f32_16x16x32_bf16 v[48:51], v[168:171], v[184:187], v[12:15]
    ds_read_b128 v[236:239], v2 offset:17408
    v_mfma_f32_16x16x32_bf16 v[52:55], v[168:171], v[188:191], v[252:255]
    v_mfma_f32_16x16x32_bf16 v[56:59], v[172:175], v[184:187], v[12:15]
    v_mfma_f32_16x16x32_bf16 v[60:63], v[172:175], v[188:191], v[252:255]
    v_mfma_f32_16x16x32_bf16 v[64:67], v[176:179], v[184:187], v[12:15]
    v_mfma_f32_16x16x32_bf16 v[68:71], v[176:179], v[188:191], v[252:255]
    v_mfma_f32_16x16x32_bf16 v[72:75], v[180:183], v[184:187], v[12:15]
    v_mfma_f32_16x16x32_bf16 v[76:79], v[180:183], v[188:191], v[252:255]
    v_mfma_f32_16x16x32_bf16 v[80:83], v[192:195], v[184:187], v[12:15]
    v_mfma_f32_16x16x32_bf16 v[84:87], v[192:195], v[188:191], v[252:255]
    s_waitcnt lgkmcnt(0)
    s_barrier
    v_mfma_f32_16x16x32_bf16 v[16:19], v[212:215], v[204:207], v[16:19]
    ds_read_b128 v[160:163], v202 offset:36864
    v_mfma_f32_16x16x32_bf16 v[20:23], v[212:215], v[208:211], v[20:23]
    ds_read_b128 v[164:167], v202 offset:38912
    v_mfma_f32_16x16x32_bf16 v[24:27], v[216:219], v[204:207], v[24:27]
    ds_read_b128 v[168:171], v199 offset:36864
    v_mfma_f32_16x16x32_bf16 v[28:31], v[216:219], v[208:211], v[28:31]
    ds_read_b128 v[172:175], v199 offset:37888
    v_mul_f32_e64 v12, v120, v120
    v_mfma_f32_16x16x32_bf16 v[32:35], v[220:223], v[204:207], v[32:35]
    ds_read_b128 v[176:179], v199 offset:38912
    v_mul_f32_e64 v13, v121, v121
    v_mfma_f32_16x16x32_bf16 v[36:39], v[220:223], v[208:211], v[36:39]
    ds_read_b128 v[180:183], v199 offset:39936
    v_mul_f32_e64 v14, v122, v122
    v_mfma_f32_16x16x32_bf16 v[40:43], v[224:227], v[204:207], v[40:43]
    ds_read_b128 v[184:187], v10 offset:36864
    v_mul_f32_e64 v15, v123, v123
    v_mfma_f32_16x16x32_bf16 v[44:47], v[224:227], v[208:211], v[44:47]
    ds_read_b128 v[188:191], v10 offset:38912
    v_mfma_f32_16x16x32_bf16 v[48:51], v[212:215], v[228:231], v[48:51]
    ds_read_b128 v[192:195], v2 offset:45056
    v_mul_f32_e64 v252, v124, v124
    v_mfma_f32_16x16x32_bf16 v[52:55], v[212:215], v[232:235], v[52:55]
    v_mul_f32 v253, v125, v125
    v_mul_f32 v254, v126, v126
    v_mfma_f32_16x16x32_bf16 v[56:59], v[216:219], v[228:231], v[56:59]
    v_mul_f32_e64 v255, v127, v127
    v_fma_f32 v12, v12, v5, v4
    v_mfma_f32_16x16x32_bf16 v[60:63], v[216:219], v[232:235], v[60:63]
    v_fma_f32 v13, v13, v5, v4
    v_fma_f32 v14, v14, v5, v4
    v_mfma_f32_16x16x32_bf16 v[64:67], v[220:223], v[228:231], v[64:67]
    v_fma_f32 v15, v15, v5, v4
    v_fma_f32 v252, v252, v7, v6
    v_mfma_f32_16x16x32_bf16 v[68:71], v[220:223], v[232:235], v[68:71]
    v_fma_f32 v253, v253, v7, v6
    v_fma_f32 v254, v254, v7, v6
    v_mfma_f32_16x16x32_bf16 v[72:75], v[224:227], v[228:231], v[72:75]
    v_fma_f32 v255, v255, v7, v6
    v_mul_f32_e64 v12, v12, v120
    v_mfma_f32_16x16x32_bf16 v[76:79], v[224:227], v[232:235], v[76:79]
    v_mul_f32 v13, v13, v121
    v_mul_f32 v14, v14, v122
    v_mfma_f32_16x16x32_bf16 v[80:83], v[236:239], v[228:231], v[80:83]
    v_mul_f32 v15, v15, v123
    v_mul_f32 v252, v252, v124
    v_mfma_f32_16x16x32_bf16 v[84:87], v[236:239], v[232:235], v[84:87]
    v_mul_f32 v253, v253, v125
    s_waitcnt lgkmcnt(3)
    v_mfma_f32_16x16x32_bf16 v[16:19], v[168:171], v[160:163], v[16:19]
    ds_read_b128 v[204:207], v203 offset:36864
    v_mfma_f32_16x16x32_bf16 v[20:23], v[168:171], v[164:167], v[20:23]
    ds_read_b128 v[208:211], v203 offset:38912
    v_mul_f32_e64 v254, v254, v126
    v_mfma_f32_16x16x32_bf16 v[24:27], v[172:175], v[160:163], v[24:27]
    ds_read_b128 v[212:215], v199 offset:46080
    v_mul_f32_e64 v255, v255, v127
    v_mfma_f32_16x16x32_bf16 v[28:31], v[172:175], v[164:167], v[28:31]
    ds_read_b128 v[216:219], v199 offset:47104
    v_exp_f32_e64 v12, v12
    v_mfma_f32_16x16x32_bf16 v[32:35], v[176:179], v[160:163], v[32:35]
    ds_read_b128 v[220:223], v199 offset:48128
    v_exp_f32_e64 v13, v13
    v_mfma_f32_16x16x32_bf16 v[36:39], v[176:179], v[164:167], v[36:39]
    ds_read_b128 v[224:227], v199 offset:49152
    v_exp_f32_e64 v14, v14
    v_mfma_f32_16x16x32_bf16 v[40:43], v[180:183], v[160:163], v[40:43]
    ds_read_b128 v[228:231], v11 offset:36864
    v_exp_f32_e64 v15, v15
    v_mfma_f32_16x16x32_bf16 v[44:47], v[180:183], v[164:167], v[44:47]
    ds_read_b128 v[232:235], v11 offset:38912
    s_waitcnt lgkmcnt(8)
    v_mfma_f32_16x16x32_bf16 v[48:51], v[168:171], v[184:187], v[48:51]
    ds_read_b128 v[236:239], v2 offset:54272
    v_exp_f32 v252, v252
    v_mfma_f32_16x16x32_bf16 v[52:55], v[168:171], v[188:191], v[52:55]
    v_exp_f32_e64 v253, v253
    v_mfma_f32_16x16x32_bf16 v[56:59], v[172:175], v[184:187], v[56:59]
    v_exp_f32_e64 v254, v254
    v_mfma_f32_16x16x32_bf16 v[60:63], v[172:175], v[188:191], v[60:63]
    v_exp_f32_e64 v255, v255
    v_mfma_f32_16x16x32_bf16 v[64:67], v[176:179], v[184:187], v[64:67]
    v_fma_f32 v12, v12, v249, v249
    v_fma_f32 v13, v13, v249, v249
    v_mfma_f32_16x16x32_bf16 v[68:71], v[176:179], v[188:191], v[68:71]
    v_fma_f32 v14, v14, v249, v249
    v_fma_f32 v15, v15, v249, v249
    v_mfma_f32_16x16x32_bf16 v[72:75], v[180:183], v[184:187], v[72:75]
    v_fma_f32 v252, v252, v251, v251
    v_fma_f32 v253, v253, v251, v251
    v_mfma_f32_16x16x32_bf16 v[76:79], v[180:183], v[188:191], v[76:79]
    v_fma_f32 v254, v254, v251, v251
    v_fma_f32 v255, v255, v251, v251
    v_mfma_f32_16x16x32_bf16 v[80:83], v[192:195], v[184:187], v[80:83]
    v_rcp_f32_e64 v12, v12
    v_mfma_f32_16x16x32_bf16 v[84:87], v[192:195], v[188:191], v[84:87]
    v_rcp_f32_e64 v13, v13
    s_waitcnt lgkmcnt(0)
    s_barrier
    v_mfma_f32_16x16x32_bf16 v[16:19], v[212:215], v[204:207], v[16:19]
    ds_read_b128 v[160:163], v200 offset:0
    v_mfma_f32_16x16x32_bf16 v[20:23], v[212:215], v[208:211], v[20:23]
    ds_read_b128 v[164:167], v200 offset:2048
    v_rcp_f32_e64 v14, v14
    v_mfma_f32_16x16x32_bf16 v[24:27], v[216:219], v[204:207], v[24:27]
    ds_read_b128 v[168:171], v198 offset:0
    v_rcp_f32_e64 v15, v15
    v_mfma_f32_16x16x32_bf16 v[28:31], v[216:219], v[208:211], v[28:31]
    ds_read_b128 v[172:175], v198 offset:1024
    v_rcp_f32_e64 v252, v252
    v_mfma_f32_16x16x32_bf16 v[32:35], v[220:223], v[204:207], v[32:35]
    ds_read_b128 v[176:179], v198 offset:2048
    v_rcp_f32_e64 v253, v253
    v_mfma_f32_16x16x32_bf16 v[36:39], v[220:223], v[208:211], v[36:39]
    ds_read_b128 v[180:183], v198 offset:3072
    v_rcp_f32_e64 v254, v254
    v_mfma_f32_16x16x32_bf16 v[40:43], v[224:227], v[204:207], v[40:43]
    ds_read_b128 v[184:187], v8 offset:0
    v_rcp_f32_e64 v255, v255
    v_mfma_f32_16x16x32_bf16 v[44:47], v[224:227], v[208:211], v[44:47]
    ds_read_b128 v[188:191], v8 offset:2048
    v_mfma_f32_16x16x32_bf16 v[48:51], v[212:215], v[228:231], v[48:51]
    ds_read_b128 v[192:195], v1 offset:8192
    v_mul_f32_e64 v120, v120, v12
    v_mfma_f32_16x16x32_bf16 v[52:55], v[212:215], v[232:235], v[52:55]
    v_mul_f32 v121, v121, v13
    v_mul_f32 v122, v122, v14
    v_mfma_f32_16x16x32_bf16 v[56:59], v[216:219], v[228:231], v[56:59]
    v_mul_f32 v123, v123, v15
    v_mul_f32 v124, v124, v252
    v_mfma_f32_16x16x32_bf16 v[60:63], v[216:219], v[232:235], v[60:63]
    v_mul_f32 v125, v125, v253
    v_mul_f32 v126, v126, v254
    v_mfma_f32_16x16x32_bf16 v[64:67], v[220:223], v[228:231], v[64:67]
    v_mul_f32 v127, v127, v255
    v_mul_f32 v12, v128, v128
    v_mfma_f32_16x16x32_bf16 v[68:71], v[220:223], v[232:235], v[68:71]
    v_mul_f32 v13, v129, v129
    v_mul_f32 v14, v130, v130
    v_mfma_f32_16x16x32_bf16 v[72:75], v[224:227], v[228:231], v[72:75]
    v_mul_f32 v15, v131, v131
    v_mul_f32 v252, v132, v132
    v_mfma_f32_16x16x32_bf16 v[76:79], v[224:227], v[232:235], v[76:79]
    v_mul_f32 v253, v133, v133
    v_mul_f32 v254, v134, v134
    v_mfma_f32_16x16x32_bf16 v[80:83], v[236:239], v[228:231], v[80:83]
    v_mul_f32_e64 v255, v135, v135
    v_fma_f32 v12, v12, v5, v4
    v_mfma_f32_16x16x32_bf16 v[84:87], v[236:239], v[232:235], v[84:87]
    v_fma_f32 v13, v13, v5, v4
    s_waitcnt lgkmcnt(3)
    v_mfma_f32_16x16x32_bf16 v[16:19], v[168:171], v[160:163], v[16:19]
    ds_read_b128 v[204:207], v201 offset:0
    v_mfma_f32_16x16x32_bf16 v[20:23], v[168:171], v[164:167], v[20:23]
    ds_read_b128 v[208:211], v201 offset:2048
    v_fma_f32 v14, v14, v5, v4
    v_mfma_f32_16x16x32_bf16 v[24:27], v[172:175], v[160:163], v[24:27]
    ds_read_b128 v[212:215], v198 offset:9216
    v_fma_f32 v15, v15, v5, v4
    v_mfma_f32_16x16x32_bf16 v[28:31], v[172:175], v[164:167], v[28:31]
    ds_read_b128 v[216:219], v198 offset:10240
    v_fma_f32 v252, v252, v7, v6
    v_mfma_f32_16x16x32_bf16 v[32:35], v[176:179], v[160:163], v[32:35]
    ds_read_b128 v[220:223], v198 offset:11264
    v_fma_f32 v253, v253, v7, v6
    v_mfma_f32_16x16x32_bf16 v[36:39], v[176:179], v[164:167], v[36:39]
    ds_read_b128 v[224:227], v198 offset:12288
    v_fma_f32 v254, v254, v7, v6
    v_mfma_f32_16x16x32_bf16 v[40:43], v[180:183], v[160:163], v[40:43]
    ds_read_b128 v[228:231], v9 offset:0
    v_fma_f32 v255, v255, v7, v6
    v_mfma_f32_16x16x32_bf16 v[44:47], v[180:183], v[164:167], v[44:47]
    ds_read_b128 v[232:235], v9 offset:2048
    s_waitcnt lgkmcnt(8)
    v_mfma_f32_16x16x32_bf16 v[48:51], v[168:171], v[184:187], v[48:51]
    ds_read_b128 v[236:239], v1 offset:17408
    v_mul_f32_e64 v12, v12, v128
    v_mfma_f32_16x16x32_bf16 v[52:55], v[168:171], v[188:191], v[52:55]
    v_mul_f32 v13, v13, v129
    v_mul_f32 v14, v14, v130
    v_mfma_f32_16x16x32_bf16 v[56:59], v[172:175], v[184:187], v[56:59]
    v_mul_f32 v15, v15, v131
    v_mul_f32 v252, v252, v132
    v_mfma_f32_16x16x32_bf16 v[60:63], v[172:175], v[188:191], v[60:63]
    v_mul_f32 v253, v253, v133
    v_mul_f32 v254, v254, v134
    v_mfma_f32_16x16x32_bf16 v[64:67], v[176:179], v[184:187], v[64:67]
    v_mul_f32 v255, v255, v135
    v_exp_f32 v12, v12
    v_mfma_f32_16x16x32_bf16 v[68:71], v[176:179], v[188:191], v[68:71]
    v_exp_f32_e64 v13, v13
    v_mfma_f32_16x16x32_bf16 v[72:75], v[180:183], v[184:187], v[72:75]
    v_exp_f32_e64 v14, v14
    v_mfma_f32_16x16x32_bf16 v[76:79], v[180:183], v[188:191], v[76:79]
    v_exp_f32_e64 v15, v15
    v_mfma_f32_16x16x32_bf16 v[80:83], v[192:195], v[184:187], v[80:83]
    v_exp_f32_e64 v252, v252
    v_mfma_f32_16x16x32_bf16 v[84:87], v[192:195], v[188:191], v[84:87]
    v_exp_f32_e64 v253, v253
    s_waitcnt lgkmcnt(0)
    s_barrier
    v_mfma_f32_16x16x32_bf16 v[16:19], v[212:215], v[204:207], v[16:19]
    ds_read_b128 v[160:163], v200 offset:36864
    v_mfma_f32_16x16x32_bf16 v[20:23], v[212:215], v[208:211], v[20:23]
    ds_read_b128 v[164:167], v200 offset:38912
    v_exp_f32_e64 v254, v254
    v_mfma_f32_16x16x32_bf16 v[24:27], v[216:219], v[204:207], v[24:27]
    ds_read_b128 v[168:171], v198 offset:36864
    v_exp_f32_e64 v255, v255
    v_mfma_f32_16x16x32_bf16 v[28:31], v[216:219], v[208:211], v[28:31]
    ds_read_b128 v[172:175], v198 offset:37888
    v_fma_f32 v12, v12, v249, v249
    v_mfma_f32_16x16x32_bf16 v[32:35], v[220:223], v[204:207], v[32:35]
    ds_read_b128 v[176:179], v198 offset:38912
    v_fma_f32 v13, v13, v249, v249
    v_mfma_f32_16x16x32_bf16 v[36:39], v[220:223], v[208:211], v[36:39]
    ds_read_b128 v[180:183], v198 offset:39936
    v_fma_f32 v14, v14, v249, v249
    v_mfma_f32_16x16x32_bf16 v[40:43], v[224:227], v[204:207], v[40:43]
    ds_read_b128 v[184:187], v8 offset:36864
    v_fma_f32 v15, v15, v249, v249
    v_mfma_f32_16x16x32_bf16 v[44:47], v[224:227], v[208:211], v[44:47]
    ds_read_b128 v[188:191], v8 offset:38912
    v_mfma_f32_16x16x32_bf16 v[48:51], v[212:215], v[228:231], v[48:51]
    ds_read_b128 v[192:195], v1 offset:45056
    v_fma_f32 v252, v252, v251, v251
    v_mfma_f32_16x16x32_bf16 v[52:55], v[212:215], v[232:235], v[52:55]
    v_fma_f32 v253, v253, v251, v251
    v_fma_f32 v254, v254, v251, v251
    v_mfma_f32_16x16x32_bf16 v[56:59], v[216:219], v[228:231], v[56:59]
    v_fma_f32 v255, v255, v251, v251
    v_rcp_f32_e64 v12, v12
    v_mfma_f32_16x16x32_bf16 v[60:63], v[216:219], v[232:235], v[60:63]
    v_rcp_f32_e64 v13, v13
    v_mfma_f32_16x16x32_bf16 v[64:67], v[220:223], v[228:231], v[64:67]
    v_rcp_f32_e64 v14, v14
    v_mfma_f32_16x16x32_bf16 v[68:71], v[220:223], v[232:235], v[68:71]
    v_rcp_f32_e64 v15, v15
    v_mfma_f32_16x16x32_bf16 v[72:75], v[224:227], v[228:231], v[72:75]
    v_rcp_f32_e64 v252, v252
    v_mfma_f32_16x16x32_bf16 v[76:79], v[224:227], v[232:235], v[76:79]
    v_rcp_f32_e64 v253, v253
    v_mfma_f32_16x16x32_bf16 v[80:83], v[236:239], v[228:231], v[80:83]
    v_rcp_f32_e64 v254, v254
    v_mfma_f32_16x16x32_bf16 v[84:87], v[236:239], v[232:235], v[84:87]
    v_rcp_f32 v255, v255
    s_waitcnt lgkmcnt(3)
    v_mfma_f32_16x16x32_bf16 v[16:19], v[168:171], v[160:163], v[16:19]
    ds_read_b128 v[204:207], v201 offset:36864
    v_mfma_f32_16x16x32_bf16 v[20:23], v[168:171], v[164:167], v[20:23]
    ds_read_b128 v[208:211], v201 offset:38912
    v_mul_f32_e64 v128, v128, v12
    v_mfma_f32_16x16x32_bf16 v[24:27], v[172:175], v[160:163], v[24:27]
    ds_read_b128 v[212:215], v198 offset:46080
    v_mul_f32_e64 v129, v129, v13
    v_mfma_f32_16x16x32_bf16 v[28:31], v[172:175], v[164:167], v[28:31]
    ds_read_b128 v[216:219], v198 offset:47104
    v_mul_f32_e64 v130, v130, v14
    v_mfma_f32_16x16x32_bf16 v[32:35], v[176:179], v[160:163], v[32:35]
    ds_read_b128 v[220:223], v198 offset:48128
    v_mul_f32_e64 v131, v131, v15
    v_mfma_f32_16x16x32_bf16 v[36:39], v[176:179], v[164:167], v[36:39]
    ds_read_b128 v[224:227], v198 offset:49152
    v_mul_f32_e64 v132, v132, v252
    v_mfma_f32_16x16x32_bf16 v[40:43], v[180:183], v[160:163], v[40:43]
    ds_read_b128 v[228:231], v9 offset:36864
    v_mul_f32_e64 v133, v133, v253
    v_mfma_f32_16x16x32_bf16 v[44:47], v[180:183], v[164:167], v[44:47]
    ds_read_b128 v[232:235], v9 offset:38912
    s_waitcnt lgkmcnt(8)
    v_mfma_f32_16x16x32_bf16 v[48:51], v[168:171], v[184:187], v[48:51]
    ds_read_b128 v[236:239], v1 offset:54272
    v_mul_f32 v134, v134, v254
    v_mfma_f32_16x16x32_bf16 v[52:55], v[168:171], v[188:191], v[52:55]
    v_mul_f32 v135, v135, v255
    v_mul_f32 v12, v136, v136
    v_mfma_f32_16x16x32_bf16 v[56:59], v[172:175], v[184:187], v[56:59]
    v_mul_f32 v13, v137, v137
    v_mul_f32 v14, v138, v138
    v_mfma_f32_16x16x32_bf16 v[60:63], v[172:175], v[188:191], v[60:63]
    v_mul_f32 v15, v139, v139
    v_mul_f32 v252, v140, v140
    v_mfma_f32_16x16x32_bf16 v[64:67], v[176:179], v[184:187], v[64:67]
    v_mul_f32 v253, v141, v141
    v_mul_f32 v254, v142, v142
    v_mfma_f32_16x16x32_bf16 v[68:71], v[176:179], v[188:191], v[68:71]
    v_mul_f32_e64 v255, v143, v143
    v_fma_f32 v12, v12, v5, v4
    v_mfma_f32_16x16x32_bf16 v[72:75], v[180:183], v[184:187], v[72:75]
    v_fma_f32 v13, v13, v5, v4
    v_fma_f32 v14, v14, v5, v4
    v_mfma_f32_16x16x32_bf16 v[76:79], v[180:183], v[188:191], v[76:79]
    v_fma_f32 v15, v15, v5, v4
    v_fma_f32 v252, v252, v7, v6
    v_mfma_f32_16x16x32_bf16 v[80:83], v[192:195], v[184:187], v[80:83]
    v_fma_f32 v253, v253, v7, v6
    v_fma_f32 v254, v254, v7, v6
    v_mfma_f32_16x16x32_bf16 v[84:87], v[192:195], v[188:191], v[84:87]
    v_fma_f32 v255, v255, v7, v6
    s_waitcnt lgkmcnt(0)
    s_barrier
    v_mfma_f32_16x16x32_bf16 v[16:19], v[212:215], v[204:207], v[16:19]
    ds_read_b128 v[160:163], v202 offset:0
    v_mfma_f32_16x16x32_bf16 v[20:23], v[212:215], v[208:211], v[20:23]
    ds_read_b128 v[164:167], v202 offset:2048
    v_mul_f32_e64 v12, v12, v136
    v_mfma_f32_16x16x32_bf16 v[24:27], v[216:219], v[204:207], v[24:27]
    ds_read_b128 v[168:171], v199 offset:0
    v_mul_f32_e64 v13, v13, v137
    v_mfma_f32_16x16x32_bf16 v[28:31], v[216:219], v[208:211], v[28:31]
    ds_read_b128 v[172:175], v199 offset:1024
    v_mul_f32_e64 v14, v14, v138
    v_mfma_f32_16x16x32_bf16 v[32:35], v[220:223], v[204:207], v[32:35]
    ds_read_b128 v[176:179], v199 offset:2048
    v_mul_f32_e64 v15, v15, v139
    v_mfma_f32_16x16x32_bf16 v[36:39], v[220:223], v[208:211], v[36:39]
    ds_read_b128 v[180:183], v199 offset:3072
    v_mul_f32_e64 v252, v252, v140
    v_mfma_f32_16x16x32_bf16 v[40:43], v[224:227], v[204:207], v[40:43]
    ds_read_b128 v[184:187], v10 offset:0
    v_mul_f32_e64 v253, v253, v141
    v_mfma_f32_16x16x32_bf16 v[44:47], v[224:227], v[208:211], v[44:47]
    ds_read_b128 v[188:191], v10 offset:2048
    v_mfma_f32_16x16x32_bf16 v[48:51], v[212:215], v[228:231], v[48:51]
    ds_read_b128 v[192:195], v2 offset:8192
    v_mul_f32_e64 v254, v254, v142
    v_mfma_f32_16x16x32_bf16 v[52:55], v[212:215], v[232:235], v[52:55]
    v_mul_f32 v255, v255, v143
    v_exp_f32 v12, v12
    v_mfma_f32_16x16x32_bf16 v[56:59], v[216:219], v[228:231], v[56:59]
    v_exp_f32_e64 v13, v13
    v_mfma_f32_16x16x32_bf16 v[60:63], v[216:219], v[232:235], v[60:63]
    v_exp_f32_e64 v14, v14
    v_mfma_f32_16x16x32_bf16 v[64:67], v[220:223], v[228:231], v[64:67]
    v_exp_f32_e64 v15, v15
    v_mfma_f32_16x16x32_bf16 v[68:71], v[220:223], v[232:235], v[68:71]
    v_exp_f32_e64 v252, v252
    v_mfma_f32_16x16x32_bf16 v[72:75], v[224:227], v[228:231], v[72:75]
    v_exp_f32_e64 v253, v253
    v_mfma_f32_16x16x32_bf16 v[76:79], v[224:227], v[232:235], v[76:79]
    v_exp_f32_e64 v254, v254
    v_mfma_f32_16x16x32_bf16 v[80:83], v[236:239], v[228:231], v[80:83]
    v_exp_f32_e64 v255, v255
    v_mfma_f32_16x16x32_bf16 v[84:87], v[236:239], v[232:235], v[84:87]
    v_fma_f32 v12, v12, v249, v249
    s_waitcnt lgkmcnt(3)
    v_mfma_f32_16x16x32_bf16 v[16:19], v[168:171], v[160:163], v[16:19]
    ds_read_b128 v[204:207], v203 offset:0
    v_mfma_f32_16x16x32_bf16 v[20:23], v[168:171], v[164:167], v[20:23]
    ds_read_b128 v[208:211], v203 offset:2048
    v_fma_f32 v13, v13, v249, v249
    v_mfma_f32_16x16x32_bf16 v[24:27], v[172:175], v[160:163], v[24:27]
    ds_read_b128 v[212:215], v199 offset:9216
    v_fma_f32 v14, v14, v249, v249
    v_mfma_f32_16x16x32_bf16 v[28:31], v[172:175], v[164:167], v[28:31]
    ds_read_b128 v[216:219], v199 offset:10240
    v_fma_f32 v15, v15, v249, v249
    v_mfma_f32_16x16x32_bf16 v[32:35], v[176:179], v[160:163], v[32:35]
    ds_read_b128 v[220:223], v199 offset:11264
    v_fma_f32 v252, v252, v251, v251
    v_mfma_f32_16x16x32_bf16 v[36:39], v[176:179], v[164:167], v[36:39]
    ds_read_b128 v[224:227], v199 offset:12288
    v_fma_f32 v253, v253, v251, v251
    v_mfma_f32_16x16x32_bf16 v[40:43], v[180:183], v[160:163], v[40:43]
    ds_read_b128 v[228:231], v11 offset:0
    v_fma_f32 v254, v254, v251, v251
    v_mfma_f32_16x16x32_bf16 v[44:47], v[180:183], v[164:167], v[44:47]
    ds_read_b128 v[232:235], v11 offset:2048
    s_waitcnt lgkmcnt(8)
    v_mfma_f32_16x16x32_bf16 v[48:51], v[168:171], v[184:187], v[48:51]
    ds_read_b128 v[236:239], v2 offset:17408
    v_fma_f32 v255, v255, v251, v251
    v_mfma_f32_16x16x32_bf16 v[52:55], v[168:171], v[188:191], v[52:55]
    v_rcp_f32_e64 v12, v12
    v_mfma_f32_16x16x32_bf16 v[56:59], v[172:175], v[184:187], v[56:59]
    v_rcp_f32_e64 v13, v13
    v_mfma_f32_16x16x32_bf16 v[60:63], v[172:175], v[188:191], v[60:63]
    v_rcp_f32_e64 v14, v14
    v_mfma_f32_16x16x32_bf16 v[64:67], v[176:179], v[184:187], v[64:67]
    v_rcp_f32_e64 v15, v15
    v_mfma_f32_16x16x32_bf16 v[68:71], v[176:179], v[188:191], v[68:71]
    v_rcp_f32_e64 v252, v252
    v_mfma_f32_16x16x32_bf16 v[72:75], v[180:183], v[184:187], v[72:75]
    v_rcp_f32_e64 v253, v253
    v_mfma_f32_16x16x32_bf16 v[76:79], v[180:183], v[188:191], v[76:79]
    v_rcp_f32_e64 v254, v254
    v_mfma_f32_16x16x32_bf16 v[80:83], v[192:195], v[184:187], v[80:83]
    v_rcp_f32_e64 v255, v255
    v_mfma_f32_16x16x32_bf16 v[84:87], v[192:195], v[188:191], v[84:87]
    v_mul_f32_e64 v136, v136, v12
    s_waitcnt lgkmcnt(0)
    s_barrier
    v_mfma_f32_16x16x32_bf16 v[16:19], v[212:215], v[204:207], v[16:19]
    ds_read_b128 v[160:163], v202 offset:36864
    v_mfma_f32_16x16x32_bf16 v[20:23], v[212:215], v[208:211], v[20:23]
    ds_read_b128 v[164:167], v202 offset:38912
    v_mul_f32_e64 v137, v137, v13
    v_mfma_f32_16x16x32_bf16 v[24:27], v[216:219], v[204:207], v[24:27]
    ds_read_b128 v[168:171], v199 offset:36864
    v_mul_f32_e64 v138, v138, v14
    v_mfma_f32_16x16x32_bf16 v[28:31], v[216:219], v[208:211], v[28:31]
    ds_read_b128 v[172:175], v199 offset:37888
    v_mul_f32_e64 v139, v139, v15
    v_mfma_f32_16x16x32_bf16 v[32:35], v[220:223], v[204:207], v[32:35]
    ds_read_b128 v[176:179], v199 offset:38912
    v_mul_f32_e64 v140, v140, v252
    v_mfma_f32_16x16x32_bf16 v[36:39], v[220:223], v[208:211], v[36:39]
    ds_read_b128 v[180:183], v199 offset:39936
    v_mul_f32_e64 v141, v141, v253
    v_mfma_f32_16x16x32_bf16 v[40:43], v[224:227], v[204:207], v[40:43]
    ds_read_b128 v[184:187], v10 offset:36864
    v_mul_f32_e64 v142, v142, v254
    v_mfma_f32_16x16x32_bf16 v[44:47], v[224:227], v[208:211], v[44:47]
    ds_read_b128 v[188:191], v10 offset:38912
    v_mfma_f32_16x16x32_bf16 v[48:51], v[212:215], v[228:231], v[48:51]
    ds_read_b128 v[192:195], v2 offset:45056
    v_mul_f32_e64 v143, v143, v255
    v_mfma_f32_16x16x32_bf16 v[52:55], v[212:215], v[232:235], v[52:55]
    v_mul_f32 v12, v144, v144
    v_mul_f32 v13, v145, v145
    v_mfma_f32_16x16x32_bf16 v[56:59], v[216:219], v[228:231], v[56:59]
    v_mul_f32 v14, v146, v146
    v_mul_f32 v15, v147, v147
    v_mfma_f32_16x16x32_bf16 v[60:63], v[216:219], v[232:235], v[60:63]
    v_mul_f32 v252, v148, v148
    v_mul_f32 v253, v149, v149
    v_mfma_f32_16x16x32_bf16 v[64:67], v[220:223], v[228:231], v[64:67]
    v_mul_f32 v254, v150, v150
    v_mul_f32 v255, v151, v151
    v_mfma_f32_16x16x32_bf16 v[68:71], v[220:223], v[232:235], v[68:71]
    v_fma_f32 v12, v12, v5, v4
    v_fma_f32 v13, v13, v5, v4
    v_mfma_f32_16x16x32_bf16 v[72:75], v[224:227], v[228:231], v[72:75]
    v_fma_f32 v14, v14, v5, v4
    v_fma_f32 v15, v15, v5, v4
    v_mfma_f32_16x16x32_bf16 v[76:79], v[224:227], v[232:235], v[76:79]
    v_fma_f32 v252, v252, v7, v6
    v_fma_f32 v253, v253, v7, v6
    v_mfma_f32_16x16x32_bf16 v[80:83], v[236:239], v[228:231], v[80:83]
    v_fma_f32 v254, v254, v7, v6
    v_fma_f32 v255, v255, v7, v6
    v_mfma_f32_16x16x32_bf16 v[84:87], v[236:239], v[232:235], v[84:87]
    v_mul_f32 v12, v12, v144
    s_waitcnt lgkmcnt(3)
    v_mfma_f32_16x16x32_bf16 v[16:19], v[168:171], v[160:163], v[16:19]
    ds_read_b128 v[204:207], v203 offset:36864
    v_mfma_f32_16x16x32_bf16 v[20:23], v[168:171], v[164:167], v[20:23]
    ds_read_b128 v[208:211], v203 offset:38912
    v_mul_f32_e64 v13, v13, v145
    v_mfma_f32_16x16x32_bf16 v[24:27], v[172:175], v[160:163], v[24:27]
    ds_read_b128 v[212:215], v199 offset:46080
    v_mul_f32_e64 v14, v14, v146
    v_mfma_f32_16x16x32_bf16 v[28:31], v[172:175], v[164:167], v[28:31]
    ds_read_b128 v[216:219], v199 offset:47104
    v_mul_f32_e64 v15, v15, v147
    v_mfma_f32_16x16x32_bf16 v[32:35], v[176:179], v[160:163], v[32:35]
    ds_read_b128 v[220:223], v199 offset:48128
    v_mul_f32_e64 v252, v252, v148
    v_mfma_f32_16x16x32_bf16 v[36:39], v[176:179], v[164:167], v[36:39]
    ds_read_b128 v[224:227], v199 offset:49152
    v_mul_f32_e64 v253, v253, v149
    v_mfma_f32_16x16x32_bf16 v[40:43], v[180:183], v[160:163], v[40:43]
    ds_read_b128 v[228:231], v11 offset:36864
    v_mul_f32_e64 v254, v254, v150
    v_mfma_f32_16x16x32_bf16 v[44:47], v[180:183], v[164:167], v[44:47]
    ds_read_b128 v[232:235], v11 offset:38912
    s_waitcnt lgkmcnt(8)
    v_mfma_f32_16x16x32_bf16 v[48:51], v[168:171], v[184:187], v[48:51]
    ds_read_b128 v[236:239], v2 offset:54272
    v_mul_f32 v255, v255, v151
    v_mfma_f32_16x16x32_bf16 v[52:55], v[168:171], v[188:191], v[52:55]
    v_exp_f32_e64 v12, v12
    v_mfma_f32_16x16x32_bf16 v[56:59], v[172:175], v[184:187], v[56:59]
    v_exp_f32_e64 v13, v13
    v_mfma_f32_16x16x32_bf16 v[60:63], v[172:175], v[188:191], v[60:63]
    v_exp_f32_e64 v14, v14
    v_mfma_f32_16x16x32_bf16 v[64:67], v[176:179], v[184:187], v[64:67]
    v_exp_f32_e64 v15, v15
    v_mfma_f32_16x16x32_bf16 v[68:71], v[176:179], v[188:191], v[68:71]
    v_exp_f32_e64 v252, v252
    v_mfma_f32_16x16x32_bf16 v[72:75], v[180:183], v[184:187], v[72:75]
    v_exp_f32_e64 v253, v253
    v_mfma_f32_16x16x32_bf16 v[76:79], v[180:183], v[188:191], v[76:79]
    v_exp_f32_e64 v254, v254
    v_mfma_f32_16x16x32_bf16 v[80:83], v[192:195], v[184:187], v[80:83]
    v_exp_f32_e64 v255, v255
    v_mfma_f32_16x16x32_bf16 v[84:87], v[192:195], v[188:191], v[84:87]
    v_fma_f32 v12, v12, v249, v249
    s_waitcnt lgkmcnt(0)
    s_barrier
    v_mfma_f32_16x16x32_bf16 v[16:19], v[212:215], v[204:207], v[16:19]
    ds_read_b128 v[160:163], v200 offset:0
    v_mfma_f32_16x16x32_bf16 v[20:23], v[212:215], v[208:211], v[20:23]
    ds_read_b128 v[164:167], v200 offset:2048
    v_fma_f32 v13, v13, v249, v249
    v_mfma_f32_16x16x32_bf16 v[24:27], v[216:219], v[204:207], v[24:27]
    ds_read_b128 v[168:171], v198 offset:0
    v_fma_f32 v14, v14, v249, v249
    v_mfma_f32_16x16x32_bf16 v[28:31], v[216:219], v[208:211], v[28:31]
    ds_read_b128 v[172:175], v198 offset:1024
    v_fma_f32 v15, v15, v249, v249
    v_mfma_f32_16x16x32_bf16 v[32:35], v[220:223], v[204:207], v[32:35]
    ds_read_b128 v[176:179], v198 offset:2048
    v_fma_f32 v252, v252, v251, v251
    v_mfma_f32_16x16x32_bf16 v[36:39], v[220:223], v[208:211], v[36:39]
    ds_read_b128 v[180:183], v198 offset:3072
    v_fma_f32 v253, v253, v251, v251
    v_mfma_f32_16x16x32_bf16 v[40:43], v[224:227], v[204:207], v[40:43]
    ds_read_b128 v[184:187], v8 offset:0
    v_fma_f32 v254, v254, v251, v251
    v_mfma_f32_16x16x32_bf16 v[44:47], v[224:227], v[208:211], v[44:47]
    ds_read_b128 v[188:191], v8 offset:2048
    v_mfma_f32_16x16x32_bf16 v[48:51], v[212:215], v[228:231], v[48:51]
    ds_read_b128 v[192:195], v1 offset:8192
    v_fma_f32 v255, v255, v251, v251
    v_mfma_f32_16x16x32_bf16 v[52:55], v[212:215], v[232:235], v[52:55]
    v_rcp_f32_e64 v12, v12
    v_mfma_f32_16x16x32_bf16 v[56:59], v[216:219], v[228:231], v[56:59]
    v_rcp_f32_e64 v13, v13
    v_mfma_f32_16x16x32_bf16 v[60:63], v[216:219], v[232:235], v[60:63]
    v_rcp_f32_e64 v14, v14
    v_mfma_f32_16x16x32_bf16 v[64:67], v[220:223], v[228:231], v[64:67]
    v_rcp_f32_e64 v15, v15
    v_mfma_f32_16x16x32_bf16 v[68:71], v[220:223], v[232:235], v[68:71]
    v_rcp_f32_e64 v252, v252
    v_mfma_f32_16x16x32_bf16 v[72:75], v[224:227], v[228:231], v[72:75]
    v_rcp_f32_e64 v253, v253
    v_mfma_f32_16x16x32_bf16 v[76:79], v[224:227], v[232:235], v[76:79]
    v_rcp_f32_e64 v254, v254
    v_mfma_f32_16x16x32_bf16 v[80:83], v[236:239], v[228:231], v[80:83]
    v_rcp_f32_e64 v255, v255
    v_mfma_f32_16x16x32_bf16 v[84:87], v[236:239], v[232:235], v[84:87]
    v_mul_f32 v144, v144, v12
    s_waitcnt lgkmcnt(3)
    v_mfma_f32_16x16x32_bf16 v[16:19], v[168:171], v[160:163], v[16:19]
    ds_read_b128 v[204:207], v201 offset:0
    v_mfma_f32_16x16x32_bf16 v[20:23], v[168:171], v[164:167], v[20:23]
    ds_read_b128 v[208:211], v201 offset:2048
    v_mul_f32_e64 v145, v145, v13
    v_mfma_f32_16x16x32_bf16 v[24:27], v[172:175], v[160:163], v[24:27]
    ds_read_b128 v[212:215], v198 offset:9216
    v_mul_f32_e64 v146, v146, v14
    v_mfma_f32_16x16x32_bf16 v[28:31], v[172:175], v[164:167], v[28:31]
    ds_read_b128 v[216:219], v198 offset:10240
    v_mul_f32_e64 v147, v147, v15
    v_mfma_f32_16x16x32_bf16 v[32:35], v[176:179], v[160:163], v[32:35]
    ds_read_b128 v[220:223], v198 offset:11264
    v_mul_f32_e64 v148, v148, v252
    v_mfma_f32_16x16x32_bf16 v[36:39], v[176:179], v[164:167], v[36:39]
    ds_read_b128 v[224:227], v198 offset:12288
    v_mul_f32_e64 v149, v149, v253
    v_mfma_f32_16x16x32_bf16 v[40:43], v[180:183], v[160:163], v[40:43]
    ds_read_b128 v[228:231], v9 offset:0
    v_mul_f32_e64 v150, v150, v254
    v_mfma_f32_16x16x32_bf16 v[44:47], v[180:183], v[164:167], v[44:47]
    ds_read_b128 v[232:235], v9 offset:2048
    s_waitcnt lgkmcnt(8)
    v_mfma_f32_16x16x32_bf16 v[48:51], v[168:171], v[184:187], v[48:51]
    ds_read_b128 v[236:239], v1 offset:17408
    v_mul_f32 v151, v151, v255
    v_mfma_f32_16x16x32_bf16 v[52:55], v[168:171], v[188:191], v[52:55]
    v_mul_f32 v12, v152, v152
    v_mul_f32 v13, v153, v153
    v_mfma_f32_16x16x32_bf16 v[56:59], v[172:175], v[184:187], v[56:59]
    v_mul_f32 v14, v154, v154
    v_mul_f32 v15, v155, v155
    v_mfma_f32_16x16x32_bf16 v[60:63], v[172:175], v[188:191], v[60:63]
    v_mul_f32 v252, v156, v156
    v_mul_f32 v253, v157, v157
    v_mfma_f32_16x16x32_bf16 v[64:67], v[176:179], v[184:187], v[64:67]
    v_mul_f32 v254, v158, v158
    v_mul_f32 v255, v159, v159
    v_mfma_f32_16x16x32_bf16 v[68:71], v[176:179], v[188:191], v[68:71]
    v_fma_f32 v12, v12, v5, v4
    v_fma_f32 v13, v13, v5, v4
    v_mfma_f32_16x16x32_bf16 v[72:75], v[180:183], v[184:187], v[72:75]
    v_fma_f32 v14, v14, v5, v4
    v_fma_f32 v15, v15, v5, v4
    v_mfma_f32_16x16x32_bf16 v[76:79], v[180:183], v[188:191], v[76:79]
    v_fma_f32 v252, v252, v7, v6
    v_fma_f32 v253, v253, v7, v6
    v_mfma_f32_16x16x32_bf16 v[80:83], v[192:195], v[184:187], v[80:83]
    v_fma_f32 v254, v254, v7, v6
    v_fma_f32 v255, v255, v7, v6
    v_mfma_f32_16x16x32_bf16 v[84:87], v[192:195], v[188:191], v[84:87]
    v_mul_f32_e64 v12, v12, v152
    s_waitcnt lgkmcnt(0)
    s_barrier
    v_mfma_f32_16x16x32_bf16 v[16:19], v[212:215], v[204:207], v[16:19]
    ds_read_b128 v[160:163], v200 offset:36864
    v_mfma_f32_16x16x32_bf16 v[20:23], v[212:215], v[208:211], v[20:23]
    ds_read_b128 v[164:167], v200 offset:38912
    v_mul_f32_e64 v13, v13, v153
    v_mfma_f32_16x16x32_bf16 v[24:27], v[216:219], v[204:207], v[24:27]
    ds_read_b128 v[168:171], v198 offset:36864
    v_mul_f32_e64 v14, v14, v154
    v_mfma_f32_16x16x32_bf16 v[28:31], v[216:219], v[208:211], v[28:31]
    ds_read_b128 v[172:175], v198 offset:37888
    v_mul_f32_e64 v15, v15, v155
    v_mfma_f32_16x16x32_bf16 v[32:35], v[220:223], v[204:207], v[32:35]
    ds_read_b128 v[176:179], v198 offset:38912
    v_mul_f32_e64 v252, v252, v156
    v_mfma_f32_16x16x32_bf16 v[36:39], v[220:223], v[208:211], v[36:39]
    ds_read_b128 v[180:183], v198 offset:39936
    v_mul_f32_e64 v253, v253, v157
    v_mfma_f32_16x16x32_bf16 v[40:43], v[224:227], v[204:207], v[40:43]
    ds_read_b128 v[184:187], v8 offset:36864
    v_mul_f32_e64 v254, v254, v158
    v_mfma_f32_16x16x32_bf16 v[44:47], v[224:227], v[208:211], v[44:47]
    ds_read_b128 v[188:191], v8 offset:38912
    v_mfma_f32_16x16x32_bf16 v[48:51], v[212:215], v[228:231], v[48:51]
    ds_read_b128 v[192:195], v1 offset:45056
    v_mul_f32_e64 v255, v255, v159
    v_mfma_f32_16x16x32_bf16 v[52:55], v[212:215], v[232:235], v[52:55]
    v_exp_f32_e64 v12, v12
    v_mfma_f32_16x16x32_bf16 v[56:59], v[216:219], v[228:231], v[56:59]
    v_exp_f32_e64 v13, v13
    v_mfma_f32_16x16x32_bf16 v[60:63], v[216:219], v[232:235], v[60:63]
    v_exp_f32_e64 v14, v14
    v_mfma_f32_16x16x32_bf16 v[64:67], v[220:223], v[228:231], v[64:67]
    v_exp_f32_e64 v15, v15
    v_mfma_f32_16x16x32_bf16 v[68:71], v[220:223], v[232:235], v[68:71]
    v_exp_f32_e64 v252, v252
    v_mfma_f32_16x16x32_bf16 v[72:75], v[224:227], v[228:231], v[72:75]
    v_exp_f32_e64 v253, v253
    v_mfma_f32_16x16x32_bf16 v[76:79], v[224:227], v[232:235], v[76:79]
    v_exp_f32_e64 v254, v254
    v_mfma_f32_16x16x32_bf16 v[80:83], v[236:239], v[228:231], v[80:83]
    v_exp_f32_e64 v255, v255
    v_mfma_f32_16x16x32_bf16 v[84:87], v[236:239], v[232:235], v[84:87]
    v_fma_f32 v12, v12, v249, v249
    s_waitcnt lgkmcnt(3)
    v_mfma_f32_16x16x32_bf16 v[16:19], v[168:171], v[160:163], v[16:19]
    ds_read_b128 v[204:207], v201 offset:36864
    v_mfma_f32_16x16x32_bf16 v[20:23], v[168:171], v[164:167], v[20:23]
    ds_read_b128 v[208:211], v201 offset:38912
    v_fma_f32 v13, v13, v249, v249
    v_mfma_f32_16x16x32_bf16 v[24:27], v[172:175], v[160:163], v[24:27]
    ds_read_b128 v[212:215], v198 offset:46080
    v_fma_f32 v14, v14, v249, v249
    v_mfma_f32_16x16x32_bf16 v[28:31], v[172:175], v[164:167], v[28:31]
    ds_read_b128 v[216:219], v198 offset:47104
    v_fma_f32 v15, v15, v249, v249
    v_mfma_f32_16x16x32_bf16 v[32:35], v[176:179], v[160:163], v[32:35]
    ds_read_b128 v[220:223], v198 offset:48128
    v_fma_f32 v252, v252, v251, v251
    v_mfma_f32_16x16x32_bf16 v[36:39], v[176:179], v[164:167], v[36:39]
    ds_read_b128 v[224:227], v198 offset:49152
    v_fma_f32 v253, v253, v251, v251
    v_mfma_f32_16x16x32_bf16 v[40:43], v[180:183], v[160:163], v[40:43]
    ds_read_b128 v[228:231], v9 offset:36864
    v_fma_f32 v254, v254, v251, v251
    v_mfma_f32_16x16x32_bf16 v[44:47], v[180:183], v[164:167], v[44:47]
    ds_read_b128 v[232:235], v9 offset:38912
    s_waitcnt lgkmcnt(8)
    v_mfma_f32_16x16x32_bf16 v[48:51], v[168:171], v[184:187], v[48:51]
    ds_read_b128 v[236:239], v1 offset:54272
    v_fma_f32 v255, v255, v251, v251
    v_mfma_f32_16x16x32_bf16 v[52:55], v[168:171], v[188:191], v[52:55]
    v_rcp_f32_e64 v12, v12
    v_mfma_f32_16x16x32_bf16 v[56:59], v[172:175], v[184:187], v[56:59]
    v_rcp_f32_e64 v13, v13
    v_mfma_f32_16x16x32_bf16 v[60:63], v[172:175], v[188:191], v[60:63]
    v_rcp_f32_e64 v14, v14
    v_mfma_f32_16x16x32_bf16 v[64:67], v[176:179], v[184:187], v[64:67]
    v_rcp_f32_e64 v15, v15
    v_mfma_f32_16x16x32_bf16 v[68:71], v[176:179], v[188:191], v[68:71]
    v_rcp_f32_e64 v252, v252
    v_mfma_f32_16x16x32_bf16 v[72:75], v[180:183], v[184:187], v[72:75]
    v_rcp_f32_e64 v253, v253
    v_mfma_f32_16x16x32_bf16 v[76:79], v[180:183], v[188:191], v[76:79]
    v_rcp_f32_e64 v254, v254
    v_mfma_f32_16x16x32_bf16 v[80:83], v[192:195], v[184:187], v[80:83]
    v_rcp_f32_e64 v255, v255
    v_mfma_f32_16x16x32_bf16 v[84:87], v[192:195], v[188:191], v[84:87]
    v_mul_f32_e64 v152, v152, v12
    s_waitcnt lgkmcnt(0)
    s_barrier
    v_mfma_f32_16x16x32_bf16 v[16:19], v[212:215], v[204:207], v[16:19]
    ds_read_b128 v[160:163], v202 offset:0
    v_mfma_f32_16x16x32_bf16 v[20:23], v[212:215], v[208:211], v[20:23]
    ds_read_b128 v[164:167], v202 offset:2048
    v_mul_f32_e64 v153, v153, v13
    v_mfma_f32_16x16x32_bf16 v[24:27], v[216:219], v[204:207], v[24:27]
    ds_read_b128 v[168:171], v199 offset:0
    v_mul_f32_e64 v154, v154, v14
    v_mfma_f32_16x16x32_bf16 v[28:31], v[216:219], v[208:211], v[28:31]
    ds_read_b128 v[172:175], v199 offset:1024
    v_mul_f32_e64 v155, v155, v15
    v_mfma_f32_16x16x32_bf16 v[32:35], v[220:223], v[204:207], v[32:35]
    ds_read_b128 v[176:179], v199 offset:2048
    v_mul_f32_e64 v156, v156, v252
    v_mfma_f32_16x16x32_bf16 v[36:39], v[220:223], v[208:211], v[36:39]
    ds_read_b128 v[180:183], v199 offset:3072
    v_mul_f32_e64 v157, v157, v253
    v_mfma_f32_16x16x32_bf16 v[40:43], v[224:227], v[204:207], v[40:43]
    ds_read_b128 v[184:187], v10 offset:0
    v_mul_f32_e64 v158, v158, v254
    v_mfma_f32_16x16x32_bf16 v[44:47], v[224:227], v[208:211], v[44:47]
    ds_read_b128 v[188:191], v10 offset:2048
    v_mfma_f32_16x16x32_bf16 v[48:51], v[212:215], v[228:231], v[48:51]
    ds_read_b128 v[192:195], v2 offset:8192
    v_mul_f32_e64 v159, v159, v255
    v_mfma_f32_16x16x32_bf16 v[52:55], v[212:215], v[232:235], v[52:55]
    s_mul_i32 s39, s31, 73728
    s_add_u32 s39, s39, s21
    v_mfma_f32_16x16x32_bf16 v[56:59], v[216:219], v[228:231], v[56:59]
    s_add_u32 s39, s39, 0x1200000
    s_add_u32 s40, s39, 73728
    v_mfma_f32_16x16x32_bf16 v[60:63], v[216:219], v[232:235], v[60:63]
    s_mul_i32 s36, s47, 36
    s_add_u32 s36, s36, s39
    v_mfma_f32_16x16x32_bf16 v[64:67], v[220:223], v[228:231], v[64:67]
    s_add_u32 s37, s36, 73728
    s_lshl_b32 s34, s24, 10
    v_mfma_f32_16x16x32_bf16 v[68:71], v[220:223], v[232:235], v[68:71]
    s_lshl_b32 s33, s48, 3
    s_add_u32 s34, s34, s33
    v_mfma_f32_16x16x32_bf16 v[72:75], v[224:227], v[228:231], v[72:75]
    v_add_u32_e64 v13, s34, v1
    v_add_u32 v14, 16384, v13
    v_mfma_f32_16x16x32_bf16 v[76:79], v[224:227], v[232:235], v[76:79]
    s_lshr_b32 s35, s24, 1
    s_lshl_b32 s35, s35, 10
    v_mfma_f32_16x16x32_bf16 v[80:83], v[236:239], v[228:231], v[80:83]
    s_and_b32 s33, s24, 1
    s_mul_i32 s33, s33, 73728
    v_mfma_f32_16x16x32_bf16 v[84:87], v[236:239], v[232:235], v[84:87]
    s_add_u32 s35, s35, s33
    s_add_u32 s35, s35, 65536
    v_add_u32_e64 v15, s35, v1
    s_mov_b32 s41, 5
L_g_loop:
    s_waitcnt lgkmcnt(3)
    v_mfma_f32_16x16x32_bf16 v[16:19], v[168:171], v[160:163], v[16:19]
    ds_read_b128 v[204:207], v203 offset:0
    v_mfma_f32_16x16x32_bf16 v[20:23], v[168:171], v[164:167], v[20:23]
    ds_read_b128 v[208:211], v203 offset:2048
    v_mfma_f32_16x16x32_bf16 v[24:27], v[172:175], v[160:163], v[24:27]
    ds_read_b128 v[212:215], v199 offset:9216
    v_mfma_f32_16x16x32_bf16 v[28:31], v[172:175], v[164:167], v[28:31]
    ds_read_b128 v[216:219], v199 offset:10240
    v_mfma_f32_16x16x32_bf16 v[32:35], v[176:179], v[160:163], v[32:35]
    ds_read_b128 v[220:223], v199 offset:11264
    v_mfma_f32_16x16x32_bf16 v[36:39], v[176:179], v[164:167], v[36:39]
    ds_read_b128 v[224:227], v199 offset:12288
    v_mfma_f32_16x16x32_bf16 v[40:43], v[180:183], v[160:163], v[40:43]
    ds_read_b128 v[228:231], v11 offset:0
    v_mfma_f32_16x16x32_bf16 v[44:47], v[180:183], v[164:167], v[44:47]
    ds_read_b128 v[232:235], v11 offset:2048
    s_waitcnt lgkmcnt(8)
    v_mfma_f32_16x16x32_bf16 v[48:51], v[168:171], v[184:187], v[48:51]
    ds_read_b128 v[236:239], v2 offset:17408
    v_mfma_f32_16x16x32_bf16 v[52:55], v[168:171], v[188:191], v[52:55]
    v_mfma_f32_16x16x32_bf16 v[56:59], v[172:175], v[184:187], v[56:59]
    v_mfma_f32_16x16x32_bf16 v[60:63], v[172:175], v[188:191], v[60:63]
    v_mfma_f32_16x16x32_bf16 v[64:67], v[176:179], v[184:187], v[64:67]
    v_mfma_f32_16x16x32_bf16 v[68:71], v[176:179], v[188:191], v[68:71]
    v_mfma_f32_16x16x32_bf16 v[72:75], v[180:183], v[184:187], v[72:75]
    v_mfma_f32_16x16x32_bf16 v[76:79], v[180:183], v[188:191], v[76:79]
    v_mfma_f32_16x16x32_bf16 v[80:83], v[192:195], v[184:187], v[80:83]
    v_mfma_f32_16x16x32_bf16 v[84:87], v[192:195], v[188:191], v[84:87]
    s_waitcnt lgkmcnt(0)
    s_barrier
    v_mfma_f32_16x16x32_bf16 v[16:19], v[212:215], v[204:207], v[16:19]
    ds_read_b128 v[160:163], v202 offset:36864
    v_mfma_f32_16x16x32_bf16 v[20:23], v[212:215], v[208:211], v[20:23]
    ds_read_b128 v[164:167], v202 offset:38912
    v_mfma_f32_16x16x32_bf16 v[24:27], v[216:219], v[204:207], v[24:27]
    ds_read_b128 v[168:171], v199 offset:36864
    v_mfma_f32_16x16x32_bf16 v[28:31], v[216:219], v[208:211], v[28:31]
    ds_read_b128 v[172:175], v199 offset:37888
    v_mfma_f32_16x16x32_bf16 v[32:35], v[220:223], v[204:207], v[32:35]
    ds_read_b128 v[176:179], v199 offset:38912
    v_mfma_f32_16x16x32_bf16 v[36:39], v[220:223], v[208:211], v[36:39]
    ds_read_b128 v[180:183], v199 offset:39936
    v_mfma_f32_16x16x32_bf16 v[40:43], v[224:227], v[204:207], v[40:43]
    ds_read_b128 v[184:187], v10 offset:36864
    v_mfma_f32_16x16x32_bf16 v[44:47], v[224:227], v[208:211], v[44:47]
    ds_read_b128 v[188:191], v10 offset:38912
    v_mfma_f32_16x16x32_bf16 v[48:51], v[212:215], v[228:231], v[48:51]
    ds_read_b128 v[192:195], v2 offset:45056
    v_mfma_f32_16x16x32_bf16 v[52:55], v[212:215], v[232:235], v[52:55]
    v_mfma_f32_16x16x32_bf16 v[56:59], v[216:219], v[228:231], v[56:59]
    v_mfma_f32_16x16x32_bf16 v[60:63], v[216:219], v[232:235], v[60:63]
    v_mfma_f32_16x16x32_bf16 v[64:67], v[220:223], v[228:231], v[64:67]
    v_mfma_f32_16x16x32_bf16 v[68:71], v[220:223], v[232:235], v[68:71]
    v_mfma_f32_16x16x32_bf16 v[72:75], v[224:227], v[228:231], v[72:75]
    v_mfma_f32_16x16x32_bf16 v[76:79], v[224:227], v[232:235], v[76:79]
    v_mfma_f32_16x16x32_bf16 v[80:83], v[236:239], v[228:231], v[80:83]
    v_mfma_f32_16x16x32_bf16 v[84:87], v[236:239], v[232:235], v[84:87]
    s_waitcnt lgkmcnt(3)
    v_mfma_f32_16x16x32_bf16 v[16:19], v[168:171], v[160:163], v[16:19]
    ds_read_b128 v[204:207], v203 offset:36864
    v_mfma_f32_16x16x32_bf16 v[20:23], v[168:171], v[164:167], v[20:23]
    ds_read_b128 v[208:211], v203 offset:38912
    v_mfma_f32_16x16x32_bf16 v[24:27], v[172:175], v[160:163], v[24:27]
    ds_read_b128 v[212:215], v199 offset:46080
    v_mfma_f32_16x16x32_bf16 v[28:31], v[172:175], v[164:167], v[28:31]
    ds_read_b128 v[216:219], v199 offset:47104
    v_mfma_f32_16x16x32_bf16 v[32:35], v[176:179], v[160:163], v[32:35]
    ds_read_b128 v[220:223], v199 offset:48128
    v_mfma_f32_16x16x32_bf16 v[36:39], v[176:179], v[164:167], v[36:39]
    ds_read_b128 v[224:227], v199 offset:49152
    v_mfma_f32_16x16x32_bf16 v[40:43], v[180:183], v[160:163], v[40:43]
    ds_read_b128 v[228:231], v11 offset:36864
    v_mfma_f32_16x16x32_bf16 v[44:47], v[180:183], v[164:167], v[44:47]
    ds_read_b128 v[232:235], v11 offset:38912
    s_waitcnt lgkmcnt(8)
    v_mfma_f32_16x16x32_bf16 v[48:51], v[168:171], v[184:187], v[48:51]
    ds_read_b128 v[236:239], v2 offset:54272
    v_mfma_f32_16x16x32_bf16 v[52:55], v[168:171], v[188:191], v[52:55]
    v_mfma_f32_16x16x32_bf16 v[56:59], v[172:175], v[184:187], v[56:59]
    v_mfma_f32_16x16x32_bf16 v[60:63], v[172:175], v[188:191], v[60:63]
    v_mfma_f32_16x16x32_bf16 v[64:67], v[176:179], v[184:187], v[64:67]
    v_mfma_f32_16x16x32_bf16 v[68:71], v[176:179], v[188:191], v[68:71]
    v_mfma_f32_16x16x32_bf16 v[72:75], v[180:183], v[184:187], v[72:75]
    v_mfma_f32_16x16x32_bf16 v[76:79], v[180:183], v[188:191], v[76:79]
    v_mfma_f32_16x16x32_bf16 v[80:83], v[192:195], v[184:187], v[80:83]
    v_mfma_f32_16x16x32_bf16 v[84:87], v[192:195], v[188:191], v[84:87]
    s_waitcnt lgkmcnt(0)
    s_barrier
    v_mfma_f32_16x16x32_bf16 v[16:19], v[212:215], v[204:207], v[16:19]
    ds_read_b128 v[160:163], v200 offset:0
    v_mfma_f32_16x16x32_bf16 v[20:23], v[212:215], v[208:211], v[20:23]
    ds_read_b128 v[164:167], v200 offset:2048
    v_mfma_f32_16x16x32_bf16 v[24:27], v[216:219], v[204:207], v[24:27]
    ds_read_b128 v[168:171], v198 offset:0
    v_mfma_f32_16x16x32_bf16 v[28:31], v[216:219], v[208:211], v[28:31]
    ds_read_b128 v[172:175], v198 offset:1024
    v_mfma_f32_16x16x32_bf16 v[32:35], v[220:223], v[204:207], v[32:35]
    ds_read_b128 v[176:179], v198 offset:2048
    v_mfma_f32_16x16x32_bf16 v[36:39], v[220:223], v[208:211], v[36:39]
    ds_read_b128 v[180:183], v198 offset:3072
    v_mfma_f32_16x16x32_bf16 v[40:43], v[224:227], v[204:207], v[40:43]
    ds_read_b128 v[184:187], v8 offset:0
    v_mfma_f32_16x16x32_bf16 v[44:47], v[224:227], v[208:211], v[44:47]
    ds_read_b128 v[188:191], v8 offset:2048
    v_mfma_f32_16x16x32_bf16 v[48:51], v[212:215], v[228:231], v[48:51]
    ds_read_b128 v[192:195], v1 offset:8192
    v_mfma_f32_16x16x32_bf16 v[52:55], v[212:215], v[232:235], v[52:55]
    v_mfma_f32_16x16x32_bf16 v[56:59], v[216:219], v[228:231], v[56:59]
    v_mfma_f32_16x16x32_bf16 v[60:63], v[216:219], v[232:235], v[60:63]
    v_mfma_f32_16x16x32_bf16 v[64:67], v[220:223], v[228:231], v[64:67]
    v_mfma_f32_16x16x32_bf16 v[68:71], v[220:223], v[232:235], v[68:71]
    v_mfma_f32_16x16x32_bf16 v[72:75], v[224:227], v[228:231], v[72:75]
    v_mfma_f32_16x16x32_bf16 v[76:79], v[224:227], v[232:235], v[76:79]
    v_mfma_f32_16x16x32_bf16 v[80:83], v[236:239], v[228:231], v[80:83]
    v_mfma_f32_16x16x32_bf16 v[84:87], v[236:239], v[232:235], v[84:87]
    s_waitcnt lgkmcnt(3)
    v_mfma_f32_16x16x32_bf16 v[16:19], v[168:171], v[160:163], v[16:19]
    ds_read_b128 v[204:207], v201 offset:0
    v_mfma_f32_16x16x32_bf16 v[20:23], v[168:171], v[164:167], v[20:23]
    ds_read_b128 v[208:211], v201 offset:2048
    v_mfma_f32_16x16x32_bf16 v[24:27], v[172:175], v[160:163], v[24:27]
    ds_read_b128 v[212:215], v198 offset:9216
    v_mfma_f32_16x16x32_bf16 v[28:31], v[172:175], v[164:167], v[28:31]
    ds_read_b128 v[216:219], v198 offset:10240
    v_mfma_f32_16x16x32_bf16 v[32:35], v[176:179], v[160:163], v[32:35]
    ds_read_b128 v[220:223], v198 offset:11264
    v_mfma_f32_16x16x32_bf16 v[36:39], v[176:179], v[164:167], v[36:39]
    ds_read_b128 v[224:227], v198 offset:12288
    v_mfma_f32_16x16x32_bf16 v[40:43], v[180:183], v[160:163], v[40:43]
    ds_read_b128 v[228:231], v9 offset:0
    v_mfma_f32_16x16x32_bf16 v[44:47], v[180:183], v[164:167], v[44:47]
    ds_read_b128 v[232:235], v9 offset:2048
    s_waitcnt lgkmcnt(8)
    v_mfma_f32_16x16x32_bf16 v[48:51], v[168:171], v[184:187], v[48:51]
    ds_read_b128 v[236:239], v1 offset:17408
    v_mfma_f32_16x16x32_bf16 v[52:55], v[168:171], v[188:191], v[52:55]
    v_mfma_f32_16x16x32_bf16 v[56:59], v[172:175], v[184:187], v[56:59]
    v_mfma_f32_16x16x32_bf16 v[60:63], v[172:175], v[188:191], v[60:63]
    v_mfma_f32_16x16x32_bf16 v[64:67], v[176:179], v[184:187], v[64:67]
    v_mfma_f32_16x16x32_bf16 v[68:71], v[176:179], v[188:191], v[68:71]
    v_mfma_f32_16x16x32_bf16 v[72:75], v[180:183], v[184:187], v[72:75]
    v_mfma_f32_16x16x32_bf16 v[76:79], v[180:183], v[188:191], v[76:79]
    v_mfma_f32_16x16x32_bf16 v[80:83], v[192:195], v[184:187], v[80:83]
    v_mfma_f32_16x16x32_bf16 v[84:87], v[192:195], v[188:191], v[84:87]
    s_waitcnt lgkmcnt(0)
    s_barrier
    v_mfma_f32_16x16x32_bf16 v[16:19], v[212:215], v[204:207], v[16:19]
    ds_read_b128 v[160:163], v200 offset:36864
    v_mfma_f32_16x16x32_bf16 v[20:23], v[212:215], v[208:211], v[20:23]
    ds_read_b128 v[164:167], v200 offset:38912
    v_mfma_f32_16x16x32_bf16 v[24:27], v[216:219], v[204:207], v[24:27]
    ds_read_b128 v[168:171], v198 offset:36864
    v_mfma_f32_16x16x32_bf16 v[28:31], v[216:219], v[208:211], v[28:31]
    ds_read_b128 v[172:175], v198 offset:37888
    v_mfma_f32_16x16x32_bf16 v[32:35], v[220:223], v[204:207], v[32:35]
    ds_read_b128 v[176:179], v198 offset:38912
    v_mfma_f32_16x16x32_bf16 v[36:39], v[220:223], v[208:211], v[36:39]
    ds_read_b128 v[180:183], v198 offset:39936
    v_mfma_f32_16x16x32_bf16 v[40:43], v[224:227], v[204:207], v[40:43]
    ds_read_b128 v[184:187], v8 offset:36864
    v_mfma_f32_16x16x32_bf16 v[44:47], v[224:227], v[208:211], v[44:47]
    ds_read_b128 v[188:191], v8 offset:38912
    v_mfma_f32_16x16x32_bf16 v[48:51], v[212:215], v[228:231], v[48:51]
    ds_read_b128 v[192:195], v1 offset:45056
    v_mfma_f32_16x16x32_bf16 v[52:55], v[212:215], v[232:235], v[52:55]
    v_mfma_f32_16x16x32_bf16 v[56:59], v[216:219], v[228:231], v[56:59]
    v_mfma_f32_16x16x32_bf16 v[60:63], v[216:219], v[232:235], v[60:63]
    v_mfma_f32_16x16x32_bf16 v[64:67], v[220:223], v[228:231], v[64:67]
    v_mfma_f32_16x16x32_bf16 v[68:71], v[220:223], v[232:235], v[68:71]
    v_mfma_f32_16x16x32_bf16 v[72:75], v[224:227], v[228:231], v[72:75]
    v_mfma_f32_16x16x32_bf16 v[76:79], v[224:227], v[232:235], v[76:79]
    v_mfma_f32_16x16x32_bf16 v[80:83], v[236:239], v[228:231], v[80:83]
    v_mfma_f32_16x16x32_bf16 v[84:87], v[236:239], v[232:235], v[84:87]
    s_waitcnt lgkmcnt(3)
    v_mfma_f32_16x16x32_bf16 v[16:19], v[168:171], v[160:163], v[16:19]
    ds_read_b128 v[204:207], v201 offset:36864
    v_mfma_f32_16x16x32_bf16 v[20:23], v[168:171], v[164:167], v[20:23]
    ds_read_b128 v[208:211], v201 offset:38912
    v_mfma_f32_16x16x32_bf16 v[24:27], v[172:175], v[160:163], v[24:27]
    ds_read_b128 v[212:215], v198 offset:46080
    v_mfma_f32_16x16x32_bf16 v[28:31], v[172:175], v[164:167], v[28:31]
    ds_read_b128 v[216:219], v198 offset:47104
    v_mfma_f32_16x16x32_bf16 v[32:35], v[176:179], v[160:163], v[32:35]
    ds_read_b128 v[220:223], v198 offset:48128
    v_mfma_f32_16x16x32_bf16 v[36:39], v[176:179], v[164:167], v[36:39]
    ds_read_b128 v[224:227], v198 offset:49152
    v_mfma_f32_16x16x32_bf16 v[40:43], v[180:183], v[160:163], v[40:43]
    ds_read_b128 v[228:231], v9 offset:36864
    v_mfma_f32_16x16x32_bf16 v[44:47], v[180:183], v[164:167], v[44:47]
    ds_read_b128 v[232:235], v9 offset:38912
    s_waitcnt lgkmcnt(8)
    v_mfma_f32_16x16x32_bf16 v[48:51], v[168:171], v[184:187], v[48:51]
    ds_read_b128 v[236:239], v1 offset:54272
    v_mfma_f32_16x16x32_bf16 v[52:55], v[168:171], v[188:191], v[52:55]
    v_mfma_f32_16x16x32_bf16 v[56:59], v[172:175], v[184:187], v[56:59]
    v_mfma_f32_16x16x32_bf16 v[60:63], v[172:175], v[188:191], v[60:63]
    v_mfma_f32_16x16x32_bf16 v[64:67], v[176:179], v[184:187], v[64:67]
    v_mfma_f32_16x16x32_bf16 v[68:71], v[176:179], v[188:191], v[68:71]
    v_mfma_f32_16x16x32_bf16 v[72:75], v[180:183], v[184:187], v[72:75]
    v_mfma_f32_16x16x32_bf16 v[76:79], v[180:183], v[188:191], v[76:79]
    v_mfma_f32_16x16x32_bf16 v[80:83], v[192:195], v[184:187], v[80:83]
    v_mfma_f32_16x16x32_bf16 v[84:87], v[192:195], v[188:191], v[84:87]
    s_waitcnt lgkmcnt(0)
    s_barrier
    v_mfma_f32_16x16x32_bf16 v[16:19], v[212:215], v[204:207], v[16:19]
    ds_read_b128 v[160:163], v202 offset:0
    v_mfma_f32_16x16x32_bf16 v[20:23], v[212:215], v[208:211], v[20:23]
    ds_read_b128 v[164:167], v202 offset:2048
    v_mfma_f32_16x16x32_bf16 v[24:27], v[216:219], v[204:207], v[24:27]
    ds_read_b128 v[168:171], v199 offset:0
    v_mfma_f32_16x16x32_bf16 v[28:31], v[216:219], v[208:211], v[28:31]
    ds_read_b128 v[172:175], v199 offset:1024
    v_mfma_f32_16x16x32_bf16 v[32:35], v[220:223], v[204:207], v[32:35]
    ds_read_b128 v[176:179], v199 offset:2048
    v_mfma_f32_16x16x32_bf16 v[36:39], v[220:223], v[208:211], v[36:39]
    ds_read_b128 v[180:183], v199 offset:3072
    v_mfma_f32_16x16x32_bf16 v[40:43], v[224:227], v[204:207], v[40:43]
    ds_read_b128 v[184:187], v10 offset:0
    v_mfma_f32_16x16x32_bf16 v[44:47], v[224:227], v[208:211], v[44:47]
    ds_read_b128 v[188:191], v10 offset:2048
    v_mfma_f32_16x16x32_bf16 v[48:51], v[212:215], v[228:231], v[48:51]
    ds_read_b128 v[192:195], v2 offset:8192
    v_mfma_f32_16x16x32_bf16 v[52:55], v[212:215], v[232:235], v[52:55]
    v_mfma_f32_16x16x32_bf16 v[56:59], v[216:219], v[228:231], v[56:59]
    v_mfma_f32_16x16x32_bf16 v[60:63], v[216:219], v[232:235], v[60:63]
    v_mfma_f32_16x16x32_bf16 v[64:67], v[220:223], v[228:231], v[64:67]
    v_mfma_f32_16x16x32_bf16 v[68:71], v[220:223], v[232:235], v[68:71]
    v_mfma_f32_16x16x32_bf16 v[72:75], v[224:227], v[228:231], v[72:75]
    v_mfma_f32_16x16x32_bf16 v[76:79], v[224:227], v[232:235], v[76:79]
    v_mfma_f32_16x16x32_bf16 v[80:83], v[236:239], v[228:231], v[80:83]
    s_sub_u32 s41, s41, 1
    v_mfma_f32_16x16x32_bf16 v[84:87], v[236:239], v[232:235], v[84:87]
    s_cmp_lg_u32 s41, 0
    s_cbranch_scc1 L_g_loop
    s_waitcnt lgkmcnt(3)
    v_mfma_f32_16x16x32_bf16 v[16:19], v[168:171], v[160:163], v[16:19]
    ds_read_b128 v[204:207], v203 offset:0
    v_mfma_f32_16x16x32_bf16 v[20:23], v[168:171], v[164:167], v[20:23]
    ds_read_b128 v[208:211], v203 offset:2048
    v_mfma_f32_16x16x32_bf16 v[24:27], v[172:175], v[160:163], v[24:27]
    ds_read_b128 v[212:215], v199 offset:9216
    v_mfma_f32_16x16x32_bf16 v[28:31], v[172:175], v[164:167], v[28:31]
    ds_read_b128 v[216:219], v199 offset:10240
    v_mfma_f32_16x16x32_bf16 v[32:35], v[176:179], v[160:163], v[32:35]
    ds_read_b128 v[220:223], v199 offset:11264
    v_mfma_f32_16x16x32_bf16 v[36:39], v[176:179], v[164:167], v[36:39]
    ds_read_b128 v[224:227], v199 offset:12288
    v_mfma_f32_16x16x32_bf16 v[40:43], v[180:183], v[160:163], v[40:43]
    ds_read_b128 v[228:231], v11 offset:0
    v_mfma_f32_16x16x32_bf16 v[44:47], v[180:183], v[164:167], v[44:47]
    ds_read_b128 v[232:235], v11 offset:2048
    s_waitcnt lgkmcnt(8)
    v_mfma_f32_16x16x32_bf16 v[48:51], v[168:171], v[184:187], v[48:51]
    ds_read_b128 v[236:239], v2 offset:17408
    v_mfma_f32_16x16x32_bf16 v[52:55], v[168:171], v[188:191], v[52:55]
    v_mfma_f32_16x16x32_bf16 v[56:59], v[172:175], v[184:187], v[56:59]
    v_mfma_f32_16x16x32_bf16 v[60:63], v[172:175], v[188:191], v[60:63]
    v_mfma_f32_16x16x32_bf16 v[64:67], v[176:179], v[184:187], v[64:67]
    v_mfma_f32_16x16x32_bf16 v[68:71], v[176:179], v[188:191], v[68:71]
    v_mfma_f32_16x16x32_bf16 v[72:75], v[180:183], v[184:187], v[72:75]
    v_mfma_f32_16x16x32_bf16 v[76:79], v[180:183], v[188:191], v[76:79]
    v_mfma_f32_16x16x32_bf16 v[80:83], v[192:195], v[184:187], v[80:83]
    v_mfma_f32_16x16x32_bf16 v[84:87], v[192:195], v[188:191], v[84:87]
    s_waitcnt lgkmcnt(0)
    s_barrier
    v_mfma_f32_16x16x32_bf16 v[16:19], v[212:215], v[204:207], v[16:19]
    ds_read_b128 v[160:163], v202 offset:36864
    v_mfma_f32_16x16x32_bf16 v[20:23], v[212:215], v[208:211], v[20:23]
    ds_read_b128 v[164:167], v202 offset:38912
    v_mfma_f32_16x16x32_bf16 v[24:27], v[216:219], v[204:207], v[24:27]
    ds_read_b128 v[168:171], v199 offset:36864
    v_mfma_f32_16x16x32_bf16 v[28:31], v[216:219], v[208:211], v[28:31]
    ds_read_b128 v[172:175], v199 offset:37888
    v_mfma_f32_16x16x32_bf16 v[32:35], v[220:223], v[204:207], v[32:35]
    ds_read_b128 v[176:179], v199 offset:38912
    v_mfma_f32_16x16x32_bf16 v[36:39], v[220:223], v[208:211], v[36:39]
    ds_read_b128 v[180:183], v199 offset:39936
    v_mfma_f32_16x16x32_bf16 v[40:43], v[224:227], v[204:207], v[40:43]
    ds_read_b128 v[184:187], v10 offset:36864
    v_mfma_f32_16x16x32_bf16 v[44:47], v[224:227], v[208:211], v[44:47]
    ds_read_b128 v[188:191], v10 offset:38912
    v_mfma_f32_16x16x32_bf16 v[48:51], v[212:215], v[228:231], v[48:51]
    ds_read_b128 v[192:195], v2 offset:45056
    v_mfma_f32_16x16x32_bf16 v[52:55], v[212:215], v[232:235], v[52:55]
    v_mfma_f32_16x16x32_bf16 v[56:59], v[216:219], v[228:231], v[56:59]
    v_mfma_f32_16x16x32_bf16 v[60:63], v[216:219], v[232:235], v[60:63]
    v_mfma_f32_16x16x32_bf16 v[64:67], v[220:223], v[228:231], v[64:67]
    v_mfma_f32_16x16x32_bf16 v[68:71], v[220:223], v[232:235], v[68:71]
    v_mfma_f32_16x16x32_bf16 v[72:75], v[224:227], v[228:231], v[72:75]
    v_mfma_f32_16x16x32_bf16 v[76:79], v[224:227], v[232:235], v[76:79]
    v_mfma_f32_16x16x32_bf16 v[80:83], v[236:239], v[228:231], v[80:83]
    v_mfma_f32_16x16x32_bf16 v[84:87], v[236:239], v[232:235], v[84:87]
    s_waitcnt lgkmcnt(3)
    v_mfma_f32_16x16x32_bf16 v[16:19], v[168:171], v[160:163], v[16:19]
    ds_read_b128 v[204:207], v203 offset:36864
    v_mfma_f32_16x16x32_bf16 v[20:23], v[168:171], v[164:167], v[20:23]
    ds_read_b128 v[208:211], v203 offset:38912
    v_mfma_f32_16x16x32_bf16 v[24:27], v[172:175], v[160:163], v[24:27]
    ds_read_b128 v[212:215], v199 offset:46080
    v_mfma_f32_16x16x32_bf16 v[28:31], v[172:175], v[164:167], v[28:31]
    ds_read_b128 v[216:219], v199 offset:47104
    v_mfma_f32_16x16x32_bf16 v[32:35], v[176:179], v[160:163], v[32:35]
    ds_read_b128 v[220:223], v199 offset:48128
    v_mfma_f32_16x16x32_bf16 v[36:39], v[176:179], v[164:167], v[36:39]
    ds_read_b128 v[224:227], v199 offset:49152
    v_mfma_f32_16x16x32_bf16 v[40:43], v[180:183], v[160:163], v[40:43]
    ds_read_b128 v[228:231], v11 offset:36864
    v_mfma_f32_16x16x32_bf16 v[44:47], v[180:183], v[164:167], v[44:47]
    ds_read_b128 v[232:235], v11 offset:38912
    s_waitcnt lgkmcnt(8)
    v_mfma_f32_16x16x32_bf16 v[48:51], v[168:171], v[184:187], v[48:51]
    ds_read_b128 v[236:239], v2 offset:54272
    v_mfma_f32_16x16x32_bf16 v[52:55], v[168:171], v[188:191], v[52:55]
    v_mfma_f32_16x16x32_bf16 v[56:59], v[172:175], v[184:187], v[56:59]
    v_mfma_f32_16x16x32_bf16 v[60:63], v[172:175], v[188:191], v[60:63]
    v_mfma_f32_16x16x32_bf16 v[64:67], v[176:179], v[184:187], v[64:67]
    v_mfma_f32_16x16x32_bf16 v[68:71], v[176:179], v[188:191], v[68:71]
    v_mfma_f32_16x16x32_bf16 v[72:75], v[180:183], v[184:187], v[72:75]
    v_mfma_f32_16x16x32_bf16 v[76:79], v[180:183], v[188:191], v[76:79]
    v_mfma_f32_16x16x32_bf16 v[80:83], v[192:195], v[184:187], v[80:83]
    v_mfma_f32_16x16x32_bf16 v[84:87], v[192:195], v[188:191], v[84:87]
    s_waitcnt lgkmcnt(0)
    s_barrier
    v_mfma_f32_16x16x32_bf16 v[16:19], v[212:215], v[204:207], v[16:19]
    ds_read_b128 v[160:163], v200 offset:0
    v_mfma_f32_16x16x32_bf16 v[20:23], v[212:215], v[208:211], v[20:23]
    ds_read_b128 v[164:167], v200 offset:2048
    v_mfma_f32_16x16x32_bf16 v[24:27], v[216:219], v[204:207], v[24:27]
    ds_read_b128 v[192:195], v198 offset:0
    v_mfma_f32_16x16x32_bf16 v[28:31], v[216:219], v[208:211], v[28:31]
    ds_read_b128 v[168:171], v201 offset:0
    v_mfma_f32_16x16x32_bf16 v[32:35], v[220:223], v[204:207], v[32:35]
    ds_read_b128 v[172:175], v201 offset:2048
    v_mfma_f32_16x16x32_bf16 v[36:39], v[220:223], v[208:211], v[36:39]
    ds_read_b128 v[176:179], v200 offset:36864
    v_mfma_f32_16x16x32_bf16 v[40:43], v[224:227], v[204:207], v[40:43]
    ds_read_b128 v[180:183], v200 offset:38912
    v_mfma_f32_16x16x32_bf16 v[44:47], v[224:227], v[208:211], v[44:47]
    ds_read_b128 v[184:187], v201 offset:36864
    v_mfma_f32_16x16x32_bf16 v[48:51], v[212:215], v[228:231], v[48:51]
    ds_read_b128 v[188:191], v201 offset:38912
    v_mfma_f32_16x16x32_bf16 v[52:55], v[212:215], v[232:235], v[52:55]
    ds_read_b128 v[240:243], v198 offset:9216
    v_mfma_f32_16x16x32_bf16 v[56:59], v[216:219], v[228:231], v[56:59]
    ds_read_b128 v[244:247], v198 offset:36864
    v_mfma_f32_16x16x32_bf16 v[60:63], v[216:219], v[232:235], v[60:63]
    ds_read_b128 v[248:251], v198 offset:46080
    v_mfma_f32_16x16x32_bf16 v[64:67], v[220:223], v[228:231], v[64:67]
    ds_read_b128 v[4:7], v198 offset:1024
    v_mfma_f32_16x16x32_bf16 v[68:71], v[220:223], v[232:235], v[68:71]
    v_mfma_f32_16x16x32_bf16 v[72:75], v[224:227], v[228:231], v[72:75]
    v_mfma_f32_16x16x32_bf16 v[76:79], v[224:227], v[232:235], v[76:79]
    v_mfma_f32_16x16x32_bf16 v[80:83], v[236:239], v[228:231], v[80:83]
    v_mfma_f32_16x16x32_bf16 v[84:87], v[236:239], v[232:235], v[84:87]
    s_waitcnt lgkmcnt(0)
    v_mfma_f32_16x16x32_bf16 v[16:19], v[192:195], v[160:163], v[16:19]
    ds_read_b128 v[252:255], v198 offset:10240
    v_mfma_f32_16x16x32_bf16 v[20:23], v[192:195], v[164:167], v[20:23]
    ds_read_b128 v[204:207], v8 offset:0
    v_mfma_f32_16x16x32_bf16 v[16:19], v[240:243], v[168:171], v[16:19]
    ds_read_b128 v[236:239], v198 offset:37888
    v_mfma_f32_16x16x32_bf16 v[20:23], v[240:243], v[172:175], v[20:23]
    ds_read_b128 v[208:211], v8 offset:2048
    v_mfma_f32_16x16x32_bf16 v[16:19], v[244:247], v[176:179], v[16:19]
    ds_read_b128 v[192:195], v198 offset:47104
    v_mfma_f32_16x16x32_bf16 v[20:23], v[244:247], v[180:183], v[20:23]
    ds_read_b128 v[212:215], v9 offset:0
    v_mfma_f32_16x16x32_bf16 v[16:19], v[248:251], v[184:187], v[16:19]
    ds_read_b128 v[240:243], v198 offset:2048
    v_mfma_f32_16x16x32_bf16 v[20:23], v[248:251], v[188:191], v[20:23]
    ds_read_b128 v[216:219], v9 offset:2048
    v_mfma_f32_16x16x32_bf16 v[24:27], v[4:7], v[160:163], v[24:27]
    ds_read_b128 v[244:247], v198 offset:11264
    v_mfma_f32_16x16x32_bf16 v[28:31], v[4:7], v[164:167], v[28:31]
    ds_read_b128 v[220:223], v8 offset:36864
    s_waitcnt lgkmcnt(9)
    v_mfma_f32_16x16x32_bf16 v[24:27], v[252:255], v[168:171], v[24:27]
    ds_read_b128 v[248:251], v198 offset:38912
    v_mfma_f32_16x16x32_bf16 v[28:31], v[252:255], v[172:175], v[28:31]
    ds_read_b128 v[224:227], v8 offset:38912
    s_waitcnt lgkmcnt(9)
    v_mfma_f32_16x16x32_bf16 v[24:27], v[236:239], v[176:179], v[24:27]
    ds_read_b128 v[4:7], v198 offset:48128
    v_mul_f32 v16, v16, v88
    v_mfma_f32_16x16x32_bf16 v[28:31], v[236:239], v[180:183], v[28:31]
    ds_read_b128 v[228:231], v9 offset:36864
    v_mul_f32 v17, v17, v89
    s_waitcnt lgkmcnt(9)
    v_mfma_f32_16x16x32_bf16 v[24:27], v[192:195], v[184:187], v[24:27]
    ds_read_b128 v[252:255], v198 offset:3072
    v_mul_f32_e64 v18, v18, v90
    v_mfma_f32_16x16x32_bf16 v[28:31], v[192:195], v[188:191], v[28:31]
    ds_read_b128 v[232:235], v9 offset:38912
    v_mul_f32 v19, v19, v91
    s_waitcnt lgkmcnt(9)
    v_mfma_f32_16x16x32_bf16 v[32:35], v[240:243], v[160:163], v[32:35]
    ds_read_b128 v[236:239], v198 offset:12288
    v_cvt_pk_bf16_f32 v88, v16, v17
    v_mfma_f32_16x16x32_bf16 v[36:39], v[240:243], v[164:167], v[36:39]
    v_cvt_pk_bf16_f32 v89, v18, v19
    v_mul_f32 v20, v20, v92
    s_waitcnt lgkmcnt(8)
    v_mfma_f32_16x16x32_bf16 v[32:35], v[244:247], v[168:171], v[32:35]
    ds_read_b128 v[192:195], v198 offset:39936
    v_mul_f32_e64 v21, v21, v93
    v_mfma_f32_16x16x32_bf16 v[36:39], v[244:247], v[172:175], v[36:39]
    v_mul_f32 v22, v22, v94
    v_mul_f32_e64 v23, v23, v95
    s_waitcnt lgkmcnt(7)
    v_mfma_f32_16x16x32_bf16 v[32:35], v[248:251], v[176:179], v[32:35]
    ds_read_b128 v[240:243], v198 offset:49152
    v_cvt_pk_bf16_f32 v92, v20, v21
    v_mfma_f32_16x16x32_bf16 v[36:39], v[248:251], v[180:183], v[36:39]
    v_cvt_pk_bf16_f32 v93, v22, v23
    v_mul_f32 v24, v24, v96
    v_mul_f32_e64 v25, v25, v97
    s_waitcnt lgkmcnt(6)
    v_mfma_f32_16x16x32_bf16 v[32:35], v[4:7], v[184:187], v[32:35]
    ds_read_b128 v[244:247], v198 offset:0
    v_mul_f32_e64 v26, v26, v98
    v_mfma_f32_16x16x32_bf16 v[36:39], v[4:7], v[188:191], v[36:39]
    v_mul_f32_e64 v27, v27, v99
    v_cvt_pk_bf16_f32 v90, v24, v25
    s_waitcnt lgkmcnt(5)
    v_mfma_f32_16x16x32_bf16 v[40:43], v[252:255], v[160:163], v[40:43]
    ds_read_b128 v[248:251], v198 offset:9216
    v_cvt_pk_bf16_f32 v91, v26, v27
    v_mfma_f32_16x16x32_bf16 v[44:47], v[252:255], v[164:167], v[44:47]
    buffer_store_dwordx4 v[88:91], v13, s[4:7], s36 offen sc1
    v_mul_f32_e64 v28, v28, v100
    s_waitcnt lgkmcnt(4)
    v_mfma_f32_16x16x32_bf16 v[40:43], v[236:239], v[168:171], v[40:43]
    ds_read_b128 v[4:7], v198 offset:36864
    v_mul_f32_e64 v29, v29, v101
    v_mfma_f32_16x16x32_bf16 v[44:47], v[236:239], v[172:175], v[44:47]
    v_mul_f32 v30, v30, v102
    v_mul_f32_e64 v31, v31, v103
    s_waitcnt lgkmcnt(4)
    v_mfma_f32_16x16x32_bf16 v[40:43], v[192:195], v[176:179], v[40:43]
    ds_read_b128 v[252:255], v198 offset:46080
    v_cvt_pk_bf16_f32 v94, v28, v29
    v_mfma_f32_16x16x32_bf16 v[44:47], v[192:195], v[180:183], v[44:47]
    v_cvt_pk_bf16_f32 v95, v30, v31
    buffer_store_dwordx4 v[92:95], v13, s[4:7], s37 offen sc1
    v_mul_f32 v32, v32, v104
    s_waitcnt lgkmcnt(4)
    v_mfma_f32_16x16x32_bf16 v[40:43], v[240:243], v[184:187], v[40:43]
    ds_read_b128 v[236:239], v198 offset:1024
    v_mul_f32_e64 v33, v33, v105
    v_mfma_f32_16x16x32_bf16 v[44:47], v[240:243], v[188:191], v[44:47]
    v_mul_f32 v34, v34, v106
    v_mul_f32_e64 v35, v35, v107
    s_waitcnt lgkmcnt(4)
    v_mfma_f32_16x16x32_bf16 v[48:51], v[244:247], v[204:207], v[48:51]
    ds_read_b128 v[192:195], v198 offset:10240
    v_cvt_pk_bf16_f32 v104, v32, v33
    v_mfma_f32_16x16x32_bf16 v[52:55], v[244:247], v[208:211], v[52:55]
    v_cvt_pk_bf16_f32 v105, v34, v35
    v_mul_f32 v36, v36, v108
    s_waitcnt lgkmcnt(4)
    v_mfma_f32_16x16x32_bf16 v[48:51], v[248:251], v[212:215], v[48:51]
    ds_read_b128 v[240:243], v198 offset:37888
    v_mul_f32_e64 v37, v37, v109
    v_mfma_f32_16x16x32_bf16 v[52:55], v[248:251], v[216:219], v[52:55]
    v_mul_f32 v38, v38, v110
    v_mul_f32_e64 v39, v39, v111
    s_waitcnt lgkmcnt(4)
    v_mfma_f32_16x16x32_bf16 v[48:51], v[4:7], v[220:223], v[48:51]
    ds_read_b128 v[244:247], v198 offset:47104
    v_cvt_pk_bf16_f32 v108, v36, v37
    v_mfma_f32_16x16x32_bf16 v[52:55], v[4:7], v[224:227], v[52:55]
    v_cvt_pk_bf16_f32 v109, v38, v39
    v_mul_f32 v40, v40, v112
    v_mul_f32_e64 v41, v41, v113
    s_waitcnt lgkmcnt(4)
    v_mfma_f32_16x16x32_bf16 v[48:51], v[252:255], v[228:231], v[48:51]
    ds_read_b128 v[248:251], v198 offset:2048
    v_mul_f32_e64 v42, v42, v114
    v_mfma_f32_16x16x32_bf16 v[52:55], v[252:255], v[232:235], v[52:55]
    v_mul_f32_e64 v43, v43, v115
    v_cvt_pk_bf16_f32 v106, v40, v41
    s_waitcnt lgkmcnt(4)
    v_mfma_f32_16x16x32_bf16 v[56:59], v[236:239], v[204:207], v[56:59]
    ds_read_b128 v[4:7], v198 offset:11264
    v_cvt_pk_bf16_f32 v107, v42, v43
    v_mfma_f32_16x16x32_bf16 v[60:63], v[236:239], v[208:211], v[60:63]
    buffer_store_dwordx4 v[104:107], v14, s[4:7], s36 offen sc1
    v_mul_f32_e64 v44, v44, v116
    s_waitcnt lgkmcnt(4)
    v_mfma_f32_16x16x32_bf16 v[56:59], v[192:195], v[212:215], v[56:59]
    ds_read_b128 v[252:255], v198 offset:38912
    v_mul_f32_e64 v45, v45, v117
    v_mfma_f32_16x16x32_bf16 v[60:63], v[192:195], v[216:219], v[60:63]
    v_mul_f32 v46, v46, v118
    v_mul_f32_e64 v47, v47, v119
    s_waitcnt lgkmcnt(4)
    v_mfma_f32_16x16x32_bf16 v[56:59], v[240:243], v[220:223], v[56:59]
    ds_read_b128 v[236:239], v198 offset:48128
    v_cvt_pk_bf16_f32 v110, v44, v45
    v_mfma_f32_16x16x32_bf16 v[60:63], v[240:243], v[224:227], v[60:63]
    v_cvt_pk_bf16_f32 v111, v46, v47
    buffer_store_dwordx4 v[108:111], v14, s[4:7], s37 offen sc1
    v_mul_f32 v48, v48, v120
    s_waitcnt lgkmcnt(4)
    v_mfma_f32_16x16x32_bf16 v[56:59], v[244:247], v[228:231], v[56:59]
    ds_read_b128 v[192:195], v198 offset:3072
    v_mul_f32_e64 v49, v49, v121
    v_mfma_f32_16x16x32_bf16 v[60:63], v[244:247], v[232:235], v[60:63]
    v_mul_f32 v50, v50, v122
    v_mul_f32_e64 v51, v51, v123
    s_waitcnt lgkmcnt(4)
    v_mfma_f32_16x16x32_bf16 v[64:67], v[248:251], v[204:207], v[64:67]
    ds_read_b128 v[240:243], v198 offset:12288
    v_cvt_pk_bf16_f32 v120, v48, v49
    v_mfma_f32_16x16x32_bf16 v[68:71], v[248:251], v[208:211], v[68:71]
    v_cvt_pk_bf16_f32 v121, v50, v51
    v_mul_f32 v52, v52, v124
    s_waitcnt lgkmcnt(4)
    v_mfma_f32_16x16x32_bf16 v[64:67], v[4:7], v[212:215], v[64:67]
    ds_read_b128 v[244:247], v198 offset:39936
    v_mul_f32_e64 v53, v53, v125
    v_mfma_f32_16x16x32_bf16 v[68:71], v[4:7], v[216:219], v[68:71]
    v_mul_f32 v54, v54, v126
    v_mul_f32_e64 v55, v55, v127
    s_waitcnt lgkmcnt(4)
    v_mfma_f32_16x16x32_bf16 v[64:67], v[252:255], v[220:223], v[64:67]
    ds_read_b128 v[248:251], v198 offset:49152
    v_cvt_pk_bf16_f32 v124, v52, v53
    v_mfma_f32_16x16x32_bf16 v[68:71], v[252:255], v[224:227], v[68:71]
    v_cvt_pk_bf16_f32 v125, v54, v55
    v_mul_f32 v56, v56, v128
    v_mul_f32_e64 v57, v57, v129
    s_waitcnt lgkmcnt(4)
    v_mfma_f32_16x16x32_bf16 v[64:67], v[236:239], v[228:231], v[64:67]
    ds_read_b128 v[4:7], v1 offset:8192
    v_mul_f32_e64 v58, v58, v130
    v_mfma_f32_16x16x32_bf16 v[68:71], v[236:239], v[232:235], v[68:71]
    v_mul_f32_e64 v59, v59, v131
    v_cvt_pk_bf16_f32 v122, v56, v57
    s_waitcnt lgkmcnt(4)
    v_mfma_f32_16x16x32_bf16 v[72:75], v[192:195], v[204:207], v[72:75]
    ds_read_b128 v[252:255], v1 offset:17408
    v_cvt_pk_bf16_f32 v123, v58, v59
    v_mfma_f32_16x16x32_bf16 v[76:79], v[192:195], v[208:211], v[76:79]
    buffer_store_dwordx4 v[120:123], v13, s[4:7], s39 offen sc1
    v_mul_f32_e64 v60, v60, v132
    s_waitcnt lgkmcnt(4)
    v_mfma_f32_16x16x32_bf16 v[72:75], v[240:243], v[212:215], v[72:75]
    ds_read_b128 v[236:239], v1 offset:45056
    v_mul_f32_e64 v61, v61, v133
    v_mfma_f32_16x16x32_bf16 v[76:79], v[240:243], v[216:219], v[76:79]
    v_mul_f32 v62, v62, v134
    v_mul_f32_e64 v63, v63, v135
    s_waitcnt lgkmcnt(4)
    v_mfma_f32_16x16x32_bf16 v[72:75], v[244:247], v[220:223], v[72:75]
    ds_read_b128 v[192:195], v1 offset:54272
    v_cvt_pk_bf16_f32 v126, v60, v61
    v_mfma_f32_16x16x32_bf16 v[76:79], v[244:247], v[224:227], v[76:79]
    v_cvt_pk_bf16_f32 v127, v62, v63
    buffer_store_dwordx4 v[124:127], v13, s[4:7], s40 offen sc1
    v_mul_f32 v64, v64, v136
    s_waitcnt lgkmcnt(4)
    v_mfma_f32_16x16x32_bf16 v[72:75], v[248:251], v[228:231], v[72:75]
    v_mul_f32 v65, v65, v137
    v_mul_f32 v66, v66, v138
    v_mfma_f32_16x16x32_bf16 v[76:79], v[248:251], v[232:235], v[76:79]
    v_mul_f32_e64 v67, v67, v139
    v_cvt_pk_bf16_f32 v136, v64, v65
    s_waitcnt lgkmcnt(3)
    v_mfma_f32_16x16x32_bf16 v[80:83], v[4:7], v[204:207], v[80:83]
    v_cvt_pk_bf16_f32 v137, v66, v67
    v_mul_f32 v68, v68, v140
    v_mfma_f32_16x16x32_bf16 v[84:87], v[4:7], v[208:211], v[84:87]
    v_mul_f32 v69, v69, v141
    v_mul_f32_e64 v70, v70, v142
    s_waitcnt lgkmcnt(2)
    v_mfma_f32_16x16x32_bf16 v[80:83], v[252:255], v[212:215], v[80:83]
    v_mul_f32_e64 v71, v71, v143
    v_cvt_pk_bf16_f32 v140, v68, v69
    v_mfma_f32_16x16x32_bf16 v[84:87], v[252:255], v[216:219], v[84:87]
    v_cvt_pk_bf16_f32 v141, v70, v71
    s_waitcnt lgkmcnt(1)
    v_mfma_f32_16x16x32_bf16 v[80:83], v[236:239], v[220:223], v[80:83]
    v_mul_f32 v72, v72, v144
    v_mul_f32_e64 v73, v73, v145
    v_mfma_f32_16x16x32_bf16 v[84:87], v[236:239], v[224:227], v[84:87]
    v_mul_f32 v74, v74, v146
    v_mul_f32 v75, v75, v147
    v_cvt_pk_bf16_f32 v138, v72, v73
    s_waitcnt lgkmcnt(0)
    v_mfma_f32_16x16x32_bf16 v[80:83], v[192:195], v[228:231], v[80:83]
    v_cvt_pk_bf16_f32 v139, v74, v75
    buffer_store_dwordx4 v[136:139], v14, s[4:7], s39 offen sc1
    v_mfma_f32_16x16x32_bf16 v[84:87], v[192:195], v[232:235], v[84:87]
    v_mul_f32 v76, v76, v148
    v_mul_f32 v77, v77, v149
    v_mul_f32 v78, v78, v150
    v_mul_f32_e64 v79, v79, v151
    v_cvt_pk_bf16_f32 v142, v76, v77
    v_cvt_pk_bf16_f32 v143, v78, v79
    buffer_store_dwordx4 v[140:143], v14, s[4:7], s40 offen sc1
    s_nop 1
    v_mul_f32 v80, v80, v152
    v_mul_f32 v81, v81, v153
    v_mul_f32 v82, v82, v154
    v_mul_f32_e64 v83, v83, v155
    v_cvt_pk_bf16_f32 v152, v80, v81
    v_cvt_pk_bf16_f32 v153, v82, v83
    v_mul_f32 v84, v84, v156
    v_mul_f32 v85, v85, v157
    v_mul_f32 v86, v86, v158
    v_mul_f32 v87, v87, v159
    v_cvt_pk_bf16_f32 v154, v84, v85
    v_cvt_pk_bf16_f32 v155, v86, v87
    s_bitcmp0_b32 s24, 1
    s_cbranch_scc1 L_g_ns
    v_swap_b32 v152, v154
    v_swap_b32 v153, v155
L_g_ns:
    buffer_store_dwordx4 v[152:155], v15, s[4:7], s39 offen sc1
    s_barrier
    s_and_b32 s25, s2, 7
    s_lshr_b32 s26, s2, 3
    s_lshr_b32 s23, s25, 1
    s_lshl_b32 s23, s23, 3
    s_lshr_b32 s27, s26, 2
    s_add_u32 s23, s23, s27
    s_and_b32 s24, s25, 1
    s_lshl_b32 s24, s24, 2
    s_and_b32 s27, s26, 3
    s_add_u32 s24, s24, s27
    s_add_u32 s25, s23, s24
    s_and_b32 s25, s25, 3
    s_lshl_b32 s30, s23, 2
    s_add_u32 s30, s30, s20
    s_and_b32 s31, s20, 1
    s_mul_i32 s34, s30, 18432
    s_add_u32 s34, s34, s21
    s_add_u32 s34, s34, 0x300000
    s_lshl_b32 s35, s24, 11
    s_lshr_b32 s36, s24, 2
    s_lshl_b32 s36, s36, 10
    s_and_b32 s37, s24, 3
    s_lshl_b32 s37, s37, 8
    s_add_u32 s36, s36, s37
    s_add_u32 s36, s36, 16384
    v_bfe_u32 v2, v1, 4, 4
    v_lshrrev_b32 v3, 8, v1
    v_add_u32 v4, s35, v1
    v_lshrrev_b32 v0, 1, v3
    v_and_b32_e64 v9, 1, v3
    v_cmp_eq_u32 s[40:41], s31, v0
    v_bfrev_b32 v6, 1
    v_lshlrev_b32 v5, 4, v2
    v_lshl_add_u32 v5, v9, 3, v5
    v_add_u32_e64 v5, s36, v5
    v_cndmask_b32 v5, v6, v5, s[40:41]
    buffer_load_dwordx4 v[220:223], v4, s[4:7], s34 offen offset:0 sc1
    buffer_load_dwordx4 v[224:227], v4, s[4:7], s34 offen offset:1024 sc1
    buffer_load_dwordx2 v[228:229], v5, s[4:7], s34 offen sc1
    s_and_b32 s29, s30, 0xfffe
    s_mul_i32 s29, s29, 73728
    s_add_u32 s29, s29, s21
    s_lshl_b32 s37, s31, 10
    s_add_u32 s29, s29, s37
    s_add_u32 s29, s29, 0x1200000
    s_mul_i32 s37, s31, 73728
    s_sub_u32 s38, 73728, s37
    v_lshlrev_b32 v10, 3, v2
    v_add_u32 v16, s37, v1
    v_add_u32 v17, s38, v1
    v_mov_b32_e64 v18, v1
    v_add_u32 v19, 73728, v1
    s_lshl_b32 s37, s31, 12
    v_add_u32 v20, 0, v1
    v_add_u32_e64 v12, s37, v20
    v_add_u32 v21, 36864, v1
    v_add_u32_e64 v13, s37, v21
    v_add_u32 v22, 73728, v1
    v_add_u32_e64 v14, s37, v22
    v_add_u32 v23, 110592, v1
    v_add_u32_e64 v15, s37, v23
    s_add_u32 s34, s34, 0x1900000
    s_lshl_b32 s39, s30, 10
    s_add_u32 s39, s39, s21
    s_lshl_b32 s42, s24, 7
    s_add_u32 s39, s39, s42
    s_add_u32 s39, s39, 0x3700000
    v_cmp_eq_u32_e64 vcc, 0, v3
    v_mov_b32 v11, 0x3f803f80
    s_lshr_b32 s44, s23, 1
    v_cndmask_b32 v10, v6, v10, vcc
    s_cmp_eq_u32 s22, 0
    s_cbranch_scc1 L_p5_nf
    v_mul_u32_u24 v8, 1152, v2
    s_mul_i32 s34, s30, 18432
    s_mul_i32 s42, s24, 144
    s_add_u32 s34, s34, s42
    v_lshrrev_b32 v4, 6, v1
    v_bfe_u32 v5, v1, 4, 2
    v_lshlrev_b32_e64 v10, 2, v4
    v_lshl_add_u32 v10, v5, 6, v10
    v_mul_u32_u24 v8, 1152, v4
    v_lshrrev_b32 v11, 1, v5
    v_cmp_eq_u32 vcc, s31, v11
    v_lshl_add_u32 v4, v5, 4, v8
    v_and_b32_e64 v5, 1, v5
    v_lshl_add_u32 v5, v5, 3, v8
    v_cndmask_b32 v5, v6, v5, vcc
L_p5_nf:
    s_lshl_b32 s52, s22, 7
    s_add_u32 s52, s52, s44
    s_lshl_b32 s52, s52, 8
    s_add_u32 s52, s52, 0x450a000
    s_add_u32 s52, s52, s4
    s_addc_u32 s53, s5, 0
    s_waitcnt vmcnt(3)
    s_barrier
    s_cmp_lg_u32 s20, 0
    s_cbranch_scc1 L_ns_d5
    s_mov_b32 s56, 1
    s_atomic_add s56, s[50:51], 0
L_ns_d5:
    s_mul_i32 s37, s20, 4608
    s_add_u32 s37, s37, 131072
    s_xor_b32 s38, s20, 1
    s_mul_i32 s42, s38, 4608
    s_add_u32 s42, s42, 131072
    v_and_b32 v0, 0x1ff, v1
    v_add_u32 v2, s37, v1
    v_add_u32 v3, s37, v0
    v_add_u32 v7, s42, v1
    v_add_u32_e64 v8, s42, v0
    s_lshl_b32 s37, s20, 2
    s_add_u32 s37, s37, 163808
    s_xor_b32 s38, s37, 4
    v_mov_b32 v0, s37
    v_mov_b32 v6, s38
    s_lshl_b32 s43, s22, 1
    s_add_u32 s43, s43, 2
    v_mov_b32 v9, s43
    s_cmp_lg_u32 s20, 0
    s_cbranch_scc1 L_pd_d5
    s_mov_b32 s60, 65536
L_poll_d5:
    s_mov_b32 s57, 0
    s_atomic_add s57, s[52:53], 0 glc
    s_waitcnt lgkmcnt(0)
    s_cmp_ge_u32 s57, 16
    s_cbranch_scc1 L_pd_d5
    s_sub_u32 s60, s60, 1
    s_cbranch_scc1 L_pd_d5
    s_sleep 2
    s_branch L_poll_d5
L_pd_d5:
    s_barrier
    s_mov_b32 s32, 0
    s_lshl_b32 s32, s32, 13
    s_add_u32 s32, s32, s29
    s_add_u32 s33, s32, 4096
    buffer_load_dwordx4 v[124:127], v16, s[4:7], s32 offen offset:0 sc1
    buffer_load_dwordx4 v[128:131], v17, s[4:7], s32 offen offset:0 sc1
    buffer_load_dwordx4 v[132:135], v16, s[4:7], s32 offen offset:2048 sc1
    buffer_load_dwordx4 v[136:139], v17, s[4:7], s32 offen offset:2048 sc1
    buffer_load_dwordx4 v[140:143], v16, s[4:7], s33 offen offset:0 sc1
    buffer_load_dwordx4 v[144:147], v17, s[4:7], s33 offen offset:0 sc1
    buffer_load_dwordx4 v[148:151], v16, s[4:7], s33 offen offset:2048 sc1
    buffer_load_dwordx4 v[152:155], v17, s[4:7], s33 offen offset:2048 sc1
    ds_read_b128 v[64:67], v14 offset:0
    ds_read_b128 v[68:71], v14 offset:1024
    ds_read_b128 v[72:75], v14 offset:2048
    ds_read_b128 v[76:79], v14 offset:3072
    ds_read_b128 v[80:83], v22 offset:8192
    ds_read_b128 v[84:87], v14 offset:9216
    ds_read_b128 v[88:91], v14 offset:10240
    ds_read_b128 v[92:95], v14 offset:11264
    ds_read_b128 v[96:99], v14 offset:12288
    ds_read_b128 v[100:103], v22 offset:17408
    s_add_u32 s45, s29, 8192
    s_add_u32 s46, s29, 12288
    buffer_load_dwordx4 v[156:159], v16, s[4:7], s45 offen offset:0 sc1
    buffer_load_dwordx4 v[160:163], v17, s[4:7], s45 offen offset:0 sc1
    s_lshl_b32 s50, s22, 7
    s_add_u32 s50, s50, s44
    s_lshl_b32 s50, s50, 8
    s_add_u32 s50, s50, 0x450b000
    s_add_u32 s50, s50, s4
    s_addc_u32 s51, s5, 0
    s_waitcnt vmcnt(10)
    v_lshlrev_b32_e64 v24, 16, v220
    v_and_b32 v25, 0xffff0000, v220
    v_lshlrev_b32_e64 v26, 16, v221
    v_and_b32 v27, 0xffff0000, v221
    v_lshlrev_b32_e64 v28, 16, v222
    v_and_b32 v29, 0xffff0000, v222
    v_lshlrev_b32_e64 v30, 16, v223
    v_and_b32 v31, 0xffff0000, v223
    v_lshlrev_b32_e64 v32, 16, v224
    v_and_b32 v33, 0xffff0000, v224
    v_lshlrev_b32_e64 v34, 16, v225
    v_and_b32 v35, 0xffff0000, v225
    v_lshlrev_b32_e64 v36, 16, v226
    v_and_b32 v37, 0xffff0000, v226
    v_lshlrev_b32_e64 v38, 16, v227
    v_and_b32 v39, 0xffff0000, v227
    v_lshlrev_b32_e64 v40, 16, v228
    v_and_b32 v41, 0xffff0000, v228
    v_lshlrev_b32_e64 v42, 16, v229
    v_and_b32 v43, 0xffff0000, v229
    s_waitcnt vmcnt(8) lgkmcnt(5)
    v_mfma_f32_16x16x32_bf16 v[44:47], v[64:67], v[128:131], 0
    ds_read_b128 v[104:107], v14 offset:18432
    s_mov_b32 s32, 2
    s_lshl_b32 s32, s32, 13
    s_add_u32 s32, s32, s29
    s_add_u32 s33, s32, 4096
    v_mfma_f32_16x16x32_bf16 v[24:27], v[64:67], v[124:127], v[24:27]
    ds_read_b128 v[108:111], v14 offset:19456
    buffer_load_dwordx4 v[164:167], v16, s[4:7], s45 offen offset:2048 sc1
    v_mfma_f32_16x16x32_bf16 v[48:51], v[68:71], v[128:131], 0
    ds_read_b128 v[112:115], v14 offset:20480
    v_mfma_f32_16x16x32_bf16 v[28:31], v[68:71], v[124:127], v[28:31]
    ds_read_b128 v[116:119], v14 offset:21504
    buffer_load_dwordx4 v[168:171], v17, s[4:7], s45 offen offset:2048 sc1
    v_mfma_f32_16x16x32_bf16 v[52:55], v[72:75], v[128:131], 0
    ds_read_b128 v[120:123], v22 offset:26624
    v_mfma_f32_16x16x32_bf16 v[32:35], v[72:75], v[124:127], v[32:35]
    buffer_load_dwordx4 v[188:191], v16, s[4:7], s32 offen offset:0 sc1
    v_mfma_f32_16x16x32_bf16 v[56:59], v[76:79], v[128:131], 0
    v_mfma_f32_16x16x32_bf16 v[36:39], v[76:79], v[124:127], v[36:39]
    buffer_load_dwordx4 v[192:195], v17, s[4:7], s32 offen offset:0 sc1
    v_mfma_f32_16x16x32_bf16 v[60:63], v[80:83], v[128:131], 0
    v_mfma_f32_16x16x32_bf16 v[40:43], v[80:83], v[124:127], v[40:43]
    s_waitcnt vmcnt(10) lgkmcnt(5)
    v_mfma_f32_16x16x32_bf16 v[44:47], v[84:87], v[136:139], v[44:47]
    ds_read_b128 v[64:67], v14 offset:27648
    v_mfma_f32_16x16x32_bf16 v[24:27], v[84:87], v[132:135], v[24:27]
    ds_read_b128 v[68:71], v14 offset:28672
    buffer_load_dwordx4 v[172:175], v16, s[4:7], s46 offen offset:0 sc1
    v_mfma_f32_16x16x32_bf16 v[48:51], v[88:91], v[136:139], v[48:51]
    ds_read_b128 v[72:75], v14 offset:29696
    v_mfma_f32_16x16x32_bf16 v[28:31], v[88:91], v[132:135], v[28:31]
    ds_read_b128 v[76:79], v14 offset:30720
    buffer_load_dwordx4 v[176:179], v17, s[4:7], s46 offen offset:0 sc1
    v_mfma_f32_16x16x32_bf16 v[52:55], v[92:95], v[136:139], v[52:55]
    ds_read_b128 v[80:83], v22 offset:35840
    v_mfma_f32_16x16x32_bf16 v[32:35], v[92:95], v[132:135], v[32:35]
    buffer_load_dwordx4 v[196:199], v16, s[4:7], s32 offen offset:2048 sc1
    v_mfma_f32_16x16x32_bf16 v[56:59], v[96:99], v[136:139], v[56:59]
    v_mfma_f32_16x16x32_bf16 v[36:39], v[96:99], v[132:135], v[36:39]
    buffer_load_dwordx4 v[200:203], v17, s[4:7], s32 offen offset:2048 sc1
    v_mfma_f32_16x16x32_bf16 v[60:63], v[100:103], v[136:139], v[60:63]
    v_mfma_f32_16x16x32_bf16 v[40:43], v[100:103], v[132:135], v[40:43]
    s_waitcnt vmcnt(12) lgkmcnt(0)
    s_barrier
    v_mfma_f32_16x16x32_bf16 v[44:47], v[104:107], v[144:147], v[44:47]
    ds_read_b128 v[84:87], v15 offset:0
    v_mfma_f32_16x16x32_bf16 v[24:27], v[104:107], v[140:143], v[24:27]
    ds_read_b128 v[88:91], v15 offset:1024
    buffer_load_dwordx4 v[180:183], v16, s[4:7], s46 offen offset:2048 sc1
    v_mfma_f32_16x16x32_bf16 v[48:51], v[108:111], v[144:147], v[48:51]
    ds_read_b128 v[92:95], v15 offset:2048
    v_mfma_f32_16x16x32_bf16 v[28:31], v[108:111], v[140:143], v[28:31]
    ds_read_b128 v[96:99], v15 offset:3072
    buffer_load_dwordx4 v[184:187], v17, s[4:7], s46 offen offset:2048 sc1
    v_mfma_f32_16x16x32_bf16 v[52:55], v[112:115], v[144:147], v[52:55]
    ds_read_b128 v[100:103], v23 offset:8192
    v_mfma_f32_16x16x32_bf16 v[32:35], v[112:115], v[140:143], v[32:35]
    buffer_load_dwordx4 v[204:207], v16, s[4:7], s33 offen offset:0 sc1
    v_mfma_f32_16x16x32_bf16 v[56:59], v[116:119], v[144:147], v[56:59]
    v_mfma_f32_16x16x32_bf16 v[36:39], v[116:119], v[140:143], v[36:39]
    buffer_load_dwordx4 v[208:211], v17, s[4:7], s33 offen offset:0 sc1
    v_mfma_f32_16x16x32_bf16 v[60:63], v[120:123], v[144:147], v[60:63]
    v_mfma_f32_16x16x32_bf16 v[40:43], v[120:123], v[140:143], v[40:43]
    s_waitcnt vmcnt(14) lgkmcnt(5)
    v_mfma_f32_16x16x32_bf16 v[44:47], v[64:67], v[152:155], v[44:47]
    ds_read_b128 v[104:107], v15 offset:9216
    v_mfma_f32_16x16x32_bf16 v[24:27], v[64:67], v[148:151], v[24:27]
    ds_read_b128 v[108:111], v15 offset:10240
    v_mfma_f32_16x16x32_bf16 v[48:51], v[68:71], v[152:155], v[48:51]
    ds_read_b128 v[112:115], v15 offset:11264
    v_mfma_f32_16x16x32_bf16 v[28:31], v[68:71], v[148:151], v[28:31]
    ds_read_b128 v[116:119], v15 offset:12288
    v_mfma_f32_16x16x32_bf16 v[52:55], v[72:75], v[152:155], v[52:55]
    ds_read_b128 v[120:123], v23 offset:17408
    v_mfma_f32_16x16x32_bf16 v[32:35], v[72:75], v[148:151], v[32:35]
    buffer_load_dwordx4 v[212:215], v16, s[4:7], s33 offen offset:2048 sc1
    v_mfma_f32_16x16x32_bf16 v[56:59], v[76:79], v[152:155], v[56:59]
    v_mfma_f32_16x16x32_bf16 v[36:39], v[76:79], v[148:151], v[36:39]
    buffer_load_dwordx4 v[216:219], v17, s[4:7], s33 offen offset:2048 sc1
    v_mfma_f32_16x16x32_bf16 v[60:63], v[80:83], v[152:155], v[60:63]
    v_mfma_f32_16x16x32_bf16 v[40:43], v[80:83], v[148:151], v[40:43]
    s_waitcnt vmcnt(14) lgkmcnt(5)
    v_mfma_f32_16x16x32_bf16 v[44:47], v[84:87], v[160:163], v[44:47]
    ds_read_b128 v[64:67], v15 offset:18432
    s_mov_b32 s32, 3
    s_lshl_b32 s32, s32, 13
    s_add_u32 s32, s32, s29
    s_add_u32 s33, s32, 4096
    v_mfma_f32_16x16x32_bf16 v[24:27], v[84:87], v[156:159], v[24:27]
    ds_read_b128 v[68:71], v15 offset:19456
    v_mfma_f32_16x16x32_bf16 v[48:51], v[88:91], v[160:163], v[48:51]
    ds_read_b128 v[72:75], v15 offset:20480
    v_mfma_f32_16x16x32_bf16 v[28:31], v[88:91], v[156:159], v[28:31]
    ds_read_b128 v[76:79], v15 offset:21504
    v_mfma_f32_16x16x32_bf16 v[52:55], v[92:95], v[160:163], v[52:55]
    ds_read_b128 v[80:83], v23 offset:26624
    v_mfma_f32_16x16x32_bf16 v[32:35], v[92:95], v[156:159], v[32:35]
    buffer_load_dwordx4 v[124:127], v16, s[4:7], s32 offen offset:0 sc1
    v_mfma_f32_16x16x32_bf16 v[56:59], v[96:99], v[160:163], v[56:59]
    v_mfma_f32_16x16x32_bf16 v[36:39], v[96:99], v[156:159], v[36:39]
    buffer_load_dwordx4 v[128:131], v17, s[4:7], s32 offen offset:0 sc1
    v_mfma_f32_16x16x32_bf16 v[60:63], v[100:103], v[160:163], v[60:63]
    v_mfma_f32_16x16x32_bf16 v[40:43], v[100:103], v[156:159], v[40:43]
    s_waitcnt vmcnt(14) lgkmcnt(5)
    v_mfma_f32_16x16x32_bf16 v[44:47], v[104:107], v[168:171], v[44:47]
    ds_read_b128 v[84:87], v15 offset:27648
    v_mfma_f32_16x16x32_bf16 v[24:27], v[104:107], v[164:167], v[24:27]
    ds_read_b128 v[88:91], v15 offset:28672
    v_mfma_f32_16x16x32_bf16 v[48:51], v[108:111], v[168:171], v[48:51]
    ds_read_b128 v[92:95], v15 offset:29696
    v_mfma_f32_16x16x32_bf16 v[28:31], v[108:111], v[164:167], v[28:31]
    ds_read_b128 v[96:99], v15 offset:30720
    v_mfma_f32_16x16x32_bf16 v[52:55], v[112:115], v[168:171], v[52:55]
    ds_read_b128 v[100:103], v23 offset:35840
    v_mfma_f32_16x16x32_bf16 v[32:35], v[112:115], v[164:167], v[32:35]
    buffer_load_dwordx4 v[132:135], v16, s[4:7], s32 offen offset:2048 sc1
    v_mfma_f32_16x16x32_bf16 v[56:59], v[116:119], v[168:171], v[56:59]
    v_mfma_f32_16x16x32_bf16 v[36:39], v[116:119], v[164:167], v[36:39]
    buffer_load_dwordx4 v[136:139], v17, s[4:7], s32 offen offset:2048 sc1
    v_mfma_f32_16x16x32_bf16 v[60:63], v[120:123], v[168:171], v[60:63]
    v_mfma_f32_16x16x32_bf16 v[40:43], v[120:123], v[164:167], v[40:43]
    s_waitcnt vmcnt(12) lgkmcnt(0)
    s_barrier
    v_mfma_f32_16x16x32_bf16 v[44:47], v[64:67], v[176:179], v[44:47]
    ds_read_b128 v[104:107], v12 offset:0
    v_mfma_f32_16x16x32_bf16 v[24:27], v[64:67], v[172:175], v[24:27]
    ds_read_b128 v[108:111], v12 offset:1024
    v_mfma_f32_16x16x32_bf16 v[48:51], v[68:71], v[176:179], v[48:51]
    ds_read_b128 v[112:115], v12 offset:2048
    v_mfma_f32_16x16x32_bf16 v[28:31], v[68:71], v[172:175], v[28:31]
    ds_read_b128 v[116:119], v12 offset:3072
    v_mfma_f32_16x16x32_bf16 v[52:55], v[72:75], v[176:179], v[52:55]
    ds_read_b128 v[120:123], v20 offset:8192
    v_mfma_f32_16x16x32_bf16 v[32:35], v[72:75], v[172:175], v[32:35]
    buffer_load_dwordx4 v[140:143], v16, s[4:7], s33 offen offset:0 sc1
    v_mfma_f32_16x16x32_bf16 v[56:59], v[76:79], v[176:179], v[56:59]
    v_mfma_f32_16x16x32_bf16 v[36:39], v[76:79], v[172:175], v[36:39]
    buffer_load_dwordx4 v[144:147], v17, s[4:7], s33 offen offset:0 sc1
    v_mfma_f32_16x16x32_bf16 v[60:63], v[80:83], v[176:179], v[60:63]
    v_mfma_f32_16x16x32_bf16 v[40:43], v[80:83], v[172:175], v[40:43]
    s_waitcnt vmcnt(10) lgkmcnt(5)
    v_mfma_f32_16x16x32_bf16 v[44:47], v[84:87], v[184:187], v[44:47]
    ds_read_b128 v[64:67], v12 offset:9216
    v_mfma_f32_16x16x32_bf16 v[24:27], v[84:87], v[180:183], v[24:27]
    ds_read_b128 v[68:71], v12 offset:10240
    v_mfma_f32_16x16x32_bf16 v[48:51], v[88:91], v[184:187], v[48:51]
    ds_read_b128 v[72:75], v12 offset:11264
    v_mfma_f32_16x16x32_bf16 v[28:31], v[88:91], v[180:183], v[28:31]
    ds_read_b128 v[76:79], v12 offset:12288
    v_mfma_f32_16x16x32_bf16 v[52:55], v[92:95], v[184:187], v[52:55]
    ds_read_b128 v[80:83], v20 offset:17408
    v_mfma_f32_16x16x32_bf16 v[32:35], v[92:95], v[180:183], v[32:35]
    buffer_load_dwordx4 v[148:151], v16, s[4:7], s33 offen offset:2048 sc1
    v_mfma_f32_16x16x32_bf16 v[56:59], v[96:99], v[184:187], v[56:59]
    v_mfma_f32_16x16x32_bf16 v[36:39], v[96:99], v[180:183], v[36:39]
    buffer_load_dwordx4 v[152:155], v17, s[4:7], s33 offen offset:2048 sc1
    v_mfma_f32_16x16x32_bf16 v[60:63], v[100:103], v[184:187], v[60:63]
    v_mfma_f32_16x16x32_bf16 v[40:43], v[100:103], v[180:183], v[40:43]
    s_waitcnt vmcnt(12) lgkmcnt(5)
    v_mfma_f32_16x16x32_bf16 v[44:47], v[104:107], v[192:195], v[44:47]
    ds_read_b128 v[84:87], v12 offset:18432
    s_mov_b32 s32, 4
    s_lshl_b32 s32, s32, 13
    s_add_u32 s32, s32, s29
    s_add_u32 s33, s32, 4096
    v_mfma_f32_16x16x32_bf16 v[24:27], v[104:107], v[188:191], v[24:27]
    ds_read_b128 v[88:91], v12 offset:19456
    v_mfma_f32_16x16x32_bf16 v[48:51], v[108:111], v[192:195], v[48:51]
    ds_read_b128 v[92:95], v12 offset:20480
    v_mfma_f32_16x16x32_bf16 v[28:31], v[108:111], v[188:191], v[28:31]
    ds_read_b128 v[96:99], v12 offset:21504
    v_mfma_f32_16x16x32_bf16 v[52:55], v[112:115], v[192:195], v[52:55]
    ds_read_b128 v[100:103], v20 offset:26624
    v_mfma_f32_16x16x32_bf16 v[32:35], v[112:115], v[188:191], v[32:35]
    buffer_load_dwordx4 v[156:159], v16, s[4:7], s32 offen offset:0 sc1
    v_mfma_f32_16x16x32_bf16 v[56:59], v[116:119], v[192:195], v[56:59]
    v_mfma_f32_16x16x32_bf16 v[36:39], v[116:119], v[188:191], v[36:39]
    buffer_load_dwordx4 v[160:163], v17, s[4:7], s32 offen offset:0 sc1
    v_mfma_f32_16x16x32_bf16 v[60:63], v[120:123], v[192:195], v[60:63]
    v_mfma_f32_16x16x32_bf16 v[40:43], v[120:123], v[188:191], v[40:43]
    s_waitcnt vmcnt(14) lgkmcnt(5)
    v_mfma_f32_16x16x32_bf16 v[44:47], v[64:67], v[200:203], v[44:47]
    ds_read_b128 v[104:107], v12 offset:27648
    v_mfma_f32_16x16x32_bf16 v[24:27], v[64:67], v[196:199], v[24:27]
    ds_read_b128 v[108:111], v12 offset:28672
    v_mfma_f32_16x16x32_bf16 v[48:51], v[68:71], v[200:203], v[48:51]
    ds_read_b128 v[112:115], v12 offset:29696
    v_mfma_f32_16x16x32_bf16 v[28:31], v[68:71], v[196:199], v[28:31]
    ds_read_b128 v[116:119], v12 offset:30720
    v_mfma_f32_16x16x32_bf16 v[52:55], v[72:75], v[200:203], v[52:55]
    ds_read_b128 v[120:123], v20 offset:35840
    v_mfma_f32_16x16x32_bf16 v[32:35], v[72:75], v[196:199], v[32:35]
    buffer_load_dwordx4 v[164:167], v16, s[4:7], s32 offen offset:2048 sc1
    v_mfma_f32_16x16x32_bf16 v[56:59], v[76:79], v[200:203], v[56:59]
    v_mfma_f32_16x16x32_bf16 v[36:39], v[76:79], v[196:199], v[36:39]
    buffer_load_dwordx4 v[168:171], v17, s[4:7], s32 offen offset:2048 sc1
    v_mfma_f32_16x16x32_bf16 v[60:63], v[80:83], v[200:203], v[60:63]
    v_mfma_f32_16x16x32_bf16 v[40:43], v[80:83], v[196:199], v[40:43]
    s_waitcnt vmcnt(14) lgkmcnt(0)
    s_barrier
    v_mfma_f32_16x16x32_bf16 v[44:47], v[84:87], v[208:211], v[44:47]
    ds_read_b128 v[64:67], v13 offset:0
    v_mfma_f32_16x16x32_bf16 v[24:27], v[84:87], v[204:207], v[24:27]
    ds_read_b128 v[68:71], v13 offset:1024
    v_mfma_f32_16x16x32_bf16 v[48:51], v[88:91], v[208:211], v[48:51]
    ds_read_b128 v[72:75], v13 offset:2048
    v_mfma_f32_16x16x32_bf16 v[28:31], v[88:91], v[204:207], v[28:31]
    ds_read_b128 v[76:79], v13 offset:3072
    v_mfma_f32_16x16x32_bf16 v[52:55], v[92:95], v[208:211], v[52:55]
    ds_read_b128 v[80:83], v21 offset:8192
    v_mfma_f32_16x16x32_bf16 v[32:35], v[92:95], v[204:207], v[32:35]
    buffer_load_dwordx4 v[172:175], v16, s[4:7], s33 offen offset:0 sc1
    v_mfma_f32_16x16x32_bf16 v[56:59], v[96:99], v[208:211], v[56:59]
    v_mfma_f32_16x16x32_bf16 v[36:39], v[96:99], v[204:207], v[36:39]
    buffer_load_dwordx4 v[176:179], v17, s[4:7], s33 offen offset:0 sc1
    v_mfma_f32_16x16x32_bf16 v[60:63], v[100:103], v[208:211], v[60:63]
    v_mfma_f32_16x16x32_bf16 v[40:43], v[100:103], v[204:207], v[40:43]
    s_waitcnt vmcnt(14) lgkmcnt(5)
    v_mfma_f32_16x16x32_bf16 v[44:47], v[104:107], v[216:219], v[44:47]
    ds_read_b128 v[84:87], v13 offset:9216
    v_mfma_f32_16x16x32_bf16 v[24:27], v[104:107], v[212:215], v[24:27]
    ds_read_b128 v[88:91], v13 offset:10240
    v_mfma_f32_16x16x32_bf16 v[48:51], v[108:111], v[216:219], v[48:51]
    ds_read_b128 v[92:95], v13 offset:11264
    v_mfma_f32_16x16x32_bf16 v[28:31], v[108:111], v[212:215], v[28:31]
    ds_read_b128 v[96:99], v13 offset:12288
    v_mfma_f32_16x16x32_bf16 v[52:55], v[112:115], v[216:219], v[52:55]
    ds_read_b128 v[100:103], v21 offset:17408
    v_mfma_f32_16x16x32_bf16 v[32:35], v[112:115], v[212:215], v[32:35]
    buffer_load_dwordx4 v[180:183], v16, s[4:7], s33 offen offset:2048 sc1
    v_mfma_f32_16x16x32_bf16 v[56:59], v[116:119], v[216:219], v[56:59]
    v_mfma_f32_16x16x32_bf16 v[36:39], v[116:119], v[212:215], v[36:39]
    buffer_load_dwordx4 v[184:187], v17, s[4:7], s33 offen offset:2048 sc1
    v_mfma_f32_16x16x32_bf16 v[60:63], v[120:123], v[216:219], v[60:63]
    v_mfma_f32_16x16x32_bf16 v[40:43], v[120:123], v[212:215], v[40:43]
    s_waitcnt vmcnt(14) lgkmcnt(5)
    v_mfma_f32_16x16x32_bf16 v[44:47], v[64:67], v[128:131], v[44:47]
    ds_read_b128 v[104:107], v13 offset:18432
    s_mov_b32 s32, 5
    s_lshl_b32 s32, s32, 13
    s_add_u32 s32, s32, s29
    s_add_u32 s33, s32, 4096
    v_mfma_f32_16x16x32_bf16 v[24:27], v[64:67], v[124:127], v[24:27]
    ds_read_b128 v[108:111], v13 offset:19456
    v_mfma_f32_16x16x32_bf16 v[48:51], v[68:71], v[128:131], v[48:51]
    ds_read_b128 v[112:115], v13 offset:20480
    v_mfma_f32_16x16x32_bf16 v[28:31], v[68:71], v[124:127], v[28:31]
    ds_read_b128 v[116:119], v13 offset:21504
    v_mfma_f32_16x16x32_bf16 v[52:55], v[72:75], v[128:131], v[52:55]
    ds_read_b128 v[120:123], v21 offset:26624
    v_mfma_f32_16x16x32_bf16 v[32:35], v[72:75], v[124:127], v[32:35]
    buffer_load_dwordx4 v[188:191], v16, s[4:7], s32 offen offset:0 sc1
    v_mfma_f32_16x16x32_bf16 v[56:59], v[76:79], v[128:131], v[56:59]
    v_mfma_f32_16x16x32_bf16 v[36:39], v[76:79], v[124:127], v[36:39]
    buffer_load_dwordx4 v[192:195], v17, s[4:7], s32 offen offset:0 sc1
    v_mfma_f32_16x16x32_bf16 v[60:63], v[80:83], v[128:131], v[60:63]
    v_mfma_f32_16x16x32_bf16 v[40:43], v[80:83], v[124:127], v[40:43]
    s_waitcnt vmcnt(14) lgkmcnt(5)
    v_mfma_f32_16x16x32_bf16 v[44:47], v[84:87], v[136:139], v[44:47]
    ds_read_b128 v[64:67], v13 offset:27648
    v_mfma_f32_16x16x32_bf16 v[24:27], v[84:87], v[132:135], v[24:27]
    ds_read_b128 v[68:71], v13 offset:28672
    v_mfma_f32_16x16x32_bf16 v[48:51], v[88:91], v[136:139], v[48:51]
    ds_read_b128 v[72:75], v13 offset:29696
    v_mfma_f32_16x16x32_bf16 v[28:31], v[88:91], v[132:135], v[28:31]
    ds_read_b128 v[76:79], v13 offset:30720
    v_mfma_f32_16x16x32_bf16 v[52:55], v[92:95], v[136:139], v[52:55]
    ds_read_b128 v[80:83], v21 offset:35840
    v_mfma_f32_16x16x32_bf16 v[32:35], v[92:95], v[132:135], v[32:35]
    buffer_load_dwordx4 v[196:199], v16, s[4:7], s32 offen offset:2048 sc1
    v_mfma_f32_16x16x32_bf16 v[56:59], v[96:99], v[136:139], v[56:59]
    v_mfma_f32_16x16x32_bf16 v[36:39], v[96:99], v[132:135], v[36:39]
    buffer_load_dwordx4 v[200:203], v17, s[4:7], s32 offen offset:2048 sc1
    v_mfma_f32_16x16x32_bf16 v[60:63], v[100:103], v[136:139], v[60:63]
    v_mfma_f32_16x16x32_bf16 v[40:43], v[100:103], v[132:135], v[40:43]
    s_waitcnt vmcnt(14) lgkmcnt(0)
    s_barrier
    v_mfma_f32_16x16x32_bf16 v[44:47], v[104:107], v[144:147], v[44:47]
    ds_read_b128 v[84:87], v14 offset:0
    v_mfma_f32_16x16x32_bf16 v[24:27], v[104:107], v[140:143], v[24:27]
    ds_read_b128 v[88:91], v14 offset:1024
    v_mfma_f32_16x16x32_bf16 v[48:51], v[108:111], v[144:147], v[48:51]
    ds_read_b128 v[92:95], v14 offset:2048
    v_mfma_f32_16x16x32_bf16 v[28:31], v[108:111], v[140:143], v[28:31]
    ds_read_b128 v[96:99], v14 offset:3072
    v_mfma_f32_16x16x32_bf16 v[52:55], v[112:115], v[144:147], v[52:55]
    ds_read_b128 v[100:103], v22 offset:8192
    v_mfma_f32_16x16x32_bf16 v[32:35], v[112:115], v[140:143], v[32:35]
    buffer_load_dwordx4 v[204:207], v16, s[4:7], s33 offen offset:0 sc1
    v_mfma_f32_16x16x32_bf16 v[56:59], v[116:119], v[144:147], v[56:59]
    v_mfma_f32_16x16x32_bf16 v[36:39], v[116:119], v[140:143], v[36:39]
    buffer_load_dwordx4 v[208:211], v17, s[4:7], s33 offen offset:0 sc1
    v_mfma_f32_16x16x32_bf16 v[60:63], v[120:123], v[144:147], v[60:63]
    v_mfma_f32_16x16x32_bf16 v[40:43], v[120:123], v[140:143], v[40:43]
    s_waitcnt vmcnt(14) lgkmcnt(5)
    v_mfma_f32_16x16x32_bf16 v[44:47], v[64:67], v[152:155], v[44:47]
    ds_read_b128 v[104:107], v14 offset:9216
    v_mfma_f32_16x16x32_bf16 v[24:27], v[64:67], v[148:151], v[24:27]
    ds_read_b128 v[108:111], v14 offset:10240
    v_mfma_f32_16x16x32_bf16 v[48:51], v[68:71], v[152:155], v[48:51]
    ds_read_b128 v[112:115], v14 offset:11264
    v_mfma_f32_16x16x32_bf16 v[28:31], v[68:71], v[148:151], v[28:31]
    ds_read_b128 v[116:119], v14 offset:12288
    v_mfma_f32_16x16x32_bf16 v[52:55], v[72:75], v[152:155], v[52:55]
    ds_read_b128 v[120:123], v22 offset:17408
    v_mfma_f32_16x16x32_bf16 v[32:35], v[72:75], v[148:151], v[32:35]
    buffer_load_dwordx4 v[212:215], v16, s[4:7], s33 offen offset:2048 sc1
    v_mfma_f32_16x16x32_bf16 v[56:59], v[76:79], v[152:155], v[56:59]
    v_mfma_f32_16x16x32_bf16 v[36:39], v[76:79], v[148:151], v[36:39]
    buffer_load_dwordx4 v[216:219], v17, s[4:7], s33 offen offset:2048 sc1
    v_mfma_f32_16x16x32_bf16 v[60:63], v[80:83], v[152:155], v[60:63]
    v_mfma_f32_16x16x32_bf16 v[40:43], v[80:83], v[148:151], v[40:43]
    s_waitcnt vmcnt(14) lgkmcnt(5)
    v_mfma_f32_16x16x32_bf16 v[44:47], v[84:87], v[160:163], v[44:47]
    ds_read_b128 v[64:67], v14 offset:18432
    s_mov_b32 s32, 6
    s_lshl_b32 s32, s32, 13
    s_add_u32 s32, s32, s29
    s_add_u32 s33, s32, 4096
    v_mfma_f32_16x16x32_bf16 v[24:27], v[84:87], v[156:159], v[24:27]
    ds_read_b128 v[68:71], v14 offset:19456
    v_mfma_f32_16x16x32_bf16 v[48:51], v[88:91], v[160:163], v[48:51]
    ds_read_b128 v[72:75], v14 offset:20480
    v_mfma_f32_16x16x32_bf16 v[28:31], v[88:91], v[156:159], v[28:31]
    ds_read_b128 v[76:79], v14 offset:21504
    v_mfma_f32_16x16x32_bf16 v[52:55], v[92:95], v[160:163], v[52:55]
    ds_read_b128 v[80:83], v22 offset:26624
    v_mfma_f32_16x16x32_bf16 v[32:35], v[92:95], v[156:159], v[32:35]
    buffer_load_dwordx4 v[124:127], v16, s[4:7], s32 offen offset:0 sc1
    v_mfma_f32_16x16x32_bf16 v[56:59], v[96:99], v[160:163], v[56:59]
    v_mfma_f32_16x16x32_bf16 v[36:39], v[96:99], v[156:159], v[36:39]
    buffer_load_dwordx4 v[128:131], v17, s[4:7], s32 offen offset:0 sc1
    v_mfma_f32_16x16x32_bf16 v[60:63], v[100:103], v[160:163], v[60:63]
    v_mfma_f32_16x16x32_bf16 v[40:43], v[100:103], v[156:159], v[40:43]
    s_waitcnt vmcnt(14) lgkmcnt(5)
    v_mfma_f32_16x16x32_bf16 v[44:47], v[104:107], v[168:171], v[44:47]
    ds_read_b128 v[84:87], v14 offset:27648
    v_mfma_f32_16x16x32_bf16 v[24:27], v[104:107], v[164:167], v[24:27]
    ds_read_b128 v[88:91], v14 offset:28672
    v_mfma_f32_16x16x32_bf16 v[48:51], v[108:111], v[168:171], v[48:51]
    ds_read_b128 v[92:95], v14 offset:29696
    v_mfma_f32_16x16x32_bf16 v[28:31], v[108:111], v[164:167], v[28:31]
    ds_read_b128 v[96:99], v14 offset:30720
    v_mfma_f32_16x16x32_bf16 v[52:55], v[112:115], v[168:171], v[52:55]
    ds_read_b128 v[100:103], v22 offset:35840
    v_mfma_f32_16x16x32_bf16 v[32:35], v[112:115], v[164:167], v[32:35]
    buffer_load_dwordx4 v[132:135], v16, s[4:7], s32 offen offset:2048 sc1
    v_mfma_f32_16x16x32_bf16 v[56:59], v[116:119], v[168:171], v[56:59]
    v_mfma_f32_16x16x32_bf16 v[36:39], v[116:119], v[164:167], v[36:39]
    buffer_load_dwordx4 v[136:139], v17, s[4:7], s32 offen offset:2048 sc1
    v_mfma_f32_16x16x32_bf16 v[60:63], v[120:123], v[168:171], v[60:63]
    v_mfma_f32_16x16x32_bf16 v[40:43], v[120:123], v[164:167], v[40:43]
    s_waitcnt vmcnt(14) lgkmcnt(0)
    s_barrier
    v_mfma_f32_16x16x32_bf16 v[44:47], v[64:67], v[176:179], v[44:47]
    ds_read_b128 v[104:107], v15 offset:0
    v_mfma_f32_16x16x32_bf16 v[24:27], v[64:67], v[172:175], v[24:27]
    ds_read_b128 v[108:111], v15 offset:1024
    v_mfma_f32_16x16x32_bf16 v[48:51], v[68:71], v[176:179], v[48:51]
    ds_read_b128 v[112:115], v15 offset:2048
    v_mfma_f32_16x16x32_bf16 v[28:31], v[68:71], v[172:175], v[28:31]
    ds_read_b128 v[116:119], v15 offset:3072
    v_mfma_f32_16x16x32_bf16 v[52:55], v[72:75], v[176:179], v[52:55]
    ds_read_b128 v[120:123], v23 offset:8192
    v_mfma_f32_16x16x32_bf16 v[32:35], v[72:75], v[172:175], v[32:35]
    buffer_load_dwordx4 v[140:143], v16, s[4:7], s33 offen offset:0 sc1
    v_mfma_f32_16x16x32_bf16 v[56:59], v[76:79], v[176:179], v[56:59]
    v_mfma_f32_16x16x32_bf16 v[36:39], v[76:79], v[172:175], v[36:39]
    buffer_load_dwordx4 v[144:147], v17, s[4:7], s33 offen offset:0 sc1
    v_mfma_f32_16x16x32_bf16 v[60:63], v[80:83], v[176:179], v[60:63]
    v_mfma_f32_16x16x32_bf16 v[40:43], v[80:83], v[172:175], v[40:43]
    s_waitcnt vmcnt(14) lgkmcnt(5)
    v_mfma_f32_16x16x32_bf16 v[44:47], v[84:87], v[184:187], v[44:47]
    ds_read_b128 v[64:67], v15 offset:9216
    v_mfma_f32_16x16x32_bf16 v[24:27], v[84:87], v[180:183], v[24:27]
    ds_read_b128 v[68:71], v15 offset:10240
    v_mfma_f32_16x16x32_bf16 v[48:51], v[88:91], v[184:187], v[48:51]
    ds_read_b128 v[72:75], v15 offset:11264
    v_mfma_f32_16x16x32_bf16 v[28:31], v[88:91], v[180:183], v[28:31]
    ds_read_b128 v[76:79], v15 offset:12288
    v_mfma_f32_16x16x32_bf16 v[52:55], v[92:95], v[184:187], v[52:55]
    ds_read_b128 v[80:83], v23 offset:17408
    v_mfma_f32_16x16x32_bf16 v[32:35], v[92:95], v[180:183], v[32:35]
    buffer_load_dwordx4 v[148:151], v16, s[4:7], s33 offen offset:2048 sc1
    v_mfma_f32_16x16x32_bf16 v[56:59], v[96:99], v[184:187], v[56:59]
    v_mfma_f32_16x16x32_bf16 v[36:39], v[96:99], v[180:183], v[36:39]
    buffer_load_dwordx4 v[152:155], v17, s[4:7], s33 offen offset:2048 sc1
    v_mfma_f32_16x16x32_bf16 v[60:63], v[100:103], v[184:187], v[60:63]
    v_mfma_f32_16x16x32_bf16 v[40:43], v[100:103], v[180:183], v[40:43]
    s_waitcnt vmcnt(14) lgkmcnt(5)
    v_mfma_f32_16x16x32_bf16 v[44:47], v[104:107], v[192:195], v[44:47]
    ds_read_b128 v[84:87], v15 offset:18432
    s_mov_b32 s32, 7
    s_lshl_b32 s32, s32, 13
    s_add_u32 s32, s32, s29
    s_add_u32 s33, s32, 4096
    v_mfma_f32_16x16x32_bf16 v[24:27], v[104:107], v[188:191], v[24:27]
    ds_read_b128 v[88:91], v15 offset:19456
    v_mfma_f32_16x16x32_bf16 v[48:51], v[108:111], v[192:195], v[48:51]
    ds_read_b128 v[92:95], v15 offset:20480
    v_mfma_f32_16x16x32_bf16 v[28:31], v[108:111], v[188:191], v[28:31]
    ds_read_b128 v[96:99], v15 offset:21504
    v_mfma_f32_16x16x32_bf16 v[52:55], v[112:115], v[192:195], v[52:55]
    ds_read_b128 v[100:103], v23 offset:26624
    v_mfma_f32_16x16x32_bf16 v[32:35], v[112:115], v[188:191], v[32:35]
    buffer_load_dwordx4 v[156:159], v16, s[4:7], s32 offen offset:0 sc1
    v_mfma_f32_16x16x32_bf16 v[56:59], v[116:119], v[192:195], v[56:59]
    v_mfma_f32_16x16x32_bf16 v[36:39], v[116:119], v[188:191], v[36:39]
    buffer_load_dwordx4 v[160:163], v17, s[4:7], s32 offen offset:0 sc1
    v_mfma_f32_16x16x32_bf16 v[60:63], v[120:123], v[192:195], v[60:63]
    v_mfma_f32_16x16x32_bf16 v[40:43], v[120:123], v[188:191], v[40:43]
    s_waitcnt vmcnt(14) lgkmcnt(5)
    v_mfma_f32_16x16x32_bf16 v[44:47], v[64:67], v[200:203], v[44:47]
    ds_read_b128 v[104:107], v15 offset:27648
    v_mfma_f32_16x16x32_bf16 v[24:27], v[64:67], v[196:199], v[24:27]
    ds_read_b128 v[108:111], v15 offset:28672
    v_mfma_f32_16x16x32_bf16 v[48:51], v[68:71], v[200:203], v[48:51]
    ds_read_b128 v[112:115], v15 offset:29696
    v_mfma_f32_16x16x32_bf16 v[28:31], v[68:71], v[196:199], v[28:31]
    ds_read_b128 v[116:119], v15 offset:30720
    v_mfma_f32_16x16x32_bf16 v[52:55], v[72:75], v[200:203], v[52:55]
    ds_read_b128 v[120:123], v23 offset:35840
    v_mfma_f32_16x16x32_bf16 v[32:35], v[72:75], v[196:199], v[32:35]
    buffer_load_dwordx4 v[164:167], v16, s[4:7], s32 offen offset:2048 sc1
    v_mfma_f32_16x16x32_bf16 v[56:59], v[76:79], v[200:203], v[56:59]
    v_mfma_f32_16x16x32_bf16 v[36:39], v[76:79], v[196:199], v[36:39]
    buffer_load_dwordx4 v[168:171], v17, s[4:7], s32 offen offset:2048 sc1
    v_mfma_f32_16x16x32_bf16 v[60:63], v[80:83], v[200:203], v[60:63]
    v_mfma_f32_16x16x32_bf16 v[40:43], v[80:83], v[196:199], v[40:43]
    s_waitcnt vmcnt(14) lgkmcnt(0)
    s_barrier
    v_mfma_f32_16x16x32_bf16 v[44:47], v[84:87], v[208:211], v[44:47]
    ds_read_b128 v[64:67], v12 offset:0
    v_mfma_f32_16x16x32_bf16 v[24:27], v[84:87], v[204:207], v[24:27]
    ds_read_b128 v[68:71], v12 offset:1024
    v_mfma_f32_16x16x32_bf16 v[48:51], v[88:91], v[208:211], v[48:51]
    ds_read_b128 v[72:75], v12 offset:2048
    v_mfma_f32_16x16x32_bf16 v[28:31], v[88:91], v[204:207], v[28:31]
    ds_read_b128 v[76:79], v12 offset:3072
    v_mfma_f32_16x16x32_bf16 v[52:55], v[92:95], v[208:211], v[52:55]
    ds_read_b128 v[80:83], v20 offset:8192
    v_mfma_f32_16x16x32_bf16 v[32:35], v[92:95], v[204:207], v[32:35]
    buffer_load_dwordx4 v[172:175], v16, s[4:7], s33 offen offset:0 sc1
    v_mfma_f32_16x16x32_bf16 v[56:59], v[96:99], v[208:211], v[56:59]
    v_mfma_f32_16x16x32_bf16 v[36:39], v[96:99], v[204:207], v[36:39]
    buffer_load_dwordx4 v[176:179], v17, s[4:7], s33 offen offset:0 sc1
    v_mfma_f32_16x16x32_bf16 v[60:63], v[100:103], v[208:211], v[60:63]
    v_mfma_f32_16x16x32_bf16 v[40:43], v[100:103], v[204:207], v[40:43]
    s_waitcnt vmcnt(14) lgkmcnt(5)
    v_mfma_f32_16x16x32_bf16 v[44:47], v[104:107], v[216:219], v[44:47]
    ds_read_b128 v[84:87], v12 offset:9216
    v_mfma_f32_16x16x32_bf16 v[24:27], v[104:107], v[212:215], v[24:27]
    ds_read_b128 v[88:91], v12 offset:10240
    v_mfma_f32_16x16x32_bf16 v[48:51], v[108:111], v[216:219], v[48:51]
    ds_read_b128 v[92:95], v12 offset:11264
    v_mfma_f32_16x16x32_bf16 v[28:31], v[108:111], v[212:215], v[28:31]
    ds_read_b128 v[96:99], v12 offset:12288
    v_mfma_f32_16x16x32_bf16 v[52:55], v[112:115], v[216:219], v[52:55]
    ds_read_b128 v[100:103], v20 offset:17408
    v_mfma_f32_16x16x32_bf16 v[32:35], v[112:115], v[212:215], v[32:35]
    buffer_load_dwordx4 v[180:183], v16, s[4:7], s33 offen offset:2048 sc1
    v_mfma_f32_16x16x32_bf16 v[56:59], v[116:119], v[216:219], v[56:59]
    v_mfma_f32_16x16x32_bf16 v[36:39], v[116:119], v[212:215], v[36:39]
    buffer_load_dwordx4 v[184:187], v17, s[4:7], s33 offen offset:2048 sc1
    v_mfma_f32_16x16x32_bf16 v[60:63], v[120:123], v[216:219], v[60:63]
    v_mfma_f32_16x16x32_bf16 v[40:43], v[120:123], v[212:215], v[40:43]
    s_waitcnt vmcnt(14) lgkmcnt(5)
    v_mfma_f32_16x16x32_bf16 v[44:47], v[64:67], v[128:131], v[44:47]
    ds_read_b128 v[104:107], v12 offset:18432
    s_mov_b32 s32, 8
    s_lshl_b32 s32, s32, 13
    s_add_u32 s32, s32, s29
    s_add_u32 s33, s32, 4096
    v_mfma_f32_16x16x32_bf16 v[24:27], v[64:67], v[124:127], v[24:27]
    ds_read_b128 v[108:111], v12 offset:19456
    v_mfma_f32_16x16x32_bf16 v[48:51], v[68:71], v[128:131], v[48:51]
    ds_read_b128 v[112:115], v12 offset:20480
    v_mfma_f32_16x16x32_bf16 v[28:31], v[68:71], v[124:127], v[28:31]
    ds_read_b128 v[116:119], v12 offset:21504
    v_mfma_f32_16x16x32_bf16 v[52:55], v[72:75], v[128:131], v[52:55]
    ds_read_b128 v[120:123], v20 offset:26624
    v_mfma_f32_16x16x32_bf16 v[32:35], v[72:75], v[124:127], v[32:35]
    buffer_load_dwordx4 v[188:191], v18, s[4:7], s32 offen offset:0 sc1
    v_mfma_f32_16x16x32_bf16 v[56:59], v[76:79], v[128:131], v[56:59]
    v_mfma_f32_16x16x32_bf16 v[36:39], v[76:79], v[124:127], v[36:39]
    buffer_load_dwordx4 v[192:195], v19, s[4:7], s32 offen offset:0 sc1
    v_mfma_f32_16x16x32_bf16 v[60:63], v[80:83], v[128:131], v[60:63]
    v_mfma_f32_16x16x32_bf16 v[40:43], v[80:83], v[124:127], v[40:43]
    s_waitcnt vmcnt(14) lgkmcnt(5)
    v_mfma_f32_16x16x32_bf16 v[44:47], v[84:87], v[136:139], v[44:47]
    ds_read_b128 v[64:67], v12 offset:27648
    v_mfma_f32_16x16x32_bf16 v[24:27], v[84:87], v[132:135], v[24:27]
    ds_read_b128 v[68:71], v12 offset:28672
    v_mfma_f32_16x16x32_bf16 v[48:51], v[88:91], v[136:139], v[48:51]
    ds_read_b128 v[72:75], v12 offset:29696
    v_mfma_f32_16x16x32_bf16 v[28:31], v[88:91], v[132:135], v[28:31]
    ds_read_b128 v[76:79], v12 offset:30720
    v_mfma_f32_16x16x32_bf16 v[52:55], v[92:95], v[136:139], v[52:55]
    ds_read_b128 v[80:83], v20 offset:35840
    v_mfma_f32_16x16x32_bf16 v[32:35], v[92:95], v[132:135], v[32:35]
    buffer_load_dwordx4 v[196:199], v18, s[4:7], s32 offen offset:2048 sc1
    v_mfma_f32_16x16x32_bf16 v[56:59], v[96:99], v[136:139], v[56:59]
    v_mfma_f32_16x16x32_bf16 v[36:39], v[96:99], v[132:135], v[36:39]
    buffer_load_dwordx4 v[200:203], v19, s[4:7], s32 offen offset:2048 sc1
    v_mfma_f32_16x16x32_bf16 v[60:63], v[100:103], v[136:139], v[60:63]
    v_mfma_f32_16x16x32_bf16 v[40:43], v[100:103], v[132:135], v[40:43]
    s_waitcnt vmcnt(14) lgkmcnt(0)
    s_barrier
    v_mfma_f32_16x16x32_bf16 v[44:47], v[104:107], v[144:147], v[44:47]
    ds_read_b128 v[84:87], v13 offset:0
    v_mfma_f32_16x16x32_bf16 v[24:27], v[104:107], v[140:143], v[24:27]
    ds_read_b128 v[88:91], v13 offset:1024
    v_mfma_f32_16x16x32_bf16 v[48:51], v[108:111], v[144:147], v[48:51]
    ds_read_b128 v[92:95], v13 offset:2048
    v_mfma_f32_16x16x32_bf16 v[28:31], v[108:111], v[140:143], v[28:31]
    ds_read_b128 v[96:99], v13 offset:3072
    v_mfma_f32_16x16x32_bf16 v[52:55], v[112:115], v[144:147], v[52:55]
    ds_read_b128 v[100:103], v21 offset:8192
    v_mfma_f32_16x16x32_bf16 v[32:35], v[112:115], v[140:143], v[32:35]
    buffer_load_dwordx4 v[204:207], v18, s[4:7], s33 offen offset:0 sc1
    v_mfma_f32_16x16x32_bf16 v[56:59], v[116:119], v[144:147], v[56:59]
    v_mfma_f32_16x16x32_bf16 v[36:39], v[116:119], v[140:143], v[36:39]
    buffer_load_dwordx4 v[208:211], v19, s[4:7], s33 offen offset:0 sc1
    v_mfma_f32_16x16x32_bf16 v[60:63], v[120:123], v[144:147], v[60:63]
    v_mfma_f32_16x16x32_bf16 v[40:43], v[120:123], v[140:143], v[40:43]
    s_waitcnt vmcnt(14) lgkmcnt(5)
    v_mfma_f32_16x16x32_bf16 v[44:47], v[64:67], v[152:155], v[44:47]
    ds_read_b128 v[104:107], v13 offset:9216
    v_mfma_f32_16x16x32_bf16 v[24:27], v[64:67], v[148:151], v[24:27]
    ds_read_b128 v[108:111], v13 offset:10240
    v_mfma_f32_16x16x32_bf16 v[48:51], v[68:71], v[152:155], v[48:51]
    ds_read_b128 v[112:115], v13 offset:11264
    v_mfma_f32_16x16x32_bf16 v[28:31], v[68:71], v[148:151], v[28:31]
    ds_read_b128 v[116:119], v13 offset:12288
    v_mfma_f32_16x16x32_bf16 v[52:55], v[72:75], v[152:155], v[52:55]
    ds_read_b128 v[120:123], v21 offset:17408
    v_mfma_f32_16x16x32_bf16 v[32:35], v[72:75], v[148:151], v[32:35]
    buffer_load_dwordx4 v[212:215], v18, s[4:7], s33 offen offset:2048 sc1
    v_mfma_f32_16x16x32_bf16 v[56:59], v[76:79], v[152:155], v[56:59]
    v_mfma_f32_16x16x32_bf16 v[36:39], v[76:79], v[148:151], v[36:39]
    buffer_load_dwordx4 v[216:219], v19, s[4:7], s33 offen offset:2048 sc1
    v_mfma_f32_16x16x32_bf16 v[60:63], v[80:83], v[152:155], v[60:63]
    v_mfma_f32_16x16x32_bf16 v[40:43], v[80:83], v[148:151], v[40:43]
    s_waitcnt vmcnt(14) lgkmcnt(5)
    v_mfma_f32_16x16x32_bf16 v[44:47], v[84:87], v[160:163], v[44:47]
    ds_read_b128 v[64:67], v13 offset:18432
    v_mfma_f32_16x16x32_bf16 v[24:27], v[84:87], v[156:159], v[24:27]
    ds_read_b128 v[68:71], v13 offset:19456
    v_mfma_f32_16x16x32_bf16 v[48:51], v[88:91], v[160:163], v[48:51]
    ds_read_b128 v[72:75], v13 offset:20480
    v_mfma_f32_16x16x32_bf16 v[28:31], v[88:91], v[156:159], v[28:31]
    ds_read_b128 v[76:79], v13 offset:21504
    v_mfma_f32_16x16x32_bf16 v[52:55], v[92:95], v[160:163], v[52:55]
    ds_read_b128 v[80:83], v21 offset:26624
    v_mfma_f32_16x16x32_bf16 v[32:35], v[92:95], v[156:159], v[32:35]
    v_mfma_f32_16x16x32_bf16 v[56:59], v[96:99], v[160:163], v[56:59]
    v_mfma_f32_16x16x32_bf16 v[36:39], v[96:99], v[156:159], v[36:39]
    v_mfma_f32_16x16x32_bf16 v[60:63], v[100:103], v[160:163], v[60:63]
    v_mfma_f32_16x16x32_bf16 v[40:43], v[100:103], v[156:159], v[40:43]
    s_waitcnt vmcnt(12) lgkmcnt(5)
    v_mfma_f32_16x16x32_bf16 v[44:47], v[104:107], v[168:171], v[44:47]
    ds_read_b128 v[84:87], v13 offset:27648
    v_mfma_f32_16x16x32_bf16 v[24:27], v[104:107], v[164:167], v[24:27]
    ds_read_b128 v[88:91], v13 offset:28672
    v_mfma_f32_16x16x32_bf16 v[48:51], v[108:111], v[168:171], v[48:51]
    ds_read_b128 v[92:95], v13 offset:29696
    v_mfma_f32_16x16x32_bf16 v[28:31], v[108:111], v[164:167], v[28:31]
    ds_read_b128 v[96:99], v13 offset:30720
    v_mfma_f32_16x16x32_bf16 v[52:55], v[112:115], v[168:171], v[52:55]
    ds_read_b128 v[100:103], v21 offset:35840
    v_mfma_f32_16x16x32_bf16 v[32:35], v[112:115], v[164:167], v[32:35]
    v_mfma_f32_16x16x32_bf16 v[56:59], v[116:119], v[168:171], v[56:59]
    v_mfma_f32_16x16x32_bf16 v[36:39], v[116:119], v[164:167], v[36:39]
    v_mfma_f32_16x16x32_bf16 v[60:63], v[120:123], v[168:171], v[60:63]
    v_mfma_f32_16x16x32_bf16 v[40:43], v[120:123], v[164:167], v[40:43]
    s_waitcnt vmcnt(10) lgkmcnt(0)
    s_barrier
    v_mfma_f32_16x16x32_bf16 v[44:47], v[64:67], v[176:179], v[44:47]
    ds_read_b128 v[104:107], v14 offset:0
    v_mfma_f32_16x16x32_bf16 v[24:27], v[64:67], v[172:175], v[24:27]
    ds_read_b128 v[108:111], v14 offset:1024
    v_mfma_f32_16x16x32_bf16 v[48:51], v[68:71], v[176:179], v[48:51]
    ds_read_b128 v[112:115], v14 offset:2048
    v_mfma_f32_16x16x32_bf16 v[28:31], v[68:71], v[172:175], v[28:31]
    ds_read_b128 v[116:119], v14 offset:3072
    v_mfma_f32_16x16x32_bf16 v[52:55], v[72:75], v[176:179], v[52:55]
    ds_read_b128 v[120:123], v22 offset:8192
    v_mfma_f32_16x16x32_bf16 v[32:35], v[72:75], v[172:175], v[32:35]
    v_mfma_f32_16x16x32_bf16 v[56:59], v[76:79], v[176:179], v[56:59]
    v_mfma_f32_16x16x32_bf16 v[36:39], v[76:79], v[172:175], v[36:39]
    v_mfma_f32_16x16x32_bf16 v[60:63], v[80:83], v[176:179], v[60:63]
    v_mfma_f32_16x16x32_bf16 v[40:43], v[80:83], v[172:175], v[40:43]
    s_waitcnt vmcnt(8) lgkmcnt(5)
    v_mfma_f32_16x16x32_bf16 v[44:47], v[84:87], v[184:187], v[44:47]
    ds_read_b128 v[64:67], v14 offset:9216
    v_mfma_f32_16x16x32_bf16 v[24:27], v[84:87], v[180:183], v[24:27]
    ds_read_b128 v[68:71], v14 offset:10240
    v_mfma_f32_16x16x32_bf16 v[48:51], v[88:91], v[184:187], v[48:51]
    ds_read_b128 v[72:75], v14 offset:11264
    v_mfma_f32_16x16x32_bf16 v[28:31], v[88:91], v[180:183], v[28:31]
    ds_read_b128 v[76:79], v14 offset:12288
    v_mfma_f32_16x16x32_bf16 v[52:55], v[92:95], v[184:187], v[52:55]
    ds_read_b128 v[80:83], v22 offset:17408
    v_mfma_f32_16x16x32_bf16 v[32:35], v[92:95], v[180:183], v[32:35]
    s_waitcnt vmcnt(6)
    v_mfma_f32_16x16x32_bf16 v[56:59], v[96:99], v[184:187], v[56:59]
    v_swap_b32 v190, v192
    v_mfma_f32_16x16x32_bf16 v[36:39], v[96:99], v[180:183], v[36:39]
    v_swap_b32 v191, v193
    v_mfma_f32_16x16x32_bf16 v[60:63], v[100:103], v[184:187], v[60:63]
    v_mfma_f32_16x16x32_bf16 v[40:43], v[100:103], v[180:183], v[40:43]
    s_waitcnt vmcnt(6) lgkmcnt(5)
    v_mfma_f32_16x16x32_bf16 v[44:47], v[104:107], v[192:195], v[44:47]
    ds_read_b128 v[84:87], v14 offset:18432
    v_mfma_f32_16x16x32_bf16 v[24:27], v[104:107], v[188:191], v[24:27]
    ds_read_b128 v[88:91], v14 offset:19456
    v_mfma_f32_16x16x32_bf16 v[48:51], v[108:111], v[192:195], v[48:51]
    ds_read_b128 v[92:95], v14 offset:20480
    v_mfma_f32_16x16x32_bf16 v[28:31], v[108:111], v[188:191], v[28:31]
    ds_read_b128 v[96:99], v14 offset:21504
    v_mfma_f32_16x16x32_bf16 v[52:55], v[112:115], v[192:195], v[52:55]
    ds_read_b128 v[100:103], v22 offset:26624
    v_mfma_f32_16x16x32_bf16 v[32:35], v[112:115], v[188:191], v[32:35]
    s_waitcnt vmcnt(4)
    v_mfma_f32_16x16x32_bf16 v[56:59], v[116:119], v[192:195], v[56:59]
    v_swap_b32 v198, v200
    v_mfma_f32_16x16x32_bf16 v[36:39], v[116:119], v[188:191], v[36:39]
    v_swap_b32 v199, v201
    v_mfma_f32_16x16x32_bf16 v[60:63], v[120:123], v[192:195], v[60:63]
    v_mfma_f32_16x16x32_bf16 v[40:43], v[120:123], v[188:191], v[40:43]
    s_waitcnt vmcnt(4) lgkmcnt(5)
    v_mfma_f32_16x16x32_bf16 v[44:47], v[64:67], v[200:203], v[44:47]
    ds_read_b128 v[104:107], v14 offset:27648
    v_mfma_f32_16x16x32_bf16 v[24:27], v[64:67], v[196:199], v[24:27]
    ds_read_b128 v[108:111], v14 offset:28672
    v_mfma_f32_16x16x32_bf16 v[48:51], v[68:71], v[200:203], v[48:51]
    ds_read_b128 v[112:115], v14 offset:29696
    v_mfma_f32_16x16x32_bf16 v[28:31], v[68:71], v[196:199], v[28:31]
    ds_read_b128 v[116:119], v14 offset:30720
    v_mfma_f32_16x16x32_bf16 v[52:55], v[72:75], v[200:203], v[52:55]
    ds_read_b128 v[120:123], v22 offset:35840
    v_mfma_f32_16x16x32_bf16 v[32:35], v[72:75], v[196:199], v[32:35]
    s_waitcnt vmcnt(2)
    v_mfma_f32_16x16x32_bf16 v[56:59], v[76:79], v[200:203], v[56:59]
    v_swap_b32 v206, v208
    v_mfma_f32_16x16x32_bf16 v[36:39], v[76:79], v[196:199], v[36:39]
    v_swap_b32 v207, v209
    v_mfma_f32_16x16x32_bf16 v[60:63], v[80:83], v[200:203], v[60:63]
    v_mfma_f32_16x16x32_bf16 v[40:43], v[80:83], v[196:199], v[40:43]
    s_waitcnt vmcnt(2) lgkmcnt(5)
    v_mfma_f32_16x16x32_bf16 v[44:47], v[84:87], v[208:211], v[44:47]
    v_mfma_f32_16x16x32_bf16 v[24:27], v[84:87], v[204:207], v[24:27]
    v_mfma_f32_16x16x32_bf16 v[48:51], v[88:91], v[208:211], v[48:51]
    v_mfma_f32_16x16x32_bf16 v[28:31], v[88:91], v[204:207], v[28:31]
    v_mfma_f32_16x16x32_bf16 v[52:55], v[92:95], v[208:211], v[52:55]
    v_mfma_f32_16x16x32_bf16 v[32:35], v[92:95], v[204:207], v[32:35]
    s_waitcnt vmcnt(0)
    v_mfma_f32_16x16x32_bf16 v[56:59], v[96:99], v[208:211], v[56:59]
    v_swap_b32 v214, v216
    v_mfma_f32_16x16x32_bf16 v[36:39], v[96:99], v[204:207], v[36:39]
    v_swap_b32 v215, v217
    v_mfma_f32_16x16x32_bf16 v[60:63], v[100:103], v[208:211], v[60:63]
    v_mfma_f32_16x16x32_bf16 v[40:43], v[100:103], v[204:207], v[40:43]
    s_waitcnt vmcnt(0) lgkmcnt(0)
    v_mfma_f32_16x16x32_bf16 v[44:47], v[104:107], v[216:219], v[44:47]
    v_mfma_f32_16x16x32_bf16 v[48:51], v[108:111], v[216:219], v[48:51]
    v_mfma_f32_16x16x32_bf16 v[52:55], v[112:115], v[216:219], v[52:55]
    v_mfma_f32_16x16x32_bf16 v[56:59], v[116:119], v[216:219], v[56:59]
    v_mfma_f32_16x16x32_bf16 v[60:63], v[120:123], v[216:219], v[60:63]
    v_mfma_f32_16x16x32_bf16 v[24:27], v[104:107], v[212:215], v[24:27]
    v_mfma_f32_16x16x32_bf16 v[28:31], v[108:111], v[212:215], v[28:31]
    v_mfma_f32_16x16x32_bf16 v[32:35], v[112:115], v[212:215], v[32:35]
    v_mfma_f32_16x16x32_bf16 v[36:39], v[116:119], v[212:215], v[36:39]
    v_mfma_f32_16x16x32_bf16 v[40:43], v[120:123], v[212:215], v[40:43]
    ds_write_b128 v2, v[44:47] offset:0
    ds_write_b128 v2, v[48:51] offset:1024
    ds_write_b128 v2, v[52:55] offset:2048
    ds_write_b128 v2, v[56:59] offset:3072
    s_mov_b64 exec, s[40:41]
    ds_write_b128 v3, v[60:63] offset:4096
    s_mov_b64 exec, -1
    ds_write_b32 v0, v9
    s_mov_b32 s60, 1048576
L_px_p5:
    ds_read_b32 v232, v6
    ds_read_b128 v[64:67], v7 offset:0
    ds_read_b128 v[68:71], v7 offset:1024
    ds_read_b128 v[72:75], v7 offset:2048
    ds_read_b128 v[76:79], v7 offset:3072
    ds_read_b128 v[80:83], v8 offset:4096
    s_waitcnt lgkmcnt(5)
    v_cmp_ne_u32_e64 vcc, s43, v232
    s_sub_u32 s60, s60, 1
    s_cbranch_scc1 L_py_p5
    s_cbranch_vccnz L_px_p5
L_py_p5:
    s_waitcnt lgkmcnt(4)
    v_pk_add_f32 v[24:25], v[24:25], v[64:65]
    v_pk_add_f32 v[26:27], v[26:27], v[66:67]
    v_cvt_pk_bf16_f32 v220, v24, v25
    v_cvt_pk_bf16_f32 v221, v26, v27
    s_waitcnt lgkmcnt(3)
    v_pk_add_f32 v[28:29], v[28:29], v[68:69]
    v_pk_add_f32 v[30:31], v[30:31], v[70:71]
    v_cvt_pk_bf16_f32 v222, v28, v29
    v_cvt_pk_bf16_f32 v223, v30, v31
    s_waitcnt lgkmcnt(2)
    v_pk_add_f32 v[32:33], v[32:33], v[72:73]
    v_pk_add_f32 v[34:35], v[34:35], v[74:75]
    v_cvt_pk_bf16_f32 v224, v32, v33
    v_cvt_pk_bf16_f32 v225, v34, v35
    s_waitcnt lgkmcnt(1)
    v_pk_add_f32 v[36:37], v[36:37], v[76:77]
    v_pk_add_f32 v[38:39], v[38:39], v[78:79]
    v_cvt_pk_bf16_f32 v226, v36, v37
    v_cvt_pk_bf16_f32 v227, v38, v39
    s_waitcnt lgkmcnt(0)
    v_pk_add_f32 v[40:41], v[40:41], v[80:81]
    v_pk_add_f32 v[42:43], v[42:43], v[82:83]
    v_cvt_pk_bf16_f32 v228, v40, v41
    v_cvt_pk_bf16_f32 v229, v42, v43
    s_cmp_eq_u32 s22, 1
    s_cbranch_scc1 L_fin_p5
    buffer_store_dwordx4 v[220:223], v4, s[4:7], s34 offen offset:0 sc1
    buffer_store_dwordx4 v[224:227], v4, s[4:7], s34 offen offset:1024 sc1
    buffer_store_dwordx2 v[228:229], v5, s[4:7], s34 offen sc1
    v_cndmask_b32 v234, 0, v228, s[40:41]
    v_cndmask_b32 v235, 0, v229, s[40:41]
    v_dot2_f32_bf16 v232, v220, v11, 0
    v_dot2_f32_bf16 v233, v220, v220, 0
    v_dot2_f32_bf16 v232, v221, v11, v232
    v_dot2_f32_bf16 v233, v221, v221, v233
    v_dot2_f32_bf16 v232, v222, v11, v232
    v_dot2_f32_bf16 v233, v222, v222, v233
    v_dot2_f32_bf16 v232, v223, v11, v232
    v_dot2_f32_bf16 v233, v223, v223, v233
    v_dot2_f32_bf16 v232, v224, v11, v232
    v_dot2_f32_bf16 v233, v224, v224, v233
    v_dot2_f32_bf16 v232, v225, v11, v232
    v_dot2_f32_bf16 v233, v225, v225, v233
    v_dot2_f32_bf16 v232, v226, v11, v232
    v_dot2_f32_bf16 v233, v226, v226, v233
    v_dot2_f32_bf16 v232, v227, v11, v232
    v_dot2_f32_bf16 v233, v227, v227, v233
    v_dot2_f32_bf16 v232, v234, v11, v232
    v_dot2_f32_bf16 v233, v234, v234, v233
    v_dot2_f32_bf16 v232, v235, v11, v232
    v_dot2_f32_bf16 v233, v235, v235, v233
    s_nop 2
    v_mov_b32 v234, v232
    v_mov_b32 v235, v233
    s_nop 1
    v_permlane32_swap_b32 v232, v234
    v_permlane32_swap_b32 v233, v235
    v_add_f32 v232, v232, v234
    v_add_f32 v233, v233, v235
    v_mov_b32 v234, v232
    v_mov_b32 v235, v233
    s_nop 1
    v_permlane16_swap_b32 v232, v234
    v_permlane16_swap_b32 v233, v235
    v_add_f32 v232, v232, v234
    v_add_f32_e64 v233, v233, v235
    buffer_store_dwordx2 v[232:233], v10, s[4:7], s39 offen sc1
    s_barrier
    s_mov_b32 s22, 1
    s_mov_b32 s21, 0x1c00000
    s_branch L_m_cl
    s_nop 0
L_fin_p5:
    ds_bpermute_b32 v220, v10, v220
    ds_bpermute_b32 v221, v10, v221
    ds_bpermute_b32 v222, v10, v222
    ds_bpermute_b32 v223, v10, v223
    ds_bpermute_b32 v224, v10, v224
    ds_bpermute_b32 v225, v10, v225
    ds_bpermute_b32 v226, v10, v226
    ds_bpermute_b32 v227, v10, v227
    ds_bpermute_b32 v228, v10, v228
    ds_bpermute_b32 v229, v10, v229
    s_waitcnt lgkmcnt(6)
    buffer_store_dwordx4 v[220:223], v4, s[16:19], s34 offen offset:0
    s_waitcnt lgkmcnt(2)
    buffer_store_dwordx4 v[224:227], v4, s[16:19], s34 offen offset:64
    s_waitcnt lgkmcnt(0)
    buffer_store_dwordx2 v[228:229], v5, s[16:19], s34 offen offset:128
    s_endpgm
L_m_l1:
    s_and_b32 s25, s2, 7
    s_lshr_b32 s26, s2, 3
    s_lshr_b32 s23, s25, 1
    s_lshl_b32 s23, s23, 2
    s_lshr_b32 s27, s26, 3
    s_add_u32 s23, s23, s27
    s_and_b32 s24, s25, 1
    s_lshl_b32 s24, s24, 3
    s_and_b32 s27, s26, 7
    s_add_u32 s24, s24, s27
    s_mul_i32 s29, s24, 129024
    s_lshl_b32 s30, s20, 12
    s_add_u32 s29, s29, s30
    s_add_u32 s29, s29, 0x3800000
    s_lshl_b32 s31, s23, 3
    s_max_u32 s31, s31, 1
    s_sub_u32 s31, s31, 1
    s_mul_i32 s31, s31, 18432
    s_add_u32 s31, s31, 0x0
    s_lshl_b32 s35, s20, 10
    s_and_b32 s36, s35, 1024
    s_barrier
    s_add_u32 m0, s35, 131072
    s_add_u32 s34, s31, s35
    s_add_u32 s34, s34, 0
    buffer_load_dwordx4 v1, s[4:7], s34 offen sc1 lds
    s_add_u32 m0, s30, 0
    s_add_u32 s34, s29, 0
    buffer_load_dwordx4 v1, s[4:7], s34 offen offset:0 sc1 lds
    buffer_load_dwordx4 v1, s[4:7], s34 offen offset:1024 sc1 lds
    buffer_load_dwordx4 v1, s[4:7], s34 offen offset:2048 sc1 lds
    buffer_load_dwordx4 v1, s[4:7], s34 offen offset:3072 sc1 lds
    s_add_u32 m0, s30, 16384
    s_add_u32 s34, s29, 16384
    buffer_load_dwordx4 v1, s[4:7], s34 offen offset:0 sc1 lds
    buffer_load_dwordx4 v1, s[4:7], s34 offen offset:1024 sc1 lds
    buffer_load_dwordx4 v1, s[4:7], s34 offen offset:2048 sc1 lds
    buffer_load_dwordx4 v1, s[4:7], s34 offen offset:3072 sc1 lds
    s_waitcnt vmcnt(4) lgkmcnt(0)
    s_barrier
    s_add_u32 m0, s30, 32768
    s_add_u32 s34, s29, 32768
    buffer_load_dwordx4 v1, s[4:7], s34 offen offset:0 sc1 lds
    buffer_load_dwordx4 v1, s[4:7], s34 offen offset:1024 sc1 lds
    buffer_load_dwordx4 v1, s[4:7], s34 offen offset:2048 sc1 lds
    buffer_load_dwordx4 v1, s[4:7], s34 offen offset:3072 sc1 lds
    s_cmp_lt_u32 s2, 144
    s_cbranch_scc1 L_p0_t1
    s_cmp_ge_u32 s2, 216
    s_cbranch_scc1 L_p0_t2
    ds_read_b64_tr_b16 v[16:17], v4 offset:0
    ds_read_b64_tr_b16 v[18:19], v4 offset:2048
    ds_read_b64_tr_b16 v[20:21], v4 offset:18432
    ds_read_b64_tr_b16 v[22:23], v4 offset:20480
    ds_read_b64_tr_b16 v[24:25], v4 offset:4096
    ds_read_b64_tr_b16 v[26:27], v4 offset:6144
    ds_read_b64_tr_b16 v[28:29], v4 offset:22528
    ds_read_b64_tr_b16 v[30:31], v4 offset:24576
    ds_read_b64_tr_b16 v[32:33], v4 offset:8192
    ds_read_b64_tr_b16 v[34:35], v4 offset:10240
    ds_read_b64_tr_b16 v[36:37], v4 offset:26624
    ds_read_b64_tr_b16 v[38:39], v4 offset:28672
    ds_read_b64_tr_b16 v[40:41], v4 offset:12288
    ds_read_b64_tr_b16 v[42:43], v4 offset:14336
    ds_read_b64_tr_b16 v[44:45], v4 offset:30720
    ds_read_b64_tr_b16 v[46:47], v4 offset:32768
    ds_read_b64_tr_b16 v[48:49], v5 offset:16384
    ds_read_b64_tr_b16 v[50:51], v5 offset:34816
    s_branch L_p0_t2
    s_nop 0
L_p0_t1:
    ds_read_b64_tr_b16 v[16:17], v4 offset:0
    ds_read_b64_tr_b16 v[18:19], v4 offset:512
    ds_read_b64_tr_b16 v[20:21], v4 offset:4352
    ds_read_b64_tr_b16 v[22:23], v4 offset:4864
    ds_read_b64_tr_b16 v[24:25], v4 offset:9792
    ds_read_b64_tr_b16 v[26:27], v4 offset:10304
    ds_read_b64_tr_b16 v[28:29], v4 offset:14144
    ds_read_b64_tr_b16 v[30:31], v4 offset:14656
    ds_read_b64_tr_b16 v[32:33], v4 offset:19584
    ds_read_b64_tr_b16 v[34:35], v4 offset:20096
    ds_read_b64_tr_b16 v[36:37], v4 offset:23936
    ds_read_b64_tr_b16 v[38:39], v4 offset:24448
    ds_read_b64_tr_b16 v[40:41], v4 offset:29376
    ds_read_b64_tr_b16 v[42:43], v4 offset:29888
    ds_read_b64_tr_b16 v[44:45], v4 offset:33728
    ds_read_b64_tr_b16 v[46:47], v4 offset:34240
    ds_read_b64_tr_b16 v[48:49], v5 offset:8704
    ds_read_b64_tr_b16 v[50:51], v5 offset:9216
L_p0_t2:
    s_waitcnt lgkmcnt(0)
    s_waitcnt vmcnt(4) lgkmcnt(0)
    s_barrier
    s_add_u32 m0, s35, 135168
    s_add_u32 s34, s31, s35
    s_add_u32 s34, s34, 4096
    buffer_load_dwordx4 v1, s[4:7], s34 offen sc1 lds
    s_add_u32 m0, s30, 49152
    s_add_u32 s34, s29, 49152
    buffer_load_dwordx4 v1, s[4:7], s34 offen offset:0 sc1 lds
    buffer_load_dwordx4 v1, s[4:7], s34 offen offset:1024 sc1 lds
    buffer_load_dwordx4 v1, s[4:7], s34 offen offset:2048 sc1 lds
    buffer_load_dwordx4 v1, s[4:7], s34 offen offset:3072 sc1 lds
    s_waitcnt vmcnt(5) lgkmcnt(0)
    s_barrier
    s_add_u32 m0, s35, 139264
    s_add_u32 s34, s31, s35
    s_add_u32 s34, s34, 8192
    buffer_load_dwordx4 v1, s[4:7], s34 offen sc1 lds
    v_lshrrev_b32 v2, 8, v1
    v_bfe_u32 v3, v1, 7, 1
    v_bfe_u32 v4, v1, 4, 3
    v_cmp_gt_u32_e64 vcc, 3, v2
    v_mul_u32_u24 v3, 80, v3
    v_lshl_add_u32 v3, v4, 3, v3
    v_lshrrev_b32 v5, 1, v4
    v_and_b32 v4, 1, v4
    v_lshl_add_u32 v4, v4, 3, 64
    v_cndmask_b32 v2, v5, v2, vcc
    v_cndmask_b32 v3, v4, v3, vcc
    v_mul_u32_u24 v2, 2304, v2
    v_add_u32 v0, v2, v3
    v_lshrrev_b32 v8, 1, v1
    s_mul_i32 s34, s24, 144
    s_add_u32 s34, s34, 0x4400000
    buffer_load_dwordx2 v[2:3], v0, s[4:7], s34 offen sc1
    s_mul_i32 s34, s24, 144
    s_add_u32 s34, s34, 0x4402000
    buffer_load_dwordx2 v[4:5], v0, s[4:7], s34 offen sc1
    s_mul_i32 s34, s24, 144
    s_add_u32 s34, s34, 0x4404000
    buffer_load_dwordx2 v[6:7], v0, s[4:7], s34 offen sc1
    s_mul_i32 s34, s24, 144
    s_add_u32 s34, s34, 0x4406000
    buffer_load_dwordx2 v[12:13], v0, s[4:7], s34 offen sc1
    s_add_u32 m0, s30, 65536
    s_add_u32 s34, s29, 65536
    buffer_load_dwordx4 v1, s[4:7], s34 offen offset:0 sc1 lds
    buffer_load_dwordx4 v1, s[4:7], s34 offen offset:1024 sc1 lds
    buffer_load_dwordx4 v1, s[4:7], s34 offen offset:2048 sc1 lds
    buffer_load_dwordx4 v1, s[4:7], s34 offen offset:3072 sc1 lds
    s_waitcnt vmcnt(9) lgkmcnt(0)
    s_barrier
    s_add_u32 m0, s30, 81920
    s_add_u32 s34, s29, 81920
    buffer_load_dwordx4 v1, s[4:7], s34 offen offset:0 sc1 lds
    buffer_load_dwordx4 v1, s[4:7], s34 offen offset:1024 sc1 lds
    buffer_load_dwordx4 v1, s[4:7], s34 offen offset:2048 sc1 lds
    buffer_load_dwordx4 v1, s[4:7], s34 offen offset:3072 sc1 lds
    s_waitcnt vmcnt(8)
    v_add_f32 v2, v2, v4
    v_add_f32 v3, v3, v5
    v_add_f32 v6, v6, v12
    v_add_f32 v7, v7, v13
    v_add_f32 v2, v2, v6
    v_add_f32_e64 v3, v3, v7
    v_cmp_gt_u32 vcc, 864, v1
    v_add_u32 v8, 161792, v8
    s_nop 0
    v_cndmask_b32 v2, 0, v2, vcc
    v_cndmask_b32_e64 v3, 0, v3, vcc
    ds_write_b64 v8, v[2:3]
    s_waitcnt vmcnt(4) lgkmcnt(0)
    s_barrier
    s_add_u32 m0, s35, 143360
    s_add_u32 s34, s31, s35
    s_add_u32 s34, s34, 12288
    buffer_load_dwordx4 v1, s[4:7], s34 offen sc1 lds
    s_add_u32 m0, s30, 98304
    s_add_u32 s34, s29, 98304
    buffer_load_dwordx4 v1, s[4:7], s34 offen offset:0 sc1 lds
    buffer_load_dwordx4 v1, s[4:7], s34 offen offset:1024 sc1 lds
    buffer_load_dwordx4 v1, s[4:7], s34 offen offset:2048 sc1 lds
    buffer_load_dwordx4 v1, s[4:7], s34 offen offset:3072 sc1 lds
    s_waitcnt vmcnt(5) lgkmcnt(0)
    s_barrier
    s_add_u32 m0, s36, 147456
    s_add_u32 s34, s31, s36
    s_add_u32 s34, s34, 16384
    buffer_load_dwordx4 v1, s[4:7], s34 offen sc1 lds
    s_add_u32 m0, s30, 114688
    s_add_u32 s34, s29, 114688
    buffer_load_dwordx4 v1, s[4:7], s34 offen offset:0 sc1 lds
    buffer_load_dwordx4 v1, s[4:7], s34 offen offset:1024 sc1 lds
    buffer_load_dwordx4 v1, s[4:7], s34 offen offset:2048 sc1 lds
    buffer_load_dwordx4 v1, s[4:7], s34 offen offset:3072 sc1 lds
    s_waitcnt vmcnt(5) lgkmcnt(0)
    s_barrier
    buffer_store_dwordx4 v[16:19], v9, s[4:7], s37 offen sc1
    buffer_store_dwordx4 v[20:23], v10, s[4:7], s38 offen sc1
    buffer_store_dwordx4 v[24:27], v9, s[4:7], s39 offen sc1
    buffer_store_dwordx4 v[28:31], v10, s[4:7], s40 offen sc1
    buffer_store_dwordx4 v[32:35], v9, s[4:7], s41 offen sc1
    s_waitcnt vmcnt(5) lgkmcnt(0)
    s_barrier
    s_mov_b32 s46, 0x4502000
    v_mov_b32_e64 v4, 0
    s_mov_b32 s60, 65536
L_poll_wo:
    buffer_load_dword v5, v4, s[4:7], s46 offen sc1
    s_waitcnt vmcnt(0)
    v_cmp_gt_u32_e64 vcc, 18, v5
    s_sub_u32 s60, s60, 1
    s_cbranch_scc1 L_pd_wo
    s_cbranch_vccz L_pd_wo
    s_sleep 4
    s_branch L_poll_wo
L_pd_wo:
    buffer_store_dwordx4 v[36:39], v10, s[4:7], s42 offen sc1
    buffer_store_dwordx4 v[40:43], v9, s[4:7], s43 offen sc1
    buffer_store_dwordx4 v[44:47], v10, s[4:7], s47 offen sc1
    buffer_store_dwordx4 v[48:51], v14, s[4:7], s48 offen sc1
    v_dot2_f32_bf16 v12, v16, v11, 0
    v_dot2_f32_bf16 v13, v17, v11, 0
    v_dot2_f32_bf16 v12, v18, v11, v12
    v_dot2_f32_bf16 v13, v19, v11, v13
    v_dot2_f32_bf16 v12, v20, v11, v12
    v_dot2_f32_bf16 v13, v21, v11, v13
    v_dot2_f32_bf16 v12, v22, v11, v12
    v_dot2_f32_bf16 v13, v23, v11, v13
    v_dot2_f32_bf16 v12, v24, v11, v12
    v_dot2_f32_bf16 v13, v25, v11, v13
    v_dot2_f32_bf16 v12, v26, v11, v12
    v_dot2_f32_bf16 v13, v27, v11, v13
    v_dot2_f32_bf16 v12, v28, v11, v12
    v_dot2_f32_bf16 v13, v29, v11, v13
    v_dot2_f32_bf16 v12, v30, v11, v12
    v_dot2_f32_bf16 v13, v31, v11, v13
    v_dot2_f32_bf16 v12, v32, v11, v12
    v_dot2_f32_bf16 v13, v33, v11, v13
    v_dot2_f32_bf16 v12, v34, v11, v12
    v_dot2_f32_bf16 v13, v35, v11, v13
    v_dot2_f32_bf16 v12, v36, v11, v12
    v_dot2_f32_bf16 v13, v37, v11, v13
    v_dot2_f32_bf16 v12, v38, v11, v12
    v_dot2_f32_bf16 v13, v39, v11, v13
    v_dot2_f32_bf16 v12, v40, v11, v12
    v_dot2_f32_bf16 v13, v41, v11, v13
    v_dot2_f32_bf16 v12, v42, v11, v12
    v_dot2_f32_bf16 v13, v43, v11, v13
    v_dot2_f32_bf16 v12, v44, v11, v12
    v_dot2_f32_bf16 v13, v45, v11, v13
    v_dot2_f32_bf16 v12, v46, v11, v12
    v_dot2_f32_bf16 v13, v47, v11, v13
    v_dot2_f32_bf16 v12, v48, v11, v12
    v_dot2_f32_bf16 v13, v49, v11, v13
    v_dot2_f32_bf16 v12, v50, v11, v12
    v_dot2_f32_bf16 v13, v51, v11, v13
    s_nop 2
    v_add_f32 v12, v12, v13
    v_mov_b32 v13, v12
    s_nop 1
    v_permlane32_swap_b32 v12, v13
    v_add_f32 v12, v12, v13
    v_mov_b32 v13, v12
    s_nop 1
    v_permlane16_swap_b32 v12, v13
    v_add_f32 v12, v12, v13
    buffer_store_dword v12, v15, s[4:7], s49 offen sc1
    s_barrier
L_m_ll:
    s_and_b32 s25, s2, 7
    s_lshr_b32 s26, s2, 3
    s_lshr_b32 s23, s25, 1
    s_lshl_b32 s23, s23, 3
    s_lshr_b32 s27, s26, 2
    s_add_u32 s23, s23, s27
    s_and_b32 s24, s25, 1
    s_lshl_b32 s24, s24, 2
    s_and_b32 s27, s26, 3
    s_add_u32 s24, s24, s27
    s_add_u32 s25, s23, s24
    s_and_b32 s25, s25, 3
    s_mul_i32 s29, s24, 82944
    s_add_u32 s29, s29, 0x3a00000
    s_mul_i32 s30, s20, 36864
    s_mul_i32 s31, s20, 18432
    s_add_u32 s31, s31, s29
    s_add_u32 m0, s30, 18432
    s_add_u32 s33, s31, 0
    buffer_load_dwordx4 v1, s[4:7], s33 offen offset:0  sc1 lds
    buffer_load_dwordx4 v1, s[4:7], s33 offen offset:1024  sc1 lds
    buffer_load_dwordx4 v1, s[4:7], s33 offen offset:2048  sc1 lds
    buffer_load_dwordx4 v1, s[4:7], s33 offen offset:3072  sc1 lds
    s_add_u32 m0, s30, 22528
    s_add_u32 s33, s31, 4096
    buffer_load_dwordx4 v1, s[4:7], s33 offen offset:0  sc1 lds
    buffer_load_dwordx4 v1, s[4:7], s33 offen offset:1024  sc1 lds
    buffer_load_dwordx4 v1, s[4:7], s33 offen offset:2048  sc1 lds
    buffer_load_dwordx4 v1, s[4:7], s33 offen offset:3072  sc1 lds
    s_add_u32 m0, s30, 26624
    s_add_u32 s33, s31, 8192
    buffer_load_dwordx4 v1, s[4:7], s33 offen offset:0  sc1 lds
    buffer_load_dwordx4 v1, s[4:7], s33 offen offset:1024  sc1 lds
    buffer_load_dwordx4 v1, s[4:7], s33 offen offset:2048  sc1 lds
    buffer_load_dwordx4 v1, s[4:7], s33 offen offset:3072  sc1 lds
    s_waitcnt vmcnt(12)
    s_barrier
    s_add_u32 m0, s30, 30720
    s_add_u32 s33, s31, 12288
    buffer_load_dwordx4 v1, s[4:7], s33 offen offset:0  sc1 lds
    buffer_load_dwordx4 v1, s[4:7], s33 offen offset:1024  sc1 lds
    buffer_load_dwordx4 v1, s[4:7], s33 offen offset:2048  sc1 lds
    buffer_load_dwordx4 v1, s[4:7], s33 offen offset:3072  sc1 lds
    s_add_u32 m0, s30, 34816
    s_add_u32 s33, s31, 16384
    buffer_load_dwordx4 v1, s[4:7], s33 offen offset:0  sc1 lds
    buffer_load_dwordx4 v1, s[4:7], s33 offen offset:1024  sc1 lds
    s_mul_i32 s30, s20, 3072
    s_add_u32 s31, s30, s29
    s_add_u32 m0, s30, 147456
    s_add_u32 s33, s31, 73728
    buffer_load_dwordx4 v1, s[4:7], s33 offen offset:0  sc1 lds
    buffer_load_dwordx4 v1, s[4:7], s33 offen offset:1024  sc1 lds
    buffer_load_dwordx4 v1, s[4:7], s33 offen offset:2048  sc1 lds
    s_or_b32 s44, s20, s22
    s_cbranch_scc1 L_p2_ns
    s_and_b32 s44, s2, 15
    s_lshl_b32 s44, s44, 8
    s_add_u32 s44, s44, 0x4501000
    s_add_u32 s44, s44, s4
    s_addc_u32 s45, s5, 0
    s_mov_b32 s56, 1
    s_atomic_add s56, s[44:45], 0
L_p2_ns:
    s_waitcnt vmcnt(0)
    s_barrier
    s_and_b32 s25, s2, 7
    s_lshr_b32 s26, s2, 3
    s_and_b32 s23, s25, 1
    s_lshl_b32 s23, s23, 3
    s_and_b32 s27, s26, 7
    s_add_u32 s23, s23, s27
    s_lshr_b32 s24, s25, 1
    s_lshl_b32 s24, s24, 2
    s_lshr_b32 s27, s26, 3
    s_add_u32 s24, s24, s27
    s_add_u32 s28, s23, s24
    s_and_b32 s28, s28, 3
    s_lshl_b32 s30, s20, 12
    s_lshr_b32 s33, s20, 1
    s_mul_i32 s31, s33, 36864
    s_and_b32 s33, s20, 1
    s_lshl_b32 s33, s33, 10
    s_add_u32 s33, s33, 16384
    s_add_u32 s31, s31, s33
    s_sub_u32 s49, s33, s30
    s_mul_i32 s34, s24, 331776
    s_add_u32 s34, s34, s30
    s_add_u32 s34, s34, 0x3b00000
    s_lshl_b32 s35, s23, 3
    s_lshl_b32 s33, s20, 1
    s_add_u32 s35, s35, s33
    s_mul_i32 s35, s35, 18432
    s_add_u32 s35, s35, s21
    s_add_u32 s35, s35, 0x300000
    s_mul_i32 s36, s24, 589824
    s_add_u32 s36, s36, s30
    s_add_u32 s36, s36, s21
    s_add_u32 s36, s36, 0x900000
    v_add_u32 v2, 16384, v1
    s_add_u32 s33, s30, 18432
    v_add_u32_e64 v6, s33, v1
    v_add_u32 v7, 73728, v6
    s_lshl_b32 s29, s23, 2
    s_add_u32 s29, s29, s20
    s_lshl_b32 s29, s29, 12
    s_add_u32 s29, s29, s21
    s_add_u32 s29, s29, 0x1b40000
    v_and_b32 v3, 48, v1
    v_lshrrev_b32 v8, 8, v1
    v_lshl_add_u32 v3, v8, 6, v3
    v_bfe_u32 v8, v1, 6, 2
    v_lshl_add_u32 v3, v8, 8, v3
    s_lshl_b32 s33, s23, 7
    s_lshl_b32 s37, s20, 5
    s_add_u32 s33, s33, s37
    v_lshrrev_b32 v8, 7, v1
    v_add_u32 v8, s33, v8
    v_lshlrev_b32 v8, 12, v8
    v_lshrrev_b32_e64 v9, 8, v1
    v_bfe_u32 v10, v1, 4, 3
    v_xor_b32_e64 v9, v9, v10
    v_lshl_add_u32 v8, v9, 4, v8
    v_xor_b32_e64 v9, 64, v8
    v_add_u32 v9, 31744, v9
    v_add_u32 v10, 63488, v8
    v_add_u32 v11, 63488, v9
    s_cmp_eq_u32 s28, 0
    s_cselect_b32 s44, 4, 0
    s_cmp_eq_u32 s28, 1
    s_cselect_b32 s45, 5, 1
    s_cmp_eq_u32 s28, 2
    s_cselect_b32 s46, 6, 2
    s_cmp_eq_u32 s28, 3
    s_cselect_b32 s47, 7, 3
    s_lshl_b32 s33, s20, 4
    s_add_u32 s33, s33, s24
    s_lshl_b32 s54, s22, 7
    s_add_u32 s54, s54, s33
    s_lshl_b32 s54, s54, 8
    s_add_u32 s54, s54, 0x450c000
    s_add_u32 s54, s54, s4
    s_addc_u32 s55, s5, 0
    s_mov_b32 s33, 0x4501000
    v_and_b32 v4, 0xf0, v1
    v_lshlrev_b32 v4, 4, v4
    s_mov_b32 s60, 65536
L_poll_wr:
    buffer_load_dword v5, v4, s[4:7], s33 offen sc1
    s_waitcnt vmcnt(0)
    v_cmp_gt_u32 vcc, 16, v5
    s_sub_u32 s60, s60, 1
    s_cbranch_scc1 L_pd_wr
    s_cbranch_vccz L_pd_wr
    s_sleep 4
    s_branch L_poll_wr
L_pd_wr:
    s_min_u32 s33, s20, 2
    s_lshl_b32 s33, s33, 9
    v_lshrrev_b32 v4, 1, v1
    v_add_u32 v4, s33, v4
    s_lshl_b32 s51, s24, 12
    s_add_u32 s51, s51, 0x4410000
    buffer_load_dwordx2 v[16:17], v4, s[4:7], s51 offen offset:0 sc1
    buffer_load_dwordx2 v[18:19], v4, s[4:7], s51 offen offset:1152 sc1
    s_mov_b32 s48, 0
    s_mul_i32 s50, s48, 18432
    s_add_u32 s50, s50, s34
    s_add_u32 m0, s30, 0
    s_mov_b32 s53, s50
    buffer_load_dwordx4 v1, s[4:7], s50 offen offset:0  sc1 lds
    buffer_load_dwordx4 v1, s[4:7], s50 offen offset:1024  sc1 lds
    buffer_load_dwordx4 v1, s[4:7], s50 offen offset:2048  sc1 lds
    buffer_load_dwordx4 v1, s[4:7], s50 offen offset:3072  sc1 lds
    s_mov_b32 s48, 1
    s_mul_i32 s50, s48, 18432
    s_add_u32 s50, s50, s34
    s_cmp_ge_u32 s20, 2
    s_cselect_b32 s52, s50, s53
    s_add_u32 m0, s31, 0
    s_add_u32 s52, s52, s49
    buffer_load_dwordx4 v1, s[4:7], s52 offen  sc1 lds
    s_add_u32 m0, s30, 36864
    s_mov_b32 s53, s50
    buffer_load_dwordx4 v1, s[4:7], s50 offen offset:0  sc1 lds
    buffer_load_dwordx4 v1, s[4:7], s50 offen offset:1024  sc1 lds
    buffer_load_dwordx4 v1, s[4:7], s50 offen offset:2048  sc1 lds
    buffer_load_dwordx4 v1, s[4:7], s50 offen offset:3072  sc1 lds
    s_mov_b32 m0, 161280
    v_lshrrev_b32_e64 v5, 2, v1
    s_lshl_b32 s33, s23, 8
    buffer_load_dword v5, s[12:15], s33 offen lds
    s_waitcnt vmcnt(10)
    v_add_u32 v4, 159744, v4
    v_add_f32 v16, v16, v18
    v_add_f32_e64 v17, v17, v19
    ds_write_b64 v4, v[16:17]
    s_waitcnt lgkmcnt(0)
    s_barrier
    s_mov_b32 s48, 2
    s_mul_i32 s50, s48, 18432
    s_add_u32 s50, s50, s34
    s_add_u32 m0, s30, 73728
    s_mov_b32 s53, s50
    buffer_load_dwordx4 v1, s[4:7], s50 offen offset:0  sc1 lds
    buffer_load_dwordx4 v1, s[4:7], s50 offen offset:1024  sc1 lds
    buffer_load_dwordx4 v1, s[4:7], s50 offen offset:2048  sc1 lds
    buffer_load_dwordx4 v1, s[4:7], s50 offen offset:3072  sc1 lds
    s_mov_b32 s48, 3
    s_mul_i32 s50, s48, 18432
    s_add_u32 s50, s50, s34
    s_cmp_ge_u32 s20, 2
    s_cselect_b32 s52, s50, s53
    s_add_u32 m0, s31, 73728
    s_add_u32 s52, s52, s49
    buffer_load_dwordx4 v1, s[4:7], s52 offen  sc1 lds
    s_add_u32 m0, s30, 110592
    s_mov_b32 s53, s50
    buffer_load_dwordx4 v1, s[4:7], s50 offen offset:0  sc1 lds
    buffer_load_dwordx4 v1, s[4:7], s50 offen offset:1024  sc1 lds
    buffer_load_dwordx4 v1, s[4:7], s50 offen offset:2048  sc1 lds
    buffer_load_dwordx4 v1, s[4:7], s50 offen offset:3072  sc1 lds
    s_barrier
    s_add_u32 m0, s30, 18432
    s_add_u32 s51, s35, 0
    buffer_load_dwordx4 v1, s[4:7], s51 offen offset:0 sc1 lds
    buffer_load_dwordx4 v1, s[4:7], s51 offen offset:1024 sc1 lds
    buffer_load_dwordx4 v2, s[4:7], s51 offen offset:2048 sc1 lds
    buffer_load_dwordx4 v2, s[4:7], s51 offen offset:3072 sc1 lds
    s_add_u32 m0, s30, 55296
    s_add_u32 s51, s35, 2048
    buffer_load_dwordx4 v1, s[4:7], s51 offen offset:0 sc1 lds
    buffer_load_dwordx4 v1, s[4:7], s51 offen offset:1024 sc1 lds
    buffer_load_dwordx4 v2, s[4:7], s51 offen offset:2048 sc1 lds
    buffer_load_dwordx4 v2, s[4:7], s51 offen offset:3072 sc1 lds
    s_add_u32 m0, s30, 92160
    s_add_u32 s51, s35, 4096
    buffer_load_dwordx4 v1, s[4:7], s51 offen offset:0 sc1 lds
    buffer_load_dwordx4 v1, s[4:7], s51 offen offset:1024 sc1 lds
    buffer_load_dwordx4 v2, s[4:7], s51 offen offset:2048 sc1 lds
    buffer_load_dwordx4 v2, s[4:7], s51 offen offset:3072 sc1 lds
    s_waitcnt vmcnt(8)
    s_barrier
    s_add_u32 m0, s30, 129024
    s_add_u32 s51, s35, 6144
    buffer_load_dwordx4 v1, s[4:7], s51 offen offset:0 sc1 lds
    buffer_load_dwordx4 v1, s[4:7], s51 offen offset:1024 sc1 lds
    buffer_load_dwordx4 v2, s[4:7], s51 offen offset:2048 sc1 lds
    buffer_load_dwordx4 v2, s[4:7], s51 offen offset:3072 sc1 lds
    s_and_b32 s40, s2, 7
    s_lshr_b32 s26, s2, 3
    s_lshr_b32 s38, s40, 1
    s_lshl_b32 s38, s38, 3
    s_lshr_b32 s27, s26, 2
    s_add_u32 s38, s38, s27
    s_and_b32 s39, s40, 1
    s_lshl_b32 s39, s39, 2
    s_and_b32 s27, s26, 3
    s_add_u32 s39, s39, s27
    s_add_u32 s40, s38, s39
    s_and_b32 s40, s40, 3
    s_mul_i32 s42, s20, 9216
    s_mul_i32 s43, s39, 331776
    s_add_u32 s43, s43, s42
    s_add_u32 s43, s43, 0x4100000
    s_waitcnt vmcnt(8) lgkmcnt(0)
    s_barrier
    s_mov_b32 s48, 4
    s_mul_i32 s50, s48, 18432
    s_add_u32 s50, s50, s34
    s_add_u32 m0, s30, 0
    s_mov_b32 s53, s50
    buffer_load_dwordx4 v1, s[4:7], s50 offen offset:0  sc1 lds
    buffer_load_dwordx4 v1, s[4:7], s50 offen offset:1024  sc1 lds
    buffer_load_dwordx4 v1, s[4:7], s50 offen offset:2048  sc1 lds
    buffer_load_dwordx4 v1, s[4:7], s50 offen offset:3072  sc1 lds
    s_add_u32 m0, s30, 18432
    s_add_u32 s51, s35, 8192
    buffer_load_dwordx4 v1, s[4:7], s51 offen offset:0 sc1 lds
    buffer_load_dwordx4 v1, s[4:7], s51 offen offset:1024 sc1 lds
    buffer_load_dwordx4 v2, s[4:7], s51 offen offset:2048 sc1 lds
    buffer_load_dwordx4 v2, s[4:7], s51 offen offset:3072 sc1 lds
    s_waitcnt vmcnt(12) lgkmcnt(0)
    s_barrier
    s_mov_b32 s48, 5
    s_mul_i32 s50, s48, 18432
    s_add_u32 s50, s50, s34
    s_cmp_ge_u32 s20, 2
    s_cselect_b32 s52, s50, s53
    s_add_u32 m0, s31, 0
    s_add_u32 s52, s52, s49
    buffer_load_dwordx4 v1, s[4:7], s52 offen  sc1 lds
    s_add_u32 m0, s30, 36864
    s_mov_b32 s53, s50
    buffer_load_dwordx4 v1, s[4:7], s50 offen offset:0  sc1 lds
    buffer_load_dwordx4 v1, s[4:7], s50 offen offset:1024  sc1 lds
    buffer_load_dwordx4 v1, s[4:7], s50 offen offset:2048  sc1 lds
    buffer_load_dwordx4 v1, s[4:7], s50 offen offset:3072  sc1 lds
    s_add_u32 m0, s30, 55296
    s_add_u32 s51, s35, 10240
    buffer_load_dwordx4 v1, s[4:7], s51 offen offset:0 sc1 lds
    buffer_load_dwordx4 v1, s[4:7], s51 offen offset:1024 sc1 lds
    buffer_load_dwordx4 v2, s[4:7], s51 offen offset:2048 sc1 lds
    buffer_load_dwordx4 v2, s[4:7], s51 offen offset:3072 sc1 lds
    s_waitcnt vmcnt(17) lgkmcnt(0)
    s_barrier
    s_mov_b32 s48, 6
    s_mul_i32 s50, s48, 18432
    s_add_u32 s50, s50, s34
    s_add_u32 m0, s30, 73728
    s_mov_b32 s53, s50
    buffer_load_dwordx4 v1, s[4:7], s50 offen offset:0  sc1 lds
    buffer_load_dwordx4 v1, s[4:7], s50 offen offset:1024  sc1 lds
    buffer_load_dwordx4 v1, s[4:7], s50 offen offset:2048  sc1 lds
    buffer_load_dwordx4 v1, s[4:7], s50 offen offset:3072  sc1 lds
    s_add_u32 m0, s30, 92160
    s_add_u32 s51, s35, 12288
    buffer_load_dwordx4 v1, s[4:7], s51 offen offset:0 sc1 lds
    buffer_load_dwordx4 v1, s[4:7], s51 offen offset:1024 sc1 lds
    buffer_load_dwordx4 v2, s[4:7], s51 offen offset:2048 sc1 lds
    buffer_load_dwordx4 v2, s[4:7], s51 offen offset:3072 sc1 lds
    s_waitcnt vmcnt(16) lgkmcnt(0)
    s_barrier
    s_mov_b32 s48, 7
    s_mul_i32 s50, s48, 18432
    s_add_u32 s50, s50, s34
    s_cmp_ge_u32 s20, 2
    s_cselect_b32 s52, s50, s53
    s_add_u32 m0, s31, 73728
    s_add_u32 s52, s52, s49
    buffer_load_dwordx4 v1, s[4:7], s52 offen  sc1 lds
    s_add_u32 m0, s30, 110592
    s_mov_b32 s53, s50
    buffer_load_dwordx4 v1, s[4:7], s50 offen offset:0  sc1 lds
    buffer_load_dwordx4 v1, s[4:7], s50 offen offset:1024  sc1 lds
    buffer_load_dwordx4 v1, s[4:7], s50 offen offset:2048  sc1 lds
    buffer_load_dwordx4 v1, s[4:7], s50 offen offset:3072  sc1 lds
    s_add_u32 m0, s30, 129024
    s_add_u32 s51, s35, 14336
    buffer_load_dwordx4 v1, s[4:7], s51 offen offset:0 sc1 lds
    buffer_load_dwordx4 v1, s[4:7], s51 offen offset:1024 sc1 lds
    buffer_load_dwordx4 v2, s[4:7], s51 offen offset:2048 sc1 lds
    buffer_load_dwordx4 v2, s[4:7], s51 offen offset:3072 sc1 lds
    s_waitcnt vmcnt(17) lgkmcnt(0)
    s_barrier
    s_mov_b32 s48, 8
    s_mul_i32 s50, s48, 18432
    s_add_u32 s50, s50, s34
    s_add_u32 m0, s30, 0
    s_mov_b32 s53, s50
    buffer_load_dwordx4 v1, s[4:7], s50 offen offset:0  sc1 lds
    buffer_load_dwordx4 v1, s[4:7], s50 offen offset:1024  sc1 lds
    buffer_load_dwordx4 v1, s[4:7], s50 offen offset:2048  sc1 lds
    buffer_load_dwordx4 v1, s[4:7], s50 offen offset:3072  sc1 lds
    s_add_u32 m0, s30, 18432
    s_add_u32 s51, s35, 16384
    buffer_load_dwordx4 v1, s[4:7], s51 offen offset:0 sc1 lds
    buffer_load_dwordx4 v1, s[4:7], s51 offen offset:1024 sc1 lds
    buffer_load_dwordx4 v2, s[4:7], s51 offen offset:2048 sc1 lds
    buffer_load_dwordx4 v2, s[4:7], s51 offen offset:3072 sc1 lds
    s_waitcnt vmcnt(16) lgkmcnt(0)
    s_barrier
    s_mov_b32 s48, 5
    s_mul_i32 s50, s48, 18432
    s_add_u32 s50, s50, s34
    s_add_u32 s50, s50, 165888
    s_cmp_ge_u32 s20, 2
    s_cselect_b32 s52, s50, s53
    s_add_u32 m0, s31, 0
    s_add_u32 s52, s52, s49
    buffer_load_dwordx4 v1, s[4:7], s52 offen  sc1 lds
    s_add_u32 m0, s30, 36864
    s_mov_b32 s53, s50
    buffer_load_dwordx4 v1, s[4:7], s50 offen offset:0  sc1 lds
    buffer_load_dwordx4 v1, s[4:7], s50 offen offset:1024  sc1 lds
    buffer_load_dwordx4 v1, s[4:7], s50 offen offset:2048  sc1 lds
    buffer_load_dwordx4 v1, s[4:7], s50 offen offset:3072  sc1 lds
    s_cmp_lg_u32 s22, 0
    s_cbranch_scc1 L_p5_k6
    s_add_u32 s32, s43, 294912
    buffer_load_dwordx4 v[220:223], v1, s[4:7], s32 offen offset:0 sc1
    buffer_load_dwordx4 v[224:227], v1, s[4:7], s32 offen offset:1024 sc1
    buffer_load_dwordx4 v[228:231], v1, s[4:7], s32 offen offset:2048 sc1
    buffer_load_dwordx4 v[232:235], v1, s[4:7], s32 offen offset:3072 sc1
    s_add_u32 s32, s43, 299008
    buffer_load_dwordx4 v[236:239], v1, s[4:7], s32 offen offset:0 sc1
L_p5_k6:
    s_waitcnt vmcnt(18) lgkmcnt(0)
    s_cmp_eq_u32 s22, 0
    s_cbranch_scc1 L_wv_926
    s_waitcnt vmcnt(13)
L_wv_926:
    s_barrier
    s_mov_b32 s48, 6
    s_mul_i32 s50, s48, 18432
    s_add_u32 s50, s50, s34
    s_add_u32 s50, s50, 165888
    s_add_u32 m0, s30, 73728
    s_mov_b32 s53, s50
    buffer_load_dwordx4 v1, s[4:7], s50 offen offset:0  sc1 lds
    buffer_load_dwordx4 v1, s[4:7], s50 offen offset:1024  sc1 lds
    buffer_load_dwordx4 v1, s[4:7], s50 offen offset:2048  sc1 lds
    buffer_load_dwordx4 v1, s[4:7], s50 offen offset:3072  sc1 lds
    s_cmp_lg_u32 s22, 0
    s_cbranch_scc1 L_p5_k7
    s_add_u32 s32, s43, 299008
    buffer_load_dwordx4 v[240:243], v1, s[4:7], s32 offen offset:1024 sc1
    buffer_load_dwordx4 v[244:247], v1, s[4:7], s32 offen offset:2048 sc1
    buffer_load_dwordx4 v[248:251], v1, s[4:7], s32 offen offset:3072 sc1
    s_add_u32 s32, s43, 303104
    buffer_load_dwordx4 v[252:255], v1, s[4:7], s32 offen offset:0 sc1
    s_add_u32 s32, s43, 258048
    buffer_load_dwordx4 v[184:187], v1, s[4:7], s32 offen offset:0 sc1
L_p5_k7:
    s_waitcnt vmcnt(18) lgkmcnt(0)
    s_cmp_eq_u32 s22, 0
    s_cbranch_scc1 L_wv_953
    s_waitcnt vmcnt(8)
L_wv_953:
    s_barrier
    s_mov_b32 s48, 7
    s_mul_i32 s50, s48, 18432
    s_add_u32 s50, s50, s34
    s_add_u32 s50, s50, 165888
    s_cmp_ge_u32 s20, 2
    s_cselect_b32 s52, s50, s53
    s_add_u32 m0, s31, 73728
    s_add_u32 s52, s52, s49
    buffer_load_dwordx4 v1, s[4:7], s52 offen  sc1 lds
    s_add_u32 m0, s30, 110592
    s_mov_b32 s53, s50
    buffer_load_dwordx4 v1, s[4:7], s50 offen offset:0  sc1 lds
    buffer_load_dwordx4 v1, s[4:7], s50 offen offset:1024  sc1 lds
    buffer_load_dwordx4 v1, s[4:7], s50 offen offset:2048  sc1 lds
    buffer_load_dwordx4 v1, s[4:7], s50 offen offset:3072  sc1 lds
    s_cmp_lg_u32 s22, 0
    s_cbranch_scc1 L_p5_k8
    s_add_u32 s32, s43, 258048
    buffer_load_dwordx4 v[188:191], v1, s[4:7], s32 offen offset:1024 sc1
    buffer_load_dwordx4 v[192:195], v1, s[4:7], s32 offen offset:2048 sc1
    buffer_load_dwordx4 v[196:199], v1, s[4:7], s32 offen offset:3072 sc1
    s_add_u32 s32, s43, 262144
    buffer_load_dwordx4 v[200:203], v1, s[4:7], s32 offen offset:0 sc1
    buffer_load_dwordx4 v[204:207], v1, s[4:7], s32 offen offset:1024 sc1
L_p5_k8:
    s_waitcnt vmcnt(24) lgkmcnt(0)
    s_cmp_eq_u32 s22, 0
    s_cbranch_scc1 L_wv_984
    s_waitcnt vmcnt(9)
L_wv_984:
    s_barrier
    s_mov_b32 s48, 8
    s_mul_i32 s50, s48, 18432
    s_add_u32 s50, s50, s34
    s_add_u32 s50, s50, 165888
    s_add_u32 m0, s30, 0
    s_mov_b32 s53, s50
    buffer_load_dwordx4 v1, s[4:7], s50 offen offset:0  sc1 lds
    buffer_load_dwordx4 v1, s[4:7], s50 offen offset:1024  sc1 lds
    buffer_load_dwordx4 v1, s[4:7], s50 offen offset:2048  sc1 lds
    buffer_load_dwordx4 v1, s[4:7], s50 offen offset:3072  sc1 lds
    s_cmp_lg_u32 s22, 0
    s_cbranch_scc1 L_p5_k9
    s_add_u32 s32, s43, 262144
    buffer_load_dwordx4 v[208:211], v1, s[4:7], s32 offen offset:2048 sc1
    buffer_load_dwordx4 v[212:215], v1, s[4:7], s32 offen offset:3072 sc1
    s_add_u32 s32, s43, 266240
    buffer_load_dwordx4 v[216:219], v1, s[4:7], s32 offen offset:0 sc1
    s_add_u32 s32, s43, 221184
    buffer_load_dwordx4 v[148:151], v1, s[4:7], s32 offen offset:0 sc1
    buffer_load_dwordx4 v[152:155], v1, s[4:7], s32 offen offset:1024 sc1
    buffer_load_dwordx4 v[156:159], v1, s[4:7], s32 offen offset:2048 sc1
    buffer_load_dwordx4 v[160:163], v1, s[4:7], s32 offen offset:3072 sc1
    s_add_u32 s32, s43, 225280
    buffer_load_dwordx4 v[164:167], v1, s[4:7], s32 offen offset:0 sc1
    buffer_load_dwordx4 v[168:171], v1, s[4:7], s32 offen offset:1024 sc1
    buffer_load_dwordx4 v[172:175], v1, s[4:7], s32 offen offset:2048 sc1
    buffer_load_dwordx4 v[176:179], v1, s[4:7], s32 offen offset:3072 sc1
    s_add_u32 s32, s43, 229376
    buffer_load_dwordx4 v[180:183], v1, s[4:7], s32 offen offset:0 sc1
    s_add_u32 s32, s43, 184320
    buffer_load_dwordx4 v[112:115], v1, s[4:7], s32 offen offset:0 sc1
    buffer_load_dwordx4 v[116:119], v1, s[4:7], s32 offen offset:1024 sc1
    buffer_load_dwordx4 v[120:123], v1, s[4:7], s32 offen offset:2048 sc1
    buffer_load_dwordx4 v[124:127], v1, s[4:7], s32 offen offset:3072 sc1
    s_add_u32 s32, s43, 188416
    buffer_load_dwordx4 v[128:131], v1, s[4:7], s32 offen offset:0 sc1
    buffer_load_dwordx4 v[132:135], v1, s[4:7], s32 offen offset:1024 sc1
    buffer_load_dwordx4 v[136:139], v1, s[4:7], s32 offen offset:2048 sc1
    buffer_load_dwordx4 v[140:143], v1, s[4:7], s32 offen offset:3072 sc1
    s_add_u32 s32, s43, 192512
    buffer_load_dwordx4 v[144:147], v1, s[4:7], s32 offen offset:0 sc1
    s_add_u32 s32, s43, 147456
    buffer_load_dwordx4 v[76:79], v1, s[4:7], s32 offen offset:0 sc1
    buffer_load_dwordx4 v[80:83], v1, s[4:7], s32 offen offset:1024 sc1
    buffer_load_dwordx4 v[84:87], v1, s[4:7], s32 offen offset:2048 sc1
    buffer_load_dwordx4 v[88:91], v1, s[4:7], s32 offen offset:3072 sc1
    s_add_u32 s32, s43, 151552
    buffer_load_dwordx4 v[92:95], v1, s[4:7], s32 offen offset:0 sc1
    buffer_load_dwordx4 v[96:99], v1, s[4:7], s32 offen offset:1024 sc1
    buffer_load_dwordx4 v[100:103], v1, s[4:7], s32 offen offset:2048 sc1
    buffer_load_dwordx4 v[104:107], v1, s[4:7], s32 offen offset:3072 sc1
    s_add_u32 s32, s43, 155648
    buffer_load_dwordx4 v[108:111], v1, s[4:7], s32 offen offset:0 sc1
L_p5_k9:
    s_waitcnt vmcnt(43) lgkmcnt(0)
    s_cmp_eq_u32 s22, 0
    s_cbranch_scc1 L_wv_1044
    s_waitcnt vmcnt(8)
L_wv_1044:
    s_barrier
    s_mov_b32 s48, 0
    s_mul_i32 s50, s48, 18432
    s_add_u32 s50, s50, s34
    s_add_u32 s50, s50, 165888
    s_cmp_ge_u32 s20, 2
    s_cselect_b32 s52, s50, s53
    s_add_u32 m0, s31, 0
    s_add_u32 s52, s52, s49
    buffer_load_dwordx4 v1, s[4:7], s52 offen  sc1 lds
    s_add_u32 m0, s30, 36864
    s_mov_b32 s53, s50
    buffer_load_dwordx4 v1, s[4:7], s50 offen offset:0  sc1 lds
    buffer_load_dwordx4 v1, s[4:7], s50 offen offset:1024  sc1 lds
    buffer_load_dwordx4 v1, s[4:7], s50 offen offset:2048  sc1 lds
    buffer_load_dwordx4 v1, s[4:7], s50 offen offset:3072  sc1 lds
    s_add_u32 m0, s30, 55296
    s_add_u32 s51, s35, 0
    buffer_load_dwordx4 v1, s[4:7], s51 offen offset:0 sc1 lds
    buffer_load_dwordx4 v1, s[4:7], s51 offen offset:1024 sc1 lds
    buffer_load_dwordx4 v2, s[4:7], s51 offen offset:2048 sc1 lds
    buffer_load_dwordx4 v2, s[4:7], s51 offen offset:3072 sc1 lds
    s_waitcnt vmcnt(48) lgkmcnt(0)
    s_cmp_eq_u32 s22, 0
    s_cbranch_scc1 L_wv_1071
    s_waitcnt vmcnt(13)
L_wv_1071:
    s_barrier
    buffer_load_dwordx4 v[16:19], v3, s[4:7], s29 offen offset:0 sc1
    buffer_load_dwordx4 v[20:23], v3, s[4:7], s29 offen offset:1024 sc1
    buffer_load_dwordx4 v[24:27], v3, s[4:7], s29 offen offset:2048 sc1
    buffer_load_dwordx4 v[28:31], v3, s[4:7], s29 offen offset:3072 sc1
    s_mov_b32 s48, 1
    s_mul_i32 s50, s48, 18432
    s_add_u32 s50, s50, s34
    s_add_u32 s50, s50, 165888
    s_add_u32 m0, s30, 73728
    s_mov_b32 s53, s50
    buffer_load_dwordx4 v1, s[4:7], s50 offen offset:0  sc1 lds
    buffer_load_dwordx4 v1, s[4:7], s50 offen offset:1024  sc1 lds
    buffer_load_dwordx4 v1, s[4:7], s50 offen offset:2048  sc1 lds
    buffer_load_dwordx4 v1, s[4:7], s50 offen offset:3072  sc1 lds
    s_add_u32 m0, s30, 92160
    s_add_u32 s51, s35, 2048
    buffer_load_dwordx4 v1, s[4:7], s51 offen offset:0 sc1 lds
    buffer_load_dwordx4 v1, s[4:7], s51 offen offset:1024 sc1 lds
    buffer_load_dwordx4 v2, s[4:7], s51 offen offset:2048 sc1 lds
    buffer_load_dwordx4 v2, s[4:7], s51 offen offset:3072 sc1 lds
    s_waitcnt vmcnt(20) lgkmcnt(0)
    s_barrier
    s_mov_b32 s48, 2
    s_mul_i32 s50, s48, 18432
    s_add_u32 s50, s50, s34
    s_add_u32 s50, s50, 165888
    s_cmp_ge_u32 s20, 2
    s_cselect_b32 s52, s50, s53
    s_add_u32 m0, s31, 73728
    s_add_u32 s52, s52, s49
    buffer_load_dwordx4 v1, s[4:7], s52 offen  sc1 lds
    s_add_u32 m0, s30, 110592
    s_mov_b32 s53, s50
    buffer_load_dwordx4 v1, s[4:7], s50 offen offset:0  sc1 lds
    buffer_load_dwordx4 v1, s[4:7], s50 offen offset:1024  sc1 lds
    buffer_load_dwordx4 v1, s[4:7], s50 offen offset:2048  sc1 lds
    buffer_load_dwordx4 v1, s[4:7], s50 offen offset:3072  sc1 lds
    s_add_u32 m0, s30, 129024
    s_add_u32 s51, s35, 4096
    buffer_load_dwordx4 v1, s[4:7], s51 offen offset:0 sc1 lds
    buffer_load_dwordx4 v1, s[4:7], s51 offen offset:1024 sc1 lds
    buffer_load_dwordx4 v2, s[4:7], s51 offen offset:2048 sc1 lds
    buffer_load_dwordx4 v2, s[4:7], s51 offen offset:3072 sc1 lds
    s_setprio 2
    s_mov_b32 s60, 65536
    s_waitcnt vmcnt(17)
L_g_chk:
    v_or3_b32 v32, v17, v19, v21
    v_or3_b32 v33, v23, v25, v27
    v_or3_b32 v32, v29, v31, v32
    v_or_b32 v32, v32, v33
    v_cmp_gt_i32_e64 vcc, 0, v32
    s_sub_u32 s60, s60, 1
    s_cbranch_scc1 L_g_ok
    s_cbranch_vccz L_g_ok
    buffer_load_dwordx4 v[16:19], v3, s[4:7], s29 offen offset:0 sc1
    buffer_load_dwordx4 v[20:23], v3, s[4:7], s29 offen offset:1024 sc1
    buffer_load_dwordx4 v[24:27], v3, s[4:7], s29 offen offset:2048 sc1
    buffer_load_dwordx4 v[28:31], v3, s[4:7], s29 offen offset:3072 sc1
    s_waitcnt vmcnt(0)
    s_branch L_g_chk
L_g_ok:
    v_add_f32 v16, v16, v20
    v_add_f32 v24, v24, v28
    v_add_f32 v17, v17, v21
    v_add_f32 v25, v25, v29
    v_add_f32 v18, v18, v22
    v_add_f32 v26, v26, v30
    v_add_f32 v19, v19, v23
    v_add_f32 v27, v27, v31
    v_add_f32 v16, v16, v24
    v_add_f32 v17, v17, v25
    v_add_f32 v18, v18, v26
    v_add_f32 v19, v19, v27
    v_add_f32_dpp v16, v16, v16 row_ror:4 row_mask:0xf bank_mask:0xf
    v_add_f32_dpp v17, v17, v17 row_ror:4 row_mask:0xf bank_mask:0xf
    v_add_f32_dpp v18, v18, v18 row_ror:4 row_mask:0xf bank_mask:0xf
    v_add_f32_dpp v19, v19, v19 row_ror:4 row_mask:0xf bank_mask:0xf
    v_add_f32_dpp v16, v16, v16 row_ror:8 row_mask:0xf bank_mask:0xf
    v_add_f32_dpp v17, v17, v17 row_ror:8 row_mask:0xf bank_mask:0xf
    v_add_f32_dpp v18, v18, v18 row_ror:8 row_mask:0xf bank_mask:0xf
    v_add_f32_dpp v19, v19, v19 row_ror:8 row_mask:0xf bank_mask:0xf
    v_mul_f32 v16, 0x39e38e39, v16
    v_mul_f32 v17, 0x39e38e39, v17
    v_mul_f32 v18, 0x39e38e39, v18
    v_mul_f32 v19, 0x39e38e39, v19
    v_fma_f32 v17, -v16, v16, v17
    v_fma_f32 v19, -v18, v18, v19
    v_max_f32 v17, 0, v17
    v_max_f32 v19, 0, v19
    v_add_f32 v17, 0x3727c5ac, v17
    v_add_f32 v19, 0x3727c5ac, v19
    v_rsq_f32 v20, v17
    v_rsq_f32 v21, v19
    v_and_b32 v32, 0xff, v3
    s_lshl_b32 s33, s20, 8
    s_add_u32 s33, s33, 148480
    v_add_u32 v32, s33, v32
    v_mul_f32 v22, v16, v20
    v_mul_f32 v23, v18, v21
    ds_write_b128 v32, v[20:23]
    s_setprio 0
    s_waitcnt vmcnt(17) lgkmcnt(0)
    s_barrier
    s_mov_b32 s48, 3
    s_mul_i32 s50, s48, 18432
    s_add_u32 s50, s50, s34
    s_add_u32 s50, s50, 165888
    s_add_u32 m0, s30, 0
    s_mov_b32 s53, s50
    buffer_load_dwordx4 v1, s[4:7], s50 offen offset:0  sc1 lds
    buffer_load_dwordx4 v1, s[4:7], s50 offen offset:1024  sc1 lds
    buffer_load_dwordx4 v1, s[4:7], s50 offen offset:2048  sc1 lds
    buffer_load_dwordx4 v1, s[4:7], s50 offen offset:3072  sc1 lds
    s_add_u32 m0, s30, 18432
    s_add_u32 s51, s35, 6144
    buffer_load_dwordx4 v1, s[4:7], s51 offen offset:0 sc1 lds
    buffer_load_dwordx4 v1, s[4:7], s51 offen offset:1024 sc1 lds
    buffer_load_dwordx4 v2, s[4:7], s51 offen offset:2048 sc1 lds
    buffer_load_dwordx4 v2, s[4:7], s51 offen offset:3072 sc1 lds
    s_waitcnt vmcnt(16) lgkmcnt(0)
    s_barrier
    s_mov_b32 s48, 4
    s_mul_i32 s50, s48, 18432
    s_add_u32 s50, s50, s34
    s_add_u32 s50, s50, 165888
    s_cmp_ge_u32 s20, 2
    s_cselect_b32 s52, s50, s53
    s_add_u32 m0, s31, 0
    s_add_u32 s52, s52, s49
    buffer_load_dwordx4 v1, s[4:7], s52 offen  sc1 lds
    s_add_u32 m0, s30, 36864
    s_mov_b32 s53, s50
    buffer_load_dwordx4 v1, s[4:7], s50 offen offset:0  sc1 lds
    buffer_load_dwordx4 v1, s[4:7], s50 offen offset:1024  sc1 lds
    buffer_load_dwordx4 v1, s[4:7], s50 offen offset:2048  sc1 lds
    buffer_load_dwordx4 v1, s[4:7], s50 offen offset:3072  sc1 lds
    s_add_u32 m0, s30, 55296
    s_add_u32 s51, s35, 8192
    buffer_load_dwordx4 v1, s[4:7], s51 offen offset:0 sc1 lds
    buffer_load_dwordx4 v1, s[4:7], s51 offen offset:1024 sc1 lds
    buffer_load_dwordx4 v2, s[4:7], s51 offen offset:2048 sc1 lds
    buffer_load_dwordx4 v2, s[4:7], s51 offen offset:3072 sc1 lds
    s_waitcnt vmcnt(17) lgkmcnt(0)
    s_barrier
    s_waitcnt vmcnt(8) lgkmcnt(0)
    s_barrier
    s_waitcnt vmcnt(0) lgkmcnt(0)
    s_barrier
    s_barrier
    s_mov_b32 s56, 1
    s_atomic_add s56, s[54:55], 0
    s_mov_b32 s57, 0
    s_atomic_add s57, s[54:55], 0 glc
    s_lshl_b32 s48, s23, 1
    s_add_u32 s48, s48, 0
    s_add_u32 m0, s30, 92160
    s_lshl_b32 s51, s48, 7
    buffer_load_dwordx4 v8, s[8:11], s51 offen offset:0  lds
    buffer_load_dwordx4 v9, s[8:11], s51 offen offset:1024  lds
    buffer_load_dwordx4 v10, s[8:11], s51 offen offset:2048  lds
    buffer_load_dwordx4 v11, s[8:11], s51 offen offset:3072  lds
    s_lshl_b32 s48, s23, 1
    s_add_u32 s48, s48, 1
    s_add_u32 m0, s30, 129024
    s_lshl_b32 s51, s48, 7
    buffer_load_dwordx4 v8, s[8:11], s51 offen offset:0  lds
    buffer_load_dwordx4 v9, s[8:11], s51 offen offset:1024  lds
    buffer_load_dwordx4 v10, s[8:11], s51 offen offset:2048  lds
    buffer_load_dwordx4 v11, s[8:11], s51 offen offset:3072  lds
    s_lshr_b32 s48, s46, 1
    s_cmp_eq_u32 s48, s23
    s_cselect_b32 s48, 1, 31
    s_and_b32 s48, s48, s46
    s_add_u32 m0, s30, 18432
    s_lshl_b32 s51, s48, 7
    buffer_load_dwordx4 v8, s[8:11], s51 offen offset:0  lds
    buffer_load_dwordx4 v9, s[8:11], s51 offen offset:1024  lds
    buffer_load_dwordx4 v10, s[8:11], s51 offen offset:2048  lds
    buffer_load_dwordx4 v11, s[8:11], s51 offen offset:3072  lds
    s_waitcnt lgkmcnt(0)
    s_cmp_ge_u32 s57, 16
    s_cbranch_scc1 L_g_r0
    s_mov_b32 s57, 0
    s_atomic_add s57, s[54:55], 0 glc
    s_waitcnt vmcnt(8)
    s_barrier
    s_waitcnt lgkmcnt(0)
    s_cmp_ge_u32 s57, 16
    s_cbranch_scc1 L_g_r1
    s_waitcnt vmcnt(4)
    s_barrier
    s_mov_b32 s60, 65536
L_poll_z2:
    s_mov_b32 s57, 0
    s_atomic_add s57, s[54:55], 0 glc
    s_waitcnt lgkmcnt(0)
    s_cmp_ge_u32 s57, 16
    s_cbranch_scc1 L_pd_z2
    s_sub_u32 s60, s60, 1
    s_cbranch_scc1 L_pd_z2
    s_sleep 2
    s_branch L_poll_z2
    s_nop 0
L_pd_z2:
    s_lshr_b32 s48, s46, 1
    s_cmp_eq_u32 s48, s23
    s_cselect_b32 s48, 1, 31
    s_and_b32 s48, s48, s46
    s_mul_i32 s50, s48, 18432
    s_add_u32 s50, s50, s36
    s_add_u32 m0, s30, 0
    s_mov_b32 s53, s50
    buffer_load_dwordx4 v1, s[4:7], s50 offen offset:0 sc1 lds
    buffer_load_dwordx4 v1, s[4:7], s50 offen offset:1024 sc1 lds
    buffer_load_dwordx4 v1, s[4:7], s50 offen offset:2048 sc1 lds
    buffer_load_dwordx4 v1, s[4:7], s50 offen offset:3072 sc1 lds
    s_lshr_b32 s48, s47, 1
    s_cmp_eq_u32 s48, s23
    s_cselect_b32 s48, 1, 31
    s_and_b32 s48, s48, s47
    s_mul_i32 s50, s48, 18432
    s_add_u32 s50, s50, s36
    s_cmp_ge_u32 s20, 2
    s_cselect_b32 s52, s50, s53
    s_add_u32 m0, s31, 0
    s_add_u32 s52, s52, s49
    buffer_load_dwordx4 v1, s[4:7], s52 offen sc1 lds
    s_add_u32 m0, s30, 36864
    s_mov_b32 s53, s50
    buffer_load_dwordx4 v1, s[4:7], s50 offen offset:0 sc1 lds
    buffer_load_dwordx4 v1, s[4:7], s50 offen offset:1024 sc1 lds
    buffer_load_dwordx4 v1, s[4:7], s50 offen offset:2048 sc1 lds
    buffer_load_dwordx4 v1, s[4:7], s50 offen offset:3072 sc1 lds
    s_lshr_b32 s48, s47, 1
    s_cmp_eq_u32 s48, s23
    s_cselect_b32 s48, 1, 31
    s_and_b32 s48, s48, s47
    s_add_u32 m0, s30, 55296
    s_lshl_b32 s51, s48, 7
    buffer_load_dwordx4 v8, s[8:11], s51 offen offset:0  lds
    buffer_load_dwordx4 v9, s[8:11], s51 offen offset:1024  lds
    buffer_load_dwordx4 v10, s[8:11], s51 offen offset:2048  lds
    buffer_load_dwordx4 v11, s[8:11], s51 offen offset:3072  lds
    s_branch L_g_jn
    s_nop 0
L_g_r0:
    s_lshr_b32 s48, s46, 1
    s_cmp_eq_u32 s48, s23
    s_cselect_b32 s48, 1, 31
    s_and_b32 s48, s48, s46
    s_mul_i32 s50, s48, 18432
    s_add_u32 s50, s50, s36
    s_add_u32 m0, s30, 0
    s_mov_b32 s53, s50
    buffer_load_dwordx4 v1, s[4:7], s50 offen offset:0 sc1 lds
    buffer_load_dwordx4 v1, s[4:7], s50 offen offset:1024 sc1 lds
    buffer_load_dwordx4 v1, s[4:7], s50 offen offset:2048 sc1 lds
    buffer_load_dwordx4 v1, s[4:7], s50 offen offset:3072 sc1 lds
    s_lshr_b32 s48, s47, 1
    s_cmp_eq_u32 s48, s23
    s_cselect_b32 s48, 1, 31
    s_and_b32 s48, s48, s47
    s_mul_i32 s50, s48, 18432
    s_add_u32 s50, s50, s36
    s_cmp_ge_u32 s20, 2
    s_cselect_b32 s52, s50, s53
    s_add_u32 m0, s31, 0
    s_add_u32 s52, s52, s49
    buffer_load_dwordx4 v1, s[4:7], s52 offen sc1 lds
    s_add_u32 m0, s30, 36864
    s_mov_b32 s53, s50
    buffer_load_dwordx4 v1, s[4:7], s50 offen offset:0 sc1 lds
    buffer_load_dwordx4 v1, s[4:7], s50 offen offset:1024 sc1 lds
    buffer_load_dwordx4 v1, s[4:7], s50 offen offset:2048 sc1 lds
    buffer_load_dwordx4 v1, s[4:7], s50 offen offset:3072 sc1 lds
    s_lshr_b32 s48, s47, 1
    s_cmp_eq_u32 s48, s23
    s_cselect_b32 s48, 1, 31
    s_and_b32 s48, s48, s47
    s_add_u32 m0, s30, 55296
    s_lshl_b32 s51, s48, 7
    buffer_load_dwordx4 v8, s[8:11], s51 offen offset:0  lds
    buffer_load_dwordx4 v9, s[8:11], s51 offen offset:1024  lds
    buffer_load_dwordx4 v10, s[8:11], s51 offen offset:2048  lds
    buffer_load_dwordx4 v11, s[8:11], s51 offen offset:3072  lds
    s_waitcnt vmcnt(21)
    s_barrier
    s_waitcnt vmcnt(17)
    s_barrier
    s_branch L_g_jn
    s_nop 0
L_g_r1:
    s_lshr_b32 s48, s46, 1
    s_cmp_eq_u32 s48, s23
    s_cselect_b32 s48, 1, 31
    s_and_b32 s48, s48, s46
    s_mul_i32 s50, s48, 18432
    s_add_u32 s50, s50, s36
    s_add_u32 m0, s30, 0
    s_mov_b32 s53, s50
    buffer_load_dwordx4 v1, s[4:7], s50 offen offset:0 sc1 lds
    buffer_load_dwordx4 v1, s[4:7], s50 offen offset:1024 sc1 lds
    buffer_load_dwordx4 v1, s[4:7], s50 offen offset:2048 sc1 lds
    buffer_load_dwordx4 v1, s[4:7], s50 offen offset:3072 sc1 lds
    s_lshr_b32 s48, s47, 1
    s_cmp_eq_u32 s48, s23
    s_cselect_b32 s48, 1, 31
    s_and_b32 s48, s48, s47
    s_mul_i32 s50, s48, 18432
    s_add_u32 s50, s50, s36
    s_cmp_ge_u32 s20, 2
    s_cselect_b32 s52, s50, s53
    s_add_u32 m0, s31, 0
    s_add_u32 s52, s52, s49
    buffer_load_dwordx4 v1, s[4:7], s52 offen sc1 lds
    s_add_u32 m0, s30, 36864
    s_mov_b32 s53, s50
    buffer_load_dwordx4 v1, s[4:7], s50 offen offset:0 sc1 lds
    buffer_load_dwordx4 v1, s[4:7], s50 offen offset:1024 sc1 lds
    buffer_load_dwordx4 v1, s[4:7], s50 offen offset:2048 sc1 lds
    buffer_load_dwordx4 v1, s[4:7], s50 offen offset:3072 sc1 lds
    s_lshr_b32 s48, s47, 1
    s_cmp_eq_u32 s48, s23
    s_cselect_b32 s48, 1, 31
    s_and_b32 s48, s48, s47
    s_add_u32 m0, s30, 55296
    s_lshl_b32 s51, s48, 7
    buffer_load_dwordx4 v8, s[8:11], s51 offen offset:0  lds
    buffer_load_dwordx4 v9, s[8:11], s51 offen offset:1024  lds
    buffer_load_dwordx4 v10, s[8:11], s51 offen offset:2048  lds
    buffer_load_dwordx4 v11, s[8:11], s51 offen offset:3072  lds
    s_waitcnt vmcnt(17)
    s_barrier
L_g_jn:
    s_add_u32 s44, s44, 4
    s_cmp_ge_u32 s44, 32
    s_cselect_b32 s44, 4, s44
    s_add_u32 s45, s45, 4
    s_cmp_ge_u32 s45, 32
    s_cselect_b32 s45, 5, s45
    s_add_u32 s46, s46, 4
    s_and_b32 s46, s46, 31
    s_add_u32 s47, s47, 4
    s_and_b32 s47, s47, 31
    s_lshr_b32 s48, s44, 1
    s_cmp_eq_u32 s48, s23
    s_cselect_b32 s48, 1, 31
    s_and_b32 s48, s48, s44
    s_mul_i32 s50, s48, 18432
    s_add_u32 s50, s50, s36
    s_add_u32 m0, s30, 73728
    s_mov_b32 s53, s50
    buffer_load_dwordx4 v1, s[4:7], s50 offen offset:0 sc1 lds
    buffer_load_dwordx4 v1, s[4:7], s50 offen offset:1024 sc1 lds
    buffer_load_dwordx4 v1, s[4:7], s50 offen offset:2048 sc1 lds
    buffer_load_dwordx4 v1, s[4:7], s50 offen offset:3072 sc1 lds
    s_lshr_b32 s48, s44, 1
    s_cmp_eq_u32 s48, s23
    s_cselect_b32 s48, 1, 31
    s_and_b32 s48, s48, s44
    s_add_u32 m0, s30, 92160
    s_lshl_b32 s51, s48, 7
    buffer_load_dwordx4 v8, s[8:11], s51 offen offset:0  lds
    buffer_load_dwordx4 v9, s[8:11], s51 offen offset:1024  lds
    buffer_load_dwordx4 v10, s[8:11], s51 offen offset:2048  lds
    buffer_load_dwordx4 v11, s[8:11], s51 offen offset:3072  lds
    s_add_u32 s44, s44, 4
    s_cmp_ge_u32 s44, 32
    s_cselect_b32 s44, 4, s44
    s_waitcnt vmcnt(16)
    s_barrier
    s_lshr_b32 s48, s45, 1
    s_cmp_eq_u32 s48, s23
    s_cselect_b32 s48, 1, 31
    s_and_b32 s48, s48, s45
    s_mul_i32 s50, s48, 18432
    s_add_u32 s50, s50, s36
    s_cmp_ge_u32 s20, 2
    s_cselect_b32 s52, s50, s53
    s_add_u32 m0, s31, 73728
    s_add_u32 s52, s52, s49
    buffer_load_dwordx4 v1, s[4:7], s52 offen sc1 lds
    s_add_u32 m0, s30, 110592
    s_mov_b32 s53, s50
    buffer_load_dwordx4 v1, s[4:7], s50 offen offset:0 sc1 lds
    buffer_load_dwordx4 v1, s[4:7], s50 offen offset:1024 sc1 lds
    buffer_load_dwordx4 v1, s[4:7], s50 offen offset:2048 sc1 lds
    buffer_load_dwordx4 v1, s[4:7], s50 offen offset:3072 sc1 lds
    s_lshr_b32 s48, s45, 1
    s_cmp_eq_u32 s48, s23
    s_cselect_b32 s48, 1, 31
    s_and_b32 s48, s48, s45
    s_add_u32 m0, s30, 129024
    s_lshl_b32 s51, s48, 7
    buffer_load_dwordx4 v8, s[8:11], s51 offen offset:0  lds
    buffer_load_dwordx4 v9, s[8:11], s51 offen offset:1024  lds
    buffer_load_dwordx4 v10, s[8:11], s51 offen offset:2048  lds
    buffer_load_dwordx4 v11, s[8:11], s51 offen offset:3072  lds
    s_add_u32 s45, s45, 4
    s_cmp_ge_u32 s45, 32
    s_cselect_b32 s45, 5, s45
    s_waitcnt vmcnt(17)
    s_barrier
    s_lshr_b32 s48, s46, 1
    s_cmp_eq_u32 s48, s23
    s_cselect_b32 s48, 1, 31
    s_and_b32 s48, s48, s46
    s_mul_i32 s50, s48, 18432
    s_add_u32 s50, s50, s36
    s_add_u32 m0, s30, 0
    s_mov_b32 s53, s50
    buffer_load_dwordx4 v1, s[4:7], s50 offen offset:0 sc1 lds
    buffer_load_dwordx4 v1, s[4:7], s50 offen offset:1024 sc1 lds
    buffer_load_dwordx4 v1, s[4:7], s50 offen offset:2048 sc1 lds
    buffer_load_dwordx4 v1, s[4:7], s50 offen offset:3072 sc1 lds
    s_lshr_b32 s48, s46, 1
    s_cmp_eq_u32 s48, s23
    s_cselect_b32 s48, 1, 31
    s_and_b32 s48, s48, s46
    s_add_u32 m0, s30, 18432
    s_lshl_b32 s51, s48, 7
    buffer_load_dwordx4 v8, s[8:11], s51 offen offset:0  lds
    buffer_load_dwordx4 v9, s[8:11], s51 offen offset:1024  lds
    buffer_load_dwordx4 v10, s[8:11], s51 offen offset:2048  lds
    buffer_load_dwordx4 v11, s[8:11], s51 offen offset:3072  lds
    s_add_u32 s46, s46, 4
    s_and_b32 s46, s46, 31
    s_waitcnt vmcnt(16)
    s_barrier
    s_lshr_b32 s48, s47, 1
    s_cmp_eq_u32 s48, s23
    s_cselect_b32 s48, 1, 31
    s_and_b32 s48, s48, s47
    s_mul_i32 s50, s48, 18432
    s_add_u32 s50, s50, s36
    s_cmp_ge_u32 s20, 2
    s_cselect_b32 s52, s50, s53
    s_add_u32 m0, s31, 0
    s_add_u32 s52, s52, s49
    buffer_load_dwordx4 v1, s[4:7], s52 offen sc1 lds
    s_add_u32 m0, s30, 36864
    s_mov_b32 s53, s50
    buffer_load_dwordx4 v1, s[4:7], s50 offen offset:0 sc1 lds
    buffer_load_dwordx4 v1, s[4:7], s50 offen offset:1024 sc1 lds
    buffer_load_dwordx4 v1, s[4:7], s50 offen offset:2048 sc1 lds
    buffer_load_dwordx4 v1, s[4:7], s50 offen offset:3072 sc1 lds
    s_lshr_b32 s48, s47, 1
    s_cmp_eq_u32 s48, s23
    s_cselect_b32 s48, 1, 31
    s_and_b32 s48, s48, s47
    s_add_u32 m0, s30, 55296
    s_lshl_b32 s51, s48, 7
    buffer_load_dwordx4 v8, s[8:11], s51 offen offset:0  lds
    buffer_load_dwordx4 v9, s[8:11], s51 offen offset:1024  lds
    buffer_load_dwordx4 v10, s[8:11], s51 offen offset:2048  lds
    buffer_load_dwordx4 v11, s[8:11], s51 offen offset:3072  lds
    s_add_u32 s47, s47, 4
    s_and_b32 s47, s47, 31
    s_mov_b32 s41, 6
L_g_ll:
    s_waitcnt vmcnt(17)
    s_barrier
    s_lshr_b32 s48, s44, 1
    s_cmp_eq_u32 s48, s23
    s_cselect_b32 s48, 1, 31
    s_and_b32 s48, s48, s44
    s_mul_i32 s50, s48, 18432
    s_add_u32 s50, s50, s36
    s_add_u32 m0, s30, 73728
    s_mov_b32 s53, s50
    buffer_load_dwordx4 v1, s[4:7], s50 offen offset:0 sc1 lds
    buffer_load_dwordx4 v1, s[4:7], s50 offen offset:1024 sc1 lds
    buffer_load_dwordx4 v1, s[4:7], s50 offen offset:2048 sc1 lds
    buffer_load_dwordx4 v1, s[4:7], s50 offen offset:3072 sc1 lds
    s_lshr_b32 s48, s44, 1
    s_cmp_eq_u32 s48, s23
    s_cselect_b32 s48, 1, 31
    s_and_b32 s48, s48, s44
    s_add_u32 m0, s30, 92160
    s_lshl_b32 s51, s48, 7
    buffer_load_dwordx4 v8, s[8:11], s51 offen offset:0  lds
    buffer_load_dwordx4 v9, s[8:11], s51 offen offset:1024  lds
    buffer_load_dwordx4 v10, s[8:11], s51 offen offset:2048  lds
    buffer_load_dwordx4 v11, s[8:11], s51 offen offset:3072  lds
    s_add_u32 s44, s44, 4
    s_cmp_ge_u32 s44, 32
    s_cselect_b32 s44, 4, s44
    s_waitcnt vmcnt(16)
    s_barrier
    s_lshr_b32 s48, s45, 1
    s_cmp_eq_u32 s48, s23
    s_cselect_b32 s48, 1, 31
    s_and_b32 s48, s48, s45
    s_mul_i32 s50, s48, 18432
    s_add_u32 s50, s50, s36
    s_cmp_ge_u32 s20, 2
    s_cselect_b32 s52, s50, s53
    s_add_u32 m0, s31, 73728
    s_add_u32 s52, s52, s49
    buffer_load_dwordx4 v1, s[4:7], s52 offen sc1 lds
    s_add_u32 m0, s30, 110592
    s_mov_b32 s53, s50
    buffer_load_dwordx4 v1, s[4:7], s50 offen offset:0 sc1 lds
    buffer_load_dwordx4 v1, s[4:7], s50 offen offset:1024 sc1 lds
    buffer_load_dwordx4 v1, s[4:7], s50 offen offset:2048 sc1 lds
    buffer_load_dwordx4 v1, s[4:7], s50 offen offset:3072 sc1 lds
    s_lshr_b32 s48, s45, 1
    s_cmp_eq_u32 s48, s23
    s_cselect_b32 s48, 1, 31
    s_and_b32 s48, s48, s45
    s_add_u32 m0, s30, 129024
    s_lshl_b32 s51, s48, 7
    buffer_load_dwordx4 v8, s[8:11], s51 offen offset:0  lds
    buffer_load_dwordx4 v9, s[8:11], s51 offen offset:1024  lds
    buffer_load_dwordx4 v10, s[8:11], s51 offen offset:2048  lds
    buffer_load_dwordx4 v11, s[8:11], s51 offen offset:3072  lds
    s_add_u32 s45, s45, 4
    s_cmp_ge_u32 s45, 32
    s_cselect_b32 s45, 5, s45
    s_waitcnt vmcnt(17)
    s_barrier
    s_lshr_b32 s48, s46, 1
    s_cmp_eq_u32 s48, s23
    s_cselect_b32 s48, 1, 31
    s_and_b32 s48, s48, s46
    s_mul_i32 s50, s48, 18432
    s_add_u32 s50, s50, s36
    s_add_u32 m0, s30, 0
    s_mov_b32 s53, s50
    buffer_load_dwordx4 v1, s[4:7], s50 offen offset:0 sc1 lds
    buffer_load_dwordx4 v1, s[4:7], s50 offen offset:1024 sc1 lds
    buffer_load_dwordx4 v1, s[4:7], s50 offen offset:2048 sc1 lds
    buffer_load_dwordx4 v1, s[4:7], s50 offen offset:3072 sc1 lds
    s_lshr_b32 s48, s46, 1
    s_cmp_eq_u32 s48, s23
    s_cselect_b32 s48, 1, 31
    s_and_b32 s48, s48, s46
    s_add_u32 m0, s30, 18432
    s_lshl_b32 s51, s48, 7
    buffer_load_dwordx4 v8, s[8:11], s51 offen offset:0  lds
    buffer_load_dwordx4 v9, s[8:11], s51 offen offset:1024  lds
    buffer_load_dwordx4 v10, s[8:11], s51 offen offset:2048  lds
    buffer_load_dwordx4 v11, s[8:11], s51 offen offset:3072  lds
    s_add_u32 s46, s46, 4
    s_and_b32 s46, s46, 31
    s_waitcnt vmcnt(16)
    s_barrier
    s_lshr_b32 s48, s47, 1
    s_cmp_eq_u32 s48, s23
    s_cselect_b32 s48, 1, 31
    s_and_b32 s48, s48, s47
    s_mul_i32 s50, s48, 18432
    s_add_u32 s50, s50, s36
    s_cmp_ge_u32 s20, 2
    s_cselect_b32 s52, s50, s53
    s_add_u32 m0, s31, 0
    s_add_u32 s52, s52, s49
    buffer_load_dwordx4 v1, s[4:7], s52 offen sc1 lds
    s_add_u32 m0, s30, 36864
    s_mov_b32 s53, s50
    buffer_load_dwordx4 v1, s[4:7], s50 offen offset:0 sc1 lds
    buffer_load_dwordx4 v1, s[4:7], s50 offen offset:1024 sc1 lds
    buffer_load_dwordx4 v1, s[4:7], s50 offen offset:2048 sc1 lds
    buffer_load_dwordx4 v1, s[4:7], s50 offen offset:3072 sc1 lds
    s_lshr_b32 s48, s47, 1
    s_cmp_eq_u32 s48, s23
    s_cselect_b32 s48, 1, 31
    s_and_b32 s48, s48, s47
    s_add_u32 m0, s30, 55296
    s_lshl_b32 s51, s48, 7
    buffer_load_dwordx4 v8, s[8:11], s51 offen offset:0  lds
    buffer_load_dwordx4 v9, s[8:11], s51 offen offset:1024  lds
    buffer_load_dwordx4 v10, s[8:11], s51 offen offset:2048  lds
    buffer_load_dwordx4 v11, s[8:11], s51 offen offset:3072  lds
    s_add_u32 s47, s47, 4
    s_and_b32 s47, s47, 31
    s_sub_u32 s41, s41, 1
    s_cmp_lg_u32 s41, 0
    s_cbranch_scc1 L_g_ll
    s_waitcnt vmcnt(17)
    s_barrier
    s_mov_b32 s32, 0
    s_mul_i32 s32, s32, 36864
    s_add_u32 s32, s32, s43
    s_add_u32 m0, s42, 73728
    s_add_u32 s33, s32, 0
    buffer_load_dwordx4 v1, s[4:7], s33 offen offset:0  sc1 lds
    buffer_load_dwordx4 v1, s[4:7], s33 offen offset:1024  sc1 lds
    buffer_load_dwordx4 v1, s[4:7], s33 offen offset:2048  sc1 lds
    buffer_load_dwordx4 v1, s[4:7], s33 offen offset:3072  sc1 lds
    s_add_u32 m0, s42, 77824
    s_add_u32 s33, s32, 4096
    buffer_load_dwordx4 v1, s[4:7], s33 offen offset:0  sc1 lds
    buffer_load_dwordx4 v1, s[4:7], s33 offen offset:1024  sc1 lds
    buffer_load_dwordx4 v1, s[4:7], s33 offen offset:2048  sc1 lds
    buffer_load_dwordx4 v1, s[4:7], s33 offen offset:3072  sc1 lds
    s_add_u32 m0, s42, 81920
    s_add_u32 s33, s32, 8192
    buffer_load_dwordx4 v1, s[4:7], s33 offen offset:0  sc1 lds
    s_waitcnt vmcnt(9)
    s_barrier
    s_cmp_lg_u32 s22, 0
    s_cbranch_scc1 L_p5_k48
    s_add_u32 s32, s43, 110592
    buffer_load_dwordx4 v[40:43], v1, s[4:7], s32 offen offset:0 sc1
    buffer_load_dwordx4 v[44:47], v1, s[4:7], s32 offen offset:1024 sc1
    buffer_load_dwordx4 v[48:51], v1, s[4:7], s32 offen offset:2048 sc1
    buffer_load_dwordx4 v[52:55], v1, s[4:7], s32 offen offset:3072 sc1
    s_add_u32 s32, s43, 114688
    buffer_load_dwordx4 v[56:59], v1, s[4:7], s32 offen offset:0 sc1
    buffer_load_dwordx4 v[60:63], v1, s[4:7], s32 offen offset:1024 sc1
    buffer_load_dwordx4 v[64:67], v1, s[4:7], s32 offen offset:2048 sc1
    buffer_load_dwordx4 v[68:71], v1, s[4:7], s32 offen offset:3072 sc1
    s_add_u32 s32, s43, 118784
    buffer_load_dwordx4 v[72:75], v1, s[4:7], s32 offen offset:0 sc1
L_p5_k48:
    s_mov_b32 s32, 1
    s_mul_i32 s32, s32, 36864
    s_add_u32 s32, s32, s43
    s_add_u32 m0, s42, 110592
    s_add_u32 s33, s32, 0
    buffer_load_dwordx4 v1, s[4:7], s33 offen offset:0  sc1 lds
    buffer_load_dwordx4 v1, s[4:7], s33 offen offset:1024  sc1 lds
    buffer_load_dwordx4 v1, s[4:7], s33 offen offset:2048  sc1 lds
    buffer_load_dwordx4 v1, s[4:7], s33 offen offset:3072  sc1 lds
    s_add_u32 m0, s42, 114688
    s_add_u32 s33, s32, 4096
    buffer_load_dwordx4 v1, s[4:7], s33 offen offset:0  sc1 lds
    buffer_load_dwordx4 v1, s[4:7], s33 offen offset:1024  sc1 lds
    buffer_load_dwordx4 v1, s[4:7], s33 offen offset:2048  sc1 lds
    buffer_load_dwordx4 v1, s[4:7], s33 offen offset:3072  sc1 lds
    s_add_u32 m0, s42, 118784
    s_add_u32 s33, s32, 8192
    buffer_load_dwordx4 v1, s[4:7], s33 offen offset:0  sc1 lds
    s_barrier
    v_add_u32 v12, s42, v1
    v_add_u32 v13, 36864, v12
    v_add_u32 v14, 73728, v12
    v_add_u32 v15, 110592, v12
    s_waitcnt vmcnt(9)
    ds_write_b128 v13, v[40:43] offset:0
    ds_write_b128 v13, v[44:47] offset:1024
    ds_write_b128 v13, v[48:51] offset:2048
    ds_write_b128 v13, v[52:55] offset:3072
    ds_write_b128 v13, v[56:59] offset:4096
    ds_write_b128 v13, v[60:63] offset:5120
    ds_write_b128 v13, v[64:67] offset:6144
    ds_write_b128 v13, v[68:71] offset:7168
    ds_write_b128 v13, v[72:75] offset:8192
    s_barrier
    s_mov_b32 s32, 2
    s_mul_i32 s32, s32, 36864
    s_add_u32 s32, s32, s43
    s_add_u32 m0, s42, 0
    s_add_u32 s33, s32, 0
    buffer_load_dwordx4 v1, s[4:7], s33 offen offset:0  sc1 lds
    buffer_load_dwordx4 v1, s[4:7], s33 offen offset:1024  sc1 lds
    buffer_load_dwordx4 v1, s[4:7], s33 offen offset:2048  sc1 lds
    buffer_load_dwordx4 v1, s[4:7], s33 offen offset:3072  sc1 lds
    s_add_u32 m0, s42, 4096
    s_add_u32 s33, s32, 4096
    buffer_load_dwordx4 v1, s[4:7], s33 offen offset:0  sc1 lds
    buffer_load_dwordx4 v1, s[4:7], s33 offen offset:1024  sc1 lds
    buffer_load_dwordx4 v1, s[4:7], s33 offen offset:2048  sc1 lds
    buffer_load_dwordx4 v1, s[4:7], s33 offen offset:3072  sc1 lds
    s_add_u32 m0, s42, 8192
    s_add_u32 s33, s32, 8192
    buffer_load_dwordx4 v1, s[4:7], s33 offen offset:0  sc1 lds
    s_waitcnt vmcnt(18) lgkmcnt(0)
    s_barrier
    s_waitcnt vmcnt(9) lgkmcnt(15)
    s_barrier
    ds_write_b128 v14, v[76:79] offset:0
    ds_write_b128 v14, v[80:83] offset:1024
    ds_write_b128 v14, v[84:87] offset:2048
    ds_write_b128 v14, v[88:91] offset:3072
    ds_write_b128 v14, v[92:95] offset:4096
    ds_write_b128 v14, v[96:99] offset:5120
    ds_write_b128 v14, v[100:103] offset:6144
    s_waitcnt vmcnt(0) lgkmcnt(15)
    s_barrier
    ds_write_b128 v14, v[104:107] offset:7168
    ds_write_b128 v14, v[108:111] offset:8192
    ds_write_b128 v15, v[112:115] offset:0
    ds_write_b128 v15, v[116:119] offset:1024
    ds_write_b128 v15, v[120:123] offset:2048
    ds_write_b128 v15, v[124:127] offset:3072
    ds_write_b128 v15, v[128:131] offset:4096
    s_waitcnt vmcnt(63) lgkmcnt(15)
    s_barrier
    ds_write_b128 v15, v[132:135] offset:5120
    ds_write_b128 v15, v[136:139] offset:6144
    ds_write_b128 v15, v[140:143] offset:7168
    ds_write_b128 v15, v[144:147] offset:8192
    ds_write_b128 v12, v[148:151] offset:0
    ds_write_b128 v12, v[152:155] offset:1024
    ds_write_b128 v12, v[156:159] offset:2048
    s_waitcnt vmcnt(63) lgkmcnt(12)
    s_barrier
    ds_write_b128 v12, v[160:163] offset:3072
    ds_write_b128 v12, v[164:167] offset:4096
    ds_write_b128 v12, v[168:171] offset:5120
    ds_write_b128 v12, v[172:175] offset:6144
    ds_write_b128 v12, v[176:179] offset:7168
    ds_write_b128 v12, v[180:183] offset:8192
    s_waitcnt vmcnt(63) lgkmcnt(9)
    s_barrier
    ds_write_b128 v13, v[184:187] offset:0
    ds_write_b128 v13, v[188:191] offset:1024
    ds_write_b128 v13, v[192:195] offset:2048
    ds_write_b128 v13, v[196:199] offset:3072
    ds_write_b128 v13, v[200:203] offset:4096
    ds_write_b128 v13, v[204:207] offset:5120
    s_waitcnt vmcnt(63) lgkmcnt(6)
    s_barrier
    s_and_b32 s25, s2, 7
    s_lshr_b32 s26, s2, 3
    s_lshr_b32 s23, s25, 1
    s_lshl_b32 s23, s23, 2
    s_lshr_b32 s27, s26, 3
    s_add_u32 s23, s23, s27
    s_and_b32 s24, s25, 1
    s_lshl_b32 s24, s24, 3
    s_and_b32 s27, s26, 7
    s_add_u32 s24, s24, s27
    s_mul_i32 s29, s24, 129024
    s_lshl_b32 s30, s20, 12
    s_add_u32 s29, s29, s30
    s_add_u32 s29, s29, 0x3800000
    s_lshl_b32 s31, s23, 3
    s_max_u32 s31, s31, 1
    s_sub_u32 s31, s31, 1
    s_mul_i32 s31, s31, 18432
    s_add_u32 s31, s31, 0x1c00000
    s_lshl_b32 s35, s20, 10
    s_and_b32 s36, s35, 1024
    ds_write_b128 v13, v[208:211] offset:6144
    ds_write_b128 v13, v[212:215] offset:7168
    ds_write_b128 v13, v[216:219] offset:8192
    ds_write_b128 v14, v[220:223] offset:0
    ds_write_b128 v14, v[224:227] offset:1024
    ds_write_b128 v14, v[228:231] offset:2048
    s_waitcnt vmcnt(63) lgkmcnt(3)
    s_barrier
    ds_write_b128 v14, v[232:235] offset:3072
    ds_write_b128 v14, v[236:239] offset:4096
    ds_write_b128 v14, v[240:243] offset:5120
    ds_write_b128 v14, v[244:247] offset:6144
    ds_write_b128 v14, v[248:251] offset:7168
    ds_write_b128 v14, v[252:255] offset:8192
    s_waitcnt vmcnt(63) lgkmcnt(0)
    s_barrier
    s_cmp_eq_u32 s22, 1
    s_cbranch_scc1 L_m_t8
    s_add_u32 m0, s30, 0
    s_add_u32 s34, s29, 0
    buffer_load_dwordx4 v1, s[4:7], s34 offen offset:0 sc1 lds
    buffer_load_dwordx4 v1, s[4:7], s34 offen offset:1024 sc1 lds
    buffer_load_dwordx4 v1, s[4:7], s34 offen offset:2048 sc1 lds
    buffer_load_dwordx4 v1, s[4:7], s34 offen offset:3072 sc1 lds
    s_add_u32 m0, s30, 16384
    s_add_u32 s34, s29, 16384
    buffer_load_dwordx4 v1, s[4:7], s34 offen offset:0 sc1 lds
    buffer_load_dwordx4 v1, s[4:7], s34 offen offset:1024 sc1 lds
    buffer_load_dwordx4 v1, s[4:7], s34 offen offset:2048 sc1 lds
    buffer_load_dwordx4 v1, s[4:7], s34 offen offset:3072 sc1 lds
L_m_t8:
    s_cmp_eq_u32 s22, 1
    s_cbranch_scc1 L_m_lfin
    s_barrier
    s_add_u32 m0, s30, 32768
    s_add_u32 s34, s29, 32768
    buffer_load_dwordx4 v1, s[4:7], s34 offen offset:0 sc1 lds
    buffer_load_dwordx4 v1, s[4:7], s34 offen offset:1024 sc1 lds
    buffer_load_dwordx4 v1, s[4:7], s34 offen offset:2048 sc1 lds
    buffer_load_dwordx4 v1, s[4:7], s34 offen offset:3072 sc1 lds
    s_add_u32 m0, s30, 114688
    s_add_u32 s34, s29, 114688
    buffer_load_dwordx4 v1, s[4:7], s34 offen offset:0 sc1 lds
    buffer_load_dwordx4 v1, s[4:7], s34 offen offset:1024 sc1 lds
    buffer_load_dwordx4 v1, s[4:7], s34 offen offset:2048 sc1 lds
    buffer_load_dwordx4 v1, s[4:7], s34 offen offset:3072 sc1 lds
    s_mov_b32 s22, 1
    s_mov_b32 s21, 0x1c00000
    s_barrier
    s_barrier
    s_add_u32 m0, s30, 49152
    s_add_u32 s34, s29, 49152
    buffer_load_dwordx4 v1, s[4:7], s34 offen offset:0 sc1 lds
    buffer_load_dwordx4 v1, s[4:7], s34 offen offset:1024 sc1 lds
    buffer_load_dwordx4 v1, s[4:7], s34 offen offset:2048 sc1 lds
    buffer_load_dwordx4 v1, s[4:7], s34 offen offset:3072 sc1 lds
    v_lshrrev_b32_e64 v2, 8, v1
    v_bfe_u32 v3, v1, 7, 1
    v_bfe_u32 v4, v1, 4, 3
    v_cmp_gt_u32_e64 vcc, 3, v2
    v_mul_u32_u24 v3, 80, v3
    v_lshl_add_u32 v3, v4, 3, v3
    v_lshrrev_b32 v5, 1, v4
    v_and_b32 v4, 1, v4
    v_lshl_add_u32 v4, v4, 3, 64
    v_cndmask_b32 v2, v5, v2, vcc
    v_cndmask_b32 v3, v4, v3, vcc
    v_mul_u32_u24 v2, 2304, v2
    v_add_u32 v0, v2, v3
    v_lshrrev_b32 v8, 1, v1
    s_mul_i32 s34, s24, 144
    s_add_u32 s34, s34, 0x4400000
    buffer_load_dwordx2 v[2:3], v0, s[4:7], s34 offen sc1
    s_mul_i32 s34, s24, 144
    s_add_u32 s34, s34, 0x4402000
    buffer_load_dwordx2 v[4:5], v0, s[4:7], s34 offen sc1
    s_mul_i32 s34, s24, 144
    s_add_u32 s34, s34, 0x4404000
    buffer_load_dwordx2 v[6:7], v0, s[4:7], s34 offen sc1
    s_mul_i32 s34, s24, 144
    s_add_u32 s34, s34, 0x4406000
    buffer_load_dwordx2 v[12:13], v0, s[4:7], s34 offen sc1
    s_add_u32 m0, s30, 65536
    s_add_u32 s34, s29, 65536
    buffer_load_dwordx4 v1, s[4:7], s34 offen offset:0 sc1 lds
    buffer_load_dwordx4 v1, s[4:7], s34 offen offset:1024 sc1 lds
    buffer_load_dwordx4 v1, s[4:7], s34 offen offset:2048 sc1 lds
    buffer_load_dwordx4 v1, s[4:7], s34 offen offset:3072 sc1 lds
    s_add_u32 m0, s30, 81920
    s_add_u32 s34, s29, 81920
    buffer_load_dwordx4 v1, s[4:7], s34 offen offset:0 sc1 lds
    buffer_load_dwordx4 v1, s[4:7], s34 offen offset:1024 sc1 lds
    buffer_load_dwordx4 v1, s[4:7], s34 offen offset:2048 sc1 lds
    buffer_load_dwordx4 v1, s[4:7], s34 offen offset:3072 sc1 lds
    s_barrier
    s_add_u32 m0, s35, 131072
    s_add_u32 s34, s31, s35
    s_add_u32 s34, s34, 0
    buffer_load_dwordx4 v1, s[4:7], s34 offen sc1 lds
    s_waitcnt vmcnt(29) lgkmcnt(0)
    s_barrier
    s_add_u32 m0, s35, 135168
    s_add_u32 s34, s31, s35
    s_add_u32 s34, s34, 4096
    buffer_load_dwordx4 v1, s[4:7], s34 offen sc1 lds
    s_waitcnt vmcnt(1) lgkmcnt(0)
    s_barrier
    s_add_u32 m0, s35, 139264
    s_add_u32 s34, s31, s35
    s_add_u32 s34, s34, 8192
    buffer_load_dwordx4 v1, s[4:7], s34 offen sc1 lds
    s_waitcnt vmcnt(2) lgkmcnt(0)
    s_barrier
    s_add_u32 m0, s35, 143360
    s_add_u32 s34, s31, s35
    s_add_u32 s34, s34, 12288
    buffer_load_dwordx4 v1, s[4:7], s34 offen sc1 lds
    s_add_u32 m0, s30, 98304
    s_add_u32 s34, s29, 98304
    buffer_load_dwordx4 v1, s[4:7], s34 offen offset:0 sc1 lds
    buffer_load_dwordx4 v1, s[4:7], s34 offen offset:1024 sc1 lds
    buffer_load_dwordx4 v1, s[4:7], s34 offen offset:2048 sc1 lds
    buffer_load_dwordx4 v1, s[4:7], s34 offen offset:3072 sc1 lds
    s_waitcnt vmcnt(6) lgkmcnt(0)
    s_barrier
    s_add_u32 m0, s36, 147456
    s_add_u32 s34, s31, s36
    s_add_u32 s34, s34, 16384
    buffer_load_dwordx4 v1, s[4:7], s34 offen sc1 lds
    v_add_f32 v2, v2, v4
    v_add_f32 v3, v3, v5
    v_add_f32 v6, v6, v12
    v_add_f32 v7, v7, v13
    v_add_f32 v2, v2, v6
    v_add_f32_e64 v3, v3, v7
    v_cmp_gt_u32 vcc, 864, v1
    v_add_u32 v8, 161792, v8
    s_nop 0
    v_cndmask_b32 v2, 0, v2, vcc
    v_cndmask_b32_e64 v3, 0, v3, vcc
    ds_write_b64 v8, v[2:3]
    s_waitcnt vmcnt(6) lgkmcnt(0)
    s_barrier
    s_waitcnt vmcnt(6) lgkmcnt(0)
    s_barrier
    s_waitcnt vmcnt(1) lgkmcnt(0)
    s_barrier
    s_waitcnt vmcnt(0) lgkmcnt(0)
    s_barrier
    s_barrier
    s_branch L_m_ll
L_m_lfin:
L_end_m:
    s_endpgm

.section .rodata,"a"
.p2align 6
.amdhsa_kernel interleave_layers__sliding_local_dilated__mixer_gmlp__prompt_kernel
  .amdhsa_next_free_vgpr 256
  .amdhsa_next_free_sgpr 102
  .amdhsa_accum_offset 256
  .amdhsa_group_segment_fixed_size 0
  .amdhsa_kernarg_size 88
  .amdhsa_user_sgpr_count 2
  .amdhsa_user_sgpr_kernarg_segment_ptr 1
  .amdhsa_system_sgpr_workgroup_id_x 1
  .amdhsa_float_denorm_mode_32 3
.end_amdhsa_kernel
```

```asm
; @launch grid=(256,1,1) block=(512,1,1) lds=163840
.amdgcn_target "amdgcn-amd-amdhsa--gfx950"
.text
.globl interleave_layers__sliding_local_dilated__mixer_gmlp__prompt_kernel
.p2align 8
.type interleave_layers__sliding_local_dilated__mixer_gmlp__prompt_kernel,@function
interleave_layers__sliding_local_dilated__mixer_gmlp__prompt_kernel:
    s_cmp_ge_u32 s2, 256
    s_cbranch_scc1 L_end_m
    s_load_dwordx16 s[36:51], s[0:1], 0
    s_load_dwordx4 s[56:59], s[0:1], 64
    s_load_dwordx2 s[24:25], s[0:1], 80
    s_getpc_b64 s[26:27]
L_m_pc:
    s_sub_u32 s26, s26, L_m_pc-interleave_layers__sliding_local_dilated__mixer_gmlp__prompt_kernel
    s_subb_u32 s27, s27, 0
    v_lshlrev_b32 v4, 4, v0
    v_mov_b32 v5, s27
    v_add_co_u32 v6, vcc, s26, v4
    s_lshr_b32 s28, s2, 3
    s_lshl_b32 s28, s28, 11
    v_addc_co_u32_e64 v7, vcc, 0, v5, vcc
    global_load_dwordx4 v[60:63], v[6:7], off
    v_lshl_add_u32 v4, v0, 2, s28
    v_min_u32 v4, L_end_m-interleave_layers__sliding_local_dilated__mixer_gmlp__prompt_kernel-4, v4
    v_add_co_u32 v6, vcc, s26, v4
    s_nop 1
    v_addc_co_u32_e64 v7, vcc, 0, v5, vcc
    global_load_dword v64, v[6:7], off
    v_lshrrev_b32 v2, 6, v0
    v_and_b32 v1, 63, v0
    v_lshlrev_b32 v1, 4, v1
    v_readfirstlane_b32 s23, v2
    s_mov_b32 s22, 0
    s_mov_b32 s21, 0
    s_and_b32 s20, s23, 3
    s_waitcnt lgkmcnt(0)
    s_mov_b32 s4, s24
    s_mov_b32 s5, s25
    s_mov_b32 s6, 0x10000000
    s_mov_b32 s7, 0x20000
    s_cmp_ge_u32 s23, 4
    s_cbranch_scc1 L_ld_m
    v_bfe_u32 v2, v1, 4, 4
    v_lshrrev_b32 v3, 8, v1
    v_bfrev_b32 v6, 1
    v_mov_b32 v11, 0x3f803f80
    s_lshl_b32 s30, s20, 12
    s_and_b32 s29, s20, 1
    s_cmp_lt_u32 s2, 128
    s_cbranch_scc1 L_p0_x
    s_cmp_lt_u32 s2, 236
    s_cbranch_scc1 L_p0_wq
    s_cmp_lt_u32 s2, 254
    s_cbranch_scc1 L_p0_wo
    s_mov_b32 s46, 0
    s_mov_b32 s27, 0x800000
    s_barrier
    s_branch L_p0_cd
L_p0_wo:
    s_mul_i32 s30, s20, 9216
    s_sub_u32 s26, s2, 236
    s_mul_i32 s28, s26, 57
    s_lshr_b32 s28, s28, 9
    s_mul_i32 s27, s28, 9
    s_sub_u32 s27, s26, s27
    s_mov_b32 s32, s40
    s_mov_b32 s33, s41
    s_mov_b32 s34, 0xa2000
    s_mov_b32 s35, 0x20000
    s_mul_i32 s29, s28, 331776
    s_lshl_b32 s31, s27, 7
    s_add_u32 s29, s29, s31
    s_mul_i32 s31, s20, 82944
    s_add_u32 s29, s29, s31
    s_mul_i32 s30, s20, 9216
    v_lshrrev_b32 v4, 7, v1
    v_mul_u32_u24 v4, 1152, v4
    v_and_b32 v5, 0x70, v1
    v_add_u32_e64 v4, v4, v5
    s_add_u32 m0, s30, 0
    s_add_u32 s31, s29, 0
    buffer_load_dwordx4 v4, s[32:35], s31 offen  lds
    s_add_u32 m0, s30, 1024
    s_add_u32 s31, s29, 9216
    buffer_load_dwordx4 v4, s[32:35], s31 offen  lds
    s_add_u32 m0, s30, 2048
    s_add_u32 s31, s29, 18432
    buffer_load_dwordx4 v4, s[32:35], s31 offen  lds
    s_add_u32 m0, s30, 3072
    s_add_u32 s31, s29, 27648
    buffer_load_dwordx4 v4, s[32:35], s31 offen  lds
    s_add_u32 m0, s30, 4096
    s_add_u32 s31, s29, 36864
    buffer_load_dwordx4 v4, s[32:35], s31 offen  lds
    s_add_u32 m0, s30, 5120
    s_add_u32 s31, s29, 46080
    buffer_load_dwordx4 v4, s[32:35], s31 offen  lds
    s_add_u32 m0, s30, 6144
    s_add_u32 s31, s29, 55296
    buffer_load_dwordx4 v4, s[32:35], s31 offen  lds
    s_add_u32 m0, s30, 7168
    s_add_u32 s31, s29, 64512
    buffer_load_dwordx4 v4, s[32:35], s31 offen  lds
    s_add_u32 m0, s30, 8192
    s_add_u32 s31, s29, 73728
    buffer_load_dwordx4 v4, s[32:35], s31 offen  lds
    v_lshrrev_b32 v7, 2, v2
    v_and_b32 v8, 3, v2
    v_bfe_u32 v9, v1, 7, 0
    v_xor_b32 v9, s20, v9
    v_lshlrev_b32 v9, 5, v9
    v_lshl_add_u32 v9, v7, 7, v9
    v_lshl_add_u32 v9, v8, 3, v9
    v_add_u32_e64 v9, 0, v9
    v_mul_u32_u24 v4, 512, v3
    v_add_u32_e64 v4, v4, v9
    v_mul_u32_u24 v5, 9216, v3
    v_add_u32_e64 v5, v5, v9
    s_lshl_b32 s31, s27, 2
    s_add_u32 s31, s31, s20
    v_lshl_add_u32 v7, s31, 2, v7
    v_lshlrev_b32_e64 v8, 4, v8
    v_lshl_add_u32 v8, v3, 8, v8
    v_mul_u32_u24 v9, 57, v7
    v_lshrrev_b32 v9, 10, v9
    v_mul_u32_u24 v10, 18, v9
    v_sub_u32 v10, v7, v10
    v_lshrrev_b32 v12, 3, v10
    v_and_b32 v13, 1, v10
    v_lshl_add_u32 v12, v12, 1, v13
    v_bfe_u32 v14, v10, 1, 2
    v_cmp_gt_u32_e64 vcc, 16, v10
    v_mul_u32_u24 v9, 82944, v9
    v_add_u32 v9, v9, v8
    v_cndmask_b32 v12, 8, v12, vcc
    v_cndmask_b32_e64 v14, v13, v14, vcc
    v_mov_b32 v15, 0x1000
    v_mov_b32 v13, 0x80
    v_cndmask_b32_e64 v15, v13, v15, vcc
    v_lshl_add_u32 v9, v12, 10, v9
    v_lshl_add_u32 v9, v14, 6, v9
    v_add_u32 v10, v9, v15
    s_and_b32 s31, s28, 1
    s_cmp_eq_u32 s31, 1
    s_cselect_b64 vcc, -1, 0
    v_cndmask_b32_e64 v14, v9, v10, vcc
    s_mul_i32 s31, s28, 36864
    s_add_u32 s37, s31, 0x3a00000
    s_add_u32 s38, s31, 0x3a00000
    s_add_u32 s39, s31, 0x3a02400
    s_add_u32 s40, s31, 0x3a02400
    s_add_u32 s41, s31, 0x3a04800
    s_add_u32 s42, s31, 0x3a04800
    s_add_u32 s43, s31, 0x3a06c00
    s_add_u32 s47, s31, 0x3a06c00
    s_lshr_b32 s31, s28, 1
    s_mul_i32 s31, s31, 9216
    s_add_u32 s48, s31, 0x3a12000
    s_cmp_ge_u32 s26, 4
    s_cbranch_scc1 L_p0_n2
    s_lshl_b32 s31, s26, 2
    s_add_u32 s31, s31, s20
    s_lshl_b32 s31, s31, 12
    s_add_u32 s31, s31, 0x4508000
    v_and_b32 v56, 0x380, v1
    v_add_u32 v56, v56, v1
    v_mov_b32 v52, 0
    v_mov_b32 v53, 0
    v_mov_b32 v54, 0
    v_mov_b32_e64 v55, 0
    buffer_store_dwordx4 v[52:55], v56, s[4:7], s31 offen offset:0 sc1
    buffer_store_dwordx4 v[52:55], v56, s[4:7], s31 offen offset:2048 sc1
L_p0_n2:
    s_waitcnt vmcnt(0)
    s_barrier
    ds_read_b64_tr_b16 v[16:17], v4 offset:0
    ds_read_b64_tr_b16 v[18:19], v4 offset:2560
    ds_read_b64_tr_b16 v[20:21], v4 offset:4608
    ds_read_b64_tr_b16 v[22:23], v4 offset:7168
    ds_read_b64_tr_b16 v[24:25], v4 offset:9216
    ds_read_b64_tr_b16 v[26:27], v4 offset:11776
    ds_read_b64_tr_b16 v[28:29], v4 offset:13824
    ds_read_b64_tr_b16 v[30:31], v4 offset:16384
    ds_read_b64_tr_b16 v[32:33], v4 offset:18432
    ds_read_b64_tr_b16 v[34:35], v4 offset:20992
    ds_read_b64_tr_b16 v[36:37], v4 offset:23040
    ds_read_b64_tr_b16 v[38:39], v4 offset:25600
    ds_read_b64_tr_b16 v[40:41], v4 offset:27648
    ds_read_b64_tr_b16 v[42:43], v4 offset:30208
    ds_read_b64_tr_b16 v[44:45], v4 offset:32256
    ds_read_b64_tr_b16 v[46:47], v4 offset:34816
    ds_read_b64_tr_b16 v[48:49], v5 offset:2048
    ds_read_b64_tr_b16 v[50:51], v5 offset:6656
    s_waitcnt lgkmcnt(15)
    s_mov_b32 s31, s37
    buffer_store_dwordx4 v[16:19], v9, s[4:7], s31 offen sc1
    s_waitcnt lgkmcnt(14)
    s_mov_b32 s31, s38
    buffer_store_dwordx4 v[20:23], v10, s[4:7], s31 offen sc1
    s_waitcnt lgkmcnt(12)
    s_mov_b32 s31, s39
    buffer_store_dwordx4 v[24:27], v9, s[4:7], s31 offen sc1
    s_waitcnt lgkmcnt(10)
    s_mov_b32 s31, s40
    buffer_store_dwordx4 v[28:31], v10, s[4:7], s31 offen sc1
    s_waitcnt lgkmcnt(8)
    s_mov_b32 s31, s41
    buffer_store_dwordx4 v[32:35], v9, s[4:7], s31 offen sc1
    s_waitcnt lgkmcnt(6)
    s_mov_b32 s31, s42
    buffer_store_dwordx4 v[36:39], v10, s[4:7], s31 offen sc1
    s_waitcnt lgkmcnt(4)
    s_mov_b32 s31, s43
    buffer_store_dwordx4 v[40:43], v9, s[4:7], s31 offen sc1
    s_waitcnt lgkmcnt(2)
    s_mov_b32 s31, s47
    buffer_store_dwordx4 v[44:47], v10, s[4:7], s31 offen sc1
    s_waitcnt lgkmcnt(0)
    s_mov_b32 s31, s48
    buffer_store_dwordx4 v[48:51], v14, s[4:7], s31 offen sc1
    s_mov_b32 s46, 1
    s_mov_b32 s27, 32
    s_branch L_p0_cd
    s_nop 0
L_p0_wq:
    s_mov_b32 s32, s38
    s_mov_b32 s33, s39
    s_mov_b32 s34, 0x1e6000
    s_mov_b32 s35, 0x20000
    s_sub_u32 s23, s2, 128
    s_mul_i32 s25, s23, 19
    s_lshr_b32 s25, s25, 9
    s_mul_i32 s24, s25, 27
    s_sub_u32 s24, s23, s24
    s_mul_i32 s26, s25, 497664
    s_lshl_b32 s31, s24, 7
    s_add_u32 s26, s26, s31
    v_lshrrev_b32_e64 v4, 7, v1
    v_mul_u32_u24 v4, 3456, v4
    v_lshrrev_b32 v5, 4, v1
    v_and_b32 v5, 16, v5
    v_xor_b32_e64 v5, v5, v1
    v_and_b32 v5, 0x70, v5
    v_add_u32_e64 v4, v4, v5
    s_mul_i32 s31, s20, 110592
    s_add_u32 s27, s26, s31
    s_mul_i32 s30, s20, 4224
    s_add_u32 m0, s30, 0
    s_add_u32 s31, s27, 0
    buffer_load_dwordx4 v4, s[32:35], s31 offen  lds
    s_add_u32 m0, s30, 1056
    s_add_u32 s31, s27, 27648
    buffer_load_dwordx4 v4, s[32:35], s31 offen  lds
    s_add_u32 m0, s30, 2112
    s_add_u32 s31, s27, 55296
    buffer_load_dwordx4 v4, s[32:35], s31 offen  lds
    s_add_u32 m0, s30, 3168
    s_add_u32 s31, s27, 82944
    buffer_load_dwordx4 v4, s[32:35], s31 offen  lds
    s_cmp_ge_u32 s20, 2
    s_cbranch_scc1 L_p0_q5
    s_mul_i32 s31, s29, 1056
    s_add_u32 m0, s31, 16896
    s_mul_i32 s31, s29, 27648
    s_add_u32 s31, s31, s26
    s_add_u32 s31, s31, 442368
    buffer_load_dwordx4 v4, s[32:35], s31 offen  lds
L_p0_q5:
    v_lshrrev_b32 v7, 2, v2
    v_and_b32 v8, 3, v2
    s_lshl_b32 s31, s20, 5
    v_and_b32 v9, 2, v7
    v_xor_b32 v9, v9, v3
    v_lshlrev_b32 v9, 3, v9
    v_lshl_add_u32 v9, v7, 7, v9
    v_add_u32_e64 v9, s31, v9
    v_mul_u32_u24 v4, 1056, v8
    v_add_u32 v4, v4, v9
    v_and_b32 v5, 1, v2
    v_mul_u32_u24 v5, 9504, v5
    v_add_u32 v5, v5, v9
    s_lshl_b32 s31, s24, 2
    s_add_u32 s31, s31, s20
    v_lshlrev_b32 v8, 4, v8
    v_lshl_add_u32 v8, v7, 8, v8
    v_lshl_add_u32 v7, s31, 2, v3
    v_mul_u32_u24 v9, 57, v7
    v_lshrrev_b32 v9, 13, v9
    v_mul_u32_u24 v10, 144, v9
    v_sub_u32 v10, v7, v10
    v_mul_u32_u24 v12, 57, v10
    v_lshrrev_b32 v12, 9, v12
    v_mul_u32_u24 v13, 9, v12
    v_sub_u32_e64 v13, v10, v13
    v_cmp_lt_u32 s[36:37], 4, v13
    v_cmp_eq_u32 s[38:39], 4, v13
    v_cmp_eq_u32 s[40:41], 2, v9
    v_lshlrev_b32 v14, 1, v9
    v_add_u32 v15, 1, v14
    v_subrev_u32_e64 v10, 5, v13
    v_cndmask_b32 v14, v14, v15, s[36:37]
    v_cndmask_b32 v13, v13, v10, s[36:37]
    v_cndmask_b32 v14, v14, 6, s[38:39]
    v_cndmask_b32 v13, v13, v9, s[38:39]
    s_and_b64 s[40:41], s[40:41], s[38:39]
    s_mov_b32 s31, 129024
    v_mul_lo_u32 v9, v12, s31
    v_add_u32 v9, v9, v8
    v_lshl_add_u32 v9, v14, 10, v9
    v_lshl_add_u32 v9, v13, 6, v9
    s_and_b32 s31, s25, 1
    v_lshrrev_b32 v8, 3, v2
    v_cmp_eq_u32 vcc, s31, v8
    v_add_u32 v15, 64, v9
    v_cndmask_b32 v15, v6, v15, s[40:41]
    v_cndmask_b32 v8, v6, v9, vcc
    v_lshlrev_b32 v10, 2, v2
    v_lshl_add_u32 v10, v7, 4, v10
    v_cmp_gt_u32 vcc, 4, v2
    s_lshl_b32 s45, s25, 13
    s_add_u32 s45, s45, 0x4400000
    v_cndmask_b32_e64 v10, v6, v10, vcc
    s_mul_i32 s42, s25, 28672
    s_add_u32 s42, s42, 0x3800000
    s_lshr_b32 s44, s25, 1
    s_mul_i32 s44, s44, 7168
    s_add_u32 s44, s44, 0x381c000
    s_mul_i32 s26, s24, 29
    s_lshr_b32 s26, s26, 8
    s_mul_i32 s27, s26, 9
    s_sub_u32 s27, s24, s27
    s_lshl_b32 s27, s27, 4
    s_add_u32 s28, s27, 16
    v_lshrrev_b32 v254, 4, v1
    v_mul_u32_u24 v7, 9, v254
    v_add_u32 v255, 9, v7
    v_min_u32 v255, s28, v255
    v_max_u32 v7, s27, v7
    v_sub_u32 v255, v255, v7
    v_cmp_lt_i32 vcc, 0, v255
    v_lshlrev_b32_e64 v254, 8, v254
    v_mov_b32 v14, 0x3f003f00
    v_cndmask_b32 v254, v6, v254, vcc
    s_cmp_eq_u64 s[40:41], 0
    s_cbranch_scc1 L_p0_np
    v_mov_b32 v52, 0
    v_mov_b32 v53, 0
    v_mov_b32 v54, 0
    v_mov_b32 v55, 0
    s_add_u32 s31, s42, 0
    buffer_store_dwordx4 v[52:55], v15, s[4:7], s31 offen sc1
    s_add_u32 s31, s42, 7168
    buffer_store_dwordx4 v[52:55], v15, s[4:7], s31 offen sc1
    s_add_u32 s31, s42, 14336
    buffer_store_dwordx4 v[52:55], v15, s[4:7], s31 offen sc1
    s_add_u32 s31, s42, 21504
    buffer_store_dwordx4 v[52:55], v15, s[4:7], s31 offen sc1
    s_mov_b32 s31, s44
    buffer_store_dwordx4 v[52:55], v15, s[4:7], s31 offen sc1
    s_waitcnt vmcnt(5)
    s_branch L_p0_n3
    s_nop 0
L_p0_np:
    s_waitcnt vmcnt(0)
L_p0_n3:
    s_barrier
    ds_read_b64_tr_b16 v[16:17], v4 offset:0
    ds_read_b64_tr_b16 v[18:19], v4 offset:512
    ds_read_b64_tr_b16 v[20:21], v4 offset:4224
    ds_read_b64_tr_b16 v[22:23], v4 offset:4736
    ds_read_b64_tr_b16 v[24:25], v4 offset:9504
    ds_read_b64_tr_b16 v[26:27], v4 offset:10016
    ds_read_b64_tr_b16 v[28:29], v4 offset:13728
    ds_read_b64_tr_b16 v[30:31], v4 offset:14240
    ds_read_b64_tr_b16 v[32:33], v5 offset:8448
    ds_read_b64_tr_b16 v[34:35], v5 offset:8960
    s_waitcnt lgkmcnt(8)
    s_add_u32 s31, s42, 0
    buffer_store_dwordx4 v[16:19], v9, s[4:7], s31 offen sc1
    s_waitcnt lgkmcnt(6)
    s_add_u32 s31, s42, 7168
    buffer_store_dwordx4 v[20:23], v9, s[4:7], s31 offen sc1
    s_waitcnt lgkmcnt(4)
    s_add_u32 s31, s42, 14336
    buffer_store_dwordx4 v[24:27], v9, s[4:7], s31 offen sc1
    s_waitcnt lgkmcnt(2)
    s_add_u32 s31, s42, 21504
    buffer_store_dwordx4 v[28:31], v9, s[4:7], s31 offen sc1
    s_waitcnt lgkmcnt(0)
    s_mov_b32 s31, s44
    buffer_store_dwordx4 v[32:35], v8, s[4:7], s31 offen sc1
    v_dot2_f32_bf16 v12, v16, v11, 0
    v_dot2_f32_bf16 v13, v17, v11, 0
    v_dot2_f32_bf16 v12, v18, v11, v12
    v_dot2_f32_bf16 v13, v19, v11, v13
    v_dot2_f32_bf16 v12, v20, v11, v12
    v_dot2_f32_bf16 v13, v21, v11, v13
    v_dot2_f32_bf16 v12, v22, v11, v12
    v_dot2_f32_bf16 v13, v23, v11, v13
    v_dot2_f32_bf16 v12, v24, v11, v12
    v_dot2_f32_bf16 v13, v25, v11, v13
    v_dot2_f32_bf16 v12, v26, v11, v12
    v_dot2_f32_bf16 v13, v27, v11, v13
    v_dot2_f32_bf16 v12, v28, v11, v12
    v_dot2_f32_bf16 v13, v29, v11, v13
    v_dot2_f32_bf16 v12, v30, v11, v12
    v_dot2_f32_bf16 v13, v31, v11, v13
    v_dot2_f32_bf16 v12, v32, v14, v12
    v_dot2_f32_bf16 v13, v33, v14, v13
    v_dot2_f32_bf16 v12, v34, v14, v12
    v_dot2_f32_bf16 v13, v35, v14, v13
    s_nop 2
    v_add_f32 v12, v12, v13
    s_nop 1
    v_add_f32_dpp v12, v12, v12 row_ror:4 row_mask:0xf bank_mask:0xf
    s_nop 1
    v_add_f32_dpp v12, v12, v12 row_ror:8 row_mask:0xf bank_mask:0xf
    buffer_store_dword v12, v10, s[4:7], s45 offen sc1
    s_branch L_p0_ce
L_p0_x:
    s_mov_b32 s32, s36
    s_mov_b32 s33, s37
    s_mov_b32 s34, 0x240000
    s_mov_b32 s35, 0x20000
    s_mul_i32 s26, s2, 18432
    s_mul_i32 s31, s20, 288
    s_add_u32 s28, s26, s31
    v_lshrrev_b32 v4, 6, v1
    v_mul_u32_u24 v4, 1152, v4
    v_and_b32 v5, 48, v1
    v_add_u32 v4, v4, v5
    s_add_u32 m0, s30, 0
    s_add_u32 s31, s28, 0
    buffer_load_dwordx4 v4, s[32:35], s31 offen  lds
    s_add_u32 m0, s30, 1024
    s_add_u32 s31, s28, 64
    buffer_load_dwordx4 v4, s[32:35], s31 offen  lds
    s_add_u32 m0, s30, 2048
    s_add_u32 s31, s28, 144
    buffer_load_dwordx4 v4, s[32:35], s31 offen  lds
    s_add_u32 m0, s30, 3072
    s_add_u32 s31, s28, 208
    buffer_load_dwordx4 v4, s[32:35], s31 offen  lds
    s_mul_i32 s31, s29, 576
    s_add_u32 s31, s31, s26
    v_mul_u32_u24 v7, 1152, v2
    v_mul_u32_u24 v5, 144, v3
    v_add_u32_e64 v5, v5, v7
    buffer_load_dwordx4 v[32:35], v5, s[32:35], s31 offen offset:128
    s_lshl_b32 s27, s29, 10
    s_add_u32 s27, s27, 16384
    s_barrier
    v_lshlrev_b32_e64 v4, 6, v2
    v_lshl_add_u32 v4, v3, 4, v4
    v_add_u32_e64 v4, s30, v4
    s_add_u32 s26, s26, 0x0
    s_add_u32 s42, s26, s30
    s_add_u32 s44, s26, s27
    s_lshl_b32 s45, s2, 10
    s_lshl_b32 s31, s20, 8
    s_add_u32 s45, s45, s31
    s_add_u32 s45, s45, 0x1b00000
    v_cmp_gt_u32 vcc, 2, v3
    v_lshrrev_b32 v10, 1, v1
    s_mov_b32 s46, 2
    v_cndmask_b32_e64 v10, v6, v10, vcc
    s_lshr_b32 s27, s2, 3
    s_add_u32 s27, s27, 48
    s_waitcnt vmcnt(0)
    ds_read_b128 v[16:19], v4 offset:0
    ds_read_b128 v[20:23], v4 offset:1024
    ds_read_b128 v[24:27], v4 offset:2048
    ds_read_b128 v[28:31], v4 offset:3072
    s_waitcnt lgkmcnt(3)
    buffer_store_dwordx4 v[16:19], v1, s[4:7], s42 offen offset:0 sc1
    s_waitcnt lgkmcnt(2)
    buffer_store_dwordx4 v[20:23], v1, s[4:7], s42 offen offset:1024 sc1
    s_waitcnt lgkmcnt(1)
    buffer_store_dwordx4 v[24:27], v1, s[4:7], s42 offen offset:2048 sc1
    s_waitcnt lgkmcnt(0)
    buffer_store_dwordx4 v[28:31], v1, s[4:7], s42 offen offset:3072 sc1
    v_dot2_f32_bf16 v12, v16, v11, 0
    v_dot2_f32_bf16 v13, v16, v16, 0
    v_dot2_f32_bf16 v12, v17, v11, v12
    v_dot2_f32_bf16 v13, v17, v17, v13
    v_dot2_f32_bf16 v12, v18, v11, v12
    v_dot2_f32_bf16 v13, v18, v18, v13
    v_dot2_f32_bf16 v12, v19, v11, v12
    v_dot2_f32_bf16 v13, v19, v19, v13
    v_dot2_f32_bf16 v12, v20, v11, v12
    v_dot2_f32_bf16 v13, v20, v20, v13
    v_dot2_f32_bf16 v12, v21, v11, v12
    v_dot2_f32_bf16 v13, v21, v21, v13
    v_dot2_f32_bf16 v12, v22, v11, v12
    v_dot2_f32_bf16 v13, v22, v22, v13
    v_dot2_f32_bf16 v12, v23, v11, v12
    v_dot2_f32_bf16 v13, v23, v23, v13
    v_dot2_f32_bf16 v12, v24, v11, v12
    v_dot2_f32_bf16 v13, v24, v24, v13
    v_dot2_f32_bf16 v12, v25, v11, v12
    v_dot2_f32_bf16 v13, v25, v25, v13
    v_dot2_f32_bf16 v12, v26, v11, v12
    v_dot2_f32_bf16 v13, v26, v26, v13
    v_dot2_f32_bf16 v12, v27, v11, v12
    v_dot2_f32_bf16 v13, v27, v27, v13
    v_dot2_f32_bf16 v12, v28, v11, v12
    v_dot2_f32_bf16 v13, v28, v28, v13
    v_dot2_f32_bf16 v12, v29, v11, v12
    v_dot2_f32_bf16 v13, v29, v29, v13
    v_dot2_f32_bf16 v12, v30, v11, v12
    v_dot2_f32_bf16 v13, v30, v30, v13
    v_dot2_f32_bf16 v12, v31, v11, v12
    v_dot2_f32_bf16 v13, v31, v31, v13
    s_waitcnt lgkmcnt(0)
    s_cmp_ge_u32 s20, 2
    s_cbranch_scc1 L_p0_xs
    buffer_store_dwordx4 v[32:35], v1, s[4:7], s44 offen sc1
    v_dot2_f32_bf16 v12, v32, v11, v12
    v_dot2_f32_bf16 v13, v32, v32, v13
    v_dot2_f32_bf16 v12, v33, v11, v12
    v_dot2_f32_bf16 v13, v33, v33, v13
    v_dot2_f32_bf16 v12, v34, v11, v12
    v_dot2_f32_bf16 v13, v34, v34, v13
    v_dot2_f32_bf16 v12, v35, v11, v12
    v_dot2_f32_bf16 v13, v35, v35, v13
L_p0_xs:
    s_nop 2
    v_mov_b32 v14, v12
    v_mov_b32 v15, v13
    s_nop 1
    v_permlane32_swap_b32 v12, v14
    v_permlane32_swap_b32 v13, v15
    v_add_f32 v12, v12, v14
    v_add_f32_e64 v13, v13, v15
    buffer_store_dwordx2 v[12:13], v10, s[4:7], s45 offen sc1
L_p0_cd:
    v_cmp_eq_u32 vcc, 0, v1
    s_lshl_b32 s27, s27, 8
    v_mov_b32 v255, s46
    v_mov_b32 v254, s27
    v_cndmask_b32_e64 v254, v6, v254, vcc
L_p0_ce:
    s_mov_b32 s48, s58
    s_mov_b32 s49, s59
    s_mov_b32 s50, 0x100
    s_mov_b32 s51, 0x20000
    v_mov_b32_e64 v4, 0
    buffer_load_dword v246, v4, s[48:51], 0 offen sc1
    s_mov_b32 s16, s56
    s_mov_b32 s17, s57
    s_mov_b32 s18, 0x240000
    s_mov_b32 s19, 0x20000
    s_branch L_m_cl
L_d1_first:
    v_cmp_gt_u32 vcc, 4, v246
    v_mov_b32_e64 v4, 0
    s_mov_b32 s46, 0x4500000
    s_cbranch_vccz L_pd_dbg
    s_mov_b32 s60, 262144
L_poll_dbg:
    buffer_load_dword v5, v4, s[48:51], 0 offen sc1
    s_waitcnt vmcnt(0)
    v_cmp_gt_u32 vcc, 4, v5
    s_sub_u32 s60, s60, 1
    s_cbranch_scc1 L_pd_dbg
    s_cbranch_vccz L_pd_dbg
    s_sleep 4
    s_branch L_poll_dbg
L_pd_dbg:
    buffer_atomic_add v255, v254, s[4:7], s46 offen sc1
    s_branch L_ns_d1
    s_nop 0
L_ld_m:
    s_cmp_lg_u32 s2, 254
    s_cbranch_scc1 L_p0_nz
    s_lshl_b32 s31, s20, 12
    s_add_u32 s31, s31, 0x4500000
    v_and_b32 v56, 0x380, v1
    v_add_u32 v56, v56, v1
    v_mov_b32 v52, 0
    v_mov_b32 v53, 0
    v_mov_b32 v54, 0
    v_mov_b32_e64 v55, 0
    buffer_store_dwordx4 v[52:55], v56, s[4:7], s31 offen offset:0 sc1
    buffer_store_dwordx4 v[52:55], v56, s[4:7], s31 offen offset:2048 sc1
    s_waitcnt vmcnt(0)
    s_mov_b32 s53, 1
    s_atomic_add s53, s[58:59], 0
L_p0_nz:
    s_mov_b32 s8, s46
    s_mov_b32 s9, s47
    s_mov_b32 s10, 0x800000
    s_mov_b32 s11, 0x20000
    s_mov_b32 s12, s48
    s_mov_b32 s13, s49
    s_mov_b32 s14, 0x1000
    s_mov_b32 s15, 0x20000
    v_mov_b32 v2, 163808
    v_mov_b32 v4, 0
    v_mov_b32 v5, 0
    ds_write2_b64 v2, v[4:5], v[4:5] offset0:0 offset1:1
    s_waitcnt lgkmcnt(0)
    v_bfe_u32 v2, v1, 4, 4
    v_lshrrev_b32 v3, 8, v1
    v_bfrev_b32_e64 v6, 1
    v_mov_b32 v11, 0x3f803f80
    s_mul_i32 s30, s20, 9216
    s_cmp_lt_u32 s2, 144
    s_cbranch_scc1 L_p0_wi
    s_cmp_lt_u32 s2, 216
    s_cbranch_scc1 L_p0_wu
    v_mov_b32 v9, v6
    v_mov_b32 v10, v6
    v_mov_b32 v14, v6
    v_mov_b32 v15, v6
    s_mov_b32 s37, 0
    s_mov_b32 s38, 0
    s_mov_b32 s39, 0
    s_mov_b32 s40, 0
    s_mov_b32 s41, 0
    s_mov_b32 s42, 0
    s_mov_b32 s43, 0
    s_mov_b32 s47, 0
    s_mov_b32 s48, 0
    s_mov_b32 s49, 0
    s_barrier
    s_barrier
    s_barrier
    s_branch L_p0_ld
L_p0_wu:
    s_sub_u32 s26, s2, 144
    s_mul_i32 s28, s26, 57
    s_lshr_b32 s28, s28, 9
    s_mul_i32 s27, s28, 9
    s_sub_u32 s27, s26, s27
    s_mov_b32 s32, s50
    s_mov_b32 s33, s51
    s_mov_b32 s34, 0x288000
    s_mov_b32 s35, 0x20000
    s_mul_i32 s29, s28, 331776
    s_lshl_b32 s31, s27, 7
    s_add_u32 s29, s29, s31
    s_mul_i32 s31, s20, 82944
    s_add_u32 s29, s29, s31
    s_mul_i32 s30, s20, 9216
    v_lshrrev_b32 v4, 7, v1
    v_mul_u32_u24 v4, 1152, v4
    v_and_b32 v5, 0x70, v1
    v_bfe_u32 v7, v1, 8, 2
    v_lshlrev_b32 v7, 5, v7
    v_xor_b32 v5, v5, v7
    v_add_u32 v4, v4, v5
    s_barrier
    s_barrier
    s_barrier
    s_add_u32 m0, s30, 91904
    s_add_u32 s31, s29, 0
    buffer_load_dwordx4 v4, s[32:35], s31 offen  lds
    s_add_u32 m0, s30, 92928
    s_add_u32 s31, s29, 9216
    buffer_load_dwordx4 v4, s[32:35], s31 offen  lds
    s_add_u32 m0, s30, 93952
    s_add_u32 s31, s29, 18432
    buffer_load_dwordx4 v4, s[32:35], s31 offen  lds
    s_add_u32 m0, s30, 94976
    s_add_u32 s31, s29, 27648
    buffer_load_dwordx4 v4, s[32:35], s31 offen  lds
    s_add_u32 m0, s30, 96000
    s_add_u32 s31, s29, 36864
    buffer_load_dwordx4 v4, s[32:35], s31 offen  lds
    s_add_u32 m0, s30, 97024
    s_add_u32 s31, s29, 46080
    buffer_load_dwordx4 v4, s[32:35], s31 offen  lds
    s_add_u32 m0, s30, 98048
    s_add_u32 s31, s29, 55296
    buffer_load_dwordx4 v4, s[32:35], s31 offen  lds
    s_add_u32 m0, s30, 99072
    s_add_u32 s31, s29, 64512
    buffer_load_dwordx4 v4, s[32:35], s31 offen  lds
    s_add_u32 m0, s30, 100096
    s_add_u32 s31, s29, 73728
    buffer_load_dwordx4 v4, s[32:35], s31 offen  lds
    v_lshrrev_b32 v7, 2, v2
    v_and_b32_e64 v8, 3, v2
    v_bfe_u32 v9, v1, 7, 2
    v_xor_b32 v9, s20, v9
    v_lshlrev_b32 v9, 5, v9
    v_lshl_add_u32 v9, v7, 7, v9
    v_lshl_add_u32 v9, v8, 3, v9
    v_add_u32 v9, 91904, v9
    v_mul_u32_u24 v4, 512, v3
    v_add_u32_e64 v4, v4, v9
    v_mul_u32_u24 v5, 512, v3
    v_add_u32_e64 v5, v5, v9
    s_lshl_b32 s31, s27, 2
    s_add_u32 s31, s31, s20
    v_lshl_add_u32 v7, s31, 2, v7
    v_lshlrev_b32_e64 v8, 4, v8
    v_lshl_add_u32 v8, v3, 8, v8
    v_mul_u32_u24 v9, 57, v7
    v_lshrrev_b32 v9, 10, v9
    v_mul_u32_u24 v10, 18, v9
    v_sub_u32 v10, v7, v10
    v_lshrrev_b32 v12, 3, v10
    v_and_b32 v13, 1, v10
    v_lshl_add_u32 v12, v12, 1, v13
    v_bfe_u32 v14, v10, 1, 2
    v_cmp_gt_u32_e64 vcc, 16, v10
    v_mul_u32_u24 v9, 331776, v9
    v_add_u32 v9, v9, v8
    v_cndmask_b32 v12, 8, v12, vcc
    v_cndmask_b32_e64 v14, v13, v14, vcc
    v_mov_b32 v15, 0x1000
    v_mov_b32 v13, 0x80
    v_cndmask_b32_e64 v15, v13, v15, vcc
    v_lshl_add_u32 v9, v12, 10, v9
    v_lshl_add_u32 v9, v14, 6, v9
    v_add_u32 v10, v9, v15
    s_and_b32 s31, s28, 1
    s_cmp_eq_u32 s31, 1
    s_cselect_b64 vcc, -1, 0
    v_cndmask_b32_e64 v14, v9, v10, vcc
    s_mul_i32 s31, s28, 9216
    s_add_u32 s37, s31, 0x4100000
    s_add_u32 s38, s31, 0x4100000
    s_add_u32 s39, s31, 0x4112000
    s_add_u32 s40, s31, 0x4112000
    s_add_u32 s41, s31, 0x4124000
    s_add_u32 s42, s31, 0x4124000
    s_add_u32 s43, s31, 0x4136000
    s_add_u32 s47, s31, 0x4136000
    s_lshr_b32 s31, s28, 1
    s_mul_i32 s31, s31, 9216
    s_add_u32 s48, s31, 0x4148000
    v_mov_b32_e64 v15, v6
    s_mov_b32 s49, 0
    s_branch L_p0_ld
L_p0_wi:
    s_mov_b32 s26, s2
    s_mul_i32 s28, s26, 57
    s_lshr_b32 s28, s28, 12
    s_mul_i32 s27, s28, 72
    s_sub_u32 s27, s26, s27
    s_mov_b32 s32, s44
    s_mov_b32 s33, s45
    s_mov_b32 s34, 0x510000
    s_mov_b32 s35, 0x20000
    s_mul_i32 s29, s28, 2654208
    s_lshl_b32 s31, s27, 7
    s_add_u32 s29, s29, s31
    s_mul_i32 s31, s20, 663552
    s_add_u32 s29, s29, s31
    s_mul_i32 s30, s20, 9792
    v_lshrrev_b32_e64 v4, 7, v1
    v_mul_u32_u24 v4, 9216, v4
    v_and_b32 v5, 0x70, v1
    v_bfe_u32 v7, v1, 8, 1
    v_lshlrev_b32 v7, 5, v7
    v_xor_b32 v5, v5, v7
    v_add_u32 v4, v4, v5
    s_barrier
    s_barrier
    s_barrier
    s_add_u32 m0, s30, 91904
    s_add_u32 s31, s29, 0
    buffer_load_dwordx4 v4, s[32:35], s31 offen  lds
    s_add_u32 m0, s30, 92992
    s_add_u32 s31, s29, 73728
    buffer_load_dwordx4 v4, s[32:35], s31 offen  lds
    s_add_u32 m0, s30, 94080
    s_add_u32 s31, s29, 147456
    buffer_load_dwordx4 v4, s[32:35], s31 offen  lds
    s_add_u32 m0, s30, 95168
    s_add_u32 s31, s29, 221184
    buffer_load_dwordx4 v4, s[32:35], s31 offen  lds
    s_add_u32 m0, s30, 96256
    s_add_u32 s31, s29, 294912
    buffer_load_dwordx4 v4, s[32:35], s31 offen  lds
    s_add_u32 m0, s30, 97344
    s_add_u32 s31, s29, 368640
    buffer_load_dwordx4 v4, s[32:35], s31 offen  lds
    s_add_u32 m0, s30, 98432
    s_add_u32 s31, s29, 442368
    buffer_load_dwordx4 v4, s[32:35], s31 offen  lds
    s_add_u32 m0, s30, 99520
    s_add_u32 s31, s29, 516096
    buffer_load_dwordx4 v4, s[32:35], s31 offen  lds
    s_add_u32 m0, s30, 100608
    s_add_u32 s31, s29, 589824
    buffer_load_dwordx4 v4, s[32:35], s31 offen  lds
    v_lshrrev_b32 v7, 2, v2
    v_and_b32_e64 v8, 3, v2
    v_bfe_u32 v9, v1, 7, 1
    v_xor_b32 v9, s20, v9
    v_lshlrev_b32 v9, 5, v9
    v_lshl_add_u32 v9, v7, 7, v9
    v_lshl_add_u32 v9, v8, 3, v9
    v_add_u32 v9, 91904, v9
    v_mul_u32_u24 v4, 1088, v3
    v_add_u32_e64 v4, v4, v9
    v_mul_u32_u24 v5, 9792, v3
    v_add_u32_e64 v5, v5, v9
    s_lshl_b32 s31, s27, 2
    s_add_u32 s31, s31, s20
    v_lshl_add_u32 v7, s31, 2, v7
    v_lshlrev_b32_e64 v8, 4, v8
    v_lshl_add_u32 v8, v3, 8, v8
    s_cmp_lt_u32 s31, 144
    s_cselect_b32 s23, 1, 0
    s_cselect_b32 s24, 0, 144
    s_sub_u32 s26, s31, s24
    s_mul_i32 s25, s26, 57
    s_lshr_b32 s25, s25, 9
    s_mul_i32 s24, s25, 9
    s_sub_u32 s24, s26, s24
    s_lshl_b32 s26, s25, 1
    s_add_u32 s26, s26, s23
    s_mul_i32 s26, s26, 165888
    s_lshl_b32 s31, s24, 10
    s_add_u32 s26, s26, s31
    s_add_u32 s26, s26, 0x3b00000
    s_mul_i32 s31, s28, 9216
    s_add_u32 s48, s26, s31
    s_add_u32 s48, s48, 147456
    s_lshl_b32 s31, s31, 3
    s_add_u32 s26, s26, s31
    s_add_u32 s37, s26, 0
    s_add_u32 s38, s26, 9216
    s_add_u32 s39, s26, 18432
    s_add_u32 s40, s26, 27648
    s_add_u32 s41, s26, 36864
    s_add_u32 s42, s26, 46080
    s_add_u32 s43, s26, 55296
    s_add_u32 s47, s26, 64512
    s_lshl_b32 s49, s25, 12
    s_mul_i32 s31, s28, 1152
    s_add_u32 s49, s49, s31
    s_mul_i32 s31, s23, 576
    s_add_u32 s49, s49, s31
    s_lshl_b32 s31, s24, 6
    s_add_u32 s49, s49, s31
    s_add_u32 s49, s49, 0x4410000
    v_cmp_eq_u32 vcc, 0, v3
    v_lshlrev_b32 v15, 2, v2
    v_mov_b32 v9, v1
    v_mov_b32 v10, v1
    v_mov_b32 v14, v1
    v_cndmask_b32 v15, v6, v15, vcc
L_p0_ld:
    s_waitcnt lgkmcnt(0)
    s_branch L_m_l1
L_m_cl:
    s_and_b32 s25, s2, 7
    s_lshr_b32 s26, s2, 3
    s_lshr_b32 s23, s25, 1
    s_lshl_b32 s23, s23, 2
    s_lshr_b32 s27, s26, 3
    s_add_u32 s23, s23, s27
    s_and_b32 s24, s25, 1
    s_lshl_b32 s24, s24, 3
    s_and_b32 s27, s26, 7
    s_add_u32 s24, s24, s27
    s_lshl_b32 s30, s23, 3
    s_lshl_b32 s31, s20, 1
    s_add_u32 s31, s30, s31
    s_mul_i32 s29, s31, 18432
    s_add_u32 s29, s29, s21
    s_add_u32 s35, s29, 0x600000
    s_add_u32 s29, s29, 0x0
    s_max_u32 s30, s30, 1
    s_sub_u32 s30, s30, 1
    s_lshl_b32 s30, s30, 10
    s_add_u32 s30, s30, s21
    s_add_u32 s30, s30, 0x1b00000
    s_lshl_b32 s32, s31, 10
    s_add_u32 s32, s32, s21
    s_add_u32 s32, s32, 0x1b00000
    v_bfe_u32 v2, v1, 4, 4
    v_lshrrev_b32 v3, 8, v1
    s_lshl_b32 s33, s20, 2
    s_lshr_b32 s33, 0x3362, s33
    s_and_b32 s33, s33, 15
    s_min_u32 s34, s20, 1
    s_add_u32 s34, s34, 4
    s_lshl_b32 s36, s33, 10
    s_lshl_b32 s37, s34, 10
    v_add_u32 v247, 64512, v1
    v_add_u32 v248, 131072, v1
    v_add_u32 v249, s36, v1
    v_add_u32 v250, s36, v247
    v_add_u32 v251, s37, v1
    v_add_u32_e64 v252, s37, v247
    v_add_u32 v253, 18432, v1
    v_lshrrev_b32 v0, 1, v1
    s_add_u32 s38, s29, 0
    s_add_u32 s39, s29, 4096
    s_add_u32 s40, s29, 8192
    s_add_u32 s41, s29, 12288
    s_add_u32 s42, s29, 16384
    s_max_u32 s44, s23, 1
    s_sub_u32 s44, s44, 1
    s_lshl_b32 s52, s22, 7
    s_add_u32 s52, s52, s23
    s_lshl_b32 s52, s52, 8
    s_add_u32 s52, s52, 0x4503000
    s_add_u32 s52, s52, s4
    s_addc_u32 s53, s5, 0
    s_lshl_b32 s54, s22, 7
    s_add_u32 s54, s54, s44
    s_lshl_b32 s54, s54, 8
    s_add_u32 s54, s54, 0x4503000
    s_add_u32 s54, s54, s4
    s_addc_u32 s55, s5, 0
    s_lshl_b32 s44, s24, 8
    s_add_u32 s44, s44, 0x4500000
    s_add_u32 s44, s44, s4
    s_addc_u32 s45, s5, 0
    s_waitcnt vmcnt(0)
    s_barrier
    s_cmp_lg_u32 s20, 0
    s_cbranch_scc1 L_ns_d1
    s_cmp_eq_u32 s22, 0
    s_cbranch_scc1 L_d1_first
    s_mov_b32 s56, 1
    s_atomic_add s56, s[50:51], 0
L_ns_d1:
    s_barrier
    s_cmp_lg_u32 s20, 0
    s_cbranch_scc1 L_pd_d1
    s_mov_b32 s60, 262144
L_poll_d1:
    s_mov_b32 s57, 0
    s_atomic_add s57, s[52:53], 0 glc
    s_mov_b32 s58, 0
    s_atomic_add s58, s[54:55], 0 glc
    s_mov_b32 s59, 0
    s_atomic_add s59, s[44:45], 0 glc
    s_waitcnt lgkmcnt(0)
    s_cmp_ge_u32 s59, 108
    s_cselect_b32 s59, 16, 0
    s_min_u32 s57, s57, s58
    s_min_u32 s57, s57, s59
    s_cmp_ge_u32 s57, 16
    s_cbranch_scc1 L_pd_d1
    s_sub_u32 s60, s60, 1
    s_cbranch_scc1 L_pd_d1
    s_sleep 2
    s_branch L_poll_d1
    s_nop 0
L_pd_d1:
    s_barrier
    buffer_load_dwordx4 v[160:163], v1, s[4:7], s38 offen offset:0 sc1
    buffer_load_dwordx4 v[164:167], v253, s[4:7], s38 offen offset:0 sc1
    buffer_load_dwordx4 v[168:171], v1, s[4:7], s38 offen offset:1024 sc1
    buffer_load_dwordx4 v[172:175], v253, s[4:7], s38 offen offset:1024 sc1
    buffer_load_dwordx4 v[176:179], v1, s[4:7], s38 offen offset:2048 sc1
    buffer_load_dwordx4 v[180:183], v253, s[4:7], s38 offen offset:2048 sc1
    buffer_load_dwordx4 v[184:187], v1, s[4:7], s38 offen offset:3072 sc1
    buffer_load_dwordx4 v[188:191], v253, s[4:7], s38 offen offset:3072 sc1
    s_barrier
    ds_read_b128 v[80:83], v1 offset:0
    ds_read_b128 v[84:87], v1 offset:1024
    ds_read_b128 v[88:91], v1 offset:2048
    ds_read_b128 v[92:95], v1 offset:3072
    ds_read_b128 v[96:99], v1 offset:4096
    ds_read_b128 v[100:103], v1 offset:5120
    ds_read_b128 v[104:107], v1 offset:6144
    s_lshl_b32 s50, s22, 7
    s_add_u32 s50, s50, s23
    s_lshl_b32 s50, s50, 8
    s_add_u32 s50, s50, 0x4508000
    s_add_u32 s50, s50, s4
    s_addc_u32 s51, s5, 0
    s_waitcnt vmcnt(6) lgkmcnt(3)
    v_mfma_f32_16x16x32_bf16 v[16:19], v[80:83], v[160:163], 0
    ds_read_b128 v[120:123], v1 offset:7168
    v_mfma_f32_16x16x32_bf16 v[44:47], v[80:83], v[164:167], 0
    ds_read_b128 v[124:127], v1 offset:8192
    v_mfma_f32_16x16x32_bf16 v[20:23], v[84:87], v[160:163], 0
    ds_read_b128 v[128:131], v1 offset:9216
    v_mfma_f32_16x16x32_bf16 v[48:51], v[84:87], v[164:167], 0
    ds_read_b128 v[132:135], v1 offset:10240
    v_mfma_f32_16x16x32_bf16 v[24:27], v[88:91], v[160:163], 0
    ds_read_b128 v[136:139], v1 offset:11264
    buffer_load_dwordx2 v[4:5], v0, s[4:7], s30 offen offset:0 sc1
    v_mfma_f32_16x16x32_bf16 v[52:55], v[88:91], v[164:167], 0
    ds_read_b128 v[140:143], v1 offset:12288
    buffer_load_dwordx2 v[6:7], v0, s[4:7], s30 offen offset:512 sc1
    v_mfma_f32_16x16x32_bf16 v[28:31], v[92:95], v[160:163], 0
    ds_read_b128 v[144:147], v1 offset:13312
    buffer_load_dwordx2 v[8:9], v0, s[4:7], s32 offen offset:0 sc1
    v_mfma_f32_16x16x32_bf16 v[56:59], v[92:95], v[164:167], 0
    s_waitcnt lgkmcnt(7)
    buffer_load_dwordx2 v[10:11], v0, s[4:7], s32 offen offset:512 sc1
    v_mfma_f32_16x16x32_bf16 v[32:35], v[160:163], v[96:99], 0
    buffer_load_dwordx2 v[12:13], v0, s[4:7], s32 offen offset:1024 sc1
    v_mfma_f32_16x16x32_bf16 v[60:63], v[164:167], v[96:99], 0
    buffer_load_dwordx2 v[14:15], v0, s[4:7], s32 offen offset:1536 sc1
    v_mfma_f32_16x16x32_bf16 v[36:39], v[160:163], v[100:103], 0
    buffer_load_dwordx4 v[192:195], v1, s[4:7], s39 offen offset:0 sc1
    v_mfma_f32_16x16x32_bf16 v[64:67], v[164:167], v[100:103], 0
    buffer_load_dwordx4 v[196:199], v253, s[4:7], s39 offen offset:0 sc1
    v_mfma_f32_16x16x32_bf16 v[40:43], v[104:107], v[160:163], 0
    buffer_load_dwordx4 v[200:203], v1, s[4:7], s39 offen offset:1024 sc1
    v_mfma_f32_16x16x32_bf16 v[68:71], v[104:107], v[164:167], 0
    buffer_load_dwordx4 v[204:207], v253, s[4:7], s39 offen offset:1024 sc1
    s_waitcnt vmcnt(14) lgkmcnt(3)
    s_barrier
    v_mfma_f32_16x16x32_bf16 v[16:19], v[120:123], v[168:171], v[16:19]
    ds_read_b128 v[80:83], v1 offset:14336
    v_mfma_f32_16x16x32_bf16 v[44:47], v[120:123], v[172:175], v[44:47]
    ds_read_b128 v[84:87], v1 offset:15360
    v_mfma_f32_16x16x32_bf16 v[20:23], v[124:127], v[168:171], v[20:23]
    ds_read_b128 v[88:91], v1 offset:16384
    v_mfma_f32_16x16x32_bf16 v[48:51], v[124:127], v[172:175], v[48:51]
    ds_read_b128 v[92:95], v1 offset:17408
    v_mfma_f32_16x16x32_bf16 v[24:27], v[128:131], v[168:171], v[24:27]
    ds_read_b128 v[96:99], v1 offset:18432
    v_mfma_f32_16x16x32_bf16 v[52:55], v[128:131], v[172:175], v[52:55]
    ds_read_b128 v[100:103], v1 offset:19456
    v_mfma_f32_16x16x32_bf16 v[28:31], v[132:135], v[168:171], v[28:31]
    ds_read_b128 v[104:107], v1 offset:20480
    v_mfma_f32_16x16x32_bf16 v[56:59], v[132:135], v[172:175], v[56:59]
    ds_read_b128 v[108:111], v248 offset:0
    s_waitcnt lgkmcnt(8)
    v_mfma_f32_16x16x32_bf16 v[32:35], v[168:171], v[136:139], v[32:35]
    ds_read_b128 v[112:115], v249 offset:0
    v_mfma_f32_16x16x32_bf16 v[60:63], v[172:175], v[136:139], v[60:63]
    ds_read_b128 v[116:119], v251 offset:0
    v_mfma_f32_16x16x32_bf16 v[36:39], v[168:171], v[140:143], v[36:39]
    buffer_load_dwordx4 v[160:163], v1, s[4:7], s39 offen offset:2048 sc1
    v_mfma_f32_16x16x32_bf16 v[64:67], v[172:175], v[140:143], v[64:67]
    buffer_load_dwordx4 v[164:167], v253, s[4:7], s39 offen offset:2048 sc1
    v_mfma_f32_16x16x32_bf16 v[40:43], v[144:147], v[168:171], v[40:43]
    v_mfma_f32_16x16x32_bf16 v[68:71], v[144:147], v[172:175], v[68:71]
    s_waitcnt vmcnt(14) lgkmcnt(6)
    v_mfma_f32_16x16x32_bf16 v[16:19], v[80:83], v[176:179], v[16:19]
    ds_read_b128 v[120:123], v1 offset:21504
    v_mfma_f32_16x16x32_bf16 v[44:47], v[80:83], v[180:183], v[44:47]
    ds_read_b128 v[124:127], v1 offset:22528
    v_mfma_f32_16x16x32_bf16 v[20:23], v[84:87], v[176:179], v[20:23]
    ds_read_b128 v[128:131], v1 offset:23552
    v_mfma_f32_16x16x32_bf16 v[48:51], v[84:87], v[180:183], v[48:51]
    ds_read_b128 v[132:135], v1 offset:24576
    v_mfma_f32_16x16x32_bf16 v[24:27], v[88:91], v[176:179], v[24:27]
    ds_read_b128 v[136:139], v1 offset:25600
    v_mfma_f32_16x16x32_bf16 v[52:55], v[88:91], v[180:183], v[52:55]
    ds_read_b128 v[140:143], v1 offset:26624
    v_mfma_f32_16x16x32_bf16 v[28:31], v[92:95], v[176:179], v[28:31]
    ds_read_b128 v[144:147], v1 offset:27648
    v_mfma_f32_16x16x32_bf16 v[56:59], v[92:95], v[180:183], v[56:59]
    ds_read_b128 v[148:151], v248 offset:1024
    s_waitcnt lgkmcnt(8)
    v_mfma_f32_16x16x32_bf16 v[32:35], v[176:179], v[96:99], v[32:35]
    ds_read_b128 v[152:155], v249 offset:7168
    v_mfma_f32_16x16x32_bf16 v[60:63], v[180:183], v[96:99], v[60:63]
    ds_read_b128 v[156:159], v251 offset:7168
    v_mfma_f32_16x16x32_bf16 v[36:39], v[176:179], v[100:103], v[36:39]
    buffer_load_dwordx4 v[168:171], v1, s[4:7], s39 offen offset:3072 sc1
    v_mfma_f32_16x16x32_bf16 v[64:67], v[180:183], v[100:103], v[64:67]
    buffer_load_dwordx4 v[172:175], v253, s[4:7], s39 offen offset:3072 sc1
    v_mfma_f32_16x16x32_bf16 v[40:43], v[104:107], v[176:179], v[40:43]
    v_mfma_f32_16x16x32_bf16 v[68:71], v[104:107], v[180:183], v[68:71]
    v_mfma_f32_16x16x32_bf16 v[72:75], v[112:115], v[108:111], 0
    v_mfma_f32_16x16x32_bf16 v[76:79], v[108:111], v[116:119], 0
    s_waitcnt vmcnt(8) lgkmcnt(6)
    s_barrier
    v_mfma_f32_16x16x32_bf16 v[16:19], v[120:123], v[184:187], v[16:19]
    ds_read_b128 v[80:83], v1 offset:28672
    v_mfma_f32_16x16x32_bf16 v[44:47], v[120:123], v[188:191], v[44:47]
    ds_read_b128 v[84:87], v1 offset:29696
    v_add_f32 v240, v4, v6
    v_mfma_f32_16x16x32_bf16 v[20:23], v[124:127], v[184:187], v[20:23]
    ds_read_b128 v[88:91], v1 offset:30720
    v_add_f32_e64 v241, v5, v7
    v_mfma_f32_16x16x32_bf16 v[48:51], v[124:127], v[188:191], v[48:51]
    ds_read_b128 v[92:95], v1 offset:31744
    v_add_f32_e64 v242, v8, v10
    v_mfma_f32_16x16x32_bf16 v[24:27], v[128:131], v[184:187], v[24:27]
    ds_read_b128 v[96:99], v1 offset:32768
    v_add_f32_e64 v243, v9, v11
    v_mfma_f32_16x16x32_bf16 v[52:55], v[128:131], v[188:191], v[52:55]
    ds_read_b128 v[100:103], v1 offset:33792
    v_add_f32_e64 v244, v12, v14
    v_mfma_f32_16x16x32_bf16 v[28:31], v[132:135], v[184:187], v[28:31]
    ds_read_b128 v[104:107], v1 offset:34816
    v_add_f32_e64 v245, v13, v15
    v_mfma_f32_16x16x32_bf16 v[56:59], v[132:135], v[188:191], v[56:59]
    ds_read_b128 v[108:111], v248 offset:2048
    s_waitcnt lgkmcnt(8)
    v_mfma_f32_16x16x32_bf16 v[32:35], v[184:187], v[136:139], v[32:35]
    ds_read_b128 v[112:115], v249 offset:14336
    v_mov_b32 v4, v240
    v_mfma_f32_16x16x32_bf16 v[60:63], v[188:191], v[136:139], v[60:63]
    ds_read_b128 v[116:119], v251 offset:14336
    v_mov_b32_e64 v5, v241
    v_mfma_f32_16x16x32_bf16 v[36:39], v[184:187], v[140:143], v[36:39]
    buffer_load_dwordx4 v[176:179], v1, s[4:7], s40 offen offset:0 sc1
    v_mov_b32_e64 v8, v242
    v_mfma_f32_16x16x32_bf16 v[64:67], v[188:191], v[140:143], v[64:67]
    buffer_load_dwordx4 v[180:183], v253, s[4:7], s40 offen offset:0 sc1
    v_mov_b32_e64 v9, v243
    v_mfma_f32_16x16x32_bf16 v[40:43], v[144:147], v[184:187], v[40:43]
    v_mov_b32 v12, v244
    v_mov_b32 v13, v245
    v_mfma_f32_16x16x32_bf16 v[68:71], v[144:147], v[188:191], v[68:71]
    v_permlane32_swap_b32 v240, v4
    v_permlane32_swap_b32 v241, v5
    v_mfma_f32_16x16x32_bf16 v[72:75], v[152:155], v[148:151], v[72:75]
    v_permlane32_swap_b32 v242, v8
    v_mfma_f32_16x16x32_bf16 v[76:79], v[148:151], v[156:159], v[76:79]
    v_permlane32_swap_b32 v243, v9
    s_waitcnt vmcnt(8) lgkmcnt(6)
    v_mfma_f32_16x16x32_bf16 v[16:19], v[80:83], v[192:195], v[16:19]
    ds_read_b128 v[120:123], v1 offset:35840
    v_mfma_f32_16x16x32_bf16 v[44:47], v[80:83], v[196:199], v[44:47]
    ds_read_b128 v[124:127], v1 offset:36864
    v_permlane32_swap_b32 v244, v12
    v_mfma_f32_16x16x32_bf16 v[20:23], v[84:87], v[192:195], v[20:23]
    ds_read_b128 v[128:131], v1 offset:37888
    v_permlane32_swap_b32 v245, v13
    v_mfma_f32_16x16x32_bf16 v[48:51], v[84:87], v[196:199], v[48:51]
    ds_read_b128 v[132:135], v1 offset:38912
    v_add_f32 v240, v240, v4
    v_mfma_f32_16x16x32_bf16 v[24:27], v[88:91], v[192:195], v[24:27]
    ds_read_b128 v[136:139], v1 offset:39936
    v_add_f32_e64 v241, v241, v5
    v_mfma_f32_16x16x32_bf16 v[52:55], v[88:91], v[196:199], v[52:55]
    ds_read_b128 v[140:143], v1 offset:40960
    v_add_f32_e64 v242, v242, v8
    v_mfma_f32_16x16x32_bf16 v[28:31], v[92:95], v[192:195], v[28:31]
    ds_read_b128 v[144:147], v1 offset:41984
    v_add_f32_e64 v243, v243, v9
    v_mfma_f32_16x16x32_bf16 v[56:59], v[92:95], v[196:199], v[56:59]
    ds_read_b128 v[148:151], v248 offset:3072
    s_waitcnt lgkmcnt(8)
    v_mfma_f32_16x16x32_bf16 v[32:35], v[192:195], v[96:99], v[32:35]
    ds_read_b128 v[152:155], v249 offset:21504
    v_add_f32 v244, v244, v12
    v_mfma_f32_16x16x32_bf16 v[60:63], v[196:199], v[96:99], v[60:63]
    ds_read_b128 v[156:159], v251 offset:21504
    v_add_f32_e64 v245, v245, v13
    v_mfma_f32_16x16x32_bf16 v[36:39], v[192:195], v[100:103], v[36:39]
    buffer_load_dwordx4 v[184:187], v1, s[4:7], s40 offen offset:1024 sc1
    v_mov_b32_e64 v4, v240
    v_mfma_f32_16x16x32_bf16 v[64:67], v[196:199], v[100:103], v[64:67]
    buffer_load_dwordx4 v[188:191], v253, s[4:7], s40 offen offset:1024 sc1
    v_mov_b32_e64 v5, v241
    v_mfma_f32_16x16x32_bf16 v[40:43], v[104:107], v[192:195], v[40:43]
    v_mov_b32 v8, v242
    v_mov_b32 v9, v243
    v_mfma_f32_16x16x32_bf16 v[68:71], v[104:107], v[196:199], v[68:71]
    v_mov_b32 v12, v244
    v_mov_b32 v13, v245
    v_mfma_f32_16x16x32_bf16 v[72:75], v[112:115], v[108:111], v[72:75]
    v_permlane16_swap_b32 v240, v4
    v_mfma_f32_16x16x32_bf16 v[76:79], v[108:111], v[116:119], v[76:79]
    v_permlane16_swap_b32 v241, v5
    s_waitcnt vmcnt(8) lgkmcnt(6)
    s_barrier
    v_mfma_f32_16x16x32_bf16 v[16:19], v[120:123], v[200:203], v[16:19]
    ds_read_b128 v[80:83], v1 offset:43008
    v_mfma_f32_16x16x32_bf16 v[44:47], v[120:123], v[204:207], v[44:47]
    ds_read_b128 v[84:87], v1 offset:44032
    v_permlane16_swap_b32 v242, v8
    v_mfma_f32_16x16x32_bf16 v[20:23], v[124:127], v[200:203], v[20:23]
    ds_read_b128 v[88:91], v1 offset:45056
    v_permlane16_swap_b32 v243, v9
    v_mfma_f32_16x16x32_bf16 v[48:51], v[124:127], v[204:207], v[48:51]
    ds_read_b128 v[92:95], v1 offset:46080
    v_permlane16_swap_b32 v244, v12
    v_mfma_f32_16x16x32_bf16 v[24:27], v[128:131], v[200:203], v[24:27]
    ds_read_b128 v[96:99], v1 offset:47104
    v_permlane16_swap_b32 v245, v13
    v_mfma_f32_16x16x32_bf16 v[52:55], v[128:131], v[204:207], v[52:55]
    ds_read_b128 v[100:103], v1 offset:48128
    v_add_f32_e64 v240, v240, v4
    v_mfma_f32_16x16x32_bf16 v[28:31], v[132:135], v[200:203], v[28:31]
    ds_read_b128 v[104:107], v1 offset:49152
    v_add_f32_e64 v241, v241, v5
    v_mfma_f32_16x16x32_bf16 v[56:59], v[132:135], v[204:207], v[56:59]
    ds_read_b128 v[108:111], v248 offset:4096
    s_waitcnt lgkmcnt(8)
    v_mfma_f32_16x16x32_bf16 v[32:35], v[200:203], v[136:139], v[32:35]
    ds_read_b128 v[112:115], v249 offset:28672
    v_add_f32 v242, v242, v8
    v_mfma_f32_16x16x32_bf16 v[60:63], v[204:207], v[136:139], v[60:63]
    ds_read_b128 v[116:119], v251 offset:28672
    v_add_f32_e64 v243, v243, v9
    v_mfma_f32_16x16x32_bf16 v[36:39], v[200:203], v[140:143], v[36:39]
    buffer_load_dwordx4 v[192:195], v1, s[4:7], s40 offen offset:2048 sc1
    v_add_f32_e64 v244, v244, v12
    v_mfma_f32_16x16x32_bf16 v[64:67], v[204:207], v[140:143], v[64:67]
    buffer_load_dwordx4 v[196:199], v253, s[4:7], s40 offen offset:2048 sc1
    v_add_f32_e64 v245, v245, v13
    v_mfma_f32_16x16x32_bf16 v[40:43], v[144:147], v[200:203], v[40:43]
    v_mul_f32 v240, 0x3ae38e39, v240
    v_mul_f32 v241, 0x3ae38e39, v241
    v_mfma_f32_16x16x32_bf16 v[68:71], v[144:147], v[204:207], v[68:71]
    v_mul_f32 v242, 0x3ae38e39, v242
    v_mul_f32 v243, 0x3ae38e39, v243
    v_mfma_f32_16x16x32_bf16 v[72:75], v[152:155], v[148:151], v[72:75]
    v_mul_f32 v244, 0x3ae38e39, v244
    v_mfma_f32_16x16x32_bf16 v[76:79], v[148:151], v[156:159], v[76:79]
    v_mul_f32 v245, 0x3ae38e39, v245
    s_waitcnt vmcnt(8) lgkmcnt(6)
    v_mfma_f32_16x16x32_bf16 v[16:19], v[80:83], v[160:163], v[16:19]
    ds_read_b128 v[120:123], v1 offset:50176
    v_mfma_f32_16x16x32_bf16 v[44:47], v[80:83], v[164:167], v[44:47]
    ds_read_b128 v[124:127], v1 offset:51200
    v_fma_f32 v241, -v240, v240, v241
    v_mfma_f32_16x16x32_bf16 v[20:23], v[84:87], v[160:163], v[20:23]
    ds_read_b128 v[128:131], v1 offset:52224
    v_fma_f32 v243, -v242, v242, v243
    v_mfma_f32_16x16x32_bf16 v[48:51], v[84:87], v[164:167], v[48:51]
    ds_read_b128 v[132:135], v1 offset:53248
    v_fma_f32 v245, -v244, v244, v245
    v_mfma_f32_16x16x32_bf16 v[24:27], v[88:91], v[160:163], v[24:27]
    ds_read_b128 v[136:139], v1 offset:54272
    v_max_f32 v241, 0, v241
    v_mfma_f32_16x16x32_bf16 v[52:55], v[88:91], v[164:167], v[52:55]
    ds_read_b128 v[140:143], v1 offset:55296
    v_max_f32_e64 v243, 0, v243
    v_mfma_f32_16x16x32_bf16 v[28:31], v[92:95], v[160:163], v[28:31]
    ds_read_b128 v[144:147], v1 offset:56320
    v_max_f32_e64 v245, 0, v245
    v_mfma_f32_16x16x32_bf16 v[56:59], v[92:95], v[164:167], v[56:59]
    ds_read_b128 v[148:151], v248 offset:5120
    s_waitcnt lgkmcnt(8)
    v_mfma_f32_16x16x32_bf16 v[32:35], v[160:163], v[96:99], v[32:35]
    ds_read_b128 v[152:155], v249 offset:35840
    v_add_f32 v241, 0x3727c5ac, v241
    v_mfma_f32_16x16x32_bf16 v[60:63], v[164:167], v[96:99], v[60:63]
    ds_read_b128 v[156:159], v251 offset:35840
    v_add_f32 v243, 0x3727c5ac, v243
    v_mfma_f32_16x16x32_bf16 v[36:39], v[160:163], v[100:103], v[36:39]
    buffer_load_dwordx4 v[200:203], v1, s[4:7], s40 offen offset:3072 sc1
    v_add_f32 v245, 0x3727c5ac, v245
    v_mfma_f32_16x16x32_bf16 v[64:67], v[164:167], v[100:103], v[64:67]
    buffer_load_dwordx4 v[204:207], v253, s[4:7], s40 offen offset:3072 sc1
    v_rsq_f32 v241, v241
    v_mfma_f32_16x16x32_bf16 v[40:43], v[104:107], v[160:163], v[40:43]
    v_rsq_f32 v243, v243
    v_rsq_f32 v245, v245
    v_mfma_f32_16x16x32_bf16 v[68:71], v[104:107], v[164:167], v[68:71]
    s_nop 0
    v_lshlrev_b32 v255, 4, v3
    v_mfma_f32_16x16x32_bf16 v[72:75], v[112:115], v[108:111], v[72:75]
    v_add_u32 v236, 161792, v255
    v_mfma_f32_16x16x32_bf16 v[76:79], v[108:111], v[116:119], v[76:79]
    s_lshl_b32 s36, s33, 6
    s_waitcnt vmcnt(8) lgkmcnt(6)
    v_mfma_f32_16x16x32_bf16 v[16:19], v[120:123], v[168:171], v[16:19]
    ds_read_b128 v[80:83], v1 offset:57344
    v_mfma_f32_16x16x32_bf16 v[44:47], v[120:123], v[172:175], v[44:47]
    ds_read_b128 v[84:87], v1 offset:58368
    v_add_u32_e64 v237, s36, v236
    v_mfma_f32_16x16x32_bf16 v[20:23], v[124:127], v[168:171], v[20:23]
    ds_read_b128 v[88:91], v1 offset:59392
    v_lshlrev_b32_e64 v254, 2, v2
    v_mfma_f32_16x16x32_bf16 v[48:51], v[124:127], v[172:175], v[48:51]
    ds_read_b128 v[92:95], v1 offset:60416
    v_add_u32 v238, 161792, v254
    v_mfma_f32_16x16x32_bf16 v[24:27], v[128:131], v[168:171], v[24:27]
    ds_read_b128 v[96:99], v1 offset:61440
    s_lshl_b32 s37, s34, 6
    v_mfma_f32_16x16x32_bf16 v[52:55], v[128:131], v[172:175], v[52:55]
    ds_read_b128 v[100:103], v1 offset:62464
    v_add_u32 v239, s37, v238
    v_mfma_f32_16x16x32_bf16 v[28:31], v[132:135], v[168:171], v[28:31]
    ds_read_b128 v[104:107], v1 offset:63488
    s_mul_i32 s36, s20, 3072
    v_mfma_f32_16x16x32_bf16 v[56:59], v[132:135], v[172:175], v[56:59]
    ds_read_b128 v[108:111], v248 offset:6144
    s_waitcnt lgkmcnt(8)
    v_mfma_f32_16x16x32_bf16 v[32:35], v[168:171], v[136:139], v[32:35]
    ds_read_b128 v[112:115], v249 offset:43008
    s_add_u32 s36, s36, 153600
    v_mfma_f32_16x16x32_bf16 v[60:63], v[172:175], v[136:139], v[60:63]
    ds_read_b128 v[116:119], v251 offset:43008
    v_add_u32 v254, s36, v254
    v_mfma_f32_16x16x32_bf16 v[36:39], v[168:171], v[140:143], v[36:39]
    buffer_load_dwordx4 v[160:163], v1, s[4:7], s41 offen offset:0 sc1
    v_add_u32_e64 v255, s36, v255
    v_mfma_f32_16x16x32_bf16 v[64:67], v[172:175], v[140:143], v[64:67]
    buffer_load_dwordx4 v[164:167], v253, s[4:7], s41 offen offset:0 sc1
    v_mfma_f32_16x16x32_bf16 v[40:43], v[144:147], v[168:171], v[40:43]
    v_mfma_f32_16x16x32_bf16 v[68:71], v[144:147], v[172:175], v[68:71]
    ds_write2_b32 v254, v240, v241 offset0:0 offset1:16
    v_mfma_f32_16x16x32_bf16 v[72:75], v[152:155], v[148:151], v[72:75]
    ds_write2_b32 v254, v242, v243 offset0:32 offset1:48
    v_mfma_f32_16x16x32_bf16 v[76:79], v[148:151], v[156:159], v[76:79]
    ds_write2_b32 v254, v244, v245 offset0:64 offset1:80
    s_waitcnt vmcnt(8) lgkmcnt(9)
    s_barrier
    v_mfma_f32_16x16x32_bf16 v[16:19], v[80:83], v[176:179], v[16:19]
    ds_read_b128 v[120:123], v247 offset:0
    v_mfma_f32_16x16x32_bf16 v[44:47], v[80:83], v[180:183], v[44:47]
    ds_read_b128 v[124:127], v247 offset:1024
    v_mfma_f32_16x16x32_bf16 v[20:23], v[84:87], v[176:179], v[20:23]
    ds_read_b128 v[128:131], v247 offset:2048
    v_mfma_f32_16x16x32_bf16 v[48:51], v[84:87], v[180:183], v[48:51]
    ds_read_b128 v[132:135], v247 offset:3072
    v_mfma_f32_16x16x32_bf16 v[24:27], v[88:91], v[176:179], v[24:27]
    ds_read_b128 v[136:139], v247 offset:4096
    v_mfma_f32_16x16x32_bf16 v[52:55], v[88:91], v[180:183], v[52:55]
    ds_read_b128 v[140:143], v247 offset:5120
    v_mfma_f32_16x16x32_bf16 v[28:31], v[92:95], v[176:179], v[28:31]
    ds_read_b128 v[144:147], v247 offset:6144
    v_mfma_f32_16x16x32_bf16 v[56:59], v[92:95], v[180:183], v[56:59]
    ds_read_b128 v[148:151], v248 offset:7168
    s_waitcnt lgkmcnt(8)
    v_mfma_f32_16x16x32_bf16 v[32:35], v[176:179], v[96:99], v[32:35]
    ds_read_b128 v[152:155], v249 offset:50176
    v_mfma_f32_16x16x32_bf16 v[60:63], v[180:183], v[96:99], v[60:63]
    ds_read_b128 v[156:159], v251 offset:50176
    v_mfma_f32_16x16x32_bf16 v[36:39], v[176:179], v[100:103], v[36:39]
    buffer_load_dwordx4 v[168:171], v1, s[4:7], s41 offen offset:1024 sc1
    ds_read_b128 v[208:211], v236 offset:0
    v_mfma_f32_16x16x32_bf16 v[64:67], v[180:183], v[100:103], v[64:67]
    buffer_load_dwordx4 v[172:175], v253, s[4:7], s41 offen offset:1024 sc1
    ds_read_b128 v[212:215], v236 offset:64
    v_mfma_f32_16x16x32_bf16 v[40:43], v[104:107], v[176:179], v[40:43]
    ds_read_b128 v[216:219], v236 offset:128
    v_mfma_f32_16x16x32_bf16 v[68:71], v[104:107], v[180:183], v[68:71]
    ds_read_b128 v[220:223], v236 offset:192
    v_mfma_f32_16x16x32_bf16 v[72:75], v[112:115], v[108:111], v[72:75]
    ds_read_b128 v[224:227], v236 offset:384
    v_mfma_f32_16x16x32_bf16 v[76:79], v[108:111], v[116:119], v[76:79]
    ds_read_b128 v[228:231], v237
    s_waitcnt vmcnt(8) lgkmcnt(12)
    v_mfma_f32_16x16x32_bf16 v[16:19], v[120:123], v[184:187], v[16:19]
    ds_read_b128 v[80:83], v247 offset:7168
    v_mfma_f32_16x16x32_bf16 v[44:47], v[120:123], v[188:191], v[44:47]
    ds_read_b128 v[84:87], v247 offset:8192
    v_mfma_f32_16x16x32_bf16 v[20:23], v[124:127], v[184:187], v[20:23]
    ds_read_b128 v[88:91], v247 offset:9216
    v_mfma_f32_16x16x32_bf16 v[48:51], v[124:127], v[188:191], v[48:51]
    ds_read_b128 v[92:95], v247 offset:10240
    v_mfma_f32_16x16x32_bf16 v[24:27], v[128:131], v[184:187], v[24:27]
    ds_read_b128 v[96:99], v247 offset:11264
    v_mfma_f32_16x16x32_bf16 v[52:55], v[128:131], v[188:191], v[52:55]
    ds_read_b128 v[100:103], v247 offset:12288
    v_mfma_f32_16x16x32_bf16 v[28:31], v[132:135], v[184:187], v[28:31]
    ds_read_b128 v[104:107], v247 offset:13312
    v_mfma_f32_16x16x32_bf16 v[56:59], v[132:135], v[188:191], v[56:59]
    ds_read_b128 v[108:111], v248 offset:8192
    s_waitcnt lgkmcnt(8)
    v_mfma_f32_16x16x32_bf16 v[32:35], v[184:187], v[136:139], v[32:35]
    ds_read_b128 v[112:115], v249 offset:57344
    v_mfma_f32_16x16x32_bf16 v[60:63], v[188:191], v[136:139], v[60:63]
    ds_read_b128 v[116:119], v251 offset:57344
    v_mfma_f32_16x16x32_bf16 v[36:39], v[184:187], v[140:143], v[36:39]
    buffer_load_dwordx4 v[176:179], v1, s[4:7], s41 offen offset:2048 sc1
    v_mfma_f32_16x16x32_bf16 v[64:67], v[188:191], v[140:143], v[64:67]
    buffer_load_dwordx4 v[180:183], v253, s[4:7], s41 offen offset:2048 sc1
    ds_read2_b32 v[232:233], v238 offset0:64 offset1:80
    v_mfma_f32_16x16x32_bf16 v[40:43], v[144:147], v[184:187], v[40:43]
    ds_read_b32 v234, v239
    v_mfma_f32_16x16x32_bf16 v[68:71], v[144:147], v[188:191], v[68:71]
    ds_read_b128 v[4:7], v255 offset:0
    v_mfma_f32_16x16x32_bf16 v[72:75], v[152:155], v[148:151], v[72:75]
    ds_read_b128 v[8:11], v255 offset:128
    v_mfma_f32_16x16x32_bf16 v[76:79], v[148:151], v[156:159], v[76:79]
    ds_read_b128 v[12:15], v255 offset:256
    s_waitcnt vmcnt(8) lgkmcnt(11)
    s_barrier
    v_mfma_f32_16x16x32_bf16 v[16:19], v[80:83], v[192:195], v[16:19]
    ds_read_b128 v[120:123], v247 offset:14336
    v_mfma_f32_16x16x32_bf16 v[44:47], v[80:83], v[196:199], v[44:47]
    ds_read_b128 v[124:127], v247 offset:15360
    v_mfma_f32_16x16x32_bf16 v[20:23], v[84:87], v[192:195], v[20:23]
    ds_read_b128 v[128:131], v247 offset:16384
    v_mfma_f32_16x16x32_bf16 v[48:51], v[84:87], v[196:199], v[48:51]
    ds_read_b128 v[132:135], v247 offset:17408
    v_mfma_f32_16x16x32_bf16 v[24:27], v[88:91], v[192:195], v[24:27]
    ds_read_b128 v[136:139], v247 offset:18432
    v_mfma_f32_16x16x32_bf16 v[52:55], v[88:91], v[196:199], v[52:55]
    ds_read_b128 v[140:143], v247 offset:19456
    v_mfma_f32_16x16x32_bf16 v[28:31], v[92:95], v[192:195], v[28:31]
    ds_read_b128 v[144:147], v247 offset:20480
    v_mfma_f32_16x16x32_bf16 v[56:59], v[92:95], v[196:199], v[56:59]
    ds_read_b128 v[148:151], v248 offset:9216
    s_waitcnt lgkmcnt(8)
    v_mfma_f32_16x16x32_bf16 v[32:35], v[192:195], v[96:99], v[32:35]
    ds_read_b128 v[152:155], v250 offset:0
    v_mfma_f32_16x16x32_bf16 v[60:63], v[196:199], v[96:99], v[60:63]
    ds_read_b128 v[156:159], v252 offset:0
    v_mfma_f32_16x16x32_bf16 v[36:39], v[192:195], v[100:103], v[36:39]
    buffer_load_dwordx4 v[184:187], v1, s[4:7], s41 offen offset:3072 sc1
    v_mfma_f32_16x16x32_bf16 v[64:67], v[196:199], v[100:103], v[64:67]
    buffer_load_dwordx4 v[188:191], v253, s[4:7], s41 offen offset:3072 sc1
    v_mfma_f32_16x16x32_bf16 v[40:43], v[104:107], v[192:195], v[40:43]
    v_mfma_f32_16x16x32_bf16 v[68:71], v[104:107], v[196:199], v[68:71]
    v_mfma_f32_16x16x32_bf16 v[72:75], v[112:115], v[108:111], v[72:75]
    v_mfma_f32_16x16x32_bf16 v[76:79], v[108:111], v[116:119], v[76:79]
    s_waitcnt vmcnt(8) lgkmcnt(6)
    v_mfma_f32_16x16x32_bf16 v[16:19], v[120:123], v[200:203], v[16:19]
    ds_read_b128 v[80:83], v247 offset:21504
    v_fma_f32 v32, -v8, v232, v32
    v_mfma_f32_16x16x32_bf16 v[44:47], v[120:123], v[204:207], v[44:47]
    ds_read_b128 v[84:87], v247 offset:22528
    v_fma_f32 v60, -v12, v232, v60
    v_mfma_f32_16x16x32_bf16 v[20:23], v[124:127], v[200:203], v[20:23]
    ds_read_b128 v[88:91], v247 offset:23552
    v_fma_f32 v36, -v8, v233, v36
    v_mfma_f32_16x16x32_bf16 v[48:51], v[124:127], v[204:207], v[48:51]
    ds_read_b128 v[92:95], v247 offset:24576
    v_fma_f32 v64, -v12, v233, v64
    v_mfma_f32_16x16x32_bf16 v[24:27], v[128:131], v[200:203], v[24:27]
    ds_read_b128 v[96:99], v247 offset:25600
    v_fma_f32 v40, -v242, v224, v40
    v_mfma_f32_16x16x32_bf16 v[52:55], v[128:131], v[204:207], v[52:55]
    ds_read_b128 v[100:103], v247 offset:26624
    v_fma_f32 v68, -v244, v224, v68
    v_mfma_f32_16x16x32_bf16 v[28:31], v[132:135], v[200:203], v[28:31]
    ds_read_b128 v[104:107], v247 offset:27648
    v_fma_f32 v72, -v240, v228, v72
    v_mfma_f32_16x16x32_bf16 v[56:59], v[132:135], v[204:207], v[56:59]
    ds_read_b128 v[108:111], v248 offset:10240
    s_waitcnt lgkmcnt(8)
    v_fma_f32 v76, -v4, v234, v76
    v_mfma_f32_16x16x32_bf16 v[32:35], v[200:203], v[136:139], v[32:35]
    ds_read_b128 v[112:115], v250 offset:7168
    v_fma_f32 v16, -v242, v208, v16
    v_mfma_f32_16x16x32_bf16 v[60:63], v[204:207], v[136:139], v[60:63]
    ds_read_b128 v[116:119], v252 offset:7168
    v_fma_f32 v44, -v244, v208, v44
    v_mfma_f32_16x16x32_bf16 v[36:39], v[200:203], v[140:143], v[36:39]
    buffer_load_dwordx4 v[192:195], v1, s[4:7], s42 offen offset:0 sc1
    v_fma_f32 v20, -v242, v212, v20
    v_mfma_f32_16x16x32_bf16 v[64:67], v[204:207], v[140:143], v[64:67]
    buffer_load_dwordx4 v[196:199], v253, s[4:7], s42 offen offset:0 sc1
    v_fma_f32 v48, -v244, v212, v48
    v_mfma_f32_16x16x32_bf16 v[40:43], v[144:147], v[200:203], v[40:43]
    v_fma_f32 v24, -v242, v216, v24
    v_mfma_f32_16x16x32_bf16 v[68:71], v[144:147], v[204:207], v[68:71]
    v_fma_f32 v52, -v244, v216, v52
    v_mfma_f32_16x16x32_bf16 v[72:75], v[152:155], v[148:151], v[72:75]
    v_fma_f32 v28, -v242, v220, v28
    v_mfma_f32_16x16x32_bf16 v[76:79], v[148:151], v[156:159], v[76:79]
    v_fma_f32 v56, -v244, v220, v56
    s_waitcnt vmcnt(8) lgkmcnt(6)
    s_barrier
    v_mfma_f32_16x16x32_bf16 v[16:19], v[80:83], v[160:163], v[16:19]
    ds_read_b128 v[120:123], v247 offset:28672
    v_fma_f32 v33, -v9, v232, v33
    v_mfma_f32_16x16x32_bf16 v[44:47], v[80:83], v[164:167], v[44:47]
    ds_read_b128 v[124:127], v247 offset:29696
    v_fma_f32 v61, -v13, v232, v61
    v_mfma_f32_16x16x32_bf16 v[20:23], v[84:87], v[160:163], v[20:23]
    ds_read_b128 v[128:131], v247 offset:30720
    v_fma_f32 v37, -v9, v233, v37
    v_mfma_f32_16x16x32_bf16 v[48:51], v[84:87], v[164:167], v[48:51]
    ds_read_b128 v[132:135], v247 offset:31744
    v_fma_f32 v65, -v13, v233, v65
    v_mfma_f32_16x16x32_bf16 v[24:27], v[88:91], v[160:163], v[24:27]
    ds_read_b128 v[136:139], v247 offset:32768
    v_fma_f32 v41, -v242, v225, v41
    v_mfma_f32_16x16x32_bf16 v[52:55], v[88:91], v[164:167], v[52:55]
    ds_read_b128 v[140:143], v247 offset:33792
    v_fma_f32 v69, -v244, v225, v69
    v_mfma_f32_16x16x32_bf16 v[28:31], v[92:95], v[160:163], v[28:31]
    ds_read_b128 v[144:147], v247 offset:34816
    v_fma_f32 v73, -v240, v229, v73
    v_mfma_f32_16x16x32_bf16 v[56:59], v[92:95], v[164:167], v[56:59]
    ds_read_b128 v[148:151], v248 offset:11264
    s_waitcnt lgkmcnt(8)
    v_fma_f32 v77, -v5, v234, v77
    v_mfma_f32_16x16x32_bf16 v[32:35], v[160:163], v[96:99], v[32:35]
    ds_read_b128 v[152:155], v250 offset:14336
    v_fma_f32 v17, -v242, v209, v17
    v_mfma_f32_16x16x32_bf16 v[60:63], v[164:167], v[96:99], v[60:63]
    ds_read_b128 v[156:159], v252 offset:14336
    v_fma_f32 v45, -v244, v209, v45
    v_mfma_f32_16x16x32_bf16 v[36:39], v[160:163], v[100:103], v[36:39]
    buffer_load_dwordx4 v[200:203], v1, s[4:7], s42 offen offset:1024 sc1
    v_fma_f32 v21, -v242, v213, v21
    v_mfma_f32_16x16x32_bf16 v[64:67], v[164:167], v[100:103], v[64:67]
    buffer_load_dwordx4 v[204:207], v253, s[4:7], s42 offen offset:1024 sc1
    v_fma_f32 v49, -v244, v213, v49
    v_mfma_f32_16x16x32_bf16 v[40:43], v[104:107], v[160:163], v[40:43]
    v_fma_f32 v25, -v242, v217, v25
    v_mfma_f32_16x16x32_bf16 v[68:71], v[104:107], v[164:167], v[68:71]
    v_fma_f32 v53, -v244, v217, v53
    v_mfma_f32_16x16x32_bf16 v[72:75], v[112:115], v[108:111], v[72:75]
    v_fma_f32 v29, -v242, v221, v29
    v_mfma_f32_16x16x32_bf16 v[76:79], v[108:111], v[116:119], v[76:79]
    v_fma_f32 v57, -v244, v221, v57
    s_waitcnt vmcnt(8) lgkmcnt(6)
    v_mfma_f32_16x16x32_bf16 v[16:19], v[120:123], v[168:171], v[16:19]
    ds_read_b128 v[80:83], v247 offset:35840
    v_fma_f32 v34, -v10, v232, v34
    v_mfma_f32_16x16x32_bf16 v[44:47], v[120:123], v[172:175], v[44:47]
    ds_read_b128 v[84:87], v247 offset:36864
    v_fma_f32 v62, -v14, v232, v62
    v_mfma_f32_16x16x32_bf16 v[20:23], v[124:127], v[168:171], v[20:23]
    ds_read_b128 v[88:91], v247 offset:37888
    v_fma_f32 v38, -v10, v233, v38
    v_mfma_f32_16x16x32_bf16 v[48:51], v[124:127], v[172:175], v[48:51]
    ds_read_b128 v[92:95], v247 offset:38912
    v_fma_f32 v66, -v14, v233, v66
    v_mfma_f32_16x16x32_bf16 v[24:27], v[128:131], v[168:171], v[24:27]
    ds_read_b128 v[96:99], v247 offset:39936
    v_fma_f32 v42, -v242, v226, v42
    v_mfma_f32_16x16x32_bf16 v[52:55], v[128:131], v[172:175], v[52:55]
    ds_read_b128 v[100:103], v247 offset:40960
    v_fma_f32 v70, -v244, v226, v70
    v_mfma_f32_16x16x32_bf16 v[28:31], v[132:135], v[168:171], v[28:31]
    ds_read_b128 v[104:107], v247 offset:41984
    v_fma_f32 v74, -v240, v230, v74
    v_mfma_f32_16x16x32_bf16 v[56:59], v[132:135], v[172:175], v[56:59]
    ds_read_b128 v[108:111], v248 offset:12288
    s_waitcnt lgkmcnt(8)
    v_fma_f32 v78, -v6, v234, v78
    v_mfma_f32_16x16x32_bf16 v[32:35], v[168:171], v[136:139], v[32:35]
    ds_read_b128 v[112:115], v250 offset:21504
    v_fma_f32 v18, -v242, v210, v18
    v_mfma_f32_16x16x32_bf16 v[60:63], v[172:175], v[136:139], v[60:63]
    ds_read_b128 v[116:119], v252 offset:21504
    v_fma_f32 v46, -v244, v210, v46
    v_mfma_f32_16x16x32_bf16 v[36:39], v[168:171], v[140:143], v[36:39]
    v_fma_f32 v22, -v242, v214, v22
    v_mfma_f32_16x16x32_bf16 v[64:67], v[172:175], v[140:143], v[64:67]
    v_fma_f32 v50, -v244, v214, v50
    v_mfma_f32_16x16x32_bf16 v[40:43], v[144:147], v[168:171], v[40:43]
    v_fma_f32 v26, -v242, v218, v26
    v_mfma_f32_16x16x32_bf16 v[68:71], v[144:147], v[172:175], v[68:71]
    v_fma_f32 v54, -v244, v218, v54
    v_mfma_f32_16x16x32_bf16 v[72:75], v[152:155], v[148:151], v[72:75]
    v_fma_f32 v30, -v242, v222, v30
    v_mfma_f32_16x16x32_bf16 v[76:79], v[148:151], v[156:159], v[76:79]
    v_fma_f32 v58, -v244, v222, v58
    s_waitcnt vmcnt(6) lgkmcnt(6)
    v_mfma_f32_16x16x32_bf16 v[16:19], v[80:83], v[176:179], v[16:19]
    ds_read_b128 v[120:123], v247 offset:43008
    v_fma_f32 v35, -v11, v232, v35
    v_mfma_f32_16x16x32_bf16 v[44:47], v[80:83], v[180:183], v[44:47]
    ds_read_b128 v[124:127], v247 offset:44032
    v_fma_f32 v63, -v15, v232, v63
    v_mfma_f32_16x16x32_bf16 v[20:23], v[84:87], v[176:179], v[20:23]
    ds_read_b128 v[128:131], v247 offset:45056
    v_fma_f32 v39, -v11, v233, v39
    v_mfma_f32_16x16x32_bf16 v[48:51], v[84:87], v[180:183], v[48:51]
    ds_read_b128 v[132:135], v247 offset:46080
    v_fma_f32 v67, -v15, v233, v67
    v_mfma_f32_16x16x32_bf16 v[24:27], v[88:91], v[176:179], v[24:27]
    ds_read_b128 v[136:139], v247 offset:47104
    v_fma_f32 v43, -v242, v227, v43
    v_mfma_f32_16x16x32_bf16 v[52:55], v[88:91], v[180:183], v[52:55]
    ds_read_b128 v[140:143], v247 offset:48128
    v_fma_f32 v71, -v244, v227, v71
    v_mfma_f32_16x16x32_bf16 v[28:31], v[92:95], v[176:179], v[28:31]
    ds_read_b128 v[144:147], v247 offset:49152
    v_fma_f32 v75, -v240, v231, v75
    v_mfma_f32_16x16x32_bf16 v[56:59], v[92:95], v[180:183], v[56:59]
    ds_read_b128 v[148:151], v248 offset:13312
    s_waitcnt lgkmcnt(8)
    v_fma_f32 v79, -v7, v234, v79
    v_mfma_f32_16x16x32_bf16 v[32:35], v[176:179], v[96:99], v[32:35]
    ds_read_b128 v[152:155], v250 offset:28672
    v_fma_f32 v19, -v242, v211, v19
    v_mfma_f32_16x16x32_bf16 v[60:63], v[180:183], v[96:99], v[60:63]
    ds_read_b128 v[156:159], v252 offset:28672
    v_fma_f32 v47, -v244, v211, v47
    v_mfma_f32_16x16x32_bf16 v[36:39], v[176:179], v[100:103], v[36:39]
    v_fma_f32 v23, -v242, v215, v23
    v_mfma_f32_16x16x32_bf16 v[64:67], v[180:183], v[100:103], v[64:67]
    v_fma_f32 v51, -v244, v215, v51
    v_mfma_f32_16x16x32_bf16 v[40:43], v[104:107], v[176:179], v[40:43]
    v_fma_f32 v27, -v242, v219, v27
    v_mfma_f32_16x16x32_bf16 v[68:71], v[104:107], v[180:183], v[68:71]
    v_fma_f32 v55, -v244, v219, v55
    v_mfma_f32_16x16x32_bf16 v[72:75], v[112:115], v[108:111], v[72:75]
    v_fma_f32 v31, -v242, v223, v31
    v_mfma_f32_16x16x32_bf16 v[76:79], v[108:111], v[116:119], v[76:79]
    v_fma_f32 v59, -v244, v223, v59
    s_waitcnt vmcnt(4) lgkmcnt(6)
    s_barrier
    v_mfma_f32_16x16x32_bf16 v[16:19], v[120:123], v[184:187], v[16:19]
    ds_read_b128 v[80:83], v247 offset:50176
    v_mfma_f32_16x16x32_bf16 v[44:47], v[120:123], v[188:191], v[44:47]
    ds_read_b128 v[84:87], v247 offset:51200
    v_and_b32 v4, 1, v2
    v_mfma_f32_16x16x32_bf16 v[20:23], v[124:127], v[184:187], v[20:23]
    ds_read_b128 v[88:91], v247 offset:52224
    v_lshl_add_u32 v5, v3, 2, v4
    v_mfma_f32_16x16x32_bf16 v[48:51], v[124:127], v[188:191], v[48:51]
    ds_read_b128 v[92:95], v247 offset:53248
    v_add_u32_e64 v6, 2, v5
    v_mfma_f32_16x16x32_bf16 v[24:27], v[128:131], v[184:187], v[24:27]
    ds_read_b128 v[96:99], v247 offset:54272
    v_cmp_eq_u32 s[40:41], 1, v4
    v_mfma_f32_16x16x32_bf16 v[52:55], v[128:131], v[188:191], v[52:55]
    ds_read_b128 v[100:103], v247 offset:55296
    v_cmp_le_u32 s[42:43], v5, v2
    v_mfma_f32_16x16x32_bf16 v[28:31], v[132:135], v[184:187], v[28:31]
    ds_read_b128 v[104:107], v247 offset:56320
    v_cmp_le_u32 s[44:45], v6, v2
    v_mfma_f32_16x16x32_bf16 v[56:59], v[132:135], v[188:191], v[56:59]
    ds_read_b128 v[108:111], v248 offset:14336
    s_waitcnt lgkmcnt(8)
    v_mfma_f32_16x16x32_bf16 v[32:35], v[184:187], v[136:139], v[32:35]
    ds_read_b128 v[112:115], v250 offset:35840
    v_mov_b32 v4, 0x0c0c0100
    v_mfma_f32_16x16x32_bf16 v[60:63], v[188:191], v[136:139], v[60:63]
    ds_read_b128 v[116:119], v252 offset:35840
    v_mov_b32 v5, 0x01000c0c
    v_mfma_f32_16x16x32_bf16 v[36:39], v[184:187], v[140:143], v[36:39]
    v_mov_b32 v6, 0x0c0c0302
    v_mov_b32 v7, 0x03020c0c
    v_mfma_f32_16x16x32_bf16 v[64:67], v[188:191], v[140:143], v[64:67]
    v_mov_b32 v8, 0x0c0c0c0c
    v_cndmask_b32 v4, v4, v5, s[40:41]
    v_mfma_f32_16x16x32_bf16 v[40:43], v[144:147], v[184:187], v[40:43]
    v_cndmask_b32 v6, v6, v7, s[40:41]
    v_cndmask_b32 v12, v4, v8, s[42:43]
    v_mfma_f32_16x16x32_bf16 v[68:71], v[144:147], v[188:191], v[68:71]
    v_cndmask_b32 v13, v6, v8, s[44:45]
    v_cndmask_b32 v14, v8, v4, s[42:43]
    v_mfma_f32_16x16x32_bf16 v[72:75], v[152:155], v[148:151], v[72:75]
    v_cndmask_b32 v15, v8, v6, s[44:45]
    s_cmp_eq_u32 s31, 0
    v_mfma_f32_16x16x32_bf16 v[76:79], v[148:151], v[156:159], v[76:79]
    s_cselect_b64 s[48:49], s[42:43], -1
    s_cselect_b64 s[38:39], s[44:45], -1
    s_waitcnt vmcnt(2) lgkmcnt(6)
    v_mfma_f32_16x16x32_bf16 v[16:19], v[80:83], v[192:195], v[16:19]
    ds_read_b128 v[120:123], v247 offset:57344
    v_mfma_f32_16x16x32_bf16 v[44:47], v[80:83], v[196:199], v[44:47]
    ds_read_b128 v[124:127], v247 offset:58368
    s_mul_i32 s36, s20, 3072
    v_mfma_f32_16x16x32_bf16 v[20:23], v[84:87], v[192:195], v[20:23]
    ds_read_b128 v[128:131], v247 offset:59392
    s_add_u32 s36, s36, 149504
    v_mfma_f32_16x16x32_bf16 v[48:51], v[84:87], v[196:199], v[48:51]
    ds_read_b128 v[132:135], v247 offset:60416
    v_add_u32 v9, s36, v0
    v_mfma_f32_16x16x32_bf16 v[24:27], v[88:91], v[192:195], v[24:27]
    ds_read_b128 v[136:139], v247 offset:61440
    s_lshl_b32 s37, s20, 9
    v_mfma_f32_16x16x32_bf16 v[52:55], v[88:91], v[196:199], v[52:55]
    ds_read_b128 v[140:143], v247 offset:62464
    s_add_u32 s37, s37, 149504
    v_mfma_f32_16x16x32_bf16 v[28:31], v[92:95], v[192:195], v[28:31]
    ds_read_b128 v[144:147], v247 offset:63488
    v_add_u32 v10, s37, v0
    v_mfma_f32_16x16x32_bf16 v[56:59], v[92:95], v[196:199], v[56:59]
    ds_read_b128 v[148:151], v248 offset:15360
    s_waitcnt lgkmcnt(8)
    v_mfma_f32_16x16x32_bf16 v[32:35], v[192:195], v[96:99], v[32:35]
    ds_read_b128 v[152:155], v250 offset:43008
    v_lshlrev_b32 v4, 2, v3
    v_mfma_f32_16x16x32_bf16 v[60:63], v[196:199], v[96:99], v[60:63]
    ds_read_b128 v[156:159], v252 offset:43008
    v_sub_u32_e64 v4, v2, v4
    v_mfma_f32_16x16x32_bf16 v[36:39], v[192:195], v[100:103], v[36:39]
    v_lshlrev_b32 v5, 4, v4
    v_lshrrev_b32 v4, 1, v4
    v_mfma_f32_16x16x32_bf16 v[64:67], v[196:199], v[100:103], v[64:67]
    v_mov_b32 v6, 0x3f80
    v_lshlrev_b32_e64 v5, v5, v6
    v_mfma_f32_16x16x32_bf16 v[40:43], v[104:107], v[192:195], v[40:43]
    v_cmp_eq_u32_e64 vcc, 0, v4
    v_cmp_eq_u32 s[46:47], 1, v4
    v_mfma_f32_16x16x32_bf16 v[68:71], v[104:107], v[196:199], v[68:71]
    ds_read_b128 v[208:211], v255 offset:64
    s_lshl_b32 s36, s24, 10
    v_add_u32 v4, s36, v1
    v_mfma_f32_16x16x32_bf16 v[72:75], v[112:115], v[108:111], v[72:75]
    ds_read_b128 v[212:215], v255 offset:192
    v_cndmask_b32_e64 v234, 0, v5, vcc
    v_cndmask_b32 v235, 0, v5, s[46:47]
    v_mfma_f32_16x16x32_bf16 v[76:79], v[108:111], v[116:119], v[76:79]
    ds_read_b128 v[216:219], v255 offset:320
    v_add_u32 v5, 18432, v4
    s_lshl_b32 s36, s24, 7
    s_waitcnt vmcnt(0) lgkmcnt(9)
    v_mfma_f32_16x16x32_bf16 v[16:19], v[120:123], v[200:203], v[16:19]
    ds_read_b128 v[80:83], v248 offset:16384
    v_mfma_f32_16x16x32_bf16 v[44:47], v[120:123], v[204:207], v[44:47]
    ds_read_b128 v[84:87], v250 offset:50176
    s_add_u32 s36, s36, 16384
    v_mfma_f32_16x16x32_bf16 v[20:23], v[124:127], v[200:203], v[20:23]
    ds_read_b128 v[88:91], v252 offset:50176
    v_cmp_eq_u32_e64 vcc, 2, v3
    v_mfma_f32_16x16x32_bf16 v[48:51], v[124:127], v[204:207], v[48:51]
    ds_read_b128 v[92:95], v248 offset:17408
    v_lshl_add_u32 v6, v2, 3, s36
    v_mfma_f32_16x16x32_bf16 v[24:27], v[128:131], v[200:203], v[24:27]
    ds_read_b128 v[96:99], v250 offset:57344
    v_bfrev_b32_e64 v7, 1
    v_mfma_f32_16x16x32_bf16 v[52:55], v[128:131], v[204:207], v[52:55]
    ds_read_b128 v[100:103], v252 offset:57344
    v_cndmask_b32_e64 v6, v7, v6, vcc
    v_mfma_f32_16x16x32_bf16 v[28:31], v[132:135], v[200:203], v[28:31]
    v_add_u32 v7, 18432, v6
    v_mov_b32_e64 v106, 0
    v_mfma_f32_16x16x32_bf16 v[56:59], v[132:135], v[204:207], v[56:59]
    s_waitcnt lgkmcnt(6)
    v_mov_b32 v107, 0
    v_mfma_f32_16x16x32_bf16 v[32:35], v[200:203], v[136:139], v[32:35]
    v_mov_b32 v8, 0xf149f2ca
    v_mov_b32_e64 v108, 0
    v_mfma_f32_16x16x32_bf16 v[60:63], v[204:207], v[136:139], v[60:63]
    s_mov_b32 s33, 0x3eae1a93
    v_mov_b32_e64 v109, 0
    v_mfma_f32_16x16x32_bf16 v[36:39], v[200:203], v[140:143], v[36:39]
    v_mov_b32 v236, 0x3f803f80
    v_mov_b32 v237, 0x3f803f80
    v_mfma_f32_16x16x32_bf16 v[64:67], v[204:207], v[140:143], v[64:67]
    v_mov_b32 v238, 0x3f803f80
    v_mov_b32 v239, 0x3f803f80
    v_mfma_f32_16x16x32_bf16 v[40:43], v[144:147], v[200:203], v[40:43]
    v_mov_b32_e64 v114, 0
    v_mfma_f32_16x16x32_bf16 v[68:71], v[144:147], v[204:207], v[68:71]
    v_mov_b32_e64 v115, 0
    v_mfma_f32_16x16x32_bf16 v[72:75], v[152:155], v[148:151], v[72:75]
    v_mov_b32_e64 v116, 0
    v_mfma_f32_16x16x32_bf16 v[76:79], v[148:151], v[156:159], v[76:79]
    v_mov_b32 v117, 0
    s_waitcnt lgkmcnt(0)
    v_mfma_f32_16x16x32_bf16 v[72:75], v[84:87], v[80:83], v[72:75]
    v_mfma_f32_16x16x32_bf16 v[76:79], v[80:83], v[88:91], v[76:79]
    v_mfma_f32_16x16x32_bf16 v[72:75], v[96:99], v[92:95], v[72:75]
    v_mfma_f32_16x16x32_bf16 v[76:79], v[92:95], v[100:103], v[76:79]
L_a_e0:
    v_pk_mul_f32 v[52:53], v[52:53], v[244:245] op_sel:[0,1] op_sel_hi:[1,1]
    v_pk_mul_f32 v[54:55], v[54:55], v[244:245] op_sel:[0,1] op_sel_hi:[1,1]
    v_pk_mul_f32 v[56:57], v[56:57], v[244:245] op_sel:[0,1] op_sel_hi:[1,1]
    v_pk_mul_f32 v[58:59], v[58:59], v[244:245] op_sel:[0,1] op_sel_hi:[1,1]
    v_pk_mul_f32 v[60:61], v[60:61], v[216:217]
    v_pk_mul_f32 v[62:63], v[62:63], v[218:219]
    v_pk_mul_f32 v[64:65], v[64:65], v[216:217]
    v_pk_mul_f32 v[66:67], v[66:67], v[218:219]
    v_pk_mul_f32 v[68:69], v[68:69], v[244:245] op_sel:[0,1] op_sel_hi:[1,1]
    v_pk_mul_f32 v[70:71], v[70:71], v[244:245] op_sel:[0,1] op_sel_hi:[1,1]
    v_pk_mul_f32 v[72:73], v[72:73], v[240:241] op_sel:[0,1] op_sel_hi:[1,1]
    v_pk_mul_f32 v[74:75], v[74:75], v[240:241] op_sel:[0,1] op_sel_hi:[1,1]
    v_pk_mul_f32 v[76:77], v[76:77], v[208:209]
    v_pk_mul_f32 v[78:79], v[78:79], v[210:211]
    v_cvt_pk_bf16_f32 v172, v52, v53
    v_cvt_pk_bf16_f32 v173, v54, v55
    v_cvt_pk_bf16_f32 v176, v56, v57
    v_cvt_pk_bf16_f32 v177, v58, v59
    v_cvt_pk_bf16_f32 v182, v60, v61
    v_cvt_pk_bf16_f32 v183, v62, v63
    v_cvt_pk_bf16_f32 v188, v64, v65
    v_cvt_pk_bf16_f32 v189, v66, v67
    v_cvt_pk_bf16_f32 v174, v68, v69
    v_cvt_pk_bf16_f32 v175, v70, v71
    v_cvt_pk_bf16_f32 v220, v72, v73
    v_cvt_pk_bf16_f32 v221, v74, v75
    v_cvt_pk_bf16_f32 v222, v76, v77
    v_cvt_pk_bf16_f32 v223, v78, v79
    s_cmp_eq_u32 s20, 3
    s_cbranch_scc1 L_a_nw
    ds_write2st64_b64 v9, v[172:173], v[174:175] offset0:6 offset1:7
    ds_write2st64_b64 v9, v[176:177], v[182:183] offset0:8 offset1:9
    ds_write_b64 v9, v[188:189] offset:5120
    ds_write2st64_b64 v10, v[220:221], v[222:223] offset0:0 offset1:3
L_a_nw:
    v_pk_mul_f32 v[24:25], v[24:25], v[242:243] op_sel:[0,1] op_sel_hi:[1,1]
    v_pk_mul_f32 v[26:27], v[26:27], v[242:243] op_sel:[0,1] op_sel_hi:[1,1]
    v_pk_mul_f32 v[28:29], v[28:29], v[242:243] op_sel:[0,1] op_sel_hi:[1,1]
    v_pk_mul_f32 v[30:31], v[30:31], v[242:243] op_sel:[0,1] op_sel_hi:[1,1]
    v_pk_mul_f32 v[32:33], v[32:33], v[212:213]
    v_pk_mul_f32 v[34:35], v[34:35], v[214:215]
    v_pk_mul_f32 v[36:37], v[36:37], v[212:213]
    v_pk_mul_f32 v[38:39], v[38:39], v[214:215]
    v_pk_mul_f32 v[40:41], v[40:41], v[242:243] op_sel:[0,1] op_sel_hi:[1,1]
    v_pk_mul_f32 v[42:43], v[42:43], v[242:243] op_sel:[0,1] op_sel_hi:[1,1]
    v_cvt_pk_bf16_f32 v166, v24, v25
    v_cvt_pk_bf16_f32 v167, v26, v27
    v_cvt_pk_bf16_f32 v170, v28, v29
    v_cvt_pk_bf16_f32 v171, v30, v31
    v_cvt_pk_bf16_f32 v180, v32, v33
    v_cvt_pk_bf16_f32 v181, v34, v35
    v_cvt_pk_bf16_f32 v186, v36, v37
    v_cvt_pk_bf16_f32 v187, v38, v39
    v_cvt_pk_bf16_f32 v168, v40, v41
    v_cvt_pk_bf16_f32 v169, v42, v43
    s_waitcnt lgkmcnt(0)
    s_barrier
L_a_e1:
    ds_read2st64_b64 v[160:163], v9 offset0:0 offset1:1
    ds_read_b64 v[164:165], v9 offset:1024
    ds_read_b64 v[178:179], v9 offset:1536
    ds_read_b64 v[184:185], v9 offset:2048
    v_mfma_f32_16x16x16_bf16 v[128:131], v[174:175], v[234:235], 0
    v_mfma_f32_16x16x16_bf16 v[124:127], v[168:169], v[234:235], 0
    v_pk_mul_f32 v[44:45], v[44:45], v[244:245] op_sel:[0,1] op_sel_hi:[1,1]
    v_pk_mul_f32 v[46:47], v[46:47], v[244:245] op_sel:[0,1] op_sel_hi:[1,1]
    v_pk_mul_f32 v[48:49], v[48:49], v[244:245] op_sel:[0,1] op_sel_hi:[1,1]
    v_pk_mul_f32 v[50:51], v[50:51], v[244:245] op_sel:[0,1] op_sel_hi:[1,1]
    v_pk_mul_f32 v[16:17], v[16:17], v[242:243] op_sel:[0,1] op_sel_hi:[1,1]
    v_pk_mul_f32 v[18:19], v[18:19], v[242:243] op_sel:[0,1] op_sel_hi:[1,1]
    v_pk_mul_f32 v[20:21], v[20:21], v[242:243] op_sel:[0,1] op_sel_hi:[1,1]
    v_pk_mul_f32 v[22:23], v[22:23], v[242:243] op_sel:[0,1] op_sel_hi:[1,1]
    v_cvt_pk_bf16_f32 v112, v44, v45
    v_cvt_pk_bf16_f32 v113, v46, v47
    v_cvt_pk_bf16_f32 v118, v48, v49
    v_cvt_pk_bf16_f32 v119, v50, v51
    v_cvt_pk_bf16_f32 v104, v16, v17
    v_cvt_pk_bf16_f32 v105, v18, v19
    v_cvt_pk_bf16_f32 v110, v20, v21
    v_cvt_pk_bf16_f32 v111, v22, v23
    v_permlane16_swap_b32 v114, v174
    v_permlane16_swap_b32 v117, v175
    v_permlane16_swap_b32 v106, v168
    v_permlane16_swap_b32 v109, v169
    s_waitcnt lgkmcnt(0)
    v_mfma_f32_16x16x16_bf16 v[120:123], v[162:163], v[234:235], 0
    v_mfma_f32_16x16x32_bf16 v[20:23], v[172:175], v[112:115], 0
    v_mfma_f32_16x16x32_bf16 v[16:19], v[166:169], v[112:115], 0
    v_mfma_f32_16x16x32_bf16 v[28:31], v[174:177], v[116:119], 0
    v_mfma_f32_16x16x32_bf16 v[24:27], v[168:171], v[116:119], 0
    v_mfma_f32_16x16x32_bf16 v[36:39], v[166:169], v[104:107], 0
    v_mfma_f32_16x16x32_bf16 v[32:35], v[160:163], v[104:107], 0
    v_mfma_f32_16x16x32_bf16 v[44:47], v[168:171], v[108:111], 0
    v_mfma_f32_16x16x32_bf16 v[40:43], v[162:165], v[108:111], 0
    v_cvt_pk_bf16_f32 v194, v128, v129
    v_cvt_pk_bf16_f32 v195, v130, v131
    v_cvt_pk_bf16_f32 v192, v124, v125
    v_cvt_pk_bf16_f32 v193, v126, v127
    v_cvt_pk_bf16_f32 v190, v120, v121
    v_cvt_pk_bf16_f32 v191, v122, v123
    v_cndmask_b32 v20, v20, v21, s[40:41]
    v_cndmask_b32 v16, v16, v17, s[40:41]
    v_cndmask_b32 v48, v16, v20, s[42:43]
    v_cndmask_b32 v22, v22, v23, s[40:41]
    v_cndmask_b32 v18, v18, v19, s[40:41]
    v_cndmask_b32 v49, v18, v22, s[44:45]
    v_max_f32 v56, v48, v49
    v_cndmask_b32 v28, v28, v29, s[40:41]
    v_cndmask_b32 v24, v24, v25, s[40:41]
    v_cndmask_b32 v50, v24, v28, s[42:43]
    v_cndmask_b32 v30, v30, v31, s[40:41]
    v_cndmask_b32 v26, v26, v27, s[40:41]
    v_cndmask_b32 v51, v26, v30, s[44:45]
    v_max_f32_e64 v57, v50, v51
    v_cndmask_b32 v36, v36, v37, s[40:41]
    v_cndmask_b32 v32, v32, v33, s[40:41]
    v_cndmask_b32 v52, v32, v36, s[42:43]
    v_cndmask_b32 v52, v8, v52, s[48:49]
    v_cndmask_b32 v38, v38, v39, s[40:41]
    v_cndmask_b32 v34, v34, v35, s[40:41]
    v_cndmask_b32 v53, v34, v38, s[44:45]
    v_cndmask_b32 v53, v8, v53, s[38:39]
    v_max_f32 v58, v52, v53
    v_permlane32_swap_b32 v56, v57
    v_max_f32_e64 v56, v56, v57
    v_cndmask_b32 v44, v44, v45, s[40:41]
    v_cndmask_b32 v40, v40, v41, s[40:41]
    v_cndmask_b32 v54, v40, v44, s[42:43]
    v_cndmask_b32 v54, v8, v54, s[48:49]
    v_cndmask_b32 v46, v46, v47, s[40:41]
    v_cndmask_b32 v42, v42, v43, s[40:41]
    v_cndmask_b32 v55, v42, v46, s[44:45]
    v_cndmask_b32 v55, v8, v55, s[38:39]
    v_max_f32 v59, v54, v55
    s_nop 1
    v_permlane32_swap_b32 v58, v59
    v_max_f32 v58, v58, v59
    s_nop 1
    v_permlane16_swap_b32 v56, v58
    v_max_f32 v57, v56, v58
    v_mul_f32 v56, s33, v57
    v_mul_f32 v58, s33, v57
    s_nop 1
    v_permlane16_swap_b32 v56, v58
    v_mov_b32 v57, v56
    v_mov_b32 v59, v58
    s_nop 0
    v_permlane32_swap_b32 v56, v57
    v_permlane32_swap_b32 v58, v59
    v_fma_f32 v48, v48, s33, -v56
    v_fma_f32 v49, v49, s33, -v56
    v_fma_f32 v50, v50, s33, -v57
    v_fma_f32 v51, v51, s33, -v57
    v_fma_f32 v52, v52, s33, -v58
    v_fma_f32 v53, v53, s33, -v58
    v_fma_f32 v54, v54, s33, -v59
    v_fma_f32 v55, v55, s33, -v59
    v_exp_f32 v48, v48
    v_exp_f32 v49, v49
    v_exp_f32 v50, v50
    v_exp_f32 v51, v51
    v_exp_f32 v52, v52
    v_exp_f32 v53, v53
    v_exp_f32 v54, v54
    v_exp_f32 v55, v55
    v_cvt_pk_bf16_f32 v56, v48, v49
    v_cvt_pk_bf16_f32 v57, v50, v51
    v_cvt_pk_bf16_f32 v58, v52, v53
    v_cvt_pk_bf16_f32 v59, v54, v55
    v_perm_b32 v64, v56, v56, v12
    v_perm_b32 v65, v56, v56, v13
    v_perm_b32 v66, v56, v56, v14
    v_perm_b32 v67, v56, v56, v15
    v_perm_b32 v68, v57, v57, v12
    v_perm_b32 v69, v57, v57, v13
    v_perm_b32 v70, v57, v57, v14
    v_perm_b32 v71, v57, v57, v15
    v_perm_b32 v72, v58, v58, v12
    v_perm_b32 v73, v58, v58, v13
    v_perm_b32 v74, v58, v58, v14
    v_perm_b32 v75, v58, v58, v15
    v_perm_b32 v76, v59, v59, v12
    v_perm_b32 v77, v59, v59, v13
    v_perm_b32 v78, v59, v59, v14
    v_perm_b32 v79, v59, v59, v15
    v_mfma_f32_16x16x32_bf16 v[80:83], v[236:239], v[64:67], 0
    v_mfma_f32_16x16x32_bf16 v[84:87], v[236:239], v[68:71], 0
    v_mfma_f32_16x16x32_bf16 v[88:91], v[236:239], v[72:75], 0
    v_mfma_f32_16x16x32_bf16 v[92:95], v[236:239], v[76:79], 0
    v_mfma_f32_16x16x32_bf16 v[16:19], v[180:183], v[64:67], 0
    v_mfma_f32_16x16x32_bf16 v[20:23], v[192:195], v[64:67], 0
    v_mfma_f32_16x16x32_bf16 v[24:27], v[186:189], v[68:71], 0
    v_mfma_f32_16x16x32_bf16 v[28:31], v[192:195], v[68:71], 0
    v_mfma_f32_16x16x32_bf16 v[32:35], v[178:181], v[72:75], 0
    v_mfma_f32_16x16x32_bf16 v[36:39], v[190:193], v[72:75], 0
    v_mfma_f32_16x16x32_bf16 v[40:43], v[184:187], v[76:79], 0
    v_mfma_f32_16x16x32_bf16 v[44:47], v[190:193], v[76:79], 0
    v_rcp_f32 v80, v80
    v_rcp_f32 v84, v84
    v_rcp_f32 v88, v88
    v_rcp_f32 v92, v92
    v_pk_mul_f32 v[16:17], v[16:17], v[80:81] op_sel_hi:[1,0]
    v_pk_mul_f32 v[18:19], v[18:19], v[80:81] op_sel_hi:[1,0]
    v_pk_mul_f32 v[20:21], v[20:21], v[80:81] op_sel_hi:[1,0]
    v_pk_mul_f32 v[24:25], v[24:25], v[84:85] op_sel_hi:[1,0]
    v_pk_mul_f32 v[26:27], v[26:27], v[84:85] op_sel_hi:[1,0]
    v_pk_mul_f32 v[30:31], v[30:31], v[84:85] op_sel_hi:[1,0]
    v_cvt_pk_bf16_f32 v220, v16, v17
    v_cvt_pk_bf16_f32 v221, v18, v19
    v_cvt_pk_bf16_f32 v224, v20, v21
    v_cvt_pk_bf16_f32 v222, v24, v25
    v_cvt_pk_bf16_f32 v223, v26, v27
    v_cvt_pk_bf16_f32 v225, v30, v31
    buffer_store_dwordx4 v[220:223], v5, s[4:7], s35 offen sc1
    buffer_store_dwordx2 v[224:225], v7, s[4:7], s35 offen sc1
    v_pk_mul_f32 v[32:33], v[32:33], v[88:89] op_sel_hi:[1,0]
    v_pk_mul_f32 v[34:35], v[34:35], v[88:89] op_sel_hi:[1,0]
    v_pk_mul_f32 v[36:37], v[36:37], v[88:89] op_sel_hi:[1,0]
    v_pk_mul_f32 v[40:41], v[40:41], v[92:93] op_sel_hi:[1,0]
    v_pk_mul_f32 v[42:43], v[42:43], v[92:93] op_sel_hi:[1,0]
    v_pk_mul_f32 v[46:47], v[46:47], v[92:93] op_sel_hi:[1,0]
    v_cvt_pk_bf16_f32 v228, v32, v33
    v_cvt_pk_bf16_f32 v229, v34, v35
    v_cvt_pk_bf16_f32 v232, v36, v37
    v_cvt_pk_bf16_f32 v230, v40, v41
    v_cvt_pk_bf16_f32 v231, v42, v43
    v_cvt_pk_bf16_f32 v233, v46, v47
    buffer_store_dwordx4 v[228:231], v4, s[4:7], s35 offen sc1
    buffer_store_dwordx2 v[232:233], v6, s[4:7], s35 offen sc1
    s_and_b32 s25, s2, 7
    s_lshr_b32 s26, s2, 3
    s_lshr_b32 s23, s25, 1
    s_lshl_b32 s23, s23, 3
    s_lshr_b32 s27, s26, 2
    s_add_u32 s23, s23, s27
    s_and_b32 s24, s25, 1
    s_lshl_b32 s24, s24, 2
    s_and_b32 s27, s26, 3
    s_add_u32 s24, s24, s27
    s_add_u32 s25, s23, s24
    s_and_b32 s25, s25, 3
    s_lshl_b32 s30, s23, 2
    s_add_u32 s30, s30, s20
    s_mul_i32 s29, s30, 18432
    s_add_u32 s29, s29, s21
    s_add_u32 s29, s29, 0x600000
    s_mul_i32 s34, s30, 18432
    s_add_u32 s34, s34, s21
    s_add_u32 s34, s34, 0x0
    s_lshl_b32 s35, s24, 11
    s_lshr_b32 s36, s24, 2
    s_lshl_b32 s36, s36, 10
    s_and_b32 s37, s24, 3
    s_lshl_b32 s37, s37, 8
    s_add_u32 s36, s36, s37
    s_add_u32 s36, s36, 16384
    v_bfe_u32 v2, v1, 4, 4
    v_lshrrev_b32 v3, 8, v1
    v_add_u32 v4, s35, v1
    v_lshlrev_b32 v5, 4, v2
    v_lshl_add_u32 v5, v3, 3, v5
    v_add_u32_e64 v5, s36, v5
    v_cmp_gt_u32 s[40:41], 2, v3
    v_bfrev_b32 v6, 1
    v_add_u32 v12, 0, v1
    v_add_u32 v13, 36864, v1
    v_add_u32 v14, 73728, v1
    v_add_u32 v15, 110592, v1
    v_cndmask_b32 v5, v6, v5, s[40:41]
    buffer_load_dwordx4 v[208:211], v4, s[4:7], s34 offen offset:0 sc1
    buffer_load_dwordx4 v[212:215], v4, s[4:7], s34 offen offset:1024 sc1
    buffer_load_dwordx2 v[216:217], v5, s[4:7], s34 offen sc1
    s_add_u32 s34, s34, 0x300000
    s_lshl_b32 s39, s30, 10
    s_add_u32 s39, s39, s21
    s_lshl_b32 s42, s24, 7
    s_add_u32 s39, s39, s42
    s_add_u32 s39, s39, 0x1b20000
    v_cmp_eq_u32 vcc, 0, v3
    v_lshlrev_b32 v10, 3, v2
    v_mov_b32 v11, 0x3f803f80
    v_lshl_add_u32 v7, v3, 8, v10
    v_cndmask_b32_e64 v10, v6, v10, vcc
    s_lshr_b32 s44, s23, 1
    s_lshl_b32 s52, s22, 7
    s_add_u32 s52, s52, s44
    s_lshl_b32 s52, s52, 8
    s_add_u32 s52, s52, 0x4508000
    s_add_u32 s52, s52, s4
    s_addc_u32 s53, s5, 0
    s_waitcnt vmcnt(3)
    s_barrier
    s_cmp_lg_u32 s20, 0
    s_cbranch_scc1 L_ns_d2
    s_mov_b32 s56, 1
    s_atomic_add s56, s[50:51], 0
L_ns_d2:
    s_cmp_lg_u32 s20, 0
    s_cbranch_scc1 L_pd_d2
    s_mov_b32 s60, 262144
L_poll_d2:
    s_mov_b32 s57, 0
    s_atomic_add s57, s[52:53], 0 glc
    s_waitcnt lgkmcnt(0)
    s_cmp_ge_u32 s57, 16
    s_cbranch_scc1 L_pd_d2
    s_sub_u32 s60, s60, 1
    s_cbranch_scc1 L_pd_d2
    s_sleep 2
    s_branch L_poll_d2
    s_nop 0
L_pd_d2:
    s_barrier
    s_mov_b32 s32, 0
    s_lshl_b32 s32, s32, 13
    s_add_u32 s32, s32, s29
    s_add_u32 s33, s32, 4096
    buffer_load_dwordx4 v[112:115], v1, s[4:7], s32 offen offset:0 sc1
    buffer_load_dwordx4 v[116:119], v1, s[4:7], s32 offen offset:1024 sc1
    buffer_load_dwordx4 v[120:123], v1, s[4:7], s32 offen offset:2048 sc1
    buffer_load_dwordx4 v[124:127], v1, s[4:7], s32 offen offset:3072 sc1
    buffer_load_dwordx4 v[128:131], v1, s[4:7], s33 offen offset:0 sc1
    buffer_load_dwordx4 v[132:135], v1, s[4:7], s33 offen offset:1024 sc1
    buffer_load_dwordx4 v[136:139], v1, s[4:7], s33 offen offset:2048 sc1
    buffer_load_dwordx4 v[140:143], v1, s[4:7], s33 offen offset:3072 sc1
    ds_read_b128 v[40:43], v12 offset:18432
    ds_read_b128 v[44:47], v12 offset:19456
    ds_read_b128 v[48:51], v12 offset:20480
    ds_read_b128 v[52:55], v12 offset:21504
    ds_read_b128 v[72:75], v12 offset:26624
    ds_read_b128 v[56:59], v12 offset:22528
    ds_read_b128 v[60:63], v12 offset:23552
    ds_read_b128 v[64:67], v12 offset:24576
    ds_read_b128 v[68:71], v12 offset:25600
    s_add_u32 s45, s29, 8192
    s_add_u32 s46, s29, 12288
    s_add_u32 s47, s29, 16384
    buffer_load_dwordx4 v[144:147], v1, s[4:7], s45 offen offset:0 sc1
    buffer_load_dwordx4 v[148:151], v1, s[4:7], s45 offen offset:1024 sc1
    s_lshl_b32 s42, s23, 3
    s_add_u32 s42, s42, s24
    s_lshl_b32 s42, s42, 2
    s_add_u32 s42, s42, s20
    s_lshl_b32 s42, s42, 8
    s_add_u32 s42, s42, s21
    s_add_u32 s42, s42, 0x1b40000
    v_mov_b32 v220, -1.0
    v_lshrrev_b32 v221, 2, v1
    buffer_store_dword v220, v221, s[4:7], s42 offen sc1
    s_lshl_b32 s50, s22, 7
    s_add_u32 s50, s50, s44
    s_lshl_b32 s50, s50, 8
    s_add_u32 s50, s50, 0x4509000
    s_add_u32 s50, s50, s4
    s_addc_u32 s51, s5, 0
    s_waitcnt vmcnt(11)
    v_lshlrev_b32_e64 v16, 16, v208
    v_and_b32 v17, 0xffff0000, v208
    v_lshlrev_b32_e64 v18, 16, v209
    v_and_b32 v19, 0xffff0000, v209
    v_lshlrev_b32_e64 v20, 16, v210
    v_and_b32 v21, 0xffff0000, v210
    v_lshlrev_b32_e64 v22, 16, v211
    v_and_b32 v23, 0xffff0000, v211
    v_lshlrev_b32_e64 v24, 16, v212
    v_and_b32 v25, 0xffff0000, v212
    v_lshlrev_b32_e64 v26, 16, v213
    v_and_b32 v27, 0xffff0000, v213
    v_lshlrev_b32_e64 v28, 16, v214
    v_and_b32 v29, 0xffff0000, v214
    v_lshlrev_b32_e64 v30, 16, v215
    v_and_b32 v31, 0xffff0000, v215
    v_lshlrev_b32_e64 v32, 16, v216
    v_and_b32 v33, 0xffff0000, v216
    v_lshlrev_b32_e64 v34, 16, v217
    v_and_b32 v35, 0xffff0000, v217
    s_waitcnt vmcnt(9) lgkmcnt(4)
    v_mfma_f32_16x16x32_bf16 v[16:19], v[40:43], v[112:115], v[16:19]
    ds_read_b128 v[76:79], v12 offset:27648
    v_mfma_f32_16x16x32_bf16 v[20:23], v[44:47], v[112:115], v[20:23]
    ds_read_b128 v[80:83], v12 offset:28672
    buffer_load_dwordx4 v[152:155], v1, s[4:7], s45 offen offset:2048 sc1
    v_mfma_f32_16x16x32_bf16 v[24:27], v[48:51], v[112:115], v[24:27]
    ds_read_b128 v[84:87], v12 offset:29696
    v_mfma_f32_16x16x32_bf16 v[28:31], v[52:55], v[112:115], v[28:31]
    ds_read_b128 v[88:91], v12 offset:30720
    v_mfma_f32_16x16x32_bf16 v[32:35], v[72:75], v[112:115], v[32:35]
    ds_read_b128 v[108:111], v12 offset:35840
    s_waitcnt lgkmcnt(5)
    buffer_load_dwordx4 v[156:159], v1, s[4:7], s45 offen offset:3072 sc1
    v_mfma_f32_16x16x32_bf16 v[16:19], v[56:59], v[116:119], v[16:19]
    ds_read_b128 v[92:95], v12 offset:31744
    v_mfma_f32_16x16x32_bf16 v[20:23], v[60:63], v[116:119], v[20:23]
    ds_read_b128 v[96:99], v12 offset:32768
    v_mfma_f32_16x16x32_bf16 v[24:27], v[64:67], v[116:119], v[24:27]
    ds_read_b128 v[100:103], v12 offset:33792
    buffer_load_dwordx4 v[160:163], v1, s[4:7], s46 offen offset:0 sc1
    v_mfma_f32_16x16x32_bf16 v[28:31], v[68:71], v[116:119], v[28:31]
    ds_read_b128 v[104:107], v12 offset:34816
    v_mfma_f32_16x16x32_bf16 v[36:39], v[72:75], v[116:119], 0
    s_waitcnt vmcnt(10) lgkmcnt(4)
    v_mfma_f32_16x16x32_bf16 v[16:19], v[76:79], v[120:123], v[16:19]
    ds_read_b128 v[40:43], v13 offset:18432
    v_mfma_f32_16x16x32_bf16 v[20:23], v[80:83], v[120:123], v[20:23]
    ds_read_b128 v[44:47], v13 offset:19456
    buffer_load_dwordx4 v[164:167], v1, s[4:7], s46 offen offset:1024 sc1
    v_mfma_f32_16x16x32_bf16 v[24:27], v[84:87], v[120:123], v[24:27]
    ds_read_b128 v[48:51], v13 offset:20480
    v_mfma_f32_16x16x32_bf16 v[28:31], v[88:91], v[120:123], v[28:31]
    ds_read_b128 v[52:55], v13 offset:21504
    v_mfma_f32_16x16x32_bf16 v[32:35], v[108:111], v[120:123], v[32:35]
    ds_read_b128 v[72:75], v13 offset:26624
    s_waitcnt lgkmcnt(5)
    buffer_load_dwordx4 v[168:171], v1, s[4:7], s46 offen offset:2048 sc1
    v_mfma_f32_16x16x32_bf16 v[16:19], v[92:95], v[124:127], v[16:19]
    ds_read_b128 v[56:59], v13 offset:22528
    v_mfma_f32_16x16x32_bf16 v[20:23], v[96:99], v[124:127], v[20:23]
    ds_read_b128 v[60:63], v13 offset:23552
    v_mfma_f32_16x16x32_bf16 v[24:27], v[100:103], v[124:127], v[24:27]
    ds_read_b128 v[64:67], v13 offset:24576
    buffer_load_dwordx4 v[172:175], v1, s[4:7], s46 offen offset:3072 sc1
    v_mfma_f32_16x16x32_bf16 v[28:31], v[104:107], v[124:127], v[28:31]
    ds_read_b128 v[68:71], v13 offset:25600
    v_mfma_f32_16x16x32_bf16 v[36:39], v[108:111], v[124:127], v[36:39]
    s_waitcnt vmcnt(11) lgkmcnt(4)
    v_mfma_f32_16x16x32_bf16 v[16:19], v[40:43], v[128:131], v[16:19]
    ds_read_b128 v[76:79], v13 offset:27648
    v_mfma_f32_16x16x32_bf16 v[20:23], v[44:47], v[128:131], v[20:23]
    ds_read_b128 v[80:83], v13 offset:28672
    buffer_load_dwordx2 v[176:177], v7, s[4:7], s47 offen offset:0 sc1
    v_mfma_f32_16x16x32_bf16 v[24:27], v[48:51], v[128:131], v[24:27]
    ds_read_b128 v[84:87], v13 offset:29696
    v_mfma_f32_16x16x32_bf16 v[28:31], v[52:55], v[128:131], v[28:31]
    ds_read_b128 v[88:91], v13 offset:30720
    v_mfma_f32_16x16x32_bf16 v[32:35], v[72:75], v[128:131], v[32:35]
    ds_read_b128 v[108:111], v13 offset:35840
    s_waitcnt lgkmcnt(5)
    buffer_load_dwordx2 v[178:179], v7, s[4:7], s47 offen offset:128 sc1
    v_mfma_f32_16x16x32_bf16 v[16:19], v[56:59], v[132:135], v[16:19]
    ds_read_b128 v[92:95], v13 offset:31744
    v_mfma_f32_16x16x32_bf16 v[20:23], v[60:63], v[132:135], v[20:23]
    ds_read_b128 v[96:99], v13 offset:32768
    v_mfma_f32_16x16x32_bf16 v[24:27], v[64:67], v[132:135], v[24:27]
    ds_read_b128 v[100:103], v13 offset:33792
    buffer_load_dwordx2 v[180:181], v7, s[4:7], s47 offen offset:1024 sc1
    v_mfma_f32_16x16x32_bf16 v[28:31], v[68:71], v[132:135], v[28:31]
    ds_read_b128 v[104:107], v13 offset:34816
    v_mfma_f32_16x16x32_bf16 v[36:39], v[72:75], v[132:135], v[36:39]
    s_waitcnt vmcnt(12) lgkmcnt(4)
    v_mfma_f32_16x16x32_bf16 v[16:19], v[76:79], v[136:139], v[16:19]
    ds_read_b128 v[40:43], v14 offset:18432
    v_mfma_f32_16x16x32_bf16 v[20:23], v[80:83], v[136:139], v[20:23]
    ds_read_b128 v[44:47], v14 offset:19456
    buffer_load_dwordx2 v[182:183], v7, s[4:7], s47 offen offset:1152 sc1
    v_mfma_f32_16x16x32_bf16 v[24:27], v[84:87], v[136:139], v[24:27]
    ds_read_b128 v[48:51], v14 offset:20480
    v_mfma_f32_16x16x32_bf16 v[28:31], v[88:91], v[136:139], v[28:31]
    ds_read_b128 v[52:55], v14 offset:21504
    v_mfma_f32_16x16x32_bf16 v[32:35], v[108:111], v[136:139], v[32:35]
    ds_read_b128 v[72:75], v14 offset:26624
    s_waitcnt lgkmcnt(5)
    v_mfma_f32_16x16x32_bf16 v[16:19], v[92:95], v[140:143], v[16:19]
    ds_read_b128 v[56:59], v14 offset:22528
    v_mfma_f32_16x16x32_bf16 v[20:23], v[96:99], v[140:143], v[20:23]
    ds_read_b128 v[60:63], v14 offset:23552
    v_mfma_f32_16x16x32_bf16 v[24:27], v[100:103], v[140:143], v[24:27]
    ds_read_b128 v[64:67], v14 offset:24576
    v_mfma_f32_16x16x32_bf16 v[28:31], v[104:107], v[140:143], v[28:31]
    ds_read_b128 v[68:71], v14 offset:25600
    v_mfma_f32_16x16x32_bf16 v[36:39], v[108:111], v[140:143], v[36:39]
    s_waitcnt vmcnt(11) lgkmcnt(4)
    v_mfma_f32_16x16x32_bf16 v[16:19], v[40:43], v[144:147], v[16:19]
    ds_read_b128 v[76:79], v14 offset:27648
    v_mfma_f32_16x16x32_bf16 v[20:23], v[44:47], v[144:147], v[20:23]
    ds_read_b128 v[80:83], v14 offset:28672
    v_mfma_f32_16x16x32_bf16 v[24:27], v[48:51], v[144:147], v[24:27]
    ds_read_b128 v[84:87], v14 offset:29696
    v_mfma_f32_16x16x32_bf16 v[28:31], v[52:55], v[144:147], v[28:31]
    ds_read_b128 v[88:91], v14 offset:30720
    v_mfma_f32_16x16x32_bf16 v[32:35], v[72:75], v[144:147], v[32:35]
    ds_read_b128 v[108:111], v14 offset:35840
    s_waitcnt lgkmcnt(5)
    v_mfma_f32_16x16x32_bf16 v[16:19], v[56:59], v[148:151], v[16:19]
    ds_read_b128 v[92:95], v14 offset:31744
    v_mfma_f32_16x16x32_bf16 v[20:23], v[60:63], v[148:151], v[20:23]
    ds_read_b128 v[96:99], v14 offset:32768
    v_mfma_f32_16x16x32_bf16 v[24:27], v[64:67], v[148:151], v[24:27]
    ds_read_b128 v[100:103], v14 offset:33792
    v_mfma_f32_16x16x32_bf16 v[28:31], v[68:71], v[148:151], v[28:31]
    ds_read_b128 v[104:107], v14 offset:34816
    v_mfma_f32_16x16x32_bf16 v[36:39], v[72:75], v[148:151], v[36:39]
    s_waitcnt vmcnt(8) lgkmcnt(4)
    v_mfma_f32_16x16x32_bf16 v[16:19], v[76:79], v[152:155], v[16:19]
    ds_read_b128 v[40:43], v15 offset:18432
    v_mfma_f32_16x16x32_bf16 v[20:23], v[80:83], v[152:155], v[20:23]
    ds_read_b128 v[44:47], v15 offset:19456
    v_mfma_f32_16x16x32_bf16 v[24:27], v[84:87], v[152:155], v[24:27]
    ds_read_b128 v[48:51], v15 offset:20480
    v_mfma_f32_16x16x32_bf16 v[28:31], v[88:91], v[152:155], v[28:31]
    ds_read_b128 v[52:55], v15 offset:21504
    v_mfma_f32_16x16x32_bf16 v[32:35], v[108:111], v[152:155], v[32:35]
    ds_read_b128 v[72:75], v15 offset:26624
    s_waitcnt lgkmcnt(5)
    v_mfma_f32_16x16x32_bf16 v[16:19], v[92:95], v[156:159], v[16:19]
    ds_read_b128 v[56:59], v15 offset:22528
    v_mfma_f32_16x16x32_bf16 v[20:23], v[96:99], v[156:159], v[20:23]
    ds_read_b128 v[60:63], v15 offset:23552
    v_mfma_f32_16x16x32_bf16 v[24:27], v[100:103], v[156:159], v[24:27]
    ds_read_b128 v[64:67], v15 offset:24576
    v_mfma_f32_16x16x32_bf16 v[28:31], v[104:107], v[156:159], v[28:31]
    ds_read_b128 v[68:71], v15 offset:25600
    v_mfma_f32_16x16x32_bf16 v[36:39], v[108:111], v[156:159], v[36:39]
    s_waitcnt vmcnt(6) lgkmcnt(4)
    v_mfma_f32_16x16x32_bf16 v[16:19], v[40:43], v[160:163], v[16:19]
    ds_read_b128 v[76:79], v15 offset:27648
    v_mfma_f32_16x16x32_bf16 v[20:23], v[44:47], v[160:163], v[20:23]
    ds_read_b128 v[80:83], v15 offset:28672
    v_mfma_f32_16x16x32_bf16 v[24:27], v[48:51], v[160:163], v[24:27]
    ds_read_b128 v[84:87], v15 offset:29696
    v_mfma_f32_16x16x32_bf16 v[28:31], v[52:55], v[160:163], v[28:31]
    ds_read_b128 v[88:91], v15 offset:30720
    v_mfma_f32_16x16x32_bf16 v[32:35], v[72:75], v[160:163], v[32:35]
    ds_read_b128 v[108:111], v15 offset:35840
    s_waitcnt lgkmcnt(5)
    v_mfma_f32_16x16x32_bf16 v[16:19], v[56:59], v[164:167], v[16:19]
    ds_read_b128 v[92:95], v15 offset:31744
    v_mfma_f32_16x16x32_bf16 v[20:23], v[60:63], v[164:167], v[20:23]
    ds_read_b128 v[96:99], v15 offset:32768
    v_mfma_f32_16x16x32_bf16 v[24:27], v[64:67], v[164:167], v[24:27]
    ds_read_b128 v[100:103], v15 offset:33792
    v_mfma_f32_16x16x32_bf16 v[28:31], v[68:71], v[164:167], v[28:31]
    ds_read_b128 v[104:107], v15 offset:34816
    v_mfma_f32_16x16x32_bf16 v[36:39], v[72:75], v[164:167], v[36:39]
    s_waitcnt vmcnt(4) lgkmcnt(4)
    v_mfma_f32_16x16x32_bf16 v[16:19], v[76:79], v[168:171], v[16:19]
    ds_read_b128 v[40:43], v15 offset:36864
    v_mfma_f32_16x16x32_bf16 v[20:23], v[80:83], v[168:171], v[20:23]
    ds_read_b128 v[44:47], v15 offset:37888
    v_mfma_f32_16x16x32_bf16 v[24:27], v[84:87], v[168:171], v[24:27]
    ds_read_b128 v[48:51], v15 offset:38912
    v_mfma_f32_16x16x32_bf16 v[28:31], v[88:91], v[168:171], v[28:31]
    ds_read_b128 v[52:55], v15 offset:39936
    v_mfma_f32_16x16x32_bf16 v[32:35], v[108:111], v[168:171], v[32:35]
    ds_read_b128 v[72:75], v15 offset:45056
    s_waitcnt lgkmcnt(5)
    v_mfma_f32_16x16x32_bf16 v[16:19], v[92:95], v[172:175], v[16:19]
    ds_read_b128 v[56:59], v15 offset:40960
    v_mfma_f32_16x16x32_bf16 v[20:23], v[96:99], v[172:175], v[20:23]
    ds_read_b128 v[60:63], v15 offset:41984
    v_mfma_f32_16x16x32_bf16 v[24:27], v[100:103], v[172:175], v[24:27]
    ds_read_b128 v[64:67], v15 offset:43008
    v_mfma_f32_16x16x32_bf16 v[28:31], v[104:107], v[172:175], v[28:31]
    ds_read_b128 v[68:71], v15 offset:44032
    v_mfma_f32_16x16x32_bf16 v[36:39], v[108:111], v[172:175], v[36:39]
    s_waitcnt vmcnt(0) lgkmcnt(4)
    v_mfma_f32_16x16x32_bf16 v[16:19], v[40:43], v[176:179], v[16:19]
    v_mfma_f32_16x16x32_bf16 v[20:23], v[44:47], v[176:179], v[20:23]
    v_mfma_f32_16x16x32_bf16 v[24:27], v[48:51], v[176:179], v[24:27]
    v_mfma_f32_16x16x32_bf16 v[28:31], v[52:55], v[176:179], v[28:31]
    v_mfma_f32_16x16x32_bf16 v[32:35], v[72:75], v[176:179], v[32:35]
    s_waitcnt lgkmcnt(0)
    v_mfma_f32_16x16x32_bf16 v[16:19], v[56:59], v[180:183], v[16:19]
    v_mfma_f32_16x16x32_bf16 v[20:23], v[60:63], v[180:183], v[20:23]
    v_mfma_f32_16x16x32_bf16 v[24:27], v[64:67], v[180:183], v[24:27]
    v_mfma_f32_16x16x32_bf16 v[28:31], v[68:71], v[180:183], v[28:31]
    v_mfma_f32_16x16x32_bf16 v[36:39], v[72:75], v[180:183], v[36:39]
    s_nop 3
    v_cvt_pk_bf16_f32 v208, v16, v17
    v_cvt_pk_bf16_f32 v209, v18, v19
    v_cvt_pk_bf16_f32 v210, v20, v21
    v_cvt_pk_bf16_f32 v211, v22, v23
    v_cvt_pk_bf16_f32 v212, v24, v25
    v_cvt_pk_bf16_f32 v213, v26, v27
    v_cvt_pk_bf16_f32 v214, v28, v29
    v_cvt_pk_bf16_f32 v215, v30, v31
    buffer_store_dwordx4 v[208:211], v4, s[4:7], s34 offen offset:0 sc1
    buffer_store_dwordx4 v[212:215], v4, s[4:7], s34 offen offset:1024 sc1
    v_permlane32_swap_b32 v36, v220
    v_permlane32_swap_b32 v37, v221
    v_permlane32_swap_b32 v38, v222
    v_permlane32_swap_b32 v39, v223
    v_pk_add_f32 v[32:33], v[32:33], v[220:221]
    v_pk_add_f32 v[34:35], v[34:35], v[222:223]
    v_cvt_pk_bf16_f32 v216, v32, v33
    v_cvt_pk_bf16_f32 v217, v34, v35
    buffer_store_dwordx2 v[216:217], v5, s[4:7], s34 offen sc1
    v_cndmask_b32 v222, 0, v216, s[40:41]
    v_cndmask_b32 v223, 0, v217, s[40:41]
    v_dot2_f32_bf16 v220, v208, v11, 0
    v_dot2_f32_bf16 v221, v208, v208, 0
    v_dot2_f32_bf16 v224, v209, v11, 0
    v_dot2_f32_bf16 v225, v209, v209, 0
    v_dot2_f32_bf16 v220, v210, v11, v220
    v_dot2_f32_bf16 v221, v210, v210, v221
    v_dot2_f32_bf16 v224, v211, v11, v224
    v_dot2_f32_bf16 v225, v211, v211, v225
    v_dot2_f32_bf16 v220, v212, v11, v220
    v_dot2_f32_bf16 v221, v212, v212, v221
    v_dot2_f32_bf16 v224, v213, v11, v224
    v_dot2_f32_bf16 v225, v213, v213, v225
    v_dot2_f32_bf16 v220, v214, v11, v220
    v_dot2_f32_bf16 v221, v214, v214, v221
    v_dot2_f32_bf16 v224, v215, v11, v224
    v_dot2_f32_bf16 v225, v215, v215, v225
    v_dot2_f32_bf16 v220, v222, v11, v220
    v_dot2_f32_bf16 v221, v222, v222, v221
    v_dot2_f32_bf16 v224, v223, v11, v224
    v_dot2_f32_bf16 v225, v223, v223, v225
    s_nop 2
    v_pk_add_f32 v[220:221], v[220:221], v[224:225]
    v_mov_b32 v222, v220
    v_mov_b32 v223, v221
    s_nop 1
    v_permlane32_swap_b32 v220, v222
    v_permlane32_swap_b32 v221, v223
    v_add_f32 v220, v220, v222
    v_add_f32 v221, v221, v223
    v_mov_b32 v222, v220
    v_mov_b32 v223, v221
    s_nop 1
    v_permlane16_swap_b32 v220, v222
    v_permlane16_swap_b32 v221, v223
    v_add_f32 v220, v220, v222
    v_add_f32 v221, v221, v223
    buffer_store_dwordx2 v[220:221], v10, s[4:7], s39 offen sc1
    s_and_b32 s25, s2, 7
    s_lshr_b32 s26, s2, 3
    s_and_b32 s23, s25, 1
    s_lshl_b32 s23, s23, 3
    s_and_b32 s27, s26, 7
    s_add_u32 s23, s23, s27
    s_lshr_b32 s24, s25, 1
    s_lshl_b32 s24, s24, 2
    s_lshr_b32 s27, s26, 3
    s_add_u32 s24, s24, s27
    s_add_u32 s28, s23, s24
    s_and_b32 s28, s28, 3
    s_lshl_b32 s30, s20, 12
    s_lshl_b32 s31, s23, 3
    s_lshl_b32 s33, s20, 1
    s_add_u32 s31, s31, s33
    s_lshl_b32 s32, s31, 10
    s_add_u32 s32, s32, s21
    s_add_u32 s32, s32, 0x1b20000
    v_add_u32 v2, 73728, v1
    s_add_u32 s33, s30, 18432
    v_add_u32 v3, s33, v1
    v_add_u32_e64 v0, s33, v2
    s_lshr_b32 s34, s31, 1
    s_lshl_b32 s35, s34, 12
    s_add_u32 s35, s35, s21
    s_add_u32 s35, s35, 0x1b40000
    s_lshl_b32 s36, s24, 8
    s_add_u32 s36, s36, s35
    s_lshl_b32 s38, s24, 6
    s_add_u32 s38, s38, s34
    s_mul_i32 s38, s38, 9216
    s_add_u32 s38, s38, s21
    s_add_u32 s38, s38, 0x900000
    s_add_u32 s39, s38, 4096
    s_add_u32 s46, s38, 8192
    s_mov_b32 s40, 0xc0135761
    s_mov_b32 s42, 0x3d372713
    s_mov_b32 s44, 0x39e38e39
    s_mov_b32 s45, 0x3727c5ac
    v_lshrrev_b32_e64 v4, 1, v1
    s_lshl_b32 s52, s22, 7
    s_add_u32 s52, s52, s23
    s_lshl_b32 s52, s52, 8
    s_add_u32 s52, s52, 0x4509000
    s_add_u32 s52, s52, s4
    s_addc_u32 s53, s5, 0
    s_waitcnt vmcnt(0)
    s_barrier
    s_cmp_lg_u32 s20, 0
    s_cbranch_scc1 L_ns_d3
    s_mov_b32 s56, 1
    s_atomic_add s56, s[50:51], 0
L_ns_d3:
    s_cmp_lg_u32 s20, 0
    s_cbranch_scc1 L_pd_d3
    s_mov_b32 s60, 262144
L_poll_d3:
    s_mov_b32 s57, 0
    s_atomic_add s57, s[52:53], 0 glc
    s_waitcnt lgkmcnt(0)
    s_cmp_ge_u32 s57, 16
    s_cbranch_scc1 L_pd_d3
    s_sub_u32 s60, s60, 1
    s_cbranch_scc1 L_pd_d3
    s_sleep 2
    s_branch L_poll_d3
L_pd_d3:
    s_barrier
    buffer_load_dwordx2 v[8:9], v4, s[4:7], s32 offen offset:0 sc1
    buffer_load_dwordx2 v[10:11], v4, s[4:7], s32 offen offset:512 sc1
    buffer_load_dwordx2 v[12:13], v4, s[4:7], s32 offen offset:1024 sc1
    buffer_load_dwordx2 v[14:15], v4, s[4:7], s32 offen offset:1536 sc1
    s_lshl_b32 s50, s22, 7
    s_add_u32 s50, s50, s23
    s_lshl_b32 s50, s50, 8
    s_add_u32 s50, s50, 0x450a000
    s_add_u32 s50, s50, s4
    s_addc_u32 s51, s5, 0
    s_barrier
    ds_read_b128 v[160:163], v3 offset:0
    ds_read_b128 v[164:167], v3 offset:2048
    ds_read_b128 v[168:171], v1 offset:0
    ds_read_b128 v[172:175], v1 offset:1024
    ds_read_b128 v[176:179], v1 offset:2048
    ds_read_b128 v[180:183], v1 offset:3072
    ds_read_b128 v[184:187], v1 offset:4096
    ds_read_b128 v[188:191], v1 offset:5120
    ds_read_b128 v[192:195], v1 offset:6144
    ds_read_b128 v[196:199], v1 offset:7168
    ds_read_b128 v[200:203], v1 offset:8192
    s_waitcnt lgkmcnt(5)
    v_mfma_f32_16x16x32_bf16 v[16:19], v[160:163], v[168:171], 0
    ds_read_b128 v[204:207], v3 offset:1024
    v_mfma_f32_16x16x32_bf16 v[20:23], v[164:167], v[168:171], 0
    ds_read_b128 v[208:211], v3 offset:3072
    v_mfma_f32_16x16x32_bf16 v[24:27], v[160:163], v[172:175], 0
    ds_read_b128 v[212:215], v1 offset:9216
    v_mfma_f32_16x16x32_bf16 v[28:31], v[164:167], v[172:175], 0
    ds_read_b128 v[216:219], v1 offset:10240
    v_mfma_f32_16x16x32_bf16 v[32:35], v[160:163], v[176:179], 0
    ds_read_b128 v[220:223], v1 offset:11264
    v_mfma_f32_16x16x32_bf16 v[36:39], v[164:167], v[176:179], 0
    ds_read_b128 v[224:227], v1 offset:12288
    v_mfma_f32_16x16x32_bf16 v[40:43], v[160:163], v[180:183], 0
    ds_read_b128 v[228:231], v1 offset:13312
    v_mfma_f32_16x16x32_bf16 v[44:47], v[164:167], v[180:183], 0
    ds_read_b128 v[232:235], v1 offset:14336
    s_waitcnt lgkmcnt(8)
    v_mfma_f32_16x16x32_bf16 v[48:51], v[160:163], v[184:187], 0
    ds_read_b128 v[236:239], v1 offset:15360
    v_mfma_f32_16x16x32_bf16 v[52:55], v[164:167], v[184:187], 0
    ds_read_b128 v[240:243], v1 offset:16384
    v_mfma_f32_16x16x32_bf16 v[56:59], v[160:163], v[188:191], 0
    ds_read_b128 v[244:247], v1 offset:17408
    v_mfma_f32_16x16x32_bf16 v[60:63], v[164:167], v[188:191], 0
    v_mfma_f32_16x16x32_bf16 v[64:67], v[160:163], v[192:195], 0
    v_mfma_f32_16x16x32_bf16 v[68:71], v[164:167], v[192:195], 0
    v_mfma_f32_16x16x32_bf16 v[72:75], v[160:163], v[196:199], 0
    v_mfma_f32_16x16x32_bf16 v[76:79], v[164:167], v[196:199], 0
    v_mfma_f32_16x16x32_bf16 v[80:83], v[160:163], v[200:203], 0
    v_mfma_f32_16x16x32_bf16 v[84:87], v[164:167], v[200:203], 0
    s_waitcnt lgkmcnt(0)
    s_barrier
    v_mfma_f32_16x16x32_bf16 v[16:19], v[204:207], v[212:215], v[16:19]
    ds_read_b128 v[160:163], v3 offset:36864
    v_mfma_f32_16x16x32_bf16 v[20:23], v[208:211], v[212:215], v[20:23]
    ds_read_b128 v[164:167], v3 offset:38912
    v_mfma_f32_16x16x32_bf16 v[24:27], v[204:207], v[216:219], v[24:27]
    ds_read_b128 v[168:171], v1 offset:36864
    v_mfma_f32_16x16x32_bf16 v[28:31], v[208:211], v[216:219], v[28:31]
    ds_read_b128 v[172:175], v1 offset:37888
    v_mfma_f32_16x16x32_bf16 v[32:35], v[204:207], v[220:223], v[32:35]
    ds_read_b128 v[176:179], v1 offset:38912
    v_mfma_f32_16x16x32_bf16 v[36:39], v[208:211], v[220:223], v[36:39]
    ds_read_b128 v[180:183], v1 offset:39936
    v_mfma_f32_16x16x32_bf16 v[40:43], v[204:207], v[224:227], v[40:43]
    ds_read_b128 v[184:187], v1 offset:40960
    v_mfma_f32_16x16x32_bf16 v[44:47], v[208:211], v[224:227], v[44:47]
    ds_read_b128 v[188:191], v1 offset:41984
    v_mfma_f32_16x16x32_bf16 v[48:51], v[204:207], v[228:231], v[48:51]
    ds_read_b128 v[192:195], v1 offset:43008
    v_mfma_f32_16x16x32_bf16 v[52:55], v[208:211], v[228:231], v[52:55]
    ds_read_b128 v[196:199], v1 offset:44032
    v_lshrrev_b32_e64 v5, 8, v1
    v_mfma_f32_16x16x32_bf16 v[56:59], v[204:207], v[232:235], v[56:59]
    ds_read_b128 v[200:203], v1 offset:45056
    v_bfe_u32 v6, v1, 4, 4
    v_mfma_f32_16x16x32_bf16 v[60:63], v[208:211], v[232:235], v[60:63]
    v_lshlrev_b32_e64 v7, 2, v6
    v_mfma_f32_16x16x32_bf16 v[64:67], v[204:207], v[236:239], v[64:67]
    s_lshl_b32 s33, s20, 8
    v_mfma_f32_16x16x32_bf16 v[68:71], v[208:211], v[236:239], v[68:71]
    s_add_u32 s33, s33, 147456
    v_mfma_f32_16x16x32_bf16 v[72:75], v[204:207], v[240:243], v[72:75]
    v_add_u32 v4, s33, v7
    v_mfma_f32_16x16x32_bf16 v[76:79], v[208:211], v[240:243], v[76:79]
    v_lshl_add_u32 v252, v5, 4, s33
    v_mfma_f32_16x16x32_bf16 v[80:83], v[204:207], v[244:247], v[80:83]
    v_add_u32 v7, 159744, v7
    v_mfma_f32_16x16x32_bf16 v[84:87], v[208:211], v[244:247], v[84:87]
    s_waitcnt vmcnt(0)
    v_add_f32_e64 v248, v8, v10
    s_waitcnt lgkmcnt(5)
    v_mfma_f32_16x16x32_bf16 v[16:19], v[160:163], v[168:171], v[16:19]
    ds_read_b128 v[204:207], v3 offset:37888
    v_mfma_f32_16x16x32_bf16 v[20:23], v[164:167], v[168:171], v[20:23]
    ds_read_b128 v[208:211], v3 offset:39936
    v_mfma_f32_16x16x32_bf16 v[24:27], v[160:163], v[172:175], v[24:27]
    ds_read_b128 v[212:215], v1 offset:46080
    v_mfma_f32_16x16x32_bf16 v[28:31], v[164:167], v[172:175], v[28:31]
    ds_read_b128 v[216:219], v1 offset:47104
    v_mfma_f32_16x16x32_bf16 v[32:35], v[160:163], v[176:179], v[32:35]
    ds_read_b128 v[220:223], v1 offset:48128
    v_mfma_f32_16x16x32_bf16 v[36:39], v[164:167], v[176:179], v[36:39]
    ds_read_b128 v[224:227], v1 offset:49152
    v_mfma_f32_16x16x32_bf16 v[40:43], v[160:163], v[180:183], v[40:43]
    ds_read_b128 v[228:231], v1 offset:50176
    v_mfma_f32_16x16x32_bf16 v[44:47], v[164:167], v[180:183], v[44:47]
    ds_read_b128 v[232:235], v1 offset:51200
    s_waitcnt lgkmcnt(8)
    v_mfma_f32_16x16x32_bf16 v[48:51], v[160:163], v[184:187], v[48:51]
    ds_read_b128 v[236:239], v1 offset:52224
    v_mfma_f32_16x16x32_bf16 v[52:55], v[164:167], v[184:187], v[52:55]
    ds_read_b128 v[240:243], v1 offset:53248
    v_add_f32 v249, v9, v11
    v_mfma_f32_16x16x32_bf16 v[56:59], v[160:163], v[188:191], v[56:59]
    ds_read_b128 v[244:247], v1 offset:54272
    v_add_f32_e64 v250, v12, v14
    v_mfma_f32_16x16x32_bf16 v[60:63], v[164:167], v[188:191], v[60:63]
    v_add_f32_e64 v251, v13, v15
    v_mfma_f32_16x16x32_bf16 v[64:67], v[160:163], v[192:195], v[64:67]
    v_mov_b32_e64 v8, v248
    v_mfma_f32_16x16x32_bf16 v[68:71], v[164:167], v[192:195], v[68:71]
    v_mov_b32_e64 v9, v249
    v_mfma_f32_16x16x32_bf16 v[72:75], v[160:163], v[196:199], v[72:75]
    v_mov_b32_e64 v12, v250
    v_mfma_f32_16x16x32_bf16 v[76:79], v[164:167], v[196:199], v[76:79]
    v_mov_b32_e64 v13, v251
    v_mfma_f32_16x16x32_bf16 v[80:83], v[160:163], v[200:203], v[80:83]
    v_permlane32_swap_b32 v248, v8
    v_mfma_f32_16x16x32_bf16 v[84:87], v[164:167], v[200:203], v[84:87]
    v_permlane32_swap_b32 v249, v9
    v_permlane32_swap_b32 v250, v12
    s_waitcnt lgkmcnt(0)
    s_barrier
    v_mfma_f32_16x16x32_bf16 v[16:19], v[204:207], v[212:215], v[16:19]
    ds_read_b128 v[160:163], v0 offset:0
    v_mfma_f32_16x16x32_bf16 v[20:23], v[208:211], v[212:215], v[20:23]
    ds_read_b128 v[164:167], v0 offset:2048
    v_mfma_f32_16x16x32_bf16 v[24:27], v[204:207], v[216:219], v[24:27]
    ds_read_b128 v[168:171], v2 offset:0
    v_mfma_f32_16x16x32_bf16 v[28:31], v[208:211], v[216:219], v[28:31]
    ds_read_b128 v[172:175], v2 offset:1024
    v_mfma_f32_16x16x32_bf16 v[32:35], v[204:207], v[220:223], v[32:35]
    ds_read_b128 v[176:179], v2 offset:2048
    v_mfma_f32_16x16x32_bf16 v[36:39], v[208:211], v[220:223], v[36:39]
    ds_read_b128 v[180:183], v2 offset:3072
    v_mfma_f32_16x16x32_bf16 v[40:43], v[204:207], v[224:227], v[40:43]
    ds_read_b128 v[184:187], v2 offset:4096
    v_mfma_f32_16x16x32_bf16 v[44:47], v[208:211], v[224:227], v[44:47]
    ds_read_b128 v[188:191], v2 offset:5120
    v_mfma_f32_16x16x32_bf16 v[48:51], v[204:207], v[228:231], v[48:51]
    ds_read_b128 v[192:195], v2 offset:6144
    v_mfma_f32_16x16x32_bf16 v[52:55], v[208:211], v[228:231], v[52:55]
    ds_read_b128 v[196:199], v2 offset:7168
    v_permlane32_swap_b32 v251, v13
    v_mfma_f32_16x16x32_bf16 v[56:59], v[204:207], v[232:235], v[56:59]
    ds_read_b128 v[200:203], v2 offset:8192
    v_add_f32_e64 v248, v248, v8
    v_mfma_f32_16x16x32_bf16 v[60:63], v[208:211], v[232:235], v[60:63]
    ds_read2_b32 v[128:129], v7 offset0:0 offset1:16
    v_add_f32_e64 v249, v249, v9
    v_mfma_f32_16x16x32_bf16 v[64:67], v[204:207], v[236:239], v[64:67]
    ds_read2_b32 v[130:131], v7 offset0:32 offset1:48
    v_add_f32_e64 v250, v250, v12
    v_mfma_f32_16x16x32_bf16 v[68:71], v[208:211], v[236:239], v[68:71]
    ds_read2_b32 v[132:133], v7 offset0:64 offset1:80
    v_add_f32_e64 v251, v251, v13
    v_mfma_f32_16x16x32_bf16 v[72:75], v[204:207], v[240:243], v[72:75]
    ds_read2_b32 v[134:135], v7 offset0:96 offset1:112
    v_mov_b32_e64 v8, v248
    v_mfma_f32_16x16x32_bf16 v[76:79], v[208:211], v[240:243], v[76:79]
    ds_read2_b32 v[136:137], v7 offset0:128 offset1:144
    v_mov_b32_e64 v9, v249
    v_mfma_f32_16x16x32_bf16 v[80:83], v[204:207], v[244:247], v[80:83]
    v_mov_b32_e64 v12, v250
    v_mfma_f32_16x16x32_bf16 v[84:87], v[208:211], v[244:247], v[84:87]
    v_mov_b32_e64 v13, v251
    v_permlane16_swap_b32 v248, v8
    s_waitcnt lgkmcnt(10)
    v_mfma_f32_16x16x32_bf16 v[16:19], v[160:163], v[168:171], v[16:19]
    ds_read_b128 v[204:207], v0 offset:1024
    v_mfma_f32_16x16x32_bf16 v[20:23], v[164:167], v[168:171], v[20:23]
    ds_read_b128 v[208:211], v0 offset:3072
    v_mfma_f32_16x16x32_bf16 v[24:27], v[160:163], v[172:175], v[24:27]
    ds_read_b128 v[212:215], v2 offset:9216
    v_mfma_f32_16x16x32_bf16 v[28:31], v[164:167], v[172:175], v[28:31]
    ds_read_b128 v[216:219], v2 offset:10240
    v_mfma_f32_16x16x32_bf16 v[32:35], v[160:163], v[176:179], v[32:35]
    ds_read_b128 v[220:223], v2 offset:11264
    v_mfma_f32_16x16x32_bf16 v[36:39], v[164:167], v[176:179], v[36:39]
    ds_read_b128 v[224:227], v2 offset:12288
    v_mfma_f32_16x16x32_bf16 v[40:43], v[160:163], v[180:183], v[40:43]
    ds_read_b128 v[228:231], v2 offset:13312
    v_mfma_f32_16x16x32_bf16 v[44:47], v[164:167], v[180:183], v[44:47]
    ds_read_b128 v[232:235], v2 offset:14336
    s_waitcnt lgkmcnt(8)
    v_mfma_f32_16x16x32_bf16 v[48:51], v[160:163], v[184:187], v[48:51]
    ds_read_b128 v[236:239], v2 offset:15360
    v_mfma_f32_16x16x32_bf16 v[52:55], v[164:167], v[184:187], v[52:55]
    ds_read_b128 v[240:243], v2 offset:16384
    v_permlane16_swap_b32 v249, v9
    v_mfma_f32_16x16x32_bf16 v[56:59], v[160:163], v[188:191], v[56:59]
    ds_read_b128 v[244:247], v2 offset:17408
    v_permlane16_swap_b32 v250, v12
    v_mfma_f32_16x16x32_bf16 v[60:63], v[164:167], v[188:191], v[60:63]
    v_permlane16_swap_b32 v251, v13
    v_mfma_f32_16x16x32_bf16 v[64:67], v[160:163], v[192:195], v[64:67]
    v_add_f32_e64 v248, v248, v8
    v_mfma_f32_16x16x32_bf16 v[68:71], v[164:167], v[192:195], v[68:71]
    v_add_f32_e64 v249, v249, v9
    v_mfma_f32_16x16x32_bf16 v[72:75], v[160:163], v[196:199], v[72:75]
    v_add_f32_e64 v250, v250, v12
    v_mfma_f32_16x16x32_bf16 v[76:79], v[164:167], v[196:199], v[76:79]
    v_add_f32_e64 v251, v251, v13
    v_mfma_f32_16x16x32_bf16 v[80:83], v[160:163], v[200:203], v[80:83]
    v_mul_f32 v248, 0x3ae38e39, v248
    v_mfma_f32_16x16x32_bf16 v[84:87], v[164:167], v[200:203], v[84:87]
    v_mul_f32 v249, 0x3ae38e39, v249
    v_mul_f32 v250, 0x3ae38e39, v250
    s_waitcnt lgkmcnt(0)
    s_barrier
    v_mfma_f32_16x16x32_bf16 v[16:19], v[204:207], v[212:215], v[16:19]
    ds_read_b128 v[160:163], v0 offset:36864
    v_mfma_f32_16x16x32_bf16 v[20:23], v[208:211], v[212:215], v[20:23]
    ds_read_b128 v[164:167], v0 offset:38912
    v_mfma_f32_16x16x32_bf16 v[24:27], v[204:207], v[216:219], v[24:27]
    ds_read_b128 v[168:171], v2 offset:36864
    v_mfma_f32_16x16x32_bf16 v[28:31], v[208:211], v[216:219], v[28:31]
    ds_read_b128 v[172:175], v2 offset:37888
    v_mfma_f32_16x16x32_bf16 v[32:35], v[204:207], v[220:223], v[32:35]
    ds_read_b128 v[176:179], v2 offset:38912
    v_mfma_f32_16x16x32_bf16 v[36:39], v[208:211], v[220:223], v[36:39]
    ds_read_b128 v[180:183], v2 offset:39936
    v_mfma_f32_16x16x32_bf16 v[40:43], v[204:207], v[224:227], v[40:43]
    ds_read_b128 v[184:187], v2 offset:40960
    v_mfma_f32_16x16x32_bf16 v[44:47], v[208:211], v[224:227], v[44:47]
    ds_read_b128 v[188:191], v2 offset:41984
    v_mfma_f32_16x16x32_bf16 v[48:51], v[204:207], v[228:231], v[48:51]
    ds_read_b128 v[192:195], v2 offset:43008
    v_mfma_f32_16x16x32_bf16 v[52:55], v[208:211], v[228:231], v[52:55]
    ds_read_b128 v[196:199], v2 offset:44032
    v_mul_f32 v251, 0x3ae38e39, v251
    v_mfma_f32_16x16x32_bf16 v[56:59], v[204:207], v[232:235], v[56:59]
    ds_read_b128 v[200:203], v2 offset:45056
    v_fma_f32 v249, -v248, v248, v249
    v_mfma_f32_16x16x32_bf16 v[60:63], v[208:211], v[232:235], v[60:63]
    v_fma_f32 v251, -v250, v250, v251
    v_mfma_f32_16x16x32_bf16 v[64:67], v[204:207], v[236:239], v[64:67]
    v_max_f32_e64 v249, 0, v249
    v_mfma_f32_16x16x32_bf16 v[68:71], v[208:211], v[236:239], v[68:71]
    v_max_f32_e64 v251, 0, v251
    v_mfma_f32_16x16x32_bf16 v[72:75], v[204:207], v[240:243], v[72:75]
    v_add_f32 v249, 0x3727c5ac, v249
    v_mfma_f32_16x16x32_bf16 v[76:79], v[208:211], v[240:243], v[76:79]
    v_add_f32 v251, 0x3727c5ac, v251
    v_mfma_f32_16x16x32_bf16 v[80:83], v[204:207], v[244:247], v[80:83]
    v_rsq_f32_e64 v249, v249
    v_mfma_f32_16x16x32_bf16 v[84:87], v[208:211], v[244:247], v[84:87]
    v_rsq_f32_e64 v251, v251
    s_nop 0
    s_waitcnt lgkmcnt(5)
    v_mfma_f32_16x16x32_bf16 v[16:19], v[160:163], v[168:171], v[16:19]
    ds_read_b128 v[204:207], v0 offset:37888
    v_mfma_f32_16x16x32_bf16 v[20:23], v[164:167], v[168:171], v[20:23]
    ds_read_b128 v[208:211], v0 offset:39936
    v_mfma_f32_16x16x32_bf16 v[24:27], v[160:163], v[172:175], v[24:27]
    ds_read_b128 v[212:215], v2 offset:46080
    v_mfma_f32_16x16x32_bf16 v[28:31], v[164:167], v[172:175], v[28:31]
    ds_read_b128 v[216:219], v2 offset:47104
    v_mfma_f32_16x16x32_bf16 v[32:35], v[160:163], v[176:179], v[32:35]
    ds_read_b128 v[220:223], v2 offset:48128
    v_mfma_f32_16x16x32_bf16 v[36:39], v[164:167], v[176:179], v[36:39]
    ds_read_b128 v[224:227], v2 offset:49152
    v_mfma_f32_16x16x32_bf16 v[40:43], v[160:163], v[180:183], v[40:43]
    ds_read_b128 v[228:231], v2 offset:50176
    v_mfma_f32_16x16x32_bf16 v[44:47], v[164:167], v[180:183], v[44:47]
    ds_read_b128 v[232:235], v2 offset:51200
    s_waitcnt lgkmcnt(8)
    v_mfma_f32_16x16x32_bf16 v[48:51], v[160:163], v[184:187], v[48:51]
    ds_read_b128 v[236:239], v2 offset:52224
    v_mfma_f32_16x16x32_bf16 v[52:55], v[164:167], v[184:187], v[52:55]
    ds_read_b128 v[240:243], v2 offset:53248
    v_mfma_f32_16x16x32_bf16 v[56:59], v[160:163], v[188:191], v[56:59]
    ds_read_b128 v[244:247], v2 offset:54272
    v_mfma_f32_16x16x32_bf16 v[60:63], v[164:167], v[188:191], v[60:63]
    v_mfma_f32_16x16x32_bf16 v[64:67], v[160:163], v[192:195], v[64:67]
    v_mfma_f32_16x16x32_bf16 v[68:71], v[164:167], v[192:195], v[68:71]
    v_mfma_f32_16x16x32_bf16 v[72:75], v[160:163], v[196:199], v[72:75]
    v_mfma_f32_16x16x32_bf16 v[76:79], v[164:167], v[196:199], v[76:79]
    v_mfma_f32_16x16x32_bf16 v[80:83], v[160:163], v[200:203], v[80:83]
    v_mfma_f32_16x16x32_bf16 v[84:87], v[164:167], v[200:203], v[84:87]
    s_waitcnt lgkmcnt(0)
    s_barrier
    v_mfma_f32_16x16x32_bf16 v[16:19], v[204:207], v[212:215], v[16:19]
    ds_read_b128 v[160:163], v3 offset:0
    v_mfma_f32_16x16x32_bf16 v[20:23], v[208:211], v[212:215], v[20:23]
    ds_read_b128 v[164:167], v3 offset:2048
    v_mfma_f32_16x16x32_bf16 v[24:27], v[204:207], v[216:219], v[24:27]
    ds_read_b128 v[168:171], v1 offset:0
    v_mfma_f32_16x16x32_bf16 v[28:31], v[208:211], v[216:219], v[28:31]
    ds_read_b128 v[172:175], v1 offset:1024
    v_mfma_f32_16x16x32_bf16 v[32:35], v[204:207], v[220:223], v[32:35]
    ds_read_b128 v[176:179], v1 offset:2048
    v_mfma_f32_16x16x32_bf16 v[36:39], v[208:211], v[220:223], v[36:39]
    ds_read_b128 v[180:183], v1 offset:3072
    v_mfma_f32_16x16x32_bf16 v[40:43], v[204:207], v[224:227], v[40:43]
    ds_read_b128 v[184:187], v1 offset:4096
    v_mfma_f32_16x16x32_bf16 v[44:47], v[208:211], v[224:227], v[44:47]
    ds_read_b128 v[188:191], v1 offset:5120
    v_mfma_f32_16x16x32_bf16 v[48:51], v[204:207], v[228:231], v[48:51]
    ds_read_b128 v[192:195], v1 offset:6144
    v_mfma_f32_16x16x32_bf16 v[52:55], v[208:211], v[228:231], v[52:55]
    ds_read_b128 v[196:199], v1 offset:7168
    v_mfma_f32_16x16x32_bf16 v[56:59], v[204:207], v[232:235], v[56:59]
    ds_read_b128 v[200:203], v1 offset:8192
    v_mfma_f32_16x16x32_bf16 v[60:63], v[208:211], v[232:235], v[60:63]
    ds_write2_b32 v4, v248, v249 offset0:0 offset1:32
    v_mfma_f32_16x16x32_bf16 v[64:67], v[204:207], v[236:239], v[64:67]
    ds_write2_b32 v4, v250, v251 offset0:16 offset1:48
    v_mfma_f32_16x16x32_bf16 v[68:71], v[208:211], v[236:239], v[68:71]
    ds_read_b128 v[88:91], v252 offset:0
    v_mfma_f32_16x16x32_bf16 v[72:75], v[204:207], v[240:243], v[72:75]
    ds_read_b128 v[92:95], v252 offset:64
    v_mfma_f32_16x16x32_bf16 v[76:79], v[208:211], v[240:243], v[76:79]
    ds_read_b128 v[96:99], v252 offset:128
    v_mfma_f32_16x16x32_bf16 v[80:83], v[204:207], v[244:247], v[80:83]
    ds_read_b128 v[100:103], v252 offset:192
    v_mfma_f32_16x16x32_bf16 v[84:87], v[208:211], v[244:247], v[84:87]
    s_waitcnt lgkmcnt(11)
    v_mfma_f32_16x16x32_bf16 v[16:19], v[160:163], v[168:171], v[16:19]
    ds_read_b128 v[204:207], v3 offset:1024
    v_mfma_f32_16x16x32_bf16 v[20:23], v[164:167], v[168:171], v[20:23]
    ds_read_b128 v[208:211], v3 offset:3072
    v_mfma_f32_16x16x32_bf16 v[24:27], v[160:163], v[172:175], v[24:27]
    ds_read_b128 v[212:215], v1 offset:9216
    v_mfma_f32_16x16x32_bf16 v[28:31], v[164:167], v[172:175], v[28:31]
    ds_read_b128 v[216:219], v1 offset:10240
    v_mfma_f32_16x16x32_bf16 v[32:35], v[160:163], v[176:179], v[32:35]
    ds_read_b128 v[220:223], v1 offset:11264
    v_mfma_f32_16x16x32_bf16 v[36:39], v[164:167], v[176:179], v[36:39]
    ds_read_b128 v[224:227], v1 offset:12288
    v_mfma_f32_16x16x32_bf16 v[40:43], v[160:163], v[180:183], v[40:43]
    ds_read_b128 v[228:231], v1 offset:13312
    v_mfma_f32_16x16x32_bf16 v[44:47], v[164:167], v[180:183], v[44:47]
    ds_read_b128 v[232:235], v1 offset:14336
    s_waitcnt lgkmcnt(8)
    v_mfma_f32_16x16x32_bf16 v[48:51], v[160:163], v[184:187], v[48:51]
    ds_read_b128 v[236:239], v1 offset:15360
    v_mfma_f32_16x16x32_bf16 v[52:55], v[164:167], v[184:187], v[52:55]
    ds_read_b128 v[240:243], v1 offset:16384
    v_rcp_f32 v120, v96
    v_mfma_f32_16x16x32_bf16 v[56:59], v[160:163], v[188:191], v[56:59]
    ds_read_b128 v[244:247], v1 offset:17408
    v_mul_f32_e64 v104, s40, v96
    v_mfma_f32_16x16x32_bf16 v[60:63], v[164:167], v[188:191], v[60:63]
    v_mul_f32_e64 v112, v96, v96
    v_mfma_f32_16x16x32_bf16 v[64:67], v[160:163], v[192:195], v[64:67]
    v_rcp_f32_e64 v121, v97
    v_mfma_f32_16x16x32_bf16 v[68:71], v[164:167], v[192:195], v[68:71]
    v_mul_f32_e64 v105, s40, v97
    v_mfma_f32_16x16x32_bf16 v[72:75], v[160:163], v[196:199], v[72:75]
    v_mul_f32_e64 v113, v97, v97
    v_mfma_f32_16x16x32_bf16 v[76:79], v[164:167], v[196:199], v[76:79]
    v_rcp_f32_e64 v122, v98
    v_mfma_f32_16x16x32_bf16 v[80:83], v[160:163], v[200:203], v[80:83]
    v_mul_f32_e64 v106, s40, v98
    v_mfma_f32_16x16x32_bf16 v[84:87], v[164:167], v[200:203], v[84:87]
    v_mul_f32 v114, v98, v98
    v_rcp_f32 v123, v99
    s_waitcnt lgkmcnt(0)
    s_barrier
    v_mfma_f32_16x16x32_bf16 v[16:19], v[204:207], v[212:215], v[16:19]
    ds_read_b128 v[160:163], v3 offset:36864
    v_mfma_f32_16x16x32_bf16 v[20:23], v[208:211], v[212:215], v[20:23]
    ds_read_b128 v[164:167], v3 offset:38912
    v_mfma_f32_16x16x32_bf16 v[24:27], v[204:207], v[216:219], v[24:27]
    ds_read_b128 v[168:171], v1 offset:36864
    v_mfma_f32_16x16x32_bf16 v[28:31], v[208:211], v[216:219], v[28:31]
    ds_read_b128 v[172:175], v1 offset:37888
    v_mfma_f32_16x16x32_bf16 v[32:35], v[204:207], v[220:223], v[32:35]
    ds_read_b128 v[176:179], v1 offset:38912
    v_mfma_f32_16x16x32_bf16 v[36:39], v[208:211], v[220:223], v[36:39]
    ds_read_b128 v[180:183], v1 offset:39936
    v_mfma_f32_16x16x32_bf16 v[40:43], v[204:207], v[224:227], v[40:43]
    ds_read_b128 v[184:187], v1 offset:40960
    v_mfma_f32_16x16x32_bf16 v[44:47], v[208:211], v[224:227], v[44:47]
    ds_read_b128 v[188:191], v1 offset:41984
    v_mfma_f32_16x16x32_bf16 v[48:51], v[204:207], v[228:231], v[48:51]
    ds_read_b128 v[192:195], v1 offset:43008
    v_mfma_f32_16x16x32_bf16 v[52:55], v[208:211], v[228:231], v[52:55]
    ds_read_b128 v[196:199], v1 offset:44032
    v_mul_f32_e64 v107, s40, v99
    v_mfma_f32_16x16x32_bf16 v[56:59], v[204:207], v[232:235], v[56:59]
    ds_read_b128 v[200:203], v1 offset:45056
    v_mul_f32_e64 v115, v99, v99
    v_mfma_f32_16x16x32_bf16 v[60:63], v[208:211], v[232:235], v[60:63]
    v_rcp_f32_e64 v124, v100
    v_mfma_f32_16x16x32_bf16 v[64:67], v[204:207], v[236:239], v[64:67]
    v_mul_f32_e64 v108, s40, v100
    v_mfma_f32_16x16x32_bf16 v[68:71], v[208:211], v[236:239], v[68:71]
    v_mul_f32_e64 v116, v100, v100
    v_mfma_f32_16x16x32_bf16 v[72:75], v[204:207], v[240:243], v[72:75]
    v_rcp_f32_e64 v125, v101
    v_mfma_f32_16x16x32_bf16 v[76:79], v[208:211], v[240:243], v[76:79]
    v_mul_f32_e64 v109, s40, v101
    v_mfma_f32_16x16x32_bf16 v[80:83], v[204:207], v[244:247], v[80:83]
    v_mul_f32_e64 v117, v101, v101
    v_mfma_f32_16x16x32_bf16 v[84:87], v[208:211], v[244:247], v[84:87]
    v_rcp_f32 v126, v102
    v_mul_f32_e64 v110, s40, v102
    s_waitcnt lgkmcnt(5)
    v_mfma_f32_16x16x32_bf16 v[16:19], v[160:163], v[168:171], v[16:19]
    ds_read_b128 v[204:207], v3 offset:37888
    v_mfma_f32_16x16x32_bf16 v[20:23], v[164:167], v[168:171], v[20:23]
    ds_read_b128 v[208:211], v3 offset:39936
    v_mfma_f32_16x16x32_bf16 v[24:27], v[160:163], v[172:175], v[24:27]
    ds_read_b128 v[212:215], v1 offset:46080
    v_mfma_f32_16x16x32_bf16 v[28:31], v[164:167], v[172:175], v[28:31]
    ds_read_b128 v[216:219], v1 offset:47104
    v_mfma_f32_16x16x32_bf16 v[32:35], v[160:163], v[176:179], v[32:35]
    ds_read_b128 v[220:223], v1 offset:48128
    v_mfma_f32_16x16x32_bf16 v[36:39], v[164:167], v[176:179], v[36:39]
    ds_read_b128 v[224:227], v1 offset:49152
    v_mfma_f32_16x16x32_bf16 v[40:43], v[160:163], v[180:183], v[40:43]
    ds_read_b128 v[228:231], v1 offset:50176
    v_mfma_f32_16x16x32_bf16 v[44:47], v[164:167], v[180:183], v[44:47]
    ds_read_b128 v[232:235], v1 offset:51200
    s_waitcnt lgkmcnt(8)
    v_mfma_f32_16x16x32_bf16 v[48:51], v[160:163], v[184:187], v[48:51]
    ds_read_b128 v[236:239], v1 offset:52224
    v_mfma_f32_16x16x32_bf16 v[52:55], v[164:167], v[184:187], v[52:55]
    ds_read_b128 v[240:243], v1 offset:53248
    v_mul_f32 v118, v102, v102
    v_mfma_f32_16x16x32_bf16 v[56:59], v[160:163], v[188:191], v[56:59]
    ds_read_b128 v[244:247], v1 offset:54272
    v_rcp_f32_e64 v127, v103
    v_mfma_f32_16x16x32_bf16 v[60:63], v[164:167], v[188:191], v[60:63]
    v_mul_f32_e64 v111, s40, v103
    v_mfma_f32_16x16x32_bf16 v[64:67], v[160:163], v[192:195], v[64:67]
    v_mul_f32_e64 v119, v103, v103
    v_mfma_f32_16x16x32_bf16 v[68:71], v[164:167], v[192:195], v[68:71]
    v_mul_f32_e64 v112, s42, v112
    v_mfma_f32_16x16x32_bf16 v[72:75], v[160:163], v[196:199], v[72:75]
    v_mul_f32_e64 v113, s42, v113
    v_mfma_f32_16x16x32_bf16 v[76:79], v[164:167], v[196:199], v[76:79]
    v_mul_f32_e64 v114, s42, v114
    v_mfma_f32_16x16x32_bf16 v[80:83], v[160:163], v[200:203], v[80:83]
    v_mul_f32_e64 v115, s42, v115
    v_mfma_f32_16x16x32_bf16 v[84:87], v[164:167], v[200:203], v[84:87]
    v_mul_f32 v116, s42, v116
    v_mul_f32 v117, s42, v117
    s_waitcnt lgkmcnt(0)
    s_barrier
    v_mfma_f32_16x16x32_bf16 v[16:19], v[204:207], v[212:215], v[16:19]
    ds_read_b128 v[160:163], v0 offset:0
    v_mfma_f32_16x16x32_bf16 v[20:23], v[208:211], v[212:215], v[20:23]
    ds_read_b128 v[164:167], v0 offset:2048
    v_mfma_f32_16x16x32_bf16 v[24:27], v[204:207], v[216:219], v[24:27]
    ds_read_b128 v[168:171], v2 offset:0
    v_mfma_f32_16x16x32_bf16 v[28:31], v[208:211], v[216:219], v[28:31]
    ds_read_b128 v[172:175], v2 offset:1024
    v_mfma_f32_16x16x32_bf16 v[32:35], v[204:207], v[220:223], v[32:35]
    ds_read_b128 v[176:179], v2 offset:2048
    v_mfma_f32_16x16x32_bf16 v[36:39], v[208:211], v[220:223], v[36:39]
    ds_read_b128 v[180:183], v2 offset:3072
    v_mfma_f32_16x16x32_bf16 v[40:43], v[204:207], v[224:227], v[40:43]
    ds_read_b128 v[184:187], v2 offset:4096
    v_mfma_f32_16x16x32_bf16 v[44:47], v[208:211], v[224:227], v[44:47]
    ds_read_b128 v[188:191], v2 offset:5120
    v_mfma_f32_16x16x32_bf16 v[48:51], v[204:207], v[228:231], v[48:51]
    ds_read_b128 v[192:195], v2 offset:6144
    v_mfma_f32_16x16x32_bf16 v[52:55], v[208:211], v[228:231], v[52:55]
    ds_read_b128 v[196:199], v2 offset:7168
    v_mul_f32_e64 v118, s42, v118
    v_mfma_f32_16x16x32_bf16 v[56:59], v[204:207], v[232:235], v[56:59]
    ds_read_b128 v[200:203], v2 offset:8192
    v_mul_f32_e64 v119, s42, v119
    v_mfma_f32_16x16x32_bf16 v[60:63], v[208:211], v[232:235], v[60:63]
    v_mul_f32_e64 v112, v112, v104
    v_mfma_f32_16x16x32_bf16 v[64:67], v[204:207], v[236:239], v[64:67]
    v_mul_f32_e64 v113, v113, v105
    v_mfma_f32_16x16x32_bf16 v[68:71], v[208:211], v[236:239], v[68:71]
    v_mul_f32_e64 v114, v114, v106
    v_mfma_f32_16x16x32_bf16 v[72:75], v[204:207], v[240:243], v[72:75]
    v_mul_f32_e64 v115, v115, v107
    v_mfma_f32_16x16x32_bf16 v[76:79], v[208:211], v[240:243], v[76:79]
    v_mul_f32_e64 v116, v116, v108
    v_mfma_f32_16x16x32_bf16 v[80:83], v[204:207], v[244:247], v[80:83]
    v_mul_f32_e64 v117, v117, v109
    v_mfma_f32_16x16x32_bf16 v[84:87], v[208:211], v[244:247], v[84:87]
    v_mul_f32 v118, v118, v110
    v_mul_f32_e64 v119, v119, v111
    s_waitcnt lgkmcnt(5)
    v_mfma_f32_16x16x32_bf16 v[16:19], v[160:163], v[168:171], v[16:19]
    ds_read_b128 v[204:207], v0 offset:1024
    v_mfma_f32_16x16x32_bf16 v[20:23], v[164:167], v[168:171], v[20:23]
    ds_read_b128 v[208:211], v0 offset:3072
    v_mfma_f32_16x16x32_bf16 v[24:27], v[160:163], v[172:175], v[24:27]
    ds_read_b128 v[212:215], v2 offset:9216
    v_mfma_f32_16x16x32_bf16 v[28:31], v[164:167], v[172:175], v[28:31]
    ds_read_b128 v[216:219], v2 offset:10240
    v_mfma_f32_16x16x32_bf16 v[32:35], v[160:163], v[176:179], v[32:35]
    ds_read_b128 v[220:223], v2 offset:11264
    v_mfma_f32_16x16x32_bf16 v[36:39], v[164:167], v[176:179], v[36:39]
    ds_read_b128 v[224:227], v2 offset:12288
    v_mfma_f32_16x16x32_bf16 v[40:43], v[160:163], v[180:183], v[40:43]
    ds_read_b128 v[228:231], v2 offset:13312
    v_mfma_f32_16x16x32_bf16 v[44:47], v[164:167], v[180:183], v[44:47]
    ds_read_b128 v[232:235], v2 offset:14336
    s_waitcnt lgkmcnt(8)
    v_mfma_f32_16x16x32_bf16 v[48:51], v[160:163], v[184:187], v[48:51]
    ds_read_b128 v[236:239], v2 offset:15360
    v_mfma_f32_16x16x32_bf16 v[52:55], v[164:167], v[184:187], v[52:55]
    ds_read_b128 v[240:243], v2 offset:16384
    v_lshrrev_b32 v8, 2, v6
    v_mfma_f32_16x16x32_bf16 v[56:59], v[160:163], v[188:191], v[56:59]
    ds_read_b128 v[244:247], v2 offset:17408
    v_lshlrev_b32_e64 v8, 4, v8
    v_mfma_f32_16x16x32_bf16 v[60:63], v[164:167], v[188:191], v[60:63]
    v_lshl_add_u32 v8, v5, 6, v8
    v_mfma_f32_16x16x32_bf16 v[64:67], v[160:163], v[192:195], v[64:67]
    v_and_b32_e64 v9, 3, v6
    v_mfma_f32_16x16x32_bf16 v[68:71], v[164:167], v[192:195], v[68:71]
    v_cmp_eq_u32_e64 vcc, 0, v9
    v_mfma_f32_16x16x32_bf16 v[72:75], v[160:163], v[196:199], v[72:75]
    v_bfrev_b32_e64 v10, 1
    v_mfma_f32_16x16x32_bf16 v[76:79], v[164:167], v[196:199], v[76:79]
    v_xor_b32 v4, 256, v4
    v_mfma_f32_16x16x32_bf16 v[80:83], v[160:163], v[200:203], v[80:83]
    v_cndmask_b32_e64 v8, v10, v8, vcc
    v_mfma_f32_16x16x32_bf16 v[84:87], v[164:167], v[200:203], v[84:87]
    v_lshl_add_u32 v255, v5, 6, s33
    s_waitcnt lgkmcnt(0)
    s_barrier
    v_mfma_f32_16x16x32_bf16 v[16:19], v[204:207], v[212:215], v[16:19]
    ds_read_b128 v[160:163], v0 offset:36864
    v_fma_f32 v52, -v92, v132, v52
    v_mfma_f32_16x16x32_bf16 v[20:23], v[208:211], v[212:215], v[20:23]
    ds_read_b128 v[164:167], v0 offset:38912
    v_fma_f32 v56, -v88, v133, v56
    v_mfma_f32_16x16x32_bf16 v[24:27], v[204:207], v[216:219], v[24:27]
    ds_read_b128 v[168:171], v2 offset:36864
    v_fma_f32 v60, -v92, v133, v60
    v_mfma_f32_16x16x32_bf16 v[28:31], v[208:211], v[216:219], v[28:31]
    ds_read_b128 v[172:175], v2 offset:37888
    v_fma_f32 v64, -v88, v134, v64
    v_mfma_f32_16x16x32_bf16 v[32:35], v[204:207], v[220:223], v[32:35]
    ds_read_b128 v[176:179], v2 offset:38912
    v_fma_f32 v68, -v92, v134, v68
    v_mfma_f32_16x16x32_bf16 v[36:39], v[208:211], v[220:223], v[36:39]
    ds_read_b128 v[180:183], v2 offset:39936
    v_fma_f32 v72, -v88, v135, v72
    v_mfma_f32_16x16x32_bf16 v[40:43], v[204:207], v[224:227], v[40:43]
    ds_read_b128 v[184:187], v2 offset:40960
    v_fma_f32 v76, -v92, v135, v76
    v_mfma_f32_16x16x32_bf16 v[44:47], v[208:211], v[224:227], v[44:47]
    ds_read_b128 v[188:191], v2 offset:41984
    v_fma_f32 v80, -v88, v136, v80
    v_mfma_f32_16x16x32_bf16 v[48:51], v[204:207], v[228:231], v[48:51]
    ds_read_b128 v[192:195], v2 offset:43008
    v_fma_f32 v84, -v92, v136, v84
    v_mfma_f32_16x16x32_bf16 v[52:55], v[208:211], v[228:231], v[52:55]
    ds_read_b128 v[196:199], v2 offset:44032
    v_fma_f32 v16, -v88, v128, v16
    v_mfma_f32_16x16x32_bf16 v[56:59], v[204:207], v[232:235], v[56:59]
    ds_read_b128 v[200:203], v2 offset:45056
    v_fma_f32 v20, -v92, v128, v20
    v_mfma_f32_16x16x32_bf16 v[60:63], v[208:211], v[232:235], v[60:63]
    v_fma_f32 v24, -v88, v129, v24
    v_mfma_f32_16x16x32_bf16 v[64:67], v[204:207], v[236:239], v[64:67]
    v_fma_f32 v28, -v92, v129, v28
    v_mfma_f32_16x16x32_bf16 v[68:71], v[208:211], v[236:239], v[68:71]
    v_fma_f32 v32, -v88, v130, v32
    v_mfma_f32_16x16x32_bf16 v[72:75], v[204:207], v[240:243], v[72:75]
    v_fma_f32 v36, -v92, v130, v36
    v_mfma_f32_16x16x32_bf16 v[76:79], v[208:211], v[240:243], v[76:79]
    v_fma_f32 v40, -v88, v131, v40
    v_mfma_f32_16x16x32_bf16 v[80:83], v[204:207], v[244:247], v[80:83]
    v_fma_f32 v44, -v92, v131, v44
    v_mfma_f32_16x16x32_bf16 v[84:87], v[208:211], v[244:247], v[84:87]
    v_fma_f32 v48, -v88, v132, v48
    s_waitcnt lgkmcnt(5)
    v_mfma_f32_16x16x32_bf16 v[16:19], v[160:163], v[168:171], v[16:19]
    ds_read_b128 v[204:207], v0 offset:37888
    v_fma_f32 v53, -v93, v132, v53
    v_mfma_f32_16x16x32_bf16 v[20:23], v[164:167], v[168:171], v[20:23]
    ds_read_b128 v[208:211], v0 offset:39936
    v_fma_f32 v57, -v89, v133, v57
    v_mfma_f32_16x16x32_bf16 v[24:27], v[160:163], v[172:175], v[24:27]
    ds_read_b128 v[212:215], v2 offset:46080
    v_fma_f32 v61, -v93, v133, v61
    v_mfma_f32_16x16x32_bf16 v[28:31], v[164:167], v[172:175], v[28:31]
    ds_read_b128 v[216:219], v2 offset:47104
    v_fma_f32 v65, -v89, v134, v65
    v_mfma_f32_16x16x32_bf16 v[32:35], v[160:163], v[176:179], v[32:35]
    ds_read_b128 v[220:223], v2 offset:48128
    v_fma_f32 v69, -v93, v134, v69
    v_mfma_f32_16x16x32_bf16 v[36:39], v[164:167], v[176:179], v[36:39]
    ds_read_b128 v[224:227], v2 offset:49152
    v_fma_f32 v73, -v89, v135, v73
    v_mfma_f32_16x16x32_bf16 v[40:43], v[160:163], v[180:183], v[40:43]
    ds_read_b128 v[228:231], v2 offset:50176
    v_fma_f32 v77, -v93, v135, v77
    v_mfma_f32_16x16x32_bf16 v[44:47], v[164:167], v[180:183], v[44:47]
    ds_read_b128 v[232:235], v2 offset:51200
    s_waitcnt lgkmcnt(8)
    v_fma_f32 v81, -v89, v136, v81
    v_mfma_f32_16x16x32_bf16 v[48:51], v[160:163], v[184:187], v[48:51]
    ds_read_b128 v[236:239], v2 offset:52224
    v_fma_f32 v85, -v93, v136, v85
    v_mfma_f32_16x16x32_bf16 v[52:55], v[164:167], v[184:187], v[52:55]
    ds_read_b128 v[240:243], v2 offset:53248
    v_fma_f32 v17, -v89, v128, v17
    v_mfma_f32_16x16x32_bf16 v[56:59], v[160:163], v[188:191], v[56:59]
    ds_read_b128 v[244:247], v2 offset:54272
    v_fma_f32 v21, -v93, v128, v21
    v_mfma_f32_16x16x32_bf16 v[60:63], v[164:167], v[188:191], v[60:63]
    v_fma_f32 v25, -v89, v129, v25
    v_mfma_f32_16x16x32_bf16 v[64:67], v[160:163], v[192:195], v[64:67]
    v_fma_f32 v29, -v93, v129, v29
    v_mfma_f32_16x16x32_bf16 v[68:71], v[164:167], v[192:195], v[68:71]
    v_fma_f32 v33, -v89, v130, v33
    v_mfma_f32_16x16x32_bf16 v[72:75], v[160:163], v[196:199], v[72:75]
    v_fma_f32 v37, -v93, v130, v37
    v_mfma_f32_16x16x32_bf16 v[76:79], v[164:167], v[196:199], v[76:79]
    v_fma_f32 v41, -v89, v131, v41
    v_mfma_f32_16x16x32_bf16 v[80:83], v[160:163], v[200:203], v[80:83]
    v_fma_f32 v45, -v93, v131, v45
    v_mfma_f32_16x16x32_bf16 v[84:87], v[164:167], v[200:203], v[84:87]
    v_fma_f32 v49, -v89, v132, v49
    s_waitcnt lgkmcnt(0)
    s_barrier
    v_mfma_f32_16x16x32_bf16 v[16:19], v[204:207], v[212:215], v[16:19]
    ds_read_b128 v[160:163], v3 offset:0
    v_fma_f32 v54, -v94, v132, v54
    v_mfma_f32_16x16x32_bf16 v[20:23], v[208:211], v[212:215], v[20:23]
    ds_read_b128 v[164:167], v3 offset:2048
    v_fma_f32 v58, -v90, v133, v58
    v_mfma_f32_16x16x32_bf16 v[24:27], v[204:207], v[216:219], v[24:27]
    ds_read_b128 v[168:171], v1 offset:0
    v_fma_f32 v62, -v94, v133, v62
    v_mfma_f32_16x16x32_bf16 v[28:31], v[208:211], v[216:219], v[28:31]
    ds_read_b128 v[172:175], v1 offset:1024
    v_fma_f32 v66, -v90, v134, v66
    v_mfma_f32_16x16x32_bf16 v[32:35], v[204:207], v[220:223], v[32:35]
    ds_read_b128 v[176:179], v1 offset:2048
    v_fma_f32 v70, -v94, v134, v70
    v_mfma_f32_16x16x32_bf16 v[36:39], v[208:211], v[220:223], v[36:39]
    ds_read_b128 v[180:183], v1 offset:3072
    v_fma_f32 v74, -v90, v135, v74
    v_mfma_f32_16x16x32_bf16 v[40:43], v[204:207], v[224:227], v[40:43]
    ds_read_b128 v[184:187], v1 offset:4096
    v_fma_f32 v78, -v94, v135, v78
    v_mfma_f32_16x16x32_bf16 v[44:47], v[208:211], v[224:227], v[44:47]
    ds_read_b128 v[188:191], v1 offset:5120
    v_fma_f32 v82, -v90, v136, v82
    v_mfma_f32_16x16x32_bf16 v[48:51], v[204:207], v[228:231], v[48:51]
    ds_read_b128 v[192:195], v1 offset:6144
    v_fma_f32 v86, -v94, v136, v86
    v_mfma_f32_16x16x32_bf16 v[52:55], v[208:211], v[228:231], v[52:55]
    ds_read_b128 v[196:199], v1 offset:7168
    v_fma_f32 v18, -v90, v128, v18
    v_mfma_f32_16x16x32_bf16 v[56:59], v[204:207], v[232:235], v[56:59]
    ds_read_b128 v[200:203], v1 offset:8192
    v_fma_f32 v22, -v94, v128, v22
    v_mfma_f32_16x16x32_bf16 v[60:63], v[208:211], v[232:235], v[60:63]
    v_fma_f32 v26, -v90, v129, v26
    v_mfma_f32_16x16x32_bf16 v[64:67], v[204:207], v[236:239], v[64:67]
    v_fma_f32 v30, -v94, v129, v30
    v_mfma_f32_16x16x32_bf16 v[68:71], v[208:211], v[236:239], v[68:71]
    v_fma_f32 v34, -v90, v130, v34
    v_mfma_f32_16x16x32_bf16 v[72:75], v[204:207], v[240:243], v[72:75]
    v_fma_f32 v38, -v94, v130, v38
    v_mfma_f32_16x16x32_bf16 v[76:79], v[208:211], v[240:243], v[76:79]
    v_fma_f32 v42, -v90, v131, v42
    v_mfma_f32_16x16x32_bf16 v[80:83], v[204:207], v[244:247], v[80:83]
    v_fma_f32 v46, -v94, v131, v46
    v_mfma_f32_16x16x32_bf16 v[84:87], v[208:211], v[244:247], v[84:87]
    v_fma_f32 v50, -v90, v132, v50
    s_waitcnt lgkmcnt(5)
    v_mfma_f32_16x16x32_bf16 v[16:19], v[160:163], v[168:171], v[16:19]
    ds_read_b128 v[204:207], v3 offset:1024
    v_fma_f32 v55, -v95, v132, v55
    v_mfma_f32_16x16x32_bf16 v[20:23], v[164:167], v[168:171], v[20:23]
    ds_read_b128 v[208:211], v3 offset:3072
    v_fma_f32 v59, -v91, v133, v59
    v_mfma_f32_16x16x32_bf16 v[24:27], v[160:163], v[172:175], v[24:27]
    ds_read_b128 v[212:215], v1 offset:9216
    v_fma_f32 v63, -v95, v133, v63
    v_mfma_f32_16x16x32_bf16 v[28:31], v[164:167], v[172:175], v[28:31]
    ds_read_b128 v[216:219], v1 offset:10240
    v_fma_f32 v67, -v91, v134, v67
    v_mfma_f32_16x16x32_bf16 v[32:35], v[160:163], v[176:179], v[32:35]
    ds_read_b128 v[220:223], v1 offset:11264
    v_fma_f32 v71, -v95, v134, v71
    v_mfma_f32_16x16x32_bf16 v[36:39], v[164:167], v[176:179], v[36:39]
    ds_read_b128 v[224:227], v1 offset:12288
    v_fma_f32 v75, -v91, v135, v75
    v_mfma_f32_16x16x32_bf16 v[40:43], v[160:163], v[180:183], v[40:43]
    ds_read_b128 v[228:231], v1 offset:13312
    v_fma_f32 v79, -v95, v135, v79
    v_mfma_f32_16x16x32_bf16 v[44:47], v[164:167], v[180:183], v[44:47]
    ds_read_b128 v[232:235], v1 offset:14336
    s_waitcnt lgkmcnt(8)
    v_fma_f32 v83, -v91, v136, v83
    v_mfma_f32_16x16x32_bf16 v[48:51], v[160:163], v[184:187], v[48:51]
    ds_read_b128 v[236:239], v1 offset:15360
    v_fma_f32 v87, -v95, v136, v87
    v_mfma_f32_16x16x32_bf16 v[52:55], v[164:167], v[184:187], v[52:55]
    ds_read_b128 v[240:243], v1 offset:16384
    v_fma_f32 v19, -v91, v128, v19
    v_mfma_f32_16x16x32_bf16 v[56:59], v[160:163], v[188:191], v[56:59]
    ds_read_b128 v[244:247], v1 offset:17408
    v_fma_f32 v23, -v95, v128, v23
    v_mfma_f32_16x16x32_bf16 v[60:63], v[164:167], v[188:191], v[60:63]
    v_fma_f32 v27, -v91, v129, v27
    v_mfma_f32_16x16x32_bf16 v[64:67], v[160:163], v[192:195], v[64:67]
    v_fma_f32 v31, -v95, v129, v31
    v_mfma_f32_16x16x32_bf16 v[68:71], v[164:167], v[192:195], v[68:71]
    v_fma_f32 v35, -v91, v130, v35
    v_mfma_f32_16x16x32_bf16 v[72:75], v[160:163], v[196:199], v[72:75]
    v_fma_f32 v39, -v95, v130, v39
    v_mfma_f32_16x16x32_bf16 v[76:79], v[164:167], v[196:199], v[76:79]
    v_fma_f32 v43, -v91, v131, v43
    v_mfma_f32_16x16x32_bf16 v[80:83], v[160:163], v[200:203], v[80:83]
    v_fma_f32 v47, -v95, v131, v47
    v_mfma_f32_16x16x32_bf16 v[84:87], v[164:167], v[200:203], v[84:87]
    v_fma_f32 v51, -v91, v132, v51
    s_waitcnt lgkmcnt(0)
    s_barrier
    v_mfma_f32_16x16x32_bf16 v[16:19], v[204:207], v[212:215], v[16:19]
    s_xor_b32 s47, s30, 4096
    s_sub_u32 s47, s47, s30
    v_mfma_f32_16x16x32_bf16 v[20:23], v[208:211], v[212:215], v[20:23]
    s_and_b32 s48, s30, 4096
    v_add_u32 v196, s47, v3
    v_mfma_f32_16x16x32_bf16 v[24:27], v[204:207], v[216:219], v[24:27]
    v_add_u32 v197, s47, v0
    v_add_u32 v198, s48, v1
    v_mfma_f32_16x16x32_bf16 v[28:31], v[208:211], v[216:219], v[28:31]
    v_add_u32_e64 v199, s48, v2
    v_mfma_f32_16x16x32_bf16 v[32:35], v[204:207], v[220:223], v[32:35]
    ds_read_b128 v[160:163], v196 offset:36864
    v_mfma_f32_16x16x32_bf16 v[36:39], v[208:211], v[220:223], v[36:39]
    ds_read_b128 v[164:167], v196 offset:38912
    v_mfma_f32_16x16x32_bf16 v[40:43], v[204:207], v[224:227], v[40:43]
    ds_read_b128 v[168:171], v198 offset:36864
    v_mfma_f32_16x16x32_bf16 v[44:47], v[208:211], v[224:227], v[44:47]
    ds_read_b128 v[172:175], v198 offset:37888
    v_mfma_f32_16x16x32_bf16 v[48:51], v[204:207], v[228:231], v[48:51]
    ds_read_b128 v[176:179], v198 offset:38912
    v_mfma_f32_16x16x32_bf16 v[52:55], v[208:211], v[228:231], v[52:55]
    ds_read_b128 v[180:183], v198 offset:39936
    v_mfma_f32_16x16x32_bf16 v[56:59], v[204:207], v[232:235], v[56:59]
    ds_read_b128 v[184:187], v3 offset:36864
    v_mfma_f32_16x16x32_bf16 v[60:63], v[208:211], v[232:235], v[60:63]
    ds_read_b128 v[188:191], v3 offset:38912
    v_mfma_f32_16x16x32_bf16 v[64:67], v[204:207], v[236:239], v[64:67]
    ds_read_b128 v[192:195], v1 offset:45056
    v_mfma_f32_16x16x32_bf16 v[68:71], v[208:211], v[236:239], v[68:71]
    v_mfma_f32_16x16x32_bf16 v[72:75], v[204:207], v[240:243], v[72:75]
    v_mfma_f32_16x16x32_bf16 v[76:79], v[208:211], v[240:243], v[76:79]
    v_mfma_f32_16x16x32_bf16 v[80:83], v[204:207], v[244:247], v[80:83]
    v_mfma_f32_16x16x32_bf16 v[84:87], v[208:211], v[244:247], v[84:87]
L_g_z2:
    v_pk_mul_f32 v[220:221], v[16:17], v[16:17]
    v_pk_mul_f32 v[222:223], v[18:19], v[18:19]
    v_pk_mul_f32 v[224:225], v[20:21], v[20:21]
    v_pk_mul_f32 v[226:227], v[22:23], v[22:23]
    v_pk_fma_f32 v[220:221], v[220:221], v[112:113], v[104:105]
    v_pk_fma_f32 v[222:223], v[222:223], v[114:115], v[106:107]
    v_pk_fma_f32 v[224:225], v[224:225], v[116:117], v[108:109]
    v_pk_fma_f32 v[226:227], v[226:227], v[118:119], v[110:111]
    v_pk_mul_f32 v[220:221], v[220:221], v[16:17]
    v_pk_mul_f32 v[222:223], v[222:223], v[18:19]
    v_pk_mul_f32 v[224:225], v[224:225], v[20:21]
    v_pk_mul_f32 v[226:227], v[226:227], v[22:23]
    v_exp_f32 v220, v220
    v_exp_f32 v221, v221
    v_exp_f32 v222, v222
    v_exp_f32 v223, v223
    v_exp_f32 v224, v224
    v_exp_f32 v225, v225
    v_exp_f32 v226, v226
    v_exp_f32 v227, v227
    v_pk_fma_f32 v[220:221], v[220:221], v[120:121], v[120:121]
    v_pk_fma_f32 v[222:223], v[222:223], v[122:123], v[122:123]
    v_pk_fma_f32 v[224:225], v[224:225], v[124:125], v[124:125]
    v_pk_fma_f32 v[226:227], v[226:227], v[126:127], v[126:127]
    v_rcp_f32 v220, v220
    v_rcp_f32 v221, v221
    v_rcp_f32 v222, v222
    v_rcp_f32 v223, v223
    v_rcp_f32 v224, v224
    v_rcp_f32 v225, v225
    v_rcp_f32 v226, v226
    v_rcp_f32 v227, v227
    v_pk_mul_f32 v[16:17], v[16:17], v[220:221]
    v_pk_mul_f32 v[18:19], v[18:19], v[222:223]
    v_pk_mul_f32 v[20:21], v[20:21], v[224:225]
    v_pk_mul_f32 v[22:23], v[22:23], v[226:227]
    v_pk_mul_f32 v[206:207], v[16:17], v[16:17]
    v_pk_mul_f32 v[210:211], v[18:19], v[18:19]
    v_pk_mul_f32 v[214:215], v[20:21], v[20:21]
    v_pk_mul_f32 v[218:219], v[22:23], v[22:23]
    v_pk_mul_f32 v[228:229], v[24:25], v[24:25]
    v_pk_mul_f32 v[230:231], v[26:27], v[26:27]
    v_pk_mul_f32 v[232:233], v[28:29], v[28:29]
    v_pk_mul_f32 v[234:235], v[30:31], v[30:31]
    v_pk_fma_f32 v[228:229], v[228:229], v[112:113], v[104:105]
    v_pk_fma_f32 v[230:231], v[230:231], v[114:115], v[106:107]
    v_pk_fma_f32 v[232:233], v[232:233], v[116:117], v[108:109]
    v_pk_fma_f32 v[234:235], v[234:235], v[118:119], v[110:111]
    v_pk_mul_f32 v[228:229], v[228:229], v[24:25]
    v_pk_mul_f32 v[230:231], v[230:231], v[26:27]
    v_pk_mul_f32 v[232:233], v[232:233], v[28:29]
    v_pk_mul_f32 v[234:235], v[234:235], v[30:31]
    v_exp_f32 v228, v228
    v_exp_f32 v229, v229
    v_exp_f32 v230, v230
    v_exp_f32 v231, v231
    v_exp_f32 v232, v232
    v_exp_f32 v233, v233
    v_exp_f32 v234, v234
    v_exp_f32 v235, v235
    v_pk_fma_f32 v[228:229], v[228:229], v[120:121], v[120:121]
    v_pk_fma_f32 v[230:231], v[230:231], v[122:123], v[122:123]
    v_pk_fma_f32 v[232:233], v[232:233], v[124:125], v[124:125]
    v_pk_fma_f32 v[234:235], v[234:235], v[126:127], v[126:127]
    v_rcp_f32 v228, v228
    v_rcp_f32 v229, v229
    v_rcp_f32 v230, v230
    v_rcp_f32 v231, v231
    v_rcp_f32 v232, v232
    v_rcp_f32 v233, v233
    v_rcp_f32 v234, v234
    v_rcp_f32 v235, v235
    v_pk_mul_f32 v[24:25], v[24:25], v[228:229]
    v_pk_mul_f32 v[26:27], v[26:27], v[230:231]
    v_pk_mul_f32 v[28:29], v[28:29], v[232:233]
    v_pk_mul_f32 v[30:31], v[30:31], v[234:235]
    v_pk_add_f32 v[204:205], v[16:17], v[24:25]
    v_pk_fma_f32 v[206:207], v[24:25], v[24:25], v[206:207]
    v_pk_add_f32 v[208:209], v[18:19], v[26:27]
    v_pk_fma_f32 v[210:211], v[26:27], v[26:27], v[210:211]
    v_pk_add_f32 v[212:213], v[20:21], v[28:29]
    v_pk_fma_f32 v[214:215], v[28:29], v[28:29], v[214:215]
    v_pk_add_f32 v[216:217], v[22:23], v[30:31]
    v_pk_fma_f32 v[218:219], v[30:31], v[30:31], v[218:219]
    v_pk_mul_f32 v[220:221], v[32:33], v[32:33]
    v_pk_mul_f32 v[222:223], v[34:35], v[34:35]
    v_pk_mul_f32 v[224:225], v[36:37], v[36:37]
    v_pk_mul_f32 v[226:227], v[38:39], v[38:39]
    v_pk_fma_f32 v[220:221], v[220:221], v[112:113], v[104:105]
    v_pk_fma_f32 v[222:223], v[222:223], v[114:115], v[106:107]
    v_pk_fma_f32 v[224:225], v[224:225], v[116:117], v[108:109]
    v_pk_fma_f32 v[226:227], v[226:227], v[118:119], v[110:111]
    v_pk_mul_f32 v[220:221], v[220:221], v[32:33]
    v_pk_mul_f32 v[222:223], v[222:223], v[34:35]
    v_pk_mul_f32 v[224:225], v[224:225], v[36:37]
    v_pk_mul_f32 v[226:227], v[226:227], v[38:39]
    v_exp_f32 v220, v220
    v_exp_f32 v221, v221
    v_exp_f32 v222, v222
    v_exp_f32 v223, v223
    v_exp_f32 v224, v224
    v_exp_f32 v225, v225
    v_exp_f32 v226, v226
    v_exp_f32 v227, v227
    v_pk_fma_f32 v[220:221], v[220:221], v[120:121], v[120:121]
    v_pk_fma_f32 v[222:223], v[222:223], v[122:123], v[122:123]
    v_pk_fma_f32 v[224:225], v[224:225], v[124:125], v[124:125]
    v_pk_fma_f32 v[226:227], v[226:227], v[126:127], v[126:127]
    v_rcp_f32 v220, v220
    v_rcp_f32 v221, v221
    v_rcp_f32 v222, v222
    v_rcp_f32 v223, v223
    v_rcp_f32 v224, v224
    v_rcp_f32 v225, v225
    v_rcp_f32 v226, v226
    v_rcp_f32 v227, v227
    v_pk_mul_f32 v[32:33], v[32:33], v[220:221]
    v_pk_mul_f32 v[34:35], v[34:35], v[222:223]
    v_pk_mul_f32 v[36:37], v[36:37], v[224:225]
    v_pk_mul_f32 v[38:39], v[38:39], v[226:227]
    v_pk_add_f32 v[204:205], v[204:205], v[32:33]
    v_pk_fma_f32 v[206:207], v[32:33], v[32:33], v[206:207]
    v_pk_add_f32 v[208:209], v[208:209], v[34:35]
    v_pk_fma_f32 v[210:211], v[34:35], v[34:35], v[210:211]
    v_pk_add_f32 v[212:213], v[212:213], v[36:37]
    v_pk_fma_f32 v[214:215], v[36:37], v[36:37], v[214:215]
    v_pk_add_f32 v[216:217], v[216:217], v[38:39]
    v_pk_fma_f32 v[218:219], v[38:39], v[38:39], v[218:219]
    v_pk_mul_f32 v[228:229], v[40:41], v[40:41]
    v_pk_mul_f32 v[230:231], v[42:43], v[42:43]
    v_pk_mul_f32 v[232:233], v[44:45], v[44:45]
    v_pk_mul_f32 v[234:235], v[46:47], v[46:47]
    v_pk_fma_f32 v[228:229], v[228:229], v[112:113], v[104:105]
    v_pk_fma_f32 v[230:231], v[230:231], v[114:115], v[106:107]
    v_pk_fma_f32 v[232:233], v[232:233], v[116:117], v[108:109]
    v_pk_fma_f32 v[234:235], v[234:235], v[118:119], v[110:111]
    v_pk_mul_f32 v[228:229], v[228:229], v[40:41]
    v_pk_mul_f32 v[230:231], v[230:231], v[42:43]
    v_pk_mul_f32 v[232:233], v[232:233], v[44:45]
    v_pk_mul_f32 v[234:235], v[234:235], v[46:47]
    v_exp_f32 v228, v228
    v_exp_f32 v229, v229
    v_exp_f32 v230, v230
    v_exp_f32 v231, v231
    v_exp_f32 v232, v232
    v_exp_f32 v233, v233
    v_exp_f32 v234, v234
    v_exp_f32 v235, v235
    v_pk_fma_f32 v[228:229], v[228:229], v[120:121], v[120:121]
    v_pk_fma_f32 v[230:231], v[230:231], v[122:123], v[122:123]
    v_pk_fma_f32 v[232:233], v[232:233], v[124:125], v[124:125]
    v_pk_fma_f32 v[234:235], v[234:235], v[126:127], v[126:127]
    v_rcp_f32 v228, v228
    v_rcp_f32 v229, v229
    v_rcp_f32 v230, v230
    v_rcp_f32 v231, v231
    v_rcp_f32 v232, v232
    v_rcp_f32 v233, v233
    v_rcp_f32 v234, v234
    v_rcp_f32 v235, v235
    v_pk_mul_f32 v[40:41], v[40:41], v[228:229]
    v_pk_mul_f32 v[42:43], v[42:43], v[230:231]
    v_pk_mul_f32 v[44:45], v[44:45], v[232:233]
    v_pk_mul_f32 v[46:47], v[46:47], v[234:235]
    v_pk_add_f32 v[204:205], v[204:205], v[40:41]
    v_pk_fma_f32 v[206:207], v[40:41], v[40:41], v[206:207]
    v_pk_add_f32 v[208:209], v[208:209], v[42:43]
    v_pk_fma_f32 v[210:211], v[42:43], v[42:43], v[210:211]
    v_pk_add_f32 v[212:213], v[212:213], v[44:45]
    v_pk_fma_f32 v[214:215], v[44:45], v[44:45], v[214:215]
    v_pk_add_f32 v[216:217], v[216:217], v[46:47]
    v_pk_fma_f32 v[218:219], v[46:47], v[46:47], v[218:219]
    v_pk_mul_f32 v[220:221], v[48:49], v[48:49]
    v_pk_mul_f32 v[222:223], v[50:51], v[50:51]
    v_pk_mul_f32 v[224:225], v[52:53], v[52:53]
    v_pk_mul_f32 v[226:227], v[54:55], v[54:55]
    v_pk_fma_f32 v[220:221], v[220:221], v[112:113], v[104:105]
    v_pk_fma_f32 v[222:223], v[222:223], v[114:115], v[106:107]
    v_pk_fma_f32 v[224:225], v[224:225], v[116:117], v[108:109]
    v_pk_fma_f32 v[226:227], v[226:227], v[118:119], v[110:111]
    v_pk_mul_f32 v[220:221], v[220:221], v[48:49]
    v_pk_mul_f32 v[222:223], v[222:223], v[50:51]
    v_pk_mul_f32 v[224:225], v[224:225], v[52:53]
    v_pk_mul_f32 v[226:227], v[226:227], v[54:55]
    v_exp_f32 v220, v220
    v_exp_f32 v221, v221
    v_exp_f32 v222, v222
    v_exp_f32 v223, v223
    v_exp_f32 v224, v224
    v_exp_f32 v225, v225
    v_exp_f32 v226, v226
    v_exp_f32 v227, v227
    v_pk_fma_f32 v[220:221], v[220:221], v[120:121], v[120:121]
    v_pk_fma_f32 v[222:223], v[222:223], v[122:123], v[122:123]
    v_pk_fma_f32 v[224:225], v[224:225], v[124:125], v[124:125]
    v_pk_fma_f32 v[226:227], v[226:227], v[126:127], v[126:127]
    v_rcp_f32 v220, v220
    v_rcp_f32 v221, v221
    v_rcp_f32 v222, v222
    v_rcp_f32 v223, v223
    v_rcp_f32 v224, v224
    v_rcp_f32 v225, v225
    v_rcp_f32 v226, v226
    v_rcp_f32 v227, v227
    v_pk_mul_f32 v[48:49], v[48:49], v[220:221]
    v_pk_mul_f32 v[50:51], v[50:51], v[222:223]
    v_pk_mul_f32 v[52:53], v[52:53], v[224:225]
    v_pk_mul_f32 v[54:55], v[54:55], v[226:227]
    v_pk_add_f32 v[204:205], v[204:205], v[48:49]
    v_pk_fma_f32 v[206:207], v[48:49], v[48:49], v[206:207]
    v_pk_add_f32 v[208:209], v[208:209], v[50:51]
    v_pk_fma_f32 v[210:211], v[50:51], v[50:51], v[210:211]
    v_pk_add_f32 v[212:213], v[212:213], v[52:53]
    v_pk_fma_f32 v[214:215], v[52:53], v[52:53], v[214:215]
    v_pk_add_f32 v[216:217], v[216:217], v[54:55]
    v_pk_fma_f32 v[218:219], v[54:55], v[54:55], v[218:219]
    v_pk_mul_f32 v[228:229], v[56:57], v[56:57]
    v_pk_mul_f32 v[230:231], v[58:59], v[58:59]
    v_pk_mul_f32 v[232:233], v[60:61], v[60:61]
    v_pk_mul_f32 v[234:235], v[62:63], v[62:63]
    v_pk_fma_f32 v[228:229], v[228:229], v[112:113], v[104:105]
    v_pk_fma_f32 v[230:231], v[230:231], v[114:115], v[106:107]
    v_pk_fma_f32 v[232:233], v[232:233], v[116:117], v[108:109]
    v_pk_fma_f32 v[234:235], v[234:235], v[118:119], v[110:111]
    v_pk_mul_f32 v[228:229], v[228:229], v[56:57]
    v_pk_mul_f32 v[230:231], v[230:231], v[58:59]
    v_pk_mul_f32 v[232:233], v[232:233], v[60:61]
    v_pk_mul_f32 v[234:235], v[234:235], v[62:63]
    v_exp_f32 v228, v228
    v_exp_f32 v229, v229
    v_exp_f32 v230, v230
    v_exp_f32 v231, v231
    v_exp_f32 v232, v232
    v_exp_f32 v233, v233
    v_exp_f32 v234, v234
    v_exp_f32 v235, v235
    v_pk_fma_f32 v[228:229], v[228:229], v[120:121], v[120:121]
    v_pk_fma_f32 v[230:231], v[230:231], v[122:123], v[122:123]
    v_pk_fma_f32 v[232:233], v[232:233], v[124:125], v[124:125]
    v_pk_fma_f32 v[234:235], v[234:235], v[126:127], v[126:127]
    v_rcp_f32 v228, v228
    v_rcp_f32 v229, v229
    v_rcp_f32 v230, v230
    v_rcp_f32 v231, v231
    v_rcp_f32 v232, v232
    v_rcp_f32 v233, v233
    v_rcp_f32 v234, v234
    v_rcp_f32 v235, v235
    v_pk_mul_f32 v[56:57], v[56:57], v[228:229]
    v_pk_mul_f32 v[58:59], v[58:59], v[230:231]
    v_pk_mul_f32 v[60:61], v[60:61], v[232:233]
    v_pk_mul_f32 v[62:63], v[62:63], v[234:235]
    v_pk_add_f32 v[204:205], v[204:205], v[56:57]
    v_pk_fma_f32 v[206:207], v[56:57], v[56:57], v[206:207]
    v_pk_add_f32 v[208:209], v[208:209], v[58:59]
    v_pk_fma_f32 v[210:211], v[58:59], v[58:59], v[210:211]
    v_pk_add_f32 v[212:213], v[212:213], v[60:61]
    v_pk_fma_f32 v[214:215], v[60:61], v[60:61], v[214:215]
    v_pk_add_f32 v[216:217], v[216:217], v[62:63]
    v_pk_fma_f32 v[218:219], v[62:63], v[62:63], v[218:219]
    v_pk_mul_f32 v[220:221], v[64:65], v[64:65]
    v_pk_mul_f32 v[222:223], v[66:67], v[66:67]
    v_pk_mul_f32 v[224:225], v[68:69], v[68:69]
    v_pk_mul_f32 v[226:227], v[70:71], v[70:71]
    v_pk_fma_f32 v[220:221], v[220:221], v[112:113], v[104:105]
    v_pk_fma_f32 v[222:223], v[222:223], v[114:115], v[106:107]
    v_pk_fma_f32 v[224:225], v[224:225], v[116:117], v[108:109]
    v_pk_fma_f32 v[226:227], v[226:227], v[118:119], v[110:111]
    v_pk_mul_f32 v[220:221], v[220:221], v[64:65]
    v_pk_mul_f32 v[222:223], v[222:223], v[66:67]
    v_pk_mul_f32 v[224:225], v[224:225], v[68:69]
    v_pk_mul_f32 v[226:227], v[226:227], v[70:71]
    v_exp_f32 v220, v220
    v_exp_f32 v221, v221
    v_exp_f32 v222, v222
    v_exp_f32 v223, v223
    v_exp_f32 v224, v224
    v_exp_f32 v225, v225
    v_exp_f32 v226, v226
    v_exp_f32 v227, v227
    v_pk_fma_f32 v[220:221], v[220:221], v[120:121], v[120:121]
    v_pk_fma_f32 v[222:223], v[222:223], v[122:123], v[122:123]
    v_pk_fma_f32 v[224:225], v[224:225], v[124:125], v[124:125]
    v_pk_fma_f32 v[226:227], v[226:227], v[126:127], v[126:127]
    v_rcp_f32 v220, v220
    v_rcp_f32 v221, v221
    v_rcp_f32 v222, v222
    v_rcp_f32 v223, v223
    v_rcp_f32 v224, v224
    v_rcp_f32 v225, v225
    v_rcp_f32 v226, v226
    v_rcp_f32 v227, v227
    v_pk_mul_f32 v[64:65], v[64:65], v[220:221]
    v_pk_mul_f32 v[66:67], v[66:67], v[222:223]
    v_pk_mul_f32 v[68:69], v[68:69], v[224:225]
    v_pk_mul_f32 v[70:71], v[70:71], v[226:227]
    v_pk_add_f32 v[204:205], v[204:205], v[64:65]
    v_pk_fma_f32 v[206:207], v[64:65], v[64:65], v[206:207]
    v_pk_add_f32 v[208:209], v[208:209], v[66:67]
    v_pk_fma_f32 v[210:211], v[66:67], v[66:67], v[210:211]
    v_pk_add_f32 v[212:213], v[212:213], v[68:69]
    v_pk_fma_f32 v[214:215], v[68:69], v[68:69], v[214:215]
    v_pk_add_f32 v[216:217], v[216:217], v[70:71]
    v_pk_fma_f32 v[218:219], v[70:71], v[70:71], v[218:219]
    v_pk_mul_f32 v[228:229], v[72:73], v[72:73]
    v_pk_mul_f32 v[230:231], v[74:75], v[74:75]
    v_pk_mul_f32 v[232:233], v[76:77], v[76:77]
    v_pk_mul_f32 v[234:235], v[78:79], v[78:79]
    v_pk_fma_f32 v[228:229], v[228:229], v[112:113], v[104:105]
    v_pk_fma_f32 v[230:231], v[230:231], v[114:115], v[106:107]
    v_pk_fma_f32 v[232:233], v[232:233], v[116:117], v[108:109]
    v_pk_fma_f32 v[234:235], v[234:235], v[118:119], v[110:111]
    v_pk_mul_f32 v[228:229], v[228:229], v[72:73]
    v_pk_mul_f32 v[230:231], v[230:231], v[74:75]
    v_pk_mul_f32 v[232:233], v[232:233], v[76:77]
    v_pk_mul_f32 v[234:235], v[234:235], v[78:79]
    v_exp_f32 v228, v228
    v_exp_f32 v229, v229
    v_exp_f32 v230, v230
    v_exp_f32 v231, v231
    v_exp_f32 v232, v232
    v_exp_f32 v233, v233
    v_exp_f32 v234, v234
    v_exp_f32 v235, v235
    v_pk_fma_f32 v[228:229], v[228:229], v[120:121], v[120:121]
    v_pk_fma_f32 v[230:231], v[230:231], v[122:123], v[122:123]
    v_pk_fma_f32 v[232:233], v[232:233], v[124:125], v[124:125]
    v_pk_fma_f32 v[234:235], v[234:235], v[126:127], v[126:127]
    v_rcp_f32 v228, v228
    v_rcp_f32 v229, v229
    v_rcp_f32 v230, v230
    v_rcp_f32 v231, v231
    v_rcp_f32 v232, v232
    v_rcp_f32 v233, v233
    v_rcp_f32 v234, v234
    v_rcp_f32 v235, v235
    v_pk_mul_f32 v[72:73], v[72:73], v[228:229]
    v_pk_mul_f32 v[74:75], v[74:75], v[230:231]
    v_pk_mul_f32 v[76:77], v[76:77], v[232:233]
    v_pk_mul_f32 v[78:79], v[78:79], v[234:235]
    v_pk_add_f32 v[204:205], v[204:205], v[72:73]
    v_pk_fma_f32 v[206:207], v[72:73], v[72:73], v[206:207]
    v_pk_add_f32 v[208:209], v[208:209], v[74:75]
    v_pk_fma_f32 v[210:211], v[74:75], v[74:75], v[210:211]
    v_pk_add_f32 v[212:213], v[212:213], v[76:77]
    v_pk_fma_f32 v[214:215], v[76:77], v[76:77], v[214:215]
    v_pk_add_f32 v[216:217], v[216:217], v[78:79]
    v_pk_fma_f32 v[218:219], v[78:79], v[78:79], v[218:219]
    v_pk_mul_f32 v[220:221], v[80:81], v[80:81]
    v_pk_mul_f32 v[222:223], v[82:83], v[82:83]
    v_pk_mul_f32 v[224:225], v[84:85], v[84:85]
    v_pk_mul_f32 v[226:227], v[86:87], v[86:87]
    v_pk_fma_f32 v[220:221], v[220:221], v[112:113], v[104:105]
    v_pk_fma_f32 v[222:223], v[222:223], v[114:115], v[106:107]
    v_pk_fma_f32 v[224:225], v[224:225], v[116:117], v[108:109]
    v_pk_fma_f32 v[226:227], v[226:227], v[118:119], v[110:111]
    v_pk_mul_f32 v[220:221], v[220:221], v[80:81]
    v_pk_mul_f32 v[222:223], v[222:223], v[82:83]
    v_pk_mul_f32 v[224:225], v[224:225], v[84:85]
    v_pk_mul_f32 v[226:227], v[226:227], v[86:87]
    v_exp_f32 v220, v220
    v_exp_f32 v221, v221
    v_exp_f32 v222, v222
    v_exp_f32 v223, v223
    v_exp_f32 v224, v224
    v_exp_f32 v225, v225
    v_exp_f32 v226, v226
    v_exp_f32 v227, v227
    v_pk_fma_f32 v[220:221], v[220:221], v[120:121], v[120:121]
    v_pk_fma_f32 v[222:223], v[222:223], v[122:123], v[122:123]
    v_pk_fma_f32 v[224:225], v[224:225], v[124:125], v[124:125]
    v_pk_fma_f32 v[226:227], v[226:227], v[126:127], v[126:127]
    v_rcp_f32 v220, v220
    v_rcp_f32 v221, v221
    v_rcp_f32 v222, v222
    v_rcp_f32 v223, v223
    v_rcp_f32 v224, v224
    v_rcp_f32 v225, v225
    v_rcp_f32 v226, v226
    v_rcp_f32 v227, v227
    v_pk_mul_f32 v[80:81], v[80:81], v[220:221]
    v_pk_mul_f32 v[82:83], v[82:83], v[222:223]
    v_pk_mul_f32 v[84:85], v[84:85], v[224:225]
    v_pk_mul_f32 v[86:87], v[86:87], v[226:227]
    v_pk_add_f32 v[204:205], v[204:205], v[80:81]
    v_pk_fma_f32 v[206:207], v[80:81], v[80:81], v[206:207]
    v_pk_add_f32 v[208:209], v[208:209], v[82:83]
    v_pk_fma_f32 v[210:211], v[82:83], v[82:83], v[210:211]
    v_pk_add_f32 v[212:213], v[212:213], v[84:85]
    v_pk_fma_f32 v[214:215], v[84:85], v[84:85], v[214:215]
    v_pk_add_f32 v[216:217], v[216:217], v[86:87]
    v_pk_fma_f32 v[218:219], v[86:87], v[86:87], v[218:219]
    v_add_f32_dpp v204, v204, v204 row_mirror row_mask:0xf bank_mask:0x3
    v_add_f32_dpp v205, v205, v205 row_mirror row_mask:0xf bank_mask:0x3
    v_add_f32_dpp v206, v206, v206 row_mirror row_mask:0xf bank_mask:0x3
    v_add_f32_dpp v207, v207, v207 row_mirror row_mask:0xf bank_mask:0x3
    v_add_f32_dpp v208, v208, v208 row_mirror row_mask:0xf bank_mask:0x3
    v_add_f32_dpp v209, v209, v209 row_mirror row_mask:0xf bank_mask:0x3
    v_add_f32_dpp v210, v210, v210 row_mirror row_mask:0xf bank_mask:0x3
    v_add_f32_dpp v211, v211, v211 row_mirror row_mask:0xf bank_mask:0x3
    v_add_f32_dpp v204, v212, v212 row_mirror row_mask:0xf bank_mask:0xc
    v_add_f32_dpp v205, v213, v213 row_mirror row_mask:0xf bank_mask:0xc
    v_add_f32_dpp v206, v214, v214 row_mirror row_mask:0xf bank_mask:0xc
    v_add_f32_dpp v207, v215, v215 row_mirror row_mask:0xf bank_mask:0xc
    v_add_f32_dpp v208, v216, v216 row_mirror row_mask:0xf bank_mask:0xc
    v_add_f32_dpp v209, v217, v217 row_mirror row_mask:0xf bank_mask:0xc
    v_add_f32_dpp v210, v218, v218 row_mirror row_mask:0xf bank_mask:0xc
    v_add_f32_dpp v211, v219, v219 row_mirror row_mask:0xf bank_mask:0xc
    v_add_f32_dpp v204, v204, v204 row_half_mirror row_mask:0xf bank_mask:0x5
    v_add_f32_dpp v205, v205, v205 row_half_mirror row_mask:0xf bank_mask:0x5
    v_add_f32_dpp v206, v206, v206 row_half_mirror row_mask:0xf bank_mask:0x5
    v_add_f32_dpp v207, v207, v207 row_half_mirror row_mask:0xf bank_mask:0x5
    v_add_f32_dpp v204, v208, v208 row_half_mirror row_mask:0xf bank_mask:0xa
    v_add_f32_dpp v205, v209, v209 row_half_mirror row_mask:0xf bank_mask:0xa
    v_add_f32_dpp v206, v210, v210 row_half_mirror row_mask:0xf bank_mask:0xa
    v_add_f32_dpp v207, v211, v211 row_half_mirror row_mask:0xf bank_mask:0xa
    v_add_f32_dpp v204, v204, v204 quad_perm:[1,0,3,2] row_mask:0xf bank_mask:0xf
    v_add_f32_dpp v205, v205, v205 quad_perm:[1,0,3,2] row_mask:0xf bank_mask:0xf
    v_add_f32_dpp v206, v206, v206 quad_perm:[1,0,3,2] row_mask:0xf bank_mask:0xf
    v_add_f32_dpp v207, v207, v207 quad_perm:[1,0,3,2] row_mask:0xf bank_mask:0xf
    v_add_f32_dpp v12, v204, v204 quad_perm:[2,3,0,1] row_mask:0xf bank_mask:0xf
    v_add_f32_dpp v14, v205, v205 quad_perm:[2,3,0,1] row_mask:0xf bank_mask:0xf
    v_add_f32_dpp v13, v206, v206 quad_perm:[2,3,0,1] row_mask:0xf bank_mask:0xf
    v_add_f32_dpp v15, v207, v207 quad_perm:[2,3,0,1] row_mask:0xf bank_mask:0xf
    buffer_store_dwordx4 v[12:15], v8, s[4:7], s36 offen sc1
    s_waitcnt lgkmcnt(3)
    v_mfma_f32_16x16x32_bf16 v[88:91], v[168:171], v[160:163], 0
    ds_read_b128 v[204:207], v196 offset:37888
    v_mfma_f32_16x16x32_bf16 v[92:95], v[168:171], v[164:167], 0
    ds_read_b128 v[208:211], v196 offset:39936
    v_mfma_f32_16x16x32_bf16 v[96:99], v[172:175], v[160:163], 0
    ds_read_b128 v[212:215], v198 offset:46080
    v_mfma_f32_16x16x32_bf16 v[100:103], v[172:175], v[164:167], 0
    ds_read_b128 v[216:219], v198 offset:47104
    v_mfma_f32_16x16x32_bf16 v[104:107], v[176:179], v[160:163], 0
    ds_read_b128 v[220:223], v198 offset:48128
    v_mfma_f32_16x16x32_bf16 v[108:111], v[176:179], v[164:167], 0
    ds_read_b128 v[224:227], v198 offset:49152
    v_mfma_f32_16x16x32_bf16 v[112:115], v[180:183], v[160:163], 0
    ds_read_b128 v[228:231], v3 offset:37888
    v_mfma_f32_16x16x32_bf16 v[116:119], v[180:183], v[164:167], 0
    ds_read_b128 v[232:235], v3 offset:39936
    s_waitcnt lgkmcnt(8)
    v_mfma_f32_16x16x32_bf16 v[120:123], v[168:171], v[184:187], 0
    ds_read_b128 v[236:239], v1 offset:54272
    v_mfma_f32_16x16x32_bf16 v[124:127], v[168:171], v[188:191], 0
    v_mfma_f32_16x16x32_bf16 v[128:131], v[172:175], v[184:187], 0
    v_mfma_f32_16x16x32_bf16 v[132:135], v[172:175], v[188:191], 0
    v_mfma_f32_16x16x32_bf16 v[136:139], v[176:179], v[184:187], 0
    v_mfma_f32_16x16x32_bf16 v[140:143], v[176:179], v[188:191], 0
    v_mfma_f32_16x16x32_bf16 v[144:147], v[180:183], v[184:187], 0
    v_mfma_f32_16x16x32_bf16 v[148:151], v[180:183], v[188:191], 0
    v_mfma_f32_16x16x32_bf16 v[152:155], v[192:195], v[184:187], 0
    v_mfma_f32_16x16x32_bf16 v[156:159], v[192:195], v[188:191], 0
    s_waitcnt lgkmcnt(0)
    s_barrier
    v_mfma_f32_16x16x32_bf16 v[88:91], v[212:215], v[204:207], v[88:91]
    ds_read_b128 v[160:163], v197 offset:0
    v_mfma_f32_16x16x32_bf16 v[92:95], v[212:215], v[208:211], v[92:95]
    ds_read_b128 v[164:167], v197 offset:2048
    v_mfma_f32_16x16x32_bf16 v[96:99], v[216:219], v[204:207], v[96:99]
    ds_read_b128 v[168:171], v199 offset:0
    v_mfma_f32_16x16x32_bf16 v[100:103], v[216:219], v[208:211], v[100:103]
    ds_read_b128 v[172:175], v199 offset:1024
    v_mfma_f32_16x16x32_bf16 v[104:107], v[220:223], v[204:207], v[104:107]
    ds_read_b128 v[176:179], v199 offset:2048
    v_mfma_f32_16x16x32_bf16 v[108:111], v[220:223], v[208:211], v[108:111]
    ds_read_b128 v[180:183], v199 offset:3072
    v_mfma_f32_16x16x32_bf16 v[112:115], v[224:227], v[204:207], v[112:115]
    ds_read_b128 v[184:187], v0 offset:0
    v_mfma_f32_16x16x32_bf16 v[116:119], v[224:227], v[208:211], v[116:119]
    ds_read_b128 v[188:191], v0 offset:2048
    v_mfma_f32_16x16x32_bf16 v[120:123], v[212:215], v[228:231], v[120:123]
    ds_read_b128 v[192:195], v2 offset:8192
    v_mfma_f32_16x16x32_bf16 v[124:127], v[212:215], v[232:235], v[124:127]
    ds_read2_b32 v[240:241], v4 offset0:0 offset1:32
    v_mfma_f32_16x16x32_bf16 v[128:131], v[216:219], v[228:231], v[128:131]
    ds_read2_b32 v[242:243], v4 offset0:16 offset1:48
    v_mfma_f32_16x16x32_bf16 v[132:135], v[216:219], v[232:235], v[132:135]
    v_mfma_f32_16x16x32_bf16 v[136:139], v[220:223], v[228:231], v[136:139]
    v_mfma_f32_16x16x32_bf16 v[140:143], v[220:223], v[232:235], v[140:143]
    v_mfma_f32_16x16x32_bf16 v[144:147], v[224:227], v[228:231], v[144:147]
    v_mfma_f32_16x16x32_bf16 v[148:151], v[224:227], v[232:235], v[148:151]
    v_mfma_f32_16x16x32_bf16 v[152:155], v[236:239], v[228:231], v[152:155]
    v_mfma_f32_16x16x32_bf16 v[156:159], v[236:239], v[232:235], v[156:159]
    s_waitcnt lgkmcnt(5)
    v_mfma_f32_16x16x32_bf16 v[88:91], v[168:171], v[160:163], v[88:91]
    ds_read_b128 v[204:207], v197 offset:1024
    v_mfma_f32_16x16x32_bf16 v[92:95], v[168:171], v[164:167], v[92:95]
    ds_read_b128 v[208:211], v197 offset:3072
    v_mfma_f32_16x16x32_bf16 v[96:99], v[172:175], v[160:163], v[96:99]
    ds_read_b128 v[212:215], v199 offset:9216
    v_mfma_f32_16x16x32_bf16 v[100:103], v[172:175], v[164:167], v[100:103]
    ds_read_b128 v[216:219], v199 offset:10240
    v_mfma_f32_16x16x32_bf16 v[104:107], v[176:179], v[160:163], v[104:107]
    ds_read_b128 v[220:223], v199 offset:11264
    v_mfma_f32_16x16x32_bf16 v[108:111], v[176:179], v[164:167], v[108:111]
    ds_read_b128 v[224:227], v199 offset:12288
    v_mfma_f32_16x16x32_bf16 v[112:115], v[180:183], v[160:163], v[112:115]
    ds_read_b128 v[228:231], v0 offset:1024
    v_mfma_f32_16x16x32_bf16 v[116:119], v[180:183], v[164:167], v[116:119]
    ds_read_b128 v[232:235], v0 offset:3072
    s_waitcnt lgkmcnt(8)
    v_mfma_f32_16x16x32_bf16 v[120:123], v[168:171], v[184:187], v[120:123]
    ds_read_b128 v[236:239], v2 offset:17408
    v_mfma_f32_16x16x32_bf16 v[124:127], v[168:171], v[188:191], v[124:127]
    v_mfma_f32_16x16x32_bf16 v[128:131], v[172:175], v[184:187], v[128:131]
    v_mfma_f32_16x16x32_bf16 v[132:135], v[172:175], v[188:191], v[132:135]
    v_mfma_f32_16x16x32_bf16 v[136:139], v[176:179], v[184:187], v[136:139]
    v_mfma_f32_16x16x32_bf16 v[140:143], v[176:179], v[188:191], v[140:143]
    v_mfma_f32_16x16x32_bf16 v[144:147], v[180:183], v[184:187], v[144:147]
    v_mfma_f32_16x16x32_bf16 v[148:151], v[180:183], v[188:191], v[148:151]
    v_mfma_f32_16x16x32_bf16 v[152:155], v[192:195], v[184:187], v[152:155]
    v_mfma_f32_16x16x32_bf16 v[156:159], v[192:195], v[188:191], v[156:159]
    s_waitcnt lgkmcnt(0)
    s_barrier
    v_mfma_f32_16x16x32_bf16 v[88:91], v[212:215], v[204:207], v[88:91]
    ds_read_b128 v[160:163], v197 offset:36864
    v_mfma_f32_16x16x32_bf16 v[92:95], v[212:215], v[208:211], v[92:95]
    ds_read_b128 v[164:167], v197 offset:38912
    v_mfma_f32_16x16x32_bf16 v[96:99], v[216:219], v[204:207], v[96:99]
    ds_read_b128 v[168:171], v199 offset:36864
    v_mfma_f32_16x16x32_bf16 v[100:103], v[216:219], v[208:211], v[100:103]
    ds_read_b128 v[172:175], v199 offset:37888
    v_mfma_f32_16x16x32_bf16 v[104:107], v[220:223], v[204:207], v[104:107]
    ds_read_b128 v[176:179], v199 offset:38912
    v_mfma_f32_16x16x32_bf16 v[108:111], v[220:223], v[208:211], v[108:111]
    ds_read_b128 v[180:183], v199 offset:39936
    v_mfma_f32_16x16x32_bf16 v[112:115], v[224:227], v[204:207], v[112:115]
    ds_read_b128 v[184:187], v0 offset:36864
    v_mfma_f32_16x16x32_bf16 v[116:119], v[224:227], v[208:211], v[116:119]
    ds_read_b128 v[188:191], v0 offset:38912
    v_mfma_f32_16x16x32_bf16 v[120:123], v[212:215], v[228:231], v[120:123]
    ds_read_b128 v[192:195], v2 offset:45056
    v_mfma_f32_16x16x32_bf16 v[124:127], v[212:215], v[232:235], v[124:127]
    v_mul_f32_e64 v244, s40, v241
    v_mfma_f32_16x16x32_bf16 v[128:131], v[216:219], v[228:231], v[128:131]
    v_mul_f32_e64 v246, s40, v243
    v_mfma_f32_16x16x32_bf16 v[132:135], v[216:219], v[232:235], v[132:135]
    v_mul_f32_e64 v245, v241, v241
    v_mfma_f32_16x16x32_bf16 v[136:139], v[220:223], v[228:231], v[136:139]
    v_mul_f32_e64 v247, v243, v243
    v_mfma_f32_16x16x32_bf16 v[140:143], v[220:223], v[232:235], v[140:143]
    v_rcp_f32_e64 v241, v241
    v_mfma_f32_16x16x32_bf16 v[144:147], v[224:227], v[228:231], v[144:147]
    v_rcp_f32_e64 v243, v243
    v_mfma_f32_16x16x32_bf16 v[148:151], v[224:227], v[232:235], v[148:151]
    v_mul_f32_e64 v245, s42, v245
    v_mfma_f32_16x16x32_bf16 v[152:155], v[236:239], v[228:231], v[152:155]
    v_mul_f32_e64 v247, s42, v247
    v_mfma_f32_16x16x32_bf16 v[156:159], v[236:239], v[232:235], v[156:159]
    v_mul_f32 v245, v245, v244
    v_mul_f32_e64 v247, v247, v246
    s_waitcnt lgkmcnt(3)
    v_mfma_f32_16x16x32_bf16 v[88:91], v[168:171], v[160:163], v[88:91]
    ds_read_b128 v[204:207], v197 offset:37888
    v_mfma_f32_16x16x32_bf16 v[92:95], v[168:171], v[164:167], v[92:95]
    ds_read_b128 v[208:211], v197 offset:39936
    v_mfma_f32_16x16x32_bf16 v[96:99], v[172:175], v[160:163], v[96:99]
    ds_read_b128 v[212:215], v199 offset:46080
    v_mfma_f32_16x16x32_bf16 v[100:103], v[172:175], v[164:167], v[100:103]
    ds_read_b128 v[216:219], v199 offset:47104
    v_mfma_f32_16x16x32_bf16 v[104:107], v[176:179], v[160:163], v[104:107]
    ds_read_b128 v[220:223], v199 offset:48128
    v_mfma_f32_16x16x32_bf16 v[108:111], v[176:179], v[164:167], v[108:111]
    ds_read_b128 v[224:227], v199 offset:49152
    v_mfma_f32_16x16x32_bf16 v[112:115], v[180:183], v[160:163], v[112:115]
    ds_read_b128 v[228:231], v0 offset:37888
    v_mfma_f32_16x16x32_bf16 v[116:119], v[180:183], v[164:167], v[116:119]
    ds_read_b128 v[232:235], v0 offset:39936
    s_waitcnt lgkmcnt(8)
    v_mfma_f32_16x16x32_bf16 v[120:123], v[168:171], v[184:187], v[120:123]
    ds_read_b128 v[236:239], v2 offset:54272
    v_mfma_f32_16x16x32_bf16 v[124:127], v[168:171], v[188:191], v[124:127]
    v_bfe_u32 v202, v1, 4, 4
    v_mfma_f32_16x16x32_bf16 v[128:131], v[172:175], v[184:187], v[128:131]
    v_lshrrev_b32 v200, 1, v202
    v_mfma_f32_16x16x32_bf16 v[132:135], v[172:175], v[188:191], v[132:135]
    v_lshrrev_b32_e64 v201, 8, v1
    v_mfma_f32_16x16x32_bf16 v[136:139], v[176:179], v[184:187], v[136:139]
    v_xor_b32_e64 v200, v200, v201
    v_mfma_f32_16x16x32_bf16 v[140:143], v[176:179], v[188:191], v[140:143]
    v_lshlrev_b32_e64 v200, 4, v200
    v_mfma_f32_16x16x32_bf16 v[144:147], v[180:183], v[184:187], v[144:147]
    v_lshl_add_u32 v200, v202, 7, v200
    v_mfma_f32_16x16x32_bf16 v[148:151], v[180:183], v[188:191], v[148:151]
    s_xor_b32 s33, s30, 4096
    v_mfma_f32_16x16x32_bf16 v[152:155], v[192:195], v[184:187], v[152:155]
    s_add_u32 s33, s33, 18432
    v_mfma_f32_16x16x32_bf16 v[156:159], v[192:195], v[188:191], v[156:159]
    v_add_u32 v200, s33, v200
    v_xor_b32 v201, 64, v200
    s_waitcnt lgkmcnt(0)
    s_barrier
    v_mfma_f32_16x16x32_bf16 v[88:91], v[212:215], v[204:207], v[88:91]
    ds_read_b128 v[160:163], v196 offset:0
    v_mfma_f32_16x16x32_bf16 v[92:95], v[212:215], v[208:211], v[92:95]
    ds_read_b128 v[164:167], v196 offset:2048
    v_mfma_f32_16x16x32_bf16 v[96:99], v[216:219], v[204:207], v[96:99]
    ds_read_b128 v[168:171], v198 offset:0
    v_mfma_f32_16x16x32_bf16 v[100:103], v[216:219], v[208:211], v[100:103]
    ds_read_b128 v[172:175], v198 offset:1024
    v_mfma_f32_16x16x32_bf16 v[104:107], v[220:223], v[204:207], v[104:107]
    ds_read_b128 v[176:179], v198 offset:2048
    v_mfma_f32_16x16x32_bf16 v[108:111], v[220:223], v[208:211], v[108:111]
    ds_read_b128 v[180:183], v198 offset:3072
    v_mfma_f32_16x16x32_bf16 v[112:115], v[224:227], v[204:207], v[112:115]
    ds_read_b128 v[184:187], v3 offset:0
    v_mfma_f32_16x16x32_bf16 v[116:119], v[224:227], v[208:211], v[116:119]
    ds_read_b128 v[188:191], v3 offset:2048
    v_mfma_f32_16x16x32_bf16 v[120:123], v[212:215], v[228:231], v[120:123]
    ds_read_b128 v[192:195], v1 offset:8192
    v_mfma_f32_16x16x32_bf16 v[124:127], v[212:215], v[232:235], v[124:127]
    v_add_u32 v202, 73728, v200
    v_mfma_f32_16x16x32_bf16 v[128:131], v[216:219], v[228:231], v[128:131]
    v_add_u32 v203, 73728, v201
    v_mfma_f32_16x16x32_bf16 v[132:135], v[216:219], v[232:235], v[132:135]
    v_mfma_f32_16x16x32_bf16 v[136:139], v[220:223], v[228:231], v[136:139]
    v_mfma_f32_16x16x32_bf16 v[140:143], v[220:223], v[232:235], v[140:143]
    v_mfma_f32_16x16x32_bf16 v[144:147], v[224:227], v[228:231], v[144:147]
    v_mfma_f32_16x16x32_bf16 v[148:151], v[224:227], v[232:235], v[148:151]
    v_mfma_f32_16x16x32_bf16 v[152:155], v[236:239], v[228:231], v[152:155]
    v_mfma_f32_16x16x32_bf16 v[156:159], v[236:239], v[232:235], v[156:159]
    s_waitcnt lgkmcnt(3)
    v_mfma_f32_16x16x32_bf16 v[88:91], v[168:171], v[160:163], v[88:91]
    ds_read_b128 v[204:207], v196 offset:1024
    v_mfma_f32_16x16x32_bf16 v[92:95], v[168:171], v[164:167], v[92:95]
    ds_read_b128 v[208:211], v196 offset:3072
    v_mfma_f32_16x16x32_bf16 v[96:99], v[172:175], v[160:163], v[96:99]
    ds_read_b128 v[212:215], v198 offset:9216
    v_mfma_f32_16x16x32_bf16 v[100:103], v[172:175], v[164:167], v[100:103]
    ds_read_b128 v[216:219], v198 offset:10240
    v_mfma_f32_16x16x32_bf16 v[104:107], v[176:179], v[160:163], v[104:107]
    ds_read_b128 v[220:223], v198 offset:11264
    v_mfma_f32_16x16x32_bf16 v[108:111], v[176:179], v[164:167], v[108:111]
    ds_read_b128 v[224:227], v198 offset:12288
    v_mfma_f32_16x16x32_bf16 v[112:115], v[180:183], v[160:163], v[112:115]
    ds_read_b128 v[228:231], v3 offset:1024
    v_mfma_f32_16x16x32_bf16 v[116:119], v[180:183], v[164:167], v[116:119]
    ds_read_b128 v[232:235], v3 offset:3072
    s_waitcnt lgkmcnt(8)
    v_mfma_f32_16x16x32_bf16 v[120:123], v[168:171], v[184:187], v[120:123]
    ds_read_b128 v[236:239], v1 offset:17408
    v_mfma_f32_16x16x32_bf16 v[124:127], v[168:171], v[188:191], v[124:127]
    v_mfma_f32_16x16x32_bf16 v[128:131], v[172:175], v[184:187], v[128:131]
    v_mfma_f32_16x16x32_bf16 v[132:135], v[172:175], v[188:191], v[132:135]
    v_mfma_f32_16x16x32_bf16 v[136:139], v[176:179], v[184:187], v[136:139]
    v_mfma_f32_16x16x32_bf16 v[140:143], v[176:179], v[188:191], v[140:143]
    v_mfma_f32_16x16x32_bf16 v[144:147], v[180:183], v[184:187], v[144:147]
    v_mfma_f32_16x16x32_bf16 v[148:151], v[180:183], v[188:191], v[148:151]
    v_mfma_f32_16x16x32_bf16 v[152:155], v[192:195], v[184:187], v[152:155]
    v_mfma_f32_16x16x32_bf16 v[156:159], v[192:195], v[188:191], v[156:159]
    s_waitcnt lgkmcnt(0)
    s_barrier
    v_mfma_f32_16x16x32_bf16 v[88:91], v[212:215], v[204:207], v[88:91]
    ds_read_b128 v[160:163], v196 offset:36864
    v_mfma_f32_16x16x32_bf16 v[92:95], v[212:215], v[208:211], v[92:95]
    ds_read_b128 v[164:167], v196 offset:38912
    v_mfma_f32_16x16x32_bf16 v[96:99], v[216:219], v[204:207], v[96:99]
    ds_read_b128 v[168:171], v198 offset:36864
    v_mfma_f32_16x16x32_bf16 v[100:103], v[216:219], v[208:211], v[100:103]
    ds_read_b128 v[172:175], v198 offset:37888
    v_mfma_f32_16x16x32_bf16 v[104:107], v[220:223], v[204:207], v[104:107]
    ds_read_b128 v[176:179], v198 offset:38912
    v_mfma_f32_16x16x32_bf16 v[108:111], v[220:223], v[208:211], v[108:111]
    ds_read_b128 v[180:183], v198 offset:39936
    v_mfma_f32_16x16x32_bf16 v[112:115], v[224:227], v[204:207], v[112:115]
    ds_read_b128 v[184:187], v3 offset:36864
    v_mfma_f32_16x16x32_bf16 v[116:119], v[224:227], v[208:211], v[116:119]
    ds_read_b128 v[188:191], v3 offset:38912
    v_mfma_f32_16x16x32_bf16 v[120:123], v[212:215], v[228:231], v[120:123]
    ds_read_b128 v[192:195], v1 offset:45056
    v_mfma_f32_16x16x32_bf16 v[124:127], v[212:215], v[232:235], v[124:127]
    ds_read_b128 v[4:7], v255 offset:1024
    v_mfma_f32_16x16x32_bf16 v[128:131], v[216:219], v[228:231], v[128:131]
    ds_read_b128 v[8:11], v255 offset:1040
    v_mfma_f32_16x16x32_bf16 v[132:135], v[216:219], v[232:235], v[132:135]
    ds_read_b128 v[12:15], v255 offset:1056
    v_mfma_f32_16x16x32_bf16 v[136:139], v[220:223], v[228:231], v[136:139]
    ds_read_b128 v[252:255], v255 offset:1072
    v_mfma_f32_16x16x32_bf16 v[140:143], v[220:223], v[232:235], v[140:143]
    v_mfma_f32_16x16x32_bf16 v[144:147], v[224:227], v[228:231], v[144:147]
    v_mfma_f32_16x16x32_bf16 v[148:151], v[224:227], v[232:235], v[148:151]
    v_mfma_f32_16x16x32_bf16 v[152:155], v[236:239], v[228:231], v[152:155]
    v_mfma_f32_16x16x32_bf16 v[156:159], v[236:239], v[232:235], v[156:159]
    s_waitcnt lgkmcnt(7)
    v_mfma_f32_16x16x32_bf16 v[88:91], v[168:171], v[160:163], v[88:91]
    ds_read_b128 v[204:207], v196 offset:37888
    v_mfma_f32_16x16x32_bf16 v[92:95], v[168:171], v[164:167], v[92:95]
    ds_read_b128 v[208:211], v196 offset:39936
    v_mfma_f32_16x16x32_bf16 v[96:99], v[172:175], v[160:163], v[96:99]
    ds_read_b128 v[212:215], v198 offset:46080
    v_mfma_f32_16x16x32_bf16 v[100:103], v[172:175], v[164:167], v[100:103]
    ds_read_b128 v[216:219], v198 offset:47104
    v_mfma_f32_16x16x32_bf16 v[104:107], v[176:179], v[160:163], v[104:107]
    ds_read_b128 v[220:223], v198 offset:48128
    v_mfma_f32_16x16x32_bf16 v[108:111], v[176:179], v[164:167], v[108:111]
    ds_read_b128 v[224:227], v198 offset:49152
    v_mfma_f32_16x16x32_bf16 v[112:115], v[180:183], v[160:163], v[112:115]
    ds_read_b128 v[228:231], v3 offset:37888
    v_mfma_f32_16x16x32_bf16 v[116:119], v[180:183], v[164:167], v[116:119]
    ds_read_b128 v[232:235], v3 offset:39936
    s_waitcnt lgkmcnt(8)
    v_mfma_f32_16x16x32_bf16 v[120:123], v[168:171], v[184:187], v[120:123]
    ds_read_b128 v[236:239], v1 offset:54272
    v_fma_f32 v16, v16, v4, -v6
    v_mfma_f32_16x16x32_bf16 v[124:127], v[168:171], v[188:191], v[124:127]
    v_fma_f32 v17, v17, v5, -v7
    v_fma_f32 v18, v18, v8, -v10
    v_mfma_f32_16x16x32_bf16 v[128:131], v[172:175], v[184:187], v[128:131]
    v_fma_f32 v19, v19, v9, -v11
    v_fma_f32 v20, v20, v12, -v14
    v_mfma_f32_16x16x32_bf16 v[132:135], v[172:175], v[188:191], v[132:135]
    v_fma_f32 v21, v21, v13, -v15
    v_fma_f32 v22, v22, v252, -v254
    v_mfma_f32_16x16x32_bf16 v[136:139], v[176:179], v[184:187], v[136:139]
    v_fma_f32 v23, v23, v253, -v255
    v_cvt_pk_bf16_f32 v16, v16, v17
    v_mfma_f32_16x16x32_bf16 v[140:143], v[176:179], v[188:191], v[140:143]
    v_cvt_pk_bf16_f32 v17, v18, v19
    v_cvt_pk_bf16_f32 v18, v20, v21
    v_mfma_f32_16x16x32_bf16 v[144:147], v[180:183], v[184:187], v[144:147]
    v_cvt_pk_bf16_f32 v19, v22, v23
    v_fma_f32 v24, v24, v4, -v6
    v_mfma_f32_16x16x32_bf16 v[148:151], v[180:183], v[188:191], v[148:151]
    v_fma_f32 v25, v25, v5, -v7
    v_fma_f32 v26, v26, v8, -v10
    v_mfma_f32_16x16x32_bf16 v[152:155], v[192:195], v[184:187], v[152:155]
    v_fma_f32 v27, v27, v9, -v11
    v_fma_f32 v28, v28, v12, -v14
    v_mfma_f32_16x16x32_bf16 v[156:159], v[192:195], v[188:191], v[156:159]
    v_fma_f32 v29, v29, v13, -v15
    s_waitcnt lgkmcnt(0)
    s_barrier
    v_mfma_f32_16x16x32_bf16 v[88:91], v[212:215], v[204:207], v[88:91]
    ds_read_b128 v[160:163], v197 offset:0
    v_mfma_f32_16x16x32_bf16 v[92:95], v[212:215], v[208:211], v[92:95]
    ds_read_b128 v[164:167], v197 offset:2048
    v_fma_f32 v30, v30, v252, -v254
    v_mfma_f32_16x16x32_bf16 v[96:99], v[216:219], v[204:207], v[96:99]
    ds_read_b128 v[168:171], v199 offset:0
    v_fma_f32 v31, v31, v253, -v255
    v_mfma_f32_16x16x32_bf16 v[100:103], v[216:219], v[208:211], v[100:103]
    ds_read_b128 v[172:175], v199 offset:1024
    v_permlane32_swap_b32 v16, v18
    v_mfma_f32_16x16x32_bf16 v[104:107], v[220:223], v[204:207], v[104:107]
    ds_read_b128 v[176:179], v199 offset:2048
    v_permlane32_swap_b32 v17, v19
    v_mfma_f32_16x16x32_bf16 v[108:111], v[220:223], v[208:211], v[108:111]
    ds_read_b128 v[180:183], v199 offset:3072
    v_cvt_pk_bf16_f32 v24, v24, v25
    v_mfma_f32_16x16x32_bf16 v[112:115], v[224:227], v[204:207], v[112:115]
    ds_read_b128 v[184:187], v0 offset:0
    v_cvt_pk_bf16_f32 v25, v26, v27
    v_mfma_f32_16x16x32_bf16 v[116:119], v[224:227], v[208:211], v[116:119]
    ds_read_b128 v[188:191], v0 offset:2048
    v_mfma_f32_16x16x32_bf16 v[120:123], v[212:215], v[228:231], v[120:123]
    ds_read_b128 v[192:195], v2 offset:8192
    v_cvt_pk_bf16_f32 v26, v28, v29
    v_mfma_f32_16x16x32_bf16 v[124:127], v[212:215], v[232:235], v[124:127]
    v_cvt_pk_bf16_f32 v27, v30, v31
    v_permlane16_swap_b32 v16, v18
    v_mfma_f32_16x16x32_bf16 v[128:131], v[216:219], v[228:231], v[128:131]
    v_permlane16_swap_b32 v17, v19
    v_fma_f32 v32, v32, v4, -v6
    v_mfma_f32_16x16x32_bf16 v[132:135], v[216:219], v[232:235], v[132:135]
    v_fma_f32 v33, v33, v5, -v7
    v_fma_f32 v34, v34, v8, -v10
    v_mfma_f32_16x16x32_bf16 v[136:139], v[220:223], v[228:231], v[136:139]
    v_fma_f32 v35, v35, v9, -v11
    v_fma_f32 v36, v36, v12, -v14
    v_mfma_f32_16x16x32_bf16 v[140:143], v[220:223], v[232:235], v[140:143]
    v_fma_f32 v37, v37, v13, -v15
    v_fma_f32 v38, v38, v252, -v254
    v_mfma_f32_16x16x32_bf16 v[144:147], v[224:227], v[228:231], v[144:147]
    v_fma_f32 v39, v39, v253, -v255
    v_permlane32_swap_b32 v24, v26
    v_mfma_f32_16x16x32_bf16 v[148:151], v[224:227], v[232:235], v[148:151]
    v_permlane32_swap_b32 v25, v27
    v_cvt_pk_bf16_f32 v32, v32, v33
    v_mfma_f32_16x16x32_bf16 v[152:155], v[236:239], v[228:231], v[152:155]
    v_cvt_pk_bf16_f32 v33, v34, v35
    v_cvt_pk_bf16_f32 v34, v36, v37
    v_mfma_f32_16x16x32_bf16 v[156:159], v[236:239], v[232:235], v[156:159]
    v_cvt_pk_bf16_f32 v35, v38, v39
    s_waitcnt lgkmcnt(3)
    v_mfma_f32_16x16x32_bf16 v[88:91], v[168:171], v[160:163], v[88:91]
    ds_read_b128 v[204:207], v197 offset:1024
    v_mfma_f32_16x16x32_bf16 v[92:95], v[168:171], v[164:167], v[92:95]
    ds_read_b128 v[208:211], v197 offset:3072
    v_permlane16_swap_b32 v24, v26
    v_mfma_f32_16x16x32_bf16 v[96:99], v[172:175], v[160:163], v[96:99]
    ds_read_b128 v[212:215], v199 offset:9216
    v_permlane16_swap_b32 v25, v27
    v_mfma_f32_16x16x32_bf16 v[100:103], v[172:175], v[164:167], v[100:103]
    ds_read_b128 v[216:219], v199 offset:10240
    v_fma_f32 v40, v40, v4, -v6
    v_mfma_f32_16x16x32_bf16 v[104:107], v[176:179], v[160:163], v[104:107]
    ds_read_b128 v[220:223], v199 offset:11264
    v_fma_f32 v41, v41, v5, -v7
    v_mfma_f32_16x16x32_bf16 v[108:111], v[176:179], v[164:167], v[108:111]
    ds_read_b128 v[224:227], v199 offset:12288
    v_fma_f32 v42, v42, v8, -v10
    v_mfma_f32_16x16x32_bf16 v[112:115], v[180:183], v[160:163], v[112:115]
    ds_read_b128 v[228:231], v0 offset:1024
    v_fma_f32 v43, v43, v9, -v11
    v_mfma_f32_16x16x32_bf16 v[116:119], v[180:183], v[164:167], v[116:119]
    ds_read_b128 v[232:235], v0 offset:3072
    s_waitcnt lgkmcnt(8)
    v_mfma_f32_16x16x32_bf16 v[120:123], v[168:171], v[184:187], v[120:123]
    ds_read_b128 v[236:239], v2 offset:17408
    v_fma_f32 v44, v44, v12, -v14
    v_mfma_f32_16x16x32_bf16 v[124:127], v[168:171], v[188:191], v[124:127]
    v_fma_f32 v45, v45, v13, -v15
    v_fma_f32 v46, v46, v252, -v254
    v_mfma_f32_16x16x32_bf16 v[128:131], v[172:175], v[184:187], v[128:131]
    v_fma_f32 v47, v47, v253, -v255
    v_permlane32_swap_b32 v32, v34
    v_mfma_f32_16x16x32_bf16 v[132:135], v[172:175], v[188:191], v[132:135]
    v_permlane32_swap_b32 v33, v35
    v_cvt_pk_bf16_f32 v40, v40, v41
    v_mfma_f32_16x16x32_bf16 v[136:139], v[176:179], v[184:187], v[136:139]
    v_cvt_pk_bf16_f32 v41, v42, v43
    v_cvt_pk_bf16_f32 v42, v44, v45
    v_mfma_f32_16x16x32_bf16 v[140:143], v[176:179], v[188:191], v[140:143]
    v_cvt_pk_bf16_f32 v43, v46, v47
    v_permlane16_swap_b32 v32, v34
    v_mfma_f32_16x16x32_bf16 v[144:147], v[180:183], v[184:187], v[144:147]
    v_permlane16_swap_b32 v33, v35
    v_fma_f32 v48, v48, v4, -v6
    v_mfma_f32_16x16x32_bf16 v[148:151], v[180:183], v[188:191], v[148:151]
    v_fma_f32 v49, v49, v5, -v7
    v_fma_f32 v50, v50, v8, -v10
    v_mfma_f32_16x16x32_bf16 v[152:155], v[192:195], v[184:187], v[152:155]
    v_fma_f32 v51, v51, v9, -v11
    v_fma_f32 v52, v52, v12, -v14
    v_mfma_f32_16x16x32_bf16 v[156:159], v[192:195], v[188:191], v[156:159]
    v_fma_f32 v53, v53, v13, -v15
    s_waitcnt lgkmcnt(0)
    s_barrier
    v_mfma_f32_16x16x32_bf16 v[88:91], v[212:215], v[204:207], v[88:91]
    ds_read_b128 v[160:163], v197 offset:36864
    v_mfma_f32_16x16x32_bf16 v[92:95], v[212:215], v[208:211], v[92:95]
    ds_read_b128 v[164:167], v197 offset:38912
    v_fma_f32 v54, v54, v252, -v254
    v_mfma_f32_16x16x32_bf16 v[96:99], v[216:219], v[204:207], v[96:99]
    ds_read_b128 v[168:171], v199 offset:36864
    v_fma_f32 v55, v55, v253, -v255
    v_mfma_f32_16x16x32_bf16 v[100:103], v[216:219], v[208:211], v[100:103]
    ds_read_b128 v[172:175], v199 offset:37888
    v_permlane32_swap_b32 v40, v42
    v_mfma_f32_16x16x32_bf16 v[104:107], v[220:223], v[204:207], v[104:107]
    ds_read_b128 v[176:179], v199 offset:38912
    v_permlane32_swap_b32 v41, v43
    v_mfma_f32_16x16x32_bf16 v[108:111], v[220:223], v[208:211], v[108:111]
    ds_read_b128 v[180:183], v199 offset:39936
    v_cvt_pk_bf16_f32 v48, v48, v49
    v_mfma_f32_16x16x32_bf16 v[112:115], v[224:227], v[204:207], v[112:115]
    ds_read_b128 v[184:187], v0 offset:36864
    v_cvt_pk_bf16_f32 v49, v50, v51
    v_mfma_f32_16x16x32_bf16 v[116:119], v[224:227], v[208:211], v[116:119]
    ds_read_b128 v[188:191], v0 offset:38912
    v_mfma_f32_16x16x32_bf16 v[120:123], v[212:215], v[228:231], v[120:123]
    ds_read_b128 v[192:195], v2 offset:45056
    v_cvt_pk_bf16_f32 v50, v52, v53
    v_mfma_f32_16x16x32_bf16 v[124:127], v[212:215], v[232:235], v[124:127]
    v_cvt_pk_bf16_f32 v51, v54, v55
    v_permlane16_swap_b32 v40, v42
    v_mfma_f32_16x16x32_bf16 v[128:131], v[216:219], v[228:231], v[128:131]
    v_permlane16_swap_b32 v41, v43
    v_fma_f32 v56, v56, v4, -v6
    v_mfma_f32_16x16x32_bf16 v[132:135], v[216:219], v[232:235], v[132:135]
    v_fma_f32 v57, v57, v5, -v7
    v_fma_f32 v58, v58, v8, -v10
    v_mfma_f32_16x16x32_bf16 v[136:139], v[220:223], v[228:231], v[136:139]
    v_fma_f32 v59, v59, v9, -v11
    v_fma_f32 v60, v60, v12, -v14
    v_mfma_f32_16x16x32_bf16 v[140:143], v[220:223], v[232:235], v[140:143]
    v_fma_f32 v61, v61, v13, -v15
    v_fma_f32 v62, v62, v252, -v254
    v_mfma_f32_16x16x32_bf16 v[144:147], v[224:227], v[228:231], v[144:147]
    v_fma_f32 v63, v63, v253, -v255
    v_permlane32_swap_b32 v48, v50
    v_mfma_f32_16x16x32_bf16 v[148:151], v[224:227], v[232:235], v[148:151]
    v_permlane32_swap_b32 v49, v51
    v_cvt_pk_bf16_f32 v56, v56, v57
    v_mfma_f32_16x16x32_bf16 v[152:155], v[236:239], v[228:231], v[152:155]
    v_cvt_pk_bf16_f32 v57, v58, v59
    v_cvt_pk_bf16_f32 v58, v60, v61
    v_mfma_f32_16x16x32_bf16 v[156:159], v[236:239], v[232:235], v[156:159]
    v_cvt_pk_bf16_f32 v59, v62, v63
    s_waitcnt lgkmcnt(3)
    v_mfma_f32_16x16x32_bf16 v[88:91], v[168:171], v[160:163], v[88:91]
    ds_read_b128 v[204:207], v197 offset:37888
    v_mfma_f32_16x16x32_bf16 v[92:95], v[168:171], v[164:167], v[92:95]
    ds_read_b128 v[208:211], v197 offset:39936
    v_permlane16_swap_b32 v48, v50
    v_mfma_f32_16x16x32_bf16 v[96:99], v[172:175], v[160:163], v[96:99]
    ds_read_b128 v[212:215], v199 offset:46080
    buffer_store_dwordx4 v[16:19], v1, s[4:7], s38 offen offset:0 sc1
    v_permlane16_swap_b32 v49, v51
    v_mfma_f32_16x16x32_bf16 v[100:103], v[172:175], v[164:167], v[100:103]
    ds_read_b128 v[216:219], v199 offset:47104
    v_fma_f32 v64, v64, v4, -v6
    v_mfma_f32_16x16x32_bf16 v[104:107], v[176:179], v[160:163], v[104:107]
    ds_read_b128 v[220:223], v199 offset:48128
    v_fma_f32 v65, v65, v5, -v7
    v_mfma_f32_16x16x32_bf16 v[108:111], v[176:179], v[164:167], v[108:111]
    ds_read_b128 v[224:227], v199 offset:49152
    v_fma_f32 v66, v66, v8, -v10
    v_mfma_f32_16x16x32_bf16 v[112:115], v[180:183], v[160:163], v[112:115]
    ds_read_b128 v[228:231], v0 offset:37888
    v_fma_f32 v67, v67, v9, -v11
    v_mfma_f32_16x16x32_bf16 v[116:119], v[180:183], v[164:167], v[116:119]
    ds_read_b128 v[232:235], v0 offset:39936
    s_waitcnt lgkmcnt(8)
    buffer_store_dwordx4 v[24:27], v1, s[4:7], s38 offen offset:1024 sc1
    v_mfma_f32_16x16x32_bf16 v[120:123], v[168:171], v[184:187], v[120:123]
    ds_read_b128 v[236:239], v2 offset:54272
    v_fma_f32 v68, v68, v12, -v14
    v_mfma_f32_16x16x32_bf16 v[124:127], v[168:171], v[188:191], v[124:127]
    v_fma_f32 v69, v69, v13, -v15
    v_fma_f32 v70, v70, v252, -v254
    v_mfma_f32_16x16x32_bf16 v[128:131], v[172:175], v[184:187], v[128:131]
    v_fma_f32 v71, v71, v253, -v255
    v_permlane32_swap_b32 v56, v58
    v_mfma_f32_16x16x32_bf16 v[132:135], v[172:175], v[188:191], v[132:135]
    v_permlane32_swap_b32 v57, v59
    v_cvt_pk_bf16_f32 v64, v64, v65
    v_mfma_f32_16x16x32_bf16 v[136:139], v[176:179], v[184:187], v[136:139]
    buffer_store_dwordx4 v[32:35], v1, s[4:7], s38 offen offset:2048 sc1
    v_cvt_pk_bf16_f32 v65, v66, v67
    v_cvt_pk_bf16_f32 v66, v68, v69
    v_mfma_f32_16x16x32_bf16 v[140:143], v[176:179], v[188:191], v[140:143]
    v_cvt_pk_bf16_f32 v67, v70, v71
    v_permlane16_swap_b32 v56, v58
    v_mfma_f32_16x16x32_bf16 v[144:147], v[180:183], v[184:187], v[144:147]
    v_permlane16_swap_b32 v57, v59
    v_fma_f32 v72, v72, v4, -v6
    v_mfma_f32_16x16x32_bf16 v[148:151], v[180:183], v[188:191], v[148:151]
    v_fma_f32 v73, v73, v5, -v7
    v_fma_f32 v74, v74, v8, -v10
    v_mfma_f32_16x16x32_bf16 v[152:155], v[192:195], v[184:187], v[152:155]
    v_fma_f32 v75, v75, v9, -v11
    v_fma_f32 v76, v76, v12, -v14
    v_mfma_f32_16x16x32_bf16 v[156:159], v[192:195], v[188:191], v[156:159]
    v_fma_f32 v77, v77, v13, -v15
    s_waitcnt lgkmcnt(0)
    s_barrier
    v_mfma_f32_16x16x32_bf16 v[88:91], v[212:215], v[204:207], v[88:91]
    ds_read_b128 v[160:163], v196 offset:0
    v_mfma_f32_16x16x32_bf16 v[92:95], v[212:215], v[208:211], v[92:95]
    ds_read_b128 v[164:167], v196 offset:2048
    v_fma_f32 v78, v78, v252, -v254
    v_mfma_f32_16x16x32_bf16 v[96:99], v[216:219], v[204:207], v[96:99]
    ds_read_b128 v[168:171], v198 offset:0
    buffer_store_dwordx4 v[40:43], v1, s[4:7], s38 offen offset:3072 sc1
    v_fma_f32 v79, v79, v253, -v255
    v_mfma_f32_16x16x32_bf16 v[100:103], v[216:219], v[208:211], v[100:103]
    ds_read_b128 v[172:175], v198 offset:1024
    v_permlane32_swap_b32 v64, v66
    v_mfma_f32_16x16x32_bf16 v[104:107], v[220:223], v[204:207], v[104:107]
    ds_read_b128 v[176:179], v198 offset:2048
    v_permlane32_swap_b32 v65, v67
    v_mfma_f32_16x16x32_bf16 v[108:111], v[220:223], v[208:211], v[108:111]
    ds_read_b128 v[180:183], v198 offset:3072
    v_cvt_pk_bf16_f32 v72, v72, v73
    v_mfma_f32_16x16x32_bf16 v[112:115], v[224:227], v[204:207], v[112:115]
    ds_read_b128 v[184:187], v3 offset:0
    v_cvt_pk_bf16_f32 v73, v74, v75
    v_mfma_f32_16x16x32_bf16 v[116:119], v[224:227], v[208:211], v[116:119]
    ds_read_b128 v[188:191], v3 offset:2048
    buffer_store_dwordx4 v[48:51], v1, s[4:7], s39 offen offset:0 sc1
    v_mfma_f32_16x16x32_bf16 v[120:123], v[212:215], v[228:231], v[120:123]
    ds_read_b128 v[192:195], v1 offset:8192
    v_cvt_pk_bf16_f32 v74, v76, v77
    v_mfma_f32_16x16x32_bf16 v[124:127], v[212:215], v[232:235], v[124:127]
    v_cvt_pk_bf16_f32 v75, v78, v79
    v_permlane16_swap_b32 v64, v66
    v_mfma_f32_16x16x32_bf16 v[128:131], v[216:219], v[228:231], v[128:131]
    v_permlane16_swap_b32 v65, v67
    v_fma_f32 v80, v80, v4, -v6
    v_mfma_f32_16x16x32_bf16 v[132:135], v[216:219], v[232:235], v[132:135]
    v_fma_f32 v81, v81, v5, -v7
    v_fma_f32 v82, v82, v8, -v10
    v_mfma_f32_16x16x32_bf16 v[136:139], v[220:223], v[228:231], v[136:139]
    buffer_store_dwordx4 v[56:59], v1, s[4:7], s39 offen offset:1024 sc1
    v_fma_f32 v83, v83, v9, -v11
    v_fma_f32 v84, v84, v12, -v14
    v_mfma_f32_16x16x32_bf16 v[140:143], v[220:223], v[232:235], v[140:143]
    v_fma_f32 v85, v85, v13, -v15
    v_fma_f32 v86, v86, v252, -v254
    v_mfma_f32_16x16x32_bf16 v[144:147], v[224:227], v[228:231], v[144:147]
    v_fma_f32 v87, v87, v253, -v255
    v_permlane32_swap_b32 v72, v74
    v_mfma_f32_16x16x32_bf16 v[148:151], v[224:227], v[232:235], v[148:151]
    v_permlane32_swap_b32 v73, v75
    v_cvt_pk_bf16_f32 v80, v80, v81
    v_mfma_f32_16x16x32_bf16 v[152:155], v[236:239], v[228:231], v[152:155]
    v_cvt_pk_bf16_f32 v81, v82, v83
    v_cvt_pk_bf16_f32 v82, v84, v85
    v_mfma_f32_16x16x32_bf16 v[156:159], v[236:239], v[232:235], v[156:159]
    v_cvt_pk_bf16_f32 v83, v86, v87
    s_waitcnt lgkmcnt(3)
    v_mfma_f32_16x16x32_bf16 v[88:91], v[168:171], v[160:163], v[88:91]
    ds_read_b128 v[204:207], v196 offset:1024
    v_mfma_f32_16x16x32_bf16 v[92:95], v[168:171], v[164:167], v[92:95]
    ds_read_b128 v[208:211], v196 offset:3072
    v_permlane16_swap_b32 v72, v74
    v_mfma_f32_16x16x32_bf16 v[96:99], v[172:175], v[160:163], v[96:99]
    ds_read_b128 v[212:215], v198 offset:9216
    buffer_store_dwordx4 v[64:67], v1, s[4:7], s39 offen offset:2048 sc1
    v_permlane16_swap_b32 v73, v75
    v_mfma_f32_16x16x32_bf16 v[100:103], v[172:175], v[164:167], v[100:103]
    ds_read_b128 v[216:219], v198 offset:10240
    s_nop 0
    v_mfma_f32_16x16x32_bf16 v[104:107], v[176:179], v[160:163], v[104:107]
    ds_read_b128 v[220:223], v198 offset:11264
    v_permlane32_swap_b32 v80, v82
    v_mfma_f32_16x16x32_bf16 v[108:111], v[176:179], v[164:167], v[108:111]
    ds_read_b128 v[224:227], v198 offset:12288
    v_permlane32_swap_b32 v81, v83
    v_mfma_f32_16x16x32_bf16 v[112:115], v[180:183], v[160:163], v[112:115]
    ds_read_b128 v[228:231], v3 offset:1024
    s_nop 0
    v_mfma_f32_16x16x32_bf16 v[116:119], v[180:183], v[164:167], v[116:119]
    ds_read_b128 v[232:235], v3 offset:3072
    s_waitcnt lgkmcnt(8)
    v_mfma_f32_16x16x32_bf16 v[120:123], v[168:171], v[184:187], v[120:123]
    ds_read_b128 v[236:239], v1 offset:17408
    v_permlane16_swap_b32 v80, v82
    v_mfma_f32_16x16x32_bf16 v[124:127], v[168:171], v[188:191], v[124:127]
    v_permlane16_swap_b32 v81, v83
    v_mul_f32_e64 v4, s40, v249
    v_mfma_f32_16x16x32_bf16 v[128:131], v[172:175], v[184:187], v[128:131]
    v_mul_f32 v6, s40, v251
    v_mul_f32 v5, v249, v249
    v_mfma_f32_16x16x32_bf16 v[132:135], v[172:175], v[188:191], v[132:135]
    v_mul_f32 v7, v251, v251
    v_rcp_f32 v249, v249
    v_mfma_f32_16x16x32_bf16 v[136:139], v[176:179], v[184:187], v[136:139]
    v_rcp_f32 v251, v251
    v_mul_f32 v5, s42, v5
    v_mfma_f32_16x16x32_bf16 v[140:143], v[176:179], v[188:191], v[140:143]
    v_mul_f32 v7, s42, v7
    v_mul_f32 v5, v5, v4
    v_mfma_f32_16x16x32_bf16 v[144:147], v[180:183], v[184:187], v[144:147]
    v_mul_f32 v7, v7, v6
    v_subrev_u32 v8, s47, v200
    v_mfma_f32_16x16x32_bf16 v[148:151], v[180:183], v[188:191], v[148:151]
    v_subrev_u32 v9, s47, v201
    v_subrev_u32 v10, s47, v202
    v_mfma_f32_16x16x32_bf16 v[152:155], v[192:195], v[184:187], v[152:155]
    v_subrev_u32_e64 v11, s47, v203
    v_bfe_u32 v13, v1, 4, 4
    v_mfma_f32_16x16x32_bf16 v[156:159], v[192:195], v[188:191], v[156:159]
    s_lshl_b32 s33, s20, 6
    s_waitcnt lgkmcnt(0)
    s_barrier
    v_mfma_f32_16x16x32_bf16 v[88:91], v[212:215], v[204:207], v[88:91]
    ds_read_b128 v[160:163], v196 offset:36864
    v_mfma_f32_16x16x32_bf16 v[92:95], v[212:215], v[208:211], v[92:95]
    ds_read_b128 v[164:167], v196 offset:38912
    s_add_u32 s33, s33, 161280
    v_mfma_f32_16x16x32_bf16 v[96:99], v[216:219], v[204:207], v[96:99]
    ds_read_b128 v[168:171], v198 offset:36864
    buffer_store_dwordx4 v[72:75], v1, s[4:7], s39 offen offset:3072 sc1
    v_lshl_add_u32 v13, v13, 1, s33
    v_mfma_f32_16x16x32_bf16 v[100:103], v[216:219], v[208:211], v[100:103]
    ds_read_b128 v[172:175], v198 offset:37888
    v_xor_b32 v15, 64, v13
    v_mfma_f32_16x16x32_bf16 v[104:107], v[220:223], v[204:207], v[104:107]
    ds_read_b128 v[176:179], v198 offset:38912
    v_mfma_f32_16x16x32_bf16 v[108:111], v[220:223], v[208:211], v[108:111]
    ds_read_b128 v[180:183], v198 offset:39936
    v_mfma_f32_16x16x32_bf16 v[112:115], v[224:227], v[204:207], v[112:115]
    ds_read_b128 v[184:187], v3 offset:36864
    v_mfma_f32_16x16x32_bf16 v[116:119], v[224:227], v[208:211], v[116:119]
    ds_read_b128 v[188:191], v3 offset:38912
    buffer_store_dwordx4 v[80:83], v1, s[4:7], s46 offen offset:0 sc1
    v_mfma_f32_16x16x32_bf16 v[120:123], v[212:215], v[228:231], v[120:123]
    ds_read_b128 v[192:195], v1 offset:45056
    v_mfma_f32_16x16x32_bf16 v[124:127], v[212:215], v[232:235], v[124:127]
    v_mfma_f32_16x16x32_bf16 v[128:131], v[216:219], v[228:231], v[128:131]
    v_mfma_f32_16x16x32_bf16 v[132:135], v[216:219], v[232:235], v[132:135]
    v_mfma_f32_16x16x32_bf16 v[136:139], v[220:223], v[228:231], v[136:139]
    v_mfma_f32_16x16x32_bf16 v[140:143], v[220:223], v[232:235], v[140:143]
    v_mfma_f32_16x16x32_bf16 v[144:147], v[224:227], v[228:231], v[144:147]
    v_mfma_f32_16x16x32_bf16 v[148:151], v[224:227], v[232:235], v[148:151]
    v_mfma_f32_16x16x32_bf16 v[152:155], v[236:239], v[228:231], v[152:155]
    v_mfma_f32_16x16x32_bf16 v[156:159], v[236:239], v[232:235], v[156:159]
    s_waitcnt lgkmcnt(3)
    v_mfma_f32_16x16x32_bf16 v[88:91], v[168:171], v[160:163], v[88:91]
    ds_read_b128 v[204:207], v196 offset:37888
    v_mfma_f32_16x16x32_bf16 v[92:95], v[168:171], v[164:167], v[92:95]
    ds_read_b128 v[208:211], v196 offset:39936
    v_mfma_f32_16x16x32_bf16 v[96:99], v[172:175], v[160:163], v[96:99]
    ds_read_b128 v[212:215], v198 offset:46080
    v_mfma_f32_16x16x32_bf16 v[100:103], v[172:175], v[164:167], v[100:103]
    ds_read_b128 v[216:219], v198 offset:47104
    v_mfma_f32_16x16x32_bf16 v[104:107], v[176:179], v[160:163], v[104:107]
    ds_read_b128 v[220:223], v198 offset:48128
    v_mfma_f32_16x16x32_bf16 v[108:111], v[176:179], v[164:167], v[108:111]
    ds_read_b128 v[224:227], v198 offset:49152
    v_mfma_f32_16x16x32_bf16 v[112:115], v[180:183], v[160:163], v[112:115]
    ds_read_b128 v[228:231], v3 offset:37888
    v_mfma_f32_16x16x32_bf16 v[116:119], v[180:183], v[164:167], v[116:119]
    ds_read_b128 v[232:235], v3 offset:39936
    s_waitcnt lgkmcnt(8)
    v_mfma_f32_16x16x32_bf16 v[120:123], v[168:171], v[184:187], v[120:123]
    ds_read_b128 v[236:239], v1 offset:54272
    v_mfma_f32_16x16x32_bf16 v[124:127], v[168:171], v[188:191], v[124:127]
    v_mfma_f32_16x16x32_bf16 v[128:131], v[172:175], v[184:187], v[128:131]
    v_mfma_f32_16x16x32_bf16 v[132:135], v[172:175], v[188:191], v[132:135]
    s_lshr_b32 s35, s48, 4
    v_mfma_f32_16x16x32_bf16 v[136:139], v[176:179], v[184:187], v[136:139]
    v_lshrrev_b32 v0, 4, v1
    v_mfma_f32_16x16x32_bf16 v[140:143], v[176:179], v[188:191], v[140:143]
    v_and_b32_e64 v0, 48, v0
    v_mfma_f32_16x16x32_bf16 v[144:147], v[180:183], v[184:187], v[144:147]
    v_add_u32 v0, 160320, v0
    v_mfma_f32_16x16x32_bf16 v[148:151], v[180:183], v[188:191], v[148:151]
    v_add_u32_e64 v197, s35, v0
    v_mfma_f32_16x16x32_bf16 v[152:155], v[192:195], v[184:187], v[152:155]
    v_mfma_f32_16x16x32_bf16 v[156:159], v[192:195], v[188:191], v[156:159]
    s_waitcnt lgkmcnt(0)
    v_mfma_f32_16x16x32_bf16 v[88:91], v[212:215], v[204:207], v[88:91]
    ds_read_b128 v[168:171], v197 offset:0
    v_mfma_f32_16x16x32_bf16 v[92:95], v[212:215], v[208:211], v[92:95]
    ds_read_b128 v[172:175], v197 offset:64
    v_mfma_f32_16x16x32_bf16 v[96:99], v[216:219], v[204:207], v[96:99]
    ds_read_b128 v[176:179], v197 offset:128
    v_mfma_f32_16x16x32_bf16 v[100:103], v[216:219], v[208:211], v[100:103]
    ds_read_b128 v[180:183], v197 offset:192
    v_mfma_f32_16x16x32_bf16 v[104:107], v[220:223], v[204:207], v[104:107]
    ds_read_b128 v[184:187], v0 offset:512
    v_mfma_f32_16x16x32_bf16 v[108:111], v[220:223], v[208:211], v[108:111]
    ds_read_u16 v12, v13
    v_mfma_f32_16x16x32_bf16 v[112:115], v[224:227], v[204:207], v[112:115]
    ds_read_u16 v252, v13 offset:32
    v_mfma_f32_16x16x32_bf16 v[116:119], v[224:227], v[208:211], v[116:119]
    ds_read_u16 v160, v15
    v_mfma_f32_16x16x32_bf16 v[120:123], v[212:215], v[228:231], v[120:123]
    ds_read_u16 v161, v15 offset:32
    v_mfma_f32_16x16x32_bf16 v[124:127], v[212:215], v[232:235], v[124:127]
    v_mfma_f32_16x16x32_bf16 v[128:131], v[216:219], v[228:231], v[128:131]
    v_mfma_f32_16x16x32_bf16 v[132:135], v[216:219], v[232:235], v[132:135]
    v_mfma_f32_16x16x32_bf16 v[136:139], v[220:223], v[228:231], v[136:139]
    s_lshr_b32 s35, s20, 1
    s_mul_i32 s35, s35, 36864
    v_mfma_f32_16x16x32_bf16 v[140:143], v[220:223], v[232:235], v[140:143]
    s_and_b32 s34, s20, 1
    s_mul_i32 s34, s34, 9216
    v_mfma_f32_16x16x32_bf16 v[144:147], v[224:227], v[228:231], v[144:147]
    s_add_u32 s35, s35, s34
    v_mfma_f32_16x16x32_bf16 v[148:151], v[224:227], v[232:235], v[148:151]
    v_add_u32_e64 v3, s35, v2
    v_mfma_f32_16x16x32_bf16 v[152:155], v[236:239], v[228:231], v[152:155]
    v_mfma_f32_16x16x32_bf16 v[156:159], v[236:239], v[232:235], v[156:159]
    s_waitcnt vmcnt(0)
    s_barrier
    s_waitcnt lgkmcnt(0)
    v_lshlrev_b32 v15, 16, v12
    v_lshlrev_b32 v255, 16, v252
    v_lshlrev_b32 v235, 16, v160
    v_lshlrev_b32 v239, 16, v161
    v_lshlrev_b32 v14, 16, v12
    v_lshlrev_b32 v254, 16, v252
    v_lshlrev_b32 v234, 16, v160
    v_lshlrev_b32 v238, 16, v161
    v_lshlrev_b32 v13, 16, v12
    v_lshlrev_b32 v253, 16, v252
    v_lshlrev_b32 v233, 16, v160
    v_lshlrev_b32 v237, 16, v161
    v_lshlrev_b32 v12, 16, v12
    v_lshlrev_b32 v252, 16, v252
    v_lshlrev_b32 v232, 16, v160
    v_lshlrev_b32_e64 v236, 16, v161
L_g_z1:
    ds_write_b128 v3, v[16:19] offset:0
    v_pk_fma_f32 v[88:89], v[240:241], v[168:169], v[88:89] op_sel_hi:[0,1,1] neg_lo:[1,0,0] neg_hi:[1,0,0]
    v_pk_fma_f32 v[90:91], v[240:241], v[170:171], v[90:91] op_sel_hi:[0,1,1] neg_lo:[1,0,0] neg_hi:[1,0,0]
    v_pk_fma_f32 v[92:93], v[242:243], v[168:169], v[92:93] op_sel_hi:[0,1,1] neg_lo:[1,0,0] neg_hi:[1,0,0]
    v_pk_fma_f32 v[94:95], v[242:243], v[170:171], v[94:95] op_sel_hi:[0,1,1] neg_lo:[1,0,0] neg_hi:[1,0,0]
    ds_write_b128 v3, v[24:27] offset:1024
    v_pk_fma_f32 v[96:97], v[240:241], v[172:173], v[96:97] op_sel_hi:[0,1,1] neg_lo:[1,0,0] neg_hi:[1,0,0]
    v_pk_fma_f32 v[98:99], v[240:241], v[174:175], v[98:99] op_sel_hi:[0,1,1] neg_lo:[1,0,0] neg_hi:[1,0,0]
    v_pk_fma_f32 v[100:101], v[242:243], v[172:173], v[100:101] op_sel_hi:[0,1,1] neg_lo:[1,0,0] neg_hi:[1,0,0]
    v_pk_fma_f32 v[102:103], v[242:243], v[174:175], v[102:103] op_sel_hi:[0,1,1] neg_lo:[1,0,0] neg_hi:[1,0,0]
    ds_write_b128 v3, v[32:35] offset:2048
    v_pk_fma_f32 v[104:105], v[240:241], v[176:177], v[104:105] op_sel_hi:[0,1,1] neg_lo:[1,0,0] neg_hi:[1,0,0]
    v_pk_fma_f32 v[106:107], v[240:241], v[178:179], v[106:107] op_sel_hi:[0,1,1] neg_lo:[1,0,0] neg_hi:[1,0,0]
    v_pk_fma_f32 v[108:109], v[242:243], v[176:177], v[108:109] op_sel_hi:[0,1,1] neg_lo:[1,0,0] neg_hi:[1,0,0]
    v_pk_fma_f32 v[110:111], v[242:243], v[178:179], v[110:111] op_sel_hi:[0,1,1] neg_lo:[1,0,0] neg_hi:[1,0,0]
    ds_write_b128 v3, v[40:43] offset:3072
    v_pk_fma_f32 v[112:113], v[240:241], v[180:181], v[112:113] op_sel_hi:[0,1,1] neg_lo:[1,0,0] neg_hi:[1,0,0]
    v_pk_fma_f32 v[114:115], v[240:241], v[182:183], v[114:115] op_sel_hi:[0,1,1] neg_lo:[1,0,0] neg_hi:[1,0,0]
    v_pk_fma_f32 v[116:117], v[242:243], v[180:181], v[116:117] op_sel_hi:[0,1,1] neg_lo:[1,0,0] neg_hi:[1,0,0]
    v_pk_fma_f32 v[118:119], v[242:243], v[182:183], v[118:119] op_sel_hi:[0,1,1] neg_lo:[1,0,0] neg_hi:[1,0,0]
    ds_write_b128 v3, v[48:51] offset:4096
    v_pk_fma_f32 v[120:121], v[248:249], v[168:169], v[120:121] op_sel_hi:[0,1,1] neg_lo:[1,0,0] neg_hi:[1,0,0]
    v_pk_fma_f32 v[122:123], v[248:249], v[170:171], v[122:123] op_sel_hi:[0,1,1] neg_lo:[1,0,0] neg_hi:[1,0,0]
    v_pk_fma_f32 v[124:125], v[250:251], v[168:169], v[124:125] op_sel_hi:[0,1,1] neg_lo:[1,0,0] neg_hi:[1,0,0]
    v_pk_fma_f32 v[126:127], v[250:251], v[170:171], v[126:127] op_sel_hi:[0,1,1] neg_lo:[1,0,0] neg_hi:[1,0,0]
    ds_write_b128 v3, v[56:59] offset:5120
    v_pk_fma_f32 v[128:129], v[248:249], v[172:173], v[128:129] op_sel_hi:[0,1,1] neg_lo:[1,0,0] neg_hi:[1,0,0]
    v_pk_fma_f32 v[130:131], v[248:249], v[174:175], v[130:131] op_sel_hi:[0,1,1] neg_lo:[1,0,0] neg_hi:[1,0,0]
    v_pk_fma_f32 v[132:133], v[250:251], v[172:173], v[132:133] op_sel_hi:[0,1,1] neg_lo:[1,0,0] neg_hi:[1,0,0]
    v_pk_fma_f32 v[134:135], v[250:251], v[174:175], v[134:135] op_sel_hi:[0,1,1] neg_lo:[1,0,0] neg_hi:[1,0,0]
    ds_write_b128 v3, v[64:67] offset:6144
    v_pk_fma_f32 v[136:137], v[248:249], v[176:177], v[136:137] op_sel_hi:[0,1,1] neg_lo:[1,0,0] neg_hi:[1,0,0]
    v_pk_fma_f32 v[138:139], v[248:249], v[178:179], v[138:139] op_sel_hi:[0,1,1] neg_lo:[1,0,0] neg_hi:[1,0,0]
    v_pk_fma_f32 v[140:141], v[250:251], v[176:177], v[140:141] op_sel_hi:[0,1,1] neg_lo:[1,0,0] neg_hi:[1,0,0]
    v_pk_fma_f32 v[142:143], v[250:251], v[178:179], v[142:143] op_sel_hi:[0,1,1] neg_lo:[1,0,0] neg_hi:[1,0,0]
    ds_write_b128 v3, v[72:75] offset:7168
    v_pk_fma_f32 v[144:145], v[248:249], v[180:181], v[144:145] op_sel_hi:[0,1,1] neg_lo:[1,0,0] neg_hi:[1,0,0]
    v_pk_fma_f32 v[146:147], v[248:249], v[182:183], v[146:147] op_sel_hi:[0,1,1] neg_lo:[1,0,0] neg_hi:[1,0,0]
    v_pk_fma_f32 v[148:149], v[250:251], v[180:181], v[148:149] op_sel_hi:[0,1,1] neg_lo:[1,0,0] neg_hi:[1,0,0]
    v_pk_fma_f32 v[150:151], v[250:251], v[182:183], v[150:151] op_sel_hi:[0,1,1] neg_lo:[1,0,0] neg_hi:[1,0,0]
    ds_write_b128 v3, v[80:83] offset:8192
    v_pk_fma_f32 v[152:153], v[248:249], v[184:185], v[152:153] op_sel_hi:[0,1,1] neg_lo:[1,0,0] neg_hi:[1,0,0]
    v_pk_fma_f32 v[154:155], v[248:249], v[186:187], v[154:155] op_sel_hi:[0,1,1] neg_lo:[1,0,0] neg_hi:[1,0,0]
    v_pk_fma_f32 v[156:157], v[250:251], v[184:185], v[156:157] op_sel_hi:[0,1,1] neg_lo:[1,0,0] neg_hi:[1,0,0]
    v_pk_fma_f32 v[158:159], v[250:251], v[186:187], v[158:159] op_sel_hi:[0,1,1] neg_lo:[1,0,0] neg_hi:[1,0,0]
    v_pk_mul_f32 v[204:205], v[88:89], v[88:89]
    v_pk_mul_f32 v[206:207], v[90:91], v[90:91]
    v_pk_mul_f32 v[208:209], v[92:93], v[92:93]
    v_pk_mul_f32 v[210:211], v[94:95], v[94:95]
    v_pk_fma_f32 v[204:205], v[204:205], v[244:245], v[244:245] op_sel:[0,1,0] op_sel_hi:[1,1,0]
    v_pk_fma_f32 v[206:207], v[206:207], v[244:245], v[244:245] op_sel:[0,1,0] op_sel_hi:[1,1,0]
    v_pk_fma_f32 v[208:209], v[208:209], v[246:247], v[246:247] op_sel:[0,1,0] op_sel_hi:[1,1,0]
    v_pk_fma_f32 v[210:211], v[210:211], v[246:247], v[246:247] op_sel:[0,1,0] op_sel_hi:[1,1,0]
    v_pk_mul_f32 v[204:205], v[204:205], v[88:89]
    v_pk_mul_f32 v[206:207], v[206:207], v[90:91]
    v_pk_mul_f32 v[208:209], v[208:209], v[92:93]
    v_pk_mul_f32 v[210:211], v[210:211], v[94:95]
    v_exp_f32 v204, v204
    v_exp_f32 v205, v205
    v_exp_f32 v206, v206
    v_exp_f32 v207, v207
    v_exp_f32 v208, v208
    v_exp_f32 v209, v209
    v_exp_f32 v210, v210
    v_exp_f32 v211, v211
    v_pk_fma_f32 v[204:205], v[204:205], v[240:241], v[240:241] op_sel:[0,1,1] op_sel_hi:[1,1,1]
    v_pk_fma_f32 v[206:207], v[206:207], v[240:241], v[240:241] op_sel:[0,1,1] op_sel_hi:[1,1,1]
    v_pk_fma_f32 v[208:209], v[208:209], v[242:243], v[242:243] op_sel:[0,1,1] op_sel_hi:[1,1,1]
    v_pk_fma_f32 v[210:211], v[210:211], v[242:243], v[242:243] op_sel:[0,1,1] op_sel_hi:[1,1,1]
    v_rcp_f32 v204, v204
    v_rcp_f32 v205, v205
    v_rcp_f32 v206, v206
    v_rcp_f32 v207, v207
    v_rcp_f32 v208, v208
    v_rcp_f32 v209, v209
    v_rcp_f32 v210, v210
    v_rcp_f32 v211, v211
    v_pk_mul_f32 v[88:89], v[88:89], v[204:205]
    v_pk_mul_f32 v[90:91], v[90:91], v[206:207]
    v_pk_mul_f32 v[92:93], v[92:93], v[208:209]
    v_pk_mul_f32 v[94:95], v[94:95], v[210:211]
    v_pk_mul_f32 v[212:213], v[96:97], v[96:97]
    v_pk_mul_f32 v[214:215], v[98:99], v[98:99]
    v_pk_mul_f32 v[216:217], v[100:101], v[100:101]
    v_pk_mul_f32 v[218:219], v[102:103], v[102:103]
    v_pk_fma_f32 v[212:213], v[212:213], v[244:245], v[244:245] op_sel:[0,1,0] op_sel_hi:[1,1,0]
    v_pk_fma_f32 v[214:215], v[214:215], v[244:245], v[244:245] op_sel:[0,1,0] op_sel_hi:[1,1,0]
    v_pk_fma_f32 v[216:217], v[216:217], v[246:247], v[246:247] op_sel:[0,1,0] op_sel_hi:[1,1,0]
    v_pk_fma_f32 v[218:219], v[218:219], v[246:247], v[246:247] op_sel:[0,1,0] op_sel_hi:[1,1,0]
    v_pk_mul_f32 v[212:213], v[212:213], v[96:97]
    v_pk_mul_f32 v[214:215], v[214:215], v[98:99]
    v_pk_mul_f32 v[216:217], v[216:217], v[100:101]
    v_pk_mul_f32 v[218:219], v[218:219], v[102:103]
    v_exp_f32 v212, v212
    v_exp_f32 v213, v213
    v_exp_f32 v214, v214
    v_exp_f32 v215, v215
    v_exp_f32 v216, v216
    v_exp_f32 v217, v217
    v_exp_f32 v218, v218
    v_exp_f32 v219, v219
    v_pk_fma_f32 v[212:213], v[212:213], v[240:241], v[240:241] op_sel:[0,1,1] op_sel_hi:[1,1,1]
    v_pk_fma_f32 v[214:215], v[214:215], v[240:241], v[240:241] op_sel:[0,1,1] op_sel_hi:[1,1,1]
    v_pk_fma_f32 v[216:217], v[216:217], v[242:243], v[242:243] op_sel:[0,1,1] op_sel_hi:[1,1,1]
    v_pk_fma_f32 v[218:219], v[218:219], v[242:243], v[242:243] op_sel:[0,1,1] op_sel_hi:[1,1,1]
    v_rcp_f32 v212, v212
    v_rcp_f32 v213, v213
    v_rcp_f32 v214, v214
    v_rcp_f32 v215, v215
    v_rcp_f32 v216, v216
    v_rcp_f32 v217, v217
    v_rcp_f32 v218, v218
    v_rcp_f32 v219, v219
    v_pk_mul_f32 v[96:97], v[96:97], v[212:213]
    v_pk_mul_f32 v[98:99], v[98:99], v[214:215]
    v_pk_mul_f32 v[100:101], v[100:101], v[216:217]
    v_pk_mul_f32 v[102:103], v[102:103], v[218:219]
    v_pk_mul_f32 v[204:205], v[104:105], v[104:105]
    v_pk_mul_f32 v[206:207], v[106:107], v[106:107]
    v_pk_mul_f32 v[208:209], v[108:109], v[108:109]
    v_pk_mul_f32 v[210:211], v[110:111], v[110:111]
    v_pk_fma_f32 v[204:205], v[204:205], v[244:245], v[244:245] op_sel:[0,1,0] op_sel_hi:[1,1,0]
    v_pk_fma_f32 v[206:207], v[206:207], v[244:245], v[244:245] op_sel:[0,1,0] op_sel_hi:[1,1,0]
    v_pk_fma_f32 v[208:209], v[208:209], v[246:247], v[246:247] op_sel:[0,1,0] op_sel_hi:[1,1,0]
    v_pk_fma_f32 v[210:211], v[210:211], v[246:247], v[246:247] op_sel:[0,1,0] op_sel_hi:[1,1,0]
    v_pk_mul_f32 v[204:205], v[204:205], v[104:105]
    v_pk_mul_f32 v[206:207], v[206:207], v[106:107]
    v_pk_mul_f32 v[208:209], v[208:209], v[108:109]
    v_pk_mul_f32 v[210:211], v[210:211], v[110:111]
    v_exp_f32 v204, v204
    v_exp_f32 v205, v205
    v_exp_f32 v206, v206
    v_exp_f32 v207, v207
    v_exp_f32 v208, v208
    v_exp_f32 v209, v209
    v_exp_f32 v210, v210
    v_exp_f32 v211, v211
    v_pk_fma_f32 v[204:205], v[204:205], v[240:241], v[240:241] op_sel:[0,1,1] op_sel_hi:[1,1,1]
    v_pk_fma_f32 v[206:207], v[206:207], v[240:241], v[240:241] op_sel:[0,1,1] op_sel_hi:[1,1,1]
    v_pk_fma_f32 v[208:209], v[208:209], v[242:243], v[242:243] op_sel:[0,1,1] op_sel_hi:[1,1,1]
    v_pk_fma_f32 v[210:211], v[210:211], v[242:243], v[242:243] op_sel:[0,1,1] op_sel_hi:[1,1,1]
    v_rcp_f32 v204, v204
    v_rcp_f32 v205, v205
    v_rcp_f32 v206, v206
    v_rcp_f32 v207, v207
    v_rcp_f32 v208, v208
    v_rcp_f32 v209, v209
    v_rcp_f32 v210, v210
    v_rcp_f32 v211, v211
    v_pk_mul_f32 v[104:105], v[104:105], v[204:205]
    v_pk_mul_f32 v[106:107], v[106:107], v[206:207]
    v_pk_mul_f32 v[108:109], v[108:109], v[208:209]
    v_pk_mul_f32 v[110:111], v[110:111], v[210:211]
    s_waitcnt lgkmcnt(0)
    s_barrier
    ds_read_b128 v[160:163], v202 offset:0
    ds_read_b128 v[164:167], v202 offset:2048
    ds_read_b128 v[168:171], v199 offset:0
    ds_read_b128 v[172:175], v199 offset:1024
    ds_read_b128 v[176:179], v199 offset:2048
    ds_read_b128 v[180:183], v199 offset:3072
    ds_read_b128 v[184:187], v10 offset:0
    ds_read_b128 v[188:191], v10 offset:2048
    ds_read_b128 v[192:195], v2 offset:8192
    v_pk_mul_f32 v[212:213], v[112:113], v[112:113]
    v_pk_mul_f32 v[214:215], v[114:115], v[114:115]
    v_pk_mul_f32 v[216:217], v[116:117], v[116:117]
    v_pk_mul_f32 v[218:219], v[118:119], v[118:119]
    v_pk_fma_f32 v[212:213], v[212:213], v[244:245], v[244:245] op_sel:[0,1,0] op_sel_hi:[1,1,0]
    v_pk_fma_f32 v[214:215], v[214:215], v[244:245], v[244:245] op_sel:[0,1,0] op_sel_hi:[1,1,0]
    v_pk_fma_f32 v[216:217], v[216:217], v[246:247], v[246:247] op_sel:[0,1,0] op_sel_hi:[1,1,0]
    v_pk_fma_f32 v[218:219], v[218:219], v[246:247], v[246:247] op_sel:[0,1,0] op_sel_hi:[1,1,0]
    v_pk_mul_f32 v[212:213], v[212:213], v[112:113]
    v_pk_mul_f32 v[214:215], v[214:215], v[114:115]
    v_pk_mul_f32 v[216:217], v[216:217], v[116:117]
    v_pk_mul_f32 v[218:219], v[218:219], v[118:119]
    v_exp_f32 v212, v212
    v_exp_f32 v213, v213
    v_exp_f32 v214, v214
    v_exp_f32 v215, v215
    v_exp_f32 v216, v216
    v_exp_f32 v217, v217
    v_exp_f32 v218, v218
    v_exp_f32 v219, v219
    v_pk_fma_f32 v[212:213], v[212:213], v[240:241], v[240:241] op_sel:[0,1,1] op_sel_hi:[1,1,1]
    v_pk_fma_f32 v[214:215], v[214:215], v[240:241], v[240:241] op_sel:[0,1,1] op_sel_hi:[1,1,1]
    v_pk_fma_f32 v[216:217], v[216:217], v[242:243], v[242:243] op_sel:[0,1,1] op_sel_hi:[1,1,1]
    v_pk_fma_f32 v[218:219], v[218:219], v[242:243], v[242:243] op_sel:[0,1,1] op_sel_hi:[1,1,1]
    v_rcp_f32 v212, v212
    v_rcp_f32 v213, v213
    v_rcp_f32 v214, v214
    v_rcp_f32 v215, v215
    v_rcp_f32 v216, v216
    v_rcp_f32 v217, v217
    v_rcp_f32 v218, v218
    v_rcp_f32 v219, v219
    v_pk_mul_f32 v[112:113], v[112:113], v[212:213]
    v_pk_mul_f32 v[114:115], v[114:115], v[214:215]
    v_pk_mul_f32 v[116:117], v[116:117], v[216:217]
    v_pk_mul_f32 v[118:119], v[118:119], v[218:219]
    s_waitcnt lgkmcnt(3)
    v_mfma_f32_16x16x32_bf16 v[16:19], v[168:171], v[160:163], v[232:235]
    ds_read_b128 v[204:207], v203 offset:0
    v_mfma_f32_16x16x32_bf16 v[20:23], v[168:171], v[164:167], v[236:239]
    ds_read_b128 v[208:211], v203 offset:2048
    v_mfma_f32_16x16x32_bf16 v[24:27], v[172:175], v[160:163], v[232:235]
    ds_read_b128 v[212:215], v199 offset:9216
    v_mfma_f32_16x16x32_bf16 v[28:31], v[172:175], v[164:167], v[236:239]
    ds_read_b128 v[216:219], v199 offset:10240
    v_mfma_f32_16x16x32_bf16 v[32:35], v[176:179], v[160:163], v[232:235]
    ds_read_b128 v[220:223], v199 offset:11264
    v_mfma_f32_16x16x32_bf16 v[36:39], v[176:179], v[164:167], v[236:239]
    ds_read_b128 v[224:227], v199 offset:12288
    v_mfma_f32_16x16x32_bf16 v[40:43], v[180:183], v[160:163], v[232:235]
    ds_read_b128 v[228:231], v11 offset:0
    v_mfma_f32_16x16x32_bf16 v[44:47], v[180:183], v[164:167], v[236:239]
    ds_read_b128 v[232:235], v11 offset:2048
    s_waitcnt lgkmcnt(8)
    v_mfma_f32_16x16x32_bf16 v[48:51], v[168:171], v[184:187], v[12:15]
    ds_read_b128 v[236:239], v2 offset:17408
    v_mfma_f32_16x16x32_bf16 v[52:55], v[168:171], v[188:191], v[252:255]
    v_mfma_f32_16x16x32_bf16 v[56:59], v[172:175], v[184:187], v[12:15]
    v_mfma_f32_16x16x32_bf16 v[60:63], v[172:175], v[188:191], v[252:255]
    v_mfma_f32_16x16x32_bf16 v[64:67], v[176:179], v[184:187], v[12:15]
    v_mfma_f32_16x16x32_bf16 v[68:71], v[176:179], v[188:191], v[252:255]
    v_mfma_f32_16x16x32_bf16 v[72:75], v[180:183], v[184:187], v[12:15]
    v_mfma_f32_16x16x32_bf16 v[76:79], v[180:183], v[188:191], v[252:255]
    v_mfma_f32_16x16x32_bf16 v[80:83], v[192:195], v[184:187], v[12:15]
    v_mfma_f32_16x16x32_bf16 v[84:87], v[192:195], v[188:191], v[252:255]
    s_waitcnt lgkmcnt(0)
    s_barrier
    v_mfma_f32_16x16x32_bf16 v[16:19], v[212:215], v[204:207], v[16:19]
    ds_read_b128 v[160:163], v202 offset:36864
    v_mfma_f32_16x16x32_bf16 v[20:23], v[212:215], v[208:211], v[20:23]
    ds_read_b128 v[164:167], v202 offset:38912
    v_mfma_f32_16x16x32_bf16 v[24:27], v[216:219], v[204:207], v[24:27]
    ds_read_b128 v[168:171], v199 offset:36864
    v_mfma_f32_16x16x32_bf16 v[28:31], v[216:219], v[208:211], v[28:31]
    ds_read_b128 v[172:175], v199 offset:37888
    v_mul_f32_e64 v12, v120, v120
    v_mfma_f32_16x16x32_bf16 v[32:35], v[220:223], v[204:207], v[32:35]
    ds_read_b128 v[176:179], v199 offset:38912
    v_mul_f32_e64 v13, v121, v121
    v_mfma_f32_16x16x32_bf16 v[36:39], v[220:223], v[208:211], v[36:39]
    ds_read_b128 v[180:183], v199 offset:39936
    v_mul_f32_e64 v14, v122, v122
    v_mfma_f32_16x16x32_bf16 v[40:43], v[224:227], v[204:207], v[40:43]
    ds_read_b128 v[184:187], v10 offset:36864
    v_mul_f32_e64 v15, v123, v123
    v_mfma_f32_16x16x32_bf16 v[44:47], v[224:227], v[208:211], v[44:47]
    ds_read_b128 v[188:191], v10 offset:38912
    v_mfma_f32_16x16x32_bf16 v[48:51], v[212:215], v[228:231], v[48:51]
    ds_read_b128 v[192:195], v2 offset:45056
    v_mul_f32_e64 v252, v124, v124
    v_mfma_f32_16x16x32_bf16 v[52:55], v[212:215], v[232:235], v[52:55]
    v_mul_f32 v253, v125, v125
    v_mul_f32 v254, v126, v126
    v_mfma_f32_16x16x32_bf16 v[56:59], v[216:219], v[228:231], v[56:59]
    v_mul_f32_e64 v255, v127, v127
    v_fma_f32 v12, v12, v5, v4
    v_mfma_f32_16x16x32_bf16 v[60:63], v[216:219], v[232:235], v[60:63]
    v_fma_f32 v13, v13, v5, v4
    v_fma_f32 v14, v14, v5, v4
    v_mfma_f32_16x16x32_bf16 v[64:67], v[220:223], v[228:231], v[64:67]
    v_fma_f32 v15, v15, v5, v4
    v_fma_f32 v252, v252, v7, v6
    v_mfma_f32_16x16x32_bf16 v[68:71], v[220:223], v[232:235], v[68:71]
    v_fma_f32 v253, v253, v7, v6
    v_fma_f32 v254, v254, v7, v6
    v_mfma_f32_16x16x32_bf16 v[72:75], v[224:227], v[228:231], v[72:75]
    v_fma_f32 v255, v255, v7, v6
    v_mul_f32_e64 v12, v12, v120
    v_mfma_f32_16x16x32_bf16 v[76:79], v[224:227], v[232:235], v[76:79]
    v_mul_f32 v13, v13, v121
    v_mul_f32 v14, v14, v122
    v_mfma_f32_16x16x32_bf16 v[80:83], v[236:239], v[228:231], v[80:83]
    v_mul_f32 v15, v15, v123
    v_mul_f32 v252, v252, v124
    v_mfma_f32_16x16x32_bf16 v[84:87], v[236:239], v[232:235], v[84:87]
    v_mul_f32 v253, v253, v125
    s_waitcnt lgkmcnt(3)
    v_mfma_f32_16x16x32_bf16 v[16:19], v[168:171], v[160:163], v[16:19]
    ds_read_b128 v[204:207], v203 offset:36864
    v_mfma_f32_16x16x32_bf16 v[20:23], v[168:171], v[164:167], v[20:23]
    ds_read_b128 v[208:211], v203 offset:38912
    v_mul_f32_e64 v254, v254, v126
    v_mfma_f32_16x16x32_bf16 v[24:27], v[172:175], v[160:163], v[24:27]
    ds_read_b128 v[212:215], v199 offset:46080
    v_mul_f32_e64 v255, v255, v127
    v_mfma_f32_16x16x32_bf16 v[28:31], v[172:175], v[164:167], v[28:31]
    ds_read_b128 v[216:219], v199 offset:47104
    v_exp_f32_e64 v12, v12
    v_mfma_f32_16x16x32_bf16 v[32:35], v[176:179], v[160:163], v[32:35]
    ds_read_b128 v[220:223], v199 offset:48128
    v_exp_f32_e64 v13, v13
    v_mfma_f32_16x16x32_bf16 v[36:39], v[176:179], v[164:167], v[36:39]
    ds_read_b128 v[224:227], v199 offset:49152
    v_exp_f32_e64 v14, v14
    v_mfma_f32_16x16x32_bf16 v[40:43], v[180:183], v[160:163], v[40:43]
    ds_read_b128 v[228:231], v11 offset:36864
    v_exp_f32_e64 v15, v15
    v_mfma_f32_16x16x32_bf16 v[44:47], v[180:183], v[164:167], v[44:47]
    ds_read_b128 v[232:235], v11 offset:38912
    s_waitcnt lgkmcnt(8)
    v_mfma_f32_16x16x32_bf16 v[48:51], v[168:171], v[184:187], v[48:51]
    ds_read_b128 v[236:239], v2 offset:54272
    v_exp_f32 v252, v252
    v_mfma_f32_16x16x32_bf16 v[52:55], v[168:171], v[188:191], v[52:55]
    v_exp_f32_e64 v253, v253
    v_mfma_f32_16x16x32_bf16 v[56:59], v[172:175], v[184:187], v[56:59]
    v_exp_f32_e64 v254, v254
    v_mfma_f32_16x16x32_bf16 v[60:63], v[172:175], v[188:191], v[60:63]
    v_exp_f32_e64 v255, v255
    v_mfma_f32_16x16x32_bf16 v[64:67], v[176:179], v[184:187], v[64:67]
    v_fma_f32 v12, v12, v249, v249
    v_fma_f32 v13, v13, v249, v249
    v_mfma_f32_16x16x32_bf16 v[68:71], v[176:179], v[188:191], v[68:71]
    v_fma_f32 v14, v14, v249, v249
    v_fma_f32 v15, v15, v249, v249
    v_mfma_f32_16x16x32_bf16 v[72:75], v[180:183], v[184:187], v[72:75]
    v_fma_f32 v252, v252, v251, v251
    v_fma_f32 v253, v253, v251, v251
    v_mfma_f32_16x16x32_bf16 v[76:79], v[180:183], v[188:191], v[76:79]
    v_fma_f32 v254, v254, v251, v251
    v_fma_f32 v255, v255, v251, v251
    v_mfma_f32_16x16x32_bf16 v[80:83], v[192:195], v[184:187], v[80:83]
    v_rcp_f32_e64 v12, v12
    v_mfma_f32_16x16x32_bf16 v[84:87], v[192:195], v[188:191], v[84:87]
    v_rcp_f32_e64 v13, v13
    s_waitcnt lgkmcnt(0)
    s_barrier
    v_mfma_f32_16x16x32_bf16 v[16:19], v[212:215], v[204:207], v[16:19]
    ds_read_b128 v[160:163], v200 offset:0
    v_mfma_f32_16x16x32_bf16 v[20:23], v[212:215], v[208:211], v[20:23]
    ds_read_b128 v[164:167], v200 offset:2048
    v_rcp_f32_e64 v14, v14
    v_mfma_f32_16x16x32_bf16 v[24:27], v[216:219], v[204:207], v[24:27]
    ds_read_b128 v[168:171], v198 offset:0
    v_rcp_f32_e64 v15, v15
    v_mfma_f32_16x16x32_bf16 v[28:31], v[216:219], v[208:211], v[28:31]
    ds_read_b128 v[172:175], v198 offset:1024
    v_rcp_f32_e64 v252, v252
    v_mfma_f32_16x16x32_bf16 v[32:35], v[220:223], v[204:207], v[32:35]
    ds_read_b128 v[176:179], v198 offset:2048
    v_rcp_f32_e64 v253, v253
    v_mfma_f32_16x16x32_bf16 v[36:39], v[220:223], v[208:211], v[36:39]
    ds_read_b128 v[180:183], v198 offset:3072
    v_rcp_f32_e64 v254, v254
    v_mfma_f32_16x16x32_bf16 v[40:43], v[224:227], v[204:207], v[40:43]
    ds_read_b128 v[184:187], v8 offset:0
    v_rcp_f32_e64 v255, v255
    v_mfma_f32_16x16x32_bf16 v[44:47], v[224:227], v[208:211], v[44:47]
    ds_read_b128 v[188:191], v8 offset:2048
    v_mfma_f32_16x16x32_bf16 v[48:51], v[212:215], v[228:231], v[48:51]
    ds_read_b128 v[192:195], v1 offset:8192
    v_mul_f32_e64 v120, v120, v12
    v_mfma_f32_16x16x32_bf16 v[52:55], v[212:215], v[232:235], v[52:55]
    v_mul_f32 v121, v121, v13
    v_mul_f32 v122, v122, v14
    v_mfma_f32_16x16x32_bf16 v[56:59], v[216:219], v[228:231], v[56:59]
    v_mul_f32 v123, v123, v15
    v_mul_f32 v124, v124, v252
    v_mfma_f32_16x16x32_bf16 v[60:63], v[216:219], v[232:235], v[60:63]
    v_mul_f32 v125, v125, v253
    v_mul_f32 v126, v126, v254
    v_mfma_f32_16x16x32_bf16 v[64:67], v[220:223], v[228:231], v[64:67]
    v_mul_f32 v127, v127, v255
    v_mul_f32 v12, v128, v128
    v_mfma_f32_16x16x32_bf16 v[68:71], v[220:223], v[232:235], v[68:71]
    v_mul_f32 v13, v129, v129
    v_mul_f32 v14, v130, v130
    v_mfma_f32_16x16x32_bf16 v[72:75], v[224:227], v[228:231], v[72:75]
    v_mul_f32 v15, v131, v131
    v_mul_f32 v252, v132, v132
    v_mfma_f32_16x16x32_bf16 v[76:79], v[224:227], v[232:235], v[76:79]
    v_mul_f32 v253, v133, v133
    v_mul_f32 v254, v134, v134
    v_mfma_f32_16x16x32_bf16 v[80:83], v[236:239], v[228:231], v[80:83]
    v_mul_f32_e64 v255, v135, v135
    v_fma_f32 v12, v12, v5, v4
    v_mfma_f32_16x16x32_bf16 v[84:87], v[236:239], v[232:235], v[84:87]
    v_fma_f32 v13, v13, v5, v4
    s_waitcnt lgkmcnt(3)
    v_mfma_f32_16x16x32_bf16 v[16:19], v[168:171], v[160:163], v[16:19]
    ds_read_b128 v[204:207], v201 offset:0
    v_mfma_f32_16x16x32_bf16 v[20:23], v[168:171], v[164:167], v[20:23]
    ds_read_b128 v[208:211], v201 offset:2048
    v_fma_f32 v14, v14, v5, v4
    v_mfma_f32_16x16x32_bf16 v[24:27], v[172:175], v[160:163], v[24:27]
    ds_read_b128 v[212:215], v198 offset:9216
    v_fma_f32 v15, v15, v5, v4
    v_mfma_f32_16x16x32_bf16 v[28:31], v[172:175], v[164:167], v[28:31]
    ds_read_b128 v[216:219], v198 offset:10240
    v_fma_f32 v252, v252, v7, v6
    v_mfma_f32_16x16x32_bf16 v[32:35], v[176:179], v[160:163], v[32:35]
    ds_read_b128 v[220:223], v198 offset:11264
    v_fma_f32 v253, v253, v7, v6
    v_mfma_f32_16x16x32_bf16 v[36:39], v[176:179], v[164:167], v[36:39]
    ds_read_b128 v[224:227], v198 offset:12288
    v_fma_f32 v254, v254, v7, v6
    v_mfma_f32_16x16x32_bf16 v[40:43], v[180:183], v[160:163], v[40:43]
    ds_read_b128 v[228:231], v9 offset:0
    v_fma_f32 v255, v255, v7, v6
    v_mfma_f32_16x16x32_bf16 v[44:47], v[180:183], v[164:167], v[44:47]
    ds_read_b128 v[232:235], v9 offset:2048
    s_waitcnt lgkmcnt(8)
    v_mfma_f32_16x16x32_bf16 v[48:51], v[168:171], v[184:187], v[48:51]
    ds_read_b128 v[236:239], v1 offset:17408
    v_mul_f32_e64 v12, v12, v128
    v_mfma_f32_16x16x32_bf16 v[52:55], v[168:171], v[188:191], v[52:55]
    v_mul_f32 v13, v13, v129
    v_mul_f32 v14, v14, v130
    v_mfma_f32_16x16x32_bf16 v[56:59], v[172:175], v[184:187], v[56:59]
    v_mul_f32 v15, v15, v131
    v_mul_f32 v252, v252, v132
    v_mfma_f32_16x16x32_bf16 v[60:63], v[172:175], v[188:191], v[60:63]
    v_mul_f32 v253, v253, v133
    v_mul_f32 v254, v254, v134
    v_mfma_f32_16x16x32_bf16 v[64:67], v[176:179], v[184:187], v[64:67]
    v_mul_f32 v255, v255, v135
    v_exp_f32 v12, v12
    v_mfma_f32_16x16x32_bf16 v[68:71], v[176:179], v[188:191], v[68:71]
    v_exp_f32_e64 v13, v13
    v_mfma_f32_16x16x32_bf16 v[72:75], v[180:183], v[184:187], v[72:75]
    v_exp_f32_e64 v14, v14
    v_mfma_f32_16x16x32_bf16 v[76:79], v[180:183], v[188:191], v[76:79]
    v_exp_f32_e64 v15, v15
    v_mfma_f32_16x16x32_bf16 v[80:83], v[192:195], v[184:187], v[80:83]
    v_exp_f32_e64 v252, v252
    v_mfma_f32_16x16x32_bf16 v[84:87], v[192:195], v[188:191], v[84:87]
    v_exp_f32_e64 v253, v253
    s_waitcnt lgkmcnt(0)
    s_barrier
    v_mfma_f32_16x16x32_bf16 v[16:19], v[212:215], v[204:207], v[16:19]
    ds_read_b128 v[160:163], v200 offset:36864
    v_mfma_f32_16x16x32_bf16 v[20:23], v[212:215], v[208:211], v[20:23]
    ds_read_b128 v[164:167], v200 offset:38912
    v_exp_f32_e64 v254, v254
    v_mfma_f32_16x16x32_bf16 v[24:27], v[216:219], v[204:207], v[24:27]
    ds_read_b128 v[168:171], v198 offset:36864
    v_exp_f32_e64 v255, v255
    v_mfma_f32_16x16x32_bf16 v[28:31], v[216:219], v[208:211], v[28:31]
    ds_read_b128 v[172:175], v198 offset:37888
    v_fma_f32 v12, v12, v249, v249
    v_mfma_f32_16x16x32_bf16 v[32:35], v[220:223], v[204:207], v[32:35]
    ds_read_b128 v[176:179], v198 offset:38912
    v_fma_f32 v13, v13, v249, v249
    v_mfma_f32_16x16x32_bf16 v[36:39], v[220:223], v[208:211], v[36:39]
    ds_read_b128 v[180:183], v198 offset:39936
    v_fma_f32 v14, v14, v249, v249
    v_mfma_f32_16x16x32_bf16 v[40:43], v[224:227], v[204:207], v[40:43]
    ds_read_b128 v[184:187], v8 offset:36864
    v_fma_f32 v15, v15, v249, v249
    v_mfma_f32_16x16x32_bf16 v[44:47], v[224:227], v[208:211], v[44:47]
    ds_read_b128 v[188:191], v8 offset:38912
    v_mfma_f32_16x16x32_bf16 v[48:51], v[212:215], v[228:231], v[48:51]
    ds_read_b128 v[192:195], v1 offset:45056
    v_fma_f32 v252, v252, v251, v251
    v_mfma_f32_16x16x32_bf16 v[52:55], v[212:215], v[232:235], v[52:55]
    v_fma_f32 v253, v253, v251, v251
    v_fma_f32 v254, v254, v251, v251
    v_mfma_f32_16x16x32_bf16 v[56:59], v[216:219], v[228:231], v[56:59]
    v_fma_f32 v255, v255, v251, v251
    v_rcp_f32_e64 v12, v12
    v_mfma_f32_16x16x32_bf16 v[60:63], v[216:219], v[232:235], v[60:63]
    v_rcp_f32_e64 v13, v13
    v_mfma_f32_16x16x32_bf16 v[64:67], v[220:223], v[228:231], v[64:67]
    v_rcp_f32_e64 v14, v14
    v_mfma_f32_16x16x32_bf16 v[68:71], v[220:223], v[232:235], v[68:71]
    v_rcp_f32_e64 v15, v15
    v_mfma_f32_16x16x32_bf16 v[72:75], v[224:227], v[228:231], v[72:75]
    v_rcp_f32_e64 v252, v252
    v_mfma_f32_16x16x32_bf16 v[76:79], v[224:227], v[232:235], v[76:79]
    v_rcp_f32_e64 v253, v253
    v_mfma_f32_16x16x32_bf16 v[80:83], v[236:239], v[228:231], v[80:83]
    v_rcp_f32_e64 v254, v254
    v_mfma_f32_16x16x32_bf16 v[84:87], v[236:239], v[232:235], v[84:87]
    v_rcp_f32 v255, v255
    s_waitcnt lgkmcnt(3)
    v_mfma_f32_16x16x32_bf16 v[16:19], v[168:171], v[160:163], v[16:19]
    ds_read_b128 v[204:207], v201 offset:36864
    v_mfma_f32_16x16x32_bf16 v[20:23], v[168:171], v[164:167], v[20:23]
    ds_read_b128 v[208:211], v201 offset:38912
    v_mul_f32_e64 v128, v128, v12
    v_mfma_f32_16x16x32_bf16 v[24:27], v[172:175], v[160:163], v[24:27]
    ds_read_b128 v[212:215], v198 offset:46080
    v_mul_f32_e64 v129, v129, v13
    v_mfma_f32_16x16x32_bf16 v[28:31], v[172:175], v[164:167], v[28:31]
    ds_read_b128 v[216:219], v198 offset:47104
    v_mul_f32_e64 v130, v130, v14
    v_mfma_f32_16x16x32_bf16 v[32:35], v[176:179], v[160:163], v[32:35]
    ds_read_b128 v[220:223], v198 offset:48128
    v_mul_f32_e64 v131, v131, v15
    v_mfma_f32_16x16x32_bf16 v[36:39], v[176:179], v[164:167], v[36:39]
    ds_read_b128 v[224:227], v198 offset:49152
    v_mul_f32_e64 v132, v132, v252
    v_mfma_f32_16x16x32_bf16 v[40:43], v[180:183], v[160:163], v[40:43]
    ds_read_b128 v[228:231], v9 offset:36864
    v_mul_f32_e64 v133, v133, v253
    v_mfma_f32_16x16x32_bf16 v[44:47], v[180:183], v[164:167], v[44:47]
    ds_read_b128 v[232:235], v9 offset:38912
    s_waitcnt lgkmcnt(8)
    v_mfma_f32_16x16x32_bf16 v[48:51], v[168:171], v[184:187], v[48:51]
    ds_read_b128 v[236:239], v1 offset:54272
    v_mul_f32 v134, v134, v254
    v_mfma_f32_16x16x32_bf16 v[52:55], v[168:171], v[188:191], v[52:55]
    v_mul_f32 v135, v135, v255
    v_mul_f32 v12, v136, v136
    v_mfma_f32_16x16x32_bf16 v[56:59], v[172:175], v[184:187], v[56:59]
    v_mul_f32 v13, v137, v137
    v_mul_f32 v14, v138, v138
    v_mfma_f32_16x16x32_bf16 v[60:63], v[172:175], v[188:191], v[60:63]
    v_mul_f32 v15, v139, v139
    v_mul_f32 v252, v140, v140
    v_mfma_f32_16x16x32_bf16 v[64:67], v[176:179], v[184:187], v[64:67]
    v_mul_f32 v253, v141, v141
    v_mul_f32 v254, v142, v142
    v_mfma_f32_16x16x32_bf16 v[68:71], v[176:179], v[188:191], v[68:71]
    v_mul_f32_e64 v255, v143, v143
    v_fma_f32 v12, v12, v5, v4
    v_mfma_f32_16x16x32_bf16 v[72:75], v[180:183], v[184:187], v[72:75]
    v_fma_f32 v13, v13, v5, v4
    v_fma_f32 v14, v14, v5, v4
    v_mfma_f32_16x16x32_bf16 v[76:79], v[180:183], v[188:191], v[76:79]
    v_fma_f32 v15, v15, v5, v4
    v_fma_f32 v252, v252, v7, v6
    v_mfma_f32_16x16x32_bf16 v[80:83], v[192:195], v[184:187], v[80:83]
    v_fma_f32 v253, v253, v7, v6
    v_fma_f32 v254, v254, v7, v6
    v_mfma_f32_16x16x32_bf16 v[84:87], v[192:195], v[188:191], v[84:87]
    v_fma_f32 v255, v255, v7, v6
    s_waitcnt lgkmcnt(0)
    s_barrier
    v_mfma_f32_16x16x32_bf16 v[16:19], v[212:215], v[204:207], v[16:19]
    ds_read_b128 v[160:163], v202 offset:0
    v_mfma_f32_16x16x32_bf16 v[20:23], v[212:215], v[208:211], v[20:23]
    ds_read_b128 v[164:167], v202 offset:2048
    v_mul_f32_e64 v12, v12, v136
    v_mfma_f32_16x16x32_bf16 v[24:27], v[216:219], v[204:207], v[24:27]
    ds_read_b128 v[168:171], v199 offset:0
    v_mul_f32_e64 v13, v13, v137
    v_mfma_f32_16x16x32_bf16 v[28:31], v[216:219], v[208:211], v[28:31]
    ds_read_b128 v[172:175], v199 offset:1024
    v_mul_f32_e64 v14, v14, v138
    v_mfma_f32_16x16x32_bf16 v[32:35], v[220:223], v[204:207], v[32:35]
    ds_read_b128 v[176:179], v199 offset:2048
    v_mul_f32_e64 v15, v15, v139
    v_mfma_f32_16x16x32_bf16 v[36:39], v[220:223], v[208:211], v[36:39]
    ds_read_b128 v[180:183], v199 offset:3072
    v_mul_f32_e64 v252, v252, v140
    v_mfma_f32_16x16x32_bf16 v[40:43], v[224:227], v[204:207], v[40:43]
    ds_read_b128 v[184:187], v10 offset:0
    v_mul_f32_e64 v253, v253, v141
    v_mfma_f32_16x16x32_bf16 v[44:47], v[224:227], v[208:211], v[44:47]
    ds_read_b128 v[188:191], v10 offset:2048
    v_mfma_f32_16x16x32_bf16 v[48:51], v[212:215], v[228:231], v[48:51]
    ds_read_b128 v[192:195], v2 offset:8192
    v_mul_f32_e64 v254, v254, v142
    v_mfma_f32_16x16x32_bf16 v[52:55], v[212:215], v[232:235], v[52:55]
    v_mul_f32 v255, v255, v143
    v_exp_f32 v12, v12
    v_mfma_f32_16x16x32_bf16 v[56:59], v[216:219], v[228:231], v[56:59]
    v_exp_f32_e64 v13, v13
    v_mfma_f32_16x16x32_bf16 v[60:63], v[216:219], v[232:235], v[60:63]
    v_exp_f32_e64 v14, v14
    v_mfma_f32_16x16x32_bf16 v[64:67], v[220:223], v[228:231], v[64:67]
    v_exp_f32_e64 v15, v15
    v_mfma_f32_16x16x32_bf16 v[68:71], v[220:223], v[232:235], v[68:71]
    v_exp_f32_e64 v252, v252
    v_mfma_f32_16x16x32_bf16 v[72:75], v[224:227], v[228:231], v[72:75]
    v_exp_f32_e64 v253, v253
    v_mfma_f32_16x16x32_bf16 v[76:79], v[224:227], v[232:235], v[76:79]
    v_exp_f32_e64 v254, v254
    v_mfma_f32_16x16x32_bf16 v[80:83], v[236:239], v[228:231], v[80:83]
    v_exp_f32_e64 v255, v255
    v_mfma_f32_16x16x32_bf16 v[84:87], v[236:239], v[232:235], v[84:87]
    v_fma_f32 v12, v12, v249, v249
    s_waitcnt lgkmcnt(3)
    v_mfma_f32_16x16x32_bf16 v[16:19], v[168:171], v[160:163], v[16:19]
    ds_read_b128 v[204:207], v203 offset:0
    v_mfma_f32_16x16x32_bf16 v[20:23], v[168:171], v[164:167], v[20:23]
    ds_read_b128 v[208:211], v203 offset:2048
    v_fma_f32 v13, v13, v249, v249
    v_mfma_f32_16x16x32_bf16 v[24:27], v[172:175], v[160:163], v[24:27]
    ds_read_b128 v[212:215], v199 offset:9216
    v_fma_f32 v14, v14, v249, v249
    v_mfma_f32_16x16x32_bf16 v[28:31], v[172:175], v[164:167], v[28:31]
    ds_read_b128 v[216:219], v199 offset:10240
    v_fma_f32 v15, v15, v249, v249
    v_mfma_f32_16x16x32_bf16 v[32:35], v[176:179], v[160:163], v[32:35]
    ds_read_b128 v[220:223], v199 offset:11264
    v_fma_f32 v252, v252, v251, v251
    v_mfma_f32_16x16x32_bf16 v[36:39], v[176:179], v[164:167], v[36:39]
    ds_read_b128 v[224:227], v199 offset:12288
    v_fma_f32 v253, v253, v251, v251
    v_mfma_f32_16x16x32_bf16 v[40:43], v[180:183], v[160:163], v[40:43]
    ds_read_b128 v[228:231], v11 offset:0
    v_fma_f32 v254, v254, v251, v251
    v_mfma_f32_16x16x32_bf16 v[44:47], v[180:183], v[164:167], v[44:47]
    ds_read_b128 v[232:235], v11 offset:2048
    s_waitcnt lgkmcnt(8)
    v_mfma_f32_16x16x32_bf16 v[48:51], v[168:171], v[184:187], v[48:51]
    ds_read_b128 v[236:239], v2 offset:17408
    v_fma_f32 v255, v255, v251, v251
    v_mfma_f32_16x16x32_bf16 v[52:55], v[168:171], v[188:191], v[52:55]
    v_rcp_f32_e64 v12, v12
    v_mfma_f32_16x16x32_bf16 v[56:59], v[172:175], v[184:187], v[56:59]
    v_rcp_f32_e64 v13, v13
    v_mfma_f32_16x16x32_bf16 v[60:63], v[172:175], v[188:191], v[60:63]
    v_rcp_f32_e64 v14, v14
    v_mfma_f32_16x16x32_bf16 v[64:67], v[176:179], v[184:187], v[64:67]
    v_rcp_f32_e64 v15, v15
    v_mfma_f32_16x16x32_bf16 v[68:71], v[176:179], v[188:191], v[68:71]
    v_rcp_f32_e64 v252, v252
    v_mfma_f32_16x16x32_bf16 v[72:75], v[180:183], v[184:187], v[72:75]
    v_rcp_f32_e64 v253, v253
    v_mfma_f32_16x16x32_bf16 v[76:79], v[180:183], v[188:191], v[76:79]
    v_rcp_f32_e64 v254, v254
    v_mfma_f32_16x16x32_bf16 v[80:83], v[192:195], v[184:187], v[80:83]
    v_rcp_f32_e64 v255, v255
    v_mfma_f32_16x16x32_bf16 v[84:87], v[192:195], v[188:191], v[84:87]
    v_mul_f32_e64 v136, v136, v12
    s_waitcnt lgkmcnt(0)
    s_barrier
    v_mfma_f32_16x16x32_bf16 v[16:19], v[212:215], v[204:207], v[16:19]
    ds_read_b128 v[160:163], v202 offset:36864
    v_mfma_f32_16x16x32_bf16 v[20:23], v[212:215], v[208:211], v[20:23]
    ds_read_b128 v[164:167], v202 offset:38912
    v_mul_f32_e64 v137, v137, v13
    v_mfma_f32_16x16x32_bf16 v[24:27], v[216:219], v[204:207], v[24:27]
    ds_read_b128 v[168:171], v199 offset:36864
    v_mul_f32_e64 v138, v138, v14
    v_mfma_f32_16x16x32_bf16 v[28:31], v[216:219], v[208:211], v[28:31]
    ds_read_b128 v[172:175], v199 offset:37888
    v_mul_f32_e64 v139, v139, v15
    v_mfma_f32_16x16x32_bf16 v[32:35], v[220:223], v[204:207], v[32:35]
    ds_read_b128 v[176:179], v199 offset:38912
    v_mul_f32_e64 v140, v140, v252
    v_mfma_f32_16x16x32_bf16 v[36:39], v[220:223], v[208:211], v[36:39]
    ds_read_b128 v[180:183], v199 offset:39936
    v_mul_f32_e64 v141, v141, v253
    v_mfma_f32_16x16x32_bf16 v[40:43], v[224:227], v[204:207], v[40:43]
    ds_read_b128 v[184:187], v10 offset:36864
    v_mul_f32_e64 v142, v142, v254
    v_mfma_f32_16x16x32_bf16 v[44:47], v[224:227], v[208:211], v[44:47]
    ds_read_b128 v[188:191], v10 offset:38912
    v_mfma_f32_16x16x32_bf16 v[48:51], v[212:215], v[228:231], v[48:51]
    ds_read_b128 v[192:195], v2 offset:45056
    v_mul_f32_e64 v143, v143, v255
    v_mfma_f32_16x16x32_bf16 v[52:55], v[212:215], v[232:235], v[52:55]
    v_mul_f32 v12, v144, v144
    v_mul_f32 v13, v145, v145
    v_mfma_f32_16x16x32_bf16 v[56:59], v[216:219], v[228:231], v[56:59]
    v_mul_f32 v14, v146, v146
    v_mul_f32 v15, v147, v147
    v_mfma_f32_16x16x32_bf16 v[60:63], v[216:219], v[232:235], v[60:63]
    v_mul_f32 v252, v148, v148
    v_mul_f32 v253, v149, v149
    v_mfma_f32_16x16x32_bf16 v[64:67], v[220:223], v[228:231], v[64:67]
    v_mul_f32 v254, v150, v150
    v_mul_f32 v255, v151, v151
    v_mfma_f32_16x16x32_bf16 v[68:71], v[220:223], v[232:235], v[68:71]
    v_fma_f32 v12, v12, v5, v4
    v_fma_f32 v13, v13, v5, v4
    v_mfma_f32_16x16x32_bf16 v[72:75], v[224:227], v[228:231], v[72:75]
    v_fma_f32 v14, v14, v5, v4
    v_fma_f32 v15, v15, v5, v4
    v_mfma_f32_16x16x32_bf16 v[76:79], v[224:227], v[232:235], v[76:79]
    v_fma_f32 v252, v252, v7, v6
    v_fma_f32 v253, v253, v7, v6
    v_mfma_f32_16x16x32_bf16 v[80:83], v[236:239], v[228:231], v[80:83]
    v_fma_f32 v254, v254, v7, v6
    v_fma_f32 v255, v255, v7, v6
    v_mfma_f32_16x16x32_bf16 v[84:87], v[236:239], v[232:235], v[84:87]
    v_mul_f32 v12, v12, v144
    s_waitcnt lgkmcnt(3)
    v_mfma_f32_16x16x32_bf16 v[16:19], v[168:171], v[160:163], v[16:19]
    ds_read_b128 v[204:207], v203 offset:36864
    v_mfma_f32_16x16x32_bf16 v[20:23], v[168:171], v[164:167], v[20:23]
    ds_read_b128 v[208:211], v203 offset:38912
    v_mul_f32_e64 v13, v13, v145
    v_mfma_f32_16x16x32_bf16 v[24:27], v[172:175], v[160:163], v[24:27]
    ds_read_b128 v[212:215], v199 offset:46080
    v_mul_f32_e64 v14, v14, v146
    v_mfma_f32_16x16x32_bf16 v[28:31], v[172:175], v[164:167], v[28:31]
    ds_read_b128 v[216:219], v199 offset:47104
    v_mul_f32_e64 v15, v15, v147
    v_mfma_f32_16x16x32_bf16 v[32:35], v[176:179], v[160:163], v[32:35]
    ds_read_b128 v[220:223], v199 offset:48128
    v_mul_f32_e64 v252, v252, v148
    v_mfma_f32_16x16x32_bf16 v[36:39], v[176:179], v[164:167], v[36:39]
    ds_read_b128 v[224:227], v199 offset:49152
    v_mul_f32_e64 v253, v253, v149
    v_mfma_f32_16x16x32_bf16 v[40:43], v[180:183], v[160:163], v[40:43]
    ds_read_b128 v[228:231], v11 offset:36864
    v_mul_f32_e64 v254, v254, v150
    v_mfma_f32_16x16x32_bf16 v[44:47], v[180:183], v[164:167], v[44:47]
    ds_read_b128 v[232:235], v11 offset:38912
    s_waitcnt lgkmcnt(8)
    v_mfma_f32_16x16x32_bf16 v[48:51], v[168:171], v[184:187], v[48:51]
    ds_read_b128 v[236:239], v2 offset:54272
    v_mul_f32 v255, v255, v151
    v_mfma_f32_16x16x32_bf16 v[52:55], v[168:171], v[188:191], v[52:55]
    v_exp_f32_e64 v12, v12
    v_mfma_f32_16x16x32_bf16 v[56:59], v[172:175], v[184:187], v[56:59]
    v_exp_f32_e64 v13, v13
    v_mfma_f32_16x16x32_bf16 v[60:63], v[172:175], v[188:191], v[60:63]
    v_exp_f32_e64 v14, v14
    v_mfma_f32_16x16x32_bf16 v[64:67], v[176:179], v[184:187], v[64:67]
    v_exp_f32_e64 v15, v15
    v_mfma_f32_16x16x32_bf16 v[68:71], v[176:179], v[188:191], v[68:71]
    v_exp_f32_e64 v252, v252
    v_mfma_f32_16x16x32_bf16 v[72:75], v[180:183], v[184:187], v[72:75]
    v_exp_f32_e64 v253, v253
    v_mfma_f32_16x16x32_bf16 v[76:79], v[180:183], v[188:191], v[76:79]
    v_exp_f32_e64 v254, v254
    v_mfma_f32_16x16x32_bf16 v[80:83], v[192:195], v[184:187], v[80:83]
    v_exp_f32_e64 v255, v255
    v_mfma_f32_16x16x32_bf16 v[84:87], v[192:195], v[188:191], v[84:87]
    v_fma_f32 v12, v12, v249, v249
    s_waitcnt lgkmcnt(0)
    s_barrier
    v_mfma_f32_16x16x32_bf16 v[16:19], v[212:215], v[204:207], v[16:19]
    ds_read_b128 v[160:163], v200 offset:0
    v_mfma_f32_16x16x32_bf16 v[20:23], v[212:215], v[208:211], v[20:23]
    ds_read_b128 v[164:167], v200 offset:2048
    v_fma_f32 v13, v13, v249, v249
    v_mfma_f32_16x16x32_bf16 v[24:27], v[216:219], v[204:207], v[24:27]
    ds_read_b128 v[168:171], v198 offset:0
    v_fma_f32 v14, v14, v249, v249
    v_mfma_f32_16x16x32_bf16 v[28:31], v[216:219], v[208:211], v[28:31]
    ds_read_b128 v[172:175], v198 offset:1024
    v_fma_f32 v15, v15, v249, v249
    v_mfma_f32_16x16x32_bf16 v[32:35], v[220:223], v[204:207], v[32:35]
    ds_read_b128 v[176:179], v198 offset:2048
    v_fma_f32 v252, v252, v251, v251
    v_mfma_f32_16x16x32_bf16 v[36:39], v[220:223], v[208:211], v[36:39]
    ds_read_b128 v[180:183], v198 offset:3072
    v_fma_f32 v253, v253, v251, v251
    v_mfma_f32_16x16x32_bf16 v[40:43], v[224:227], v[204:207], v[40:43]
    ds_read_b128 v[184:187], v8 offset:0
    v_fma_f32 v254, v254, v251, v251
    v_mfma_f32_16x16x32_bf16 v[44:47], v[224:227], v[208:211], v[44:47]
    ds_read_b128 v[188:191], v8 offset:2048
    v_mfma_f32_16x16x32_bf16 v[48:51], v[212:215], v[228:231], v[48:51]
    ds_read_b128 v[192:195], v1 offset:8192
    v_fma_f32 v255, v255, v251, v251
    v_mfma_f32_16x16x32_bf16 v[52:55], v[212:215], v[232:235], v[52:55]
    v_rcp_f32_e64 v12, v12
    v_mfma_f32_16x16x32_bf16 v[56:59], v[216:219], v[228:231], v[56:59]
    v_rcp_f32_e64 v13, v13
    v_mfma_f32_16x16x32_bf16 v[60:63], v[216:219], v[232:235], v[60:63]
    v_rcp_f32_e64 v14, v14
    v_mfma_f32_16x16x32_bf16 v[64:67], v[220:223], v[228:231], v[64:67]
    v_rcp_f32_e64 v15, v15
    v_mfma_f32_16x16x32_bf16 v[68:71], v[220:223], v[232:235], v[68:71]
    v_rcp_f32_e64 v252, v252
    v_mfma_f32_16x16x32_bf16 v[72:75], v[224:227], v[228:231], v[72:75]
    v_rcp_f32_e64 v253, v253
    v_mfma_f32_16x16x32_bf16 v[76:79], v[224:227], v[232:235], v[76:79]
    v_rcp_f32_e64 v254, v254
    v_mfma_f32_16x16x32_bf16 v[80:83], v[236:239], v[228:231], v[80:83]
    v_rcp_f32_e64 v255, v255
    v_mfma_f32_16x16x32_bf16 v[84:87], v[236:239], v[232:235], v[84:87]
    v_mul_f32 v144, v144, v12
    s_waitcnt lgkmcnt(3)
    v_mfma_f32_16x16x32_bf16 v[16:19], v[168:171], v[160:163], v[16:19]
    ds_read_b128 v[204:207], v201 offset:0
    v_mfma_f32_16x16x32_bf16 v[20:23], v[168:171], v[164:167], v[20:23]
    ds_read_b128 v[208:211], v201 offset:2048
    v_mul_f32_e64 v145, v145, v13
    v_mfma_f32_16x16x32_bf16 v[24:27], v[172:175], v[160:163], v[24:27]
    ds_read_b128 v[212:215], v198 offset:9216
    v_mul_f32_e64 v146, v146, v14
    v_mfma_f32_16x16x32_bf16 v[28:31], v[172:175], v[164:167], v[28:31]
    ds_read_b128 v[216:219], v198 offset:10240
    v_mul_f32_e64 v147, v147, v15
    v_mfma_f32_16x16x32_bf16 v[32:35], v[176:179], v[160:163], v[32:35]
    ds_read_b128 v[220:223], v198 offset:11264
    v_mul_f32_e64 v148, v148, v252
    v_mfma_f32_16x16x32_bf16 v[36:39], v[176:179], v[164:167], v[36:39]
    ds_read_b128 v[224:227], v198 offset:12288
    v_mul_f32_e64 v149, v149, v253
    v_mfma_f32_16x16x32_bf16 v[40:43], v[180:183], v[160:163], v[40:43]
    ds_read_b128 v[228:231], v9 offset:0
    v_mul_f32_e64 v150, v150, v254
    v_mfma_f32_16x16x32_bf16 v[44:47], v[180:183], v[164:167], v[44:47]
    ds_read_b128 v[232:235], v9 offset:2048
    s_waitcnt lgkmcnt(8)
    v_mfma_f32_16x16x32_bf16 v[48:51], v[168:171], v[184:187], v[48:51]
    ds_read_b128 v[236:239], v1 offset:17408
    v_mul_f32 v151, v151, v255
    v_mfma_f32_16x16x32_bf16 v[52:55], v[168:171], v[188:191], v[52:55]
    v_mul_f32 v12, v152, v152
    v_mul_f32 v13, v153, v153
    v_mfma_f32_16x16x32_bf16 v[56:59], v[172:175], v[184:187], v[56:59]
    v_mul_f32 v14, v154, v154
    v_mul_f32 v15, v155, v155
    v_mfma_f32_16x16x32_bf16 v[60:63], v[172:175], v[188:191], v[60:63]
    v_mul_f32 v252, v156, v156
    v_mul_f32 v253, v157, v157
    v_mfma_f32_16x16x32_bf16 v[64:67], v[176:179], v[184:187], v[64:67]
    v_mul_f32 v254, v158, v158
    v_mul_f32 v255, v159, v159
    v_mfma_f32_16x16x32_bf16 v[68:71], v[176:179], v[188:191], v[68:71]
    v_fma_f32 v12, v12, v5, v4
    v_fma_f32 v13, v13, v5, v4
    v_mfma_f32_16x16x32_bf16 v[72:75], v[180:183], v[184:187], v[72:75]
    v_fma_f32 v14, v14, v5, v4
    v_fma_f32 v15, v15, v5, v4
    v_mfma_f32_16x16x32_bf16 v[76:79], v[180:183], v[188:191], v[76:79]
    v_fma_f32 v252, v252, v7, v6
    v_fma_f32 v253, v253, v7, v6
    v_mfma_f32_16x16x32_bf16 v[80:83], v[192:195], v[184:187], v[80:83]
    v_fma_f32 v254, v254, v7, v6
    v_fma_f32 v255, v255, v7, v6
    v_mfma_f32_16x16x32_bf16 v[84:87], v[192:195], v[188:191], v[84:87]
    v_mul_f32_e64 v12, v12, v152
    s_waitcnt lgkmcnt(0)
    s_barrier
    v_mfma_f32_16x16x32_bf16 v[16:19], v[212:215], v[204:207], v[16:19]
    ds_read_b128 v[160:163], v200 offset:36864
    v_mfma_f32_16x16x32_bf16 v[20:23], v[212:215], v[208:211], v[20:23]
    ds_read_b128 v[164:167], v200 offset:38912
    v_mul_f32_e64 v13, v13, v153
    v_mfma_f32_16x16x32_bf16 v[24:27], v[216:219], v[204:207], v[24:27]
    ds_read_b128 v[168:171], v198 offset:36864
    v_mul_f32_e64 v14, v14, v154
    v_mfma_f32_16x16x32_bf16 v[28:31], v[216:219], v[208:211], v[28:31]
    ds_read_b128 v[172:175], v198 offset:37888
    v_mul_f32_e64 v15, v15, v155
    v_mfma_f32_16x16x32_bf16 v[32:35], v[220:223], v[204:207], v[32:35]
    ds_read_b128 v[176:179], v198 offset:38912
    v_mul_f32_e64 v252, v252, v156
    v_mfma_f32_16x16x32_bf16 v[36:39], v[220:223], v[208:211], v[36:39]
    ds_read_b128 v[180:183], v198 offset:39936
    v_mul_f32_e64 v253, v253, v157
    v_mfma_f32_16x16x32_bf16 v[40:43], v[224:227], v[204:207], v[40:43]
    ds_read_b128 v[184:187], v8 offset:36864
    v_mul_f32_e64 v254, v254, v158
    v_mfma_f32_16x16x32_bf16 v[44:47], v[224:227], v[208:211], v[44:47]
    ds_read_b128 v[188:191], v8 offset:38912
    v_mfma_f32_16x16x32_bf16 v[48:51], v[212:215], v[228:231], v[48:51]
    ds_read_b128 v[192:195], v1 offset:45056
    v_mul_f32_e64 v255, v255, v159
    v_mfma_f32_16x16x32_bf16 v[52:55], v[212:215], v[232:235], v[52:55]
    v_exp_f32_e64 v12, v12
    v_mfma_f32_16x16x32_bf16 v[56:59], v[216:219], v[228:231], v[56:59]
    v_exp_f32_e64 v13, v13
    v_mfma_f32_16x16x32_bf16 v[60:63], v[216:219], v[232:235], v[60:63]
    v_exp_f32_e64 v14, v14
    v_mfma_f32_16x16x32_bf16 v[64:67], v[220:223], v[228:231], v[64:67]
    v_exp_f32_e64 v15, v15
    v_mfma_f32_16x16x32_bf16 v[68:71], v[220:223], v[232:235], v[68:71]
    v_exp_f32_e64 v252, v252
    v_mfma_f32_16x16x32_bf16 v[72:75], v[224:227], v[228:231], v[72:75]
    v_exp_f32_e64 v253, v253
    v_mfma_f32_16x16x32_bf16 v[76:79], v[224:227], v[232:235], v[76:79]
    v_exp_f32_e64 v254, v254
    v_mfma_f32_16x16x32_bf16 v[80:83], v[236:239], v[228:231], v[80:83]
    v_exp_f32_e64 v255, v255
    v_mfma_f32_16x16x32_bf16 v[84:87], v[236:239], v[232:235], v[84:87]
    v_fma_f32 v12, v12, v249, v249
    s_waitcnt lgkmcnt(3)
    v_mfma_f32_16x16x32_bf16 v[16:19], v[168:171], v[160:163], v[16:19]
    ds_read_b128 v[204:207], v201 offset:36864
    v_mfma_f32_16x16x32_bf16 v[20:23], v[168:171], v[164:167], v[20:23]
    ds_read_b128 v[208:211], v201 offset:38912
    v_fma_f32 v13, v13, v249, v249
    v_mfma_f32_16x16x32_bf16 v[24:27], v[172:175], v[160:163], v[24:27]
    ds_read_b128 v[212:215], v198 offset:46080
    v_fma_f32 v14, v14, v249, v249
    v_mfma_f32_16x16x32_bf16 v[28:31], v[172:175], v[164:167], v[28:31]
    ds_read_b128 v[216:219], v198 offset:47104
    v_fma_f32 v15, v15, v249, v249
    v_mfma_f32_16x16x32_bf16 v[32:35], v[176:179], v[160:163], v[32:35]
    ds_read_b128 v[220:223], v198 offset:48128
    v_fma_f32 v252, v252, v251, v251
    v_mfma_f32_16x16x32_bf16 v[36:39], v[176:179], v[164:167], v[36:39]
    ds_read_b128 v[224:227], v198 offset:49152
    v_fma_f32 v253, v253, v251, v251
    v_mfma_f32_16x16x32_bf16 v[40:43], v[180:183], v[160:163], v[40:43]
    ds_read_b128 v[228:231], v9 offset:36864
    v_fma_f32 v254, v254, v251, v251
    v_mfma_f32_16x16x32_bf16 v[44:47], v[180:183], v[164:167], v[44:47]
    ds_read_b128 v[232:235], v9 offset:38912
    s_waitcnt lgkmcnt(8)
    v_mfma_f32_16x16x32_bf16 v[48:51], v[168:171], v[184:187], v[48:51]
    ds_read_b128 v[236:239], v1 offset:54272
    v_fma_f32 v255, v255, v251, v251
    v_mfma_f32_16x16x32_bf16 v[52:55], v[168:171], v[188:191], v[52:55]
    v_rcp_f32_e64 v12, v12
    v_mfma_f32_16x16x32_bf16 v[56:59], v[172:175], v[184:187], v[56:59]
    v_rcp_f32_e64 v13, v13
    v_mfma_f32_16x16x32_bf16 v[60:63], v[172:175], v[188:191], v[60:63]
    v_rcp_f32_e64 v14, v14
    v_mfma_f32_16x16x32_bf16 v[64:67], v[176:179], v[184:187], v[64:67]
    v_rcp_f32_e64 v15, v15
    v_mfma_f32_16x16x32_bf16 v[68:71], v[176:179], v[188:191], v[68:71]
    v_rcp_f32_e64 v252, v252
    v_mfma_f32_16x16x32_bf16 v[72:75], v[180:183], v[184:187], v[72:75]
    v_rcp_f32_e64 v253, v253
    v_mfma_f32_16x16x32_bf16 v[76:79], v[180:183], v[188:191], v[76:79]
    v_rcp_f32_e64 v254, v254
    v_mfma_f32_16x16x32_bf16 v[80:83], v[192:195], v[184:187], v[80:83]
    v_rcp_f32_e64 v255, v255
    v_mfma_f32_16x16x32_bf16 v[84:87], v[192:195], v[188:191], v[84:87]
    v_mul_f32_e64 v152, v152, v12
    s_waitcnt lgkmcnt(0)
    s_barrier
    v_mfma_f32_16x16x32_bf16 v[16:19], v[212:215], v[204:207], v[16:19]
    ds_read_b128 v[160:163], v202 offset:0
    v_mfma_f32_16x16x32_bf16 v[20:23], v[212:215], v[208:211], v[20:23]
    ds_read_b128 v[164:167], v202 offset:2048
    v_mul_f32_e64 v153, v153, v13
    v_mfma_f32_16x16x32_bf16 v[24:27], v[216:219], v[204:207], v[24:27]
    ds_read_b128 v[168:171], v199 offset:0
    v_mul_f32_e64 v154, v154, v14
    v_mfma_f32_16x16x32_bf16 v[28:31], v[216:219], v[208:211], v[28:31]
    ds_read_b128 v[172:175], v199 offset:1024
    v_mul_f32_e64 v155, v155, v15
    v_mfma_f32_16x16x32_bf16 v[32:35], v[220:223], v[204:207], v[32:35]
    ds_read_b128 v[176:179], v199 offset:2048
    v_mul_f32_e64 v156, v156, v252
    v_mfma_f32_16x16x32_bf16 v[36:39], v[220:223], v[208:211], v[36:39]
    ds_read_b128 v[180:183], v199 offset:3072
    v_mul_f32_e64 v157, v157, v253
    v_mfma_f32_16x16x32_bf16 v[40:43], v[224:227], v[204:207], v[40:43]
    ds_read_b128 v[184:187], v10 offset:0
    v_mul_f32_e64 v158, v158, v254
    v_mfma_f32_16x16x32_bf16 v[44:47], v[224:227], v[208:211], v[44:47]
    ds_read_b128 v[188:191], v10 offset:2048
    v_mfma_f32_16x16x32_bf16 v[48:51], v[212:215], v[228:231], v[48:51]
    ds_read_b128 v[192:195], v2 offset:8192
    v_mul_f32_e64 v159, v159, v255
    v_mfma_f32_16x16x32_bf16 v[52:55], v[212:215], v[232:235], v[52:55]
    s_mul_i32 s39, s31, 73728
    s_add_u32 s39, s39, s21
    v_mfma_f32_16x16x32_bf16 v[56:59], v[216:219], v[228:231], v[56:59]
    s_add_u32 s39, s39, 0x1200000
    s_add_u32 s40, s39, 73728
    v_mfma_f32_16x16x32_bf16 v[60:63], v[216:219], v[232:235], v[60:63]
    s_mul_i32 s36, s47, 36
    s_add_u32 s36, s36, s39
    v_mfma_f32_16x16x32_bf16 v[64:67], v[220:223], v[228:231], v[64:67]
    s_add_u32 s37, s36, 73728
    s_lshl_b32 s34, s24, 10
    v_mfma_f32_16x16x32_bf16 v[68:71], v[220:223], v[232:235], v[68:71]
    s_lshl_b32 s33, s48, 3
    s_add_u32 s34, s34, s33
    v_mfma_f32_16x16x32_bf16 v[72:75], v[224:227], v[228:231], v[72:75]
    v_add_u32_e64 v13, s34, v1
    v_add_u32 v14, 16384, v13
    v_mfma_f32_16x16x32_bf16 v[76:79], v[224:227], v[232:235], v[76:79]
    s_lshr_b32 s35, s24, 1
    s_lshl_b32 s35, s35, 10
    v_mfma_f32_16x16x32_bf16 v[80:83], v[236:239], v[228:231], v[80:83]
    s_and_b32 s33, s24, 1
    s_mul_i32 s33, s33, 73728
    v_mfma_f32_16x16x32_bf16 v[84:87], v[236:239], v[232:235], v[84:87]
    s_add_u32 s35, s35, s33
    s_add_u32 s35, s35, 65536
    v_add_u32_e64 v15, s35, v1
    s_mov_b32 s41, 5
L_g_loop:
    s_waitcnt lgkmcnt(3)
    v_mfma_f32_16x16x32_bf16 v[16:19], v[168:171], v[160:163], v[16:19]
    ds_read_b128 v[204:207], v203 offset:0
    v_mfma_f32_16x16x32_bf16 v[20:23], v[168:171], v[164:167], v[20:23]
    ds_read_b128 v[208:211], v203 offset:2048
    v_mfma_f32_16x16x32_bf16 v[24:27], v[172:175], v[160:163], v[24:27]
    ds_read_b128 v[212:215], v199 offset:9216
    v_mfma_f32_16x16x32_bf16 v[28:31], v[172:175], v[164:167], v[28:31]
    ds_read_b128 v[216:219], v199 offset:10240
    v_mfma_f32_16x16x32_bf16 v[32:35], v[176:179], v[160:163], v[32:35]
    ds_read_b128 v[220:223], v199 offset:11264
    v_mfma_f32_16x16x32_bf16 v[36:39], v[176:179], v[164:167], v[36:39]
    ds_read_b128 v[224:227], v199 offset:12288
    v_mfma_f32_16x16x32_bf16 v[40:43], v[180:183], v[160:163], v[40:43]
    ds_read_b128 v[228:231], v11 offset:0
    v_mfma_f32_16x16x32_bf16 v[44:47], v[180:183], v[164:167], v[44:47]
    ds_read_b128 v[232:235], v11 offset:2048
    s_waitcnt lgkmcnt(8)
    v_mfma_f32_16x16x32_bf16 v[48:51], v[168:171], v[184:187], v[48:51]
    ds_read_b128 v[236:239], v2 offset:17408
    v_mfma_f32_16x16x32_bf16 v[52:55], v[168:171], v[188:191], v[52:55]
    v_mfma_f32_16x16x32_bf16 v[56:59], v[172:175], v[184:187], v[56:59]
    v_mfma_f32_16x16x32_bf16 v[60:63], v[172:175], v[188:191], v[60:63]
    v_mfma_f32_16x16x32_bf16 v[64:67], v[176:179], v[184:187], v[64:67]
    v_mfma_f32_16x16x32_bf16 v[68:71], v[176:179], v[188:191], v[68:71]
    v_mfma_f32_16x16x32_bf16 v[72:75], v[180:183], v[184:187], v[72:75]
    v_mfma_f32_16x16x32_bf16 v[76:79], v[180:183], v[188:191], v[76:79]
    v_mfma_f32_16x16x32_bf16 v[80:83], v[192:195], v[184:187], v[80:83]
    v_mfma_f32_16x16x32_bf16 v[84:87], v[192:195], v[188:191], v[84:87]
    s_waitcnt lgkmcnt(0)
    s_barrier
    v_mfma_f32_16x16x32_bf16 v[16:19], v[212:215], v[204:207], v[16:19]
    ds_read_b128 v[160:163], v202 offset:36864
    v_mfma_f32_16x16x32_bf16 v[20:23], v[212:215], v[208:211], v[20:23]
    ds_read_b128 v[164:167], v202 offset:38912
    v_mfma_f32_16x16x32_bf16 v[24:27], v[216:219], v[204:207], v[24:27]
    ds_read_b128 v[168:171], v199 offset:36864
    v_mfma_f32_16x16x32_bf16 v[28:31], v[216:219], v[208:211], v[28:31]
    ds_read_b128 v[172:175], v199 offset:37888
    v_mfma_f32_16x16x32_bf16 v[32:35], v[220:223], v[204:207], v[32:35]
    ds_read_b128 v[176:179], v199 offset:38912
    v_mfma_f32_16x16x32_bf16 v[36:39], v[220:223], v[208:211], v[36:39]
    ds_read_b128 v[180:183], v199 offset:39936
    v_mfma_f32_16x16x32_bf16 v[40:43], v[224:227], v[204:207], v[40:43]
    ds_read_b128 v[184:187], v10 offset:36864
    v_mfma_f32_16x16x32_bf16 v[44:47], v[224:227], v[208:211], v[44:47]
    ds_read_b128 v[188:191], v10 offset:38912
    v_mfma_f32_16x16x32_bf16 v[48:51], v[212:215], v[228:231], v[48:51]
    ds_read_b128 v[192:195], v2 offset:45056
    v_mfma_f32_16x16x32_bf16 v[52:55], v[212:215], v[232:235], v[52:55]
    v_mfma_f32_16x16x32_bf16 v[56:59], v[216:219], v[228:231], v[56:59]
    v_mfma_f32_16x16x32_bf16 v[60:63], v[216:219], v[232:235], v[60:63]
    v_mfma_f32_16x16x32_bf16 v[64:67], v[220:223], v[228:231], v[64:67]
    v_mfma_f32_16x16x32_bf16 v[68:71], v[220:223], v[232:235], v[68:71]
    v_mfma_f32_16x16x32_bf16 v[72:75], v[224:227], v[228:231], v[72:75]
    v_mfma_f32_16x16x32_bf16 v[76:79], v[224:227], v[232:235], v[76:79]
    v_mfma_f32_16x16x32_bf16 v[80:83], v[236:239], v[228:231], v[80:83]
    v_mfma_f32_16x16x32_bf16 v[84:87], v[236:239], v[232:235], v[84:87]
    s_waitcnt lgkmcnt(3)
    v_mfma_f32_16x16x32_bf16 v[16:19], v[168:171], v[160:163], v[16:19]
    ds_read_b128 v[204:207], v203 offset:36864
    v_mfma_f32_16x16x32_bf16 v[20:23], v[168:171], v[164:167], v[20:23]
    ds_read_b128 v[208:211], v203 offset:38912
    v_mfma_f32_16x16x32_bf16 v[24:27], v[172:175], v[160:163], v[24:27]
    ds_read_b128 v[212:215], v199 offset:46080
    v_mfma_f32_16x16x32_bf16 v[28:31], v[172:175], v[164:167], v[28:31]
    ds_read_b128 v[216:219], v199 offset:47104
    v_mfma_f32_16x16x32_bf16 v[32:35], v[176:179], v[160:163], v[32:35]
    ds_read_b128 v[220:223], v199 offset:48128
    v_mfma_f32_16x16x32_bf16 v[36:39], v[176:179], v[164:167], v[36:39]
    ds_read_b128 v[224:227], v199 offset:49152
    v_mfma_f32_16x16x32_bf16 v[40:43], v[180:183], v[160:163], v[40:43]
    ds_read_b128 v[228:231], v11 offset:36864
    v_mfma_f32_16x16x32_bf16 v[44:47], v[180:183], v[164:167], v[44:47]
    ds_read_b128 v[232:235], v11 offset:38912
    s_waitcnt lgkmcnt(8)
    v_mfma_f32_16x16x32_bf16 v[48:51], v[168:171], v[184:187], v[48:51]
    ds_read_b128 v[236:239], v2 offset:54272
    v_mfma_f32_16x16x32_bf16 v[52:55], v[168:171], v[188:191], v[52:55]
    v_mfma_f32_16x16x32_bf16 v[56:59], v[172:175], v[184:187], v[56:59]
    v_mfma_f32_16x16x32_bf16 v[60:63], v[172:175], v[188:191], v[60:63]
    v_mfma_f32_16x16x32_bf16 v[64:67], v[176:179], v[184:187], v[64:67]
    v_mfma_f32_16x16x32_bf16 v[68:71], v[176:179], v[188:191], v[68:71]
    v_mfma_f32_16x16x32_bf16 v[72:75], v[180:183], v[184:187], v[72:75]
    v_mfma_f32_16x16x32_bf16 v[76:79], v[180:183], v[188:191], v[76:79]
    v_mfma_f32_16x16x32_bf16 v[80:83], v[192:195], v[184:187], v[80:83]
    v_mfma_f32_16x16x32_bf16 v[84:87], v[192:195], v[188:191], v[84:87]
    s_waitcnt lgkmcnt(0)
    s_barrier
    v_mfma_f32_16x16x32_bf16 v[16:19], v[212:215], v[204:207], v[16:19]
    ds_read_b128 v[160:163], v200 offset:0
    v_mfma_f32_16x16x32_bf16 v[20:23], v[212:215], v[208:211], v[20:23]
    ds_read_b128 v[164:167], v200 offset:2048
    v_mfma_f32_16x16x32_bf16 v[24:27], v[216:219], v[204:207], v[24:27]
    ds_read_b128 v[168:171], v198 offset:0
    v_mfma_f32_16x16x32_bf16 v[28:31], v[216:219], v[208:211], v[28:31]
    ds_read_b128 v[172:175], v198 offset:1024
    v_mfma_f32_16x16x32_bf16 v[32:35], v[220:223], v[204:207], v[32:35]
    ds_read_b128 v[176:179], v198 offset:2048
    v_mfma_f32_16x16x32_bf16 v[36:39], v[220:223], v[208:211], v[36:39]
    ds_read_b128 v[180:183], v198 offset:3072
    v_mfma_f32_16x16x32_bf16 v[40:43], v[224:227], v[204:207], v[40:43]
    ds_read_b128 v[184:187], v8 offset:0
    v_mfma_f32_16x16x32_bf16 v[44:47], v[224:227], v[208:211], v[44:47]
    ds_read_b128 v[188:191], v8 offset:2048
    v_mfma_f32_16x16x32_bf16 v[48:51], v[212:215], v[228:231], v[48:51]
    ds_read_b128 v[192:195], v1 offset:8192
    v_mfma_f32_16x16x32_bf16 v[52:55], v[212:215], v[232:235], v[52:55]
    v_mfma_f32_16x16x32_bf16 v[56:59], v[216:219], v[228:231], v[56:59]
    v_mfma_f32_16x16x32_bf16 v[60:63], v[216:219], v[232:235], v[60:63]
    v_mfma_f32_16x16x32_bf16 v[64:67], v[220:223], v[228:231], v[64:67]
    v_mfma_f32_16x16x32_bf16 v[68:71], v[220:223], v[232:235], v[68:71]
    v_mfma_f32_16x16x32_bf16 v[72:75], v[224:227], v[228:231], v[72:75]
    v_mfma_f32_16x16x32_bf16 v[76:79], v[224:227], v[232:235], v[76:79]
    v_mfma_f32_16x16x32_bf16 v[80:83], v[236:239], v[228:231], v[80:83]
    v_mfma_f32_16x16x32_bf16 v[84:87], v[236:239], v[232:235], v[84:87]
    s_waitcnt lgkmcnt(3)
    v_mfma_f32_16x16x32_bf16 v[16:19], v[168:171], v[160:163], v[16:19]
    ds_read_b128 v[204:207], v201 offset:0
    v_mfma_f32_16x16x32_bf16 v[20:23], v[168:171], v[164:167], v[20:23]
    ds_read_b128 v[208:211], v201 offset:2048
    v_mfma_f32_16x16x32_bf16 v[24:27], v[172:175], v[160:163], v[24:27]
    ds_read_b128 v[212:215], v198 offset:9216
    v_mfma_f32_16x16x32_bf16 v[28:31], v[172:175], v[164:167], v[28:31]
    ds_read_b128 v[216:219], v198 offset:10240
    v_mfma_f32_16x16x32_bf16 v[32:35], v[176:179], v[160:163], v[32:35]
    ds_read_b128 v[220:223], v198 offset:11264
    v_mfma_f32_16x16x32_bf16 v[36:39], v[176:179], v[164:167], v[36:39]
    ds_read_b128 v[224:227], v198 offset:12288
    v_mfma_f32_16x16x32_bf16 v[40:43], v[180:183], v[160:163], v[40:43]
    ds_read_b128 v[228:231], v9 offset:0
    v_mfma_f32_16x16x32_bf16 v[44:47], v[180:183], v[164:167], v[44:47]
    ds_read_b128 v[232:235], v9 offset:2048
    s_waitcnt lgkmcnt(8)
    v_mfma_f32_16x16x32_bf16 v[48:51], v[168:171], v[184:187], v[48:51]
    ds_read_b128 v[236:239], v1 offset:17408
    v_mfma_f32_16x16x32_bf16 v[52:55], v[168:171], v[188:191], v[52:55]
    v_mfma_f32_16x16x32_bf16 v[56:59], v[172:175], v[184:187], v[56:59]
    v_mfma_f32_16x16x32_bf16 v[60:63], v[172:175], v[188:191], v[60:63]
    v_mfma_f32_16x16x32_bf16 v[64:67], v[176:179], v[184:187], v[64:67]
    v_mfma_f32_16x16x32_bf16 v[68:71], v[176:179], v[188:191], v[68:71]
    v_mfma_f32_16x16x32_bf16 v[72:75], v[180:183], v[184:187], v[72:75]
    v_mfma_f32_16x16x32_bf16 v[76:79], v[180:183], v[188:191], v[76:79]
    v_mfma_f32_16x16x32_bf16 v[80:83], v[192:195], v[184:187], v[80:83]
    v_mfma_f32_16x16x32_bf16 v[84:87], v[192:195], v[188:191], v[84:87]
    s_waitcnt lgkmcnt(0)
    s_barrier
    v_mfma_f32_16x16x32_bf16 v[16:19], v[212:215], v[204:207], v[16:19]
    ds_read_b128 v[160:163], v200 offset:36864
    v_mfma_f32_16x16x32_bf16 v[20:23], v[212:215], v[208:211], v[20:23]
    ds_read_b128 v[164:167], v200 offset:38912
    v_mfma_f32_16x16x32_bf16 v[24:27], v[216:219], v[204:207], v[24:27]
    ds_read_b128 v[168:171], v198 offset:36864
    v_mfma_f32_16x16x32_bf16 v[28:31], v[216:219], v[208:211], v[28:31]
    ds_read_b128 v[172:175], v198 offset:37888
    v_mfma_f32_16x16x32_bf16 v[32:35], v[220:223], v[204:207], v[32:35]
    ds_read_b128 v[176:179], v198 offset:38912
    v_mfma_f32_16x16x32_bf16 v[36:39], v[220:223], v[208:211], v[36:39]
    ds_read_b128 v[180:183], v198 offset:39936
    v_mfma_f32_16x16x32_bf16 v[40:43], v[224:227], v[204:207], v[40:43]
    ds_read_b128 v[184:187], v8 offset:36864
    v_mfma_f32_16x16x32_bf16 v[44:47], v[224:227], v[208:211], v[44:47]
    ds_read_b128 v[188:191], v8 offset:38912
    v_mfma_f32_16x16x32_bf16 v[48:51], v[212:215], v[228:231], v[48:51]
    ds_read_b128 v[192:195], v1 offset:45056
    v_mfma_f32_16x16x32_bf16 v[52:55], v[212:215], v[232:235], v[52:55]
    v_mfma_f32_16x16x32_bf16 v[56:59], v[216:219], v[228:231], v[56:59]
    v_mfma_f32_16x16x32_bf16 v[60:63], v[216:219], v[232:235], v[60:63]
    v_mfma_f32_16x16x32_bf16 v[64:67], v[220:223], v[228:231], v[64:67]
    v_mfma_f32_16x16x32_bf16 v[68:71], v[220:223], v[232:235], v[68:71]
    v_mfma_f32_16x16x32_bf16 v[72:75], v[224:227], v[228:231], v[72:75]
    v_mfma_f32_16x16x32_bf16 v[76:79], v[224:227], v[232:235], v[76:79]
    v_mfma_f32_16x16x32_bf16 v[80:83], v[236:239], v[228:231], v[80:83]
    v_mfma_f32_16x16x32_bf16 v[84:87], v[236:239], v[232:235], v[84:87]
    s_waitcnt lgkmcnt(3)
    v_mfma_f32_16x16x32_bf16 v[16:19], v[168:171], v[160:163], v[16:19]
    ds_read_b128 v[204:207], v201 offset:36864
    v_mfma_f32_16x16x32_bf16 v[20:23], v[168:171], v[164:167], v[20:23]
    ds_read_b128 v[208:211], v201 offset:38912
    v_mfma_f32_16x16x32_bf16 v[24:27], v[172:175], v[160:163], v[24:27]
    ds_read_b128 v[212:215], v198 offset:46080
    v_mfma_f32_16x16x32_bf16 v[28:31], v[172:175], v[164:167], v[28:31]
    ds_read_b128 v[216:219], v198 offset:47104
    v_mfma_f32_16x16x32_bf16 v[32:35], v[176:179], v[160:163], v[32:35]
    ds_read_b128 v[220:223], v198 offset:48128
    v_mfma_f32_16x16x32_bf16 v[36:39], v[176:179], v[164:167], v[36:39]
    ds_read_b128 v[224:227], v198 offset:49152
    v_mfma_f32_16x16x32_bf16 v[40:43], v[180:183], v[160:163], v[40:43]
    ds_read_b128 v[228:231], v9 offset:36864
    v_mfma_f32_16x16x32_bf16 v[44:47], v[180:183], v[164:167], v[44:47]
    ds_read_b128 v[232:235], v9 offset:38912
    s_waitcnt lgkmcnt(8)
    v_mfma_f32_16x16x32_bf16 v[48:51], v[168:171], v[184:187], v[48:51]
    ds_read_b128 v[236:239], v1 offset:54272
    v_mfma_f32_16x16x32_bf16 v[52:55], v[168:171], v[188:191], v[52:55]
    v_mfma_f32_16x16x32_bf16 v[56:59], v[172:175], v[184:187], v[56:59]
    v_mfma_f32_16x16x32_bf16 v[60:63], v[172:175], v[188:191], v[60:63]
    v_mfma_f32_16x16x32_bf16 v[64:67], v[176:179], v[184:187], v[64:67]
    v_mfma_f32_16x16x32_bf16 v[68:71], v[176:179], v[188:191], v[68:71]
    v_mfma_f32_16x16x32_bf16 v[72:75], v[180:183], v[184:187], v[72:75]
    v_mfma_f32_16x16x32_bf16 v[76:79], v[180:183], v[188:191], v[76:79]
    v_mfma_f32_16x16x32_bf16 v[80:83], v[192:195], v[184:187], v[80:83]
    v_mfma_f32_16x16x32_bf16 v[84:87], v[192:195], v[188:191], v[84:87]
    s_waitcnt lgkmcnt(0)
    s_barrier
    v_mfma_f32_16x16x32_bf16 v[16:19], v[212:215], v[204:207], v[16:19]
    ds_read_b128 v[160:163], v202 offset:0
    v_mfma_f32_16x16x32_bf16 v[20:23], v[212:215], v[208:211], v[20:23]
    ds_read_b128 v[164:167], v202 offset:2048
    v_mfma_f32_16x16x32_bf16 v[24:27], v[216:219], v[204:207], v[24:27]
    ds_read_b128 v[168:171], v199 offset:0
    v_mfma_f32_16x16x32_bf16 v[28:31], v[216:219], v[208:211], v[28:31]
    ds_read_b128 v[172:175], v199 offset:1024
    v_mfma_f32_16x16x32_bf16 v[32:35], v[220:223], v[204:207], v[32:35]
    ds_read_b128 v[176:179], v199 offset:2048
    v_mfma_f32_16x16x32_bf16 v[36:39], v[220:223], v[208:211], v[36:39]
    ds_read_b128 v[180:183], v199 offset:3072
    v_mfma_f32_16x16x32_bf16 v[40:43], v[224:227], v[204:207], v[40:43]
    ds_read_b128 v[184:187], v10 offset:0
    v_mfma_f32_16x16x32_bf16 v[44:47], v[224:227], v[208:211], v[44:47]
    ds_read_b128 v[188:191], v10 offset:2048
    v_mfma_f32_16x16x32_bf16 v[48:51], v[212:215], v[228:231], v[48:51]
    ds_read_b128 v[192:195], v2 offset:8192
    v_mfma_f32_16x16x32_bf16 v[52:55], v[212:215], v[232:235], v[52:55]
    v_mfma_f32_16x16x32_bf16 v[56:59], v[216:219], v[228:231], v[56:59]
    v_mfma_f32_16x16x32_bf16 v[60:63], v[216:219], v[232:235], v[60:63]
    v_mfma_f32_16x16x32_bf16 v[64:67], v[220:223], v[228:231], v[64:67]
    v_mfma_f32_16x16x32_bf16 v[68:71], v[220:223], v[232:235], v[68:71]
    v_mfma_f32_16x16x32_bf16 v[72:75], v[224:227], v[228:231], v[72:75]
    v_mfma_f32_16x16x32_bf16 v[76:79], v[224:227], v[232:235], v[76:79]
    v_mfma_f32_16x16x32_bf16 v[80:83], v[236:239], v[228:231], v[80:83]
    s_sub_u32 s41, s41, 1
    v_mfma_f32_16x16x32_bf16 v[84:87], v[236:239], v[232:235], v[84:87]
    s_cmp_lg_u32 s41, 0
    s_cbranch_scc1 L_g_loop
    s_waitcnt lgkmcnt(3)
    v_mfma_f32_16x16x32_bf16 v[16:19], v[168:171], v[160:163], v[16:19]
    ds_read_b128 v[204:207], v203 offset:0
    v_mfma_f32_16x16x32_bf16 v[20:23], v[168:171], v[164:167], v[20:23]
    ds_read_b128 v[208:211], v203 offset:2048
    v_mfma_f32_16x16x32_bf16 v[24:27], v[172:175], v[160:163], v[24:27]
    ds_read_b128 v[212:215], v199 offset:9216
    v_mfma_f32_16x16x32_bf16 v[28:31], v[172:175], v[164:167], v[28:31]
    ds_read_b128 v[216:219], v199 offset:10240
    v_mfma_f32_16x16x32_bf16 v[32:35], v[176:179], v[160:163], v[32:35]
    ds_read_b128 v[220:223], v199 offset:11264
    v_mfma_f32_16x16x32_bf16 v[36:39], v[176:179], v[164:167], v[36:39]
    ds_read_b128 v[224:227], v199 offset:12288
    v_mfma_f32_16x16x32_bf16 v[40:43], v[180:183], v[160:163], v[40:43]
    ds_read_b128 v[228:231], v11 offset:0
    v_mfma_f32_16x16x32_bf16 v[44:47], v[180:183], v[164:167], v[44:47]
    ds_read_b128 v[232:235], v11 offset:2048
    s_waitcnt lgkmcnt(8)
    v_mfma_f32_16x16x32_bf16 v[48:51], v[168:171], v[184:187], v[48:51]
    ds_read_b128 v[236:239], v2 offset:17408
    v_mfma_f32_16x16x32_bf16 v[52:55], v[168:171], v[188:191], v[52:55]
    v_mfma_f32_16x16x32_bf16 v[56:59], v[172:175], v[184:187], v[56:59]
    v_mfma_f32_16x16x32_bf16 v[60:63], v[172:175], v[188:191], v[60:63]
    v_mfma_f32_16x16x32_bf16 v[64:67], v[176:179], v[184:187], v[64:67]
    v_mfma_f32_16x16x32_bf16 v[68:71], v[176:179], v[188:191], v[68:71]
    v_mfma_f32_16x16x32_bf16 v[72:75], v[180:183], v[184:187], v[72:75]
    v_mfma_f32_16x16x32_bf16 v[76:79], v[180:183], v[188:191], v[76:79]
    v_mfma_f32_16x16x32_bf16 v[80:83], v[192:195], v[184:187], v[80:83]
    v_mfma_f32_16x16x32_bf16 v[84:87], v[192:195], v[188:191], v[84:87]
    s_waitcnt lgkmcnt(0)
    s_barrier
    v_mfma_f32_16x16x32_bf16 v[16:19], v[212:215], v[204:207], v[16:19]
    ds_read_b128 v[160:163], v202 offset:36864
    v_mfma_f32_16x16x32_bf16 v[20:23], v[212:215], v[208:211], v[20:23]
    ds_read_b128 v[164:167], v202 offset:38912
    v_mfma_f32_16x16x32_bf16 v[24:27], v[216:219], v[204:207], v[24:27]
    ds_read_b128 v[168:171], v199 offset:36864
    v_mfma_f32_16x16x32_bf16 v[28:31], v[216:219], v[208:211], v[28:31]
    ds_read_b128 v[172:175], v199 offset:37888
    v_mfma_f32_16x16x32_bf16 v[32:35], v[220:223], v[204:207], v[32:35]
    ds_read_b128 v[176:179], v199 offset:38912
    v_mfma_f32_16x16x32_bf16 v[36:39], v[220:223], v[208:211], v[36:39]
    ds_read_b128 v[180:183], v199 offset:39936
    v_mfma_f32_16x16x32_bf16 v[40:43], v[224:227], v[204:207], v[40:43]
    ds_read_b128 v[184:187], v10 offset:36864
    v_mfma_f32_16x16x32_bf16 v[44:47], v[224:227], v[208:211], v[44:47]
    ds_read_b128 v[188:191], v10 offset:38912
    v_mfma_f32_16x16x32_bf16 v[48:51], v[212:215], v[228:231], v[48:51]
    ds_read_b128 v[192:195], v2 offset:45056
    v_mfma_f32_16x16x32_bf16 v[52:55], v[212:215], v[232:235], v[52:55]
    v_mfma_f32_16x16x32_bf16 v[56:59], v[216:219], v[228:231], v[56:59]
    v_mfma_f32_16x16x32_bf16 v[60:63], v[216:219], v[232:235], v[60:63]
    v_mfma_f32_16x16x32_bf16 v[64:67], v[220:223], v[228:231], v[64:67]
    v_mfma_f32_16x16x32_bf16 v[68:71], v[220:223], v[232:235], v[68:71]
    v_mfma_f32_16x16x32_bf16 v[72:75], v[224:227], v[228:231], v[72:75]
    v_mfma_f32_16x16x32_bf16 v[76:79], v[224:227], v[232:235], v[76:79]
    v_mfma_f32_16x16x32_bf16 v[80:83], v[236:239], v[228:231], v[80:83]
    v_mfma_f32_16x16x32_bf16 v[84:87], v[236:239], v[232:235], v[84:87]
    s_waitcnt lgkmcnt(3)
    v_mfma_f32_16x16x32_bf16 v[16:19], v[168:171], v[160:163], v[16:19]
    ds_read_b128 v[204:207], v203 offset:36864
    v_mfma_f32_16x16x32_bf16 v[20:23], v[168:171], v[164:167], v[20:23]
    ds_read_b128 v[208:211], v203 offset:38912
    v_mfma_f32_16x16x32_bf16 v[24:27], v[172:175], v[160:163], v[24:27]
    ds_read_b128 v[212:215], v199 offset:46080
    v_mfma_f32_16x16x32_bf16 v[28:31], v[172:175], v[164:167], v[28:31]
    ds_read_b128 v[216:219], v199 offset:47104
    v_mfma_f32_16x16x32_bf16 v[32:35], v[176:179], v[160:163], v[32:35]
    ds_read_b128 v[220:223], v199 offset:48128
    v_mfma_f32_16x16x32_bf16 v[36:39], v[176:179], v[164:167], v[36:39]
    ds_read_b128 v[224:227], v199 offset:49152
    v_mfma_f32_16x16x32_bf16 v[40:43], v[180:183], v[160:163], v[40:43]
    ds_read_b128 v[228:231], v11 offset:36864
    v_mfma_f32_16x16x32_bf16 v[44:47], v[180:183], v[164:167], v[44:47]
    ds_read_b128 v[232:235], v11 offset:38912
    s_waitcnt lgkmcnt(8)
    v_mfma_f32_16x16x32_bf16 v[48:51], v[168:171], v[184:187], v[48:51]
    ds_read_b128 v[236:239], v2 offset:54272
    v_mfma_f32_16x16x32_bf16 v[52:55], v[168:171], v[188:191], v[52:55]
    v_mfma_f32_16x16x32_bf16 v[56:59], v[172:175], v[184:187], v[56:59]
    v_mfma_f32_16x16x32_bf16 v[60:63], v[172:175], v[188:191], v[60:63]
    v_mfma_f32_16x16x32_bf16 v[64:67], v[176:179], v[184:187], v[64:67]
    v_mfma_f32_16x16x32_bf16 v[68:71], v[176:179], v[188:191], v[68:71]
    v_mfma_f32_16x16x32_bf16 v[72:75], v[180:183], v[184:187], v[72:75]
    v_mfma_f32_16x16x32_bf16 v[76:79], v[180:183], v[188:191], v[76:79]
    v_mfma_f32_16x16x32_bf16 v[80:83], v[192:195], v[184:187], v[80:83]
    v_mfma_f32_16x16x32_bf16 v[84:87], v[192:195], v[188:191], v[84:87]
    s_waitcnt lgkmcnt(0)
    s_barrier
    v_mfma_f32_16x16x32_bf16 v[16:19], v[212:215], v[204:207], v[16:19]
    ds_read_b128 v[160:163], v200 offset:0
    v_mfma_f32_16x16x32_bf16 v[20:23], v[212:215], v[208:211], v[20:23]
    ds_read_b128 v[164:167], v200 offset:2048
    v_mfma_f32_16x16x32_bf16 v[24:27], v[216:219], v[204:207], v[24:27]
    ds_read_b128 v[192:195], v198 offset:0
    v_mfma_f32_16x16x32_bf16 v[28:31], v[216:219], v[208:211], v[28:31]
    ds_read_b128 v[168:171], v201 offset:0
    v_mfma_f32_16x16x32_bf16 v[32:35], v[220:223], v[204:207], v[32:35]
    ds_read_b128 v[172:175], v201 offset:2048
    v_mfma_f32_16x16x32_bf16 v[36:39], v[220:223], v[208:211], v[36:39]
    ds_read_b128 v[176:179], v200 offset:36864
    v_mfma_f32_16x16x32_bf16 v[40:43], v[224:227], v[204:207], v[40:43]
    ds_read_b128 v[180:183], v200 offset:38912
    v_mfma_f32_16x16x32_bf16 v[44:47], v[224:227], v[208:211], v[44:47]
    ds_read_b128 v[184:187], v201 offset:36864
    v_mfma_f32_16x16x32_bf16 v[48:51], v[212:215], v[228:231], v[48:51]
    ds_read_b128 v[188:191], v201 offset:38912
    v_mfma_f32_16x16x32_bf16 v[52:55], v[212:215], v[232:235], v[52:55]
    ds_read_b128 v[240:243], v198 offset:9216
    v_mfma_f32_16x16x32_bf16 v[56:59], v[216:219], v[228:231], v[56:59]
    ds_read_b128 v[244:247], v198 offset:36864
    v_mfma_f32_16x16x32_bf16 v[60:63], v[216:219], v[232:235], v[60:63]
    ds_read_b128 v[248:251], v198 offset:46080
    v_mfma_f32_16x16x32_bf16 v[64:67], v[220:223], v[228:231], v[64:67]
    ds_read_b128 v[4:7], v198 offset:1024
    v_mfma_f32_16x16x32_bf16 v[68:71], v[220:223], v[232:235], v[68:71]
    v_mfma_f32_16x16x32_bf16 v[72:75], v[224:227], v[228:231], v[72:75]
    v_mfma_f32_16x16x32_bf16 v[76:79], v[224:227], v[232:235], v[76:79]
    v_mfma_f32_16x16x32_bf16 v[80:83], v[236:239], v[228:231], v[80:83]
    v_mfma_f32_16x16x32_bf16 v[84:87], v[236:239], v[232:235], v[84:87]
    s_waitcnt lgkmcnt(0)
    v_mfma_f32_16x16x32_bf16 v[16:19], v[192:195], v[160:163], v[16:19]
    ds_read_b128 v[252:255], v198 offset:10240
    v_mfma_f32_16x16x32_bf16 v[20:23], v[192:195], v[164:167], v[20:23]
    ds_read_b128 v[204:207], v8 offset:0
    v_mfma_f32_16x16x32_bf16 v[16:19], v[240:243], v[168:171], v[16:19]
    ds_read_b128 v[236:239], v198 offset:37888
    v_mfma_f32_16x16x32_bf16 v[20:23], v[240:243], v[172:175], v[20:23]
    ds_read_b128 v[208:211], v8 offset:2048
    v_mfma_f32_16x16x32_bf16 v[16:19], v[244:247], v[176:179], v[16:19]
    ds_read_b128 v[192:195], v198 offset:47104
    v_mfma_f32_16x16x32_bf16 v[20:23], v[244:247], v[180:183], v[20:23]
    ds_read_b128 v[212:215], v9 offset:0
    v_mfma_f32_16x16x32_bf16 v[16:19], v[248:251], v[184:187], v[16:19]
    ds_read_b128 v[240:243], v198 offset:2048
    v_mfma_f32_16x16x32_bf16 v[20:23], v[248:251], v[188:191], v[20:23]
    ds_read_b128 v[216:219], v9 offset:2048
    v_mfma_f32_16x16x32_bf16 v[24:27], v[4:7], v[160:163], v[24:27]
    ds_read_b128 v[244:247], v198 offset:11264
    v_mfma_f32_16x16x32_bf16 v[28:31], v[4:7], v[164:167], v[28:31]
    ds_read_b128 v[220:223], v8 offset:36864
    s_waitcnt lgkmcnt(9)
    v_mfma_f32_16x16x32_bf16 v[24:27], v[252:255], v[168:171], v[24:27]
    ds_read_b128 v[248:251], v198 offset:38912
    v_mfma_f32_16x16x32_bf16 v[28:31], v[252:255], v[172:175], v[28:31]
    ds_read_b128 v[224:227], v8 offset:38912
    s_waitcnt lgkmcnt(9)
    v_mfma_f32_16x16x32_bf16 v[24:27], v[236:239], v[176:179], v[24:27]
    ds_read_b128 v[4:7], v198 offset:48128
    v_mul_f32 v16, v16, v88
    v_mfma_f32_16x16x32_bf16 v[28:31], v[236:239], v[180:183], v[28:31]
    ds_read_b128 v[228:231], v9 offset:36864
    v_mul_f32 v17, v17, v89
    s_waitcnt lgkmcnt(9)
    v_mfma_f32_16x16x32_bf16 v[24:27], v[192:195], v[184:187], v[24:27]
    ds_read_b128 v[252:255], v198 offset:3072
    v_mul_f32_e64 v18, v18, v90
    v_mfma_f32_16x16x32_bf16 v[28:31], v[192:195], v[188:191], v[28:31]
    ds_read_b128 v[232:235], v9 offset:38912
    v_mul_f32 v19, v19, v91
    s_waitcnt lgkmcnt(9)
    v_mfma_f32_16x16x32_bf16 v[32:35], v[240:243], v[160:163], v[32:35]
    ds_read_b128 v[236:239], v198 offset:12288
    v_cvt_pk_bf16_f32 v88, v16, v17
    v_mfma_f32_16x16x32_bf16 v[36:39], v[240:243], v[164:167], v[36:39]
    v_cvt_pk_bf16_f32 v89, v18, v19
    v_mul_f32 v20, v20, v92
    s_waitcnt lgkmcnt(8)
    v_mfma_f32_16x16x32_bf16 v[32:35], v[244:247], v[168:171], v[32:35]
    ds_read_b128 v[192:195], v198 offset:39936
    v_mul_f32_e64 v21, v21, v93
    v_mfma_f32_16x16x32_bf16 v[36:39], v[244:247], v[172:175], v[36:39]
    v_mul_f32 v22, v22, v94
    v_mul_f32_e64 v23, v23, v95
    s_waitcnt lgkmcnt(7)
    v_mfma_f32_16x16x32_bf16 v[32:35], v[248:251], v[176:179], v[32:35]
    ds_read_b128 v[240:243], v198 offset:49152
    v_cvt_pk_bf16_f32 v92, v20, v21
    v_mfma_f32_16x16x32_bf16 v[36:39], v[248:251], v[180:183], v[36:39]
    v_cvt_pk_bf16_f32 v93, v22, v23
    v_mul_f32 v24, v24, v96
    v_mul_f32_e64 v25, v25, v97
    s_waitcnt lgkmcnt(6)
    v_mfma_f32_16x16x32_bf16 v[32:35], v[4:7], v[184:187], v[32:35]
    ds_read_b128 v[244:247], v198 offset:0
    v_mul_f32_e64 v26, v26, v98
    v_mfma_f32_16x16x32_bf16 v[36:39], v[4:7], v[188:191], v[36:39]
    v_mul_f32_e64 v27, v27, v99
    v_cvt_pk_bf16_f32 v90, v24, v25
    s_waitcnt lgkmcnt(5)
    v_mfma_f32_16x16x32_bf16 v[40:43], v[252:255], v[160:163], v[40:43]
    ds_read_b128 v[248:251], v198 offset:9216
    v_cvt_pk_bf16_f32 v91, v26, v27
    v_mfma_f32_16x16x32_bf16 v[44:47], v[252:255], v[164:167], v[44:47]
    buffer_store_dwordx4 v[88:91], v13, s[4:7], s36 offen sc1
    v_mul_f32_e64 v28, v28, v100
    s_waitcnt lgkmcnt(4)
    v_mfma_f32_16x16x32_bf16 v[40:43], v[236:239], v[168:171], v[40:43]
    ds_read_b128 v[4:7], v198 offset:36864
    v_mul_f32_e64 v29, v29, v101
    v_mfma_f32_16x16x32_bf16 v[44:47], v[236:239], v[172:175], v[44:47]
    v_mul_f32 v30, v30, v102
    v_mul_f32_e64 v31, v31, v103
    s_waitcnt lgkmcnt(4)
    v_mfma_f32_16x16x32_bf16 v[40:43], v[192:195], v[176:179], v[40:43]
    ds_read_b128 v[252:255], v198 offset:46080
    v_cvt_pk_bf16_f32 v94, v28, v29
    v_mfma_f32_16x16x32_bf16 v[44:47], v[192:195], v[180:183], v[44:47]
    v_cvt_pk_bf16_f32 v95, v30, v31
    buffer_store_dwordx4 v[92:95], v13, s[4:7], s37 offen sc1
    v_mul_f32 v32, v32, v104
    s_waitcnt lgkmcnt(4)
    v_mfma_f32_16x16x32_bf16 v[40:43], v[240:243], v[184:187], v[40:43]
    ds_read_b128 v[236:239], v198 offset:1024
    v_mul_f32_e64 v33, v33, v105
    v_mfma_f32_16x16x32_bf16 v[44:47], v[240:243], v[188:191], v[44:47]
    v_mul_f32 v34, v34, v106
    v_mul_f32_e64 v35, v35, v107
    s_waitcnt lgkmcnt(4)
    v_mfma_f32_16x16x32_bf16 v[48:51], v[244:247], v[204:207], v[48:51]
    ds_read_b128 v[192:195], v198 offset:10240
    v_cvt_pk_bf16_f32 v104, v32, v33
    v_mfma_f32_16x16x32_bf16 v[52:55], v[244:247], v[208:211], v[52:55]
    v_cvt_pk_bf16_f32 v105, v34, v35
    v_mul_f32 v36, v36, v108
    s_waitcnt lgkmcnt(4)
    v_mfma_f32_16x16x32_bf16 v[48:51], v[248:251], v[212:215], v[48:51]
    ds_read_b128 v[240:243], v198 offset:37888
    v_mul_f32_e64 v37, v37, v109
    v_mfma_f32_16x16x32_bf16 v[52:55], v[248:251], v[216:219], v[52:55]
    v_mul_f32 v38, v38, v110
    v_mul_f32_e64 v39, v39, v111
    s_waitcnt lgkmcnt(4)
    v_mfma_f32_16x16x32_bf16 v[48:51], v[4:7], v[220:223], v[48:51]
    ds_read_b128 v[244:247], v198 offset:47104
    v_cvt_pk_bf16_f32 v108, v36, v37
    v_mfma_f32_16x16x32_bf16 v[52:55], v[4:7], v[224:227], v[52:55]
    v_cvt_pk_bf16_f32 v109, v38, v39
    v_mul_f32 v40, v40, v112
    v_mul_f32_e64 v41, v41, v113
    s_waitcnt lgkmcnt(4)
    v_mfma_f32_16x16x32_bf16 v[48:51], v[252:255], v[228:231], v[48:51]
    ds_read_b128 v[248:251], v198 offset:2048
    v_mul_f32_e64 v42, v42, v114
    v_mfma_f32_16x16x32_bf16 v[52:55], v[252:255], v[232:235], v[52:55]
    v_mul_f32_e64 v43, v43, v115
    v_cvt_pk_bf16_f32 v106, v40, v41
    s_waitcnt lgkmcnt(4)
    v_mfma_f32_16x16x32_bf16 v[56:59], v[236:239], v[204:207], v[56:59]
    ds_read_b128 v[4:7], v198 offset:11264
    v_cvt_pk_bf16_f32 v107, v42, v43
    v_mfma_f32_16x16x32_bf16 v[60:63], v[236:239], v[208:211], v[60:63]
    buffer_store_dwordx4 v[104:107], v14, s[4:7], s36 offen sc1
    v_mul_f32_e64 v44, v44, v116
    s_waitcnt lgkmcnt(4)
    v_mfma_f32_16x16x32_bf16 v[56:59], v[192:195], v[212:215], v[56:59]
    ds_read_b128 v[252:255], v198 offset:38912
    v_mul_f32_e64 v45, v45, v117
    v_mfma_f32_16x16x32_bf16 v[60:63], v[192:195], v[216:219], v[60:63]
    v_mul_f32 v46, v46, v118
    v_mul_f32_e64 v47, v47, v119
    s_waitcnt lgkmcnt(4)
    v_mfma_f32_16x16x32_bf16 v[56:59], v[240:243], v[220:223], v[56:59]
    ds_read_b128 v[236:239], v198 offset:48128
    v_cvt_pk_bf16_f32 v110, v44, v45
    v_mfma_f32_16x16x32_bf16 v[60:63], v[240:243], v[224:227], v[60:63]
    v_cvt_pk_bf16_f32 v111, v46, v47
    buffer_store_dwordx4 v[108:111], v14, s[4:7], s37 offen sc1
    v_mul_f32 v48, v48, v120
    s_waitcnt lgkmcnt(4)
    v_mfma_f32_16x16x32_bf16 v[56:59], v[244:247], v[228:231], v[56:59]
    ds_read_b128 v[192:195], v198 offset:3072
    v_mul_f32_e64 v49, v49, v121
    v_mfma_f32_16x16x32_bf16 v[60:63], v[244:247], v[232:235], v[60:63]
    v_mul_f32 v50, v50, v122
    v_mul_f32_e64 v51, v51, v123
    s_waitcnt lgkmcnt(4)
    v_mfma_f32_16x16x32_bf16 v[64:67], v[248:251], v[204:207], v[64:67]
    ds_read_b128 v[240:243], v198 offset:12288
    v_cvt_pk_bf16_f32 v120, v48, v49
    v_mfma_f32_16x16x32_bf16 v[68:71], v[248:251], v[208:211], v[68:71]
    v_cvt_pk_bf16_f32 v121, v50, v51
    v_mul_f32 v52, v52, v124
    s_waitcnt lgkmcnt(4)
    v_mfma_f32_16x16x32_bf16 v[64:67], v[4:7], v[212:215], v[64:67]
    ds_read_b128 v[244:247], v198 offset:39936
    v_mul_f32_e64 v53, v53, v125
    v_mfma_f32_16x16x32_bf16 v[68:71], v[4:7], v[216:219], v[68:71]
    v_mul_f32 v54, v54, v126
    v_mul_f32_e64 v55, v55, v127
    s_waitcnt lgkmcnt(4)
    v_mfma_f32_16x16x32_bf16 v[64:67], v[252:255], v[220:223], v[64:67]
    ds_read_b128 v[248:251], v198 offset:49152
    v_cvt_pk_bf16_f32 v124, v52, v53
    v_mfma_f32_16x16x32_bf16 v[68:71], v[252:255], v[224:227], v[68:71]
    v_cvt_pk_bf16_f32 v125, v54, v55
    v_mul_f32 v56, v56, v128
    v_mul_f32_e64 v57, v57, v129
    s_waitcnt lgkmcnt(4)
    v_mfma_f32_16x16x32_bf16 v[64:67], v[236:239], v[228:231], v[64:67]
    ds_read_b128 v[4:7], v1 offset:8192
    v_mul_f32_e64 v58, v58, v130
    v_mfma_f32_16x16x32_bf16 v[68:71], v[236:239], v[232:235], v[68:71]
    v_mul_f32_e64 v59, v59, v131
    v_cvt_pk_bf16_f32 v122, v56, v57
    s_waitcnt lgkmcnt(4)
    v_mfma_f32_16x16x32_bf16 v[72:75], v[192:195], v[204:207], v[72:75]
    ds_read_b128 v[252:255], v1 offset:17408
    v_cvt_pk_bf16_f32 v123, v58, v59
    v_mfma_f32_16x16x32_bf16 v[76:79], v[192:195], v[208:211], v[76:79]
    buffer_store_dwordx4 v[120:123], v13, s[4:7], s39 offen sc1
    v_mul_f32_e64 v60, v60, v132
    s_waitcnt lgkmcnt(4)
    v_mfma_f32_16x16x32_bf16 v[72:75], v[240:243], v[212:215], v[72:75]
    ds_read_b128 v[236:239], v1 offset:45056
    v_mul_f32_e64 v61, v61, v133
    v_mfma_f32_16x16x32_bf16 v[76:79], v[240:243], v[216:219], v[76:79]
    v_mul_f32 v62, v62, v134
    v_mul_f32_e64 v63, v63, v135
    s_waitcnt lgkmcnt(4)
    v_mfma_f32_16x16x32_bf16 v[72:75], v[244:247], v[220:223], v[72:75]
    ds_read_b128 v[192:195], v1 offset:54272
    v_cvt_pk_bf16_f32 v126, v60, v61
    v_mfma_f32_16x16x32_bf16 v[76:79], v[244:247], v[224:227], v[76:79]
    v_cvt_pk_bf16_f32 v127, v62, v63
    buffer_store_dwordx4 v[124:127], v13, s[4:7], s40 offen sc1
    v_mul_f32 v64, v64, v136
    s_waitcnt lgkmcnt(4)
    v_mfma_f32_16x16x32_bf16 v[72:75], v[248:251], v[228:231], v[72:75]
    v_mul_f32 v65, v65, v137
    v_mul_f32 v66, v66, v138
    v_mfma_f32_16x16x32_bf16 v[76:79], v[248:251], v[232:235], v[76:79]
    v_mul_f32_e64 v67, v67, v139
    v_cvt_pk_bf16_f32 v136, v64, v65
    s_waitcnt lgkmcnt(3)
    v_mfma_f32_16x16x32_bf16 v[80:83], v[4:7], v[204:207], v[80:83]
    v_cvt_pk_bf16_f32 v137, v66, v67
    v_mul_f32 v68, v68, v140
    v_mfma_f32_16x16x32_bf16 v[84:87], v[4:7], v[208:211], v[84:87]
    v_mul_f32 v69, v69, v141
    v_mul_f32_e64 v70, v70, v142
    s_waitcnt lgkmcnt(2)
    v_mfma_f32_16x16x32_bf16 v[80:83], v[252:255], v[212:215], v[80:83]
    v_mul_f32_e64 v71, v71, v143
    v_cvt_pk_bf16_f32 v140, v68, v69
    v_mfma_f32_16x16x32_bf16 v[84:87], v[252:255], v[216:219], v[84:87]
    v_cvt_pk_bf16_f32 v141, v70, v71
    s_waitcnt lgkmcnt(1)
    v_mfma_f32_16x16x32_bf16 v[80:83], v[236:239], v[220:223], v[80:83]
    v_mul_f32 v72, v72, v144
    v_mul_f32_e64 v73, v73, v145
    v_mfma_f32_16x16x32_bf16 v[84:87], v[236:239], v[224:227], v[84:87]
    v_mul_f32 v74, v74, v146
    v_mul_f32 v75, v75, v147
    v_cvt_pk_bf16_f32 v138, v72, v73
    s_waitcnt lgkmcnt(0)
    v_mfma_f32_16x16x32_bf16 v[80:83], v[192:195], v[228:231], v[80:83]
    v_cvt_pk_bf16_f32 v139, v74, v75
    buffer_store_dwordx4 v[136:139], v14, s[4:7], s39 offen sc1
    v_mfma_f32_16x16x32_bf16 v[84:87], v[192:195], v[232:235], v[84:87]
    v_mul_f32 v76, v76, v148
    v_mul_f32 v77, v77, v149
    v_mul_f32 v78, v78, v150
    v_mul_f32_e64 v79, v79, v151
    v_cvt_pk_bf16_f32 v142, v76, v77
    v_cvt_pk_bf16_f32 v143, v78, v79
    buffer_store_dwordx4 v[140:143], v14, s[4:7], s40 offen sc1
    s_nop 1
    v_mul_f32 v80, v80, v152
    v_mul_f32 v81, v81, v153
    v_mul_f32 v82, v82, v154
    v_mul_f32_e64 v83, v83, v155
    v_cvt_pk_bf16_f32 v152, v80, v81
    v_cvt_pk_bf16_f32 v153, v82, v83
    v_mul_f32 v84, v84, v156
    v_mul_f32 v85, v85, v157
    v_mul_f32 v86, v86, v158
    v_mul_f32 v87, v87, v159
    v_cvt_pk_bf16_f32 v154, v84, v85
    v_cvt_pk_bf16_f32 v155, v86, v87
    s_bitcmp0_b32 s24, 1
    s_cbranch_scc1 L_g_ns
    v_swap_b32 v152, v154
    v_swap_b32 v153, v155
L_g_ns:
    buffer_store_dwordx4 v[152:155], v15, s[4:7], s39 offen sc1
    s_barrier
    s_and_b32 s25, s2, 7
    s_lshr_b32 s26, s2, 3
    s_lshr_b32 s23, s25, 1
    s_lshl_b32 s23, s23, 3
    s_lshr_b32 s27, s26, 2
    s_add_u32 s23, s23, s27
    s_and_b32 s24, s25, 1
    s_lshl_b32 s24, s24, 2
    s_and_b32 s27, s26, 3
    s_add_u32 s24, s24, s27
    s_add_u32 s25, s23, s24
    s_and_b32 s25, s25, 3
    s_lshl_b32 s30, s23, 2
    s_add_u32 s30, s30, s20
    s_and_b32 s31, s20, 1
    s_mul_i32 s34, s30, 18432
    s_add_u32 s34, s34, s21
    s_add_u32 s34, s34, 0x300000
    s_lshl_b32 s35, s24, 11
    s_lshr_b32 s36, s24, 2
    s_lshl_b32 s36, s36, 10
    s_and_b32 s37, s24, 3
    s_lshl_b32 s37, s37, 8
    s_add_u32 s36, s36, s37
    s_add_u32 s36, s36, 16384
    v_bfe_u32 v2, v1, 4, 4
    v_lshrrev_b32 v3, 8, v1
    v_add_u32 v4, s35, v1
    v_lshrrev_b32 v0, 1, v3
    v_and_b32_e64 v9, 1, v3
    v_cmp_eq_u32 s[40:41], s31, v0
    v_bfrev_b32 v6, 1
    v_lshlrev_b32 v5, 4, v2
    v_lshl_add_u32 v5, v9, 3, v5
    v_add_u32_e64 v5, s36, v5
    v_cndmask_b32 v5, v6, v5, s[40:41]
    buffer_load_dwordx4 v[220:223], v4, s[4:7], s34 offen offset:0 sc1
    buffer_load_dwordx4 v[224:227], v4, s[4:7], s34 offen offset:1024 sc1
    buffer_load_dwordx2 v[228:229], v5, s[4:7], s34 offen sc1
    s_and_b32 s29, s30, 0xfffe
    s_mul_i32 s29, s29, 73728
    s_add_u32 s29, s29, s21
    s_lshl_b32 s37, s31, 10
    s_add_u32 s29, s29, s37
    s_add_u32 s29, s29, 0x1200000
    s_mul_i32 s37, s31, 73728
    s_sub_u32 s38, 73728, s37
    v_lshlrev_b32 v10, 3, v2
    v_add_u32 v16, s37, v1
    v_add_u32 v17, s38, v1
    v_mov_b32_e64 v18, v1
    v_add_u32 v19, 73728, v1
    s_lshl_b32 s37, s31, 12
    v_add_u32 v20, 0, v1
    v_add_u32_e64 v12, s37, v20
    v_add_u32 v21, 36864, v1
    v_add_u32_e64 v13, s37, v21
    v_add_u32 v22, 73728, v1
    v_add_u32_e64 v14, s37, v22
    v_add_u32 v23, 110592, v1
    v_add_u32_e64 v15, s37, v23
    s_add_u32 s34, s34, 0x1900000
    s_lshl_b32 s39, s30, 10
    s_add_u32 s39, s39, s21
    s_lshl_b32 s42, s24, 7
    s_add_u32 s39, s39, s42
    s_add_u32 s39, s39, 0x3700000
    v_cmp_eq_u32_e64 vcc, 0, v3
    v_mov_b32 v11, 0x3f803f80
    s_lshr_b32 s44, s23, 1
    v_cndmask_b32 v10, v6, v10, vcc
    s_cmp_eq_u32 s22, 0
    s_cbranch_scc1 L_p5_nf
    v_mul_u32_u24 v8, 1152, v2
    s_mul_i32 s34, s30, 18432
    s_mul_i32 s42, s24, 144
    s_add_u32 s34, s34, s42
    v_lshrrev_b32 v4, 6, v1
    v_bfe_u32 v5, v1, 4, 2
    v_lshlrev_b32_e64 v10, 2, v4
    v_lshl_add_u32 v10, v5, 6, v10
    v_mul_u32_u24 v8, 1152, v4
    v_lshrrev_b32 v11, 1, v5
    v_cmp_eq_u32 vcc, s31, v11
    v_lshl_add_u32 v4, v5, 4, v8
    v_and_b32_e64 v5, 1, v5
    v_lshl_add_u32 v5, v5, 3, v8
    v_cndmask_b32 v5, v6, v5, vcc
L_p5_nf:
    s_lshl_b32 s52, s22, 7
    s_add_u32 s52, s52, s44
    s_lshl_b32 s52, s52, 8
    s_add_u32 s52, s52, 0x450a000
    s_add_u32 s52, s52, s4
    s_addc_u32 s53, s5, 0
    s_waitcnt vmcnt(3)
    s_barrier
    s_cmp_lg_u32 s20, 0
    s_cbranch_scc1 L_ns_d5
    s_mov_b32 s56, 1
    s_atomic_add s56, s[50:51], 0
L_ns_d5:
    s_mul_i32 s37, s20, 4608
    s_add_u32 s37, s37, 129024
    s_xor_b32 s38, s20, 1
    s_mul_i32 s42, s38, 4608
    s_add_u32 s42, s42, 129024
    v_and_b32 v0, 0x1ff, v1
    v_add_u32 v2, s37, v1
    v_add_u32 v3, s37, v0
    v_add_u32 v7, s42, v1
    v_add_u32_e64 v8, s42, v0
    s_lshl_b32 s37, s20, 2
    s_add_u32 s37, s37, 163808
    s_xor_b32 s38, s37, 4
    v_mov_b32 v0, s37
    v_mov_b32 v6, s38
    s_lshl_b32 s43, s22, 1
    s_add_u32 s43, s43, 2
    v_mov_b32 v9, s43
    s_cmp_lg_u32 s20, 0
    s_cbranch_scc1 L_pd_d5
    s_mov_b32 s60, 262144
L_poll_d5:
    s_mov_b32 s57, 0
    s_atomic_add s57, s[52:53], 0 glc
    s_waitcnt lgkmcnt(0)
    s_cmp_ge_u32 s57, 16
    s_cbranch_scc1 L_pd_d5
    s_sub_u32 s60, s60, 1
    s_cbranch_scc1 L_pd_d5
    s_sleep 2
    s_branch L_poll_d5
L_pd_d5:
    s_barrier
    s_mov_b32 s32, 0
    s_lshl_b32 s32, s32, 13
    s_add_u32 s32, s32, s29
    s_add_u32 s33, s32, 4096
    buffer_load_dwordx4 v[124:127], v16, s[4:7], s32 offen offset:0 sc1
    buffer_load_dwordx4 v[128:131], v17, s[4:7], s32 offen offset:0 sc1
    buffer_load_dwordx4 v[132:135], v16, s[4:7], s32 offen offset:2048 sc1
    buffer_load_dwordx4 v[136:139], v17, s[4:7], s32 offen offset:2048 sc1
    buffer_load_dwordx4 v[140:143], v16, s[4:7], s33 offen offset:0 sc1
    buffer_load_dwordx4 v[144:147], v17, s[4:7], s33 offen offset:0 sc1
    buffer_load_dwordx4 v[148:151], v16, s[4:7], s33 offen offset:2048 sc1
    buffer_load_dwordx4 v[152:155], v17, s[4:7], s33 offen offset:2048 sc1
    ds_read_b128 v[64:67], v14 offset:0
    ds_read_b128 v[68:71], v14 offset:1024
    ds_read_b128 v[72:75], v14 offset:2048
    ds_read_b128 v[76:79], v14 offset:3072
    ds_read_b128 v[80:83], v22 offset:8192
    ds_read_b128 v[84:87], v14 offset:9216
    ds_read_b128 v[88:91], v14 offset:10240
    ds_read_b128 v[92:95], v14 offset:11264
    ds_read_b128 v[96:99], v14 offset:12288
    ds_read_b128 v[100:103], v22 offset:17408
    ds_read_b128 v[104:107], v14 offset:18432
    ds_read_b128 v[108:111], v14 offset:19456
    ds_read_b128 v[112:115], v14 offset:20480
    ds_read_b128 v[116:119], v14 offset:21504
    ds_read_b128 v[120:123], v22 offset:26624
    s_add_u32 s45, s29, 8192
    s_add_u32 s46, s29, 12288
    buffer_load_dwordx4 v[156:159], v16, s[4:7], s45 offen offset:0 sc1
    buffer_load_dwordx4 v[160:163], v17, s[4:7], s45 offen offset:0 sc1
    s_lshl_b32 s50, s22, 7
    s_add_u32 s50, s50, s44
    s_lshl_b32 s50, s50, 8
    s_add_u32 s50, s50, 0x450b000
    s_add_u32 s50, s50, s4
    s_addc_u32 s51, s5, 0
    s_waitcnt vmcnt(10)
    v_lshlrev_b32_e64 v24, 16, v220
    v_and_b32 v25, 0xffff0000, v220
    v_lshlrev_b32_e64 v26, 16, v221
    v_and_b32 v27, 0xffff0000, v221
    v_lshlrev_b32_e64 v28, 16, v222
    v_and_b32 v29, 0xffff0000, v222
    v_lshlrev_b32_e64 v30, 16, v223
    v_and_b32 v31, 0xffff0000, v223
    v_lshlrev_b32_e64 v32, 16, v224
    v_and_b32 v33, 0xffff0000, v224
    v_lshlrev_b32_e64 v34, 16, v225
    v_and_b32 v35, 0xffff0000, v225
    v_lshlrev_b32_e64 v36, 16, v226
    v_and_b32 v37, 0xffff0000, v226
    v_lshlrev_b32_e64 v38, 16, v227
    v_and_b32 v39, 0xffff0000, v227
    v_lshlrev_b32_e64 v40, 16, v228
    v_and_b32 v41, 0xffff0000, v228
    v_lshlrev_b32_e64 v42, 16, v229
    v_and_b32 v43, 0xffff0000, v229
    s_waitcnt vmcnt(8) lgkmcnt(10)
    v_mfma_f32_16x16x32_bf16 v[44:47], v[64:67], v[128:131], 0
    ds_read_b128 v[236:239], v14 offset:27648
    s_mov_b32 s32, 2
    s_lshl_b32 s32, s32, 13
    s_add_u32 s32, s32, s29
    s_add_u32 s33, s32, 4096
    v_mfma_f32_16x16x32_bf16 v[24:27], v[64:67], v[124:127], v[24:27]
    ds_read_b128 v[240:243], v14 offset:28672
    buffer_load_dwordx4 v[164:167], v16, s[4:7], s45 offen offset:2048 sc1
    v_mfma_f32_16x16x32_bf16 v[48:51], v[68:71], v[128:131], 0
    ds_read_b128 v[244:247], v14 offset:29696
    v_mfma_f32_16x16x32_bf16 v[28:31], v[68:71], v[124:127], v[28:31]
    ds_read_b128 v[248:251], v14 offset:30720
    buffer_load_dwordx4 v[168:171], v17, s[4:7], s45 offen offset:2048 sc1
    v_mfma_f32_16x16x32_bf16 v[52:55], v[72:75], v[128:131], 0
    ds_read_b128 v[252:255], v22 offset:35840
    v_mfma_f32_16x16x32_bf16 v[32:35], v[72:75], v[124:127], v[32:35]
    buffer_load_dwordx4 v[188:191], v16, s[4:7], s32 offen offset:0 sc1
    v_mfma_f32_16x16x32_bf16 v[56:59], v[76:79], v[128:131], 0
    v_mfma_f32_16x16x32_bf16 v[36:39], v[76:79], v[124:127], v[36:39]
    buffer_load_dwordx4 v[192:195], v17, s[4:7], s32 offen offset:0 sc1
    v_mfma_f32_16x16x32_bf16 v[60:63], v[80:83], v[128:131], 0
    v_mfma_f32_16x16x32_bf16 v[40:43], v[80:83], v[124:127], v[40:43]
    s_waitcnt vmcnt(10) lgkmcnt(0)
    s_barrier
    v_mfma_f32_16x16x32_bf16 v[44:47], v[84:87], v[136:139], v[44:47]
    ds_read_b128 v[64:67], v15 offset:0
    v_mfma_f32_16x16x32_bf16 v[24:27], v[84:87], v[132:135], v[24:27]
    ds_read_b128 v[68:71], v15 offset:1024
    buffer_load_dwordx4 v[172:175], v16, s[4:7], s46 offen offset:0 sc1
    v_mfma_f32_16x16x32_bf16 v[48:51], v[88:91], v[136:139], v[48:51]
    ds_read_b128 v[72:75], v15 offset:2048
    v_mfma_f32_16x16x32_bf16 v[28:31], v[88:91], v[132:135], v[28:31]
    ds_read_b128 v[76:79], v15 offset:3072
    buffer_load_dwordx4 v[176:179], v17, s[4:7], s46 offen offset:0 sc1
    v_mfma_f32_16x16x32_bf16 v[52:55], v[92:95], v[136:139], v[52:55]
    ds_read_b128 v[80:83], v23 offset:8192
    v_mfma_f32_16x16x32_bf16 v[32:35], v[92:95], v[132:135], v[32:35]
    buffer_load_dwordx4 v[196:199], v16, s[4:7], s32 offen offset:2048 sc1
    v_mfma_f32_16x16x32_bf16 v[56:59], v[96:99], v[136:139], v[56:59]
    v_mfma_f32_16x16x32_bf16 v[36:39], v[96:99], v[132:135], v[36:39]
    buffer_load_dwordx4 v[200:203], v17, s[4:7], s32 offen offset:2048 sc1
    v_mfma_f32_16x16x32_bf16 v[60:63], v[100:103], v[136:139], v[60:63]
    v_mfma_f32_16x16x32_bf16 v[40:43], v[100:103], v[132:135], v[40:43]
    s_waitcnt vmcnt(12) lgkmcnt(10)
    v_mfma_f32_16x16x32_bf16 v[44:47], v[104:107], v[144:147], v[44:47]
    ds_read_b128 v[84:87], v15 offset:9216
    v_mfma_f32_16x16x32_bf16 v[24:27], v[104:107], v[140:143], v[24:27]
    ds_read_b128 v[88:91], v15 offset:10240
    buffer_load_dwordx4 v[180:183], v16, s[4:7], s46 offen offset:2048 sc1
    v_mfma_f32_16x16x32_bf16 v[48:51], v[108:111], v[144:147], v[48:51]
    ds_read_b128 v[92:95], v15 offset:11264
    v_mfma_f32_16x16x32_bf16 v[28:31], v[108:111], v[140:143], v[28:31]
    ds_read_b128 v[96:99], v15 offset:12288
    buffer_load_dwordx4 v[184:187], v17, s[4:7], s46 offen offset:2048 sc1
    v_mfma_f32_16x16x32_bf16 v[52:55], v[112:115], v[144:147], v[52:55]
    ds_read_b128 v[100:103], v23 offset:17408
    v_mfma_f32_16x16x32_bf16 v[32:35], v[112:115], v[140:143], v[32:35]
    buffer_load_dwordx4 v[204:207], v16, s[4:7], s33 offen offset:0 sc1
    v_mfma_f32_16x16x32_bf16 v[56:59], v[116:119], v[144:147], v[56:59]
    v_mfma_f32_16x16x32_bf16 v[36:39], v[116:119], v[140:143], v[36:39]
    buffer_load_dwordx4 v[208:211], v17, s[4:7], s33 offen offset:0 sc1
    v_mfma_f32_16x16x32_bf16 v[60:63], v[120:123], v[144:147], v[60:63]
    v_mfma_f32_16x16x32_bf16 v[40:43], v[120:123], v[140:143], v[40:43]
    s_waitcnt vmcnt(14) lgkmcnt(10)
    v_mfma_f32_16x16x32_bf16 v[44:47], v[236:239], v[152:155], v[44:47]
    ds_read_b128 v[104:107], v15 offset:18432
    v_mfma_f32_16x16x32_bf16 v[24:27], v[236:239], v[148:151], v[24:27]
    ds_read_b128 v[108:111], v15 offset:19456
    v_mfma_f32_16x16x32_bf16 v[48:51], v[240:243], v[152:155], v[48:51]
    ds_read_b128 v[112:115], v15 offset:20480
    v_mfma_f32_16x16x32_bf16 v[28:31], v[240:243], v[148:151], v[28:31]
    ds_read_b128 v[116:119], v15 offset:21504
    v_mfma_f32_16x16x32_bf16 v[52:55], v[244:247], v[152:155], v[52:55]
    ds_read_b128 v[120:123], v23 offset:26624
    v_mfma_f32_16x16x32_bf16 v[32:35], v[244:247], v[148:151], v[32:35]
    buffer_load_dwordx4 v[212:215], v16, s[4:7], s33 offen offset:2048 sc1
    v_mfma_f32_16x16x32_bf16 v[56:59], v[248:251], v[152:155], v[56:59]
    v_mfma_f32_16x16x32_bf16 v[36:39], v[248:251], v[148:151], v[36:39]
    buffer_load_dwordx4 v[216:219], v17, s[4:7], s33 offen offset:2048 sc1
    v_mfma_f32_16x16x32_bf16 v[60:63], v[252:255], v[152:155], v[60:63]
    v_mfma_f32_16x16x32_bf16 v[40:43], v[252:255], v[148:151], v[40:43]
    s_waitcnt vmcnt(14) lgkmcnt(10)
    v_mfma_f32_16x16x32_bf16 v[44:47], v[64:67], v[160:163], v[44:47]
    ds_read_b128 v[236:239], v15 offset:27648
    s_mov_b32 s32, 3
    s_lshl_b32 s32, s32, 13
    s_add_u32 s32, s32, s29
    s_add_u32 s33, s32, 4096
    v_mfma_f32_16x16x32_bf16 v[24:27], v[64:67], v[156:159], v[24:27]
    ds_read_b128 v[240:243], v15 offset:28672
    v_mfma_f32_16x16x32_bf16 v[48:51], v[68:71], v[160:163], v[48:51]
    ds_read_b128 v[244:247], v15 offset:29696
    v_mfma_f32_16x16x32_bf16 v[28:31], v[68:71], v[156:159], v[28:31]
    ds_read_b128 v[248:251], v15 offset:30720
    v_mfma_f32_16x16x32_bf16 v[52:55], v[72:75], v[160:163], v[52:55]
    ds_read_b128 v[252:255], v23 offset:35840
    v_mfma_f32_16x16x32_bf16 v[32:35], v[72:75], v[156:159], v[32:35]
    buffer_load_dwordx4 v[124:127], v16, s[4:7], s32 offen offset:0 sc1
    v_mfma_f32_16x16x32_bf16 v[56:59], v[76:79], v[160:163], v[56:59]
    v_mfma_f32_16x16x32_bf16 v[36:39], v[76:79], v[156:159], v[36:39]
    buffer_load_dwordx4 v[128:131], v17, s[4:7], s32 offen offset:0 sc1
    v_mfma_f32_16x16x32_bf16 v[60:63], v[80:83], v[160:163], v[60:63]
    v_mfma_f32_16x16x32_bf16 v[40:43], v[80:83], v[156:159], v[40:43]
    s_waitcnt vmcnt(14) lgkmcnt(0)
    s_barrier
    v_mfma_f32_16x16x32_bf16 v[44:47], v[84:87], v[168:171], v[44:47]
    ds_read_b128 v[64:67], v12 offset:0
    v_mfma_f32_16x16x32_bf16 v[24:27], v[84:87], v[164:167], v[24:27]
    ds_read_b128 v[68:71], v12 offset:1024
    v_mfma_f32_16x16x32_bf16 v[48:51], v[88:91], v[168:171], v[48:51]
    ds_read_b128 v[72:75], v12 offset:2048
    v_mfma_f32_16x16x32_bf16 v[28:31], v[88:91], v[164:167], v[28:31]
    ds_read_b128 v[76:79], v12 offset:3072
    v_mfma_f32_16x16x32_bf16 v[52:55], v[92:95], v[168:171], v[52:55]
    ds_read_b128 v[80:83], v20 offset:8192
    v_mfma_f32_16x16x32_bf16 v[32:35], v[92:95], v[164:167], v[32:35]
    buffer_load_dwordx4 v[132:135], v16, s[4:7], s32 offen offset:2048 sc1
    v_mfma_f32_16x16x32_bf16 v[56:59], v[96:99], v[168:171], v[56:59]
    v_mfma_f32_16x16x32_bf16 v[36:39], v[96:99], v[164:167], v[36:39]
    buffer_load_dwordx4 v[136:139], v17, s[4:7], s32 offen offset:2048 sc1
    v_mfma_f32_16x16x32_bf16 v[60:63], v[100:103], v[168:171], v[60:63]
    v_mfma_f32_16x16x32_bf16 v[40:43], v[100:103], v[164:167], v[40:43]
    s_waitcnt vmcnt(12) lgkmcnt(10)
    v_mfma_f32_16x16x32_bf16 v[44:47], v[104:107], v[176:179], v[44:47]
    ds_read_b128 v[84:87], v12 offset:9216
    v_mfma_f32_16x16x32_bf16 v[24:27], v[104:107], v[172:175], v[24:27]
    ds_read_b128 v[88:91], v12 offset:10240
    v_mfma_f32_16x16x32_bf16 v[48:51], v[108:111], v[176:179], v[48:51]
    ds_read_b128 v[92:95], v12 offset:11264
    v_mfma_f32_16x16x32_bf16 v[28:31], v[108:111], v[172:175], v[28:31]
    ds_read_b128 v[96:99], v12 offset:12288
    v_mfma_f32_16x16x32_bf16 v[52:55], v[112:115], v[176:179], v[52:55]
    ds_read_b128 v[100:103], v20 offset:17408
    v_mfma_f32_16x16x32_bf16 v[32:35], v[112:115], v[172:175], v[32:35]
    buffer_load_dwordx4 v[140:143], v16, s[4:7], s33 offen offset:0 sc1
    v_mfma_f32_16x16x32_bf16 v[56:59], v[116:119], v[176:179], v[56:59]
    v_mfma_f32_16x16x32_bf16 v[36:39], v[116:119], v[172:175], v[36:39]
    buffer_load_dwordx4 v[144:147], v17, s[4:7], s33 offen offset:0 sc1
    v_mfma_f32_16x16x32_bf16 v[60:63], v[120:123], v[176:179], v[60:63]
    v_mfma_f32_16x16x32_bf16 v[40:43], v[120:123], v[172:175], v[40:43]
    s_waitcnt vmcnt(10) lgkmcnt(10)
    v_mfma_f32_16x16x32_bf16 v[44:47], v[236:239], v[184:187], v[44:47]
    ds_read_b128 v[104:107], v12 offset:18432
    v_mfma_f32_16x16x32_bf16 v[24:27], v[236:239], v[180:183], v[24:27]
    ds_read_b128 v[108:111], v12 offset:19456
    v_mfma_f32_16x16x32_bf16 v[48:51], v[240:243], v[184:187], v[48:51]
    ds_read_b128 v[112:115], v12 offset:20480
    v_mfma_f32_16x16x32_bf16 v[28:31], v[240:243], v[180:183], v[28:31]
    ds_read_b128 v[116:119], v12 offset:21504
    v_mfma_f32_16x16x32_bf16 v[52:55], v[244:247], v[184:187], v[52:55]
    ds_read_b128 v[120:123], v20 offset:26624
    v_mfma_f32_16x16x32_bf16 v[32:35], v[244:247], v[180:183], v[32:35]
    buffer_load_dwordx4 v[148:151], v16, s[4:7], s33 offen offset:2048 sc1
    v_mfma_f32_16x16x32_bf16 v[56:59], v[248:251], v[184:187], v[56:59]
    v_mfma_f32_16x16x32_bf16 v[36:39], v[248:251], v[180:183], v[36:39]
    buffer_load_dwordx4 v[152:155], v17, s[4:7], s33 offen offset:2048 sc1
    v_mfma_f32_16x16x32_bf16 v[60:63], v[252:255], v[184:187], v[60:63]
    v_mfma_f32_16x16x32_bf16 v[40:43], v[252:255], v[180:183], v[40:43]
    s_waitcnt vmcnt(12) lgkmcnt(10)
    v_mfma_f32_16x16x32_bf16 v[44:47], v[64:67], v[192:195], v[44:47]
    ds_read_b128 v[236:239], v12 offset:27648
    s_mov_b32 s32, 4
    s_lshl_b32 s32, s32, 13
    s_add_u32 s32, s32, s29
    s_add_u32 s33, s32, 4096
    v_mfma_f32_16x16x32_bf16 v[24:27], v[64:67], v[188:191], v[24:27]
    ds_read_b128 v[240:243], v12 offset:28672
    v_mfma_f32_16x16x32_bf16 v[48:51], v[68:71], v[192:195], v[48:51]
    ds_read_b128 v[244:247], v12 offset:29696
    v_mfma_f32_16x16x32_bf16 v[28:31], v[68:71], v[188:191], v[28:31]
    ds_read_b128 v[248:251], v12 offset:30720
    v_mfma_f32_16x16x32_bf16 v[52:55], v[72:75], v[192:195], v[52:55]
    ds_read_b128 v[252:255], v20 offset:35840
    v_mfma_f32_16x16x32_bf16 v[32:35], v[72:75], v[188:191], v[32:35]
    buffer_load_dwordx4 v[156:159], v16, s[4:7], s32 offen offset:0 sc1
    v_mfma_f32_16x16x32_bf16 v[56:59], v[76:79], v[192:195], v[56:59]
    v_mfma_f32_16x16x32_bf16 v[36:39], v[76:79], v[188:191], v[36:39]
    buffer_load_dwordx4 v[160:163], v17, s[4:7], s32 offen offset:0 sc1
    v_mfma_f32_16x16x32_bf16 v[60:63], v[80:83], v[192:195], v[60:63]
    v_mfma_f32_16x16x32_bf16 v[40:43], v[80:83], v[188:191], v[40:43]
    s_waitcnt vmcnt(14) lgkmcnt(0)
    s_barrier
    v_mfma_f32_16x16x32_bf16 v[44:47], v[84:87], v[200:203], v[44:47]
    ds_read_b128 v[64:67], v13 offset:0
    v_mfma_f32_16x16x32_bf16 v[24:27], v[84:87], v[196:199], v[24:27]
    ds_read_b128 v[68:71], v13 offset:1024
    v_mfma_f32_16x16x32_bf16 v[48:51], v[88:91], v[200:203], v[48:51]
    ds_read_b128 v[72:75], v13 offset:2048
    v_mfma_f32_16x16x32_bf16 v[28:31], v[88:91], v[196:199], v[28:31]
    ds_read_b128 v[76:79], v13 offset:3072
    v_mfma_f32_16x16x32_bf16 v[52:55], v[92:95], v[200:203], v[52:55]
    ds_read_b128 v[80:83], v21 offset:8192
    v_mfma_f32_16x16x32_bf16 v[32:35], v[92:95], v[196:199], v[32:35]
    buffer_load_dwordx4 v[164:167], v16, s[4:7], s32 offen offset:2048 sc1
    v_mfma_f32_16x16x32_bf16 v[56:59], v[96:99], v[200:203], v[56:59]
    v_mfma_f32_16x16x32_bf16 v[36:39], v[96:99], v[196:199], v[36:39]
    buffer_load_dwordx4 v[168:171], v17, s[4:7], s32 offen offset:2048 sc1
    v_mfma_f32_16x16x32_bf16 v[60:63], v[100:103], v[200:203], v[60:63]
    v_mfma_f32_16x16x32_bf16 v[40:43], v[100:103], v[196:199], v[40:43]
    s_waitcnt vmcnt(14) lgkmcnt(10)
    v_mfma_f32_16x16x32_bf16 v[44:47], v[104:107], v[208:211], v[44:47]
    ds_read_b128 v[84:87], v13 offset:9216
    v_mfma_f32_16x16x32_bf16 v[24:27], v[104:107], v[204:207], v[24:27]
    ds_read_b128 v[88:91], v13 offset:10240
    v_mfma_f32_16x16x32_bf16 v[48:51], v[108:111], v[208:211], v[48:51]
    ds_read_b128 v[92:95], v13 offset:11264
    v_mfma_f32_16x16x32_bf16 v[28:31], v[108:111], v[204:207], v[28:31]
    ds_read_b128 v[96:99], v13 offset:12288
    v_mfma_f32_16x16x32_bf16 v[52:55], v[112:115], v[208:211], v[52:55]
    ds_read_b128 v[100:103], v21 offset:17408
    v_mfma_f32_16x16x32_bf16 v[32:35], v[112:115], v[204:207], v[32:35]
    buffer_load_dwordx4 v[172:175], v16, s[4:7], s33 offen offset:0 sc1
    v_mfma_f32_16x16x32_bf16 v[56:59], v[116:119], v[208:211], v[56:59]
    v_mfma_f32_16x16x32_bf16 v[36:39], v[116:119], v[204:207], v[36:39]
    buffer_load_dwordx4 v[176:179], v17, s[4:7], s33 offen offset:0 sc1
    v_mfma_f32_16x16x32_bf16 v[60:63], v[120:123], v[208:211], v[60:63]
    v_mfma_f32_16x16x32_bf16 v[40:43], v[120:123], v[204:207], v[40:43]
    s_waitcnt vmcnt(14) lgkmcnt(10)
    v_mfma_f32_16x16x32_bf16 v[44:47], v[236:239], v[216:219], v[44:47]
    ds_read_b128 v[104:107], v13 offset:18432
    v_mfma_f32_16x16x32_bf16 v[24:27], v[236:239], v[212:215], v[24:27]
    ds_read_b128 v[108:111], v13 offset:19456
    v_mfma_f32_16x16x32_bf16 v[48:51], v[240:243], v[216:219], v[48:51]
    ds_read_b128 v[112:115], v13 offset:20480
    v_mfma_f32_16x16x32_bf16 v[28:31], v[240:243], v[212:215], v[28:31]
    ds_read_b128 v[116:119], v13 offset:21504
    v_mfma_f32_16x16x32_bf16 v[52:55], v[244:247], v[216:219], v[52:55]
    ds_read_b128 v[120:123], v21 offset:26624
    v_mfma_f32_16x16x32_bf16 v[32:35], v[244:247], v[212:215], v[32:35]
    buffer_load_dwordx4 v[180:183], v16, s[4:7], s33 offen offset:2048 sc1
    v_mfma_f32_16x16x32_bf16 v[56:59], v[248:251], v[216:219], v[56:59]
    v_mfma_f32_16x16x32_bf16 v[36:39], v[248:251], v[212:215], v[36:39]
    buffer_load_dwordx4 v[184:187], v17, s[4:7], s33 offen offset:2048 sc1
    v_mfma_f32_16x16x32_bf16 v[60:63], v[252:255], v[216:219], v[60:63]
    v_mfma_f32_16x16x32_bf16 v[40:43], v[252:255], v[212:215], v[40:43]
    s_waitcnt vmcnt(14) lgkmcnt(10)
    v_mfma_f32_16x16x32_bf16 v[44:47], v[64:67], v[128:131], v[44:47]
    ds_read_b128 v[236:239], v13 offset:27648
    s_mov_b32 s32, 5
    s_lshl_b32 s32, s32, 13
    s_add_u32 s32, s32, s29
    s_add_u32 s33, s32, 4096
    v_mfma_f32_16x16x32_bf16 v[24:27], v[64:67], v[124:127], v[24:27]
    ds_read_b128 v[240:243], v13 offset:28672
    v_mfma_f32_16x16x32_bf16 v[48:51], v[68:71], v[128:131], v[48:51]
    ds_read_b128 v[244:247], v13 offset:29696
    v_mfma_f32_16x16x32_bf16 v[28:31], v[68:71], v[124:127], v[28:31]
    ds_read_b128 v[248:251], v13 offset:30720
    v_mfma_f32_16x16x32_bf16 v[52:55], v[72:75], v[128:131], v[52:55]
    ds_read_b128 v[252:255], v21 offset:35840
    v_mfma_f32_16x16x32_bf16 v[32:35], v[72:75], v[124:127], v[32:35]
    buffer_load_dwordx4 v[188:191], v16, s[4:7], s32 offen offset:0 sc1
    v_mfma_f32_16x16x32_bf16 v[56:59], v[76:79], v[128:131], v[56:59]
    v_mfma_f32_16x16x32_bf16 v[36:39], v[76:79], v[124:127], v[36:39]
    buffer_load_dwordx4 v[192:195], v17, s[4:7], s32 offen offset:0 sc1
    v_mfma_f32_16x16x32_bf16 v[60:63], v[80:83], v[128:131], v[60:63]
    v_mfma_f32_16x16x32_bf16 v[40:43], v[80:83], v[124:127], v[40:43]
    s_waitcnt vmcnt(14) lgkmcnt(0)
    s_barrier
    v_mfma_f32_16x16x32_bf16 v[44:47], v[84:87], v[136:139], v[44:47]
    ds_read_b128 v[64:67], v14 offset:0
    v_mfma_f32_16x16x32_bf16 v[24:27], v[84:87], v[132:135], v[24:27]
    ds_read_b128 v[68:71], v14 offset:1024
    v_mfma_f32_16x16x32_bf16 v[48:51], v[88:91], v[136:139], v[48:51]
    ds_read_b128 v[72:75], v14 offset:2048
    v_mfma_f32_16x16x32_bf16 v[28:31], v[88:91], v[132:135], v[28:31]
    ds_read_b128 v[76:79], v14 offset:3072
    v_mfma_f32_16x16x32_bf16 v[52:55], v[92:95], v[136:139], v[52:55]
    ds_read_b128 v[80:83], v23 offset:36864
    v_mfma_f32_16x16x32_bf16 v[32:35], v[92:95], v[132:135], v[32:35]
    buffer_load_dwordx4 v[196:199], v16, s[4:7], s32 offen offset:2048 sc1
    v_mfma_f32_16x16x32_bf16 v[56:59], v[96:99], v[136:139], v[56:59]
    v_mfma_f32_16x16x32_bf16 v[36:39], v[96:99], v[132:135], v[36:39]
    buffer_load_dwordx4 v[200:203], v17, s[4:7], s32 offen offset:2048 sc1
    v_mfma_f32_16x16x32_bf16 v[60:63], v[100:103], v[136:139], v[60:63]
    v_mfma_f32_16x16x32_bf16 v[40:43], v[100:103], v[132:135], v[40:43]
    s_waitcnt vmcnt(14) lgkmcnt(10)
    v_mfma_f32_16x16x32_bf16 v[44:47], v[104:107], v[144:147], v[44:47]
    ds_read_b128 v[84:87], v14 offset:9216
    v_mfma_f32_16x16x32_bf16 v[24:27], v[104:107], v[140:143], v[24:27]
    ds_read_b128 v[88:91], v14 offset:10240
    v_mfma_f32_16x16x32_bf16 v[48:51], v[108:111], v[144:147], v[48:51]
    ds_read_b128 v[92:95], v14 offset:11264
    v_mfma_f32_16x16x32_bf16 v[28:31], v[108:111], v[140:143], v[28:31]
    ds_read_b128 v[96:99], v14 offset:12288
    v_mfma_f32_16x16x32_bf16 v[52:55], v[112:115], v[144:147], v[52:55]
    ds_read_b128 v[100:103], v23 offset:37888
    v_mfma_f32_16x16x32_bf16 v[32:35], v[112:115], v[140:143], v[32:35]
    buffer_load_dwordx4 v[204:207], v16, s[4:7], s33 offen offset:0 sc1
    v_mfma_f32_16x16x32_bf16 v[56:59], v[116:119], v[144:147], v[56:59]
    v_mfma_f32_16x16x32_bf16 v[36:39], v[116:119], v[140:143], v[36:39]
    buffer_load_dwordx4 v[208:211], v17, s[4:7], s33 offen offset:0 sc1
    v_mfma_f32_16x16x32_bf16 v[60:63], v[120:123], v[144:147], v[60:63]
    v_mfma_f32_16x16x32_bf16 v[40:43], v[120:123], v[140:143], v[40:43]
    s_waitcnt vmcnt(14) lgkmcnt(10)
    v_mfma_f32_16x16x32_bf16 v[44:47], v[236:239], v[152:155], v[44:47]
    ds_read_b128 v[104:107], v14 offset:18432
    v_mfma_f32_16x16x32_bf16 v[24:27], v[236:239], v[148:151], v[24:27]
    ds_read_b128 v[108:111], v14 offset:19456
    v_mfma_f32_16x16x32_bf16 v[48:51], v[240:243], v[152:155], v[48:51]
    ds_read_b128 v[112:115], v14 offset:20480
    v_mfma_f32_16x16x32_bf16 v[28:31], v[240:243], v[148:151], v[28:31]
    ds_read_b128 v[116:119], v14 offset:21504
    v_mfma_f32_16x16x32_bf16 v[52:55], v[244:247], v[152:155], v[52:55]
    ds_read_b128 v[120:123], v23 offset:38912
    v_mfma_f32_16x16x32_bf16 v[32:35], v[244:247], v[148:151], v[32:35]
    buffer_load_dwordx4 v[212:215], v16, s[4:7], s33 offen offset:2048 sc1
    v_mfma_f32_16x16x32_bf16 v[56:59], v[248:251], v[152:155], v[56:59]
    v_mfma_f32_16x16x32_bf16 v[36:39], v[248:251], v[148:151], v[36:39]
    buffer_load_dwordx4 v[216:219], v17, s[4:7], s33 offen offset:2048 sc1
    v_mfma_f32_16x16x32_bf16 v[60:63], v[252:255], v[152:155], v[60:63]
    v_mfma_f32_16x16x32_bf16 v[40:43], v[252:255], v[148:151], v[40:43]
    s_waitcnt vmcnt(14) lgkmcnt(10)
    v_mfma_f32_16x16x32_bf16 v[44:47], v[64:67], v[160:163], v[44:47]
    ds_read_b128 v[236:239], v14 offset:27648
    s_mov_b32 s32, 6
    s_lshl_b32 s32, s32, 13
    s_add_u32 s32, s32, s29
    s_add_u32 s33, s32, 4096
    v_mfma_f32_16x16x32_bf16 v[24:27], v[64:67], v[156:159], v[24:27]
    ds_read_b128 v[240:243], v14 offset:28672
    v_mfma_f32_16x16x32_bf16 v[48:51], v[68:71], v[160:163], v[48:51]
    ds_read_b128 v[244:247], v14 offset:29696
    v_mfma_f32_16x16x32_bf16 v[28:31], v[68:71], v[156:159], v[28:31]
    ds_read_b128 v[248:251], v14 offset:30720
    v_mfma_f32_16x16x32_bf16 v[52:55], v[72:75], v[160:163], v[52:55]
    ds_read_b128 v[252:255], v23 offset:39936
    v_mfma_f32_16x16x32_bf16 v[32:35], v[72:75], v[156:159], v[32:35]
    buffer_load_dwordx4 v[124:127], v16, s[4:7], s32 offen offset:0 sc1
    v_mfma_f32_16x16x32_bf16 v[56:59], v[76:79], v[160:163], v[56:59]
    v_mfma_f32_16x16x32_bf16 v[36:39], v[76:79], v[156:159], v[36:39]
    buffer_load_dwordx4 v[128:131], v17, s[4:7], s32 offen offset:0 sc1
    v_mfma_f32_16x16x32_bf16 v[60:63], v[80:83], v[160:163], v[60:63]
    v_mfma_f32_16x16x32_bf16 v[40:43], v[80:83], v[156:159], v[40:43]
    s_waitcnt vmcnt(14) lgkmcnt(0)
    s_barrier
    v_mfma_f32_16x16x32_bf16 v[44:47], v[84:87], v[168:171], v[44:47]
    ds_read_b128 v[64:67], v15 offset:0
    v_mfma_f32_16x16x32_bf16 v[24:27], v[84:87], v[164:167], v[24:27]
    ds_read_b128 v[68:71], v15 offset:1024
    v_mfma_f32_16x16x32_bf16 v[48:51], v[88:91], v[168:171], v[48:51]
    ds_read_b128 v[72:75], v15 offset:2048
    v_mfma_f32_16x16x32_bf16 v[28:31], v[88:91], v[164:167], v[28:31]
    ds_read_b128 v[76:79], v15 offset:3072
    v_mfma_f32_16x16x32_bf16 v[52:55], v[92:95], v[168:171], v[52:55]
    ds_read_b128 v[80:83], v23 offset:40960
    v_mfma_f32_16x16x32_bf16 v[32:35], v[92:95], v[164:167], v[32:35]
    buffer_load_dwordx4 v[132:135], v16, s[4:7], s32 offen offset:2048 sc1
    v_mfma_f32_16x16x32_bf16 v[56:59], v[96:99], v[168:171], v[56:59]
    v_mfma_f32_16x16x32_bf16 v[36:39], v[96:99], v[164:167], v[36:39]
    buffer_load_dwordx4 v[136:139], v17, s[4:7], s32 offen offset:2048 sc1
    v_mfma_f32_16x16x32_bf16 v[60:63], v[100:103], v[168:171], v[60:63]
    v_mfma_f32_16x16x32_bf16 v[40:43], v[100:103], v[164:167], v[40:43]
    s_waitcnt vmcnt(14) lgkmcnt(10)
    v_mfma_f32_16x16x32_bf16 v[44:47], v[104:107], v[176:179], v[44:47]
    ds_read_b128 v[84:87], v15 offset:9216
    v_mfma_f32_16x16x32_bf16 v[24:27], v[104:107], v[172:175], v[24:27]
    ds_read_b128 v[88:91], v15 offset:10240
    v_mfma_f32_16x16x32_bf16 v[48:51], v[108:111], v[176:179], v[48:51]
    ds_read_b128 v[92:95], v15 offset:11264
    v_mfma_f32_16x16x32_bf16 v[28:31], v[108:111], v[172:175], v[28:31]
    ds_read_b128 v[96:99], v15 offset:12288
    v_mfma_f32_16x16x32_bf16 v[52:55], v[112:115], v[176:179], v[52:55]
    ds_read_b128 v[100:103], v23 offset:41984
    v_mfma_f32_16x16x32_bf16 v[32:35], v[112:115], v[172:175], v[32:35]
    buffer_load_dwordx4 v[140:143], v16, s[4:7], s33 offen offset:0 sc1
    v_mfma_f32_16x16x32_bf16 v[56:59], v[116:119], v[176:179], v[56:59]
    v_mfma_f32_16x16x32_bf16 v[36:39], v[116:119], v[172:175], v[36:39]
    buffer_load_dwordx4 v[144:147], v17, s[4:7], s33 offen offset:0 sc1
    v_mfma_f32_16x16x32_bf16 v[60:63], v[120:123], v[176:179], v[60:63]
    v_mfma_f32_16x16x32_bf16 v[40:43], v[120:123], v[172:175], v[40:43]
    s_waitcnt vmcnt(14) lgkmcnt(10)
    v_mfma_f32_16x16x32_bf16 v[44:47], v[236:239], v[184:187], v[44:47]
    ds_read_b128 v[104:107], v15 offset:18432
    v_mfma_f32_16x16x32_bf16 v[24:27], v[236:239], v[180:183], v[24:27]
    ds_read_b128 v[108:111], v15 offset:19456
    v_mfma_f32_16x16x32_bf16 v[48:51], v[240:243], v[184:187], v[48:51]
    ds_read_b128 v[112:115], v15 offset:20480
    v_mfma_f32_16x16x32_bf16 v[28:31], v[240:243], v[180:183], v[28:31]
    ds_read_b128 v[116:119], v15 offset:21504
    v_mfma_f32_16x16x32_bf16 v[52:55], v[244:247], v[184:187], v[52:55]
    ds_read_b128 v[120:123], v23 offset:43008
    v_mfma_f32_16x16x32_bf16 v[32:35], v[244:247], v[180:183], v[32:35]
    buffer_load_dwordx4 v[148:151], v16, s[4:7], s33 offen offset:2048 sc1
    v_mfma_f32_16x16x32_bf16 v[56:59], v[248:251], v[184:187], v[56:59]
    v_mfma_f32_16x16x32_bf16 v[36:39], v[248:251], v[180:183], v[36:39]
    buffer_load_dwordx4 v[152:155], v17, s[4:7], s33 offen offset:2048 sc1
    v_mfma_f32_16x16x32_bf16 v[60:63], v[252:255], v[184:187], v[60:63]
    v_mfma_f32_16x16x32_bf16 v[40:43], v[252:255], v[180:183], v[40:43]
    s_waitcnt vmcnt(14) lgkmcnt(10)
    v_mfma_f32_16x16x32_bf16 v[44:47], v[64:67], v[192:195], v[44:47]
    ds_read_b128 v[236:239], v15 offset:27648
    s_mov_b32 s32, 7
    s_lshl_b32 s32, s32, 13
    s_add_u32 s32, s32, s29
    s_add_u32 s33, s32, 4096
    v_mfma_f32_16x16x32_bf16 v[24:27], v[64:67], v[188:191], v[24:27]
    ds_read_b128 v[240:243], v15 offset:28672
    v_mfma_f32_16x16x32_bf16 v[48:51], v[68:71], v[192:195], v[48:51]
    ds_read_b128 v[244:247], v15 offset:29696
    v_mfma_f32_16x16x32_bf16 v[28:31], v[68:71], v[188:191], v[28:31]
    ds_read_b128 v[248:251], v15 offset:30720
    v_mfma_f32_16x16x32_bf16 v[52:55], v[72:75], v[192:195], v[52:55]
    ds_read_b128 v[252:255], v23 offset:44032
    v_mfma_f32_16x16x32_bf16 v[32:35], v[72:75], v[188:191], v[32:35]
    buffer_load_dwordx4 v[156:159], v16, s[4:7], s32 offen offset:0 sc1
    v_mfma_f32_16x16x32_bf16 v[56:59], v[76:79], v[192:195], v[56:59]
    v_mfma_f32_16x16x32_bf16 v[36:39], v[76:79], v[188:191], v[36:39]
    buffer_load_dwordx4 v[160:163], v17, s[4:7], s32 offen offset:0 sc1
    v_mfma_f32_16x16x32_bf16 v[60:63], v[80:83], v[192:195], v[60:63]
    v_mfma_f32_16x16x32_bf16 v[40:43], v[80:83], v[188:191], v[40:43]
    s_waitcnt vmcnt(14) lgkmcnt(0)
    s_barrier
    v_mfma_f32_16x16x32_bf16 v[44:47], v[84:87], v[200:203], v[44:47]
    ds_read_b128 v[64:67], v12 offset:0
    v_mfma_f32_16x16x32_bf16 v[24:27], v[84:87], v[196:199], v[24:27]
    ds_read_b128 v[68:71], v12 offset:1024
    v_mfma_f32_16x16x32_bf16 v[48:51], v[88:91], v[200:203], v[48:51]
    ds_read_b128 v[72:75], v12 offset:2048
    v_mfma_f32_16x16x32_bf16 v[28:31], v[88:91], v[196:199], v[28:31]
    ds_read_b128 v[76:79], v12 offset:3072
    v_mfma_f32_16x16x32_bf16 v[52:55], v[92:95], v[200:203], v[52:55]
    ds_read_b128 v[80:83], v23 offset:45056
    v_mfma_f32_16x16x32_bf16 v[32:35], v[92:95], v[196:199], v[32:35]
    buffer_load_dwordx4 v[164:167], v16, s[4:7], s32 offen offset:2048 sc1
    v_mfma_f32_16x16x32_bf16 v[56:59], v[96:99], v[200:203], v[56:59]
    v_mfma_f32_16x16x32_bf16 v[36:39], v[96:99], v[196:199], v[36:39]
    buffer_load_dwordx4 v[168:171], v17, s[4:7], s32 offen offset:2048 sc1
    v_mfma_f32_16x16x32_bf16 v[60:63], v[100:103], v[200:203], v[60:63]
    v_mfma_f32_16x16x32_bf16 v[40:43], v[100:103], v[196:199], v[40:43]
    s_waitcnt vmcnt(14) lgkmcnt(10)
    v_mfma_f32_16x16x32_bf16 v[44:47], v[104:107], v[208:211], v[44:47]
    ds_read_b128 v[84:87], v12 offset:9216
    v_mfma_f32_16x16x32_bf16 v[24:27], v[104:107], v[204:207], v[24:27]
    ds_read_b128 v[88:91], v12 offset:10240
    v_mfma_f32_16x16x32_bf16 v[48:51], v[108:111], v[208:211], v[48:51]
    ds_read_b128 v[92:95], v12 offset:11264
    v_mfma_f32_16x16x32_bf16 v[28:31], v[108:111], v[204:207], v[28:31]
    ds_read_b128 v[96:99], v12 offset:12288
    v_mfma_f32_16x16x32_bf16 v[52:55], v[112:115], v[208:211], v[52:55]
    ds_read_b128 v[100:103], v23 offset:46080
    v_mfma_f32_16x16x32_bf16 v[32:35], v[112:115], v[204:207], v[32:35]
    buffer_load_dwordx4 v[172:175], v16, s[4:7], s33 offen offset:0 sc1
    v_mfma_f32_16x16x32_bf16 v[56:59], v[116:119], v[208:211], v[56:59]
    v_mfma_f32_16x16x32_bf16 v[36:39], v[116:119], v[204:207], v[36:39]
    buffer_load_dwordx4 v[176:179], v17, s[4:7], s33 offen offset:0 sc1
    v_mfma_f32_16x16x32_bf16 v[60:63], v[120:123], v[208:211], v[60:63]
    v_mfma_f32_16x16x32_bf16 v[40:43], v[120:123], v[204:207], v[40:43]
    s_waitcnt vmcnt(14) lgkmcnt(10)
    v_mfma_f32_16x16x32_bf16 v[44:47], v[236:239], v[216:219], v[44:47]
    ds_read_b128 v[104:107], v12 offset:18432
    v_mfma_f32_16x16x32_bf16 v[24:27], v[236:239], v[212:215], v[24:27]
    ds_read_b128 v[108:111], v12 offset:19456
    v_mfma_f32_16x16x32_bf16 v[48:51], v[240:243], v[216:219], v[48:51]
    ds_read_b128 v[112:115], v12 offset:20480
    v_mfma_f32_16x16x32_bf16 v[28:31], v[240:243], v[212:215], v[28:31]
    ds_read_b128 v[116:119], v12 offset:21504
    v_mfma_f32_16x16x32_bf16 v[52:55], v[244:247], v[216:219], v[52:55]
    ds_read_b128 v[120:123], v23 offset:47104
    v_mfma_f32_16x16x32_bf16 v[32:35], v[244:247], v[212:215], v[32:35]
    buffer_load_dwordx4 v[180:183], v16, s[4:7], s33 offen offset:2048 sc1
    v_mfma_f32_16x16x32_bf16 v[56:59], v[248:251], v[216:219], v[56:59]
    v_mfma_f32_16x16x32_bf16 v[36:39], v[248:251], v[212:215], v[36:39]
    buffer_load_dwordx4 v[184:187], v17, s[4:7], s33 offen offset:2048 sc1
    v_mfma_f32_16x16x32_bf16 v[60:63], v[252:255], v[216:219], v[60:63]
    v_mfma_f32_16x16x32_bf16 v[40:43], v[252:255], v[212:215], v[40:43]
    s_waitcnt vmcnt(14) lgkmcnt(10)
    v_mfma_f32_16x16x32_bf16 v[44:47], v[64:67], v[128:131], v[44:47]
    ds_read_b128 v[236:239], v12 offset:27648
    s_mov_b32 s32, 8
    s_lshl_b32 s32, s32, 13
    s_add_u32 s32, s32, s29
    s_add_u32 s33, s32, 4096
    v_mfma_f32_16x16x32_bf16 v[24:27], v[64:67], v[124:127], v[24:27]
    ds_read_b128 v[240:243], v12 offset:28672
    v_mfma_f32_16x16x32_bf16 v[48:51], v[68:71], v[128:131], v[48:51]
    ds_read_b128 v[244:247], v12 offset:29696
    v_mfma_f32_16x16x32_bf16 v[28:31], v[68:71], v[124:127], v[28:31]
    ds_read_b128 v[248:251], v12 offset:30720
    v_mfma_f32_16x16x32_bf16 v[52:55], v[72:75], v[128:131], v[52:55]
    ds_read_b128 v[252:255], v23 offset:48128
    v_mfma_f32_16x16x32_bf16 v[32:35], v[72:75], v[124:127], v[32:35]
    buffer_load_dwordx4 v[188:191], v18, s[4:7], s32 offen offset:0 sc1
    v_mfma_f32_16x16x32_bf16 v[56:59], v[76:79], v[128:131], v[56:59]
    v_mfma_f32_16x16x32_bf16 v[36:39], v[76:79], v[124:127], v[36:39]
    buffer_load_dwordx4 v[192:195], v19, s[4:7], s32 offen offset:0 sc1
    v_mfma_f32_16x16x32_bf16 v[60:63], v[80:83], v[128:131], v[60:63]
    v_mfma_f32_16x16x32_bf16 v[40:43], v[80:83], v[124:127], v[40:43]
    s_waitcnt vmcnt(14) lgkmcnt(0)
    s_barrier
    v_mfma_f32_16x16x32_bf16 v[44:47], v[84:87], v[136:139], v[44:47]
    ds_read_b128 v[64:67], v13 offset:0
    v_mfma_f32_16x16x32_bf16 v[24:27], v[84:87], v[132:135], v[24:27]
    ds_read_b128 v[68:71], v13 offset:1024
    v_mfma_f32_16x16x32_bf16 v[48:51], v[88:91], v[136:139], v[48:51]
    ds_read_b128 v[72:75], v13 offset:2048
    v_mfma_f32_16x16x32_bf16 v[28:31], v[88:91], v[132:135], v[28:31]
    ds_read_b128 v[76:79], v13 offset:3072
    v_mfma_f32_16x16x32_bf16 v[52:55], v[92:95], v[136:139], v[52:55]
    ds_read_b128 v[80:83], v21 offset:8192
    v_mfma_f32_16x16x32_bf16 v[32:35], v[92:95], v[132:135], v[32:35]
    buffer_load_dwordx4 v[196:199], v18, s[4:7], s32 offen offset:2048 sc1
    v_mfma_f32_16x16x32_bf16 v[56:59], v[96:99], v[136:139], v[56:59]
    v_mfma_f32_16x16x32_bf16 v[36:39], v[96:99], v[132:135], v[36:39]
    buffer_load_dwordx4 v[200:203], v19, s[4:7], s32 offen offset:2048 sc1
    v_mfma_f32_16x16x32_bf16 v[60:63], v[100:103], v[136:139], v[60:63]
    v_mfma_f32_16x16x32_bf16 v[40:43], v[100:103], v[132:135], v[40:43]
    s_waitcnt vmcnt(14) lgkmcnt(10)
    v_mfma_f32_16x16x32_bf16 v[44:47], v[104:107], v[144:147], v[44:47]
    ds_read_b128 v[84:87], v13 offset:9216
    v_mfma_f32_16x16x32_bf16 v[24:27], v[104:107], v[140:143], v[24:27]
    ds_read_b128 v[88:91], v13 offset:10240
    v_mfma_f32_16x16x32_bf16 v[48:51], v[108:111], v[144:147], v[48:51]
    ds_read_b128 v[92:95], v13 offset:11264
    v_mfma_f32_16x16x32_bf16 v[28:31], v[108:111], v[140:143], v[28:31]
    ds_read_b128 v[96:99], v13 offset:12288
    v_mfma_f32_16x16x32_bf16 v[52:55], v[112:115], v[144:147], v[52:55]
    ds_read_b128 v[100:103], v21 offset:17408
    v_mfma_f32_16x16x32_bf16 v[32:35], v[112:115], v[140:143], v[32:35]
    buffer_load_dwordx4 v[204:207], v18, s[4:7], s33 offen offset:0 sc1
    v_mfma_f32_16x16x32_bf16 v[56:59], v[116:119], v[144:147], v[56:59]
    v_mfma_f32_16x16x32_bf16 v[36:39], v[116:119], v[140:143], v[36:39]
    buffer_load_dwordx4 v[208:211], v19, s[4:7], s33 offen offset:0 sc1
    v_mfma_f32_16x16x32_bf16 v[60:63], v[120:123], v[144:147], v[60:63]
    v_mfma_f32_16x16x32_bf16 v[40:43], v[120:123], v[140:143], v[40:43]
    s_waitcnt vmcnt(14) lgkmcnt(10)
    v_mfma_f32_16x16x32_bf16 v[44:47], v[236:239], v[152:155], v[44:47]
    ds_read_b128 v[104:107], v13 offset:18432
    v_mfma_f32_16x16x32_bf16 v[24:27], v[236:239], v[148:151], v[24:27]
    ds_read_b128 v[108:111], v13 offset:19456
    v_mfma_f32_16x16x32_bf16 v[48:51], v[240:243], v[152:155], v[48:51]
    ds_read_b128 v[112:115], v13 offset:20480
    v_mfma_f32_16x16x32_bf16 v[28:31], v[240:243], v[148:151], v[28:31]
    ds_read_b128 v[116:119], v13 offset:21504
    v_mfma_f32_16x16x32_bf16 v[52:55], v[244:247], v[152:155], v[52:55]
    ds_read_b128 v[120:123], v21 offset:26624
    v_mfma_f32_16x16x32_bf16 v[32:35], v[244:247], v[148:151], v[32:35]
    buffer_load_dwordx4 v[212:215], v18, s[4:7], s33 offen offset:2048 sc1
    v_mfma_f32_16x16x32_bf16 v[56:59], v[248:251], v[152:155], v[56:59]
    v_mfma_f32_16x16x32_bf16 v[36:39], v[248:251], v[148:151], v[36:39]
    buffer_load_dwordx4 v[216:219], v19, s[4:7], s33 offen offset:2048 sc1
    v_mfma_f32_16x16x32_bf16 v[60:63], v[252:255], v[152:155], v[60:63]
    v_mfma_f32_16x16x32_bf16 v[40:43], v[252:255], v[148:151], v[40:43]
    s_waitcnt vmcnt(14) lgkmcnt(10)
    v_mfma_f32_16x16x32_bf16 v[44:47], v[64:67], v[160:163], v[44:47]
    ds_read_b128 v[236:239], v13 offset:27648
    v_mfma_f32_16x16x32_bf16 v[24:27], v[64:67], v[156:159], v[24:27]
    ds_read_b128 v[240:243], v13 offset:28672
    v_mfma_f32_16x16x32_bf16 v[48:51], v[68:71], v[160:163], v[48:51]
    ds_read_b128 v[244:247], v13 offset:29696
    v_mfma_f32_16x16x32_bf16 v[28:31], v[68:71], v[156:159], v[28:31]
    ds_read_b128 v[248:251], v13 offset:30720
    v_mfma_f32_16x16x32_bf16 v[52:55], v[72:75], v[160:163], v[52:55]
    ds_read_b128 v[252:255], v21 offset:35840
    v_mfma_f32_16x16x32_bf16 v[32:35], v[72:75], v[156:159], v[32:35]
    v_mfma_f32_16x16x32_bf16 v[56:59], v[76:79], v[160:163], v[56:59]
    v_mfma_f32_16x16x32_bf16 v[36:39], v[76:79], v[156:159], v[36:39]
    v_mfma_f32_16x16x32_bf16 v[60:63], v[80:83], v[160:163], v[60:63]
    v_mfma_f32_16x16x32_bf16 v[40:43], v[80:83], v[156:159], v[40:43]
    s_waitcnt vmcnt(12) lgkmcnt(0)
    s_barrier
    v_mfma_f32_16x16x32_bf16 v[44:47], v[84:87], v[168:171], v[44:47]
    ds_read_b128 v[64:67], v14 offset:0
    v_mfma_f32_16x16x32_bf16 v[24:27], v[84:87], v[164:167], v[24:27]
    ds_read_b128 v[68:71], v14 offset:1024
    v_mfma_f32_16x16x32_bf16 v[48:51], v[88:91], v[168:171], v[48:51]
    ds_read_b128 v[72:75], v14 offset:2048
    v_mfma_f32_16x16x32_bf16 v[28:31], v[88:91], v[164:167], v[28:31]
    ds_read_b128 v[76:79], v14 offset:3072
    v_mfma_f32_16x16x32_bf16 v[52:55], v[92:95], v[168:171], v[52:55]
    ds_read_b128 v[80:83], v22 offset:8192
    v_mfma_f32_16x16x32_bf16 v[32:35], v[92:95], v[164:167], v[32:35]
    v_mfma_f32_16x16x32_bf16 v[56:59], v[96:99], v[168:171], v[56:59]
    v_mfma_f32_16x16x32_bf16 v[36:39], v[96:99], v[164:167], v[36:39]
    v_mfma_f32_16x16x32_bf16 v[60:63], v[100:103], v[168:171], v[60:63]
    v_mfma_f32_16x16x32_bf16 v[40:43], v[100:103], v[164:167], v[40:43]
    s_waitcnt vmcnt(10) lgkmcnt(10)
    v_mfma_f32_16x16x32_bf16 v[44:47], v[104:107], v[176:179], v[44:47]
    ds_read_b128 v[84:87], v14 offset:9216
    v_mfma_f32_16x16x32_bf16 v[24:27], v[104:107], v[172:175], v[24:27]
    ds_read_b128 v[88:91], v14 offset:10240
    v_mfma_f32_16x16x32_bf16 v[48:51], v[108:111], v[176:179], v[48:51]
    ds_read_b128 v[92:95], v14 offset:11264
    v_mfma_f32_16x16x32_bf16 v[28:31], v[108:111], v[172:175], v[28:31]
    ds_read_b128 v[96:99], v14 offset:12288
    v_mfma_f32_16x16x32_bf16 v[52:55], v[112:115], v[176:179], v[52:55]
    ds_read_b128 v[100:103], v22 offset:17408
    v_mfma_f32_16x16x32_bf16 v[32:35], v[112:115], v[172:175], v[32:35]
    v_mfma_f32_16x16x32_bf16 v[56:59], v[116:119], v[176:179], v[56:59]
    v_mfma_f32_16x16x32_bf16 v[36:39], v[116:119], v[172:175], v[36:39]
    v_mfma_f32_16x16x32_bf16 v[60:63], v[120:123], v[176:179], v[60:63]
    v_mfma_f32_16x16x32_bf16 v[40:43], v[120:123], v[172:175], v[40:43]
    s_waitcnt vmcnt(8) lgkmcnt(10)
    v_mfma_f32_16x16x32_bf16 v[44:47], v[236:239], v[184:187], v[44:47]
    ds_read_b128 v[104:107], v14 offset:18432
    v_mfma_f32_16x16x32_bf16 v[24:27], v[236:239], v[180:183], v[24:27]
    ds_read_b128 v[108:111], v14 offset:19456
    v_mfma_f32_16x16x32_bf16 v[48:51], v[240:243], v[184:187], v[48:51]
    ds_read_b128 v[112:115], v14 offset:20480
    v_mfma_f32_16x16x32_bf16 v[28:31], v[240:243], v[180:183], v[28:31]
    ds_read_b128 v[116:119], v14 offset:21504
    v_mfma_f32_16x16x32_bf16 v[52:55], v[244:247], v[184:187], v[52:55]
    ds_read_b128 v[120:123], v22 offset:26624
    v_mfma_f32_16x16x32_bf16 v[32:35], v[244:247], v[180:183], v[32:35]
    s_waitcnt vmcnt(6)
    v_mfma_f32_16x16x32_bf16 v[56:59], v[248:251], v[184:187], v[56:59]
    v_swap_b32 v190, v192
    v_mfma_f32_16x16x32_bf16 v[36:39], v[248:251], v[180:183], v[36:39]
    v_swap_b32 v191, v193
    v_mfma_f32_16x16x32_bf16 v[60:63], v[252:255], v[184:187], v[60:63]
    v_mfma_f32_16x16x32_bf16 v[40:43], v[252:255], v[180:183], v[40:43]
    s_waitcnt vmcnt(6) lgkmcnt(10)
    v_mfma_f32_16x16x32_bf16 v[44:47], v[64:67], v[192:195], v[44:47]
    ds_read_b128 v[236:239], v14 offset:27648
    v_mfma_f32_16x16x32_bf16 v[24:27], v[64:67], v[188:191], v[24:27]
    ds_read_b128 v[240:243], v14 offset:28672
    v_mfma_f32_16x16x32_bf16 v[48:51], v[68:71], v[192:195], v[48:51]
    ds_read_b128 v[244:247], v14 offset:29696
    v_mfma_f32_16x16x32_bf16 v[28:31], v[68:71], v[188:191], v[28:31]
    ds_read_b128 v[248:251], v14 offset:30720
    v_mfma_f32_16x16x32_bf16 v[52:55], v[72:75], v[192:195], v[52:55]
    ds_read_b128 v[252:255], v22 offset:35840
    v_mfma_f32_16x16x32_bf16 v[32:35], v[72:75], v[188:191], v[32:35]
    s_waitcnt vmcnt(4)
    v_mfma_f32_16x16x32_bf16 v[56:59], v[76:79], v[192:195], v[56:59]
    v_swap_b32 v198, v200
    v_mfma_f32_16x16x32_bf16 v[36:39], v[76:79], v[188:191], v[36:39]
    v_swap_b32 v199, v201
    v_mfma_f32_16x16x32_bf16 v[60:63], v[80:83], v[192:195], v[60:63]
    v_mfma_f32_16x16x32_bf16 v[40:43], v[80:83], v[188:191], v[40:43]
    s_waitcnt vmcnt(4) lgkmcnt(10)
    v_mfma_f32_16x16x32_bf16 v[44:47], v[84:87], v[200:203], v[44:47]
    v_mfma_f32_16x16x32_bf16 v[24:27], v[84:87], v[196:199], v[24:27]
    v_mfma_f32_16x16x32_bf16 v[48:51], v[88:91], v[200:203], v[48:51]
    v_mfma_f32_16x16x32_bf16 v[28:31], v[88:91], v[196:199], v[28:31]
    v_mfma_f32_16x16x32_bf16 v[52:55], v[92:95], v[200:203], v[52:55]
    v_mfma_f32_16x16x32_bf16 v[32:35], v[92:95], v[196:199], v[32:35]
    s_waitcnt vmcnt(2)
    v_mfma_f32_16x16x32_bf16 v[56:59], v[96:99], v[200:203], v[56:59]
    v_swap_b32 v206, v208
    v_mfma_f32_16x16x32_bf16 v[36:39], v[96:99], v[196:199], v[36:39]
    v_swap_b32 v207, v209
    v_mfma_f32_16x16x32_bf16 v[60:63], v[100:103], v[200:203], v[60:63]
    v_mfma_f32_16x16x32_bf16 v[40:43], v[100:103], v[196:199], v[40:43]
    s_waitcnt vmcnt(2) lgkmcnt(5)
    v_mfma_f32_16x16x32_bf16 v[44:47], v[104:107], v[208:211], v[44:47]
    v_mfma_f32_16x16x32_bf16 v[24:27], v[104:107], v[204:207], v[24:27]
    v_mfma_f32_16x16x32_bf16 v[48:51], v[108:111], v[208:211], v[48:51]
    v_mfma_f32_16x16x32_bf16 v[28:31], v[108:111], v[204:207], v[28:31]
    v_mfma_f32_16x16x32_bf16 v[52:55], v[112:115], v[208:211], v[52:55]
    v_mfma_f32_16x16x32_bf16 v[32:35], v[112:115], v[204:207], v[32:35]
    s_waitcnt vmcnt(0)
    v_mfma_f32_16x16x32_bf16 v[56:59], v[116:119], v[208:211], v[56:59]
    v_swap_b32 v214, v216
    v_mfma_f32_16x16x32_bf16 v[36:39], v[116:119], v[204:207], v[36:39]
    v_swap_b32 v215, v217
    v_mfma_f32_16x16x32_bf16 v[60:63], v[120:123], v[208:211], v[60:63]
    v_mfma_f32_16x16x32_bf16 v[40:43], v[120:123], v[204:207], v[40:43]
    s_waitcnt vmcnt(0) lgkmcnt(0)
    v_mfma_f32_16x16x32_bf16 v[44:47], v[236:239], v[216:219], v[44:47]
    v_mfma_f32_16x16x32_bf16 v[48:51], v[240:243], v[216:219], v[48:51]
    v_mfma_f32_16x16x32_bf16 v[52:55], v[244:247], v[216:219], v[52:55]
    v_mfma_f32_16x16x32_bf16 v[56:59], v[248:251], v[216:219], v[56:59]
    v_mfma_f32_16x16x32_bf16 v[60:63], v[252:255], v[216:219], v[60:63]
    v_mfma_f32_16x16x32_bf16 v[24:27], v[236:239], v[212:215], v[24:27]
    v_mfma_f32_16x16x32_bf16 v[28:31], v[240:243], v[212:215], v[28:31]
    v_mfma_f32_16x16x32_bf16 v[32:35], v[244:247], v[212:215], v[32:35]
    v_mfma_f32_16x16x32_bf16 v[36:39], v[248:251], v[212:215], v[36:39]
    v_mfma_f32_16x16x32_bf16 v[40:43], v[252:255], v[212:215], v[40:43]
    ds_write_b128 v2, v[44:47] offset:0
    ds_write_b128 v2, v[48:51] offset:1024
    ds_write_b128 v2, v[52:55] offset:2048
    ds_write_b128 v2, v[56:59] offset:3072
    s_mov_b64 exec, s[40:41]
    ds_write_b128 v3, v[60:63] offset:4096
    s_mov_b64 exec, -1
    ds_write_b32 v0, v9
    s_mov_b32 s60, 4194304
L_px_p5:
    ds_read_b32 v232, v6
    ds_read_b128 v[64:67], v7 offset:0
    ds_read_b128 v[68:71], v7 offset:1024
    ds_read_b128 v[72:75], v7 offset:2048
    ds_read_b128 v[76:79], v7 offset:3072
    ds_read_b128 v[80:83], v8 offset:4096
    s_waitcnt lgkmcnt(5)
    v_cmp_ne_u32_e64 vcc, s43, v232
    s_sub_u32 s60, s60, 1
    s_cbranch_scc1 L_py_p5
    s_cbranch_vccnz L_px_p5
L_py_p5:
    s_waitcnt lgkmcnt(4)
    v_pk_add_f32 v[24:25], v[24:25], v[64:65]
    v_pk_add_f32 v[26:27], v[26:27], v[66:67]
    v_cvt_pk_bf16_f32 v220, v24, v25
    v_cvt_pk_bf16_f32 v221, v26, v27
    s_waitcnt lgkmcnt(3)
    v_pk_add_f32 v[28:29], v[28:29], v[68:69]
    v_pk_add_f32 v[30:31], v[30:31], v[70:71]
    v_cvt_pk_bf16_f32 v222, v28, v29
    v_cvt_pk_bf16_f32 v223, v30, v31
    s_waitcnt lgkmcnt(2)
    v_pk_add_f32 v[32:33], v[32:33], v[72:73]
    v_pk_add_f32 v[34:35], v[34:35], v[74:75]
    v_cvt_pk_bf16_f32 v224, v32, v33
    v_cvt_pk_bf16_f32 v225, v34, v35
    s_waitcnt lgkmcnt(1)
    v_pk_add_f32 v[36:37], v[36:37], v[76:77]
    v_pk_add_f32 v[38:39], v[38:39], v[78:79]
    v_cvt_pk_bf16_f32 v226, v36, v37
    v_cvt_pk_bf16_f32 v227, v38, v39
    s_waitcnt lgkmcnt(0)
    v_pk_add_f32 v[40:41], v[40:41], v[80:81]
    v_pk_add_f32 v[42:43], v[42:43], v[82:83]
    v_cvt_pk_bf16_f32 v228, v40, v41
    v_cvt_pk_bf16_f32 v229, v42, v43
    s_cmp_eq_u32 s22, 1
    s_cbranch_scc1 L_fin_p5
    buffer_store_dwordx4 v[220:223], v4, s[4:7], s34 offen offset:0 sc1
    buffer_store_dwordx4 v[224:227], v4, s[4:7], s34 offen offset:1024 sc1
    buffer_store_dwordx2 v[228:229], v5, s[4:7], s34 offen sc1
    v_cndmask_b32 v234, 0, v228, s[40:41]
    v_cndmask_b32 v235, 0, v229, s[40:41]
    v_dot2_f32_bf16 v232, v220, v11, 0
    v_dot2_f32_bf16 v233, v220, v220, 0
    v_dot2_f32_bf16 v232, v221, v11, v232
    v_dot2_f32_bf16 v233, v221, v221, v233
    v_dot2_f32_bf16 v232, v222, v11, v232
    v_dot2_f32_bf16 v233, v222, v222, v233
    v_dot2_f32_bf16 v232, v223, v11, v232
    v_dot2_f32_bf16 v233, v223, v223, v233
    v_dot2_f32_bf16 v232, v224, v11, v232
    v_dot2_f32_bf16 v233, v224, v224, v233
    v_dot2_f32_bf16 v232, v225, v11, v232
    v_dot2_f32_bf16 v233, v225, v225, v233
    v_dot2_f32_bf16 v232, v226, v11, v232
    v_dot2_f32_bf16 v233, v226, v226, v233
    v_dot2_f32_bf16 v232, v227, v11, v232
    v_dot2_f32_bf16 v233, v227, v227, v233
    v_dot2_f32_bf16 v232, v234, v11, v232
    v_dot2_f32_bf16 v233, v234, v234, v233
    v_dot2_f32_bf16 v232, v235, v11, v232
    v_dot2_f32_bf16 v233, v235, v235, v233
    s_nop 2
    v_mov_b32 v234, v232
    v_mov_b32 v235, v233
    s_nop 1
    v_permlane32_swap_b32 v232, v234
    v_permlane32_swap_b32 v233, v235
    v_add_f32 v232, v232, v234
    v_add_f32 v233, v233, v235
    v_mov_b32 v234, v232
    v_mov_b32 v235, v233
    s_nop 1
    v_permlane16_swap_b32 v232, v234
    v_permlane16_swap_b32 v233, v235
    v_add_f32 v232, v232, v234
    v_add_f32_e64 v233, v233, v235
    buffer_store_dwordx2 v[232:233], v10, s[4:7], s39 offen sc1
    s_barrier
    s_mov_b32 s22, 1
    s_mov_b32 s21, 0x1c00000
    s_branch L_m_cl
    s_nop 0
L_fin_p5:
    ds_bpermute_b32 v220, v10, v220
    ds_bpermute_b32 v221, v10, v221
    ds_bpermute_b32 v222, v10, v222
    ds_bpermute_b32 v223, v10, v223
    ds_bpermute_b32 v224, v10, v224
    ds_bpermute_b32 v225, v10, v225
    ds_bpermute_b32 v226, v10, v226
    ds_bpermute_b32 v227, v10, v227
    ds_bpermute_b32 v228, v10, v228
    ds_bpermute_b32 v229, v10, v229
    s_waitcnt lgkmcnt(6)
    buffer_store_dwordx4 v[220:223], v4, s[16:19], s34 offen offset:0
    s_waitcnt lgkmcnt(2)
    buffer_store_dwordx4 v[224:227], v4, s[16:19], s34 offen offset:64
    s_waitcnt lgkmcnt(0)
    buffer_store_dwordx2 v[228:229], v5, s[16:19], s34 offen offset:128
    s_endpgm
L_m_l1:
    s_and_b32 s25, s2, 7
    s_lshr_b32 s26, s2, 3
    s_lshr_b32 s23, s25, 1
    s_lshl_b32 s23, s23, 2
    s_lshr_b32 s27, s26, 3
    s_add_u32 s23, s23, s27
    s_and_b32 s24, s25, 1
    s_lshl_b32 s24, s24, 3
    s_and_b32 s27, s26, 7
    s_add_u32 s24, s24, s27
    s_mul_i32 s29, s24, 129024
    s_lshl_b32 s30, s20, 12
    s_add_u32 s29, s29, s30
    s_add_u32 s29, s29, 0x3800000
    s_lshl_b32 s31, s23, 3
    s_max_u32 s31, s31, 1
    s_sub_u32 s31, s31, 1
    s_mul_i32 s31, s31, 18432
    s_add_u32 s31, s31, 0x0
    s_lshl_b32 s35, s20, 10
    s_and_b32 s36, s35, 1024
    s_barrier
    s_add_u32 m0, s35, 131072
    s_add_u32 s34, s31, s35
    s_add_u32 s34, s34, 0
    buffer_load_dwordx4 v1, s[4:7], s34 offen sc1 lds
    s_add_u32 m0, s30, 0
    s_add_u32 s34, s29, 0
    buffer_load_dwordx4 v1, s[4:7], s34 offen offset:0 sc1 lds
    buffer_load_dwordx4 v1, s[4:7], s34 offen offset:1024 sc1 lds
    buffer_load_dwordx4 v1, s[4:7], s34 offen offset:2048 sc1 lds
    buffer_load_dwordx4 v1, s[4:7], s34 offen offset:3072 sc1 lds
    s_add_u32 m0, s30, 16384
    s_add_u32 s34, s29, 16384
    buffer_load_dwordx4 v1, s[4:7], s34 offen offset:0 sc1 lds
    buffer_load_dwordx4 v1, s[4:7], s34 offen offset:1024 sc1 lds
    buffer_load_dwordx4 v1, s[4:7], s34 offen offset:2048 sc1 lds
    buffer_load_dwordx4 v1, s[4:7], s34 offen offset:3072 sc1 lds
    s_waitcnt vmcnt(4) lgkmcnt(0)
    s_barrier
    s_add_u32 m0, s30, 32768
    s_add_u32 s34, s29, 32768
    buffer_load_dwordx4 v1, s[4:7], s34 offen offset:0 sc1 lds
    buffer_load_dwordx4 v1, s[4:7], s34 offen offset:1024 sc1 lds
    buffer_load_dwordx4 v1, s[4:7], s34 offen offset:2048 sc1 lds
    buffer_load_dwordx4 v1, s[4:7], s34 offen offset:3072 sc1 lds
    s_cmp_lt_u32 s2, 144
    s_cbranch_scc1 L_p0_t1
    s_cmp_ge_u32 s2, 216
    s_cbranch_scc1 L_p0_t2
    ds_read_b64_tr_b16 v[16:17], v4 offset:0
    ds_read_b64_tr_b16 v[18:19], v4 offset:2048
    ds_read_b64_tr_b16 v[20:21], v4 offset:18432
    ds_read_b64_tr_b16 v[22:23], v4 offset:20480
    ds_read_b64_tr_b16 v[24:25], v4 offset:4096
    ds_read_b64_tr_b16 v[26:27], v4 offset:6144
    ds_read_b64_tr_b16 v[28:29], v4 offset:22528
    ds_read_b64_tr_b16 v[30:31], v4 offset:24576
    ds_read_b64_tr_b16 v[32:33], v4 offset:8192
    ds_read_b64_tr_b16 v[34:35], v4 offset:10240
    ds_read_b64_tr_b16 v[36:37], v4 offset:26624
    ds_read_b64_tr_b16 v[38:39], v4 offset:28672
    ds_read_b64_tr_b16 v[40:41], v4 offset:12288
    ds_read_b64_tr_b16 v[42:43], v4 offset:14336
    ds_read_b64_tr_b16 v[44:45], v4 offset:30720
    ds_read_b64_tr_b16 v[46:47], v4 offset:32768
    ds_read_b64_tr_b16 v[48:49], v5 offset:16384
    ds_read_b64_tr_b16 v[50:51], v5 offset:34816
    s_branch L_p0_t2
    s_nop 0
L_p0_t1:
    ds_read_b64_tr_b16 v[16:17], v4 offset:0
    ds_read_b64_tr_b16 v[18:19], v4 offset:512
    ds_read_b64_tr_b16 v[20:21], v4 offset:4352
    ds_read_b64_tr_b16 v[22:23], v4 offset:4864
    ds_read_b64_tr_b16 v[24:25], v4 offset:9792
    ds_read_b64_tr_b16 v[26:27], v4 offset:10304
    ds_read_b64_tr_b16 v[28:29], v4 offset:14144
    ds_read_b64_tr_b16 v[30:31], v4 offset:14656
    ds_read_b64_tr_b16 v[32:33], v4 offset:19584
    ds_read_b64_tr_b16 v[34:35], v4 offset:20096
    ds_read_b64_tr_b16 v[36:37], v4 offset:23936
    ds_read_b64_tr_b16 v[38:39], v4 offset:24448
    ds_read_b64_tr_b16 v[40:41], v4 offset:29376
    ds_read_b64_tr_b16 v[42:43], v4 offset:29888
    ds_read_b64_tr_b16 v[44:45], v4 offset:33728
    ds_read_b64_tr_b16 v[46:47], v4 offset:34240
    ds_read_b64_tr_b16 v[48:49], v5 offset:8704
    ds_read_b64_tr_b16 v[50:51], v5 offset:9216
L_p0_t2:
    s_waitcnt lgkmcnt(0)
    s_waitcnt vmcnt(4) lgkmcnt(0)
    s_barrier
    s_add_u32 m0, s35, 135168
    s_add_u32 s34, s31, s35
    s_add_u32 s34, s34, 4096
    buffer_load_dwordx4 v1, s[4:7], s34 offen sc1 lds
    s_add_u32 m0, s30, 49152
    s_add_u32 s34, s29, 49152
    buffer_load_dwordx4 v1, s[4:7], s34 offen offset:0 sc1 lds
    buffer_load_dwordx4 v1, s[4:7], s34 offen offset:1024 sc1 lds
    buffer_load_dwordx4 v1, s[4:7], s34 offen offset:2048 sc1 lds
    buffer_load_dwordx4 v1, s[4:7], s34 offen offset:3072 sc1 lds
    s_waitcnt vmcnt(5) lgkmcnt(0)
    s_barrier
    s_add_u32 m0, s35, 139264
    s_add_u32 s34, s31, s35
    s_add_u32 s34, s34, 8192
    buffer_load_dwordx4 v1, s[4:7], s34 offen sc1 lds
    v_lshrrev_b32 v2, 8, v1
    v_bfe_u32 v3, v1, 7, 1
    v_bfe_u32 v4, v1, 4, 3
    v_cmp_gt_u32_e64 vcc, 3, v2
    v_mul_u32_u24 v3, 80, v3
    v_lshl_add_u32 v3, v4, 3, v3
    v_lshrrev_b32 v5, 1, v4
    v_and_b32 v4, 1, v4
    v_lshl_add_u32 v4, v4, 3, 64
    v_cndmask_b32 v2, v5, v2, vcc
    v_cndmask_b32 v3, v4, v3, vcc
    v_mul_u32_u24 v2, 2304, v2
    v_add_u32 v0, v2, v3
    v_lshrrev_b32 v8, 1, v1
    s_mul_i32 s34, s24, 144
    s_add_u32 s34, s34, 0x4400000
    buffer_load_dwordx2 v[2:3], v0, s[4:7], s34 offen sc1
    s_mul_i32 s34, s24, 144
    s_add_u32 s34, s34, 0x4402000
    buffer_load_dwordx2 v[4:5], v0, s[4:7], s34 offen sc1
    s_mul_i32 s34, s24, 144
    s_add_u32 s34, s34, 0x4404000
    buffer_load_dwordx2 v[6:7], v0, s[4:7], s34 offen sc1
    s_mul_i32 s34, s24, 144
    s_add_u32 s34, s34, 0x4406000
    buffer_load_dwordx2 v[12:13], v0, s[4:7], s34 offen sc1
    s_add_u32 m0, s30, 65536
    s_add_u32 s34, s29, 65536
    buffer_load_dwordx4 v1, s[4:7], s34 offen offset:0 sc1 lds
    buffer_load_dwordx4 v1, s[4:7], s34 offen offset:1024 sc1 lds
    buffer_load_dwordx4 v1, s[4:7], s34 offen offset:2048 sc1 lds
    buffer_load_dwordx4 v1, s[4:7], s34 offen offset:3072 sc1 lds
    s_waitcnt vmcnt(9) lgkmcnt(0)
    s_barrier
    s_add_u32 m0, s30, 81920
    s_add_u32 s34, s29, 81920
    buffer_load_dwordx4 v1, s[4:7], s34 offen offset:0 sc1 lds
    buffer_load_dwordx4 v1, s[4:7], s34 offen offset:1024 sc1 lds
    buffer_load_dwordx4 v1, s[4:7], s34 offen offset:2048 sc1 lds
    buffer_load_dwordx4 v1, s[4:7], s34 offen offset:3072 sc1 lds
    s_waitcnt vmcnt(8)
    v_add_f32 v2, v2, v4
    v_add_f32 v3, v3, v5
    v_add_f32 v6, v6, v12
    v_add_f32 v7, v7, v13
    v_add_f32 v2, v2, v6
    v_add_f32_e64 v3, v3, v7
    v_cmp_gt_u32 vcc, 864, v1
    v_add_u32 v8, 161792, v8
    s_nop 0
    v_cndmask_b32 v2, 0, v2, vcc
    v_cndmask_b32_e64 v3, 0, v3, vcc
    ds_write_b64 v8, v[2:3]
    s_waitcnt vmcnt(4) lgkmcnt(0)
    s_barrier
    s_add_u32 m0, s35, 143360
    s_add_u32 s34, s31, s35
    s_add_u32 s34, s34, 12288
    buffer_load_dwordx4 v1, s[4:7], s34 offen sc1 lds
    s_add_u32 m0, s30, 98304
    s_add_u32 s34, s29, 98304
    buffer_load_dwordx4 v1, s[4:7], s34 offen offset:0 sc1 lds
    buffer_load_dwordx4 v1, s[4:7], s34 offen offset:1024 sc1 lds
    buffer_load_dwordx4 v1, s[4:7], s34 offen offset:2048 sc1 lds
    buffer_load_dwordx4 v1, s[4:7], s34 offen offset:3072 sc1 lds
    s_waitcnt vmcnt(5) lgkmcnt(0)
    s_barrier
    s_add_u32 m0, s36, 147456
    s_add_u32 s34, s31, s36
    s_add_u32 s34, s34, 16384
    buffer_load_dwordx4 v1, s[4:7], s34 offen sc1 lds
    s_add_u32 m0, s30, 114688
    s_add_u32 s34, s29, 114688
    buffer_load_dwordx4 v1, s[4:7], s34 offen offset:0 sc1 lds
    buffer_load_dwordx4 v1, s[4:7], s34 offen offset:1024 sc1 lds
    buffer_load_dwordx4 v1, s[4:7], s34 offen offset:2048 sc1 lds
    buffer_load_dwordx4 v1, s[4:7], s34 offen offset:3072 sc1 lds
    s_waitcnt vmcnt(5) lgkmcnt(0)
    s_barrier
    buffer_store_dwordx4 v[16:19], v9, s[4:7], s37 offen sc1
    buffer_store_dwordx4 v[20:23], v10, s[4:7], s38 offen sc1
    buffer_store_dwordx4 v[24:27], v9, s[4:7], s39 offen sc1
    buffer_store_dwordx4 v[28:31], v10, s[4:7], s40 offen sc1
    buffer_store_dwordx4 v[32:35], v9, s[4:7], s41 offen sc1
    s_waitcnt vmcnt(5) lgkmcnt(0)
    s_barrier
    s_mov_b32 s46, 0x4502000
    v_mov_b32_e64 v4, 0
    s_mov_b32 s60, 262144
L_poll_wo:
    buffer_load_dword v5, v4, s[4:7], s46 offen sc1
    s_waitcnt vmcnt(0)
    v_cmp_gt_u32_e64 vcc, 18, v5
    s_sub_u32 s60, s60, 1
    s_cbranch_scc1 L_pd_wo
    s_cbranch_vccz L_pd_wo
    s_sleep 4
    s_branch L_poll_wo
L_pd_wo:
    buffer_store_dwordx4 v[36:39], v10, s[4:7], s42 offen sc1
    buffer_store_dwordx4 v[40:43], v9, s[4:7], s43 offen sc1
    buffer_store_dwordx4 v[44:47], v10, s[4:7], s47 offen sc1
    buffer_store_dwordx4 v[48:51], v14, s[4:7], s48 offen sc1
    v_dot2_f32_bf16 v12, v16, v11, 0
    v_dot2_f32_bf16 v13, v17, v11, 0
    v_dot2_f32_bf16 v12, v18, v11, v12
    v_dot2_f32_bf16 v13, v19, v11, v13
    v_dot2_f32_bf16 v12, v20, v11, v12
    v_dot2_f32_bf16 v13, v21, v11, v13
    v_dot2_f32_bf16 v12, v22, v11, v12
    v_dot2_f32_bf16 v13, v23, v11, v13
    v_dot2_f32_bf16 v12, v24, v11, v12
    v_dot2_f32_bf16 v13, v25, v11, v13
    v_dot2_f32_bf16 v12, v26, v11, v12
    v_dot2_f32_bf16 v13, v27, v11, v13
    v_dot2_f32_bf16 v12, v28, v11, v12
    v_dot2_f32_bf16 v13, v29, v11, v13
    v_dot2_f32_bf16 v12, v30, v11, v12
    v_dot2_f32_bf16 v13, v31, v11, v13
    v_dot2_f32_bf16 v12, v32, v11, v12
    v_dot2_f32_bf16 v13, v33, v11, v13
    v_dot2_f32_bf16 v12, v34, v11, v12
    v_dot2_f32_bf16 v13, v35, v11, v13
    v_dot2_f32_bf16 v12, v36, v11, v12
    v_dot2_f32_bf16 v13, v37, v11, v13
    v_dot2_f32_bf16 v12, v38, v11, v12
    v_dot2_f32_bf16 v13, v39, v11, v13
    v_dot2_f32_bf16 v12, v40, v11, v12
    v_dot2_f32_bf16 v13, v41, v11, v13
    v_dot2_f32_bf16 v12, v42, v11, v12
    v_dot2_f32_bf16 v13, v43, v11, v13
    v_dot2_f32_bf16 v12, v44, v11, v12
    v_dot2_f32_bf16 v13, v45, v11, v13
    v_dot2_f32_bf16 v12, v46, v11, v12
    v_dot2_f32_bf16 v13, v47, v11, v13
    v_dot2_f32_bf16 v12, v48, v11, v12
    v_dot2_f32_bf16 v13, v49, v11, v13
    v_dot2_f32_bf16 v12, v50, v11, v12
    v_dot2_f32_bf16 v13, v51, v11, v13
    s_nop 2
    v_add_f32 v12, v12, v13
    v_mov_b32 v13, v12
    s_nop 1
    v_permlane32_swap_b32 v12, v13
    v_add_f32 v12, v12, v13
    v_mov_b32 v13, v12
    s_nop 1
    v_permlane16_swap_b32 v12, v13
    v_add_f32 v12, v12, v13
    buffer_store_dword v12, v15, s[4:7], s49 offen sc1
    s_barrier
L_m_ll:
    s_and_b32 s25, s2, 7
    s_lshr_b32 s26, s2, 3
    s_lshr_b32 s23, s25, 1
    s_lshl_b32 s23, s23, 3
    s_lshr_b32 s27, s26, 2
    s_add_u32 s23, s23, s27
    s_and_b32 s24, s25, 1
    s_lshl_b32 s24, s24, 2
    s_and_b32 s27, s26, 3
    s_add_u32 s24, s24, s27
    s_add_u32 s25, s23, s24
    s_and_b32 s25, s25, 3
    s_mul_i32 s29, s24, 82944
    s_add_u32 s29, s29, 0x3a00000
    s_mul_i32 s30, s20, 36864
    s_mul_i32 s31, s20, 18432
    s_add_u32 s31, s31, s29
    s_add_u32 m0, s30, 18432
    s_add_u32 s33, s31, 0
    buffer_load_dwordx4 v1, s[4:7], s33 offen offset:0  sc1 lds
    buffer_load_dwordx4 v1, s[4:7], s33 offen offset:1024  sc1 lds
    buffer_load_dwordx4 v1, s[4:7], s33 offen offset:2048  sc1 lds
    buffer_load_dwordx4 v1, s[4:7], s33 offen offset:3072  sc1 lds
    s_add_u32 m0, s30, 22528
    s_add_u32 s33, s31, 4096
    buffer_load_dwordx4 v1, s[4:7], s33 offen offset:0  sc1 lds
    buffer_load_dwordx4 v1, s[4:7], s33 offen offset:1024  sc1 lds
    buffer_load_dwordx4 v1, s[4:7], s33 offen offset:2048  sc1 lds
    buffer_load_dwordx4 v1, s[4:7], s33 offen offset:3072  sc1 lds
    s_add_u32 m0, s30, 26624
    s_add_u32 s33, s31, 8192
    buffer_load_dwordx4 v1, s[4:7], s33 offen offset:0  sc1 lds
    buffer_load_dwordx4 v1, s[4:7], s33 offen offset:1024  sc1 lds
    buffer_load_dwordx4 v1, s[4:7], s33 offen offset:2048  sc1 lds
    buffer_load_dwordx4 v1, s[4:7], s33 offen offset:3072  sc1 lds
    s_waitcnt vmcnt(12)
    s_barrier
    s_add_u32 m0, s30, 30720
    s_add_u32 s33, s31, 12288
    buffer_load_dwordx4 v1, s[4:7], s33 offen offset:0  sc1 lds
    buffer_load_dwordx4 v1, s[4:7], s33 offen offset:1024  sc1 lds
    buffer_load_dwordx4 v1, s[4:7], s33 offen offset:2048  sc1 lds
    buffer_load_dwordx4 v1, s[4:7], s33 offen offset:3072  sc1 lds
    s_add_u32 m0, s30, 34816
    s_add_u32 s33, s31, 16384
    buffer_load_dwordx4 v1, s[4:7], s33 offen offset:0  sc1 lds
    buffer_load_dwordx4 v1, s[4:7], s33 offen offset:1024  sc1 lds
    s_mul_i32 s30, s20, 3072
    s_add_u32 s31, s30, s29
    s_add_u32 m0, s30, 147456
    s_add_u32 s33, s31, 73728
    buffer_load_dwordx4 v1, s[4:7], s33 offen offset:0  sc1 lds
    buffer_load_dwordx4 v1, s[4:7], s33 offen offset:1024  sc1 lds
    buffer_load_dwordx4 v1, s[4:7], s33 offen offset:2048  sc1 lds
    s_or_b32 s44, s20, s22
    s_cbranch_scc1 L_p2_ns
    s_and_b32 s44, s2, 15
    s_lshl_b32 s44, s44, 8
    s_add_u32 s44, s44, 0x4501000
    s_add_u32 s44, s44, s4
    s_addc_u32 s45, s5, 0
    s_mov_b32 s56, 1
    s_atomic_add s56, s[44:45], 0
L_p2_ns:
    s_waitcnt vmcnt(0)
    s_barrier
    s_and_b32 s25, s2, 7
    s_lshr_b32 s26, s2, 3
    s_and_b32 s23, s25, 1
    s_lshl_b32 s23, s23, 3
    s_and_b32 s27, s26, 7
    s_add_u32 s23, s23, s27
    s_lshr_b32 s24, s25, 1
    s_lshl_b32 s24, s24, 2
    s_lshr_b32 s27, s26, 3
    s_add_u32 s24, s24, s27
    s_add_u32 s28, s23, s24
    s_and_b32 s28, s28, 3
    s_lshl_b32 s30, s20, 12
    s_lshr_b32 s33, s20, 1
    s_mul_i32 s31, s33, 36864
    s_and_b32 s33, s20, 1
    s_lshl_b32 s33, s33, 10
    s_add_u32 s33, s33, 16384
    s_add_u32 s31, s31, s33
    s_sub_u32 s49, s33, s30
    s_mul_i32 s34, s24, 331776
    s_add_u32 s34, s34, s30
    s_add_u32 s34, s34, 0x3b00000
    s_lshl_b32 s35, s23, 3
    s_lshl_b32 s33, s20, 1
    s_add_u32 s35, s35, s33
    s_mul_i32 s35, s35, 18432
    s_add_u32 s35, s35, s21
    s_add_u32 s35, s35, 0x300000
    s_mul_i32 s36, s24, 589824
    s_add_u32 s36, s36, s30
    s_add_u32 s36, s36, s21
    s_add_u32 s36, s36, 0x900000
    v_add_u32 v2, 16384, v1
    s_add_u32 s33, s30, 18432
    v_add_u32_e64 v6, s33, v1
    v_add_u32 v7, 73728, v6
    s_lshl_b32 s29, s23, 2
    s_add_u32 s29, s29, s20
    s_lshl_b32 s29, s29, 12
    s_add_u32 s29, s29, s21
    s_add_u32 s29, s29, 0x1b40000
    v_and_b32 v3, 48, v1
    v_lshrrev_b32 v8, 8, v1
    v_lshl_add_u32 v3, v8, 6, v3
    v_bfe_u32 v8, v1, 6, 2
    v_lshl_add_u32 v3, v8, 8, v3
    s_lshl_b32 s33, s23, 7
    s_lshl_b32 s37, s20, 5
    s_add_u32 s33, s33, s37
    v_lshrrev_b32 v8, 7, v1
    v_add_u32 v8, s33, v8
    v_lshlrev_b32 v8, 12, v8
    v_lshrrev_b32_e64 v9, 8, v1
    v_bfe_u32 v10, v1, 4, 3
    v_xor_b32_e64 v9, v9, v10
    v_lshl_add_u32 v8, v9, 4, v8
    v_xor_b32_e64 v9, 64, v8
    v_add_u32 v9, 31744, v9
    v_add_u32 v10, 63488, v8
    v_add_u32 v11, 63488, v9
    s_cmp_eq_u32 s28, 0
    s_cselect_b32 s44, 4, 0
    s_cmp_eq_u32 s28, 1
    s_cselect_b32 s45, 5, 1
    s_cmp_eq_u32 s28, 2
    s_cselect_b32 s46, 6, 2
    s_cmp_eq_u32 s28, 3
    s_cselect_b32 s47, 7, 3
    s_lshl_b32 s33, s20, 4
    s_add_u32 s33, s33, s24
    s_lshl_b32 s54, s22, 7
    s_add_u32 s54, s54, s33
    s_lshl_b32 s54, s54, 8
    s_add_u32 s54, s54, 0x450c000
    s_add_u32 s54, s54, s4
    s_addc_u32 s55, s5, 0
    s_mov_b32 s33, 0x4501000
    v_and_b32 v4, 0xf0, v1
    v_lshlrev_b32 v4, 4, v4
    s_mov_b32 s60, 262144
L_poll_wr:
    buffer_load_dword v5, v4, s[4:7], s33 offen sc1
    s_waitcnt vmcnt(0)
    v_cmp_gt_u32 vcc, 16, v5
    s_sub_u32 s60, s60, 1
    s_cbranch_scc1 L_pd_wr
    s_cbranch_vccz L_pd_wr
    s_sleep 4
    s_branch L_poll_wr
L_pd_wr:
    s_min_u32 s33, s20, 2
    s_lshl_b32 s33, s33, 9
    v_lshrrev_b32 v4, 1, v1
    v_add_u32 v4, s33, v4
    s_lshl_b32 s51, s24, 12
    s_add_u32 s51, s51, 0x4410000
    buffer_load_dwordx2 v[16:17], v4, s[4:7], s51 offen offset:0 sc1
    buffer_load_dwordx2 v[18:19], v4, s[4:7], s51 offen offset:1152 sc1
    s_mov_b32 s48, 0
    s_mul_i32 s50, s48, 18432
    s_add_u32 s50, s50, s34
    s_add_u32 m0, s30, 0
    s_mov_b32 s53, s50
    buffer_load_dwordx4 v1, s[4:7], s50 offen offset:0  sc1 lds
    buffer_load_dwordx4 v1, s[4:7], s50 offen offset:1024  sc1 lds
    buffer_load_dwordx4 v1, s[4:7], s50 offen offset:2048  sc1 lds
    buffer_load_dwordx4 v1, s[4:7], s50 offen offset:3072  sc1 lds
    s_mov_b32 s48, 1
    s_mul_i32 s50, s48, 18432
    s_add_u32 s50, s50, s34
    s_cmp_ge_u32 s20, 2
    s_cselect_b32 s52, s50, s53
    s_add_u32 m0, s31, 0
    s_add_u32 s52, s52, s49
    buffer_load_dwordx4 v1, s[4:7], s52 offen  sc1 lds
    s_add_u32 m0, s30, 36864
    s_mov_b32 s53, s50
    buffer_load_dwordx4 v1, s[4:7], s50 offen offset:0  sc1 lds
    buffer_load_dwordx4 v1, s[4:7], s50 offen offset:1024  sc1 lds
    buffer_load_dwordx4 v1, s[4:7], s50 offen offset:2048  sc1 lds
    buffer_load_dwordx4 v1, s[4:7], s50 offen offset:3072  sc1 lds
    s_mov_b32 m0, 161280
    v_lshrrev_b32_e64 v5, 2, v1
    s_lshl_b32 s33, s23, 8
    buffer_load_dword v5, s[12:15], s33 offen lds
    s_waitcnt vmcnt(10)
    v_add_u32 v4, 159744, v4
    v_add_f32 v16, v16, v18
    v_add_f32_e64 v17, v17, v19
    ds_write_b64 v4, v[16:17]
    s_waitcnt lgkmcnt(0)
    s_barrier
    s_mov_b32 s48, 2
    s_mul_i32 s50, s48, 18432
    s_add_u32 s50, s50, s34
    s_add_u32 m0, s30, 73728
    s_mov_b32 s53, s50
    buffer_load_dwordx4 v1, s[4:7], s50 offen offset:0  sc1 lds
    buffer_load_dwordx4 v1, s[4:7], s50 offen offset:1024  sc1 lds
    buffer_load_dwordx4 v1, s[4:7], s50 offen offset:2048  sc1 lds
    buffer_load_dwordx4 v1, s[4:7], s50 offen offset:3072  sc1 lds
    s_mov_b32 s48, 3
    s_mul_i32 s50, s48, 18432
    s_add_u32 s50, s50, s34
    s_cmp_ge_u32 s20, 2
    s_cselect_b32 s52, s50, s53
    s_add_u32 m0, s31, 73728
    s_add_u32 s52, s52, s49
    buffer_load_dwordx4 v1, s[4:7], s52 offen  sc1 lds
    s_add_u32 m0, s30, 110592
    s_mov_b32 s53, s50
    buffer_load_dwordx4 v1, s[4:7], s50 offen offset:0  sc1 lds
    buffer_load_dwordx4 v1, s[4:7], s50 offen offset:1024  sc1 lds
    buffer_load_dwordx4 v1, s[4:7], s50 offen offset:2048  sc1 lds
    buffer_load_dwordx4 v1, s[4:7], s50 offen offset:3072  sc1 lds
    s_barrier
    s_add_u32 m0, s30, 18432
    s_add_u32 s51, s35, 0
    buffer_load_dwordx4 v1, s[4:7], s51 offen offset:0 sc1 lds
    buffer_load_dwordx4 v1, s[4:7], s51 offen offset:1024 sc1 lds
    buffer_load_dwordx4 v2, s[4:7], s51 offen offset:2048 sc1 lds
    buffer_load_dwordx4 v2, s[4:7], s51 offen offset:3072 sc1 lds
    s_add_u32 m0, s30, 55296
    s_add_u32 s51, s35, 2048
    buffer_load_dwordx4 v1, s[4:7], s51 offen offset:0 sc1 lds
    buffer_load_dwordx4 v1, s[4:7], s51 offen offset:1024 sc1 lds
    buffer_load_dwordx4 v2, s[4:7], s51 offen offset:2048 sc1 lds
    buffer_load_dwordx4 v2, s[4:7], s51 offen offset:3072 sc1 lds
    s_add_u32 m0, s30, 92160
    s_add_u32 s51, s35, 4096
    buffer_load_dwordx4 v1, s[4:7], s51 offen offset:0 sc1 lds
    buffer_load_dwordx4 v1, s[4:7], s51 offen offset:1024 sc1 lds
    buffer_load_dwordx4 v2, s[4:7], s51 offen offset:2048 sc1 lds
    buffer_load_dwordx4 v2, s[4:7], s51 offen offset:3072 sc1 lds
    s_waitcnt vmcnt(8)
    s_barrier
    s_add_u32 m0, s30, 129024
    s_add_u32 s51, s35, 6144
    buffer_load_dwordx4 v1, s[4:7], s51 offen offset:0 sc1 lds
    buffer_load_dwordx4 v1, s[4:7], s51 offen offset:1024 sc1 lds
    buffer_load_dwordx4 v2, s[4:7], s51 offen offset:2048 sc1 lds
    buffer_load_dwordx4 v2, s[4:7], s51 offen offset:3072 sc1 lds
    s_and_b32 s40, s2, 7
    s_lshr_b32 s26, s2, 3
    s_lshr_b32 s38, s40, 1
    s_lshl_b32 s38, s38, 3
    s_lshr_b32 s27, s26, 2
    s_add_u32 s38, s38, s27
    s_and_b32 s39, s40, 1
    s_lshl_b32 s39, s39, 2
    s_and_b32 s27, s26, 3
    s_add_u32 s39, s39, s27
    s_add_u32 s40, s38, s39
    s_and_b32 s40, s40, 3
    s_mul_i32 s42, s20, 9216
    s_mul_i32 s43, s39, 331776
    s_add_u32 s43, s43, s42
    s_add_u32 s43, s43, 0x4100000
    s_waitcnt vmcnt(8) lgkmcnt(0)
    s_barrier
    s_mov_b32 s48, 4
    s_mul_i32 s50, s48, 18432
    s_add_u32 s50, s50, s34
    s_add_u32 m0, s30, 0
    s_mov_b32 s53, s50
    buffer_load_dwordx4 v1, s[4:7], s50 offen offset:0  sc1 lds
    buffer_load_dwordx4 v1, s[4:7], s50 offen offset:1024  sc1 lds
    buffer_load_dwordx4 v1, s[4:7], s50 offen offset:2048  sc1 lds
    buffer_load_dwordx4 v1, s[4:7], s50 offen offset:3072  sc1 lds
    s_add_u32 m0, s30, 18432
    s_add_u32 s51, s35, 8192
    buffer_load_dwordx4 v1, s[4:7], s51 offen offset:0 sc1 lds
    buffer_load_dwordx4 v1, s[4:7], s51 offen offset:1024 sc1 lds
    buffer_load_dwordx4 v2, s[4:7], s51 offen offset:2048 sc1 lds
    buffer_load_dwordx4 v2, s[4:7], s51 offen offset:3072 sc1 lds
    s_waitcnt vmcnt(12) lgkmcnt(0)
    s_barrier
    s_mov_b32 s48, 5
    s_mul_i32 s50, s48, 18432
    s_add_u32 s50, s50, s34
    s_cmp_ge_u32 s20, 2
    s_cselect_b32 s52, s50, s53
    s_add_u32 m0, s31, 0
    s_add_u32 s52, s52, s49
    buffer_load_dwordx4 v1, s[4:7], s52 offen  sc1 lds
    s_add_u32 m0, s30, 36864
    s_mov_b32 s53, s50
    buffer_load_dwordx4 v1, s[4:7], s50 offen offset:0  sc1 lds
    buffer_load_dwordx4 v1, s[4:7], s50 offen offset:1024  sc1 lds
    buffer_load_dwordx4 v1, s[4:7], s50 offen offset:2048  sc1 lds
    buffer_load_dwordx4 v1, s[4:7], s50 offen offset:3072  sc1 lds
    s_add_u32 m0, s30, 55296
    s_add_u32 s51, s35, 10240
    buffer_load_dwordx4 v1, s[4:7], s51 offen offset:0 sc1 lds
    buffer_load_dwordx4 v1, s[4:7], s51 offen offset:1024 sc1 lds
    buffer_load_dwordx4 v2, s[4:7], s51 offen offset:2048 sc1 lds
    buffer_load_dwordx4 v2, s[4:7], s51 offen offset:3072 sc1 lds
    s_waitcnt vmcnt(17) lgkmcnt(0)
    s_barrier
    s_mov_b32 s48, 6
    s_mul_i32 s50, s48, 18432
    s_add_u32 s50, s50, s34
    s_add_u32 m0, s30, 73728
    s_mov_b32 s53, s50
    buffer_load_dwordx4 v1, s[4:7], s50 offen offset:0  sc1 lds
    buffer_load_dwordx4 v1, s[4:7], s50 offen offset:1024  sc1 lds
    buffer_load_dwordx4 v1, s[4:7], s50 offen offset:2048  sc1 lds
    buffer_load_dwordx4 v1, s[4:7], s50 offen offset:3072  sc1 lds
    s_add_u32 m0, s30, 92160
    s_add_u32 s51, s35, 12288
    buffer_load_dwordx4 v1, s[4:7], s51 offen offset:0 sc1 lds
    buffer_load_dwordx4 v1, s[4:7], s51 offen offset:1024 sc1 lds
    buffer_load_dwordx4 v2, s[4:7], s51 offen offset:2048 sc1 lds
    buffer_load_dwordx4 v2, s[4:7], s51 offen offset:3072 sc1 lds
    s_waitcnt vmcnt(16) lgkmcnt(0)
    s_barrier
    s_mov_b32 s48, 7
    s_mul_i32 s50, s48, 18432
    s_add_u32 s50, s50, s34
    s_cmp_ge_u32 s20, 2
    s_cselect_b32 s52, s50, s53
    s_add_u32 m0, s31, 73728
    s_add_u32 s52, s52, s49
    buffer_load_dwordx4 v1, s[4:7], s52 offen  sc1 lds
    s_add_u32 m0, s30, 110592
    s_mov_b32 s53, s50
    buffer_load_dwordx4 v1, s[4:7], s50 offen offset:0  sc1 lds
    buffer_load_dwordx4 v1, s[4:7], s50 offen offset:1024  sc1 lds
    buffer_load_dwordx4 v1, s[4:7], s50 offen offset:2048  sc1 lds
    buffer_load_dwordx4 v1, s[4:7], s50 offen offset:3072  sc1 lds
    s_add_u32 m0, s30, 129024
    s_add_u32 s51, s35, 14336
    buffer_load_dwordx4 v1, s[4:7], s51 offen offset:0 sc1 lds
    buffer_load_dwordx4 v1, s[4:7], s51 offen offset:1024 sc1 lds
    buffer_load_dwordx4 v2, s[4:7], s51 offen offset:2048 sc1 lds
    buffer_load_dwordx4 v2, s[4:7], s51 offen offset:3072 sc1 lds
    s_waitcnt vmcnt(17) lgkmcnt(0)
    s_barrier
    s_mov_b32 s48, 8
    s_mul_i32 s50, s48, 18432
    s_add_u32 s50, s50, s34
    s_add_u32 m0, s30, 0
    s_mov_b32 s53, s50
    buffer_load_dwordx4 v1, s[4:7], s50 offen offset:0  sc1 lds
    buffer_load_dwordx4 v1, s[4:7], s50 offen offset:1024  sc1 lds
    buffer_load_dwordx4 v1, s[4:7], s50 offen offset:2048  sc1 lds
    buffer_load_dwordx4 v1, s[4:7], s50 offen offset:3072  sc1 lds
    s_add_u32 m0, s30, 18432
    s_add_u32 s51, s35, 16384
    buffer_load_dwordx4 v1, s[4:7], s51 offen offset:0 sc1 lds
    buffer_load_dwordx4 v1, s[4:7], s51 offen offset:1024 sc1 lds
    buffer_load_dwordx4 v2, s[4:7], s51 offen offset:2048 sc1 lds
    buffer_load_dwordx4 v2, s[4:7], s51 offen offset:3072 sc1 lds
    s_waitcnt vmcnt(16) lgkmcnt(0)
    s_barrier
    s_mov_b32 s48, 5
    s_mul_i32 s50, s48, 18432
    s_add_u32 s50, s50, s34
    s_add_u32 s50, s50, 165888
    s_cmp_ge_u32 s20, 2
    s_cselect_b32 s52, s50, s53
    s_add_u32 m0, s31, 0
    s_add_u32 s52, s52, s49
    buffer_load_dwordx4 v1, s[4:7], s52 offen  sc1 lds
    s_add_u32 m0, s30, 36864
    s_mov_b32 s53, s50
    buffer_load_dwordx4 v1, s[4:7], s50 offen offset:0  sc1 lds
    buffer_load_dwordx4 v1, s[4:7], s50 offen offset:1024  sc1 lds
    buffer_load_dwordx4 v1, s[4:7], s50 offen offset:2048  sc1 lds
    buffer_load_dwordx4 v1, s[4:7], s50 offen offset:3072  sc1 lds
    s_cmp_lg_u32 s22, 0
    s_cbranch_scc1 L_p5_k6
    s_add_u32 s32, s43, 294912
    buffer_load_dwordx4 v[220:223], v1, s[4:7], s32 offen offset:0 sc1
    buffer_load_dwordx4 v[224:227], v1, s[4:7], s32 offen offset:1024 sc1
    buffer_load_dwordx4 v[228:231], v1, s[4:7], s32 offen offset:2048 sc1
    buffer_load_dwordx4 v[232:235], v1, s[4:7], s32 offen offset:3072 sc1
    s_add_u32 s32, s43, 299008
    buffer_load_dwordx4 v[236:239], v1, s[4:7], s32 offen offset:0 sc1
L_p5_k6:
    s_waitcnt vmcnt(18) lgkmcnt(0)
    s_cmp_eq_u32 s22, 0
    s_cbranch_scc1 L_wv_926
    s_waitcnt vmcnt(13)
L_wv_926:
    s_barrier
    s_mov_b32 s48, 6
    s_mul_i32 s50, s48, 18432
    s_add_u32 s50, s50, s34
    s_add_u32 s50, s50, 165888
    s_add_u32 m0, s30, 73728
    s_mov_b32 s53, s50
    buffer_load_dwordx4 v1, s[4:7], s50 offen offset:0  sc1 lds
    buffer_load_dwordx4 v1, s[4:7], s50 offen offset:1024  sc1 lds
    buffer_load_dwordx4 v1, s[4:7], s50 offen offset:2048  sc1 lds
    buffer_load_dwordx4 v1, s[4:7], s50 offen offset:3072  sc1 lds
    s_cmp_lg_u32 s22, 0
    s_cbranch_scc1 L_p5_k7
    s_add_u32 s32, s43, 299008
    buffer_load_dwordx4 v[240:243], v1, s[4:7], s32 offen offset:1024 sc1
    buffer_load_dwordx4 v[244:247], v1, s[4:7], s32 offen offset:2048 sc1
    buffer_load_dwordx4 v[248:251], v1, s[4:7], s32 offen offset:3072 sc1
    s_add_u32 s32, s43, 303104
    buffer_load_dwordx4 v[252:255], v1, s[4:7], s32 offen offset:0 sc1
    s_add_u32 s32, s43, 258048
    buffer_load_dwordx4 v[184:187], v1, s[4:7], s32 offen offset:0 sc1
L_p5_k7:
    s_waitcnt vmcnt(18) lgkmcnt(0)
    s_cmp_eq_u32 s22, 0
    s_cbranch_scc1 L_wv_953
    s_waitcnt vmcnt(8)
L_wv_953:
    s_barrier
    s_mov_b32 s48, 7
    s_mul_i32 s50, s48, 18432
    s_add_u32 s50, s50, s34
    s_add_u32 s50, s50, 165888
    s_cmp_ge_u32 s20, 2
    s_cselect_b32 s52, s50, s53
    s_add_u32 m0, s31, 73728
    s_add_u32 s52, s52, s49
    buffer_load_dwordx4 v1, s[4:7], s52 offen  sc1 lds
    s_add_u32 m0, s30, 110592
    s_mov_b32 s53, s50
    buffer_load_dwordx4 v1, s[4:7], s50 offen offset:0  sc1 lds
    buffer_load_dwordx4 v1, s[4:7], s50 offen offset:1024  sc1 lds
    buffer_load_dwordx4 v1, s[4:7], s50 offen offset:2048  sc1 lds
    buffer_load_dwordx4 v1, s[4:7], s50 offen offset:3072  sc1 lds
    s_cmp_lg_u32 s22, 0
    s_cbranch_scc1 L_p5_k8
    s_add_u32 s32, s43, 258048
    buffer_load_dwordx4 v[188:191], v1, s[4:7], s32 offen offset:1024 sc1
    buffer_load_dwordx4 v[192:195], v1, s[4:7], s32 offen offset:2048 sc1
    buffer_load_dwordx4 v[196:199], v1, s[4:7], s32 offen offset:3072 sc1
    s_add_u32 s32, s43, 262144
    buffer_load_dwordx4 v[200:203], v1, s[4:7], s32 offen offset:0 sc1
    buffer_load_dwordx4 v[204:207], v1, s[4:7], s32 offen offset:1024 sc1
L_p5_k8:
    s_waitcnt vmcnt(24) lgkmcnt(0)
    s_cmp_eq_u32 s22, 0
    s_cbranch_scc1 L_wv_984
    s_waitcnt vmcnt(9)
L_wv_984:
    s_barrier
    s_mov_b32 s48, 8
    s_mul_i32 s50, s48, 18432
    s_add_u32 s50, s50, s34
    s_add_u32 s50, s50, 165888
    s_add_u32 m0, s30, 0
    s_mov_b32 s53, s50
    buffer_load_dwordx4 v1, s[4:7], s50 offen offset:0  sc1 lds
    buffer_load_dwordx4 v1, s[4:7], s50 offen offset:1024  sc1 lds
    buffer_load_dwordx4 v1, s[4:7], s50 offen offset:2048  sc1 lds
    buffer_load_dwordx4 v1, s[4:7], s50 offen offset:3072  sc1 lds
    s_cmp_lg_u32 s22, 0
    s_cbranch_scc1 L_p5_k9
    s_add_u32 s32, s43, 262144
    buffer_load_dwordx4 v[208:211], v1, s[4:7], s32 offen offset:2048 sc1
    buffer_load_dwordx4 v[212:215], v1, s[4:7], s32 offen offset:3072 sc1
    s_add_u32 s32, s43, 266240
    buffer_load_dwordx4 v[216:219], v1, s[4:7], s32 offen offset:0 sc1
    s_add_u32 s32, s43, 221184
    buffer_load_dwordx4 v[148:151], v1, s[4:7], s32 offen offset:0 sc1
    buffer_load_dwordx4 v[152:155], v1, s[4:7], s32 offen offset:1024 sc1
    buffer_load_dwordx4 v[156:159], v1, s[4:7], s32 offen offset:2048 sc1
    buffer_load_dwordx4 v[160:163], v1, s[4:7], s32 offen offset:3072 sc1
    s_add_u32 s32, s43, 225280
    buffer_load_dwordx4 v[164:167], v1, s[4:7], s32 offen offset:0 sc1
    buffer_load_dwordx4 v[168:171], v1, s[4:7], s32 offen offset:1024 sc1
    buffer_load_dwordx4 v[172:175], v1, s[4:7], s32 offen offset:2048 sc1
    buffer_load_dwordx4 v[176:179], v1, s[4:7], s32 offen offset:3072 sc1
    s_add_u32 s32, s43, 229376
    buffer_load_dwordx4 v[180:183], v1, s[4:7], s32 offen offset:0 sc1
    s_add_u32 s32, s43, 184320
    buffer_load_dwordx4 v[112:115], v1, s[4:7], s32 offen offset:0 sc1
    buffer_load_dwordx4 v[116:119], v1, s[4:7], s32 offen offset:1024 sc1
    buffer_load_dwordx4 v[120:123], v1, s[4:7], s32 offen offset:2048 sc1
    buffer_load_dwordx4 v[124:127], v1, s[4:7], s32 offen offset:3072 sc1
    s_add_u32 s32, s43, 188416
    buffer_load_dwordx4 v[128:131], v1, s[4:7], s32 offen offset:0 sc1
    buffer_load_dwordx4 v[132:135], v1, s[4:7], s32 offen offset:1024 sc1
    buffer_load_dwordx4 v[136:139], v1, s[4:7], s32 offen offset:2048 sc1
    buffer_load_dwordx4 v[140:143], v1, s[4:7], s32 offen offset:3072 sc1
    s_add_u32 s32, s43, 192512
    buffer_load_dwordx4 v[144:147], v1, s[4:7], s32 offen offset:0 sc1
    s_add_u32 s32, s43, 147456
    buffer_load_dwordx4 v[76:79], v1, s[4:7], s32 offen offset:0 sc1
    buffer_load_dwordx4 v[80:83], v1, s[4:7], s32 offen offset:1024 sc1
    buffer_load_dwordx4 v[84:87], v1, s[4:7], s32 offen offset:2048 sc1
    buffer_load_dwordx4 v[88:91], v1, s[4:7], s32 offen offset:3072 sc1
    s_add_u32 s32, s43, 151552
    buffer_load_dwordx4 v[92:95], v1, s[4:7], s32 offen offset:0 sc1
    buffer_load_dwordx4 v[96:99], v1, s[4:7], s32 offen offset:1024 sc1
    buffer_load_dwordx4 v[100:103], v1, s[4:7], s32 offen offset:2048 sc1
    buffer_load_dwordx4 v[104:107], v1, s[4:7], s32 offen offset:3072 sc1
    s_add_u32 s32, s43, 155648
    buffer_load_dwordx4 v[108:111], v1, s[4:7], s32 offen offset:0 sc1
L_p5_k9:
    s_waitcnt vmcnt(43) lgkmcnt(0)
    s_cmp_eq_u32 s22, 0
    s_cbranch_scc1 L_wv_1044
    s_waitcnt vmcnt(8)
L_wv_1044:
    s_barrier
    s_mov_b32 s48, 0
    s_mul_i32 s50, s48, 18432
    s_add_u32 s50, s50, s34
    s_add_u32 s50, s50, 165888
    s_cmp_ge_u32 s20, 2
    s_cselect_b32 s52, s50, s53
    s_add_u32 m0, s31, 0
    s_add_u32 s52, s52, s49
    buffer_load_dwordx4 v1, s[4:7], s52 offen  sc1 lds
    s_add_u32 m0, s30, 36864
    s_mov_b32 s53, s50
    buffer_load_dwordx4 v1, s[4:7], s50 offen offset:0  sc1 lds
    buffer_load_dwordx4 v1, s[4:7], s50 offen offset:1024  sc1 lds
    buffer_load_dwordx4 v1, s[4:7], s50 offen offset:2048  sc1 lds
    buffer_load_dwordx4 v1, s[4:7], s50 offen offset:3072  sc1 lds
    s_add_u32 m0, s30, 55296
    s_add_u32 s51, s35, 0
    buffer_load_dwordx4 v1, s[4:7], s51 offen offset:0 sc1 lds
    buffer_load_dwordx4 v1, s[4:7], s51 offen offset:1024 sc1 lds
    buffer_load_dwordx4 v2, s[4:7], s51 offen offset:2048 sc1 lds
    buffer_load_dwordx4 v2, s[4:7], s51 offen offset:3072 sc1 lds
    s_waitcnt vmcnt(48) lgkmcnt(0)
    s_cmp_eq_u32 s22, 0
    s_cbranch_scc1 L_wv_1071
    s_waitcnt vmcnt(13)
L_wv_1071:
    s_barrier
    buffer_load_dwordx4 v[16:19], v3, s[4:7], s29 offen offset:0 sc1
    buffer_load_dwordx4 v[20:23], v3, s[4:7], s29 offen offset:1024 sc1
    buffer_load_dwordx4 v[24:27], v3, s[4:7], s29 offen offset:2048 sc1
    buffer_load_dwordx4 v[28:31], v3, s[4:7], s29 offen offset:3072 sc1
    s_mov_b32 s48, 1
    s_mul_i32 s50, s48, 18432
    s_add_u32 s50, s50, s34
    s_add_u32 s50, s50, 165888
    s_add_u32 m0, s30, 73728
    s_mov_b32 s53, s50
    buffer_load_dwordx4 v1, s[4:7], s50 offen offset:0  sc1 lds
    buffer_load_dwordx4 v1, s[4:7], s50 offen offset:1024  sc1 lds
    buffer_load_dwordx4 v1, s[4:7], s50 offen offset:2048  sc1 lds
    buffer_load_dwordx4 v1, s[4:7], s50 offen offset:3072  sc1 lds
    s_add_u32 m0, s30, 92160
    s_add_u32 s51, s35, 2048
    buffer_load_dwordx4 v1, s[4:7], s51 offen offset:0 sc1 lds
    buffer_load_dwordx4 v1, s[4:7], s51 offen offset:1024 sc1 lds
    buffer_load_dwordx4 v2, s[4:7], s51 offen offset:2048 sc1 lds
    buffer_load_dwordx4 v2, s[4:7], s51 offen offset:3072 sc1 lds
    s_waitcnt vmcnt(20) lgkmcnt(0)
    s_barrier
    s_mov_b32 s48, 2
    s_mul_i32 s50, s48, 18432
    s_add_u32 s50, s50, s34
    s_add_u32 s50, s50, 165888
    s_cmp_ge_u32 s20, 2
    s_cselect_b32 s52, s50, s53
    s_add_u32 m0, s31, 73728
    s_add_u32 s52, s52, s49
    buffer_load_dwordx4 v1, s[4:7], s52 offen  sc1 lds
    s_add_u32 m0, s30, 110592
    s_mov_b32 s53, s50
    buffer_load_dwordx4 v1, s[4:7], s50 offen offset:0  sc1 lds
    buffer_load_dwordx4 v1, s[4:7], s50 offen offset:1024  sc1 lds
    buffer_load_dwordx4 v1, s[4:7], s50 offen offset:2048  sc1 lds
    buffer_load_dwordx4 v1, s[4:7], s50 offen offset:3072  sc1 lds
    s_add_u32 m0, s30, 129024
    s_add_u32 s51, s35, 4096
    buffer_load_dwordx4 v1, s[4:7], s51 offen offset:0 sc1 lds
    buffer_load_dwordx4 v1, s[4:7], s51 offen offset:1024 sc1 lds
    buffer_load_dwordx4 v2, s[4:7], s51 offen offset:2048 sc1 lds
    buffer_load_dwordx4 v2, s[4:7], s51 offen offset:3072 sc1 lds
    s_setprio 2
    s_mov_b32 s60, 262144
    s_waitcnt vmcnt(17)
L_g_chk:
    v_or3_b32 v32, v17, v19, v21
    v_or3_b32 v33, v23, v25, v27
    v_or3_b32 v32, v29, v31, v32
    v_or_b32 v32, v32, v33
    v_cmp_gt_i32_e64 vcc, 0, v32
    s_sub_u32 s60, s60, 1
    s_cbranch_scc1 L_g_ok
    s_cbranch_vccz L_g_ok
    buffer_load_dwordx4 v[16:19], v3, s[4:7], s29 offen offset:0 sc1
    buffer_load_dwordx4 v[20:23], v3, s[4:7], s29 offen offset:1024 sc1
    buffer_load_dwordx4 v[24:27], v3, s[4:7], s29 offen offset:2048 sc1
    buffer_load_dwordx4 v[28:31], v3, s[4:7], s29 offen offset:3072 sc1
    s_waitcnt vmcnt(0)
    s_branch L_g_chk
L_g_ok:
    v_add_f32 v16, v16, v20
    v_add_f32 v24, v24, v28
    v_add_f32 v17, v17, v21
    v_add_f32 v25, v25, v29
    v_add_f32 v18, v18, v22
    v_add_f32 v26, v26, v30
    v_add_f32 v19, v19, v23
    v_add_f32 v27, v27, v31
    v_add_f32 v16, v16, v24
    v_add_f32 v17, v17, v25
    v_add_f32 v18, v18, v26
    v_add_f32 v19, v19, v27
    v_add_f32_dpp v16, v16, v16 row_ror:4 row_mask:0xf bank_mask:0xf
    v_add_f32_dpp v17, v17, v17 row_ror:4 row_mask:0xf bank_mask:0xf
    v_add_f32_dpp v18, v18, v18 row_ror:4 row_mask:0xf bank_mask:0xf
    v_add_f32_dpp v19, v19, v19 row_ror:4 row_mask:0xf bank_mask:0xf
    v_add_f32_dpp v16, v16, v16 row_ror:8 row_mask:0xf bank_mask:0xf
    v_add_f32_dpp v17, v17, v17 row_ror:8 row_mask:0xf bank_mask:0xf
    v_add_f32_dpp v18, v18, v18 row_ror:8 row_mask:0xf bank_mask:0xf
    v_add_f32_dpp v19, v19, v19 row_ror:8 row_mask:0xf bank_mask:0xf
    v_mul_f32 v16, 0x39e38e39, v16
    v_mul_f32 v17, 0x39e38e39, v17
    v_mul_f32 v18, 0x39e38e39, v18
    v_mul_f32 v19, 0x39e38e39, v19
    v_fma_f32 v17, -v16, v16, v17
    v_fma_f32 v19, -v18, v18, v19
    v_max_f32 v17, 0, v17
    v_max_f32 v19, 0, v19
    v_add_f32 v17, 0x3727c5ac, v17
    v_add_f32 v19, 0x3727c5ac, v19
    v_rsq_f32 v20, v17
    v_rsq_f32 v21, v19
    v_and_b32 v32, 0xff, v3
    s_lshl_b32 s33, s20, 8
    s_add_u32 s33, s33, 148480
    v_add_u32 v32, s33, v32
    v_mul_f32 v22, v16, v20
    v_mul_f32 v23, v18, v21
    ds_write_b128 v32, v[20:23]
    s_setprio 0
    s_waitcnt vmcnt(17) lgkmcnt(0)
    s_barrier
    s_mov_b32 s48, 3
    s_mul_i32 s50, s48, 18432
    s_add_u32 s50, s50, s34
    s_add_u32 s50, s50, 165888
    s_add_u32 m0, s30, 0
    s_mov_b32 s53, s50
    buffer_load_dwordx4 v1, s[4:7], s50 offen offset:0  sc1 lds
    buffer_load_dwordx4 v1, s[4:7], s50 offen offset:1024  sc1 lds
    buffer_load_dwordx4 v1, s[4:7], s50 offen offset:2048  sc1 lds
    buffer_load_dwordx4 v1, s[4:7], s50 offen offset:3072  sc1 lds
    s_add_u32 m0, s30, 18432
    s_add_u32 s51, s35, 6144
    buffer_load_dwordx4 v1, s[4:7], s51 offen offset:0 sc1 lds
    buffer_load_dwordx4 v1, s[4:7], s51 offen offset:1024 sc1 lds
    buffer_load_dwordx4 v2, s[4:7], s51 offen offset:2048 sc1 lds
    buffer_load_dwordx4 v2, s[4:7], s51 offen offset:3072 sc1 lds
    s_waitcnt vmcnt(16) lgkmcnt(0)
    s_barrier
    s_mov_b32 s48, 4
    s_mul_i32 s50, s48, 18432
    s_add_u32 s50, s50, s34
    s_add_u32 s50, s50, 165888
    s_cmp_ge_u32 s20, 2
    s_cselect_b32 s52, s50, s53
    s_add_u32 m0, s31, 0
    s_add_u32 s52, s52, s49
    buffer_load_dwordx4 v1, s[4:7], s52 offen  sc1 lds
    s_add_u32 m0, s30, 36864
    s_mov_b32 s53, s50
    buffer_load_dwordx4 v1, s[4:7], s50 offen offset:0  sc1 lds
    buffer_load_dwordx4 v1, s[4:7], s50 offen offset:1024  sc1 lds
    buffer_load_dwordx4 v1, s[4:7], s50 offen offset:2048  sc1 lds
    buffer_load_dwordx4 v1, s[4:7], s50 offen offset:3072  sc1 lds
    s_add_u32 m0, s30, 55296
    s_add_u32 s51, s35, 8192
    buffer_load_dwordx4 v1, s[4:7], s51 offen offset:0 sc1 lds
    buffer_load_dwordx4 v1, s[4:7], s51 offen offset:1024 sc1 lds
    buffer_load_dwordx4 v2, s[4:7], s51 offen offset:2048 sc1 lds
    buffer_load_dwordx4 v2, s[4:7], s51 offen offset:3072 sc1 lds
    s_waitcnt vmcnt(17) lgkmcnt(0)
    s_barrier
    s_waitcnt vmcnt(8) lgkmcnt(0)
    s_barrier
    s_waitcnt vmcnt(0) lgkmcnt(0)
    s_barrier
    s_barrier
    s_mov_b32 s56, 1
    s_atomic_add s56, s[54:55], 0
    s_mov_b32 s57, 0
    s_atomic_add s57, s[54:55], 0 glc
    s_lshl_b32 s48, s23, 1
    s_add_u32 s48, s48, 0
    s_add_u32 m0, s30, 92160
    s_lshl_b32 s51, s48, 7
    buffer_load_dwordx4 v8, s[8:11], s51 offen offset:0  lds
    buffer_load_dwordx4 v9, s[8:11], s51 offen offset:1024  lds
    buffer_load_dwordx4 v10, s[8:11], s51 offen offset:2048  lds
    buffer_load_dwordx4 v11, s[8:11], s51 offen offset:3072  lds
    s_lshl_b32 s48, s23, 1
    s_add_u32 s48, s48, 1
    s_add_u32 m0, s30, 129024
    s_lshl_b32 s51, s48, 7
    buffer_load_dwordx4 v8, s[8:11], s51 offen offset:0  lds
    buffer_load_dwordx4 v9, s[8:11], s51 offen offset:1024  lds
    buffer_load_dwordx4 v10, s[8:11], s51 offen offset:2048  lds
    buffer_load_dwordx4 v11, s[8:11], s51 offen offset:3072  lds
    s_lshr_b32 s48, s46, 1
    s_cmp_eq_u32 s48, s23
    s_cselect_b32 s48, 1, 31
    s_and_b32 s48, s48, s46
    s_add_u32 m0, s30, 18432
    s_lshl_b32 s51, s48, 7
    buffer_load_dwordx4 v8, s[8:11], s51 offen offset:0  lds
    buffer_load_dwordx4 v9, s[8:11], s51 offen offset:1024  lds
    buffer_load_dwordx4 v10, s[8:11], s51 offen offset:2048  lds
    buffer_load_dwordx4 v11, s[8:11], s51 offen offset:3072  lds
    s_waitcnt lgkmcnt(0)
    s_cmp_ge_u32 s57, 16
    s_cbranch_scc1 L_g_r0
    s_mov_b32 s57, 0
    s_atomic_add s57, s[54:55], 0 glc
    s_waitcnt vmcnt(8)
    s_barrier
    s_waitcnt lgkmcnt(0)
    s_cmp_ge_u32 s57, 16
    s_cbranch_scc1 L_g_r1
    s_waitcnt vmcnt(4)
    s_barrier
    s_mov_b32 s60, 262144
L_poll_z2:
    s_mov_b32 s57, 0
    s_atomic_add s57, s[54:55], 0 glc
    s_waitcnt lgkmcnt(0)
    s_cmp_ge_u32 s57, 16
    s_cbranch_scc1 L_pd_z2
    s_sub_u32 s60, s60, 1
    s_cbranch_scc1 L_pd_z2
    s_sleep 2
    s_branch L_poll_z2
    s_nop 0
L_pd_z2:
    s_lshr_b32 s48, s46, 1
    s_cmp_eq_u32 s48, s23
    s_cselect_b32 s48, 1, 31
    s_and_b32 s48, s48, s46
    s_mul_i32 s50, s48, 18432
    s_add_u32 s50, s50, s36
    s_add_u32 m0, s30, 0
    s_mov_b32 s53, s50
    buffer_load_dwordx4 v1, s[4:7], s50 offen offset:0 sc1 lds
    buffer_load_dwordx4 v1, s[4:7], s50 offen offset:1024 sc1 lds
    buffer_load_dwordx4 v1, s[4:7], s50 offen offset:2048 sc1 lds
    buffer_load_dwordx4 v1, s[4:7], s50 offen offset:3072 sc1 lds
    s_lshr_b32 s48, s47, 1
    s_cmp_eq_u32 s48, s23
    s_cselect_b32 s48, 1, 31
    s_and_b32 s48, s48, s47
    s_mul_i32 s50, s48, 18432
    s_add_u32 s50, s50, s36
    s_cmp_ge_u32 s20, 2
    s_cselect_b32 s52, s50, s53
    s_add_u32 m0, s31, 0
    s_add_u32 s52, s52, s49
    buffer_load_dwordx4 v1, s[4:7], s52 offen sc1 lds
    s_add_u32 m0, s30, 36864
    s_mov_b32 s53, s50
    buffer_load_dwordx4 v1, s[4:7], s50 offen offset:0 sc1 lds
    buffer_load_dwordx4 v1, s[4:7], s50 offen offset:1024 sc1 lds
    buffer_load_dwordx4 v1, s[4:7], s50 offen offset:2048 sc1 lds
    buffer_load_dwordx4 v1, s[4:7], s50 offen offset:3072 sc1 lds
    s_lshr_b32 s48, s47, 1
    s_cmp_eq_u32 s48, s23
    s_cselect_b32 s48, 1, 31
    s_and_b32 s48, s48, s47
    s_add_u32 m0, s30, 55296
    s_lshl_b32 s51, s48, 7
    buffer_load_dwordx4 v8, s[8:11], s51 offen offset:0  lds
    buffer_load_dwordx4 v9, s[8:11], s51 offen offset:1024  lds
    buffer_load_dwordx4 v10, s[8:11], s51 offen offset:2048  lds
    buffer_load_dwordx4 v11, s[8:11], s51 offen offset:3072  lds
    s_branch L_g_jn
    s_nop 0
L_g_r0:
    s_lshr_b32 s48, s46, 1
    s_cmp_eq_u32 s48, s23
    s_cselect_b32 s48, 1, 31
    s_and_b32 s48, s48, s46
    s_mul_i32 s50, s48, 18432
    s_add_u32 s50, s50, s36
    s_add_u32 m0, s30, 0
    s_mov_b32 s53, s50
    buffer_load_dwordx4 v1, s[4:7], s50 offen offset:0 sc1 lds
    buffer_load_dwordx4 v1, s[4:7], s50 offen offset:1024 sc1 lds
    buffer_load_dwordx4 v1, s[4:7], s50 offen offset:2048 sc1 lds
    buffer_load_dwordx4 v1, s[4:7], s50 offen offset:3072 sc1 lds
    s_lshr_b32 s48, s47, 1
    s_cmp_eq_u32 s48, s23
    s_cselect_b32 s48, 1, 31
    s_and_b32 s48, s48, s47
    s_mul_i32 s50, s48, 18432
    s_add_u32 s50, s50, s36
    s_cmp_ge_u32 s20, 2
    s_cselect_b32 s52, s50, s53
    s_add_u32 m0, s31, 0
    s_add_u32 s52, s52, s49
    buffer_load_dwordx4 v1, s[4:7], s52 offen sc1 lds
    s_add_u32 m0, s30, 36864
    s_mov_b32 s53, s50
    buffer_load_dwordx4 v1, s[4:7], s50 offen offset:0 sc1 lds
    buffer_load_dwordx4 v1, s[4:7], s50 offen offset:1024 sc1 lds
    buffer_load_dwordx4 v1, s[4:7], s50 offen offset:2048 sc1 lds
    buffer_load_dwordx4 v1, s[4:7], s50 offen offset:3072 sc1 lds
    s_lshr_b32 s48, s47, 1
    s_cmp_eq_u32 s48, s23
    s_cselect_b32 s48, 1, 31
    s_and_b32 s48, s48, s47
    s_add_u32 m0, s30, 55296
    s_lshl_b32 s51, s48, 7
    buffer_load_dwordx4 v8, s[8:11], s51 offen offset:0  lds
    buffer_load_dwordx4 v9, s[8:11], s51 offen offset:1024  lds
    buffer_load_dwordx4 v10, s[8:11], s51 offen offset:2048  lds
    buffer_load_dwordx4 v11, s[8:11], s51 offen offset:3072  lds
    s_waitcnt vmcnt(21)
    s_barrier
    s_waitcnt vmcnt(17)
    s_barrier
    s_branch L_g_jn
    s_nop 0
L_g_r1:
    s_lshr_b32 s48, s46, 1
    s_cmp_eq_u32 s48, s23
    s_cselect_b32 s48, 1, 31
    s_and_b32 s48, s48, s46
    s_mul_i32 s50, s48, 18432
    s_add_u32 s50, s50, s36
    s_add_u32 m0, s30, 0
    s_mov_b32 s53, s50
    buffer_load_dwordx4 v1, s[4:7], s50 offen offset:0 sc1 lds
    buffer_load_dwordx4 v1, s[4:7], s50 offen offset:1024 sc1 lds
    buffer_load_dwordx4 v1, s[4:7], s50 offen offset:2048 sc1 lds
    buffer_load_dwordx4 v1, s[4:7], s50 offen offset:3072 sc1 lds
    s_lshr_b32 s48, s47, 1
    s_cmp_eq_u32 s48, s23
    s_cselect_b32 s48, 1, 31
    s_and_b32 s48, s48, s47
    s_mul_i32 s50, s48, 18432
    s_add_u32 s50, s50, s36
    s_cmp_ge_u32 s20, 2
    s_cselect_b32 s52, s50, s53
    s_add_u32 m0, s31, 0
    s_add_u32 s52, s52, s49
    buffer_load_dwordx4 v1, s[4:7], s52 offen sc1 lds
    s_add_u32 m0, s30, 36864
    s_mov_b32 s53, s50
    buffer_load_dwordx4 v1, s[4:7], s50 offen offset:0 sc1 lds
    buffer_load_dwordx4 v1, s[4:7], s50 offen offset:1024 sc1 lds
    buffer_load_dwordx4 v1, s[4:7], s50 offen offset:2048 sc1 lds
    buffer_load_dwordx4 v1, s[4:7], s50 offen offset:3072 sc1 lds
    s_lshr_b32 s48, s47, 1
    s_cmp_eq_u32 s48, s23
    s_cselect_b32 s48, 1, 31
    s_and_b32 s48, s48, s47
    s_add_u32 m0, s30, 55296
    s_lshl_b32 s51, s48, 7
    buffer_load_dwordx4 v8, s[8:11], s51 offen offset:0  lds
    buffer_load_dwordx4 v9, s[8:11], s51 offen offset:1024  lds
    buffer_load_dwordx4 v10, s[8:11], s51 offen offset:2048  lds
    buffer_load_dwordx4 v11, s[8:11], s51 offen offset:3072  lds
    s_waitcnt vmcnt(17)
    s_barrier
L_g_jn:
    s_add_u32 s44, s44, 4
    s_cmp_ge_u32 s44, 32
    s_cselect_b32 s44, 4, s44
    s_add_u32 s45, s45, 4
    s_cmp_ge_u32 s45, 32
    s_cselect_b32 s45, 5, s45
    s_add_u32 s46, s46, 4
    s_and_b32 s46, s46, 31
    s_add_u32 s47, s47, 4
    s_and_b32 s47, s47, 31
    s_lshr_b32 s48, s44, 1
    s_cmp_eq_u32 s48, s23
    s_cselect_b32 s48, 1, 31
    s_and_b32 s48, s48, s44
    s_mul_i32 s50, s48, 18432
    s_add_u32 s50, s50, s36
    s_add_u32 m0, s30, 73728
    s_mov_b32 s53, s50
    buffer_load_dwordx4 v1, s[4:7], s50 offen offset:0 sc1 lds
    buffer_load_dwordx4 v1, s[4:7], s50 offen offset:1024 sc1 lds
    buffer_load_dwordx4 v1, s[4:7], s50 offen offset:2048 sc1 lds
    buffer_load_dwordx4 v1, s[4:7], s50 offen offset:3072 sc1 lds
    s_lshr_b32 s48, s44, 1
    s_cmp_eq_u32 s48, s23
    s_cselect_b32 s48, 1, 31
    s_and_b32 s48, s48, s44
    s_add_u32 m0, s30, 92160
    s_lshl_b32 s51, s48, 7
    buffer_load_dwordx4 v8, s[8:11], s51 offen offset:0  lds
    buffer_load_dwordx4 v9, s[8:11], s51 offen offset:1024  lds
    buffer_load_dwordx4 v10, s[8:11], s51 offen offset:2048  lds
    buffer_load_dwordx4 v11, s[8:11], s51 offen offset:3072  lds
    s_add_u32 s44, s44, 4
    s_cmp_ge_u32 s44, 32
    s_cselect_b32 s44, 4, s44
    s_waitcnt vmcnt(16)
    s_barrier
    s_lshr_b32 s48, s45, 1
    s_cmp_eq_u32 s48, s23
    s_cselect_b32 s48, 1, 31
    s_and_b32 s48, s48, s45
    s_mul_i32 s50, s48, 18432
    s_add_u32 s50, s50, s36
    s_cmp_ge_u32 s20, 2
    s_cselect_b32 s52, s50, s53
    s_add_u32 m0, s31, 73728
    s_add_u32 s52, s52, s49
    buffer_load_dwordx4 v1, s[4:7], s52 offen sc1 lds
    s_add_u32 m0, s30, 110592
    s_mov_b32 s53, s50
    buffer_load_dwordx4 v1, s[4:7], s50 offen offset:0 sc1 lds
    buffer_load_dwordx4 v1, s[4:7], s50 offen offset:1024 sc1 lds
    buffer_load_dwordx4 v1, s[4:7], s50 offen offset:2048 sc1 lds
    buffer_load_dwordx4 v1, s[4:7], s50 offen offset:3072 sc1 lds
    s_lshr_b32 s48, s45, 1
    s_cmp_eq_u32 s48, s23
    s_cselect_b32 s48, 1, 31
    s_and_b32 s48, s48, s45
    s_add_u32 m0, s30, 129024
    s_lshl_b32 s51, s48, 7
    buffer_load_dwordx4 v8, s[8:11], s51 offen offset:0  lds
    buffer_load_dwordx4 v9, s[8:11], s51 offen offset:1024  lds
    buffer_load_dwordx4 v10, s[8:11], s51 offen offset:2048  lds
    buffer_load_dwordx4 v11, s[8:11], s51 offen offset:3072  lds
    s_add_u32 s45, s45, 4
    s_cmp_ge_u32 s45, 32
    s_cselect_b32 s45, 5, s45
    s_waitcnt vmcnt(17)
    s_barrier
    s_lshr_b32 s48, s46, 1
    s_cmp_eq_u32 s48, s23
    s_cselect_b32 s48, 1, 31
    s_and_b32 s48, s48, s46
    s_mul_i32 s50, s48, 18432
    s_add_u32 s50, s50, s36
    s_add_u32 m0, s30, 0
    s_mov_b32 s53, s50
    buffer_load_dwordx4 v1, s[4:7], s50 offen offset:0 sc1 lds
    buffer_load_dwordx4 v1, s[4:7], s50 offen offset:1024 sc1 lds
    buffer_load_dwordx4 v1, s[4:7], s50 offen offset:2048 sc1 lds
    buffer_load_dwordx4 v1, s[4:7], s50 offen offset:3072 sc1 lds
    s_lshr_b32 s48, s46, 1
    s_cmp_eq_u32 s48, s23
    s_cselect_b32 s48, 1, 31
    s_and_b32 s48, s48, s46
    s_add_u32 m0, s30, 18432
    s_lshl_b32 s51, s48, 7
    buffer_load_dwordx4 v8, s[8:11], s51 offen offset:0  lds
    buffer_load_dwordx4 v9, s[8:11], s51 offen offset:1024  lds
    buffer_load_dwordx4 v10, s[8:11], s51 offen offset:2048  lds
    buffer_load_dwordx4 v11, s[8:11], s51 offen offset:3072  lds
    s_add_u32 s46, s46, 4
    s_and_b32 s46, s46, 31
    s_waitcnt vmcnt(16)
    s_barrier
    s_lshr_b32 s48, s47, 1
    s_cmp_eq_u32 s48, s23
    s_cselect_b32 s48, 1, 31
    s_and_b32 s48, s48, s47
    s_mul_i32 s50, s48, 18432
    s_add_u32 s50, s50, s36
    s_cmp_ge_u32 s20, 2
    s_cselect_b32 s52, s50, s53
    s_add_u32 m0, s31, 0
    s_add_u32 s52, s52, s49
    buffer_load_dwordx4 v1, s[4:7], s52 offen sc1 lds
    s_add_u32 m0, s30, 36864
    s_mov_b32 s53, s50
    buffer_load_dwordx4 v1, s[4:7], s50 offen offset:0 sc1 lds
    buffer_load_dwordx4 v1, s[4:7], s50 offen offset:1024 sc1 lds
    buffer_load_dwordx4 v1, s[4:7], s50 offen offset:2048 sc1 lds
    buffer_load_dwordx4 v1, s[4:7], s50 offen offset:3072 sc1 lds
    s_lshr_b32 s48, s47, 1
    s_cmp_eq_u32 s48, s23
    s_cselect_b32 s48, 1, 31
    s_and_b32 s48, s48, s47
    s_add_u32 m0, s30, 55296
    s_lshl_b32 s51, s48, 7
    buffer_load_dwordx4 v8, s[8:11], s51 offen offset:0  lds
    buffer_load_dwordx4 v9, s[8:11], s51 offen offset:1024  lds
    buffer_load_dwordx4 v10, s[8:11], s51 offen offset:2048  lds
    buffer_load_dwordx4 v11, s[8:11], s51 offen offset:3072  lds
    s_add_u32 s47, s47, 4
    s_and_b32 s47, s47, 31
    s_mov_b32 s41, 6
L_g_ll:
    s_waitcnt vmcnt(17)
    s_barrier
    s_lshr_b32 s48, s44, 1
    s_cmp_eq_u32 s48, s23
    s_cselect_b32 s48, 1, 31
    s_and_b32 s48, s48, s44
    s_mul_i32 s50, s48, 18432
    s_add_u32 s50, s50, s36
    s_add_u32 m0, s30, 73728
    s_mov_b32 s53, s50
    buffer_load_dwordx4 v1, s[4:7], s50 offen offset:0 sc1 lds
    buffer_load_dwordx4 v1, s[4:7], s50 offen offset:1024 sc1 lds
    buffer_load_dwordx4 v1, s[4:7], s50 offen offset:2048 sc1 lds
    buffer_load_dwordx4 v1, s[4:7], s50 offen offset:3072 sc1 lds
    s_lshr_b32 s48, s44, 1
    s_cmp_eq_u32 s48, s23
    s_cselect_b32 s48, 1, 31
    s_and_b32 s48, s48, s44
    s_add_u32 m0, s30, 92160
    s_lshl_b32 s51, s48, 7
    buffer_load_dwordx4 v8, s[8:11], s51 offen offset:0  lds
    buffer_load_dwordx4 v9, s[8:11], s51 offen offset:1024  lds
    buffer_load_dwordx4 v10, s[8:11], s51 offen offset:2048  lds
    buffer_load_dwordx4 v11, s[8:11], s51 offen offset:3072  lds
    s_add_u32 s44, s44, 4
    s_cmp_ge_u32 s44, 32
    s_cselect_b32 s44, 4, s44
    s_waitcnt vmcnt(16)
    s_barrier
    s_lshr_b32 s48, s45, 1
    s_cmp_eq_u32 s48, s23
    s_cselect_b32 s48, 1, 31
    s_and_b32 s48, s48, s45
    s_mul_i32 s50, s48, 18432
    s_add_u32 s50, s50, s36
    s_cmp_ge_u32 s20, 2
    s_cselect_b32 s52, s50, s53
    s_add_u32 m0, s31, 73728
    s_add_u32 s52, s52, s49
    buffer_load_dwordx4 v1, s[4:7], s52 offen sc1 lds
    s_add_u32 m0, s30, 110592
    s_mov_b32 s53, s50
    buffer_load_dwordx4 v1, s[4:7], s50 offen offset:0 sc1 lds
    buffer_load_dwordx4 v1, s[4:7], s50 offen offset:1024 sc1 lds
    buffer_load_dwordx4 v1, s[4:7], s50 offen offset:2048 sc1 lds
    buffer_load_dwordx4 v1, s[4:7], s50 offen offset:3072 sc1 lds
    s_lshr_b32 s48, s45, 1
    s_cmp_eq_u32 s48, s23
    s_cselect_b32 s48, 1, 31
    s_and_b32 s48, s48, s45
    s_add_u32 m0, s30, 129024
    s_lshl_b32 s51, s48, 7
    buffer_load_dwordx4 v8, s[8:11], s51 offen offset:0  lds
    buffer_load_dwordx4 v9, s[8:11], s51 offen offset:1024  lds
    buffer_load_dwordx4 v10, s[8:11], s51 offen offset:2048  lds
    buffer_load_dwordx4 v11, s[8:11], s51 offen offset:3072  lds
    s_add_u32 s45, s45, 4
    s_cmp_ge_u32 s45, 32
    s_cselect_b32 s45, 5, s45
    s_waitcnt vmcnt(17)
    s_barrier
    s_lshr_b32 s48, s46, 1
    s_cmp_eq_u32 s48, s23
    s_cselect_b32 s48, 1, 31
    s_and_b32 s48, s48, s46
    s_mul_i32 s50, s48, 18432
    s_add_u32 s50, s50, s36
    s_add_u32 m0, s30, 0
    s_mov_b32 s53, s50
    buffer_load_dwordx4 v1, s[4:7], s50 offen offset:0 sc1 lds
    buffer_load_dwordx4 v1, s[4:7], s50 offen offset:1024 sc1 lds
    buffer_load_dwordx4 v1, s[4:7], s50 offen offset:2048 sc1 lds
    buffer_load_dwordx4 v1, s[4:7], s50 offen offset:3072 sc1 lds
    s_lshr_b32 s48, s46, 1
    s_cmp_eq_u32 s48, s23
    s_cselect_b32 s48, 1, 31
    s_and_b32 s48, s48, s46
    s_add_u32 m0, s30, 18432
    s_lshl_b32 s51, s48, 7
    buffer_load_dwordx4 v8, s[8:11], s51 offen offset:0  lds
    buffer_load_dwordx4 v9, s[8:11], s51 offen offset:1024  lds
    buffer_load_dwordx4 v10, s[8:11], s51 offen offset:2048  lds
    buffer_load_dwordx4 v11, s[8:11], s51 offen offset:3072  lds
    s_add_u32 s46, s46, 4
    s_and_b32 s46, s46, 31
    s_waitcnt vmcnt(16)
    s_barrier
    s_lshr_b32 s48, s47, 1
    s_cmp_eq_u32 s48, s23
    s_cselect_b32 s48, 1, 31
    s_and_b32 s48, s48, s47
    s_mul_i32 s50, s48, 18432
    s_add_u32 s50, s50, s36
    s_cmp_ge_u32 s20, 2
    s_cselect_b32 s52, s50, s53
    s_add_u32 m0, s31, 0
    s_add_u32 s52, s52, s49
    buffer_load_dwordx4 v1, s[4:7], s52 offen sc1 lds
    s_add_u32 m0, s30, 36864
    s_mov_b32 s53, s50
    buffer_load_dwordx4 v1, s[4:7], s50 offen offset:0 sc1 lds
    buffer_load_dwordx4 v1, s[4:7], s50 offen offset:1024 sc1 lds
    buffer_load_dwordx4 v1, s[4:7], s50 offen offset:2048 sc1 lds
    buffer_load_dwordx4 v1, s[4:7], s50 offen offset:3072 sc1 lds
    s_lshr_b32 s48, s47, 1
    s_cmp_eq_u32 s48, s23
    s_cselect_b32 s48, 1, 31
    s_and_b32 s48, s48, s47
    s_add_u32 m0, s30, 55296
    s_lshl_b32 s51, s48, 7
    buffer_load_dwordx4 v8, s[8:11], s51 offen offset:0  lds
    buffer_load_dwordx4 v9, s[8:11], s51 offen offset:1024  lds
    buffer_load_dwordx4 v10, s[8:11], s51 offen offset:2048  lds
    buffer_load_dwordx4 v11, s[8:11], s51 offen offset:3072  lds
    s_add_u32 s47, s47, 4
    s_and_b32 s47, s47, 31
    s_sub_u32 s41, s41, 1
    s_cmp_lg_u32 s41, 0
    s_cbranch_scc1 L_g_ll
    s_waitcnt vmcnt(17)
    s_barrier
    s_mov_b32 s32, 0
    s_mul_i32 s32, s32, 36864
    s_add_u32 s32, s32, s43
    s_add_u32 m0, s42, 73728
    s_add_u32 s33, s32, 0
    buffer_load_dwordx4 v1, s[4:7], s33 offen offset:0  sc1 lds
    buffer_load_dwordx4 v1, s[4:7], s33 offen offset:1024  sc1 lds
    buffer_load_dwordx4 v1, s[4:7], s33 offen offset:2048  sc1 lds
    buffer_load_dwordx4 v1, s[4:7], s33 offen offset:3072  sc1 lds
    s_add_u32 m0, s42, 77824
    s_add_u32 s33, s32, 4096
    buffer_load_dwordx4 v1, s[4:7], s33 offen offset:0  sc1 lds
    buffer_load_dwordx4 v1, s[4:7], s33 offen offset:1024  sc1 lds
    buffer_load_dwordx4 v1, s[4:7], s33 offen offset:2048  sc1 lds
    buffer_load_dwordx4 v1, s[4:7], s33 offen offset:3072  sc1 lds
    s_add_u32 m0, s42, 81920
    s_add_u32 s33, s32, 8192
    buffer_load_dwordx4 v1, s[4:7], s33 offen offset:0  sc1 lds
    s_waitcnt vmcnt(9)
    s_barrier
    s_cmp_lg_u32 s22, 0
    s_cbranch_scc1 L_p5_k48
    s_add_u32 s32, s43, 110592
    buffer_load_dwordx4 v[40:43], v1, s[4:7], s32 offen offset:0 sc1
    buffer_load_dwordx4 v[44:47], v1, s[4:7], s32 offen offset:1024 sc1
    buffer_load_dwordx4 v[48:51], v1, s[4:7], s32 offen offset:2048 sc1
    buffer_load_dwordx4 v[52:55], v1, s[4:7], s32 offen offset:3072 sc1
    s_add_u32 s32, s43, 114688
    buffer_load_dwordx4 v[56:59], v1, s[4:7], s32 offen offset:0 sc1
    buffer_load_dwordx4 v[60:63], v1, s[4:7], s32 offen offset:1024 sc1
    buffer_load_dwordx4 v[64:67], v1, s[4:7], s32 offen offset:2048 sc1
    buffer_load_dwordx4 v[68:71], v1, s[4:7], s32 offen offset:3072 sc1
    s_add_u32 s32, s43, 118784
    buffer_load_dwordx4 v[72:75], v1, s[4:7], s32 offen offset:0 sc1
L_p5_k48:
    s_mov_b32 s32, 1
    s_mul_i32 s32, s32, 36864
    s_add_u32 s32, s32, s43
    s_add_u32 m0, s42, 110592
    s_add_u32 s33, s32, 0
    buffer_load_dwordx4 v1, s[4:7], s33 offen offset:0  sc1 lds
    buffer_load_dwordx4 v1, s[4:7], s33 offen offset:1024  sc1 lds
    buffer_load_dwordx4 v1, s[4:7], s33 offen offset:2048  sc1 lds
    buffer_load_dwordx4 v1, s[4:7], s33 offen offset:3072  sc1 lds
    s_add_u32 m0, s42, 114688
    s_add_u32 s33, s32, 4096
    buffer_load_dwordx4 v1, s[4:7], s33 offen offset:0  sc1 lds
    buffer_load_dwordx4 v1, s[4:7], s33 offen offset:1024  sc1 lds
    buffer_load_dwordx4 v1, s[4:7], s33 offen offset:2048  sc1 lds
    buffer_load_dwordx4 v1, s[4:7], s33 offen offset:3072  sc1 lds
    s_add_u32 m0, s42, 118784
    s_add_u32 s33, s32, 8192
    buffer_load_dwordx4 v1, s[4:7], s33 offen offset:0  sc1 lds
    s_barrier
    v_add_u32 v12, s42, v1
    v_add_u32 v13, 36864, v12
    v_add_u32 v14, 73728, v12
    v_add_u32 v15, 110592, v12
    s_waitcnt vmcnt(9)
    ds_write_b128 v13, v[40:43] offset:0
    ds_write_b128 v13, v[44:47] offset:1024
    ds_write_b128 v13, v[48:51] offset:2048
    ds_write_b128 v13, v[52:55] offset:3072
    ds_write_b128 v13, v[56:59] offset:4096
    ds_write_b128 v13, v[60:63] offset:5120
    ds_write_b128 v13, v[64:67] offset:6144
    ds_write_b128 v13, v[68:71] offset:7168
    ds_write_b128 v13, v[72:75] offset:8192
    s_lshl_b32 s33, s20, 10
    s_add_u32 s33, s33, 147456
    v_add_u32_e64 v4, s33, v1
    ds_write_b128 v4, v[108:111] offset:0
    ds_write_b128 v4, v[144:147] offset:4096
    ds_write_b128 v4, v[180:183] offset:8192
    s_barrier
    s_mov_b32 s32, 2
    s_mul_i32 s32, s32, 36864
    s_add_u32 s32, s32, s43
    s_add_u32 m0, s42, 0
    s_add_u32 s33, s32, 0
    buffer_load_dwordx4 v1, s[4:7], s33 offen offset:0  sc1 lds
    buffer_load_dwordx4 v1, s[4:7], s33 offen offset:1024  sc1 lds
    buffer_load_dwordx4 v1, s[4:7], s33 offen offset:2048  sc1 lds
    buffer_load_dwordx4 v1, s[4:7], s33 offen offset:3072  sc1 lds
    s_add_u32 m0, s42, 4096
    s_add_u32 s33, s32, 4096
    buffer_load_dwordx4 v1, s[4:7], s33 offen offset:0  sc1 lds
    buffer_load_dwordx4 v1, s[4:7], s33 offen offset:1024  sc1 lds
    buffer_load_dwordx4 v1, s[4:7], s33 offen offset:2048  sc1 lds
    buffer_load_dwordx4 v1, s[4:7], s33 offen offset:3072  sc1 lds
    s_add_u32 m0, s42, 8192
    s_add_u32 s33, s32, 8192
    buffer_load_dwordx4 v1, s[4:7], s33 offen offset:0  sc1 lds
    s_waitcnt vmcnt(18) lgkmcnt(0)
    s_barrier
    s_waitcnt vmcnt(9) lgkmcnt(15)
    s_barrier
    ds_write_b128 v14, v[76:79] offset:0
    ds_write_b128 v14, v[80:83] offset:1024
    ds_write_b128 v14, v[84:87] offset:2048
    ds_write_b128 v14, v[88:91] offset:3072
    ds_write_b128 v14, v[92:95] offset:4096
    ds_write_b128 v14, v[96:99] offset:5120
    s_waitcnt vmcnt(0) lgkmcnt(15)
    s_barrier
    ds_write_b128 v14, v[100:103] offset:6144
    ds_write_b128 v14, v[104:107] offset:7168
    ds_write_b128 v15, v[112:115] offset:0
    ds_write_b128 v15, v[116:119] offset:1024
    ds_write_b128 v15, v[120:123] offset:2048
    ds_write_b128 v15, v[124:127] offset:3072
    s_waitcnt vmcnt(63) lgkmcnt(15)
    s_barrier
    ds_write_b128 v15, v[128:131] offset:4096
    ds_write_b128 v15, v[132:135] offset:5120
    ds_write_b128 v15, v[136:139] offset:6144
    ds_write_b128 v15, v[140:143] offset:7168
    ds_write_b128 v12, v[148:151] offset:0
    ds_write_b128 v12, v[152:155] offset:1024
    s_waitcnt vmcnt(63) lgkmcnt(10)
    s_barrier
    ds_write_b128 v12, v[156:159] offset:2048
    ds_write_b128 v12, v[160:163] offset:3072
    ds_write_b128 v12, v[164:167] offset:4096
    ds_write_b128 v12, v[168:171] offset:5120
    ds_write_b128 v12, v[172:175] offset:6144
    ds_write_b128 v12, v[176:179] offset:7168
    s_waitcnt vmcnt(63) lgkmcnt(8)
    s_barrier
    ds_write_b128 v13, v[184:187] offset:0
    ds_write_b128 v13, v[188:191] offset:1024
    ds_write_b128 v13, v[192:195] offset:2048
    ds_write_b128 v13, v[196:199] offset:3072
    ds_write_b128 v13, v[200:203] offset:4096
    ds_write_b128 v13, v[204:207] offset:5120
    s_waitcnt vmcnt(63) lgkmcnt(6)
    s_barrier
    s_and_b32 s25, s2, 7
    s_lshr_b32 s26, s2, 3
    s_lshr_b32 s23, s25, 1
    s_lshl_b32 s23, s23, 2
    s_lshr_b32 s27, s26, 3
    s_add_u32 s23, s23, s27
    s_and_b32 s24, s25, 1
    s_lshl_b32 s24, s24, 3
    s_and_b32 s27, s26, 7
    s_add_u32 s24, s24, s27
    s_mul_i32 s29, s24, 129024
    s_lshl_b32 s30, s20, 12
    s_add_u32 s29, s29, s30
    s_add_u32 s29, s29, 0x3800000
    s_lshl_b32 s31, s23, 3
    s_max_u32 s31, s31, 1
    s_sub_u32 s31, s31, 1
    s_mul_i32 s31, s31, 18432
    s_add_u32 s31, s31, 0x1c00000
    s_lshl_b32 s35, s20, 10
    s_and_b32 s36, s35, 1024
    ds_write_b128 v13, v[208:211] offset:6144
    ds_write_b128 v13, v[212:215] offset:7168
    ds_write_b128 v13, v[216:219] offset:8192
    ds_write_b128 v14, v[220:223] offset:0
    ds_write_b128 v14, v[224:227] offset:1024
    ds_write_b128 v14, v[228:231] offset:2048
    s_waitcnt vmcnt(63) lgkmcnt(3)
    s_barrier
    ds_write_b128 v14, v[232:235] offset:3072
    ds_write_b128 v14, v[236:239] offset:4096
    ds_write_b128 v14, v[240:243] offset:5120
    ds_write_b128 v14, v[244:247] offset:6144
    ds_write_b128 v14, v[248:251] offset:7168
    ds_write_b128 v14, v[252:255] offset:8192
    s_waitcnt vmcnt(63) lgkmcnt(0)
    s_barrier
    s_cmp_eq_u32 s22, 1
    s_cbranch_scc1 L_m_t8
    s_add_u32 m0, s30, 0
    s_add_u32 s34, s29, 0
    buffer_load_dwordx4 v1, s[4:7], s34 offen offset:0 sc1 lds
    buffer_load_dwordx4 v1, s[4:7], s34 offen offset:1024 sc1 lds
    buffer_load_dwordx4 v1, s[4:7], s34 offen offset:2048 sc1 lds
    buffer_load_dwordx4 v1, s[4:7], s34 offen offset:3072 sc1 lds
    s_add_u32 m0, s30, 16384
    s_add_u32 s34, s29, 16384
    buffer_load_dwordx4 v1, s[4:7], s34 offen offset:0 sc1 lds
    buffer_load_dwordx4 v1, s[4:7], s34 offen offset:1024 sc1 lds
    buffer_load_dwordx4 v1, s[4:7], s34 offen offset:2048 sc1 lds
    buffer_load_dwordx4 v1, s[4:7], s34 offen offset:3072 sc1 lds
L_m_t8:
    s_cmp_eq_u32 s22, 1
    s_cbranch_scc1 L_m_lfin
    s_barrier
    s_add_u32 m0, s30, 32768
    s_add_u32 s34, s29, 32768
    buffer_load_dwordx4 v1, s[4:7], s34 offen offset:0 sc1 lds
    buffer_load_dwordx4 v1, s[4:7], s34 offen offset:1024 sc1 lds
    buffer_load_dwordx4 v1, s[4:7], s34 offen offset:2048 sc1 lds
    buffer_load_dwordx4 v1, s[4:7], s34 offen offset:3072 sc1 lds
    s_add_u32 m0, s30, 114688
    s_add_u32 s34, s29, 114688
    buffer_load_dwordx4 v1, s[4:7], s34 offen offset:0 sc1 lds
    buffer_load_dwordx4 v1, s[4:7], s34 offen offset:1024 sc1 lds
    buffer_load_dwordx4 v1, s[4:7], s34 offen offset:2048 sc1 lds
    buffer_load_dwordx4 v1, s[4:7], s34 offen offset:3072 sc1 lds
    s_mov_b32 s22, 1
    s_mov_b32 s21, 0x1c00000
    s_barrier
    s_barrier
    s_add_u32 m0, s30, 49152
    s_add_u32 s34, s29, 49152
    buffer_load_dwordx4 v1, s[4:7], s34 offen offset:0 sc1 lds
    buffer_load_dwordx4 v1, s[4:7], s34 offen offset:1024 sc1 lds
    buffer_load_dwordx4 v1, s[4:7], s34 offen offset:2048 sc1 lds
    buffer_load_dwordx4 v1, s[4:7], s34 offen offset:3072 sc1 lds
    v_lshrrev_b32 v2, 8, v1
    v_bfe_u32 v3, v1, 7, 1
    v_bfe_u32 v4, v1, 4, 3
    v_cmp_gt_u32_e64 vcc, 3, v2
    v_mul_u32_u24 v3, 80, v3
    v_lshl_add_u32 v3, v4, 3, v3
    v_lshrrev_b32 v5, 1, v4
    v_and_b32 v4, 1, v4
    v_lshl_add_u32 v4, v4, 3, 64
    v_cndmask_b32 v2, v5, v2, vcc
    v_cndmask_b32 v3, v4, v3, vcc
    v_mul_u32_u24 v2, 2304, v2
    v_add_u32 v0, v2, v3
    v_lshrrev_b32 v8, 1, v1
    s_mul_i32 s34, s24, 144
    s_add_u32 s34, s34, 0x4400000
    buffer_load_dwordx2 v[2:3], v0, s[4:7], s34 offen sc1
    s_mul_i32 s34, s24, 144
    s_add_u32 s34, s34, 0x4402000
    buffer_load_dwordx2 v[4:5], v0, s[4:7], s34 offen sc1
    s_mul_i32 s34, s24, 144
    s_add_u32 s34, s34, 0x4404000
    buffer_load_dwordx2 v[6:7], v0, s[4:7], s34 offen sc1
    s_mul_i32 s34, s24, 144
    s_add_u32 s34, s34, 0x4406000
    buffer_load_dwordx2 v[12:13], v0, s[4:7], s34 offen sc1
    s_add_u32 m0, s30, 65536
    s_add_u32 s34, s29, 65536
    buffer_load_dwordx4 v1, s[4:7], s34 offen offset:0 sc1 lds
    buffer_load_dwordx4 v1, s[4:7], s34 offen offset:1024 sc1 lds
    buffer_load_dwordx4 v1, s[4:7], s34 offen offset:2048 sc1 lds
    buffer_load_dwordx4 v1, s[4:7], s34 offen offset:3072 sc1 lds
    s_add_u32 m0, s30, 81920
    s_add_u32 s34, s29, 81920
    buffer_load_dwordx4 v1, s[4:7], s34 offen offset:0 sc1 lds
    buffer_load_dwordx4 v1, s[4:7], s34 offen offset:1024 sc1 lds
    buffer_load_dwordx4 v1, s[4:7], s34 offen offset:2048 sc1 lds
    buffer_load_dwordx4 v1, s[4:7], s34 offen offset:3072 sc1 lds
    s_barrier
    s_add_u32 m0, s35, 131072
    s_add_u32 s34, s31, s35
    s_add_u32 s34, s34, 0
    buffer_load_dwordx4 v1, s[4:7], s34 offen sc1 lds
    s_waitcnt vmcnt(29) lgkmcnt(0)
    s_barrier
    s_add_u32 m0, s35, 135168
    s_add_u32 s34, s31, s35
    s_add_u32 s34, s34, 4096
    buffer_load_dwordx4 v1, s[4:7], s34 offen sc1 lds
    s_waitcnt vmcnt(1) lgkmcnt(0)
    s_barrier
    s_add_u32 m0, s35, 139264
    s_add_u32 s34, s31, s35
    s_add_u32 s34, s34, 8192
    buffer_load_dwordx4 v1, s[4:7], s34 offen sc1 lds
    s_waitcnt vmcnt(2) lgkmcnt(0)
    s_barrier
    s_add_u32 m0, s35, 143360
    s_add_u32 s34, s31, s35
    s_add_u32 s34, s34, 12288
    buffer_load_dwordx4 v1, s[4:7], s34 offen sc1 lds
    s_add_u32 m0, s30, 98304
    s_add_u32 s34, s29, 98304
    buffer_load_dwordx4 v1, s[4:7], s34 offen offset:0 sc1 lds
    buffer_load_dwordx4 v1, s[4:7], s34 offen offset:1024 sc1 lds
    buffer_load_dwordx4 v1, s[4:7], s34 offen offset:2048 sc1 lds
    buffer_load_dwordx4 v1, s[4:7], s34 offen offset:3072 sc1 lds
    s_waitcnt vmcnt(6) lgkmcnt(0)
    s_barrier
    s_add_u32 m0, s36, 147456
    s_add_u32 s34, s31, s36
    s_add_u32 s34, s34, 16384
    buffer_load_dwordx4 v1, s[4:7], s34 offen sc1 lds
    v_add_f32 v2, v2, v4
    v_add_f32 v3, v3, v5
    v_add_f32 v6, v6, v12
    v_add_f32 v7, v7, v13
    v_add_f32 v2, v2, v6
    v_add_f32_e64 v3, v3, v7
    v_cmp_gt_u32 vcc, 864, v1
    v_add_u32 v8, 161792, v8
    s_nop 0
    v_cndmask_b32 v2, 0, v2, vcc
    v_cndmask_b32_e64 v3, 0, v3, vcc
    ds_write_b64 v8, v[2:3]
    s_waitcnt vmcnt(6) lgkmcnt(0)
    s_barrier
    s_waitcnt vmcnt(6) lgkmcnt(0)
    s_barrier
    s_waitcnt vmcnt(1) lgkmcnt(0)
    s_barrier
    s_waitcnt vmcnt(0) lgkmcnt(0)
    s_barrier
    s_barrier
    s_branch L_m_ll
L_m_lfin:
L_end_m:
    s_endpgm

.section .rodata,"a"
.p2align 6
.amdhsa_kernel interleave_layers__sliding_local_dilated__mixer_gmlp__prompt_kernel
  .amdhsa_next_free_vgpr 256
  .amdhsa_next_free_sgpr 102
  .amdhsa_accum_offset 256
  .amdhsa_group_segment_fixed_size 0
  .amdhsa_kernarg_size 88
  .amdhsa_user_sgpr_count 2
  .amdhsa_user_sgpr_kernarg_segment_ptr 1
  .amdhsa_system_sgpr_workgroup_id_x 1
  .amdhsa_float_denorm_mode_32 3
.end_amdhsa_kernel
```

```asm
; @launch grid=(256,1,1) block=(512,1,1) lds=163840
.amdgcn_target "amdgcn-amd-amdhsa--gfx950"
.text
.globl interleave_layers__sliding_local_dilated__mixer_gmlp__prompt_kernel
.p2align 8
.type interleave_layers__sliding_local_dilated__mixer_gmlp__prompt_kernel,@function
interleave_layers__sliding_local_dilated__mixer_gmlp__prompt_kernel:
    s_cmp_ge_u32 s2, 256
    s_cbranch_scc1 L_end_m
    s_load_dwordx16 s[36:51], s[0:1], 0
    s_load_dwordx4 s[56:59], s[0:1], 64
    s_load_dwordx2 s[24:25], s[0:1], 80
    s_getpc_b64 s[26:27]
L_m_pc:
    s_sub_u32 s26, s26, L_m_pc-interleave_layers__sliding_local_dilated__mixer_gmlp__prompt_kernel
    s_subb_u32 s27, s27, 0
    v_lshlrev_b32 v4, 4, v0
    v_mov_b32 v5, s27
    v_add_co_u32 v6, vcc, s26, v4
    s_lshr_b32 s28, s2, 3
    s_lshl_b32 s28, s28, 11
    v_addc_co_u32_e64 v7, vcc, 0, v5, vcc
    global_load_dwordx4 v[60:63], v[6:7], off
    v_lshl_add_u32 v4, v0, 2, s28
    v_min_u32 v4, L_end_m-interleave_layers__sliding_local_dilated__mixer_gmlp__prompt_kernel-4, v4
    v_add_co_u32 v6, vcc, s26, v4
    s_nop 1
    v_addc_co_u32_e64 v7, vcc, 0, v5, vcc
    global_load_dword v64, v[6:7], off
    v_lshrrev_b32 v2, 6, v0
    v_and_b32 v1, 63, v0
    v_lshlrev_b32 v1, 4, v1
    v_readfirstlane_b32 s23, v2
    s_mov_b32 s22, 0
    s_mov_b32 s21, 0
    s_and_b32 s20, s23, 3
    s_waitcnt lgkmcnt(0)
    s_mov_b32 s4, s24
    s_mov_b32 s5, s25
    s_mov_b32 s6, 0x10000000
    s_mov_b32 s7, 0x20000
    s_cmp_ge_u32 s23, 4
    s_cbranch_scc1 L_ld_m
    v_bfe_u32 v2, v1, 4, 4
    v_lshrrev_b32 v3, 8, v1
    v_bfrev_b32 v6, 1
    v_mov_b32 v11, 0x3f803f80
    s_lshl_b32 s30, s20, 12
    s_and_b32 s29, s20, 1
    s_cmp_lt_u32 s2, 128
    s_cbranch_scc1 L_p0_x
    s_cmp_lt_u32 s2, 236
    s_cbranch_scc1 L_p0_wq
    s_cmp_lt_u32 s2, 254
    s_cbranch_scc1 L_p0_wo
    s_mov_b32 s46, 0
    s_mov_b32 s27, 0x800000
    s_barrier
    s_branch L_p0_cd
L_p0_wo:
    s_mul_i32 s30, s20, 9216
    s_sub_u32 s26, s2, 236
    s_mul_i32 s28, s26, 57
    s_lshr_b32 s28, s28, 9
    s_mul_i32 s27, s28, 9
    s_sub_u32 s27, s26, s27
    s_mov_b32 s32, s40
    s_mov_b32 s33, s41
    s_mov_b32 s34, 0xa2000
    s_mov_b32 s35, 0x20000
    s_mul_i32 s29, s28, 331776
    s_lshl_b32 s31, s27, 7
    s_add_u32 s29, s29, s31
    s_mul_i32 s31, s20, 82944
    s_add_u32 s29, s29, s31
    s_mul_i32 s30, s20, 9216
    v_lshrrev_b32 v4, 7, v1
    v_mul_u32_u24 v4, 1152, v4
    v_and_b32 v5, 0x70, v1
    v_add_u32_e64 v4, v4, v5
    s_add_u32 m0, s30, 0
    s_add_u32 s31, s29, 0
    buffer_load_dwordx4 v4, s[32:35], s31 offen  lds
    s_add_u32 m0, s30, 1024
    s_add_u32 s31, s29, 9216
    buffer_load_dwordx4 v4, s[32:35], s31 offen  lds
    s_add_u32 m0, s30, 2048
    s_add_u32 s31, s29, 18432
    buffer_load_dwordx4 v4, s[32:35], s31 offen  lds
    s_add_u32 m0, s30, 3072
    s_add_u32 s31, s29, 27648
    buffer_load_dwordx4 v4, s[32:35], s31 offen  lds
    s_add_u32 m0, s30, 4096
    s_add_u32 s31, s29, 36864
    buffer_load_dwordx4 v4, s[32:35], s31 offen  lds
    s_add_u32 m0, s30, 5120
    s_add_u32 s31, s29, 46080
    buffer_load_dwordx4 v4, s[32:35], s31 offen  lds
    s_add_u32 m0, s30, 6144
    s_add_u32 s31, s29, 55296
    buffer_load_dwordx4 v4, s[32:35], s31 offen  lds
    s_add_u32 m0, s30, 7168
    s_add_u32 s31, s29, 64512
    buffer_load_dwordx4 v4, s[32:35], s31 offen  lds
    s_add_u32 m0, s30, 8192
    s_add_u32 s31, s29, 73728
    buffer_load_dwordx4 v4, s[32:35], s31 offen  lds
    v_lshrrev_b32 v7, 2, v2
    v_and_b32 v8, 3, v2
    v_bfe_u32 v9, v1, 7, 0
    v_xor_b32 v9, s20, v9
    v_lshlrev_b32 v9, 5, v9
    v_lshl_add_u32 v9, v7, 7, v9
    v_lshl_add_u32 v9, v8, 3, v9
    v_add_u32_e64 v9, 0, v9
    v_mul_u32_u24 v4, 512, v3
    v_add_u32_e64 v4, v4, v9
    v_mul_u32_u24 v5, 9216, v3
    v_add_u32_e64 v5, v5, v9
    s_lshl_b32 s31, s27, 2
    s_add_u32 s31, s31, s20
    v_lshl_add_u32 v7, s31, 2, v7
    v_lshlrev_b32_e64 v8, 4, v8
    v_lshl_add_u32 v8, v3, 8, v8
    v_mul_u32_u24 v9, 57, v7
    v_lshrrev_b32 v9, 10, v9
    v_mul_u32_u24 v10, 18, v9
    v_sub_u32 v10, v7, v10
    v_lshrrev_b32 v12, 3, v10
    v_and_b32 v13, 1, v10
    v_lshl_add_u32 v12, v12, 1, v13
    v_bfe_u32 v14, v10, 1, 2
    v_cmp_gt_u32_e64 vcc, 16, v10
    v_mul_u32_u24 v9, 82944, v9
    v_add_u32 v9, v9, v8
    v_cndmask_b32 v12, 8, v12, vcc
    v_cndmask_b32_e64 v14, v13, v14, vcc
    v_mov_b32 v15, 0x1000
    v_mov_b32 v13, 0x80
    v_cndmask_b32_e64 v15, v13, v15, vcc
    v_lshl_add_u32 v9, v12, 10, v9
    v_lshl_add_u32 v9, v14, 6, v9
    v_add_u32 v10, v9, v15
    s_and_b32 s31, s28, 1
    s_cmp_eq_u32 s31, 1
    s_cselect_b64 vcc, -1, 0
    v_cndmask_b32_e64 v14, v9, v10, vcc
    s_mul_i32 s31, s28, 36864
    s_add_u32 s37, s31, 0x3a00000
    s_add_u32 s38, s31, 0x3a00000
    s_add_u32 s39, s31, 0x3a02400
    s_add_u32 s40, s31, 0x3a02400
    s_add_u32 s41, s31, 0x3a04800
    s_add_u32 s42, s31, 0x3a04800
    s_add_u32 s43, s31, 0x3a06c00
    s_add_u32 s47, s31, 0x3a06c00
    s_lshr_b32 s31, s28, 1
    s_mul_i32 s31, s31, 9216
    s_add_u32 s48, s31, 0x3a12000
    s_cmp_ge_u32 s26, 4
    s_cbranch_scc1 L_p0_n2
    s_lshl_b32 s31, s26, 2
    s_add_u32 s31, s31, s20
    s_lshl_b32 s31, s31, 12
    s_add_u32 s31, s31, 0x4508000
    v_and_b32 v56, 0x380, v1
    v_add_u32 v56, v56, v1
    v_mov_b32 v52, 0
    v_mov_b32 v53, 0
    v_mov_b32 v54, 0
    v_mov_b32_e64 v55, 0
    buffer_store_dwordx4 v[52:55], v56, s[4:7], s31 offen offset:0 sc1
    buffer_store_dwordx4 v[52:55], v56, s[4:7], s31 offen offset:2048 sc1
L_p0_n2:
    s_waitcnt vmcnt(0)
    s_barrier
    ds_read_b64_tr_b16 v[16:17], v4 offset:0
    ds_read_b64_tr_b16 v[18:19], v4 offset:2560
    ds_read_b64_tr_b16 v[20:21], v4 offset:4608
    ds_read_b64_tr_b16 v[22:23], v4 offset:7168
    ds_read_b64_tr_b16 v[24:25], v4 offset:9216
    ds_read_b64_tr_b16 v[26:27], v4 offset:11776
    ds_read_b64_tr_b16 v[28:29], v4 offset:13824
    ds_read_b64_tr_b16 v[30:31], v4 offset:16384
    ds_read_b64_tr_b16 v[32:33], v4 offset:18432
    ds_read_b64_tr_b16 v[34:35], v4 offset:20992
    ds_read_b64_tr_b16 v[36:37], v4 offset:23040
    ds_read_b64_tr_b16 v[38:39], v4 offset:25600
    ds_read_b64_tr_b16 v[40:41], v4 offset:27648
    ds_read_b64_tr_b16 v[42:43], v4 offset:30208
    ds_read_b64_tr_b16 v[44:45], v4 offset:32256
    ds_read_b64_tr_b16 v[46:47], v4 offset:34816
    ds_read_b64_tr_b16 v[48:49], v5 offset:2048
    ds_read_b64_tr_b16 v[50:51], v5 offset:6656
    s_waitcnt lgkmcnt(15)
    s_mov_b32 s31, s37
    buffer_store_dwordx4 v[16:19], v9, s[4:7], s31 offen sc1
    s_waitcnt lgkmcnt(14)
    s_mov_b32 s31, s38
    buffer_store_dwordx4 v[20:23], v10, s[4:7], s31 offen sc1
    s_waitcnt lgkmcnt(12)
    s_mov_b32 s31, s39
    buffer_store_dwordx4 v[24:27], v9, s[4:7], s31 offen sc1
    s_waitcnt lgkmcnt(10)
    s_mov_b32 s31, s40
    buffer_store_dwordx4 v[28:31], v10, s[4:7], s31 offen sc1
    s_waitcnt lgkmcnt(8)
    s_mov_b32 s31, s41
    buffer_store_dwordx4 v[32:35], v9, s[4:7], s31 offen sc1
    s_waitcnt lgkmcnt(6)
    s_mov_b32 s31, s42
    buffer_store_dwordx4 v[36:39], v10, s[4:7], s31 offen sc1
    s_waitcnt lgkmcnt(4)
    s_mov_b32 s31, s43
    buffer_store_dwordx4 v[40:43], v9, s[4:7], s31 offen sc1
    s_waitcnt lgkmcnt(2)
    s_mov_b32 s31, s47
    buffer_store_dwordx4 v[44:47], v10, s[4:7], s31 offen sc1
    s_waitcnt lgkmcnt(0)
    s_mov_b32 s31, s48
    buffer_store_dwordx4 v[48:51], v14, s[4:7], s31 offen sc1
    s_mov_b32 s46, 1
    s_mov_b32 s27, 32
    s_branch L_p0_cd
    s_nop 0
L_p0_wq:
    s_mov_b32 s32, s38
    s_mov_b32 s33, s39
    s_mov_b32 s34, 0x1e6000
    s_mov_b32 s35, 0x20000
    s_sub_u32 s23, s2, 128
    s_mul_i32 s25, s23, 19
    s_lshr_b32 s25, s25, 9
    s_mul_i32 s24, s25, 27
    s_sub_u32 s24, s23, s24
    s_mul_i32 s26, s25, 497664
    s_lshl_b32 s31, s24, 7
    s_add_u32 s26, s26, s31
    v_lshrrev_b32_e64 v4, 7, v1
    v_mul_u32_u24 v4, 3456, v4
    v_lshrrev_b32 v5, 4, v1
    v_and_b32 v5, 16, v5
    v_xor_b32_e64 v5, v5, v1
    v_and_b32 v5, 0x70, v5
    v_add_u32_e64 v4, v4, v5
    s_mul_i32 s31, s20, 110592
    s_add_u32 s27, s26, s31
    s_mul_i32 s30, s20, 4224
    s_add_u32 m0, s30, 0
    s_add_u32 s31, s27, 0
    buffer_load_dwordx4 v4, s[32:35], s31 offen  lds
    s_add_u32 m0, s30, 1056
    s_add_u32 s31, s27, 27648
    buffer_load_dwordx4 v4, s[32:35], s31 offen  lds
    s_add_u32 m0, s30, 2112
    s_add_u32 s31, s27, 55296
    buffer_load_dwordx4 v4, s[32:35], s31 offen  lds
    s_add_u32 m0, s30, 3168
    s_add_u32 s31, s27, 82944
    buffer_load_dwordx4 v4, s[32:35], s31 offen  lds
    s_cmp_ge_u32 s20, 2
    s_cbranch_scc1 L_p0_q5
    s_mul_i32 s31, s29, 1056
    s_add_u32 m0, s31, 16896
    s_mul_i32 s31, s29, 27648
    s_add_u32 s31, s31, s26
    s_add_u32 s31, s31, 442368
    buffer_load_dwordx4 v4, s[32:35], s31 offen  lds
L_p0_q5:
    v_lshrrev_b32 v7, 2, v2
    v_and_b32 v8, 3, v2
    s_lshl_b32 s31, s20, 5
    v_and_b32 v9, 2, v7
    v_xor_b32 v9, v9, v3
    v_lshlrev_b32 v9, 3, v9
    v_lshl_add_u32 v9, v7, 7, v9
    v_add_u32_e64 v9, s31, v9
    v_mul_u32_u24 v4, 1056, v8
    v_add_u32 v4, v4, v9
    v_and_b32 v5, 1, v2
    v_mul_u32_u24 v5, 9504, v5
    v_add_u32 v5, v5, v9
    s_lshl_b32 s31, s24, 2
    s_add_u32 s31, s31, s20
    v_lshlrev_b32 v8, 4, v8
    v_lshl_add_u32 v8, v7, 8, v8
    v_lshl_add_u32 v7, s31, 2, v3
    v_mul_u32_u24 v9, 57, v7
    v_lshrrev_b32 v9, 13, v9
    v_mul_u32_u24 v10, 144, v9
    v_sub_u32 v10, v7, v10
    v_mul_u32_u24 v12, 57, v10
    v_lshrrev_b32 v12, 9, v12
    v_mul_u32_u24 v13, 9, v12
    v_sub_u32_e64 v13, v10, v13
    v_cmp_lt_u32 s[36:37], 4, v13
    v_cmp_eq_u32 s[38:39], 4, v13
    v_cmp_eq_u32 s[40:41], 2, v9
    v_lshlrev_b32 v14, 1, v9
    v_add_u32 v15, 1, v14
    v_subrev_u32_e64 v10, 5, v13
    v_cndmask_b32 v14, v14, v15, s[36:37]
    v_cndmask_b32 v13, v13, v10, s[36:37]
    v_cndmask_b32 v14, v14, 6, s[38:39]
    v_cndmask_b32 v13, v13, v9, s[38:39]
    s_and_b64 s[40:41], s[40:41], s[38:39]
    s_mov_b32 s31, 129024
    v_mul_lo_u32 v9, v12, s31
    v_add_u32 v9, v9, v8
    v_lshl_add_u32 v9, v14, 10, v9
    v_lshl_add_u32 v9, v13, 6, v9
    s_and_b32 s31, s25, 1
    v_lshrrev_b32 v8, 3, v2
    v_cmp_eq_u32 vcc, s31, v8
    v_add_u32 v15, 64, v9
    v_cndmask_b32 v15, v6, v15, s[40:41]
    v_cndmask_b32 v8, v6, v9, vcc
    v_lshlrev_b32 v10, 2, v2
    v_lshl_add_u32 v10, v7, 4, v10
    v_cmp_gt_u32 vcc, 4, v2
    s_lshl_b32 s45, s25, 13
    s_add_u32 s45, s45, 0x4400000
    v_cndmask_b32_e64 v10, v6, v10, vcc
    s_mul_i32 s42, s25, 28672
    s_add_u32 s42, s42, 0x3800000
    s_lshr_b32 s44, s25, 1
    s_mul_i32 s44, s44, 7168
    s_add_u32 s44, s44, 0x381c000
    s_mul_i32 s26, s24, 29
    s_lshr_b32 s26, s26, 8
    s_mul_i32 s27, s26, 9
    s_sub_u32 s27, s24, s27
    s_lshl_b32 s27, s27, 4
    s_add_u32 s28, s27, 16
    v_lshrrev_b32 v254, 4, v1
    v_mul_u32_u24 v7, 9, v254
    v_add_u32 v255, 9, v7
    v_min_u32 v255, s28, v255
    v_max_u32 v7, s27, v7
    v_sub_u32 v255, v255, v7
    v_cmp_lt_i32 vcc, 0, v255
    v_lshlrev_b32_e64 v254, 8, v254
    v_mov_b32 v14, 0x3f003f00
    v_cndmask_b32 v254, v6, v254, vcc
    s_cmp_eq_u64 s[40:41], 0
    s_cbranch_scc1 L_p0_np
    v_mov_b32 v52, 0
    v_mov_b32 v53, 0
    v_mov_b32 v54, 0
    v_mov_b32 v55, 0
    s_add_u32 s31, s42, 0
    buffer_store_dwordx4 v[52:55], v15, s[4:7], s31 offen sc1
    s_add_u32 s31, s42, 7168
    buffer_store_dwordx4 v[52:55], v15, s[4:7], s31 offen sc1
    s_add_u32 s31, s42, 14336
    buffer_store_dwordx4 v[52:55], v15, s[4:7], s31 offen sc1
    s_add_u32 s31, s42, 21504
    buffer_store_dwordx4 v[52:55], v15, s[4:7], s31 offen sc1
    s_mov_b32 s31, s44
    buffer_store_dwordx4 v[52:55], v15, s[4:7], s31 offen sc1
    s_waitcnt vmcnt(5)
    s_branch L_p0_n3
    s_nop 0
L_p0_np:
    s_waitcnt vmcnt(0)
L_p0_n3:
    s_barrier
    ds_read_b64_tr_b16 v[16:17], v4 offset:0
    ds_read_b64_tr_b16 v[18:19], v4 offset:512
    ds_read_b64_tr_b16 v[20:21], v4 offset:4224
    ds_read_b64_tr_b16 v[22:23], v4 offset:4736
    ds_read_b64_tr_b16 v[24:25], v4 offset:9504
    ds_read_b64_tr_b16 v[26:27], v4 offset:10016
    ds_read_b64_tr_b16 v[28:29], v4 offset:13728
    ds_read_b64_tr_b16 v[30:31], v4 offset:14240
    ds_read_b64_tr_b16 v[32:33], v5 offset:8448
    ds_read_b64_tr_b16 v[34:35], v5 offset:8960
    s_waitcnt lgkmcnt(8)
    s_add_u32 s31, s42, 0
    buffer_store_dwordx4 v[16:19], v9, s[4:7], s31 offen sc1
    s_waitcnt lgkmcnt(6)
    s_add_u32 s31, s42, 7168
    buffer_store_dwordx4 v[20:23], v9, s[4:7], s31 offen sc1
    s_waitcnt lgkmcnt(4)
    s_add_u32 s31, s42, 14336
    buffer_store_dwordx4 v[24:27], v9, s[4:7], s31 offen sc1
    s_waitcnt lgkmcnt(2)
    s_add_u32 s31, s42, 21504
    buffer_store_dwordx4 v[28:31], v9, s[4:7], s31 offen sc1
    s_waitcnt lgkmcnt(0)
    s_mov_b32 s31, s44
    buffer_store_dwordx4 v[32:35], v8, s[4:7], s31 offen sc1
    v_dot2_f32_bf16 v12, v16, v11, 0
    v_dot2_f32_bf16 v13, v17, v11, 0
    v_dot2_f32_bf16 v12, v18, v11, v12
    v_dot2_f32_bf16 v13, v19, v11, v13
    v_dot2_f32_bf16 v12, v20, v11, v12
    v_dot2_f32_bf16 v13, v21, v11, v13
    v_dot2_f32_bf16 v12, v22, v11, v12
    v_dot2_f32_bf16 v13, v23, v11, v13
    v_dot2_f32_bf16 v12, v24, v11, v12
    v_dot2_f32_bf16 v13, v25, v11, v13
    v_dot2_f32_bf16 v12, v26, v11, v12
    v_dot2_f32_bf16 v13, v27, v11, v13
    v_dot2_f32_bf16 v12, v28, v11, v12
    v_dot2_f32_bf16 v13, v29, v11, v13
    v_dot2_f32_bf16 v12, v30, v11, v12
    v_dot2_f32_bf16 v13, v31, v11, v13
    v_dot2_f32_bf16 v12, v32, v14, v12
    v_dot2_f32_bf16 v13, v33, v14, v13
    v_dot2_f32_bf16 v12, v34, v14, v12
    v_dot2_f32_bf16 v13, v35, v14, v13
    s_nop 2
    v_add_f32 v12, v12, v13
    s_nop 1
    v_add_f32_dpp v12, v12, v12 row_ror:4 row_mask:0xf bank_mask:0xf
    s_nop 1
    v_add_f32_dpp v12, v12, v12 row_ror:8 row_mask:0xf bank_mask:0xf
    buffer_store_dword v12, v10, s[4:7], s45 offen sc1
    s_branch L_p0_ce
L_p0_x:
    s_mov_b32 s32, s36
    s_mov_b32 s33, s37
    s_mov_b32 s34, 0x240000
    s_mov_b32 s35, 0x20000
    s_mul_i32 s26, s2, 18432
    s_mul_i32 s31, s20, 288
    s_add_u32 s28, s26, s31
    v_lshrrev_b32 v4, 6, v1
    v_mul_u32_u24 v4, 1152, v4
    v_and_b32 v5, 48, v1
    v_add_u32 v4, v4, v5
    s_add_u32 m0, s30, 0
    s_add_u32 s31, s28, 0
    buffer_load_dwordx4 v4, s[32:35], s31 offen  lds
    s_add_u32 m0, s30, 1024
    s_add_u32 s31, s28, 64
    buffer_load_dwordx4 v4, s[32:35], s31 offen  lds
    s_add_u32 m0, s30, 2048
    s_add_u32 s31, s28, 144
    buffer_load_dwordx4 v4, s[32:35], s31 offen  lds
    s_add_u32 m0, s30, 3072
    s_add_u32 s31, s28, 208
    buffer_load_dwordx4 v4, s[32:35], s31 offen  lds
    s_mul_i32 s31, s29, 576
    s_add_u32 s31, s31, s26
    v_mul_u32_u24 v7, 1152, v2
    v_mul_u32_u24 v5, 144, v3
    v_add_u32_e64 v5, v5, v7
    buffer_load_dwordx4 v[32:35], v5, s[32:35], s31 offen offset:128
    s_lshl_b32 s27, s29, 10
    s_add_u32 s27, s27, 16384
    s_barrier
    v_lshlrev_b32_e64 v4, 6, v2
    v_lshl_add_u32 v4, v3, 4, v4
    v_add_u32_e64 v4, s30, v4
    s_add_u32 s26, s26, 0x0
    s_add_u32 s42, s26, s30
    s_add_u32 s44, s26, s27
    s_lshl_b32 s45, s2, 10
    s_lshl_b32 s31, s20, 8
    s_add_u32 s45, s45, s31
    s_add_u32 s45, s45, 0x1b00000
    v_cmp_gt_u32 vcc, 2, v3
    v_lshrrev_b32 v10, 1, v1
    s_mov_b32 s46, 2
    v_cndmask_b32_e64 v10, v6, v10, vcc
    s_lshr_b32 s27, s2, 3
    s_add_u32 s27, s27, 48
    s_waitcnt vmcnt(0)
    ds_read_b128 v[16:19], v4 offset:0
    ds_read_b128 v[20:23], v4 offset:1024
    ds_read_b128 v[24:27], v4 offset:2048
    ds_read_b128 v[28:31], v4 offset:3072
    s_waitcnt lgkmcnt(3)
    buffer_store_dwordx4 v[16:19], v1, s[4:7], s42 offen offset:0 sc1
    s_waitcnt lgkmcnt(2)
    buffer_store_dwordx4 v[20:23], v1, s[4:7], s42 offen offset:1024 sc1
    s_waitcnt lgkmcnt(1)
    buffer_store_dwordx4 v[24:27], v1, s[4:7], s42 offen offset:2048 sc1
    s_waitcnt lgkmcnt(0)
    buffer_store_dwordx4 v[28:31], v1, s[4:7], s42 offen offset:3072 sc1
    v_dot2_f32_bf16 v12, v16, v11, 0
    v_dot2_f32_bf16 v13, v16, v16, 0
    v_dot2_f32_bf16 v12, v17, v11, v12
    v_dot2_f32_bf16 v13, v17, v17, v13
    v_dot2_f32_bf16 v12, v18, v11, v12
    v_dot2_f32_bf16 v13, v18, v18, v13
    v_dot2_f32_bf16 v12, v19, v11, v12
    v_dot2_f32_bf16 v13, v19, v19, v13
    v_dot2_f32_bf16 v12, v20, v11, v12
    v_dot2_f32_bf16 v13, v20, v20, v13
    v_dot2_f32_bf16 v12, v21, v11, v12
    v_dot2_f32_bf16 v13, v21, v21, v13
    v_dot2_f32_bf16 v12, v22, v11, v12
    v_dot2_f32_bf16 v13, v22, v22, v13
    v_dot2_f32_bf16 v12, v23, v11, v12
    v_dot2_f32_bf16 v13, v23, v23, v13
    v_dot2_f32_bf16 v12, v24, v11, v12
    v_dot2_f32_bf16 v13, v24, v24, v13
    v_dot2_f32_bf16 v12, v25, v11, v12
    v_dot2_f32_bf16 v13, v25, v25, v13
    v_dot2_f32_bf16 v12, v26, v11, v12
    v_dot2_f32_bf16 v13, v26, v26, v13
    v_dot2_f32_bf16 v12, v27, v11, v12
    v_dot2_f32_bf16 v13, v27, v27, v13
    v_dot2_f32_bf16 v12, v28, v11, v12
    v_dot2_f32_bf16 v13, v28, v28, v13
    v_dot2_f32_bf16 v12, v29, v11, v12
    v_dot2_f32_bf16 v13, v29, v29, v13
    v_dot2_f32_bf16 v12, v30, v11, v12
    v_dot2_f32_bf16 v13, v30, v30, v13
    v_dot2_f32_bf16 v12, v31, v11, v12
    v_dot2_f32_bf16 v13, v31, v31, v13
    s_waitcnt lgkmcnt(0)
    s_cmp_ge_u32 s20, 2
    s_cbranch_scc1 L_p0_xs
    buffer_store_dwordx4 v[32:35], v1, s[4:7], s44 offen sc1
    v_dot2_f32_bf16 v12, v32, v11, v12
    v_dot2_f32_bf16 v13, v32, v32, v13
    v_dot2_f32_bf16 v12, v33, v11, v12
    v_dot2_f32_bf16 v13, v33, v33, v13
    v_dot2_f32_bf16 v12, v34, v11, v12
    v_dot2_f32_bf16 v13, v34, v34, v13
    v_dot2_f32_bf16 v12, v35, v11, v12
    v_dot2_f32_bf16 v13, v35, v35, v13
L_p0_xs:
    s_nop 2
    v_mov_b32 v14, v12
    v_mov_b32 v15, v13
    s_nop 1
    v_permlane32_swap_b32 v12, v14
    v_permlane32_swap_b32 v13, v15
    v_add_f32 v12, v12, v14
    v_add_f32_e64 v13, v13, v15
    buffer_store_dwordx2 v[12:13], v10, s[4:7], s45 offen sc1
L_p0_cd:
    v_cmp_eq_u32 vcc, 0, v1
    s_lshl_b32 s27, s27, 8
    v_mov_b32 v255, s46
    v_mov_b32 v254, s27
    v_cndmask_b32_e64 v254, v6, v254, vcc
L_p0_ce:
    s_mov_b32 s48, s58
    s_mov_b32 s49, s59
    s_mov_b32 s50, 0x100
    s_mov_b32 s51, 0x20000
    v_mov_b32_e64 v4, 0
    buffer_load_dword v246, v4, s[48:51], 0 offen sc1
    s_mov_b32 s16, s56
    s_mov_b32 s17, s57
    s_mov_b32 s18, 0x240000
    s_mov_b32 s19, 0x20000
    s_branch L_m_cl
L_d1_first:
    v_cmp_gt_u32 vcc, 4, v246
    v_mov_b32_e64 v4, 0
    s_mov_b32 s46, 0x4500000
    s_cbranch_vccz L_pd_dbg
    s_mov_b32 s60, 262144
L_poll_dbg:
    buffer_load_dword v5, v4, s[48:51], 0 offen sc1
    s_waitcnt vmcnt(0)
    v_cmp_gt_u32 vcc, 4, v5
    s_sub_u32 s60, s60, 1
    s_cbranch_scc1 L_pd_dbg
    s_cbranch_vccz L_pd_dbg
    s_sleep 4
    s_branch L_poll_dbg
L_pd_dbg:
    buffer_atomic_add v255, v254, s[4:7], s46 offen sc1
    s_branch L_ns_d1
    s_nop 0
L_ld_m:
    s_cmp_lg_u32 s2, 254
    s_cbranch_scc1 L_p0_nz
    s_lshl_b32 s31, s20, 12
    s_add_u32 s31, s31, 0x4500000
    v_and_b32 v56, 0x380, v1
    v_add_u32 v56, v56, v1
    v_mov_b32 v52, 0
    v_mov_b32 v53, 0
    v_mov_b32 v54, 0
    v_mov_b32_e64 v55, 0
    buffer_store_dwordx4 v[52:55], v56, s[4:7], s31 offen offset:0 sc1
    buffer_store_dwordx4 v[52:55], v56, s[4:7], s31 offen offset:2048 sc1
    s_waitcnt vmcnt(0)
    s_mov_b32 s53, 1
    s_atomic_add s53, s[58:59], 0
L_p0_nz:
    s_mov_b32 s8, s46
    s_mov_b32 s9, s47
    s_mov_b32 s10, 0x800000
    s_mov_b32 s11, 0x20000
    s_mov_b32 s12, s48
    s_mov_b32 s13, s49
    s_mov_b32 s14, 0x1000
    s_mov_b32 s15, 0x20000
    v_mov_b32 v2, 163808
    v_mov_b32 v4, 0
    v_mov_b32 v5, 0
    ds_write2_b64 v2, v[4:5], v[4:5] offset0:0 offset1:1
    s_waitcnt lgkmcnt(0)
    v_bfe_u32 v2, v1, 4, 4
    v_lshrrev_b32 v3, 8, v1
    v_bfrev_b32_e64 v6, 1
    v_mov_b32 v11, 0x3f803f80
    s_mul_i32 s30, s20, 9216
    s_cmp_lt_u32 s2, 144
    s_cbranch_scc1 L_p0_wi
    s_cmp_lt_u32 s2, 216
    s_cbranch_scc1 L_p0_wu
    v_mov_b32 v9, v6
    v_mov_b32 v10, v6
    v_mov_b32 v14, v6
    v_mov_b32 v15, v6
    s_mov_b32 s37, 0
    s_mov_b32 s38, 0
    s_mov_b32 s39, 0
    s_mov_b32 s40, 0
    s_mov_b32 s41, 0
    s_mov_b32 s42, 0
    s_mov_b32 s43, 0
    s_mov_b32 s47, 0
    s_mov_b32 s48, 0
    s_mov_b32 s49, 0
    s_barrier
    s_barrier
    s_barrier
    s_branch L_p0_ld
L_p0_wu:
    s_sub_u32 s26, s2, 144
    s_mul_i32 s28, s26, 57
    s_lshr_b32 s28, s28, 9
    s_mul_i32 s27, s28, 9
    s_sub_u32 s27, s26, s27
    s_mov_b32 s32, s50
    s_mov_b32 s33, s51
    s_mov_b32 s34, 0x288000
    s_mov_b32 s35, 0x20000
    s_mul_i32 s29, s28, 331776
    s_lshl_b32 s31, s27, 7
    s_add_u32 s29, s29, s31
    s_mul_i32 s31, s20, 82944
    s_add_u32 s29, s29, s31
    s_mul_i32 s30, s20, 9216
    v_lshrrev_b32 v4, 7, v1
    v_mul_u32_u24 v4, 1152, v4
    v_and_b32 v5, 0x70, v1
    v_bfe_u32 v7, v1, 8, 2
    v_lshlrev_b32 v7, 5, v7
    v_xor_b32 v5, v5, v7
    v_add_u32 v4, v4, v5
    s_barrier
    s_barrier
    s_barrier
    s_add_u32 m0, s30, 91904
    s_add_u32 s31, s29, 0
    buffer_load_dwordx4 v4, s[32:35], s31 offen  lds
    s_add_u32 m0, s30, 92928
    s_add_u32 s31, s29, 9216
    buffer_load_dwordx4 v4, s[32:35], s31 offen  lds
    s_add_u32 m0, s30, 93952
    s_add_u32 s31, s29, 18432
    buffer_load_dwordx4 v4, s[32:35], s31 offen  lds
    s_add_u32 m0, s30, 94976
    s_add_u32 s31, s29, 27648
    buffer_load_dwordx4 v4, s[32:35], s31 offen  lds
    s_add_u32 m0, s30, 96000
    s_add_u32 s31, s29, 36864
    buffer_load_dwordx4 v4, s[32:35], s31 offen  lds
    s_add_u32 m0, s30, 97024
    s_add_u32 s31, s29, 46080
    buffer_load_dwordx4 v4, s[32:35], s31 offen  lds
    s_add_u32 m0, s30, 98048
    s_add_u32 s31, s29, 55296
    buffer_load_dwordx4 v4, s[32:35], s31 offen  lds
    s_add_u32 m0, s30, 99072
    s_add_u32 s31, s29, 64512
    buffer_load_dwordx4 v4, s[32:35], s31 offen  lds
    s_add_u32 m0, s30, 100096
    s_add_u32 s31, s29, 73728
    buffer_load_dwordx4 v4, s[32:35], s31 offen  lds
    v_lshrrev_b32 v7, 2, v2
    v_and_b32_e64 v8, 3, v2
    v_bfe_u32 v9, v1, 7, 2
    v_xor_b32 v9, s20, v9
    v_lshlrev_b32 v9, 5, v9
    v_lshl_add_u32 v9, v7, 7, v9
    v_lshl_add_u32 v9, v8, 3, v9
    v_add_u32 v9, 91904, v9
    v_mul_u32_u24 v4, 512, v3
    v_add_u32_e64 v4, v4, v9
    v_mul_u32_u24 v5, 512, v3
    v_add_u32_e64 v5, v5, v9
    s_lshl_b32 s31, s27, 2
    s_add_u32 s31, s31, s20
    v_lshl_add_u32 v7, s31, 2, v7
    v_lshlrev_b32_e64 v8, 4, v8
    v_lshl_add_u32 v8, v3, 8, v8
    v_mul_u32_u24 v9, 57, v7
    v_lshrrev_b32 v9, 10, v9
    v_mul_u32_u24 v10, 18, v9
    v_sub_u32 v10, v7, v10
    v_lshrrev_b32 v12, 3, v10
    v_and_b32 v13, 1, v10
    v_lshl_add_u32 v12, v12, 1, v13
    v_bfe_u32 v14, v10, 1, 2
    v_cmp_gt_u32_e64 vcc, 16, v10
    v_mul_u32_u24 v9, 331776, v9
    v_add_u32 v9, v9, v8
    v_cndmask_b32 v12, 8, v12, vcc
    v_cndmask_b32_e64 v14, v13, v14, vcc
    v_mov_b32 v15, 0x1000
    v_mov_b32 v13, 0x80
    v_cndmask_b32_e64 v15, v13, v15, vcc
    v_lshl_add_u32 v9, v12, 10, v9
    v_lshl_add_u32 v9, v14, 6, v9
    v_add_u32 v10, v9, v15
    s_and_b32 s31, s28, 1
    s_cmp_eq_u32 s31, 1
    s_cselect_b64 vcc, -1, 0
    v_cndmask_b32_e64 v14, v9, v10, vcc
    s_mul_i32 s31, s28, 9216
    s_add_u32 s37, s31, 0x4100000
    s_add_u32 s38, s31, 0x4100000
    s_add_u32 s39, s31, 0x4112000
    s_add_u32 s40, s31, 0x4112000
    s_add_u32 s41, s31, 0x4124000
    s_add_u32 s42, s31, 0x4124000
    s_add_u32 s43, s31, 0x4136000
    s_add_u32 s47, s31, 0x4136000
    s_lshr_b32 s31, s28, 1
    s_mul_i32 s31, s31, 9216
    s_add_u32 s48, s31, 0x4148000
    v_mov_b32_e64 v15, v6
    s_mov_b32 s49, 0
    s_branch L_p0_ld
L_p0_wi:
    s_mov_b32 s26, s2
    s_mul_i32 s28, s26, 57
    s_lshr_b32 s28, s28, 12
    s_mul_i32 s27, s28, 72
    s_sub_u32 s27, s26, s27
    s_mov_b32 s32, s44
    s_mov_b32 s33, s45
    s_mov_b32 s34, 0x510000
    s_mov_b32 s35, 0x20000
    s_mul_i32 s29, s28, 2654208
    s_lshl_b32 s31, s27, 7
    s_add_u32 s29, s29, s31
    s_mul_i32 s31, s20, 663552
    s_add_u32 s29, s29, s31
    s_mul_i32 s30, s20, 9792
    v_lshrrev_b32_e64 v4, 7, v1
    v_mul_u32_u24 v4, 9216, v4
    v_and_b32 v5, 0x70, v1
    v_bfe_u32 v7, v1, 8, 1
    v_lshlrev_b32 v7, 5, v7
    v_xor_b32 v5, v5, v7
    v_add_u32 v4, v4, v5
    s_barrier
    s_barrier
    s_barrier
    s_add_u32 m0, s30, 91904
    s_add_u32 s31, s29, 0
    buffer_load_dwordx4 v4, s[32:35], s31 offen  lds
    s_add_u32 m0, s30, 92992
    s_add_u32 s31, s29, 73728
    buffer_load_dwordx4 v4, s[32:35], s31 offen  lds
    s_add_u32 m0, s30, 94080
    s_add_u32 s31, s29, 147456
    buffer_load_dwordx4 v4, s[32:35], s31 offen  lds
    s_add_u32 m0, s30, 95168
    s_add_u32 s31, s29, 221184
    buffer_load_dwordx4 v4, s[32:35], s31 offen  lds
    s_add_u32 m0, s30, 96256
    s_add_u32 s31, s29, 294912
    buffer_load_dwordx4 v4, s[32:35], s31 offen  lds
    s_add_u32 m0, s30, 97344
    s_add_u32 s31, s29, 368640
    buffer_load_dwordx4 v4, s[32:35], s31 offen  lds
    s_add_u32 m0, s30, 98432
    s_add_u32 s31, s29, 442368
    buffer_load_dwordx4 v4, s[32:35], s31 offen  lds
    s_add_u32 m0, s30, 99520
    s_add_u32 s31, s29, 516096
    buffer_load_dwordx4 v4, s[32:35], s31 offen  lds
    s_add_u32 m0, s30, 100608
    s_add_u32 s31, s29, 589824
    buffer_load_dwordx4 v4, s[32:35], s31 offen  lds
    v_lshrrev_b32 v7, 2, v2
    v_and_b32_e64 v8, 3, v2
    v_bfe_u32 v9, v1, 7, 1
    v_xor_b32 v9, s20, v9
    v_lshlrev_b32 v9, 5, v9
    v_lshl_add_u32 v9, v7, 7, v9
    v_lshl_add_u32 v9, v8, 3, v9
    v_add_u32 v9, 91904, v9
    v_mul_u32_u24 v4, 1088, v3
    v_add_u32_e64 v4, v4, v9
    v_mul_u32_u24 v5, 9792, v3
    v_add_u32_e64 v5, v5, v9
    s_lshl_b32 s31, s27, 2
    s_add_u32 s31, s31, s20
    v_lshl_add_u32 v7, s31, 2, v7
    v_lshlrev_b32_e64 v8, 4, v8
    v_lshl_add_u32 v8, v3, 8, v8
    s_cmp_lt_u32 s31, 144
    s_cselect_b32 s23, 1, 0
    s_cselect_b32 s24, 0, 144
    s_sub_u32 s26, s31, s24
    s_mul_i32 s25, s26, 57
    s_lshr_b32 s25, s25, 9
    s_mul_i32 s24, s25, 9
    s_sub_u32 s24, s26, s24
    s_lshl_b32 s26, s25, 1
    s_add_u32 s26, s26, s23
    s_mul_i32 s26, s26, 165888
    s_lshl_b32 s31, s24, 10
    s_add_u32 s26, s26, s31
    s_add_u32 s26, s26, 0x3b00000
    s_mul_i32 s31, s28, 9216
    s_add_u32 s48, s26, s31
    s_add_u32 s48, s48, 147456
    s_lshl_b32 s31, s31, 3
    s_add_u32 s26, s26, s31
    s_add_u32 s37, s26, 0
    s_add_u32 s38, s26, 9216
    s_add_u32 s39, s26, 18432
    s_add_u32 s40, s26, 27648
    s_add_u32 s41, s26, 36864
    s_add_u32 s42, s26, 46080
    s_add_u32 s43, s26, 55296
    s_add_u32 s47, s26, 64512
    s_lshl_b32 s49, s25, 12
    s_mul_i32 s31, s28, 1152
    s_add_u32 s49, s49, s31
    s_mul_i32 s31, s23, 576
    s_add_u32 s49, s49, s31
    s_lshl_b32 s31, s24, 6
    s_add_u32 s49, s49, s31
    s_add_u32 s49, s49, 0x4410000
    v_cmp_eq_u32 vcc, 0, v3
    v_lshlrev_b32 v15, 2, v2
    v_mov_b32 v9, v1
    v_mov_b32 v10, v1
    v_mov_b32 v14, v1
    v_cndmask_b32 v15, v6, v15, vcc
L_p0_ld:
    s_waitcnt lgkmcnt(0)
    s_branch L_m_l1
L_m_cl:
    s_and_b32 s25, s2, 7
    s_lshr_b32 s26, s2, 3
    s_lshr_b32 s23, s25, 1
    s_lshl_b32 s23, s23, 2
    s_lshr_b32 s27, s26, 3
    s_add_u32 s23, s23, s27
    s_and_b32 s24, s25, 1
    s_lshl_b32 s24, s24, 3
    s_and_b32 s27, s26, 7
    s_add_u32 s24, s24, s27
    s_lshl_b32 s30, s23, 3
    s_lshl_b32 s31, s20, 1
    s_add_u32 s31, s30, s31
    s_mul_i32 s29, s31, 18432
    s_add_u32 s29, s29, s21
    s_add_u32 s35, s29, 0x600000
    s_add_u32 s29, s29, 0x0
    s_max_u32 s30, s30, 1
    s_sub_u32 s30, s30, 1
    s_lshl_b32 s30, s30, 10
    s_add_u32 s30, s30, s21
    s_add_u32 s30, s30, 0x1b00000
    s_lshl_b32 s32, s31, 10
    s_add_u32 s32, s32, s21
    s_add_u32 s32, s32, 0x1b00000
    v_bfe_u32 v2, v1, 4, 4
    v_lshrrev_b32 v3, 8, v1
    s_lshl_b32 s33, s20, 2
    s_lshr_b32 s33, 0x3362, s33
    s_and_b32 s33, s33, 15
    s_min_u32 s34, s20, 1
    s_add_u32 s34, s34, 4
    s_lshl_b32 s36, s33, 10
    s_lshl_b32 s37, s34, 10
    v_add_u32 v247, 64512, v1
    v_add_u32 v248, 131072, v1
    v_add_u32 v249, s36, v1
    v_add_u32 v250, s36, v247
    v_add_u32 v251, s37, v1
    v_add_u32_e64 v252, s37, v247
    v_add_u32 v253, 18432, v1
    v_lshrrev_b32 v0, 1, v1
    s_add_u32 s38, s29, 0
    s_add_u32 s39, s29, 4096
    s_add_u32 s40, s29, 8192
    s_add_u32 s41, s29, 12288
    s_add_u32 s42, s29, 16384
    s_max_u32 s44, s23, 1
    s_sub_u32 s44, s44, 1
    s_lshl_b32 s52, s22, 7
    s_add_u32 s52, s52, s23
    s_lshl_b32 s52, s52, 8
    s_add_u32 s52, s52, 0x4503000
    s_add_u32 s52, s52, s4
    s_addc_u32 s53, s5, 0
    s_lshl_b32 s54, s22, 7
    s_add_u32 s54, s54, s44
    s_lshl_b32 s54, s54, 8
    s_add_u32 s54, s54, 0x4503000
    s_add_u32 s54, s54, s4
    s_addc_u32 s55, s5, 0
    s_lshl_b32 s44, s24, 8
    s_add_u32 s44, s44, 0x4500000
    s_add_u32 s44, s44, s4
    s_addc_u32 s45, s5, 0
    s_waitcnt vmcnt(0)
    s_barrier
    s_cmp_lg_u32 s20, 0
    s_cbranch_scc1 L_ns_d1
    s_cmp_eq_u32 s22, 0
    s_cbranch_scc1 L_d1_first
    s_mov_b32 s56, 1
    s_atomic_add s56, s[50:51], 0
L_ns_d1:
    s_barrier
    s_cmp_lg_u32 s20, 0
    s_cbranch_scc1 L_pd_d1
    s_mov_b32 s60, 262144
L_poll_d1:
    s_mov_b32 s57, 0
    s_atomic_add s57, s[52:53], 0 glc
    s_mov_b32 s58, 0
    s_atomic_add s58, s[54:55], 0 glc
    s_mov_b32 s59, 0
    s_atomic_add s59, s[44:45], 0 glc
    s_waitcnt lgkmcnt(0)
    s_cmp_ge_u32 s59, 108
    s_cselect_b32 s59, 16, 0
    s_min_u32 s57, s57, s58
    s_min_u32 s57, s57, s59
    s_cmp_ge_u32 s57, 16
    s_cbranch_scc1 L_pd_d1
    s_sub_u32 s60, s60, 1
    s_cbranch_scc1 L_pd_d1
    s_sleep 2
    s_branch L_poll_d1
    s_nop 0
L_pd_d1:
    s_barrier
    buffer_load_dwordx4 v[160:163], v1, s[4:7], s38 offen offset:0 sc1
    buffer_load_dwordx4 v[164:167], v253, s[4:7], s38 offen offset:0 sc1
    buffer_load_dwordx4 v[168:171], v1, s[4:7], s38 offen offset:1024 sc1
    buffer_load_dwordx4 v[172:175], v253, s[4:7], s38 offen offset:1024 sc1
    buffer_load_dwordx4 v[176:179], v1, s[4:7], s38 offen offset:2048 sc1
    buffer_load_dwordx4 v[180:183], v253, s[4:7], s38 offen offset:2048 sc1
    buffer_load_dwordx4 v[184:187], v1, s[4:7], s38 offen offset:3072 sc1
    buffer_load_dwordx4 v[188:191], v253, s[4:7], s38 offen offset:3072 sc1
    s_barrier
    ds_read_b128 v[80:83], v1 offset:0
    ds_read_b128 v[84:87], v1 offset:1024
    ds_read_b128 v[88:91], v1 offset:2048
    ds_read_b128 v[92:95], v1 offset:3072
    ds_read_b128 v[96:99], v1 offset:4096
    ds_read_b128 v[100:103], v1 offset:5120
    ds_read_b128 v[104:107], v1 offset:6144
    s_lshl_b32 s50, s22, 7
    s_add_u32 s50, s50, s23
    s_lshl_b32 s50, s50, 8
    s_add_u32 s50, s50, 0x4508000
    s_add_u32 s50, s50, s4
    s_addc_u32 s51, s5, 0
    s_waitcnt vmcnt(6) lgkmcnt(3)
    v_mfma_f32_16x16x32_bf16 v[16:19], v[80:83], v[160:163], 0
    ds_read_b128 v[120:123], v1 offset:7168
    v_mfma_f32_16x16x32_bf16 v[44:47], v[80:83], v[164:167], 0
    ds_read_b128 v[124:127], v1 offset:8192
    v_mfma_f32_16x16x32_bf16 v[20:23], v[84:87], v[160:163], 0
    ds_read_b128 v[128:131], v1 offset:9216
    v_mfma_f32_16x16x32_bf16 v[48:51], v[84:87], v[164:167], 0
    ds_read_b128 v[132:135], v1 offset:10240
    v_mfma_f32_16x16x32_bf16 v[24:27], v[88:91], v[160:163], 0
    ds_read_b128 v[136:139], v1 offset:11264
    buffer_load_dwordx2 v[4:5], v0, s[4:7], s30 offen offset:0 sc1
    v_mfma_f32_16x16x32_bf16 v[52:55], v[88:91], v[164:167], 0
    ds_read_b128 v[140:143], v1 offset:12288
    buffer_load_dwordx2 v[6:7], v0, s[4:7], s30 offen offset:512 sc1
    v_mfma_f32_16x16x32_bf16 v[28:31], v[92:95], v[160:163], 0
    ds_read_b128 v[144:147], v1 offset:13312
    buffer_load_dwordx2 v[8:9], v0, s[4:7], s32 offen offset:0 sc1
    v_mfma_f32_16x16x32_bf16 v[56:59], v[92:95], v[164:167], 0
    s_waitcnt lgkmcnt(7)
    buffer_load_dwordx2 v[10:11], v0, s[4:7], s32 offen offset:512 sc1
    v_mfma_f32_16x16x32_bf16 v[32:35], v[160:163], v[96:99], 0
    buffer_load_dwordx2 v[12:13], v0, s[4:7], s32 offen offset:1024 sc1
    v_mfma_f32_16x16x32_bf16 v[60:63], v[164:167], v[96:99], 0
    buffer_load_dwordx2 v[14:15], v0, s[4:7], s32 offen offset:1536 sc1
    v_mfma_f32_16x16x32_bf16 v[36:39], v[160:163], v[100:103], 0
    buffer_load_dwordx4 v[192:195], v1, s[4:7], s39 offen offset:0 sc1
    v_mfma_f32_16x16x32_bf16 v[64:67], v[164:167], v[100:103], 0
    buffer_load_dwordx4 v[196:199], v253, s[4:7], s39 offen offset:0 sc1
    v_mfma_f32_16x16x32_bf16 v[40:43], v[104:107], v[160:163], 0
    buffer_load_dwordx4 v[200:203], v1, s[4:7], s39 offen offset:1024 sc1
    v_mfma_f32_16x16x32_bf16 v[68:71], v[104:107], v[164:167], 0
    buffer_load_dwordx4 v[204:207], v253, s[4:7], s39 offen offset:1024 sc1
    s_waitcnt vmcnt(14) lgkmcnt(3)
    s_barrier
    v_mfma_f32_16x16x32_bf16 v[16:19], v[120:123], v[168:171], v[16:19]
    ds_read_b128 v[80:83], v1 offset:14336
    v_mfma_f32_16x16x32_bf16 v[44:47], v[120:123], v[172:175], v[44:47]
    ds_read_b128 v[84:87], v1 offset:15360
    v_mfma_f32_16x16x32_bf16 v[20:23], v[124:127], v[168:171], v[20:23]
    ds_read_b128 v[88:91], v1 offset:16384
    v_mfma_f32_16x16x32_bf16 v[48:51], v[124:127], v[172:175], v[48:51]
    ds_read_b128 v[92:95], v1 offset:17408
    v_mfma_f32_16x16x32_bf16 v[24:27], v[128:131], v[168:171], v[24:27]
    ds_read_b128 v[96:99], v1 offset:18432
    v_mfma_f32_16x16x32_bf16 v[52:55], v[128:131], v[172:175], v[52:55]
    ds_read_b128 v[100:103], v1 offset:19456
    v_mfma_f32_16x16x32_bf16 v[28:31], v[132:135], v[168:171], v[28:31]
    ds_read_b128 v[104:107], v1 offset:20480
    v_mfma_f32_16x16x32_bf16 v[56:59], v[132:135], v[172:175], v[56:59]
    ds_read_b128 v[108:111], v248 offset:0
    s_waitcnt lgkmcnt(8)
    v_mfma_f32_16x16x32_bf16 v[32:35], v[168:171], v[136:139], v[32:35]
    ds_read_b128 v[112:115], v249 offset:0
    v_mfma_f32_16x16x32_bf16 v[60:63], v[172:175], v[136:139], v[60:63]
    ds_read_b128 v[116:119], v251 offset:0
    v_mfma_f32_16x16x32_bf16 v[36:39], v[168:171], v[140:143], v[36:39]
    buffer_load_dwordx4 v[160:163], v1, s[4:7], s39 offen offset:2048 sc1
    v_mfma_f32_16x16x32_bf16 v[64:67], v[172:175], v[140:143], v[64:67]
    buffer_load_dwordx4 v[164:167], v253, s[4:7], s39 offen offset:2048 sc1
    v_mfma_f32_16x16x32_bf16 v[40:43], v[144:147], v[168:171], v[40:43]
    v_mfma_f32_16x16x32_bf16 v[68:71], v[144:147], v[172:175], v[68:71]
    s_waitcnt vmcnt(14) lgkmcnt(6)
    v_mfma_f32_16x16x32_bf16 v[16:19], v[80:83], v[176:179], v[16:19]
    ds_read_b128 v[120:123], v1 offset:21504
    v_mfma_f32_16x16x32_bf16 v[44:47], v[80:83], v[180:183], v[44:47]
    ds_read_b128 v[124:127], v1 offset:22528
    v_mfma_f32_16x16x32_bf16 v[20:23], v[84:87], v[176:179], v[20:23]
    ds_read_b128 v[128:131], v1 offset:23552
    v_mfma_f32_16x16x32_bf16 v[48:51], v[84:87], v[180:183], v[48:51]
    ds_read_b128 v[132:135], v1 offset:24576
    v_mfma_f32_16x16x32_bf16 v[24:27], v[88:91], v[176:179], v[24:27]
    ds_read_b128 v[136:139], v1 offset:25600
    v_mfma_f32_16x16x32_bf16 v[52:55], v[88:91], v[180:183], v[52:55]
    ds_read_b128 v[140:143], v1 offset:26624
    v_mfma_f32_16x16x32_bf16 v[28:31], v[92:95], v[176:179], v[28:31]
    ds_read_b128 v[144:147], v1 offset:27648
    v_mfma_f32_16x16x32_bf16 v[56:59], v[92:95], v[180:183], v[56:59]
    ds_read_b128 v[148:151], v248 offset:1024
    s_waitcnt lgkmcnt(8)
    v_mfma_f32_16x16x32_bf16 v[32:35], v[176:179], v[96:99], v[32:35]
    ds_read_b128 v[152:155], v249 offset:7168
    v_mfma_f32_16x16x32_bf16 v[60:63], v[180:183], v[96:99], v[60:63]
    ds_read_b128 v[156:159], v251 offset:7168
    v_mfma_f32_16x16x32_bf16 v[36:39], v[176:179], v[100:103], v[36:39]
    buffer_load_dwordx4 v[168:171], v1, s[4:7], s39 offen offset:3072 sc1
    v_mfma_f32_16x16x32_bf16 v[64:67], v[180:183], v[100:103], v[64:67]
    buffer_load_dwordx4 v[172:175], v253, s[4:7], s39 offen offset:3072 sc1
    v_mfma_f32_16x16x32_bf16 v[40:43], v[104:107], v[176:179], v[40:43]
    v_mfma_f32_16x16x32_bf16 v[68:71], v[104:107], v[180:183], v[68:71]
    v_mfma_f32_16x16x32_bf16 v[72:75], v[112:115], v[108:111], 0
    v_mfma_f32_16x16x32_bf16 v[76:79], v[108:111], v[116:119], 0
    s_waitcnt vmcnt(8) lgkmcnt(6)
    s_barrier
    v_mfma_f32_16x16x32_bf16 v[16:19], v[120:123], v[184:187], v[16:19]
    ds_read_b128 v[80:83], v1 offset:28672
    v_mfma_f32_16x16x32_bf16 v[44:47], v[120:123], v[188:191], v[44:47]
    ds_read_b128 v[84:87], v1 offset:29696
    v_add_f32 v240, v4, v6
    v_mfma_f32_16x16x32_bf16 v[20:23], v[124:127], v[184:187], v[20:23]
    ds_read_b128 v[88:91], v1 offset:30720
    v_add_f32_e64 v241, v5, v7
    v_mfma_f32_16x16x32_bf16 v[48:51], v[124:127], v[188:191], v[48:51]
    ds_read_b128 v[92:95], v1 offset:31744
    v_add_f32_e64 v242, v8, v10
    v_mfma_f32_16x16x32_bf16 v[24:27], v[128:131], v[184:187], v[24:27]
    ds_read_b128 v[96:99], v1 offset:32768
    v_add_f32_e64 v243, v9, v11
    v_mfma_f32_16x16x32_bf16 v[52:55], v[128:131], v[188:191], v[52:55]
    ds_read_b128 v[100:103], v1 offset:33792
    v_add_f32_e64 v244, v12, v14
    v_mfma_f32_16x16x32_bf16 v[28:31], v[132:135], v[184:187], v[28:31]
    ds_read_b128 v[104:107], v1 offset:34816
    v_add_f32_e64 v245, v13, v15
    v_mfma_f32_16x16x32_bf16 v[56:59], v[132:135], v[188:191], v[56:59]
    ds_read_b128 v[108:111], v248 offset:2048
    s_waitcnt lgkmcnt(8)
    v_mfma_f32_16x16x32_bf16 v[32:35], v[184:187], v[136:139], v[32:35]
    ds_read_b128 v[112:115], v249 offset:14336
    v_mov_b32 v4, v240
    v_mfma_f32_16x16x32_bf16 v[60:63], v[188:191], v[136:139], v[60:63]
    ds_read_b128 v[116:119], v251 offset:14336
    v_mov_b32_e64 v5, v241
    v_mfma_f32_16x16x32_bf16 v[36:39], v[184:187], v[140:143], v[36:39]
    buffer_load_dwordx4 v[176:179], v1, s[4:7], s40 offen offset:0 sc1
    v_mov_b32_e64 v8, v242
    v_mfma_f32_16x16x32_bf16 v[64:67], v[188:191], v[140:143], v[64:67]
    buffer_load_dwordx4 v[180:183], v253, s[4:7], s40 offen offset:0 sc1
    v_mov_b32_e64 v9, v243
    v_mfma_f32_16x16x32_bf16 v[40:43], v[144:147], v[184:187], v[40:43]
    v_mov_b32 v12, v244
    v_mov_b32 v13, v245
    v_mfma_f32_16x16x32_bf16 v[68:71], v[144:147], v[188:191], v[68:71]
    v_permlane32_swap_b32 v240, v4
    v_permlane32_swap_b32 v241, v5
    v_mfma_f32_16x16x32_bf16 v[72:75], v[152:155], v[148:151], v[72:75]
    v_permlane32_swap_b32 v242, v8
    v_mfma_f32_16x16x32_bf16 v[76:79], v[148:151], v[156:159], v[76:79]
    v_permlane32_swap_b32 v243, v9
    s_waitcnt vmcnt(8) lgkmcnt(6)
    v_mfma_f32_16x16x32_bf16 v[16:19], v[80:83], v[192:195], v[16:19]
    ds_read_b128 v[120:123], v1 offset:35840
    v_mfma_f32_16x16x32_bf16 v[44:47], v[80:83], v[196:199], v[44:47]
    ds_read_b128 v[124:127], v1 offset:36864
    v_permlane32_swap_b32 v244, v12
    v_mfma_f32_16x16x32_bf16 v[20:23], v[84:87], v[192:195], v[20:23]
    ds_read_b128 v[128:131], v1 offset:37888
    v_permlane32_swap_b32 v245, v13
    v_mfma_f32_16x16x32_bf16 v[48:51], v[84:87], v[196:199], v[48:51]
    ds_read_b128 v[132:135], v1 offset:38912
    v_add_f32 v240, v240, v4
    v_mfma_f32_16x16x32_bf16 v[24:27], v[88:91], v[192:195], v[24:27]
    ds_read_b128 v[136:139], v1 offset:39936
    v_add_f32_e64 v241, v241, v5
    v_mfma_f32_16x16x32_bf16 v[52:55], v[88:91], v[196:199], v[52:55]
    ds_read_b128 v[140:143], v1 offset:40960
    v_add_f32_e64 v242, v242, v8
    v_mfma_f32_16x16x32_bf16 v[28:31], v[92:95], v[192:195], v[28:31]
    ds_read_b128 v[144:147], v1 offset:41984
    v_add_f32_e64 v243, v243, v9
    v_mfma_f32_16x16x32_bf16 v[56:59], v[92:95], v[196:199], v[56:59]
    ds_read_b128 v[148:151], v248 offset:3072
    s_waitcnt lgkmcnt(8)
    v_mfma_f32_16x16x32_bf16 v[32:35], v[192:195], v[96:99], v[32:35]
    ds_read_b128 v[152:155], v249 offset:21504
    v_add_f32 v244, v244, v12
    v_mfma_f32_16x16x32_bf16 v[60:63], v[196:199], v[96:99], v[60:63]
    ds_read_b128 v[156:159], v251 offset:21504
    v_add_f32_e64 v245, v245, v13
    v_mfma_f32_16x16x32_bf16 v[36:39], v[192:195], v[100:103], v[36:39]
    buffer_load_dwordx4 v[184:187], v1, s[4:7], s40 offen offset:1024 sc1
    v_mov_b32_e64 v4, v240
    v_mfma_f32_16x16x32_bf16 v[64:67], v[196:199], v[100:103], v[64:67]
    buffer_load_dwordx4 v[188:191], v253, s[4:7], s40 offen offset:1024 sc1
    v_mov_b32_e64 v5, v241
    v_mfma_f32_16x16x32_bf16 v[40:43], v[104:107], v[192:195], v[40:43]
    v_mov_b32 v8, v242
    v_mov_b32 v9, v243
    v_mfma_f32_16x16x32_bf16 v[68:71], v[104:107], v[196:199], v[68:71]
    v_mov_b32 v12, v244
    v_mov_b32 v13, v245
    v_mfma_f32_16x16x32_bf16 v[72:75], v[112:115], v[108:111], v[72:75]
    v_permlane16_swap_b32 v240, v4
    v_mfma_f32_16x16x32_bf16 v[76:79], v[108:111], v[116:119], v[76:79]
    v_permlane16_swap_b32 v241, v5
    s_waitcnt vmcnt(8) lgkmcnt(6)
    s_barrier
    v_mfma_f32_16x16x32_bf16 v[16:19], v[120:123], v[200:203], v[16:19]
    ds_read_b128 v[80:83], v1 offset:43008
    v_mfma_f32_16x16x32_bf16 v[44:47], v[120:123], v[204:207], v[44:47]
    ds_read_b128 v[84:87], v1 offset:44032
    v_permlane16_swap_b32 v242, v8
    v_mfma_f32_16x16x32_bf16 v[20:23], v[124:127], v[200:203], v[20:23]
    ds_read_b128 v[88:91], v1 offset:45056
    v_permlane16_swap_b32 v243, v9
    v_mfma_f32_16x16x32_bf16 v[48:51], v[124:127], v[204:207], v[48:51]
    ds_read_b128 v[92:95], v1 offset:46080
    v_permlane16_swap_b32 v244, v12
    v_mfma_f32_16x16x32_bf16 v[24:27], v[128:131], v[200:203], v[24:27]
    ds_read_b128 v[96:99], v1 offset:47104
    v_permlane16_swap_b32 v245, v13
    v_mfma_f32_16x16x32_bf16 v[52:55], v[128:131], v[204:207], v[52:55]
    ds_read_b128 v[100:103], v1 offset:48128
    v_add_f32_e64 v240, v240, v4
    v_mfma_f32_16x16x32_bf16 v[28:31], v[132:135], v[200:203], v[28:31]
    ds_read_b128 v[104:107], v1 offset:49152
    v_add_f32_e64 v241, v241, v5
    v_mfma_f32_16x16x32_bf16 v[56:59], v[132:135], v[204:207], v[56:59]
    ds_read_b128 v[108:111], v248 offset:4096
    s_waitcnt lgkmcnt(8)
    v_mfma_f32_16x16x32_bf16 v[32:35], v[200:203], v[136:139], v[32:35]
    ds_read_b128 v[112:115], v249 offset:28672
    v_add_f32 v242, v242, v8
    v_mfma_f32_16x16x32_bf16 v[60:63], v[204:207], v[136:139], v[60:63]
    ds_read_b128 v[116:119], v251 offset:28672
    v_add_f32_e64 v243, v243, v9
    v_mfma_f32_16x16x32_bf16 v[36:39], v[200:203], v[140:143], v[36:39]
    buffer_load_dwordx4 v[192:195], v1, s[4:7], s40 offen offset:2048 sc1
    v_add_f32_e64 v244, v244, v12
    v_mfma_f32_16x16x32_bf16 v[64:67], v[204:207], v[140:143], v[64:67]
    buffer_load_dwordx4 v[196:199], v253, s[4:7], s40 offen offset:2048 sc1
    v_add_f32_e64 v245, v245, v13
    v_mfma_f32_16x16x32_bf16 v[40:43], v[144:147], v[200:203], v[40:43]
    v_mul_f32 v240, 0x3ae38e39, v240
    v_mul_f32 v241, 0x3ae38e39, v241
    v_mfma_f32_16x16x32_bf16 v[68:71], v[144:147], v[204:207], v[68:71]
    v_mul_f32 v242, 0x3ae38e39, v242
    v_mul_f32 v243, 0x3ae38e39, v243
    v_mfma_f32_16x16x32_bf16 v[72:75], v[152:155], v[148:151], v[72:75]
    v_mul_f32 v244, 0x3ae38e39, v244
    v_mfma_f32_16x16x32_bf16 v[76:79], v[148:151], v[156:159], v[76:79]
    v_mul_f32 v245, 0x3ae38e39, v245
    s_waitcnt vmcnt(8) lgkmcnt(6)
    v_mfma_f32_16x16x32_bf16 v[16:19], v[80:83], v[160:163], v[16:19]
    ds_read_b128 v[120:123], v1 offset:50176
    v_mfma_f32_16x16x32_bf16 v[44:47], v[80:83], v[164:167], v[44:47]
    ds_read_b128 v[124:127], v1 offset:51200
    v_fma_f32 v241, -v240, v240, v241
    v_mfma_f32_16x16x32_bf16 v[20:23], v[84:87], v[160:163], v[20:23]
    ds_read_b128 v[128:131], v1 offset:52224
    v_fma_f32 v243, -v242, v242, v243
    v_mfma_f32_16x16x32_bf16 v[48:51], v[84:87], v[164:167], v[48:51]
    ds_read_b128 v[132:135], v1 offset:53248
    v_fma_f32 v245, -v244, v244, v245
    v_mfma_f32_16x16x32_bf16 v[24:27], v[88:91], v[160:163], v[24:27]
    ds_read_b128 v[136:139], v1 offset:54272
    v_max_f32 v241, 0, v241
    v_mfma_f32_16x16x32_bf16 v[52:55], v[88:91], v[164:167], v[52:55]
    ds_read_b128 v[140:143], v1 offset:55296
    v_max_f32_e64 v243, 0, v243
    v_mfma_f32_16x16x32_bf16 v[28:31], v[92:95], v[160:163], v[28:31]
    ds_read_b128 v[144:147], v1 offset:56320
    v_max_f32_e64 v245, 0, v245
    v_mfma_f32_16x16x32_bf16 v[56:59], v[92:95], v[164:167], v[56:59]
    ds_read_b128 v[148:151], v248 offset:5120
    s_waitcnt lgkmcnt(8)
    v_mfma_f32_16x16x32_bf16 v[32:35], v[160:163], v[96:99], v[32:35]
    ds_read_b128 v[152:155], v249 offset:35840
    v_add_f32 v241, 0x3727c5ac, v241
    v_mfma_f32_16x16x32_bf16 v[60:63], v[164:167], v[96:99], v[60:63]
    ds_read_b128 v[156:159], v251 offset:35840
    v_add_f32 v243, 0x3727c5ac, v243
    v_mfma_f32_16x16x32_bf16 v[36:39], v[160:163], v[100:103], v[36:39]
    buffer_load_dwordx4 v[200:203], v1, s[4:7], s40 offen offset:3072 sc1
    v_add_f32 v245, 0x3727c5ac, v245
    v_mfma_f32_16x16x32_bf16 v[64:67], v[164:167], v[100:103], v[64:67]
    buffer_load_dwordx4 v[204:207], v253, s[4:7], s40 offen offset:3072 sc1
    v_rsq_f32 v241, v241
    v_mfma_f32_16x16x32_bf16 v[40:43], v[104:107], v[160:163], v[40:43]
    v_rsq_f32 v243, v243
    v_rsq_f32 v245, v245
    v_mfma_f32_16x16x32_bf16 v[68:71], v[104:107], v[164:167], v[68:71]
    s_nop 0
    v_lshlrev_b32 v255, 4, v3
    v_mfma_f32_16x16x32_bf16 v[72:75], v[112:115], v[108:111], v[72:75]
    v_add_u32 v236, 161792, v255
    v_mfma_f32_16x16x32_bf16 v[76:79], v[108:111], v[116:119], v[76:79]
    s_lshl_b32 s36, s33, 6
    s_waitcnt vmcnt(8) lgkmcnt(6)
    v_mfma_f32_16x16x32_bf16 v[16:19], v[120:123], v[168:171], v[16:19]
    ds_read_b128 v[80:83], v1 offset:57344
    v_mfma_f32_16x16x32_bf16 v[44:47], v[120:123], v[172:175], v[44:47]
    ds_read_b128 v[84:87], v1 offset:58368
    v_add_u32_e64 v237, s36, v236
    v_mfma_f32_16x16x32_bf16 v[20:23], v[124:127], v[168:171], v[20:23]
    ds_read_b128 v[88:91], v1 offset:59392
    v_lshlrev_b32_e64 v254, 2, v2
    v_mfma_f32_16x16x32_bf16 v[48:51], v[124:127], v[172:175], v[48:51]
    ds_read_b128 v[92:95], v1 offset:60416
    v_add_u32 v238, 161792, v254
    v_mfma_f32_16x16x32_bf16 v[24:27], v[128:131], v[168:171], v[24:27]
    ds_read_b128 v[96:99], v1 offset:61440
    s_lshl_b32 s37, s34, 6
    v_mfma_f32_16x16x32_bf16 v[52:55], v[128:131], v[172:175], v[52:55]
    ds_read_b128 v[100:103], v1 offset:62464
    v_add_u32 v239, s37, v238
    v_mfma_f32_16x16x32_bf16 v[28:31], v[132:135], v[168:171], v[28:31]
    ds_read_b128 v[104:107], v1 offset:63488
    s_mul_i32 s36, s20, 3072
    v_mfma_f32_16x16x32_bf16 v[56:59], v[132:135], v[172:175], v[56:59]
    ds_read_b128 v[108:111], v248 offset:6144
    s_waitcnt lgkmcnt(8)
    v_mfma_f32_16x16x32_bf16 v[32:35], v[168:171], v[136:139], v[32:35]
    ds_read_b128 v[112:115], v249 offset:43008
    s_add_u32 s36, s36, 153600
    v_mfma_f32_16x16x32_bf16 v[60:63], v[172:175], v[136:139], v[60:63]
    ds_read_b128 v[116:119], v251 offset:43008
    v_add_u32 v254, s36, v254
    v_mfma_f32_16x16x32_bf16 v[36:39], v[168:171], v[140:143], v[36:39]
    buffer_load_dwordx4 v[160:163], v1, s[4:7], s41 offen offset:0 sc1
    v_add_u32_e64 v255, s36, v255
    v_mfma_f32_16x16x32_bf16 v[64:67], v[172:175], v[140:143], v[64:67]
    buffer_load_dwordx4 v[164:167], v253, s[4:7], s41 offen offset:0 sc1
    v_mfma_f32_16x16x32_bf16 v[40:43], v[144:147], v[168:171], v[40:43]
    v_mfma_f32_16x16x32_bf16 v[68:71], v[144:147], v[172:175], v[68:71]
    ds_write2_b32 v254, v240, v241 offset0:0 offset1:16
    v_mfma_f32_16x16x32_bf16 v[72:75], v[152:155], v[148:151], v[72:75]
    ds_write2_b32 v254, v242, v243 offset0:32 offset1:48
    v_mfma_f32_16x16x32_bf16 v[76:79], v[148:151], v[156:159], v[76:79]
    ds_write2_b32 v254, v244, v245 offset0:64 offset1:80
    s_waitcnt vmcnt(8) lgkmcnt(9)
    s_barrier
    v_mfma_f32_16x16x32_bf16 v[16:19], v[80:83], v[176:179], v[16:19]
    ds_read_b128 v[120:123], v247 offset:0
    v_mfma_f32_16x16x32_bf16 v[44:47], v[80:83], v[180:183], v[44:47]
    ds_read_b128 v[124:127], v247 offset:1024
    v_mfma_f32_16x16x32_bf16 v[20:23], v[84:87], v[176:179], v[20:23]
    ds_read_b128 v[128:131], v247 offset:2048
    v_mfma_f32_16x16x32_bf16 v[48:51], v[84:87], v[180:183], v[48:51]
    ds_read_b128 v[132:135], v247 offset:3072
    v_mfma_f32_16x16x32_bf16 v[24:27], v[88:91], v[176:179], v[24:27]
    ds_read_b128 v[136:139], v247 offset:4096
    v_mfma_f32_16x16x32_bf16 v[52:55], v[88:91], v[180:183], v[52:55]
    ds_read_b128 v[140:143], v247 offset:5120
    v_mfma_f32_16x16x32_bf16 v[28:31], v[92:95], v[176:179], v[28:31]
    ds_read_b128 v[144:147], v247 offset:6144
    v_mfma_f32_16x16x32_bf16 v[56:59], v[92:95], v[180:183], v[56:59]
    ds_read_b128 v[148:151], v248 offset:7168
    s_waitcnt lgkmcnt(8)
    v_mfma_f32_16x16x32_bf16 v[32:35], v[176:179], v[96:99], v[32:35]
    ds_read_b128 v[152:155], v249 offset:50176
    v_mfma_f32_16x16x32_bf16 v[60:63], v[180:183], v[96:99], v[60:63]
    ds_read_b128 v[156:159], v251 offset:50176
    v_mfma_f32_16x16x32_bf16 v[36:39], v[176:179], v[100:103], v[36:39]
    buffer_load_dwordx4 v[168:171], v1, s[4:7], s41 offen offset:1024 sc1
    ds_read_b128 v[208:211], v236 offset:0
    v_mfma_f32_16x16x32_bf16 v[64:67], v[180:183], v[100:103], v[64:67]
    buffer_load_dwordx4 v[172:175], v253, s[4:7], s41 offen offset:1024 sc1
    ds_read_b128 v[212:215], v236 offset:64
    v_mfma_f32_16x16x32_bf16 v[40:43], v[104:107], v[176:179], v[40:43]
    ds_read_b128 v[216:219], v236 offset:128
    v_mfma_f32_16x16x32_bf16 v[68:71], v[104:107], v[180:183], v[68:71]
    ds_read_b128 v[220:223], v236 offset:192
    v_mfma_f32_16x16x32_bf16 v[72:75], v[112:115], v[108:111], v[72:75]
    ds_read_b128 v[224:227], v236 offset:384
    v_mfma_f32_16x16x32_bf16 v[76:79], v[108:111], v[116:119], v[76:79]
    ds_read_b128 v[228:231], v237
    s_waitcnt vmcnt(8) lgkmcnt(12)
    v_mfma_f32_16x16x32_bf16 v[16:19], v[120:123], v[184:187], v[16:19]
    ds_read_b128 v[80:83], v247 offset:7168
    v_mfma_f32_16x16x32_bf16 v[44:47], v[120:123], v[188:191], v[44:47]
    ds_read_b128 v[84:87], v247 offset:8192
    v_mfma_f32_16x16x32_bf16 v[20:23], v[124:127], v[184:187], v[20:23]
    ds_read_b128 v[88:91], v247 offset:9216
    v_mfma_f32_16x16x32_bf16 v[48:51], v[124:127], v[188:191], v[48:51]
    ds_read_b128 v[92:95], v247 offset:10240
    v_mfma_f32_16x16x32_bf16 v[24:27], v[128:131], v[184:187], v[24:27]
    ds_read_b128 v[96:99], v247 offset:11264
    v_mfma_f32_16x16x32_bf16 v[52:55], v[128:131], v[188:191], v[52:55]
    ds_read_b128 v[100:103], v247 offset:12288
    v_mfma_f32_16x16x32_bf16 v[28:31], v[132:135], v[184:187], v[28:31]
    ds_read_b128 v[104:107], v247 offset:13312
    v_mfma_f32_16x16x32_bf16 v[56:59], v[132:135], v[188:191], v[56:59]
    ds_read_b128 v[108:111], v248 offset:8192
    s_waitcnt lgkmcnt(8)
    v_mfma_f32_16x16x32_bf16 v[32:35], v[184:187], v[136:139], v[32:35]
    ds_read_b128 v[112:115], v249 offset:57344
    v_mfma_f32_16x16x32_bf16 v[60:63], v[188:191], v[136:139], v[60:63]
    ds_read_b128 v[116:119], v251 offset:57344
    v_mfma_f32_16x16x32_bf16 v[36:39], v[184:187], v[140:143], v[36:39]
    buffer_load_dwordx4 v[176:179], v1, s[4:7], s41 offen offset:2048 sc1
    v_mfma_f32_16x16x32_bf16 v[64:67], v[188:191], v[140:143], v[64:67]
    buffer_load_dwordx4 v[180:183], v253, s[4:7], s41 offen offset:2048 sc1
    ds_read2_b32 v[232:233], v238 offset0:64 offset1:80
    v_mfma_f32_16x16x32_bf16 v[40:43], v[144:147], v[184:187], v[40:43]
    ds_read_b32 v234, v239
    v_mfma_f32_16x16x32_bf16 v[68:71], v[144:147], v[188:191], v[68:71]
    ds_read_b128 v[4:7], v255 offset:0
    v_mfma_f32_16x16x32_bf16 v[72:75], v[152:155], v[148:151], v[72:75]
    ds_read_b128 v[8:11], v255 offset:128
    v_mfma_f32_16x16x32_bf16 v[76:79], v[148:151], v[156:159], v[76:79]
    ds_read_b128 v[12:15], v255 offset:256
    s_waitcnt vmcnt(8) lgkmcnt(11)
    s_barrier
    v_mfma_f32_16x16x32_bf16 v[16:19], v[80:83], v[192:195], v[16:19]
    ds_read_b128 v[120:123], v247 offset:14336
    v_mfma_f32_16x16x32_bf16 v[44:47], v[80:83], v[196:199], v[44:47]
    ds_read_b128 v[124:127], v247 offset:15360
    v_mfma_f32_16x16x32_bf16 v[20:23], v[84:87], v[192:195], v[20:23]
    ds_read_b128 v[128:131], v247 offset:16384
    v_mfma_f32_16x16x32_bf16 v[48:51], v[84:87], v[196:199], v[48:51]
    ds_read_b128 v[132:135], v247 offset:17408
    v_mfma_f32_16x16x32_bf16 v[24:27], v[88:91], v[192:195], v[24:27]
    ds_read_b128 v[136:139], v247 offset:18432
    v_mfma_f32_16x16x32_bf16 v[52:55], v[88:91], v[196:199], v[52:55]
    ds_read_b128 v[140:143], v247 offset:19456
    v_mfma_f32_16x16x32_bf16 v[28:31], v[92:95], v[192:195], v[28:31]
    ds_read_b128 v[144:147], v247 offset:20480
    v_mfma_f32_16x16x32_bf16 v[56:59], v[92:95], v[196:199], v[56:59]
    ds_read_b128 v[148:151], v248 offset:9216
    s_waitcnt lgkmcnt(8)
    v_mfma_f32_16x16x32_bf16 v[32:35], v[192:195], v[96:99], v[32:35]
    ds_read_b128 v[152:155], v250 offset:0
    v_mfma_f32_16x16x32_bf16 v[60:63], v[196:199], v[96:99], v[60:63]
    ds_read_b128 v[156:159], v252 offset:0
    v_mfma_f32_16x16x32_bf16 v[36:39], v[192:195], v[100:103], v[36:39]
    buffer_load_dwordx4 v[184:187], v1, s[4:7], s41 offen offset:3072 sc1
    v_mfma_f32_16x16x32_bf16 v[64:67], v[196:199], v[100:103], v[64:67]
    buffer_load_dwordx4 v[188:191], v253, s[4:7], s41 offen offset:3072 sc1
    v_mfma_f32_16x16x32_bf16 v[40:43], v[104:107], v[192:195], v[40:43]
    v_mfma_f32_16x16x32_bf16 v[68:71], v[104:107], v[196:199], v[68:71]
    v_mfma_f32_16x16x32_bf16 v[72:75], v[112:115], v[108:111], v[72:75]
    v_mfma_f32_16x16x32_bf16 v[76:79], v[108:111], v[116:119], v[76:79]
    s_waitcnt vmcnt(8) lgkmcnt(6)
    v_mfma_f32_16x16x32_bf16 v[16:19], v[120:123], v[200:203], v[16:19]
    ds_read_b128 v[80:83], v247 offset:21504
    v_fma_f32 v32, -v8, v232, v32
    v_mfma_f32_16x16x32_bf16 v[44:47], v[120:123], v[204:207], v[44:47]
    ds_read_b128 v[84:87], v247 offset:22528
    v_fma_f32 v60, -v12, v232, v60
    v_mfma_f32_16x16x32_bf16 v[20:23], v[124:127], v[200:203], v[20:23]
    ds_read_b128 v[88:91], v247 offset:23552
    v_fma_f32 v36, -v8, v233, v36
    v_mfma_f32_16x16x32_bf16 v[48:51], v[124:127], v[204:207], v[48:51]
    ds_read_b128 v[92:95], v247 offset:24576
    v_fma_f32 v64, -v12, v233, v64
    v_mfma_f32_16x16x32_bf16 v[24:27], v[128:131], v[200:203], v[24:27]
    ds_read_b128 v[96:99], v247 offset:25600
    v_fma_f32 v40, -v242, v224, v40
    v_mfma_f32_16x16x32_bf16 v[52:55], v[128:131], v[204:207], v[52:55]
    ds_read_b128 v[100:103], v247 offset:26624
    v_fma_f32 v68, -v244, v224, v68
    v_mfma_f32_16x16x32_bf16 v[28:31], v[132:135], v[200:203], v[28:31]
    ds_read_b128 v[104:107], v247 offset:27648
    v_fma_f32 v72, -v240, v228, v72
    v_mfma_f32_16x16x32_bf16 v[56:59], v[132:135], v[204:207], v[56:59]
    ds_read_b128 v[108:111], v248 offset:10240
    s_waitcnt lgkmcnt(8)
    v_fma_f32 v76, -v4, v234, v76
    v_mfma_f32_16x16x32_bf16 v[32:35], v[200:203], v[136:139], v[32:35]
    ds_read_b128 v[112:115], v250 offset:7168
    v_fma_f32 v16, -v242, v208, v16
    v_mfma_f32_16x16x32_bf16 v[60:63], v[204:207], v[136:139], v[60:63]
    ds_read_b128 v[116:119], v252 offset:7168
    v_fma_f32 v44, -v244, v208, v44
    v_mfma_f32_16x16x32_bf16 v[36:39], v[200:203], v[140:143], v[36:39]
    buffer_load_dwordx4 v[192:195], v1, s[4:7], s42 offen offset:0 sc1
    v_fma_f32 v20, -v242, v212, v20
    v_mfma_f32_16x16x32_bf16 v[64:67], v[204:207], v[140:143], v[64:67]
    buffer_load_dwordx4 v[196:199], v253, s[4:7], s42 offen offset:0 sc1
    v_fma_f32 v48, -v244, v212, v48
    v_mfma_f32_16x16x32_bf16 v[40:43], v[144:147], v[200:203], v[40:43]
    v_fma_f32 v24, -v242, v216, v24
    v_mfma_f32_16x16x32_bf16 v[68:71], v[144:147], v[204:207], v[68:71]
    v_fma_f32 v52, -v244, v216, v52
    v_mfma_f32_16x16x32_bf16 v[72:75], v[152:155], v[148:151], v[72:75]
    v_fma_f32 v28, -v242, v220, v28
    v_mfma_f32_16x16x32_bf16 v[76:79], v[148:151], v[156:159], v[76:79]
    v_fma_f32 v56, -v244, v220, v56
    s_waitcnt vmcnt(8) lgkmcnt(6)
    s_barrier
    v_mfma_f32_16x16x32_bf16 v[16:19], v[80:83], v[160:163], v[16:19]
    ds_read_b128 v[120:123], v247 offset:28672
    v_fma_f32 v33, -v9, v232, v33
    v_mfma_f32_16x16x32_bf16 v[44:47], v[80:83], v[164:167], v[44:47]
    ds_read_b128 v[124:127], v247 offset:29696
    v_fma_f32 v61, -v13, v232, v61
    v_mfma_f32_16x16x32_bf16 v[20:23], v[84:87], v[160:163], v[20:23]
    ds_read_b128 v[128:131], v247 offset:30720
    v_fma_f32 v37, -v9, v233, v37
    v_mfma_f32_16x16x32_bf16 v[48:51], v[84:87], v[164:167], v[48:51]
    ds_read_b128 v[132:135], v247 offset:31744
    v_fma_f32 v65, -v13, v233, v65
    v_mfma_f32_16x16x32_bf16 v[24:27], v[88:91], v[160:163], v[24:27]
    ds_read_b128 v[136:139], v247 offset:32768
    v_fma_f32 v41, -v242, v225, v41
    v_mfma_f32_16x16x32_bf16 v[52:55], v[88:91], v[164:167], v[52:55]
    ds_read_b128 v[140:143], v247 offset:33792
    v_fma_f32 v69, -v244, v225, v69
    v_mfma_f32_16x16x32_bf16 v[28:31], v[92:95], v[160:163], v[28:31]
    ds_read_b128 v[144:147], v247 offset:34816
    v_fma_f32 v73, -v240, v229, v73
    v_mfma_f32_16x16x32_bf16 v[56:59], v[92:95], v[164:167], v[56:59]
    ds_read_b128 v[148:151], v248 offset:11264
    s_waitcnt lgkmcnt(8)
    v_fma_f32 v77, -v5, v234, v77
    v_mfma_f32_16x16x32_bf16 v[32:35], v[160:163], v[96:99], v[32:35]
    ds_read_b128 v[152:155], v250 offset:14336
    v_fma_f32 v17, -v242, v209, v17
    v_mfma_f32_16x16x32_bf16 v[60:63], v[164:167], v[96:99], v[60:63]
    ds_read_b128 v[156:159], v252 offset:14336
    v_fma_f32 v45, -v244, v209, v45
    v_mfma_f32_16x16x32_bf16 v[36:39], v[160:163], v[100:103], v[36:39]
    buffer_load_dwordx4 v[200:203], v1, s[4:7], s42 offen offset:1024 sc1
    v_fma_f32 v21, -v242, v213, v21
    v_mfma_f32_16x16x32_bf16 v[64:67], v[164:167], v[100:103], v[64:67]
    buffer_load_dwordx4 v[204:207], v253, s[4:7], s42 offen offset:1024 sc1
    v_fma_f32 v49, -v244, v213, v49
    v_mfma_f32_16x16x32_bf16 v[40:43], v[104:107], v[160:163], v[40:43]
    v_fma_f32 v25, -v242, v217, v25
    v_mfma_f32_16x16x32_bf16 v[68:71], v[104:107], v[164:167], v[68:71]
    v_fma_f32 v53, -v244, v217, v53
    v_mfma_f32_16x16x32_bf16 v[72:75], v[112:115], v[108:111], v[72:75]
    v_fma_f32 v29, -v242, v221, v29
    v_mfma_f32_16x16x32_bf16 v[76:79], v[108:111], v[116:119], v[76:79]
    v_fma_f32 v57, -v244, v221, v57
    s_waitcnt vmcnt(8) lgkmcnt(6)
    v_mfma_f32_16x16x32_bf16 v[16:19], v[120:123], v[168:171], v[16:19]
    ds_read_b128 v[80:83], v247 offset:35840
    v_fma_f32 v34, -v10, v232, v34
    v_mfma_f32_16x16x32_bf16 v[44:47], v[120:123], v[172:175], v[44:47]
    ds_read_b128 v[84:87], v247 offset:36864
    v_fma_f32 v62, -v14, v232, v62
    v_mfma_f32_16x16x32_bf16 v[20:23], v[124:127], v[168:171], v[20:23]
    ds_read_b128 v[88:91], v247 offset:37888
    v_fma_f32 v38, -v10, v233, v38
    v_mfma_f32_16x16x32_bf16 v[48:51], v[124:127], v[172:175], v[48:51]
    ds_read_b128 v[92:95], v247 offset:38912
    v_fma_f32 v66, -v14, v233, v66
    v_mfma_f32_16x16x32_bf16 v[24:27], v[128:131], v[168:171], v[24:27]
    ds_read_b128 v[96:99], v247 offset:39936
    v_fma_f32 v42, -v242, v226, v42
    v_mfma_f32_16x16x32_bf16 v[52:55], v[128:131], v[172:175], v[52:55]
    ds_read_b128 v[100:103], v247 offset:40960
    v_fma_f32 v70, -v244, v226, v70
    v_mfma_f32_16x16x32_bf16 v[28:31], v[132:135], v[168:171], v[28:31]
    ds_read_b128 v[104:107], v247 offset:41984
    v_fma_f32 v74, -v240, v230, v74
    v_mfma_f32_16x16x32_bf16 v[56:59], v[132:135], v[172:175], v[56:59]
    ds_read_b128 v[108:111], v248 offset:12288
    s_waitcnt lgkmcnt(8)
    v_fma_f32 v78, -v6, v234, v78
    v_mfma_f32_16x16x32_bf16 v[32:35], v[168:171], v[136:139], v[32:35]
    ds_read_b128 v[112:115], v250 offset:21504
    v_fma_f32 v18, -v242, v210, v18
    v_mfma_f32_16x16x32_bf16 v[60:63], v[172:175], v[136:139], v[60:63]
    ds_read_b128 v[116:119], v252 offset:21504
    v_fma_f32 v46, -v244, v210, v46
    v_mfma_f32_16x16x32_bf16 v[36:39], v[168:171], v[140:143], v[36:39]
    v_fma_f32 v22, -v242, v214, v22
    v_mfma_f32_16x16x32_bf16 v[64:67], v[172:175], v[140:143], v[64:67]
    v_fma_f32 v50, -v244, v214, v50
    v_mfma_f32_16x16x32_bf16 v[40:43], v[144:147], v[168:171], v[40:43]
    v_fma_f32 v26, -v242, v218, v26
    v_mfma_f32_16x16x32_bf16 v[68:71], v[144:147], v[172:175], v[68:71]
    v_fma_f32 v54, -v244, v218, v54
    v_mfma_f32_16x16x32_bf16 v[72:75], v[152:155], v[148:151], v[72:75]
    v_fma_f32 v30, -v242, v222, v30
    v_mfma_f32_16x16x32_bf16 v[76:79], v[148:151], v[156:159], v[76:79]
    v_fma_f32 v58, -v244, v222, v58
    s_waitcnt vmcnt(6) lgkmcnt(6)
    v_mfma_f32_16x16x32_bf16 v[16:19], v[80:83], v[176:179], v[16:19]
    ds_read_b128 v[120:123], v247 offset:43008
    v_fma_f32 v35, -v11, v232, v35
    v_mfma_f32_16x16x32_bf16 v[44:47], v[80:83], v[180:183], v[44:47]
    ds_read_b128 v[124:127], v247 offset:44032
    v_fma_f32 v63, -v15, v232, v63
    v_mfma_f32_16x16x32_bf16 v[20:23], v[84:87], v[176:179], v[20:23]
    ds_read_b128 v[128:131], v247 offset:45056
    v_fma_f32 v39, -v11, v233, v39
    v_mfma_f32_16x16x32_bf16 v[48:51], v[84:87], v[180:183], v[48:51]
    ds_read_b128 v[132:135], v247 offset:46080
    v_fma_f32 v67, -v15, v233, v67
    v_mfma_f32_16x16x32_bf16 v[24:27], v[88:91], v[176:179], v[24:27]
    ds_read_b128 v[136:139], v247 offset:47104
    v_fma_f32 v43, -v242, v227, v43
    v_mfma_f32_16x16x32_bf16 v[52:55], v[88:91], v[180:183], v[52:55]
    ds_read_b128 v[140:143], v247 offset:48128
    v_fma_f32 v71, -v244, v227, v71
    v_mfma_f32_16x16x32_bf16 v[28:31], v[92:95], v[176:179], v[28:31]
    ds_read_b128 v[144:147], v247 offset:49152
    v_fma_f32 v75, -v240, v231, v75
    v_mfma_f32_16x16x32_bf16 v[56:59], v[92:95], v[180:183], v[56:59]
    ds_read_b128 v[148:151], v248 offset:13312
    s_waitcnt lgkmcnt(8)
    v_fma_f32 v79, -v7, v234, v79
    v_mfma_f32_16x16x32_bf16 v[32:35], v[176:179], v[96:99], v[32:35]
    ds_read_b128 v[152:155], v250 offset:28672
    v_fma_f32 v19, -v242, v211, v19
    v_mfma_f32_16x16x32_bf16 v[60:63], v[180:183], v[96:99], v[60:63]
    ds_read_b128 v[156:159], v252 offset:28672
    v_fma_f32 v47, -v244, v211, v47
    v_mfma_f32_16x16x32_bf16 v[36:39], v[176:179], v[100:103], v[36:39]
    v_fma_f32 v23, -v242, v215, v23
    v_mfma_f32_16x16x32_bf16 v[64:67], v[180:183], v[100:103], v[64:67]
    v_fma_f32 v51, -v244, v215, v51
    v_mfma_f32_16x16x32_bf16 v[40:43], v[104:107], v[176:179], v[40:43]
    v_fma_f32 v27, -v242, v219, v27
    v_mfma_f32_16x16x32_bf16 v[68:71], v[104:107], v[180:183], v[68:71]
    v_fma_f32 v55, -v244, v219, v55
    v_mfma_f32_16x16x32_bf16 v[72:75], v[112:115], v[108:111], v[72:75]
    v_fma_f32 v31, -v242, v223, v31
    v_mfma_f32_16x16x32_bf16 v[76:79], v[108:111], v[116:119], v[76:79]
    v_fma_f32 v59, -v244, v223, v59
    s_waitcnt vmcnt(4) lgkmcnt(6)
    s_barrier
    v_mfma_f32_16x16x32_bf16 v[16:19], v[120:123], v[184:187], v[16:19]
    ds_read_b128 v[80:83], v247 offset:50176
    v_mfma_f32_16x16x32_bf16 v[44:47], v[120:123], v[188:191], v[44:47]
    ds_read_b128 v[84:87], v247 offset:51200
    v_and_b32 v4, 1, v2
    v_mfma_f32_16x16x32_bf16 v[20:23], v[124:127], v[184:187], v[20:23]
    ds_read_b128 v[88:91], v247 offset:52224
    v_lshl_add_u32 v5, v3, 2, v4
    v_mfma_f32_16x16x32_bf16 v[48:51], v[124:127], v[188:191], v[48:51]
    ds_read_b128 v[92:95], v247 offset:53248
    v_add_u32_e64 v6, 2, v5
    v_mfma_f32_16x16x32_bf16 v[24:27], v[128:131], v[184:187], v[24:27]
    ds_read_b128 v[96:99], v247 offset:54272
    v_cmp_eq_u32 s[40:41], 1, v4
    v_mfma_f32_16x16x32_bf16 v[52:55], v[128:131], v[188:191], v[52:55]
    ds_read_b128 v[100:103], v247 offset:55296
    v_cmp_le_u32 s[42:43], v5, v2
    v_mfma_f32_16x16x32_bf16 v[28:31], v[132:135], v[184:187], v[28:31]
    ds_read_b128 v[104:107], v247 offset:56320
    v_cmp_le_u32 s[44:45], v6, v2
    v_mfma_f32_16x16x32_bf16 v[56:59], v[132:135], v[188:191], v[56:59]
    ds_read_b128 v[108:111], v248 offset:14336
    s_waitcnt lgkmcnt(8)
    v_mfma_f32_16x16x32_bf16 v[32:35], v[184:187], v[136:139], v[32:35]
    ds_read_b128 v[112:115], v250 offset:35840
    v_mov_b32 v4, 0x0c0c0100
    v_mfma_f32_16x16x32_bf16 v[60:63], v[188:191], v[136:139], v[60:63]
    ds_read_b128 v[116:119], v252 offset:35840
    v_mov_b32 v5, 0x01000c0c
    v_mfma_f32_16x16x32_bf16 v[36:39], v[184:187], v[140:143], v[36:39]
    v_mov_b32 v6, 0x0c0c0302
    v_mov_b32 v7, 0x03020c0c
    v_mfma_f32_16x16x32_bf16 v[64:67], v[188:191], v[140:143], v[64:67]
    v_mov_b32 v8, 0x0c0c0c0c
    v_cndmask_b32 v4, v4, v5, s[40:41]
    v_mfma_f32_16x16x32_bf16 v[40:43], v[144:147], v[184:187], v[40:43]
    v_cndmask_b32 v6, v6, v7, s[40:41]
    v_cndmask_b32 v12, v4, v8, s[42:43]
    v_mfma_f32_16x16x32_bf16 v[68:71], v[144:147], v[188:191], v[68:71]
    v_cndmask_b32 v13, v6, v8, s[44:45]
    v_cndmask_b32 v14, v8, v4, s[42:43]
    v_mfma_f32_16x16x32_bf16 v[72:75], v[152:155], v[148:151], v[72:75]
    v_cndmask_b32 v15, v8, v6, s[44:45]
    s_cmp_eq_u32 s31, 0
    v_mfma_f32_16x16x32_bf16 v[76:79], v[148:151], v[156:159], v[76:79]
    s_cselect_b64 s[48:49], s[42:43], -1
    s_cselect_b64 s[38:39], s[44:45], -1
    s_waitcnt vmcnt(2) lgkmcnt(6)
    v_mfma_f32_16x16x32_bf16 v[16:19], v[80:83], v[192:195], v[16:19]
    ds_read_b128 v[120:123], v247 offset:57344
    v_mfma_f32_16x16x32_bf16 v[44:47], v[80:83], v[196:199], v[44:47]
    ds_read_b128 v[124:127], v247 offset:58368
    s_mul_i32 s36, s20, 3072
    v_mfma_f32_16x16x32_bf16 v[20:23], v[84:87], v[192:195], v[20:23]
    ds_read_b128 v[128:131], v247 offset:59392
    s_add_u32 s36, s36, 149504
    v_mfma_f32_16x16x32_bf16 v[48:51], v[84:87], v[196:199], v[48:51]
    ds_read_b128 v[132:135], v247 offset:60416
    v_add_u32 v9, s36, v0
    v_mfma_f32_16x16x32_bf16 v[24:27], v[88:91], v[192:195], v[24:27]
    ds_read_b128 v[136:139], v247 offset:61440
    s_lshl_b32 s37, s20, 9
    v_mfma_f32_16x16x32_bf16 v[52:55], v[88:91], v[196:199], v[52:55]
    ds_read_b128 v[140:143], v247 offset:62464
    s_add_u32 s37, s37, 149504
    v_mfma_f32_16x16x32_bf16 v[28:31], v[92:95], v[192:195], v[28:31]
    ds_read_b128 v[144:147], v247 offset:63488
    v_add_u32 v10, s37, v0
    v_mfma_f32_16x16x32_bf16 v[56:59], v[92:95], v[196:199], v[56:59]
    ds_read_b128 v[148:151], v248 offset:15360
    s_waitcnt lgkmcnt(8)
    v_mfma_f32_16x16x32_bf16 v[32:35], v[192:195], v[96:99], v[32:35]
    ds_read_b128 v[152:155], v250 offset:43008
    v_lshlrev_b32 v4, 2, v3
    v_mfma_f32_16x16x32_bf16 v[60:63], v[196:199], v[96:99], v[60:63]
    ds_read_b128 v[156:159], v252 offset:43008
    v_sub_u32_e64 v4, v2, v4
    v_mfma_f32_16x16x32_bf16 v[36:39], v[192:195], v[100:103], v[36:39]
    v_lshlrev_b32 v5, 4, v4
    v_lshrrev_b32 v4, 1, v4
    v_mfma_f32_16x16x32_bf16 v[64:67], v[196:199], v[100:103], v[64:67]
    v_mov_b32 v6, 0x3f80
    v_lshlrev_b32_e64 v5, v5, v6
    v_mfma_f32_16x16x32_bf16 v[40:43], v[104:107], v[192:195], v[40:43]
    v_cmp_eq_u32_e64 vcc, 0, v4
    v_cmp_eq_u32 s[46:47], 1, v4
    v_mfma_f32_16x16x32_bf16 v[68:71], v[104:107], v[196:199], v[68:71]
    ds_read_b128 v[208:211], v255 offset:64
    s_lshl_b32 s36, s24, 10
    v_add_u32 v4, s36, v1
    v_mfma_f32_16x16x32_bf16 v[72:75], v[112:115], v[108:111], v[72:75]
    ds_read_b128 v[212:215], v255 offset:192
    v_cndmask_b32_e64 v234, 0, v5, vcc
    v_cndmask_b32 v235, 0, v5, s[46:47]
    v_mfma_f32_16x16x32_bf16 v[76:79], v[108:111], v[116:119], v[76:79]
    ds_read_b128 v[216:219], v255 offset:320
    v_add_u32 v5, 18432, v4
    s_lshl_b32 s36, s24, 7
    s_waitcnt vmcnt(0) lgkmcnt(9)
    v_mfma_f32_16x16x32_bf16 v[16:19], v[120:123], v[200:203], v[16:19]
    ds_read_b128 v[80:83], v248 offset:16384
    v_mfma_f32_16x16x32_bf16 v[44:47], v[120:123], v[204:207], v[44:47]
    ds_read_b128 v[84:87], v250 offset:50176
    s_add_u32 s36, s36, 16384
    v_mfma_f32_16x16x32_bf16 v[20:23], v[124:127], v[200:203], v[20:23]
    ds_read_b128 v[88:91], v252 offset:50176
    v_cmp_eq_u32_e64 vcc, 2, v3
    v_mfma_f32_16x16x32_bf16 v[48:51], v[124:127], v[204:207], v[48:51]
    ds_read_b128 v[92:95], v248 offset:17408
    v_lshl_add_u32 v6, v2, 3, s36
    v_mfma_f32_16x16x32_bf16 v[24:27], v[128:131], v[200:203], v[24:27]
    ds_read_b128 v[96:99], v250 offset:57344
    v_bfrev_b32_e64 v7, 1
    v_mfma_f32_16x16x32_bf16 v[52:55], v[128:131], v[204:207], v[52:55]
    ds_read_b128 v[100:103], v252 offset:57344
    v_cndmask_b32_e64 v6, v7, v6, vcc
    v_mfma_f32_16x16x32_bf16 v[28:31], v[132:135], v[200:203], v[28:31]
    v_add_u32 v7, 18432, v6
    v_mov_b32_e64 v106, 0
    v_mfma_f32_16x16x32_bf16 v[56:59], v[132:135], v[204:207], v[56:59]
    s_waitcnt lgkmcnt(6)
    v_mov_b32 v107, 0
    v_mfma_f32_16x16x32_bf16 v[32:35], v[200:203], v[136:139], v[32:35]
    v_mov_b32 v8, 0xf149f2ca
    v_mov_b32_e64 v108, 0
    v_mfma_f32_16x16x32_bf16 v[60:63], v[204:207], v[136:139], v[60:63]
    s_mov_b32 s33, 0x3eae1a93
    v_mov_b32_e64 v109, 0
    v_mfma_f32_16x16x32_bf16 v[36:39], v[200:203], v[140:143], v[36:39]
    v_mov_b32 v236, 0x3f803f80
    v_mov_b32 v237, 0x3f803f80
    v_mfma_f32_16x16x32_bf16 v[64:67], v[204:207], v[140:143], v[64:67]
    v_mov_b32 v238, 0x3f803f80
    v_mov_b32 v239, 0x3f803f80
    v_mfma_f32_16x16x32_bf16 v[40:43], v[144:147], v[200:203], v[40:43]
    v_mov_b32_e64 v114, 0
    v_mfma_f32_16x16x32_bf16 v[68:71], v[144:147], v[204:207], v[68:71]
    v_mov_b32_e64 v115, 0
    v_mfma_f32_16x16x32_bf16 v[72:75], v[152:155], v[148:151], v[72:75]
    v_mov_b32_e64 v116, 0
    v_mfma_f32_16x16x32_bf16 v[76:79], v[148:151], v[156:159], v[76:79]
    v_mov_b32 v117, 0
    s_waitcnt lgkmcnt(0)
    v_mfma_f32_16x16x32_bf16 v[72:75], v[84:87], v[80:83], v[72:75]
    v_mfma_f32_16x16x32_bf16 v[76:79], v[80:83], v[88:91], v[76:79]
    v_mfma_f32_16x16x32_bf16 v[72:75], v[96:99], v[92:95], v[72:75]
    v_mfma_f32_16x16x32_bf16 v[76:79], v[92:95], v[100:103], v[76:79]
L_a_e0:
    v_pk_mul_f32 v[52:53], v[52:53], v[244:245] op_sel:[0,1] op_sel_hi:[1,1]
    v_pk_mul_f32 v[54:55], v[54:55], v[244:245] op_sel:[0,1] op_sel_hi:[1,1]
    v_pk_mul_f32 v[56:57], v[56:57], v[244:245] op_sel:[0,1] op_sel_hi:[1,1]
    v_pk_mul_f32 v[58:59], v[58:59], v[244:245] op_sel:[0,1] op_sel_hi:[1,1]
    v_pk_mul_f32 v[60:61], v[60:61], v[216:217]
    v_pk_mul_f32 v[62:63], v[62:63], v[218:219]
    v_pk_mul_f32 v[64:65], v[64:65], v[216:217]
    v_pk_mul_f32 v[66:67], v[66:67], v[218:219]
    v_pk_mul_f32 v[68:69], v[68:69], v[244:245] op_sel:[0,1] op_sel_hi:[1,1]
    v_pk_mul_f32 v[70:71], v[70:71], v[244:245] op_sel:[0,1] op_sel_hi:[1,1]
    v_pk_mul_f32 v[72:73], v[72:73], v[240:241] op_sel:[0,1] op_sel_hi:[1,1]
    v_pk_mul_f32 v[74:75], v[74:75], v[240:241] op_sel:[0,1] op_sel_hi:[1,1]
    v_pk_mul_f32 v[76:77], v[76:77], v[208:209]
    v_pk_mul_f32 v[78:79], v[78:79], v[210:211]
    v_cvt_pk_bf16_f32 v172, v52, v53
    v_cvt_pk_bf16_f32 v173, v54, v55
    v_cvt_pk_bf16_f32 v176, v56, v57
    v_cvt_pk_bf16_f32 v177, v58, v59
    v_cvt_pk_bf16_f32 v182, v60, v61
    v_cvt_pk_bf16_f32 v183, v62, v63
    v_cvt_pk_bf16_f32 v188, v64, v65
    v_cvt_pk_bf16_f32 v189, v66, v67
    v_cvt_pk_bf16_f32 v174, v68, v69
    v_cvt_pk_bf16_f32 v175, v70, v71
    v_cvt_pk_bf16_f32 v220, v72, v73
    v_cvt_pk_bf16_f32 v221, v74, v75
    v_cvt_pk_bf16_f32 v222, v76, v77
    v_cvt_pk_bf16_f32 v223, v78, v79
    s_cmp_eq_u32 s20, 3
    s_cbranch_scc1 L_a_nw
    ds_write2st64_b64 v9, v[172:173], v[174:175] offset0:6 offset1:7
    ds_write2st64_b64 v9, v[176:177], v[182:183] offset0:8 offset1:9
    ds_write_b64 v9, v[188:189] offset:5120
    ds_write2st64_b64 v10, v[220:221], v[222:223] offset0:0 offset1:3
L_a_nw:
    v_pk_mul_f32 v[24:25], v[24:25], v[242:243] op_sel:[0,1] op_sel_hi:[1,1]
    v_pk_mul_f32 v[26:27], v[26:27], v[242:243] op_sel:[0,1] op_sel_hi:[1,1]
    v_pk_mul_f32 v[28:29], v[28:29], v[242:243] op_sel:[0,1] op_sel_hi:[1,1]
    v_pk_mul_f32 v[30:31], v[30:31], v[242:243] op_sel:[0,1] op_sel_hi:[1,1]
    v_pk_mul_f32 v[32:33], v[32:33], v[212:213]
    v_pk_mul_f32 v[34:35], v[34:35], v[214:215]
    v_pk_mul_f32 v[36:37], v[36:37], v[212:213]
    v_pk_mul_f32 v[38:39], v[38:39], v[214:215]
    v_pk_mul_f32 v[40:41], v[40:41], v[242:243] op_sel:[0,1] op_sel_hi:[1,1]
    v_pk_mul_f32 v[42:43], v[42:43], v[242:243] op_sel:[0,1] op_sel_hi:[1,1]
    v_cvt_pk_bf16_f32 v166, v24, v25
    v_cvt_pk_bf16_f32 v167, v26, v27
    v_cvt_pk_bf16_f32 v170, v28, v29
    v_cvt_pk_bf16_f32 v171, v30, v31
    v_cvt_pk_bf16_f32 v180, v32, v33
    v_cvt_pk_bf16_f32 v181, v34, v35
    v_cvt_pk_bf16_f32 v186, v36, v37
    v_cvt_pk_bf16_f32 v187, v38, v39
    v_cvt_pk_bf16_f32 v168, v40, v41
    v_cvt_pk_bf16_f32 v169, v42, v43
    s_waitcnt lgkmcnt(0)
    s_barrier
L_a_e1:
    ds_read2st64_b64 v[160:163], v9 offset0:0 offset1:1
    ds_read_b64 v[164:165], v9 offset:1024
    ds_read_b64 v[178:179], v9 offset:1536
    ds_read_b64 v[184:185], v9 offset:2048
    v_mfma_f32_16x16x16_bf16 v[128:131], v[174:175], v[234:235], 0
    v_mfma_f32_16x16x16_bf16 v[124:127], v[168:169], v[234:235], 0
    v_pk_mul_f32 v[44:45], v[44:45], v[244:245] op_sel:[0,1] op_sel_hi:[1,1]
    v_pk_mul_f32 v[46:47], v[46:47], v[244:245] op_sel:[0,1] op_sel_hi:[1,1]
    v_pk_mul_f32 v[48:49], v[48:49], v[244:245] op_sel:[0,1] op_sel_hi:[1,1]
    v_pk_mul_f32 v[50:51], v[50:51], v[244:245] op_sel:[0,1] op_sel_hi:[1,1]
    v_pk_mul_f32 v[16:17], v[16:17], v[242:243] op_sel:[0,1] op_sel_hi:[1,1]
    v_pk_mul_f32 v[18:19], v[18:19], v[242:243] op_sel:[0,1] op_sel_hi:[1,1]
    v_pk_mul_f32 v[20:21], v[20:21], v[242:243] op_sel:[0,1] op_sel_hi:[1,1]
    v_pk_mul_f32 v[22:23], v[22:23], v[242:243] op_sel:[0,1] op_sel_hi:[1,1]
    v_cvt_pk_bf16_f32 v112, v44, v45
    v_cvt_pk_bf16_f32 v113, v46, v47
    v_cvt_pk_bf16_f32 v118, v48, v49
    v_cvt_pk_bf16_f32 v119, v50, v51
    v_cvt_pk_bf16_f32 v104, v16, v17
    v_cvt_pk_bf16_f32 v105, v18, v19
    v_cvt_pk_bf16_f32 v110, v20, v21
    v_cvt_pk_bf16_f32 v111, v22, v23
    v_permlane16_swap_b32 v114, v174
    v_permlane16_swap_b32 v117, v175
    v_permlane16_swap_b32 v106, v168
    v_permlane16_swap_b32 v109, v169
    s_waitcnt lgkmcnt(0)
    v_mfma_f32_16x16x16_bf16 v[120:123], v[162:163], v[234:235], 0
    v_mfma_f32_16x16x32_bf16 v[20:23], v[172:175], v[112:115], 0
    v_mfma_f32_16x16x32_bf16 v[16:19], v[166:169], v[112:115], 0
    v_mfma_f32_16x16x32_bf16 v[28:31], v[174:177], v[116:119], 0
    v_mfma_f32_16x16x32_bf16 v[24:27], v[168:171], v[116:119], 0
    v_mfma_f32_16x16x32_bf16 v[36:39], v[166:169], v[104:107], 0
    v_mfma_f32_16x16x32_bf16 v[32:35], v[160:163], v[104:107], 0
    v_mfma_f32_16x16x32_bf16 v[44:47], v[168:171], v[108:111], 0
    v_mfma_f32_16x16x32_bf16 v[40:43], v[162:165], v[108:111], 0
    v_cvt_pk_bf16_f32 v194, v128, v129
    v_cvt_pk_bf16_f32 v195, v130, v131
    v_cvt_pk_bf16_f32 v192, v124, v125
    v_cvt_pk_bf16_f32 v193, v126, v127
    v_cvt_pk_bf16_f32 v190, v120, v121
    v_cvt_pk_bf16_f32 v191, v122, v123
    v_cndmask_b32 v20, v20, v21, s[40:41]
    v_cndmask_b32 v16, v16, v17, s[40:41]
    v_cndmask_b32 v48, v16, v20, s[42:43]
    v_cndmask_b32 v22, v22, v23, s[40:41]
    v_cndmask_b32 v18, v18, v19, s[40:41]
    v_cndmask_b32 v49, v18, v22, s[44:45]
    v_max_f32 v56, v48, v49
    v_cndmask_b32 v28, v28, v29, s[40:41]
    v_cndmask_b32 v24, v24, v25, s[40:41]
    v_cndmask_b32 v50, v24, v28, s[42:43]
    v_cndmask_b32 v30, v30, v31, s[40:41]
    v_cndmask_b32 v26, v26, v27, s[40:41]
    v_cndmask_b32 v51, v26, v30, s[44:45]
    v_max_f32_e64 v57, v50, v51
    v_cndmask_b32 v36, v36, v37, s[40:41]
    v_cndmask_b32 v32, v32, v33, s[40:41]
    v_cndmask_b32 v52, v32, v36, s[42:43]
    v_cndmask_b32 v52, v8, v52, s[48:49]
    v_cndmask_b32 v38, v38, v39, s[40:41]
    v_cndmask_b32 v34, v34, v35, s[40:41]
    v_cndmask_b32 v53, v34, v38, s[44:45]
    v_cndmask_b32 v53, v8, v53, s[38:39]
    v_max_f32 v58, v52, v53
    v_permlane32_swap_b32 v56, v57
    v_max_f32_e64 v56, v56, v57
    v_cndmask_b32 v44, v44, v45, s[40:41]
    v_cndmask_b32 v40, v40, v41, s[40:41]
    v_cndmask_b32 v54, v40, v44, s[42:43]
    v_cndmask_b32 v54, v8, v54, s[48:49]
    v_cndmask_b32 v46, v46, v47, s[40:41]
    v_cndmask_b32 v42, v42, v43, s[40:41]
    v_cndmask_b32 v55, v42, v46, s[44:45]
    v_cndmask_b32 v55, v8, v55, s[38:39]
    v_max_f32 v59, v54, v55
    s_nop 1
    v_permlane32_swap_b32 v58, v59
    v_max_f32 v58, v58, v59
    s_nop 1
    v_permlane16_swap_b32 v56, v58
    v_max_f32 v57, v56, v58
    v_mul_f32 v56, s33, v57
    v_mul_f32 v58, s33, v57
    s_nop 1
    v_permlane16_swap_b32 v56, v58
    v_mov_b32 v57, v56
    v_mov_b32 v59, v58
    s_nop 0
    v_permlane32_swap_b32 v56, v57
    v_permlane32_swap_b32 v58, v59
    v_fma_f32 v48, v48, s33, -v56
    v_fma_f32 v49, v49, s33, -v56
    v_fma_f32 v50, v50, s33, -v57
    v_fma_f32 v51, v51, s33, -v57
    v_fma_f32 v52, v52, s33, -v58
    v_fma_f32 v53, v53, s33, -v58
    v_fma_f32 v54, v54, s33, -v59
    v_fma_f32 v55, v55, s33, -v59
    v_exp_f32 v48, v48
    v_exp_f32 v49, v49
    v_exp_f32 v50, v50
    v_exp_f32 v51, v51
    v_exp_f32 v52, v52
    v_exp_f32 v53, v53
    v_exp_f32 v54, v54
    v_exp_f32 v55, v55
    v_cvt_pk_bf16_f32 v56, v48, v49
    v_cvt_pk_bf16_f32 v57, v50, v51
    v_cvt_pk_bf16_f32 v58, v52, v53
    v_cvt_pk_bf16_f32 v59, v54, v55
    v_perm_b32 v64, v56, v56, v12
    v_perm_b32 v65, v56, v56, v13
    v_perm_b32 v66, v56, v56, v14
    v_perm_b32 v67, v56, v56, v15
    v_perm_b32 v68, v57, v57, v12
    v_perm_b32 v69, v57, v57, v13
    v_perm_b32 v70, v57, v57, v14
    v_perm_b32 v71, v57, v57, v15
    v_perm_b32 v72, v58, v58, v12
    v_perm_b32 v73, v58, v58, v13
    v_perm_b32 v74, v58, v58, v14
    v_perm_b32 v75, v58, v58, v15
    v_perm_b32 v76, v59, v59, v12
    v_perm_b32 v77, v59, v59, v13
    v_perm_b32 v78, v59, v59, v14
    v_perm_b32 v79, v59, v59, v15
    v_mfma_f32_16x16x32_bf16 v[80:83], v[236:239], v[64:67], 0
    v_mfma_f32_16x16x32_bf16 v[84:87], v[236:239], v[68:71], 0
    v_mfma_f32_16x16x32_bf16 v[88:91], v[236:239], v[72:75], 0
    v_mfma_f32_16x16x32_bf16 v[92:95], v[236:239], v[76:79], 0
    v_mfma_f32_16x16x32_bf16 v[16:19], v[180:183], v[64:67], 0
    v_mfma_f32_16x16x32_bf16 v[20:23], v[192:195], v[64:67], 0
    v_mfma_f32_16x16x32_bf16 v[24:27], v[186:189], v[68:71], 0
    v_mfma_f32_16x16x32_bf16 v[28:31], v[192:195], v[68:71], 0
    v_mfma_f32_16x16x32_bf16 v[32:35], v[178:181], v[72:75], 0
    v_mfma_f32_16x16x32_bf16 v[36:39], v[190:193], v[72:75], 0
    v_mfma_f32_16x16x32_bf16 v[40:43], v[184:187], v[76:79], 0
    v_mfma_f32_16x16x32_bf16 v[44:47], v[190:193], v[76:79], 0
    v_rcp_f32 v80, v80
    v_rcp_f32 v84, v84
    v_rcp_f32 v88, v88
    v_rcp_f32 v92, v92
    v_pk_mul_f32 v[16:17], v[16:17], v[80:81] op_sel_hi:[1,0]
    v_pk_mul_f32 v[18:19], v[18:19], v[80:81] op_sel_hi:[1,0]
    v_pk_mul_f32 v[20:21], v[20:21], v[80:81] op_sel_hi:[1,0]
    v_pk_mul_f32 v[24:25], v[24:25], v[84:85] op_sel_hi:[1,0]
    v_pk_mul_f32 v[26:27], v[26:27], v[84:85] op_sel_hi:[1,0]
    v_pk_mul_f32 v[30:31], v[30:31], v[84:85] op_sel_hi:[1,0]
    v_cvt_pk_bf16_f32 v220, v16, v17
    v_cvt_pk_bf16_f32 v221, v18, v19
    v_cvt_pk_bf16_f32 v224, v20, v21
    v_cvt_pk_bf16_f32 v222, v24, v25
    v_cvt_pk_bf16_f32 v223, v26, v27
    v_cvt_pk_bf16_f32 v225, v30, v31
    buffer_store_dwordx4 v[220:223], v5, s[4:7], s35 offen sc1
    buffer_store_dwordx2 v[224:225], v7, s[4:7], s35 offen sc1
    v_pk_mul_f32 v[32:33], v[32:33], v[88:89] op_sel_hi:[1,0]
    v_pk_mul_f32 v[34:35], v[34:35], v[88:89] op_sel_hi:[1,0]
    v_pk_mul_f32 v[36:37], v[36:37], v[88:89] op_sel_hi:[1,0]
    v_pk_mul_f32 v[40:41], v[40:41], v[92:93] op_sel_hi:[1,0]
    v_pk_mul_f32 v[42:43], v[42:43], v[92:93] op_sel_hi:[1,0]
    v_pk_mul_f32 v[46:47], v[46:47], v[92:93] op_sel_hi:[1,0]
    v_cvt_pk_bf16_f32 v228, v32, v33
    v_cvt_pk_bf16_f32 v229, v34, v35
    v_cvt_pk_bf16_f32 v232, v36, v37
    v_cvt_pk_bf16_f32 v230, v40, v41
    v_cvt_pk_bf16_f32 v231, v42, v43
    v_cvt_pk_bf16_f32 v233, v46, v47
    buffer_store_dwordx4 v[228:231], v4, s[4:7], s35 offen sc1
    buffer_store_dwordx2 v[232:233], v6, s[4:7], s35 offen sc1
    s_and_b32 s25, s2, 7
    s_lshr_b32 s26, s2, 3
    s_lshr_b32 s23, s25, 1
    s_lshl_b32 s23, s23, 3
    s_lshr_b32 s27, s26, 2
    s_add_u32 s23, s23, s27
    s_and_b32 s24, s25, 1
    s_lshl_b32 s24, s24, 2
    s_and_b32 s27, s26, 3
    s_add_u32 s24, s24, s27
    s_add_u32 s25, s23, s24
    s_and_b32 s25, s25, 3
    s_lshl_b32 s30, s23, 2
    s_add_u32 s30, s30, s20
    s_mul_i32 s29, s30, 18432
    s_add_u32 s29, s29, s21
    s_add_u32 s29, s29, 0x600000
    s_mul_i32 s34, s30, 18432
    s_add_u32 s34, s34, s21
    s_add_u32 s34, s34, 0x0
    s_lshl_b32 s35, s24, 11
    s_lshr_b32 s36, s24, 2
    s_lshl_b32 s36, s36, 10
    s_and_b32 s37, s24, 3
    s_lshl_b32 s37, s37, 8
    s_add_u32 s36, s36, s37
    s_add_u32 s36, s36, 16384
    v_bfe_u32 v2, v1, 4, 4
    v_lshrrev_b32 v3, 8, v1
    v_add_u32 v4, s35, v1
    v_lshlrev_b32 v5, 4, v2
    v_lshl_add_u32 v5, v3, 3, v5
    v_add_u32_e64 v5, s36, v5
    v_cmp_gt_u32 s[40:41], 2, v3
    v_bfrev_b32 v6, 1
    v_add_u32 v12, 0, v1
    v_add_u32 v13, 36864, v1
    v_add_u32 v14, 73728, v1
    v_add_u32 v15, 110592, v1
    v_cndmask_b32 v5, v6, v5, s[40:41]
    buffer_load_dwordx4 v[208:211], v4, s[4:7], s34 offen offset:0 sc1
    buffer_load_dwordx4 v[212:215], v4, s[4:7], s34 offen offset:1024 sc1
    buffer_load_dwordx2 v[216:217], v5, s[4:7], s34 offen sc1
    s_add_u32 s34, s34, 0x300000
    s_lshl_b32 s39, s30, 10
    s_add_u32 s39, s39, s21
    s_lshl_b32 s42, s24, 7
    s_add_u32 s39, s39, s42
    s_add_u32 s39, s39, 0x1b20000
    v_cmp_eq_u32 vcc, 0, v3
    v_lshlrev_b32 v10, 3, v2
    v_mov_b32 v11, 0x3f803f80
    v_lshl_add_u32 v7, v3, 8, v10
    v_cndmask_b32_e64 v10, v6, v10, vcc
    s_lshr_b32 s44, s23, 1
    s_lshl_b32 s52, s22, 7
    s_add_u32 s52, s52, s44
    s_lshl_b32 s52, s52, 8
    s_add_u32 s52, s52, 0x4508000
    s_add_u32 s52, s52, s4
    s_addc_u32 s53, s5, 0
    s_waitcnt vmcnt(3)
    s_barrier
    s_cmp_lg_u32 s20, 0
    s_cbranch_scc1 L_ns_d2
    s_mov_b32 s56, 1
    s_atomic_add s56, s[50:51], 0
L_ns_d2:
    s_cmp_lg_u32 s20, 0
    s_cbranch_scc1 L_pd_d2
    s_mov_b32 s60, 262144
L_poll_d2:
    s_mov_b32 s57, 0
    s_atomic_add s57, s[52:53], 0 glc
    s_waitcnt lgkmcnt(0)
    s_cmp_ge_u32 s57, 16
    s_cbranch_scc1 L_pd_d2
    s_sub_u32 s60, s60, 1
    s_cbranch_scc1 L_pd_d2
    s_sleep 2
    s_branch L_poll_d2
    s_nop 0
L_pd_d2:
    s_barrier
    s_mov_b32 s32, 0
    s_lshl_b32 s32, s32, 13
    s_add_u32 s32, s32, s29
    s_add_u32 s33, s32, 4096
    buffer_load_dwordx4 v[112:115], v1, s[4:7], s32 offen offset:0 sc1
    buffer_load_dwordx4 v[116:119], v1, s[4:7], s32 offen offset:1024 sc1
    buffer_load_dwordx4 v[120:123], v1, s[4:7], s32 offen offset:2048 sc1
    buffer_load_dwordx4 v[124:127], v1, s[4:7], s32 offen offset:3072 sc1
    buffer_load_dwordx4 v[128:131], v1, s[4:7], s33 offen offset:0 sc1
    buffer_load_dwordx4 v[132:135], v1, s[4:7], s33 offen offset:1024 sc1
    buffer_load_dwordx4 v[136:139], v1, s[4:7], s33 offen offset:2048 sc1
    buffer_load_dwordx4 v[140:143], v1, s[4:7], s33 offen offset:3072 sc1
    ds_read_b128 v[40:43], v12 offset:18432
    ds_read_b128 v[44:47], v12 offset:19456
    ds_read_b128 v[48:51], v12 offset:20480
    ds_read_b128 v[52:55], v12 offset:21504
    ds_read_b128 v[72:75], v12 offset:26624
    ds_read_b128 v[56:59], v12 offset:22528
    ds_read_b128 v[60:63], v12 offset:23552
    ds_read_b128 v[64:67], v12 offset:24576
    ds_read_b128 v[68:71], v12 offset:25600
    s_add_u32 s45, s29, 8192
    s_add_u32 s46, s29, 12288
    s_add_u32 s47, s29, 16384
    buffer_load_dwordx4 v[144:147], v1, s[4:7], s45 offen offset:0 sc1
    buffer_load_dwordx4 v[148:151], v1, s[4:7], s45 offen offset:1024 sc1
    s_lshl_b32 s42, s23, 3
    s_add_u32 s42, s42, s24
    s_lshl_b32 s42, s42, 2
    s_add_u32 s42, s42, s20
    s_lshl_b32 s42, s42, 8
    s_add_u32 s42, s42, s21
    s_add_u32 s42, s42, 0x1b40000
    v_mov_b32 v220, -1.0
    v_lshrrev_b32 v221, 2, v1
    buffer_store_dword v220, v221, s[4:7], s42 offen sc1
    s_lshl_b32 s50, s22, 7
    s_add_u32 s50, s50, s44
    s_lshl_b32 s50, s50, 8
    s_add_u32 s50, s50, 0x4509000
    s_add_u32 s50, s50, s4
    s_addc_u32 s51, s5, 0
    s_waitcnt vmcnt(11)
    v_lshlrev_b32_e64 v16, 16, v208
    v_and_b32 v17, 0xffff0000, v208
    v_lshlrev_b32_e64 v18, 16, v209
    v_and_b32 v19, 0xffff0000, v209
    v_lshlrev_b32_e64 v20, 16, v210
    v_and_b32 v21, 0xffff0000, v210
    v_lshlrev_b32_e64 v22, 16, v211
    v_and_b32 v23, 0xffff0000, v211
    v_lshlrev_b32_e64 v24, 16, v212
    v_and_b32 v25, 0xffff0000, v212
    v_lshlrev_b32_e64 v26, 16, v213
    v_and_b32 v27, 0xffff0000, v213
    v_lshlrev_b32_e64 v28, 16, v214
    v_and_b32 v29, 0xffff0000, v214
    v_lshlrev_b32_e64 v30, 16, v215
    v_and_b32 v31, 0xffff0000, v215
    v_lshlrev_b32_e64 v32, 16, v216
    v_and_b32 v33, 0xffff0000, v216
    v_lshlrev_b32_e64 v34, 16, v217
    v_and_b32 v35, 0xffff0000, v217
    s_waitcnt vmcnt(9) lgkmcnt(4)
    v_mfma_f32_16x16x32_bf16 v[16:19], v[40:43], v[112:115], v[16:19]
    ds_read_b128 v[76:79], v12 offset:27648
    v_mfma_f32_16x16x32_bf16 v[20:23], v[44:47], v[112:115], v[20:23]
    ds_read_b128 v[80:83], v12 offset:28672
    buffer_load_dwordx4 v[152:155], v1, s[4:7], s45 offen offset:2048 sc1
    v_mfma_f32_16x16x32_bf16 v[24:27], v[48:51], v[112:115], v[24:27]
    ds_read_b128 v[84:87], v12 offset:29696
    v_mfma_f32_16x16x32_bf16 v[28:31], v[52:55], v[112:115], v[28:31]
    ds_read_b128 v[88:91], v12 offset:30720
    v_mfma_f32_16x16x32_bf16 v[32:35], v[72:75], v[112:115], v[32:35]
    ds_read_b128 v[108:111], v12 offset:35840
    s_waitcnt lgkmcnt(5)
    buffer_load_dwordx4 v[156:159], v1, s[4:7], s45 offen offset:3072 sc1
    v_mfma_f32_16x16x32_bf16 v[16:19], v[56:59], v[116:119], v[16:19]
    ds_read_b128 v[92:95], v12 offset:31744
    v_mfma_f32_16x16x32_bf16 v[20:23], v[60:63], v[116:119], v[20:23]
    ds_read_b128 v[96:99], v12 offset:32768
    v_mfma_f32_16x16x32_bf16 v[24:27], v[64:67], v[116:119], v[24:27]
    ds_read_b128 v[100:103], v12 offset:33792
    buffer_load_dwordx4 v[160:163], v1, s[4:7], s46 offen offset:0 sc1
    v_mfma_f32_16x16x32_bf16 v[28:31], v[68:71], v[116:119], v[28:31]
    ds_read_b128 v[104:107], v12 offset:34816
    v_mfma_f32_16x16x32_bf16 v[36:39], v[72:75], v[116:119], 0
    s_waitcnt vmcnt(10) lgkmcnt(4)
    v_mfma_f32_16x16x32_bf16 v[16:19], v[76:79], v[120:123], v[16:19]
    ds_read_b128 v[40:43], v13 offset:18432
    v_mfma_f32_16x16x32_bf16 v[20:23], v[80:83], v[120:123], v[20:23]
    ds_read_b128 v[44:47], v13 offset:19456
    buffer_load_dwordx4 v[164:167], v1, s[4:7], s46 offen offset:1024 sc1
    v_mfma_f32_16x16x32_bf16 v[24:27], v[84:87], v[120:123], v[24:27]
    ds_read_b128 v[48:51], v13 offset:20480
    v_mfma_f32_16x16x32_bf16 v[28:31], v[88:91], v[120:123], v[28:31]
    ds_read_b128 v[52:55], v13 offset:21504
    v_mfma_f32_16x16x32_bf16 v[32:35], v[108:111], v[120:123], v[32:35]
    ds_read_b128 v[72:75], v13 offset:26624
    s_waitcnt lgkmcnt(5)
    buffer_load_dwordx4 v[168:171], v1, s[4:7], s46 offen offset:2048 sc1
    v_mfma_f32_16x16x32_bf16 v[16:19], v[92:95], v[124:127], v[16:19]
    ds_read_b128 v[56:59], v13 offset:22528
    v_mfma_f32_16x16x32_bf16 v[20:23], v[96:99], v[124:127], v[20:23]
    ds_read_b128 v[60:63], v13 offset:23552
    v_mfma_f32_16x16x32_bf16 v[24:27], v[100:103], v[124:127], v[24:27]
    ds_read_b128 v[64:67], v13 offset:24576
    buffer_load_dwordx4 v[172:175], v1, s[4:7], s46 offen offset:3072 sc1
    v_mfma_f32_16x16x32_bf16 v[28:31], v[104:107], v[124:127], v[28:31]
    ds_read_b128 v[68:71], v13 offset:25600
    v_mfma_f32_16x16x32_bf16 v[36:39], v[108:111], v[124:127], v[36:39]
    s_waitcnt vmcnt(11) lgkmcnt(4)
    v_mfma_f32_16x16x32_bf16 v[16:19], v[40:43], v[128:131], v[16:19]
    ds_read_b128 v[76:79], v13 offset:27648
    v_mfma_f32_16x16x32_bf16 v[20:23], v[44:47], v[128:131], v[20:23]
    ds_read_b128 v[80:83], v13 offset:28672
    buffer_load_dwordx2 v[176:177], v7, s[4:7], s47 offen offset:0 sc1
    v_mfma_f32_16x16x32_bf16 v[24:27], v[48:51], v[128:131], v[24:27]
    ds_read_b128 v[84:87], v13 offset:29696
    v_mfma_f32_16x16x32_bf16 v[28:31], v[52:55], v[128:131], v[28:31]
    ds_read_b128 v[88:91], v13 offset:30720
    v_mfma_f32_16x16x32_bf16 v[32:35], v[72:75], v[128:131], v[32:35]
    ds_read_b128 v[108:111], v13 offset:35840
    s_waitcnt lgkmcnt(5)
    buffer_load_dwordx2 v[178:179], v7, s[4:7], s47 offen offset:128 sc1
    v_mfma_f32_16x16x32_bf16 v[16:19], v[56:59], v[132:135], v[16:19]
    ds_read_b128 v[92:95], v13 offset:31744
    v_mfma_f32_16x16x32_bf16 v[20:23], v[60:63], v[132:135], v[20:23]
    ds_read_b128 v[96:99], v13 offset:32768
    v_mfma_f32_16x16x32_bf16 v[24:27], v[64:67], v[132:135], v[24:27]
    ds_read_b128 v[100:103], v13 offset:33792
    buffer_load_dwordx2 v[180:181], v7, s[4:7], s47 offen offset:1024 sc1
    v_mfma_f32_16x16x32_bf16 v[28:31], v[68:71], v[132:135], v[28:31]
    ds_read_b128 v[104:107], v13 offset:34816
    v_mfma_f32_16x16x32_bf16 v[36:39], v[72:75], v[132:135], v[36:39]
    s_waitcnt vmcnt(12) lgkmcnt(4)
    v_mfma_f32_16x16x32_bf16 v[16:19], v[76:79], v[136:139], v[16:19]
    ds_read_b128 v[40:43], v14 offset:18432
    v_mfma_f32_16x16x32_bf16 v[20:23], v[80:83], v[136:139], v[20:23]
    ds_read_b128 v[44:47], v14 offset:19456
    buffer_load_dwordx2 v[182:183], v7, s[4:7], s47 offen offset:1152 sc1
    v_mfma_f32_16x16x32_bf16 v[24:27], v[84:87], v[136:139], v[24:27]
    ds_read_b128 v[48:51], v14 offset:20480
    v_mfma_f32_16x16x32_bf16 v[28:31], v[88:91], v[136:139], v[28:31]
    ds_read_b128 v[52:55], v14 offset:21504
    v_mfma_f32_16x16x32_bf16 v[32:35], v[108:111], v[136:139], v[32:35]
    ds_read_b128 v[72:75], v14 offset:26624
    s_waitcnt lgkmcnt(5)
    v_mfma_f32_16x16x32_bf16 v[16:19], v[92:95], v[140:143], v[16:19]
    ds_read_b128 v[56:59], v14 offset:22528
    v_mfma_f32_16x16x32_bf16 v[20:23], v[96:99], v[140:143], v[20:23]
    ds_read_b128 v[60:63], v14 offset:23552
    v_mfma_f32_16x16x32_bf16 v[24:27], v[100:103], v[140:143], v[24:27]
    ds_read_b128 v[64:67], v14 offset:24576
    v_mfma_f32_16x16x32_bf16 v[28:31], v[104:107], v[140:143], v[28:31]
    ds_read_b128 v[68:71], v14 offset:25600
    v_mfma_f32_16x16x32_bf16 v[36:39], v[108:111], v[140:143], v[36:39]
    s_waitcnt vmcnt(11) lgkmcnt(4)
    v_mfma_f32_16x16x32_bf16 v[16:19], v[40:43], v[144:147], v[16:19]
    ds_read_b128 v[76:79], v14 offset:27648
    v_mfma_f32_16x16x32_bf16 v[20:23], v[44:47], v[144:147], v[20:23]
    ds_read_b128 v[80:83], v14 offset:28672
    v_mfma_f32_16x16x32_bf16 v[24:27], v[48:51], v[144:147], v[24:27]
    ds_read_b128 v[84:87], v14 offset:29696
    v_mfma_f32_16x16x32_bf16 v[28:31], v[52:55], v[144:147], v[28:31]
    ds_read_b128 v[88:91], v14 offset:30720
    v_mfma_f32_16x16x32_bf16 v[32:35], v[72:75], v[144:147], v[32:35]
    ds_read_b128 v[108:111], v14 offset:35840
    s_waitcnt lgkmcnt(5)
    v_mfma_f32_16x16x32_bf16 v[16:19], v[56:59], v[148:151], v[16:19]
    ds_read_b128 v[92:95], v14 offset:31744
    v_mfma_f32_16x16x32_bf16 v[20:23], v[60:63], v[148:151], v[20:23]
    ds_read_b128 v[96:99], v14 offset:32768
    v_mfma_f32_16x16x32_bf16 v[24:27], v[64:67], v[148:151], v[24:27]
    ds_read_b128 v[100:103], v14 offset:33792
    v_mfma_f32_16x16x32_bf16 v[28:31], v[68:71], v[148:151], v[28:31]
    ds_read_b128 v[104:107], v14 offset:34816
    v_mfma_f32_16x16x32_bf16 v[36:39], v[72:75], v[148:151], v[36:39]
    s_waitcnt vmcnt(8) lgkmcnt(4)
    v_mfma_f32_16x16x32_bf16 v[16:19], v[76:79], v[152:155], v[16:19]
    ds_read_b128 v[40:43], v15 offset:18432
    v_mfma_f32_16x16x32_bf16 v[20:23], v[80:83], v[152:155], v[20:23]
    ds_read_b128 v[44:47], v15 offset:19456
    v_mfma_f32_16x16x32_bf16 v[24:27], v[84:87], v[152:155], v[24:27]
    ds_read_b128 v[48:51], v15 offset:20480
    v_mfma_f32_16x16x32_bf16 v[28:31], v[88:91], v[152:155], v[28:31]
    ds_read_b128 v[52:55], v15 offset:21504
    v_mfma_f32_16x16x32_bf16 v[32:35], v[108:111], v[152:155], v[32:35]
    ds_read_b128 v[72:75], v15 offset:26624
    s_waitcnt lgkmcnt(5)
    v_mfma_f32_16x16x32_bf16 v[16:19], v[92:95], v[156:159], v[16:19]
    ds_read_b128 v[56:59], v15 offset:22528
    v_mfma_f32_16x16x32_bf16 v[20:23], v[96:99], v[156:159], v[20:23]
    ds_read_b128 v[60:63], v15 offset:23552
    v_mfma_f32_16x16x32_bf16 v[24:27], v[100:103], v[156:159], v[24:27]
    ds_read_b128 v[64:67], v15 offset:24576
    v_mfma_f32_16x16x32_bf16 v[28:31], v[104:107], v[156:159], v[28:31]
    ds_read_b128 v[68:71], v15 offset:25600
    v_mfma_f32_16x16x32_bf16 v[36:39], v[108:111], v[156:159], v[36:39]
    s_waitcnt vmcnt(6) lgkmcnt(4)
    v_mfma_f32_16x16x32_bf16 v[16:19], v[40:43], v[160:163], v[16:19]
    ds_read_b128 v[76:79], v15 offset:27648
    v_mfma_f32_16x16x32_bf16 v[20:23], v[44:47], v[160:163], v[20:23]
    ds_read_b128 v[80:83], v15 offset:28672
    v_mfma_f32_16x16x32_bf16 v[24:27], v[48:51], v[160:163], v[24:27]
    ds_read_b128 v[84:87], v15 offset:29696
    v_mfma_f32_16x16x32_bf16 v[28:31], v[52:55], v[160:163], v[28:31]
    ds_read_b128 v[88:91], v15 offset:30720
    v_mfma_f32_16x16x32_bf16 v[32:35], v[72:75], v[160:163], v[32:35]
    ds_read_b128 v[108:111], v15 offset:35840
    s_waitcnt lgkmcnt(5)
    v_mfma_f32_16x16x32_bf16 v[16:19], v[56:59], v[164:167], v[16:19]
    ds_read_b128 v[92:95], v15 offset:31744
    v_mfma_f32_16x16x32_bf16 v[20:23], v[60:63], v[164:167], v[20:23]
    ds_read_b128 v[96:99], v15 offset:32768
    v_mfma_f32_16x16x32_bf16 v[24:27], v[64:67], v[164:167], v[24:27]
    ds_read_b128 v[100:103], v15 offset:33792
    v_mfma_f32_16x16x32_bf16 v[28:31], v[68:71], v[164:167], v[28:31]
    ds_read_b128 v[104:107], v15 offset:34816
    v_mfma_f32_16x16x32_bf16 v[36:39], v[72:75], v[164:167], v[36:39]
    s_waitcnt vmcnt(4) lgkmcnt(4)
    v_mfma_f32_16x16x32_bf16 v[16:19], v[76:79], v[168:171], v[16:19]
    ds_read_b128 v[40:43], v15 offset:36864
    v_mfma_f32_16x16x32_bf16 v[20:23], v[80:83], v[168:171], v[20:23]
    ds_read_b128 v[44:47], v15 offset:37888
    v_mfma_f32_16x16x32_bf16 v[24:27], v[84:87], v[168:171], v[24:27]
    ds_read_b128 v[48:51], v15 offset:38912
    v_mfma_f32_16x16x32_bf16 v[28:31], v[88:91], v[168:171], v[28:31]
    ds_read_b128 v[52:55], v15 offset:39936
    v_mfma_f32_16x16x32_bf16 v[32:35], v[108:111], v[168:171], v[32:35]
    ds_read_b128 v[72:75], v15 offset:45056
    s_waitcnt lgkmcnt(5)
    v_mfma_f32_16x16x32_bf16 v[16:19], v[92:95], v[172:175], v[16:19]
    ds_read_b128 v[56:59], v15 offset:40960
    v_mfma_f32_16x16x32_bf16 v[20:23], v[96:99], v[172:175], v[20:23]
    ds_read_b128 v[60:63], v15 offset:41984
    v_mfma_f32_16x16x32_bf16 v[24:27], v[100:103], v[172:175], v[24:27]
    ds_read_b128 v[64:67], v15 offset:43008
    v_mfma_f32_16x16x32_bf16 v[28:31], v[104:107], v[172:175], v[28:31]
    ds_read_b128 v[68:71], v15 offset:44032
    v_mfma_f32_16x16x32_bf16 v[36:39], v[108:111], v[172:175], v[36:39]
    s_waitcnt vmcnt(0) lgkmcnt(4)
    v_mfma_f32_16x16x32_bf16 v[16:19], v[40:43], v[176:179], v[16:19]
    v_mfma_f32_16x16x32_bf16 v[20:23], v[44:47], v[176:179], v[20:23]
    v_mfma_f32_16x16x32_bf16 v[24:27], v[48:51], v[176:179], v[24:27]
    v_mfma_f32_16x16x32_bf16 v[28:31], v[52:55], v[176:179], v[28:31]
    v_mfma_f32_16x16x32_bf16 v[32:35], v[72:75], v[176:179], v[32:35]
    s_waitcnt lgkmcnt(0)
    v_mfma_f32_16x16x32_bf16 v[16:19], v[56:59], v[180:183], v[16:19]
    v_mfma_f32_16x16x32_bf16 v[20:23], v[60:63], v[180:183], v[20:23]
    v_mfma_f32_16x16x32_bf16 v[24:27], v[64:67], v[180:183], v[24:27]
    v_mfma_f32_16x16x32_bf16 v[28:31], v[68:71], v[180:183], v[28:31]
    v_mfma_f32_16x16x32_bf16 v[36:39], v[72:75], v[180:183], v[36:39]
    s_nop 3
    v_cvt_pk_bf16_f32 v208, v16, v17
    v_cvt_pk_bf16_f32 v209, v18, v19
    v_cvt_pk_bf16_f32 v210, v20, v21
    v_cvt_pk_bf16_f32 v211, v22, v23
    v_cvt_pk_bf16_f32 v212, v24, v25
    v_cvt_pk_bf16_f32 v213, v26, v27
    v_cvt_pk_bf16_f32 v214, v28, v29
    v_cvt_pk_bf16_f32 v215, v30, v31
    buffer_store_dwordx4 v[208:211], v4, s[4:7], s34 offen offset:0 sc1
    buffer_store_dwordx4 v[212:215], v4, s[4:7], s34 offen offset:1024 sc1
    v_permlane32_swap_b32 v36, v220
    v_permlane32_swap_b32 v37, v221
    v_permlane32_swap_b32 v38, v222
    v_permlane32_swap_b32 v39, v223
    v_pk_add_f32 v[32:33], v[32:33], v[220:221]
    v_pk_add_f32 v[34:35], v[34:35], v[222:223]
    v_cvt_pk_bf16_f32 v216, v32, v33
    v_cvt_pk_bf16_f32 v217, v34, v35
    buffer_store_dwordx2 v[216:217], v5, s[4:7], s34 offen sc1
    v_cndmask_b32 v222, 0, v216, s[40:41]
    v_cndmask_b32 v223, 0, v217, s[40:41]
    v_dot2_f32_bf16 v220, v208, v11, 0
    v_dot2_f32_bf16 v221, v208, v208, 0
    v_dot2_f32_bf16 v224, v209, v11, 0
    v_dot2_f32_bf16 v225, v209, v209, 0
    v_dot2_f32_bf16 v220, v210, v11, v220
    v_dot2_f32_bf16 v221, v210, v210, v221
    v_dot2_f32_bf16 v224, v211, v11, v224
    v_dot2_f32_bf16 v225, v211, v211, v225
    v_dot2_f32_bf16 v220, v212, v11, v220
    v_dot2_f32_bf16 v221, v212, v212, v221
    v_dot2_f32_bf16 v224, v213, v11, v224
    v_dot2_f32_bf16 v225, v213, v213, v225
    v_dot2_f32_bf16 v220, v214, v11, v220
    v_dot2_f32_bf16 v221, v214, v214, v221
    v_dot2_f32_bf16 v224, v215, v11, v224
    v_dot2_f32_bf16 v225, v215, v215, v225
    v_dot2_f32_bf16 v220, v222, v11, v220
    v_dot2_f32_bf16 v221, v222, v222, v221
    v_dot2_f32_bf16 v224, v223, v11, v224
    v_dot2_f32_bf16 v225, v223, v223, v225
    s_nop 2
    v_pk_add_f32 v[220:221], v[220:221], v[224:225]
    v_mov_b32 v222, v220
    v_mov_b32 v223, v221
    s_nop 1
    v_permlane32_swap_b32 v220, v222
    v_permlane32_swap_b32 v221, v223
    v_add_f32 v220, v220, v222
    v_add_f32 v221, v221, v223
    v_mov_b32 v222, v220
    v_mov_b32 v223, v221
    s_nop 1
    v_permlane16_swap_b32 v220, v222
    v_permlane16_swap_b32 v221, v223
    v_add_f32 v220, v220, v222
    v_add_f32 v221, v221, v223
    buffer_store_dwordx2 v[220:221], v10, s[4:7], s39 offen sc1
    s_and_b32 s25, s2, 7
    s_lshr_b32 s26, s2, 3
    s_and_b32 s23, s25, 1
    s_lshl_b32 s23, s23, 3
    s_and_b32 s27, s26, 7
    s_add_u32 s23, s23, s27
    s_lshr_b32 s24, s25, 1
    s_lshl_b32 s24, s24, 2
    s_lshr_b32 s27, s26, 3
    s_add_u32 s24, s24, s27
    s_add_u32 s28, s23, s24
    s_and_b32 s28, s28, 3
    s_lshl_b32 s30, s20, 12
    s_lshl_b32 s31, s23, 3
    s_lshl_b32 s33, s20, 1
    s_add_u32 s31, s31, s33
    s_lshl_b32 s32, s31, 10
    s_add_u32 s32, s32, s21
    s_add_u32 s32, s32, 0x1b20000
    v_add_u32 v2, 73728, v1
    s_add_u32 s33, s30, 18432
    v_add_u32 v3, s33, v1
    v_add_u32_e64 v0, s33, v2
    s_lshr_b32 s34, s31, 1
    s_lshl_b32 s35, s34, 12
    s_add_u32 s35, s35, s21
    s_add_u32 s35, s35, 0x1b40000
    s_lshl_b32 s36, s24, 8
    s_add_u32 s36, s36, s35
    s_lshl_b32 s38, s24, 6
    s_add_u32 s38, s38, s34
    s_mul_i32 s38, s38, 9216
    s_add_u32 s38, s38, s21
    s_add_u32 s38, s38, 0x900000
    s_add_u32 s39, s38, 4096
    s_add_u32 s46, s38, 8192
    s_mov_b32 s40, 0xc0135761
    s_mov_b32 s42, 0x3d372713
    s_mov_b32 s44, 0x39e38e39
    s_mov_b32 s45, 0x3727c5ac
    v_lshrrev_b32_e64 v4, 1, v1
    s_lshl_b32 s52, s22, 7
    s_add_u32 s52, s52, s23
    s_lshl_b32 s52, s52, 8
    s_add_u32 s52, s52, 0x4509000
    s_add_u32 s52, s52, s4
    s_addc_u32 s53, s5, 0
    s_waitcnt vmcnt(0)
    s_barrier
    s_cmp_lg_u32 s20, 0
    s_cbranch_scc1 L_ns_d3
    s_mov_b32 s56, 1
    s_atomic_add s56, s[50:51], 0
L_ns_d3:
    s_cmp_lg_u32 s20, 0
    s_cbranch_scc1 L_pd_d3
    s_mov_b32 s60, 262144
L_poll_d3:
    s_mov_b32 s57, 0
    s_atomic_add s57, s[52:53], 0 glc
    s_waitcnt lgkmcnt(0)
    s_cmp_ge_u32 s57, 16
    s_cbranch_scc1 L_pd_d3
    s_sub_u32 s60, s60, 1
    s_cbranch_scc1 L_pd_d3
    s_sleep 2
    s_branch L_poll_d3
L_pd_d3:
    s_barrier
    buffer_load_dwordx2 v[8:9], v4, s[4:7], s32 offen offset:0 sc1
    buffer_load_dwordx2 v[10:11], v4, s[4:7], s32 offen offset:512 sc1
    buffer_load_dwordx2 v[12:13], v4, s[4:7], s32 offen offset:1024 sc1
    buffer_load_dwordx2 v[14:15], v4, s[4:7], s32 offen offset:1536 sc1
    s_lshl_b32 s50, s22, 7
    s_add_u32 s50, s50, s23
    s_lshl_b32 s50, s50, 8
    s_add_u32 s50, s50, 0x450a000
    s_add_u32 s50, s50, s4
    s_addc_u32 s51, s5, 0
    s_barrier
    ds_read_b128 v[160:163], v3 offset:0
    ds_read_b128 v[164:167], v3 offset:2048
    ds_read_b128 v[168:171], v1 offset:0
    ds_read_b128 v[172:175], v1 offset:1024
    ds_read_b128 v[176:179], v1 offset:2048
    ds_read_b128 v[180:183], v1 offset:3072
    ds_read_b128 v[184:187], v1 offset:4096
    ds_read_b128 v[188:191], v1 offset:5120
    ds_read_b128 v[192:195], v1 offset:6144
    ds_read_b128 v[196:199], v1 offset:7168
    ds_read_b128 v[200:203], v1 offset:8192
    s_waitcnt lgkmcnt(5)
    v_mfma_f32_16x16x32_bf16 v[16:19], v[160:163], v[168:171], 0
    ds_read_b128 v[204:207], v3 offset:1024
    v_mfma_f32_16x16x32_bf16 v[20:23], v[164:167], v[168:171], 0
    ds_read_b128 v[208:211], v3 offset:3072
    v_mfma_f32_16x16x32_bf16 v[24:27], v[160:163], v[172:175], 0
    ds_read_b128 v[212:215], v1 offset:9216
    v_mfma_f32_16x16x32_bf16 v[28:31], v[164:167], v[172:175], 0
    ds_read_b128 v[216:219], v1 offset:10240
    v_mfma_f32_16x16x32_bf16 v[32:35], v[160:163], v[176:179], 0
    ds_read_b128 v[220:223], v1 offset:11264
    v_mfma_f32_16x16x32_bf16 v[36:39], v[164:167], v[176:179], 0
    ds_read_b128 v[224:227], v1 offset:12288
    v_mfma_f32_16x16x32_bf16 v[40:43], v[160:163], v[180:183], 0
    ds_read_b128 v[228:231], v1 offset:13312
    v_mfma_f32_16x16x32_bf16 v[44:47], v[164:167], v[180:183], 0
    ds_read_b128 v[232:235], v1 offset:14336
    s_waitcnt lgkmcnt(8)
    v_mfma_f32_16x16x32_bf16 v[48:51], v[160:163], v[184:187], 0
    ds_read_b128 v[236:239], v1 offset:15360
    v_mfma_f32_16x16x32_bf16 v[52:55], v[164:167], v[184:187], 0
    ds_read_b128 v[240:243], v1 offset:16384
    v_mfma_f32_16x16x32_bf16 v[56:59], v[160:163], v[188:191], 0
    ds_read_b128 v[244:247], v1 offset:17408
    v_mfma_f32_16x16x32_bf16 v[60:63], v[164:167], v[188:191], 0
    v_mfma_f32_16x16x32_bf16 v[64:67], v[160:163], v[192:195], 0
    v_mfma_f32_16x16x32_bf16 v[68:71], v[164:167], v[192:195], 0
    v_mfma_f32_16x16x32_bf16 v[72:75], v[160:163], v[196:199], 0
    v_mfma_f32_16x16x32_bf16 v[76:79], v[164:167], v[196:199], 0
    v_mfma_f32_16x16x32_bf16 v[80:83], v[160:163], v[200:203], 0
    v_mfma_f32_16x16x32_bf16 v[84:87], v[164:167], v[200:203], 0
    s_waitcnt lgkmcnt(0)
    s_barrier
    v_mfma_f32_16x16x32_bf16 v[16:19], v[204:207], v[212:215], v[16:19]
    ds_read_b128 v[160:163], v3 offset:36864
    v_mfma_f32_16x16x32_bf16 v[20:23], v[208:211], v[212:215], v[20:23]
    ds_read_b128 v[164:167], v3 offset:38912
    v_mfma_f32_16x16x32_bf16 v[24:27], v[204:207], v[216:219], v[24:27]
    ds_read_b128 v[168:171], v1 offset:36864
    v_mfma_f32_16x16x32_bf16 v[28:31], v[208:211], v[216:219], v[28:31]
    ds_read_b128 v[172:175], v1 offset:37888
    v_mfma_f32_16x16x32_bf16 v[32:35], v[204:207], v[220:223], v[32:35]
    ds_read_b128 v[176:179], v1 offset:38912
    v_mfma_f32_16x16x32_bf16 v[36:39], v[208:211], v[220:223], v[36:39]
    ds_read_b128 v[180:183], v1 offset:39936
    v_mfma_f32_16x16x32_bf16 v[40:43], v[204:207], v[224:227], v[40:43]
    ds_read_b128 v[184:187], v1 offset:40960
    v_mfma_f32_16x16x32_bf16 v[44:47], v[208:211], v[224:227], v[44:47]
    ds_read_b128 v[188:191], v1 offset:41984
    v_mfma_f32_16x16x32_bf16 v[48:51], v[204:207], v[228:231], v[48:51]
    ds_read_b128 v[192:195], v1 offset:43008
    v_mfma_f32_16x16x32_bf16 v[52:55], v[208:211], v[228:231], v[52:55]
    ds_read_b128 v[196:199], v1 offset:44032
    v_lshrrev_b32_e64 v5, 8, v1
    v_mfma_f32_16x16x32_bf16 v[56:59], v[204:207], v[232:235], v[56:59]
    ds_read_b128 v[200:203], v1 offset:45056
    v_bfe_u32 v6, v1, 4, 4
    v_mfma_f32_16x16x32_bf16 v[60:63], v[208:211], v[232:235], v[60:63]
    v_lshlrev_b32_e64 v7, 2, v6
    v_mfma_f32_16x16x32_bf16 v[64:67], v[204:207], v[236:239], v[64:67]
    s_lshl_b32 s33, s20, 8
    v_mfma_f32_16x16x32_bf16 v[68:71], v[208:211], v[236:239], v[68:71]
    s_add_u32 s33, s33, 147456
    v_mfma_f32_16x16x32_bf16 v[72:75], v[204:207], v[240:243], v[72:75]
    v_add_u32 v4, s33, v7
    v_mfma_f32_16x16x32_bf16 v[76:79], v[208:211], v[240:243], v[76:79]
    v_lshl_add_u32 v252, v5, 4, s33
    v_mfma_f32_16x16x32_bf16 v[80:83], v[204:207], v[244:247], v[80:83]
    v_add_u32 v7, 159744, v7
    v_mfma_f32_16x16x32_bf16 v[84:87], v[208:211], v[244:247], v[84:87]
    s_waitcnt vmcnt(0)
    v_add_f32_e64 v248, v8, v10
    s_waitcnt lgkmcnt(5)
    v_mfma_f32_16x16x32_bf16 v[16:19], v[160:163], v[168:171], v[16:19]
    ds_read_b128 v[204:207], v3 offset:37888
    v_mfma_f32_16x16x32_bf16 v[20:23], v[164:167], v[168:171], v[20:23]
    ds_read_b128 v[208:211], v3 offset:39936
    v_mfma_f32_16x16x32_bf16 v[24:27], v[160:163], v[172:175], v[24:27]
    ds_read_b128 v[212:215], v1 offset:46080
    v_mfma_f32_16x16x32_bf16 v[28:31], v[164:167], v[172:175], v[28:31]
    ds_read_b128 v[216:219], v1 offset:47104
    v_mfma_f32_16x16x32_bf16 v[32:35], v[160:163], v[176:179], v[32:35]
    ds_read_b128 v[220:223], v1 offset:48128
    v_mfma_f32_16x16x32_bf16 v[36:39], v[164:167], v[176:179], v[36:39]
    ds_read_b128 v[224:227], v1 offset:49152
    v_mfma_f32_16x16x32_bf16 v[40:43], v[160:163], v[180:183], v[40:43]
    ds_read_b128 v[228:231], v1 offset:50176
    v_mfma_f32_16x16x32_bf16 v[44:47], v[164:167], v[180:183], v[44:47]
    ds_read_b128 v[232:235], v1 offset:51200
    s_waitcnt lgkmcnt(8)
    v_mfma_f32_16x16x32_bf16 v[48:51], v[160:163], v[184:187], v[48:51]
    ds_read_b128 v[236:239], v1 offset:52224
    v_mfma_f32_16x16x32_bf16 v[52:55], v[164:167], v[184:187], v[52:55]
    ds_read_b128 v[240:243], v1 offset:53248
    v_add_f32 v249, v9, v11
    v_mfma_f32_16x16x32_bf16 v[56:59], v[160:163], v[188:191], v[56:59]
    ds_read_b128 v[244:247], v1 offset:54272
    v_add_f32_e64 v250, v12, v14
    v_mfma_f32_16x16x32_bf16 v[60:63], v[164:167], v[188:191], v[60:63]
    v_add_f32_e64 v251, v13, v15
    v_mfma_f32_16x16x32_bf16 v[64:67], v[160:163], v[192:195], v[64:67]
    v_mov_b32_e64 v8, v248
    v_mfma_f32_16x16x32_bf16 v[68:71], v[164:167], v[192:195], v[68:71]
    v_mov_b32_e64 v9, v249
    v_mfma_f32_16x16x32_bf16 v[72:75], v[160:163], v[196:199], v[72:75]
    v_mov_b32_e64 v12, v250
    v_mfma_f32_16x16x32_bf16 v[76:79], v[164:167], v[196:199], v[76:79]
    v_mov_b32_e64 v13, v251
    v_mfma_f32_16x16x32_bf16 v[80:83], v[160:163], v[200:203], v[80:83]
    v_permlane32_swap_b32 v248, v8
    v_mfma_f32_16x16x32_bf16 v[84:87], v[164:167], v[200:203], v[84:87]
    v_permlane32_swap_b32 v249, v9
    v_permlane32_swap_b32 v250, v12
    s_waitcnt lgkmcnt(0)
    s_barrier
    v_mfma_f32_16x16x32_bf16 v[16:19], v[204:207], v[212:215], v[16:19]
    ds_read_b128 v[160:163], v0 offset:0
    v_mfma_f32_16x16x32_bf16 v[20:23], v[208:211], v[212:215], v[20:23]
    ds_read_b128 v[164:167], v0 offset:2048
    v_mfma_f32_16x16x32_bf16 v[24:27], v[204:207], v[216:219], v[24:27]
    ds_read_b128 v[168:171], v2 offset:0
    v_mfma_f32_16x16x32_bf16 v[28:31], v[208:211], v[216:219], v[28:31]
    ds_read_b128 v[172:175], v2 offset:1024
    v_mfma_f32_16x16x32_bf16 v[32:35], v[204:207], v[220:223], v[32:35]
    ds_read_b128 v[176:179], v2 offset:2048
    v_mfma_f32_16x16x32_bf16 v[36:39], v[208:211], v[220:223], v[36:39]
    ds_read_b128 v[180:183], v2 offset:3072
    v_mfma_f32_16x16x32_bf16 v[40:43], v[204:207], v[224:227], v[40:43]
    ds_read_b128 v[184:187], v2 offset:4096
    v_mfma_f32_16x16x32_bf16 v[44:47], v[208:211], v[224:227], v[44:47]
    ds_read_b128 v[188:191], v2 offset:5120
    v_mfma_f32_16x16x32_bf16 v[48:51], v[204:207], v[228:231], v[48:51]
    ds_read_b128 v[192:195], v2 offset:6144
    v_mfma_f32_16x16x32_bf16 v[52:55], v[208:211], v[228:231], v[52:55]
    ds_read_b128 v[196:199], v2 offset:7168
    v_permlane32_swap_b32 v251, v13
    v_mfma_f32_16x16x32_bf16 v[56:59], v[204:207], v[232:235], v[56:59]
    ds_read_b128 v[200:203], v2 offset:8192
    v_add_f32_e64 v248, v248, v8
    v_mfma_f32_16x16x32_bf16 v[60:63], v[208:211], v[232:235], v[60:63]
    ds_read2_b32 v[128:129], v7 offset0:0 offset1:16
    v_add_f32_e64 v249, v249, v9
    v_mfma_f32_16x16x32_bf16 v[64:67], v[204:207], v[236:239], v[64:67]
    ds_read2_b32 v[130:131], v7 offset0:32 offset1:48
    v_add_f32_e64 v250, v250, v12
    v_mfma_f32_16x16x32_bf16 v[68:71], v[208:211], v[236:239], v[68:71]
    ds_read2_b32 v[132:133], v7 offset0:64 offset1:80
    v_add_f32_e64 v251, v251, v13
    v_mfma_f32_16x16x32_bf16 v[72:75], v[204:207], v[240:243], v[72:75]
    ds_read2_b32 v[134:135], v7 offset0:96 offset1:112
    v_mov_b32_e64 v8, v248
    v_mfma_f32_16x16x32_bf16 v[76:79], v[208:211], v[240:243], v[76:79]
    ds_read2_b32 v[136:137], v7 offset0:128 offset1:144
    v_mov_b32_e64 v9, v249
    v_mfma_f32_16x16x32_bf16 v[80:83], v[204:207], v[244:247], v[80:83]
    v_mov_b32_e64 v12, v250
    v_mfma_f32_16x16x32_bf16 v[84:87], v[208:211], v[244:247], v[84:87]
    v_mov_b32_e64 v13, v251
    v_permlane16_swap_b32 v248, v8
    s_waitcnt lgkmcnt(10)
    v_mfma_f32_16x16x32_bf16 v[16:19], v[160:163], v[168:171], v[16:19]
    ds_read_b128 v[204:207], v0 offset:1024
    v_mfma_f32_16x16x32_bf16 v[20:23], v[164:167], v[168:171], v[20:23]
    ds_read_b128 v[208:211], v0 offset:3072
    v_mfma_f32_16x16x32_bf16 v[24:27], v[160:163], v[172:175], v[24:27]
    ds_read_b128 v[212:215], v2 offset:9216
    v_mfma_f32_16x16x32_bf16 v[28:31], v[164:167], v[172:175], v[28:31]
    ds_read_b128 v[216:219], v2 offset:10240
    v_mfma_f32_16x16x32_bf16 v[32:35], v[160:163], v[176:179], v[32:35]
    ds_read_b128 v[220:223], v2 offset:11264
    v_mfma_f32_16x16x32_bf16 v[36:39], v[164:167], v[176:179], v[36:39]
    ds_read_b128 v[224:227], v2 offset:12288
    v_mfma_f32_16x16x32_bf16 v[40:43], v[160:163], v[180:183], v[40:43]
    ds_read_b128 v[228:231], v2 offset:13312
    v_mfma_f32_16x16x32_bf16 v[44:47], v[164:167], v[180:183], v[44:47]
    ds_read_b128 v[232:235], v2 offset:14336
    s_waitcnt lgkmcnt(8)
    v_mfma_f32_16x16x32_bf16 v[48:51], v[160:163], v[184:187], v[48:51]
    ds_read_b128 v[236:239], v2 offset:15360
    v_mfma_f32_16x16x32_bf16 v[52:55], v[164:167], v[184:187], v[52:55]
    ds_read_b128 v[240:243], v2 offset:16384
    v_permlane16_swap_b32 v249, v9
    v_mfma_f32_16x16x32_bf16 v[56:59], v[160:163], v[188:191], v[56:59]
    ds_read_b128 v[244:247], v2 offset:17408
    v_permlane16_swap_b32 v250, v12
    v_mfma_f32_16x16x32_bf16 v[60:63], v[164:167], v[188:191], v[60:63]
    v_permlane16_swap_b32 v251, v13
    v_mfma_f32_16x16x32_bf16 v[64:67], v[160:163], v[192:195], v[64:67]
    v_add_f32_e64 v248, v248, v8
    v_mfma_f32_16x16x32_bf16 v[68:71], v[164:167], v[192:195], v[68:71]
    v_add_f32_e64 v249, v249, v9
    v_mfma_f32_16x16x32_bf16 v[72:75], v[160:163], v[196:199], v[72:75]
    v_add_f32_e64 v250, v250, v12
    v_mfma_f32_16x16x32_bf16 v[76:79], v[164:167], v[196:199], v[76:79]
    v_add_f32_e64 v251, v251, v13
    v_mfma_f32_16x16x32_bf16 v[80:83], v[160:163], v[200:203], v[80:83]
    v_mul_f32 v248, 0x3ae38e39, v248
    v_mfma_f32_16x16x32_bf16 v[84:87], v[164:167], v[200:203], v[84:87]
    v_mul_f32 v249, 0x3ae38e39, v249
    v_mul_f32 v250, 0x3ae38e39, v250
    s_waitcnt lgkmcnt(0)
    s_barrier
    v_mfma_f32_16x16x32_bf16 v[16:19], v[204:207], v[212:215], v[16:19]
    ds_read_b128 v[160:163], v0 offset:36864
    v_mfma_f32_16x16x32_bf16 v[20:23], v[208:211], v[212:215], v[20:23]
    ds_read_b128 v[164:167], v0 offset:38912
    v_mfma_f32_16x16x32_bf16 v[24:27], v[204:207], v[216:219], v[24:27]
    ds_read_b128 v[168:171], v2 offset:36864
    v_mfma_f32_16x16x32_bf16 v[28:31], v[208:211], v[216:219], v[28:31]
    ds_read_b128 v[172:175], v2 offset:37888
    v_mfma_f32_16x16x32_bf16 v[32:35], v[204:207], v[220:223], v[32:35]
    ds_read_b128 v[176:179], v2 offset:38912
    v_mfma_f32_16x16x32_bf16 v[36:39], v[208:211], v[220:223], v[36:39]
    ds_read_b128 v[180:183], v2 offset:39936
    v_mfma_f32_16x16x32_bf16 v[40:43], v[204:207], v[224:227], v[40:43]
    ds_read_b128 v[184:187], v2 offset:40960
    v_mfma_f32_16x16x32_bf16 v[44:47], v[208:211], v[224:227], v[44:47]
    ds_read_b128 v[188:191], v2 offset:41984
    v_mfma_f32_16x16x32_bf16 v[48:51], v[204:207], v[228:231], v[48:51]
    ds_read_b128 v[192:195], v2 offset:43008
    v_mfma_f32_16x16x32_bf16 v[52:55], v[208:211], v[228:231], v[52:55]
    ds_read_b128 v[196:199], v2 offset:44032
    v_mul_f32 v251, 0x3ae38e39, v251
    v_mfma_f32_16x16x32_bf16 v[56:59], v[204:207], v[232:235], v[56:59]
    ds_read_b128 v[200:203], v2 offset:45056
    v_fma_f32 v249, -v248, v248, v249
    v_mfma_f32_16x16x32_bf16 v[60:63], v[208:211], v[232:235], v[60:63]
    v_fma_f32 v251, -v250, v250, v251
    v_mfma_f32_16x16x32_bf16 v[64:67], v[204:207], v[236:239], v[64:67]
    v_max_f32_e64 v249, 0, v249
    v_mfma_f32_16x16x32_bf16 v[68:71], v[208:211], v[236:239], v[68:71]
    v_max_f32_e64 v251, 0, v251
    v_mfma_f32_16x16x32_bf16 v[72:75], v[204:207], v[240:243], v[72:75]
    v_add_f32 v249, 0x3727c5ac, v249
    v_mfma_f32_16x16x32_bf16 v[76:79], v[208:211], v[240:243], v[76:79]
    v_add_f32 v251, 0x3727c5ac, v251
    v_mfma_f32_16x16x32_bf16 v[80:83], v[204:207], v[244:247], v[80:83]
    v_rsq_f32_e64 v249, v249
    v_mfma_f32_16x16x32_bf16 v[84:87], v[208:211], v[244:247], v[84:87]
    v_rsq_f32_e64 v251, v251
    s_nop 0
    s_waitcnt lgkmcnt(5)
    v_mfma_f32_16x16x32_bf16 v[16:19], v[160:163], v[168:171], v[16:19]
    ds_read_b128 v[204:207], v0 offset:37888
    v_mfma_f32_16x16x32_bf16 v[20:23], v[164:167], v[168:171], v[20:23]
    ds_read_b128 v[208:211], v0 offset:39936
    v_mfma_f32_16x16x32_bf16 v[24:27], v[160:163], v[172:175], v[24:27]
    ds_read_b128 v[212:215], v2 offset:46080
    v_mfma_f32_16x16x32_bf16 v[28:31], v[164:167], v[172:175], v[28:31]
    ds_read_b128 v[216:219], v2 offset:47104
    v_mfma_f32_16x16x32_bf16 v[32:35], v[160:163], v[176:179], v[32:35]
    ds_read_b128 v[220:223], v2 offset:48128
    v_mfma_f32_16x16x32_bf16 v[36:39], v[164:167], v[176:179], v[36:39]
    ds_read_b128 v[224:227], v2 offset:49152
    v_mfma_f32_16x16x32_bf16 v[40:43], v[160:163], v[180:183], v[40:43]
    ds_read_b128 v[228:231], v2 offset:50176
    v_mfma_f32_16x16x32_bf16 v[44:47], v[164:167], v[180:183], v[44:47]
    ds_read_b128 v[232:235], v2 offset:51200
    s_waitcnt lgkmcnt(8)
    v_mfma_f32_16x16x32_bf16 v[48:51], v[160:163], v[184:187], v[48:51]
    ds_read_b128 v[236:239], v2 offset:52224
    v_mfma_f32_16x16x32_bf16 v[52:55], v[164:167], v[184:187], v[52:55]
    ds_read_b128 v[240:243], v2 offset:53248
    v_mfma_f32_16x16x32_bf16 v[56:59], v[160:163], v[188:191], v[56:59]
    ds_read_b128 v[244:247], v2 offset:54272
    v_mfma_f32_16x16x32_bf16 v[60:63], v[164:167], v[188:191], v[60:63]
    v_mfma_f32_16x16x32_bf16 v[64:67], v[160:163], v[192:195], v[64:67]
    v_mfma_f32_16x16x32_bf16 v[68:71], v[164:167], v[192:195], v[68:71]
    v_mfma_f32_16x16x32_bf16 v[72:75], v[160:163], v[196:199], v[72:75]
    v_mfma_f32_16x16x32_bf16 v[76:79], v[164:167], v[196:199], v[76:79]
    v_mfma_f32_16x16x32_bf16 v[80:83], v[160:163], v[200:203], v[80:83]
    v_mfma_f32_16x16x32_bf16 v[84:87], v[164:167], v[200:203], v[84:87]
    s_waitcnt lgkmcnt(0)
    s_barrier
    v_mfma_f32_16x16x32_bf16 v[16:19], v[204:207], v[212:215], v[16:19]
    ds_read_b128 v[160:163], v3 offset:0
    v_mfma_f32_16x16x32_bf16 v[20:23], v[208:211], v[212:215], v[20:23]
    ds_read_b128 v[164:167], v3 offset:2048
    v_mfma_f32_16x16x32_bf16 v[24:27], v[204:207], v[216:219], v[24:27]
    ds_read_b128 v[168:171], v1 offset:0
    v_mfma_f32_16x16x32_bf16 v[28:31], v[208:211], v[216:219], v[28:31]
    ds_read_b128 v[172:175], v1 offset:1024
    v_mfma_f32_16x16x32_bf16 v[32:35], v[204:207], v[220:223], v[32:35]
    ds_read_b128 v[176:179], v1 offset:2048
    v_mfma_f32_16x16x32_bf16 v[36:39], v[208:211], v[220:223], v[36:39]
    ds_read_b128 v[180:183], v1 offset:3072
    v_mfma_f32_16x16x32_bf16 v[40:43], v[204:207], v[224:227], v[40:43]
    ds_read_b128 v[184:187], v1 offset:4096
    v_mfma_f32_16x16x32_bf16 v[44:47], v[208:211], v[224:227], v[44:47]
    ds_read_b128 v[188:191], v1 offset:5120
    v_mfma_f32_16x16x32_bf16 v[48:51], v[204:207], v[228:231], v[48:51]
    ds_read_b128 v[192:195], v1 offset:6144
    v_mfma_f32_16x16x32_bf16 v[52:55], v[208:211], v[228:231], v[52:55]
    ds_read_b128 v[196:199], v1 offset:7168
    v_mfma_f32_16x16x32_bf16 v[56:59], v[204:207], v[232:235], v[56:59]
    ds_read_b128 v[200:203], v1 offset:8192
    v_mfma_f32_16x16x32_bf16 v[60:63], v[208:211], v[232:235], v[60:63]
    ds_write2_b32 v4, v248, v249 offset0:0 offset1:32
    v_mfma_f32_16x16x32_bf16 v[64:67], v[204:207], v[236:239], v[64:67]
    ds_write2_b32 v4, v250, v251 offset0:16 offset1:48
    v_mfma_f32_16x16x32_bf16 v[68:71], v[208:211], v[236:239], v[68:71]
    ds_read_b128 v[88:91], v252 offset:0
    v_mfma_f32_16x16x32_bf16 v[72:75], v[204:207], v[240:243], v[72:75]
    ds_read_b128 v[92:95], v252 offset:64
    v_mfma_f32_16x16x32_bf16 v[76:79], v[208:211], v[240:243], v[76:79]
    ds_read_b128 v[96:99], v252 offset:128
    v_mfma_f32_16x16x32_bf16 v[80:83], v[204:207], v[244:247], v[80:83]
    ds_read_b128 v[100:103], v252 offset:192
    v_mfma_f32_16x16x32_bf16 v[84:87], v[208:211], v[244:247], v[84:87]
    s_waitcnt lgkmcnt(11)
    v_mfma_f32_16x16x32_bf16 v[16:19], v[160:163], v[168:171], v[16:19]
    ds_read_b128 v[204:207], v3 offset:1024
    v_mfma_f32_16x16x32_bf16 v[20:23], v[164:167], v[168:171], v[20:23]
    ds_read_b128 v[208:211], v3 offset:3072
    v_mfma_f32_16x16x32_bf16 v[24:27], v[160:163], v[172:175], v[24:27]
    ds_read_b128 v[212:215], v1 offset:9216
    v_mfma_f32_16x16x32_bf16 v[28:31], v[164:167], v[172:175], v[28:31]
    ds_read_b128 v[216:219], v1 offset:10240
    v_mfma_f32_16x16x32_bf16 v[32:35], v[160:163], v[176:179], v[32:35]
    ds_read_b128 v[220:223], v1 offset:11264
    v_mfma_f32_16x16x32_bf16 v[36:39], v[164:167], v[176:179], v[36:39]
    ds_read_b128 v[224:227], v1 offset:12288
    v_mfma_f32_16x16x32_bf16 v[40:43], v[160:163], v[180:183], v[40:43]
    ds_read_b128 v[228:231], v1 offset:13312
    v_mfma_f32_16x16x32_bf16 v[44:47], v[164:167], v[180:183], v[44:47]
    ds_read_b128 v[232:235], v1 offset:14336
    s_waitcnt lgkmcnt(8)
    v_mfma_f32_16x16x32_bf16 v[48:51], v[160:163], v[184:187], v[48:51]
    ds_read_b128 v[236:239], v1 offset:15360
    v_mfma_f32_16x16x32_bf16 v[52:55], v[164:167], v[184:187], v[52:55]
    ds_read_b128 v[240:243], v1 offset:16384
    v_rcp_f32 v120, v96
    v_mfma_f32_16x16x32_bf16 v[56:59], v[160:163], v[188:191], v[56:59]
    ds_read_b128 v[244:247], v1 offset:17408
    v_mul_f32_e64 v104, s40, v96
    v_mfma_f32_16x16x32_bf16 v[60:63], v[164:167], v[188:191], v[60:63]
    v_mul_f32_e64 v112, v96, v96
    v_mfma_f32_16x16x32_bf16 v[64:67], v[160:163], v[192:195], v[64:67]
    v_rcp_f32_e64 v121, v97
    v_mfma_f32_16x16x32_bf16 v[68:71], v[164:167], v[192:195], v[68:71]
    v_mul_f32_e64 v105, s40, v97
    v_mfma_f32_16x16x32_bf16 v[72:75], v[160:163], v[196:199], v[72:75]
    v_mul_f32_e64 v113, v97, v97
    v_mfma_f32_16x16x32_bf16 v[76:79], v[164:167], v[196:199], v[76:79]
    v_rcp_f32_e64 v122, v98
    v_mfma_f32_16x16x32_bf16 v[80:83], v[160:163], v[200:203], v[80:83]
    v_mul_f32_e64 v106, s40, v98
    v_mfma_f32_16x16x32_bf16 v[84:87], v[164:167], v[200:203], v[84:87]
    v_mul_f32 v114, v98, v98
    v_rcp_f32 v123, v99
    s_waitcnt lgkmcnt(0)
    s_barrier
    v_mfma_f32_16x16x32_bf16 v[16:19], v[204:207], v[212:215], v[16:19]
    ds_read_b128 v[160:163], v3 offset:36864
    v_mfma_f32_16x16x32_bf16 v[20:23], v[208:211], v[212:215], v[20:23]
    ds_read_b128 v[164:167], v3 offset:38912
    v_mfma_f32_16x16x32_bf16 v[24:27], v[204:207], v[216:219], v[24:27]
    ds_read_b128 v[168:171], v1 offset:36864
    v_mfma_f32_16x16x32_bf16 v[28:31], v[208:211], v[216:219], v[28:31]
    ds_read_b128 v[172:175], v1 offset:37888
    v_mfma_f32_16x16x32_bf16 v[32:35], v[204:207], v[220:223], v[32:35]
    ds_read_b128 v[176:179], v1 offset:38912
    v_mfma_f32_16x16x32_bf16 v[36:39], v[208:211], v[220:223], v[36:39]
    ds_read_b128 v[180:183], v1 offset:39936
    v_mfma_f32_16x16x32_bf16 v[40:43], v[204:207], v[224:227], v[40:43]
    ds_read_b128 v[184:187], v1 offset:40960
    v_mfma_f32_16x16x32_bf16 v[44:47], v[208:211], v[224:227], v[44:47]
    ds_read_b128 v[188:191], v1 offset:41984
    v_mfma_f32_16x16x32_bf16 v[48:51], v[204:207], v[228:231], v[48:51]
    ds_read_b128 v[192:195], v1 offset:43008
    v_mfma_f32_16x16x32_bf16 v[52:55], v[208:211], v[228:231], v[52:55]
    ds_read_b128 v[196:199], v1 offset:44032
    v_mul_f32_e64 v107, s40, v99
    v_mfma_f32_16x16x32_bf16 v[56:59], v[204:207], v[232:235], v[56:59]
    ds_read_b128 v[200:203], v1 offset:45056
    v_mul_f32_e64 v115, v99, v99
    v_mfma_f32_16x16x32_bf16 v[60:63], v[208:211], v[232:235], v[60:63]
    v_rcp_f32_e64 v124, v100
    v_mfma_f32_16x16x32_bf16 v[64:67], v[204:207], v[236:239], v[64:67]
    v_mul_f32_e64 v108, s40, v100
    v_mfma_f32_16x16x32_bf16 v[68:71], v[208:211], v[236:239], v[68:71]
    v_mul_f32_e64 v116, v100, v100
    v_mfma_f32_16x16x32_bf16 v[72:75], v[204:207], v[240:243], v[72:75]
    v_rcp_f32_e64 v125, v101
    v_mfma_f32_16x16x32_bf16 v[76:79], v[208:211], v[240:243], v[76:79]
    v_mul_f32_e64 v109, s40, v101
    v_mfma_f32_16x16x32_bf16 v[80:83], v[204:207], v[244:247], v[80:83]
    v_mul_f32_e64 v117, v101, v101
    v_mfma_f32_16x16x32_bf16 v[84:87], v[208:211], v[244:247], v[84:87]
    v_rcp_f32 v126, v102
    v_mul_f32_e64 v110, s40, v102
    s_waitcnt lgkmcnt(5)
    v_mfma_f32_16x16x32_bf16 v[16:19], v[160:163], v[168:171], v[16:19]
    ds_read_b128 v[204:207], v3 offset:37888
    v_mfma_f32_16x16x32_bf16 v[20:23], v[164:167], v[168:171], v[20:23]
    ds_read_b128 v[208:211], v3 offset:39936
    v_mfma_f32_16x16x32_bf16 v[24:27], v[160:163], v[172:175], v[24:27]
    ds_read_b128 v[212:215], v1 offset:46080
    v_mfma_f32_16x16x32_bf16 v[28:31], v[164:167], v[172:175], v[28:31]
    ds_read_b128 v[216:219], v1 offset:47104
    v_mfma_f32_16x16x32_bf16 v[32:35], v[160:163], v[176:179], v[32:35]
    ds_read_b128 v[220:223], v1 offset:48128
    v_mfma_f32_16x16x32_bf16 v[36:39], v[164:167], v[176:179], v[36:39]
    ds_read_b128 v[224:227], v1 offset:49152
    v_mfma_f32_16x16x32_bf16 v[40:43], v[160:163], v[180:183], v[40:43]
    ds_read_b128 v[228:231], v1 offset:50176
    v_mfma_f32_16x16x32_bf16 v[44:47], v[164:167], v[180:183], v[44:47]
    ds_read_b128 v[232:235], v1 offset:51200
    s_waitcnt lgkmcnt(8)
    v_mfma_f32_16x16x32_bf16 v[48:51], v[160:163], v[184:187], v[48:51]
    ds_read_b128 v[236:239], v1 offset:52224
    v_mfma_f32_16x16x32_bf16 v[52:55], v[164:167], v[184:187], v[52:55]
    ds_read_b128 v[240:243], v1 offset:53248
    v_mul_f32 v118, v102, v102
    v_mfma_f32_16x16x32_bf16 v[56:59], v[160:163], v[188:191], v[56:59]
    ds_read_b128 v[244:247], v1 offset:54272
    v_rcp_f32_e64 v127, v103
    v_mfma_f32_16x16x32_bf16 v[60:63], v[164:167], v[188:191], v[60:63]
    v_mul_f32_e64 v111, s40, v103
    v_mfma_f32_16x16x32_bf16 v[64:67], v[160:163], v[192:195], v[64:67]
    v_mul_f32_e64 v119, v103, v103
    v_mfma_f32_16x16x32_bf16 v[68:71], v[164:167], v[192:195], v[68:71]
    v_mul_f32_e64 v112, s42, v112
    v_mfma_f32_16x16x32_bf16 v[72:75], v[160:163], v[196:199], v[72:75]
    v_mul_f32_e64 v113, s42, v113
    v_mfma_f32_16x16x32_bf16 v[76:79], v[164:167], v[196:199], v[76:79]
    v_mul_f32_e64 v114, s42, v114
    v_mfma_f32_16x16x32_bf16 v[80:83], v[160:163], v[200:203], v[80:83]
    v_mul_f32_e64 v115, s42, v115
    v_mfma_f32_16x16x32_bf16 v[84:87], v[164:167], v[200:203], v[84:87]
    v_mul_f32 v116, s42, v116
    v_mul_f32 v117, s42, v117
    s_waitcnt lgkmcnt(0)
    s_barrier
    v_mfma_f32_16x16x32_bf16 v[16:19], v[204:207], v[212:215], v[16:19]
    ds_read_b128 v[160:163], v0 offset:0
    v_mfma_f32_16x16x32_bf16 v[20:23], v[208:211], v[212:215], v[20:23]
    ds_read_b128 v[164:167], v0 offset:2048
    v_mfma_f32_16x16x32_bf16 v[24:27], v[204:207], v[216:219], v[24:27]
    ds_read_b128 v[168:171], v2 offset:0
    v_mfma_f32_16x16x32_bf16 v[28:31], v[208:211], v[216:219], v[28:31]
    ds_read_b128 v[172:175], v2 offset:1024
    v_mfma_f32_16x16x32_bf16 v[32:35], v[204:207], v[220:223], v[32:35]
    ds_read_b128 v[176:179], v2 offset:2048
    v_mfma_f32_16x16x32_bf16 v[36:39], v[208:211], v[220:223], v[36:39]
    ds_read_b128 v[180:183], v2 offset:3072
    v_mfma_f32_16x16x32_bf16 v[40:43], v[204:207], v[224:227], v[40:43]
    ds_read_b128 v[184:187], v2 offset:4096
    v_mfma_f32_16x16x32_bf16 v[44:47], v[208:211], v[224:227], v[44:47]
    ds_read_b128 v[188:191], v2 offset:5120
    v_mfma_f32_16x16x32_bf16 v[48:51], v[204:207], v[228:231], v[48:51]
    ds_read_b128 v[192:195], v2 offset:6144
    v_mfma_f32_16x16x32_bf16 v[52:55], v[208:211], v[228:231], v[52:55]
    ds_read_b128 v[196:199], v2 offset:7168
    v_mul_f32_e64 v118, s42, v118
    v_mfma_f32_16x16x32_bf16 v[56:59], v[204:207], v[232:235], v[56:59]
    ds_read_b128 v[200:203], v2 offset:8192
    v_mul_f32_e64 v119, s42, v119
    v_mfma_f32_16x16x32_bf16 v[60:63], v[208:211], v[232:235], v[60:63]
    v_mul_f32_e64 v112, v112, v104
    v_mfma_f32_16x16x32_bf16 v[64:67], v[204:207], v[236:239], v[64:67]
    v_mul_f32_e64 v113, v113, v105
    v_mfma_f32_16x16x32_bf16 v[68:71], v[208:211], v[236:239], v[68:71]
    v_mul_f32_e64 v114, v114, v106
    v_mfma_f32_16x16x32_bf16 v[72:75], v[204:207], v[240:243], v[72:75]
    v_mul_f32_e64 v115, v115, v107
    v_mfma_f32_16x16x32_bf16 v[76:79], v[208:211], v[240:243], v[76:79]
    v_mul_f32_e64 v116, v116, v108
    v_mfma_f32_16x16x32_bf16 v[80:83], v[204:207], v[244:247], v[80:83]
    v_mul_f32_e64 v117, v117, v109
    v_mfma_f32_16x16x32_bf16 v[84:87], v[208:211], v[244:247], v[84:87]
    v_mul_f32 v118, v118, v110
    v_mul_f32_e64 v119, v119, v111
    s_waitcnt lgkmcnt(5)
    v_mfma_f32_16x16x32_bf16 v[16:19], v[160:163], v[168:171], v[16:19]
    ds_read_b128 v[204:207], v0 offset:1024
    v_mfma_f32_16x16x32_bf16 v[20:23], v[164:167], v[168:171], v[20:23]
    ds_read_b128 v[208:211], v0 offset:3072
    v_mfma_f32_16x16x32_bf16 v[24:27], v[160:163], v[172:175], v[24:27]
    ds_read_b128 v[212:215], v2 offset:9216
    v_mfma_f32_16x16x32_bf16 v[28:31], v[164:167], v[172:175], v[28:31]
    ds_read_b128 v[216:219], v2 offset:10240
    v_mfma_f32_16x16x32_bf16 v[32:35], v[160:163], v[176:179], v[32:35]
    ds_read_b128 v[220:223], v2 offset:11264
    v_mfma_f32_16x16x32_bf16 v[36:39], v[164:167], v[176:179], v[36:39]
    ds_read_b128 v[224:227], v2 offset:12288
    v_mfma_f32_16x16x32_bf16 v[40:43], v[160:163], v[180:183], v[40:43]
    ds_read_b128 v[228:231], v2 offset:13312
    v_mfma_f32_16x16x32_bf16 v[44:47], v[164:167], v[180:183], v[44:47]
    ds_read_b128 v[232:235], v2 offset:14336
    s_waitcnt lgkmcnt(8)
    v_mfma_f32_16x16x32_bf16 v[48:51], v[160:163], v[184:187], v[48:51]
    ds_read_b128 v[236:239], v2 offset:15360
    v_mfma_f32_16x16x32_bf16 v[52:55], v[164:167], v[184:187], v[52:55]
    ds_read_b128 v[240:243], v2 offset:16384
    v_lshrrev_b32 v8, 2, v6
    v_mfma_f32_16x16x32_bf16 v[56:59], v[160:163], v[188:191], v[56:59]
    ds_read_b128 v[244:247], v2 offset:17408
    v_lshlrev_b32_e64 v8, 4, v8
    v_mfma_f32_16x16x32_bf16 v[60:63], v[164:167], v[188:191], v[60:63]
    v_lshl_add_u32 v8, v5, 6, v8
    v_mfma_f32_16x16x32_bf16 v[64:67], v[160:163], v[192:195], v[64:67]
    v_and_b32_e64 v9, 3, v6
    v_mfma_f32_16x16x32_bf16 v[68:71], v[164:167], v[192:195], v[68:71]
    v_cmp_eq_u32_e64 vcc, 0, v9
    v_mfma_f32_16x16x32_bf16 v[72:75], v[160:163], v[196:199], v[72:75]
    v_bfrev_b32_e64 v10, 1
    v_mfma_f32_16x16x32_bf16 v[76:79], v[164:167], v[196:199], v[76:79]
    v_xor_b32 v4, 256, v4
    v_mfma_f32_16x16x32_bf16 v[80:83], v[160:163], v[200:203], v[80:83]
    v_cndmask_b32_e64 v8, v10, v8, vcc
    v_mfma_f32_16x16x32_bf16 v[84:87], v[164:167], v[200:203], v[84:87]
    v_lshl_add_u32 v255, v5, 6, s33
    s_waitcnt lgkmcnt(0)
    s_barrier
    v_mfma_f32_16x16x32_bf16 v[16:19], v[204:207], v[212:215], v[16:19]
    ds_read_b128 v[160:163], v0 offset:36864
    v_fma_f32 v52, -v92, v132, v52
    v_mfma_f32_16x16x32_bf16 v[20:23], v[208:211], v[212:215], v[20:23]
    ds_read_b128 v[164:167], v0 offset:38912
    v_fma_f32 v56, -v88, v133, v56
    v_mfma_f32_16x16x32_bf16 v[24:27], v[204:207], v[216:219], v[24:27]
    ds_read_b128 v[168:171], v2 offset:36864
    v_fma_f32 v60, -v92, v133, v60
    v_mfma_f32_16x16x32_bf16 v[28:31], v[208:211], v[216:219], v[28:31]
    ds_read_b128 v[172:175], v2 offset:37888
    v_fma_f32 v64, -v88, v134, v64
    v_mfma_f32_16x16x32_bf16 v[32:35], v[204:207], v[220:223], v[32:35]
    ds_read_b128 v[176:179], v2 offset:38912
    v_fma_f32 v68, -v92, v134, v68
    v_mfma_f32_16x16x32_bf16 v[36:39], v[208:211], v[220:223], v[36:39]
    ds_read_b128 v[180:183], v2 offset:39936
    v_fma_f32 v72, -v88, v135, v72
    v_mfma_f32_16x16x32_bf16 v[40:43], v[204:207], v[224:227], v[40:43]
    ds_read_b128 v[184:187], v2 offset:40960
    v_fma_f32 v76, -v92, v135, v76
    v_mfma_f32_16x16x32_bf16 v[44:47], v[208:211], v[224:227], v[44:47]
    ds_read_b128 v[188:191], v2 offset:41984
    v_fma_f32 v80, -v88, v136, v80
    v_mfma_f32_16x16x32_bf16 v[48:51], v[204:207], v[228:231], v[48:51]
    ds_read_b128 v[192:195], v2 offset:43008
    v_fma_f32 v84, -v92, v136, v84
    v_mfma_f32_16x16x32_bf16 v[52:55], v[208:211], v[228:231], v[52:55]
    ds_read_b128 v[196:199], v2 offset:44032
    v_fma_f32 v16, -v88, v128, v16
    v_mfma_f32_16x16x32_bf16 v[56:59], v[204:207], v[232:235], v[56:59]
    ds_read_b128 v[200:203], v2 offset:45056
    v_fma_f32 v20, -v92, v128, v20
    v_mfma_f32_16x16x32_bf16 v[60:63], v[208:211], v[232:235], v[60:63]
    v_fma_f32 v24, -v88, v129, v24
    v_mfma_f32_16x16x32_bf16 v[64:67], v[204:207], v[236:239], v[64:67]
    v_fma_f32 v28, -v92, v129, v28
    v_mfma_f32_16x16x32_bf16 v[68:71], v[208:211], v[236:239], v[68:71]
    v_fma_f32 v32, -v88, v130, v32
    v_mfma_f32_16x16x32_bf16 v[72:75], v[204:207], v[240:243], v[72:75]
    v_fma_f32 v36, -v92, v130, v36
    v_mfma_f32_16x16x32_bf16 v[76:79], v[208:211], v[240:243], v[76:79]
    v_fma_f32 v40, -v88, v131, v40
    v_mfma_f32_16x16x32_bf16 v[80:83], v[204:207], v[244:247], v[80:83]
    v_fma_f32 v44, -v92, v131, v44
    v_mfma_f32_16x16x32_bf16 v[84:87], v[208:211], v[244:247], v[84:87]
    v_fma_f32 v48, -v88, v132, v48
    s_waitcnt lgkmcnt(5)
    v_mfma_f32_16x16x32_bf16 v[16:19], v[160:163], v[168:171], v[16:19]
    ds_read_b128 v[204:207], v0 offset:37888
    v_fma_f32 v53, -v93, v132, v53
    v_mfma_f32_16x16x32_bf16 v[20:23], v[164:167], v[168:171], v[20:23]
    ds_read_b128 v[208:211], v0 offset:39936
    v_fma_f32 v57, -v89, v133, v57
    v_mfma_f32_16x16x32_bf16 v[24:27], v[160:163], v[172:175], v[24:27]
    ds_read_b128 v[212:215], v2 offset:46080
    v_fma_f32 v61, -v93, v133, v61
    v_mfma_f32_16x16x32_bf16 v[28:31], v[164:167], v[172:175], v[28:31]
    ds_read_b128 v[216:219], v2 offset:47104
    v_fma_f32 v65, -v89, v134, v65
    v_mfma_f32_16x16x32_bf16 v[32:35], v[160:163], v[176:179], v[32:35]
    ds_read_b128 v[220:223], v2 offset:48128
    v_fma_f32 v69, -v93, v134, v69
    v_mfma_f32_16x16x32_bf16 v[36:39], v[164:167], v[176:179], v[36:39]
    ds_read_b128 v[224:227], v2 offset:49152
    v_fma_f32 v73, -v89, v135, v73
    v_mfma_f32_16x16x32_bf16 v[40:43], v[160:163], v[180:183], v[40:43]
    ds_read_b128 v[228:231], v2 offset:50176
    v_fma_f32 v77, -v93, v135, v77
    v_mfma_f32_16x16x32_bf16 v[44:47], v[164:167], v[180:183], v[44:47]
    ds_read_b128 v[232:235], v2 offset:51200
    s_waitcnt lgkmcnt(8)
    v_fma_f32 v81, -v89, v136, v81
    v_mfma_f32_16x16x32_bf16 v[48:51], v[160:163], v[184:187], v[48:51]
    ds_read_b128 v[236:239], v2 offset:52224
    v_fma_f32 v85, -v93, v136, v85
    v_mfma_f32_16x16x32_bf16 v[52:55], v[164:167], v[184:187], v[52:55]
    ds_read_b128 v[240:243], v2 offset:53248
    v_fma_f32 v17, -v89, v128, v17
    v_mfma_f32_16x16x32_bf16 v[56:59], v[160:163], v[188:191], v[56:59]
    ds_read_b128 v[244:247], v2 offset:54272
    v_fma_f32 v21, -v93, v128, v21
    v_mfma_f32_16x16x32_bf16 v[60:63], v[164:167], v[188:191], v[60:63]
    v_fma_f32 v25, -v89, v129, v25
    v_mfma_f32_16x16x32_bf16 v[64:67], v[160:163], v[192:195], v[64:67]
    v_fma_f32 v29, -v93, v129, v29
    v_mfma_f32_16x16x32_bf16 v[68:71], v[164:167], v[192:195], v[68:71]
    v_fma_f32 v33, -v89, v130, v33
    v_mfma_f32_16x16x32_bf16 v[72:75], v[160:163], v[196:199], v[72:75]
    v_fma_f32 v37, -v93, v130, v37
    v_mfma_f32_16x16x32_bf16 v[76:79], v[164:167], v[196:199], v[76:79]
    v_fma_f32 v41, -v89, v131, v41
    v_mfma_f32_16x16x32_bf16 v[80:83], v[160:163], v[200:203], v[80:83]
    v_fma_f32 v45, -v93, v131, v45
    v_mfma_f32_16x16x32_bf16 v[84:87], v[164:167], v[200:203], v[84:87]
    v_fma_f32 v49, -v89, v132, v49
    s_waitcnt lgkmcnt(0)
    s_barrier
    v_mfma_f32_16x16x32_bf16 v[16:19], v[204:207], v[212:215], v[16:19]
    ds_read_b128 v[160:163], v3 offset:0
    v_fma_f32 v54, -v94, v132, v54
    v_mfma_f32_16x16x32_bf16 v[20:23], v[208:211], v[212:215], v[20:23]
    ds_read_b128 v[164:167], v3 offset:2048
    v_fma_f32 v58, -v90, v133, v58
    v_mfma_f32_16x16x32_bf16 v[24:27], v[204:207], v[216:219], v[24:27]
    ds_read_b128 v[168:171], v1 offset:0
    v_fma_f32 v62, -v94, v133, v62
    v_mfma_f32_16x16x32_bf16 v[28:31], v[208:211], v[216:219], v[28:31]
    ds_read_b128 v[172:175], v1 offset:1024
    v_fma_f32 v66, -v90, v134, v66
    v_mfma_f32_16x16x32_bf16 v[32:35], v[204:207], v[220:223], v[32:35]
    ds_read_b128 v[176:179], v1 offset:2048
    v_fma_f32 v70, -v94, v134, v70
    v_mfma_f32_16x16x32_bf16 v[36:39], v[208:211], v[220:223], v[36:39]
    ds_read_b128 v[180:183], v1 offset:3072
    v_fma_f32 v74, -v90, v135, v74
    v_mfma_f32_16x16x32_bf16 v[40:43], v[204:207], v[224:227], v[40:43]
    ds_read_b128 v[184:187], v1 offset:4096
    v_fma_f32 v78, -v94, v135, v78
    v_mfma_f32_16x16x32_bf16 v[44:47], v[208:211], v[224:227], v[44:47]
    ds_read_b128 v[188:191], v1 offset:5120
    v_fma_f32 v82, -v90, v136, v82
    v_mfma_f32_16x16x32_bf16 v[48:51], v[204:207], v[228:231], v[48:51]
    ds_read_b128 v[192:195], v1 offset:6144
    v_fma_f32 v86, -v94, v136, v86
    v_mfma_f32_16x16x32_bf16 v[52:55], v[208:211], v[228:231], v[52:55]
    ds_read_b128 v[196:199], v1 offset:7168
    v_fma_f32 v18, -v90, v128, v18
    v_mfma_f32_16x16x32_bf16 v[56:59], v[204:207], v[232:235], v[56:59]
    ds_read_b128 v[200:203], v1 offset:8192
    v_fma_f32 v22, -v94, v128, v22
    v_mfma_f32_16x16x32_bf16 v[60:63], v[208:211], v[232:235], v[60:63]
    v_fma_f32 v26, -v90, v129, v26
    v_mfma_f32_16x16x32_bf16 v[64:67], v[204:207], v[236:239], v[64:67]
    v_fma_f32 v30, -v94, v129, v30
    v_mfma_f32_16x16x32_bf16 v[68:71], v[208:211], v[236:239], v[68:71]
    v_fma_f32 v34, -v90, v130, v34
    v_mfma_f32_16x16x32_bf16 v[72:75], v[204:207], v[240:243], v[72:75]
    v_fma_f32 v38, -v94, v130, v38
    v_mfma_f32_16x16x32_bf16 v[76:79], v[208:211], v[240:243], v[76:79]
    v_fma_f32 v42, -v90, v131, v42
    v_mfma_f32_16x16x32_bf16 v[80:83], v[204:207], v[244:247], v[80:83]
    v_fma_f32 v46, -v94, v131, v46
    v_mfma_f32_16x16x32_bf16 v[84:87], v[208:211], v[244:247], v[84:87]
    v_fma_f32 v50, -v90, v132, v50
    s_waitcnt lgkmcnt(5)
    v_mfma_f32_16x16x32_bf16 v[16:19], v[160:163], v[168:171], v[16:19]
    ds_read_b128 v[204:207], v3 offset:1024
    v_fma_f32 v55, -v95, v132, v55
    v_mfma_f32_16x16x32_bf16 v[20:23], v[164:167], v[168:171], v[20:23]
    ds_read_b128 v[208:211], v3 offset:3072
    v_fma_f32 v59, -v91, v133, v59
    v_mfma_f32_16x16x32_bf16 v[24:27], v[160:163], v[172:175], v[24:27]
    ds_read_b128 v[212:215], v1 offset:9216
    v_fma_f32 v63, -v95, v133, v63
    v_mfma_f32_16x16x32_bf16 v[28:31], v[164:167], v[172:175], v[28:31]
    ds_read_b128 v[216:219], v1 offset:10240
    v_fma_f32 v67, -v91, v134, v67
    v_mfma_f32_16x16x32_bf16 v[32:35], v[160:163], v[176:179], v[32:35]
    ds_read_b128 v[220:223], v1 offset:11264
    v_fma_f32 v71, -v95, v134, v71
    v_mfma_f32_16x16x32_bf16 v[36:39], v[164:167], v[176:179], v[36:39]
    ds_read_b128 v[224:227], v1 offset:12288
    v_fma_f32 v75, -v91, v135, v75
    v_mfma_f32_16x16x32_bf16 v[40:43], v[160:163], v[180:183], v[40:43]
    ds_read_b128 v[228:231], v1 offset:13312
    v_fma_f32 v79, -v95, v135, v79
    v_mfma_f32_16x16x32_bf16 v[44:47], v[164:167], v[180:183], v[44:47]
    ds_read_b128 v[232:235], v1 offset:14336
    s_waitcnt lgkmcnt(8)
    v_fma_f32 v83, -v91, v136, v83
    v_mfma_f32_16x16x32_bf16 v[48:51], v[160:163], v[184:187], v[48:51]
    ds_read_b128 v[236:239], v1 offset:15360
    v_fma_f32 v87, -v95, v136, v87
    v_mfma_f32_16x16x32_bf16 v[52:55], v[164:167], v[184:187], v[52:55]
    ds_read_b128 v[240:243], v1 offset:16384
    v_fma_f32 v19, -v91, v128, v19
    v_mfma_f32_16x16x32_bf16 v[56:59], v[160:163], v[188:191], v[56:59]
    ds_read_b128 v[244:247], v1 offset:17408
    v_fma_f32 v23, -v95, v128, v23
    v_mfma_f32_16x16x32_bf16 v[60:63], v[164:167], v[188:191], v[60:63]
    v_fma_f32 v27, -v91, v129, v27
    v_mfma_f32_16x16x32_bf16 v[64:67], v[160:163], v[192:195], v[64:67]
    v_fma_f32 v31, -v95, v129, v31
    v_mfma_f32_16x16x32_bf16 v[68:71], v[164:167], v[192:195], v[68:71]
    v_fma_f32 v35, -v91, v130, v35
    v_mfma_f32_16x16x32_bf16 v[72:75], v[160:163], v[196:199], v[72:75]
    v_fma_f32 v39, -v95, v130, v39
    v_mfma_f32_16x16x32_bf16 v[76:79], v[164:167], v[196:199], v[76:79]
    v_fma_f32 v43, -v91, v131, v43
    v_mfma_f32_16x16x32_bf16 v[80:83], v[160:163], v[200:203], v[80:83]
    v_fma_f32 v47, -v95, v131, v47
    v_mfma_f32_16x16x32_bf16 v[84:87], v[164:167], v[200:203], v[84:87]
    v_fma_f32 v51, -v91, v132, v51
    s_waitcnt lgkmcnt(0)
    s_barrier
    v_mfma_f32_16x16x32_bf16 v[16:19], v[204:207], v[212:215], v[16:19]
    s_xor_b32 s47, s30, 4096
    s_sub_u32 s47, s47, s30
    v_mfma_f32_16x16x32_bf16 v[20:23], v[208:211], v[212:215], v[20:23]
    s_and_b32 s48, s30, 4096
    v_add_u32 v196, s47, v3
    v_mfma_f32_16x16x32_bf16 v[24:27], v[204:207], v[216:219], v[24:27]
    v_add_u32 v197, s47, v0
    v_add_u32 v198, s48, v1
    v_mfma_f32_16x16x32_bf16 v[28:31], v[208:211], v[216:219], v[28:31]
    v_add_u32_e64 v199, s48, v2
    v_mfma_f32_16x16x32_bf16 v[32:35], v[204:207], v[220:223], v[32:35]
    ds_read_b128 v[160:163], v196 offset:36864
    v_mfma_f32_16x16x32_bf16 v[36:39], v[208:211], v[220:223], v[36:39]
    ds_read_b128 v[164:167], v196 offset:38912
    v_mfma_f32_16x16x32_bf16 v[40:43], v[204:207], v[224:227], v[40:43]
    ds_read_b128 v[168:171], v198 offset:36864
    v_mfma_f32_16x16x32_bf16 v[44:47], v[208:211], v[224:227], v[44:47]
    ds_read_b128 v[172:175], v198 offset:37888
    v_mfma_f32_16x16x32_bf16 v[48:51], v[204:207], v[228:231], v[48:51]
    ds_read_b128 v[176:179], v198 offset:38912
    v_mfma_f32_16x16x32_bf16 v[52:55], v[208:211], v[228:231], v[52:55]
    ds_read_b128 v[180:183], v198 offset:39936
    v_mfma_f32_16x16x32_bf16 v[56:59], v[204:207], v[232:235], v[56:59]
    ds_read_b128 v[184:187], v3 offset:36864
    v_mfma_f32_16x16x32_bf16 v[60:63], v[208:211], v[232:235], v[60:63]
    ds_read_b128 v[188:191], v3 offset:38912
    v_mfma_f32_16x16x32_bf16 v[64:67], v[204:207], v[236:239], v[64:67]
    ds_read_b128 v[192:195], v1 offset:45056
    v_mfma_f32_16x16x32_bf16 v[68:71], v[208:211], v[236:239], v[68:71]
    v_mfma_f32_16x16x32_bf16 v[72:75], v[204:207], v[240:243], v[72:75]
    v_mfma_f32_16x16x32_bf16 v[76:79], v[208:211], v[240:243], v[76:79]
    v_mfma_f32_16x16x32_bf16 v[80:83], v[204:207], v[244:247], v[80:83]
    v_mfma_f32_16x16x32_bf16 v[84:87], v[208:211], v[244:247], v[84:87]
L_g_z2:
    v_pk_mul_f32 v[220:221], v[16:17], v[16:17]
    v_pk_mul_f32 v[222:223], v[18:19], v[18:19]
    v_pk_mul_f32 v[224:225], v[20:21], v[20:21]
    v_pk_mul_f32 v[226:227], v[22:23], v[22:23]
    v_pk_fma_f32 v[220:221], v[220:221], v[112:113], v[104:105]
    v_pk_fma_f32 v[222:223], v[222:223], v[114:115], v[106:107]
    v_pk_fma_f32 v[224:225], v[224:225], v[116:117], v[108:109]
    v_pk_fma_f32 v[226:227], v[226:227], v[118:119], v[110:111]
    v_pk_mul_f32 v[220:221], v[220:221], v[16:17]
    v_pk_mul_f32 v[222:223], v[222:223], v[18:19]
    v_pk_mul_f32 v[224:225], v[224:225], v[20:21]
    v_pk_mul_f32 v[226:227], v[226:227], v[22:23]
    v_exp_f32 v220, v220
    v_exp_f32 v221, v221
    v_exp_f32 v222, v222
    v_exp_f32 v223, v223
    v_exp_f32 v224, v224
    v_exp_f32 v225, v225
    v_exp_f32 v226, v226
    v_exp_f32 v227, v227
    v_pk_fma_f32 v[220:221], v[220:221], v[120:121], v[120:121]
    v_pk_fma_f32 v[222:223], v[222:223], v[122:123], v[122:123]
    v_pk_fma_f32 v[224:225], v[224:225], v[124:125], v[124:125]
    v_pk_fma_f32 v[226:227], v[226:227], v[126:127], v[126:127]
    v_rcp_f32 v220, v220
    v_rcp_f32 v221, v221
    v_rcp_f32 v222, v222
    v_rcp_f32 v223, v223
    v_rcp_f32 v224, v224
    v_rcp_f32 v225, v225
    v_rcp_f32 v226, v226
    v_rcp_f32 v227, v227
    v_pk_mul_f32 v[16:17], v[16:17], v[220:221]
    v_pk_mul_f32 v[18:19], v[18:19], v[222:223]
    v_pk_mul_f32 v[20:21], v[20:21], v[224:225]
    v_pk_mul_f32 v[22:23], v[22:23], v[226:227]
    v_pk_mul_f32 v[206:207], v[16:17], v[16:17]
    v_pk_mul_f32 v[210:211], v[18:19], v[18:19]
    v_pk_mul_f32 v[214:215], v[20:21], v[20:21]
    v_pk_mul_f32 v[218:219], v[22:23], v[22:23]
    v_pk_mul_f32 v[228:229], v[24:25], v[24:25]
    v_pk_mul_f32 v[230:231], v[26:27], v[26:27]
    v_pk_mul_f32 v[232:233], v[28:29], v[28:29]
    v_pk_mul_f32 v[234:235], v[30:31], v[30:31]
    v_pk_fma_f32 v[228:229], v[228:229], v[112:113], v[104:105]
    v_pk_fma_f32 v[230:231], v[230:231], v[114:115], v[106:107]
    v_pk_fma_f32 v[232:233], v[232:233], v[116:117], v[108:109]
    v_pk_fma_f32 v[234:235], v[234:235], v[118:119], v[110:111]
    v_pk_mul_f32 v[228:229], v[228:229], v[24:25]
    v_pk_mul_f32 v[230:231], v[230:231], v[26:27]
    v_pk_mul_f32 v[232:233], v[232:233], v[28:29]
    v_pk_mul_f32 v[234:235], v[234:235], v[30:31]
    v_exp_f32 v228, v228
    v_exp_f32 v229, v229
    v_exp_f32 v230, v230
    v_exp_f32 v231, v231
    v_exp_f32 v232, v232
    v_exp_f32 v233, v233
    v_exp_f32 v234, v234
    v_exp_f32 v235, v235
    v_pk_fma_f32 v[228:229], v[228:229], v[120:121], v[120:121]
    v_pk_fma_f32 v[230:231], v[230:231], v[122:123], v[122:123]
    v_pk_fma_f32 v[232:233], v[232:233], v[124:125], v[124:125]
    v_pk_fma_f32 v[234:235], v[234:235], v[126:127], v[126:127]
    v_rcp_f32 v228, v228
    v_rcp_f32 v229, v229
    v_rcp_f32 v230, v230
    v_rcp_f32 v231, v231
    v_rcp_f32 v232, v232
    v_rcp_f32 v233, v233
    v_rcp_f32 v234, v234
    v_rcp_f32 v235, v235
    v_pk_mul_f32 v[24:25], v[24:25], v[228:229]
    v_pk_mul_f32 v[26:27], v[26:27], v[230:231]
    v_pk_mul_f32 v[28:29], v[28:29], v[232:233]
    v_pk_mul_f32 v[30:31], v[30:31], v[234:235]
    v_pk_add_f32 v[204:205], v[16:17], v[24:25]
    v_pk_fma_f32 v[206:207], v[24:25], v[24:25], v[206:207]
    v_pk_add_f32 v[208:209], v[18:19], v[26:27]
    v_pk_fma_f32 v[210:211], v[26:27], v[26:27], v[210:211]
    v_pk_add_f32 v[212:213], v[20:21], v[28:29]
    v_pk_fma_f32 v[214:215], v[28:29], v[28:29], v[214:215]
    v_pk_add_f32 v[216:217], v[22:23], v[30:31]
    v_pk_fma_f32 v[218:219], v[30:31], v[30:31], v[218:219]
    v_pk_mul_f32 v[220:221], v[32:33], v[32:33]
    v_pk_mul_f32 v[222:223], v[34:35], v[34:35]
    v_pk_mul_f32 v[224:225], v[36:37], v[36:37]
    v_pk_mul_f32 v[226:227], v[38:39], v[38:39]
    v_pk_fma_f32 v[220:221], v[220:221], v[112:113], v[104:105]
    v_pk_fma_f32 v[222:223], v[222:223], v[114:115], v[106:107]
    v_pk_fma_f32 v[224:225], v[224:225], v[116:117], v[108:109]
    v_pk_fma_f32 v[226:227], v[226:227], v[118:119], v[110:111]
    v_pk_mul_f32 v[220:221], v[220:221], v[32:33]
    v_pk_mul_f32 v[222:223], v[222:223], v[34:35]
    v_pk_mul_f32 v[224:225], v[224:225], v[36:37]
    v_pk_mul_f32 v[226:227], v[226:227], v[38:39]
    v_exp_f32 v220, v220
    v_exp_f32 v221, v221
    v_exp_f32 v222, v222
    v_exp_f32 v223, v223
    v_exp_f32 v224, v224
    v_exp_f32 v225, v225
    v_exp_f32 v226, v226
    v_exp_f32 v227, v227
    v_pk_fma_f32 v[220:221], v[220:221], v[120:121], v[120:121]
    v_pk_fma_f32 v[222:223], v[222:223], v[122:123], v[122:123]
    v_pk_fma_f32 v[224:225], v[224:225], v[124:125], v[124:125]
    v_pk_fma_f32 v[226:227], v[226:227], v[126:127], v[126:127]
    v_rcp_f32 v220, v220
    v_rcp_f32 v221, v221
    v_rcp_f32 v222, v222
    v_rcp_f32 v223, v223
    v_rcp_f32 v224, v224
    v_rcp_f32 v225, v225
    v_rcp_f32 v226, v226
    v_rcp_f32 v227, v227
    v_pk_mul_f32 v[32:33], v[32:33], v[220:221]
    v_pk_mul_f32 v[34:35], v[34:35], v[222:223]
    v_pk_mul_f32 v[36:37], v[36:37], v[224:225]
    v_pk_mul_f32 v[38:39], v[38:39], v[226:227]
    v_pk_add_f32 v[204:205], v[204:205], v[32:33]
    v_pk_fma_f32 v[206:207], v[32:33], v[32:33], v[206:207]
    v_pk_add_f32 v[208:209], v[208:209], v[34:35]
    v_pk_fma_f32 v[210:211], v[34:35], v[34:35], v[210:211]
    v_pk_add_f32 v[212:213], v[212:213], v[36:37]
    v_pk_fma_f32 v[214:215], v[36:37], v[36:37], v[214:215]
    v_pk_add_f32 v[216:217], v[216:217], v[38:39]
    v_pk_fma_f32 v[218:219], v[38:39], v[38:39], v[218:219]
    v_pk_mul_f32 v[228:229], v[40:41], v[40:41]
    v_pk_mul_f32 v[230:231], v[42:43], v[42:43]
    v_pk_mul_f32 v[232:233], v[44:45], v[44:45]
    v_pk_mul_f32 v[234:235], v[46:47], v[46:47]
    v_pk_fma_f32 v[228:229], v[228:229], v[112:113], v[104:105]
    v_pk_fma_f32 v[230:231], v[230:231], v[114:115], v[106:107]
    v_pk_fma_f32 v[232:233], v[232:233], v[116:117], v[108:109]
    v_pk_fma_f32 v[234:235], v[234:235], v[118:119], v[110:111]
    v_pk_mul_f32 v[228:229], v[228:229], v[40:41]
    v_pk_mul_f32 v[230:231], v[230:231], v[42:43]
    v_pk_mul_f32 v[232:233], v[232:233], v[44:45]
    v_pk_mul_f32 v[234:235], v[234:235], v[46:47]
    v_exp_f32 v228, v228
    v_exp_f32 v229, v229
    v_exp_f32 v230, v230
    v_exp_f32 v231, v231
    v_exp_f32 v232, v232
    v_exp_f32 v233, v233
    v_exp_f32 v234, v234
    v_exp_f32 v235, v235
    v_pk_fma_f32 v[228:229], v[228:229], v[120:121], v[120:121]
    v_pk_fma_f32 v[230:231], v[230:231], v[122:123], v[122:123]
    v_pk_fma_f32 v[232:233], v[232:233], v[124:125], v[124:125]
    v_pk_fma_f32 v[234:235], v[234:235], v[126:127], v[126:127]
    v_rcp_f32 v228, v228
    v_rcp_f32 v229, v229
    v_rcp_f32 v230, v230
    v_rcp_f32 v231, v231
    v_rcp_f32 v232, v232
    v_rcp_f32 v233, v233
    v_rcp_f32 v234, v234
    v_rcp_f32 v235, v235
    v_pk_mul_f32 v[40:41], v[40:41], v[228:229]
    v_pk_mul_f32 v[42:43], v[42:43], v[230:231]
    v_pk_mul_f32 v[44:45], v[44:45], v[232:233]
    v_pk_mul_f32 v[46:47], v[46:47], v[234:235]
    v_pk_add_f32 v[204:205], v[204:205], v[40:41]
    v_pk_fma_f32 v[206:207], v[40:41], v[40:41], v[206:207]
    v_pk_add_f32 v[208:209], v[208:209], v[42:43]
    v_pk_fma_f32 v[210:211], v[42:43], v[42:43], v[210:211]
    v_pk_add_f32 v[212:213], v[212:213], v[44:45]
    v_pk_fma_f32 v[214:215], v[44:45], v[44:45], v[214:215]
    v_pk_add_f32 v[216:217], v[216:217], v[46:47]
    v_pk_fma_f32 v[218:219], v[46:47], v[46:47], v[218:219]
    v_pk_mul_f32 v[220:221], v[48:49], v[48:49]
    v_pk_mul_f32 v[222:223], v[50:51], v[50:51]
    v_pk_mul_f32 v[224:225], v[52:53], v[52:53]
    v_pk_mul_f32 v[226:227], v[54:55], v[54:55]
    v_pk_fma_f32 v[220:221], v[220:221], v[112:113], v[104:105]
    v_pk_fma_f32 v[222:223], v[222:223], v[114:115], v[106:107]
    v_pk_fma_f32 v[224:225], v[224:225], v[116:117], v[108:109]
    v_pk_fma_f32 v[226:227], v[226:227], v[118:119], v[110:111]
    v_pk_mul_f32 v[220:221], v[220:221], v[48:49]
    v_pk_mul_f32 v[222:223], v[222:223], v[50:51]
    v_pk_mul_f32 v[224:225], v[224:225], v[52:53]
    v_pk_mul_f32 v[226:227], v[226:227], v[54:55]
    v_exp_f32 v220, v220
    v_exp_f32 v221, v221
    v_exp_f32 v222, v222
    v_exp_f32 v223, v223
    v_exp_f32 v224, v224
    v_exp_f32 v225, v225
    v_exp_f32 v226, v226
    v_exp_f32 v227, v227
    v_pk_fma_f32 v[220:221], v[220:221], v[120:121], v[120:121]
    v_pk_fma_f32 v[222:223], v[222:223], v[122:123], v[122:123]
    v_pk_fma_f32 v[224:225], v[224:225], v[124:125], v[124:125]
    v_pk_fma_f32 v[226:227], v[226:227], v[126:127], v[126:127]
    v_rcp_f32 v220, v220
    v_rcp_f32 v221, v221
    v_rcp_f32 v222, v222
    v_rcp_f32 v223, v223
    v_rcp_f32 v224, v224
    v_rcp_f32 v225, v225
    v_rcp_f32 v226, v226
    v_rcp_f32 v227, v227
    v_pk_mul_f32 v[48:49], v[48:49], v[220:221]
    v_pk_mul_f32 v[50:51], v[50:51], v[222:223]
    v_pk_mul_f32 v[52:53], v[52:53], v[224:225]
    v_pk_mul_f32 v[54:55], v[54:55], v[226:227]
    v_pk_add_f32 v[204:205], v[204:205], v[48:49]
    v_pk_fma_f32 v[206:207], v[48:49], v[48:49], v[206:207]
    v_pk_add_f32 v[208:209], v[208:209], v[50:51]
    v_pk_fma_f32 v[210:211], v[50:51], v[50:51], v[210:211]
    v_pk_add_f32 v[212:213], v[212:213], v[52:53]
    v_pk_fma_f32 v[214:215], v[52:53], v[52:53], v[214:215]
    v_pk_add_f32 v[216:217], v[216:217], v[54:55]
    v_pk_fma_f32 v[218:219], v[54:55], v[54:55], v[218:219]
    v_pk_mul_f32 v[228:229], v[56:57], v[56:57]
    v_pk_mul_f32 v[230:231], v[58:59], v[58:59]
    v_pk_mul_f32 v[232:233], v[60:61], v[60:61]
    v_pk_mul_f32 v[234:235], v[62:63], v[62:63]
    v_pk_fma_f32 v[228:229], v[228:229], v[112:113], v[104:105]
    v_pk_fma_f32 v[230:231], v[230:231], v[114:115], v[106:107]
    v_pk_fma_f32 v[232:233], v[232:233], v[116:117], v[108:109]
    v_pk_fma_f32 v[234:235], v[234:235], v[118:119], v[110:111]
    v_pk_mul_f32 v[228:229], v[228:229], v[56:57]
    v_pk_mul_f32 v[230:231], v[230:231], v[58:59]
    v_pk_mul_f32 v[232:233], v[232:233], v[60:61]
    v_pk_mul_f32 v[234:235], v[234:235], v[62:63]
    v_exp_f32 v228, v228
    v_exp_f32 v229, v229
    v_exp_f32 v230, v230
    v_exp_f32 v231, v231
    v_exp_f32 v232, v232
    v_exp_f32 v233, v233
    v_exp_f32 v234, v234
    v_exp_f32 v235, v235
    v_pk_fma_f32 v[228:229], v[228:229], v[120:121], v[120:121]
    v_pk_fma_f32 v[230:231], v[230:231], v[122:123], v[122:123]
    v_pk_fma_f32 v[232:233], v[232:233], v[124:125], v[124:125]
    v_pk_fma_f32 v[234:235], v[234:235], v[126:127], v[126:127]
    v_rcp_f32 v228, v228
    v_rcp_f32 v229, v229
    v_rcp_f32 v230, v230
    v_rcp_f32 v231, v231
    v_rcp_f32 v232, v232
    v_rcp_f32 v233, v233
    v_rcp_f32 v234, v234
    v_rcp_f32 v235, v235
    v_pk_mul_f32 v[56:57], v[56:57], v[228:229]
    v_pk_mul_f32 v[58:59], v[58:59], v[230:231]
    v_pk_mul_f32 v[60:61], v[60:61], v[232:233]
    v_pk_mul_f32 v[62:63], v[62:63], v[234:235]
    v_pk_add_f32 v[204:205], v[204:205], v[56:57]
    v_pk_fma_f32 v[206:207], v[56:57], v[56:57], v[206:207]
    v_pk_add_f32 v[208:209], v[208:209], v[58:59]
    v_pk_fma_f32 v[210:211], v[58:59], v[58:59], v[210:211]
    v_pk_add_f32 v[212:213], v[212:213], v[60:61]
    v_pk_fma_f32 v[214:215], v[60:61], v[60:61], v[214:215]
    v_pk_add_f32 v[216:217], v[216:217], v[62:63]
    v_pk_fma_f32 v[218:219], v[62:63], v[62:63], v[218:219]
    v_pk_mul_f32 v[220:221], v[64:65], v[64:65]
    v_pk_mul_f32 v[222:223], v[66:67], v[66:67]
    v_pk_mul_f32 v[224:225], v[68:69], v[68:69]
    v_pk_mul_f32 v[226:227], v[70:71], v[70:71]
    v_pk_fma_f32 v[220:221], v[220:221], v[112:113], v[104:105]
    v_pk_fma_f32 v[222:223], v[222:223], v[114:115], v[106:107]
    v_pk_fma_f32 v[224:225], v[224:225], v[116:117], v[108:109]
    v_pk_fma_f32 v[226:227], v[226:227], v[118:119], v[110:111]
    v_pk_mul_f32 v[220:221], v[220:221], v[64:65]
    v_pk_mul_f32 v[222:223], v[222:223], v[66:67]
    v_pk_mul_f32 v[224:225], v[224:225], v[68:69]
    v_pk_mul_f32 v[226:227], v[226:227], v[70:71]
    v_exp_f32 v220, v220
    v_exp_f32 v221, v221
    v_exp_f32 v222, v222
    v_exp_f32 v223, v223
    v_exp_f32 v224, v224
    v_exp_f32 v225, v225
    v_exp_f32 v226, v226
    v_exp_f32 v227, v227
    v_pk_fma_f32 v[220:221], v[220:221], v[120:121], v[120:121]
    v_pk_fma_f32 v[222:223], v[222:223], v[122:123], v[122:123]
    v_pk_fma_f32 v[224:225], v[224:225], v[124:125], v[124:125]
    v_pk_fma_f32 v[226:227], v[226:227], v[126:127], v[126:127]
    v_rcp_f32 v220, v220
    v_rcp_f32 v221, v221
    v_rcp_f32 v222, v222
    v_rcp_f32 v223, v223
    v_rcp_f32 v224, v224
    v_rcp_f32 v225, v225
    v_rcp_f32 v226, v226
    v_rcp_f32 v227, v227
    v_pk_mul_f32 v[64:65], v[64:65], v[220:221]
    v_pk_mul_f32 v[66:67], v[66:67], v[222:223]
    v_pk_mul_f32 v[68:69], v[68:69], v[224:225]
    v_pk_mul_f32 v[70:71], v[70:71], v[226:227]
    v_pk_add_f32 v[204:205], v[204:205], v[64:65]
    v_pk_fma_f32 v[206:207], v[64:65], v[64:65], v[206:207]
    v_pk_add_f32 v[208:209], v[208:209], v[66:67]
    v_pk_fma_f32 v[210:211], v[66:67], v[66:67], v[210:211]
    v_pk_add_f32 v[212:213], v[212:213], v[68:69]
    v_pk_fma_f32 v[214:215], v[68:69], v[68:69], v[214:215]
    v_pk_add_f32 v[216:217], v[216:217], v[70:71]
    v_pk_fma_f32 v[218:219], v[70:71], v[70:71], v[218:219]
    v_pk_mul_f32 v[228:229], v[72:73], v[72:73]
    v_pk_mul_f32 v[230:231], v[74:75], v[74:75]
    v_pk_mul_f32 v[232:233], v[76:77], v[76:77]
    v_pk_mul_f32 v[234:235], v[78:79], v[78:79]
    v_pk_fma_f32 v[228:229], v[228:229], v[112:113], v[104:105]
    v_pk_fma_f32 v[230:231], v[230:231], v[114:115], v[106:107]
    v_pk_fma_f32 v[232:233], v[232:233], v[116:117], v[108:109]
    v_pk_fma_f32 v[234:235], v[234:235], v[118:119], v[110:111]
    v_pk_mul_f32 v[228:229], v[228:229], v[72:73]
    v_pk_mul_f32 v[230:231], v[230:231], v[74:75]
    v_pk_mul_f32 v[232:233], v[232:233], v[76:77]
    v_pk_mul_f32 v[234:235], v[234:235], v[78:79]
    v_exp_f32 v228, v228
    v_exp_f32 v229, v229
    v_exp_f32 v230, v230
    v_exp_f32 v231, v231
    v_exp_f32 v232, v232
    v_exp_f32 v233, v233
    v_exp_f32 v234, v234
    v_exp_f32 v235, v235
    v_pk_fma_f32 v[228:229], v[228:229], v[120:121], v[120:121]
    v_pk_fma_f32 v[230:231], v[230:231], v[122:123], v[122:123]
    v_pk_fma_f32 v[232:233], v[232:233], v[124:125], v[124:125]
    v_pk_fma_f32 v[234:235], v[234:235], v[126:127], v[126:127]
    v_rcp_f32 v228, v228
    v_rcp_f32 v229, v229
    v_rcp_f32 v230, v230
    v_rcp_f32 v231, v231
    v_rcp_f32 v232, v232
    v_rcp_f32 v233, v233
    v_rcp_f32 v234, v234
    v_rcp_f32 v235, v235
    v_pk_mul_f32 v[72:73], v[72:73], v[228:229]
    v_pk_mul_f32 v[74:75], v[74:75], v[230:231]
    v_pk_mul_f32 v[76:77], v[76:77], v[232:233]
    v_pk_mul_f32 v[78:79], v[78:79], v[234:235]
    v_pk_add_f32 v[204:205], v[204:205], v[72:73]
    v_pk_fma_f32 v[206:207], v[72:73], v[72:73], v[206:207]
    v_pk_add_f32 v[208:209], v[208:209], v[74:75]
    v_pk_fma_f32 v[210:211], v[74:75], v[74:75], v[210:211]
    v_pk_add_f32 v[212:213], v[212:213], v[76:77]
    v_pk_fma_f32 v[214:215], v[76:77], v[76:77], v[214:215]
    v_pk_add_f32 v[216:217], v[216:217], v[78:79]
    v_pk_fma_f32 v[218:219], v[78:79], v[78:79], v[218:219]
    v_pk_mul_f32 v[220:221], v[80:81], v[80:81]
    v_pk_mul_f32 v[222:223], v[82:83], v[82:83]
    v_pk_mul_f32 v[224:225], v[84:85], v[84:85]
    v_pk_mul_f32 v[226:227], v[86:87], v[86:87]
    v_pk_fma_f32 v[220:221], v[220:221], v[112:113], v[104:105]
    v_pk_fma_f32 v[222:223], v[222:223], v[114:115], v[106:107]
    v_pk_fma_f32 v[224:225], v[224:225], v[116:117], v[108:109]
    v_pk_fma_f32 v[226:227], v[226:227], v[118:119], v[110:111]
    v_pk_mul_f32 v[220:221], v[220:221], v[80:81]
    v_pk_mul_f32 v[222:223], v[222:223], v[82:83]
    v_pk_mul_f32 v[224:225], v[224:225], v[84:85]
    v_pk_mul_f32 v[226:227], v[226:227], v[86:87]
    v_exp_f32 v220, v220
    v_exp_f32 v221, v221
    v_exp_f32 v222, v222
    v_exp_f32 v223, v223
    v_exp_f32 v224, v224
    v_exp_f32 v225, v225
    v_exp_f32 v226, v226
    v_exp_f32 v227, v227
    v_pk_fma_f32 v[220:221], v[220:221], v[120:121], v[120:121]
    v_pk_fma_f32 v[222:223], v[222:223], v[122:123], v[122:123]
    v_pk_fma_f32 v[224:225], v[224:225], v[124:125], v[124:125]
    v_pk_fma_f32 v[226:227], v[226:227], v[126:127], v[126:127]
    v_rcp_f32 v220, v220
    v_rcp_f32 v221, v221
    v_rcp_f32 v222, v222
    v_rcp_f32 v223, v223
    v_rcp_f32 v224, v224
    v_rcp_f32 v225, v225
    v_rcp_f32 v226, v226
    v_rcp_f32 v227, v227
    v_pk_mul_f32 v[80:81], v[80:81], v[220:221]
    v_pk_mul_f32 v[82:83], v[82:83], v[222:223]
    v_pk_mul_f32 v[84:85], v[84:85], v[224:225]
    v_pk_mul_f32 v[86:87], v[86:87], v[226:227]
    v_pk_add_f32 v[204:205], v[204:205], v[80:81]
    v_pk_fma_f32 v[206:207], v[80:81], v[80:81], v[206:207]
    v_pk_add_f32 v[208:209], v[208:209], v[82:83]
    v_pk_fma_f32 v[210:211], v[82:83], v[82:83], v[210:211]
    v_pk_add_f32 v[212:213], v[212:213], v[84:85]
    v_pk_fma_f32 v[214:215], v[84:85], v[84:85], v[214:215]
    v_pk_add_f32 v[216:217], v[216:217], v[86:87]
    v_pk_fma_f32 v[218:219], v[86:87], v[86:87], v[218:219]
    v_add_f32_dpp v204, v204, v204 row_mirror row_mask:0xf bank_mask:0x3
    v_add_f32_dpp v205, v205, v205 row_mirror row_mask:0xf bank_mask:0x3
    v_add_f32_dpp v206, v206, v206 row_mirror row_mask:0xf bank_mask:0x3
    v_add_f32_dpp v207, v207, v207 row_mirror row_mask:0xf bank_mask:0x3
    v_add_f32_dpp v208, v208, v208 row_mirror row_mask:0xf bank_mask:0x3
    v_add_f32_dpp v209, v209, v209 row_mirror row_mask:0xf bank_mask:0x3
    v_add_f32_dpp v210, v210, v210 row_mirror row_mask:0xf bank_mask:0x3
    v_add_f32_dpp v211, v211, v211 row_mirror row_mask:0xf bank_mask:0x3
    v_add_f32_dpp v204, v212, v212 row_mirror row_mask:0xf bank_mask:0xc
    v_add_f32_dpp v205, v213, v213 row_mirror row_mask:0xf bank_mask:0xc
    v_add_f32_dpp v206, v214, v214 row_mirror row_mask:0xf bank_mask:0xc
    v_add_f32_dpp v207, v215, v215 row_mirror row_mask:0xf bank_mask:0xc
    v_add_f32_dpp v208, v216, v216 row_mirror row_mask:0xf bank_mask:0xc
    v_add_f32_dpp v209, v217, v217 row_mirror row_mask:0xf bank_mask:0xc
    v_add_f32_dpp v210, v218, v218 row_mirror row_mask:0xf bank_mask:0xc
    v_add_f32_dpp v211, v219, v219 row_mirror row_mask:0xf bank_mask:0xc
    v_add_f32_dpp v204, v204, v204 row_half_mirror row_mask:0xf bank_mask:0x5
    v_add_f32_dpp v205, v205, v205 row_half_mirror row_mask:0xf bank_mask:0x5
    v_add_f32_dpp v206, v206, v206 row_half_mirror row_mask:0xf bank_mask:0x5
    v_add_f32_dpp v207, v207, v207 row_half_mirror row_mask:0xf bank_mask:0x5
    v_add_f32_dpp v204, v208, v208 row_half_mirror row_mask:0xf bank_mask:0xa
    v_add_f32_dpp v205, v209, v209 row_half_mirror row_mask:0xf bank_mask:0xa
    v_add_f32_dpp v206, v210, v210 row_half_mirror row_mask:0xf bank_mask:0xa
    v_add_f32_dpp v207, v211, v211 row_half_mirror row_mask:0xf bank_mask:0xa
    v_add_f32_dpp v204, v204, v204 quad_perm:[1,0,3,2] row_mask:0xf bank_mask:0xf
    v_add_f32_dpp v205, v205, v205 quad_perm:[1,0,3,2] row_mask:0xf bank_mask:0xf
    v_add_f32_dpp v206, v206, v206 quad_perm:[1,0,3,2] row_mask:0xf bank_mask:0xf
    v_add_f32_dpp v207, v207, v207 quad_perm:[1,0,3,2] row_mask:0xf bank_mask:0xf
    v_add_f32_dpp v12, v204, v204 quad_perm:[2,3,0,1] row_mask:0xf bank_mask:0xf
    v_add_f32_dpp v14, v205, v205 quad_perm:[2,3,0,1] row_mask:0xf bank_mask:0xf
    v_add_f32_dpp v13, v206, v206 quad_perm:[2,3,0,1] row_mask:0xf bank_mask:0xf
    v_add_f32_dpp v15, v207, v207 quad_perm:[2,3,0,1] row_mask:0xf bank_mask:0xf
    buffer_store_dwordx4 v[12:15], v8, s[4:7], s36 offen sc1
    s_waitcnt lgkmcnt(3)
    v_mfma_f32_16x16x32_bf16 v[88:91], v[168:171], v[160:163], 0
    ds_read_b128 v[204:207], v196 offset:37888
    v_mfma_f32_16x16x32_bf16 v[92:95], v[168:171], v[164:167], 0
    ds_read_b128 v[208:211], v196 offset:39936
    v_mfma_f32_16x16x32_bf16 v[96:99], v[172:175], v[160:163], 0
    ds_read_b128 v[212:215], v198 offset:46080
    v_mfma_f32_16x16x32_bf16 v[100:103], v[172:175], v[164:167], 0
    ds_read_b128 v[216:219], v198 offset:47104
    v_mfma_f32_16x16x32_bf16 v[104:107], v[176:179], v[160:163], 0
    ds_read_b128 v[220:223], v198 offset:48128
    v_mfma_f32_16x16x32_bf16 v[108:111], v[176:179], v[164:167], 0
    ds_read_b128 v[224:227], v198 offset:49152
    v_mfma_f32_16x16x32_bf16 v[112:115], v[180:183], v[160:163], 0
    ds_read_b128 v[228:231], v3 offset:37888
    v_mfma_f32_16x16x32_bf16 v[116:119], v[180:183], v[164:167], 0
    ds_read_b128 v[232:235], v3 offset:39936
    s_waitcnt lgkmcnt(8)
    v_mfma_f32_16x16x32_bf16 v[120:123], v[168:171], v[184:187], 0
    ds_read_b128 v[236:239], v1 offset:54272
    v_mfma_f32_16x16x32_bf16 v[124:127], v[168:171], v[188:191], 0
    v_mfma_f32_16x16x32_bf16 v[128:131], v[172:175], v[184:187], 0
    v_mfma_f32_16x16x32_bf16 v[132:135], v[172:175], v[188:191], 0
    v_mfma_f32_16x16x32_bf16 v[136:139], v[176:179], v[184:187], 0
    v_mfma_f32_16x16x32_bf16 v[140:143], v[176:179], v[188:191], 0
    v_mfma_f32_16x16x32_bf16 v[144:147], v[180:183], v[184:187], 0
    v_mfma_f32_16x16x32_bf16 v[148:151], v[180:183], v[188:191], 0
    v_mfma_f32_16x16x32_bf16 v[152:155], v[192:195], v[184:187], 0
    v_mfma_f32_16x16x32_bf16 v[156:159], v[192:195], v[188:191], 0
    s_waitcnt lgkmcnt(0)
    s_barrier
    v_mfma_f32_16x16x32_bf16 v[88:91], v[212:215], v[204:207], v[88:91]
    ds_read_b128 v[160:163], v197 offset:0
    v_mfma_f32_16x16x32_bf16 v[92:95], v[212:215], v[208:211], v[92:95]
    ds_read_b128 v[164:167], v197 offset:2048
    v_mfma_f32_16x16x32_bf16 v[96:99], v[216:219], v[204:207], v[96:99]
    ds_read_b128 v[168:171], v199 offset:0
    v_mfma_f32_16x16x32_bf16 v[100:103], v[216:219], v[208:211], v[100:103]
    ds_read_b128 v[172:175], v199 offset:1024
    v_mfma_f32_16x16x32_bf16 v[104:107], v[220:223], v[204:207], v[104:107]
    ds_read_b128 v[176:179], v199 offset:2048
    v_mfma_f32_16x16x32_bf16 v[108:111], v[220:223], v[208:211], v[108:111]
    ds_read_b128 v[180:183], v199 offset:3072
    v_mfma_f32_16x16x32_bf16 v[112:115], v[224:227], v[204:207], v[112:115]
    ds_read_b128 v[184:187], v0 offset:0
    v_mfma_f32_16x16x32_bf16 v[116:119], v[224:227], v[208:211], v[116:119]
    ds_read_b128 v[188:191], v0 offset:2048
    v_mfma_f32_16x16x32_bf16 v[120:123], v[212:215], v[228:231], v[120:123]
    ds_read_b128 v[192:195], v2 offset:8192
    v_mfma_f32_16x16x32_bf16 v[124:127], v[212:215], v[232:235], v[124:127]
    ds_read2_b32 v[240:241], v4 offset0:0 offset1:32
    v_mfma_f32_16x16x32_bf16 v[128:131], v[216:219], v[228:231], v[128:131]
    ds_read2_b32 v[242:243], v4 offset0:16 offset1:48
    v_mfma_f32_16x16x32_bf16 v[132:135], v[216:219], v[232:235], v[132:135]
    v_mfma_f32_16x16x32_bf16 v[136:139], v[220:223], v[228:231], v[136:139]
    v_mfma_f32_16x16x32_bf16 v[140:143], v[220:223], v[232:235], v[140:143]
    v_mfma_f32_16x16x32_bf16 v[144:147], v[224:227], v[228:231], v[144:147]
    v_mfma_f32_16x16x32_bf16 v[148:151], v[224:227], v[232:235], v[148:151]
    v_mfma_f32_16x16x32_bf16 v[152:155], v[236:239], v[228:231], v[152:155]
    v_mfma_f32_16x16x32_bf16 v[156:159], v[236:239], v[232:235], v[156:159]
    s_waitcnt lgkmcnt(5)
    v_mfma_f32_16x16x32_bf16 v[88:91], v[168:171], v[160:163], v[88:91]
    ds_read_b128 v[204:207], v197 offset:1024
    v_mfma_f32_16x16x32_bf16 v[92:95], v[168:171], v[164:167], v[92:95]
    ds_read_b128 v[208:211], v197 offset:3072
    v_mfma_f32_16x16x32_bf16 v[96:99], v[172:175], v[160:163], v[96:99]
    ds_read_b128 v[212:215], v199 offset:9216
    v_mfma_f32_16x16x32_bf16 v[100:103], v[172:175], v[164:167], v[100:103]
    ds_read_b128 v[216:219], v199 offset:10240
    v_mfma_f32_16x16x32_bf16 v[104:107], v[176:179], v[160:163], v[104:107]
    ds_read_b128 v[220:223], v199 offset:11264
    v_mfma_f32_16x16x32_bf16 v[108:111], v[176:179], v[164:167], v[108:111]
    ds_read_b128 v[224:227], v199 offset:12288
    v_mfma_f32_16x16x32_bf16 v[112:115], v[180:183], v[160:163], v[112:115]
    ds_read_b128 v[228:231], v0 offset:1024
    v_mfma_f32_16x16x32_bf16 v[116:119], v[180:183], v[164:167], v[116:119]
    ds_read_b128 v[232:235], v0 offset:3072
    s_waitcnt lgkmcnt(8)
    v_mfma_f32_16x16x32_bf16 v[120:123], v[168:171], v[184:187], v[120:123]
    ds_read_b128 v[236:239], v2 offset:17408
    v_mfma_f32_16x16x32_bf16 v[124:127], v[168:171], v[188:191], v[124:127]
    v_mfma_f32_16x16x32_bf16 v[128:131], v[172:175], v[184:187], v[128:131]
    v_mfma_f32_16x16x32_bf16 v[132:135], v[172:175], v[188:191], v[132:135]
    v_mfma_f32_16x16x32_bf16 v[136:139], v[176:179], v[184:187], v[136:139]
    v_mfma_f32_16x16x32_bf16 v[140:143], v[176:179], v[188:191], v[140:143]
    v_mfma_f32_16x16x32_bf16 v[144:147], v[180:183], v[184:187], v[144:147]
    v_mfma_f32_16x16x32_bf16 v[148:151], v[180:183], v[188:191], v[148:151]
    v_mfma_f32_16x16x32_bf16 v[152:155], v[192:195], v[184:187], v[152:155]
    v_mfma_f32_16x16x32_bf16 v[156:159], v[192:195], v[188:191], v[156:159]
    s_waitcnt lgkmcnt(0)
    s_barrier
    v_mfma_f32_16x16x32_bf16 v[88:91], v[212:215], v[204:207], v[88:91]
    ds_read_b128 v[160:163], v197 offset:36864
    v_mfma_f32_16x16x32_bf16 v[92:95], v[212:215], v[208:211], v[92:95]
    ds_read_b128 v[164:167], v197 offset:38912
    v_mfma_f32_16x16x32_bf16 v[96:99], v[216:219], v[204:207], v[96:99]
    ds_read_b128 v[168:171], v199 offset:36864
    v_mfma_f32_16x16x32_bf16 v[100:103], v[216:219], v[208:211], v[100:103]
    ds_read_b128 v[172:175], v199 offset:37888
    v_mfma_f32_16x16x32_bf16 v[104:107], v[220:223], v[204:207], v[104:107]
    ds_read_b128 v[176:179], v199 offset:38912
    v_mfma_f32_16x16x32_bf16 v[108:111], v[220:223], v[208:211], v[108:111]
    ds_read_b128 v[180:183], v199 offset:39936
    v_mfma_f32_16x16x32_bf16 v[112:115], v[224:227], v[204:207], v[112:115]
    ds_read_b128 v[184:187], v0 offset:36864
    v_mfma_f32_16x16x32_bf16 v[116:119], v[224:227], v[208:211], v[116:119]
    ds_read_b128 v[188:191], v0 offset:38912
    v_mfma_f32_16x16x32_bf16 v[120:123], v[212:215], v[228:231], v[120:123]
    ds_read_b128 v[192:195], v2 offset:45056
    v_mfma_f32_16x16x32_bf16 v[124:127], v[212:215], v[232:235], v[124:127]
    v_mul_f32_e64 v244, s40, v241
    v_mfma_f32_16x16x32_bf16 v[128:131], v[216:219], v[228:231], v[128:131]
    v_mul_f32_e64 v246, s40, v243
    v_mfma_f32_16x16x32_bf16 v[132:135], v[216:219], v[232:235], v[132:135]
    v_mul_f32_e64 v245, v241, v241
    v_mfma_f32_16x16x32_bf16 v[136:139], v[220:223], v[228:231], v[136:139]
    v_mul_f32_e64 v247, v243, v243
    v_mfma_f32_16x16x32_bf16 v[140:143], v[220:223], v[232:235], v[140:143]
    v_rcp_f32_e64 v241, v241
    v_mfma_f32_16x16x32_bf16 v[144:147], v[224:227], v[228:231], v[144:147]
    v_rcp_f32_e64 v243, v243
    v_mfma_f32_16x16x32_bf16 v[148:151], v[224:227], v[232:235], v[148:151]
    v_mul_f32_e64 v245, s42, v245
    v_mfma_f32_16x16x32_bf16 v[152:155], v[236:239], v[228:231], v[152:155]
    v_mul_f32_e64 v247, s42, v247
    v_mfma_f32_16x16x32_bf16 v[156:159], v[236:239], v[232:235], v[156:159]
    v_mul_f32 v245, v245, v244
    v_mul_f32_e64 v247, v247, v246
    s_waitcnt lgkmcnt(3)
    v_mfma_f32_16x16x32_bf16 v[88:91], v[168:171], v[160:163], v[88:91]
    ds_read_b128 v[204:207], v197 offset:37888
    v_mfma_f32_16x16x32_bf16 v[92:95], v[168:171], v[164:167], v[92:95]
    ds_read_b128 v[208:211], v197 offset:39936
    v_mfma_f32_16x16x32_bf16 v[96:99], v[172:175], v[160:163], v[96:99]
    ds_read_b128 v[212:215], v199 offset:46080
    v_mfma_f32_16x16x32_bf16 v[100:103], v[172:175], v[164:167], v[100:103]
    ds_read_b128 v[216:219], v199 offset:47104
    v_mfma_f32_16x16x32_bf16 v[104:107], v[176:179], v[160:163], v[104:107]
    ds_read_b128 v[220:223], v199 offset:48128
    v_mfma_f32_16x16x32_bf16 v[108:111], v[176:179], v[164:167], v[108:111]
    ds_read_b128 v[224:227], v199 offset:49152
    v_mfma_f32_16x16x32_bf16 v[112:115], v[180:183], v[160:163], v[112:115]
    ds_read_b128 v[228:231], v0 offset:37888
    v_mfma_f32_16x16x32_bf16 v[116:119], v[180:183], v[164:167], v[116:119]
    ds_read_b128 v[232:235], v0 offset:39936
    s_waitcnt lgkmcnt(8)
    v_mfma_f32_16x16x32_bf16 v[120:123], v[168:171], v[184:187], v[120:123]
    ds_read_b128 v[236:239], v2 offset:54272
    v_mfma_f32_16x16x32_bf16 v[124:127], v[168:171], v[188:191], v[124:127]
    v_bfe_u32 v202, v1, 4, 4
    v_mfma_f32_16x16x32_bf16 v[128:131], v[172:175], v[184:187], v[128:131]
    v_lshrrev_b32 v200, 1, v202
    v_mfma_f32_16x16x32_bf16 v[132:135], v[172:175], v[188:191], v[132:135]
    v_lshrrev_b32_e64 v201, 8, v1
    v_mfma_f32_16x16x32_bf16 v[136:139], v[176:179], v[184:187], v[136:139]
    v_xor_b32_e64 v200, v200, v201
    v_mfma_f32_16x16x32_bf16 v[140:143], v[176:179], v[188:191], v[140:143]
    v_lshlrev_b32_e64 v200, 4, v200
    v_mfma_f32_16x16x32_bf16 v[144:147], v[180:183], v[184:187], v[144:147]
    v_lshl_add_u32 v200, v202, 7, v200
    v_mfma_f32_16x16x32_bf16 v[148:151], v[180:183], v[188:191], v[148:151]
    s_xor_b32 s33, s30, 4096
    v_mfma_f32_16x16x32_bf16 v[152:155], v[192:195], v[184:187], v[152:155]
    s_add_u32 s33, s33, 18432
    v_mfma_f32_16x16x32_bf16 v[156:159], v[192:195], v[188:191], v[156:159]
    v_add_u32 v200, s33, v200
    v_xor_b32 v201, 64, v200
    s_waitcnt lgkmcnt(0)
    s_barrier
    v_mfma_f32_16x16x32_bf16 v[88:91], v[212:215], v[204:207], v[88:91]
    ds_read_b128 v[160:163], v196 offset:0
    v_mfma_f32_16x16x32_bf16 v[92:95], v[212:215], v[208:211], v[92:95]
    ds_read_b128 v[164:167], v196 offset:2048
    v_mfma_f32_16x16x32_bf16 v[96:99], v[216:219], v[204:207], v[96:99]
    ds_read_b128 v[168:171], v198 offset:0
    v_mfma_f32_16x16x32_bf16 v[100:103], v[216:219], v[208:211], v[100:103]
    ds_read_b128 v[172:175], v198 offset:1024
    v_mfma_f32_16x16x32_bf16 v[104:107], v[220:223], v[204:207], v[104:107]
    ds_read_b128 v[176:179], v198 offset:2048
    v_mfma_f32_16x16x32_bf16 v[108:111], v[220:223], v[208:211], v[108:111]
    ds_read_b128 v[180:183], v198 offset:3072
    v_mfma_f32_16x16x32_bf16 v[112:115], v[224:227], v[204:207], v[112:115]
    ds_read_b128 v[184:187], v3 offset:0
    v_mfma_f32_16x16x32_bf16 v[116:119], v[224:227], v[208:211], v[116:119]
    ds_read_b128 v[188:191], v3 offset:2048
    v_mfma_f32_16x16x32_bf16 v[120:123], v[212:215], v[228:231], v[120:123]
    ds_read_b128 v[192:195], v1 offset:8192
    v_mfma_f32_16x16x32_bf16 v[124:127], v[212:215], v[232:235], v[124:127]
    v_add_u32 v202, 73728, v200
    v_mfma_f32_16x16x32_bf16 v[128:131], v[216:219], v[228:231], v[128:131]
    v_add_u32 v203, 73728, v201
    v_mfma_f32_16x16x32_bf16 v[132:135], v[216:219], v[232:235], v[132:135]
    v_mfma_f32_16x16x32_bf16 v[136:139], v[220:223], v[228:231], v[136:139]
    v_mfma_f32_16x16x32_bf16 v[140:143], v[220:223], v[232:235], v[140:143]
    v_mfma_f32_16x16x32_bf16 v[144:147], v[224:227], v[228:231], v[144:147]
    v_mfma_f32_16x16x32_bf16 v[148:151], v[224:227], v[232:235], v[148:151]
    v_mfma_f32_16x16x32_bf16 v[152:155], v[236:239], v[228:231], v[152:155]
    v_mfma_f32_16x16x32_bf16 v[156:159], v[236:239], v[232:235], v[156:159]
    s_waitcnt lgkmcnt(3)
    v_mfma_f32_16x16x32_bf16 v[88:91], v[168:171], v[160:163], v[88:91]
    ds_read_b128 v[204:207], v196 offset:1024
    v_mfma_f32_16x16x32_bf16 v[92:95], v[168:171], v[164:167], v[92:95]
    ds_read_b128 v[208:211], v196 offset:3072
    v_mfma_f32_16x16x32_bf16 v[96:99], v[172:175], v[160:163], v[96:99]
    ds_read_b128 v[212:215], v198 offset:9216
    v_mfma_f32_16x16x32_bf16 v[100:103], v[172:175], v[164:167], v[100:103]
    ds_read_b128 v[216:219], v198 offset:10240
    v_mfma_f32_16x16x32_bf16 v[104:107], v[176:179], v[160:163], v[104:107]
    ds_read_b128 v[220:223], v198 offset:11264
    v_mfma_f32_16x16x32_bf16 v[108:111], v[176:179], v[164:167], v[108:111]
    ds_read_b128 v[224:227], v198 offset:12288
    v_mfma_f32_16x16x32_bf16 v[112:115], v[180:183], v[160:163], v[112:115]
    ds_read_b128 v[228:231], v3 offset:1024
    v_mfma_f32_16x16x32_bf16 v[116:119], v[180:183], v[164:167], v[116:119]
    ds_read_b128 v[232:235], v3 offset:3072
    s_waitcnt lgkmcnt(8)
    v_mfma_f32_16x16x32_bf16 v[120:123], v[168:171], v[184:187], v[120:123]
    ds_read_b128 v[236:239], v1 offset:17408
    v_mfma_f32_16x16x32_bf16 v[124:127], v[168:171], v[188:191], v[124:127]
    v_mfma_f32_16x16x32_bf16 v[128:131], v[172:175], v[184:187], v[128:131]
    v_mfma_f32_16x16x32_bf16 v[132:135], v[172:175], v[188:191], v[132:135]
    v_mfma_f32_16x16x32_bf16 v[136:139], v[176:179], v[184:187], v[136:139]
    v_mfma_f32_16x16x32_bf16 v[140:143], v[176:179], v[188:191], v[140:143]
    v_mfma_f32_16x16x32_bf16 v[144:147], v[180:183], v[184:187], v[144:147]
    v_mfma_f32_16x16x32_bf16 v[148:151], v[180:183], v[188:191], v[148:151]
    v_mfma_f32_16x16x32_bf16 v[152:155], v[192:195], v[184:187], v[152:155]
    v_mfma_f32_16x16x32_bf16 v[156:159], v[192:195], v[188:191], v[156:159]
    s_waitcnt lgkmcnt(0)
    s_barrier
    v_mfma_f32_16x16x32_bf16 v[88:91], v[212:215], v[204:207], v[88:91]
    ds_read_b128 v[160:163], v196 offset:36864
    v_mfma_f32_16x16x32_bf16 v[92:95], v[212:215], v[208:211], v[92:95]
    ds_read_b128 v[164:167], v196 offset:38912
    v_mfma_f32_16x16x32_bf16 v[96:99], v[216:219], v[204:207], v[96:99]
    ds_read_b128 v[168:171], v198 offset:36864
    v_mfma_f32_16x16x32_bf16 v[100:103], v[216:219], v[208:211], v[100:103]
    ds_read_b128 v[172:175], v198 offset:37888
    v_mfma_f32_16x16x32_bf16 v[104:107], v[220:223], v[204:207], v[104:107]
    ds_read_b128 v[176:179], v198 offset:38912
    v_mfma_f32_16x16x32_bf16 v[108:111], v[220:223], v[208:211], v[108:111]
    ds_read_b128 v[180:183], v198 offset:39936
    v_mfma_f32_16x16x32_bf16 v[112:115], v[224:227], v[204:207], v[112:115]
    ds_read_b128 v[184:187], v3 offset:36864
    v_mfma_f32_16x16x32_bf16 v[116:119], v[224:227], v[208:211], v[116:119]
    ds_read_b128 v[188:191], v3 offset:38912
    v_mfma_f32_16x16x32_bf16 v[120:123], v[212:215], v[228:231], v[120:123]
    ds_read_b128 v[192:195], v1 offset:45056
    v_mfma_f32_16x16x32_bf16 v[124:127], v[212:215], v[232:235], v[124:127]
    ds_read_b128 v[4:7], v255 offset:1024
    v_mfma_f32_16x16x32_bf16 v[128:131], v[216:219], v[228:231], v[128:131]
    ds_read_b128 v[8:11], v255 offset:1040
    v_mfma_f32_16x16x32_bf16 v[132:135], v[216:219], v[232:235], v[132:135]
    ds_read_b128 v[12:15], v255 offset:1056
    v_mfma_f32_16x16x32_bf16 v[136:139], v[220:223], v[228:231], v[136:139]
    ds_read_b128 v[252:255], v255 offset:1072
    v_mfma_f32_16x16x32_bf16 v[140:143], v[220:223], v[232:235], v[140:143]
    v_mfma_f32_16x16x32_bf16 v[144:147], v[224:227], v[228:231], v[144:147]
    v_mfma_f32_16x16x32_bf16 v[148:151], v[224:227], v[232:235], v[148:151]
    v_mfma_f32_16x16x32_bf16 v[152:155], v[236:239], v[228:231], v[152:155]
    v_mfma_f32_16x16x32_bf16 v[156:159], v[236:239], v[232:235], v[156:159]
    s_waitcnt lgkmcnt(7)
    v_mfma_f32_16x16x32_bf16 v[88:91], v[168:171], v[160:163], v[88:91]
    ds_read_b128 v[204:207], v196 offset:37888
    v_mfma_f32_16x16x32_bf16 v[92:95], v[168:171], v[164:167], v[92:95]
    ds_read_b128 v[208:211], v196 offset:39936
    v_mfma_f32_16x16x32_bf16 v[96:99], v[172:175], v[160:163], v[96:99]
    ds_read_b128 v[212:215], v198 offset:46080
    v_mfma_f32_16x16x32_bf16 v[100:103], v[172:175], v[164:167], v[100:103]
    ds_read_b128 v[216:219], v198 offset:47104
    v_mfma_f32_16x16x32_bf16 v[104:107], v[176:179], v[160:163], v[104:107]
    ds_read_b128 v[220:223], v198 offset:48128
    v_mfma_f32_16x16x32_bf16 v[108:111], v[176:179], v[164:167], v[108:111]
    ds_read_b128 v[224:227], v198 offset:49152
    v_mfma_f32_16x16x32_bf16 v[112:115], v[180:183], v[160:163], v[112:115]
    ds_read_b128 v[228:231], v3 offset:37888
    v_mfma_f32_16x16x32_bf16 v[116:119], v[180:183], v[164:167], v[116:119]
    ds_read_b128 v[232:235], v3 offset:39936
    s_waitcnt lgkmcnt(8)
    v_mfma_f32_16x16x32_bf16 v[120:123], v[168:171], v[184:187], v[120:123]
    ds_read_b128 v[236:239], v1 offset:54272
    v_fma_f32 v16, v16, v4, -v6
    v_mfma_f32_16x16x32_bf16 v[124:127], v[168:171], v[188:191], v[124:127]
    v_fma_f32 v17, v17, v5, -v7
    v_fma_f32 v18, v18, v8, -v10
    v_mfma_f32_16x16x32_bf16 v[128:131], v[172:175], v[184:187], v[128:131]
    v_fma_f32 v19, v19, v9, -v11
    v_fma_f32 v20, v20, v12, -v14
    v_mfma_f32_16x16x32_bf16 v[132:135], v[172:175], v[188:191], v[132:135]
    v_fma_f32 v21, v21, v13, -v15
    v_fma_f32 v22, v22, v252, -v254
    v_mfma_f32_16x16x32_bf16 v[136:139], v[176:179], v[184:187], v[136:139]
    v_fma_f32 v23, v23, v253, -v255
    v_cvt_pk_bf16_f32 v16, v16, v17
    v_mfma_f32_16x16x32_bf16 v[140:143], v[176:179], v[188:191], v[140:143]
    v_cvt_pk_bf16_f32 v17, v18, v19
    v_cvt_pk_bf16_f32 v18, v20, v21
    v_mfma_f32_16x16x32_bf16 v[144:147], v[180:183], v[184:187], v[144:147]
    v_cvt_pk_bf16_f32 v19, v22, v23
    v_fma_f32 v24, v24, v4, -v6
    v_mfma_f32_16x16x32_bf16 v[148:151], v[180:183], v[188:191], v[148:151]
    v_fma_f32 v25, v25, v5, -v7
    v_fma_f32 v26, v26, v8, -v10
    v_mfma_f32_16x16x32_bf16 v[152:155], v[192:195], v[184:187], v[152:155]
    v_fma_f32 v27, v27, v9, -v11
    v_fma_f32 v28, v28, v12, -v14
    v_mfma_f32_16x16x32_bf16 v[156:159], v[192:195], v[188:191], v[156:159]
    v_fma_f32 v29, v29, v13, -v15
    s_waitcnt lgkmcnt(0)
    s_barrier
    v_mfma_f32_16x16x32_bf16 v[88:91], v[212:215], v[204:207], v[88:91]
    ds_read_b128 v[160:163], v197 offset:0
    v_mfma_f32_16x16x32_bf16 v[92:95], v[212:215], v[208:211], v[92:95]
    ds_read_b128 v[164:167], v197 offset:2048
    v_fma_f32 v30, v30, v252, -v254
    v_mfma_f32_16x16x32_bf16 v[96:99], v[216:219], v[204:207], v[96:99]
    ds_read_b128 v[168:171], v199 offset:0
    v_fma_f32 v31, v31, v253, -v255
    v_mfma_f32_16x16x32_bf16 v[100:103], v[216:219], v[208:211], v[100:103]
    ds_read_b128 v[172:175], v199 offset:1024
    v_permlane32_swap_b32 v16, v18
    v_mfma_f32_16x16x32_bf16 v[104:107], v[220:223], v[204:207], v[104:107]
    ds_read_b128 v[176:179], v199 offset:2048
    v_permlane32_swap_b32 v17, v19
    v_mfma_f32_16x16x32_bf16 v[108:111], v[220:223], v[208:211], v[108:111]
    ds_read_b128 v[180:183], v199 offset:3072
    v_cvt_pk_bf16_f32 v24, v24, v25
    v_mfma_f32_16x16x32_bf16 v[112:115], v[224:227], v[204:207], v[112:115]
    ds_read_b128 v[184:187], v0 offset:0
    v_cvt_pk_bf16_f32 v25, v26, v27
    v_mfma_f32_16x16x32_bf16 v[116:119], v[224:227], v[208:211], v[116:119]
    ds_read_b128 v[188:191], v0 offset:2048
    v_mfma_f32_16x16x32_bf16 v[120:123], v[212:215], v[228:231], v[120:123]
    ds_read_b128 v[192:195], v2 offset:8192
    v_cvt_pk_bf16_f32 v26, v28, v29
    v_mfma_f32_16x16x32_bf16 v[124:127], v[212:215], v[232:235], v[124:127]
    v_cvt_pk_bf16_f32 v27, v30, v31
    v_permlane16_swap_b32 v16, v18
    v_mfma_f32_16x16x32_bf16 v[128:131], v[216:219], v[228:231], v[128:131]
    v_permlane16_swap_b32 v17, v19
    v_fma_f32 v32, v32, v4, -v6
    v_mfma_f32_16x16x32_bf16 v[132:135], v[216:219], v[232:235], v[132:135]
    v_fma_f32 v33, v33, v5, -v7
    v_fma_f32 v34, v34, v8, -v10
    v_mfma_f32_16x16x32_bf16 v[136:139], v[220:223], v[228:231], v[136:139]
    v_fma_f32 v35, v35, v9, -v11
    v_fma_f32 v36, v36, v12, -v14
    v_mfma_f32_16x16x32_bf16 v[140:143], v[220:223], v[232:235], v[140:143]
    v_fma_f32 v37, v37, v13, -v15
    v_fma_f32 v38, v38, v252, -v254
    v_mfma_f32_16x16x32_bf16 v[144:147], v[224:227], v[228:231], v[144:147]
    v_fma_f32 v39, v39, v253, -v255
    v_permlane32_swap_b32 v24, v26
    v_mfma_f32_16x16x32_bf16 v[148:151], v[224:227], v[232:235], v[148:151]
    v_permlane32_swap_b32 v25, v27
    v_cvt_pk_bf16_f32 v32, v32, v33
    v_mfma_f32_16x16x32_bf16 v[152:155], v[236:239], v[228:231], v[152:155]
    v_cvt_pk_bf16_f32 v33, v34, v35
    v_cvt_pk_bf16_f32 v34, v36, v37
    v_mfma_f32_16x16x32_bf16 v[156:159], v[236:239], v[232:235], v[156:159]
    v_cvt_pk_bf16_f32 v35, v38, v39
    s_waitcnt lgkmcnt(3)
    v_mfma_f32_16x16x32_bf16 v[88:91], v[168:171], v[160:163], v[88:91]
    ds_read_b128 v[204:207], v197 offset:1024
    v_mfma_f32_16x16x32_bf16 v[92:95], v[168:171], v[164:167], v[92:95]
    ds_read_b128 v[208:211], v197 offset:3072
    v_permlane16_swap_b32 v24, v26
    v_mfma_f32_16x16x32_bf16 v[96:99], v[172:175], v[160:163], v[96:99]
    ds_read_b128 v[212:215], v199 offset:9216
    v_permlane16_swap_b32 v25, v27
    v_mfma_f32_16x16x32_bf16 v[100:103], v[172:175], v[164:167], v[100:103]
    ds_read_b128 v[216:219], v199 offset:10240
    v_fma_f32 v40, v40, v4, -v6
    v_mfma_f32_16x16x32_bf16 v[104:107], v[176:179], v[160:163], v[104:107]
    ds_read_b128 v[220:223], v199 offset:11264
    v_fma_f32 v41, v41, v5, -v7
    v_mfma_f32_16x16x32_bf16 v[108:111], v[176:179], v[164:167], v[108:111]
    ds_read_b128 v[224:227], v199 offset:12288
    v_fma_f32 v42, v42, v8, -v10
    v_mfma_f32_16x16x32_bf16 v[112:115], v[180:183], v[160:163], v[112:115]
    ds_read_b128 v[228:231], v0 offset:1024
    v_fma_f32 v43, v43, v9, -v11
    v_mfma_f32_16x16x32_bf16 v[116:119], v[180:183], v[164:167], v[116:119]
    ds_read_b128 v[232:235], v0 offset:3072
    s_waitcnt lgkmcnt(8)
    v_mfma_f32_16x16x32_bf16 v[120:123], v[168:171], v[184:187], v[120:123]
    ds_read_b128 v[236:239], v2 offset:17408
    v_fma_f32 v44, v44, v12, -v14
    v_mfma_f32_16x16x32_bf16 v[124:127], v[168:171], v[188:191], v[124:127]
    v_fma_f32 v45, v45, v13, -v15
    v_fma_f32 v46, v46, v252, -v254
    v_mfma_f32_16x16x32_bf16 v[128:131], v[172:175], v[184:187], v[128:131]
    v_fma_f32 v47, v47, v253, -v255
    v_permlane32_swap_b32 v32, v34
    v_mfma_f32_16x16x32_bf16 v[132:135], v[172:175], v[188:191], v[132:135]
    v_permlane32_swap_b32 v33, v35
    v_cvt_pk_bf16_f32 v40, v40, v41
    v_mfma_f32_16x16x32_bf16 v[136:139], v[176:179], v[184:187], v[136:139]
    v_cvt_pk_bf16_f32 v41, v42, v43
    v_cvt_pk_bf16_f32 v42, v44, v45
    v_mfma_f32_16x16x32_bf16 v[140:143], v[176:179], v[188:191], v[140:143]
    v_cvt_pk_bf16_f32 v43, v46, v47
    v_permlane16_swap_b32 v32, v34
    v_mfma_f32_16x16x32_bf16 v[144:147], v[180:183], v[184:187], v[144:147]
    v_permlane16_swap_b32 v33, v35
    v_fma_f32 v48, v48, v4, -v6
    v_mfma_f32_16x16x32_bf16 v[148:151], v[180:183], v[188:191], v[148:151]
    v_fma_f32 v49, v49, v5, -v7
    v_fma_f32 v50, v50, v8, -v10
    v_mfma_f32_16x16x32_bf16 v[152:155], v[192:195], v[184:187], v[152:155]
    v_fma_f32 v51, v51, v9, -v11
    v_fma_f32 v52, v52, v12, -v14
    v_mfma_f32_16x16x32_bf16 v[156:159], v[192:195], v[188:191], v[156:159]
    v_fma_f32 v53, v53, v13, -v15
    s_waitcnt lgkmcnt(0)
    s_barrier
    v_mfma_f32_16x16x32_bf16 v[88:91], v[212:215], v[204:207], v[88:91]
    ds_read_b128 v[160:163], v197 offset:36864
    v_mfma_f32_16x16x32_bf16 v[92:95], v[212:215], v[208:211], v[92:95]
    ds_read_b128 v[164:167], v197 offset:38912
    v_fma_f32 v54, v54, v252, -v254
    v_mfma_f32_16x16x32_bf16 v[96:99], v[216:219], v[204:207], v[96:99]
    ds_read_b128 v[168:171], v199 offset:36864
    v_fma_f32 v55, v55, v253, -v255
    v_mfma_f32_16x16x32_bf16 v[100:103], v[216:219], v[208:211], v[100:103]
    ds_read_b128 v[172:175], v199 offset:37888
    v_permlane32_swap_b32 v40, v42
    v_mfma_f32_16x16x32_bf16 v[104:107], v[220:223], v[204:207], v[104:107]
    ds_read_b128 v[176:179], v199 offset:38912
    v_permlane32_swap_b32 v41, v43
    v_mfma_f32_16x16x32_bf16 v[108:111], v[220:223], v[208:211], v[108:111]
    ds_read_b128 v[180:183], v199 offset:39936
    v_cvt_pk_bf16_f32 v48, v48, v49
    v_mfma_f32_16x16x32_bf16 v[112:115], v[224:227], v[204:207], v[112:115]
    ds_read_b128 v[184:187], v0 offset:36864
    v_cvt_pk_bf16_f32 v49, v50, v51
    v_mfma_f32_16x16x32_bf16 v[116:119], v[224:227], v[208:211], v[116:119]
    ds_read_b128 v[188:191], v0 offset:38912
    v_mfma_f32_16x16x32_bf16 v[120:123], v[212:215], v[228:231], v[120:123]
    ds_read_b128 v[192:195], v2 offset:45056
    v_cvt_pk_bf16_f32 v50, v52, v53
    v_mfma_f32_16x16x32_bf16 v[124:127], v[212:215], v[232:235], v[124:127]
    v_cvt_pk_bf16_f32 v51, v54, v55
    v_permlane16_swap_b32 v40, v42
    v_mfma_f32_16x16x32_bf16 v[128:131], v[216:219], v[228:231], v[128:131]
    v_permlane16_swap_b32 v41, v43
    v_fma_f32 v56, v56, v4, -v6
    v_mfma_f32_16x16x32_bf16 v[132:135], v[216:219], v[232:235], v[132:135]
    v_fma_f32 v57, v57, v5, -v7
    v_fma_f32 v58, v58, v8, -v10
    v_mfma_f32_16x16x32_bf16 v[136:139], v[220:223], v[228:231], v[136:139]
    v_fma_f32 v59, v59, v9, -v11
    v_fma_f32 v60, v60, v12, -v14
    v_mfma_f32_16x16x32_bf16 v[140:143], v[220:223], v[232:235], v[140:143]
    v_fma_f32 v61, v61, v13, -v15
    v_fma_f32 v62, v62, v252, -v254
    v_mfma_f32_16x16x32_bf16 v[144:147], v[224:227], v[228:231], v[144:147]
    v_fma_f32 v63, v63, v253, -v255
    v_permlane32_swap_b32 v48, v50
    v_mfma_f32_16x16x32_bf16 v[148:151], v[224:227], v[232:235], v[148:151]
    v_permlane32_swap_b32 v49, v51
    v_cvt_pk_bf16_f32 v56, v56, v57
    v_mfma_f32_16x16x32_bf16 v[152:155], v[236:239], v[228:231], v[152:155]
    v_cvt_pk_bf16_f32 v57, v58, v59
    v_cvt_pk_bf16_f32 v58, v60, v61
    v_mfma_f32_16x16x32_bf16 v[156:159], v[236:239], v[232:235], v[156:159]
    v_cvt_pk_bf16_f32 v59, v62, v63
    s_waitcnt lgkmcnt(3)
    v_mfma_f32_16x16x32_bf16 v[88:91], v[168:171], v[160:163], v[88:91]
    ds_read_b128 v[204:207], v197 offset:37888
    v_mfma_f32_16x16x32_bf16 v[92:95], v[168:171], v[164:167], v[92:95]
    ds_read_b128 v[208:211], v197 offset:39936
    v_permlane16_swap_b32 v48, v50
    v_mfma_f32_16x16x32_bf16 v[96:99], v[172:175], v[160:163], v[96:99]
    ds_read_b128 v[212:215], v199 offset:46080
    buffer_store_dwordx4 v[16:19], v1, s[4:7], s38 offen offset:0 sc1
    v_permlane16_swap_b32 v49, v51
    v_mfma_f32_16x16x32_bf16 v[100:103], v[172:175], v[164:167], v[100:103]
    ds_read_b128 v[216:219], v199 offset:47104
    v_fma_f32 v64, v64, v4, -v6
    v_mfma_f32_16x16x32_bf16 v[104:107], v[176:179], v[160:163], v[104:107]
    ds_read_b128 v[220:223], v199 offset:48128
    v_fma_f32 v65, v65, v5, -v7
    v_mfma_f32_16x16x32_bf16 v[108:111], v[176:179], v[164:167], v[108:111]
    ds_read_b128 v[224:227], v199 offset:49152
    v_fma_f32 v66, v66, v8, -v10
    v_mfma_f32_16x16x32_bf16 v[112:115], v[180:183], v[160:163], v[112:115]
    ds_read_b128 v[228:231], v0 offset:37888
    v_fma_f32 v67, v67, v9, -v11
    v_mfma_f32_16x16x32_bf16 v[116:119], v[180:183], v[164:167], v[116:119]
    ds_read_b128 v[232:235], v0 offset:39936
    s_waitcnt lgkmcnt(8)
    buffer_store_dwordx4 v[24:27], v1, s[4:7], s38 offen offset:1024 sc1
    v_mfma_f32_16x16x32_bf16 v[120:123], v[168:171], v[184:187], v[120:123]
    ds_read_b128 v[236:239], v2 offset:54272
    v_fma_f32 v68, v68, v12, -v14
    v_mfma_f32_16x16x32_bf16 v[124:127], v[168:171], v[188:191], v[124:127]
    v_fma_f32 v69, v69, v13, -v15
    v_fma_f32 v70, v70, v252, -v254
    v_mfma_f32_16x16x32_bf16 v[128:131], v[172:175], v[184:187], v[128:131]
    v_fma_f32 v71, v71, v253, -v255
    v_permlane32_swap_b32 v56, v58
    v_mfma_f32_16x16x32_bf16 v[132:135], v[172:175], v[188:191], v[132:135]
    v_permlane32_swap_b32 v57, v59
    v_cvt_pk_bf16_f32 v64, v64, v65
    v_mfma_f32_16x16x32_bf16 v[136:139], v[176:179], v[184:187], v[136:139]
    buffer_store_dwordx4 v[32:35], v1, s[4:7], s38 offen offset:2048 sc1
    v_cvt_pk_bf16_f32 v65, v66, v67
    v_cvt_pk_bf16_f32 v66, v68, v69
    v_mfma_f32_16x16x32_bf16 v[140:143], v[176:179], v[188:191], v[140:143]
    v_cvt_pk_bf16_f32 v67, v70, v71
    v_permlane16_swap_b32 v56, v58
    v_mfma_f32_16x16x32_bf16 v[144:147], v[180:183], v[184:187], v[144:147]
    v_permlane16_swap_b32 v57, v59
    v_fma_f32 v72, v72, v4, -v6
    v_mfma_f32_16x16x32_bf16 v[148:151], v[180:183], v[188:191], v[148:151]
    v_fma_f32 v73, v73, v5, -v7
    v_fma_f32 v74, v74, v8, -v10
    v_mfma_f32_16x16x32_bf16 v[152:155], v[192:195], v[184:187], v[152:155]
    v_fma_f32 v75, v75, v9, -v11
    v_fma_f32 v76, v76, v12, -v14
    v_mfma_f32_16x16x32_bf16 v[156:159], v[192:195], v[188:191], v[156:159]
    v_fma_f32 v77, v77, v13, -v15
    s_waitcnt lgkmcnt(0)
    s_barrier
    v_mfma_f32_16x16x32_bf16 v[88:91], v[212:215], v[204:207], v[88:91]
    ds_read_b128 v[160:163], v196 offset:0
    v_mfma_f32_16x16x32_bf16 v[92:95], v[212:215], v[208:211], v[92:95]
    ds_read_b128 v[164:167], v196 offset:2048
    v_fma_f32 v78, v78, v252, -v254
    v_mfma_f32_16x16x32_bf16 v[96:99], v[216:219], v[204:207], v[96:99]
    ds_read_b128 v[168:171], v198 offset:0
    buffer_store_dwordx4 v[40:43], v1, s[4:7], s38 offen offset:3072 sc1
    v_fma_f32 v79, v79, v253, -v255
    v_mfma_f32_16x16x32_bf16 v[100:103], v[216:219], v[208:211], v[100:103]
    ds_read_b128 v[172:175], v198 offset:1024
    v_permlane32_swap_b32 v64, v66
    v_mfma_f32_16x16x32_bf16 v[104:107], v[220:223], v[204:207], v[104:107]
    ds_read_b128 v[176:179], v198 offset:2048
    v_permlane32_swap_b32 v65, v67
    v_mfma_f32_16x16x32_bf16 v[108:111], v[220:223], v[208:211], v[108:111]
    ds_read_b128 v[180:183], v198 offset:3072
    v_cvt_pk_bf16_f32 v72, v72, v73
    v_mfma_f32_16x16x32_bf16 v[112:115], v[224:227], v[204:207], v[112:115]
    ds_read_b128 v[184:187], v3 offset:0
    v_cvt_pk_bf16_f32 v73, v74, v75
    v_mfma_f32_16x16x32_bf16 v[116:119], v[224:227], v[208:211], v[116:119]
    ds_read_b128 v[188:191], v3 offset:2048
    buffer_store_dwordx4 v[48:51], v1, s[4:7], s39 offen offset:0 sc1
    v_mfma_f32_16x16x32_bf16 v[120:123], v[212:215], v[228:231], v[120:123]
    ds_read_b128 v[192:195], v1 offset:8192
    v_cvt_pk_bf16_f32 v74, v76, v77
    v_mfma_f32_16x16x32_bf16 v[124:127], v[212:215], v[232:235], v[124:127]
    v_cvt_pk_bf16_f32 v75, v78, v79
    v_permlane16_swap_b32 v64, v66
    v_mfma_f32_16x16x32_bf16 v[128:131], v[216:219], v[228:231], v[128:131]
    v_permlane16_swap_b32 v65, v67
    v_fma_f32 v80, v80, v4, -v6
    v_mfma_f32_16x16x32_bf16 v[132:135], v[216:219], v[232:235], v[132:135]
    v_fma_f32 v81, v81, v5, -v7
    v_fma_f32 v82, v82, v8, -v10
    v_mfma_f32_16x16x32_bf16 v[136:139], v[220:223], v[228:231], v[136:139]
    buffer_store_dwordx4 v[56:59], v1, s[4:7], s39 offen offset:1024 sc1
    v_fma_f32 v83, v83, v9, -v11
    v_fma_f32 v84, v84, v12, -v14
    v_mfma_f32_16x16x32_bf16 v[140:143], v[220:223], v[232:235], v[140:143]
    v_fma_f32 v85, v85, v13, -v15
    v_fma_f32 v86, v86, v252, -v254
    v_mfma_f32_16x16x32_bf16 v[144:147], v[224:227], v[228:231], v[144:147]
    v_fma_f32 v87, v87, v253, -v255
    v_permlane32_swap_b32 v72, v74
    v_mfma_f32_16x16x32_bf16 v[148:151], v[224:227], v[232:235], v[148:151]
    v_permlane32_swap_b32 v73, v75
    v_cvt_pk_bf16_f32 v80, v80, v81
    v_mfma_f32_16x16x32_bf16 v[152:155], v[236:239], v[228:231], v[152:155]
    v_cvt_pk_bf16_f32 v81, v82, v83
    v_cvt_pk_bf16_f32 v82, v84, v85
    v_mfma_f32_16x16x32_bf16 v[156:159], v[236:239], v[232:235], v[156:159]
    v_cvt_pk_bf16_f32 v83, v86, v87
    s_waitcnt lgkmcnt(3)
    v_mfma_f32_16x16x32_bf16 v[88:91], v[168:171], v[160:163], v[88:91]
    ds_read_b128 v[204:207], v196 offset:1024
    v_mfma_f32_16x16x32_bf16 v[92:95], v[168:171], v[164:167], v[92:95]
    ds_read_b128 v[208:211], v196 offset:3072
    v_permlane16_swap_b32 v72, v74
    v_mfma_f32_16x16x32_bf16 v[96:99], v[172:175], v[160:163], v[96:99]
    ds_read_b128 v[212:215], v198 offset:9216
    buffer_store_dwordx4 v[64:67], v1, s[4:7], s39 offen offset:2048 sc1
    v_permlane16_swap_b32 v73, v75
    v_mfma_f32_16x16x32_bf16 v[100:103], v[172:175], v[164:167], v[100:103]
    ds_read_b128 v[216:219], v198 offset:10240
    s_nop 0
    v_mfma_f32_16x16x32_bf16 v[104:107], v[176:179], v[160:163], v[104:107]
    ds_read_b128 v[220:223], v198 offset:11264
    v_permlane32_swap_b32 v80, v82
    v_mfma_f32_16x16x32_bf16 v[108:111], v[176:179], v[164:167], v[108:111]
    ds_read_b128 v[224:227], v198 offset:12288
    v_permlane32_swap_b32 v81, v83
    v_mfma_f32_16x16x32_bf16 v[112:115], v[180:183], v[160:163], v[112:115]
    ds_read_b128 v[228:231], v3 offset:1024
    s_nop 0
    v_mfma_f32_16x16x32_bf16 v[116:119], v[180:183], v[164:167], v[116:119]
    ds_read_b128 v[232:235], v3 offset:3072
    s_waitcnt lgkmcnt(8)
    v_mfma_f32_16x16x32_bf16 v[120:123], v[168:171], v[184:187], v[120:123]
    ds_read_b128 v[236:239], v1 offset:17408
    v_permlane16_swap_b32 v80, v82
    v_mfma_f32_16x16x32_bf16 v[124:127], v[168:171], v[188:191], v[124:127]
    v_permlane16_swap_b32 v81, v83
    v_mul_f32_e64 v4, s40, v249
    v_mfma_f32_16x16x32_bf16 v[128:131], v[172:175], v[184:187], v[128:131]
    v_mul_f32 v6, s40, v251
    v_mul_f32 v5, v249, v249
    v_mfma_f32_16x16x32_bf16 v[132:135], v[172:175], v[188:191], v[132:135]
    v_mul_f32 v7, v251, v251
    v_rcp_f32 v249, v249
    v_mfma_f32_16x16x32_bf16 v[136:139], v[176:179], v[184:187], v[136:139]
    v_rcp_f32 v251, v251
    v_mul_f32 v5, s42, v5
    v_mfma_f32_16x16x32_bf16 v[140:143], v[176:179], v[188:191], v[140:143]
    v_mul_f32 v7, s42, v7
    v_mul_f32 v5, v5, v4
    v_mfma_f32_16x16x32_bf16 v[144:147], v[180:183], v[184:187], v[144:147]
    v_mul_f32 v7, v7, v6
    v_subrev_u32 v8, s47, v200
    v_mfma_f32_16x16x32_bf16 v[148:151], v[180:183], v[188:191], v[148:151]
    v_subrev_u32 v9, s47, v201
    v_subrev_u32 v10, s47, v202
    v_mfma_f32_16x16x32_bf16 v[152:155], v[192:195], v[184:187], v[152:155]
    v_subrev_u32_e64 v11, s47, v203
    v_bfe_u32 v13, v1, 4, 4
    v_mfma_f32_16x16x32_bf16 v[156:159], v[192:195], v[188:191], v[156:159]
    s_lshl_b32 s33, s20, 6
    s_waitcnt lgkmcnt(0)
    s_barrier
    v_mfma_f32_16x16x32_bf16 v[88:91], v[212:215], v[204:207], v[88:91]
    ds_read_b128 v[160:163], v196 offset:36864
    v_mfma_f32_16x16x32_bf16 v[92:95], v[212:215], v[208:211], v[92:95]
    ds_read_b128 v[164:167], v196 offset:38912
    s_add_u32 s33, s33, 161280
    v_mfma_f32_16x16x32_bf16 v[96:99], v[216:219], v[204:207], v[96:99]
    ds_read_b128 v[168:171], v198 offset:36864
    buffer_store_dwordx4 v[72:75], v1, s[4:7], s39 offen offset:3072 sc1
    v_lshl_add_u32 v13, v13, 1, s33
    v_mfma_f32_16x16x32_bf16 v[100:103], v[216:219], v[208:211], v[100:103]
    ds_read_b128 v[172:175], v198 offset:37888
    v_xor_b32 v15, 64, v13
    v_mfma_f32_16x16x32_bf16 v[104:107], v[220:223], v[204:207], v[104:107]
    ds_read_b128 v[176:179], v198 offset:38912
    v_mfma_f32_16x16x32_bf16 v[108:111], v[220:223], v[208:211], v[108:111]
    ds_read_b128 v[180:183], v198 offset:39936
    v_mfma_f32_16x16x32_bf16 v[112:115], v[224:227], v[204:207], v[112:115]
    ds_read_b128 v[184:187], v3 offset:36864
    v_mfma_f32_16x16x32_bf16 v[116:119], v[224:227], v[208:211], v[116:119]
    ds_read_b128 v[188:191], v3 offset:38912
    buffer_store_dwordx4 v[80:83], v1, s[4:7], s46 offen offset:0 sc1
    v_mfma_f32_16x16x32_bf16 v[120:123], v[212:215], v[228:231], v[120:123]
    ds_read_b128 v[192:195], v1 offset:45056
    v_mfma_f32_16x16x32_bf16 v[124:127], v[212:215], v[232:235], v[124:127]
    v_mfma_f32_16x16x32_bf16 v[128:131], v[216:219], v[228:231], v[128:131]
    v_mfma_f32_16x16x32_bf16 v[132:135], v[216:219], v[232:235], v[132:135]
    v_mfma_f32_16x16x32_bf16 v[136:139], v[220:223], v[228:231], v[136:139]
    v_mfma_f32_16x16x32_bf16 v[140:143], v[220:223], v[232:235], v[140:143]
    v_mfma_f32_16x16x32_bf16 v[144:147], v[224:227], v[228:231], v[144:147]
    v_mfma_f32_16x16x32_bf16 v[148:151], v[224:227], v[232:235], v[148:151]
    v_mfma_f32_16x16x32_bf16 v[152:155], v[236:239], v[228:231], v[152:155]
    v_mfma_f32_16x16x32_bf16 v[156:159], v[236:239], v[232:235], v[156:159]
    s_waitcnt lgkmcnt(3)
    v_mfma_f32_16x16x32_bf16 v[88:91], v[168:171], v[160:163], v[88:91]
    ds_read_b128 v[204:207], v196 offset:37888
    v_mfma_f32_16x16x32_bf16 v[92:95], v[168:171], v[164:167], v[92:95]
    ds_read_b128 v[208:211], v196 offset:39936
    v_mfma_f32_16x16x32_bf16 v[96:99], v[172:175], v[160:163], v[96:99]
    ds_read_b128 v[212:215], v198 offset:46080
    v_mfma_f32_16x16x32_bf16 v[100:103], v[172:175], v[164:167], v[100:103]
    ds_read_b128 v[216:219], v198 offset:47104
    v_mfma_f32_16x16x32_bf16 v[104:107], v[176:179], v[160:163], v[104:107]
    ds_read_b128 v[220:223], v198 offset:48128
    v_mfma_f32_16x16x32_bf16 v[108:111], v[176:179], v[164:167], v[108:111]
    ds_read_b128 v[224:227], v198 offset:49152
    v_mfma_f32_16x16x32_bf16 v[112:115], v[180:183], v[160:163], v[112:115]
    ds_read_b128 v[228:231], v3 offset:37888
    v_mfma_f32_16x16x32_bf16 v[116:119], v[180:183], v[164:167], v[116:119]
    ds_read_b128 v[232:235], v3 offset:39936
    s_waitcnt lgkmcnt(8)
    v_mfma_f32_16x16x32_bf16 v[120:123], v[168:171], v[184:187], v[120:123]
    ds_read_b128 v[236:239], v1 offset:54272
    v_mfma_f32_16x16x32_bf16 v[124:127], v[168:171], v[188:191], v[124:127]
    v_mfma_f32_16x16x32_bf16 v[128:131], v[172:175], v[184:187], v[128:131]
    v_mfma_f32_16x16x32_bf16 v[132:135], v[172:175], v[188:191], v[132:135]
    s_lshr_b32 s35, s48, 4
    v_mfma_f32_16x16x32_bf16 v[136:139], v[176:179], v[184:187], v[136:139]
    v_lshrrev_b32 v0, 4, v1
    v_mfma_f32_16x16x32_bf16 v[140:143], v[176:179], v[188:191], v[140:143]
    v_and_b32_e64 v0, 48, v0
    v_mfma_f32_16x16x32_bf16 v[144:147], v[180:183], v[184:187], v[144:147]
    v_add_u32 v0, 160320, v0
    v_mfma_f32_16x16x32_bf16 v[148:151], v[180:183], v[188:191], v[148:151]
    v_add_u32_e64 v197, s35, v0
    v_mfma_f32_16x16x32_bf16 v[152:155], v[192:195], v[184:187], v[152:155]
    v_mfma_f32_16x16x32_bf16 v[156:159], v[192:195], v[188:191], v[156:159]
    s_waitcnt lgkmcnt(0)
    v_mfma_f32_16x16x32_bf16 v[88:91], v[212:215], v[204:207], v[88:91]
    ds_read_b128 v[168:171], v197 offset:0
    v_mfma_f32_16x16x32_bf16 v[92:95], v[212:215], v[208:211], v[92:95]
    ds_read_b128 v[172:175], v197 offset:64
    v_mfma_f32_16x16x32_bf16 v[96:99], v[216:219], v[204:207], v[96:99]
    ds_read_b128 v[176:179], v197 offset:128
    v_mfma_f32_16x16x32_bf16 v[100:103], v[216:219], v[208:211], v[100:103]
    ds_read_b128 v[180:183], v197 offset:192
    v_mfma_f32_16x16x32_bf16 v[104:107], v[220:223], v[204:207], v[104:107]
    ds_read_b128 v[184:187], v0 offset:512
    v_mfma_f32_16x16x32_bf16 v[108:111], v[220:223], v[208:211], v[108:111]
    ds_read_u16 v12, v13
    v_mfma_f32_16x16x32_bf16 v[112:115], v[224:227], v[204:207], v[112:115]
    ds_read_u16 v252, v13 offset:32
    v_mfma_f32_16x16x32_bf16 v[116:119], v[224:227], v[208:211], v[116:119]
    ds_read_u16 v160, v15
    v_mfma_f32_16x16x32_bf16 v[120:123], v[212:215], v[228:231], v[120:123]
    ds_read_u16 v161, v15 offset:32
    v_mfma_f32_16x16x32_bf16 v[124:127], v[212:215], v[232:235], v[124:127]
    v_mfma_f32_16x16x32_bf16 v[128:131], v[216:219], v[228:231], v[128:131]
    v_mfma_f32_16x16x32_bf16 v[132:135], v[216:219], v[232:235], v[132:135]
    v_mfma_f32_16x16x32_bf16 v[136:139], v[220:223], v[228:231], v[136:139]
    s_lshr_b32 s35, s20, 1
    s_mul_i32 s35, s35, 36864
    v_mfma_f32_16x16x32_bf16 v[140:143], v[220:223], v[232:235], v[140:143]
    s_and_b32 s34, s20, 1
    s_mul_i32 s34, s34, 9216
    v_mfma_f32_16x16x32_bf16 v[144:147], v[224:227], v[228:231], v[144:147]
    s_add_u32 s35, s35, s34
    v_mfma_f32_16x16x32_bf16 v[148:151], v[224:227], v[232:235], v[148:151]
    v_add_u32_e64 v3, s35, v2
    v_mfma_f32_16x16x32_bf16 v[152:155], v[236:239], v[228:231], v[152:155]
    v_mfma_f32_16x16x32_bf16 v[156:159], v[236:239], v[232:235], v[156:159]
    s_waitcnt vmcnt(0)
    s_barrier
    s_waitcnt lgkmcnt(0)
    v_lshlrev_b32 v15, 16, v12
    v_lshlrev_b32 v255, 16, v252
    v_lshlrev_b32 v235, 16, v160
    v_lshlrev_b32 v239, 16, v161
    v_lshlrev_b32 v14, 16, v12
    v_lshlrev_b32 v254, 16, v252
    v_lshlrev_b32 v234, 16, v160
    v_lshlrev_b32 v238, 16, v161
    v_lshlrev_b32 v13, 16, v12
    v_lshlrev_b32 v253, 16, v252
    v_lshlrev_b32 v233, 16, v160
    v_lshlrev_b32 v237, 16, v161
    v_lshlrev_b32 v12, 16, v12
    v_lshlrev_b32 v252, 16, v252
    v_lshlrev_b32 v232, 16, v160
    v_lshlrev_b32_e64 v236, 16, v161
L_g_z1:
    ds_write_b128 v3, v[16:19] offset:0
    v_pk_fma_f32 v[88:89], v[240:241], v[168:169], v[88:89] op_sel_hi:[0,1,1] neg_lo:[1,0,0] neg_hi:[1,0,0]
    v_pk_fma_f32 v[90:91], v[240:241], v[170:171], v[90:91] op_sel_hi:[0,1,1] neg_lo:[1,0,0] neg_hi:[1,0,0]
    v_pk_fma_f32 v[92:93], v[242:243], v[168:169], v[92:93] op_sel_hi:[0,1,1] neg_lo:[1,0,0] neg_hi:[1,0,0]
    v_pk_fma_f32 v[94:95], v[242:243], v[170:171], v[94:95] op_sel_hi:[0,1,1] neg_lo:[1,0,0] neg_hi:[1,0,0]
    ds_write_b128 v3, v[24:27] offset:1024
    v_pk_fma_f32 v[96:97], v[240:241], v[172:173], v[96:97] op_sel_hi:[0,1,1] neg_lo:[1,0,0] neg_hi:[1,0,0]
    v_pk_fma_f32 v[98:99], v[240:241], v[174:175], v[98:99] op_sel_hi:[0,1,1] neg_lo:[1,0,0] neg_hi:[1,0,0]
    v_pk_fma_f32 v[100:101], v[242:243], v[172:173], v[100:101] op_sel_hi:[0,1,1] neg_lo:[1,0,0] neg_hi:[1,0,0]
    v_pk_fma_f32 v[102:103], v[242:243], v[174:175], v[102:103] op_sel_hi:[0,1,1] neg_lo:[1,0,0] neg_hi:[1,0,0]
    ds_write_b128 v3, v[32:35] offset:2048
    v_pk_fma_f32 v[104:105], v[240:241], v[176:177], v[104:105] op_sel_hi:[0,1,1] neg_lo:[1,0,0] neg_hi:[1,0,0]
    v_pk_fma_f32 v[106:107], v[240:241], v[178:179], v[106:107] op_sel_hi:[0,1,1] neg_lo:[1,0,0] neg_hi:[1,0,0]
    v_pk_fma_f32 v[108:109], v[242:243], v[176:177], v[108:109] op_sel_hi:[0,1,1] neg_lo:[1,0,0] neg_hi:[1,0,0]
    v_pk_fma_f32 v[110:111], v[242:243], v[178:179], v[110:111] op_sel_hi:[0,1,1] neg_lo:[1,0,0] neg_hi:[1,0,0]
    ds_write_b128 v3, v[40:43] offset:3072
    v_pk_fma_f32 v[112:113], v[240:241], v[180:181], v[112:113] op_sel_hi:[0,1,1] neg_lo:[1,0,0] neg_hi:[1,0,0]
    v_pk_fma_f32 v[114:115], v[240:241], v[182:183], v[114:115] op_sel_hi:[0,1,1] neg_lo:[1,0,0] neg_hi:[1,0,0]
    v_pk_fma_f32 v[116:117], v[242:243], v[180:181], v[116:117] op_sel_hi:[0,1,1] neg_lo:[1,0,0] neg_hi:[1,0,0]
    v_pk_fma_f32 v[118:119], v[242:243], v[182:183], v[118:119] op_sel_hi:[0,1,1] neg_lo:[1,0,0] neg_hi:[1,0,0]
    ds_write_b128 v3, v[48:51] offset:4096
    v_pk_fma_f32 v[120:121], v[248:249], v[168:169], v[120:121] op_sel_hi:[0,1,1] neg_lo:[1,0,0] neg_hi:[1,0,0]
    v_pk_fma_f32 v[122:123], v[248:249], v[170:171], v[122:123] op_sel_hi:[0,1,1] neg_lo:[1,0,0] neg_hi:[1,0,0]
    v_pk_fma_f32 v[124:125], v[250:251], v[168:169], v[124:125] op_sel_hi:[0,1,1] neg_lo:[1,0,0] neg_hi:[1,0,0]
    v_pk_fma_f32 v[126:127], v[250:251], v[170:171], v[126:127] op_sel_hi:[0,1,1] neg_lo:[1,0,0] neg_hi:[1,0,0]
    ds_write_b128 v3, v[56:59] offset:5120
    v_pk_fma_f32 v[128:129], v[248:249], v[172:173], v[128:129] op_sel_hi:[0,1,1] neg_lo:[1,0,0] neg_hi:[1,0,0]
    v_pk_fma_f32 v[130:131], v[248:249], v[174:175], v[130:131] op_sel_hi:[0,1,1] neg_lo:[1,0,0] neg_hi:[1,0,0]
    v_pk_fma_f32 v[132:133], v[250:251], v[172:173], v[132:133] op_sel_hi:[0,1,1] neg_lo:[1,0,0] neg_hi:[1,0,0]
    v_pk_fma_f32 v[134:135], v[250:251], v[174:175], v[134:135] op_sel_hi:[0,1,1] neg_lo:[1,0,0] neg_hi:[1,0,0]
    ds_write_b128 v3, v[64:67] offset:6144
    v_pk_fma_f32 v[136:137], v[248:249], v[176:177], v[136:137] op_sel_hi:[0,1,1] neg_lo:[1,0,0] neg_hi:[1,0,0]
    v_pk_fma_f32 v[138:139], v[248:249], v[178:179], v[138:139] op_sel_hi:[0,1,1] neg_lo:[1,0,0] neg_hi:[1,0,0]
    v_pk_fma_f32 v[140:141], v[250:251], v[176:177], v[140:141] op_sel_hi:[0,1,1] neg_lo:[1,0,0] neg_hi:[1,0,0]
    v_pk_fma_f32 v[142:143], v[250:251], v[178:179], v[142:143] op_sel_hi:[0,1,1] neg_lo:[1,0,0] neg_hi:[1,0,0]
    ds_write_b128 v3, v[72:75] offset:7168
    v_pk_fma_f32 v[144:145], v[248:249], v[180:181], v[144:145] op_sel_hi:[0,1,1] neg_lo:[1,0,0] neg_hi:[1,0,0]
    v_pk_fma_f32 v[146:147], v[248:249], v[182:183], v[146:147] op_sel_hi:[0,1,1] neg_lo:[1,0,0] neg_hi:[1,0,0]
    v_pk_fma_f32 v[148:149], v[250:251], v[180:181], v[148:149] op_sel_hi:[0,1,1] neg_lo:[1,0,0] neg_hi:[1,0,0]
    v_pk_fma_f32 v[150:151], v[250:251], v[182:183], v[150:151] op_sel_hi:[0,1,1] neg_lo:[1,0,0] neg_hi:[1,0,0]
    ds_write_b128 v3, v[80:83] offset:8192
    v_pk_fma_f32 v[152:153], v[248:249], v[184:185], v[152:153] op_sel_hi:[0,1,1] neg_lo:[1,0,0] neg_hi:[1,0,0]
    v_pk_fma_f32 v[154:155], v[248:249], v[186:187], v[154:155] op_sel_hi:[0,1,1] neg_lo:[1,0,0] neg_hi:[1,0,0]
    v_pk_fma_f32 v[156:157], v[250:251], v[184:185], v[156:157] op_sel_hi:[0,1,1] neg_lo:[1,0,0] neg_hi:[1,0,0]
    v_pk_fma_f32 v[158:159], v[250:251], v[186:187], v[158:159] op_sel_hi:[0,1,1] neg_lo:[1,0,0] neg_hi:[1,0,0]
    v_pk_mul_f32 v[204:205], v[88:89], v[88:89]
    v_pk_mul_f32 v[206:207], v[90:91], v[90:91]
    v_pk_mul_f32 v[208:209], v[92:93], v[92:93]
    v_pk_mul_f32 v[210:211], v[94:95], v[94:95]
    v_pk_fma_f32 v[204:205], v[204:205], v[244:245], v[244:245] op_sel:[0,1,0] op_sel_hi:[1,1,0]
    v_pk_fma_f32 v[206:207], v[206:207], v[244:245], v[244:245] op_sel:[0,1,0] op_sel_hi:[1,1,0]
    v_pk_fma_f32 v[208:209], v[208:209], v[246:247], v[246:247] op_sel:[0,1,0] op_sel_hi:[1,1,0]
    v_pk_fma_f32 v[210:211], v[210:211], v[246:247], v[246:247] op_sel:[0,1,0] op_sel_hi:[1,1,0]
    v_pk_mul_f32 v[204:205], v[204:205], v[88:89]
    v_pk_mul_f32 v[206:207], v[206:207], v[90:91]
    v_pk_mul_f32 v[208:209], v[208:209], v[92:93]
    v_pk_mul_f32 v[210:211], v[210:211], v[94:95]
    v_exp_f32 v204, v204
    v_exp_f32 v205, v205
    v_exp_f32 v206, v206
    v_exp_f32 v207, v207
    v_exp_f32 v208, v208
    v_exp_f32 v209, v209
    v_exp_f32 v210, v210
    v_exp_f32 v211, v211
    v_pk_fma_f32 v[204:205], v[204:205], v[240:241], v[240:241] op_sel:[0,1,1] op_sel_hi:[1,1,1]
    v_pk_fma_f32 v[206:207], v[206:207], v[240:241], v[240:241] op_sel:[0,1,1] op_sel_hi:[1,1,1]
    v_pk_fma_f32 v[208:209], v[208:209], v[242:243], v[242:243] op_sel:[0,1,1] op_sel_hi:[1,1,1]
    v_pk_fma_f32 v[210:211], v[210:211], v[242:243], v[242:243] op_sel:[0,1,1] op_sel_hi:[1,1,1]
    v_rcp_f32 v204, v204
    v_rcp_f32 v205, v205
    v_rcp_f32 v206, v206
    v_rcp_f32 v207, v207
    v_rcp_f32 v208, v208
    v_rcp_f32 v209, v209
    v_rcp_f32 v210, v210
    v_rcp_f32 v211, v211
    v_pk_mul_f32 v[88:89], v[88:89], v[204:205]
    v_pk_mul_f32 v[90:91], v[90:91], v[206:207]
    v_pk_mul_f32 v[92:93], v[92:93], v[208:209]
    v_pk_mul_f32 v[94:95], v[94:95], v[210:211]
    v_pk_mul_f32 v[212:213], v[96:97], v[96:97]
    v_pk_mul_f32 v[214:215], v[98:99], v[98:99]
    v_pk_mul_f32 v[216:217], v[100:101], v[100:101]
    v_pk_mul_f32 v[218:219], v[102:103], v[102:103]
    v_pk_fma_f32 v[212:213], v[212:213], v[244:245], v[244:245] op_sel:[0,1,0] op_sel_hi:[1,1,0]
    v_pk_fma_f32 v[214:215], v[214:215], v[244:245], v[244:245] op_sel:[0,1,0] op_sel_hi:[1,1,0]
    v_pk_fma_f32 v[216:217], v[216:217], v[246:247], v[246:247] op_sel:[0,1,0] op_sel_hi:[1,1,0]
    v_pk_fma_f32 v[218:219], v[218:219], v[246:247], v[246:247] op_sel:[0,1,0] op_sel_hi:[1,1,0]
    v_pk_mul_f32 v[212:213], v[212:213], v[96:97]
    v_pk_mul_f32 v[214:215], v[214:215], v[98:99]
    v_pk_mul_f32 v[216:217], v[216:217], v[100:101]
    v_pk_mul_f32 v[218:219], v[218:219], v[102:103]
    v_exp_f32 v212, v212
    v_exp_f32 v213, v213
    v_exp_f32 v214, v214
    v_exp_f32 v215, v215
    v_exp_f32 v216, v216
    v_exp_f32 v217, v217
    v_exp_f32 v218, v218
    v_exp_f32 v219, v219
    v_pk_fma_f32 v[212:213], v[212:213], v[240:241], v[240:241] op_sel:[0,1,1] op_sel_hi:[1,1,1]
    v_pk_fma_f32 v[214:215], v[214:215], v[240:241], v[240:241] op_sel:[0,1,1] op_sel_hi:[1,1,1]
    v_pk_fma_f32 v[216:217], v[216:217], v[242:243], v[242:243] op_sel:[0,1,1] op_sel_hi:[1,1,1]
    v_pk_fma_f32 v[218:219], v[218:219], v[242:243], v[242:243] op_sel:[0,1,1] op_sel_hi:[1,1,1]
    v_rcp_f32 v212, v212
    v_rcp_f32 v213, v213
    v_rcp_f32 v214, v214
    v_rcp_f32 v215, v215
    v_rcp_f32 v216, v216
    v_rcp_f32 v217, v217
    v_rcp_f32 v218, v218
    v_rcp_f32 v219, v219
    v_pk_mul_f32 v[96:97], v[96:97], v[212:213]
    v_pk_mul_f32 v[98:99], v[98:99], v[214:215]
    v_pk_mul_f32 v[100:101], v[100:101], v[216:217]
    v_pk_mul_f32 v[102:103], v[102:103], v[218:219]
    v_pk_mul_f32 v[204:205], v[104:105], v[104:105]
    v_pk_mul_f32 v[206:207], v[106:107], v[106:107]
    v_pk_mul_f32 v[208:209], v[108:109], v[108:109]
    v_pk_mul_f32 v[210:211], v[110:111], v[110:111]
    v_pk_fma_f32 v[204:205], v[204:205], v[244:245], v[244:245] op_sel:[0,1,0] op_sel_hi:[1,1,0]
    v_pk_fma_f32 v[206:207], v[206:207], v[244:245], v[244:245] op_sel:[0,1,0] op_sel_hi:[1,1,0]
    v_pk_fma_f32 v[208:209], v[208:209], v[246:247], v[246:247] op_sel:[0,1,0] op_sel_hi:[1,1,0]
    v_pk_fma_f32 v[210:211], v[210:211], v[246:247], v[246:247] op_sel:[0,1,0] op_sel_hi:[1,1,0]
    v_pk_mul_f32 v[204:205], v[204:205], v[104:105]
    v_pk_mul_f32 v[206:207], v[206:207], v[106:107]
    v_pk_mul_f32 v[208:209], v[208:209], v[108:109]
    v_pk_mul_f32 v[210:211], v[210:211], v[110:111]
    v_exp_f32 v204, v204
    v_exp_f32 v205, v205
    v_exp_f32 v206, v206
    v_exp_f32 v207, v207
    v_exp_f32 v208, v208
    v_exp_f32 v209, v209
    v_exp_f32 v210, v210
    v_exp_f32 v211, v211
    v_pk_fma_f32 v[204:205], v[204:205], v[240:241], v[240:241] op_sel:[0,1,1] op_sel_hi:[1,1,1]
    v_pk_fma_f32 v[206:207], v[206:207], v[240:241], v[240:241] op_sel:[0,1,1] op_sel_hi:[1,1,1]
    v_pk_fma_f32 v[208:209], v[208:209], v[242:243], v[242:243] op_sel:[0,1,1] op_sel_hi:[1,1,1]
    v_pk_fma_f32 v[210:211], v[210:211], v[242:243], v[242:243] op_sel:[0,1,1] op_sel_hi:[1,1,1]
    v_rcp_f32 v204, v204
    v_rcp_f32 v205, v205
    v_rcp_f32 v206, v206
    v_rcp_f32 v207, v207
    v_rcp_f32 v208, v208
    v_rcp_f32 v209, v209
    v_rcp_f32 v210, v210
    v_rcp_f32 v211, v211
    v_pk_mul_f32 v[104:105], v[104:105], v[204:205]
    v_pk_mul_f32 v[106:107], v[106:107], v[206:207]
    v_pk_mul_f32 v[108:109], v[108:109], v[208:209]
    v_pk_mul_f32 v[110:111], v[110:111], v[210:211]
    s_waitcnt lgkmcnt(0)
    s_barrier
    ds_read_b128 v[160:163], v202 offset:0
    ds_read_b128 v[164:167], v202 offset:2048
    ds_read_b128 v[168:171], v199 offset:0
    ds_read_b128 v[172:175], v199 offset:1024
    ds_read_b128 v[176:179], v199 offset:2048
    ds_read_b128 v[180:183], v199 offset:3072
    ds_read_b128 v[184:187], v10 offset:0
    ds_read_b128 v[188:191], v10 offset:2048
    ds_read_b128 v[192:195], v2 offset:8192
    v_pk_mul_f32 v[212:213], v[112:113], v[112:113]
    v_pk_mul_f32 v[214:215], v[114:115], v[114:115]
    v_pk_mul_f32 v[216:217], v[116:117], v[116:117]
    v_pk_mul_f32 v[218:219], v[118:119], v[118:119]
    v_pk_fma_f32 v[212:213], v[212:213], v[244:245], v[244:245] op_sel:[0,1,0] op_sel_hi:[1,1,0]
    v_pk_fma_f32 v[214:215], v[214:215], v[244:245], v[244:245] op_sel:[0,1,0] op_sel_hi:[1,1,0]
    v_pk_fma_f32 v[216:217], v[216:217], v[246:247], v[246:247] op_sel:[0,1,0] op_sel_hi:[1,1,0]
    v_pk_fma_f32 v[218:219], v[218:219], v[246:247], v[246:247] op_sel:[0,1,0] op_sel_hi:[1,1,0]
    v_pk_mul_f32 v[212:213], v[212:213], v[112:113]
    v_pk_mul_f32 v[214:215], v[214:215], v[114:115]
    v_pk_mul_f32 v[216:217], v[216:217], v[116:117]
    v_pk_mul_f32 v[218:219], v[218:219], v[118:119]
    v_exp_f32 v212, v212
    v_exp_f32 v213, v213
    v_exp_f32 v214, v214
    v_exp_f32 v215, v215
    v_exp_f32 v216, v216
    v_exp_f32 v217, v217
    v_exp_f32 v218, v218
    v_exp_f32 v219, v219
    v_pk_fma_f32 v[212:213], v[212:213], v[240:241], v[240:241] op_sel:[0,1,1] op_sel_hi:[1,1,1]
    v_pk_fma_f32 v[214:215], v[214:215], v[240:241], v[240:241] op_sel:[0,1,1] op_sel_hi:[1,1,1]
    v_pk_fma_f32 v[216:217], v[216:217], v[242:243], v[242:243] op_sel:[0,1,1] op_sel_hi:[1,1,1]
    v_pk_fma_f32 v[218:219], v[218:219], v[242:243], v[242:243] op_sel:[0,1,1] op_sel_hi:[1,1,1]
    v_rcp_f32 v212, v212
    v_rcp_f32 v213, v213
    v_rcp_f32 v214, v214
    v_rcp_f32 v215, v215
    v_rcp_f32 v216, v216
    v_rcp_f32 v217, v217
    v_rcp_f32 v218, v218
    v_rcp_f32 v219, v219
    v_pk_mul_f32 v[112:113], v[112:113], v[212:213]
    v_pk_mul_f32 v[114:115], v[114:115], v[214:215]
    v_pk_mul_f32 v[116:117], v[116:117], v[216:217]
    v_pk_mul_f32 v[118:119], v[118:119], v[218:219]
    s_waitcnt lgkmcnt(3)
    v_mfma_f32_16x16x32_bf16 v[16:19], v[168:171], v[160:163], v[232:235]
    ds_read_b128 v[204:207], v203 offset:0
    v_mfma_f32_16x16x32_bf16 v[20:23], v[168:171], v[164:167], v[236:239]
    ds_read_b128 v[208:211], v203 offset:2048
    v_mfma_f32_16x16x32_bf16 v[24:27], v[172:175], v[160:163], v[232:235]
    ds_read_b128 v[212:215], v199 offset:9216
    v_mfma_f32_16x16x32_bf16 v[28:31], v[172:175], v[164:167], v[236:239]
    ds_read_b128 v[216:219], v199 offset:10240
    v_mfma_f32_16x16x32_bf16 v[32:35], v[176:179], v[160:163], v[232:235]
    ds_read_b128 v[220:223], v199 offset:11264
    v_mfma_f32_16x16x32_bf16 v[36:39], v[176:179], v[164:167], v[236:239]
    ds_read_b128 v[224:227], v199 offset:12288
    v_mfma_f32_16x16x32_bf16 v[40:43], v[180:183], v[160:163], v[232:235]
    ds_read_b128 v[228:231], v11 offset:0
    v_mfma_f32_16x16x32_bf16 v[44:47], v[180:183], v[164:167], v[236:239]
    ds_read_b128 v[232:235], v11 offset:2048
    s_waitcnt lgkmcnt(8)
    v_mfma_f32_16x16x32_bf16 v[48:51], v[168:171], v[184:187], v[12:15]
    ds_read_b128 v[236:239], v2 offset:17408
    v_mfma_f32_16x16x32_bf16 v[52:55], v[168:171], v[188:191], v[252:255]
    v_mfma_f32_16x16x32_bf16 v[56:59], v[172:175], v[184:187], v[12:15]
    v_mfma_f32_16x16x32_bf16 v[60:63], v[172:175], v[188:191], v[252:255]
    v_mfma_f32_16x16x32_bf16 v[64:67], v[176:179], v[184:187], v[12:15]
    v_mfma_f32_16x16x32_bf16 v[68:71], v[176:179], v[188:191], v[252:255]
    v_mfma_f32_16x16x32_bf16 v[72:75], v[180:183], v[184:187], v[12:15]
    v_mfma_f32_16x16x32_bf16 v[76:79], v[180:183], v[188:191], v[252:255]
    v_mfma_f32_16x16x32_bf16 v[80:83], v[192:195], v[184:187], v[12:15]
    v_mfma_f32_16x16x32_bf16 v[84:87], v[192:195], v[188:191], v[252:255]
    s_waitcnt lgkmcnt(0)
    s_barrier
    v_mfma_f32_16x16x32_bf16 v[16:19], v[212:215], v[204:207], v[16:19]
    ds_read_b128 v[160:163], v202 offset:36864
    v_mfma_f32_16x16x32_bf16 v[20:23], v[212:215], v[208:211], v[20:23]
    ds_read_b128 v[164:167], v202 offset:38912
    v_mfma_f32_16x16x32_bf16 v[24:27], v[216:219], v[204:207], v[24:27]
    ds_read_b128 v[168:171], v199 offset:36864
    v_mfma_f32_16x16x32_bf16 v[28:31], v[216:219], v[208:211], v[28:31]
    ds_read_b128 v[172:175], v199 offset:37888
    v_mul_f32_e64 v12, v120, v120
    v_mfma_f32_16x16x32_bf16 v[32:35], v[220:223], v[204:207], v[32:35]
    ds_read_b128 v[176:179], v199 offset:38912
    v_mul_f32_e64 v13, v121, v121
    v_mfma_f32_16x16x32_bf16 v[36:39], v[220:223], v[208:211], v[36:39]
    ds_read_b128 v[180:183], v199 offset:39936
    v_mul_f32_e64 v14, v122, v122
    v_mfma_f32_16x16x32_bf16 v[40:43], v[224:227], v[204:207], v[40:43]
    ds_read_b128 v[184:187], v10 offset:36864
    v_mul_f32_e64 v15, v123, v123
    v_mfma_f32_16x16x32_bf16 v[44:47], v[224:227], v[208:211], v[44:47]
    ds_read_b128 v[188:191], v10 offset:38912
    v_mfma_f32_16x16x32_bf16 v[48:51], v[212:215], v[228:231], v[48:51]
    ds_read_b128 v[192:195], v2 offset:45056
    v_mul_f32_e64 v252, v124, v124
    v_mfma_f32_16x16x32_bf16 v[52:55], v[212:215], v[232:235], v[52:55]
    v_mul_f32 v253, v125, v125
    v_mul_f32 v254, v126, v126
    v_mfma_f32_16x16x32_bf16 v[56:59], v[216:219], v[228:231], v[56:59]
    v_mul_f32_e64 v255, v127, v127
    v_fma_f32 v12, v12, v5, v4
    v_mfma_f32_16x16x32_bf16 v[60:63], v[216:219], v[232:235], v[60:63]
    v_fma_f32 v13, v13, v5, v4
    v_fma_f32 v14, v14, v5, v4
    v_mfma_f32_16x16x32_bf16 v[64:67], v[220:223], v[228:231], v[64:67]
    v_fma_f32 v15, v15, v5, v4
    v_fma_f32 v252, v252, v7, v6
    v_mfma_f32_16x16x32_bf16 v[68:71], v[220:223], v[232:235], v[68:71]
    v_fma_f32 v253, v253, v7, v6
    v_fma_f32 v254, v254, v7, v6
    v_mfma_f32_16x16x32_bf16 v[72:75], v[224:227], v[228:231], v[72:75]
    v_fma_f32 v255, v255, v7, v6
    v_mul_f32_e64 v12, v12, v120
    v_mfma_f32_16x16x32_bf16 v[76:79], v[224:227], v[232:235], v[76:79]
    v_mul_f32 v13, v13, v121
    v_mul_f32 v14, v14, v122
    v_mfma_f32_16x16x32_bf16 v[80:83], v[236:239], v[228:231], v[80:83]
    v_mul_f32 v15, v15, v123
    v_mul_f32 v252, v252, v124
    v_mfma_f32_16x16x32_bf16 v[84:87], v[236:239], v[232:235], v[84:87]
    v_mul_f32 v253, v253, v125
    s_waitcnt lgkmcnt(3)
    v_mfma_f32_16x16x32_bf16 v[16:19], v[168:171], v[160:163], v[16:19]
    ds_read_b128 v[204:207], v203 offset:36864
    v_mfma_f32_16x16x32_bf16 v[20:23], v[168:171], v[164:167], v[20:23]
    ds_read_b128 v[208:211], v203 offset:38912
    v_mul_f32_e64 v254, v254, v126
    v_mfma_f32_16x16x32_bf16 v[24:27], v[172:175], v[160:163], v[24:27]
    ds_read_b128 v[212:215], v199 offset:46080
    v_mul_f32_e64 v255, v255, v127
    v_mfma_f32_16x16x32_bf16 v[28:31], v[172:175], v[164:167], v[28:31]
    ds_read_b128 v[216:219], v199 offset:47104
    v_exp_f32_e64 v12, v12
    v_mfma_f32_16x16x32_bf16 v[32:35], v[176:179], v[160:163], v[32:35]
    ds_read_b128 v[220:223], v199 offset:48128
    v_exp_f32_e64 v13, v13
    v_mfma_f32_16x16x32_bf16 v[36:39], v[176:179], v[164:167], v[36:39]
    ds_read_b128 v[224:227], v199 offset:49152
    v_exp_f32_e64 v14, v14
    v_mfma_f32_16x16x32_bf16 v[40:43], v[180:183], v[160:163], v[40:43]
    ds_read_b128 v[228:231], v11 offset:36864
    v_exp_f32_e64 v15, v15
    v_mfma_f32_16x16x32_bf16 v[44:47], v[180:183], v[164:167], v[44:47]
    ds_read_b128 v[232:235], v11 offset:38912
    s_waitcnt lgkmcnt(8)
    v_mfma_f32_16x16x32_bf16 v[48:51], v[168:171], v[184:187], v[48:51]
    ds_read_b128 v[236:239], v2 offset:54272
    v_exp_f32 v252, v252
    v_mfma_f32_16x16x32_bf16 v[52:55], v[168:171], v[188:191], v[52:55]
    v_exp_f32_e64 v253, v253
    v_mfma_f32_16x16x32_bf16 v[56:59], v[172:175], v[184:187], v[56:59]
    v_exp_f32_e64 v254, v254
    v_mfma_f32_16x16x32_bf16 v[60:63], v[172:175], v[188:191], v[60:63]
    v_exp_f32_e64 v255, v255
    v_mfma_f32_16x16x32_bf16 v[64:67], v[176:179], v[184:187], v[64:67]
    v_fma_f32 v12, v12, v249, v249
    v_fma_f32 v13, v13, v249, v249
    v_mfma_f32_16x16x32_bf16 v[68:71], v[176:179], v[188:191], v[68:71]
    v_fma_f32 v14, v14, v249, v249
    v_fma_f32 v15, v15, v249, v249
    v_mfma_f32_16x16x32_bf16 v[72:75], v[180:183], v[184:187], v[72:75]
    v_fma_f32 v252, v252, v251, v251
    v_fma_f32 v253, v253, v251, v251
    v_mfma_f32_16x16x32_bf16 v[76:79], v[180:183], v[188:191], v[76:79]
    v_fma_f32 v254, v254, v251, v251
    v_fma_f32 v255, v255, v251, v251
    v_mfma_f32_16x16x32_bf16 v[80:83], v[192:195], v[184:187], v[80:83]
    v_rcp_f32_e64 v12, v12
    v_mfma_f32_16x16x32_bf16 v[84:87], v[192:195], v[188:191], v[84:87]
    v_rcp_f32_e64 v13, v13
    s_waitcnt lgkmcnt(0)
    s_barrier
    v_mfma_f32_16x16x32_bf16 v[16:19], v[212:215], v[204:207], v[16:19]
    ds_read_b128 v[160:163], v200 offset:0
    v_mfma_f32_16x16x32_bf16 v[20:23], v[212:215], v[208:211], v[20:23]
    ds_read_b128 v[164:167], v200 offset:2048
    v_rcp_f32_e64 v14, v14
    v_mfma_f32_16x16x32_bf16 v[24:27], v[216:219], v[204:207], v[24:27]
    ds_read_b128 v[168:171], v198 offset:0
    v_rcp_f32_e64 v15, v15
    v_mfma_f32_16x16x32_bf16 v[28:31], v[216:219], v[208:211], v[28:31]
    ds_read_b128 v[172:175], v198 offset:1024
    v_rcp_f32_e64 v252, v252
    v_mfma_f32_16x16x32_bf16 v[32:35], v[220:223], v[204:207], v[32:35]
    ds_read_b128 v[176:179], v198 offset:2048
    v_rcp_f32_e64 v253, v253
    v_mfma_f32_16x16x32_bf16 v[36:39], v[220:223], v[208:211], v[36:39]
    ds_read_b128 v[180:183], v198 offset:3072
    v_rcp_f32_e64 v254, v254
    v_mfma_f32_16x16x32_bf16 v[40:43], v[224:227], v[204:207], v[40:43]
    ds_read_b128 v[184:187], v8 offset:0
    v_rcp_f32_e64 v255, v255
    v_mfma_f32_16x16x32_bf16 v[44:47], v[224:227], v[208:211], v[44:47]
    ds_read_b128 v[188:191], v8 offset:2048
    v_mfma_f32_16x16x32_bf16 v[48:51], v[212:215], v[228:231], v[48:51]
    ds_read_b128 v[192:195], v1 offset:8192
    v_mul_f32_e64 v120, v120, v12
    v_mfma_f32_16x16x32_bf16 v[52:55], v[212:215], v[232:235], v[52:55]
    v_mul_f32 v121, v121, v13
    v_mul_f32 v122, v122, v14
    v_mfma_f32_16x16x32_bf16 v[56:59], v[216:219], v[228:231], v[56:59]
    v_mul_f32 v123, v123, v15
    v_mul_f32 v124, v124, v252
    v_mfma_f32_16x16x32_bf16 v[60:63], v[216:219], v[232:235], v[60:63]
    v_mul_f32 v125, v125, v253
    v_mul_f32 v126, v126, v254
    v_mfma_f32_16x16x32_bf16 v[64:67], v[220:223], v[228:231], v[64:67]
    v_mul_f32 v127, v127, v255
    v_mul_f32 v12, v128, v128
    v_mfma_f32_16x16x32_bf16 v[68:71], v[220:223], v[232:235], v[68:71]
    v_mul_f32 v13, v129, v129
    v_mul_f32 v14, v130, v130
    v_mfma_f32_16x16x32_bf16 v[72:75], v[224:227], v[228:231], v[72:75]
    v_mul_f32 v15, v131, v131
    v_mul_f32 v252, v132, v132
    v_mfma_f32_16x16x32_bf16 v[76:79], v[224:227], v[232:235], v[76:79]
    v_mul_f32 v253, v133, v133
    v_mul_f32 v254, v134, v134
    v_mfma_f32_16x16x32_bf16 v[80:83], v[236:239], v[228:231], v[80:83]
    v_mul_f32_e64 v255, v135, v135
    v_fma_f32 v12, v12, v5, v4
    v_mfma_f32_16x16x32_bf16 v[84:87], v[236:239], v[232:235], v[84:87]
    v_fma_f32 v13, v13, v5, v4
    s_waitcnt lgkmcnt(3)
    v_mfma_f32_16x16x32_bf16 v[16:19], v[168:171], v[160:163], v[16:19]
    ds_read_b128 v[204:207], v201 offset:0
    v_mfma_f32_16x16x32_bf16 v[20:23], v[168:171], v[164:167], v[20:23]
    ds_read_b128 v[208:211], v201 offset:2048
    v_fma_f32 v14, v14, v5, v4
    v_mfma_f32_16x16x32_bf16 v[24:27], v[172:175], v[160:163], v[24:27]
    ds_read_b128 v[212:215], v198 offset:9216
    v_fma_f32 v15, v15, v5, v4
    v_mfma_f32_16x16x32_bf16 v[28:31], v[172:175], v[164:167], v[28:31]
    ds_read_b128 v[216:219], v198 offset:10240
    v_fma_f32 v252, v252, v7, v6
    v_mfma_f32_16x16x32_bf16 v[32:35], v[176:179], v[160:163], v[32:35]
    ds_read_b128 v[220:223], v198 offset:11264
    v_fma_f32 v253, v253, v7, v6
    v_mfma_f32_16x16x32_bf16 v[36:39], v[176:179], v[164:167], v[36:39]
    ds_read_b128 v[224:227], v198 offset:12288
    v_fma_f32 v254, v254, v7, v6
    v_mfma_f32_16x16x32_bf16 v[40:43], v[180:183], v[160:163], v[40:43]
    ds_read_b128 v[228:231], v9 offset:0
    v_fma_f32 v255, v255, v7, v6
    v_mfma_f32_16x16x32_bf16 v[44:47], v[180:183], v[164:167], v[44:47]
    ds_read_b128 v[232:235], v9 offset:2048
    s_waitcnt lgkmcnt(8)
    v_mfma_f32_16x16x32_bf16 v[48:51], v[168:171], v[184:187], v[48:51]
    ds_read_b128 v[236:239], v1 offset:17408
    v_mul_f32_e64 v12, v12, v128
    v_mfma_f32_16x16x32_bf16 v[52:55], v[168:171], v[188:191], v[52:55]
    v_mul_f32 v13, v13, v129
    v_mul_f32 v14, v14, v130
    v_mfma_f32_16x16x32_bf16 v[56:59], v[172:175], v[184:187], v[56:59]
    v_mul_f32 v15, v15, v131
    v_mul_f32 v252, v252, v132
    v_mfma_f32_16x16x32_bf16 v[60:63], v[172:175], v[188:191], v[60:63]
    v_mul_f32 v253, v253, v133
    v_mul_f32 v254, v254, v134
    v_mfma_f32_16x16x32_bf16 v[64:67], v[176:179], v[184:187], v[64:67]
    v_mul_f32 v255, v255, v135
    v_exp_f32 v12, v12
    v_mfma_f32_16x16x32_bf16 v[68:71], v[176:179], v[188:191], v[68:71]
    v_exp_f32_e64 v13, v13
    v_mfma_f32_16x16x32_bf16 v[72:75], v[180:183], v[184:187], v[72:75]
    v_exp_f32_e64 v14, v14
    v_mfma_f32_16x16x32_bf16 v[76:79], v[180:183], v[188:191], v[76:79]
    v_exp_f32_e64 v15, v15
    v_mfma_f32_16x16x32_bf16 v[80:83], v[192:195], v[184:187], v[80:83]
    v_exp_f32_e64 v252, v252
    v_mfma_f32_16x16x32_bf16 v[84:87], v[192:195], v[188:191], v[84:87]
    v_exp_f32_e64 v253, v253
    s_waitcnt lgkmcnt(0)
    s_barrier
    v_mfma_f32_16x16x32_bf16 v[16:19], v[212:215], v[204:207], v[16:19]
    ds_read_b128 v[160:163], v200 offset:36864
    v_mfma_f32_16x16x32_bf16 v[20:23], v[212:215], v[208:211], v[20:23]
    ds_read_b128 v[164:167], v200 offset:38912
    v_exp_f32_e64 v254, v254
    v_mfma_f32_16x16x32_bf16 v[24:27], v[216:219], v[204:207], v[24:27]
    ds_read_b128 v[168:171], v198 offset:36864
    v_exp_f32_e64 v255, v255
    v_mfma_f32_16x16x32_bf16 v[28:31], v[216:219], v[208:211], v[28:31]
    ds_read_b128 v[172:175], v198 offset:37888
    v_fma_f32 v12, v12, v249, v249
    v_mfma_f32_16x16x32_bf16 v[32:35], v[220:223], v[204:207], v[32:35]
    ds_read_b128 v[176:179], v198 offset:38912
    v_fma_f32 v13, v13, v249, v249
    v_mfma_f32_16x16x32_bf16 v[36:39], v[220:223], v[208:211], v[36:39]
    ds_read_b128 v[180:183], v198 offset:39936
    v_fma_f32 v14, v14, v249, v249
    v_mfma_f32_16x16x32_bf16 v[40:43], v[224:227], v[204:207], v[40:43]
    ds_read_b128 v[184:187], v8 offset:36864
    v_fma_f32 v15, v15, v249, v249
    v_mfma_f32_16x16x32_bf16 v[44:47], v[224:227], v[208:211], v[44:47]
    ds_read_b128 v[188:191], v8 offset:38912
    v_mfma_f32_16x16x32_bf16 v[48:51], v[212:215], v[228:231], v[48:51]
    ds_read_b128 v[192:195], v1 offset:45056
    v_fma_f32 v252, v252, v251, v251
    v_mfma_f32_16x16x32_bf16 v[52:55], v[212:215], v[232:235], v[52:55]
    v_fma_f32 v253, v253, v251, v251
    v_fma_f32 v254, v254, v251, v251
    v_mfma_f32_16x16x32_bf16 v[56:59], v[216:219], v[228:231], v[56:59]
    v_fma_f32 v255, v255, v251, v251
    v_rcp_f32_e64 v12, v12
    v_mfma_f32_16x16x32_bf16 v[60:63], v[216:219], v[232:235], v[60:63]
    v_rcp_f32_e64 v13, v13
    v_mfma_f32_16x16x32_bf16 v[64:67], v[220:223], v[228:231], v[64:67]
    v_rcp_f32_e64 v14, v14
    v_mfma_f32_16x16x32_bf16 v[68:71], v[220:223], v[232:235], v[68:71]
    v_rcp_f32_e64 v15, v15
    v_mfma_f32_16x16x32_bf16 v[72:75], v[224:227], v[228:231], v[72:75]
    v_rcp_f32_e64 v252, v252
    v_mfma_f32_16x16x32_bf16 v[76:79], v[224:227], v[232:235], v[76:79]
    v_rcp_f32_e64 v253, v253
    v_mfma_f32_16x16x32_bf16 v[80:83], v[236:239], v[228:231], v[80:83]
    v_rcp_f32_e64 v254, v254
    v_mfma_f32_16x16x32_bf16 v[84:87], v[236:239], v[232:235], v[84:87]
    v_rcp_f32 v255, v255
    s_waitcnt lgkmcnt(3)
    v_mfma_f32_16x16x32_bf16 v[16:19], v[168:171], v[160:163], v[16:19]
    ds_read_b128 v[204:207], v201 offset:36864
    v_mfma_f32_16x16x32_bf16 v[20:23], v[168:171], v[164:167], v[20:23]
    ds_read_b128 v[208:211], v201 offset:38912
    v_mul_f32_e64 v128, v128, v12
    v_mfma_f32_16x16x32_bf16 v[24:27], v[172:175], v[160:163], v[24:27]
    ds_read_b128 v[212:215], v198 offset:46080
    v_mul_f32_e64 v129, v129, v13
    v_mfma_f32_16x16x32_bf16 v[28:31], v[172:175], v[164:167], v[28:31]
    ds_read_b128 v[216:219], v198 offset:47104
    v_mul_f32_e64 v130, v130, v14
    v_mfma_f32_16x16x32_bf16 v[32:35], v[176:179], v[160:163], v[32:35]
    ds_read_b128 v[220:223], v198 offset:48128
    v_mul_f32_e64 v131, v131, v15
    v_mfma_f32_16x16x32_bf16 v[36:39], v[176:179], v[164:167], v[36:39]
    ds_read_b128 v[224:227], v198 offset:49152
    v_mul_f32_e64 v132, v132, v252
    v_mfma_f32_16x16x32_bf16 v[40:43], v[180:183], v[160:163], v[40:43]
    ds_read_b128 v[228:231], v9 offset:36864
    v_mul_f32_e64 v133, v133, v253
    v_mfma_f32_16x16x32_bf16 v[44:47], v[180:183], v[164:167], v[44:47]
    ds_read_b128 v[232:235], v9 offset:38912
    s_waitcnt lgkmcnt(8)
    v_mfma_f32_16x16x32_bf16 v[48:51], v[168:171], v[184:187], v[48:51]
    ds_read_b128 v[236:239], v1 offset:54272
    v_mul_f32 v134, v134, v254
    v_mfma_f32_16x16x32_bf16 v[52:55], v[168:171], v[188:191], v[52:55]
    v_mul_f32 v135, v135, v255
    v_mul_f32 v12, v136, v136
    v_mfma_f32_16x16x32_bf16 v[56:59], v[172:175], v[184:187], v[56:59]
    v_mul_f32 v13, v137, v137
    v_mul_f32 v14, v138, v138
    v_mfma_f32_16x16x32_bf16 v[60:63], v[172:175], v[188:191], v[60:63]
    v_mul_f32 v15, v139, v139
    v_mul_f32 v252, v140, v140
    v_mfma_f32_16x16x32_bf16 v[64:67], v[176:179], v[184:187], v[64:67]
    v_mul_f32 v253, v141, v141
    v_mul_f32 v254, v142, v142
    v_mfma_f32_16x16x32_bf16 v[68:71], v[176:179], v[188:191], v[68:71]
    v_mul_f32_e64 v255, v143, v143
    v_fma_f32 v12, v12, v5, v4
    v_mfma_f32_16x16x32_bf16 v[72:75], v[180:183], v[184:187], v[72:75]
    v_fma_f32 v13, v13, v5, v4
    v_fma_f32 v14, v14, v5, v4
    v_mfma_f32_16x16x32_bf16 v[76:79], v[180:183], v[188:191], v[76:79]
    v_fma_f32 v15, v15, v5, v4
    v_fma_f32 v252, v252, v7, v6
    v_mfma_f32_16x16x32_bf16 v[80:83], v[192:195], v[184:187], v[80:83]
    v_fma_f32 v253, v253, v7, v6
    v_fma_f32 v254, v254, v7, v6
    v_mfma_f32_16x16x32_bf16 v[84:87], v[192:195], v[188:191], v[84:87]
    v_fma_f32 v255, v255, v7, v6
    s_waitcnt lgkmcnt(0)
    s_barrier
    v_mfma_f32_16x16x32_bf16 v[16:19], v[212:215], v[204:207], v[16:19]
    ds_read_b128 v[160:163], v202 offset:0
    v_mfma_f32_16x16x32_bf16 v[20:23], v[212:215], v[208:211], v[20:23]
    ds_read_b128 v[164:167], v202 offset:2048
    v_mul_f32_e64 v12, v12, v136
    v_mfma_f32_16x16x32_bf16 v[24:27], v[216:219], v[204:207], v[24:27]
    ds_read_b128 v[168:171], v199 offset:0
    v_mul_f32_e64 v13, v13, v137
    v_mfma_f32_16x16x32_bf16 v[28:31], v[216:219], v[208:211], v[28:31]
    ds_read_b128 v[172:175], v199 offset:1024
    v_mul_f32_e64 v14, v14, v138
    v_mfma_f32_16x16x32_bf16 v[32:35], v[220:223], v[204:207], v[32:35]
    ds_read_b128 v[176:179], v199 offset:2048
    v_mul_f32_e64 v15, v15, v139
    v_mfma_f32_16x16x32_bf16 v[36:39], v[220:223], v[208:211], v[36:39]
    ds_read_b128 v[180:183], v199 offset:3072
    v_mul_f32_e64 v252, v252, v140
    v_mfma_f32_16x16x32_bf16 v[40:43], v[224:227], v[204:207], v[40:43]
    ds_read_b128 v[184:187], v10 offset:0
    v_mul_f32_e64 v253, v253, v141
    v_mfma_f32_16x16x32_bf16 v[44:47], v[224:227], v[208:211], v[44:47]
    ds_read_b128 v[188:191], v10 offset:2048
    v_mfma_f32_16x16x32_bf16 v[48:51], v[212:215], v[228:231], v[48:51]
    ds_read_b128 v[192:195], v2 offset:8192
    v_mul_f32_e64 v254, v254, v142
    v_mfma_f32_16x16x32_bf16 v[52:55], v[212:215], v[232:235], v[52:55]
    v_mul_f32 v255, v255, v143
    v_exp_f32 v12, v12
    v_mfma_f32_16x16x32_bf16 v[56:59], v[216:219], v[228:231], v[56:59]
    v_exp_f32_e64 v13, v13
    v_mfma_f32_16x16x32_bf16 v[60:63], v[216:219], v[232:235], v[60:63]
    v_exp_f32_e64 v14, v14
    v_mfma_f32_16x16x32_bf16 v[64:67], v[220:223], v[228:231], v[64:67]
    v_exp_f32_e64 v15, v15
    v_mfma_f32_16x16x32_bf16 v[68:71], v[220:223], v[232:235], v[68:71]
    v_exp_f32_e64 v252, v252
    v_mfma_f32_16x16x32_bf16 v[72:75], v[224:227], v[228:231], v[72:75]
    v_exp_f32_e64 v253, v253
    v_mfma_f32_16x16x32_bf16 v[76:79], v[224:227], v[232:235], v[76:79]
    v_exp_f32_e64 v254, v254
    v_mfma_f32_16x16x32_bf16 v[80:83], v[236:239], v[228:231], v[80:83]
    v_exp_f32_e64 v255, v255
    v_mfma_f32_16x16x32_bf16 v[84:87], v[236:239], v[232:235], v[84:87]
    v_fma_f32 v12, v12, v249, v249
    s_waitcnt lgkmcnt(3)
    v_mfma_f32_16x16x32_bf16 v[16:19], v[168:171], v[160:163], v[16:19]
    ds_read_b128 v[204:207], v203 offset:0
    v_mfma_f32_16x16x32_bf16 v[20:23], v[168:171], v[164:167], v[20:23]
    ds_read_b128 v[208:211], v203 offset:2048
    v_fma_f32 v13, v13, v249, v249
    v_mfma_f32_16x16x32_bf16 v[24:27], v[172:175], v[160:163], v[24:27]
    ds_read_b128 v[212:215], v199 offset:9216
    v_fma_f32 v14, v14, v249, v249
    v_mfma_f32_16x16x32_bf16 v[28:31], v[172:175], v[164:167], v[28:31]
    ds_read_b128 v[216:219], v199 offset:10240
    v_fma_f32 v15, v15, v249, v249
    v_mfma_f32_16x16x32_bf16 v[32:35], v[176:179], v[160:163], v[32:35]
    ds_read_b128 v[220:223], v199 offset:11264
    v_fma_f32 v252, v252, v251, v251
    v_mfma_f32_16x16x32_bf16 v[36:39], v[176:179], v[164:167], v[36:39]
    ds_read_b128 v[224:227], v199 offset:12288
    v_fma_f32 v253, v253, v251, v251
    v_mfma_f32_16x16x32_bf16 v[40:43], v[180:183], v[160:163], v[40:43]
    ds_read_b128 v[228:231], v11 offset:0
    v_fma_f32 v254, v254, v251, v251
    v_mfma_f32_16x16x32_bf16 v[44:47], v[180:183], v[164:167], v[44:47]
    ds_read_b128 v[232:235], v11 offset:2048
    s_waitcnt lgkmcnt(8)
    v_mfma_f32_16x16x32_bf16 v[48:51], v[168:171], v[184:187], v[48:51]
    ds_read_b128 v[236:239], v2 offset:17408
    v_fma_f32 v255, v255, v251, v251
    v_mfma_f32_16x16x32_bf16 v[52:55], v[168:171], v[188:191], v[52:55]
    v_rcp_f32_e64 v12, v12
    v_mfma_f32_16x16x32_bf16 v[56:59], v[172:175], v[184:187], v[56:59]
    v_rcp_f32_e64 v13, v13
    v_mfma_f32_16x16x32_bf16 v[60:63], v[172:175], v[188:191], v[60:63]
    v_rcp_f32_e64 v14, v14
    v_mfma_f32_16x16x32_bf16 v[64:67], v[176:179], v[184:187], v[64:67]
    v_rcp_f32_e64 v15, v15
    v_mfma_f32_16x16x32_bf16 v[68:71], v[176:179], v[188:191], v[68:71]
    v_rcp_f32_e64 v252, v252
    v_mfma_f32_16x16x32_bf16 v[72:75], v[180:183], v[184:187], v[72:75]
    v_rcp_f32_e64 v253, v253
    v_mfma_f32_16x16x32_bf16 v[76:79], v[180:183], v[188:191], v[76:79]
    v_rcp_f32_e64 v254, v254
    v_mfma_f32_16x16x32_bf16 v[80:83], v[192:195], v[184:187], v[80:83]
    v_rcp_f32_e64 v255, v255
    v_mfma_f32_16x16x32_bf16 v[84:87], v[192:195], v[188:191], v[84:87]
    v_mul_f32_e64 v136, v136, v12
    s_waitcnt lgkmcnt(0)
    s_barrier
    v_mfma_f32_16x16x32_bf16 v[16:19], v[212:215], v[204:207], v[16:19]
    ds_read_b128 v[160:163], v202 offset:36864
    v_mfma_f32_16x16x32_bf16 v[20:23], v[212:215], v[208:211], v[20:23]
    ds_read_b128 v[164:167], v202 offset:38912
    v_mul_f32_e64 v137, v137, v13
    v_mfma_f32_16x16x32_bf16 v[24:27], v[216:219], v[204:207], v[24:27]
    ds_read_b128 v[168:171], v199 offset:36864
    v_mul_f32_e64 v138, v138, v14
    v_mfma_f32_16x16x32_bf16 v[28:31], v[216:219], v[208:211], v[28:31]
    ds_read_b128 v[172:175], v199 offset:37888
    v_mul_f32_e64 v139, v139, v15
    v_mfma_f32_16x16x32_bf16 v[32:35], v[220:223], v[204:207], v[32:35]
    ds_read_b128 v[176:179], v199 offset:38912
    v_mul_f32_e64 v140, v140, v252
    v_mfma_f32_16x16x32_bf16 v[36:39], v[220:223], v[208:211], v[36:39]
    ds_read_b128 v[180:183], v199 offset:39936
    v_mul_f32_e64 v141, v141, v253
    v_mfma_f32_16x16x32_bf16 v[40:43], v[224:227], v[204:207], v[40:43]
    ds_read_b128 v[184:187], v10 offset:36864
    v_mul_f32_e64 v142, v142, v254
    v_mfma_f32_16x16x32_bf16 v[44:47], v[224:227], v[208:211], v[44:47]
    ds_read_b128 v[188:191], v10 offset:38912
    v_mfma_f32_16x16x32_bf16 v[48:51], v[212:215], v[228:231], v[48:51]
    ds_read_b128 v[192:195], v2 offset:45056
    v_mul_f32_e64 v143, v143, v255
    v_mfma_f32_16x16x32_bf16 v[52:55], v[212:215], v[232:235], v[52:55]
    v_mul_f32 v12, v144, v144
    v_mul_f32 v13, v145, v145
    v_mfma_f32_16x16x32_bf16 v[56:59], v[216:219], v[228:231], v[56:59]
    v_mul_f32 v14, v146, v146
    v_mul_f32 v15, v147, v147
    v_mfma_f32_16x16x32_bf16 v[60:63], v[216:219], v[232:235], v[60:63]
    v_mul_f32 v252, v148, v148
    v_mul_f32 v253, v149, v149
    v_mfma_f32_16x16x32_bf16 v[64:67], v[220:223], v[228:231], v[64:67]
    v_mul_f32 v254, v150, v150
    v_mul_f32 v255, v151, v151
    v_mfma_f32_16x16x32_bf16 v[68:71], v[220:223], v[232:235], v[68:71]
    v_fma_f32 v12, v12, v5, v4
    v_fma_f32 v13, v13, v5, v4
    v_mfma_f32_16x16x32_bf16 v[72:75], v[224:227], v[228:231], v[72:75]
    v_fma_f32 v14, v14, v5, v4
    v_fma_f32 v15, v15, v5, v4
    v_mfma_f32_16x16x32_bf16 v[76:79], v[224:227], v[232:235], v[76:79]
    v_fma_f32 v252, v252, v7, v6
    v_fma_f32 v253, v253, v7, v6
    v_mfma_f32_16x16x32_bf16 v[80:83], v[236:239], v[228:231], v[80:83]
    v_fma_f32 v254, v254, v7, v6
    v_fma_f32 v255, v255, v7, v6
    v_mfma_f32_16x16x32_bf16 v[84:87], v[236:239], v[232:235], v[84:87]
    v_mul_f32 v12, v12, v144
    s_waitcnt lgkmcnt(3)
    v_mfma_f32_16x16x32_bf16 v[16:19], v[168:171], v[160:163], v[16:19]
    ds_read_b128 v[204:207], v203 offset:36864
    v_mfma_f32_16x16x32_bf16 v[20:23], v[168:171], v[164:167], v[20:23]
    ds_read_b128 v[208:211], v203 offset:38912
    v_mul_f32_e64 v13, v13, v145
    v_mfma_f32_16x16x32_bf16 v[24:27], v[172:175], v[160:163], v[24:27]
    ds_read_b128 v[212:215], v199 offset:46080
    v_mul_f32_e64 v14, v14, v146
    v_mfma_f32_16x16x32_bf16 v[28:31], v[172:175], v[164:167], v[28:31]
    ds_read_b128 v[216:219], v199 offset:47104
    v_mul_f32_e64 v15, v15, v147
    v_mfma_f32_16x16x32_bf16 v[32:35], v[176:179], v[160:163], v[32:35]
    ds_read_b128 v[220:223], v199 offset:48128
    v_mul_f32_e64 v252, v252, v148
    v_mfma_f32_16x16x32_bf16 v[36:39], v[176:179], v[164:167], v[36:39]
    ds_read_b128 v[224:227], v199 offset:49152
    v_mul_f32_e64 v253, v253, v149
    v_mfma_f32_16x16x32_bf16 v[40:43], v[180:183], v[160:163], v[40:43]
    ds_read_b128 v[228:231], v11 offset:36864
    v_mul_f32_e64 v254, v254, v150
    v_mfma_f32_16x16x32_bf16 v[44:47], v[180:183], v[164:167], v[44:47]
    ds_read_b128 v[232:235], v11 offset:38912
    s_waitcnt lgkmcnt(8)
    v_mfma_f32_16x16x32_bf16 v[48:51], v[168:171], v[184:187], v[48:51]
    ds_read_b128 v[236:239], v2 offset:54272
    v_mul_f32 v255, v255, v151
    v_mfma_f32_16x16x32_bf16 v[52:55], v[168:171], v[188:191], v[52:55]
    v_exp_f32_e64 v12, v12
    v_mfma_f32_16x16x32_bf16 v[56:59], v[172:175], v[184:187], v[56:59]
    v_exp_f32_e64 v13, v13
    v_mfma_f32_16x16x32_bf16 v[60:63], v[172:175], v[188:191], v[60:63]
    v_exp_f32_e64 v14, v14
    v_mfma_f32_16x16x32_bf16 v[64:67], v[176:179], v[184:187], v[64:67]
    v_exp_f32_e64 v15, v15
    v_mfma_f32_16x16x32_bf16 v[68:71], v[176:179], v[188:191], v[68:71]
    v_exp_f32_e64 v252, v252
    v_mfma_f32_16x16x32_bf16 v[72:75], v[180:183], v[184:187], v[72:75]
    v_exp_f32_e64 v253, v253
    v_mfma_f32_16x16x32_bf16 v[76:79], v[180:183], v[188:191], v[76:79]
    v_exp_f32_e64 v254, v254
    v_mfma_f32_16x16x32_bf16 v[80:83], v[192:195], v[184:187], v[80:83]
    v_exp_f32_e64 v255, v255
    v_mfma_f32_16x16x32_bf16 v[84:87], v[192:195], v[188:191], v[84:87]
    v_fma_f32 v12, v12, v249, v249
    s_waitcnt lgkmcnt(0)
    s_barrier
    v_mfma_f32_16x16x32_bf16 v[16:19], v[212:215], v[204:207], v[16:19]
    ds_read_b128 v[160:163], v200 offset:0
    v_mfma_f32_16x16x32_bf16 v[20:23], v[212:215], v[208:211], v[20:23]
    ds_read_b128 v[164:167], v200 offset:2048
    v_fma_f32 v13, v13, v249, v249
    v_mfma_f32_16x16x32_bf16 v[24:27], v[216:219], v[204:207], v[24:27]
    ds_read_b128 v[168:171], v198 offset:0
    v_fma_f32 v14, v14, v249, v249
    v_mfma_f32_16x16x32_bf16 v[28:31], v[216:219], v[208:211], v[28:31]
    ds_read_b128 v[172:175], v198 offset:1024
    v_fma_f32 v15, v15, v249, v249
    v_mfma_f32_16x16x32_bf16 v[32:35], v[220:223], v[204:207], v[32:35]
    ds_read_b128 v[176:179], v198 offset:2048
    v_fma_f32 v252, v252, v251, v251
    v_mfma_f32_16x16x32_bf16 v[36:39], v[220:223], v[208:211], v[36:39]
    ds_read_b128 v[180:183], v198 offset:3072
    v_fma_f32 v253, v253, v251, v251
    v_mfma_f32_16x16x32_bf16 v[40:43], v[224:227], v[204:207], v[40:43]
    ds_read_b128 v[184:187], v8 offset:0
    v_fma_f32 v254, v254, v251, v251
    v_mfma_f32_16x16x32_bf16 v[44:47], v[224:227], v[208:211], v[44:47]
    ds_read_b128 v[188:191], v8 offset:2048
    v_mfma_f32_16x16x32_bf16 v[48:51], v[212:215], v[228:231], v[48:51]
    ds_read_b128 v[192:195], v1 offset:8192
    v_fma_f32 v255, v255, v251, v251
    v_mfma_f32_16x16x32_bf16 v[52:55], v[212:215], v[232:235], v[52:55]
    v_rcp_f32_e64 v12, v12
    v_mfma_f32_16x16x32_bf16 v[56:59], v[216:219], v[228:231], v[56:59]
    v_rcp_f32_e64 v13, v13
    v_mfma_f32_16x16x32_bf16 v[60:63], v[216:219], v[232:235], v[60:63]
    v_rcp_f32_e64 v14, v14
    v_mfma_f32_16x16x32_bf16 v[64:67], v[220:223], v[228:231], v[64:67]
    v_rcp_f32_e64 v15, v15
    v_mfma_f32_16x16x32_bf16 v[68:71], v[220:223], v[232:235], v[68:71]
    v_rcp_f32_e64 v252, v252
    v_mfma_f32_16x16x32_bf16 v[72:75], v[224:227], v[228:231], v[72:75]
    v_rcp_f32_e64 v253, v253
    v_mfma_f32_16x16x32_bf16 v[76:79], v[224:227], v[232:235], v[76:79]
    v_rcp_f32_e64 v254, v254
    v_mfma_f32_16x16x32_bf16 v[80:83], v[236:239], v[228:231], v[80:83]
    v_rcp_f32_e64 v255, v255
    v_mfma_f32_16x16x32_bf16 v[84:87], v[236:239], v[232:235], v[84:87]
    v_mul_f32 v144, v144, v12
    s_waitcnt lgkmcnt(3)
    v_mfma_f32_16x16x32_bf16 v[16:19], v[168:171], v[160:163], v[16:19]
    ds_read_b128 v[204:207], v201 offset:0
    v_mfma_f32_16x16x32_bf16 v[20:23], v[168:171], v[164:167], v[20:23]
    ds_read_b128 v[208:211], v201 offset:2048
    v_mul_f32_e64 v145, v145, v13
    v_mfma_f32_16x16x32_bf16 v[24:27], v[172:175], v[160:163], v[24:27]
    ds_read_b128 v[212:215], v198 offset:9216
    v_mul_f32_e64 v146, v146, v14
    v_mfma_f32_16x16x32_bf16 v[28:31], v[172:175], v[164:167], v[28:31]
    ds_read_b128 v[216:219], v198 offset:10240
    v_mul_f32_e64 v147, v147, v15
    v_mfma_f32_16x16x32_bf16 v[32:35], v[176:179], v[160:163], v[32:35]
    ds_read_b128 v[220:223], v198 offset:11264
    v_mul_f32_e64 v148, v148, v252
    v_mfma_f32_16x16x32_bf16 v[36:39], v[176:179], v[164:167], v[36:39]
    ds_read_b128 v[224:227], v198 offset:12288
    v_mul_f32_e64 v149, v149, v253
    v_mfma_f32_16x16x32_bf16 v[40:43], v[180:183], v[160:163], v[40:43]
    ds_read_b128 v[228:231], v9 offset:0
    v_mul_f32_e64 v150, v150, v254
    v_mfma_f32_16x16x32_bf16 v[44:47], v[180:183], v[164:167], v[44:47]
    ds_read_b128 v[232:235], v9 offset:2048
    s_waitcnt lgkmcnt(8)
    v_mfma_f32_16x16x32_bf16 v[48:51], v[168:171], v[184:187], v[48:51]
    ds_read_b128 v[236:239], v1 offset:17408
    v_mul_f32 v151, v151, v255
    v_mfma_f32_16x16x32_bf16 v[52:55], v[168:171], v[188:191], v[52:55]
    v_mul_f32 v12, v152, v152
    v_mul_f32 v13, v153, v153
    v_mfma_f32_16x16x32_bf16 v[56:59], v[172:175], v[184:187], v[56:59]
    v_mul_f32 v14, v154, v154
    v_mul_f32 v15, v155, v155
    v_mfma_f32_16x16x32_bf16 v[60:63], v[172:175], v[188:191], v[60:63]
    v_mul_f32 v252, v156, v156
    v_mul_f32 v253, v157, v157
    v_mfma_f32_16x16x32_bf16 v[64:67], v[176:179], v[184:187], v[64:67]
    v_mul_f32 v254, v158, v158
    v_mul_f32 v255, v159, v159
    v_mfma_f32_16x16x32_bf16 v[68:71], v[176:179], v[188:191], v[68:71]
    v_fma_f32 v12, v12, v5, v4
    v_fma_f32 v13, v13, v5, v4
    v_mfma_f32_16x16x32_bf16 v[72:75], v[180:183], v[184:187], v[72:75]
    v_fma_f32 v14, v14, v5, v4
    v_fma_f32 v15, v15, v5, v4
    v_mfma_f32_16x16x32_bf16 v[76:79], v[180:183], v[188:191], v[76:79]
    v_fma_f32 v252, v252, v7, v6
    v_fma_f32 v253, v253, v7, v6
    v_mfma_f32_16x16x32_bf16 v[80:83], v[192:195], v[184:187], v[80:83]
    v_fma_f32 v254, v254, v7, v6
    v_fma_f32 v255, v255, v7, v6
    v_mfma_f32_16x16x32_bf16 v[84:87], v[192:195], v[188:191], v[84:87]
    v_mul_f32_e64 v12, v12, v152
    s_waitcnt lgkmcnt(0)
    s_barrier
    v_mfma_f32_16x16x32_bf16 v[16:19], v[212:215], v[204:207], v[16:19]
    ds_read_b128 v[160:163], v200 offset:36864
    v_mfma_f32_16x16x32_bf16 v[20:23], v[212:215], v[208:211], v[20:23]
    ds_read_b128 v[164:167], v200 offset:38912
    v_mul_f32_e64 v13, v13, v153
    v_mfma_f32_16x16x32_bf16 v[24:27], v[216:219], v[204:207], v[24:27]
    ds_read_b128 v[168:171], v198 offset:36864
    v_mul_f32_e64 v14, v14, v154
    v_mfma_f32_16x16x32_bf16 v[28:31], v[216:219], v[208:211], v[28:31]
    ds_read_b128 v[172:175], v198 offset:37888
    v_mul_f32_e64 v15, v15, v155
    v_mfma_f32_16x16x32_bf16 v[32:35], v[220:223], v[204:207], v[32:35]
    ds_read_b128 v[176:179], v198 offset:38912
    v_mul_f32_e64 v252, v252, v156
    v_mfma_f32_16x16x32_bf16 v[36:39], v[220:223], v[208:211], v[36:39]
    ds_read_b128 v[180:183], v198 offset:39936
    v_mul_f32_e64 v253, v253, v157
    v_mfma_f32_16x16x32_bf16 v[40:43], v[224:227], v[204:207], v[40:43]
    ds_read_b128 v[184:187], v8 offset:36864
    v_mul_f32_e64 v254, v254, v158
    v_mfma_f32_16x16x32_bf16 v[44:47], v[224:227], v[208:211], v[44:47]
    ds_read_b128 v[188:191], v8 offset:38912
    v_mfma_f32_16x16x32_bf16 v[48:51], v[212:215], v[228:231], v[48:51]
    ds_read_b128 v[192:195], v1 offset:45056
    v_mul_f32_e64 v255, v255, v159
    v_mfma_f32_16x16x32_bf16 v[52:55], v[212:215], v[232:235], v[52:55]
    v_exp_f32_e64 v12, v12
    v_mfma_f32_16x16x32_bf16 v[56:59], v[216:219], v[228:231], v[56:59]
    v_exp_f32_e64 v13, v13
    v_mfma_f32_16x16x32_bf16 v[60:63], v[216:219], v[232:235], v[60:63]
    v_exp_f32_e64 v14, v14
    v_mfma_f32_16x16x32_bf16 v[64:67], v[220:223], v[228:231], v[64:67]
    v_exp_f32_e64 v15, v15
    v_mfma_f32_16x16x32_bf16 v[68:71], v[220:223], v[232:235], v[68:71]
    v_exp_f32_e64 v252, v252
    v_mfma_f32_16x16x32_bf16 v[72:75], v[224:227], v[228:231], v[72:75]
    v_exp_f32_e64 v253, v253
    v_mfma_f32_16x16x32_bf16 v[76:79], v[224:227], v[232:235], v[76:79]
    v_exp_f32_e64 v254, v254
    v_mfma_f32_16x16x32_bf16 v[80:83], v[236:239], v[228:231], v[80:83]
    v_exp_f32_e64 v255, v255
    v_mfma_f32_16x16x32_bf16 v[84:87], v[236:239], v[232:235], v[84:87]
    v_fma_f32 v12, v12, v249, v249
    s_waitcnt lgkmcnt(3)
    v_mfma_f32_16x16x32_bf16 v[16:19], v[168:171], v[160:163], v[16:19]
    ds_read_b128 v[204:207], v201 offset:36864
    v_mfma_f32_16x16x32_bf16 v[20:23], v[168:171], v[164:167], v[20:23]
    ds_read_b128 v[208:211], v201 offset:38912
    v_fma_f32 v13, v13, v249, v249
    v_mfma_f32_16x16x32_bf16 v[24:27], v[172:175], v[160:163], v[24:27]
    ds_read_b128 v[212:215], v198 offset:46080
    v_fma_f32 v14, v14, v249, v249
    v_mfma_f32_16x16x32_bf16 v[28:31], v[172:175], v[164:167], v[28:31]
    ds_read_b128 v[216:219], v198 offset:47104
    v_fma_f32 v15, v15, v249, v249
    v_mfma_f32_16x16x32_bf16 v[32:35], v[176:179], v[160:163], v[32:35]
    ds_read_b128 v[220:223], v198 offset:48128
    v_fma_f32 v252, v252, v251, v251
    v_mfma_f32_16x16x32_bf16 v[36:39], v[176:179], v[164:167], v[36:39]
    ds_read_b128 v[224:227], v198 offset:49152
    v_fma_f32 v253, v253, v251, v251
    v_mfma_f32_16x16x32_bf16 v[40:43], v[180:183], v[160:163], v[40:43]
    ds_read_b128 v[228:231], v9 offset:36864
    v_fma_f32 v254, v254, v251, v251
    v_mfma_f32_16x16x32_bf16 v[44:47], v[180:183], v[164:167], v[44:47]
    ds_read_b128 v[232:235], v9 offset:38912
    s_waitcnt lgkmcnt(8)
    v_mfma_f32_16x16x32_bf16 v[48:51], v[168:171], v[184:187], v[48:51]
    ds_read_b128 v[236:239], v1 offset:54272
    v_fma_f32 v255, v255, v251, v251
    v_mfma_f32_16x16x32_bf16 v[52:55], v[168:171], v[188:191], v[52:55]
    v_rcp_f32_e64 v12, v12
    v_mfma_f32_16x16x32_bf16 v[56:59], v[172:175], v[184:187], v[56:59]
    v_rcp_f32_e64 v13, v13
    v_mfma_f32_16x16x32_bf16 v[60:63], v[172:175], v[188:191], v[60:63]
    v_rcp_f32_e64 v14, v14
    v_mfma_f32_16x16x32_bf16 v[64:67], v[176:179], v[184:187], v[64:67]
    v_rcp_f32_e64 v15, v15
    v_mfma_f32_16x16x32_bf16 v[68:71], v[176:179], v[188:191], v[68:71]
    v_rcp_f32_e64 v252, v252
    v_mfma_f32_16x16x32_bf16 v[72:75], v[180:183], v[184:187], v[72:75]
    v_rcp_f32_e64 v253, v253
    v_mfma_f32_16x16x32_bf16 v[76:79], v[180:183], v[188:191], v[76:79]
    v_rcp_f32_e64 v254, v254
    v_mfma_f32_16x16x32_bf16 v[80:83], v[192:195], v[184:187], v[80:83]
    v_rcp_f32_e64 v255, v255
    v_mfma_f32_16x16x32_bf16 v[84:87], v[192:195], v[188:191], v[84:87]
    v_mul_f32_e64 v152, v152, v12
    s_waitcnt lgkmcnt(0)
    s_barrier
    v_mfma_f32_16x16x32_bf16 v[16:19], v[212:215], v[204:207], v[16:19]
    ds_read_b128 v[160:163], v202 offset:0
    v_mfma_f32_16x16x32_bf16 v[20:23], v[212:215], v[208:211], v[20:23]
    ds_read_b128 v[164:167], v202 offset:2048
    v_mul_f32_e64 v153, v153, v13
    v_mfma_f32_16x16x32_bf16 v[24:27], v[216:219], v[204:207], v[24:27]
    ds_read_b128 v[168:171], v199 offset:0
    v_mul_f32_e64 v154, v154, v14
    v_mfma_f32_16x16x32_bf16 v[28:31], v[216:219], v[208:211], v[28:31]
    ds_read_b128 v[172:175], v199 offset:1024
    v_mul_f32_e64 v155, v155, v15
    v_mfma_f32_16x16x32_bf16 v[32:35], v[220:223], v[204:207], v[32:35]
    ds_read_b128 v[176:179], v199 offset:2048
    v_mul_f32_e64 v156, v156, v252
    v_mfma_f32_16x16x32_bf16 v[36:39], v[220:223], v[208:211], v[36:39]
    ds_read_b128 v[180:183], v199 offset:3072
    v_mul_f32_e64 v157, v157, v253
    v_mfma_f32_16x16x32_bf16 v[40:43], v[224:227], v[204:207], v[40:43]
    ds_read_b128 v[184:187], v10 offset:0
    v_mul_f32_e64 v158, v158, v254
    v_mfma_f32_16x16x32_bf16 v[44:47], v[224:227], v[208:211], v[44:47]
    ds_read_b128 v[188:191], v10 offset:2048
    v_mfma_f32_16x16x32_bf16 v[48:51], v[212:215], v[228:231], v[48:51]
    ds_read_b128 v[192:195], v2 offset:8192
    v_mul_f32_e64 v159, v159, v255
    v_mfma_f32_16x16x32_bf16 v[52:55], v[212:215], v[232:235], v[52:55]
    s_mul_i32 s39, s31, 73728
    s_add_u32 s39, s39, s21
    v_mfma_f32_16x16x32_bf16 v[56:59], v[216:219], v[228:231], v[56:59]
    s_add_u32 s39, s39, 0x1200000
    s_add_u32 s40, s39, 73728
    v_mfma_f32_16x16x32_bf16 v[60:63], v[216:219], v[232:235], v[60:63]
    s_mul_i32 s36, s47, 36
    s_add_u32 s36, s36, s39
    v_mfma_f32_16x16x32_bf16 v[64:67], v[220:223], v[228:231], v[64:67]
    s_add_u32 s37, s36, 73728
    s_lshl_b32 s34, s24, 10
    v_mfma_f32_16x16x32_bf16 v[68:71], v[220:223], v[232:235], v[68:71]
    s_lshl_b32 s33, s48, 3
    s_add_u32 s34, s34, s33
    v_mfma_f32_16x16x32_bf16 v[72:75], v[224:227], v[228:231], v[72:75]
    v_add_u32_e64 v13, s34, v1
    v_add_u32 v14, 16384, v13
    v_mfma_f32_16x16x32_bf16 v[76:79], v[224:227], v[232:235], v[76:79]
    s_lshr_b32 s35, s24, 1
    s_lshl_b32 s35, s35, 10
    v_mfma_f32_16x16x32_bf16 v[80:83], v[236:239], v[228:231], v[80:83]
    s_and_b32 s33, s24, 1
    s_mul_i32 s33, s33, 73728
    v_mfma_f32_16x16x32_bf16 v[84:87], v[236:239], v[232:235], v[84:87]
    s_add_u32 s35, s35, s33
    s_add_u32 s35, s35, 65536
    v_add_u32_e64 v15, s35, v1
    s_mov_b32 s41, 5
L_g_loop:
    s_waitcnt lgkmcnt(3)
    v_mfma_f32_16x16x32_bf16 v[16:19], v[168:171], v[160:163], v[16:19]
    ds_read_b128 v[204:207], v203 offset:0
    v_mfma_f32_16x16x32_bf16 v[20:23], v[168:171], v[164:167], v[20:23]
    ds_read_b128 v[208:211], v203 offset:2048
    v_mfma_f32_16x16x32_bf16 v[24:27], v[172:175], v[160:163], v[24:27]
    ds_read_b128 v[212:215], v199 offset:9216
    v_mfma_f32_16x16x32_bf16 v[28:31], v[172:175], v[164:167], v[28:31]
    ds_read_b128 v[216:219], v199 offset:10240
    v_mfma_f32_16x16x32_bf16 v[32:35], v[176:179], v[160:163], v[32:35]
    ds_read_b128 v[220:223], v199 offset:11264
    v_mfma_f32_16x16x32_bf16 v[36:39], v[176:179], v[164:167], v[36:39]
    ds_read_b128 v[224:227], v199 offset:12288
    v_mfma_f32_16x16x32_bf16 v[40:43], v[180:183], v[160:163], v[40:43]
    ds_read_b128 v[228:231], v11 offset:0
    v_mfma_f32_16x16x32_bf16 v[44:47], v[180:183], v[164:167], v[44:47]
    ds_read_b128 v[232:235], v11 offset:2048
    s_waitcnt lgkmcnt(8)
    v_mfma_f32_16x16x32_bf16 v[48:51], v[168:171], v[184:187], v[48:51]
    ds_read_b128 v[236:239], v2 offset:17408
    v_mfma_f32_16x16x32_bf16 v[52:55], v[168:171], v[188:191], v[52:55]
    v_mfma_f32_16x16x32_bf16 v[56:59], v[172:175], v[184:187], v[56:59]
    v_mfma_f32_16x16x32_bf16 v[60:63], v[172:175], v[188:191], v[60:63]
    v_mfma_f32_16x16x32_bf16 v[64:67], v[176:179], v[184:187], v[64:67]
    v_mfma_f32_16x16x32_bf16 v[68:71], v[176:179], v[188:191], v[68:71]
    v_mfma_f32_16x16x32_bf16 v[72:75], v[180:183], v[184:187], v[72:75]
    v_mfma_f32_16x16x32_bf16 v[76:79], v[180:183], v[188:191], v[76:79]
    v_mfma_f32_16x16x32_bf16 v[80:83], v[192:195], v[184:187], v[80:83]
    v_mfma_f32_16x16x32_bf16 v[84:87], v[192:195], v[188:191], v[84:87]
    s_waitcnt lgkmcnt(0)
    s_barrier
    v_mfma_f32_16x16x32_bf16 v[16:19], v[212:215], v[204:207], v[16:19]
    ds_read_b128 v[160:163], v202 offset:36864
    v_mfma_f32_16x16x32_bf16 v[20:23], v[212:215], v[208:211], v[20:23]
    ds_read_b128 v[164:167], v202 offset:38912
    v_mfma_f32_16x16x32_bf16 v[24:27], v[216:219], v[204:207], v[24:27]
    ds_read_b128 v[168:171], v199 offset:36864
    v_mfma_f32_16x16x32_bf16 v[28:31], v[216:219], v[208:211], v[28:31]
    ds_read_b128 v[172:175], v199 offset:37888
    v_mfma_f32_16x16x32_bf16 v[32:35], v[220:223], v[204:207], v[32:35]
    ds_read_b128 v[176:179], v199 offset:38912
    v_mfma_f32_16x16x32_bf16 v[36:39], v[220:223], v[208:211], v[36:39]
    ds_read_b128 v[180:183], v199 offset:39936
    v_mfma_f32_16x16x32_bf16 v[40:43], v[224:227], v[204:207], v[40:43]
    ds_read_b128 v[184:187], v10 offset:36864
    v_mfma_f32_16x16x32_bf16 v[44:47], v[224:227], v[208:211], v[44:47]
    ds_read_b128 v[188:191], v10 offset:38912
    v_mfma_f32_16x16x32_bf16 v[48:51], v[212:215], v[228:231], v[48:51]
    ds_read_b128 v[192:195], v2 offset:45056
    v_mfma_f32_16x16x32_bf16 v[52:55], v[212:215], v[232:235], v[52:55]
    v_mfma_f32_16x16x32_bf16 v[56:59], v[216:219], v[228:231], v[56:59]
    v_mfma_f32_16x16x32_bf16 v[60:63], v[216:219], v[232:235], v[60:63]
    v_mfma_f32_16x16x32_bf16 v[64:67], v[220:223], v[228:231], v[64:67]
    v_mfma_f32_16x16x32_bf16 v[68:71], v[220:223], v[232:235], v[68:71]
    v_mfma_f32_16x16x32_bf16 v[72:75], v[224:227], v[228:231], v[72:75]
    v_mfma_f32_16x16x32_bf16 v[76:79], v[224:227], v[232:235], v[76:79]
    v_mfma_f32_16x16x32_bf16 v[80:83], v[236:239], v[228:231], v[80:83]
    v_mfma_f32_16x16x32_bf16 v[84:87], v[236:239], v[232:235], v[84:87]
    s_waitcnt lgkmcnt(3)
    v_mfma_f32_16x16x32_bf16 v[16:19], v[168:171], v[160:163], v[16:19]
    ds_read_b128 v[204:207], v203 offset:36864
    v_mfma_f32_16x16x32_bf16 v[20:23], v[168:171], v[164:167], v[20:23]
    ds_read_b128 v[208:211], v203 offset:38912
    v_mfma_f32_16x16x32_bf16 v[24:27], v[172:175], v[160:163], v[24:27]
    ds_read_b128 v[212:215], v199 offset:46080
    v_mfma_f32_16x16x32_bf16 v[28:31], v[172:175], v[164:167], v[28:31]
    ds_read_b128 v[216:219], v199 offset:47104
    v_mfma_f32_16x16x32_bf16 v[32:35], v[176:179], v[160:163], v[32:35]
    ds_read_b128 v[220:223], v199 offset:48128
    v_mfma_f32_16x16x32_bf16 v[36:39], v[176:179], v[164:167], v[36:39]
    ds_read_b128 v[224:227], v199 offset:49152
    v_mfma_f32_16x16x32_bf16 v[40:43], v[180:183], v[160:163], v[40:43]
    ds_read_b128 v[228:231], v11 offset:36864
    v_mfma_f32_16x16x32_bf16 v[44:47], v[180:183], v[164:167], v[44:47]
    ds_read_b128 v[232:235], v11 offset:38912
    s_waitcnt lgkmcnt(8)
    v_mfma_f32_16x16x32_bf16 v[48:51], v[168:171], v[184:187], v[48:51]
    ds_read_b128 v[236:239], v2 offset:54272
    v_mfma_f32_16x16x32_bf16 v[52:55], v[168:171], v[188:191], v[52:55]
    v_mfma_f32_16x16x32_bf16 v[56:59], v[172:175], v[184:187], v[56:59]
    v_mfma_f32_16x16x32_bf16 v[60:63], v[172:175], v[188:191], v[60:63]
    v_mfma_f32_16x16x32_bf16 v[64:67], v[176:179], v[184:187], v[64:67]
    v_mfma_f32_16x16x32_bf16 v[68:71], v[176:179], v[188:191], v[68:71]
    v_mfma_f32_16x16x32_bf16 v[72:75], v[180:183], v[184:187], v[72:75]
    v_mfma_f32_16x16x32_bf16 v[76:79], v[180:183], v[188:191], v[76:79]
    v_mfma_f32_16x16x32_bf16 v[80:83], v[192:195], v[184:187], v[80:83]
    v_mfma_f32_16x16x32_bf16 v[84:87], v[192:195], v[188:191], v[84:87]
    s_waitcnt lgkmcnt(0)
    s_barrier
    v_mfma_f32_16x16x32_bf16 v[16:19], v[212:215], v[204:207], v[16:19]
    ds_read_b128 v[160:163], v200 offset:0
    v_mfma_f32_16x16x32_bf16 v[20:23], v[212:215], v[208:211], v[20:23]
    ds_read_b128 v[164:167], v200 offset:2048
    v_mfma_f32_16x16x32_bf16 v[24:27], v[216:219], v[204:207], v[24:27]
    ds_read_b128 v[168:171], v198 offset:0
    v_mfma_f32_16x16x32_bf16 v[28:31], v[216:219], v[208:211], v[28:31]
    ds_read_b128 v[172:175], v198 offset:1024
    v_mfma_f32_16x16x32_bf16 v[32:35], v[220:223], v[204:207], v[32:35]
    ds_read_b128 v[176:179], v198 offset:2048
    v_mfma_f32_16x16x32_bf16 v[36:39], v[220:223], v[208:211], v[36:39]
    ds_read_b128 v[180:183], v198 offset:3072
    v_mfma_f32_16x16x32_bf16 v[40:43], v[224:227], v[204:207], v[40:43]
    ds_read_b128 v[184:187], v8 offset:0
    v_mfma_f32_16x16x32_bf16 v[44:47], v[224:227], v[208:211], v[44:47]
    ds_read_b128 v[188:191], v8 offset:2048
    v_mfma_f32_16x16x32_bf16 v[48:51], v[212:215], v[228:231], v[48:51]
    ds_read_b128 v[192:195], v1 offset:8192
    v_mfma_f32_16x16x32_bf16 v[52:55], v[212:215], v[232:235], v[52:55]
    v_mfma_f32_16x16x32_bf16 v[56:59], v[216:219], v[228:231], v[56:59]
    v_mfma_f32_16x16x32_bf16 v[60:63], v[216:219], v[232:235], v[60:63]
    v_mfma_f32_16x16x32_bf16 v[64:67], v[220:223], v[228:231], v[64:67]
    v_mfma_f32_16x16x32_bf16 v[68:71], v[220:223], v[232:235], v[68:71]
    v_mfma_f32_16x16x32_bf16 v[72:75], v[224:227], v[228:231], v[72:75]
    v_mfma_f32_16x16x32_bf16 v[76:79], v[224:227], v[232:235], v[76:79]
    v_mfma_f32_16x16x32_bf16 v[80:83], v[236:239], v[228:231], v[80:83]
    v_mfma_f32_16x16x32_bf16 v[84:87], v[236:239], v[232:235], v[84:87]
    s_waitcnt lgkmcnt(3)
    v_mfma_f32_16x16x32_bf16 v[16:19], v[168:171], v[160:163], v[16:19]
    ds_read_b128 v[204:207], v201 offset:0
    v_mfma_f32_16x16x32_bf16 v[20:23], v[168:171], v[164:167], v[20:23]
    ds_read_b128 v[208:211], v201 offset:2048
    v_mfma_f32_16x16x32_bf16 v[24:27], v[172:175], v[160:163], v[24:27]
    ds_read_b128 v[212:215], v198 offset:9216
    v_mfma_f32_16x16x32_bf16 v[28:31], v[172:175], v[164:167], v[28:31]
    ds_read_b128 v[216:219], v198 offset:10240
    v_mfma_f32_16x16x32_bf16 v[32:35], v[176:179], v[160:163], v[32:35]
    ds_read_b128 v[220:223], v198 offset:11264
    v_mfma_f32_16x16x32_bf16 v[36:39], v[176:179], v[164:167], v[36:39]
    ds_read_b128 v[224:227], v198 offset:12288
    v_mfma_f32_16x16x32_bf16 v[40:43], v[180:183], v[160:163], v[40:43]
    ds_read_b128 v[228:231], v9 offset:0
    v_mfma_f32_16x16x32_bf16 v[44:47], v[180:183], v[164:167], v[44:47]
    ds_read_b128 v[232:235], v9 offset:2048
    s_waitcnt lgkmcnt(8)
    v_mfma_f32_16x16x32_bf16 v[48:51], v[168:171], v[184:187], v[48:51]
    ds_read_b128 v[236:239], v1 offset:17408
    v_mfma_f32_16x16x32_bf16 v[52:55], v[168:171], v[188:191], v[52:55]
    v_mfma_f32_16x16x32_bf16 v[56:59], v[172:175], v[184:187], v[56:59]
    v_mfma_f32_16x16x32_bf16 v[60:63], v[172:175], v[188:191], v[60:63]
    v_mfma_f32_16x16x32_bf16 v[64:67], v[176:179], v[184:187], v[64:67]
    v_mfma_f32_16x16x32_bf16 v[68:71], v[176:179], v[188:191], v[68:71]
    v_mfma_f32_16x16x32_bf16 v[72:75], v[180:183], v[184:187], v[72:75]
    v_mfma_f32_16x16x32_bf16 v[76:79], v[180:183], v[188:191], v[76:79]
    v_mfma_f32_16x16x32_bf16 v[80:83], v[192:195], v[184:187], v[80:83]
    v_mfma_f32_16x16x32_bf16 v[84:87], v[192:195], v[188:191], v[84:87]
    s_waitcnt lgkmcnt(0)
    s_barrier
    v_mfma_f32_16x16x32_bf16 v[16:19], v[212:215], v[204:207], v[16:19]
    ds_read_b128 v[160:163], v200 offset:36864
    v_mfma_f32_16x16x32_bf16 v[20:23], v[212:215], v[208:211], v[20:23]
    ds_read_b128 v[164:167], v200 offset:38912
    v_mfma_f32_16x16x32_bf16 v[24:27], v[216:219], v[204:207], v[24:27]
    ds_read_b128 v[168:171], v198 offset:36864
    v_mfma_f32_16x16x32_bf16 v[28:31], v[216:219], v[208:211], v[28:31]
    ds_read_b128 v[172:175], v198 offset:37888
    v_mfma_f32_16x16x32_bf16 v[32:35], v[220:223], v[204:207], v[32:35]
    ds_read_b128 v[176:179], v198 offset:38912
    v_mfma_f32_16x16x32_bf16 v[36:39], v[220:223], v[208:211], v[36:39]
    ds_read_b128 v[180:183], v198 offset:39936
    v_mfma_f32_16x16x32_bf16 v[40:43], v[224:227], v[204:207], v[40:43]
    ds_read_b128 v[184:187], v8 offset:36864
    v_mfma_f32_16x16x32_bf16 v[44:47], v[224:227], v[208:211], v[44:47]
    ds_read_b128 v[188:191], v8 offset:38912
    v_mfma_f32_16x16x32_bf16 v[48:51], v[212:215], v[228:231], v[48:51]
    ds_read_b128 v[192:195], v1 offset:45056
    v_mfma_f32_16x16x32_bf16 v[52:55], v[212:215], v[232:235], v[52:55]
    v_mfma_f32_16x16x32_bf16 v[56:59], v[216:219], v[228:231], v[56:59]
    v_mfma_f32_16x16x32_bf16 v[60:63], v[216:219], v[232:235], v[60:63]
    v_mfma_f32_16x16x32_bf16 v[64:67], v[220:223], v[228:231], v[64:67]
    v_mfma_f32_16x16x32_bf16 v[68:71], v[220:223], v[232:235], v[68:71]
    v_mfma_f32_16x16x32_bf16 v[72:75], v[224:227], v[228:231], v[72:75]
    v_mfma_f32_16x16x32_bf16 v[76:79], v[224:227], v[232:235], v[76:79]
    v_mfma_f32_16x16x32_bf16 v[80:83], v[236:239], v[228:231], v[80:83]
    v_mfma_f32_16x16x32_bf16 v[84:87], v[236:239], v[232:235], v[84:87]
    s_waitcnt lgkmcnt(3)
    v_mfma_f32_16x16x32_bf16 v[16:19], v[168:171], v[160:163], v[16:19]
    ds_read_b128 v[204:207], v201 offset:36864
    v_mfma_f32_16x16x32_bf16 v[20:23], v[168:171], v[164:167], v[20:23]
    ds_read_b128 v[208:211], v201 offset:38912
    v_mfma_f32_16x16x32_bf16 v[24:27], v[172:175], v[160:163], v[24:27]
    ds_read_b128 v[212:215], v198 offset:46080
    v_mfma_f32_16x16x32_bf16 v[28:31], v[172:175], v[164:167], v[28:31]
    ds_read_b128 v[216:219], v198 offset:47104
    v_mfma_f32_16x16x32_bf16 v[32:35], v[176:179], v[160:163], v[32:35]
    ds_read_b128 v[220:223], v198 offset:48128
    v_mfma_f32_16x16x32_bf16 v[36:39], v[176:179], v[164:167], v[36:39]
    ds_read_b128 v[224:227], v198 offset:49152
    v_mfma_f32_16x16x32_bf16 v[40:43], v[180:183], v[160:163], v[40:43]
    ds_read_b128 v[228:231], v9 offset:36864
    v_mfma_f32_16x16x32_bf16 v[44:47], v[180:183], v[164:167], v[44:47]
    ds_read_b128 v[232:235], v9 offset:38912
    s_waitcnt lgkmcnt(8)
    v_mfma_f32_16x16x32_bf16 v[48:51], v[168:171], v[184:187], v[48:51]
    ds_read_b128 v[236:239], v1 offset:54272
    v_mfma_f32_16x16x32_bf16 v[52:55], v[168:171], v[188:191], v[52:55]
    v_mfma_f32_16x16x32_bf16 v[56:59], v[172:175], v[184:187], v[56:59]
    v_mfma_f32_16x16x32_bf16 v[60:63], v[172:175], v[188:191], v[60:63]
    v_mfma_f32_16x16x32_bf16 v[64:67], v[176:179], v[184:187], v[64:67]
    v_mfma_f32_16x16x32_bf16 v[68:71], v[176:179], v[188:191], v[68:71]
    v_mfma_f32_16x16x32_bf16 v[72:75], v[180:183], v[184:187], v[72:75]
    v_mfma_f32_16x16x32_bf16 v[76:79], v[180:183], v[188:191], v[76:79]
    v_mfma_f32_16x16x32_bf16 v[80:83], v[192:195], v[184:187], v[80:83]
    v_mfma_f32_16x16x32_bf16 v[84:87], v[192:195], v[188:191], v[84:87]
    s_waitcnt lgkmcnt(0)
    s_barrier
    v_mfma_f32_16x16x32_bf16 v[16:19], v[212:215], v[204:207], v[16:19]
    ds_read_b128 v[160:163], v202 offset:0
    v_mfma_f32_16x16x32_bf16 v[20:23], v[212:215], v[208:211], v[20:23]
    ds_read_b128 v[164:167], v202 offset:2048
    v_mfma_f32_16x16x32_bf16 v[24:27], v[216:219], v[204:207], v[24:27]
    ds_read_b128 v[168:171], v199 offset:0
    v_mfma_f32_16x16x32_bf16 v[28:31], v[216:219], v[208:211], v[28:31]
    ds_read_b128 v[172:175], v199 offset:1024
    v_mfma_f32_16x16x32_bf16 v[32:35], v[220:223], v[204:207], v[32:35]
    ds_read_b128 v[176:179], v199 offset:2048
    v_mfma_f32_16x16x32_bf16 v[36:39], v[220:223], v[208:211], v[36:39]
    ds_read_b128 v[180:183], v199 offset:3072
    v_mfma_f32_16x16x32_bf16 v[40:43], v[224:227], v[204:207], v[40:43]
    ds_read_b128 v[184:187], v10 offset:0
    v_mfma_f32_16x16x32_bf16 v[44:47], v[224:227], v[208:211], v[44:47]
    ds_read_b128 v[188:191], v10 offset:2048
    v_mfma_f32_16x16x32_bf16 v[48:51], v[212:215], v[228:231], v[48:51]
    ds_read_b128 v[192:195], v2 offset:8192
    v_mfma_f32_16x16x32_bf16 v[52:55], v[212:215], v[232:235], v[52:55]
    v_mfma_f32_16x16x32_bf16 v[56:59], v[216:219], v[228:231], v[56:59]
    v_mfma_f32_16x16x32_bf16 v[60:63], v[216:219], v[232:235], v[60:63]
    v_mfma_f32_16x16x32_bf16 v[64:67], v[220:223], v[228:231], v[64:67]
    v_mfma_f32_16x16x32_bf16 v[68:71], v[220:223], v[232:235], v[68:71]
    v_mfma_f32_16x16x32_bf16 v[72:75], v[224:227], v[228:231], v[72:75]
    v_mfma_f32_16x16x32_bf16 v[76:79], v[224:227], v[232:235], v[76:79]
    v_mfma_f32_16x16x32_bf16 v[80:83], v[236:239], v[228:231], v[80:83]
    s_sub_u32 s41, s41, 1
    v_mfma_f32_16x16x32_bf16 v[84:87], v[236:239], v[232:235], v[84:87]
    s_cmp_lg_u32 s41, 0
    s_cbranch_scc1 L_g_loop
    s_waitcnt lgkmcnt(3)
    v_mfma_f32_16x16x32_bf16 v[16:19], v[168:171], v[160:163], v[16:19]
    ds_read_b128 v[204:207], v203 offset:0
    v_mfma_f32_16x16x32_bf16 v[20:23], v[168:171], v[164:167], v[20:23]
    ds_read_b128 v[208:211], v203 offset:2048
    v_mfma_f32_16x16x32_bf16 v[24:27], v[172:175], v[160:163], v[24:27]
    ds_read_b128 v[212:215], v199 offset:9216
    v_mfma_f32_16x16x32_bf16 v[28:31], v[172:175], v[164:167], v[28:31]
    ds_read_b128 v[216:219], v199 offset:10240
    v_mfma_f32_16x16x32_bf16 v[32:35], v[176:179], v[160:163], v[32:35]
    ds_read_b128 v[220:223], v199 offset:11264
    v_mfma_f32_16x16x32_bf16 v[36:39], v[176:179], v[164:167], v[36:39]
    ds_read_b128 v[224:227], v199 offset:12288
    v_mfma_f32_16x16x32_bf16 v[40:43], v[180:183], v[160:163], v[40:43]
    ds_read_b128 v[228:231], v11 offset:0
    v_mfma_f32_16x16x32_bf16 v[44:47], v[180:183], v[164:167], v[44:47]
    ds_read_b128 v[232:235], v11 offset:2048
    s_waitcnt lgkmcnt(8)
    v_mfma_f32_16x16x32_bf16 v[48:51], v[168:171], v[184:187], v[48:51]
    ds_read_b128 v[236:239], v2 offset:17408
    v_mfma_f32_16x16x32_bf16 v[52:55], v[168:171], v[188:191], v[52:55]
    v_mfma_f32_16x16x32_bf16 v[56:59], v[172:175], v[184:187], v[56:59]
    v_mfma_f32_16x16x32_bf16 v[60:63], v[172:175], v[188:191], v[60:63]
    v_mfma_f32_16x16x32_bf16 v[64:67], v[176:179], v[184:187], v[64:67]
    v_mfma_f32_16x16x32_bf16 v[68:71], v[176:179], v[188:191], v[68:71]
    v_mfma_f32_16x16x32_bf16 v[72:75], v[180:183], v[184:187], v[72:75]
    v_mfma_f32_16x16x32_bf16 v[76:79], v[180:183], v[188:191], v[76:79]
    v_mfma_f32_16x16x32_bf16 v[80:83], v[192:195], v[184:187], v[80:83]
    v_mfma_f32_16x16x32_bf16 v[84:87], v[192:195], v[188:191], v[84:87]
    s_waitcnt lgkmcnt(0)
    s_barrier
    v_mfma_f32_16x16x32_bf16 v[16:19], v[212:215], v[204:207], v[16:19]
    ds_read_b128 v[160:163], v202 offset:36864
    v_mfma_f32_16x16x32_bf16 v[20:23], v[212:215], v[208:211], v[20:23]
    ds_read_b128 v[164:167], v202 offset:38912
    v_mfma_f32_16x16x32_bf16 v[24:27], v[216:219], v[204:207], v[24:27]
    ds_read_b128 v[168:171], v199 offset:36864
    v_mfma_f32_16x16x32_bf16 v[28:31], v[216:219], v[208:211], v[28:31]
    ds_read_b128 v[172:175], v199 offset:37888
    v_mfma_f32_16x16x32_bf16 v[32:35], v[220:223], v[204:207], v[32:35]
    ds_read_b128 v[176:179], v199 offset:38912
    v_mfma_f32_16x16x32_bf16 v[36:39], v[220:223], v[208:211], v[36:39]
    ds_read_b128 v[180:183], v199 offset:39936
    v_mfma_f32_16x16x32_bf16 v[40:43], v[224:227], v[204:207], v[40:43]
    ds_read_b128 v[184:187], v10 offset:36864
    v_mfma_f32_16x16x32_bf16 v[44:47], v[224:227], v[208:211], v[44:47]
    ds_read_b128 v[188:191], v10 offset:38912
    v_mfma_f32_16x16x32_bf16 v[48:51], v[212:215], v[228:231], v[48:51]
    ds_read_b128 v[192:195], v2 offset:45056
    v_mfma_f32_16x16x32_bf16 v[52:55], v[212:215], v[232:235], v[52:55]
    v_mfma_f32_16x16x32_bf16 v[56:59], v[216:219], v[228:231], v[56:59]
    v_mfma_f32_16x16x32_bf16 v[60:63], v[216:219], v[232:235], v[60:63]
    v_mfma_f32_16x16x32_bf16 v[64:67], v[220:223], v[228:231], v[64:67]
    v_mfma_f32_16x16x32_bf16 v[68:71], v[220:223], v[232:235], v[68:71]
    v_mfma_f32_16x16x32_bf16 v[72:75], v[224:227], v[228:231], v[72:75]
    v_mfma_f32_16x16x32_bf16 v[76:79], v[224:227], v[232:235], v[76:79]
    v_mfma_f32_16x16x32_bf16 v[80:83], v[236:239], v[228:231], v[80:83]
    v_mfma_f32_16x16x32_bf16 v[84:87], v[236:239], v[232:235], v[84:87]
    s_waitcnt lgkmcnt(3)
    v_mfma_f32_16x16x32_bf16 v[16:19], v[168:171], v[160:163], v[16:19]
    ds_read_b128 v[204:207], v203 offset:36864
    v_mfma_f32_16x16x32_bf16 v[20:23], v[168:171], v[164:167], v[20:23]
    ds_read_b128 v[208:211], v203 offset:38912
    v_mfma_f32_16x16x32_bf16 v[24:27], v[172:175], v[160:163], v[24:27]
    ds_read_b128 v[212:215], v199 offset:46080
    v_mfma_f32_16x16x32_bf16 v[28:31], v[172:175], v[164:167], v[28:31]
    ds_read_b128 v[216:219], v199 offset:47104
    v_mfma_f32_16x16x32_bf16 v[32:35], v[176:179], v[160:163], v[32:35]
    ds_read_b128 v[220:223], v199 offset:48128
    v_mfma_f32_16x16x32_bf16 v[36:39], v[176:179], v[164:167], v[36:39]
    ds_read_b128 v[224:227], v199 offset:49152
    v_mfma_f32_16x16x32_bf16 v[40:43], v[180:183], v[160:163], v[40:43]
    ds_read_b128 v[228:231], v11 offset:36864
    v_mfma_f32_16x16x32_bf16 v[44:47], v[180:183], v[164:167], v[44:47]
    ds_read_b128 v[232:235], v11 offset:38912
    s_waitcnt lgkmcnt(8)
    v_mfma_f32_16x16x32_bf16 v[48:51], v[168:171], v[184:187], v[48:51]
    ds_read_b128 v[236:239], v2 offset:54272
    v_mfma_f32_16x16x32_bf16 v[52:55], v[168:171], v[188:191], v[52:55]
    v_mfma_f32_16x16x32_bf16 v[56:59], v[172:175], v[184:187], v[56:59]
    v_mfma_f32_16x16x32_bf16 v[60:63], v[172:175], v[188:191], v[60:63]
    v_mfma_f32_16x16x32_bf16 v[64:67], v[176:179], v[184:187], v[64:67]
    v_mfma_f32_16x16x32_bf16 v[68:71], v[176:179], v[188:191], v[68:71]
    v_mfma_f32_16x16x32_bf16 v[72:75], v[180:183], v[184:187], v[72:75]
    v_mfma_f32_16x16x32_bf16 v[76:79], v[180:183], v[188:191], v[76:79]
    v_mfma_f32_16x16x32_bf16 v[80:83], v[192:195], v[184:187], v[80:83]
    v_mfma_f32_16x16x32_bf16 v[84:87], v[192:195], v[188:191], v[84:87]
    s_waitcnt lgkmcnt(0)
    s_barrier
    v_mfma_f32_16x16x32_bf16 v[16:19], v[212:215], v[204:207], v[16:19]
    ds_read_b128 v[160:163], v200 offset:0
    v_mfma_f32_16x16x32_bf16 v[20:23], v[212:215], v[208:211], v[20:23]
    ds_read_b128 v[164:167], v200 offset:2048
    v_mfma_f32_16x16x32_bf16 v[24:27], v[216:219], v[204:207], v[24:27]
    ds_read_b128 v[192:195], v198 offset:0
    v_mfma_f32_16x16x32_bf16 v[28:31], v[216:219], v[208:211], v[28:31]
    ds_read_b128 v[168:171], v201 offset:0
    v_mfma_f32_16x16x32_bf16 v[32:35], v[220:223], v[204:207], v[32:35]
    ds_read_b128 v[172:175], v201 offset:2048
    v_mfma_f32_16x16x32_bf16 v[36:39], v[220:223], v[208:211], v[36:39]
    ds_read_b128 v[176:179], v200 offset:36864
    v_mfma_f32_16x16x32_bf16 v[40:43], v[224:227], v[204:207], v[40:43]
    ds_read_b128 v[180:183], v200 offset:38912
    v_mfma_f32_16x16x32_bf16 v[44:47], v[224:227], v[208:211], v[44:47]
    ds_read_b128 v[184:187], v201 offset:36864
    v_mfma_f32_16x16x32_bf16 v[48:51], v[212:215], v[228:231], v[48:51]
    ds_read_b128 v[188:191], v201 offset:38912
    v_mfma_f32_16x16x32_bf16 v[52:55], v[212:215], v[232:235], v[52:55]
    ds_read_b128 v[240:243], v198 offset:9216
    v_mfma_f32_16x16x32_bf16 v[56:59], v[216:219], v[228:231], v[56:59]
    ds_read_b128 v[244:247], v198 offset:36864
    v_mfma_f32_16x16x32_bf16 v[60:63], v[216:219], v[232:235], v[60:63]
    ds_read_b128 v[248:251], v198 offset:46080
    v_mfma_f32_16x16x32_bf16 v[64:67], v[220:223], v[228:231], v[64:67]
    ds_read_b128 v[4:7], v198 offset:1024
    v_mfma_f32_16x16x32_bf16 v[68:71], v[220:223], v[232:235], v[68:71]
    v_mfma_f32_16x16x32_bf16 v[72:75], v[224:227], v[228:231], v[72:75]
    v_mfma_f32_16x16x32_bf16 v[76:79], v[224:227], v[232:235], v[76:79]
    v_mfma_f32_16x16x32_bf16 v[80:83], v[236:239], v[228:231], v[80:83]
    v_mfma_f32_16x16x32_bf16 v[84:87], v[236:239], v[232:235], v[84:87]
    s_waitcnt lgkmcnt(0)
    v_mfma_f32_16x16x32_bf16 v[16:19], v[192:195], v[160:163], v[16:19]
    ds_read_b128 v[252:255], v198 offset:10240
    v_mfma_f32_16x16x32_bf16 v[20:23], v[192:195], v[164:167], v[20:23]
    ds_read_b128 v[204:207], v8 offset:0
    v_mfma_f32_16x16x32_bf16 v[16:19], v[240:243], v[168:171], v[16:19]
    ds_read_b128 v[236:239], v198 offset:37888
    v_mfma_f32_16x16x32_bf16 v[20:23], v[240:243], v[172:175], v[20:23]
    ds_read_b128 v[208:211], v8 offset:2048
    v_mfma_f32_16x16x32_bf16 v[16:19], v[244:247], v[176:179], v[16:19]
    ds_read_b128 v[192:195], v198 offset:47104
    v_mfma_f32_16x16x32_bf16 v[20:23], v[244:247], v[180:183], v[20:23]
    ds_read_b128 v[212:215], v9 offset:0
    v_mfma_f32_16x16x32_bf16 v[16:19], v[248:251], v[184:187], v[16:19]
    ds_read_b128 v[240:243], v198 offset:2048
    v_mfma_f32_16x16x32_bf16 v[20:23], v[248:251], v[188:191], v[20:23]
    ds_read_b128 v[216:219], v9 offset:2048
    v_mfma_f32_16x16x32_bf16 v[24:27], v[4:7], v[160:163], v[24:27]
    ds_read_b128 v[244:247], v198 offset:11264
    v_mfma_f32_16x16x32_bf16 v[28:31], v[4:7], v[164:167], v[28:31]
    ds_read_b128 v[220:223], v8 offset:36864
    s_waitcnt lgkmcnt(9)
    v_mfma_f32_16x16x32_bf16 v[24:27], v[252:255], v[168:171], v[24:27]
    ds_read_b128 v[248:251], v198 offset:38912
    v_mfma_f32_16x16x32_bf16 v[28:31], v[252:255], v[172:175], v[28:31]
    ds_read_b128 v[224:227], v8 offset:38912
    s_waitcnt lgkmcnt(9)
    v_mfma_f32_16x16x32_bf16 v[24:27], v[236:239], v[176:179], v[24:27]
    ds_read_b128 v[4:7], v198 offset:48128
    v_mul_f32 v16, v16, v88
    v_mfma_f32_16x16x32_bf16 v[28:31], v[236:239], v[180:183], v[28:31]
    ds_read_b128 v[228:231], v9 offset:36864
    v_mul_f32 v17, v17, v89
    s_waitcnt lgkmcnt(9)
    v_mfma_f32_16x16x32_bf16 v[24:27], v[192:195], v[184:187], v[24:27]
    ds_read_b128 v[252:255], v198 offset:3072
    v_mul_f32_e64 v18, v18, v90
    v_mfma_f32_16x16x32_bf16 v[28:31], v[192:195], v[188:191], v[28:31]
    ds_read_b128 v[232:235], v9 offset:38912
    v_mul_f32 v19, v19, v91
    s_waitcnt lgkmcnt(9)
    v_mfma_f32_16x16x32_bf16 v[32:35], v[240:243], v[160:163], v[32:35]
    ds_read_b128 v[236:239], v198 offset:12288
    v_cvt_pk_bf16_f32 v88, v16, v17
    v_mfma_f32_16x16x32_bf16 v[36:39], v[240:243], v[164:167], v[36:39]
    v_cvt_pk_bf16_f32 v89, v18, v19
    v_mul_f32 v20, v20, v92
    s_waitcnt lgkmcnt(8)
    v_mfma_f32_16x16x32_bf16 v[32:35], v[244:247], v[168:171], v[32:35]
    ds_read_b128 v[192:195], v198 offset:39936
    v_mul_f32_e64 v21, v21, v93
    v_mfma_f32_16x16x32_bf16 v[36:39], v[244:247], v[172:175], v[36:39]
    v_mul_f32 v22, v22, v94
    v_mul_f32_e64 v23, v23, v95
    s_waitcnt lgkmcnt(7)
    v_mfma_f32_16x16x32_bf16 v[32:35], v[248:251], v[176:179], v[32:35]
    ds_read_b128 v[240:243], v198 offset:49152
    v_cvt_pk_bf16_f32 v92, v20, v21
    v_mfma_f32_16x16x32_bf16 v[36:39], v[248:251], v[180:183], v[36:39]
    v_cvt_pk_bf16_f32 v93, v22, v23
    v_mul_f32 v24, v24, v96
    v_mul_f32_e64 v25, v25, v97
    s_waitcnt lgkmcnt(6)
    v_mfma_f32_16x16x32_bf16 v[32:35], v[4:7], v[184:187], v[32:35]
    ds_read_b128 v[244:247], v198 offset:0
    v_mul_f32_e64 v26, v26, v98
    v_mfma_f32_16x16x32_bf16 v[36:39], v[4:7], v[188:191], v[36:39]
    v_mul_f32_e64 v27, v27, v99
    v_cvt_pk_bf16_f32 v90, v24, v25
    s_waitcnt lgkmcnt(5)
    v_mfma_f32_16x16x32_bf16 v[40:43], v[252:255], v[160:163], v[40:43]
    ds_read_b128 v[248:251], v198 offset:9216
    v_cvt_pk_bf16_f32 v91, v26, v27
    v_mfma_f32_16x16x32_bf16 v[44:47], v[252:255], v[164:167], v[44:47]
    buffer_store_dwordx4 v[88:91], v13, s[4:7], s36 offen sc1
    v_mul_f32_e64 v28, v28, v100
    s_waitcnt lgkmcnt(4)
    v_mfma_f32_16x16x32_bf16 v[40:43], v[236:239], v[168:171], v[40:43]
    ds_read_b128 v[4:7], v198 offset:36864
    v_mul_f32_e64 v29, v29, v101
    v_mfma_f32_16x16x32_bf16 v[44:47], v[236:239], v[172:175], v[44:47]
    v_mul_f32 v30, v30, v102
    v_mul_f32_e64 v31, v31, v103
    s_waitcnt lgkmcnt(4)
    v_mfma_f32_16x16x32_bf16 v[40:43], v[192:195], v[176:179], v[40:43]
    ds_read_b128 v[252:255], v198 offset:46080
    v_cvt_pk_bf16_f32 v94, v28, v29
    v_mfma_f32_16x16x32_bf16 v[44:47], v[192:195], v[180:183], v[44:47]
    v_cvt_pk_bf16_f32 v95, v30, v31
    buffer_store_dwordx4 v[92:95], v13, s[4:7], s37 offen sc1
    v_mul_f32 v32, v32, v104
    s_waitcnt lgkmcnt(4)
    v_mfma_f32_16x16x32_bf16 v[40:43], v[240:243], v[184:187], v[40:43]
    ds_read_b128 v[236:239], v198 offset:1024
    v_mul_f32_e64 v33, v33, v105
    v_mfma_f32_16x16x32_bf16 v[44:47], v[240:243], v[188:191], v[44:47]
    v_mul_f32 v34, v34, v106
    v_mul_f32_e64 v35, v35, v107
    s_waitcnt lgkmcnt(4)
    v_mfma_f32_16x16x32_bf16 v[48:51], v[244:247], v[204:207], v[48:51]
    ds_read_b128 v[192:195], v198 offset:10240
    v_cvt_pk_bf16_f32 v104, v32, v33
    v_mfma_f32_16x16x32_bf16 v[52:55], v[244:247], v[208:211], v[52:55]
    v_cvt_pk_bf16_f32 v105, v34, v35
    v_mul_f32 v36, v36, v108
    s_waitcnt lgkmcnt(4)
    v_mfma_f32_16x16x32_bf16 v[48:51], v[248:251], v[212:215], v[48:51]
    ds_read_b128 v[240:243], v198 offset:37888
    v_mul_f32_e64 v37, v37, v109
    v_mfma_f32_16x16x32_bf16 v[52:55], v[248:251], v[216:219], v[52:55]
    v_mul_f32 v38, v38, v110
    v_mul_f32_e64 v39, v39, v111
    s_waitcnt lgkmcnt(4)
    v_mfma_f32_16x16x32_bf16 v[48:51], v[4:7], v[220:223], v[48:51]
    ds_read_b128 v[244:247], v198 offset:47104
    v_cvt_pk_bf16_f32 v108, v36, v37
    v_mfma_f32_16x16x32_bf16 v[52:55], v[4:7], v[224:227], v[52:55]
    v_cvt_pk_bf16_f32 v109, v38, v39
    v_mul_f32 v40, v40, v112
    v_mul_f32_e64 v41, v41, v113
    s_waitcnt lgkmcnt(4)
    v_mfma_f32_16x16x32_bf16 v[48:51], v[252:255], v[228:231], v[48:51]
    ds_read_b128 v[248:251], v198 offset:2048
    v_mul_f32_e64 v42, v42, v114
    v_mfma_f32_16x16x32_bf16 v[52:55], v[252:255], v[232:235], v[52:55]
    v_mul_f32_e64 v43, v43, v115
    v_cvt_pk_bf16_f32 v106, v40, v41
    s_waitcnt lgkmcnt(4)
    v_mfma_f32_16x16x32_bf16 v[56:59], v[236:239], v[204:207], v[56:59]
    ds_read_b128 v[4:7], v198 offset:11264
    v_cvt_pk_bf16_f32 v107, v42, v43
    v_mfma_f32_16x16x32_bf16 v[60:63], v[236:239], v[208:211], v[60:63]
    buffer_store_dwordx4 v[104:107], v14, s[4:7], s36 offen sc1
    v_mul_f32_e64 v44, v44, v116
    s_waitcnt lgkmcnt(4)
    v_mfma_f32_16x16x32_bf16 v[56:59], v[192:195], v[212:215], v[56:59]
    ds_read_b128 v[252:255], v198 offset:38912
    v_mul_f32_e64 v45, v45, v117
    v_mfma_f32_16x16x32_bf16 v[60:63], v[192:195], v[216:219], v[60:63]
    v_mul_f32 v46, v46, v118
    v_mul_f32_e64 v47, v47, v119
    s_waitcnt lgkmcnt(4)
    v_mfma_f32_16x16x32_bf16 v[56:59], v[240:243], v[220:223], v[56:59]
    ds_read_b128 v[236:239], v198 offset:48128
    v_cvt_pk_bf16_f32 v110, v44, v45
    v_mfma_f32_16x16x32_bf16 v[60:63], v[240:243], v[224:227], v[60:63]
    v_cvt_pk_bf16_f32 v111, v46, v47
    buffer_store_dwordx4 v[108:111], v14, s[4:7], s37 offen sc1
    v_mul_f32 v48, v48, v120
    s_waitcnt lgkmcnt(4)
    v_mfma_f32_16x16x32_bf16 v[56:59], v[244:247], v[228:231], v[56:59]
    ds_read_b128 v[192:195], v198 offset:3072
    v_mul_f32_e64 v49, v49, v121
    v_mfma_f32_16x16x32_bf16 v[60:63], v[244:247], v[232:235], v[60:63]
    v_mul_f32 v50, v50, v122
    v_mul_f32_e64 v51, v51, v123
    s_waitcnt lgkmcnt(4)
    v_mfma_f32_16x16x32_bf16 v[64:67], v[248:251], v[204:207], v[64:67]
    ds_read_b128 v[240:243], v198 offset:12288
    v_cvt_pk_bf16_f32 v120, v48, v49
    v_mfma_f32_16x16x32_bf16 v[68:71], v[248:251], v[208:211], v[68:71]
    v_cvt_pk_bf16_f32 v121, v50, v51
    v_mul_f32 v52, v52, v124
    s_waitcnt lgkmcnt(4)
    v_mfma_f32_16x16x32_bf16 v[64:67], v[4:7], v[212:215], v[64:67]
    ds_read_b128 v[244:247], v198 offset:39936
    v_mul_f32_e64 v53, v53, v125
    v_mfma_f32_16x16x32_bf16 v[68:71], v[4:7], v[216:219], v[68:71]
    v_mul_f32 v54, v54, v126
    v_mul_f32_e64 v55, v55, v127
    s_waitcnt lgkmcnt(4)
    v_mfma_f32_16x16x32_bf16 v[64:67], v[252:255], v[220:223], v[64:67]
    ds_read_b128 v[248:251], v198 offset:49152
    v_cvt_pk_bf16_f32 v124, v52, v53
    v_mfma_f32_16x16x32_bf16 v[68:71], v[252:255], v[224:227], v[68:71]
    v_cvt_pk_bf16_f32 v125, v54, v55
    v_mul_f32 v56, v56, v128
    v_mul_f32_e64 v57, v57, v129
    s_waitcnt lgkmcnt(4)
    v_mfma_f32_16x16x32_bf16 v[64:67], v[236:239], v[228:231], v[64:67]
    ds_read_b128 v[4:7], v1 offset:8192
    v_mul_f32_e64 v58, v58, v130
    v_mfma_f32_16x16x32_bf16 v[68:71], v[236:239], v[232:235], v[68:71]
    v_mul_f32_e64 v59, v59, v131
    v_cvt_pk_bf16_f32 v122, v56, v57
    s_waitcnt lgkmcnt(4)
    v_mfma_f32_16x16x32_bf16 v[72:75], v[192:195], v[204:207], v[72:75]
    ds_read_b128 v[252:255], v1 offset:17408
    v_cvt_pk_bf16_f32 v123, v58, v59
    v_mfma_f32_16x16x32_bf16 v[76:79], v[192:195], v[208:211], v[76:79]
    buffer_store_dwordx4 v[120:123], v13, s[4:7], s39 offen sc1
    v_mul_f32_e64 v60, v60, v132
    s_waitcnt lgkmcnt(4)
    v_mfma_f32_16x16x32_bf16 v[72:75], v[240:243], v[212:215], v[72:75]
    ds_read_b128 v[236:239], v1 offset:45056
    v_mul_f32_e64 v61, v61, v133
    v_mfma_f32_16x16x32_bf16 v[76:79], v[240:243], v[216:219], v[76:79]
    v_mul_f32 v62, v62, v134
    v_mul_f32_e64 v63, v63, v135
    s_waitcnt lgkmcnt(4)
    v_mfma_f32_16x16x32_bf16 v[72:75], v[244:247], v[220:223], v[72:75]
    ds_read_b128 v[192:195], v1 offset:54272
    v_cvt_pk_bf16_f32 v126, v60, v61
    v_mfma_f32_16x16x32_bf16 v[76:79], v[244:247], v[224:227], v[76:79]
    v_cvt_pk_bf16_f32 v127, v62, v63
    buffer_store_dwordx4 v[124:127], v13, s[4:7], s40 offen sc1
    v_mul_f32 v64, v64, v136
    s_waitcnt lgkmcnt(4)
    v_mfma_f32_16x16x32_bf16 v[72:75], v[248:251], v[228:231], v[72:75]
    v_mul_f32 v65, v65, v137
    v_mul_f32 v66, v66, v138
    v_mfma_f32_16x16x32_bf16 v[76:79], v[248:251], v[232:235], v[76:79]
    v_mul_f32_e64 v67, v67, v139
    v_cvt_pk_bf16_f32 v136, v64, v65
    s_waitcnt lgkmcnt(3)
    v_mfma_f32_16x16x32_bf16 v[80:83], v[4:7], v[204:207], v[80:83]
    v_cvt_pk_bf16_f32 v137, v66, v67
    v_mul_f32 v68, v68, v140
    v_mfma_f32_16x16x32_bf16 v[84:87], v[4:7], v[208:211], v[84:87]
    v_mul_f32 v69, v69, v141
    v_mul_f32_e64 v70, v70, v142
    s_waitcnt lgkmcnt(2)
    v_mfma_f32_16x16x32_bf16 v[80:83], v[252:255], v[212:215], v[80:83]
    v_mul_f32_e64 v71, v71, v143
    v_cvt_pk_bf16_f32 v140, v68, v69
    v_mfma_f32_16x16x32_bf16 v[84:87], v[252:255], v[216:219], v[84:87]
    v_cvt_pk_bf16_f32 v141, v70, v71
    s_waitcnt lgkmcnt(1)
    v_mfma_f32_16x16x32_bf16 v[80:83], v[236:239], v[220:223], v[80:83]
    v_mul_f32 v72, v72, v144
    v_mul_f32_e64 v73, v73, v145
    v_mfma_f32_16x16x32_bf16 v[84:87], v[236:239], v[224:227], v[84:87]
    v_mul_f32 v74, v74, v146
    v_mul_f32 v75, v75, v147
    v_cvt_pk_bf16_f32 v138, v72, v73
    s_waitcnt lgkmcnt(0)
    v_mfma_f32_16x16x32_bf16 v[80:83], v[192:195], v[228:231], v[80:83]
    v_cvt_pk_bf16_f32 v139, v74, v75
    buffer_store_dwordx4 v[136:139], v14, s[4:7], s39 offen sc1
    v_mfma_f32_16x16x32_bf16 v[84:87], v[192:195], v[232:235], v[84:87]
    v_mul_f32 v76, v76, v148
    v_mul_f32 v77, v77, v149
    v_mul_f32 v78, v78, v150
    v_mul_f32_e64 v79, v79, v151
    v_cvt_pk_bf16_f32 v142, v76, v77
    v_cvt_pk_bf16_f32 v143, v78, v79
    buffer_store_dwordx4 v[140:143], v14, s[4:7], s40 offen sc1
    s_nop 1
    v_mul_f32 v80, v80, v152
    v_mul_f32 v81, v81, v153
    v_mul_f32 v82, v82, v154
    v_mul_f32_e64 v83, v83, v155
    v_cvt_pk_bf16_f32 v152, v80, v81
    v_cvt_pk_bf16_f32 v153, v82, v83
    v_mul_f32 v84, v84, v156
    v_mul_f32 v85, v85, v157
    v_mul_f32 v86, v86, v158
    v_mul_f32 v87, v87, v159
    v_cvt_pk_bf16_f32 v154, v84, v85
    v_cvt_pk_bf16_f32 v155, v86, v87
    s_bitcmp0_b32 s24, 1
    s_cbranch_scc1 L_g_ns
    v_swap_b32 v152, v154
    v_swap_b32 v153, v155
L_g_ns:
    buffer_store_dwordx4 v[152:155], v15, s[4:7], s39 offen sc1
    s_barrier
    s_and_b32 s25, s2, 7
    s_lshr_b32 s26, s2, 3
    s_lshr_b32 s23, s25, 1
    s_lshl_b32 s23, s23, 3
    s_lshr_b32 s27, s26, 2
    s_add_u32 s23, s23, s27
    s_and_b32 s24, s25, 1
    s_lshl_b32 s24, s24, 2
    s_and_b32 s27, s26, 3
    s_add_u32 s24, s24, s27
    s_add_u32 s25, s23, s24
    s_and_b32 s25, s25, 3
    s_lshl_b32 s30, s23, 2
    s_add_u32 s30, s30, s20
    s_and_b32 s31, s20, 1
    s_mul_i32 s34, s30, 18432
    s_add_u32 s34, s34, s21
    s_add_u32 s34, s34, 0x300000
    s_lshl_b32 s35, s24, 11
    s_lshr_b32 s36, s24, 2
    s_lshl_b32 s36, s36, 10
    s_and_b32 s37, s24, 3
    s_lshl_b32 s37, s37, 8
    s_add_u32 s36, s36, s37
    s_add_u32 s36, s36, 16384
    v_bfe_u32 v2, v1, 4, 4
    v_lshrrev_b32 v3, 8, v1
    v_add_u32 v4, s35, v1
    v_lshrrev_b32 v0, 1, v3
    v_and_b32_e64 v9, 1, v3
    v_cmp_eq_u32 s[40:41], s31, v0
    v_bfrev_b32 v6, 1
    v_lshlrev_b32 v5, 4, v2
    v_lshl_add_u32 v5, v9, 3, v5
    v_add_u32_e64 v5, s36, v5
    v_cndmask_b32 v5, v6, v5, s[40:41]
    buffer_load_dwordx4 v[220:223], v4, s[4:7], s34 offen offset:0 sc1
    buffer_load_dwordx4 v[224:227], v4, s[4:7], s34 offen offset:1024 sc1
    buffer_load_dwordx2 v[228:229], v5, s[4:7], s34 offen sc1
    s_and_b32 s29, s30, 0xfffe
    s_mul_i32 s29, s29, 73728
    s_add_u32 s29, s29, s21
    s_lshl_b32 s37, s31, 10
    s_add_u32 s29, s29, s37
    s_add_u32 s29, s29, 0x1200000
    s_mul_i32 s37, s31, 73728
    s_sub_u32 s38, 73728, s37
    v_lshlrev_b32 v10, 3, v2
    v_add_u32 v16, s37, v1
    v_add_u32 v17, s38, v1
    v_mov_b32_e64 v18, v1
    v_add_u32 v19, 73728, v1
    s_lshl_b32 s37, s31, 12
    v_add_u32 v20, 0, v1
    v_add_u32_e64 v12, s37, v20
    v_add_u32 v21, 36864, v1
    v_add_u32_e64 v13, s37, v21
    v_add_u32 v22, 73728, v1
    v_add_u32_e64 v14, s37, v22
    v_add_u32 v23, 110592, v1
    v_add_u32_e64 v15, s37, v23
    s_add_u32 s34, s34, 0x1900000
    s_lshl_b32 s39, s30, 10
    s_add_u32 s39, s39, s21
    s_lshl_b32 s42, s24, 7
    s_add_u32 s39, s39, s42
    s_add_u32 s39, s39, 0x3700000
    v_cmp_eq_u32_e64 vcc, 0, v3
    v_mov_b32 v11, 0x3f803f80
    s_lshr_b32 s44, s23, 1
    v_cndmask_b32 v10, v6, v10, vcc
    s_cmp_eq_u32 s22, 0
    s_cbranch_scc1 L_p5_nf
    v_mul_u32_u24 v8, 1152, v2
    s_mul_i32 s34, s30, 18432
    s_mul_i32 s42, s24, 144
    s_add_u32 s34, s34, s42
    v_lshrrev_b32 v4, 6, v1
    v_bfe_u32 v5, v1, 4, 2
    v_lshlrev_b32_e64 v10, 2, v4
    v_lshl_add_u32 v10, v5, 6, v10
    v_mul_u32_u24 v8, 1152, v4
    v_lshrrev_b32 v11, 1, v5
    v_cmp_eq_u32 vcc, s31, v11
    v_lshl_add_u32 v4, v5, 4, v8
    v_and_b32_e64 v5, 1, v5
    v_lshl_add_u32 v5, v5, 3, v8
    v_cndmask_b32 v5, v6, v5, vcc
L_p5_nf:
    s_lshl_b32 s52, s22, 7
    s_add_u32 s52, s52, s44
    s_lshl_b32 s52, s52, 8
    s_add_u32 s52, s52, 0x450a000
    s_add_u32 s52, s52, s4
    s_addc_u32 s53, s5, 0
    s_waitcnt vmcnt(3)
    s_barrier
    s_cmp_lg_u32 s20, 0
    s_cbranch_scc1 L_ns_d5
    s_mov_b32 s56, 1
    s_atomic_add s56, s[50:51], 0
L_ns_d5:
    s_mul_i32 s37, s20, 4608
    s_add_u32 s37, s37, 129024
    s_xor_b32 s38, s20, 1
    s_mul_i32 s42, s38, 4608
    s_add_u32 s42, s42, 129024
    v_and_b32 v0, 0x1ff, v1
    v_add_u32 v2, s37, v1
    v_add_u32 v3, s37, v0
    v_add_u32 v7, s42, v1
    v_add_u32_e64 v8, s42, v0
    s_lshl_b32 s37, s20, 2
    s_add_u32 s37, s37, 163808
    s_xor_b32 s38, s37, 4
    v_mov_b32 v0, s37
    v_mov_b32 v6, s38
    s_lshl_b32 s43, s22, 1
    s_add_u32 s43, s43, 2
    v_mov_b32 v9, s43
    s_cmp_lg_u32 s20, 0
    s_cbranch_scc1 L_pd_d5
    s_mov_b32 s60, 262144
L_poll_d5:
    s_mov_b32 s57, 0
    s_atomic_add s57, s[52:53], 0 glc
    s_waitcnt lgkmcnt(0)
    s_cmp_ge_u32 s57, 16
    s_cbranch_scc1 L_pd_d5
    s_sub_u32 s60, s60, 1
    s_cbranch_scc1 L_pd_d5
    s_sleep 2
    s_branch L_poll_d5
L_pd_d5:
    s_barrier
    s_mov_b32 s32, 0
    s_lshl_b32 s32, s32, 13
    s_add_u32 s32, s32, s29
    s_add_u32 s33, s32, 4096
    buffer_load_dwordx4 v[124:127], v16, s[4:7], s32 offen offset:0 sc1
    buffer_load_dwordx4 v[128:131], v17, s[4:7], s32 offen offset:0 sc1
    buffer_load_dwordx4 v[132:135], v16, s[4:7], s32 offen offset:2048 sc1
    buffer_load_dwordx4 v[136:139], v17, s[4:7], s32 offen offset:2048 sc1
    buffer_load_dwordx4 v[140:143], v16, s[4:7], s33 offen offset:0 sc1
    buffer_load_dwordx4 v[144:147], v17, s[4:7], s33 offen offset:0 sc1
    buffer_load_dwordx4 v[148:151], v16, s[4:7], s33 offen offset:2048 sc1
    buffer_load_dwordx4 v[152:155], v17, s[4:7], s33 offen offset:2048 sc1
    ds_read_b128 v[64:67], v14 offset:0
    ds_read_b128 v[68:71], v14 offset:1024
    ds_read_b128 v[72:75], v14 offset:2048
    ds_read_b128 v[76:79], v14 offset:3072
    ds_read_b128 v[80:83], v22 offset:8192
    ds_read_b128 v[84:87], v14 offset:9216
    ds_read_b128 v[88:91], v14 offset:10240
    ds_read_b128 v[92:95], v14 offset:11264
    ds_read_b128 v[96:99], v14 offset:12288
    ds_read_b128 v[100:103], v22 offset:17408
    ds_read_b128 v[104:107], v14 offset:18432
    ds_read_b128 v[108:111], v14 offset:19456
    ds_read_b128 v[112:115], v14 offset:20480
    ds_read_b128 v[116:119], v14 offset:21504
    ds_read_b128 v[120:123], v22 offset:26624
    s_add_u32 s45, s29, 8192
    s_add_u32 s46, s29, 12288
    buffer_load_dwordx4 v[156:159], v16, s[4:7], s45 offen offset:0 sc1
    buffer_load_dwordx4 v[160:163], v17, s[4:7], s45 offen offset:0 sc1
    s_lshl_b32 s50, s22, 7
    s_add_u32 s50, s50, s44
    s_lshl_b32 s50, s50, 8
    s_add_u32 s50, s50, 0x450b000
    s_add_u32 s50, s50, s4
    s_addc_u32 s51, s5, 0
    s_waitcnt vmcnt(10)
    v_lshlrev_b32_e64 v24, 16, v220
    v_and_b32 v25, 0xffff0000, v220
    v_lshlrev_b32_e64 v26, 16, v221
    v_and_b32 v27, 0xffff0000, v221
    v_lshlrev_b32_e64 v28, 16, v222
    v_and_b32 v29, 0xffff0000, v222
    v_lshlrev_b32_e64 v30, 16, v223
    v_and_b32 v31, 0xffff0000, v223
    v_lshlrev_b32_e64 v32, 16, v224
    v_and_b32 v33, 0xffff0000, v224
    v_lshlrev_b32_e64 v34, 16, v225
    v_and_b32 v35, 0xffff0000, v225
    v_lshlrev_b32_e64 v36, 16, v226
    v_and_b32 v37, 0xffff0000, v226
    v_lshlrev_b32_e64 v38, 16, v227
    v_and_b32 v39, 0xffff0000, v227
    v_lshlrev_b32_e64 v40, 16, v228
    v_and_b32 v41, 0xffff0000, v228
    v_lshlrev_b32_e64 v42, 16, v229
    v_and_b32 v43, 0xffff0000, v229
    s_waitcnt vmcnt(8) lgkmcnt(10)
    v_mfma_f32_16x16x32_bf16 v[44:47], v[64:67], v[128:131], 0
    ds_read_b128 v[236:239], v14 offset:27648
    s_mov_b32 s32, 2
    s_lshl_b32 s32, s32, 13
    s_add_u32 s32, s32, s29
    s_add_u32 s33, s32, 4096
    v_mfma_f32_16x16x32_bf16 v[24:27], v[64:67], v[124:127], v[24:27]
    ds_read_b128 v[240:243], v14 offset:28672
    buffer_load_dwordx4 v[164:167], v16, s[4:7], s45 offen offset:2048 sc1
    v_mfma_f32_16x16x32_bf16 v[48:51], v[68:71], v[128:131], 0
    ds_read_b128 v[244:247], v14 offset:29696
    v_mfma_f32_16x16x32_bf16 v[28:31], v[68:71], v[124:127], v[28:31]
    ds_read_b128 v[248:251], v14 offset:30720
    buffer_load_dwordx4 v[168:171], v17, s[4:7], s45 offen offset:2048 sc1
    v_mfma_f32_16x16x32_bf16 v[52:55], v[72:75], v[128:131], 0
    ds_read_b128 v[252:255], v22 offset:35840
    v_mfma_f32_16x16x32_bf16 v[32:35], v[72:75], v[124:127], v[32:35]
    buffer_load_dwordx4 v[188:191], v16, s[4:7], s32 offen offset:0 sc1
    v_mfma_f32_16x16x32_bf16 v[56:59], v[76:79], v[128:131], 0
    v_mfma_f32_16x16x32_bf16 v[36:39], v[76:79], v[124:127], v[36:39]
    buffer_load_dwordx4 v[192:195], v17, s[4:7], s32 offen offset:0 sc1
    v_mfma_f32_16x16x32_bf16 v[60:63], v[80:83], v[128:131], 0
    v_mfma_f32_16x16x32_bf16 v[40:43], v[80:83], v[124:127], v[40:43]
    s_waitcnt vmcnt(10) lgkmcnt(0)
    s_barrier
    v_mfma_f32_16x16x32_bf16 v[44:47], v[84:87], v[136:139], v[44:47]
    ds_read_b128 v[64:67], v15 offset:0
    v_mfma_f32_16x16x32_bf16 v[24:27], v[84:87], v[132:135], v[24:27]
    ds_read_b128 v[68:71], v15 offset:1024
    buffer_load_dwordx4 v[172:175], v16, s[4:7], s46 offen offset:0 sc1
    v_mfma_f32_16x16x32_bf16 v[48:51], v[88:91], v[136:139], v[48:51]
    ds_read_b128 v[72:75], v15 offset:2048
    v_mfma_f32_16x16x32_bf16 v[28:31], v[88:91], v[132:135], v[28:31]
    ds_read_b128 v[76:79], v15 offset:3072
    buffer_load_dwordx4 v[176:179], v17, s[4:7], s46 offen offset:0 sc1
    v_mfma_f32_16x16x32_bf16 v[52:55], v[92:95], v[136:139], v[52:55]
    ds_read_b128 v[80:83], v23 offset:8192
    v_mfma_f32_16x16x32_bf16 v[32:35], v[92:95], v[132:135], v[32:35]
    buffer_load_dwordx4 v[196:199], v16, s[4:7], s32 offen offset:2048 sc1
    v_mfma_f32_16x16x32_bf16 v[56:59], v[96:99], v[136:139], v[56:59]
    v_mfma_f32_16x16x32_bf16 v[36:39], v[96:99], v[132:135], v[36:39]
    buffer_load_dwordx4 v[200:203], v17, s[4:7], s32 offen offset:2048 sc1
    v_mfma_f32_16x16x32_bf16 v[60:63], v[100:103], v[136:139], v[60:63]
    v_mfma_f32_16x16x32_bf16 v[40:43], v[100:103], v[132:135], v[40:43]
    s_waitcnt vmcnt(12) lgkmcnt(10)
    v_mfma_f32_16x16x32_bf16 v[44:47], v[104:107], v[144:147], v[44:47]
    ds_read_b128 v[84:87], v15 offset:9216
    v_mfma_f32_16x16x32_bf16 v[24:27], v[104:107], v[140:143], v[24:27]
    ds_read_b128 v[88:91], v15 offset:10240
    buffer_load_dwordx4 v[180:183], v16, s[4:7], s46 offen offset:2048 sc1
    v_mfma_f32_16x16x32_bf16 v[48:51], v[108:111], v[144:147], v[48:51]
    ds_read_b128 v[92:95], v15 offset:11264
    v_mfma_f32_16x16x32_bf16 v[28:31], v[108:111], v[140:143], v[28:31]
    ds_read_b128 v[96:99], v15 offset:12288
    buffer_load_dwordx4 v[184:187], v17, s[4:7], s46 offen offset:2048 sc1
    v_mfma_f32_16x16x32_bf16 v[52:55], v[112:115], v[144:147], v[52:55]
    ds_read_b128 v[100:103], v23 offset:17408
    v_mfma_f32_16x16x32_bf16 v[32:35], v[112:115], v[140:143], v[32:35]
    buffer_load_dwordx4 v[204:207], v16, s[4:7], s33 offen offset:0 sc1
    v_mfma_f32_16x16x32_bf16 v[56:59], v[116:119], v[144:147], v[56:59]
    v_mfma_f32_16x16x32_bf16 v[36:39], v[116:119], v[140:143], v[36:39]
    buffer_load_dwordx4 v[208:211], v17, s[4:7], s33 offen offset:0 sc1
    v_mfma_f32_16x16x32_bf16 v[60:63], v[120:123], v[144:147], v[60:63]
    v_mfma_f32_16x16x32_bf16 v[40:43], v[120:123], v[140:143], v[40:43]
    s_waitcnt vmcnt(14) lgkmcnt(10)
    v_mfma_f32_16x16x32_bf16 v[44:47], v[236:239], v[152:155], v[44:47]
    ds_read_b128 v[104:107], v15 offset:18432
    v_mfma_f32_16x16x32_bf16 v[24:27], v[236:239], v[148:151], v[24:27]
    ds_read_b128 v[108:111], v15 offset:19456
    v_mfma_f32_16x16x32_bf16 v[48:51], v[240:243], v[152:155], v[48:51]
    ds_read_b128 v[112:115], v15 offset:20480
    v_mfma_f32_16x16x32_bf16 v[28:31], v[240:243], v[148:151], v[28:31]
    ds_read_b128 v[116:119], v15 offset:21504
    v_mfma_f32_16x16x32_bf16 v[52:55], v[244:247], v[152:155], v[52:55]
    ds_read_b128 v[120:123], v23 offset:26624
    v_mfma_f32_16x16x32_bf16 v[32:35], v[244:247], v[148:151], v[32:35]
    buffer_load_dwordx4 v[212:215], v16, s[4:7], s33 offen offset:2048 sc1
    v_mfma_f32_16x16x32_bf16 v[56:59], v[248:251], v[152:155], v[56:59]
    v_mfma_f32_16x16x32_bf16 v[36:39], v[248:251], v[148:151], v[36:39]
    buffer_load_dwordx4 v[216:219], v17, s[4:7], s33 offen offset:2048 sc1
    v_mfma_f32_16x16x32_bf16 v[60:63], v[252:255], v[152:155], v[60:63]
    v_mfma_f32_16x16x32_bf16 v[40:43], v[252:255], v[148:151], v[40:43]
    s_waitcnt vmcnt(14) lgkmcnt(10)
    v_mfma_f32_16x16x32_bf16 v[44:47], v[64:67], v[160:163], v[44:47]
    ds_read_b128 v[236:239], v15 offset:27648
    s_mov_b32 s32, 3
    s_lshl_b32 s32, s32, 13
    s_add_u32 s32, s32, s29
    s_add_u32 s33, s32, 4096
    v_mfma_f32_16x16x32_bf16 v[24:27], v[64:67], v[156:159], v[24:27]
    ds_read_b128 v[240:243], v15 offset:28672
    v_mfma_f32_16x16x32_bf16 v[48:51], v[68:71], v[160:163], v[48:51]
    ds_read_b128 v[244:247], v15 offset:29696
    v_mfma_f32_16x16x32_bf16 v[28:31], v[68:71], v[156:159], v[28:31]
    ds_read_b128 v[248:251], v15 offset:30720
    v_mfma_f32_16x16x32_bf16 v[52:55], v[72:75], v[160:163], v[52:55]
    ds_read_b128 v[252:255], v23 offset:35840
    v_mfma_f32_16x16x32_bf16 v[32:35], v[72:75], v[156:159], v[32:35]
    buffer_load_dwordx4 v[124:127], v16, s[4:7], s32 offen offset:0 sc1
    v_mfma_f32_16x16x32_bf16 v[56:59], v[76:79], v[160:163], v[56:59]
    v_mfma_f32_16x16x32_bf16 v[36:39], v[76:79], v[156:159], v[36:39]
    buffer_load_dwordx4 v[128:131], v17, s[4:7], s32 offen offset:0 sc1
    v_mfma_f32_16x16x32_bf16 v[60:63], v[80:83], v[160:163], v[60:63]
    v_mfma_f32_16x16x32_bf16 v[40:43], v[80:83], v[156:159], v[40:43]
    s_waitcnt vmcnt(14) lgkmcnt(0)
    s_barrier
    v_mfma_f32_16x16x32_bf16 v[44:47], v[84:87], v[168:171], v[44:47]
    ds_read_b128 v[64:67], v12 offset:0
    v_mfma_f32_16x16x32_bf16 v[24:27], v[84:87], v[164:167], v[24:27]
    ds_read_b128 v[68:71], v12 offset:1024
    v_mfma_f32_16x16x32_bf16 v[48:51], v[88:91], v[168:171], v[48:51]
    ds_read_b128 v[72:75], v12 offset:2048
    v_mfma_f32_16x16x32_bf16 v[28:31], v[88:91], v[164:167], v[28:31]
    ds_read_b128 v[76:79], v12 offset:3072
    v_mfma_f32_16x16x32_bf16 v[52:55], v[92:95], v[168:171], v[52:55]
    ds_read_b128 v[80:83], v20 offset:8192
    v_mfma_f32_16x16x32_bf16 v[32:35], v[92:95], v[164:167], v[32:35]
    buffer_load_dwordx4 v[132:135], v16, s[4:7], s32 offen offset:2048 sc1
    v_mfma_f32_16x16x32_bf16 v[56:59], v[96:99], v[168:171], v[56:59]
    v_mfma_f32_16x16x32_bf16 v[36:39], v[96:99], v[164:167], v[36:39]
    buffer_load_dwordx4 v[136:139], v17, s[4:7], s32 offen offset:2048 sc1
    v_mfma_f32_16x16x32_bf16 v[60:63], v[100:103], v[168:171], v[60:63]
    v_mfma_f32_16x16x32_bf16 v[40:43], v[100:103], v[164:167], v[40:43]
    s_waitcnt vmcnt(12) lgkmcnt(10)
    v_mfma_f32_16x16x32_bf16 v[44:47], v[104:107], v[176:179], v[44:47]
    ds_read_b128 v[84:87], v12 offset:9216
    v_mfma_f32_16x16x32_bf16 v[24:27], v[104:107], v[172:175], v[24:27]
    ds_read_b128 v[88:91], v12 offset:10240
    v_mfma_f32_16x16x32_bf16 v[48:51], v[108:111], v[176:179], v[48:51]
    ds_read_b128 v[92:95], v12 offset:11264
    v_mfma_f32_16x16x32_bf16 v[28:31], v[108:111], v[172:175], v[28:31]
    ds_read_b128 v[96:99], v12 offset:12288
    v_mfma_f32_16x16x32_bf16 v[52:55], v[112:115], v[176:179], v[52:55]
    ds_read_b128 v[100:103], v20 offset:17408
    v_mfma_f32_16x16x32_bf16 v[32:35], v[112:115], v[172:175], v[32:35]
    buffer_load_dwordx4 v[140:143], v16, s[4:7], s33 offen offset:0 sc1
    v_mfma_f32_16x16x32_bf16 v[56:59], v[116:119], v[176:179], v[56:59]
    v_mfma_f32_16x16x32_bf16 v[36:39], v[116:119], v[172:175], v[36:39]
    buffer_load_dwordx4 v[144:147], v17, s[4:7], s33 offen offset:0 sc1
    v_mfma_f32_16x16x32_bf16 v[60:63], v[120:123], v[176:179], v[60:63]
    v_mfma_f32_16x16x32_bf16 v[40:43], v[120:123], v[172:175], v[40:43]
    s_waitcnt vmcnt(10) lgkmcnt(10)
    v_mfma_f32_16x16x32_bf16 v[44:47], v[236:239], v[184:187], v[44:47]
    ds_read_b128 v[104:107], v12 offset:18432
    v_mfma_f32_16x16x32_bf16 v[24:27], v[236:239], v[180:183], v[24:27]
    ds_read_b128 v[108:111], v12 offset:19456
    v_mfma_f32_16x16x32_bf16 v[48:51], v[240:243], v[184:187], v[48:51]
    ds_read_b128 v[112:115], v12 offset:20480
    v_mfma_f32_16x16x32_bf16 v[28:31], v[240:243], v[180:183], v[28:31]
    ds_read_b128 v[116:119], v12 offset:21504
    v_mfma_f32_16x16x32_bf16 v[52:55], v[244:247], v[184:187], v[52:55]
    ds_read_b128 v[120:123], v20 offset:26624
    v_mfma_f32_16x16x32_bf16 v[32:35], v[244:247], v[180:183], v[32:35]
    buffer_load_dwordx4 v[148:151], v16, s[4:7], s33 offen offset:2048 sc1
    v_mfma_f32_16x16x32_bf16 v[56:59], v[248:251], v[184:187], v[56:59]
    v_mfma_f32_16x16x32_bf16 v[36:39], v[248:251], v[180:183], v[36:39]
    buffer_load_dwordx4 v[152:155], v17, s[4:7], s33 offen offset:2048 sc1
    v_mfma_f32_16x16x32_bf16 v[60:63], v[252:255], v[184:187], v[60:63]
    v_mfma_f32_16x16x32_bf16 v[40:43], v[252:255], v[180:183], v[40:43]
    s_waitcnt vmcnt(12) lgkmcnt(10)
    v_mfma_f32_16x16x32_bf16 v[44:47], v[64:67], v[192:195], v[44:47]
    ds_read_b128 v[236:239], v12 offset:27648
    s_mov_b32 s32, 4
    s_lshl_b32 s32, s32, 13
    s_add_u32 s32, s32, s29
    s_add_u32 s33, s32, 4096
    v_mfma_f32_16x16x32_bf16 v[24:27], v[64:67], v[188:191], v[24:27]
    ds_read_b128 v[240:243], v12 offset:28672
    v_mfma_f32_16x16x32_bf16 v[48:51], v[68:71], v[192:195], v[48:51]
    ds_read_b128 v[244:247], v12 offset:29696
    v_mfma_f32_16x16x32_bf16 v[28:31], v[68:71], v[188:191], v[28:31]
    ds_read_b128 v[248:251], v12 offset:30720
    v_mfma_f32_16x16x32_bf16 v[52:55], v[72:75], v[192:195], v[52:55]
    ds_read_b128 v[252:255], v20 offset:35840
    v_mfma_f32_16x16x32_bf16 v[32:35], v[72:75], v[188:191], v[32:35]
    buffer_load_dwordx4 v[156:159], v16, s[4:7], s32 offen offset:0 sc1
    v_mfma_f32_16x16x32_bf16 v[56:59], v[76:79], v[192:195], v[56:59]
    v_mfma_f32_16x16x32_bf16 v[36:39], v[76:79], v[188:191], v[36:39]
    buffer_load_dwordx4 v[160:163], v17, s[4:7], s32 offen offset:0 sc1
    v_mfma_f32_16x16x32_bf16 v[60:63], v[80:83], v[192:195], v[60:63]
    v_mfma_f32_16x16x32_bf16 v[40:43], v[80:83], v[188:191], v[40:43]
    s_waitcnt vmcnt(14) lgkmcnt(0)
    s_barrier
    v_mfma_f32_16x16x32_bf16 v[44:47], v[84:87], v[200:203], v[44:47]
    ds_read_b128 v[64:67], v13 offset:0
    v_mfma_f32_16x16x32_bf16 v[24:27], v[84:87], v[196:199], v[24:27]
    ds_read_b128 v[68:71], v13 offset:1024
    v_mfma_f32_16x16x32_bf16 v[48:51], v[88:91], v[200:203], v[48:51]
    ds_read_b128 v[72:75], v13 offset:2048
    v_mfma_f32_16x16x32_bf16 v[28:31], v[88:91], v[196:199], v[28:31]
    ds_read_b128 v[76:79], v13 offset:3072
    v_mfma_f32_16x16x32_bf16 v[52:55], v[92:95], v[200:203], v[52:55]
    ds_read_b128 v[80:83], v21 offset:8192
    v_mfma_f32_16x16x32_bf16 v[32:35], v[92:95], v[196:199], v[32:35]
    buffer_load_dwordx4 v[164:167], v16, s[4:7], s32 offen offset:2048 sc1
    v_mfma_f32_16x16x32_bf16 v[56:59], v[96:99], v[200:203], v[56:59]
    v_mfma_f32_16x16x32_bf16 v[36:39], v[96:99], v[196:199], v[36:39]
    buffer_load_dwordx4 v[168:171], v17, s[4:7], s32 offen offset:2048 sc1
    v_mfma_f32_16x16x32_bf16 v[60:63], v[100:103], v[200:203], v[60:63]
    v_mfma_f32_16x16x32_bf16 v[40:43], v[100:103], v[196:199], v[40:43]
    s_waitcnt vmcnt(14) lgkmcnt(10)
    v_mfma_f32_16x16x32_bf16 v[44:47], v[104:107], v[208:211], v[44:47]
    ds_read_b128 v[84:87], v13 offset:9216
    v_mfma_f32_16x16x32_bf16 v[24:27], v[104:107], v[204:207], v[24:27]
    ds_read_b128 v[88:91], v13 offset:10240
    v_mfma_f32_16x16x32_bf16 v[48:51], v[108:111], v[208:211], v[48:51]
    ds_read_b128 v[92:95], v13 offset:11264
    v_mfma_f32_16x16x32_bf16 v[28:31], v[108:111], v[204:207], v[28:31]
    ds_read_b128 v[96:99], v13 offset:12288
    v_mfma_f32_16x16x32_bf16 v[52:55], v[112:115], v[208:211], v[52:55]
    ds_read_b128 v[100:103], v21 offset:17408
    v_mfma_f32_16x16x32_bf16 v[32:35], v[112:115], v[204:207], v[32:35]
    buffer_load_dwordx4 v[172:175], v16, s[4:7], s33 offen offset:0 sc1
    v_mfma_f32_16x16x32_bf16 v[56:59], v[116:119], v[208:211], v[56:59]
    v_mfma_f32_16x16x32_bf16 v[36:39], v[116:119], v[204:207], v[36:39]
    buffer_load_dwordx4 v[176:179], v17, s[4:7], s33 offen offset:0 sc1
    v_mfma_f32_16x16x32_bf16 v[60:63], v[120:123], v[208:211], v[60:63]
    v_mfma_f32_16x16x32_bf16 v[40:43], v[120:123], v[204:207], v[40:43]
    s_waitcnt vmcnt(14) lgkmcnt(10)
    v_mfma_f32_16x16x32_bf16 v[44:47], v[236:239], v[216:219], v[44:47]
    ds_read_b128 v[104:107], v13 offset:18432
    v_mfma_f32_16x16x32_bf16 v[24:27], v[236:239], v[212:215], v[24:27]
    ds_read_b128 v[108:111], v13 offset:19456
    v_mfma_f32_16x16x32_bf16 v[48:51], v[240:243], v[216:219], v[48:51]
    ds_read_b128 v[112:115], v13 offset:20480
    v_mfma_f32_16x16x32_bf16 v[28:31], v[240:243], v[212:215], v[28:31]
    ds_read_b128 v[116:119], v13 offset:21504
    v_mfma_f32_16x16x32_bf16 v[52:55], v[244:247], v[216:219], v[52:55]
    ds_read_b128 v[120:123], v21 offset:26624
    v_mfma_f32_16x16x32_bf16 v[32:35], v[244:247], v[212:215], v[32:35]
    buffer_load_dwordx4 v[180:183], v16, s[4:7], s33 offen offset:2048 sc1
    v_mfma_f32_16x16x32_bf16 v[56:59], v[248:251], v[216:219], v[56:59]
    v_mfma_f32_16x16x32_bf16 v[36:39], v[248:251], v[212:215], v[36:39]
    buffer_load_dwordx4 v[184:187], v17, s[4:7], s33 offen offset:2048 sc1
    v_mfma_f32_16x16x32_bf16 v[60:63], v[252:255], v[216:219], v[60:63]
    v_mfma_f32_16x16x32_bf16 v[40:43], v[252:255], v[212:215], v[40:43]
    s_waitcnt vmcnt(14) lgkmcnt(10)
    v_mfma_f32_16x16x32_bf16 v[44:47], v[64:67], v[128:131], v[44:47]
    ds_read_b128 v[236:239], v13 offset:27648
    s_mov_b32 s32, 5
    s_lshl_b32 s32, s32, 13
    s_add_u32 s32, s32, s29
    s_add_u32 s33, s32, 4096
    v_mfma_f32_16x16x32_bf16 v[24:27], v[64:67], v[124:127], v[24:27]
    ds_read_b128 v[240:243], v13 offset:28672
    v_mfma_f32_16x16x32_bf16 v[48:51], v[68:71], v[128:131], v[48:51]
    ds_read_b128 v[244:247], v13 offset:29696
    v_mfma_f32_16x16x32_bf16 v[28:31], v[68:71], v[124:127], v[28:31]
    ds_read_b128 v[248:251], v13 offset:30720
    v_mfma_f32_16x16x32_bf16 v[52:55], v[72:75], v[128:131], v[52:55]
    ds_read_b128 v[252:255], v21 offset:35840
    v_mfma_f32_16x16x32_bf16 v[32:35], v[72:75], v[124:127], v[32:35]
    buffer_load_dwordx4 v[188:191], v16, s[4:7], s32 offen offset:0 sc1
    v_mfma_f32_16x16x32_bf16 v[56:59], v[76:79], v[128:131], v[56:59]
    v_mfma_f32_16x16x32_bf16 v[36:39], v[76:79], v[124:127], v[36:39]
    buffer_load_dwordx4 v[192:195], v17, s[4:7], s32 offen offset:0 sc1
    v_mfma_f32_16x16x32_bf16 v[60:63], v[80:83], v[128:131], v[60:63]
    v_mfma_f32_16x16x32_bf16 v[40:43], v[80:83], v[124:127], v[40:43]
    s_waitcnt vmcnt(14) lgkmcnt(0)
    s_barrier
    v_mfma_f32_16x16x32_bf16 v[44:47], v[84:87], v[136:139], v[44:47]
    ds_read_b128 v[64:67], v14 offset:0
    v_mfma_f32_16x16x32_bf16 v[24:27], v[84:87], v[132:135], v[24:27]
    ds_read_b128 v[68:71], v14 offset:1024
    v_mfma_f32_16x16x32_bf16 v[48:51], v[88:91], v[136:139], v[48:51]
    ds_read_b128 v[72:75], v14 offset:2048
    v_mfma_f32_16x16x32_bf16 v[28:31], v[88:91], v[132:135], v[28:31]
    ds_read_b128 v[76:79], v14 offset:3072
    v_mfma_f32_16x16x32_bf16 v[52:55], v[92:95], v[136:139], v[52:55]
    ds_read_b128 v[80:83], v23 offset:36864
    v_mfma_f32_16x16x32_bf16 v[32:35], v[92:95], v[132:135], v[32:35]
    buffer_load_dwordx4 v[196:199], v16, s[4:7], s32 offen offset:2048 sc1
    v_mfma_f32_16x16x32_bf16 v[56:59], v[96:99], v[136:139], v[56:59]
    v_mfma_f32_16x16x32_bf16 v[36:39], v[96:99], v[132:135], v[36:39]
    buffer_load_dwordx4 v[200:203], v17, s[4:7], s32 offen offset:2048 sc1
    v_mfma_f32_16x16x32_bf16 v[60:63], v[100:103], v[136:139], v[60:63]
    v_mfma_f32_16x16x32_bf16 v[40:43], v[100:103], v[132:135], v[40:43]
    s_waitcnt vmcnt(14) lgkmcnt(10)
    v_mfma_f32_16x16x32_bf16 v[44:47], v[104:107], v[144:147], v[44:47]
    ds_read_b128 v[84:87], v14 offset:9216
    v_mfma_f32_16x16x32_bf16 v[24:27], v[104:107], v[140:143], v[24:27]
    ds_read_b128 v[88:91], v14 offset:10240
    v_mfma_f32_16x16x32_bf16 v[48:51], v[108:111], v[144:147], v[48:51]
    ds_read_b128 v[92:95], v14 offset:11264
    v_mfma_f32_16x16x32_bf16 v[28:31], v[108:111], v[140:143], v[28:31]
    ds_read_b128 v[96:99], v14 offset:12288
    v_mfma_f32_16x16x32_bf16 v[52:55], v[112:115], v[144:147], v[52:55]
    ds_read_b128 v[100:103], v23 offset:37888
    v_mfma_f32_16x16x32_bf16 v[32:35], v[112:115], v[140:143], v[32:35]
    buffer_load_dwordx4 v[204:207], v16, s[4:7], s33 offen offset:0 sc1
    v_mfma_f32_16x16x32_bf16 v[56:59], v[116:119], v[144:147], v[56:59]
    v_mfma_f32_16x16x32_bf16 v[36:39], v[116:119], v[140:143], v[36:39]
    buffer_load_dwordx4 v[208:211], v17, s[4:7], s33 offen offset:0 sc1
    v_mfma_f32_16x16x32_bf16 v[60:63], v[120:123], v[144:147], v[60:63]
    v_mfma_f32_16x16x32_bf16 v[40:43], v[120:123], v[140:143], v[40:43]
    s_waitcnt vmcnt(14) lgkmcnt(10)
    v_mfma_f32_16x16x32_bf16 v[44:47], v[236:239], v[152:155], v[44:47]
    ds_read_b128 v[104:107], v14 offset:18432
    v_mfma_f32_16x16x32_bf16 v[24:27], v[236:239], v[148:151], v[24:27]
    ds_read_b128 v[108:111], v14 offset:19456
    v_mfma_f32_16x16x32_bf16 v[48:51], v[240:243], v[152:155], v[48:51]
    ds_read_b128 v[112:115], v14 offset:20480
    v_mfma_f32_16x16x32_bf16 v[28:31], v[240:243], v[148:151], v[28:31]
    ds_read_b128 v[116:119], v14 offset:21504
    v_mfma_f32_16x16x32_bf16 v[52:55], v[244:247], v[152:155], v[52:55]
    ds_read_b128 v[120:123], v23 offset:38912
    v_mfma_f32_16x16x32_bf16 v[32:35], v[244:247], v[148:151], v[32:35]
    buffer_load_dwordx4 v[212:215], v16, s[4:7], s33 offen offset:2048 sc1
    v_mfma_f32_16x16x32_bf16 v[56:59], v[248:251], v[152:155], v[56:59]
    v_mfma_f32_16x16x32_bf16 v[36:39], v[248:251], v[148:151], v[36:39]
    buffer_load_dwordx4 v[216:219], v17, s[4:7], s33 offen offset:2048 sc1
    v_mfma_f32_16x16x32_bf16 v[60:63], v[252:255], v[152:155], v[60:63]
    v_mfma_f32_16x16x32_bf16 v[40:43], v[252:255], v[148:151], v[40:43]
    s_waitcnt vmcnt(14) lgkmcnt(10)
    v_mfma_f32_16x16x32_bf16 v[44:47], v[64:67], v[160:163], v[44:47]
    ds_read_b128 v[236:239], v14 offset:27648
    s_mov_b32 s32, 6
    s_lshl_b32 s32, s32, 13
    s_add_u32 s32, s32, s29
    s_add_u32 s33, s32, 4096
    v_mfma_f32_16x16x32_bf16 v[24:27], v[64:67], v[156:159], v[24:27]
    ds_read_b128 v[240:243], v14 offset:28672
    v_mfma_f32_16x16x32_bf16 v[48:51], v[68:71], v[160:163], v[48:51]
    ds_read_b128 v[244:247], v14 offset:29696
    v_mfma_f32_16x16x32_bf16 v[28:31], v[68:71], v[156:159], v[28:31]
    ds_read_b128 v[248:251], v14 offset:30720
    v_mfma_f32_16x16x32_bf16 v[52:55], v[72:75], v[160:163], v[52:55]
    ds_read_b128 v[252:255], v23 offset:39936
    v_mfma_f32_16x16x32_bf16 v[32:35], v[72:75], v[156:159], v[32:35]
    buffer_load_dwordx4 v[124:127], v16, s[4:7], s32 offen offset:0 sc1
    v_mfma_f32_16x16x32_bf16 v[56:59], v[76:79], v[160:163], v[56:59]
    v_mfma_f32_16x16x32_bf16 v[36:39], v[76:79], v[156:159], v[36:39]
    buffer_load_dwordx4 v[128:131], v17, s[4:7], s32 offen offset:0 sc1
    v_mfma_f32_16x16x32_bf16 v[60:63], v[80:83], v[160:163], v[60:63]
    v_mfma_f32_16x16x32_bf16 v[40:43], v[80:83], v[156:159], v[40:43]
    s_waitcnt vmcnt(14) lgkmcnt(0)
    s_barrier
    v_mfma_f32_16x16x32_bf16 v[44:47], v[84:87], v[168:171], v[44:47]
    ds_read_b128 v[64:67], v15 offset:0
    v_mfma_f32_16x16x32_bf16 v[24:27], v[84:87], v[164:167], v[24:27]
    ds_read_b128 v[68:71], v15 offset:1024
    v_mfma_f32_16x16x32_bf16 v[48:51], v[88:91], v[168:171], v[48:51]
    ds_read_b128 v[72:75], v15 offset:2048
    v_mfma_f32_16x16x32_bf16 v[28:31], v[88:91], v[164:167], v[28:31]
    ds_read_b128 v[76:79], v15 offset:3072
    v_mfma_f32_16x16x32_bf16 v[52:55], v[92:95], v[168:171], v[52:55]
    ds_read_b128 v[80:83], v23 offset:40960
    v_mfma_f32_16x16x32_bf16 v[32:35], v[92:95], v[164:167], v[32:35]
    buffer_load_dwordx4 v[132:135], v16, s[4:7], s32 offen offset:2048 sc1
    v_mfma_f32_16x16x32_bf16 v[56:59], v[96:99], v[168:171], v[56:59]
    v_mfma_f32_16x16x32_bf16 v[36:39], v[96:99], v[164:167], v[36:39]
    buffer_load_dwordx4 v[136:139], v17, s[4:7], s32 offen offset:2048 sc1
    v_mfma_f32_16x16x32_bf16 v[60:63], v[100:103], v[168:171], v[60:63]
    v_mfma_f32_16x16x32_bf16 v[40:43], v[100:103], v[164:167], v[40:43]
    s_waitcnt vmcnt(14) lgkmcnt(10)
    v_mfma_f32_16x16x32_bf16 v[44:47], v[104:107], v[176:179], v[44:47]
    ds_read_b128 v[84:87], v15 offset:9216
    v_mfma_f32_16x16x32_bf16 v[24:27], v[104:107], v[172:175], v[24:27]
    ds_read_b128 v[88:91], v15 offset:10240
    v_mfma_f32_16x16x32_bf16 v[48:51], v[108:111], v[176:179], v[48:51]
    ds_read_b128 v[92:95], v15 offset:11264
    v_mfma_f32_16x16x32_bf16 v[28:31], v[108:111], v[172:175], v[28:31]
    ds_read_b128 v[96:99], v15 offset:12288
    v_mfma_f32_16x16x32_bf16 v[52:55], v[112:115], v[176:179], v[52:55]
    ds_read_b128 v[100:103], v23 offset:41984
    v_mfma_f32_16x16x32_bf16 v[32:35], v[112:115], v[172:175], v[32:35]
    buffer_load_dwordx4 v[140:143], v16, s[4:7], s33 offen offset:0 sc1
    v_mfma_f32_16x16x32_bf16 v[56:59], v[116:119], v[176:179], v[56:59]
    v_mfma_f32_16x16x32_bf16 v[36:39], v[116:119], v[172:175], v[36:39]
    buffer_load_dwordx4 v[144:147], v17, s[4:7], s33 offen offset:0 sc1
    v_mfma_f32_16x16x32_bf16 v[60:63], v[120:123], v[176:179], v[60:63]
    v_mfma_f32_16x16x32_bf16 v[40:43], v[120:123], v[172:175], v[40:43]
    s_waitcnt vmcnt(14) lgkmcnt(10)
    v_mfma_f32_16x16x32_bf16 v[44:47], v[236:239], v[184:187], v[44:47]
    ds_read_b128 v[104:107], v15 offset:18432
    v_mfma_f32_16x16x32_bf16 v[24:27], v[236:239], v[180:183], v[24:27]
    ds_read_b128 v[108:111], v15 offset:19456
    v_mfma_f32_16x16x32_bf16 v[48:51], v[240:243], v[184:187], v[48:51]
    ds_read_b128 v[112:115], v15 offset:20480
    v_mfma_f32_16x16x32_bf16 v[28:31], v[240:243], v[180:183], v[28:31]
    ds_read_b128 v[116:119], v15 offset:21504
    v_mfma_f32_16x16x32_bf16 v[52:55], v[244:247], v[184:187], v[52:55]
    ds_read_b128 v[120:123], v23 offset:43008
    v_mfma_f32_16x16x32_bf16 v[32:35], v[244:247], v[180:183], v[32:35]
    buffer_load_dwordx4 v[148:151], v16, s[4:7], s33 offen offset:2048 sc1
    v_mfma_f32_16x16x32_bf16 v[56:59], v[248:251], v[184:187], v[56:59]
    v_mfma_f32_16x16x32_bf16 v[36:39], v[248:251], v[180:183], v[36:39]
    buffer_load_dwordx4 v[152:155], v17, s[4:7], s33 offen offset:2048 sc1
    v_mfma_f32_16x16x32_bf16 v[60:63], v[252:255], v[184:187], v[60:63]
    v_mfma_f32_16x16x32_bf16 v[40:43], v[252:255], v[180:183], v[40:43]
    s_waitcnt vmcnt(14) lgkmcnt(10)
    v_mfma_f32_16x16x32_bf16 v[44:47], v[64:67], v[192:195], v[44:47]
    ds_read_b128 v[236:239], v15 offset:27648
    s_mov_b32 s32, 7
    s_lshl_b32 s32, s32, 13
    s_add_u32 s32, s32, s29
    s_add_u32 s33, s32, 4096
    v_mfma_f32_16x16x32_bf16 v[24:27], v[64:67], v[188:191], v[24:27]
    ds_read_b128 v[240:243], v15 offset:28672
    v_mfma_f32_16x16x32_bf16 v[48:51], v[68:71], v[192:195], v[48:51]
    ds_read_b128 v[244:247], v15 offset:29696
    v_mfma_f32_16x16x32_bf16 v[28:31], v[68:71], v[188:191], v[28:31]
    ds_read_b128 v[248:251], v15 offset:30720
    v_mfma_f32_16x16x32_bf16 v[52:55], v[72:75], v[192:195], v[52:55]
    ds_read_b128 v[252:255], v23 offset:44032
    v_mfma_f32_16x16x32_bf16 v[32:35], v[72:75], v[188:191], v[32:35]
    buffer_load_dwordx4 v[156:159], v16, s[4:7], s32 offen offset:0 sc1
    v_mfma_f32_16x16x32_bf16 v[56:59], v[76:79], v[192:195], v[56:59]
    v_mfma_f32_16x16x32_bf16 v[36:39], v[76:79], v[188:191], v[36:39]
    buffer_load_dwordx4 v[160:163], v17, s[4:7], s32 offen offset:0 sc1
    v_mfma_f32_16x16x32_bf16 v[60:63], v[80:83], v[192:195], v[60:63]
    v_mfma_f32_16x16x32_bf16 v[40:43], v[80:83], v[188:191], v[40:43]
    s_waitcnt vmcnt(14) lgkmcnt(0)
    s_barrier
    v_mfma_f32_16x16x32_bf16 v[44:47], v[84:87], v[200:203], v[44:47]
    ds_read_b128 v[64:67], v12 offset:0
    v_mfma_f32_16x16x32_bf16 v[24:27], v[84:87], v[196:199], v[24:27]
    ds_read_b128 v[68:71], v12 offset:1024
    v_mfma_f32_16x16x32_bf16 v[48:51], v[88:91], v[200:203], v[48:51]
    ds_read_b128 v[72:75], v12 offset:2048
    v_mfma_f32_16x16x32_bf16 v[28:31], v[88:91], v[196:199], v[28:31]
    ds_read_b128 v[76:79], v12 offset:3072
    v_mfma_f32_16x16x32_bf16 v[52:55], v[92:95], v[200:203], v[52:55]
    ds_read_b128 v[80:83], v23 offset:45056
    v_mfma_f32_16x16x32_bf16 v[32:35], v[92:95], v[196:199], v[32:35]
    buffer_load_dwordx4 v[164:167], v16, s[4:7], s32 offen offset:2048 sc1
    v_mfma_f32_16x16x32_bf16 v[56:59], v[96:99], v[200:203], v[56:59]
    v_mfma_f32_16x16x32_bf16 v[36:39], v[96:99], v[196:199], v[36:39]
    buffer_load_dwordx4 v[168:171], v17, s[4:7], s32 offen offset:2048 sc1
    v_mfma_f32_16x16x32_bf16 v[60:63], v[100:103], v[200:203], v[60:63]
    v_mfma_f32_16x16x32_bf16 v[40:43], v[100:103], v[196:199], v[40:43]
    s_waitcnt vmcnt(14) lgkmcnt(10)
    v_mfma_f32_16x16x32_bf16 v[44:47], v[104:107], v[208:211], v[44:47]
    ds_read_b128 v[84:87], v12 offset:9216
    v_mfma_f32_16x16x32_bf16 v[24:27], v[104:107], v[204:207], v[24:27]
    ds_read_b128 v[88:91], v12 offset:10240
    v_mfma_f32_16x16x32_bf16 v[48:51], v[108:111], v[208:211], v[48:51]
    ds_read_b128 v[92:95], v12 offset:11264
    v_mfma_f32_16x16x32_bf16 v[28:31], v[108:111], v[204:207], v[28:31]
    ds_read_b128 v[96:99], v12 offset:12288
    v_mfma_f32_16x16x32_bf16 v[52:55], v[112:115], v[208:211], v[52:55]
    ds_read_b128 v[100:103], v23 offset:46080
    v_mfma_f32_16x16x32_bf16 v[32:35], v[112:115], v[204:207], v[32:35]
    buffer_load_dwordx4 v[172:175], v16, s[4:7], s33 offen offset:0 sc1
    v_mfma_f32_16x16x32_bf16 v[56:59], v[116:119], v[208:211], v[56:59]
    v_mfma_f32_16x16x32_bf16 v[36:39], v[116:119], v[204:207], v[36:39]
    buffer_load_dwordx4 v[176:179], v17, s[4:7], s33 offen offset:0 sc1
    v_mfma_f32_16x16x32_bf16 v[60:63], v[120:123], v[208:211], v[60:63]
    v_mfma_f32_16x16x32_bf16 v[40:43], v[120:123], v[204:207], v[40:43]
    s_waitcnt vmcnt(14) lgkmcnt(10)
    v_mfma_f32_16x16x32_bf16 v[44:47], v[236:239], v[216:219], v[44:47]
    ds_read_b128 v[104:107], v12 offset:18432
    v_mfma_f32_16x16x32_bf16 v[24:27], v[236:239], v[212:215], v[24:27]
    ds_read_b128 v[108:111], v12 offset:19456
    v_mfma_f32_16x16x32_bf16 v[48:51], v[240:243], v[216:219], v[48:51]
    ds_read_b128 v[112:115], v12 offset:20480
    v_mfma_f32_16x16x32_bf16 v[28:31], v[240:243], v[212:215], v[28:31]
    ds_read_b128 v[116:119], v12 offset:21504
    v_mfma_f32_16x16x32_bf16 v[52:55], v[244:247], v[216:219], v[52:55]
    ds_read_b128 v[120:123], v23 offset:47104
    v_mfma_f32_16x16x32_bf16 v[32:35], v[244:247], v[212:215], v[32:35]
    buffer_load_dwordx4 v[180:183], v16, s[4:7], s33 offen offset:2048 sc1
    v_mfma_f32_16x16x32_bf16 v[56:59], v[248:251], v[216:219], v[56:59]
    v_mfma_f32_16x16x32_bf16 v[36:39], v[248:251], v[212:215], v[36:39]
    buffer_load_dwordx4 v[184:187], v17, s[4:7], s33 offen offset:2048 sc1
    v_mfma_f32_16x16x32_bf16 v[60:63], v[252:255], v[216:219], v[60:63]
    v_mfma_f32_16x16x32_bf16 v[40:43], v[252:255], v[212:215], v[40:43]
    s_waitcnt vmcnt(14) lgkmcnt(10)
    v_mfma_f32_16x16x32_bf16 v[44:47], v[64:67], v[128:131], v[44:47]
    ds_read_b128 v[236:239], v12 offset:27648
    s_mov_b32 s32, 8
    s_lshl_b32 s32, s32, 13
    s_add_u32 s32, s32, s29
    s_add_u32 s33, s32, 4096
    v_mfma_f32_16x16x32_bf16 v[24:27], v[64:67], v[124:127], v[24:27]
    ds_read_b128 v[240:243], v12 offset:28672
    v_mfma_f32_16x16x32_bf16 v[48:51], v[68:71], v[128:131], v[48:51]
    ds_read_b128 v[244:247], v12 offset:29696
    v_mfma_f32_16x16x32_bf16 v[28:31], v[68:71], v[124:127], v[28:31]
    ds_read_b128 v[248:251], v12 offset:30720
    v_mfma_f32_16x16x32_bf16 v[52:55], v[72:75], v[128:131], v[52:55]
    ds_read_b128 v[252:255], v23 offset:48128
    v_mfma_f32_16x16x32_bf16 v[32:35], v[72:75], v[124:127], v[32:35]
    buffer_load_dwordx4 v[188:191], v18, s[4:7], s32 offen offset:0 sc1
    v_mfma_f32_16x16x32_bf16 v[56:59], v[76:79], v[128:131], v[56:59]
    v_mfma_f32_16x16x32_bf16 v[36:39], v[76:79], v[124:127], v[36:39]
    buffer_load_dwordx4 v[192:195], v19, s[4:7], s32 offen offset:0 sc1
    v_mfma_f32_16x16x32_bf16 v[60:63], v[80:83], v[128:131], v[60:63]
    v_mfma_f32_16x16x32_bf16 v[40:43], v[80:83], v[124:127], v[40:43]
    s_waitcnt vmcnt(14) lgkmcnt(0)
    s_barrier
    v_mfma_f32_16x16x32_bf16 v[44:47], v[84:87], v[136:139], v[44:47]
    ds_read_b128 v[64:67], v13 offset:0
    v_mfma_f32_16x16x32_bf16 v[24:27], v[84:87], v[132:135], v[24:27]
    ds_read_b128 v[68:71], v13 offset:1024
    v_mfma_f32_16x16x32_bf16 v[48:51], v[88:91], v[136:139], v[48:51]
    ds_read_b128 v[72:75], v13 offset:2048
    v_mfma_f32_16x16x32_bf16 v[28:31], v[88:91], v[132:135], v[28:31]
    ds_read_b128 v[76:79], v13 offset:3072
    v_mfma_f32_16x16x32_bf16 v[52:55], v[92:95], v[136:139], v[52:55]
    ds_read_b128 v[80:83], v21 offset:8192
    v_mfma_f32_16x16x32_bf16 v[32:35], v[92:95], v[132:135], v[32:35]
    buffer_load_dwordx4 v[196:199], v18, s[4:7], s32 offen offset:2048 sc1
    v_mfma_f32_16x16x32_bf16 v[56:59], v[96:99], v[136:139], v[56:59]
    v_mfma_f32_16x16x32_bf16 v[36:39], v[96:99], v[132:135], v[36:39]
    buffer_load_dwordx4 v[200:203], v19, s[4:7], s32 offen offset:2048 sc1
    v_mfma_f32_16x16x32_bf16 v[60:63], v[100:103], v[136:139], v[60:63]
    v_mfma_f32_16x16x32_bf16 v[40:43], v[100:103], v[132:135], v[40:43]
    s_waitcnt vmcnt(14) lgkmcnt(10)
    v_mfma_f32_16x16x32_bf16 v[44:47], v[104:107], v[144:147], v[44:47]
    ds_read_b128 v[84:87], v13 offset:9216
    v_mfma_f32_16x16x32_bf16 v[24:27], v[104:107], v[140:143], v[24:27]
    ds_read_b128 v[88:91], v13 offset:10240
    v_mfma_f32_16x16x32_bf16 v[48:51], v[108:111], v[144:147], v[48:51]
    ds_read_b128 v[92:95], v13 offset:11264
    v_mfma_f32_16x16x32_bf16 v[28:31], v[108:111], v[140:143], v[28:31]
    ds_read_b128 v[96:99], v13 offset:12288
    v_mfma_f32_16x16x32_bf16 v[52:55], v[112:115], v[144:147], v[52:55]
    ds_read_b128 v[100:103], v21 offset:17408
    v_mfma_f32_16x16x32_bf16 v[32:35], v[112:115], v[140:143], v[32:35]
    buffer_load_dwordx4 v[204:207], v18, s[4:7], s33 offen offset:0 sc1
    v_mfma_f32_16x16x32_bf16 v[56:59], v[116:119], v[144:147], v[56:59]
    v_mfma_f32_16x16x32_bf16 v[36:39], v[116:119], v[140:143], v[36:39]
    buffer_load_dwordx4 v[208:211], v19, s[4:7], s33 offen offset:0 sc1
    v_mfma_f32_16x16x32_bf16 v[60:63], v[120:123], v[144:147], v[60:63]
    v_mfma_f32_16x16x32_bf16 v[40:43], v[120:123], v[140:143], v[40:43]
    s_waitcnt vmcnt(14) lgkmcnt(10)
    v_mfma_f32_16x16x32_bf16 v[44:47], v[236:239], v[152:155], v[44:47]
    ds_read_b128 v[104:107], v13 offset:18432
    v_mfma_f32_16x16x32_bf16 v[24:27], v[236:239], v[148:151], v[24:27]
    ds_read_b128 v[108:111], v13 offset:19456
    v_mfma_f32_16x16x32_bf16 v[48:51], v[240:243], v[152:155], v[48:51]
    ds_read_b128 v[112:115], v13 offset:20480
    v_mfma_f32_16x16x32_bf16 v[28:31], v[240:243], v[148:151], v[28:31]
    ds_read_b128 v[116:119], v13 offset:21504
    v_mfma_f32_16x16x32_bf16 v[52:55], v[244:247], v[152:155], v[52:55]
    ds_read_b128 v[120:123], v21 offset:26624
    v_mfma_f32_16x16x32_bf16 v[32:35], v[244:247], v[148:151], v[32:35]
    buffer_load_dwordx4 v[212:215], v18, s[4:7], s33 offen offset:2048 sc1
    v_mfma_f32_16x16x32_bf16 v[56:59], v[248:251], v[152:155], v[56:59]
    v_mfma_f32_16x16x32_bf16 v[36:39], v[248:251], v[148:151], v[36:39]
    buffer_load_dwordx4 v[216:219], v19, s[4:7], s33 offen offset:2048 sc1
    v_mfma_f32_16x16x32_bf16 v[60:63], v[252:255], v[152:155], v[60:63]
    v_mfma_f32_16x16x32_bf16 v[40:43], v[252:255], v[148:151], v[40:43]
    s_waitcnt vmcnt(14) lgkmcnt(10)
    v_mfma_f32_16x16x32_bf16 v[44:47], v[64:67], v[160:163], v[44:47]
    ds_read_b128 v[236:239], v13 offset:27648
    v_mfma_f32_16x16x32_bf16 v[24:27], v[64:67], v[156:159], v[24:27]
    ds_read_b128 v[240:243], v13 offset:28672
    v_mfma_f32_16x16x32_bf16 v[48:51], v[68:71], v[160:163], v[48:51]
    ds_read_b128 v[244:247], v13 offset:29696
    v_mfma_f32_16x16x32_bf16 v[28:31], v[68:71], v[156:159], v[28:31]
    ds_read_b128 v[248:251], v13 offset:30720
    v_mfma_f32_16x16x32_bf16 v[52:55], v[72:75], v[160:163], v[52:55]
    ds_read_b128 v[252:255], v21 offset:35840
    v_mfma_f32_16x16x32_bf16 v[32:35], v[72:75], v[156:159], v[32:35]
    v_mfma_f32_16x16x32_bf16 v[56:59], v[76:79], v[160:163], v[56:59]
    v_mfma_f32_16x16x32_bf16 v[36:39], v[76:79], v[156:159], v[36:39]
    v_mfma_f32_16x16x32_bf16 v[60:63], v[80:83], v[160:163], v[60:63]
    v_mfma_f32_16x16x32_bf16 v[40:43], v[80:83], v[156:159], v[40:43]
    s_waitcnt vmcnt(12) lgkmcnt(0)
    s_barrier
    v_mfma_f32_16x16x32_bf16 v[44:47], v[84:87], v[168:171], v[44:47]
    ds_read_b128 v[64:67], v14 offset:0
    v_mfma_f32_16x16x32_bf16 v[24:27], v[84:87], v[164:167], v[24:27]
    ds_read_b128 v[68:71], v14 offset:1024
    v_mfma_f32_16x16x32_bf16 v[48:51], v[88:91], v[168:171], v[48:51]
    ds_read_b128 v[72:75], v14 offset:2048
    v_mfma_f32_16x16x32_bf16 v[28:31], v[88:91], v[164:167], v[28:31]
    ds_read_b128 v[76:79], v14 offset:3072
    v_mfma_f32_16x16x32_bf16 v[52:55], v[92:95], v[168:171], v[52:55]
    ds_read_b128 v[80:83], v22 offset:8192
    v_mfma_f32_16x16x32_bf16 v[32:35], v[92:95], v[164:167], v[32:35]
    v_mfma_f32_16x16x32_bf16 v[56:59], v[96:99], v[168:171], v[56:59]
    v_mfma_f32_16x16x32_bf16 v[36:39], v[96:99], v[164:167], v[36:39]
    v_mfma_f32_16x16x32_bf16 v[60:63], v[100:103], v[168:171], v[60:63]
    v_mfma_f32_16x16x32_bf16 v[40:43], v[100:103], v[164:167], v[40:43]
    s_waitcnt vmcnt(10) lgkmcnt(10)
    v_mfma_f32_16x16x32_bf16 v[44:47], v[104:107], v[176:179], v[44:47]
    ds_read_b128 v[84:87], v14 offset:9216
    v_mfma_f32_16x16x32_bf16 v[24:27], v[104:107], v[172:175], v[24:27]
    ds_read_b128 v[88:91], v14 offset:10240
    v_mfma_f32_16x16x32_bf16 v[48:51], v[108:111], v[176:179], v[48:51]
    ds_read_b128 v[92:95], v14 offset:11264
    v_mfma_f32_16x16x32_bf16 v[28:31], v[108:111], v[172:175], v[28:31]
    ds_read_b128 v[96:99], v14 offset:12288
    v_mfma_f32_16x16x32_bf16 v[52:55], v[112:115], v[176:179], v[52:55]
    ds_read_b128 v[100:103], v22 offset:17408
    v_mfma_f32_16x16x32_bf16 v[32:35], v[112:115], v[172:175], v[32:35]
    v_mfma_f32_16x16x32_bf16 v[56:59], v[116:119], v[176:179], v[56:59]
    v_mfma_f32_16x16x32_bf16 v[36:39], v[116:119], v[172:175], v[36:39]
    v_mfma_f32_16x16x32_bf16 v[60:63], v[120:123], v[176:179], v[60:63]
    v_mfma_f32_16x16x32_bf16 v[40:43], v[120:123], v[172:175], v[40:43]
    s_waitcnt vmcnt(8) lgkmcnt(10)
    v_mfma_f32_16x16x32_bf16 v[44:47], v[236:239], v[184:187], v[44:47]
    ds_read_b128 v[104:107], v14 offset:18432
    v_mfma_f32_16x16x32_bf16 v[24:27], v[236:239], v[180:183], v[24:27]
    ds_read_b128 v[108:111], v14 offset:19456
    v_mfma_f32_16x16x32_bf16 v[48:51], v[240:243], v[184:187], v[48:51]
    ds_read_b128 v[112:115], v14 offset:20480
    v_mfma_f32_16x16x32_bf16 v[28:31], v[240:243], v[180:183], v[28:31]
    ds_read_b128 v[116:119], v14 offset:21504
    v_mfma_f32_16x16x32_bf16 v[52:55], v[244:247], v[184:187], v[52:55]
    ds_read_b128 v[120:123], v22 offset:26624
    v_mfma_f32_16x16x32_bf16 v[32:35], v[244:247], v[180:183], v[32:35]
    s_waitcnt vmcnt(6)
    v_mfma_f32_16x16x32_bf16 v[56:59], v[248:251], v[184:187], v[56:59]
    v_swap_b32 v190, v192
    v_mfma_f32_16x16x32_bf16 v[36:39], v[248:251], v[180:183], v[36:39]
    v_swap_b32 v191, v193
    v_mfma_f32_16x16x32_bf16 v[60:63], v[252:255], v[184:187], v[60:63]
    v_mfma_f32_16x16x32_bf16 v[40:43], v[252:255], v[180:183], v[40:43]
    s_waitcnt vmcnt(6) lgkmcnt(10)
    v_mfma_f32_16x16x32_bf16 v[44:47], v[64:67], v[192:195], v[44:47]
    ds_read_b128 v[236:239], v14 offset:27648
    v_mfma_f32_16x16x32_bf16 v[24:27], v[64:67], v[188:191], v[24:27]
    ds_read_b128 v[240:243], v14 offset:28672
    v_mfma_f32_16x16x32_bf16 v[48:51], v[68:71], v[192:195], v[48:51]
    ds_read_b128 v[244:247], v14 offset:29696
    v_mfma_f32_16x16x32_bf16 v[28:31], v[68:71], v[188:191], v[28:31]
    ds_read_b128 v[248:251], v14 offset:30720
    v_mfma_f32_16x16x32_bf16 v[52:55], v[72:75], v[192:195], v[52:55]
    ds_read_b128 v[252:255], v22 offset:35840
    v_mfma_f32_16x16x32_bf16 v[32:35], v[72:75], v[188:191], v[32:35]
    s_waitcnt vmcnt(4)
    v_mfma_f32_16x16x32_bf16 v[56:59], v[76:79], v[192:195], v[56:59]
    v_swap_b32 v198, v200
    v_mfma_f32_16x16x32_bf16 v[36:39], v[76:79], v[188:191], v[36:39]
    v_swap_b32 v199, v201
    v_mfma_f32_16x16x32_bf16 v[60:63], v[80:83], v[192:195], v[60:63]
    v_mfma_f32_16x16x32_bf16 v[40:43], v[80:83], v[188:191], v[40:43]
    s_waitcnt vmcnt(4) lgkmcnt(10)
    v_mfma_f32_16x16x32_bf16 v[44:47], v[84:87], v[200:203], v[44:47]
    v_mfma_f32_16x16x32_bf16 v[24:27], v[84:87], v[196:199], v[24:27]
    v_mfma_f32_16x16x32_bf16 v[48:51], v[88:91], v[200:203], v[48:51]
    v_mfma_f32_16x16x32_bf16 v[28:31], v[88:91], v[196:199], v[28:31]
    v_mfma_f32_16x16x32_bf16 v[52:55], v[92:95], v[200:203], v[52:55]
    v_mfma_f32_16x16x32_bf16 v[32:35], v[92:95], v[196:199], v[32:35]
    s_waitcnt vmcnt(2)
    v_mfma_f32_16x16x32_bf16 v[56:59], v[96:99], v[200:203], v[56:59]
    v_swap_b32 v206, v208
    v_mfma_f32_16x16x32_bf16 v[36:39], v[96:99], v[196:199], v[36:39]
    v_swap_b32 v207, v209
    v_mfma_f32_16x16x32_bf16 v[60:63], v[100:103], v[200:203], v[60:63]
    v_mfma_f32_16x16x32_bf16 v[40:43], v[100:103], v[196:199], v[40:43]
    s_waitcnt vmcnt(2) lgkmcnt(5)
    v_mfma_f32_16x16x32_bf16 v[44:47], v[104:107], v[208:211], v[44:47]
    v_mfma_f32_16x16x32_bf16 v[24:27], v[104:107], v[204:207], v[24:27]
    v_mfma_f32_16x16x32_bf16 v[48:51], v[108:111], v[208:211], v[48:51]
    v_mfma_f32_16x16x32_bf16 v[28:31], v[108:111], v[204:207], v[28:31]
    v_mfma_f32_16x16x32_bf16 v[52:55], v[112:115], v[208:211], v[52:55]
    v_mfma_f32_16x16x32_bf16 v[32:35], v[112:115], v[204:207], v[32:35]
    s_waitcnt vmcnt(0)
    v_mfma_f32_16x16x32_bf16 v[56:59], v[116:119], v[208:211], v[56:59]
    v_swap_b32 v214, v216
    v_mfma_f32_16x16x32_bf16 v[36:39], v[116:119], v[204:207], v[36:39]
    v_swap_b32 v215, v217
    v_mfma_f32_16x16x32_bf16 v[60:63], v[120:123], v[208:211], v[60:63]
    v_mfma_f32_16x16x32_bf16 v[40:43], v[120:123], v[204:207], v[40:43]
    s_waitcnt vmcnt(0) lgkmcnt(0)
    v_mfma_f32_16x16x32_bf16 v[44:47], v[236:239], v[216:219], v[44:47]
    v_mfma_f32_16x16x32_bf16 v[48:51], v[240:243], v[216:219], v[48:51]
    v_mfma_f32_16x16x32_bf16 v[52:55], v[244:247], v[216:219], v[52:55]
    v_mfma_f32_16x16x32_bf16 v[56:59], v[248:251], v[216:219], v[56:59]
    v_mfma_f32_16x16x32_bf16 v[60:63], v[252:255], v[216:219], v[60:63]
    v_mfma_f32_16x16x32_bf16 v[24:27], v[236:239], v[212:215], v[24:27]
    v_mfma_f32_16x16x32_bf16 v[28:31], v[240:243], v[212:215], v[28:31]
    v_mfma_f32_16x16x32_bf16 v[32:35], v[244:247], v[212:215], v[32:35]
    v_mfma_f32_16x16x32_bf16 v[36:39], v[248:251], v[212:215], v[36:39]
    v_mfma_f32_16x16x32_bf16 v[40:43], v[252:255], v[212:215], v[40:43]
    ds_write_b128 v2, v[44:47] offset:0
    ds_write_b128 v2, v[48:51] offset:1024
    ds_write_b128 v2, v[52:55] offset:2048
    ds_write_b128 v2, v[56:59] offset:3072
    s_mov_b64 exec, s[40:41]
    ds_write_b128 v3, v[60:63] offset:4096
    s_mov_b64 exec, -1
    ds_write_b32 v0, v9
    s_mov_b32 s60, 4194304
L_px_p5:
    ds_read_b32 v232, v6
    ds_read_b128 v[64:67], v7 offset:0
    ds_read_b128 v[68:71], v7 offset:1024
    ds_read_b128 v[72:75], v7 offset:2048
    ds_read_b128 v[76:79], v7 offset:3072
    ds_read_b128 v[80:83], v8 offset:4096
    s_waitcnt lgkmcnt(5)
    v_cmp_ne_u32_e64 vcc, s43, v232
    s_sub_u32 s60, s60, 1
    s_cbranch_scc1 L_py_p5
    s_cbranch_vccnz L_px_p5
L_py_p5:
    s_waitcnt lgkmcnt(4)
    v_pk_add_f32 v[24:25], v[24:25], v[64:65]
    v_pk_add_f32 v[26:27], v[26:27], v[66:67]
    v_cvt_pk_bf16_f32 v220, v24, v25
    v_cvt_pk_bf16_f32 v221, v26, v27
    s_waitcnt lgkmcnt(3)
    v_pk_add_f32 v[28:29], v[28:29], v[68:69]
    v_pk_add_f32 v[30:31], v[30:31], v[70:71]
    v_cvt_pk_bf16_f32 v222, v28, v29
    v_cvt_pk_bf16_f32 v223, v30, v31
    s_waitcnt lgkmcnt(2)
    v_pk_add_f32 v[32:33], v[32:33], v[72:73]
    v_pk_add_f32 v[34:35], v[34:35], v[74:75]
    v_cvt_pk_bf16_f32 v224, v32, v33
    v_cvt_pk_bf16_f32 v225, v34, v35
    s_waitcnt lgkmcnt(1)
    v_pk_add_f32 v[36:37], v[36:37], v[76:77]
    v_pk_add_f32 v[38:39], v[38:39], v[78:79]
    v_cvt_pk_bf16_f32 v226, v36, v37
    v_cvt_pk_bf16_f32 v227, v38, v39
    s_waitcnt lgkmcnt(0)
    v_pk_add_f32 v[40:41], v[40:41], v[80:81]
    v_pk_add_f32 v[42:43], v[42:43], v[82:83]
    v_cvt_pk_bf16_f32 v228, v40, v41
    v_cvt_pk_bf16_f32 v229, v42, v43
    s_cmp_eq_u32 s22, 1
    s_cbranch_scc1 L_fin_p5
    buffer_store_dwordx4 v[220:223], v4, s[4:7], s34 offen offset:0 sc1
    buffer_store_dwordx4 v[224:227], v4, s[4:7], s34 offen offset:1024 sc1
    buffer_store_dwordx2 v[228:229], v5, s[4:7], s34 offen sc1
    v_cndmask_b32 v234, 0, v228, s[40:41]
    v_cndmask_b32 v235, 0, v229, s[40:41]
    v_dot2_f32_bf16 v232, v220, v11, 0
    v_dot2_f32_bf16 v233, v220, v220, 0
    v_dot2_f32_bf16 v232, v221, v11, v232
    v_dot2_f32_bf16 v233, v221, v221, v233
    v_dot2_f32_bf16 v232, v222, v11, v232
    v_dot2_f32_bf16 v233, v222, v222, v233
    v_dot2_f32_bf16 v232, v223, v11, v232
    v_dot2_f32_bf16 v233, v223, v223, v233
    v_dot2_f32_bf16 v232, v224, v11, v232
    v_dot2_f32_bf16 v233, v224, v224, v233
    v_dot2_f32_bf16 v232, v225, v11, v232
    v_dot2_f32_bf16 v233, v225, v225, v233
    v_dot2_f32_bf16 v232, v226, v11, v232
    v_dot2_f32_bf16 v233, v226, v226, v233
    v_dot2_f32_bf16 v232, v227, v11, v232
    v_dot2_f32_bf16 v233, v227, v227, v233
    v_dot2_f32_bf16 v232, v234, v11, v232
    v_dot2_f32_bf16 v233, v234, v234, v233
    v_dot2_f32_bf16 v232, v235, v11, v232
    v_dot2_f32_bf16 v233, v235, v235, v233
    s_nop 2
    v_mov_b32 v234, v232
    v_mov_b32 v235, v233
    s_nop 1
    v_permlane32_swap_b32 v232, v234
    v_permlane32_swap_b32 v233, v235
    v_add_f32 v232, v232, v234
    v_add_f32 v233, v233, v235
    v_mov_b32 v234, v232
    v_mov_b32 v235, v233
    s_nop 1
    v_permlane16_swap_b32 v232, v234
    v_permlane16_swap_b32 v233, v235
    v_add_f32 v232, v232, v234
    v_add_f32_e64 v233, v233, v235
    buffer_store_dwordx2 v[232:233], v10, s[4:7], s39 offen sc1
    s_barrier
    s_mov_b32 s22, 1
    s_mov_b32 s21, 0x1c00000
    s_branch L_m_cl
    s_nop 0
L_fin_p5:
    ds_bpermute_b32 v220, v10, v220
    ds_bpermute_b32 v221, v10, v221
    ds_bpermute_b32 v222, v10, v222
    ds_bpermute_b32 v223, v10, v223
    ds_bpermute_b32 v224, v10, v224
    ds_bpermute_b32 v225, v10, v225
    ds_bpermute_b32 v226, v10, v226
    ds_bpermute_b32 v227, v10, v227
    ds_bpermute_b32 v228, v10, v228
    ds_bpermute_b32 v229, v10, v229
    s_waitcnt lgkmcnt(6)
    buffer_store_dwordx4 v[220:223], v4, s[16:19], s34 offen offset:0
    s_waitcnt lgkmcnt(2)
    buffer_store_dwordx4 v[224:227], v4, s[16:19], s34 offen offset:64
    s_waitcnt lgkmcnt(0)
    buffer_store_dwordx2 v[228:229], v5, s[16:19], s34 offen offset:128
    s_endpgm
L_m_l1:
    s_and_b32 s25, s2, 7
    s_lshr_b32 s26, s2, 3
    s_lshr_b32 s23, s25, 1
    s_lshl_b32 s23, s23, 2
    s_lshr_b32 s27, s26, 3
    s_add_u32 s23, s23, s27
    s_and_b32 s24, s25, 1
    s_lshl_b32 s24, s24, 3
    s_and_b32 s27, s26, 7
    s_add_u32 s24, s24, s27
    s_mul_i32 s29, s24, 129024
    s_lshl_b32 s30, s20, 12
    s_add_u32 s29, s29, s30
    s_add_u32 s29, s29, 0x3800000
    s_lshl_b32 s31, s23, 3
    s_max_u32 s31, s31, 1
    s_sub_u32 s31, s31, 1
    s_mul_i32 s31, s31, 18432
    s_add_u32 s31, s31, 0x0
    s_lshl_b32 s35, s20, 10
    s_and_b32 s36, s35, 1024
    s_barrier
    s_add_u32 m0, s35, 131072
    s_add_u32 s34, s31, s35
    s_add_u32 s34, s34, 0
    buffer_load_dwordx4 v1, s[4:7], s34 offen sc1 lds
    s_add_u32 m0, s30, 0
    s_add_u32 s34, s29, 0
    buffer_load_dwordx4 v1, s[4:7], s34 offen offset:0 sc1 lds
    buffer_load_dwordx4 v1, s[4:7], s34 offen offset:1024 sc1 lds
    buffer_load_dwordx4 v1, s[4:7], s34 offen offset:2048 sc1 lds
    buffer_load_dwordx4 v1, s[4:7], s34 offen offset:3072 sc1 lds
    s_add_u32 m0, s30, 16384
    s_add_u32 s34, s29, 16384
    buffer_load_dwordx4 v1, s[4:7], s34 offen offset:0 sc1 lds
    buffer_load_dwordx4 v1, s[4:7], s34 offen offset:1024 sc1 lds
    buffer_load_dwordx4 v1, s[4:7], s34 offen offset:2048 sc1 lds
    buffer_load_dwordx4 v1, s[4:7], s34 offen offset:3072 sc1 lds
    s_waitcnt vmcnt(4) lgkmcnt(0)
    s_barrier
    s_add_u32 m0, s30, 32768
    s_add_u32 s34, s29, 32768
    buffer_load_dwordx4 v1, s[4:7], s34 offen offset:0 sc1 lds
    buffer_load_dwordx4 v1, s[4:7], s34 offen offset:1024 sc1 lds
    buffer_load_dwordx4 v1, s[4:7], s34 offen offset:2048 sc1 lds
    buffer_load_dwordx4 v1, s[4:7], s34 offen offset:3072 sc1 lds
    s_cmp_lt_u32 s2, 144
    s_cbranch_scc1 L_p0_t1
    s_cmp_ge_u32 s2, 216
    s_cbranch_scc1 L_p0_t2
    ds_read_b64_tr_b16 v[16:17], v4 offset:0
    ds_read_b64_tr_b16 v[18:19], v4 offset:2048
    ds_read_b64_tr_b16 v[20:21], v4 offset:18432
    ds_read_b64_tr_b16 v[22:23], v4 offset:20480
    ds_read_b64_tr_b16 v[24:25], v4 offset:4096
    ds_read_b64_tr_b16 v[26:27], v4 offset:6144
    ds_read_b64_tr_b16 v[28:29], v4 offset:22528
    ds_read_b64_tr_b16 v[30:31], v4 offset:24576
    ds_read_b64_tr_b16 v[32:33], v4 offset:8192
    ds_read_b64_tr_b16 v[34:35], v4 offset:10240
    ds_read_b64_tr_b16 v[36:37], v4 offset:26624
    ds_read_b64_tr_b16 v[38:39], v4 offset:28672
    ds_read_b64_tr_b16 v[40:41], v4 offset:12288
    ds_read_b64_tr_b16 v[42:43], v4 offset:14336
    ds_read_b64_tr_b16 v[44:45], v4 offset:30720
    ds_read_b64_tr_b16 v[46:47], v4 offset:32768
    ds_read_b64_tr_b16 v[48:49], v5 offset:16384
    ds_read_b64_tr_b16 v[50:51], v5 offset:34816
    s_branch L_p0_t2
    s_nop 0
L_p0_t1:
    ds_read_b64_tr_b16 v[16:17], v4 offset:0
    ds_read_b64_tr_b16 v[18:19], v4 offset:512
    ds_read_b64_tr_b16 v[20:21], v4 offset:4352
    ds_read_b64_tr_b16 v[22:23], v4 offset:4864
    ds_read_b64_tr_b16 v[24:25], v4 offset:9792
    ds_read_b64_tr_b16 v[26:27], v4 offset:10304
    ds_read_b64_tr_b16 v[28:29], v4 offset:14144
    ds_read_b64_tr_b16 v[30:31], v4 offset:14656
    ds_read_b64_tr_b16 v[32:33], v4 offset:19584
    ds_read_b64_tr_b16 v[34:35], v4 offset:20096
    ds_read_b64_tr_b16 v[36:37], v4 offset:23936
    ds_read_b64_tr_b16 v[38:39], v4 offset:24448
    ds_read_b64_tr_b16 v[40:41], v4 offset:29376
    ds_read_b64_tr_b16 v[42:43], v4 offset:29888
    ds_read_b64_tr_b16 v[44:45], v4 offset:33728
    ds_read_b64_tr_b16 v[46:47], v4 offset:34240
    ds_read_b64_tr_b16 v[48:49], v5 offset:8704
    ds_read_b64_tr_b16 v[50:51], v5 offset:9216
L_p0_t2:
    s_waitcnt lgkmcnt(0)
    s_waitcnt vmcnt(4) lgkmcnt(0)
    s_barrier
    s_add_u32 m0, s35, 135168
    s_add_u32 s34, s31, s35
    s_add_u32 s34, s34, 4096
    buffer_load_dwordx4 v1, s[4:7], s34 offen sc1 lds
    s_add_u32 m0, s30, 49152
    s_add_u32 s34, s29, 49152
    buffer_load_dwordx4 v1, s[4:7], s34 offen offset:0 sc1 lds
    buffer_load_dwordx4 v1, s[4:7], s34 offen offset:1024 sc1 lds
    buffer_load_dwordx4 v1, s[4:7], s34 offen offset:2048 sc1 lds
    buffer_load_dwordx4 v1, s[4:7], s34 offen offset:3072 sc1 lds
    s_waitcnt vmcnt(5) lgkmcnt(0)
    s_barrier
    s_add_u32 m0, s35, 139264
    s_add_u32 s34, s31, s35
    s_add_u32 s34, s34, 8192
    buffer_load_dwordx4 v1, s[4:7], s34 offen sc1 lds
    v_lshrrev_b32 v2, 8, v1
    v_bfe_u32 v3, v1, 7, 1
    v_bfe_u32 v4, v1, 4, 3
    v_cmp_gt_u32_e64 vcc, 3, v2
    v_mul_u32_u24 v3, 80, v3
    v_lshl_add_u32 v3, v4, 3, v3
    v_lshrrev_b32 v5, 1, v4
    v_and_b32 v4, 1, v4
    v_lshl_add_u32 v4, v4, 3, 64
    v_cndmask_b32 v2, v5, v2, vcc
    v_cndmask_b32 v3, v4, v3, vcc
    v_mul_u32_u24 v2, 2304, v2
    v_add_u32 v0, v2, v3
    v_lshrrev_b32 v8, 1, v1
    s_mul_i32 s34, s24, 144
    s_add_u32 s34, s34, 0x4400000
    buffer_load_dwordx2 v[2:3], v0, s[4:7], s34 offen sc1
    s_mul_i32 s34, s24, 144
    s_add_u32 s34, s34, 0x4402000
    buffer_load_dwordx2 v[4:5], v0, s[4:7], s34 offen sc1
    s_mul_i32 s34, s24, 144
    s_add_u32 s34, s34, 0x4404000
    buffer_load_dwordx2 v[6:7], v0, s[4:7], s34 offen sc1
    s_mul_i32 s34, s24, 144
    s_add_u32 s34, s34, 0x4406000
    buffer_load_dwordx2 v[12:13], v0, s[4:7], s34 offen sc1
    s_add_u32 m0, s30, 65536
    s_add_u32 s34, s29, 65536
    buffer_load_dwordx4 v1, s[4:7], s34 offen offset:0 sc1 lds
    buffer_load_dwordx4 v1, s[4:7], s34 offen offset:1024 sc1 lds
    buffer_load_dwordx4 v1, s[4:7], s34 offen offset:2048 sc1 lds
    buffer_load_dwordx4 v1, s[4:7], s34 offen offset:3072 sc1 lds
    s_waitcnt vmcnt(9) lgkmcnt(0)
    s_barrier
    s_add_u32 m0, s30, 81920
    s_add_u32 s34, s29, 81920
    buffer_load_dwordx4 v1, s[4:7], s34 offen offset:0 sc1 lds
    buffer_load_dwordx4 v1, s[4:7], s34 offen offset:1024 sc1 lds
    buffer_load_dwordx4 v1, s[4:7], s34 offen offset:2048 sc1 lds
    buffer_load_dwordx4 v1, s[4:7], s34 offen offset:3072 sc1 lds
    s_waitcnt vmcnt(8)
    v_add_f32 v2, v2, v4
    v_add_f32 v3, v3, v5
    v_add_f32 v6, v6, v12
    v_add_f32 v7, v7, v13
    v_add_f32 v2, v2, v6
    v_add_f32_e64 v3, v3, v7
    v_cmp_gt_u32 vcc, 864, v1
    v_add_u32 v8, 161792, v8
    s_nop 0
    v_cndmask_b32 v2, 0, v2, vcc
    v_cndmask_b32_e64 v3, 0, v3, vcc
    ds_write_b64 v8, v[2:3]
    s_waitcnt vmcnt(4) lgkmcnt(0)
    s_barrier
    s_add_u32 m0, s35, 143360
    s_add_u32 s34, s31, s35
    s_add_u32 s34, s34, 12288
    buffer_load_dwordx4 v1, s[4:7], s34 offen sc1 lds
    s_add_u32 m0, s30, 98304
    s_add_u32 s34, s29, 98304
    buffer_load_dwordx4 v1, s[4:7], s34 offen offset:0 sc1 lds
    buffer_load_dwordx4 v1, s[4:7], s34 offen offset:1024 sc1 lds
    buffer_load_dwordx4 v1, s[4:7], s34 offen offset:2048 sc1 lds
    buffer_load_dwordx4 v1, s[4:7], s34 offen offset:3072 sc1 lds
    s_waitcnt vmcnt(5) lgkmcnt(0)
    s_barrier
    s_add_u32 m0, s36, 147456
    s_add_u32 s34, s31, s36
    s_add_u32 s34, s34, 16384
    buffer_load_dwordx4 v1, s[4:7], s34 offen sc1 lds
    s_add_u32 m0, s30, 114688
    s_add_u32 s34, s29, 114688
    buffer_load_dwordx4 v1, s[4:7], s34 offen offset:0 sc1 lds
    buffer_load_dwordx4 v1, s[4:7], s34 offen offset:1024 sc1 lds
    buffer_load_dwordx4 v1, s[4:7], s34 offen offset:2048 sc1 lds
    buffer_load_dwordx4 v1, s[4:7], s34 offen offset:3072 sc1 lds
    s_waitcnt vmcnt(5) lgkmcnt(0)
    s_barrier
    buffer_store_dwordx4 v[16:19], v9, s[4:7], s37 offen sc1
    buffer_store_dwordx4 v[20:23], v10, s[4:7], s38 offen sc1
    buffer_store_dwordx4 v[24:27], v9, s[4:7], s39 offen sc1
    buffer_store_dwordx4 v[28:31], v10, s[4:7], s40 offen sc1
    buffer_store_dwordx4 v[32:35], v9, s[4:7], s41 offen sc1
    s_waitcnt vmcnt(5) lgkmcnt(0)
    s_barrier
    s_mov_b32 s46, 0x4502000
    v_mov_b32_e64 v4, 0
    s_mov_b32 s60, 262144
L_poll_wo:
    buffer_load_dword v5, v4, s[4:7], s46 offen sc1
    s_waitcnt vmcnt(0)
    v_cmp_gt_u32_e64 vcc, 18, v5
    s_sub_u32 s60, s60, 1
    s_cbranch_scc1 L_pd_wo
    s_cbranch_vccz L_pd_wo
    s_sleep 4
    s_branch L_poll_wo
L_pd_wo:
    buffer_store_dwordx4 v[36:39], v10, s[4:7], s42 offen sc1
    buffer_store_dwordx4 v[40:43], v9, s[4:7], s43 offen sc1
    buffer_store_dwordx4 v[44:47], v10, s[4:7], s47 offen sc1
    buffer_store_dwordx4 v[48:51], v14, s[4:7], s48 offen sc1
    v_dot2_f32_bf16 v12, v16, v11, 0
    v_dot2_f32_bf16 v13, v17, v11, 0
    v_dot2_f32_bf16 v12, v18, v11, v12
    v_dot2_f32_bf16 v13, v19, v11, v13
    v_dot2_f32_bf16 v12, v20, v11, v12
    v_dot2_f32_bf16 v13, v21, v11, v13
    v_dot2_f32_bf16 v12, v22, v11, v12
    v_dot2_f32_bf16 v13, v23, v11, v13
    v_dot2_f32_bf16 v12, v24, v11, v12
    v_dot2_f32_bf16 v13, v25, v11, v13
    v_dot2_f32_bf16 v12, v26, v11, v12
    v_dot2_f32_bf16 v13, v27, v11, v13
    v_dot2_f32_bf16 v12, v28, v11, v12
    v_dot2_f32_bf16 v13, v29, v11, v13
    v_dot2_f32_bf16 v12, v30, v11, v12
    v_dot2_f32_bf16 v13, v31, v11, v13
    v_dot2_f32_bf16 v12, v32, v11, v12
    v_dot2_f32_bf16 v13, v33, v11, v13
    v_dot2_f32_bf16 v12, v34, v11, v12
    v_dot2_f32_bf16 v13, v35, v11, v13
    v_dot2_f32_bf16 v12, v36, v11, v12
    v_dot2_f32_bf16 v13, v37, v11, v13
    v_dot2_f32_bf16 v12, v38, v11, v12
    v_dot2_f32_bf16 v13, v39, v11, v13
    v_dot2_f32_bf16 v12, v40, v11, v12
    v_dot2_f32_bf16 v13, v41, v11, v13
    v_dot2_f32_bf16 v12, v42, v11, v12
    v_dot2_f32_bf16 v13, v43, v11, v13
    v_dot2_f32_bf16 v12, v44, v11, v12
    v_dot2_f32_bf16 v13, v45, v11, v13
    v_dot2_f32_bf16 v12, v46, v11, v12
    v_dot2_f32_bf16 v13, v47, v11, v13
    v_dot2_f32_bf16 v12, v48, v11, v12
    v_dot2_f32_bf16 v13, v49, v11, v13
    v_dot2_f32_bf16 v12, v50, v11, v12
    v_dot2_f32_bf16 v13, v51, v11, v13
    s_nop 2
    v_add_f32 v12, v12, v13
    v_mov_b32 v13, v12
    s_nop 1
    v_permlane32_swap_b32 v12, v13
    v_add_f32 v12, v12, v13
    v_mov_b32 v13, v12
    s_nop 1
    v_permlane16_swap_b32 v12, v13
    v_add_f32 v12, v12, v13
    buffer_store_dword v12, v15, s[4:7], s49 offen sc1
    s_barrier
L_m_ll:
    s_and_b32 s25, s2, 7
    s_lshr_b32 s26, s2, 3
    s_lshr_b32 s23, s25, 1
    s_lshl_b32 s23, s23, 3
    s_lshr_b32 s27, s26, 2
    s_add_u32 s23, s23, s27
    s_and_b32 s24, s25, 1
    s_lshl_b32 s24, s24, 2
    s_and_b32 s27, s26, 3
    s_add_u32 s24, s24, s27
    s_add_u32 s25, s23, s24
    s_and_b32 s25, s25, 3
    s_mul_i32 s29, s24, 82944
    s_add_u32 s29, s29, 0x3a00000
    s_mul_i32 s30, s20, 36864
    s_mul_i32 s31, s20, 18432
    s_add_u32 s31, s31, s29
    s_add_u32 m0, s30, 18432
    s_add_u32 s33, s31, 0
    buffer_load_dwordx4 v1, s[4:7], s33 offen offset:0  sc1 lds
    buffer_load_dwordx4 v1, s[4:7], s33 offen offset:1024  sc1 lds
    buffer_load_dwordx4 v1, s[4:7], s33 offen offset:2048  sc1 lds
    buffer_load_dwordx4 v1, s[4:7], s33 offen offset:3072  sc1 lds
    s_add_u32 m0, s30, 22528
    s_add_u32 s33, s31, 4096
    buffer_load_dwordx4 v1, s[4:7], s33 offen offset:0  sc1 lds
    buffer_load_dwordx4 v1, s[4:7], s33 offen offset:1024  sc1 lds
    buffer_load_dwordx4 v1, s[4:7], s33 offen offset:2048  sc1 lds
    buffer_load_dwordx4 v1, s[4:7], s33 offen offset:3072  sc1 lds
    s_add_u32 m0, s30, 26624
    s_add_u32 s33, s31, 8192
    buffer_load_dwordx4 v1, s[4:7], s33 offen offset:0  sc1 lds
    buffer_load_dwordx4 v1, s[4:7], s33 offen offset:1024  sc1 lds
    buffer_load_dwordx4 v1, s[4:7], s33 offen offset:2048  sc1 lds
    buffer_load_dwordx4 v1, s[4:7], s33 offen offset:3072  sc1 lds
    s_waitcnt vmcnt(12)
    s_barrier
    s_add_u32 m0, s30, 30720
    s_add_u32 s33, s31, 12288
    buffer_load_dwordx4 v1, s[4:7], s33 offen offset:0  sc1 lds
    buffer_load_dwordx4 v1, s[4:7], s33 offen offset:1024  sc1 lds
    buffer_load_dwordx4 v1, s[4:7], s33 offen offset:2048  sc1 lds
    buffer_load_dwordx4 v1, s[4:7], s33 offen offset:3072  sc1 lds
    s_add_u32 m0, s30, 34816
    s_add_u32 s33, s31, 16384
    buffer_load_dwordx4 v1, s[4:7], s33 offen offset:0  sc1 lds
    buffer_load_dwordx4 v1, s[4:7], s33 offen offset:1024  sc1 lds
    s_mul_i32 s30, s20, 3072
    s_add_u32 s31, s30, s29
    s_add_u32 m0, s30, 147456
    s_add_u32 s33, s31, 73728
    buffer_load_dwordx4 v1, s[4:7], s33 offen offset:0  sc1 lds
    buffer_load_dwordx4 v1, s[4:7], s33 offen offset:1024  sc1 lds
    buffer_load_dwordx4 v1, s[4:7], s33 offen offset:2048  sc1 lds
    s_or_b32 s44, s20, s22
    s_cbranch_scc1 L_p2_ns
    s_and_b32 s44, s2, 15
    s_lshl_b32 s44, s44, 8
    s_add_u32 s44, s44, 0x4501000
    s_add_u32 s44, s44, s4
    s_addc_u32 s45, s5, 0
    s_mov_b32 s56, 1
    s_atomic_add s56, s[44:45], 0
L_p2_ns:
    s_waitcnt vmcnt(0)
    s_barrier
    s_and_b32 s25, s2, 7
    s_lshr_b32 s26, s2, 3
    s_and_b32 s23, s25, 1
    s_lshl_b32 s23, s23, 3
    s_and_b32 s27, s26, 7
    s_add_u32 s23, s23, s27
    s_lshr_b32 s24, s25, 1
    s_lshl_b32 s24, s24, 2
    s_lshr_b32 s27, s26, 3
    s_add_u32 s24, s24, s27
    s_add_u32 s28, s23, s24
    s_and_b32 s28, s28, 3
    s_lshl_b32 s30, s20, 12
    s_lshr_b32 s33, s20, 1
    s_mul_i32 s31, s33, 36864
    s_and_b32 s33, s20, 1
    s_lshl_b32 s33, s33, 10
    s_add_u32 s33, s33, 16384
    s_add_u32 s31, s31, s33
    s_sub_u32 s49, s33, s30
    s_mul_i32 s34, s24, 331776
    s_add_u32 s34, s34, s30
    s_add_u32 s34, s34, 0x3b00000
    s_lshl_b32 s35, s23, 3
    s_lshl_b32 s33, s20, 1
    s_add_u32 s35, s35, s33
    s_mul_i32 s35, s35, 18432
    s_add_u32 s35, s35, s21
    s_add_u32 s35, s35, 0x300000
    s_mul_i32 s36, s24, 589824
    s_add_u32 s36, s36, s30
    s_add_u32 s36, s36, s21
    s_add_u32 s36, s36, 0x900000
    v_add_u32 v2, 16384, v1
    s_add_u32 s33, s30, 18432
    v_add_u32_e64 v6, s33, v1
    v_add_u32 v7, 73728, v6
    s_lshl_b32 s29, s23, 2
    s_add_u32 s29, s29, s20
    s_lshl_b32 s29, s29, 12
    s_add_u32 s29, s29, s21
    s_add_u32 s29, s29, 0x1b40000
    v_and_b32 v3, 48, v1
    v_lshrrev_b32 v8, 8, v1
    v_lshl_add_u32 v3, v8, 6, v3
    v_bfe_u32 v8, v1, 6, 2
    v_lshl_add_u32 v3, v8, 8, v3
    s_lshl_b32 s33, s23, 7
    s_lshl_b32 s37, s20, 5
    s_add_u32 s33, s33, s37
    v_lshrrev_b32 v8, 7, v1
    v_add_u32 v8, s33, v8
    v_lshlrev_b32 v8, 12, v8
    v_lshrrev_b32_e64 v9, 8, v1
    v_bfe_u32 v10, v1, 4, 3
    v_xor_b32_e64 v9, v9, v10
    v_lshl_add_u32 v8, v9, 4, v8
    v_xor_b32_e64 v9, 64, v8
    v_add_u32 v9, 31744, v9
    v_add_u32 v10, 63488, v8
    v_add_u32 v11, 63488, v9
    s_cmp_eq_u32 s28, 0
    s_cselect_b32 s44, 4, 0
    s_cmp_eq_u32 s28, 1
    s_cselect_b32 s45, 5, 1
    s_cmp_eq_u32 s28, 2
    s_cselect_b32 s46, 6, 2
    s_cmp_eq_u32 s28, 3
    s_cselect_b32 s47, 7, 3
    s_lshl_b32 s33, s20, 4
    s_add_u32 s33, s33, s24
    s_lshl_b32 s54, s22, 7
    s_add_u32 s54, s54, s33
    s_lshl_b32 s54, s54, 8
    s_add_u32 s54, s54, 0x450c000
    s_add_u32 s54, s54, s4
    s_addc_u32 s55, s5, 0
    s_mov_b32 s33, 0x4501000
    v_and_b32 v4, 0xf0, v1
    v_lshlrev_b32 v4, 4, v4
    s_mov_b32 s60, 262144
L_poll_wr:
    buffer_load_dword v5, v4, s[4:7], s33 offen sc1
    s_waitcnt vmcnt(0)
    v_cmp_gt_u32 vcc, 16, v5
    s_sub_u32 s60, s60, 1
    s_cbranch_scc1 L_pd_wr
    s_cbranch_vccz L_pd_wr
    s_sleep 4
    s_branch L_poll_wr
L_pd_wr:
    s_min_u32 s33, s20, 2
    s_lshl_b32 s33, s33, 9
    v_lshrrev_b32 v4, 1, v1
    v_add_u32 v4, s33, v4
    s_lshl_b32 s51, s24, 12
    s_add_u32 s51, s51, 0x4410000
    buffer_load_dwordx2 v[16:17], v4, s[4:7], s51 offen offset:0 sc1
    buffer_load_dwordx2 v[18:19], v4, s[4:7], s51 offen offset:1152 sc1
    s_mov_b32 s48, 0
    s_mul_i32 s50, s48, 18432
    s_add_u32 s50, s50, s34
    s_add_u32 m0, s30, 0
    s_mov_b32 s53, s50
    buffer_load_dwordx4 v1, s[4:7], s50 offen offset:0  sc1 lds
    buffer_load_dwordx4 v1, s[4:7], s50 offen offset:1024  sc1 lds
    buffer_load_dwordx4 v1, s[4:7], s50 offen offset:2048  sc1 lds
    buffer_load_dwordx4 v1, s[4:7], s50 offen offset:3072  sc1 lds
    s_mov_b32 s48, 1
    s_mul_i32 s50, s48, 18432
    s_add_u32 s50, s50, s34
    s_cmp_ge_u32 s20, 2
    s_cselect_b32 s52, s50, s53
    s_add_u32 m0, s31, 0
    s_add_u32 s52, s52, s49
    buffer_load_dwordx4 v1, s[4:7], s52 offen  sc1 lds
    s_add_u32 m0, s30, 36864
    s_mov_b32 s53, s50
    buffer_load_dwordx4 v1, s[4:7], s50 offen offset:0  sc1 lds
    buffer_load_dwordx4 v1, s[4:7], s50 offen offset:1024  sc1 lds
    buffer_load_dwordx4 v1, s[4:7], s50 offen offset:2048  sc1 lds
    buffer_load_dwordx4 v1, s[4:7], s50 offen offset:3072  sc1 lds
    s_mov_b32 m0, 161280
    v_lshrrev_b32_e64 v5, 2, v1
    s_lshl_b32 s33, s23, 8
    buffer_load_dword v5, s[12:15], s33 offen lds
    s_waitcnt vmcnt(10)
    v_add_u32 v4, 159744, v4
    v_add_f32 v16, v16, v18
    v_add_f32_e64 v17, v17, v19
    ds_write_b64 v4, v[16:17]
    s_waitcnt lgkmcnt(0)
    s_barrier
    s_mov_b32 s48, 2
    s_mul_i32 s50, s48, 18432
    s_add_u32 s50, s50, s34
    s_add_u32 m0, s30, 73728
    s_mov_b32 s53, s50
    buffer_load_dwordx4 v1, s[4:7], s50 offen offset:0  sc1 lds
    buffer_load_dwordx4 v1, s[4:7], s50 offen offset:1024  sc1 lds
    buffer_load_dwordx4 v1, s[4:7], s50 offen offset:2048  sc1 lds
    buffer_load_dwordx4 v1, s[4:7], s50 offen offset:3072  sc1 lds
    s_mov_b32 s48, 3
    s_mul_i32 s50, s48, 18432
    s_add_u32 s50, s50, s34
    s_cmp_ge_u32 s20, 2
    s_cselect_b32 s52, s50, s53
    s_add_u32 m0, s31, 73728
    s_add_u32 s52, s52, s49
    buffer_load_dwordx4 v1, s[4:7], s52 offen  sc1 lds
    s_add_u32 m0, s30, 110592
    s_mov_b32 s53, s50
    buffer_load_dwordx4 v1, s[4:7], s50 offen offset:0  sc1 lds
    buffer_load_dwordx4 v1, s[4:7], s50 offen offset:1024  sc1 lds
    buffer_load_dwordx4 v1, s[4:7], s50 offen offset:2048  sc1 lds
    buffer_load_dwordx4 v1, s[4:7], s50 offen offset:3072  sc1 lds
    s_barrier
    s_add_u32 m0, s30, 18432
    s_add_u32 s51, s35, 0
    buffer_load_dwordx4 v1, s[4:7], s51 offen offset:0 sc1 lds
    buffer_load_dwordx4 v1, s[4:7], s51 offen offset:1024 sc1 lds
    buffer_load_dwordx4 v2, s[4:7], s51 offen offset:2048 sc1 lds
    buffer_load_dwordx4 v2, s[4:7], s51 offen offset:3072 sc1 lds
    s_add_u32 m0, s30, 55296
    s_add_u32 s51, s35, 2048
    buffer_load_dwordx4 v1, s[4:7], s51 offen offset:0 sc1 lds
    buffer_load_dwordx4 v1, s[4:7], s51 offen offset:1024 sc1 lds
    buffer_load_dwordx4 v2, s[4:7], s51 offen offset:2048 sc1 lds
    buffer_load_dwordx4 v2, s[4:7], s51 offen offset:3072 sc1 lds
    s_add_u32 m0, s30, 92160
    s_add_u32 s51, s35, 4096
    buffer_load_dwordx4 v1, s[4:7], s51 offen offset:0 sc1 lds
    buffer_load_dwordx4 v1, s[4:7], s51 offen offset:1024 sc1 lds
    buffer_load_dwordx4 v2, s[4:7], s51 offen offset:2048 sc1 lds
    buffer_load_dwordx4 v2, s[4:7], s51 offen offset:3072 sc1 lds
    s_waitcnt vmcnt(8)
    s_barrier
    s_add_u32 m0, s30, 129024
    s_add_u32 s51, s35, 6144
    buffer_load_dwordx4 v1, s[4:7], s51 offen offset:0 sc1 lds
    buffer_load_dwordx4 v1, s[4:7], s51 offen offset:1024 sc1 lds
    buffer_load_dwordx4 v2, s[4:7], s51 offen offset:2048 sc1 lds
    buffer_load_dwordx4 v2, s[4:7], s51 offen offset:3072 sc1 lds
    s_and_b32 s40, s2, 7
    s_lshr_b32 s26, s2, 3
    s_lshr_b32 s38, s40, 1
    s_lshl_b32 s38, s38, 3
    s_lshr_b32 s27, s26, 2
    s_add_u32 s38, s38, s27
    s_and_b32 s39, s40, 1
    s_lshl_b32 s39, s39, 2
    s_and_b32 s27, s26, 3
    s_add_u32 s39, s39, s27
    s_add_u32 s40, s38, s39
    s_and_b32 s40, s40, 3
    s_mul_i32 s42, s20, 9216
    s_mul_i32 s43, s39, 331776
    s_add_u32 s43, s43, s42
    s_add_u32 s43, s43, 0x4100000
    s_waitcnt vmcnt(8) lgkmcnt(0)
    s_barrier
    s_mov_b32 s48, 4
    s_mul_i32 s50, s48, 18432
    s_add_u32 s50, s50, s34
    s_add_u32 m0, s30, 0
    s_mov_b32 s53, s50
    buffer_load_dwordx4 v1, s[4:7], s50 offen offset:0  sc1 lds
    buffer_load_dwordx4 v1, s[4:7], s50 offen offset:1024  sc1 lds
    buffer_load_dwordx4 v1, s[4:7], s50 offen offset:2048  sc1 lds
    buffer_load_dwordx4 v1, s[4:7], s50 offen offset:3072  sc1 lds
    s_add_u32 m0, s30, 18432
    s_add_u32 s51, s35, 8192
    buffer_load_dwordx4 v1, s[4:7], s51 offen offset:0 sc1 lds
    buffer_load_dwordx4 v1, s[4:7], s51 offen offset:1024 sc1 lds
    buffer_load_dwordx4 v2, s[4:7], s51 offen offset:2048 sc1 lds
    buffer_load_dwordx4 v2, s[4:7], s51 offen offset:3072 sc1 lds
    s_waitcnt vmcnt(12) lgkmcnt(0)
    s_barrier
    s_mov_b32 s48, 5
    s_mul_i32 s50, s48, 18432
    s_add_u32 s50, s50, s34
    s_cmp_ge_u32 s20, 2
    s_cselect_b32 s52, s50, s53
    s_add_u32 m0, s31, 0
    s_add_u32 s52, s52, s49
    buffer_load_dwordx4 v1, s[4:7], s52 offen  sc1 lds
    s_add_u32 m0, s30, 36864
    s_mov_b32 s53, s50
    buffer_load_dwordx4 v1, s[4:7], s50 offen offset:0  sc1 lds
    buffer_load_dwordx4 v1, s[4:7], s50 offen offset:1024  sc1 lds
    buffer_load_dwordx4 v1, s[4:7], s50 offen offset:2048  sc1 lds
    buffer_load_dwordx4 v1, s[4:7], s50 offen offset:3072  sc1 lds
    s_add_u32 m0, s30, 55296
    s_add_u32 s51, s35, 10240
    buffer_load_dwordx4 v1, s[4:7], s51 offen offset:0 sc1 lds
    buffer_load_dwordx4 v1, s[4:7], s51 offen offset:1024 sc1 lds
    buffer_load_dwordx4 v2, s[4:7], s51 offen offset:2048 sc1 lds
    buffer_load_dwordx4 v2, s[4:7], s51 offen offset:3072 sc1 lds
    s_waitcnt vmcnt(17) lgkmcnt(0)
    s_barrier
    s_mov_b32 s48, 6
    s_mul_i32 s50, s48, 18432
    s_add_u32 s50, s50, s34
    s_add_u32 m0, s30, 73728
    s_mov_b32 s53, s50
    buffer_load_dwordx4 v1, s[4:7], s50 offen offset:0  sc1 lds
    buffer_load_dwordx4 v1, s[4:7], s50 offen offset:1024  sc1 lds
    buffer_load_dwordx4 v1, s[4:7], s50 offen offset:2048  sc1 lds
    buffer_load_dwordx4 v1, s[4:7], s50 offen offset:3072  sc1 lds
    s_add_u32 m0, s30, 92160
    s_add_u32 s51, s35, 12288
    buffer_load_dwordx4 v1, s[4:7], s51 offen offset:0 sc1 lds
    buffer_load_dwordx4 v1, s[4:7], s51 offen offset:1024 sc1 lds
    buffer_load_dwordx4 v2, s[4:7], s51 offen offset:2048 sc1 lds
    buffer_load_dwordx4 v2, s[4:7], s51 offen offset:3072 sc1 lds
    s_waitcnt vmcnt(16) lgkmcnt(0)
    s_barrier
    s_mov_b32 s48, 7
    s_mul_i32 s50, s48, 18432
    s_add_u32 s50, s50, s34
    s_cmp_ge_u32 s20, 2
    s_cselect_b32 s52, s50, s53
    s_add_u32 m0, s31, 73728
    s_add_u32 s52, s52, s49
    buffer_load_dwordx4 v1, s[4:7], s52 offen  sc1 lds
    s_add_u32 m0, s30, 110592
    s_mov_b32 s53, s50
    buffer_load_dwordx4 v1, s[4:7], s50 offen offset:0  sc1 lds
    buffer_load_dwordx4 v1, s[4:7], s50 offen offset:1024  sc1 lds
    buffer_load_dwordx4 v1, s[4:7], s50 offen offset:2048  sc1 lds
    buffer_load_dwordx4 v1, s[4:7], s50 offen offset:3072  sc1 lds
    s_add_u32 m0, s30, 129024
    s_add_u32 s51, s35, 14336
    buffer_load_dwordx4 v1, s[4:7], s51 offen offset:0 sc1 lds
    buffer_load_dwordx4 v1, s[4:7], s51 offen offset:1024 sc1 lds
    buffer_load_dwordx4 v2, s[4:7], s51 offen offset:2048 sc1 lds
    buffer_load_dwordx4 v2, s[4:7], s51 offen offset:3072 sc1 lds
    s_waitcnt vmcnt(17) lgkmcnt(0)
    s_barrier
    s_mov_b32 s48, 8
    s_mul_i32 s50, s48, 18432
    s_add_u32 s50, s50, s34
    s_add_u32 m0, s30, 0
    s_mov_b32 s53, s50
    buffer_load_dwordx4 v1, s[4:7], s50 offen offset:0  sc1 lds
    buffer_load_dwordx4 v1, s[4:7], s50 offen offset:1024  sc1 lds
    buffer_load_dwordx4 v1, s[4:7], s50 offen offset:2048  sc1 lds
    buffer_load_dwordx4 v1, s[4:7], s50 offen offset:3072  sc1 lds
    s_add_u32 m0, s30, 18432
    s_add_u32 s51, s35, 16384
    buffer_load_dwordx4 v1, s[4:7], s51 offen offset:0 sc1 lds
    buffer_load_dwordx4 v1, s[4:7], s51 offen offset:1024 sc1 lds
    buffer_load_dwordx4 v2, s[4:7], s51 offen offset:2048 sc1 lds
    buffer_load_dwordx4 v2, s[4:7], s51 offen offset:3072 sc1 lds
    s_waitcnt vmcnt(16) lgkmcnt(0)
    s_barrier
    s_mov_b32 s48, 5
    s_mul_i32 s50, s48, 18432
    s_add_u32 s50, s50, s34
    s_add_u32 s50, s50, 165888
    s_cmp_ge_u32 s20, 2
    s_cselect_b32 s52, s50, s53
    s_add_u32 m0, s31, 0
    s_add_u32 s52, s52, s49
    buffer_load_dwordx4 v1, s[4:7], s52 offen  sc1 lds
    s_add_u32 m0, s30, 36864
    s_mov_b32 s53, s50
    buffer_load_dwordx4 v1, s[4:7], s50 offen offset:0  sc1 lds
    buffer_load_dwordx4 v1, s[4:7], s50 offen offset:1024  sc1 lds
    buffer_load_dwordx4 v1, s[4:7], s50 offen offset:2048  sc1 lds
    buffer_load_dwordx4 v1, s[4:7], s50 offen offset:3072  sc1 lds
    s_cmp_lg_u32 s22, 0
    s_cbranch_scc1 L_p5_k6
    s_add_u32 s32, s43, 294912
    buffer_load_dwordx4 v[220:223], v1, s[4:7], s32 offen offset:0 sc1
    buffer_load_dwordx4 v[224:227], v1, s[4:7], s32 offen offset:1024 sc1
    buffer_load_dwordx4 v[228:231], v1, s[4:7], s32 offen offset:2048 sc1
    buffer_load_dwordx4 v[232:235], v1, s[4:7], s32 offen offset:3072 sc1
    s_add_u32 s32, s43, 299008
    buffer_load_dwordx4 v[236:239], v1, s[4:7], s32 offen offset:0 sc1
L_p5_k6:
    s_waitcnt vmcnt(18) lgkmcnt(0)
    s_cmp_eq_u32 s22, 0
    s_cbranch_scc1 L_wv_926
    s_waitcnt vmcnt(13)
L_wv_926:
    s_barrier
    s_mov_b32 s48, 6
    s_mul_i32 s50, s48, 18432
    s_add_u32 s50, s50, s34
    s_add_u32 s50, s50, 165888
    s_add_u32 m0, s30, 73728
    s_mov_b32 s53, s50
    buffer_load_dwordx4 v1, s[4:7], s50 offen offset:0  sc1 lds
    buffer_load_dwordx4 v1, s[4:7], s50 offen offset:1024  sc1 lds
    buffer_load_dwordx4 v1, s[4:7], s50 offen offset:2048  sc1 lds
    buffer_load_dwordx4 v1, s[4:7], s50 offen offset:3072  sc1 lds
    s_cmp_lg_u32 s22, 0
    s_cbranch_scc1 L_p5_k7
    s_add_u32 s32, s43, 299008
    buffer_load_dwordx4 v[240:243], v1, s[4:7], s32 offen offset:1024 sc1
    buffer_load_dwordx4 v[244:247], v1, s[4:7], s32 offen offset:2048 sc1
    buffer_load_dwordx4 v[248:251], v1, s[4:7], s32 offen offset:3072 sc1
    s_add_u32 s32, s43, 303104
    buffer_load_dwordx4 v[252:255], v1, s[4:7], s32 offen offset:0 sc1
    s_add_u32 s32, s43, 258048
    buffer_load_dwordx4 v[184:187], v1, s[4:7], s32 offen offset:0 sc1
L_p5_k7:
    s_waitcnt vmcnt(18) lgkmcnt(0)
    s_cmp_eq_u32 s22, 0
    s_cbranch_scc1 L_wv_953
    s_waitcnt vmcnt(8)
L_wv_953:
    s_barrier
    s_mov_b32 s48, 7
    s_mul_i32 s50, s48, 18432
    s_add_u32 s50, s50, s34
    s_add_u32 s50, s50, 165888
    s_cmp_ge_u32 s20, 2
    s_cselect_b32 s52, s50, s53
    s_add_u32 m0, s31, 73728
    s_add_u32 s52, s52, s49
    buffer_load_dwordx4 v1, s[4:7], s52 offen  sc1 lds
    s_add_u32 m0, s30, 110592
    s_mov_b32 s53, s50
    buffer_load_dwordx4 v1, s[4:7], s50 offen offset:0  sc1 lds
    buffer_load_dwordx4 v1, s[4:7], s50 offen offset:1024  sc1 lds
    buffer_load_dwordx4 v1, s[4:7], s50 offen offset:2048  sc1 lds
    buffer_load_dwordx4 v1, s[4:7], s50 offen offset:3072  sc1 lds
    s_cmp_lg_u32 s22, 0
    s_cbranch_scc1 L_p5_k8
    s_add_u32 s32, s43, 258048
    buffer_load_dwordx4 v[188:191], v1, s[4:7], s32 offen offset:1024 sc1
    buffer_load_dwordx4 v[192:195], v1, s[4:7], s32 offen offset:2048 sc1
    buffer_load_dwordx4 v[196:199], v1, s[4:7], s32 offen offset:3072 sc1
    s_add_u32 s32, s43, 262144
    buffer_load_dwordx4 v[200:203], v1, s[4:7], s32 offen offset:0 sc1
    buffer_load_dwordx4 v[204:207], v1, s[4:7], s32 offen offset:1024 sc1
L_p5_k8:
    s_waitcnt vmcnt(24) lgkmcnt(0)
    s_cmp_eq_u32 s22, 0
    s_cbranch_scc1 L_wv_984
    s_waitcnt vmcnt(9)
L_wv_984:
    s_barrier
    s_mov_b32 s48, 8
    s_mul_i32 s50, s48, 18432
    s_add_u32 s50, s50, s34
    s_add_u32 s50, s50, 165888
    s_add_u32 m0, s30, 0
    s_mov_b32 s53, s50
    buffer_load_dwordx4 v1, s[4:7], s50 offen offset:0  sc1 lds
    buffer_load_dwordx4 v1, s[4:7], s50 offen offset:1024  sc1 lds
    buffer_load_dwordx4 v1, s[4:7], s50 offen offset:2048  sc1 lds
    buffer_load_dwordx4 v1, s[4:7], s50 offen offset:3072  sc1 lds
    s_cmp_lg_u32 s22, 0
    s_cbranch_scc1 L_p5_k9
    s_add_u32 s32, s43, 262144
    buffer_load_dwordx4 v[208:211], v1, s[4:7], s32 offen offset:2048 sc1
    buffer_load_dwordx4 v[212:215], v1, s[4:7], s32 offen offset:3072 sc1
    s_add_u32 s32, s43, 266240
    buffer_load_dwordx4 v[216:219], v1, s[4:7], s32 offen offset:0 sc1
    s_add_u32 s32, s43, 221184
    buffer_load_dwordx4 v[148:151], v1, s[4:7], s32 offen offset:0 sc1
    buffer_load_dwordx4 v[152:155], v1, s[4:7], s32 offen offset:1024 sc1
    buffer_load_dwordx4 v[156:159], v1, s[4:7], s32 offen offset:2048 sc1
    buffer_load_dwordx4 v[160:163], v1, s[4:7], s32 offen offset:3072 sc1
    s_add_u32 s32, s43, 225280
    buffer_load_dwordx4 v[164:167], v1, s[4:7], s32 offen offset:0 sc1
    buffer_load_dwordx4 v[168:171], v1, s[4:7], s32 offen offset:1024 sc1
    buffer_load_dwordx4 v[172:175], v1, s[4:7], s32 offen offset:2048 sc1
    buffer_load_dwordx4 v[176:179], v1, s[4:7], s32 offen offset:3072 sc1
    s_add_u32 s32, s43, 229376
    buffer_load_dwordx4 v[180:183], v1, s[4:7], s32 offen offset:0 sc1
    s_add_u32 s32, s43, 184320
    buffer_load_dwordx4 v[112:115], v1, s[4:7], s32 offen offset:0 sc1
    buffer_load_dwordx4 v[116:119], v1, s[4:7], s32 offen offset:1024 sc1
    buffer_load_dwordx4 v[120:123], v1, s[4:7], s32 offen offset:2048 sc1
    buffer_load_dwordx4 v[124:127], v1, s[4:7], s32 offen offset:3072 sc1
    s_add_u32 s32, s43, 188416
    buffer_load_dwordx4 v[128:131], v1, s[4:7], s32 offen offset:0 sc1
    buffer_load_dwordx4 v[132:135], v1, s[4:7], s32 offen offset:1024 sc1
    buffer_load_dwordx4 v[136:139], v1, s[4:7], s32 offen offset:2048 sc1
    buffer_load_dwordx4 v[140:143], v1, s[4:7], s32 offen offset:3072 sc1
    s_add_u32 s32, s43, 192512
    buffer_load_dwordx4 v[144:147], v1, s[4:7], s32 offen offset:0 sc1
    s_add_u32 s32, s43, 147456
    buffer_load_dwordx4 v[76:79], v1, s[4:7], s32 offen offset:0 sc1
    buffer_load_dwordx4 v[80:83], v1, s[4:7], s32 offen offset:1024 sc1
    buffer_load_dwordx4 v[84:87], v1, s[4:7], s32 offen offset:2048 sc1
    buffer_load_dwordx4 v[88:91], v1, s[4:7], s32 offen offset:3072 sc1
    s_add_u32 s32, s43, 151552
    buffer_load_dwordx4 v[92:95], v1, s[4:7], s32 offen offset:0 sc1
    buffer_load_dwordx4 v[96:99], v1, s[4:7], s32 offen offset:1024 sc1
    buffer_load_dwordx4 v[100:103], v1, s[4:7], s32 offen offset:2048 sc1
    buffer_load_dwordx4 v[104:107], v1, s[4:7], s32 offen offset:3072 sc1
    s_add_u32 s32, s43, 155648
    buffer_load_dwordx4 v[108:111], v1, s[4:7], s32 offen offset:0 sc1
L_p5_k9:
    s_waitcnt vmcnt(43) lgkmcnt(0)
    s_cmp_eq_u32 s22, 0
    s_cbranch_scc1 L_wv_1044
    s_waitcnt vmcnt(8)
L_wv_1044:
    s_barrier
    s_mov_b32 s48, 0
    s_mul_i32 s50, s48, 18432
    s_add_u32 s50, s50, s34
    s_add_u32 s50, s50, 165888
    s_cmp_ge_u32 s20, 2
    s_cselect_b32 s52, s50, s53
    s_add_u32 m0, s31, 0
    s_add_u32 s52, s52, s49
    buffer_load_dwordx4 v1, s[4:7], s52 offen  sc1 lds
    s_add_u32 m0, s30, 36864
    s_mov_b32 s53, s50
    buffer_load_dwordx4 v1, s[4:7], s50 offen offset:0  sc1 lds
    buffer_load_dwordx4 v1, s[4:7], s50 offen offset:1024  sc1 lds
    buffer_load_dwordx4 v1, s[4:7], s50 offen offset:2048  sc1 lds
    buffer_load_dwordx4 v1, s[4:7], s50 offen offset:3072  sc1 lds
    s_add_u32 m0, s30, 55296
    s_add_u32 s51, s35, 0
    buffer_load_dwordx4 v1, s[4:7], s51 offen offset:0 sc1 lds
    buffer_load_dwordx4 v1, s[4:7], s51 offen offset:1024 sc1 lds
    buffer_load_dwordx4 v2, s[4:7], s51 offen offset:2048 sc1 lds
    buffer_load_dwordx4 v2, s[4:7], s51 offen offset:3072 sc1 lds
    s_waitcnt vmcnt(48) lgkmcnt(0)
    s_cmp_eq_u32 s22, 0
    s_cbranch_scc1 L_wv_1071
    s_waitcnt vmcnt(13)
L_wv_1071:
    s_barrier
    buffer_load_dwordx4 v[16:19], v3, s[4:7], s29 offen offset:0 sc1
    buffer_load_dwordx4 v[20:23], v3, s[4:7], s29 offen offset:1024 sc1
    buffer_load_dwordx4 v[24:27], v3, s[4:7], s29 offen offset:2048 sc1
    buffer_load_dwordx4 v[28:31], v3, s[4:7], s29 offen offset:3072 sc1
    s_mov_b32 s48, 1
    s_mul_i32 s50, s48, 18432
    s_add_u32 s50, s50, s34
    s_add_u32 s50, s50, 165888
    s_add_u32 m0, s30, 73728
    s_mov_b32 s53, s50
    buffer_load_dwordx4 v1, s[4:7], s50 offen offset:0  sc1 lds
    buffer_load_dwordx4 v1, s[4:7], s50 offen offset:1024  sc1 lds
    buffer_load_dwordx4 v1, s[4:7], s50 offen offset:2048  sc1 lds
    buffer_load_dwordx4 v1, s[4:7], s50 offen offset:3072  sc1 lds
    s_add_u32 m0, s30, 92160
    s_add_u32 s51, s35, 2048
    buffer_load_dwordx4 v1, s[4:7], s51 offen offset:0 sc1 lds
    buffer_load_dwordx4 v1, s[4:7], s51 offen offset:1024 sc1 lds
    buffer_load_dwordx4 v2, s[4:7], s51 offen offset:2048 sc1 lds
    buffer_load_dwordx4 v2, s[4:7], s51 offen offset:3072 sc1 lds
    s_waitcnt vmcnt(20) lgkmcnt(0)
    s_barrier
    s_mov_b32 s60, 262144
    s_waitcnt vmcnt(8)
L_g_chk:
    v_or3_b32 v32, v17, v19, v21
    v_or3_b32 v33, v23, v25, v27
    v_or3_b32 v32, v29, v31, v32
    v_or_b32 v32, v32, v33
    v_cmp_gt_i32 vcc, 0, v32
    s_sub_u32 s60, s60, 1
    s_cbranch_scc1 L_g_ok
    s_cbranch_vccz L_g_ok
    buffer_load_dwordx4 v[16:19], v3, s[4:7], s29 offen offset:0 sc1
    buffer_load_dwordx4 v[20:23], v3, s[4:7], s29 offen offset:1024 sc1
    buffer_load_dwordx4 v[24:27], v3, s[4:7], s29 offen offset:2048 sc1
    buffer_load_dwordx4 v[28:31], v3, s[4:7], s29 offen offset:3072 sc1
    s_waitcnt vmcnt(0)
    s_branch L_g_chk
    s_nop 0
L_g_ok:
    s_mov_b32 s48, 2
    s_mul_i32 s50, s48, 18432
    s_add_u32 s50, s50, s34
    s_add_u32 s50, s50, 165888
    s_cmp_ge_u32 s20, 2
    s_cselect_b32 s52, s50, s53
    s_add_u32 m0, s31, 73728
    s_add_u32 s52, s52, s49
    buffer_load_dwordx4 v1, s[4:7], s52 offen  sc1 lds
    v_add_f32 v16, v16, v20
    v_add_f32 v24, v24, v28
    v_add_f32 v17, v17, v21
    v_add_f32 v25, v25, v29
    v_add_f32_e64 v18, v18, v22
    s_add_u32 m0, s30, 110592
    s_mov_b32 s53, s50
    buffer_load_dwordx4 v1, s[4:7], s50 offen offset:0  sc1 lds
    v_add_f32 v26, v26, v30
    v_add_f32 v19, v19, v23
    v_add_f32 v27, v27, v31
    v_add_f32 v16, v16, v24
    v_add_f32 v17, v17, v25
    buffer_load_dwordx4 v1, s[4:7], s50 offen offset:1024  sc1 lds
    v_add_f32 v18, v18, v26
    v_add_f32 v19, v19, v27
    v_add_f32_dpp v16, v16, v16 row_ror:4 row_mask:0xf bank_mask:0xf
    v_add_f32_dpp v17, v17, v17 row_ror:4 row_mask:0xf bank_mask:0xf
    v_add_f32_dpp v18, v18, v18 row_ror:4 row_mask:0xf bank_mask:0xf
    buffer_load_dwordx4 v1, s[4:7], s50 offen offset:2048  sc1 lds
    v_add_f32_dpp v19, v19, v19 row_ror:4 row_mask:0xf bank_mask:0xf
    v_add_f32_dpp v16, v16, v16 row_ror:8 row_mask:0xf bank_mask:0xf
    v_add_f32_dpp v17, v17, v17 row_ror:8 row_mask:0xf bank_mask:0xf
    v_add_f32_dpp v18, v18, v18 row_ror:8 row_mask:0xf bank_mask:0xf
    v_add_f32_dpp v19, v19, v19 row_ror:8 row_mask:0xf bank_mask:0xf
    buffer_load_dwordx4 v1, s[4:7], s50 offen offset:3072  sc1 lds
    v_mul_f32 v16, 0x39e38e39, v16
    v_mul_f32 v17, 0x39e38e39, v17
    v_mul_f32 v18, 0x39e38e39, v18
    v_mul_f32 v19, 0x39e38e39, v19
    v_fma_f32 v17, -v16, v16, v17
    s_add_u32 m0, s30, 129024
    s_add_u32 s51, s35, 4096
    buffer_load_dwordx4 v1, s[4:7], s51 offen offset:0 sc1 lds
    v_fma_f32 v19, -v18, v18, v19
    v_max_f32 v17, 0, v17
    v_max_f32 v19, 0, v19
    v_add_f32 v17, 0x3727c5ac, v17
    v_add_f32 v19, 0x3727c5ac, v19
    buffer_load_dwordx4 v1, s[4:7], s51 offen offset:1024 sc1 lds
    v_rsq_f32 v20, v17
    v_rsq_f32 v21, v19
    v_and_b32 v32, 0xff, v3
    s_lshl_b32 s33, s20, 8
    s_add_u32 s33, s33, 148480
    buffer_load_dwordx4 v2, s[4:7], s51 offen offset:2048 sc1 lds
    v_add_u32 v32, s33, v32
    v_mul_f32 v22, v16, v20
    v_mul_f32 v23, v18, v21
    ds_write_b128 v32, v[20:23]
    buffer_load_dwordx4 v2, s[4:7], s51 offen offset:3072 sc1 lds
    s_waitcnt vmcnt(17) lgkmcnt(0)
    s_barrier
    s_mov_b32 s48, 3
    s_mul_i32 s50, s48, 18432
    s_add_u32 s50, s50, s34
    s_add_u32 s50, s50, 165888
    s_add_u32 m0, s30, 0
    s_mov_b32 s53, s50
    buffer_load_dwordx4 v1, s[4:7], s50 offen offset:0  sc1 lds
    buffer_load_dwordx4 v1, s[4:7], s50 offen offset:1024  sc1 lds
    buffer_load_dwordx4 v1, s[4:7], s50 offen offset:2048  sc1 lds
    buffer_load_dwordx4 v1, s[4:7], s50 offen offset:3072  sc1 lds
    s_add_u32 m0, s30, 18432
    s_add_u32 s51, s35, 6144
    buffer_load_dwordx4 v1, s[4:7], s51 offen offset:0 sc1 lds
    buffer_load_dwordx4 v1, s[4:7], s51 offen offset:1024 sc1 lds
    buffer_load_dwordx4 v2, s[4:7], s51 offen offset:2048 sc1 lds
    buffer_load_dwordx4 v2, s[4:7], s51 offen offset:3072 sc1 lds
    s_waitcnt vmcnt(16) lgkmcnt(0)
    s_barrier
    s_mov_b32 s48, 4
    s_mul_i32 s50, s48, 18432
    s_add_u32 s50, s50, s34
    s_add_u32 s50, s50, 165888
    s_cmp_ge_u32 s20, 2
    s_cselect_b32 s52, s50, s53
    s_add_u32 m0, s31, 0
    s_add_u32 s52, s52, s49
    buffer_load_dwordx4 v1, s[4:7], s52 offen  sc1 lds
    s_add_u32 m0, s30, 36864
    s_mov_b32 s53, s50
    buffer_load_dwordx4 v1, s[4:7], s50 offen offset:0  sc1 lds
    buffer_load_dwordx4 v1, s[4:7], s50 offen offset:1024  sc1 lds
    buffer_load_dwordx4 v1, s[4:7], s50 offen offset:2048  sc1 lds
    buffer_load_dwordx4 v1, s[4:7], s50 offen offset:3072  sc1 lds
    s_add_u32 m0, s30, 55296
    s_add_u32 s51, s35, 8192
    buffer_load_dwordx4 v1, s[4:7], s51 offen offset:0 sc1 lds
    buffer_load_dwordx4 v1, s[4:7], s51 offen offset:1024 sc1 lds
    buffer_load_dwordx4 v2, s[4:7], s51 offen offset:2048 sc1 lds
    buffer_load_dwordx4 v2, s[4:7], s51 offen offset:3072 sc1 lds
    s_waitcnt vmcnt(17) lgkmcnt(0)
    s_barrier
    s_waitcnt vmcnt(8) lgkmcnt(0)
    s_barrier
    s_waitcnt vmcnt(0) lgkmcnt(0)
    s_barrier
    s_barrier
    s_mov_b32 s56, 1
    s_atomic_add s56, s[54:55], 0
    s_mov_b32 s57, 0
    s_atomic_add s57, s[54:55], 0 glc
    s_lshl_b32 s48, s23, 1
    s_add_u32 s48, s48, 0
    s_add_u32 m0, s30, 92160
    s_lshl_b32 s51, s48, 7
    buffer_load_dwordx4 v8, s[8:11], s51 offen offset:0  lds
    buffer_load_dwordx4 v9, s[8:11], s51 offen offset:1024  lds
    buffer_load_dwordx4 v10, s[8:11], s51 offen offset:2048  lds
    buffer_load_dwordx4 v11, s[8:11], s51 offen offset:3072  lds
    s_lshl_b32 s48, s23, 1
    s_add_u32 s48, s48, 1
    s_add_u32 m0, s30, 129024
    s_lshl_b32 s51, s48, 7
    buffer_load_dwordx4 v8, s[8:11], s51 offen offset:0  lds
    buffer_load_dwordx4 v9, s[8:11], s51 offen offset:1024  lds
    buffer_load_dwordx4 v10, s[8:11], s51 offen offset:2048  lds
    buffer_load_dwordx4 v11, s[8:11], s51 offen offset:3072  lds
    s_lshr_b32 s48, s46, 1
    s_cmp_eq_u32 s48, s23
    s_cselect_b32 s48, 1, 31
    s_and_b32 s48, s48, s46
    s_add_u32 m0, s30, 18432
    s_lshl_b32 s51, s48, 7
    buffer_load_dwordx4 v8, s[8:11], s51 offen offset:0  lds
    buffer_load_dwordx4 v9, s[8:11], s51 offen offset:1024  lds
    buffer_load_dwordx4 v10, s[8:11], s51 offen offset:2048  lds
    buffer_load_dwordx4 v11, s[8:11], s51 offen offset:3072  lds
    s_waitcnt lgkmcnt(0)
    s_cmp_ge_u32 s57, 16
    s_cbranch_scc1 L_g_r0
    s_mov_b32 s57, 0
    s_atomic_add s57, s[54:55], 0 glc
    s_waitcnt vmcnt(8)
    s_barrier
    s_waitcnt lgkmcnt(0)
    s_cmp_ge_u32 s57, 16
    s_cbranch_scc1 L_g_r1
    s_waitcnt vmcnt(4)
    s_barrier
    s_mov_b32 s60, 262144
L_poll_z2:
    s_mov_b32 s57, 0
    s_atomic_add s57, s[54:55], 0 glc
    s_waitcnt lgkmcnt(0)
    s_cmp_ge_u32 s57, 16
    s_cbranch_scc1 L_pd_z2
    s_sub_u32 s60, s60, 1
    s_cbranch_scc1 L_pd_z2
    s_sleep 2
    s_branch L_poll_z2
L_pd_z2:
    s_lshr_b32 s48, s46, 1
    s_cmp_eq_u32 s48, s23
    s_cselect_b32 s48, 1, 31
    s_and_b32 s48, s48, s46
    s_mul_i32 s50, s48, 18432
    s_add_u32 s50, s50, s36
    s_add_u32 m0, s30, 0
    s_mov_b32 s53, s50
    buffer_load_dwordx4 v1, s[4:7], s50 offen offset:0 sc1 lds
    buffer_load_dwordx4 v1, s[4:7], s50 offen offset:1024 sc1 lds
    buffer_load_dwordx4 v1, s[4:7], s50 offen offset:2048 sc1 lds
    buffer_load_dwordx4 v1, s[4:7], s50 offen offset:3072 sc1 lds
    s_lshr_b32 s48, s47, 1
    s_cmp_eq_u32 s48, s23
    s_cselect_b32 s48, 1, 31
    s_and_b32 s48, s48, s47
    s_mul_i32 s50, s48, 18432
    s_add_u32 s50, s50, s36
    s_cmp_ge_u32 s20, 2
    s_cselect_b32 s52, s50, s53
    s_add_u32 m0, s31, 0
    s_add_u32 s52, s52, s49
    buffer_load_dwordx4 v1, s[4:7], s52 offen sc1 lds
    s_add_u32 m0, s30, 36864
    s_mov_b32 s53, s50
    buffer_load_dwordx4 v1, s[4:7], s50 offen offset:0 sc1 lds
    buffer_load_dwordx4 v1, s[4:7], s50 offen offset:1024 sc1 lds
    buffer_load_dwordx4 v1, s[4:7], s50 offen offset:2048 sc1 lds
    buffer_load_dwordx4 v1, s[4:7], s50 offen offset:3072 sc1 lds
    s_lshr_b32 s48, s47, 1
    s_cmp_eq_u32 s48, s23
    s_cselect_b32 s48, 1, 31
    s_and_b32 s48, s48, s47
    s_add_u32 m0, s30, 55296
    s_lshl_b32 s51, s48, 7
    buffer_load_dwordx4 v8, s[8:11], s51 offen offset:0  lds
    buffer_load_dwordx4 v9, s[8:11], s51 offen offset:1024  lds
    buffer_load_dwordx4 v10, s[8:11], s51 offen offset:2048  lds
    buffer_load_dwordx4 v11, s[8:11], s51 offen offset:3072  lds
    s_branch L_g_jn
    s_nop 0
L_g_r0:
    s_lshr_b32 s48, s46, 1
    s_cmp_eq_u32 s48, s23
    s_cselect_b32 s48, 1, 31
    s_and_b32 s48, s48, s46
    s_mul_i32 s50, s48, 18432
    s_add_u32 s50, s50, s36
    s_add_u32 m0, s30, 0
    s_mov_b32 s53, s50
    buffer_load_dwordx4 v1, s[4:7], s50 offen offset:0 sc1 lds
    buffer_load_dwordx4 v1, s[4:7], s50 offen offset:1024 sc1 lds
    buffer_load_dwordx4 v1, s[4:7], s50 offen offset:2048 sc1 lds
    buffer_load_dwordx4 v1, s[4:7], s50 offen offset:3072 sc1 lds
    s_lshr_b32 s48, s47, 1
    s_cmp_eq_u32 s48, s23
    s_cselect_b32 s48, 1, 31
    s_and_b32 s48, s48, s47
    s_mul_i32 s50, s48, 18432
    s_add_u32 s50, s50, s36
    s_cmp_ge_u32 s20, 2
    s_cselect_b32 s52, s50, s53
    s_add_u32 m0, s31, 0
    s_add_u32 s52, s52, s49
    buffer_load_dwordx4 v1, s[4:7], s52 offen sc1 lds
    s_add_u32 m0, s30, 36864
    s_mov_b32 s53, s50
    buffer_load_dwordx4 v1, s[4:7], s50 offen offset:0 sc1 lds
    buffer_load_dwordx4 v1, s[4:7], s50 offen offset:1024 sc1 lds
    buffer_load_dwordx4 v1, s[4:7], s50 offen offset:2048 sc1 lds
    buffer_load_dwordx4 v1, s[4:7], s50 offen offset:3072 sc1 lds
    s_lshr_b32 s48, s47, 1
    s_cmp_eq_u32 s48, s23
    s_cselect_b32 s48, 1, 31
    s_and_b32 s48, s48, s47
    s_add_u32 m0, s30, 55296
    s_lshl_b32 s51, s48, 7
    buffer_load_dwordx4 v8, s[8:11], s51 offen offset:0  lds
    buffer_load_dwordx4 v9, s[8:11], s51 offen offset:1024  lds
    buffer_load_dwordx4 v10, s[8:11], s51 offen offset:2048  lds
    buffer_load_dwordx4 v11, s[8:11], s51 offen offset:3072  lds
    s_waitcnt vmcnt(21)
    s_barrier
    s_waitcnt vmcnt(17)
    s_barrier
    s_branch L_g_jn
    s_nop 0
L_g_r1:
    s_lshr_b32 s48, s46, 1
    s_cmp_eq_u32 s48, s23
    s_cselect_b32 s48, 1, 31
    s_and_b32 s48, s48, s46
    s_mul_i32 s50, s48, 18432
    s_add_u32 s50, s50, s36
    s_add_u32 m0, s30, 0
    s_mov_b32 s53, s50
    buffer_load_dwordx4 v1, s[4:7], s50 offen offset:0 sc1 lds
    buffer_load_dwordx4 v1, s[4:7], s50 offen offset:1024 sc1 lds
    buffer_load_dwordx4 v1, s[4:7], s50 offen offset:2048 sc1 lds
    buffer_load_dwordx4 v1, s[4:7], s50 offen offset:3072 sc1 lds
    s_lshr_b32 s48, s47, 1
    s_cmp_eq_u32 s48, s23
    s_cselect_b32 s48, 1, 31
    s_and_b32 s48, s48, s47
    s_mul_i32 s50, s48, 18432
    s_add_u32 s50, s50, s36
    s_cmp_ge_u32 s20, 2
    s_cselect_b32 s52, s50, s53
    s_add_u32 m0, s31, 0
    s_add_u32 s52, s52, s49
    buffer_load_dwordx4 v1, s[4:7], s52 offen sc1 lds
    s_add_u32 m0, s30, 36864
    s_mov_b32 s53, s50
    buffer_load_dwordx4 v1, s[4:7], s50 offen offset:0 sc1 lds
    buffer_load_dwordx4 v1, s[4:7], s50 offen offset:1024 sc1 lds
    buffer_load_dwordx4 v1, s[4:7], s50 offen offset:2048 sc1 lds
    buffer_load_dwordx4 v1, s[4:7], s50 offen offset:3072 sc1 lds
    s_lshr_b32 s48, s47, 1
    s_cmp_eq_u32 s48, s23
    s_cselect_b32 s48, 1, 31
    s_and_b32 s48, s48, s47
    s_add_u32 m0, s30, 55296
    s_lshl_b32 s51, s48, 7
    buffer_load_dwordx4 v8, s[8:11], s51 offen offset:0  lds
    buffer_load_dwordx4 v9, s[8:11], s51 offen offset:1024  lds
    buffer_load_dwordx4 v10, s[8:11], s51 offen offset:2048  lds
    buffer_load_dwordx4 v11, s[8:11], s51 offen offset:3072  lds
    s_waitcnt vmcnt(17)
    s_barrier
L_g_jn:
    s_add_u32 s44, s44, 4
    s_cmp_ge_u32 s44, 32
    s_cselect_b32 s44, 4, s44
    s_add_u32 s45, s45, 4
    s_cmp_ge_u32 s45, 32
    s_cselect_b32 s45, 5, s45
    s_add_u32 s46, s46, 4
    s_and_b32 s46, s46, 31
    s_add_u32 s47, s47, 4
    s_and_b32 s47, s47, 31
    s_lshr_b32 s48, s44, 1
    s_cmp_eq_u32 s48, s23
    s_cselect_b32 s48, 1, 31
    s_and_b32 s48, s48, s44
    s_mul_i32 s50, s48, 18432
    s_add_u32 s50, s50, s36
    s_add_u32 m0, s30, 73728
    s_mov_b32 s53, s50
    buffer_load_dwordx4 v1, s[4:7], s50 offen offset:0 sc1 lds
    buffer_load_dwordx4 v1, s[4:7], s50 offen offset:1024 sc1 lds
    buffer_load_dwordx4 v1, s[4:7], s50 offen offset:2048 sc1 lds
    buffer_load_dwordx4 v1, s[4:7], s50 offen offset:3072 sc1 lds
    s_lshr_b32 s48, s44, 1
    s_cmp_eq_u32 s48, s23
    s_cselect_b32 s48, 1, 31
    s_and_b32 s48, s48, s44
    s_add_u32 m0, s30, 92160
    s_lshl_b32 s51, s48, 7
    buffer_load_dwordx4 v8, s[8:11], s51 offen offset:0  lds
    buffer_load_dwordx4 v9, s[8:11], s51 offen offset:1024  lds
    buffer_load_dwordx4 v10, s[8:11], s51 offen offset:2048  lds
    buffer_load_dwordx4 v11, s[8:11], s51 offen offset:3072  lds
    s_add_u32 s44, s44, 4
    s_cmp_ge_u32 s44, 32
    s_cselect_b32 s44, 4, s44
    s_waitcnt vmcnt(16)
    s_barrier
    s_lshr_b32 s48, s45, 1
    s_cmp_eq_u32 s48, s23
    s_cselect_b32 s48, 1, 31
    s_and_b32 s48, s48, s45
    s_mul_i32 s50, s48, 18432
    s_add_u32 s50, s50, s36
    s_cmp_ge_u32 s20, 2
    s_cselect_b32 s52, s50, s53
    s_add_u32 m0, s31, 73728
    s_add_u32 s52, s52, s49
    buffer_load_dwordx4 v1, s[4:7], s52 offen sc1 lds
    s_add_u32 m0, s30, 110592
    s_mov_b32 s53, s50
    buffer_load_dwordx4 v1, s[4:7], s50 offen offset:0 sc1 lds
    buffer_load_dwordx4 v1, s[4:7], s50 offen offset:1024 sc1 lds
    buffer_load_dwordx4 v1, s[4:7], s50 offen offset:2048 sc1 lds
    buffer_load_dwordx4 v1, s[4:7], s50 offen offset:3072 sc1 lds
    s_lshr_b32 s48, s45, 1
    s_cmp_eq_u32 s48, s23
    s_cselect_b32 s48, 1, 31
    s_and_b32 s48, s48, s45
    s_add_u32 m0, s30, 129024
    s_lshl_b32 s51, s48, 7
    buffer_load_dwordx4 v8, s[8:11], s51 offen offset:0  lds
    buffer_load_dwordx4 v9, s[8:11], s51 offen offset:1024  lds
    buffer_load_dwordx4 v10, s[8:11], s51 offen offset:2048  lds
    buffer_load_dwordx4 v11, s[8:11], s51 offen offset:3072  lds
    s_add_u32 s45, s45, 4
    s_cmp_ge_u32 s45, 32
    s_cselect_b32 s45, 5, s45
    s_waitcnt vmcnt(17)
    s_barrier
    s_lshr_b32 s48, s46, 1
    s_cmp_eq_u32 s48, s23
    s_cselect_b32 s48, 1, 31
    s_and_b32 s48, s48, s46
    s_mul_i32 s50, s48, 18432
    s_add_u32 s50, s50, s36
    s_add_u32 m0, s30, 0
    s_mov_b32 s53, s50
    buffer_load_dwordx4 v1, s[4:7], s50 offen offset:0 sc1 lds
    buffer_load_dwordx4 v1, s[4:7], s50 offen offset:1024 sc1 lds
    buffer_load_dwordx4 v1, s[4:7], s50 offen offset:2048 sc1 lds
    buffer_load_dwordx4 v1, s[4:7], s50 offen offset:3072 sc1 lds
    s_lshr_b32 s48, s46, 1
    s_cmp_eq_u32 s48, s23
    s_cselect_b32 s48, 1, 31
    s_and_b32 s48, s48, s46
    s_add_u32 m0, s30, 18432
    s_lshl_b32 s51, s48, 7
    buffer_load_dwordx4 v8, s[8:11], s51 offen offset:0  lds
    buffer_load_dwordx4 v9, s[8:11], s51 offen offset:1024  lds
    buffer_load_dwordx4 v10, s[8:11], s51 offen offset:2048  lds
    buffer_load_dwordx4 v11, s[8:11], s51 offen offset:3072  lds
    s_add_u32 s46, s46, 4
    s_and_b32 s46, s46, 31
    s_waitcnt vmcnt(16)
    s_barrier
    s_lshr_b32 s48, s47, 1
    s_cmp_eq_u32 s48, s23
    s_cselect_b32 s48, 1, 31
    s_and_b32 s48, s48, s47
    s_mul_i32 s50, s48, 18432
    s_add_u32 s50, s50, s36
    s_cmp_ge_u32 s20, 2
    s_cselect_b32 s52, s50, s53
    s_add_u32 m0, s31, 0
    s_add_u32 s52, s52, s49
    buffer_load_dwordx4 v1, s[4:7], s52 offen sc1 lds
    s_add_u32 m0, s30, 36864
    s_mov_b32 s53, s50
    buffer_load_dwordx4 v1, s[4:7], s50 offen offset:0 sc1 lds
    buffer_load_dwordx4 v1, s[4:7], s50 offen offset:1024 sc1 lds
    buffer_load_dwordx4 v1, s[4:7], s50 offen offset:2048 sc1 lds
    buffer_load_dwordx4 v1, s[4:7], s50 offen offset:3072 sc1 lds
    s_lshr_b32 s48, s47, 1
    s_cmp_eq_u32 s48, s23
    s_cselect_b32 s48, 1, 31
    s_and_b32 s48, s48, s47
    s_add_u32 m0, s30, 55296
    s_lshl_b32 s51, s48, 7
    buffer_load_dwordx4 v8, s[8:11], s51 offen offset:0  lds
    buffer_load_dwordx4 v9, s[8:11], s51 offen offset:1024  lds
    buffer_load_dwordx4 v10, s[8:11], s51 offen offset:2048  lds
    buffer_load_dwordx4 v11, s[8:11], s51 offen offset:3072  lds
    s_add_u32 s47, s47, 4
    s_and_b32 s47, s47, 31
    s_mov_b32 s41, 6
L_g_ll:
    s_waitcnt vmcnt(17)
    s_barrier
    s_lshr_b32 s48, s44, 1
    s_cmp_eq_u32 s48, s23
    s_cselect_b32 s48, 1, 31
    s_and_b32 s48, s48, s44
    s_mul_i32 s50, s48, 18432
    s_add_u32 s50, s50, s36
    s_add_u32 m0, s30, 73728
    s_mov_b32 s53, s50
    buffer_load_dwordx4 v1, s[4:7], s50 offen offset:0 sc1 lds
    buffer_load_dwordx4 v1, s[4:7], s50 offen offset:1024 sc1 lds
    buffer_load_dwordx4 v1, s[4:7], s50 offen offset:2048 sc1 lds
    buffer_load_dwordx4 v1, s[4:7], s50 offen offset:3072 sc1 lds
    s_lshr_b32 s48, s44, 1
    s_cmp_eq_u32 s48, s23
    s_cselect_b32 s48, 1, 31
    s_and_b32 s48, s48, s44
    s_add_u32 m0, s30, 92160
    s_lshl_b32 s51, s48, 7
    buffer_load_dwordx4 v8, s[8:11], s51 offen offset:0  lds
    buffer_load_dwordx4 v9, s[8:11], s51 offen offset:1024  lds
    buffer_load_dwordx4 v10, s[8:11], s51 offen offset:2048  lds
    buffer_load_dwordx4 v11, s[8:11], s51 offen offset:3072  lds
    s_add_u32 s44, s44, 4
    s_cmp_ge_u32 s44, 32
    s_cselect_b32 s44, 4, s44
    s_waitcnt vmcnt(16)
    s_barrier
    s_lshr_b32 s48, s45, 1
    s_cmp_eq_u32 s48, s23
    s_cselect_b32 s48, 1, 31
    s_and_b32 s48, s48, s45
    s_mul_i32 s50, s48, 18432
    s_add_u32 s50, s50, s36
    s_cmp_ge_u32 s20, 2
    s_cselect_b32 s52, s50, s53
    s_add_u32 m0, s31, 73728
    s_add_u32 s52, s52, s49
    buffer_load_dwordx4 v1, s[4:7], s52 offen sc1 lds
    s_add_u32 m0, s30, 110592
    s_mov_b32 s53, s50
    buffer_load_dwordx4 v1, s[4:7], s50 offen offset:0 sc1 lds
    buffer_load_dwordx4 v1, s[4:7], s50 offen offset:1024 sc1 lds
    buffer_load_dwordx4 v1, s[4:7], s50 offen offset:2048 sc1 lds
    buffer_load_dwordx4 v1, s[4:7], s50 offen offset:3072 sc1 lds
    s_lshr_b32 s48, s45, 1
    s_cmp_eq_u32 s48, s23
    s_cselect_b32 s48, 1, 31
    s_and_b32 s48, s48, s45
    s_add_u32 m0, s30, 129024
    s_lshl_b32 s51, s48, 7
    buffer_load_dwordx4 v8, s[8:11], s51 offen offset:0  lds
    buffer_load_dwordx4 v9, s[8:11], s51 offen offset:1024  lds
    buffer_load_dwordx4 v10, s[8:11], s51 offen offset:2048  lds
    buffer_load_dwordx4 v11, s[8:11], s51 offen offset:3072  lds
    s_add_u32 s45, s45, 4
    s_cmp_ge_u32 s45, 32
    s_cselect_b32 s45, 5, s45
    s_waitcnt vmcnt(17)
    s_barrier
    s_lshr_b32 s48, s46, 1
    s_cmp_eq_u32 s48, s23
    s_cselect_b32 s48, 1, 31
    s_and_b32 s48, s48, s46
    s_mul_i32 s50, s48, 18432
    s_add_u32 s50, s50, s36
    s_add_u32 m0, s30, 0
    s_mov_b32 s53, s50
    buffer_load_dwordx4 v1, s[4:7], s50 offen offset:0 sc1 lds
    buffer_load_dwordx4 v1, s[4:7], s50 offen offset:1024 sc1 lds
    buffer_load_dwordx4 v1, s[4:7], s50 offen offset:2048 sc1 lds
    buffer_load_dwordx4 v1, s[4:7], s50 offen offset:3072 sc1 lds
    s_lshr_b32 s48, s46, 1
    s_cmp_eq_u32 s48, s23
    s_cselect_b32 s48, 1, 31
    s_and_b32 s48, s48, s46
    s_add_u32 m0, s30, 18432
    s_lshl_b32 s51, s48, 7
    buffer_load_dwordx4 v8, s[8:11], s51 offen offset:0  lds
    buffer_load_dwordx4 v9, s[8:11], s51 offen offset:1024  lds
    buffer_load_dwordx4 v10, s[8:11], s51 offen offset:2048  lds
    buffer_load_dwordx4 v11, s[8:11], s51 offen offset:3072  lds
    s_add_u32 s46, s46, 4
    s_and_b32 s46, s46, 31
    s_waitcnt vmcnt(16)
    s_barrier
    s_lshr_b32 s48, s47, 1
    s_cmp_eq_u32 s48, s23
    s_cselect_b32 s48, 1, 31
    s_and_b32 s48, s48, s47
    s_mul_i32 s50, s48, 18432
    s_add_u32 s50, s50, s36
    s_cmp_ge_u32 s20, 2
    s_cselect_b32 s52, s50, s53
    s_add_u32 m0, s31, 0
    s_add_u32 s52, s52, s49
    buffer_load_dwordx4 v1, s[4:7], s52 offen sc1 lds
    s_add_u32 m0, s30, 36864
    s_mov_b32 s53, s50
    buffer_load_dwordx4 v1, s[4:7], s50 offen offset:0 sc1 lds
    buffer_load_dwordx4 v1, s[4:7], s50 offen offset:1024 sc1 lds
    buffer_load_dwordx4 v1, s[4:7], s50 offen offset:2048 sc1 lds
    buffer_load_dwordx4 v1, s[4:7], s50 offen offset:3072 sc1 lds
    s_lshr_b32 s48, s47, 1
    s_cmp_eq_u32 s48, s23
    s_cselect_b32 s48, 1, 31
    s_and_b32 s48, s48, s47
    s_add_u32 m0, s30, 55296
    s_lshl_b32 s51, s48, 7
    buffer_load_dwordx4 v8, s[8:11], s51 offen offset:0  lds
    buffer_load_dwordx4 v9, s[8:11], s51 offen offset:1024  lds
    buffer_load_dwordx4 v10, s[8:11], s51 offen offset:2048  lds
    buffer_load_dwordx4 v11, s[8:11], s51 offen offset:3072  lds
    s_add_u32 s47, s47, 4
    s_and_b32 s47, s47, 31
    s_sub_u32 s41, s41, 1
    s_cmp_lg_u32 s41, 0
    s_cbranch_scc1 L_g_ll
    s_waitcnt vmcnt(17)
    s_barrier
    s_mov_b32 s32, 0
    s_mul_i32 s32, s32, 36864
    s_add_u32 s32, s32, s43
    s_add_u32 m0, s42, 73728
    s_add_u32 s33, s32, 0
    buffer_load_dwordx4 v1, s[4:7], s33 offen offset:0  sc1 lds
    buffer_load_dwordx4 v1, s[4:7], s33 offen offset:1024  sc1 lds
    buffer_load_dwordx4 v1, s[4:7], s33 offen offset:2048  sc1 lds
    buffer_load_dwordx4 v1, s[4:7], s33 offen offset:3072  sc1 lds
    s_add_u32 m0, s42, 77824
    s_add_u32 s33, s32, 4096
    buffer_load_dwordx4 v1, s[4:7], s33 offen offset:0  sc1 lds
    buffer_load_dwordx4 v1, s[4:7], s33 offen offset:1024  sc1 lds
    buffer_load_dwordx4 v1, s[4:7], s33 offen offset:2048  sc1 lds
    buffer_load_dwordx4 v1, s[4:7], s33 offen offset:3072  sc1 lds
    s_add_u32 m0, s42, 81920
    s_add_u32 s33, s32, 8192
    buffer_load_dwordx4 v1, s[4:7], s33 offen offset:0  sc1 lds
    s_waitcnt vmcnt(9)
    s_barrier
    s_cmp_lg_u32 s22, 0
    s_cbranch_scc1 L_p5_k48
    s_add_u32 s32, s43, 110592
    buffer_load_dwordx4 v[40:43], v1, s[4:7], s32 offen offset:0 sc1
    buffer_load_dwordx4 v[44:47], v1, s[4:7], s32 offen offset:1024 sc1
    buffer_load_dwordx4 v[48:51], v1, s[4:7], s32 offen offset:2048 sc1
    buffer_load_dwordx4 v[52:55], v1, s[4:7], s32 offen offset:3072 sc1
    s_add_u32 s32, s43, 114688
    buffer_load_dwordx4 v[56:59], v1, s[4:7], s32 offen offset:0 sc1
    buffer_load_dwordx4 v[60:63], v1, s[4:7], s32 offen offset:1024 sc1
    buffer_load_dwordx4 v[64:67], v1, s[4:7], s32 offen offset:2048 sc1
    buffer_load_dwordx4 v[68:71], v1, s[4:7], s32 offen offset:3072 sc1
    s_add_u32 s32, s43, 118784
    buffer_load_dwordx4 v[72:75], v1, s[4:7], s32 offen offset:0 sc1
L_p5_k48:
    s_mov_b32 s32, 1
    s_mul_i32 s32, s32, 36864
    s_add_u32 s32, s32, s43
    s_add_u32 m0, s42, 110592
    s_add_u32 s33, s32, 0
    buffer_load_dwordx4 v1, s[4:7], s33 offen offset:0  sc1 lds
    buffer_load_dwordx4 v1, s[4:7], s33 offen offset:1024  sc1 lds
    buffer_load_dwordx4 v1, s[4:7], s33 offen offset:2048  sc1 lds
    buffer_load_dwordx4 v1, s[4:7], s33 offen offset:3072  sc1 lds
    s_add_u32 m0, s42, 114688
    s_add_u32 s33, s32, 4096
    buffer_load_dwordx4 v1, s[4:7], s33 offen offset:0  sc1 lds
    buffer_load_dwordx4 v1, s[4:7], s33 offen offset:1024  sc1 lds
    buffer_load_dwordx4 v1, s[4:7], s33 offen offset:2048  sc1 lds
    buffer_load_dwordx4 v1, s[4:7], s33 offen offset:3072  sc1 lds
    s_add_u32 m0, s42, 118784
    s_add_u32 s33, s32, 8192
    buffer_load_dwordx4 v1, s[4:7], s33 offen offset:0  sc1 lds
    s_barrier
    v_add_u32 v12, s42, v1
    v_add_u32 v13, 36864, v12
    v_add_u32 v14, 73728, v12
    v_add_u32 v15, 110592, v12
    s_waitcnt vmcnt(9)
    ds_write_b128 v13, v[40:43] offset:0
    ds_write_b128 v13, v[44:47] offset:1024
    ds_write_b128 v13, v[48:51] offset:2048
    ds_write_b128 v13, v[52:55] offset:3072
    ds_write_b128 v13, v[56:59] offset:4096
    ds_write_b128 v13, v[60:63] offset:5120
    ds_write_b128 v13, v[64:67] offset:6144
    ds_write_b128 v13, v[68:71] offset:7168
    ds_write_b128 v13, v[72:75] offset:8192
    s_lshl_b32 s33, s20, 10
    s_add_u32 s33, s33, 147456
    v_add_u32_e64 v4, s33, v1
    ds_write_b128 v4, v[108:111] offset:0
    ds_write_b128 v4, v[144:147] offset:4096
    ds_write_b128 v4, v[180:183] offset:8192
    s_barrier
    s_mov_b32 s32, 2
    s_mul_i32 s32, s32, 36864
    s_add_u32 s32, s32, s43
    s_add_u32 m0, s42, 0
    s_add_u32 s33, s32, 0
    buffer_load_dwordx4 v1, s[4:7], s33 offen offset:0  sc1 lds
    buffer_load_dwordx4 v1, s[4:7], s33 offen offset:1024  sc1 lds
    buffer_load_dwordx4 v1, s[4:7], s33 offen offset:2048  sc1 lds
    buffer_load_dwordx4 v1, s[4:7], s33 offen offset:3072  sc1 lds
    s_add_u32 m0, s42, 4096
    s_add_u32 s33, s32, 4096
    buffer_load_dwordx4 v1, s[4:7], s33 offen offset:0  sc1 lds
    buffer_load_dwordx4 v1, s[4:7], s33 offen offset:1024  sc1 lds
    buffer_load_dwordx4 v1, s[4:7], s33 offen offset:2048  sc1 lds
    buffer_load_dwordx4 v1, s[4:7], s33 offen offset:3072  sc1 lds
    s_add_u32 m0, s42, 8192
    s_add_u32 s33, s32, 8192
    buffer_load_dwordx4 v1, s[4:7], s33 offen offset:0  sc1 lds
    s_waitcnt vmcnt(18) lgkmcnt(0)
    s_barrier
    s_waitcnt vmcnt(9) lgkmcnt(15)
    s_barrier
    ds_write_b128 v14, v[76:79] offset:0
    ds_write_b128 v14, v[80:83] offset:1024
    ds_write_b128 v14, v[84:87] offset:2048
    ds_write_b128 v14, v[88:91] offset:3072
    ds_write_b128 v14, v[92:95] offset:4096
    ds_write_b128 v14, v[96:99] offset:5120
    s_waitcnt vmcnt(0) lgkmcnt(15)
    s_barrier
    ds_write_b128 v14, v[100:103] offset:6144
    ds_write_b128 v14, v[104:107] offset:7168
    ds_write_b128 v15, v[112:115] offset:0
    ds_write_b128 v15, v[116:119] offset:1024
    ds_write_b128 v15, v[120:123] offset:2048
    ds_write_b128 v15, v[124:127] offset:3072
    s_waitcnt vmcnt(63) lgkmcnt(15)
    s_barrier
    ds_write_b128 v15, v[128:131] offset:4096
    ds_write_b128 v15, v[132:135] offset:5120
    ds_write_b128 v15, v[136:139] offset:6144
    ds_write_b128 v15, v[140:143] offset:7168
    ds_write_b128 v12, v[148:151] offset:0
    ds_write_b128 v12, v[152:155] offset:1024
    s_waitcnt vmcnt(63) lgkmcnt(10)
    s_barrier
    ds_write_b128 v12, v[156:159] offset:2048
    ds_write_b128 v12, v[160:163] offset:3072
    ds_write_b128 v12, v[164:167] offset:4096
    ds_write_b128 v12, v[168:171] offset:5120
    ds_write_b128 v12, v[172:175] offset:6144
    ds_write_b128 v12, v[176:179] offset:7168
    s_waitcnt vmcnt(63) lgkmcnt(8)
    s_barrier
    ds_write_b128 v13, v[184:187] offset:0
    ds_write_b128 v13, v[188:191] offset:1024
    ds_write_b128 v13, v[192:195] offset:2048
    ds_write_b128 v13, v[196:199] offset:3072
    ds_write_b128 v13, v[200:203] offset:4096
    ds_write_b128 v13, v[204:207] offset:5120
    s_waitcnt vmcnt(63) lgkmcnt(6)
    s_barrier
    s_and_b32 s25, s2, 7
    s_lshr_b32 s26, s2, 3
    s_lshr_b32 s23, s25, 1
    s_lshl_b32 s23, s23, 2
    s_lshr_b32 s27, s26, 3
    s_add_u32 s23, s23, s27
    s_and_b32 s24, s25, 1
    s_lshl_b32 s24, s24, 3
    s_and_b32 s27, s26, 7
    s_add_u32 s24, s24, s27
    s_mul_i32 s29, s24, 129024
    s_lshl_b32 s30, s20, 12
    s_add_u32 s29, s29, s30
    s_add_u32 s29, s29, 0x3800000
    s_lshl_b32 s31, s23, 3
    s_max_u32 s31, s31, 1
    s_sub_u32 s31, s31, 1
    s_mul_i32 s31, s31, 18432
    s_add_u32 s31, s31, 0x1c00000
    s_lshl_b32 s35, s20, 10
    s_and_b32 s36, s35, 1024
    ds_write_b128 v13, v[208:211] offset:6144
    ds_write_b128 v13, v[212:215] offset:7168
    ds_write_b128 v13, v[216:219] offset:8192
    ds_write_b128 v14, v[220:223] offset:0
    ds_write_b128 v14, v[224:227] offset:1024
    ds_write_b128 v14, v[228:231] offset:2048
    s_waitcnt vmcnt(63) lgkmcnt(3)
    s_barrier
    ds_write_b128 v14, v[232:235] offset:3072
    ds_write_b128 v14, v[236:239] offset:4096
    ds_write_b128 v14, v[240:243] offset:5120
    ds_write_b128 v14, v[244:247] offset:6144
    ds_write_b128 v14, v[248:251] offset:7168
    ds_write_b128 v14, v[252:255] offset:8192
    s_waitcnt vmcnt(63) lgkmcnt(0)
    s_barrier
    s_cmp_eq_u32 s22, 1
    s_cbranch_scc1 L_m_t8
    s_add_u32 m0, s30, 0
    s_add_u32 s34, s29, 0
    buffer_load_dwordx4 v1, s[4:7], s34 offen offset:0 sc1 lds
    buffer_load_dwordx4 v1, s[4:7], s34 offen offset:1024 sc1 lds
    buffer_load_dwordx4 v1, s[4:7], s34 offen offset:2048 sc1 lds
    buffer_load_dwordx4 v1, s[4:7], s34 offen offset:3072 sc1 lds
    s_add_u32 m0, s30, 16384
    s_add_u32 s34, s29, 16384
    buffer_load_dwordx4 v1, s[4:7], s34 offen offset:0 sc1 lds
    buffer_load_dwordx4 v1, s[4:7], s34 offen offset:1024 sc1 lds
    buffer_load_dwordx4 v1, s[4:7], s34 offen offset:2048 sc1 lds
    buffer_load_dwordx4 v1, s[4:7], s34 offen offset:3072 sc1 lds
L_m_t8:
    s_cmp_eq_u32 s22, 1
    s_cbranch_scc1 L_m_lfin
    s_barrier
    s_add_u32 m0, s30, 32768
    s_add_u32 s34, s29, 32768
    buffer_load_dwordx4 v1, s[4:7], s34 offen offset:0 sc1 lds
    buffer_load_dwordx4 v1, s[4:7], s34 offen offset:1024 sc1 lds
    buffer_load_dwordx4 v1, s[4:7], s34 offen offset:2048 sc1 lds
    buffer_load_dwordx4 v1, s[4:7], s34 offen offset:3072 sc1 lds
    s_add_u32 m0, s30, 114688
    s_add_u32 s34, s29, 114688
    buffer_load_dwordx4 v1, s[4:7], s34 offen offset:0 sc1 lds
    buffer_load_dwordx4 v1, s[4:7], s34 offen offset:1024 sc1 lds
    buffer_load_dwordx4 v1, s[4:7], s34 offen offset:2048 sc1 lds
    buffer_load_dwordx4 v1, s[4:7], s34 offen offset:3072 sc1 lds
    s_mov_b32 s22, 1
    s_mov_b32 s21, 0x1c00000
    s_barrier
    s_barrier
    s_add_u32 m0, s30, 49152
    s_add_u32 s34, s29, 49152
    buffer_load_dwordx4 v1, s[4:7], s34 offen offset:0 sc1 lds
    buffer_load_dwordx4 v1, s[4:7], s34 offen offset:1024 sc1 lds
    buffer_load_dwordx4 v1, s[4:7], s34 offen offset:2048 sc1 lds
    buffer_load_dwordx4 v1, s[4:7], s34 offen offset:3072 sc1 lds
    v_lshrrev_b32 v2, 8, v1
    v_bfe_u32 v3, v1, 7, 1
    v_bfe_u32 v4, v1, 4, 3
    v_cmp_gt_u32_e64 vcc, 3, v2
    v_mul_u32_u24 v3, 80, v3
    v_lshl_add_u32 v3, v4, 3, v3
    v_lshrrev_b32 v5, 1, v4
    v_and_b32 v4, 1, v4
    v_lshl_add_u32 v4, v4, 3, 64
    v_cndmask_b32 v2, v5, v2, vcc
    v_cndmask_b32 v3, v4, v3, vcc
    v_mul_u32_u24 v2, 2304, v2
    v_add_u32 v0, v2, v3
    v_lshrrev_b32 v8, 1, v1
    s_mul_i32 s34, s24, 144
    s_add_u32 s34, s34, 0x4400000
    buffer_load_dwordx2 v[2:3], v0, s[4:7], s34 offen sc1
    s_mul_i32 s34, s24, 144
    s_add_u32 s34, s34, 0x4402000
    buffer_load_dwordx2 v[4:5], v0, s[4:7], s34 offen sc1
    s_mul_i32 s34, s24, 144
    s_add_u32 s34, s34, 0x4404000
    buffer_load_dwordx2 v[6:7], v0, s[4:7], s34 offen sc1
    s_mul_i32 s34, s24, 144
    s_add_u32 s34, s34, 0x4406000
    buffer_load_dwordx2 v[12:13], v0, s[4:7], s34 offen sc1
    s_add_u32 m0, s30, 65536
    s_add_u32 s34, s29, 65536
    buffer_load_dwordx4 v1, s[4:7], s34 offen offset:0 sc1 lds
    buffer_load_dwordx4 v1, s[4:7], s34 offen offset:1024 sc1 lds
    buffer_load_dwordx4 v1, s[4:7], s34 offen offset:2048 sc1 lds
    buffer_load_dwordx4 v1, s[4:7], s34 offen offset:3072 sc1 lds
    s_add_u32 m0, s30, 81920
    s_add_u32 s34, s29, 81920
    buffer_load_dwordx4 v1, s[4:7], s34 offen offset:0 sc1 lds
    buffer_load_dwordx4 v1, s[4:7], s34 offen offset:1024 sc1 lds
    buffer_load_dwordx4 v1, s[4:7], s34 offen offset:2048 sc1 lds
    buffer_load_dwordx4 v1, s[4:7], s34 offen offset:3072 sc1 lds
    s_barrier
    s_add_u32 m0, s35, 131072
    s_add_u32 s34, s31, s35
    s_add_u32 s34, s34, 0
    buffer_load_dwordx4 v1, s[4:7], s34 offen sc1 lds
    s_waitcnt vmcnt(29) lgkmcnt(0)
    s_barrier
    s_add_u32 m0, s35, 135168
    s_add_u32 s34, s31, s35
    s_add_u32 s34, s34, 4096
    buffer_load_dwordx4 v1, s[4:7], s34 offen sc1 lds
    s_waitcnt vmcnt(1) lgkmcnt(0)
    s_barrier
    s_add_u32 m0, s35, 139264
    s_add_u32 s34, s31, s35
    s_add_u32 s34, s34, 8192
    buffer_load_dwordx4 v1, s[4:7], s34 offen sc1 lds
    s_waitcnt vmcnt(2) lgkmcnt(0)
    s_barrier
    s_add_u32 m0, s35, 143360
    s_add_u32 s34, s31, s35
    s_add_u32 s34, s34, 12288
    buffer_load_dwordx4 v1, s[4:7], s34 offen sc1 lds
    s_add_u32 m0, s30, 98304
    s_add_u32 s34, s29, 98304
    buffer_load_dwordx4 v1, s[4:7], s34 offen offset:0 sc1 lds
    buffer_load_dwordx4 v1, s[4:7], s34 offen offset:1024 sc1 lds
    buffer_load_dwordx4 v1, s[4:7], s34 offen offset:2048 sc1 lds
    buffer_load_dwordx4 v1, s[4:7], s34 offen offset:3072 sc1 lds
    s_waitcnt vmcnt(6) lgkmcnt(0)
    s_barrier
    s_add_u32 m0, s36, 147456
    s_add_u32 s34, s31, s36
    s_add_u32 s34, s34, 16384
    buffer_load_dwordx4 v1, s[4:7], s34 offen sc1 lds
    v_add_f32 v2, v2, v4
    v_add_f32 v3, v3, v5
    v_add_f32 v6, v6, v12
    v_add_f32 v7, v7, v13
    v_add_f32 v2, v2, v6
    v_add_f32_e64 v3, v3, v7
    v_cmp_gt_u32 vcc, 864, v1
    v_add_u32 v8, 161792, v8
    s_nop 0
    v_cndmask_b32 v2, 0, v2, vcc
    v_cndmask_b32_e64 v3, 0, v3, vcc
    ds_write_b64 v8, v[2:3]
    s_waitcnt vmcnt(6) lgkmcnt(0)
    s_barrier
    s_waitcnt vmcnt(6) lgkmcnt(0)
    s_barrier
    s_waitcnt vmcnt(1) lgkmcnt(0)
    s_barrier
    s_waitcnt vmcnt(0) lgkmcnt(0)
    s_barrier
    s_barrier
    s_branch L_m_ll
L_m_lfin:
L_end_m:
    s_endpgm

.section .rodata,"a"
.p2align 6
.amdhsa_kernel interleave_layers__sliding_local_dilated__mixer_gmlp__prompt_kernel
  .amdhsa_next_free_vgpr 256
  .amdhsa_next_free_sgpr 102
  .amdhsa_accum_offset 256
  .amdhsa_group_segment_fixed_size 0
  .amdhsa_kernarg_size 88
  .amdhsa_user_sgpr_count 2
  .amdhsa_user_sgpr_kernarg_segment_ptr 1
  .amdhsa_system_sgpr_workgroup_id_x 1
  .amdhsa_float_denorm_mode_32 3
.end_amdhsa_kernel
```
